```python
import torch

def _softmax(x, axis=-1):
    return torch.softmax(x, dim=axis)

def _gelu(x):
    return torch.nn.functional.gelu(x, approximate='tanh')

def _silu(x):
    return torch.nn.functional.silu(x)

def _sigmoid(x):
    return torch.sigmoid(x)

def _layernorm(x, axis=-1, eps=1e-05):
    m = x.mean(dim=axis, keepdim=True)
    v = x.var(dim=axis, keepdim=True, unbiased=False)
    return (x - m) / torch.sqrt(v + eps)

def _scatter_add(tgt, idx, src, axis=0):
    return tgt.clone().index_add_(axis, idx, src)

def _segment_sum(src, seg, n):
    out = torch.zeros((n,) + src.shape[1:], dtype=src.dtype)
    return out.index_add_(0, seg, src)

def _pad(x, pw):
    flat = tuple((v for pair in reversed(pw) for v in pair))
    return torch.nn.functional.pad(x, flat)
kernel_name = 'sequential_preLN__memory_aug_recurrent_mem_tr__moe_arch_mod__prompt'

def setup_inputs():

    _w = lambda a: (lambda t: t.to(torch.bfloat16) if t.is_floating_point() else t)(torch.as_tensor(a))

    def _A_setup():
        B, S, Dm = (1, 2048, 512)
        H, Dh = (32, 128)
        M, seg = (8, 32)
        seg = min(seg, S)
        S = S // seg * seg
        return {'x': _w((lambda *s: torch.randn(*s, dtype=torch.bfloat16) * 0.05)(B, S, Dm)), 'mem0': _w((lambda *s: torch.randn(*s, dtype=torch.bfloat16) * 0.2)(B, M, Dm)), 'Wq': _w((lambda *s: torch.randn(*s, dtype=torch.bfloat16) * 1.6)(Dm, H, Dh) * Dm ** (-0.5)), 'Wk': _w((lambda *s: torch.randn(*s, dtype=torch.bfloat16) * 1.6)(Dm, H, Dh) * Dm ** (-0.5)), 'Wv': _w((lambda *s: torch.randn(*s, dtype=torch.bfloat16) * 0.2)(Dm, H, Dh) * Dm ** (-0.5)), 'Wo': _w((lambda *s: torch.randn(*s, dtype=torch.bfloat16) * 0.2)(H, Dh, Dm) * (H * Dh) ** (-0.5)), 'seg_len': seg}
    _A_in = _A_setup()

    def _B_setup():
        B, S, D, F, C = (1, 2048, 512, 1792, 2)
        return {'x': _w((lambda *s: torch.randn(*s, dtype=torch.bfloat16) * 0.05)(B, S, D)), 'w_r': _w((lambda *s: torch.randn(*s, dtype=torch.bfloat16) * 0.05)(D)), 'w_gate': _w((lambda *s: torch.randn(*s, dtype=torch.bfloat16) * 0.05)(D, F)), 'w_up': _w((lambda *s: torch.randn(*s, dtype=torch.bfloat16) * 0.05)(D, F)), 'w_down': _w((lambda *s: torch.randn(*s, dtype=torch.bfloat16) * 0.05)(F, D))}
    _B_in = _B_setup()
    return {'A_x': _A_in['x'], 'A_mem0': _A_in['mem0'], 'A_Wq': _A_in['Wq'], 'A_Wk': _A_in['Wk'], 'A_Wv': _A_in['Wv'], 'A_Wo': _A_in['Wo'], 'A_seg_len': _A_in['seg_len'], 'B_x': _B_in['x'], 'B_w_r': _B_in['w_r'], 'B_w_gate': _B_in['w_gate'], 'B_w_up': _B_in['w_up'], 'B_w_down': _B_in['w_down']}

def reference(A_x, A_mem0, A_Wq, A_Wk, A_Wv, A_Wo, A_seg_len, B_x, B_w_r, B_w_gate, B_w_up, B_w_down):

    def _A_ref(x, mem0, Wq, Wk, Wv, Wo, seg_len):
        B, S, Dm = x.shape
        H, Dh = (Wq.shape[1], Wq.shape[2])
        M = mem0.shape[1]
        scale = Dh ** (-0.5)
        n_seg = S // seg_len
        L = M + seg_len
        idx = torch.arange(L)
        mask = (idx[:, None] < M) | (idx[:, None] >= idx[None, :])
        mem = mem0
        outs = []
        for s in range(n_seg):
            xs = x[:, s * seg_len:(s + 1) * seg_len, :].clone()
            h = torch.concatenate([mem, xs], axis=1)
            q = torch.einsum('btd,dhe->bhte', h, Wq)
            k = torch.einsum('btd,dhe->bhte', h, Wk)
            v = torch.einsum('btd,dhe->bhte', h, Wv)
            scores = torch.einsum('bhqe,bhke->bhqk', q, k) * scale
            scores = torch.where(mask[None, None], scores, -1000000000.0)
            p = _softmax(scores, axis=-1)
            o = torch.einsum('bhqk,bhke->bhqe', p, v)
            o = torch.einsum('bhte,hed->btd', o, Wo)
            mem = o[:, :M, :].clone()
            outs.append(o[:, M:, :])
        return torch.concatenate(outs, axis=1)

    def _B_ref(x, w_r, w_gate, w_up, w_down):
        B, S, D = x.shape
        C = 2
        r = x @ w_r
        idx = torch.argsort(-r, axis=-1)[:, :C]
        idx_e = (lambda x, n, axis: torch.repeat_interleave(x, n, dim=axis))(idx.reshape(B, C, 1), D, axis=2)
        x_sel = (lambda x, i, axis: torch.take_along_dim(x, i, dim=axis))(x, idx_e, axis=1)
        g = _silu(x_sel @ w_gate)
        u = x_sel @ w_up
        y = g * u @ w_down
        r_sel = _sigmoid((lambda x, i, axis: torch.take_along_dim(x, i, dim=axis))(r, idx, axis=1))
        y = y * r_sel.reshape(B, C, 1)
        b_off = (torch.arange(B) * S).reshape(B, 1)
        flat_idx = (idx + b_off).reshape(B * C)
        zero = (x * 0.0).reshape(B * S, D)
        upd = _scatter_add(zero, flat_idx, y.reshape(B * C, D), axis=0)
        return x + upd.reshape(B, S, D)
    x = A_x
    h = x + _A_ref(_layernorm(x, axis=-1), A_mem0, A_Wq, A_Wk, A_Wv, A_Wo, A_seg_len)
    h2 = h + _B_ref(_layernorm(h, axis=-1), B_w_r, B_w_gate, B_w_up, B_w_down)
    return h2
```

```asm
; @launch grid=(256,1,1) block=(256,1,1) lds=163840
.amdgcn_target "amdgcn-amd-amdhsa--gfx950"
.text
.globl sequential_preLN__memory_aug_recurrent_mem_tr__moe_arch_mod__prompt_kernel
.p2align 8
.type sequential_preLN__memory_aug_recurrent_mem_tr__moe_arch_mod__prompt_kernel,@function
sequential_preLN__memory_aug_recurrent_mem_tr__moe_arch_mod__prompt_kernel:
    s_cmp_ge_u32 s2, 256
    s_cbranch_scc1 L_exit
    s_load_dwordx2 s[8:9], s[0:1], 112
    s_waitcnt lgkmcnt(0)
    s_and_b32 s9, s9, 0xffff
    s_mov_b32 s10, 0x10000000
    s_mov_b32 s11, 0x20000
    s_load_dwordx2 s[92:93], s[0:1], 104
    s_waitcnt lgkmcnt(0)
    s_and_b32 s93, s93, 0xffff
    s_mov_b32 s94, 0x100
    s_mov_b32 s95, 0x20000
    v_lshrrev_b32 v1, 6, v0
    s_nop 0
    v_readfirstlane_b32 s100, v1
    s_getreg_b32 s84, hwreg(HW_REG_XCC_ID)
    s_and_b32 s84, s84, 7
    s_lshl_b32 s97, s84, 4
    s_add_u32 s97, s97, 64
    s_cmp_lg_u32 s100, 0
    s_cbranch_scc1 L_at_1
    s_mov_b64 exec, 1
    v_mov_b32 v2, 1
    buffer_atomic_add v2, off, s[92:95], s97 sc0
    s_mov_b64 exec, -1
L_at_1:
    s_load_dwordx4 s[20:23], s[0:1], 16
    s_load_dwordx4 s[24:27], s[0:1], 32
    v_lshlrev_b32 v3, 6, v0
    s_lshl_b32 s28, s2, 14
    s_cmp_eq_u32 s84, 0
    s_cselect_b32 s14, 0, 0x400000
    s_mov_b32 s15, 0x20000
    s_waitcnt lgkmcnt(0)
    s_mov_b32 s12, s20
    s_and_b32 s13, s21, 0xffff
    buffer_load_dword v255, v3, s[12:15], s28 offen
    s_mov_b32 s12, s22
    s_and_b32 s13, s23, 0xffff
    buffer_load_dword v255, v3, s[12:15], s28 offen
    s_mov_b32 s12, s24
    s_and_b32 s13, s25, 0xffff
    buffer_load_dword v255, v3, s[12:15], s28 offen
    s_mov_b32 s12, s26
    s_and_b32 s13, s27, 0xffff
    buffer_load_dword v255, v3, s[12:15], s28 offen
    s_cmp_lg_u32 s100, 0
    s_cbranch_scc1 L_at2_2
    s_mov_b64 exec, 1
    v_mov_b32 v1, 0
    s_waitcnt vmcnt(4)
    ds_write_b32 v1, v2
    s_waitcnt lgkmcnt(0)
    s_mov_b64 exec, -1
L_at2_2:
    s_barrier
    v_mov_b32 v1, 0
    ds_read_b32 v2, v1
    s_waitcnt lgkmcnt(0)
    v_readfirstlane_b32 s85, v2
    s_mov_b32 s87, 0
    s_cmp_lg_u32 s2, 0
    s_cbranch_scc1 L_noz
    v_mov_b32 v4, 0
    v_mov_b32 v5, 0
    v_mov_b32 v6, 0
    v_mov_b32 v7, 0
    v_lshlrev_b32 v1, 4, v0
    s_mov_b32 s97, 0x0
    buffer_store_dwordx4 v[4:7], v1, s[8:11], s97 offen sc1
    s_mov_b32 s97, 0x1000
    buffer_store_dwordx4 v[4:7], v1, s[8:11], s97 offen sc1
    s_mov_b32 s97, 0x2000
    buffer_store_dwordx4 v[4:7], v1, s[8:11], s97 offen sc1
    s_mov_b32 s97, 0x3000
    buffer_store_dwordx4 v[4:7], v1, s[8:11], s97 offen sc1
    s_mov_b32 s97, 0x4000
    buffer_store_dwordx4 v[4:7], v1, s[8:11], s97 offen sc1
    s_mov_b32 s97, 0x5000
    buffer_store_dwordx4 v[4:7], v1, s[8:11], s97 offen sc1
    s_mov_b32 s97, 0x6000
    buffer_store_dwordx4 v[4:7], v1, s[8:11], s97 offen sc1
    s_mov_b32 s97, 0x7000
    buffer_store_dwordx4 v[4:7], v1, s[8:11], s97 offen sc1
    s_mov_b32 s97, 0x8000
    buffer_store_dwordx4 v[4:7], v1, s[8:11], s97 offen sc1
    s_waitcnt vmcnt(0)
    s_barrier
    s_cmp_lg_u32 s100, 0
    s_cbranch_scc1 L_flag_3
    v_mov_b32 v2, 1
    s_mov_b64 exec, 1
    buffer_store_dword v2, off, s[92:95], 40 sc1
    s_mov_b64 exec, -1
L_flag_3:
L_noz:
    s_cmp_lg_u32 s85, 31
    s_cbranch_scc1 L_nod
    s_cmp_lg_u32 s100, 0
    s_cbranch_scc1 L_nod
    s_mov_b64 exec, 1
    v_mov_b32 v2, 1
    buffer_atomic_add v2, off, s[92:95], 0 offset:32 sc0
    s_waitcnt vmcnt(0)
    v_readfirstlane_b32 s86, v2
    s_nop 0
    s_cmp_lg_u32 s86, 7
    s_cbranch_scc1 L_nod2
    v_mov_b32 v2, 1
    v_mov_b32 v3, 0
    buffer_atomic_cmpswap v[2:3], off, s[92:95], 0 offset:36
L_nod2:
    s_mov_b64 exec, -1
L_nod:
    s_cmp_ge_u32 s85, 32
    s_cbranch_scc1 L_odd
    s_cmp_lg_u32 s84, 0
    s_cbranch_scc1 L_other
    s_mov_b32 s20, s85
    s_mov_b32 s16, s92
    s_mov_b32 s17, s93
    s_mov_b32 s18, s94
    s_mov_b32 s19, s95
    s_mov_b32 s88, s20
    v_lshrrev_b32 v4, 6, v0
    s_nop 0
    v_readfirstlane_b32 s21, v4
    v_and_b32 v1, 63, v0
    v_lshrrev_b32 v2, 4, v1
    v_and_b32 v3, 15, v1
    v_lshrrev_b32 v6, 2, v3
    v_lshlrev_b32 v117, 4, v1
    s_lshl_b32 s51, s21, 10
    s_lshl_b32 s52, s21, 11
    s_load_dwordx8 s[60:67], s[0:1], 16
    s_mov_b32 s14, 0x400000
    s_mov_b32 s15, 0x20000
    s_lshl_b32 s41, s20, 8
    s_lshl_b32 s42, s20, 17
    s_lshr_b32 s43, s21, 1
    s_lshl_b32 s43, s43, 2
    v_or_b32 v5, s43, v2
    v_lshlrev_b32 v5, 1, v5
    v_xor_b32 v5, v5, v3
    v_lshrrev_b32 v14, 2, v5
    v_lshlrev_b32 v5, 4, v5
    s_lshl_b32 s43, s21, 4
    v_add_u32 v4, s43, v2
    v_lshl_add_u32 v8, v4, 13, v5
    s_waitcnt lgkmcnt(0)
    s_mov_b32 s12, s60
    s_and_b32 s13, s61, 0xffff
    v_xor_b32 v15, 1, v14
    v_lshl_add_u32 v15, v15, 15, v8
    s_add_u32 s43, s41, 0x0
    s_add_u32 m0, s51, 0x8000
    s_nop 0
    buffer_load_dwordx4 v15, s[12:15], s43 offen lds
    s_add_u32 s43, s41, 0x80000
    s_add_u32 m0, s51, 0x9000
    s_nop 0
    buffer_load_dwordx4 v15, s[12:15], s43 offen lds
    s_add_u32 s43, s41, 0x100000
    s_add_u32 m0, s51, 0xa000
    s_nop 0
    buffer_load_dwordx4 v15, s[12:15], s43 offen lds
    s_add_u32 s43, s41, 0x180000
    s_add_u32 m0, s51, 0xb000
    s_nop 0
    buffer_load_dwordx4 v15, s[12:15], s43 offen lds
    s_add_u32 s43, s41, 0x200000
    s_add_u32 m0, s51, 0xc000
    s_nop 0
    buffer_load_dwordx4 v15, s[12:15], s43 offen lds
    s_add_u32 s43, s41, 0x280000
    s_add_u32 m0, s51, 0xd000
    s_nop 0
    buffer_load_dwordx4 v15, s[12:15], s43 offen lds
    s_add_u32 s43, s41, 0x300000
    s_add_u32 m0, s51, 0xe000
    s_nop 0
    buffer_load_dwordx4 v15, s[12:15], s43 offen lds
    s_add_u32 s43, s41, 0x380000
    s_add_u32 m0, s51, 0xf000
    s_nop 0
    buffer_load_dwordx4 v15, s[12:15], s43 offen lds
    v_xor_b32 v15, 2, v14
    v_lshl_add_u32 v15, v15, 15, v8
    s_add_u32 s43, s41, 0x0
    s_add_u32 m0, s51, 0x10000
    s_nop 0
    buffer_load_dwordx4 v15, s[12:15], s43 offen lds
    s_add_u32 s43, s41, 0x80000
    s_add_u32 m0, s51, 0x11000
    s_nop 0
    buffer_load_dwordx4 v15, s[12:15], s43 offen lds
    s_add_u32 s43, s41, 0x100000
    s_add_u32 m0, s51, 0x12000
    s_nop 0
    buffer_load_dwordx4 v15, s[12:15], s43 offen lds
    s_add_u32 s43, s41, 0x180000
    s_add_u32 m0, s51, 0x13000
    s_nop 0
    buffer_load_dwordx4 v15, s[12:15], s43 offen lds
    s_add_u32 s43, s41, 0x200000
    s_add_u32 m0, s51, 0x14000
    s_nop 0
    buffer_load_dwordx4 v15, s[12:15], s43 offen lds
    s_add_u32 s43, s41, 0x280000
    s_add_u32 m0, s51, 0x15000
    s_nop 0
    buffer_load_dwordx4 v15, s[12:15], s43 offen lds
    s_add_u32 s43, s41, 0x300000
    s_add_u32 m0, s51, 0x16000
    s_nop 0
    buffer_load_dwordx4 v15, s[12:15], s43 offen lds
    s_add_u32 s43, s41, 0x380000
    s_add_u32 m0, s51, 0x17000
    s_nop 0
    buffer_load_dwordx4 v15, s[12:15], s43 offen lds
    v_xor_b32 v15, 3, v14
    v_lshl_add_u32 v15, v15, 15, v8
    s_add_u32 s43, s41, 0x0
    s_add_u32 m0, s51, 0x18000
    s_nop 0
    buffer_load_dwordx4 v15, s[12:15], s43 offen lds
    s_add_u32 s43, s41, 0x80000
    s_add_u32 m0, s51, 0x19000
    s_nop 0
    buffer_load_dwordx4 v15, s[12:15], s43 offen lds
    s_add_u32 s43, s41, 0x100000
    s_add_u32 m0, s51, 0x1a000
    s_nop 0
    buffer_load_dwordx4 v15, s[12:15], s43 offen lds
    s_add_u32 s43, s41, 0x180000
    s_add_u32 m0, s51, 0x1b000
    s_nop 0
    buffer_load_dwordx4 v15, s[12:15], s43 offen lds
    s_add_u32 s43, s41, 0x200000
    s_add_u32 m0, s51, 0x1c000
    s_nop 0
    buffer_load_dwordx4 v15, s[12:15], s43 offen lds
    s_add_u32 s43, s41, 0x280000
    s_add_u32 m0, s51, 0x1d000
    s_nop 0
    buffer_load_dwordx4 v15, s[12:15], s43 offen lds
    s_add_u32 s43, s41, 0x300000
    s_add_u32 m0, s51, 0x1e000
    s_nop 0
    buffer_load_dwordx4 v15, s[12:15], s43 offen lds
    s_add_u32 s43, s41, 0x380000
    s_add_u32 m0, s51, 0x1f000
    s_nop 0
    buffer_load_dwordx4 v15, s[12:15], s43 offen lds
    s_mov_b32 s12, s62
    s_and_b32 s13, s63, 0xffff
    v_xor_b32 v15, 1, v14
    v_lshl_add_u32 v15, v15, 15, v8
    s_add_u32 s43, s41, 0x0
    s_add_u32 m0, s51, 0x20000
    s_nop 0
    buffer_load_dwordx4 v15, s[12:15], s43 offen lds
    s_add_u32 s43, s41, 0x80000
    s_add_u32 m0, s51, 0x21000
    s_nop 0
    buffer_load_dwordx4 v15, s[12:15], s43 offen lds
    s_add_u32 s43, s41, 0x100000
    s_add_u32 m0, s51, 0x22000
    s_nop 0
    buffer_load_dwordx4 v15, s[12:15], s43 offen lds
    s_add_u32 s43, s41, 0x180000
    s_add_u32 m0, s51, 0x23000
    s_nop 0
    buffer_load_dwordx4 v15, s[12:15], s43 offen lds
    s_add_u32 s43, s41, 0x200000
    s_add_u32 m0, s51, 0x24000
    s_nop 0
    buffer_load_dwordx4 v15, s[12:15], s43 offen lds
    s_add_u32 s43, s41, 0x280000
    s_add_u32 m0, s51, 0x25000
    s_nop 0
    buffer_load_dwordx4 v15, s[12:15], s43 offen lds
    s_add_u32 s43, s41, 0x300000
    s_add_u32 m0, s51, 0x26000
    s_nop 0
    buffer_load_dwordx4 v15, s[12:15], s43 offen lds
    s_add_u32 s43, s41, 0x380000
    s_add_u32 m0, s51, 0x27000
    s_nop 0
    buffer_load_dwordx4 v15, s[12:15], s43 offen lds
    v_and_b32 v4, 2, v3
    v_cmp_ne_u32 vcc, 0, v4
    v_mov_b32 v4, 0x4444
    v_mov_b32 v5, 0xeeee
    v_cndmask_b32 v116, v4, v5, vcc
    v_lshrrev_b32 v5, 1, v2
    v_lshl_add_u32 v4, v6, 3, v5
    s_lshl_b32 s43, s21, 1
    v_add_u32 v4, s43, v4
    v_add_u32 v5, s20, v4
    v_and_b32 v5, 31, v5
    v_lshl_add_u32 v4, v4, 6, v5
    v_and_b32 v5, 1, v2
    v_lshl_add_u32 v4, v4, 1, v5
    v_and_b32 v5, 3, v3
    v_lshl_add_u32 v4, v4, 2, v5
    v_lshlrev_b32 v118, 4, v4
    v_and_b32 v4, 1, v2
    v_lshlrev_b32 v4, 2, v4
    v_and_b32 v7, 2, v2
    v_add_u32 v4, v4, v7
    v_and_b32 v7, 1, v6
    v_add_u32 v4, v4, v7
    v_lshl_add_u32 v4, v4, 2, v5
    v_lshlrev_b32 v4, 2, v4
    s_and_b32 s43, s21, 1
    s_lshl_b32 s43, s43, 12
    s_lshl_b32 s40, s20, 7
    s_add_u32 s43, s43, s40
    v_add_u32 v119, s43, v4
    v_xor_b32 v7, v2, v6
    v_lshl_add_u32 v4, v2, 4, v7
    v_and_b32 v5, 3, v3
    v_lshl_add_u32 v4, v4, 2, v5
    v_lshl_add_u32 v120, v4, 2, s51
    v_lshl_add_u32 v4, v3, 2, v7
    v_lshlrev_b32 v121, 4, v4
    v_and_b32 v5, 1, v3
    v_lshl_add_u32 v4, v6, 1, v5
    v_lshl_add_u32 v4, v2, 3, v4
    v_lshlrev_b32 v127, 4, v4
    v_and_or_b32 v122, v116, 8, v127
    s_lshl_b32 s43, s21, 13
    s_add_u32 s43, s43, 32768
    v_add_u32 v123, s43, v117
    v_add_u32 v124, 0x10000, v123
    s_mov_b32 s36, 0xcccccccc
    s_mov_b32 s37, 0xcccccccc
    s_mov_b32 s38, 0x00ff00ff
    s_mov_b32 s39, 0x00ff00ff
    s_mov_b32 s34, 0x3e0293ee
    s_mov_b32 s35, 0x49800000
    s_mov_b32 s50, 0x3f803f80
    v_and_b32 v5, 1, v2
    v_or_b32 v5, 0, v5
    v_xor_b32 v5, v5, v6
    v_lshlrev_b32 v5, 8, v5
    v_and_b32 v7, 3, v3
    v_lshl_add_u32 v7, v7, 4, v5
    s_lshl_b32 s43, s21, 2
    v_add_u32 v4, s43, v2
    v_lshl_add_u32 v10, v4, 10, v7
    v_and_b32 v5, 1, v2
    v_or_b32 v5, 2, v5
    v_xor_b32 v5, v5, v6
    v_lshlrev_b32 v5, 8, v5
    v_and_b32 v7, 3, v3
    v_lshl_add_u32 v7, v7, 4, v5
    s_lshl_b32 s43, s21, 2
    v_add_u32 v4, s43, v2
    v_lshl_add_u32 v9, v4, 10, v7
    v_and_b32 v5, 1, v2
    v_lshl_add_u32 v4, v5, 3, v6
    v_lshrrev_b32 v7, 1, v2
    v_lshl_add_u32 v4, v7, 5, v4
    v_lshlrev_b32 v4, 8, v4
    v_lshl_or_b32 v5, v5, 2, v6
    v_lshlrev_b32 v5, 5, v5
    s_lshl_b32 s43, s21, 6
    v_xor_b32 v5, s43, v5
    v_add_u32 v4, v4, v5
    v_and_b32 v5, 3, v3
    v_lshl_add_u32 v4, v5, 3, v4
    v_add_u32 v11, 32768, v4
    v_and_b32 v5, 1, v2
    v_lshlrev_b32 v4, 4, v5
    v_lshl_add_u32 v4, v7, 2, v4
    v_and_b32 v7, 1, v6
    v_add_u32 v4, v4, v7
    s_lshl_b32 s43, s21, 5
    v_add_u32 v4, s43, v4
    v_lshlrev_b32 v4, 8, v4
    v_lshl_or_b32 v5, v5, 1, v7
    v_xor_b32 v5, s21, v5
    v_lshl_add_u32 v4, v5, 6, v4
    v_lshrrev_b32 v5, 1, v6
    v_lshl_add_u32 v4, v5, 5, v4
    v_and_b32 v5, 3, v3
    v_lshl_add_u32 v4, v5, 3, v4
    v_add_u32 v12, 32768, v4
    v_mov_b32 v16, -1
    v_mov_b32 v17, -1
    v_mov_b32 v18, -1
    v_mov_b32 v19, -1
    s_lshl_b32 s43, s20, 13
    s_add_u32 s43, s43, 0x100000
    s_and_b32 s40, s21, 1
    s_lshl_b32 s40, s40, 12
    s_add_u32 s29, s43, s40
    s_add_u32 s43, s43, s52
    s_xor_b32 s40, s43, 0x40000
    buffer_store_dwordx4 v[16:19], v117, s[8:11], s43 offen
    buffer_store_dwordx4 v[16:19], v117, s[8:11], s43 offen offset:1024
    buffer_store_dwordx4 v[16:19], v117, s[8:11], s40 offen
    buffer_store_dwordx4 v[16:19], v117, s[8:11], s40 offen offset:1024
    s_mov_b32 s43, 0x12000
    buffer_store_dword v16, v119, s[8:11], s43 offen
    s_mov_b32 s43, 0x14000
    buffer_store_dword v16, v119, s[8:11], s43 offen
    s_mov_b32 s43, 0x16000
    buffer_store_dword v16, v119, s[8:11], s43 offen
    s_load_dwordx2 s[4:5], s[0:1], 8
    s_waitcnt lgkmcnt(0)
    s_and_b32 s5, s5, 0xffff
    s_mov_b32 s6, 8192
    s_mov_b32 s7, 0x20000
    v_and_b32 v20, 1, v2
    v_and_b32 v21, 1, v6
    v_lshl_add_u32 v20, v20, 1, v21
    v_lshlrev_b32 v20, 9, v20
    v_and_b32 v21, 3, v3
    v_lshl_add_u32 v20, v21, 4, v20
    v_and_b32 v21, 2, v2
    v_add_u32 v20, v20, v21
    s_and_b32 s43, s20, 1
    s_lshl_b32 s43, s43, 11
    s_bfe_u32 s40, s20, 0x20001
    s_lshl_b32 s40, s40, 7
    s_add_u32 s43, s43, s40
    s_and_b32 s40, s21, 1
    s_lshl_b32 s40, s40, 6
    s_add_u32 s43, s43, s40
    s_lshr_b32 s40, s20, 3
    s_lshl_b32 s40, s40, 2
    s_add_u32 s43, s43, s40
    v_add_u32 v20, s43, v20
    v_lshlrev_b32 v20, 1, v20
    buffer_load_dword v21, v20, s[4:7], 0 offen
    s_waitcnt vmcnt(32)
    s_barrier
    v_xor_b32 v13, 0, v11
    v_add_u32 v13, 0x0, v13
    ds_read_b64_tr_b16 a[0:1], v13
    ds_read_b64_tr_b16 a[2:3], v13 offset:1024
    ds_read_b64_tr_b16 a[4:5], v13 offset:16384
    ds_read_b64_tr_b16 a[6:7], v13 offset:17408
    ds_read_b64_tr_b16 a[16:17], v13 offset:4096
    ds_read_b64_tr_b16 a[18:19], v13 offset:5120
    ds_read_b64_tr_b16 a[20:21], v13 offset:20480
    ds_read_b64_tr_b16 a[22:23], v13 offset:21504
    s_waitcnt lgkmcnt(0)
    v_xor_b32 v13, 32, v11
    v_add_u32 v13, 0x0, v13
    ds_read_b64_tr_b16 a[8:9], v13
    ds_read_b64_tr_b16 a[10:11], v13 offset:1024
    ds_read_b64_tr_b16 a[12:13], v13 offset:16384
    ds_read_b64_tr_b16 a[14:15], v13 offset:17408
    ds_read_b64_tr_b16 a[24:25], v13 offset:4096
    ds_read_b64_tr_b16 a[26:27], v13 offset:5120
    ds_read_b64_tr_b16 a[28:29], v13 offset:20480
    ds_read_b64_tr_b16 a[30:31], v13 offset:21504
    s_waitcnt lgkmcnt(0)
    s_barrier
    v_xor_b32 v15, 2, v14
    v_lshl_add_u32 v15, v15, 15, v8
    s_add_u32 s43, s41, 0x0
    s_add_u32 m0, s51, 0x8000
    s_nop 0
    buffer_load_dwordx4 v15, s[12:15], s43 offen lds
    s_add_u32 s43, s41, 0x80000
    s_add_u32 m0, s51, 0x9000
    s_nop 0
    buffer_load_dwordx4 v15, s[12:15], s43 offen lds
    s_add_u32 s43, s41, 0x100000
    s_add_u32 m0, s51, 0xa000
    s_nop 0
    buffer_load_dwordx4 v15, s[12:15], s43 offen lds
    s_add_u32 s43, s41, 0x180000
    s_add_u32 m0, s51, 0xb000
    s_nop 0
    buffer_load_dwordx4 v15, s[12:15], s43 offen lds
    s_add_u32 s43, s41, 0x200000
    s_add_u32 m0, s51, 0xc000
    s_nop 0
    buffer_load_dwordx4 v15, s[12:15], s43 offen lds
    s_add_u32 s43, s41, 0x280000
    s_add_u32 m0, s51, 0xd000
    s_nop 0
    buffer_load_dwordx4 v15, s[12:15], s43 offen lds
    s_add_u32 s43, s41, 0x300000
    s_add_u32 m0, s51, 0xe000
    s_nop 0
    buffer_load_dwordx4 v15, s[12:15], s43 offen lds
    s_add_u32 s43, s41, 0x380000
    s_add_u32 m0, s51, 0xf000
    s_nop 0
    buffer_load_dwordx4 v15, s[12:15], s43 offen lds
    s_waitcnt vmcnt(32)
    s_barrier
    v_xor_b32 v13, 0, v11
    v_add_u32 v13, 0x8000, v13
    ds_read_b64_tr_b16 a[32:33], v13
    ds_read_b64_tr_b16 a[34:35], v13 offset:1024
    ds_read_b64_tr_b16 a[36:37], v13 offset:16384
    ds_read_b64_tr_b16 a[38:39], v13 offset:17408
    ds_read_b64_tr_b16 a[48:49], v13 offset:4096
    ds_read_b64_tr_b16 a[50:51], v13 offset:5120
    ds_read_b64_tr_b16 a[52:53], v13 offset:20480
    ds_read_b64_tr_b16 a[54:55], v13 offset:21504
    s_waitcnt lgkmcnt(0)
    v_xor_b32 v13, 32, v11
    v_add_u32 v13, 0x8000, v13
    ds_read_b64_tr_b16 a[40:41], v13
    ds_read_b64_tr_b16 a[42:43], v13 offset:1024
    ds_read_b64_tr_b16 a[44:45], v13 offset:16384
    ds_read_b64_tr_b16 a[46:47], v13 offset:17408
    ds_read_b64_tr_b16 a[56:57], v13 offset:4096
    ds_read_b64_tr_b16 a[58:59], v13 offset:5120
    ds_read_b64_tr_b16 a[60:61], v13 offset:20480
    ds_read_b64_tr_b16 a[62:63], v13 offset:21504
    s_waitcnt lgkmcnt(0)
    s_barrier
    v_xor_b32 v15, 3, v14
    v_lshl_add_u32 v15, v15, 15, v8
    s_add_u32 s43, s41, 0x0
    s_add_u32 m0, s51, 0x10000
    s_nop 0
    buffer_load_dwordx4 v15, s[12:15], s43 offen lds
    s_add_u32 s43, s41, 0x80000
    s_add_u32 m0, s51, 0x11000
    s_nop 0
    buffer_load_dwordx4 v15, s[12:15], s43 offen lds
    s_add_u32 s43, s41, 0x100000
    s_add_u32 m0, s51, 0x12000
    s_nop 0
    buffer_load_dwordx4 v15, s[12:15], s43 offen lds
    s_add_u32 s43, s41, 0x180000
    s_add_u32 m0, s51, 0x13000
    s_nop 0
    buffer_load_dwordx4 v15, s[12:15], s43 offen lds
    s_add_u32 s43, s41, 0x200000
    s_add_u32 m0, s51, 0x14000
    s_nop 0
    buffer_load_dwordx4 v15, s[12:15], s43 offen lds
    s_add_u32 s43, s41, 0x280000
    s_add_u32 m0, s51, 0x15000
    s_nop 0
    buffer_load_dwordx4 v15, s[12:15], s43 offen lds
    s_add_u32 s43, s41, 0x300000
    s_add_u32 m0, s51, 0x16000
    s_nop 0
    buffer_load_dwordx4 v15, s[12:15], s43 offen lds
    s_add_u32 s43, s41, 0x380000
    s_add_u32 m0, s51, 0x17000
    s_nop 0
    buffer_load_dwordx4 v15, s[12:15], s43 offen lds
    s_waitcnt vmcnt(32)
    s_barrier
    v_xor_b32 v13, 0, v11
    v_add_u32 v13, 0x10000, v13
    ds_read_b64_tr_b16 a[64:65], v13
    ds_read_b64_tr_b16 a[66:67], v13 offset:1024
    ds_read_b64_tr_b16 a[68:69], v13 offset:16384
    ds_read_b64_tr_b16 a[70:71], v13 offset:17408
    ds_read_b64_tr_b16 a[80:81], v13 offset:4096
    ds_read_b64_tr_b16 a[82:83], v13 offset:5120
    ds_read_b64_tr_b16 a[84:85], v13 offset:20480
    ds_read_b64_tr_b16 a[86:87], v13 offset:21504
    s_waitcnt lgkmcnt(0)
    v_xor_b32 v13, 32, v11
    v_add_u32 v13, 0x10000, v13
    ds_read_b64_tr_b16 a[72:73], v13
    ds_read_b64_tr_b16 a[74:75], v13 offset:1024
    ds_read_b64_tr_b16 a[76:77], v13 offset:16384
    ds_read_b64_tr_b16 a[78:79], v13 offset:17408
    ds_read_b64_tr_b16 a[88:89], v13 offset:4096
    ds_read_b64_tr_b16 a[90:91], v13 offset:5120
    ds_read_b64_tr_b16 a[92:93], v13 offset:20480
    ds_read_b64_tr_b16 a[94:95], v13 offset:21504
    s_waitcnt lgkmcnt(0)
    s_barrier
    s_mov_b32 s12, s64
    s_and_b32 s13, s65, 0xffff
    v_xor_b32 v15, 0, v14
    v_lshl_add_u32 v15, v15, 15, v8
    s_add_u32 s43, s41, 0x0
    s_add_u32 m0, s51, 0x18000
    s_nop 0
    buffer_load_dwordx4 v15, s[12:15], s43 offen lds
    s_add_u32 s43, s41, 0x80000
    s_add_u32 m0, s51, 0x19000
    s_nop 0
    buffer_load_dwordx4 v15, s[12:15], s43 offen lds
    s_add_u32 s43, s41, 0x100000
    s_add_u32 m0, s51, 0x1a000
    s_nop 0
    buffer_load_dwordx4 v15, s[12:15], s43 offen lds
    s_add_u32 s43, s41, 0x180000
    s_add_u32 m0, s51, 0x1b000
    s_nop 0
    buffer_load_dwordx4 v15, s[12:15], s43 offen lds
    s_add_u32 s43, s41, 0x200000
    s_add_u32 m0, s51, 0x1c000
    s_nop 0
    buffer_load_dwordx4 v15, s[12:15], s43 offen lds
    s_add_u32 s43, s41, 0x280000
    s_add_u32 m0, s51, 0x1d000
    s_nop 0
    buffer_load_dwordx4 v15, s[12:15], s43 offen lds
    s_add_u32 s43, s41, 0x300000
    s_add_u32 m0, s51, 0x1e000
    s_nop 0
    buffer_load_dwordx4 v15, s[12:15], s43 offen lds
    s_add_u32 s43, s41, 0x380000
    s_add_u32 m0, s51, 0x1f000
    s_nop 0
    buffer_load_dwordx4 v15, s[12:15], s43 offen lds
    s_waitcnt vmcnt(32)
    s_barrier
    v_xor_b32 v13, 0, v11
    v_add_u32 v13, 0x18000, v13
    ds_read_b64_tr_b16 a[96:97], v13
    ds_read_b64_tr_b16 a[98:99], v13 offset:1024
    ds_read_b64_tr_b16 a[100:101], v13 offset:16384
    ds_read_b64_tr_b16 a[102:103], v13 offset:17408
    ds_read_b64_tr_b16 a[112:113], v13 offset:4096
    ds_read_b64_tr_b16 a[114:115], v13 offset:5120
    ds_read_b64_tr_b16 a[116:117], v13 offset:20480
    ds_read_b64_tr_b16 a[118:119], v13 offset:21504
    s_waitcnt lgkmcnt(0)
    v_xor_b32 v13, 32, v11
    v_add_u32 v13, 0x18000, v13
    ds_read_b64_tr_b16 a[104:105], v13
    ds_read_b64_tr_b16 a[106:107], v13 offset:1024
    ds_read_b64_tr_b16 a[108:109], v13 offset:16384
    ds_read_b64_tr_b16 a[110:111], v13 offset:17408
    ds_read_b64_tr_b16 a[120:121], v13 offset:4096
    ds_read_b64_tr_b16 a[122:123], v13 offset:5120
    ds_read_b64_tr_b16 a[124:125], v13 offset:20480
    ds_read_b64_tr_b16 a[126:127], v13 offset:21504
    s_waitcnt lgkmcnt(0)
    s_barrier
    v_xor_b32 v15, 1, v14
    v_lshl_add_u32 v15, v15, 15, v8
    s_add_u32 s43, s41, 0x0
    s_add_u32 m0, s51, 0x20000
    s_nop 0
    buffer_load_dwordx4 v15, s[12:15], s43 offen lds
    s_add_u32 s43, s41, 0x80000
    s_add_u32 m0, s51, 0x21000
    s_nop 0
    buffer_load_dwordx4 v15, s[12:15], s43 offen lds
    s_add_u32 s43, s41, 0x100000
    s_add_u32 m0, s51, 0x22000
    s_nop 0
    buffer_load_dwordx4 v15, s[12:15], s43 offen lds
    s_add_u32 s43, s41, 0x180000
    s_add_u32 m0, s51, 0x23000
    s_nop 0
    buffer_load_dwordx4 v15, s[12:15], s43 offen lds
    s_add_u32 s43, s41, 0x200000
    s_add_u32 m0, s51, 0x24000
    s_nop 0
    buffer_load_dwordx4 v15, s[12:15], s43 offen lds
    s_add_u32 s43, s41, 0x280000
    s_add_u32 m0, s51, 0x25000
    s_nop 0
    buffer_load_dwordx4 v15, s[12:15], s43 offen lds
    s_add_u32 s43, s41, 0x300000
    s_add_u32 m0, s51, 0x26000
    s_nop 0
    buffer_load_dwordx4 v15, s[12:15], s43 offen lds
    s_add_u32 s43, s41, 0x380000
    s_add_u32 m0, s51, 0x27000
    s_nop 0
    buffer_load_dwordx4 v15, s[12:15], s43 offen lds
    s_waitcnt vmcnt(24)
    v_min_u32 v21, 0xfffffffe, v21
    s_mov_b32 s43, 0x10000
    s_mov_b64 exec, s[38:39]
    buffer_store_dword v21, v119, s[8:11], s43 offen
    s_mov_b64 exec, -1
    s_barrier
    v_xor_b32 v13, 0, v11
    v_add_u32 v13, 0x0, v13
    ds_read_b64_tr_b16 a[128:129], v13
    ds_read_b64_tr_b16 a[130:131], v13 offset:1024
    ds_read_b64_tr_b16 a[132:133], v13 offset:16384
    ds_read_b64_tr_b16 a[134:135], v13 offset:17408
    ds_read_b64_tr_b16 a[144:145], v13 offset:4096
    ds_read_b64_tr_b16 a[146:147], v13 offset:5120
    ds_read_b64_tr_b16 a[148:149], v13 offset:20480
    ds_read_b64_tr_b16 a[150:151], v13 offset:21504
    s_waitcnt lgkmcnt(0)
    v_xor_b32 v13, 32, v11
    v_add_u32 v13, 0x0, v13
    ds_read_b64_tr_b16 a[136:137], v13
    ds_read_b64_tr_b16 a[138:139], v13 offset:1024
    ds_read_b64_tr_b16 a[140:141], v13 offset:16384
    ds_read_b64_tr_b16 a[142:143], v13 offset:17408
    ds_read_b64_tr_b16 a[152:153], v13 offset:4096
    ds_read_b64_tr_b16 a[154:155], v13 offset:5120
    ds_read_b64_tr_b16 a[156:157], v13 offset:20480
    ds_read_b64_tr_b16 a[158:159], v13 offset:21504
    s_waitcnt lgkmcnt(0)
    s_barrier
    v_xor_b32 v15, 2, v14
    v_lshl_add_u32 v15, v15, 15, v8
    s_add_u32 s43, s41, 0x0
    s_add_u32 m0, s51, 0x8000
    s_nop 0
    buffer_load_dwordx4 v15, s[12:15], s43 offen lds
    s_add_u32 s43, s41, 0x80000
    s_add_u32 m0, s51, 0x9000
    s_nop 0
    buffer_load_dwordx4 v15, s[12:15], s43 offen lds
    s_add_u32 s43, s41, 0x100000
    s_add_u32 m0, s51, 0xa000
    s_nop 0
    buffer_load_dwordx4 v15, s[12:15], s43 offen lds
    s_add_u32 s43, s41, 0x180000
    s_add_u32 m0, s51, 0xb000
    s_nop 0
    buffer_load_dwordx4 v15, s[12:15], s43 offen lds
    s_add_u32 s43, s41, 0x200000
    s_add_u32 m0, s51, 0xc000
    s_nop 0
    buffer_load_dwordx4 v15, s[12:15], s43 offen lds
    s_add_u32 s43, s41, 0x280000
    s_add_u32 m0, s51, 0xd000
    s_nop 0
    buffer_load_dwordx4 v15, s[12:15], s43 offen lds
    s_add_u32 s43, s41, 0x300000
    s_add_u32 m0, s51, 0xe000
    s_nop 0
    buffer_load_dwordx4 v15, s[12:15], s43 offen lds
    s_add_u32 s43, s41, 0x380000
    s_add_u32 m0, s51, 0xf000
    s_nop 0
    buffer_load_dwordx4 v15, s[12:15], s43 offen lds
    s_waitcnt vmcnt(24)
    s_barrier
    v_xor_b32 v13, 0, v11
    v_add_u32 v13, 0x8000, v13
    ds_read_b64_tr_b16 a[160:161], v13
    ds_read_b64_tr_b16 a[162:163], v13 offset:1024
    ds_read_b64_tr_b16 a[164:165], v13 offset:16384
    ds_read_b64_tr_b16 a[166:167], v13 offset:17408
    ds_read_b64_tr_b16 a[176:177], v13 offset:4096
    ds_read_b64_tr_b16 a[178:179], v13 offset:5120
    ds_read_b64_tr_b16 a[180:181], v13 offset:20480
    ds_read_b64_tr_b16 a[182:183], v13 offset:21504
    s_waitcnt lgkmcnt(0)
    v_xor_b32 v13, 32, v11
    v_add_u32 v13, 0x8000, v13
    ds_read_b64_tr_b16 a[168:169], v13
    ds_read_b64_tr_b16 a[170:171], v13 offset:1024
    ds_read_b64_tr_b16 a[172:173], v13 offset:16384
    ds_read_b64_tr_b16 a[174:175], v13 offset:17408
    ds_read_b64_tr_b16 a[184:185], v13 offset:4096
    ds_read_b64_tr_b16 a[186:187], v13 offset:5120
    ds_read_b64_tr_b16 a[188:189], v13 offset:20480
    ds_read_b64_tr_b16 a[190:191], v13 offset:21504
    s_waitcnt lgkmcnt(0)
    s_barrier
    v_xor_b32 v15, 3, v14
    v_lshl_add_u32 v15, v15, 15, v8
    s_add_u32 s43, s41, 0x0
    s_add_u32 m0, s51, 0x10000
    s_nop 0
    buffer_load_dwordx4 v15, s[12:15], s43 offen lds
    s_add_u32 s43, s41, 0x80000
    s_add_u32 m0, s51, 0x11000
    s_nop 0
    buffer_load_dwordx4 v15, s[12:15], s43 offen lds
    s_add_u32 s43, s41, 0x100000
    s_add_u32 m0, s51, 0x12000
    s_nop 0
    buffer_load_dwordx4 v15, s[12:15], s43 offen lds
    s_add_u32 s43, s41, 0x180000
    s_add_u32 m0, s51, 0x13000
    s_nop 0
    buffer_load_dwordx4 v15, s[12:15], s43 offen lds
    s_add_u32 s43, s41, 0x200000
    s_add_u32 m0, s51, 0x14000
    s_nop 0
    buffer_load_dwordx4 v15, s[12:15], s43 offen lds
    s_add_u32 s43, s41, 0x280000
    s_add_u32 m0, s51, 0x15000
    s_nop 0
    buffer_load_dwordx4 v15, s[12:15], s43 offen lds
    s_add_u32 s43, s41, 0x300000
    s_add_u32 m0, s51, 0x16000
    s_nop 0
    buffer_load_dwordx4 v15, s[12:15], s43 offen lds
    s_add_u32 s43, s41, 0x380000
    s_add_u32 m0, s51, 0x17000
    s_nop 0
    buffer_load_dwordx4 v15, s[12:15], s43 offen lds
    s_waitcnt vmcnt(24)
    s_barrier
    v_xor_b32 v13, 0, v11
    v_add_u32 v13, 0x10000, v13
    ds_read_b64_tr_b16 a[192:193], v13
    ds_read_b64_tr_b16 a[194:195], v13 offset:1024
    ds_read_b64_tr_b16 a[196:197], v13 offset:16384
    ds_read_b64_tr_b16 a[198:199], v13 offset:17408
    ds_read_b64_tr_b16 a[208:209], v13 offset:4096
    ds_read_b64_tr_b16 a[210:211], v13 offset:5120
    ds_read_b64_tr_b16 a[212:213], v13 offset:20480
    ds_read_b64_tr_b16 a[214:215], v13 offset:21504
    s_waitcnt lgkmcnt(0)
    v_xor_b32 v13, 32, v11
    v_add_u32 v13, 0x10000, v13
    ds_read_b64_tr_b16 a[200:201], v13
    ds_read_b64_tr_b16 a[202:203], v13 offset:1024
    ds_read_b64_tr_b16 a[204:205], v13 offset:16384
    ds_read_b64_tr_b16 a[206:207], v13 offset:17408
    ds_read_b64_tr_b16 a[216:217], v13 offset:4096
    ds_read_b64_tr_b16 a[218:219], v13 offset:5120
    ds_read_b64_tr_b16 a[220:221], v13 offset:20480
    ds_read_b64_tr_b16 a[222:223], v13 offset:21504
    s_waitcnt lgkmcnt(0)
    s_barrier
    s_mov_b32 s12, s66
    s_and_b32 s13, s67, 0xffff
    s_add_u32 s43, s42, 0x0
    s_add_u32 m0, s51, 0x18000
    s_nop 0
    buffer_load_dwordx4 v10, s[12:15], s43 offen lds
    s_add_u32 s43, s42, 0x4000
    s_add_u32 m0, s51, 0x19000
    s_nop 0
    buffer_load_dwordx4 v9, s[12:15], s43 offen lds
    s_add_u32 s43, s42, 0x8000
    s_add_u32 m0, s51, 0x1a000
    s_nop 0
    buffer_load_dwordx4 v10, s[12:15], s43 offen lds
    s_add_u32 s43, s42, 0xc000
    s_add_u32 m0, s51, 0x1b000
    s_nop 0
    buffer_load_dwordx4 v9, s[12:15], s43 offen lds
    s_add_u32 s43, s42, 0x10000
    s_add_u32 m0, s51, 0x1c000
    s_nop 0
    buffer_load_dwordx4 v10, s[12:15], s43 offen lds
    s_add_u32 s43, s42, 0x14000
    s_add_u32 m0, s51, 0x1d000
    s_nop 0
    buffer_load_dwordx4 v9, s[12:15], s43 offen lds
    s_add_u32 s43, s42, 0x18000
    s_add_u32 m0, s51, 0x1e000
    s_nop 0
    buffer_load_dwordx4 v10, s[12:15], s43 offen lds
    s_add_u32 s43, s42, 0x1c000
    s_add_u32 m0, s51, 0x1f000
    s_nop 0
    buffer_load_dwordx4 v9, s[12:15], s43 offen lds
    s_waitcnt vmcnt(24)
    s_barrier
    v_xor_b32 v13, 0, v11
    v_add_u32 v13, 0x18000, v13
    ds_read_b64_tr_b16 a[224:225], v13
    ds_read_b64_tr_b16 a[226:227], v13 offset:1024
    ds_read_b64_tr_b16 a[228:229], v13 offset:16384
    ds_read_b64_tr_b16 a[230:231], v13 offset:17408
    ds_read_b64_tr_b16 a[240:241], v13 offset:4096
    ds_read_b64_tr_b16 a[242:243], v13 offset:5120
    ds_read_b64_tr_b16 a[244:245], v13 offset:20480
    ds_read_b64_tr_b16 a[246:247], v13 offset:21504
    s_waitcnt lgkmcnt(0)
    v_xor_b32 v13, 32, v11
    v_add_u32 v13, 0x18000, v13
    ds_read_b64_tr_b16 a[232:233], v13
    ds_read_b64_tr_b16 a[234:235], v13 offset:1024
    ds_read_b64_tr_b16 a[236:237], v13 offset:16384
    ds_read_b64_tr_b16 a[238:239], v13 offset:17408
    ds_read_b64_tr_b16 a[248:249], v13 offset:4096
    ds_read_b64_tr_b16 a[250:251], v13 offset:5120
    ds_read_b64_tr_b16 a[252:253], v13 offset:20480
    ds_read_b64_tr_b16 a[254:255], v13 offset:21504
    s_waitcnt lgkmcnt(0)
    s_barrier
    s_add_u32 s43, s42, 0x40
    s_add_u32 m0, s51, 0x20000
    s_nop 0
    buffer_load_dwordx4 v10, s[12:15], s43 offen lds
    s_add_u32 s43, s42, 0x4040
    s_add_u32 m0, s51, 0x21000
    s_nop 0
    buffer_load_dwordx4 v9, s[12:15], s43 offen lds
    s_add_u32 s43, s42, 0x8040
    s_add_u32 m0, s51, 0x22000
    s_nop 0
    buffer_load_dwordx4 v10, s[12:15], s43 offen lds
    s_add_u32 s43, s42, 0xc040
    s_add_u32 m0, s51, 0x23000
    s_nop 0
    buffer_load_dwordx4 v9, s[12:15], s43 offen lds
    s_add_u32 s43, s42, 0x10040
    s_add_u32 m0, s51, 0x24000
    s_nop 0
    buffer_load_dwordx4 v10, s[12:15], s43 offen lds
    s_add_u32 s43, s42, 0x14040
    s_add_u32 m0, s51, 0x25000
    s_nop 0
    buffer_load_dwordx4 v9, s[12:15], s43 offen lds
    s_add_u32 s43, s42, 0x18040
    s_add_u32 m0, s51, 0x26000
    s_nop 0
    buffer_load_dwordx4 v10, s[12:15], s43 offen lds
    s_add_u32 s43, s42, 0x1c040
    s_add_u32 m0, s51, 0x27000
    s_nop 0
    buffer_load_dwordx4 v9, s[12:15], s43 offen lds
    s_waitcnt vmcnt(24)
    s_barrier
    v_xor_b32 v13, 0, v11
    v_add_u32 v13, 0x0, v13
    ds_read_b64_tr_b16 v[128:129], v13
    ds_read_b64_tr_b16 v[130:131], v13 offset:1024
    ds_read_b64_tr_b16 v[132:133], v13 offset:16384
    ds_read_b64_tr_b16 v[134:135], v13 offset:17408
    ds_read_b64_tr_b16 v[144:145], v13 offset:4096
    ds_read_b64_tr_b16 v[146:147], v13 offset:5120
    ds_read_b64_tr_b16 v[148:149], v13 offset:20480
    ds_read_b64_tr_b16 v[150:151], v13 offset:21504
    s_waitcnt lgkmcnt(0)
    v_xor_b32 v13, 32, v11
    v_add_u32 v13, 0x0, v13
    ds_read_b64_tr_b16 v[136:137], v13
    ds_read_b64_tr_b16 v[138:139], v13 offset:1024
    ds_read_b64_tr_b16 v[140:141], v13 offset:16384
    ds_read_b64_tr_b16 v[142:143], v13 offset:17408
    ds_read_b64_tr_b16 v[152:153], v13 offset:4096
    ds_read_b64_tr_b16 v[154:155], v13 offset:5120
    ds_read_b64_tr_b16 v[156:157], v13 offset:20480
    ds_read_b64_tr_b16 v[158:159], v13 offset:21504
    s_waitcnt lgkmcnt(0)
    s_barrier
    s_mov_b32 s12, s60
    s_and_b32 s13, s61, 0xffff
    v_xor_b32 v15, 0, v14
    v_lshl_add_u32 v15, v15, 15, v8
    s_add_u32 s43, s41, 0x0
    s_add_u32 m0, s51, 0x8000
    s_nop 0
    buffer_load_dwordx4 v15, s[12:15], s43 offen lds
    s_add_u32 s43, s41, 0x80000
    s_add_u32 m0, s51, 0x9000
    s_nop 0
    buffer_load_dwordx4 v15, s[12:15], s43 offen lds
    s_add_u32 s43, s41, 0x100000
    s_add_u32 m0, s51, 0xa000
    s_nop 0
    buffer_load_dwordx4 v15, s[12:15], s43 offen lds
    s_add_u32 s43, s41, 0x180000
    s_add_u32 m0, s51, 0xb000
    s_nop 0
    buffer_load_dwordx4 v15, s[12:15], s43 offen lds
    s_add_u32 s43, s41, 0x200000
    s_add_u32 m0, s51, 0xc000
    s_nop 0
    buffer_load_dwordx4 v15, s[12:15], s43 offen lds
    s_add_u32 s43, s41, 0x280000
    s_add_u32 m0, s51, 0xd000
    s_nop 0
    buffer_load_dwordx4 v15, s[12:15], s43 offen lds
    s_add_u32 s43, s41, 0x300000
    s_add_u32 m0, s51, 0xe000
    s_nop 0
    buffer_load_dwordx4 v15, s[12:15], s43 offen lds
    s_add_u32 s43, s41, 0x380000
    s_add_u32 m0, s51, 0xf000
    s_nop 0
    buffer_load_dwordx4 v15, s[12:15], s43 offen lds
    s_waitcnt vmcnt(24)
    s_barrier
    s_cmp_lg_u32 s21, 0
    s_cbranch_scc1 L_arr_4
    v_mov_b32 v23, 1
    s_mov_b64 exec, 1
    buffer_atomic_add v23, off, s[16:19], 0 offset:4
    s_mov_b64 exec, -1
L_arr_4:
    v_xor_b32 v13, 0, v11
    v_add_u32 v13, 0x8000, v13
    ds_read_b64_tr_b16 v[160:161], v13
    ds_read_b64_tr_b16 v[162:163], v13 offset:1024
    ds_read_b64_tr_b16 v[164:165], v13 offset:16384
    ds_read_b64_tr_b16 v[166:167], v13 offset:17408
    ds_read_b64_tr_b16 v[176:177], v13 offset:4096
    ds_read_b64_tr_b16 v[178:179], v13 offset:5120
    ds_read_b64_tr_b16 v[180:181], v13 offset:20480
    ds_read_b64_tr_b16 v[182:183], v13 offset:21504
    s_waitcnt lgkmcnt(0)
    v_xor_b32 v13, 32, v11
    v_add_u32 v13, 0x8000, v13
    ds_read_b64_tr_b16 v[168:169], v13
    ds_read_b64_tr_b16 v[170:171], v13 offset:1024
    ds_read_b64_tr_b16 v[172:173], v13 offset:16384
    ds_read_b64_tr_b16 v[174:175], v13 offset:17408
    ds_read_b64_tr_b16 v[184:185], v13 offset:4096
    ds_read_b64_tr_b16 v[186:187], v13 offset:5120
    ds_read_b64_tr_b16 v[188:189], v13 offset:20480
    ds_read_b64_tr_b16 v[190:191], v13 offset:21504
    s_waitcnt lgkmcnt(0)
    s_barrier
    s_mov_b32 s12, s62
    s_and_b32 s13, s63, 0xffff
    v_xor_b32 v15, 0, v14
    v_lshl_add_u32 v15, v15, 15, v8
    s_add_u32 s43, s41, 0x0
    s_add_u32 m0, s51, 0x10000
    s_nop 0
    buffer_load_dwordx4 v15, s[12:15], s43 offen lds
    s_add_u32 s43, s41, 0x80000
    s_add_u32 m0, s51, 0x11000
    s_nop 0
    buffer_load_dwordx4 v15, s[12:15], s43 offen lds
    s_add_u32 s43, s41, 0x100000
    s_add_u32 m0, s51, 0x12000
    s_nop 0
    buffer_load_dwordx4 v15, s[12:15], s43 offen lds
    s_add_u32 s43, s41, 0x180000
    s_add_u32 m0, s51, 0x13000
    s_nop 0
    buffer_load_dwordx4 v15, s[12:15], s43 offen lds
    s_add_u32 s43, s41, 0x200000
    s_add_u32 m0, s51, 0x14000
    s_nop 0
    buffer_load_dwordx4 v15, s[12:15], s43 offen lds
    s_add_u32 s43, s41, 0x280000
    s_add_u32 m0, s51, 0x15000
    s_nop 0
    buffer_load_dwordx4 v15, s[12:15], s43 offen lds
    s_add_u32 s43, s41, 0x300000
    s_add_u32 m0, s51, 0x16000
    s_nop 0
    buffer_load_dwordx4 v15, s[12:15], s43 offen lds
    s_add_u32 s43, s41, 0x380000
    s_add_u32 m0, s51, 0x17000
    s_nop 0
    buffer_load_dwordx4 v15, s[12:15], s43 offen lds
    s_waitcnt vmcnt(24)
    s_barrier
    v_xor_b32 v13, 0x0, v12
    v_add_u32 v13, 0x10000, v13
    ds_read_b64_tr_b16 v[192:193], v13
    ds_read_b64_tr_b16 v[194:195], v13 offset:512
    ds_read_b64_tr_b16 v[196:197], v13 offset:2048
    ds_read_b64_tr_b16 v[198:199], v13 offset:2560
    v_xor_b32 v13, 0x2000, v12
    v_add_u32 v13, 0x10000, v13
    ds_read_b64_tr_b16 v[200:201], v13
    ds_read_b64_tr_b16 v[202:203], v13 offset:512
    ds_read_b64_tr_b16 v[204:205], v13 offset:2048
    ds_read_b64_tr_b16 v[206:207], v13 offset:2560
    s_waitcnt lgkmcnt(0)
    v_xor_b32 v13, 0x4000, v12
    v_add_u32 v13, 0x10000, v13
    ds_read_b64_tr_b16 v[208:209], v13
    ds_read_b64_tr_b16 v[210:211], v13 offset:512
    ds_read_b64_tr_b16 v[212:213], v13 offset:2048
    ds_read_b64_tr_b16 v[214:215], v13 offset:2560
    v_xor_b32 v13, 0x6000, v12
    v_add_u32 v13, 0x10000, v13
    ds_read_b64_tr_b16 v[216:217], v13
    ds_read_b64_tr_b16 v[218:219], v13 offset:512
    ds_read_b64_tr_b16 v[220:221], v13 offset:2048
    ds_read_b64_tr_b16 v[222:223], v13 offset:2560
    s_waitcnt lgkmcnt(0)
    s_barrier
    s_mov_b32 s12, s66
    s_and_b32 s13, s67, 0xffff
    s_add_u32 s43, s42, 0x80
    s_add_u32 m0, s51, 0x18000
    s_nop 0
    buffer_load_dwordx4 v10, s[12:15], s43 offen lds
    s_add_u32 s43, s42, 0x4080
    s_add_u32 m0, s51, 0x19000
    s_nop 0
    buffer_load_dwordx4 v9, s[12:15], s43 offen lds
    s_add_u32 s43, s42, 0x8080
    s_add_u32 m0, s51, 0x1a000
    s_nop 0
    buffer_load_dwordx4 v10, s[12:15], s43 offen lds
    s_add_u32 s43, s42, 0xc080
    s_add_u32 m0, s51, 0x1b000
    s_nop 0
    buffer_load_dwordx4 v9, s[12:15], s43 offen lds
    s_add_u32 s43, s42, 0x10080
    s_add_u32 m0, s51, 0x1c000
    s_nop 0
    buffer_load_dwordx4 v10, s[12:15], s43 offen lds
    s_add_u32 s43, s42, 0x14080
    s_add_u32 m0, s51, 0x1d000
    s_nop 0
    buffer_load_dwordx4 v9, s[12:15], s43 offen lds
    s_add_u32 s43, s42, 0x18080
    s_add_u32 m0, s51, 0x1e000
    s_nop 0
    buffer_load_dwordx4 v10, s[12:15], s43 offen lds
    s_add_u32 s43, s42, 0x1c080
    s_add_u32 m0, s51, 0x1f000
    s_nop 0
    buffer_load_dwordx4 v9, s[12:15], s43 offen lds
    s_waitcnt vmcnt(24)
    s_barrier
    v_xor_b32 v13, 0x0, v12
    v_add_u32 v13, 0x18000, v13
    ds_read_b64_tr_b16 v[224:225], v13
    ds_read_b64_tr_b16 v[226:227], v13 offset:512
    ds_read_b64_tr_b16 v[228:229], v13 offset:2048
    ds_read_b64_tr_b16 v[230:231], v13 offset:2560
    v_xor_b32 v13, 0x2000, v12
    v_add_u32 v13, 0x18000, v13
    ds_read_b64_tr_b16 v[232:233], v13
    ds_read_b64_tr_b16 v[234:235], v13 offset:512
    ds_read_b64_tr_b16 v[236:237], v13 offset:2048
    ds_read_b64_tr_b16 v[238:239], v13 offset:2560
    s_waitcnt lgkmcnt(0)
    v_xor_b32 v13, 0x4000, v12
    v_add_u32 v13, 0x18000, v13
    ds_read_b64_tr_b16 v[240:241], v13
    ds_read_b64_tr_b16 v[242:243], v13 offset:512
    ds_read_b64_tr_b16 v[244:245], v13 offset:2048
    ds_read_b64_tr_b16 v[246:247], v13 offset:2560
    v_xor_b32 v13, 0x6000, v12
    v_add_u32 v13, 0x18000, v13
    ds_read_b64_tr_b16 v[248:249], v13
    ds_read_b64_tr_b16 v[250:251], v13 offset:512
    ds_read_b64_tr_b16 v[252:253], v13 offset:2048
    ds_read_b64_tr_b16 v[254:255], v13 offset:2560
    s_waitcnt lgkmcnt(0)
    s_barrier
    s_add_u32 s43, s42, 0xc0
    s_add_u32 m0, s51, 0x20000
    s_nop 0
    buffer_load_dwordx4 v10, s[12:15], s43 offen lds
    s_add_u32 s43, s42, 0x40c0
    s_add_u32 m0, s51, 0x21000
    s_nop 0
    buffer_load_dwordx4 v9, s[12:15], s43 offen lds
    s_add_u32 s43, s42, 0x80c0
    s_add_u32 m0, s51, 0x22000
    s_nop 0
    buffer_load_dwordx4 v10, s[12:15], s43 offen lds
    s_add_u32 s43, s42, 0xc0c0
    s_add_u32 m0, s51, 0x23000
    s_nop 0
    buffer_load_dwordx4 v9, s[12:15], s43 offen lds
    s_add_u32 s43, s42, 0x100c0
    s_add_u32 m0, s51, 0x24000
    s_nop 0
    buffer_load_dwordx4 v10, s[12:15], s43 offen lds
    s_add_u32 s43, s42, 0x140c0
    s_add_u32 m0, s51, 0x25000
    s_nop 0
    buffer_load_dwordx4 v9, s[12:15], s43 offen lds
    s_add_u32 s43, s42, 0x180c0
    s_add_u32 m0, s51, 0x26000
    s_nop 0
    buffer_load_dwordx4 v10, s[12:15], s43 offen lds
    s_add_u32 s43, s42, 0x1c0c0
    s_add_u32 m0, s51, 0x27000
    s_nop 0
    buffer_load_dwordx4 v9, s[12:15], s43 offen lds
    s_waitcnt vmcnt(24)
    s_barrier
    v_xor_b32 v13, 0, v11
    v_add_u32 v13, 0x0, v13
    ds_read_b64_tr_b16 v[32:33], v13
    ds_read_b64_tr_b16 v[34:35], v13 offset:1024
    ds_read_b64_tr_b16 v[36:37], v13 offset:16384
    ds_read_b64_tr_b16 v[38:39], v13 offset:17408
    ds_read_b64_tr_b16 v[48:49], v13 offset:4096
    ds_read_b64_tr_b16 v[50:51], v13 offset:5120
    ds_read_b64_tr_b16 v[52:53], v13 offset:20480
    ds_read_b64_tr_b16 v[54:55], v13 offset:21504
    s_waitcnt lgkmcnt(0)
    v_xor_b32 v13, 32, v11
    v_add_u32 v13, 0x0, v13
    ds_read_b64_tr_b16 v[40:41], v13
    ds_read_b64_tr_b16 v[42:43], v13 offset:1024
    ds_read_b64_tr_b16 v[44:45], v13 offset:16384
    ds_read_b64_tr_b16 v[46:47], v13 offset:17408
    ds_read_b64_tr_b16 v[56:57], v13 offset:4096
    ds_read_b64_tr_b16 v[58:59], v13 offset:5120
    ds_read_b64_tr_b16 v[60:61], v13 offset:20480
    ds_read_b64_tr_b16 v[62:63], v13 offset:21504
    s_waitcnt lgkmcnt(0)
    s_barrier
    ds_write_b128 v123, v[32:35]
    ds_write_b128 v123, v[36:39] offset:1024
    ds_write_b128 v123, v[40:43] offset:2048
    ds_write_b128 v123, v[44:47] offset:3072
    ds_write_b128 v123, v[48:51] offset:4096
    ds_write_b128 v123, v[52:55] offset:5120
    ds_write_b128 v123, v[56:59] offset:6144
    ds_write_b128 v123, v[60:63] offset:7168
    s_waitcnt vmcnt(16)
    s_barrier
    v_xor_b32 v13, 0, v11
    v_add_u32 v13, 0x8000, v13
    ds_read_b64_tr_b16 v[32:33], v13
    ds_read_b64_tr_b16 v[34:35], v13 offset:1024
    ds_read_b64_tr_b16 v[36:37], v13 offset:16384
    ds_read_b64_tr_b16 v[38:39], v13 offset:17408
    ds_read_b64_tr_b16 v[48:49], v13 offset:4096
    ds_read_b64_tr_b16 v[50:51], v13 offset:5120
    ds_read_b64_tr_b16 v[52:53], v13 offset:20480
    ds_read_b64_tr_b16 v[54:55], v13 offset:21504
    s_waitcnt lgkmcnt(0)
    v_xor_b32 v13, 32, v11
    v_add_u32 v13, 0x8000, v13
    ds_read_b64_tr_b16 v[40:41], v13
    ds_read_b64_tr_b16 v[42:43], v13 offset:1024
    ds_read_b64_tr_b16 v[44:45], v13 offset:16384
    ds_read_b64_tr_b16 v[46:47], v13 offset:17408
    ds_read_b64_tr_b16 v[56:57], v13 offset:4096
    ds_read_b64_tr_b16 v[58:59], v13 offset:5120
    ds_read_b64_tr_b16 v[60:61], v13 offset:20480
    ds_read_b64_tr_b16 v[62:63], v13 offset:21504
    s_waitcnt lgkmcnt(0)
    s_barrier
    ds_write_b128 v123, v[32:35] offset:32768
    ds_write_b128 v123, v[36:39] offset:33792
    ds_write_b128 v123, v[40:43] offset:34816
    ds_write_b128 v123, v[44:47] offset:35840
    ds_write_b128 v123, v[48:51] offset:36864
    ds_write_b128 v123, v[52:55] offset:37888
    ds_write_b128 v123, v[56:59] offset:38912
    ds_write_b128 v123, v[60:63] offset:39936
    s_waitcnt vmcnt(8)
    s_barrier
    v_xor_b32 v13, 0x0, v12
    v_add_u32 v13, 0x10000, v13
    ds_read_b64_tr_b16 v[32:33], v13
    ds_read_b64_tr_b16 v[34:35], v13 offset:512
    ds_read_b64_tr_b16 v[36:37], v13 offset:2048
    ds_read_b64_tr_b16 v[38:39], v13 offset:2560
    v_xor_b32 v13, 0x2000, v12
    v_add_u32 v13, 0x10000, v13
    ds_read_b64_tr_b16 v[40:41], v13
    ds_read_b64_tr_b16 v[42:43], v13 offset:512
    ds_read_b64_tr_b16 v[44:45], v13 offset:2048
    ds_read_b64_tr_b16 v[46:47], v13 offset:2560
    s_waitcnt lgkmcnt(0)
    v_xor_b32 v13, 0x4000, v12
    v_add_u32 v13, 0x10000, v13
    ds_read_b64_tr_b16 v[48:49], v13
    ds_read_b64_tr_b16 v[50:51], v13 offset:512
    ds_read_b64_tr_b16 v[52:53], v13 offset:2048
    ds_read_b64_tr_b16 v[54:55], v13 offset:2560
    v_xor_b32 v13, 0x6000, v12
    v_add_u32 v13, 0x10000, v13
    ds_read_b64_tr_b16 v[56:57], v13
    ds_read_b64_tr_b16 v[58:59], v13 offset:512
    ds_read_b64_tr_b16 v[60:61], v13 offset:2048
    ds_read_b64_tr_b16 v[62:63], v13 offset:2560
    s_waitcnt lgkmcnt(0)
    s_barrier
    ds_write_b128 v124, v[32:35]
    ds_write_b128 v124, v[36:39] offset:1024
    ds_write_b128 v124, v[40:43] offset:2048
    ds_write_b128 v124, v[44:47] offset:3072
    ds_write_b128 v124, v[48:51] offset:4096
    ds_write_b128 v124, v[52:55] offset:5120
    ds_write_b128 v124, v[56:59] offset:6144
    ds_write_b128 v124, v[60:63] offset:7168
    s_waitcnt vmcnt(0)
    s_barrier
    v_xor_b32 v13, 0x0, v12
    v_add_u32 v13, 0x18000, v13
    ds_read_b64_tr_b16 v[32:33], v13
    ds_read_b64_tr_b16 v[34:35], v13 offset:512
    ds_read_b64_tr_b16 v[36:37], v13 offset:2048
    ds_read_b64_tr_b16 v[38:39], v13 offset:2560
    v_xor_b32 v13, 0x2000, v12
    v_add_u32 v13, 0x18000, v13
    ds_read_b64_tr_b16 v[40:41], v13
    ds_read_b64_tr_b16 v[42:43], v13 offset:512
    ds_read_b64_tr_b16 v[44:45], v13 offset:2048
    ds_read_b64_tr_b16 v[46:47], v13 offset:2560
    s_waitcnt lgkmcnt(0)
    v_xor_b32 v13, 0x4000, v12
    v_add_u32 v13, 0x18000, v13
    ds_read_b64_tr_b16 v[48:49], v13
    ds_read_b64_tr_b16 v[50:51], v13 offset:512
    ds_read_b64_tr_b16 v[52:53], v13 offset:2048
    ds_read_b64_tr_b16 v[54:55], v13 offset:2560
    v_xor_b32 v13, 0x6000, v12
    v_add_u32 v13, 0x18000, v13
    ds_read_b64_tr_b16 v[56:57], v13
    ds_read_b64_tr_b16 v[58:59], v13 offset:512
    ds_read_b64_tr_b16 v[60:61], v13 offset:2048
    ds_read_b64_tr_b16 v[62:63], v13 offset:2560
    s_waitcnt lgkmcnt(0)
    s_barrier
    ds_write_b128 v124, v[32:35] offset:32768
    ds_write_b128 v124, v[36:39] offset:33792
    ds_write_b128 v124, v[40:43] offset:34816
    ds_write_b128 v124, v[44:47] offset:35840
    ds_write_b128 v124, v[48:51] offset:36864
    ds_write_b128 v124, v[52:55] offset:37888
    ds_write_b128 v124, v[56:59] offset:38912
    ds_write_b128 v124, v[60:63] offset:39936
    s_waitcnt lgkmcnt(0)
    s_mov_b32 s96, 0
L_mode_5:
    buffer_load_dwordx2 v[2:3], off, s[92:95], 0 offset:36 sc1
    s_waitcnt vmcnt(0)
    v_readfirstlane_b32 s87, v2
    v_readfirstlane_b32 s97, v3
    s_nop 0
    s_min_u32 s97, s97, s87
    s_cmp_lg_u32 s97, 0
    s_cbranch_scc1 L_moded_6
    s_sleep 4
    s_add_u32 s96, s96, 1
    s_cmp_lg_u32 s96, 0x100
    s_cbranch_scc1 L_modef_7
    v_mov_b32 v2, 2
    v_mov_b32 v3, 0
    s_mov_b64 exec, 1
    buffer_atomic_cmpswap v[2:3], off, s[92:95], 0 offset:36
    s_mov_b64 exec, -1
L_modef_7:
    s_cmp_lt_u32 s96, 0x10000
    s_cbranch_scc1 L_mode_5
L_moded_6:
    s_cmp_lg_u32 s87, 1
    s_cbranch_scc1 L_fallback
    v_lshrrev_b32 v1, 4, v117
    v_and_b32 v2, 15, v1
    v_lshrrev_b32 v1, 4, v1
    v_lshlrev_b32 v1, 11, v1
    v_lshl_add_u32 v1, v2, 2, v1
    s_lshl_b32 s43, s20, 6
    s_add_u32 s43, s43, 0x2000
    s_cmp_lg_u32 s100, 0
    s_cbranch_scc1 L_polls_10
    s_mov_b32 exec_lo, 0x10001
    s_mov_b32 exec_hi, 0
    s_mov_b32 s96, 0
L_poll_8:
    buffer_load_dword v2, v1, s[8:11], s43 offen sc1
    s_waitcnt vmcnt(0)
    v_cmp_gt_u32 vcc, 1, v2
    s_cbranch_vccz L_polld_9
    s_sleep 4
    s_add_u32 s96, s96, 1
    s_cmp_lt_u32 s96, 0x10000
    s_cbranch_scc1 L_poll_8
L_polld_9:
    s_mov_b64 exec, -1
L_polls_10:
    s_barrier
    s_mov_b32 s22, 0
    s_mov_b32 s33, 0
    s_xor_b32 s53, s29, 1024
    s_mov_b32 s57, 0
    s_add_u32 s23, s51, 0x10000
    s_add_u32 s48, s23, 4096
    s_mov_b32 s24, 0x12000
    s_add_u32 s55, s24, 16384
    s_mov_b32 s25, 0x100000
    s_mov_b32 s26, 0x101000
    s_lshl_b32 s43, s20, 13
    v_mov_b32 v112, 0
    v_mov_b32 v113, 0
    v_mov_b32 v114, 0
    v_mov_b32 v115, 0
    s_add_u32 s43, s43, s52
    s_add_u32 s30, s43, 0x1000000
    s_add_u32 s31, s43, 0x2000000
    s_lshr_b32 s43, s43, 1
    s_add_u32 s32, s43, 0x220000
    s_add_u32 s27, s52, 8192
    s_mov_b32 m0, s27
    s_nop 0
    buffer_load_dwordx4 v117, s[8:11], s30 offen lds
    s_xor_b32 s27, s27, 0x6000
    buffer_load_dwordx4 v117, s[8:11], s30 offen offset:1024 lds
    s_add_u32 m0, s52, 0x6000
    s_nop 0
    buffer_load_dwordx4 v117, s[8:11], s31 offen lds
    buffer_load_dwordx4 v117, s[8:11], s31 offen offset:1024 lds
    s_add_u32 m0, s51, 4096
    v_add_u32 v126, 8192, v117
    v_bfe_u32 v1, v117, 4, 1
    v_lshlrev_b32 v1, 4, v1
    s_movk_i32 s43, 0x3f80
    v_lshlrev_b32 v125, v1, s43
    v_bfe_u32 v1, v117, 5, 3
    v_cmp_eq_u32 s[68:69], 0, v1
    v_cmp_eq_u32 s[70:71], 1, v1
    v_cmp_eq_u32 s[72:73], 2, v1
    v_cmp_eq_u32 s[74:75], 3, v1
    v_lshrrev_b32 v1, 2, v117
    s_cmp_lt_u32 s21, 2
    s_cselect_b64 vcc, -1, 0
    v_cndmask_b32 v119, v119, v1, vcc
    v_mov_b32 v32, 0
    v_mov_b32 v33, 0
    v_mov_b32 v34, 0
    v_mov_b32 v35, 0
    v_mov_b32 v36, 0
    v_mov_b32 v37, 0
    v_mov_b32 v38, 0
    v_mov_b32 v39, 0
    v_mov_b32 v40, 0
    v_mov_b32 v41, 0
    v_mov_b32 v42, 0
    v_mov_b32 v43, 0
    v_mov_b32 v44, 0
    v_mov_b32 v45, 0
    v_mov_b32 v46, 0
    v_mov_b32 v47, 0
    v_mov_b32 v48, 0
    v_mov_b32 v49, 0
    v_mov_b32 v50, 0
    v_mov_b32 v51, 0
    v_mov_b32 v52, 0
    v_mov_b32 v53, 0
    v_mov_b32 v54, 0
    v_mov_b32 v55, 0
    s_add_u32 s30, s30, 0x40000
    s_add_u32 s31, s31, 0x40000
    s_mov_b32 s45, 0
    s_mov_b32 s46, 0
    s_mov_b32 s47, 0
    s_and_b32 s43, s21, 1
    s_lshl_b32 s43, s43, 5
    s_add_u32 s43, s43, s20
    s_lshl_b32 s43, s43, 6
    s_add_u32 s28, s43, 0x2000
    s_mov_b32 s59, 0
    ds_read_b128 v[88:91], v123
    ds_read_b128 v[92:95], v123 offset:1024
    ds_read_b128 v[56:59], v123 offset:2048
    ds_read_b128 v[60:63], v123 offset:3072
    ds_read_b128 v[64:67], v123 offset:32768
    ds_read_b128 v[68:71], v123 offset:33792
    ds_read_b128 v[72:75], v123 offset:34816
    ds_read_b128 v[76:79], v123 offset:35840
    ds_read_b128 v[80:83], v123 offset:4096
    ds_read_b128 v[84:87], v123 offset:5120
    ds_read_b128 v[96:99], v123 offset:6144
    ds_read_b128 v[100:103], v123 offset:7168
    ds_read_b128 v[104:107], v123 offset:36864
    ds_read_b128 v[108:111], v123 offset:37888
    ds_read_b128 v[24:27], v123 offset:38912
    ds_read_b128 v[28:31], v123 offset:39936
    s_cmp_lg_u32 s21, 0
    s_cbranch_scc1 L_cb_skip_11
    v_mov_b32 v1, 4
    s_mov_b64 exec, 1
    s_mov_b32 s49, 0
L_cb_poll_12:
    buffer_load_dword v3, v1, s[16:19], 0 offen sc1
    s_waitcnt vmcnt(0)
    v_readfirstlane_b32 s43, v3
    s_nop 0
    s_cmp_ge_u32 s43, 32
    s_cbranch_scc1 L_cb_done_13
    s_sleep 2
    s_add_u32 s49, s49, 1
    s_cmp_lt_u32 s49, 0x40000
    s_cbranch_scc1 L_cb_poll_12
L_cb_done_13:
    s_mov_b64 exec, -1
L_cb_skip_11:
    s_mov_b32 s49, 0
    s_lshr_b32 s43, s20, 1
    s_lshl_b32 s43, s43, 7
    s_and_b32 s40, s20, 1
    s_lshl_b32 s40, s40, 4
    s_add_u32 s43, s43, s40
    s_add_u32 s44, s43, 0x1000
    s_cmp_eq_u32 s21, 0
    s_cselect_b32 s44, s44, 0x7ff00000
    s_waitcnt vmcnt(0) lgkmcnt(0)
    s_barrier
    buffer_load_dwordx4 v[0:3], v117, s[8:11], s23 offen sc1
    s_waitcnt vmcnt(0)
    s_cmp_eq_u32 s21, 1
    s_cbranch_scc1 L_chain_top1_f
    s_cmp_eq_u32 s21, 2
    s_cbranch_scc1 L_chain_top2_f
    s_cmp_eq_u32 s21, 3
    s_cbranch_scc1 L_chain_top3_f
.p2align 6
L_chain_top0_f:
    buffer_load_dwordx4 v[0:3], v117, s[8:11], s23 offen nt
    v_mov_b32 v15, 0
    v_mov_b32 v15, 0
    v_mov_b32 v15, 0
    v_mov_b32 v15, 0
    v_mov_b32 v15, 0
    v_mov_b32 v15, 0
    v_mov_b32 v15, 0
    v_mov_b32 v15, 0
    v_mov_b32 v15, 0
    v_mov_b32 v15, 0
    v_mov_b32 v15, 0
    v_mov_b32 v15, 0
    v_mov_b32 v15, 0
    v_mov_b32 v15, 0
    v_mov_b32 v15, 0
    v_mov_b32 v15, 0
    buffer_load_dwordx4 v[0:3], v117, s[8:11], s23 offen sc1
    v_mov_b32 v15, 0
    v_mov_b32 v15, 0
    v_mov_b32 v15, 0
    v_mov_b32 v15, 0
    v_mov_b32 v15, 0
    v_mov_b32 v15, 0
    v_mov_b32 v15, 0
    v_mov_b32 v15, 0
    v_mov_b32 v15, 0
    v_mov_b32 v15, 0
    v_mov_b32 v15, 0
    v_mov_b32 v15, 0
    v_mov_b32 v15, 0
    v_mov_b32 v15, 0
    v_mov_b32 v15, 0
    v_mov_b32 v15, 0
L_mret_14:
    buffer_load_dwordx4 v[0:3], v117, s[8:11], s23 offen sc1
    s_add_u32 s45, s45, 1
    s_cmp_lt_u32 s45, 0x10000
    s_cselect_b32 s56, -2, -1
    s_waitcnt vmcnt(2)
    v_max3_u32 v15, v0, v1, v2
    v_max_u32 v15, v15, v3
    v_cmp_lt_u32 vcc, s56, v15
    s_cbranch_vccnz L_mret_14
    v_smfmac_f32_16x16x64_bf16 v[32:35], v[0:3], v[88:95], v116
    ds_write_b128 v117, v[0:3]
    v_smfmac_f32_16x16x64_bf16 v[36:39], v[0:3], v[56:63], v116
    buffer_load_dwordx4 v[4:7], v117, s[8:11], s48 offen nt
    v_smfmac_f32_16x16x64_bf16 v[40:43], v[0:3], v[64:71], v116
    buffer_load_dwordx4 v117, s[8:11], s48 offen nt lds
    s_mov_b32 m0, s27
    v_smfmac_f32_16x16x64_bf16 v[44:47], v[0:3], v[72:79], v116
    s_waitcnt lgkmcnt(0)
    s_barrier
    v_smfmac_f32_16x16x64_bf16 v[48:51], v[0:3], a[192:199], v116
    ds_read_b128 v[8:11], v117 offset:1024
    ds_read_b128 v[16:19], v117 offset:2048
    ds_read_b128 v[20:23], v117 offset:3072
    v_smfmac_f32_16x16x64_bf16 v[52:55], v[0:3], a[200:207], v116
    ds_read_b128 v[88:91], v117 offset:24576
    ds_read_b128 v[92:95], v117 offset:25600
    s_waitcnt lgkmcnt(4)
    v_smfmac_f32_16x16x64_bf16 v[32:35], v[8:11], a[0:7], v116
    ds_read_b128 v[56:59], v126
    v_smfmac_f32_16x16x64_bf16 v[36:39], v[8:11], a[8:15], v116
    ds_read_b128 v[60:63], v126 offset:1024
    s_waitcnt lgkmcnt(5)
    v_smfmac_f32_16x16x64_bf16 v[32:35], v[16:19], a[32:39], v116
    ds_read_b128 v[64:67], v126 offset:2048
    v_smfmac_f32_16x16x64_bf16 v[36:39], v[16:19], a[40:47], v116
    ds_read_b128 v[68:71], v126 offset:3072
    s_waitcnt lgkmcnt(6)
    v_smfmac_f32_16x16x64_bf16 v[32:35], v[20:23], a[64:71], v116
    ds_read_b128 v[72:75], v126 offset:4096
    v_smfmac_f32_16x16x64_bf16 v[36:39], v[20:23], a[72:79], v116
    ds_read_b128 v[76:79], v126 offset:5120
    v_smfmac_f32_16x16x64_bf16 v[40:43], v[8:11], a[96:103], v116
    v_smfmac_f32_16x16x64_bf16 v[40:43], v[16:19], a[128:135], v116
    v_smfmac_f32_16x16x64_bf16 v[40:43], v[20:23], a[160:167], v116
    v_smfmac_f32_16x16x64_bf16 v[44:47], v[8:11], a[104:111], v116
    s_waitcnt vmcnt(1)
    v_max3_u32 v15, v4, v5, v6
    v_max_u32 v15, v15, v7
    v_smfmac_f32_16x16x64_bf16 v[44:47], v[16:19], a[136:143], v116
    v_cmp_lt_u32 vcc, s56, v15
    s_cbranch_vccnz L_mret_15
L_mgo_16:
    s_waitcnt vmcnt(0)
    s_barrier
    v_smfmac_f32_16x16x64_bf16 v[44:47], v[4:7], v[24:31], v116
    ds_read_b128 v[12:15], v117 offset:5120
    ds_read_b128 v[24:27], v117 offset:6144
    v_smfmac_f32_16x16x64_bf16 v[32:35], v[4:7], v[80:87], v116
    ds_read_b128 v[28:31], v117 offset:7168
    v_smfmac_f32_16x16x64_bf16 v[36:39], v[4:7], v[96:103], v116
    buffer_load_dword v125, v119, s[8:11], s28 offen sc1
    v_smfmac_f32_16x16x64_bf16 v[40:43], v[4:7], v[104:111], v116
    buffer_load_dwordx4 v117, s[8:11], s30 offen lds
    s_xor_b32 s27, s27, 0x6000
    v_mov_b32 v96, 0
    v_smfmac_f32_16x16x64_bf16 v[48:51], v[4:7], a[208:215], v116
    buffer_load_dwordx4 v117, s[8:11], s30 offen offset:1024 lds
    s_add_u32 m0, s52, 0x6000
    v_mov_b32 v97, 0
    v_smfmac_f32_16x16x64_bf16 v[52:55], v[4:7], a[216:223], v116
    s_waitcnt lgkmcnt(9)
    buffer_load_dwordx4 v117, s[8:11], s31 offen lds
    s_waitcnt lgkmcnt(2)
    v_mov_b32 v98, 0
    v_smfmac_f32_16x16x64_bf16 v[32:35], v[12:15], a[16:23], v116
    buffer_load_dwordx4 v117, s[8:11], s31 offen offset:1024 lds
    s_mov_b32 m0, 4096
    s_waitcnt lgkmcnt(1)
    v_mov_b32 v99, 0
    v_smfmac_f32_16x16x64_bf16 v[32:35], v[24:27], a[48:55], v116
    buffer_store_dwordx4 v[112:115], v117, s[8:11], s32 offen sc1
    s_waitcnt lgkmcnt(0)
    v_mov_b32 v100, 0
    v_smfmac_f32_16x16x64_bf16 v[32:35], v[28:31], a[80:87], v116
    ds_read_b128 v[80:83], v126 offset:6144
    v_mov_b32 v101, 0
    v_smfmac_f32_16x16x64_bf16 v[36:39], v[12:15], a[24:31], v116
    ds_read_b128 v[84:87], v126 offset:7168
    v_mov_b32 v102, 0
    v_smfmac_f32_16x16x64_bf16 v[36:39], v[24:27], a[56:63], v116
    ds_read_b128 v[0:3], v124
    v_add_f32 v32, v32, v34
    v_add_f32 v33, v33, v35
    v_smfmac_f32_16x16x64_bf16 v[36:39], v[28:31], a[88:95], v116
    ds_read_b128 v[4:7], v124 offset:1024
    v_mul_f32 v32, s34, v32
    v_mul_f32 v33, s34, v33
    v_smfmac_f32_16x16x64_bf16 v[40:43], v[12:15], a[112:119], v116
    v_mov_b32 v103, 0
    v_smfmac_f32_16x16x64_bf16 v[40:43], v[24:27], a[144:151], v116
    v_add_f32 v36, v36, v38
    v_add_f32 v37, v37, v39
    v_smfmac_f32_16x16x64_bf16 v[40:43], v[28:31], a[176:183], v116
    v_mul_f32 v36, s34, v36
    v_smfmac_f32_16x16x64_bf16 v[44:47], v[20:23], a[168:175], v116
    v_mul_f32 v37, s34, v37
    v_smfmac_f32_16x16x64_bf16 v[44:47], v[12:15], a[120:127], v116
    v_cvt_pk_bf16_f32 v34, v32, v36
    v_smfmac_f32_16x16x64_bf16 v[44:47], v[24:27], a[152:159], v116
    v_cvt_pk_bf16_f32 v35, v33, v37
    v_smfmac_f32_16x16x64_bf16 v[44:47], v[28:31], a[184:191], v116
    ds_write2_b32 v120, v34, v35 offset0:32 offset1:48
    v_add_f32 v40, v40, v42
    v_smfmac_f32_16x16x64_bf16 v[48:51], v[8:11], a[224:231], v116
    v_add_f32 v41, v41, v43
    v_smfmac_f32_16x16x64_bf16 v[52:55], v[8:11], a[232:239], v116
    v_add_f32 v44, v44, v46
    v_add_f32 v45, v45, v47
    v_cvt_pk_bf16_f32 v113, v40, v44
    v_cvt_pk_bf16_f32 v115, v41, v45
    v_smfmac_f32_16x16x64_bf16 v[48:51], v[12:15], a[240:247], v116
    ds_write2_b32 v120, v113, v115 offset0:0 offset1:16
    v_mov_b32 v36, s57
    v_smfmac_f32_16x16x64_bf16 v[52:55], v[12:15], a[248:255], v116
    v_mov_b32 v104, 0
    v_smfmac_f32_16x16x64_bf16 v[48:51], v[16:19], v[128:135], v116
    buffer_store_dword v36, off, s[8:11], s44 sc1
    v_mov_b32 v105, 0
    v_smfmac_f32_16x16x64_bf16 v[48:51], v[20:23], v[160:167], v116
    v_mov_b32 v106, 0
    v_smfmac_f32_16x16x64_bf16 v[48:51], v[24:27], v[144:151], v116
    s_cmp_eq_u32 s22, 63
    s_waitcnt lgkmcnt(0)
    s_barrier
    s_cbranch_scc1 L_chain_last_f
    ds_read_b128 v[32:35], v121
    v_smfmac_f32_16x16x64_bf16 v[48:51], v[28:31], v[176:183], v116
    ds_read_b128 v[36:39], v121 offset:1024
    ds_read_b128 v[40:43], v121 offset:2048
    v_mov_b32 v107, 0
    v_smfmac_f32_16x16x64_bf16 v[52:55], v[16:19], v[136:143], v116
    ds_read_b128 v[44:47], v121 offset:3072
    v_mov_b32 v108, 0
    v_smfmac_f32_16x16x64_bf16 v[52:55], v[20:23], v[168:175], v116
    ds_read_b128 v[8:11], v124 offset:32768
    v_add_f32 v48, v48, v50
    v_smfmac_f32_16x16x64_bf16 v[52:55], v[24:27], v[152:159], v116
    ds_read_b128 v[12:15], v124 offset:33792
    v_add_f32 v49, v49, v51
    v_smfmac_f32_16x16x64_bf16 v[52:55], v[28:31], v[184:191], v116
    ds_read_b128 v[16:19], v124 offset:2048
    s_waitcnt lgkmcnt(6)
    v_cvt_pk_bf16_f32 v112, v48, v49
    v_mov_b32 v109, 0
    v_mov_b32 v110, 0
    v_mov_b32 v111, 0
    v_mfma_f32_16x16x32_bf16 v[56:59], v[56:59], v[32:35], 0
    s_waitcnt lgkmcnt(5)
    v_mov_b32 v48, s50
    v_mov_b32 v49, s50
    v_mfma_f32_16x16x32_bf16 v[56:59], v[60:63], v[36:39], v[56:59]
    ds_read_b128 v[20:23], v124 offset:3072
    s_waitcnt lgkmcnt(5)
    v_mov_b32 v50, s50
    v_mfma_f32_16x16x32_bf16 v[56:59], v[64:67], v[40:43], v[56:59]
    ds_read_b128 v[24:27], v124 offset:4096
    s_waitcnt lgkmcnt(5)
    v_add_f32 v52, v52, v54
    v_mfma_f32_16x16x32_bf16 v[56:59], v[68:71], v[44:47], v[56:59]
    ds_read_b128 v[28:31], v124 offset:5120
    v_add_f32 v53, v53, v55
    v_mfma_f32_16x16x32_bf16 v[60:63], v[72:75], v[32:35], 0
    v_cvt_pk_bf16_f32 v114, v52, v53
    v_mfma_f32_16x16x32_bf16 v[60:63], v[76:79], v[36:39], v[60:63]
    v_exp_f32 v56, v56
    v_mfma_f32_16x16x32_bf16 v[60:63], v[80:83], v[40:43], v[60:63]
    v_exp_f32 v57, v57
    v_mfma_f32_16x16x32_bf16 v[60:63], v[84:87], v[44:47], v[60:63]
    v_exp_f32 v58, v58
    v_mfma_f32_16x16x32_bf16 v[64:67], v[32:35], v[32:35], 0
    v_exp_f32 v59, v59
    v_cvt_pk_bf16_f32 v68, v56, v57
    v_mfma_f32_16x16x32_bf16 v[64:67], v[36:39], v[36:39], v[64:67]
    v_exp_f32 v60, v60
    v_cvt_pk_bf16_f32 v69, v58, v59
    v_mfma_f32_16x16x32_bf16 v[64:67], v[40:43], v[40:43], v[64:67]
    v_exp_f32 v61, v61
    v_mfma_f32_16x16x32_bf16 v[64:67], v[44:47], v[44:47], v[64:67]
    v_exp_f32 v62, v62
    v_exp_f32 v63, v63
    v_cvt_pk_bf16_f32 v70, v60, v61
    v_cvt_pk_bf16_f32 v71, v62, v63
    v_mov_b32 v51, s50
    v_mov_b32 v53, 0
    v_mfma_f32_16x16x32_bf16 v[72:75], v[88:91], v[68:71], 0
    s_nop 0
    v_exp_f32 v64, v64
    v_mfma_f32_16x16x32_bf16 v[76:79], v[92:95], v[68:71], 0
    v_exp_f32 v65, v65
    v_mfma_f32_16x16x32_bf16 v[80:83], v[48:51], v[68:71], 0
    ds_read_b128 v[32:35], v124 offset:6144
    v_cvt_pk_bf16_f32 v52, v64, v65
    s_nop 1
    v_mfma_f32_16x16x16_bf16 v[72:75], v[112:113], v[52:53], v[72:75]
    ds_read_b128 v[36:39], v124 offset:7168
    v_mfma_f32_16x16x16_bf16 v[76:79], v[114:115], v[52:53], v[76:79]
    v_mfma_f32_16x16x16_bf16 v[80:83], v[48:49], v[52:53], v[80:83]
L_norm_17:
    s_mov_b64 vcc, s[36:37]
    s_nop 2
    v_cndmask_b32_dpp v76, v72, v76, vcc quad_perm:[2,3,2,3] row_mask:0xf bank_mask:0xf
    v_cndmask_b32_dpp v77, v73, v77, vcc quad_perm:[2,3,2,3] row_mask:0xf bank_mask:0xf
    v_cndmask_b32_dpp v78, v74, v78, vcc quad_perm:[2,3,2,3] row_mask:0xf bank_mask:0xf
    v_cndmask_b32_dpp v79, v75, v79, vcc quad_perm:[2,3,2,3] row_mask:0xf bank_mask:0xf
    v_rcp_f32_dpp v84, v80 quad_perm:[2,3,2,3] row_mask:0xf bank_mask:0xf
    s_nop 0
    v_pk_mul_f32 v[76:77], v[76:77], v[84:85] op_sel_hi:[1,0]
    v_pk_mul_f32 v[78:79], v[78:79], v[84:85] op_sel_hi:[1,0]
    v_cvt_pk_bf16_f32 v72, v76, v77
    v_cvt_pk_bf16_f32 v73, v78, v79
    ds_write_b64 v122, v[72:73] offset:4096
    v_max_f32_dpp v86, v80, v84 quad_perm:[2,3,2,3] row_mask:0xf bank_mask:0xf
    v_mov_b32_dpp v60, v72 quad_perm:[0,1,0,1] row_mask:0xf bank_mask:0xf
    v_mov_b32_dpp v61, v73 quad_perm:[0,1,0,1] row_mask:0xf bank_mask:0xf
    v_cmp_lt_f32 vcc, s35, v86
    v_mov_b32_dpp v62, v72 quad_perm:[2,3,2,3] row_mask:0xf bank_mask:0xf
    v_mov_b32_dpp v63, v73 quad_perm:[2,3,2,3] row_mask:0xf bank_mask:0xf
    s_cbranch_vccnz L_smax_18
    s_nop 0
    v_smfmac_f32_16x16x64_bf16 v[96:99], v[60:63], v[192:199], v116
    v_smfmac_f32_16x16x64_bf16 v[100:103], v[60:63], v[224:231], v116
    v_smfmac_f32_16x16x64_bf16 v[104:107], v[60:63], v[0:7], v116
    s_waitcnt lgkmcnt(0)
    s_barrier
    ds_read_b128 v[92:95], v127 offset:4608
    ds_read_b128 v[80:83], v127 offset:5120
    ds_read_b128 v[84:87], v127 offset:5632
    v_smfmac_f32_16x16x64_bf16 v[108:111], v[60:63], v[8:15], v116
    s_waitcnt lgkmcnt(2)
    v_smfmac_f32_16x16x64_bf16 v[96:99], v[92:95], v[200:207], v116
    s_waitcnt lgkmcnt(1)
    v_smfmac_f32_16x16x64_bf16 v[96:99], v[80:83], v[208:215], v116
    ds_read_b128 v[40:43], v124 offset:34816
    s_waitcnt lgkmcnt(1)
    v_smfmac_f32_16x16x64_bf16 v[96:99], v[84:87], v[216:223], v116
    ds_read_b128 v[44:47], v124 offset:35840
    v_smfmac_f32_16x16x64_bf16 v[100:103], v[92:95], v[232:239], v116
    ds_read_b128 v[56:59], v124 offset:36864
    v_smfmac_f32_16x16x64_bf16 v[100:103], v[80:83], v[240:247], v116
    ds_read_b128 v[60:63], v124 offset:37888
    v_cvt_pk_bf16_f32 v72, v96, v98
    v_smfmac_f32_16x16x64_bf16 v[100:103], v[84:87], v[248:255], v116
    ds_read_b128 v[64:67], v124 offset:38912
    v_and_or_b32 v72, v72, -2, s33
    v_smfmac_f32_16x16x64_bf16 v[104:107], v[92:95], v[16:23], v116
    ds_read_b128 v[68:71], v124 offset:39936
    v_cvt_pk_bf16_f32 v74, v97, v99
    v_smfmac_f32_16x16x64_bf16 v[104:107], v[80:83], v[24:31], v116
    v_cvt_pk_bf16_f32 v73, v100, v102
    v_cvt_pk_bf16_f32 v75, v101, v103
    v_smfmac_f32_16x16x64_bf16 v[104:107], v[84:87], v[32:39], v116
    buffer_store_dwordx4 v[72:75], v118, s[8:11], s25 offen
    s_waitcnt lgkmcnt(4)
    v_smfmac_f32_16x16x64_bf16 v[108:111], v[92:95], v[40:47], v116
    s_waitcnt lgkmcnt(2)
    v_smfmac_f32_16x16x64_bf16 v[108:111], v[80:83], v[56:63], v116
    s_waitcnt lgkmcnt(0)
    v_cvt_pk_bf16_f32 v76, v104, v106
    v_smfmac_f32_16x16x64_bf16 v[108:111], v[84:87], v[64:71], v116
    v_and_or_b32 v76, v76, -2, s33
    v_cvt_pk_bf16_f32 v78, v105, v107
    s_nop 5
    v_cvt_pk_bf16_f32 v77, v108, v110
    v_cvt_pk_bf16_f32 v79, v109, v111
    buffer_store_dwordx4 v[76:79], v118, s[8:11], s26 offen
    s_add_u32 s30, s30, 0x40000
    s_add_u32 s31, s31, 0x40000
    s_add_u32 s32, s32, 0x20000
    s_add_u32 s23, s24, 0
    s_add_u32 s48, s23, 4096
    s_xor_b32 s25, s25, 0x40000
    s_xor_b32 s26, s26, 0x40000
    s_mov_b32 s35, 0x49800000
    s_mov_b32 s57, s22
    s_add_u32 s22, s22, 1
    v_xor_b32 v126, 0x6000, v126
    v_mov_b32 v32, 0
    v_mov_b32 v33, 0
    v_mov_b32 v34, 0
    v_mov_b32 v35, 0
    v_mov_b32 v36, 0
    v_mov_b32 v37, 0
    v_mov_b32 v38, 0
    v_mov_b32 v39, 0
    v_mov_b32 v40, 0
    v_mov_b32 v41, 0
    v_mov_b32 v42, 0
    v_mov_b32 v43, 0
    v_mov_b32 v44, 0
    v_mov_b32 v45, 0
    v_mov_b32 v46, 0
    v_mov_b32 v47, 0
    v_mov_b32 v48, 0
    v_mov_b32 v49, 0
    v_mov_b32 v50, 0
    v_mov_b32 v51, 0
    v_mov_b32 v52, 0
    v_mov_b32 v53, 0
    v_mov_b32 v54, 0
    v_mov_b32 v55, 0
    ds_read_b128 v[88:91], v123
    ds_read_b128 v[92:95], v123 offset:1024
    ds_read_b128 v[56:59], v123 offset:2048
    ds_read_b128 v[60:63], v123 offset:3072
    ds_read_b128 v[64:67], v123 offset:32768
    ds_read_b128 v[68:71], v123 offset:33792
    ds_read_b128 v[72:75], v123 offset:34816
    ds_read_b128 v[76:79], v123 offset:35840
    ds_read_b128 v[80:83], v123 offset:4096
    ds_read_b128 v[84:87], v123 offset:5120
    ds_read_b128 v[96:99], v123 offset:6144
    ds_read_b128 v[100:103], v123 offset:7168
    ds_read_b128 v[104:107], v123 offset:36864
    ds_read_b128 v[108:111], v123 offset:37888
    ds_read_b128 v[24:27], v123 offset:38912
    ds_read_b128 v[28:31], v123 offset:39936
    s_add_u32 s24, s24, 8192
    s_bitset0_b32 s24, 15
    s_xor_b32 s55, s24, 16384
    s_xor_b32 s29, s29, 0x40000
    s_xor_b32 s53, s29, 1024
    s_bfe_u32 s33, s22, 0x10001
    s_add_u32 s40, s22, 5
    s_lshr_b32 s40, s40, 2
    s_min_u32 s40, s40, 16
    s_bfm_b32 s58, s40, 0
    s_waitcnt vmcnt(2)
    v_cmp_eq_u32 vcc, 0, v125
    s_nop 0
    s_and_b64 vcc, vcc, s[58:59]
    s_cbranch_scc1 L_kvw_19
L_kvb_20:
    v_mov_b32 v15, 0
    s_nop 2
    v_mov_b32 v15, 0
    s_nop 2
    v_mov_b32 v15, 0
    s_nop 2
    v_mov_b32 v15, 0
    s_nop 2
    v_mov_b32 v15, 0
    s_nop 2
    v_mov_b32 v15, 0
    s_nop 2
    v_mov_b32 v15, 0
    s_nop 2
    v_mov_b32 v15, 0
    s_nop 2
    v_mov_b32 v15, 0
    s_nop 2
    v_mov_b32 v15, 0
    s_nop 2
    v_mov_b32 v15, 0
    s_nop 2
    v_mov_b32 v15, 0
    s_nop 2
    v_mov_b32 v15, 0
    s_nop 2
    v_mov_b32 v15, 0
    s_nop 2
    v_mov_b32 v15, 0
    s_nop 2
    v_mov_b32 v15, 0
    s_nop 2
    v_mov_b32 v15, 0
    s_nop 2
    v_mov_b32 v15, 0
    s_nop 2
    v_mov_b32 v15, 0
    s_nop 2
    v_mov_b32 v15, 0
    s_nop 2
    v_mov_b32 v15, 0
    s_nop 2
    v_mov_b32 v15, 0
    s_nop 2
    v_mov_b32 v15, 0
    s_nop 2
    v_mov_b32 v15, 0
    s_nop 2
    v_mov_b32 v15, 0
    s_nop 2
    v_mov_b32 v15, 0
    s_nop 2
    v_mov_b32 v15, 0
    s_nop 2
    v_mov_b32 v15, 0
    s_nop 2
    v_mov_b32 v15, 0
    s_nop 2
    v_mov_b32 v15, 0
    s_nop 2
    s_waitcnt lgkmcnt(0)
    s_branch L_chain_top0_f
.p2align 6
L_chain_top1_f:
    buffer_load_dwordx4 v[0:3], v117, s[8:11], s23 offen nt
    v_mov_b32 v15, 0
    v_mov_b32 v15, 0
    v_mov_b32 v15, 0
    v_mov_b32 v15, 0
    v_mov_b32 v15, 0
    v_mov_b32 v15, 0
    v_mov_b32 v15, 0
    v_mov_b32 v15, 0
    v_mov_b32 v15, 0
    v_mov_b32 v15, 0
    v_mov_b32 v15, 0
    v_mov_b32 v15, 0
    v_mov_b32 v15, 0
    v_mov_b32 v15, 0
    v_mov_b32 v15, 0
    v_mov_b32 v15, 0
    buffer_load_dwordx4 v[0:3], v117, s[8:11], s23 offen sc1
    v_mov_b32 v15, 0
    v_mov_b32 v15, 0
    v_mov_b32 v15, 0
    v_mov_b32 v15, 0
    v_mov_b32 v15, 0
    v_mov_b32 v15, 0
    v_mov_b32 v15, 0
    v_mov_b32 v15, 0
    v_mov_b32 v15, 0
    v_mov_b32 v15, 0
    v_mov_b32 v15, 0
    v_mov_b32 v15, 0
    v_mov_b32 v15, 0
    v_mov_b32 v15, 0
    v_mov_b32 v15, 0
    v_mov_b32 v15, 0
L_mret_21:
    buffer_load_dwordx4 v[0:3], v117, s[8:11], s23 offen sc1
    s_add_u32 s45, s45, 1
    s_cmp_lt_u32 s45, 0x10000
    s_cselect_b32 s56, -2, -1
    s_waitcnt vmcnt(2)
    v_max3_u32 v15, v0, v1, v2
    v_max_u32 v15, v15, v3
    v_cmp_lt_u32 vcc, s56, v15
    s_cbranch_vccnz L_mret_21
    v_smfmac_f32_16x16x64_bf16 v[32:35], v[0:3], v[88:95], v116
    ds_write_b128 v117, v[0:3] offset:1024
    v_smfmac_f32_16x16x64_bf16 v[36:39], v[0:3], v[56:63], v116
    buffer_load_dwordx4 v[4:7], v117, s[8:11], s48 offen nt
    v_smfmac_f32_16x16x64_bf16 v[40:43], v[0:3], v[64:71], v116
    buffer_load_dwordx4 v117, s[8:11], s48 offen nt lds
    s_mov_b32 m0, s27
    v_smfmac_f32_16x16x64_bf16 v[44:47], v[0:3], v[72:79], v116
    s_waitcnt lgkmcnt(0)
    s_barrier
    v_smfmac_f32_16x16x64_bf16 v[48:51], v[0:3], a[192:199], v116
    ds_read_b128 v[8:11], v117
    ds_read_b128 v[16:19], v117 offset:3072
    ds_read_b128 v[20:23], v117 offset:2048
    v_smfmac_f32_16x16x64_bf16 v[52:55], v[0:3], a[200:207], v116
    ds_read_b128 v[88:91], v117 offset:26624
    ds_read_b128 v[92:95], v117 offset:27648
    s_waitcnt lgkmcnt(4)
    v_smfmac_f32_16x16x64_bf16 v[32:35], v[8:11], a[0:7], v116
    ds_read_b128 v[56:59], v126
    v_smfmac_f32_16x16x64_bf16 v[36:39], v[8:11], a[8:15], v116
    ds_read_b128 v[60:63], v126 offset:1024
    s_waitcnt lgkmcnt(5)
    v_smfmac_f32_16x16x64_bf16 v[32:35], v[16:19], a[32:39], v116
    ds_read_b128 v[64:67], v126 offset:2048
    v_smfmac_f32_16x16x64_bf16 v[36:39], v[16:19], a[40:47], v116
    ds_read_b128 v[68:71], v126 offset:3072
    s_waitcnt lgkmcnt(6)
    v_smfmac_f32_16x16x64_bf16 v[32:35], v[20:23], a[64:71], v116
    ds_read_b128 v[72:75], v126 offset:4096
    v_smfmac_f32_16x16x64_bf16 v[36:39], v[20:23], a[72:79], v116
    ds_read_b128 v[76:79], v126 offset:5120
    v_smfmac_f32_16x16x64_bf16 v[40:43], v[8:11], a[96:103], v116
    v_smfmac_f32_16x16x64_bf16 v[40:43], v[16:19], a[128:135], v116
    v_smfmac_f32_16x16x64_bf16 v[40:43], v[20:23], a[160:167], v116
    v_smfmac_f32_16x16x64_bf16 v[44:47], v[8:11], a[104:111], v116
    s_waitcnt vmcnt(1)
    v_max3_u32 v15, v4, v5, v6
    v_max_u32 v15, v15, v7
    v_smfmac_f32_16x16x64_bf16 v[44:47], v[16:19], a[136:143], v116
    v_cmp_lt_u32 vcc, s56, v15
    s_cbranch_vccnz L_mret_22
L_mgo_23:
    s_waitcnt vmcnt(0)
    s_barrier
    v_smfmac_f32_16x16x64_bf16 v[44:47], v[4:7], v[24:31], v116
    ds_read_b128 v[12:15], v117 offset:4096
    ds_read_b128 v[24:27], v117 offset:7168
    v_smfmac_f32_16x16x64_bf16 v[32:35], v[4:7], v[80:87], v116
    ds_read_b128 v[28:31], v117 offset:6144
    v_smfmac_f32_16x16x64_bf16 v[36:39], v[4:7], v[96:103], v116
    buffer_load_dword v125, v119, s[8:11], s28 offen sc1
    v_smfmac_f32_16x16x64_bf16 v[40:43], v[4:7], v[104:111], v116
    buffer_load_dwordx4 v117, s[8:11], s30 offen lds
    s_xor_b32 s27, s27, 0x6000
    v_mov_b32 v96, 0
    v_smfmac_f32_16x16x64_bf16 v[48:51], v[4:7], a[208:215], v116
    buffer_load_dwordx4 v117, s[8:11], s30 offen offset:1024 lds
    s_add_u32 m0, s52, 0x6000
    v_mov_b32 v97, 0
    v_smfmac_f32_16x16x64_bf16 v[52:55], v[4:7], a[216:223], v116
    s_waitcnt lgkmcnt(9)
    buffer_load_dwordx4 v117, s[8:11], s31 offen lds
    s_waitcnt lgkmcnt(2)
    v_mov_b32 v98, 0
    v_smfmac_f32_16x16x64_bf16 v[32:35], v[12:15], a[16:23], v116
    buffer_load_dwordx4 v117, s[8:11], s31 offen offset:1024 lds
    s_mov_b32 m0, 5120
    s_waitcnt lgkmcnt(1)
    v_mov_b32 v99, 0
    v_smfmac_f32_16x16x64_bf16 v[32:35], v[24:27], a[48:55], v116
    buffer_store_dwordx4 v[112:115], v117, s[8:11], s32 offen sc1
    s_waitcnt lgkmcnt(0)
    v_mov_b32 v100, 0
    v_smfmac_f32_16x16x64_bf16 v[32:35], v[28:31], a[80:87], v116
    ds_read_b128 v[80:83], v126 offset:6144
    v_mov_b32 v101, 0
    v_smfmac_f32_16x16x64_bf16 v[36:39], v[12:15], a[24:31], v116
    ds_read_b128 v[84:87], v126 offset:7168
    v_mov_b32 v102, 0
    v_smfmac_f32_16x16x64_bf16 v[36:39], v[24:27], a[56:63], v116
    ds_read_b128 v[0:3], v124
    v_add_f32 v32, v32, v34
    v_add_f32 v33, v33, v35
    v_smfmac_f32_16x16x64_bf16 v[36:39], v[28:31], a[88:95], v116
    ds_read_b128 v[4:7], v124 offset:1024
    v_mul_f32 v32, s34, v32
    v_mul_f32 v33, s34, v33
    v_smfmac_f32_16x16x64_bf16 v[40:43], v[12:15], a[112:119], v116
    v_mov_b32 v103, 0
    v_smfmac_f32_16x16x64_bf16 v[40:43], v[24:27], a[144:151], v116
    v_add_f32 v36, v36, v38
    v_add_f32 v37, v37, v39
    v_smfmac_f32_16x16x64_bf16 v[40:43], v[28:31], a[176:183], v116
    v_mul_f32 v36, s34, v36
    v_smfmac_f32_16x16x64_bf16 v[44:47], v[20:23], a[168:175], v116
    v_mul_f32 v37, s34, v37
    v_smfmac_f32_16x16x64_bf16 v[44:47], v[12:15], a[120:127], v116
    v_cvt_pk_bf16_f32 v34, v32, v36
    v_smfmac_f32_16x16x64_bf16 v[44:47], v[24:27], a[152:159], v116
    v_cvt_pk_bf16_f32 v35, v33, v37
    v_smfmac_f32_16x16x64_bf16 v[44:47], v[28:31], a[184:191], v116
    ds_write2_b32 v120, v34, v35 offset0:32 offset1:48
    v_add_f32 v40, v40, v42
    v_smfmac_f32_16x16x64_bf16 v[48:51], v[8:11], a[224:231], v116
    v_add_f32 v41, v41, v43
    v_smfmac_f32_16x16x64_bf16 v[52:55], v[8:11], a[232:239], v116
    v_add_f32 v44, v44, v46
    v_add_f32 v45, v45, v47
    v_cvt_pk_bf16_f32 v113, v40, v44
    v_cvt_pk_bf16_f32 v115, v41, v45
    v_smfmac_f32_16x16x64_bf16 v[48:51], v[12:15], a[240:247], v116
    ds_write2_b32 v120, v113, v115 offset0:0 offset1:16
    v_smfmac_f32_16x16x64_bf16 v[52:55], v[12:15], a[248:255], v116
    v_mov_b32 v104, 0
    v_smfmac_f32_16x16x64_bf16 v[48:51], v[16:19], v[128:135], v116
    v_mov_b32 v105, 0
    v_smfmac_f32_16x16x64_bf16 v[48:51], v[20:23], v[160:167], v116
    v_mov_b32 v106, 0
    v_smfmac_f32_16x16x64_bf16 v[48:51], v[24:27], v[144:151], v116
    s_cmp_eq_u32 s22, 63
    s_waitcnt lgkmcnt(0)
    s_barrier
    s_cbranch_scc1 L_chain_last_f
    ds_read_b128 v[32:35], v121
    v_smfmac_f32_16x16x64_bf16 v[48:51], v[28:31], v[176:183], v116
    ds_read_b128 v[36:39], v121 offset:1024
    ds_read_b128 v[40:43], v121 offset:2048
    v_mov_b32 v107, 0
    v_smfmac_f32_16x16x64_bf16 v[52:55], v[16:19], v[136:143], v116
    ds_read_b128 v[44:47], v121 offset:3072
    v_mov_b32 v108, 0
    v_smfmac_f32_16x16x64_bf16 v[52:55], v[20:23], v[168:175], v116
    ds_read_b128 v[8:11], v124 offset:32768
    v_add_f32 v48, v48, v50
    v_smfmac_f32_16x16x64_bf16 v[52:55], v[24:27], v[152:159], v116
    ds_read_b128 v[12:15], v124 offset:33792
    v_add_f32 v49, v49, v51
    v_smfmac_f32_16x16x64_bf16 v[52:55], v[28:31], v[184:191], v116
    ds_read_b128 v[16:19], v124 offset:2048
    s_waitcnt lgkmcnt(6)
    v_cvt_pk_bf16_f32 v112, v48, v49
    v_mov_b32 v109, 0
    v_mov_b32 v110, 0
    v_mov_b32 v111, 0
    v_mfma_f32_16x16x32_bf16 v[56:59], v[56:59], v[32:35], 0
    s_waitcnt lgkmcnt(5)
    v_mov_b32 v48, s50
    v_mov_b32 v49, s50
    v_mfma_f32_16x16x32_bf16 v[56:59], v[60:63], v[36:39], v[56:59]
    ds_read_b128 v[20:23], v124 offset:3072
    s_waitcnt lgkmcnt(5)
    v_mov_b32 v50, s50
    v_mfma_f32_16x16x32_bf16 v[56:59], v[64:67], v[40:43], v[56:59]
    ds_read_b128 v[24:27], v124 offset:4096
    s_waitcnt lgkmcnt(5)
    v_add_f32 v52, v52, v54
    v_mfma_f32_16x16x32_bf16 v[56:59], v[68:71], v[44:47], v[56:59]
    ds_read_b128 v[28:31], v124 offset:5120
    v_add_f32 v53, v53, v55
    v_mfma_f32_16x16x32_bf16 v[60:63], v[72:75], v[32:35], 0
    v_cvt_pk_bf16_f32 v114, v52, v53
    v_mfma_f32_16x16x32_bf16 v[60:63], v[76:79], v[36:39], v[60:63]
    v_exp_f32 v56, v56
    v_mfma_f32_16x16x32_bf16 v[60:63], v[80:83], v[40:43], v[60:63]
    v_exp_f32 v57, v57
    v_mfma_f32_16x16x32_bf16 v[60:63], v[84:87], v[44:47], v[60:63]
    v_exp_f32 v58, v58
    v_mfma_f32_16x16x32_bf16 v[64:67], v[32:35], v[32:35], 0
    v_exp_f32 v59, v59
    v_cvt_pk_bf16_f32 v68, v56, v57
    v_mfma_f32_16x16x32_bf16 v[64:67], v[36:39], v[36:39], v[64:67]
    v_exp_f32 v60, v60
    v_cvt_pk_bf16_f32 v69, v58, v59
    v_mfma_f32_16x16x32_bf16 v[64:67], v[40:43], v[40:43], v[64:67]
    v_exp_f32 v61, v61
    v_mfma_f32_16x16x32_bf16 v[64:67], v[44:47], v[44:47], v[64:67]
    v_exp_f32 v62, v62
    v_exp_f32 v63, v63
    v_cvt_pk_bf16_f32 v70, v60, v61
    v_cvt_pk_bf16_f32 v71, v62, v63
    v_mov_b32 v51, s50
    v_mov_b32 v53, 0
    v_mfma_f32_16x16x32_bf16 v[72:75], v[88:91], v[68:71], 0
    s_nop 0
    v_exp_f32 v64, v64
    v_mfma_f32_16x16x32_bf16 v[76:79], v[92:95], v[68:71], 0
    v_exp_f32 v65, v65
    v_mfma_f32_16x16x32_bf16 v[80:83], v[48:51], v[68:71], 0
    ds_read_b128 v[32:35], v124 offset:6144
    v_cvt_pk_bf16_f32 v52, v64, v65
    s_nop 1
    v_mfma_f32_16x16x16_bf16 v[72:75], v[112:113], v[52:53], v[72:75]
    ds_read_b128 v[36:39], v124 offset:7168
    v_mfma_f32_16x16x16_bf16 v[76:79], v[114:115], v[52:53], v[76:79]
    v_mfma_f32_16x16x16_bf16 v[80:83], v[48:49], v[52:53], v[80:83]
L_norm_24:
    s_mov_b64 vcc, s[36:37]
    s_nop 2
    v_cndmask_b32_dpp v76, v72, v76, vcc quad_perm:[2,3,2,3] row_mask:0xf bank_mask:0xf
    v_cndmask_b32_dpp v77, v73, v77, vcc quad_perm:[2,3,2,3] row_mask:0xf bank_mask:0xf
    v_cndmask_b32_dpp v78, v74, v78, vcc quad_perm:[2,3,2,3] row_mask:0xf bank_mask:0xf
    v_cndmask_b32_dpp v79, v75, v79, vcc quad_perm:[2,3,2,3] row_mask:0xf bank_mask:0xf
    v_rcp_f32_dpp v84, v80 quad_perm:[2,3,2,3] row_mask:0xf bank_mask:0xf
    s_nop 0
    v_pk_mul_f32 v[76:77], v[76:77], v[84:85] op_sel_hi:[1,0]
    v_pk_mul_f32 v[78:79], v[78:79], v[84:85] op_sel_hi:[1,0]
    v_cvt_pk_bf16_f32 v72, v76, v77
    v_cvt_pk_bf16_f32 v73, v78, v79
    ds_write_b64 v122, v[72:73] offset:4608
    v_max_f32_dpp v86, v80, v84 quad_perm:[2,3,2,3] row_mask:0xf bank_mask:0xf
    v_mov_b32_dpp v60, v72 quad_perm:[0,1,0,1] row_mask:0xf bank_mask:0xf
    v_mov_b32_dpp v61, v73 quad_perm:[0,1,0,1] row_mask:0xf bank_mask:0xf
    v_cmp_lt_f32 vcc, s35, v86
    v_mov_b32_dpp v62, v72 quad_perm:[2,3,2,3] row_mask:0xf bank_mask:0xf
    v_mov_b32_dpp v63, v73 quad_perm:[2,3,2,3] row_mask:0xf bank_mask:0xf
    s_cbranch_vccnz L_smax_25
    s_nop 0
    v_smfmac_f32_16x16x64_bf16 v[96:99], v[60:63], v[192:199], v116
    v_smfmac_f32_16x16x64_bf16 v[100:103], v[60:63], v[224:231], v116
    v_smfmac_f32_16x16x64_bf16 v[104:107], v[60:63], v[0:7], v116
    s_waitcnt lgkmcnt(0)
    s_barrier
    ds_read_b128 v[92:95], v127 offset:4096
    ds_read_b128 v[80:83], v127 offset:5632
    ds_read_b128 v[84:87], v127 offset:5120
    v_smfmac_f32_16x16x64_bf16 v[108:111], v[60:63], v[8:15], v116
    s_waitcnt lgkmcnt(2)
    v_smfmac_f32_16x16x64_bf16 v[96:99], v[92:95], v[200:207], v116
    s_waitcnt lgkmcnt(1)
    v_smfmac_f32_16x16x64_bf16 v[96:99], v[80:83], v[208:215], v116
    ds_read_b128 v[40:43], v124 offset:34816
    s_waitcnt lgkmcnt(1)
    v_smfmac_f32_16x16x64_bf16 v[96:99], v[84:87], v[216:223], v116
    ds_read_b128 v[44:47], v124 offset:35840
    v_smfmac_f32_16x16x64_bf16 v[100:103], v[92:95], v[232:239], v116
    ds_read_b128 v[56:59], v124 offset:36864
    v_smfmac_f32_16x16x64_bf16 v[100:103], v[80:83], v[240:247], v116
    ds_read_b128 v[60:63], v124 offset:37888
    v_cvt_pk_bf16_f32 v72, v96, v98
    v_smfmac_f32_16x16x64_bf16 v[100:103], v[84:87], v[248:255], v116
    ds_read_b128 v[64:67], v124 offset:38912
    v_and_or_b32 v72, v72, -2, s33
    v_smfmac_f32_16x16x64_bf16 v[104:107], v[92:95], v[16:23], v116
    ds_read_b128 v[68:71], v124 offset:39936
    v_cvt_pk_bf16_f32 v74, v97, v99
    v_smfmac_f32_16x16x64_bf16 v[104:107], v[80:83], v[24:31], v116
    v_cvt_pk_bf16_f32 v73, v100, v102
    v_cvt_pk_bf16_f32 v75, v101, v103
    v_smfmac_f32_16x16x64_bf16 v[104:107], v[84:87], v[32:39], v116
    buffer_store_dwordx4 v[72:75], v118, s[8:11], s25 offen
    s_waitcnt lgkmcnt(4)
    v_smfmac_f32_16x16x64_bf16 v[108:111], v[92:95], v[40:47], v116
    s_waitcnt lgkmcnt(2)
    v_smfmac_f32_16x16x64_bf16 v[108:111], v[80:83], v[56:63], v116
    s_waitcnt lgkmcnt(0)
    v_cvt_pk_bf16_f32 v76, v104, v106
    v_smfmac_f32_16x16x64_bf16 v[108:111], v[84:87], v[64:71], v116
    v_and_or_b32 v76, v76, -2, s33
    v_cvt_pk_bf16_f32 v78, v105, v107
    s_nop 5
    v_cvt_pk_bf16_f32 v77, v108, v110
    v_cvt_pk_bf16_f32 v79, v109, v111
    buffer_store_dwordx4 v[76:79], v118, s[8:11], s26 offen
    s_add_u32 s30, s30, 0x40000
    s_add_u32 s31, s31, 0x40000
    s_add_u32 s32, s32, 0x20000
    s_add_u32 s23, s24, 1024
    s_add_u32 s48, s23, 4096
    s_xor_b32 s25, s25, 0x40000
    s_xor_b32 s26, s26, 0x40000
    s_mov_b32 s35, 0x49800000
    s_mov_b32 s57, s22
    s_add_u32 s22, s22, 1
    v_xor_b32 v126, 0x6000, v126
    v_mov_b32 v32, 0
    v_mov_b32 v33, 0
    v_mov_b32 v34, 0
    v_mov_b32 v35, 0
    v_mov_b32 v36, 0
    v_mov_b32 v37, 0
    v_mov_b32 v38, 0
    v_mov_b32 v39, 0
    v_mov_b32 v40, 0
    v_mov_b32 v41, 0
    v_mov_b32 v42, 0
    v_mov_b32 v43, 0
    v_mov_b32 v44, 0
    v_mov_b32 v45, 0
    v_mov_b32 v46, 0
    v_mov_b32 v47, 0
    v_mov_b32 v48, 0
    v_mov_b32 v49, 0
    v_mov_b32 v50, 0
    v_mov_b32 v51, 0
    v_mov_b32 v52, 0
    v_mov_b32 v53, 0
    v_mov_b32 v54, 0
    v_mov_b32 v55, 0
    ds_read_b128 v[88:91], v123
    ds_read_b128 v[92:95], v123 offset:1024
    ds_read_b128 v[56:59], v123 offset:2048
    ds_read_b128 v[60:63], v123 offset:3072
    ds_read_b128 v[64:67], v123 offset:32768
    ds_read_b128 v[68:71], v123 offset:33792
    ds_read_b128 v[72:75], v123 offset:34816
    ds_read_b128 v[76:79], v123 offset:35840
    ds_read_b128 v[80:83], v123 offset:4096
    ds_read_b128 v[84:87], v123 offset:5120
    ds_read_b128 v[96:99], v123 offset:6144
    ds_read_b128 v[100:103], v123 offset:7168
    ds_read_b128 v[104:107], v123 offset:36864
    ds_read_b128 v[108:111], v123 offset:37888
    ds_read_b128 v[24:27], v123 offset:38912
    ds_read_b128 v[28:31], v123 offset:39936
    s_add_u32 s24, s24, 8192
    s_bitset0_b32 s24, 15
    s_xor_b32 s55, s24, 16384
    s_xor_b32 s29, s29, 0x40000
    s_xor_b32 s53, s29, 1024
    s_bfe_u32 s33, s22, 0x10001
    s_add_u32 s40, s22, 5
    s_lshr_b32 s40, s40, 2
    s_min_u32 s40, s40, 16
    s_bfm_b32 s58, s40, 0
    s_waitcnt vmcnt(2)
    v_cmp_eq_u32 vcc, 0, v125
    s_nop 0
    s_and_b64 vcc, vcc, s[58:59]
    s_cbranch_scc1 L_kvw_26
L_kvb_27:
    v_mov_b32 v15, 0
    s_nop 2
    v_mov_b32 v15, 0
    s_nop 2
    v_mov_b32 v15, 0
    s_nop 2
    v_mov_b32 v15, 0
    s_nop 2
    v_mov_b32 v15, 0
    s_nop 2
    v_mov_b32 v15, 0
    s_nop 2
    v_mov_b32 v15, 0
    s_nop 2
    v_mov_b32 v15, 0
    s_nop 2
    v_mov_b32 v15, 0
    s_nop 2
    v_mov_b32 v15, 0
    s_nop 2
    v_mov_b32 v15, 0
    s_nop 2
    v_mov_b32 v15, 0
    s_nop 2
    v_mov_b32 v15, 0
    s_nop 2
    v_mov_b32 v15, 0
    s_nop 2
    v_mov_b32 v15, 0
    s_nop 2
    v_mov_b32 v15, 0
    s_nop 2
    v_mov_b32 v15, 0
    s_nop 2
    v_mov_b32 v15, 0
    s_nop 2
    v_mov_b32 v15, 0
    s_nop 2
    v_mov_b32 v15, 0
    s_nop 2
    v_mov_b32 v15, 0
    s_nop 2
    v_mov_b32 v15, 0
    s_nop 2
    v_mov_b32 v15, 0
    s_nop 2
    v_mov_b32 v15, 0
    s_nop 2
    v_mov_b32 v15, 0
    s_nop 2
    v_mov_b32 v15, 0
    s_nop 2
    v_mov_b32 v15, 0
    s_nop 2
    v_mov_b32 v15, 0
    s_nop 2
    v_mov_b32 v15, 0
    s_nop 2
    v_mov_b32 v15, 0
    s_nop 2
    s_waitcnt lgkmcnt(0)
    s_branch L_chain_top1_f
.p2align 6
L_chain_top2_f:
    buffer_load_dwordx4 v[0:3], v117, s[8:11], s23 offen nt
    v_mov_b32 v48, 0
    v_mov_b32 v49, 0
    v_mov_b32 v50, 0
    v_mov_b32 v51, 0
    v_mov_b32 v52, 0
    v_mov_b32 v53, 0
    v_mov_b32 v15, 0
    v_mov_b32 v15, 0
    v_mov_b32 v15, 0
    v_mov_b32 v15, 0
    v_mov_b32 v15, 0
    v_mov_b32 v15, 0
    v_mov_b32 v15, 0
    v_mov_b32 v15, 0
    v_mov_b32 v15, 0
    v_mov_b32 v15, 0
    buffer_load_dwordx4 v[0:3], v117, s[8:11], s23 offen sc1
    v_mov_b32 v15, 0
    v_mov_b32 v15, 0
    v_mov_b32 v15, 0
    v_mov_b32 v15, 0
    v_mov_b32 v15, 0
    v_mov_b32 v15, 0
    v_mov_b32 v15, 0
    v_mov_b32 v15, 0
    v_mov_b32 v15, 0
    v_mov_b32 v15, 0
    v_mov_b32 v15, 0
    v_mov_b32 v15, 0
    v_mov_b32 v15, 0
    v_mov_b32 v15, 0
    v_mov_b32 v15, 0
    v_mov_b32 v15, 0
L_mret_28:
    buffer_load_dwordx4 v[0:3], v117, s[8:11], s23 offen sc1
    s_add_u32 s45, s45, 1
    s_cmp_lt_u32 s45, 0x10000
    s_cselect_b32 s56, -2, -1
    s_waitcnt vmcnt(2)
    v_max3_u32 v15, v0, v1, v2
    v_max_u32 v15, v15, v3
    v_cmp_lt_u32 vcc, s56, v15
    s_cbranch_vccnz L_mret_28
    v_smfmac_f32_16x16x64_bf16 v[32:35], v[0:3], v[88:95], v116
    ds_write_b128 v117, v[0:3] offset:2048
    v_smfmac_f32_16x16x64_bf16 v[36:39], v[0:3], v[56:63], v116
    buffer_load_dwordx4 v[4:7], v117, s[8:11], s48 offen nt
    v_smfmac_f32_16x16x64_bf16 v[40:43], v[0:3], v[64:71], v116
    buffer_load_dwordx4 v117, s[8:11], s48 offen nt lds
    s_mov_b32 m0, s27
    v_smfmac_f32_16x16x64_bf16 v[44:47], v[0:3], v[72:79], v116
    s_waitcnt lgkmcnt(0)
    s_barrier
    v_smfmac_f32_16x16x64_bf16 v[48:51], v[0:3], a[192:199], v116
    ds_read_b128 v[8:11], v117 offset:3072
    ds_read_b128 v[16:19], v117
    ds_read_b128 v[20:23], v117 offset:1024
    v_smfmac_f32_16x16x64_bf16 v[52:55], v[0:3], a[200:207], v116
    ds_read_b128 v[88:91], v117 offset:28672
    ds_read_b128 v[92:95], v117 offset:29696
    s_waitcnt lgkmcnt(4)
    v_smfmac_f32_16x16x64_bf16 v[32:35], v[8:11], a[0:7], v116
    ds_read_b128 v[56:59], v126
    v_smfmac_f32_16x16x64_bf16 v[36:39], v[8:11], a[8:15], v116
    ds_read_b128 v[60:63], v126 offset:1024
    s_waitcnt lgkmcnt(5)
    v_smfmac_f32_16x16x64_bf16 v[32:35], v[16:19], a[32:39], v116
    ds_read_b128 v[64:67], v126 offset:2048
    v_smfmac_f32_16x16x64_bf16 v[36:39], v[16:19], a[40:47], v116
    ds_read_b128 v[68:71], v126 offset:3072
    s_waitcnt lgkmcnt(6)
    v_smfmac_f32_16x16x64_bf16 v[32:35], v[20:23], a[64:71], v116
    ds_read_b128 v[72:75], v126 offset:4096
    v_smfmac_f32_16x16x64_bf16 v[36:39], v[20:23], a[72:79], v116
    ds_read_b128 v[76:79], v126 offset:5120
    v_smfmac_f32_16x16x64_bf16 v[40:43], v[8:11], a[96:103], v116
    v_smfmac_f32_16x16x64_bf16 v[40:43], v[16:19], a[128:135], v116
    v_smfmac_f32_16x16x64_bf16 v[40:43], v[20:23], a[160:167], v116
    v_smfmac_f32_16x16x64_bf16 v[44:47], v[8:11], a[104:111], v116
    s_waitcnt vmcnt(1)
    v_max3_u32 v15, v4, v5, v6
    v_max_u32 v15, v15, v7
    v_smfmac_f32_16x16x64_bf16 v[44:47], v[16:19], a[136:143], v116
    v_cmp_lt_u32 vcc, s56, v15
    s_cbranch_vccnz L_mret_29
L_mgo_30:
    s_waitcnt vmcnt(0)
    s_barrier
    v_smfmac_f32_16x16x64_bf16 v[44:47], v[4:7], v[24:31], v116
    ds_read_b128 v[12:15], v117 offset:7168
    ds_read_b128 v[24:27], v117 offset:4096
    v_smfmac_f32_16x16x64_bf16 v[32:35], v[4:7], v[80:87], v116
    ds_read_b128 v[28:31], v117 offset:5120
    v_smfmac_f32_16x16x64_bf16 v[36:39], v[4:7], v[96:103], v116
    buffer_load_dwordx4 v117, s[8:11], s30 offen lds
    s_xor_b32 s27, s27, 0x6000
    v_smfmac_f32_16x16x64_bf16 v[40:43], v[4:7], v[104:111], v116
    buffer_load_dwordx4 v117, s[8:11], s30 offen offset:1024 lds
    s_add_u32 m0, s52, 0x6000
    v_mov_b32 v96, 0
    v_smfmac_f32_16x16x64_bf16 v[48:51], v[4:7], a[208:215], v116
    s_waitcnt lgkmcnt(9)
    buffer_load_dwordx4 v117, s[8:11], s31 offen lds
    v_mov_b32 v97, 0
    v_smfmac_f32_16x16x64_bf16 v[52:55], v[4:7], a[216:223], v116
    buffer_load_dwordx4 v117, s[8:11], s31 offen offset:1024 lds
    s_mov_b32 m0, 6144
    s_waitcnt lgkmcnt(2)
    v_mov_b32 v98, 0
    v_smfmac_f32_16x16x64_bf16 v[32:35], v[12:15], a[16:23], v116
    buffer_store_dwordx4 v[112:115], v117, s[8:11], s32 offen sc1
    s_waitcnt lgkmcnt(1)
    v_mov_b32 v99, 0
    v_smfmac_f32_16x16x64_bf16 v[32:35], v[24:27], a[48:55], v116
    ds_read_b128 v[80:83], v126 offset:6144
    s_waitcnt lgkmcnt(1)
    v_mov_b32 v100, 0
    v_smfmac_f32_16x16x64_bf16 v[32:35], v[28:31], a[80:87], v116
    ds_read_b128 v[84:87], v126 offset:7168
    v_mov_b32 v101, 0
    v_smfmac_f32_16x16x64_bf16 v[36:39], v[12:15], a[24:31], v116
    ds_read_b128 v[0:3], v124
    v_mov_b32 v102, 0
    v_smfmac_f32_16x16x64_bf16 v[36:39], v[24:27], a[56:63], v116
    ds_read_b128 v[4:7], v124 offset:1024
    v_add_f32 v32, v32, v34
    v_add_f32 v33, v33, v35
    v_smfmac_f32_16x16x64_bf16 v[36:39], v[28:31], a[88:95], v116
    v_mul_f32 v32, s34, v32
    v_mul_f32 v33, s34, v33
    v_smfmac_f32_16x16x64_bf16 v[40:43], v[12:15], a[112:119], v116
    v_mov_b32 v103, 0
    v_smfmac_f32_16x16x64_bf16 v[40:43], v[24:27], a[144:151], v116
    v_add_f32 v36, v36, v38
    v_add_f32 v37, v37, v39
    v_smfmac_f32_16x16x64_bf16 v[40:43], v[28:31], a[176:183], v116
    v_mul_f32 v36, s34, v36
    v_smfmac_f32_16x16x64_bf16 v[44:47], v[20:23], a[168:175], v116
    v_mul_f32 v37, s34, v37
    v_smfmac_f32_16x16x64_bf16 v[44:47], v[12:15], a[120:127], v116
    v_cvt_pk_bf16_f32 v34, v32, v36
    v_smfmac_f32_16x16x64_bf16 v[44:47], v[24:27], a[152:159], v116
    v_cvt_pk_bf16_f32 v35, v33, v37
    v_smfmac_f32_16x16x64_bf16 v[44:47], v[28:31], a[184:191], v116
    ds_write2_b32 v120, v34, v35 offset0:32 offset1:48
    v_add_f32 v40, v40, v42
    v_smfmac_f32_16x16x64_bf16 v[48:51], v[8:11], a[224:231], v116
    v_add_f32 v41, v41, v43
    v_smfmac_f32_16x16x64_bf16 v[52:55], v[8:11], a[232:239], v116
    v_add_f32 v44, v44, v46
    v_add_f32 v45, v45, v47
    v_cvt_pk_bf16_f32 v113, v40, v44
    v_cvt_pk_bf16_f32 v115, v41, v45
    v_smfmac_f32_16x16x64_bf16 v[48:51], v[12:15], a[240:247], v116
    ds_write2_b32 v120, v113, v115 offset0:0 offset1:16
    v_mov_b32 v36, -1
    v_smfmac_f32_16x16x64_bf16 v[52:55], v[12:15], a[248:255], v116
    v_mov_b32 v104, 0
    v_smfmac_f32_16x16x64_bf16 v[48:51], v[16:19], v[128:135], v116
    buffer_store_dword v36, v119, s[8:11], s55 offen
    v_mov_b32 v105, 0
    v_smfmac_f32_16x16x64_bf16 v[48:51], v[20:23], v[160:167], v116
    v_mov_b32 v106, 0
    v_smfmac_f32_16x16x64_bf16 v[48:51], v[24:27], v[144:151], v116
    s_cmp_eq_u32 s22, 63
    s_waitcnt lgkmcnt(0)
    s_barrier
    s_cbranch_scc1 L_chain_last_f
    ds_read_b128 v[32:35], v121
    v_smfmac_f32_16x16x64_bf16 v[48:51], v[28:31], v[176:183], v116
    ds_read_b128 v[36:39], v121 offset:1024
    ds_read_b128 v[40:43], v121 offset:2048
    v_mov_b32 v107, 0
    v_smfmac_f32_16x16x64_bf16 v[52:55], v[16:19], v[136:143], v116
    ds_read_b128 v[44:47], v121 offset:3072
    v_mov_b32 v108, 0
    v_smfmac_f32_16x16x64_bf16 v[52:55], v[20:23], v[168:175], v116
    ds_read_b128 v[8:11], v124 offset:32768
    v_add_f32 v48, v48, v50
    v_smfmac_f32_16x16x64_bf16 v[52:55], v[24:27], v[152:159], v116
    ds_read_b128 v[12:15], v124 offset:33792
    v_add_f32 v49, v49, v51
    v_smfmac_f32_16x16x64_bf16 v[52:55], v[28:31], v[184:191], v116
    ds_read_b128 v[16:19], v124 offset:2048
    s_waitcnt lgkmcnt(6)
    v_cvt_pk_bf16_f32 v112, v48, v49
    v_mov_b32 v109, 0
    v_mov_b32 v110, 0
    v_mov_b32 v111, 0
    v_mfma_f32_16x16x32_bf16 v[56:59], v[56:59], v[32:35], 0
    s_waitcnt lgkmcnt(5)
    v_mov_b32 v48, s50
    v_mov_b32 v49, s50
    v_mfma_f32_16x16x32_bf16 v[56:59], v[60:63], v[36:39], v[56:59]
    ds_read_b128 v[20:23], v124 offset:3072
    s_waitcnt lgkmcnt(5)
    v_mov_b32 v50, s50
    v_mfma_f32_16x16x32_bf16 v[56:59], v[64:67], v[40:43], v[56:59]
    ds_read_b128 v[24:27], v124 offset:4096
    s_waitcnt lgkmcnt(5)
    v_add_f32 v52, v52, v54
    v_mfma_f32_16x16x32_bf16 v[56:59], v[68:71], v[44:47], v[56:59]
    ds_read_b128 v[28:31], v124 offset:5120
    v_add_f32 v53, v53, v55
    v_mfma_f32_16x16x32_bf16 v[60:63], v[72:75], v[32:35], 0
    v_cvt_pk_bf16_f32 v114, v52, v53
    v_mfma_f32_16x16x32_bf16 v[60:63], v[76:79], v[36:39], v[60:63]
    v_exp_f32 v56, v56
    v_mfma_f32_16x16x32_bf16 v[60:63], v[80:83], v[40:43], v[60:63]
    v_exp_f32 v57, v57
    v_mfma_f32_16x16x32_bf16 v[60:63], v[84:87], v[44:47], v[60:63]
    v_exp_f32 v58, v58
    v_mfma_f32_16x16x32_bf16 v[64:67], v[32:35], v[32:35], 0
    v_exp_f32 v59, v59
    v_cvt_pk_bf16_f32 v68, v56, v57
    v_mfma_f32_16x16x32_bf16 v[64:67], v[36:39], v[36:39], v[64:67]
    v_exp_f32 v60, v60
    v_cvt_pk_bf16_f32 v69, v58, v59
    v_mfma_f32_16x16x32_bf16 v[64:67], v[40:43], v[40:43], v[64:67]
    v_exp_f32 v61, v61
    v_mfma_f32_16x16x32_bf16 v[64:67], v[44:47], v[44:47], v[64:67]
    v_exp_f32 v62, v62
    v_exp_f32 v63, v63
    v_cvt_pk_bf16_f32 v70, v60, v61
    v_cvt_pk_bf16_f32 v71, v62, v63
    v_mov_b32 v51, s50
    v_mov_b32 v53, 0
    v_mfma_f32_16x16x32_bf16 v[72:75], v[88:91], v[68:71], 0
    s_nop 0
    v_exp_f32 v64, v64
    v_mfma_f32_16x16x32_bf16 v[76:79], v[92:95], v[68:71], 0
    v_exp_f32 v65, v65
    v_mfma_f32_16x16x32_bf16 v[80:83], v[48:51], v[68:71], 0
    ds_read_b128 v[32:35], v124 offset:6144
    v_cvt_pk_bf16_f32 v52, v64, v65
    s_nop 1
    v_mfma_f32_16x16x16_bf16 v[72:75], v[112:113], v[52:53], v[72:75]
    ds_read_b128 v[36:39], v124 offset:7168
    v_mfma_f32_16x16x16_bf16 v[76:79], v[114:115], v[52:53], v[76:79]
    v_mfma_f32_16x16x16_bf16 v[80:83], v[48:49], v[52:53], v[80:83]
L_norm_31:
    s_mov_b64 vcc, s[36:37]
    s_nop 2
    v_cndmask_b32_dpp v76, v72, v76, vcc quad_perm:[2,3,2,3] row_mask:0xf bank_mask:0xf
    v_cndmask_b32_dpp v77, v73, v77, vcc quad_perm:[2,3,2,3] row_mask:0xf bank_mask:0xf
    v_cndmask_b32_dpp v78, v74, v78, vcc quad_perm:[2,3,2,3] row_mask:0xf bank_mask:0xf
    v_cndmask_b32_dpp v79, v75, v79, vcc quad_perm:[2,3,2,3] row_mask:0xf bank_mask:0xf
    v_rcp_f32_dpp v84, v80 quad_perm:[2,3,2,3] row_mask:0xf bank_mask:0xf
    s_nop 0
    v_pk_mul_f32 v[76:77], v[76:77], v[84:85] op_sel_hi:[1,0]
    v_pk_mul_f32 v[78:79], v[78:79], v[84:85] op_sel_hi:[1,0]
    v_cvt_pk_bf16_f32 v72, v76, v77
    v_cvt_pk_bf16_f32 v73, v78, v79
    ds_write_b64 v122, v[72:73] offset:5120
    v_max_f32_dpp v86, v80, v84 quad_perm:[2,3,2,3] row_mask:0xf bank_mask:0xf
    v_mov_b32_dpp v60, v72 quad_perm:[0,1,0,1] row_mask:0xf bank_mask:0xf
    v_mov_b32_dpp v61, v73 quad_perm:[0,1,0,1] row_mask:0xf bank_mask:0xf
    v_cmp_lt_f32 vcc, s35, v86
    v_mov_b32_dpp v62, v72 quad_perm:[2,3,2,3] row_mask:0xf bank_mask:0xf
    v_mov_b32_dpp v63, v73 quad_perm:[2,3,2,3] row_mask:0xf bank_mask:0xf
    s_cbranch_vccnz L_smax_32
    s_nop 0
    v_smfmac_f32_16x16x64_bf16 v[96:99], v[60:63], v[192:199], v116
    v_smfmac_f32_16x16x64_bf16 v[100:103], v[60:63], v[224:231], v116
    v_smfmac_f32_16x16x64_bf16 v[104:107], v[60:63], v[0:7], v116
    s_waitcnt lgkmcnt(0)
    s_barrier
    ds_read_b128 v[92:95], v127 offset:5632
    ds_read_b128 v[80:83], v127 offset:4096
    ds_read_b128 v[84:87], v127 offset:4608
    v_smfmac_f32_16x16x64_bf16 v[108:111], v[60:63], v[8:15], v116
    s_waitcnt lgkmcnt(2)
    v_smfmac_f32_16x16x64_bf16 v[96:99], v[92:95], v[200:207], v116
    s_waitcnt lgkmcnt(1)
    v_smfmac_f32_16x16x64_bf16 v[96:99], v[80:83], v[208:215], v116
    ds_read_b128 v[40:43], v124 offset:34816
    s_waitcnt lgkmcnt(1)
    v_smfmac_f32_16x16x64_bf16 v[96:99], v[84:87], v[216:223], v116
    ds_read_b128 v[44:47], v124 offset:35840
    v_smfmac_f32_16x16x64_bf16 v[100:103], v[92:95], v[232:239], v116
    ds_read_b128 v[56:59], v124 offset:36864
    v_smfmac_f32_16x16x64_bf16 v[100:103], v[80:83], v[240:247], v116
    ds_read_b128 v[60:63], v124 offset:37888
    v_cvt_pk_bf16_f32 v72, v96, v98
    v_smfmac_f32_16x16x64_bf16 v[100:103], v[84:87], v[248:255], v116
    ds_read_b128 v[64:67], v124 offset:38912
    v_and_or_b32 v72, v72, -2, s33
    v_smfmac_f32_16x16x64_bf16 v[104:107], v[92:95], v[16:23], v116
    ds_read_b128 v[68:71], v124 offset:39936
    v_cvt_pk_bf16_f32 v74, v97, v99
    v_smfmac_f32_16x16x64_bf16 v[104:107], v[80:83], v[24:31], v116
    v_cvt_pk_bf16_f32 v73, v100, v102
    v_cvt_pk_bf16_f32 v75, v101, v103
    v_smfmac_f32_16x16x64_bf16 v[104:107], v[84:87], v[32:39], v116
    buffer_store_dwordx4 v[72:75], v118, s[8:11], s25 offen
    s_waitcnt lgkmcnt(4)
    v_smfmac_f32_16x16x64_bf16 v[108:111], v[92:95], v[40:47], v116
    s_waitcnt lgkmcnt(2)
    v_smfmac_f32_16x16x64_bf16 v[108:111], v[80:83], v[56:63], v116
    s_waitcnt lgkmcnt(0)
    v_cvt_pk_bf16_f32 v76, v104, v106
    v_smfmac_f32_16x16x64_bf16 v[108:111], v[84:87], v[64:71], v116
    v_and_or_b32 v76, v76, -2, s33
    v_cvt_pk_bf16_f32 v78, v105, v107
    s_nop 5
    v_cvt_pk_bf16_f32 v77, v108, v110
    v_cvt_pk_bf16_f32 v79, v109, v111
    buffer_store_dwordx4 v[76:79], v118, s[8:11], s26 offen
    ds_read_b128 v[88:91], v123
    ds_read_b128 v[92:95], v123 offset:1024
    ds_read_b128 v[56:59], v123 offset:2048
    ds_read_b128 v[60:63], v123 offset:3072
    ds_read_b128 v[64:67], v123 offset:32768
    ds_read_b128 v[68:71], v123 offset:33792
    ds_read_b128 v[72:75], v123 offset:34816
    ds_read_b128 v[76:79], v123 offset:35840
    ds_read_b128 v[80:83], v123 offset:4096
    ds_read_b128 v[84:87], v123 offset:5120
    ds_read_b128 v[96:99], v123 offset:6144
    ds_read_b128 v[100:103], v123 offset:7168
    ds_read_b128 v[104:107], v123 offset:36864
    ds_read_b128 v[108:111], v123 offset:37888
    ds_read_b128 v[24:27], v123 offset:38912
    ds_read_b128 v[28:31], v123 offset:39936
    s_add_u32 s30, s30, 0x40000
    s_add_u32 s31, s31, 0x40000
    s_add_u32 s32, s32, 0x20000
    s_add_u32 s23, s24, 2048
    s_add_u32 s48, s23, 4096
    s_xor_b32 s25, s25, 0x40000
    s_xor_b32 s26, s26, 0x40000
    s_mov_b32 s35, 0x49800000
    s_mov_b32 s57, s22
    s_add_u32 s22, s22, 1
    v_xor_b32 v126, 0x6000, v126
    v_cndmask_b32 v12, 0, v125, s[68:69]
    v_cndmask_b32 v13, 0, v125, s[70:71]
    v_cndmask_b32 v14, 0, v125, s[72:73]
    v_cndmask_b32 v15, 0, v125, s[74:75]
    v_mov_b32 v32, 0
    v_mov_b32 v33, 0
    v_mov_b32 v34, 0
    v_mov_b32 v35, 0
    v_mov_b32 v36, 0
    v_mov_b32 v37, 0
    v_mov_b32 v38, 0
    v_mov_b32 v39, 0
    v_mov_b32 v40, 0
    v_mov_b32 v41, 0
    v_mov_b32 v42, 0
    v_mov_b32 v43, 0
    v_mov_b32 v44, 0
    v_mov_b32 v45, 0
    v_mov_b32 v46, 0
    v_mov_b32 v47, 0
    v_mov_b32 v54, 0
    v_mov_b32 v55, 0
    v_mov_b32 v52, 0
    v_mov_b32 v52, 0
    v_mov_b32 v52, 0
    v_mov_b32 v52, 0
    v_mov_b32 v52, 0
    v_mov_b32 v52, 0
    buffer_load_dwordx4 v[4:7], v117, s[8:11], s29 offen nt
    buffer_load_dwordx4 v[8:11], v117, s[8:11], s53 offen nt
    buffer_load_dwordx4 v[16:19], v117, s[8:11], s29 offen offset:2048 nt
    buffer_load_dwordx4 v[20:23], v117, s[8:11], s53 offen offset:2048 nt
    v_mov_b32 v52, 0
    s_waitcnt vmcnt(3)
L_rl_33:
    v_mfma_f32_16x16x32_bf16 v[48:51], v[4:7], v[12:15], 0
    v_xor_b32 v52, s33, v4
    s_waitcnt vmcnt(2)
    v_mfma_f32_16x16x32_bf16 v[48:51], v[8:11], v[12:15], v[48:51]
    v_xor_b32 v53, s33, v8
    v_or_b32 v52, v52, v53
    s_waitcnt vmcnt(1)
    v_mfma_f32_16x16x32_bf16 v[48:51], v[16:19], v[12:15], v[48:51]
    v_xor_b32 v53, s33, v16
    v_or_b32 v52, v52, v53
    s_waitcnt vmcnt(0)
    v_mfma_f32_16x16x32_bf16 v[48:51], v[20:23], v[12:15], v[48:51]
    v_xor_b32 v53, s33, v20
    v_or_b32 v52, v52, v53
    v_and_b32 v52, 1, v52
    v_cmp_ne_u32 vcc, 0, v52
    s_cbranch_vccnz L_rslow_34
L_rgo_35:
    s_nop 2
    v_permlane32_swap_b32 v48, v50
    v_permlane32_swap_b32 v49, v51
    v_pk_add_f32 v[48:49], v[48:49], v[50:51]
    s_mov_b64 exec, s[38:39]
    v_cvt_pk_bf16_f32 v12, v48, v49
    v_min_u32 v12, 0xfffffffe, v12
    buffer_store_dword v12, v119, s[8:11], s24 offen
    s_mov_b64 exec, -1
    s_add_u32 s24, s24, 8192
    s_bitset0_b32 s24, 15
    s_xor_b32 s55, s24, 16384
    s_xor_b32 s29, s29, 0x40000
    s_xor_b32 s53, s29, 1024
    s_bfe_u32 s33, s22, 0x10001
    s_waitcnt lgkmcnt(0)
    s_branch L_chain_top2_f
.p2align 6
L_chain_top3_f:
    buffer_load_dwordx4 v[0:3], v117, s[8:11], s23 offen nt
    v_mov_b32 v48, 0
    v_mov_b32 v49, 0
    v_mov_b32 v50, 0
    v_mov_b32 v51, 0
    v_mov_b32 v52, 0
    v_mov_b32 v53, 0
    v_mov_b32 v15, 0
    v_mov_b32 v15, 0
    v_mov_b32 v15, 0
    v_mov_b32 v15, 0
    v_mov_b32 v15, 0
    v_mov_b32 v15, 0
    v_mov_b32 v15, 0
    v_mov_b32 v15, 0
    v_mov_b32 v15, 0
    v_mov_b32 v15, 0
    buffer_load_dwordx4 v[0:3], v117, s[8:11], s23 offen sc1
    v_mov_b32 v15, 0
    v_mov_b32 v15, 0
    v_mov_b32 v15, 0
    v_mov_b32 v15, 0
    v_mov_b32 v15, 0
    v_mov_b32 v15, 0
    v_mov_b32 v15, 0
    v_mov_b32 v15, 0
    v_mov_b32 v15, 0
    v_mov_b32 v15, 0
    v_mov_b32 v15, 0
    v_mov_b32 v15, 0
    v_mov_b32 v15, 0
    v_mov_b32 v15, 0
    v_mov_b32 v15, 0
    v_mov_b32 v15, 0
L_mret_36:
    buffer_load_dwordx4 v[0:3], v117, s[8:11], s23 offen sc1
    s_add_u32 s45, s45, 1
    s_cmp_lt_u32 s45, 0x10000
    s_cselect_b32 s56, -2, -1
    s_waitcnt vmcnt(2)
    v_max3_u32 v15, v0, v1, v2
    v_max_u32 v15, v15, v3
    v_cmp_lt_u32 vcc, s56, v15
    s_cbranch_vccnz L_mret_36
    v_smfmac_f32_16x16x64_bf16 v[32:35], v[0:3], v[88:95], v116
    ds_write_b128 v117, v[0:3] offset:3072
    v_smfmac_f32_16x16x64_bf16 v[36:39], v[0:3], v[56:63], v116
    buffer_load_dwordx4 v[4:7], v117, s[8:11], s48 offen nt
    v_smfmac_f32_16x16x64_bf16 v[40:43], v[0:3], v[64:71], v116
    buffer_load_dwordx4 v117, s[8:11], s48 offen nt lds
    s_mov_b32 m0, s27
    v_smfmac_f32_16x16x64_bf16 v[44:47], v[0:3], v[72:79], v116
    s_waitcnt lgkmcnt(0)
    s_barrier
    v_smfmac_f32_16x16x64_bf16 v[48:51], v[0:3], a[192:199], v116
    ds_read_b128 v[8:11], v117 offset:2048
    ds_read_b128 v[16:19], v117 offset:1024
    ds_read_b128 v[20:23], v117
    v_smfmac_f32_16x16x64_bf16 v[52:55], v[0:3], a[200:207], v116
    ds_read_b128 v[88:91], v117 offset:30720
    ds_read_b128 v[92:95], v117 offset:31744
    s_waitcnt lgkmcnt(4)
    v_smfmac_f32_16x16x64_bf16 v[32:35], v[8:11], a[0:7], v116
    ds_read_b128 v[56:59], v126
    v_smfmac_f32_16x16x64_bf16 v[36:39], v[8:11], a[8:15], v116
    ds_read_b128 v[60:63], v126 offset:1024
    s_waitcnt lgkmcnt(5)
    v_smfmac_f32_16x16x64_bf16 v[32:35], v[16:19], a[32:39], v116
    ds_read_b128 v[64:67], v126 offset:2048
    v_smfmac_f32_16x16x64_bf16 v[36:39], v[16:19], a[40:47], v116
    ds_read_b128 v[68:71], v126 offset:3072
    s_waitcnt lgkmcnt(6)
    v_smfmac_f32_16x16x64_bf16 v[32:35], v[20:23], a[64:71], v116
    ds_read_b128 v[72:75], v126 offset:4096
    v_smfmac_f32_16x16x64_bf16 v[36:39], v[20:23], a[72:79], v116
    ds_read_b128 v[76:79], v126 offset:5120
    v_smfmac_f32_16x16x64_bf16 v[40:43], v[8:11], a[96:103], v116
    v_smfmac_f32_16x16x64_bf16 v[40:43], v[16:19], a[128:135], v116
    v_smfmac_f32_16x16x64_bf16 v[40:43], v[20:23], a[160:167], v116
    v_smfmac_f32_16x16x64_bf16 v[44:47], v[8:11], a[104:111], v116
    s_waitcnt vmcnt(1)
    v_max3_u32 v15, v4, v5, v6
    v_max_u32 v15, v15, v7
    v_smfmac_f32_16x16x64_bf16 v[44:47], v[16:19], a[136:143], v116
    v_cmp_lt_u32 vcc, s56, v15
    s_cbranch_vccnz L_mret_37
L_mgo_38:
    s_waitcnt vmcnt(0)
    s_barrier
    v_smfmac_f32_16x16x64_bf16 v[44:47], v[4:7], v[24:31], v116
    ds_read_b128 v[12:15], v117 offset:6144
    ds_read_b128 v[24:27], v117 offset:5120
    v_smfmac_f32_16x16x64_bf16 v[32:35], v[4:7], v[80:87], v116
    ds_read_b128 v[28:31], v117 offset:4096
    v_smfmac_f32_16x16x64_bf16 v[36:39], v[4:7], v[96:103], v116
    buffer_load_dwordx4 v117, s[8:11], s30 offen lds
    s_xor_b32 s27, s27, 0x6000
    v_smfmac_f32_16x16x64_bf16 v[40:43], v[4:7], v[104:111], v116
    buffer_load_dwordx4 v117, s[8:11], s30 offen offset:1024 lds
    s_add_u32 m0, s52, 0x6000
    v_mov_b32 v96, 0
    v_smfmac_f32_16x16x64_bf16 v[48:51], v[4:7], a[208:215], v116
    s_waitcnt lgkmcnt(9)
    buffer_load_dwordx4 v117, s[8:11], s31 offen lds
    v_mov_b32 v97, 0
    v_smfmac_f32_16x16x64_bf16 v[52:55], v[4:7], a[216:223], v116
    buffer_load_dwordx4 v117, s[8:11], s31 offen offset:1024 lds
    s_mov_b32 m0, 7168
    s_waitcnt lgkmcnt(2)
    v_mov_b32 v98, 0
    v_smfmac_f32_16x16x64_bf16 v[32:35], v[12:15], a[16:23], v116
    buffer_store_dwordx4 v[112:115], v117, s[8:11], s32 offen sc1
    s_waitcnt lgkmcnt(1)
    v_mov_b32 v99, 0
    v_smfmac_f32_16x16x64_bf16 v[32:35], v[24:27], a[48:55], v116
    ds_read_b128 v[80:83], v126 offset:6144
    s_waitcnt lgkmcnt(1)
    v_mov_b32 v100, 0
    v_smfmac_f32_16x16x64_bf16 v[32:35], v[28:31], a[80:87], v116
    ds_read_b128 v[84:87], v126 offset:7168
    v_mov_b32 v101, 0
    v_smfmac_f32_16x16x64_bf16 v[36:39], v[12:15], a[24:31], v116
    ds_read_b128 v[0:3], v124
    v_mov_b32 v102, 0
    v_smfmac_f32_16x16x64_bf16 v[36:39], v[24:27], a[56:63], v116
    ds_read_b128 v[4:7], v124 offset:1024
    v_add_f32 v32, v32, v34
    v_add_f32 v33, v33, v35
    v_smfmac_f32_16x16x64_bf16 v[36:39], v[28:31], a[88:95], v116
    v_mul_f32 v32, s34, v32
    v_mul_f32 v33, s34, v33
    v_smfmac_f32_16x16x64_bf16 v[40:43], v[12:15], a[112:119], v116
    v_mov_b32 v103, 0
    v_smfmac_f32_16x16x64_bf16 v[40:43], v[24:27], a[144:151], v116
    v_add_f32 v36, v36, v38
    v_add_f32 v37, v37, v39
    v_smfmac_f32_16x16x64_bf16 v[40:43], v[28:31], a[176:183], v116
    v_mul_f32 v36, s34, v36
    v_smfmac_f32_16x16x64_bf16 v[44:47], v[20:23], a[168:175], v116
    v_mul_f32 v37, s34, v37
    v_smfmac_f32_16x16x64_bf16 v[44:47], v[12:15], a[120:127], v116
    v_cvt_pk_bf16_f32 v34, v32, v36
    v_smfmac_f32_16x16x64_bf16 v[44:47], v[24:27], a[152:159], v116
    v_cvt_pk_bf16_f32 v35, v33, v37
    v_smfmac_f32_16x16x64_bf16 v[44:47], v[28:31], a[184:191], v116
    ds_write2_b32 v120, v34, v35 offset0:32 offset1:48
    v_add_f32 v40, v40, v42
    v_smfmac_f32_16x16x64_bf16 v[48:51], v[8:11], a[224:231], v116
    v_add_f32 v41, v41, v43
    v_smfmac_f32_16x16x64_bf16 v[52:55], v[8:11], a[232:239], v116
    v_add_f32 v44, v44, v46
    v_add_f32 v45, v45, v47
    v_cvt_pk_bf16_f32 v113, v40, v44
    v_cvt_pk_bf16_f32 v115, v41, v45
    v_smfmac_f32_16x16x64_bf16 v[48:51], v[12:15], a[240:247], v116
    ds_write2_b32 v120, v113, v115 offset0:0 offset1:16
    v_mov_b32 v36, -1
    v_smfmac_f32_16x16x64_bf16 v[52:55], v[12:15], a[248:255], v116
    v_mov_b32 v104, 0
    v_smfmac_f32_16x16x64_bf16 v[48:51], v[16:19], v[128:135], v116
    v_mov_b32 v105, 0
    v_smfmac_f32_16x16x64_bf16 v[48:51], v[20:23], v[160:167], v116
    buffer_store_dword v36, v119, s[8:11], s55 offen
    v_mov_b32 v106, 0
    v_smfmac_f32_16x16x64_bf16 v[48:51], v[24:27], v[144:151], v116
    s_cmp_eq_u32 s22, 63
    s_waitcnt lgkmcnt(0)
    s_barrier
    s_cbranch_scc1 L_chain_last_f
    ds_read_b128 v[32:35], v121
    v_smfmac_f32_16x16x64_bf16 v[48:51], v[28:31], v[176:183], v116
    ds_read_b128 v[36:39], v121 offset:1024
    ds_read_b128 v[40:43], v121 offset:2048
    v_mov_b32 v107, 0
    v_smfmac_f32_16x16x64_bf16 v[52:55], v[16:19], v[136:143], v116
    ds_read_b128 v[44:47], v121 offset:3072
    v_mov_b32 v108, 0
    v_smfmac_f32_16x16x64_bf16 v[52:55], v[20:23], v[168:175], v116
    ds_read_b128 v[8:11], v124 offset:32768
    v_add_f32 v48, v48, v50
    v_smfmac_f32_16x16x64_bf16 v[52:55], v[24:27], v[152:159], v116
    ds_read_b128 v[12:15], v124 offset:33792
    v_add_f32 v49, v49, v51
    v_smfmac_f32_16x16x64_bf16 v[52:55], v[28:31], v[184:191], v116
    ds_read_b128 v[16:19], v124 offset:2048
    s_waitcnt lgkmcnt(6)
    v_cvt_pk_bf16_f32 v112, v48, v49
    v_mov_b32 v109, 0
    v_mov_b32 v110, 0
    v_mov_b32 v111, 0
    v_mfma_f32_16x16x32_bf16 v[56:59], v[56:59], v[32:35], 0
    s_waitcnt lgkmcnt(5)
    v_mov_b32 v48, s50
    v_mov_b32 v49, s50
    v_mfma_f32_16x16x32_bf16 v[56:59], v[60:63], v[36:39], v[56:59]
    ds_read_b128 v[20:23], v124 offset:3072
    s_waitcnt lgkmcnt(5)
    v_mov_b32 v50, s50
    v_mfma_f32_16x16x32_bf16 v[56:59], v[64:67], v[40:43], v[56:59]
    ds_read_b128 v[24:27], v124 offset:4096
    s_waitcnt lgkmcnt(5)
    v_add_f32 v52, v52, v54
    v_mfma_f32_16x16x32_bf16 v[56:59], v[68:71], v[44:47], v[56:59]
    ds_read_b128 v[28:31], v124 offset:5120
    v_add_f32 v53, v53, v55
    v_mfma_f32_16x16x32_bf16 v[60:63], v[72:75], v[32:35], 0
    v_cvt_pk_bf16_f32 v114, v52, v53
    v_mfma_f32_16x16x32_bf16 v[60:63], v[76:79], v[36:39], v[60:63]
    v_exp_f32 v56, v56
    v_mfma_f32_16x16x32_bf16 v[60:63], v[80:83], v[40:43], v[60:63]
    v_exp_f32 v57, v57
    v_mfma_f32_16x16x32_bf16 v[60:63], v[84:87], v[44:47], v[60:63]
    v_exp_f32 v58, v58
    v_mfma_f32_16x16x32_bf16 v[64:67], v[32:35], v[32:35], 0
    v_exp_f32 v59, v59
    v_cvt_pk_bf16_f32 v68, v56, v57
    v_mfma_f32_16x16x32_bf16 v[64:67], v[36:39], v[36:39], v[64:67]
    v_exp_f32 v60, v60
    v_cvt_pk_bf16_f32 v69, v58, v59
    v_mfma_f32_16x16x32_bf16 v[64:67], v[40:43], v[40:43], v[64:67]
    v_exp_f32 v61, v61
    v_mfma_f32_16x16x32_bf16 v[64:67], v[44:47], v[44:47], v[64:67]
    v_exp_f32 v62, v62
    v_exp_f32 v63, v63
    v_cvt_pk_bf16_f32 v70, v60, v61
    v_cvt_pk_bf16_f32 v71, v62, v63
    v_mov_b32 v51, s50
    v_mov_b32 v53, 0
    v_mfma_f32_16x16x32_bf16 v[72:75], v[88:91], v[68:71], 0
    s_nop 0
    v_exp_f32 v64, v64
    v_mfma_f32_16x16x32_bf16 v[76:79], v[92:95], v[68:71], 0
    v_exp_f32 v65, v65
    v_mfma_f32_16x16x32_bf16 v[80:83], v[48:51], v[68:71], 0
    ds_read_b128 v[32:35], v124 offset:6144
    v_cvt_pk_bf16_f32 v52, v64, v65
    s_nop 1
    v_mfma_f32_16x16x16_bf16 v[72:75], v[112:113], v[52:53], v[72:75]
    ds_read_b128 v[36:39], v124 offset:7168
    v_mfma_f32_16x16x16_bf16 v[76:79], v[114:115], v[52:53], v[76:79]
    v_mfma_f32_16x16x16_bf16 v[80:83], v[48:49], v[52:53], v[80:83]
L_norm_39:
    s_mov_b64 vcc, s[36:37]
    s_nop 2
    v_cndmask_b32_dpp v76, v72, v76, vcc quad_perm:[2,3,2,3] row_mask:0xf bank_mask:0xf
    v_cndmask_b32_dpp v77, v73, v77, vcc quad_perm:[2,3,2,3] row_mask:0xf bank_mask:0xf
    v_cndmask_b32_dpp v78, v74, v78, vcc quad_perm:[2,3,2,3] row_mask:0xf bank_mask:0xf
    v_cndmask_b32_dpp v79, v75, v79, vcc quad_perm:[2,3,2,3] row_mask:0xf bank_mask:0xf
    v_rcp_f32_dpp v84, v80 quad_perm:[2,3,2,3] row_mask:0xf bank_mask:0xf
    s_nop 0
    v_pk_mul_f32 v[76:77], v[76:77], v[84:85] op_sel_hi:[1,0]
    v_pk_mul_f32 v[78:79], v[78:79], v[84:85] op_sel_hi:[1,0]
    v_cvt_pk_bf16_f32 v72, v76, v77
    v_cvt_pk_bf16_f32 v73, v78, v79
    ds_write_b64 v122, v[72:73] offset:5632
    v_max_f32_dpp v86, v80, v84 quad_perm:[2,3,2,3] row_mask:0xf bank_mask:0xf
    v_mov_b32_dpp v60, v72 quad_perm:[0,1,0,1] row_mask:0xf bank_mask:0xf
    v_mov_b32_dpp v61, v73 quad_perm:[0,1,0,1] row_mask:0xf bank_mask:0xf
    v_cmp_lt_f32 vcc, s35, v86
    v_mov_b32_dpp v62, v72 quad_perm:[2,3,2,3] row_mask:0xf bank_mask:0xf
    v_mov_b32_dpp v63, v73 quad_perm:[2,3,2,3] row_mask:0xf bank_mask:0xf
    s_cbranch_vccnz L_smax_40
    s_nop 0
    v_smfmac_f32_16x16x64_bf16 v[96:99], v[60:63], v[192:199], v116
    v_smfmac_f32_16x16x64_bf16 v[100:103], v[60:63], v[224:231], v116
    v_smfmac_f32_16x16x64_bf16 v[104:107], v[60:63], v[0:7], v116
    s_waitcnt lgkmcnt(0)
    s_barrier
    ds_read_b128 v[92:95], v127 offset:5120
    ds_read_b128 v[80:83], v127 offset:4608
    ds_read_b128 v[84:87], v127 offset:4096
    v_smfmac_f32_16x16x64_bf16 v[108:111], v[60:63], v[8:15], v116
    s_waitcnt lgkmcnt(2)
    v_smfmac_f32_16x16x64_bf16 v[96:99], v[92:95], v[200:207], v116
    s_waitcnt lgkmcnt(1)
    v_smfmac_f32_16x16x64_bf16 v[96:99], v[80:83], v[208:215], v116
    ds_read_b128 v[40:43], v124 offset:34816
    s_waitcnt lgkmcnt(1)
    v_smfmac_f32_16x16x64_bf16 v[96:99], v[84:87], v[216:223], v116
    ds_read_b128 v[44:47], v124 offset:35840
    v_smfmac_f32_16x16x64_bf16 v[100:103], v[92:95], v[232:239], v116
    ds_read_b128 v[56:59], v124 offset:36864
    v_smfmac_f32_16x16x64_bf16 v[100:103], v[80:83], v[240:247], v116
    ds_read_b128 v[60:63], v124 offset:37888
    v_cvt_pk_bf16_f32 v72, v96, v98
    v_smfmac_f32_16x16x64_bf16 v[100:103], v[84:87], v[248:255], v116
    ds_read_b128 v[64:67], v124 offset:38912
    v_and_or_b32 v72, v72, -2, s33
    v_smfmac_f32_16x16x64_bf16 v[104:107], v[92:95], v[16:23], v116
    ds_read_b128 v[68:71], v124 offset:39936
    v_cvt_pk_bf16_f32 v74, v97, v99
    v_smfmac_f32_16x16x64_bf16 v[104:107], v[80:83], v[24:31], v116
    v_cvt_pk_bf16_f32 v73, v100, v102
    v_cvt_pk_bf16_f32 v75, v101, v103
    v_smfmac_f32_16x16x64_bf16 v[104:107], v[84:87], v[32:39], v116
    buffer_store_dwordx4 v[72:75], v118, s[8:11], s25 offen
    s_waitcnt lgkmcnt(4)
    v_smfmac_f32_16x16x64_bf16 v[108:111], v[92:95], v[40:47], v116
    s_waitcnt lgkmcnt(2)
    v_smfmac_f32_16x16x64_bf16 v[108:111], v[80:83], v[56:63], v116
    s_waitcnt lgkmcnt(0)
    v_cvt_pk_bf16_f32 v76, v104, v106
    v_smfmac_f32_16x16x64_bf16 v[108:111], v[84:87], v[64:71], v116
    v_and_or_b32 v76, v76, -2, s33
    v_cvt_pk_bf16_f32 v78, v105, v107
    s_nop 5
    v_cvt_pk_bf16_f32 v77, v108, v110
    v_cvt_pk_bf16_f32 v79, v109, v111
    buffer_store_dwordx4 v[76:79], v118, s[8:11], s26 offen
    ds_read_b128 v[88:91], v123
    ds_read_b128 v[92:95], v123 offset:1024
    ds_read_b128 v[56:59], v123 offset:2048
    ds_read_b128 v[60:63], v123 offset:3072
    ds_read_b128 v[64:67], v123 offset:32768
    ds_read_b128 v[68:71], v123 offset:33792
    ds_read_b128 v[72:75], v123 offset:34816
    ds_read_b128 v[76:79], v123 offset:35840
    ds_read_b128 v[80:83], v123 offset:4096
    ds_read_b128 v[84:87], v123 offset:5120
    ds_read_b128 v[96:99], v123 offset:6144
    ds_read_b128 v[100:103], v123 offset:7168
    ds_read_b128 v[104:107], v123 offset:36864
    ds_read_b128 v[108:111], v123 offset:37888
    ds_read_b128 v[24:27], v123 offset:38912
    ds_read_b128 v[28:31], v123 offset:39936
    s_add_u32 s30, s30, 0x40000
    s_add_u32 s31, s31, 0x40000
    s_add_u32 s32, s32, 0x20000
    s_add_u32 s23, s24, 3072
    s_add_u32 s48, s23, 4096
    s_xor_b32 s25, s25, 0x40000
    s_xor_b32 s26, s26, 0x40000
    s_mov_b32 s35, 0x49800000
    s_mov_b32 s57, s22
    s_add_u32 s22, s22, 1
    v_xor_b32 v126, 0x6000, v126
    v_cndmask_b32 v12, 0, v125, s[68:69]
    v_cndmask_b32 v13, 0, v125, s[70:71]
    v_cndmask_b32 v14, 0, v125, s[72:73]
    v_cndmask_b32 v15, 0, v125, s[74:75]
    v_mov_b32 v32, 0
    v_mov_b32 v33, 0
    v_mov_b32 v34, 0
    v_mov_b32 v35, 0
    v_mov_b32 v36, 0
    v_mov_b32 v37, 0
    v_mov_b32 v38, 0
    v_mov_b32 v39, 0
    v_mov_b32 v40, 0
    v_mov_b32 v41, 0
    v_mov_b32 v42, 0
    v_mov_b32 v43, 0
    v_mov_b32 v44, 0
    v_mov_b32 v45, 0
    v_mov_b32 v46, 0
    v_mov_b32 v47, 0
    v_mov_b32 v54, 0
    v_mov_b32 v55, 0
    v_mov_b32 v52, 0
    v_mov_b32 v52, 0
    v_mov_b32 v52, 0
    v_mov_b32 v52, 0
    v_mov_b32 v52, 0
    v_mov_b32 v52, 0
    v_mov_b32 v52, 0
    v_mov_b32 v52, 0
    v_mov_b32 v52, 0
    v_mov_b32 v52, 0
    v_mov_b32 v52, 0
    v_mov_b32 v52, 0
    v_mov_b32 v52, 0
    v_mov_b32 v52, 0
    v_mov_b32 v52, 0
    v_mov_b32 v52, 0
    v_mov_b32 v52, 0
    v_mov_b32 v52, 0
    v_mov_b32 v52, 0
    v_mov_b32 v52, 0
    v_mov_b32 v52, 0
    v_mov_b32 v52, 0
    v_mov_b32 v52, 0
    v_mov_b32 v52, 0
    v_mov_b32 v52, 0
    v_mov_b32 v52, 0
    v_mov_b32 v52, 0
    v_mov_b32 v52, 0
    v_mov_b32 v52, 0
    v_mov_b32 v52, 0
    v_mov_b32 v52, 0
    v_mov_b32 v52, 0
    v_mov_b32 v52, 0
    v_mov_b32 v52, 0
    v_mov_b32 v52, 0
    v_mov_b32 v52, 0
    buffer_load_dwordx4 v[4:7], v117, s[8:11], s29 offen nt
    buffer_load_dwordx4 v[8:11], v117, s[8:11], s53 offen nt
    buffer_load_dwordx4 v[16:19], v117, s[8:11], s29 offen offset:2048 nt
    buffer_load_dwordx4 v[20:23], v117, s[8:11], s53 offen offset:2048 nt
    v_mov_b32 v52, 0
    s_waitcnt vmcnt(3)
L_rl_41:
    v_mfma_f32_16x16x32_bf16 v[48:51], v[4:7], v[12:15], 0
    v_xor_b32 v52, s33, v4
    s_waitcnt vmcnt(2)
    v_mfma_f32_16x16x32_bf16 v[48:51], v[8:11], v[12:15], v[48:51]
    v_xor_b32 v53, s33, v8
    v_or_b32 v52, v52, v53
    s_waitcnt vmcnt(1)
    v_mfma_f32_16x16x32_bf16 v[48:51], v[16:19], v[12:15], v[48:51]
    v_xor_b32 v53, s33, v16
    v_or_b32 v52, v52, v53
    s_waitcnt vmcnt(0)
    v_mfma_f32_16x16x32_bf16 v[48:51], v[20:23], v[12:15], v[48:51]
    v_xor_b32 v53, s33, v20
    v_or_b32 v52, v52, v53
    v_and_b32 v52, 1, v52
    v_cmp_ne_u32 vcc, 0, v52
    s_cbranch_vccnz L_rslow_42
L_rgo_43:
    s_nop 2
    v_permlane32_swap_b32 v48, v50
    v_permlane32_swap_b32 v49, v51
    v_pk_add_f32 v[48:49], v[48:49], v[50:51]
    s_mov_b64 exec, s[38:39]
    v_cvt_pk_bf16_f32 v12, v48, v49
    v_min_u32 v12, 0xfffffffe, v12
    buffer_store_dword v12, v119, s[8:11], s24 offen
    s_mov_b64 exec, -1
    s_add_u32 s24, s24, 8192
    s_bitset0_b32 s24, 15
    s_xor_b32 s55, s24, 16384
    s_xor_b32 s29, s29, 0x40000
    s_xor_b32 s53, s29, 1024
    s_bfe_u32 s33, s22, 0x10001
    s_waitcnt lgkmcnt(0)
    s_branch L_chain_top3_f
L_chain_last_f:
    s_nop 1
    v_smfmac_f32_16x16x64_bf16 v[48:51], v[28:31], v[176:183], v116
    v_smfmac_f32_16x16x64_bf16 v[52:55], v[16:19], v[136:143], v116
    v_smfmac_f32_16x16x64_bf16 v[52:55], v[20:23], v[168:175], v116
    v_smfmac_f32_16x16x64_bf16 v[52:55], v[24:27], v[152:159], v116
    v_smfmac_f32_16x16x64_bf16 v[52:55], v[28:31], v[184:191], v116
    v_add_f32 v48, v48, v50
    v_add_f32 v49, v49, v51
    v_cvt_pk_bf16_f32 v112, v48, v49
    s_nop 4
    v_add_f32 v52, v52, v54
    v_add_f32 v53, v53, v55
    v_cvt_pk_bf16_f32 v114, v52, v53
    s_add_u32 s32, s32, 0x20000
    buffer_store_dwordx4 v[112:115], v117, s[8:11], s32 offen sc1
    v_mov_b32 v94, 64
    s_waitcnt vmcnt(0) lgkmcnt(0)
    s_barrier
    s_mov_b64 exec, 1
    buffer_store_dword v94, off, s[8:11], s44 sc1
    s_mov_b64 exec, -1
    s_endpgm
L_mret_15:
    s_mov_b32 s43, m0
    s_mov_b32 m0, 4096
    buffer_load_dwordx4 v[4:7], v117, s[8:11], s48 offen sc1
    buffer_load_dwordx4 v117, s[8:11], s48 offen sc1 lds
    s_mov_b32 m0, s27
    s_mov_b32 m0, s43
    s_waitcnt vmcnt(0)
    v_max3_u32 v15, v4, v5, v6
    v_max_u32 v15, v15, v7
    v_cmp_lt_u32 vcc, s56, v15
    s_add_u32 s47, s47, 1
    s_add_u32 s49, s49, 1
    s_cmp_ge_u32 s49, 0x10000
    s_cbranch_scc1 L_mgo_16
    s_cbranch_vccnz L_mret_15
    s_branch L_mgo_16
L_smax_18:
    s_add_u32 s47, s47, 1
    s_mov_b32 s35, 0x7f800000
    s_waitcnt lgkmcnt(0)
    ds_read_b128 v[56:59], v126
    ds_read_b128 v[60:63], v126 offset:1024
    ds_read_b128 v[64:67], v126 offset:2048
    ds_read_b128 v[68:71], v126 offset:3072
    ds_read_b128 v[72:75], v126 offset:4096
    ds_read_b128 v[76:79], v126 offset:5120
    ds_read_b128 v[80:83], v126 offset:6144
    ds_read_b128 v[84:87], v126 offset:7168
    ds_read_b128 v[32:35], v121
    ds_read_b128 v[36:39], v121 offset:1024
    ds_read_b128 v[40:43], v121 offset:2048
    ds_read_b128 v[44:47], v121 offset:3072
    s_waitcnt lgkmcnt(0)
    v_mfma_f32_16x16x32_bf16 v[56:59], v[56:59], v[32:35], 0
    v_mfma_f32_16x16x32_bf16 v[56:59], v[60:63], v[36:39], v[56:59]
    v_mfma_f32_16x16x32_bf16 v[56:59], v[64:67], v[40:43], v[56:59]
    v_mfma_f32_16x16x32_bf16 v[56:59], v[68:71], v[44:47], v[56:59]
    v_mfma_f32_16x16x32_bf16 v[60:63], v[72:75], v[32:35], 0
    v_mfma_f32_16x16x32_bf16 v[60:63], v[76:79], v[36:39], v[60:63]
    v_mfma_f32_16x16x32_bf16 v[60:63], v[80:83], v[40:43], v[60:63]
    v_mfma_f32_16x16x32_bf16 v[60:63], v[84:87], v[44:47], v[60:63]
    v_mfma_f32_16x16x32_bf16 v[64:67], v[32:35], v[32:35], 0
    v_mfma_f32_16x16x32_bf16 v[64:67], v[36:39], v[36:39], v[64:67]
    v_mfma_f32_16x16x32_bf16 v[64:67], v[40:43], v[40:43], v[64:67]
    v_mfma_f32_16x16x32_bf16 v[64:67], v[44:47], v[44:47], v[64:67]
    v_max3_f32 v84, v56, v57, v58
    v_max3_f32 v84, v84, v59, v60
    v_max3_f32 v84, v84, v61, v62
    s_nop 4
    v_max3_f32 v84, v84, v63, v64
    v_max_f32 v84, v84, v65
    v_mov_b32 v85, v84
    s_nop 1
    v_permlane32_swap_b32 v85, v84
    v_max_f32 v84, v85, v84
    v_mov_b32 v85, v84
    s_nop 1
    v_permlane16_swap_b32 v85, v84
    v_max_f32 v84, v85, v84
    v_sub_f32 v56, v56, v84
    v_sub_f32 v57, v57, v84
    v_sub_f32 v58, v58, v84
    v_sub_f32 v59, v59, v84
    v_sub_f32 v60, v60, v84
    v_sub_f32 v61, v61, v84
    v_sub_f32 v62, v62, v84
    v_sub_f32 v63, v63, v84
    v_sub_f32 v64, v64, v84
    v_sub_f32 v65, v65, v84
    v_exp_f32 v56, v56
    v_exp_f32 v57, v57
    v_exp_f32 v58, v58
    v_exp_f32 v59, v59
    v_exp_f32 v60, v60
    v_exp_f32 v61, v61
    v_exp_f32 v62, v62
    v_exp_f32 v63, v63
    v_exp_f32 v64, v64
    v_exp_f32 v65, v65
    v_cvt_pk_bf16_f32 v68, v56, v57
    v_cvt_pk_bf16_f32 v69, v58, v59
    v_cvt_pk_bf16_f32 v70, v60, v61
    v_cvt_pk_bf16_f32 v71, v62, v63
    v_cvt_pk_bf16_f32 v52, v64, v65
    s_nop 0
    v_mfma_f32_16x16x32_bf16 v[72:75], v[88:91], v[68:71], 0
    v_mfma_f32_16x16x32_bf16 v[76:79], v[92:95], v[68:71], 0
    v_mfma_f32_16x16x32_bf16 v[80:83], v[48:51], v[68:71], 0
    s_nop 5
    v_mfma_f32_16x16x16_bf16 v[80:83], v[48:49], v[52:53], v[80:83]
    v_mfma_f32_16x16x16_bf16 v[72:75], v[112:113], v[52:53], v[72:75]
    v_mfma_f32_16x16x16_bf16 v[76:79], v[114:115], v[52:53], v[76:79]
    ds_read_b128 v[32:35], v124 offset:6144
    ds_read_b128 v[36:39], v124 offset:7168
    ds_read_b128 v[40:43], v124 offset:34816
    ds_read_b128 v[44:47], v124 offset:35840
    s_waitcnt lgkmcnt(0)
    s_nop 2
    s_branch L_norm_17
L_kvw_19:
    s_add_u32 s47, s47, 1
    s_add_u32 s49, s49, 1
    s_cmp_ge_u32 s49, 0x10000
    s_cbranch_scc1 L_kvb_20
    s_sleep 4
    buffer_load_dword v125, v119, s[8:11], s28 offen sc1
    s_waitcnt vmcnt(0)
    v_cmp_eq_u32 vcc, 0, v125
    s_nop 0
    s_and_b64 vcc, vcc, s[58:59]
    s_cbranch_scc1 L_kvw_19
    s_branch L_kvb_20
L_mret_22:
    s_mov_b32 s43, m0
    s_mov_b32 m0, 5120
    buffer_load_dwordx4 v[4:7], v117, s[8:11], s48 offen sc1
    buffer_load_dwordx4 v117, s[8:11], s48 offen sc1 lds
    s_mov_b32 m0, s27
    s_mov_b32 m0, s43
    s_waitcnt vmcnt(0)
    v_max3_u32 v15, v4, v5, v6
    v_max_u32 v15, v15, v7
    v_cmp_lt_u32 vcc, s56, v15
    s_add_u32 s47, s47, 1
    s_add_u32 s49, s49, 1
    s_cmp_ge_u32 s49, 0x10000
    s_cbranch_scc1 L_mgo_23
    s_cbranch_vccnz L_mret_22
    s_branch L_mgo_23
L_smax_25:
    s_add_u32 s47, s47, 1
    s_mov_b32 s35, 0x7f800000
    s_waitcnt lgkmcnt(0)
    ds_read_b128 v[56:59], v126
    ds_read_b128 v[60:63], v126 offset:1024
    ds_read_b128 v[64:67], v126 offset:2048
    ds_read_b128 v[68:71], v126 offset:3072
    ds_read_b128 v[72:75], v126 offset:4096
    ds_read_b128 v[76:79], v126 offset:5120
    ds_read_b128 v[80:83], v126 offset:6144
    ds_read_b128 v[84:87], v126 offset:7168
    ds_read_b128 v[32:35], v121
    ds_read_b128 v[36:39], v121 offset:1024
    ds_read_b128 v[40:43], v121 offset:2048
    ds_read_b128 v[44:47], v121 offset:3072
    s_waitcnt lgkmcnt(0)
    v_mfma_f32_16x16x32_bf16 v[56:59], v[56:59], v[32:35], 0
    v_mfma_f32_16x16x32_bf16 v[56:59], v[60:63], v[36:39], v[56:59]
    v_mfma_f32_16x16x32_bf16 v[56:59], v[64:67], v[40:43], v[56:59]
    v_mfma_f32_16x16x32_bf16 v[56:59], v[68:71], v[44:47], v[56:59]
    v_mfma_f32_16x16x32_bf16 v[60:63], v[72:75], v[32:35], 0
    v_mfma_f32_16x16x32_bf16 v[60:63], v[76:79], v[36:39], v[60:63]
    v_mfma_f32_16x16x32_bf16 v[60:63], v[80:83], v[40:43], v[60:63]
    v_mfma_f32_16x16x32_bf16 v[60:63], v[84:87], v[44:47], v[60:63]
    v_mfma_f32_16x16x32_bf16 v[64:67], v[32:35], v[32:35], 0
    v_mfma_f32_16x16x32_bf16 v[64:67], v[36:39], v[36:39], v[64:67]
    v_mfma_f32_16x16x32_bf16 v[64:67], v[40:43], v[40:43], v[64:67]
    v_mfma_f32_16x16x32_bf16 v[64:67], v[44:47], v[44:47], v[64:67]
    v_max3_f32 v84, v56, v57, v58
    v_max3_f32 v84, v84, v59, v60
    v_max3_f32 v84, v84, v61, v62
    s_nop 4
    v_max3_f32 v84, v84, v63, v64
    v_max_f32 v84, v84, v65
    v_mov_b32 v85, v84
    s_nop 1
    v_permlane32_swap_b32 v85, v84
    v_max_f32 v84, v85, v84
    v_mov_b32 v85, v84
    s_nop 1
    v_permlane16_swap_b32 v85, v84
    v_max_f32 v84, v85, v84
    v_sub_f32 v56, v56, v84
    v_sub_f32 v57, v57, v84
    v_sub_f32 v58, v58, v84
    v_sub_f32 v59, v59, v84
    v_sub_f32 v60, v60, v84
    v_sub_f32 v61, v61, v84
    v_sub_f32 v62, v62, v84
    v_sub_f32 v63, v63, v84
    v_sub_f32 v64, v64, v84
    v_sub_f32 v65, v65, v84
    v_exp_f32 v56, v56
    v_exp_f32 v57, v57
    v_exp_f32 v58, v58
    v_exp_f32 v59, v59
    v_exp_f32 v60, v60
    v_exp_f32 v61, v61
    v_exp_f32 v62, v62
    v_exp_f32 v63, v63
    v_exp_f32 v64, v64
    v_exp_f32 v65, v65
    v_cvt_pk_bf16_f32 v68, v56, v57
    v_cvt_pk_bf16_f32 v69, v58, v59
    v_cvt_pk_bf16_f32 v70, v60, v61
    v_cvt_pk_bf16_f32 v71, v62, v63
    v_cvt_pk_bf16_f32 v52, v64, v65
    s_nop 0
    v_mfma_f32_16x16x32_bf16 v[72:75], v[88:91], v[68:71], 0
    v_mfma_f32_16x16x32_bf16 v[76:79], v[92:95], v[68:71], 0
    v_mfma_f32_16x16x32_bf16 v[80:83], v[48:51], v[68:71], 0
    s_nop 5
    v_mfma_f32_16x16x16_bf16 v[80:83], v[48:49], v[52:53], v[80:83]
    v_mfma_f32_16x16x16_bf16 v[72:75], v[112:113], v[52:53], v[72:75]
    v_mfma_f32_16x16x16_bf16 v[76:79], v[114:115], v[52:53], v[76:79]
    ds_read_b128 v[32:35], v124 offset:6144
    ds_read_b128 v[36:39], v124 offset:7168
    ds_read_b128 v[40:43], v124 offset:34816
    ds_read_b128 v[44:47], v124 offset:35840
    s_waitcnt lgkmcnt(0)
    s_nop 2
    s_branch L_norm_24
L_kvw_26:
    s_add_u32 s47, s47, 1
    s_add_u32 s49, s49, 1
    s_cmp_ge_u32 s49, 0x10000
    s_cbranch_scc1 L_kvb_27
    s_sleep 4
    buffer_load_dword v125, v119, s[8:11], s28 offen sc1
    s_waitcnt vmcnt(0)
    v_cmp_eq_u32 vcc, 0, v125
    s_nop 0
    s_and_b64 vcc, vcc, s[58:59]
    s_cbranch_scc1 L_kvw_26
    s_branch L_kvb_27
L_mret_29:
    s_mov_b32 s43, m0
    s_mov_b32 m0, 6144
    buffer_load_dwordx4 v[4:7], v117, s[8:11], s48 offen sc1
    buffer_load_dwordx4 v117, s[8:11], s48 offen sc1 lds
    s_mov_b32 m0, s27
    s_mov_b32 m0, s43
    s_waitcnt vmcnt(0)
    v_max3_u32 v15, v4, v5, v6
    v_max_u32 v15, v15, v7
    v_cmp_lt_u32 vcc, s56, v15
    s_add_u32 s47, s47, 1
    s_add_u32 s49, s49, 1
    s_cmp_ge_u32 s49, 0x10000
    s_cbranch_scc1 L_mgo_30
    s_cbranch_vccnz L_mret_29
    s_branch L_mgo_30
L_smax_32:
    s_add_u32 s47, s47, 1
    s_mov_b32 s35, 0x7f800000
    s_waitcnt lgkmcnt(0)
    ds_read_b128 v[56:59], v126
    ds_read_b128 v[60:63], v126 offset:1024
    ds_read_b128 v[64:67], v126 offset:2048
    ds_read_b128 v[68:71], v126 offset:3072
    ds_read_b128 v[72:75], v126 offset:4096
    ds_read_b128 v[76:79], v126 offset:5120
    ds_read_b128 v[80:83], v126 offset:6144
    ds_read_b128 v[84:87], v126 offset:7168
    ds_read_b128 v[32:35], v121
    ds_read_b128 v[36:39], v121 offset:1024
    ds_read_b128 v[40:43], v121 offset:2048
    ds_read_b128 v[44:47], v121 offset:3072
    s_waitcnt lgkmcnt(0)
    v_mfma_f32_16x16x32_bf16 v[56:59], v[56:59], v[32:35], 0
    v_mfma_f32_16x16x32_bf16 v[56:59], v[60:63], v[36:39], v[56:59]
    v_mfma_f32_16x16x32_bf16 v[56:59], v[64:67], v[40:43], v[56:59]
    v_mfma_f32_16x16x32_bf16 v[56:59], v[68:71], v[44:47], v[56:59]
    v_mfma_f32_16x16x32_bf16 v[60:63], v[72:75], v[32:35], 0
    v_mfma_f32_16x16x32_bf16 v[60:63], v[76:79], v[36:39], v[60:63]
    v_mfma_f32_16x16x32_bf16 v[60:63], v[80:83], v[40:43], v[60:63]
    v_mfma_f32_16x16x32_bf16 v[60:63], v[84:87], v[44:47], v[60:63]
    v_mfma_f32_16x16x32_bf16 v[64:67], v[32:35], v[32:35], 0
    v_mfma_f32_16x16x32_bf16 v[64:67], v[36:39], v[36:39], v[64:67]
    v_mfma_f32_16x16x32_bf16 v[64:67], v[40:43], v[40:43], v[64:67]
    v_mfma_f32_16x16x32_bf16 v[64:67], v[44:47], v[44:47], v[64:67]
    v_max3_f32 v84, v56, v57, v58
    v_max3_f32 v84, v84, v59, v60
    v_max3_f32 v84, v84, v61, v62
    s_nop 4
    v_max3_f32 v84, v84, v63, v64
    v_max_f32 v84, v84, v65
    v_mov_b32 v85, v84
    s_nop 1
    v_permlane32_swap_b32 v85, v84
    v_max_f32 v84, v85, v84
    v_mov_b32 v85, v84
    s_nop 1
    v_permlane16_swap_b32 v85, v84
    v_max_f32 v84, v85, v84
    v_sub_f32 v56, v56, v84
    v_sub_f32 v57, v57, v84
    v_sub_f32 v58, v58, v84
    v_sub_f32 v59, v59, v84
    v_sub_f32 v60, v60, v84
    v_sub_f32 v61, v61, v84
    v_sub_f32 v62, v62, v84
    v_sub_f32 v63, v63, v84
    v_sub_f32 v64, v64, v84
    v_sub_f32 v65, v65, v84
    v_exp_f32 v56, v56
    v_exp_f32 v57, v57
    v_exp_f32 v58, v58
    v_exp_f32 v59, v59
    v_exp_f32 v60, v60
    v_exp_f32 v61, v61
    v_exp_f32 v62, v62
    v_exp_f32 v63, v63
    v_exp_f32 v64, v64
    v_exp_f32 v65, v65
    v_cvt_pk_bf16_f32 v68, v56, v57
    v_cvt_pk_bf16_f32 v69, v58, v59
    v_cvt_pk_bf16_f32 v70, v60, v61
    v_cvt_pk_bf16_f32 v71, v62, v63
    v_cvt_pk_bf16_f32 v52, v64, v65
    s_nop 0
    v_mfma_f32_16x16x32_bf16 v[72:75], v[88:91], v[68:71], 0
    v_mfma_f32_16x16x32_bf16 v[76:79], v[92:95], v[68:71], 0
    v_mfma_f32_16x16x32_bf16 v[80:83], v[48:51], v[68:71], 0
    s_nop 5
    v_mfma_f32_16x16x16_bf16 v[80:83], v[48:49], v[52:53], v[80:83]
    v_mfma_f32_16x16x16_bf16 v[72:75], v[112:113], v[52:53], v[72:75]
    v_mfma_f32_16x16x16_bf16 v[76:79], v[114:115], v[52:53], v[76:79]
    ds_read_b128 v[32:35], v124 offset:6144
    ds_read_b128 v[36:39], v124 offset:7168
    ds_read_b128 v[40:43], v124 offset:34816
    ds_read_b128 v[44:47], v124 offset:35840
    s_waitcnt lgkmcnt(0)
    s_nop 2
    s_branch L_norm_31
L_rslow_34:
    buffer_load_dwordx4 v[4:7], v117, s[8:11], s29 offen sc1
    buffer_load_dwordx4 v[8:11], v117, s[8:11], s53 offen sc1
    buffer_load_dwordx4 v[16:19], v117, s[8:11], s29 offen offset:2048 sc1
    buffer_load_dwordx4 v[20:23], v117, s[8:11], s53 offen offset:2048 sc1
    s_add_u32 s46, s46, 1
    s_add_u32 s49, s49, 1
    s_cmp_ge_u32 s49, 0x10000
    s_cbranch_scc1 L_rgo_35
    s_waitcnt vmcnt(0)
    s_branch L_rl_33
L_mret_37:
    s_mov_b32 s43, m0
    s_mov_b32 m0, 7168
    buffer_load_dwordx4 v[4:7], v117, s[8:11], s48 offen sc1
    buffer_load_dwordx4 v117, s[8:11], s48 offen sc1 lds
    s_mov_b32 m0, s27
    s_mov_b32 m0, s43
    s_waitcnt vmcnt(0)
    v_max3_u32 v15, v4, v5, v6
    v_max_u32 v15, v15, v7
    v_cmp_lt_u32 vcc, s56, v15
    s_add_u32 s47, s47, 1
    s_add_u32 s49, s49, 1
    s_cmp_ge_u32 s49, 0x10000
    s_cbranch_scc1 L_mgo_38
    s_cbranch_vccnz L_mret_37
    s_branch L_mgo_38
L_smax_40:
    s_add_u32 s47, s47, 1
    s_mov_b32 s35, 0x7f800000
    s_waitcnt lgkmcnt(0)
    ds_read_b128 v[56:59], v126
    ds_read_b128 v[60:63], v126 offset:1024
    ds_read_b128 v[64:67], v126 offset:2048
    ds_read_b128 v[68:71], v126 offset:3072
    ds_read_b128 v[72:75], v126 offset:4096
    ds_read_b128 v[76:79], v126 offset:5120
    ds_read_b128 v[80:83], v126 offset:6144
    ds_read_b128 v[84:87], v126 offset:7168
    ds_read_b128 v[32:35], v121
    ds_read_b128 v[36:39], v121 offset:1024
    ds_read_b128 v[40:43], v121 offset:2048
    ds_read_b128 v[44:47], v121 offset:3072
    s_waitcnt lgkmcnt(0)
    v_mfma_f32_16x16x32_bf16 v[56:59], v[56:59], v[32:35], 0
    v_mfma_f32_16x16x32_bf16 v[56:59], v[60:63], v[36:39], v[56:59]
    v_mfma_f32_16x16x32_bf16 v[56:59], v[64:67], v[40:43], v[56:59]
    v_mfma_f32_16x16x32_bf16 v[56:59], v[68:71], v[44:47], v[56:59]
    v_mfma_f32_16x16x32_bf16 v[60:63], v[72:75], v[32:35], 0
    v_mfma_f32_16x16x32_bf16 v[60:63], v[76:79], v[36:39], v[60:63]
    v_mfma_f32_16x16x32_bf16 v[60:63], v[80:83], v[40:43], v[60:63]
    v_mfma_f32_16x16x32_bf16 v[60:63], v[84:87], v[44:47], v[60:63]
    v_mfma_f32_16x16x32_bf16 v[64:67], v[32:35], v[32:35], 0
    v_mfma_f32_16x16x32_bf16 v[64:67], v[36:39], v[36:39], v[64:67]
    v_mfma_f32_16x16x32_bf16 v[64:67], v[40:43], v[40:43], v[64:67]
    v_mfma_f32_16x16x32_bf16 v[64:67], v[44:47], v[44:47], v[64:67]
    v_max3_f32 v84, v56, v57, v58
    v_max3_f32 v84, v84, v59, v60
    v_max3_f32 v84, v84, v61, v62
    s_nop 4
    v_max3_f32 v84, v84, v63, v64
    v_max_f32 v84, v84, v65
    v_mov_b32 v85, v84
    s_nop 1
    v_permlane32_swap_b32 v85, v84
    v_max_f32 v84, v85, v84
    v_mov_b32 v85, v84
    s_nop 1
    v_permlane16_swap_b32 v85, v84
    v_max_f32 v84, v85, v84
    v_sub_f32 v56, v56, v84
    v_sub_f32 v57, v57, v84
    v_sub_f32 v58, v58, v84
    v_sub_f32 v59, v59, v84
    v_sub_f32 v60, v60, v84
    v_sub_f32 v61, v61, v84
    v_sub_f32 v62, v62, v84
    v_sub_f32 v63, v63, v84
    v_sub_f32 v64, v64, v84
    v_sub_f32 v65, v65, v84
    v_exp_f32 v56, v56
    v_exp_f32 v57, v57
    v_exp_f32 v58, v58
    v_exp_f32 v59, v59
    v_exp_f32 v60, v60
    v_exp_f32 v61, v61
    v_exp_f32 v62, v62
    v_exp_f32 v63, v63
    v_exp_f32 v64, v64
    v_exp_f32 v65, v65
    v_cvt_pk_bf16_f32 v68, v56, v57
    v_cvt_pk_bf16_f32 v69, v58, v59
    v_cvt_pk_bf16_f32 v70, v60, v61
    v_cvt_pk_bf16_f32 v71, v62, v63
    v_cvt_pk_bf16_f32 v52, v64, v65
    s_nop 0
    v_mfma_f32_16x16x32_bf16 v[72:75], v[88:91], v[68:71], 0
    v_mfma_f32_16x16x32_bf16 v[76:79], v[92:95], v[68:71], 0
    v_mfma_f32_16x16x32_bf16 v[80:83], v[48:51], v[68:71], 0
    s_nop 5
    v_mfma_f32_16x16x16_bf16 v[80:83], v[48:49], v[52:53], v[80:83]
    v_mfma_f32_16x16x16_bf16 v[72:75], v[112:113], v[52:53], v[72:75]
    v_mfma_f32_16x16x16_bf16 v[76:79], v[114:115], v[52:53], v[76:79]
    ds_read_b128 v[32:35], v124 offset:6144
    ds_read_b128 v[36:39], v124 offset:7168
    ds_read_b128 v[40:43], v124 offset:34816
    ds_read_b128 v[44:47], v124 offset:35840
    s_waitcnt lgkmcnt(0)
    s_nop 2
    s_branch L_norm_39
L_rslow_42:
    buffer_load_dwordx4 v[4:7], v117, s[8:11], s29 offen sc1
    buffer_load_dwordx4 v[8:11], v117, s[8:11], s53 offen sc1
    buffer_load_dwordx4 v[16:19], v117, s[8:11], s29 offen offset:2048 sc1
    buffer_load_dwordx4 v[20:23], v117, s[8:11], s53 offen offset:2048 sc1
    s_add_u32 s46, s46, 1
    s_add_u32 s49, s49, 1
    s_cmp_ge_u32 s49, 0x10000
    s_cbranch_scc1 L_rgo_43
    s_waitcnt vmcnt(0)
    s_branch L_rl_41
L_other:
    s_sub_u32 s101, s84, 1
    s_lshl_b32 s101, s101, 5
    s_add_u32 s101, s101, s85
    s_branch L_bulk
L_odd:
    s_mov_b32 s96, 0
L_mode_44:
    buffer_load_dwordx2 v[2:3], off, s[92:95], 0 offset:36 sc1
    s_waitcnt vmcnt(0)
    v_readfirstlane_b32 s87, v2
    v_readfirstlane_b32 s97, v3
    s_nop 0
    s_min_u32 s97, s97, s87
    s_cmp_lg_u32 s97, 0
    s_cbranch_scc1 L_moded_45
    s_sleep 4
    s_add_u32 s96, s96, 1
    s_cmp_lg_u32 s96, 0x100
    s_cbranch_scc1 L_modef_46
    v_mov_b32 v2, 2
    v_mov_b32 v3, 0
    s_mov_b64 exec, 1
    buffer_atomic_cmpswap v[2:3], off, s[92:95], 0 offset:36
    s_mov_b64 exec, -1
L_modef_46:
    s_cmp_lt_u32 s96, 0x10000
    s_cbranch_scc1 L_mode_44
L_moded_45:
    s_cmp_eq_u32 s87, 1
    s_cbranch_scc1 L_exit
L_fallback:
    s_waitcnt vmcnt(0) lgkmcnt(0)
    s_barrier
    v_mbcnt_lo_u32_b32 v0, -1, 0
    v_mbcnt_hi_u32_b32 v0, -1, v0
    s_lshl_b32 s96, s100, 6
    v_add_u32 v0, s96, v0
    s_mov_b32 s97, 44
    s_cmp_lg_u32 s100, 0
    s_cbranch_scc1 L_at_47
    s_mov_b64 exec, 1
    v_mov_b32 v2, 1
    buffer_atomic_add v2, off, s[92:95], s97 sc0
    s_mov_b64 exec, -1
L_at_47:
    s_cmp_lg_u32 s100, 0
    s_cbranch_scc1 L_at2_48
    s_mov_b64 exec, 1
    v_mov_b32 v1, 8
    s_waitcnt vmcnt(0)
    ds_write_b32 v1, v2
    s_waitcnt lgkmcnt(0)
    s_mov_b64 exec, -1
L_at2_48:
    s_barrier
    v_mov_b32 v1, 8
    ds_read_b32 v2, v1
    s_waitcnt lgkmcnt(0)
    v_readfirstlane_b32 s85, v2
    s_barrier
    s_sub_u32 s101, s85, 32
    s_cmp_ge_u32 s85, 32
    s_cbranch_scc1 L_bulk
    s_mov_b32 s20, s85
    s_mov_b32 s16, s92
    s_mov_b32 s17, s93
    s_mov_b32 s18, s94
    s_mov_b32 s19, s95
    s_mov_b32 s88, s20
    v_lshrrev_b32 v4, 6, v0
    s_nop 0
    v_readfirstlane_b32 s21, v4
    v_and_b32 v1, 63, v0
    v_lshrrev_b32 v2, 4, v1
    v_and_b32 v3, 15, v1
    v_lshrrev_b32 v6, 2, v3
    v_lshlrev_b32 v117, 4, v1
    s_lshl_b32 s51, s21, 10
    s_lshl_b32 s52, s21, 11
    s_load_dwordx8 s[60:67], s[0:1], 16
    s_mov_b32 s14, 0x400000
    s_mov_b32 s15, 0x20000
    s_lshl_b32 s41, s20, 8
    s_lshl_b32 s42, s20, 17
    s_lshr_b32 s43, s21, 1
    s_lshl_b32 s43, s43, 2
    v_or_b32 v5, s43, v2
    v_lshlrev_b32 v5, 1, v5
    v_xor_b32 v5, v5, v3
    v_lshrrev_b32 v14, 2, v5
    v_lshlrev_b32 v5, 4, v5
    s_lshl_b32 s43, s21, 4
    v_add_u32 v4, s43, v2
    v_lshl_add_u32 v8, v4, 13, v5
    s_waitcnt lgkmcnt(0)
    s_mov_b32 s12, s60
    s_and_b32 s13, s61, 0xffff
    v_xor_b32 v15, 1, v14
    v_lshl_add_u32 v15, v15, 15, v8
    s_add_u32 s43, s41, 0x0
    s_add_u32 m0, s51, 0x8000
    s_nop 0
    buffer_load_dwordx4 v15, s[12:15], s43 offen lds
    s_add_u32 s43, s41, 0x80000
    s_add_u32 m0, s51, 0x9000
    s_nop 0
    buffer_load_dwordx4 v15, s[12:15], s43 offen lds
    s_add_u32 s43, s41, 0x100000
    s_add_u32 m0, s51, 0xa000
    s_nop 0
    buffer_load_dwordx4 v15, s[12:15], s43 offen lds
    s_add_u32 s43, s41, 0x180000
    s_add_u32 m0, s51, 0xb000
    s_nop 0
    buffer_load_dwordx4 v15, s[12:15], s43 offen lds
    s_add_u32 s43, s41, 0x200000
    s_add_u32 m0, s51, 0xc000
    s_nop 0
    buffer_load_dwordx4 v15, s[12:15], s43 offen lds
    s_add_u32 s43, s41, 0x280000
    s_add_u32 m0, s51, 0xd000
    s_nop 0
    buffer_load_dwordx4 v15, s[12:15], s43 offen lds
    s_add_u32 s43, s41, 0x300000
    s_add_u32 m0, s51, 0xe000
    s_nop 0
    buffer_load_dwordx4 v15, s[12:15], s43 offen lds
    s_add_u32 s43, s41, 0x380000
    s_add_u32 m0, s51, 0xf000
    s_nop 0
    buffer_load_dwordx4 v15, s[12:15], s43 offen lds
    v_xor_b32 v15, 2, v14
    v_lshl_add_u32 v15, v15, 15, v8
    s_add_u32 s43, s41, 0x0
    s_add_u32 m0, s51, 0x10000
    s_nop 0
    buffer_load_dwordx4 v15, s[12:15], s43 offen lds
    s_add_u32 s43, s41, 0x80000
    s_add_u32 m0, s51, 0x11000
    s_nop 0
    buffer_load_dwordx4 v15, s[12:15], s43 offen lds
    s_add_u32 s43, s41, 0x100000
    s_add_u32 m0, s51, 0x12000
    s_nop 0
    buffer_load_dwordx4 v15, s[12:15], s43 offen lds
    s_add_u32 s43, s41, 0x180000
    s_add_u32 m0, s51, 0x13000
    s_nop 0
    buffer_load_dwordx4 v15, s[12:15], s43 offen lds
    s_add_u32 s43, s41, 0x200000
    s_add_u32 m0, s51, 0x14000
    s_nop 0
    buffer_load_dwordx4 v15, s[12:15], s43 offen lds
    s_add_u32 s43, s41, 0x280000
    s_add_u32 m0, s51, 0x15000
    s_nop 0
    buffer_load_dwordx4 v15, s[12:15], s43 offen lds
    s_add_u32 s43, s41, 0x300000
    s_add_u32 m0, s51, 0x16000
    s_nop 0
    buffer_load_dwordx4 v15, s[12:15], s43 offen lds
    s_add_u32 s43, s41, 0x380000
    s_add_u32 m0, s51, 0x17000
    s_nop 0
    buffer_load_dwordx4 v15, s[12:15], s43 offen lds
    v_xor_b32 v15, 3, v14
    v_lshl_add_u32 v15, v15, 15, v8
    s_add_u32 s43, s41, 0x0
    s_add_u32 m0, s51, 0x18000
    s_nop 0
    buffer_load_dwordx4 v15, s[12:15], s43 offen lds
    s_add_u32 s43, s41, 0x80000
    s_add_u32 m0, s51, 0x19000
    s_nop 0
    buffer_load_dwordx4 v15, s[12:15], s43 offen lds
    s_add_u32 s43, s41, 0x100000
    s_add_u32 m0, s51, 0x1a000
    s_nop 0
    buffer_load_dwordx4 v15, s[12:15], s43 offen lds
    s_add_u32 s43, s41, 0x180000
    s_add_u32 m0, s51, 0x1b000
    s_nop 0
    buffer_load_dwordx4 v15, s[12:15], s43 offen lds
    s_add_u32 s43, s41, 0x200000
    s_add_u32 m0, s51, 0x1c000
    s_nop 0
    buffer_load_dwordx4 v15, s[12:15], s43 offen lds
    s_add_u32 s43, s41, 0x280000
    s_add_u32 m0, s51, 0x1d000
    s_nop 0
    buffer_load_dwordx4 v15, s[12:15], s43 offen lds
    s_add_u32 s43, s41, 0x300000
    s_add_u32 m0, s51, 0x1e000
    s_nop 0
    buffer_load_dwordx4 v15, s[12:15], s43 offen lds
    s_add_u32 s43, s41, 0x380000
    s_add_u32 m0, s51, 0x1f000
    s_nop 0
    buffer_load_dwordx4 v15, s[12:15], s43 offen lds
    s_mov_b32 s12, s62
    s_and_b32 s13, s63, 0xffff
    v_xor_b32 v15, 1, v14
    v_lshl_add_u32 v15, v15, 15, v8
    s_add_u32 s43, s41, 0x0
    s_add_u32 m0, s51, 0x20000
    s_nop 0
    buffer_load_dwordx4 v15, s[12:15], s43 offen lds
    s_add_u32 s43, s41, 0x80000
    s_add_u32 m0, s51, 0x21000
    s_nop 0
    buffer_load_dwordx4 v15, s[12:15], s43 offen lds
    s_add_u32 s43, s41, 0x100000
    s_add_u32 m0, s51, 0x22000
    s_nop 0
    buffer_load_dwordx4 v15, s[12:15], s43 offen lds
    s_add_u32 s43, s41, 0x180000
    s_add_u32 m0, s51, 0x23000
    s_nop 0
    buffer_load_dwordx4 v15, s[12:15], s43 offen lds
    s_add_u32 s43, s41, 0x200000
    s_add_u32 m0, s51, 0x24000
    s_nop 0
    buffer_load_dwordx4 v15, s[12:15], s43 offen lds
    s_add_u32 s43, s41, 0x280000
    s_add_u32 m0, s51, 0x25000
    s_nop 0
    buffer_load_dwordx4 v15, s[12:15], s43 offen lds
    s_add_u32 s43, s41, 0x300000
    s_add_u32 m0, s51, 0x26000
    s_nop 0
    buffer_load_dwordx4 v15, s[12:15], s43 offen lds
    s_add_u32 s43, s41, 0x380000
    s_add_u32 m0, s51, 0x27000
    s_nop 0
    buffer_load_dwordx4 v15, s[12:15], s43 offen lds
    v_and_b32 v4, 2, v3
    v_cmp_ne_u32 vcc, 0, v4
    v_mov_b32 v4, 0x4444
    v_mov_b32 v5, 0xeeee
    v_cndmask_b32 v116, v4, v5, vcc
    v_lshrrev_b32 v5, 1, v2
    v_lshl_add_u32 v4, v6, 3, v5
    s_lshl_b32 s43, s21, 1
    v_add_u32 v4, s43, v4
    v_add_u32 v5, s20, v4
    v_and_b32 v5, 31, v5
    v_lshl_add_u32 v4, v4, 6, v5
    v_and_b32 v5, 1, v2
    v_lshl_add_u32 v4, v4, 1, v5
    v_and_b32 v5, 3, v3
    v_lshl_add_u32 v4, v4, 2, v5
    v_lshlrev_b32 v118, 4, v4
    v_and_b32 v4, 1, v2
    v_lshlrev_b32 v4, 2, v4
    v_and_b32 v7, 2, v2
    v_add_u32 v4, v4, v7
    v_and_b32 v7, 1, v6
    v_add_u32 v4, v4, v7
    v_lshl_add_u32 v4, v4, 2, v5
    v_lshlrev_b32 v4, 2, v4
    s_and_b32 s43, s21, 1
    s_lshl_b32 s43, s43, 12
    s_lshl_b32 s40, s20, 7
    s_add_u32 s43, s43, s40
    v_add_u32 v119, s43, v4
    v_xor_b32 v7, v2, v6
    v_lshl_add_u32 v4, v2, 4, v7
    v_and_b32 v5, 3, v3
    v_lshl_add_u32 v4, v4, 2, v5
    v_lshl_add_u32 v120, v4, 2, s51
    v_lshl_add_u32 v4, v3, 2, v7
    v_lshlrev_b32 v121, 4, v4
    v_and_b32 v5, 1, v3
    v_lshl_add_u32 v4, v6, 1, v5
    v_lshl_add_u32 v4, v2, 3, v4
    v_lshlrev_b32 v127, 4, v4
    v_and_or_b32 v122, v116, 8, v127
    s_lshl_b32 s43, s21, 13
    s_add_u32 s43, s43, 32768
    v_add_u32 v123, s43, v117
    v_add_u32 v124, 0x10000, v123
    s_mov_b32 s36, 0xcccccccc
    s_mov_b32 s37, 0xcccccccc
    s_mov_b32 s38, 0x00ff00ff
    s_mov_b32 s39, 0x00ff00ff
    s_mov_b32 s34, 0x3e0293ee
    s_mov_b32 s35, 0x49800000
    s_mov_b32 s50, 0x3f803f80
    v_and_b32 v5, 1, v2
    v_or_b32 v5, 0, v5
    v_xor_b32 v5, v5, v6
    v_lshlrev_b32 v5, 8, v5
    v_and_b32 v7, 3, v3
    v_lshl_add_u32 v7, v7, 4, v5
    s_lshl_b32 s43, s21, 2
    v_add_u32 v4, s43, v2
    v_lshl_add_u32 v10, v4, 10, v7
    v_and_b32 v5, 1, v2
    v_or_b32 v5, 2, v5
    v_xor_b32 v5, v5, v6
    v_lshlrev_b32 v5, 8, v5
    v_and_b32 v7, 3, v3
    v_lshl_add_u32 v7, v7, 4, v5
    s_lshl_b32 s43, s21, 2
    v_add_u32 v4, s43, v2
    v_lshl_add_u32 v9, v4, 10, v7
    v_and_b32 v5, 1, v2
    v_lshl_add_u32 v4, v5, 3, v6
    v_lshrrev_b32 v7, 1, v2
    v_lshl_add_u32 v4, v7, 5, v4
    v_lshlrev_b32 v4, 8, v4
    v_lshl_or_b32 v5, v5, 2, v6
    v_lshlrev_b32 v5, 5, v5
    s_lshl_b32 s43, s21, 6
    v_xor_b32 v5, s43, v5
    v_add_u32 v4, v4, v5
    v_and_b32 v5, 3, v3
    v_lshl_add_u32 v4, v5, 3, v4
    v_add_u32 v11, 32768, v4
    v_and_b32 v5, 1, v2
    v_lshlrev_b32 v4, 4, v5
    v_lshl_add_u32 v4, v7, 2, v4
    v_and_b32 v7, 1, v6
    v_add_u32 v4, v4, v7
    s_lshl_b32 s43, s21, 5
    v_add_u32 v4, s43, v4
    v_lshlrev_b32 v4, 8, v4
    v_lshl_or_b32 v5, v5, 1, v7
    v_xor_b32 v5, s21, v5
    v_lshl_add_u32 v4, v5, 6, v4
    v_lshrrev_b32 v5, 1, v6
    v_lshl_add_u32 v4, v5, 5, v4
    v_and_b32 v5, 3, v3
    v_lshl_add_u32 v4, v5, 3, v4
    v_add_u32 v12, 32768, v4
    v_mov_b32 v16, -1
    v_mov_b32 v17, -1
    v_mov_b32 v18, -1
    v_mov_b32 v19, -1
    s_lshl_b32 s43, s20, 13
    s_add_u32 s43, s43, 0x7100000
    s_and_b32 s40, s21, 1
    s_lshl_b32 s40, s40, 12
    s_add_u32 s29, s43, s40
    s_add_u32 s43, s43, s52
    s_xor_b32 s40, s43, 0x40000
    buffer_store_dwordx4 v[16:19], v117, s[8:11], s43 offen sc1
    buffer_store_dwordx4 v[16:19], v117, s[8:11], s43 offen offset:1024 sc1
    buffer_store_dwordx4 v[16:19], v117, s[8:11], s40 offen sc1
    buffer_store_dwordx4 v[16:19], v117, s[8:11], s40 offen offset:1024 sc1
    s_mov_b32 s43, 0x7012000
    buffer_store_dword v16, v119, s[8:11], s43 offen sc1
    s_mov_b32 s43, 0x7014000
    buffer_store_dword v16, v119, s[8:11], s43 offen sc1
    s_mov_b32 s43, 0x7016000
    buffer_store_dword v16, v119, s[8:11], s43 offen sc1
    s_load_dwordx2 s[4:5], s[0:1], 8
    s_waitcnt lgkmcnt(0)
    s_and_b32 s5, s5, 0xffff
    s_mov_b32 s6, 8192
    s_mov_b32 s7, 0x20000
    v_and_b32 v20, 1, v2
    v_and_b32 v21, 1, v6
    v_lshl_add_u32 v20, v20, 1, v21
    v_lshlrev_b32 v20, 9, v20
    v_and_b32 v21, 3, v3
    v_lshl_add_u32 v20, v21, 4, v20
    v_and_b32 v21, 2, v2
    v_add_u32 v20, v20, v21
    s_and_b32 s43, s20, 1
    s_lshl_b32 s43, s43, 11
    s_bfe_u32 s40, s20, 0x20001
    s_lshl_b32 s40, s40, 7
    s_add_u32 s43, s43, s40
    s_and_b32 s40, s21, 1
    s_lshl_b32 s40, s40, 6
    s_add_u32 s43, s43, s40
    s_lshr_b32 s40, s20, 3
    s_lshl_b32 s40, s40, 2
    s_add_u32 s43, s43, s40
    v_add_u32 v20, s43, v20
    v_lshlrev_b32 v20, 1, v20
    buffer_load_dword v21, v20, s[4:7], 0 offen
    s_waitcnt vmcnt(32)
    s_barrier
    v_xor_b32 v13, 0, v11
    v_add_u32 v13, 0x0, v13
    ds_read_b64_tr_b16 a[0:1], v13
    ds_read_b64_tr_b16 a[2:3], v13 offset:1024
    ds_read_b64_tr_b16 a[4:5], v13 offset:16384
    ds_read_b64_tr_b16 a[6:7], v13 offset:17408
    ds_read_b64_tr_b16 a[16:17], v13 offset:4096
    ds_read_b64_tr_b16 a[18:19], v13 offset:5120
    ds_read_b64_tr_b16 a[20:21], v13 offset:20480
    ds_read_b64_tr_b16 a[22:23], v13 offset:21504
    s_waitcnt lgkmcnt(0)
    v_xor_b32 v13, 32, v11
    v_add_u32 v13, 0x0, v13
    ds_read_b64_tr_b16 a[8:9], v13
    ds_read_b64_tr_b16 a[10:11], v13 offset:1024
    ds_read_b64_tr_b16 a[12:13], v13 offset:16384
    ds_read_b64_tr_b16 a[14:15], v13 offset:17408
    ds_read_b64_tr_b16 a[24:25], v13 offset:4096
    ds_read_b64_tr_b16 a[26:27], v13 offset:5120
    ds_read_b64_tr_b16 a[28:29], v13 offset:20480
    ds_read_b64_tr_b16 a[30:31], v13 offset:21504
    s_waitcnt lgkmcnt(0)
    s_barrier
    v_xor_b32 v15, 2, v14
    v_lshl_add_u32 v15, v15, 15, v8
    s_add_u32 s43, s41, 0x0
    s_add_u32 m0, s51, 0x8000
    s_nop 0
    buffer_load_dwordx4 v15, s[12:15], s43 offen lds
    s_add_u32 s43, s41, 0x80000
    s_add_u32 m0, s51, 0x9000
    s_nop 0
    buffer_load_dwordx4 v15, s[12:15], s43 offen lds
    s_add_u32 s43, s41, 0x100000
    s_add_u32 m0, s51, 0xa000
    s_nop 0
    buffer_load_dwordx4 v15, s[12:15], s43 offen lds
    s_add_u32 s43, s41, 0x180000
    s_add_u32 m0, s51, 0xb000
    s_nop 0
    buffer_load_dwordx4 v15, s[12:15], s43 offen lds
    s_add_u32 s43, s41, 0x200000
    s_add_u32 m0, s51, 0xc000
    s_nop 0
    buffer_load_dwordx4 v15, s[12:15], s43 offen lds
    s_add_u32 s43, s41, 0x280000
    s_add_u32 m0, s51, 0xd000
    s_nop 0
    buffer_load_dwordx4 v15, s[12:15], s43 offen lds
    s_add_u32 s43, s41, 0x300000
    s_add_u32 m0, s51, 0xe000
    s_nop 0
    buffer_load_dwordx4 v15, s[12:15], s43 offen lds
    s_add_u32 s43, s41, 0x380000
    s_add_u32 m0, s51, 0xf000
    s_nop 0
    buffer_load_dwordx4 v15, s[12:15], s43 offen lds
    s_waitcnt vmcnt(32)
    s_barrier
    v_xor_b32 v13, 0, v11
    v_add_u32 v13, 0x8000, v13
    ds_read_b64_tr_b16 a[32:33], v13
    ds_read_b64_tr_b16 a[34:35], v13 offset:1024
    ds_read_b64_tr_b16 a[36:37], v13 offset:16384
    ds_read_b64_tr_b16 a[38:39], v13 offset:17408
    ds_read_b64_tr_b16 a[48:49], v13 offset:4096
    ds_read_b64_tr_b16 a[50:51], v13 offset:5120
    ds_read_b64_tr_b16 a[52:53], v13 offset:20480
    ds_read_b64_tr_b16 a[54:55], v13 offset:21504
    s_waitcnt lgkmcnt(0)
    v_xor_b32 v13, 32, v11
    v_add_u32 v13, 0x8000, v13
    ds_read_b64_tr_b16 a[40:41], v13
    ds_read_b64_tr_b16 a[42:43], v13 offset:1024
    ds_read_b64_tr_b16 a[44:45], v13 offset:16384
    ds_read_b64_tr_b16 a[46:47], v13 offset:17408
    ds_read_b64_tr_b16 a[56:57], v13 offset:4096
    ds_read_b64_tr_b16 a[58:59], v13 offset:5120
    ds_read_b64_tr_b16 a[60:61], v13 offset:20480
    ds_read_b64_tr_b16 a[62:63], v13 offset:21504
    s_waitcnt lgkmcnt(0)
    s_barrier
    v_xor_b32 v15, 3, v14
    v_lshl_add_u32 v15, v15, 15, v8
    s_add_u32 s43, s41, 0x0
    s_add_u32 m0, s51, 0x10000
    s_nop 0
    buffer_load_dwordx4 v15, s[12:15], s43 offen lds
    s_add_u32 s43, s41, 0x80000
    s_add_u32 m0, s51, 0x11000
    s_nop 0
    buffer_load_dwordx4 v15, s[12:15], s43 offen lds
    s_add_u32 s43, s41, 0x100000
    s_add_u32 m0, s51, 0x12000
    s_nop 0
    buffer_load_dwordx4 v15, s[12:15], s43 offen lds
    s_add_u32 s43, s41, 0x180000
    s_add_u32 m0, s51, 0x13000
    s_nop 0
    buffer_load_dwordx4 v15, s[12:15], s43 offen lds
    s_add_u32 s43, s41, 0x200000
    s_add_u32 m0, s51, 0x14000
    s_nop 0
    buffer_load_dwordx4 v15, s[12:15], s43 offen lds
    s_add_u32 s43, s41, 0x280000
    s_add_u32 m0, s51, 0x15000
    s_nop 0
    buffer_load_dwordx4 v15, s[12:15], s43 offen lds
    s_add_u32 s43, s41, 0x300000
    s_add_u32 m0, s51, 0x16000
    s_nop 0
    buffer_load_dwordx4 v15, s[12:15], s43 offen lds
    s_add_u32 s43, s41, 0x380000
    s_add_u32 m0, s51, 0x17000
    s_nop 0
    buffer_load_dwordx4 v15, s[12:15], s43 offen lds
    s_waitcnt vmcnt(32)
    s_barrier
    v_xor_b32 v13, 0, v11
    v_add_u32 v13, 0x10000, v13
    ds_read_b64_tr_b16 a[64:65], v13
    ds_read_b64_tr_b16 a[66:67], v13 offset:1024
    ds_read_b64_tr_b16 a[68:69], v13 offset:16384
    ds_read_b64_tr_b16 a[70:71], v13 offset:17408
    ds_read_b64_tr_b16 a[80:81], v13 offset:4096
    ds_read_b64_tr_b16 a[82:83], v13 offset:5120
    ds_read_b64_tr_b16 a[84:85], v13 offset:20480
    ds_read_b64_tr_b16 a[86:87], v13 offset:21504
    s_waitcnt lgkmcnt(0)
    v_xor_b32 v13, 32, v11
    v_add_u32 v13, 0x10000, v13
    ds_read_b64_tr_b16 a[72:73], v13
    ds_read_b64_tr_b16 a[74:75], v13 offset:1024
    ds_read_b64_tr_b16 a[76:77], v13 offset:16384
    ds_read_b64_tr_b16 a[78:79], v13 offset:17408
    ds_read_b64_tr_b16 a[88:89], v13 offset:4096
    ds_read_b64_tr_b16 a[90:91], v13 offset:5120
    ds_read_b64_tr_b16 a[92:93], v13 offset:20480
    ds_read_b64_tr_b16 a[94:95], v13 offset:21504
    s_waitcnt lgkmcnt(0)
    s_barrier
    s_mov_b32 s12, s64
    s_and_b32 s13, s65, 0xffff
    v_xor_b32 v15, 0, v14
    v_lshl_add_u32 v15, v15, 15, v8
    s_add_u32 s43, s41, 0x0
    s_add_u32 m0, s51, 0x18000
    s_nop 0
    buffer_load_dwordx4 v15, s[12:15], s43 offen lds
    s_add_u32 s43, s41, 0x80000
    s_add_u32 m0, s51, 0x19000
    s_nop 0
    buffer_load_dwordx4 v15, s[12:15], s43 offen lds
    s_add_u32 s43, s41, 0x100000
    s_add_u32 m0, s51, 0x1a000
    s_nop 0
    buffer_load_dwordx4 v15, s[12:15], s43 offen lds
    s_add_u32 s43, s41, 0x180000
    s_add_u32 m0, s51, 0x1b000
    s_nop 0
    buffer_load_dwordx4 v15, s[12:15], s43 offen lds
    s_add_u32 s43, s41, 0x200000
    s_add_u32 m0, s51, 0x1c000
    s_nop 0
    buffer_load_dwordx4 v15, s[12:15], s43 offen lds
    s_add_u32 s43, s41, 0x280000
    s_add_u32 m0, s51, 0x1d000
    s_nop 0
    buffer_load_dwordx4 v15, s[12:15], s43 offen lds
    s_add_u32 s43, s41, 0x300000
    s_add_u32 m0, s51, 0x1e000
    s_nop 0
    buffer_load_dwordx4 v15, s[12:15], s43 offen lds
    s_add_u32 s43, s41, 0x380000
    s_add_u32 m0, s51, 0x1f000
    s_nop 0
    buffer_load_dwordx4 v15, s[12:15], s43 offen lds
    s_waitcnt vmcnt(32)
    s_barrier
    v_xor_b32 v13, 0, v11
    v_add_u32 v13, 0x18000, v13
    ds_read_b64_tr_b16 a[96:97], v13
    ds_read_b64_tr_b16 a[98:99], v13 offset:1024
    ds_read_b64_tr_b16 a[100:101], v13 offset:16384
    ds_read_b64_tr_b16 a[102:103], v13 offset:17408
    ds_read_b64_tr_b16 a[112:113], v13 offset:4096
    ds_read_b64_tr_b16 a[114:115], v13 offset:5120
    ds_read_b64_tr_b16 a[116:117], v13 offset:20480
    ds_read_b64_tr_b16 a[118:119], v13 offset:21504
    s_waitcnt lgkmcnt(0)
    v_xor_b32 v13, 32, v11
    v_add_u32 v13, 0x18000, v13
    ds_read_b64_tr_b16 a[104:105], v13
    ds_read_b64_tr_b16 a[106:107], v13 offset:1024
    ds_read_b64_tr_b16 a[108:109], v13 offset:16384
    ds_read_b64_tr_b16 a[110:111], v13 offset:17408
    ds_read_b64_tr_b16 a[120:121], v13 offset:4096
    ds_read_b64_tr_b16 a[122:123], v13 offset:5120
    ds_read_b64_tr_b16 a[124:125], v13 offset:20480
    ds_read_b64_tr_b16 a[126:127], v13 offset:21504
    s_waitcnt lgkmcnt(0)
    s_barrier
    v_xor_b32 v15, 1, v14
    v_lshl_add_u32 v15, v15, 15, v8
    s_add_u32 s43, s41, 0x0
    s_add_u32 m0, s51, 0x20000
    s_nop 0
    buffer_load_dwordx4 v15, s[12:15], s43 offen lds
    s_add_u32 s43, s41, 0x80000
    s_add_u32 m0, s51, 0x21000
    s_nop 0
    buffer_load_dwordx4 v15, s[12:15], s43 offen lds
    s_add_u32 s43, s41, 0x100000
    s_add_u32 m0, s51, 0x22000
    s_nop 0
    buffer_load_dwordx4 v15, s[12:15], s43 offen lds
    s_add_u32 s43, s41, 0x180000
    s_add_u32 m0, s51, 0x23000
    s_nop 0
    buffer_load_dwordx4 v15, s[12:15], s43 offen lds
    s_add_u32 s43, s41, 0x200000
    s_add_u32 m0, s51, 0x24000
    s_nop 0
    buffer_load_dwordx4 v15, s[12:15], s43 offen lds
    s_add_u32 s43, s41, 0x280000
    s_add_u32 m0, s51, 0x25000
    s_nop 0
    buffer_load_dwordx4 v15, s[12:15], s43 offen lds
    s_add_u32 s43, s41, 0x300000
    s_add_u32 m0, s51, 0x26000
    s_nop 0
    buffer_load_dwordx4 v15, s[12:15], s43 offen lds
    s_add_u32 s43, s41, 0x380000
    s_add_u32 m0, s51, 0x27000
    s_nop 0
    buffer_load_dwordx4 v15, s[12:15], s43 offen lds
    s_waitcnt vmcnt(24)
    v_min_u32 v21, 0xfffffffe, v21
    s_mov_b32 s43, 0x7010000
    s_mov_b64 exec, s[38:39]
    buffer_store_dword v21, v119, s[8:11], s43 offen sc1
    s_mov_b64 exec, -1
    s_barrier
    v_xor_b32 v13, 0, v11
    v_add_u32 v13, 0x0, v13
    ds_read_b64_tr_b16 a[128:129], v13
    ds_read_b64_tr_b16 a[130:131], v13 offset:1024
    ds_read_b64_tr_b16 a[132:133], v13 offset:16384
    ds_read_b64_tr_b16 a[134:135], v13 offset:17408
    ds_read_b64_tr_b16 a[144:145], v13 offset:4096
    ds_read_b64_tr_b16 a[146:147], v13 offset:5120
    ds_read_b64_tr_b16 a[148:149], v13 offset:20480
    ds_read_b64_tr_b16 a[150:151], v13 offset:21504
    s_waitcnt lgkmcnt(0)
    v_xor_b32 v13, 32, v11
    v_add_u32 v13, 0x0, v13
    ds_read_b64_tr_b16 a[136:137], v13
    ds_read_b64_tr_b16 a[138:139], v13 offset:1024
    ds_read_b64_tr_b16 a[140:141], v13 offset:16384
    ds_read_b64_tr_b16 a[142:143], v13 offset:17408
    ds_read_b64_tr_b16 a[152:153], v13 offset:4096
    ds_read_b64_tr_b16 a[154:155], v13 offset:5120
    ds_read_b64_tr_b16 a[156:157], v13 offset:20480
    ds_read_b64_tr_b16 a[158:159], v13 offset:21504
    s_waitcnt lgkmcnt(0)
    s_barrier
    v_xor_b32 v15, 2, v14
    v_lshl_add_u32 v15, v15, 15, v8
    s_add_u32 s43, s41, 0x0
    s_add_u32 m0, s51, 0x8000
    s_nop 0
    buffer_load_dwordx4 v15, s[12:15], s43 offen lds
    s_add_u32 s43, s41, 0x80000
    s_add_u32 m0, s51, 0x9000
    s_nop 0
    buffer_load_dwordx4 v15, s[12:15], s43 offen lds
    s_add_u32 s43, s41, 0x100000
    s_add_u32 m0, s51, 0xa000
    s_nop 0
    buffer_load_dwordx4 v15, s[12:15], s43 offen lds
    s_add_u32 s43, s41, 0x180000
    s_add_u32 m0, s51, 0xb000
    s_nop 0
    buffer_load_dwordx4 v15, s[12:15], s43 offen lds
    s_add_u32 s43, s41, 0x200000
    s_add_u32 m0, s51, 0xc000
    s_nop 0
    buffer_load_dwordx4 v15, s[12:15], s43 offen lds
    s_add_u32 s43, s41, 0x280000
    s_add_u32 m0, s51, 0xd000
    s_nop 0
    buffer_load_dwordx4 v15, s[12:15], s43 offen lds
    s_add_u32 s43, s41, 0x300000
    s_add_u32 m0, s51, 0xe000
    s_nop 0
    buffer_load_dwordx4 v15, s[12:15], s43 offen lds
    s_add_u32 s43, s41, 0x380000
    s_add_u32 m0, s51, 0xf000
    s_nop 0
    buffer_load_dwordx4 v15, s[12:15], s43 offen lds
    s_waitcnt vmcnt(24)
    s_barrier
    v_xor_b32 v13, 0, v11
    v_add_u32 v13, 0x8000, v13
    ds_read_b64_tr_b16 a[160:161], v13
    ds_read_b64_tr_b16 a[162:163], v13 offset:1024
    ds_read_b64_tr_b16 a[164:165], v13 offset:16384
    ds_read_b64_tr_b16 a[166:167], v13 offset:17408
    ds_read_b64_tr_b16 a[176:177], v13 offset:4096
    ds_read_b64_tr_b16 a[178:179], v13 offset:5120
    ds_read_b64_tr_b16 a[180:181], v13 offset:20480
    ds_read_b64_tr_b16 a[182:183], v13 offset:21504
    s_waitcnt lgkmcnt(0)
    v_xor_b32 v13, 32, v11
    v_add_u32 v13, 0x8000, v13
    ds_read_b64_tr_b16 a[168:169], v13
    ds_read_b64_tr_b16 a[170:171], v13 offset:1024
    ds_read_b64_tr_b16 a[172:173], v13 offset:16384
    ds_read_b64_tr_b16 a[174:175], v13 offset:17408
    ds_read_b64_tr_b16 a[184:185], v13 offset:4096
    ds_read_b64_tr_b16 a[186:187], v13 offset:5120
    ds_read_b64_tr_b16 a[188:189], v13 offset:20480
    ds_read_b64_tr_b16 a[190:191], v13 offset:21504
    s_waitcnt lgkmcnt(0)
    s_barrier
    v_xor_b32 v15, 3, v14
    v_lshl_add_u32 v15, v15, 15, v8
    s_add_u32 s43, s41, 0x0
    s_add_u32 m0, s51, 0x10000
    s_nop 0
    buffer_load_dwordx4 v15, s[12:15], s43 offen lds
    s_add_u32 s43, s41, 0x80000
    s_add_u32 m0, s51, 0x11000
    s_nop 0
    buffer_load_dwordx4 v15, s[12:15], s43 offen lds
    s_add_u32 s43, s41, 0x100000
    s_add_u32 m0, s51, 0x12000
    s_nop 0
    buffer_load_dwordx4 v15, s[12:15], s43 offen lds
    s_add_u32 s43, s41, 0x180000
    s_add_u32 m0, s51, 0x13000
    s_nop 0
    buffer_load_dwordx4 v15, s[12:15], s43 offen lds
    s_add_u32 s43, s41, 0x200000
    s_add_u32 m0, s51, 0x14000
    s_nop 0
    buffer_load_dwordx4 v15, s[12:15], s43 offen lds
    s_add_u32 s43, s41, 0x280000
    s_add_u32 m0, s51, 0x15000
    s_nop 0
    buffer_load_dwordx4 v15, s[12:15], s43 offen lds
    s_add_u32 s43, s41, 0x300000
    s_add_u32 m0, s51, 0x16000
    s_nop 0
    buffer_load_dwordx4 v15, s[12:15], s43 offen lds
    s_add_u32 s43, s41, 0x380000
    s_add_u32 m0, s51, 0x17000
    s_nop 0
    buffer_load_dwordx4 v15, s[12:15], s43 offen lds
    s_waitcnt vmcnt(24)
    s_barrier
    v_xor_b32 v13, 0, v11
    v_add_u32 v13, 0x10000, v13
    ds_read_b64_tr_b16 a[192:193], v13
    ds_read_b64_tr_b16 a[194:195], v13 offset:1024
    ds_read_b64_tr_b16 a[196:197], v13 offset:16384
    ds_read_b64_tr_b16 a[198:199], v13 offset:17408
    ds_read_b64_tr_b16 a[208:209], v13 offset:4096
    ds_read_b64_tr_b16 a[210:211], v13 offset:5120
    ds_read_b64_tr_b16 a[212:213], v13 offset:20480
    ds_read_b64_tr_b16 a[214:215], v13 offset:21504
    s_waitcnt lgkmcnt(0)
    v_xor_b32 v13, 32, v11
    v_add_u32 v13, 0x10000, v13
    ds_read_b64_tr_b16 a[200:201], v13
    ds_read_b64_tr_b16 a[202:203], v13 offset:1024
    ds_read_b64_tr_b16 a[204:205], v13 offset:16384
    ds_read_b64_tr_b16 a[206:207], v13 offset:17408
    ds_read_b64_tr_b16 a[216:217], v13 offset:4096
    ds_read_b64_tr_b16 a[218:219], v13 offset:5120
    ds_read_b64_tr_b16 a[220:221], v13 offset:20480
    ds_read_b64_tr_b16 a[222:223], v13 offset:21504
    s_waitcnt lgkmcnt(0)
    s_barrier
    s_mov_b32 s12, s66
    s_and_b32 s13, s67, 0xffff
    s_add_u32 s43, s42, 0x0
    s_add_u32 m0, s51, 0x18000
    s_nop 0
    buffer_load_dwordx4 v10, s[12:15], s43 offen lds
    s_add_u32 s43, s42, 0x4000
    s_add_u32 m0, s51, 0x19000
    s_nop 0
    buffer_load_dwordx4 v9, s[12:15], s43 offen lds
    s_add_u32 s43, s42, 0x8000
    s_add_u32 m0, s51, 0x1a000
    s_nop 0
    buffer_load_dwordx4 v10, s[12:15], s43 offen lds
    s_add_u32 s43, s42, 0xc000
    s_add_u32 m0, s51, 0x1b000
    s_nop 0
    buffer_load_dwordx4 v9, s[12:15], s43 offen lds
    s_add_u32 s43, s42, 0x10000
    s_add_u32 m0, s51, 0x1c000
    s_nop 0
    buffer_load_dwordx4 v10, s[12:15], s43 offen lds
    s_add_u32 s43, s42, 0x14000
    s_add_u32 m0, s51, 0x1d000
    s_nop 0
    buffer_load_dwordx4 v9, s[12:15], s43 offen lds
    s_add_u32 s43, s42, 0x18000
    s_add_u32 m0, s51, 0x1e000
    s_nop 0
    buffer_load_dwordx4 v10, s[12:15], s43 offen lds
    s_add_u32 s43, s42, 0x1c000
    s_add_u32 m0, s51, 0x1f000
    s_nop 0
    buffer_load_dwordx4 v9, s[12:15], s43 offen lds
    s_waitcnt vmcnt(24)
    s_barrier
    v_xor_b32 v13, 0, v11
    v_add_u32 v13, 0x18000, v13
    ds_read_b64_tr_b16 a[224:225], v13
    ds_read_b64_tr_b16 a[226:227], v13 offset:1024
    ds_read_b64_tr_b16 a[228:229], v13 offset:16384
    ds_read_b64_tr_b16 a[230:231], v13 offset:17408
    ds_read_b64_tr_b16 a[240:241], v13 offset:4096
    ds_read_b64_tr_b16 a[242:243], v13 offset:5120
    ds_read_b64_tr_b16 a[244:245], v13 offset:20480
    ds_read_b64_tr_b16 a[246:247], v13 offset:21504
    s_waitcnt lgkmcnt(0)
    v_xor_b32 v13, 32, v11
    v_add_u32 v13, 0x18000, v13
    ds_read_b64_tr_b16 a[232:233], v13
    ds_read_b64_tr_b16 a[234:235], v13 offset:1024
    ds_read_b64_tr_b16 a[236:237], v13 offset:16384
    ds_read_b64_tr_b16 a[238:239], v13 offset:17408
    ds_read_b64_tr_b16 a[248:249], v13 offset:4096
    ds_read_b64_tr_b16 a[250:251], v13 offset:5120
    ds_read_b64_tr_b16 a[252:253], v13 offset:20480
    ds_read_b64_tr_b16 a[254:255], v13 offset:21504
    s_waitcnt lgkmcnt(0)
    s_barrier
    s_add_u32 s43, s42, 0x40
    s_add_u32 m0, s51, 0x20000
    s_nop 0
    buffer_load_dwordx4 v10, s[12:15], s43 offen lds
    s_add_u32 s43, s42, 0x4040
    s_add_u32 m0, s51, 0x21000
    s_nop 0
    buffer_load_dwordx4 v9, s[12:15], s43 offen lds
    s_add_u32 s43, s42, 0x8040
    s_add_u32 m0, s51, 0x22000
    s_nop 0
    buffer_load_dwordx4 v10, s[12:15], s43 offen lds
    s_add_u32 s43, s42, 0xc040
    s_add_u32 m0, s51, 0x23000
    s_nop 0
    buffer_load_dwordx4 v9, s[12:15], s43 offen lds
    s_add_u32 s43, s42, 0x10040
    s_add_u32 m0, s51, 0x24000
    s_nop 0
    buffer_load_dwordx4 v10, s[12:15], s43 offen lds
    s_add_u32 s43, s42, 0x14040
    s_add_u32 m0, s51, 0x25000
    s_nop 0
    buffer_load_dwordx4 v9, s[12:15], s43 offen lds
    s_add_u32 s43, s42, 0x18040
    s_add_u32 m0, s51, 0x26000
    s_nop 0
    buffer_load_dwordx4 v10, s[12:15], s43 offen lds
    s_add_u32 s43, s42, 0x1c040
    s_add_u32 m0, s51, 0x27000
    s_nop 0
    buffer_load_dwordx4 v9, s[12:15], s43 offen lds
    s_waitcnt vmcnt(24)
    s_barrier
    v_xor_b32 v13, 0, v11
    v_add_u32 v13, 0x0, v13
    ds_read_b64_tr_b16 v[128:129], v13
    ds_read_b64_tr_b16 v[130:131], v13 offset:1024
    ds_read_b64_tr_b16 v[132:133], v13 offset:16384
    ds_read_b64_tr_b16 v[134:135], v13 offset:17408
    ds_read_b64_tr_b16 v[144:145], v13 offset:4096
    ds_read_b64_tr_b16 v[146:147], v13 offset:5120
    ds_read_b64_tr_b16 v[148:149], v13 offset:20480
    ds_read_b64_tr_b16 v[150:151], v13 offset:21504
    s_waitcnt lgkmcnt(0)
    v_xor_b32 v13, 32, v11
    v_add_u32 v13, 0x0, v13
    ds_read_b64_tr_b16 v[136:137], v13
    ds_read_b64_tr_b16 v[138:139], v13 offset:1024
    ds_read_b64_tr_b16 v[140:141], v13 offset:16384
    ds_read_b64_tr_b16 v[142:143], v13 offset:17408
    ds_read_b64_tr_b16 v[152:153], v13 offset:4096
    ds_read_b64_tr_b16 v[154:155], v13 offset:5120
    ds_read_b64_tr_b16 v[156:157], v13 offset:20480
    ds_read_b64_tr_b16 v[158:159], v13 offset:21504
    s_waitcnt lgkmcnt(0)
    s_barrier
    s_mov_b32 s12, s60
    s_and_b32 s13, s61, 0xffff
    v_xor_b32 v15, 0, v14
    v_lshl_add_u32 v15, v15, 15, v8
    s_add_u32 s43, s41, 0x0
    s_add_u32 m0, s51, 0x8000
    s_nop 0
    buffer_load_dwordx4 v15, s[12:15], s43 offen lds
    s_add_u32 s43, s41, 0x80000
    s_add_u32 m0, s51, 0x9000
    s_nop 0
    buffer_load_dwordx4 v15, s[12:15], s43 offen lds
    s_add_u32 s43, s41, 0x100000
    s_add_u32 m0, s51, 0xa000
    s_nop 0
    buffer_load_dwordx4 v15, s[12:15], s43 offen lds
    s_add_u32 s43, s41, 0x180000
    s_add_u32 m0, s51, 0xb000
    s_nop 0
    buffer_load_dwordx4 v15, s[12:15], s43 offen lds
    s_add_u32 s43, s41, 0x200000
    s_add_u32 m0, s51, 0xc000
    s_nop 0
    buffer_load_dwordx4 v15, s[12:15], s43 offen lds
    s_add_u32 s43, s41, 0x280000
    s_add_u32 m0, s51, 0xd000
    s_nop 0
    buffer_load_dwordx4 v15, s[12:15], s43 offen lds
    s_add_u32 s43, s41, 0x300000
    s_add_u32 m0, s51, 0xe000
    s_nop 0
    buffer_load_dwordx4 v15, s[12:15], s43 offen lds
    s_add_u32 s43, s41, 0x380000
    s_add_u32 m0, s51, 0xf000
    s_nop 0
    buffer_load_dwordx4 v15, s[12:15], s43 offen lds
    s_waitcnt vmcnt(24)
    s_barrier
    s_cmp_lg_u32 s21, 0
    s_cbranch_scc1 L_arr_49
    v_mov_b32 v23, 1
    s_mov_b64 exec, 1
    buffer_atomic_add v23, off, s[16:19], 0 offset:8
    s_mov_b64 exec, -1
L_arr_49:
    v_xor_b32 v13, 0, v11
    v_add_u32 v13, 0x8000, v13
    ds_read_b64_tr_b16 v[160:161], v13
    ds_read_b64_tr_b16 v[162:163], v13 offset:1024
    ds_read_b64_tr_b16 v[164:165], v13 offset:16384
    ds_read_b64_tr_b16 v[166:167], v13 offset:17408
    ds_read_b64_tr_b16 v[176:177], v13 offset:4096
    ds_read_b64_tr_b16 v[178:179], v13 offset:5120
    ds_read_b64_tr_b16 v[180:181], v13 offset:20480
    ds_read_b64_tr_b16 v[182:183], v13 offset:21504
    s_waitcnt lgkmcnt(0)
    v_xor_b32 v13, 32, v11
    v_add_u32 v13, 0x8000, v13
    ds_read_b64_tr_b16 v[168:169], v13
    ds_read_b64_tr_b16 v[170:171], v13 offset:1024
    ds_read_b64_tr_b16 v[172:173], v13 offset:16384
    ds_read_b64_tr_b16 v[174:175], v13 offset:17408
    ds_read_b64_tr_b16 v[184:185], v13 offset:4096
    ds_read_b64_tr_b16 v[186:187], v13 offset:5120
    ds_read_b64_tr_b16 v[188:189], v13 offset:20480
    ds_read_b64_tr_b16 v[190:191], v13 offset:21504
    s_waitcnt lgkmcnt(0)
    s_barrier
    s_mov_b32 s12, s62
    s_and_b32 s13, s63, 0xffff
    v_xor_b32 v15, 0, v14
    v_lshl_add_u32 v15, v15, 15, v8
    s_add_u32 s43, s41, 0x0
    s_add_u32 m0, s51, 0x10000
    s_nop 0
    buffer_load_dwordx4 v15, s[12:15], s43 offen lds
    s_add_u32 s43, s41, 0x80000
    s_add_u32 m0, s51, 0x11000
    s_nop 0
    buffer_load_dwordx4 v15, s[12:15], s43 offen lds
    s_add_u32 s43, s41, 0x100000
    s_add_u32 m0, s51, 0x12000
    s_nop 0
    buffer_load_dwordx4 v15, s[12:15], s43 offen lds
    s_add_u32 s43, s41, 0x180000
    s_add_u32 m0, s51, 0x13000
    s_nop 0
    buffer_load_dwordx4 v15, s[12:15], s43 offen lds
    s_add_u32 s43, s41, 0x200000
    s_add_u32 m0, s51, 0x14000
    s_nop 0
    buffer_load_dwordx4 v15, s[12:15], s43 offen lds
    s_add_u32 s43, s41, 0x280000
    s_add_u32 m0, s51, 0x15000
    s_nop 0
    buffer_load_dwordx4 v15, s[12:15], s43 offen lds
    s_add_u32 s43, s41, 0x300000
    s_add_u32 m0, s51, 0x16000
    s_nop 0
    buffer_load_dwordx4 v15, s[12:15], s43 offen lds
    s_add_u32 s43, s41, 0x380000
    s_add_u32 m0, s51, 0x17000
    s_nop 0
    buffer_load_dwordx4 v15, s[12:15], s43 offen lds
    s_waitcnt vmcnt(24)
    s_barrier
    v_xor_b32 v13, 0x0, v12
    v_add_u32 v13, 0x10000, v13
    ds_read_b64_tr_b16 v[192:193], v13
    ds_read_b64_tr_b16 v[194:195], v13 offset:512
    ds_read_b64_tr_b16 v[196:197], v13 offset:2048
    ds_read_b64_tr_b16 v[198:199], v13 offset:2560
    v_xor_b32 v13, 0x2000, v12
    v_add_u32 v13, 0x10000, v13
    ds_read_b64_tr_b16 v[200:201], v13
    ds_read_b64_tr_b16 v[202:203], v13 offset:512
    ds_read_b64_tr_b16 v[204:205], v13 offset:2048
    ds_read_b64_tr_b16 v[206:207], v13 offset:2560
    s_waitcnt lgkmcnt(0)
    v_xor_b32 v13, 0x4000, v12
    v_add_u32 v13, 0x10000, v13
    ds_read_b64_tr_b16 v[208:209], v13
    ds_read_b64_tr_b16 v[210:211], v13 offset:512
    ds_read_b64_tr_b16 v[212:213], v13 offset:2048
    ds_read_b64_tr_b16 v[214:215], v13 offset:2560
    v_xor_b32 v13, 0x6000, v12
    v_add_u32 v13, 0x10000, v13
    ds_read_b64_tr_b16 v[216:217], v13
    ds_read_b64_tr_b16 v[218:219], v13 offset:512
    ds_read_b64_tr_b16 v[220:221], v13 offset:2048
    ds_read_b64_tr_b16 v[222:223], v13 offset:2560
    s_waitcnt lgkmcnt(0)
    s_barrier
    s_mov_b32 s12, s66
    s_and_b32 s13, s67, 0xffff
    s_add_u32 s43, s42, 0x80
    s_add_u32 m0, s51, 0x18000
    s_nop 0
    buffer_load_dwordx4 v10, s[12:15], s43 offen lds
    s_add_u32 s43, s42, 0x4080
    s_add_u32 m0, s51, 0x19000
    s_nop 0
    buffer_load_dwordx4 v9, s[12:15], s43 offen lds
    s_add_u32 s43, s42, 0x8080
    s_add_u32 m0, s51, 0x1a000
    s_nop 0
    buffer_load_dwordx4 v10, s[12:15], s43 offen lds
    s_add_u32 s43, s42, 0xc080
    s_add_u32 m0, s51, 0x1b000
    s_nop 0
    buffer_load_dwordx4 v9, s[12:15], s43 offen lds
    s_add_u32 s43, s42, 0x10080
    s_add_u32 m0, s51, 0x1c000
    s_nop 0
    buffer_load_dwordx4 v10, s[12:15], s43 offen lds
    s_add_u32 s43, s42, 0x14080
    s_add_u32 m0, s51, 0x1d000
    s_nop 0
    buffer_load_dwordx4 v9, s[12:15], s43 offen lds
    s_add_u32 s43, s42, 0x18080
    s_add_u32 m0, s51, 0x1e000
    s_nop 0
    buffer_load_dwordx4 v10, s[12:15], s43 offen lds
    s_add_u32 s43, s42, 0x1c080
    s_add_u32 m0, s51, 0x1f000
    s_nop 0
    buffer_load_dwordx4 v9, s[12:15], s43 offen lds
    s_waitcnt vmcnt(24)
    s_barrier
    v_xor_b32 v13, 0x0, v12
    v_add_u32 v13, 0x18000, v13
    ds_read_b64_tr_b16 v[224:225], v13
    ds_read_b64_tr_b16 v[226:227], v13 offset:512
    ds_read_b64_tr_b16 v[228:229], v13 offset:2048
    ds_read_b64_tr_b16 v[230:231], v13 offset:2560
    v_xor_b32 v13, 0x2000, v12
    v_add_u32 v13, 0x18000, v13
    ds_read_b64_tr_b16 v[232:233], v13
    ds_read_b64_tr_b16 v[234:235], v13 offset:512
    ds_read_b64_tr_b16 v[236:237], v13 offset:2048
    ds_read_b64_tr_b16 v[238:239], v13 offset:2560
    s_waitcnt lgkmcnt(0)
    v_xor_b32 v13, 0x4000, v12
    v_add_u32 v13, 0x18000, v13
    ds_read_b64_tr_b16 v[240:241], v13
    ds_read_b64_tr_b16 v[242:243], v13 offset:512
    ds_read_b64_tr_b16 v[244:245], v13 offset:2048
    ds_read_b64_tr_b16 v[246:247], v13 offset:2560
    v_xor_b32 v13, 0x6000, v12
    v_add_u32 v13, 0x18000, v13
    ds_read_b64_tr_b16 v[248:249], v13
    ds_read_b64_tr_b16 v[250:251], v13 offset:512
    ds_read_b64_tr_b16 v[252:253], v13 offset:2048
    ds_read_b64_tr_b16 v[254:255], v13 offset:2560
    s_waitcnt lgkmcnt(0)
    s_barrier
    s_add_u32 s43, s42, 0xc0
    s_add_u32 m0, s51, 0x20000
    s_nop 0
    buffer_load_dwordx4 v10, s[12:15], s43 offen lds
    s_add_u32 s43, s42, 0x40c0
    s_add_u32 m0, s51, 0x21000
    s_nop 0
    buffer_load_dwordx4 v9, s[12:15], s43 offen lds
    s_add_u32 s43, s42, 0x80c0
    s_add_u32 m0, s51, 0x22000
    s_nop 0
    buffer_load_dwordx4 v10, s[12:15], s43 offen lds
    s_add_u32 s43, s42, 0xc0c0
    s_add_u32 m0, s51, 0x23000
    s_nop 0
    buffer_load_dwordx4 v9, s[12:15], s43 offen lds
    s_add_u32 s43, s42, 0x100c0
    s_add_u32 m0, s51, 0x24000
    s_nop 0
    buffer_load_dwordx4 v10, s[12:15], s43 offen lds
    s_add_u32 s43, s42, 0x140c0
    s_add_u32 m0, s51, 0x25000
    s_nop 0
    buffer_load_dwordx4 v9, s[12:15], s43 offen lds
    s_add_u32 s43, s42, 0x180c0
    s_add_u32 m0, s51, 0x26000
    s_nop 0
    buffer_load_dwordx4 v10, s[12:15], s43 offen lds
    s_add_u32 s43, s42, 0x1c0c0
    s_add_u32 m0, s51, 0x27000
    s_nop 0
    buffer_load_dwordx4 v9, s[12:15], s43 offen lds
    s_waitcnt vmcnt(24)
    s_barrier
    v_xor_b32 v13, 0, v11
    v_add_u32 v13, 0x0, v13
    ds_read_b64_tr_b16 v[32:33], v13
    ds_read_b64_tr_b16 v[34:35], v13 offset:1024
    ds_read_b64_tr_b16 v[36:37], v13 offset:16384
    ds_read_b64_tr_b16 v[38:39], v13 offset:17408
    ds_read_b64_tr_b16 v[48:49], v13 offset:4096
    ds_read_b64_tr_b16 v[50:51], v13 offset:5120
    ds_read_b64_tr_b16 v[52:53], v13 offset:20480
    ds_read_b64_tr_b16 v[54:55], v13 offset:21504
    s_waitcnt lgkmcnt(0)
    v_xor_b32 v13, 32, v11
    v_add_u32 v13, 0x0, v13
    ds_read_b64_tr_b16 v[40:41], v13
    ds_read_b64_tr_b16 v[42:43], v13 offset:1024
    ds_read_b64_tr_b16 v[44:45], v13 offset:16384
    ds_read_b64_tr_b16 v[46:47], v13 offset:17408
    ds_read_b64_tr_b16 v[56:57], v13 offset:4096
    ds_read_b64_tr_b16 v[58:59], v13 offset:5120
    ds_read_b64_tr_b16 v[60:61], v13 offset:20480
    ds_read_b64_tr_b16 v[62:63], v13 offset:21504
    s_waitcnt lgkmcnt(0)
    s_barrier
    ds_write_b128 v123, v[32:35]
    ds_write_b128 v123, v[36:39] offset:1024
    ds_write_b128 v123, v[40:43] offset:2048
    ds_write_b128 v123, v[44:47] offset:3072
    ds_write_b128 v123, v[48:51] offset:4096
    ds_write_b128 v123, v[52:55] offset:5120
    ds_write_b128 v123, v[56:59] offset:6144
    ds_write_b128 v123, v[60:63] offset:7168
    s_waitcnt vmcnt(16)
    s_barrier
    v_xor_b32 v13, 0, v11
    v_add_u32 v13, 0x8000, v13
    ds_read_b64_tr_b16 v[32:33], v13
    ds_read_b64_tr_b16 v[34:35], v13 offset:1024
    ds_read_b64_tr_b16 v[36:37], v13 offset:16384
    ds_read_b64_tr_b16 v[38:39], v13 offset:17408
    ds_read_b64_tr_b16 v[48:49], v13 offset:4096
    ds_read_b64_tr_b16 v[50:51], v13 offset:5120
    ds_read_b64_tr_b16 v[52:53], v13 offset:20480
    ds_read_b64_tr_b16 v[54:55], v13 offset:21504
    s_waitcnt lgkmcnt(0)
    v_xor_b32 v13, 32, v11
    v_add_u32 v13, 0x8000, v13
    ds_read_b64_tr_b16 v[40:41], v13
    ds_read_b64_tr_b16 v[42:43], v13 offset:1024
    ds_read_b64_tr_b16 v[44:45], v13 offset:16384
    ds_read_b64_tr_b16 v[46:47], v13 offset:17408
    ds_read_b64_tr_b16 v[56:57], v13 offset:4096
    ds_read_b64_tr_b16 v[58:59], v13 offset:5120
    ds_read_b64_tr_b16 v[60:61], v13 offset:20480
    ds_read_b64_tr_b16 v[62:63], v13 offset:21504
    s_waitcnt lgkmcnt(0)
    s_barrier
    ds_write_b128 v123, v[32:35] offset:32768
    ds_write_b128 v123, v[36:39] offset:33792
    ds_write_b128 v123, v[40:43] offset:34816
    ds_write_b128 v123, v[44:47] offset:35840
    ds_write_b128 v123, v[48:51] offset:36864
    ds_write_b128 v123, v[52:55] offset:37888
    ds_write_b128 v123, v[56:59] offset:38912
    ds_write_b128 v123, v[60:63] offset:39936
    s_waitcnt vmcnt(8)
    s_barrier
    v_xor_b32 v13, 0x0, v12
    v_add_u32 v13, 0x10000, v13
    ds_read_b64_tr_b16 v[32:33], v13
    ds_read_b64_tr_b16 v[34:35], v13 offset:512
    ds_read_b64_tr_b16 v[36:37], v13 offset:2048
    ds_read_b64_tr_b16 v[38:39], v13 offset:2560
    v_xor_b32 v13, 0x2000, v12
    v_add_u32 v13, 0x10000, v13
    ds_read_b64_tr_b16 v[40:41], v13
    ds_read_b64_tr_b16 v[42:43], v13 offset:512
    ds_read_b64_tr_b16 v[44:45], v13 offset:2048
    ds_read_b64_tr_b16 v[46:47], v13 offset:2560
    s_waitcnt lgkmcnt(0)
    v_xor_b32 v13, 0x4000, v12
    v_add_u32 v13, 0x10000, v13
    ds_read_b64_tr_b16 v[48:49], v13
    ds_read_b64_tr_b16 v[50:51], v13 offset:512
    ds_read_b64_tr_b16 v[52:53], v13 offset:2048
    ds_read_b64_tr_b16 v[54:55], v13 offset:2560
    v_xor_b32 v13, 0x6000, v12
    v_add_u32 v13, 0x10000, v13
    ds_read_b64_tr_b16 v[56:57], v13
    ds_read_b64_tr_b16 v[58:59], v13 offset:512
    ds_read_b64_tr_b16 v[60:61], v13 offset:2048
    ds_read_b64_tr_b16 v[62:63], v13 offset:2560
    s_waitcnt lgkmcnt(0)
    s_barrier
    ds_write_b128 v124, v[32:35]
    ds_write_b128 v124, v[36:39] offset:1024
    ds_write_b128 v124, v[40:43] offset:2048
    ds_write_b128 v124, v[44:47] offset:3072
    ds_write_b128 v124, v[48:51] offset:4096
    ds_write_b128 v124, v[52:55] offset:5120
    ds_write_b128 v124, v[56:59] offset:6144
    ds_write_b128 v124, v[60:63] offset:7168
    s_waitcnt vmcnt(0)
    s_barrier
    v_xor_b32 v13, 0x0, v12
    v_add_u32 v13, 0x18000, v13
    ds_read_b64_tr_b16 v[32:33], v13
    ds_read_b64_tr_b16 v[34:35], v13 offset:512
    ds_read_b64_tr_b16 v[36:37], v13 offset:2048
    ds_read_b64_tr_b16 v[38:39], v13 offset:2560
    v_xor_b32 v13, 0x2000, v12
    v_add_u32 v13, 0x18000, v13
    ds_read_b64_tr_b16 v[40:41], v13
    ds_read_b64_tr_b16 v[42:43], v13 offset:512
    ds_read_b64_tr_b16 v[44:45], v13 offset:2048
    ds_read_b64_tr_b16 v[46:47], v13 offset:2560
    s_waitcnt lgkmcnt(0)
    v_xor_b32 v13, 0x4000, v12
    v_add_u32 v13, 0x18000, v13
    ds_read_b64_tr_b16 v[48:49], v13
    ds_read_b64_tr_b16 v[50:51], v13 offset:512
    ds_read_b64_tr_b16 v[52:53], v13 offset:2048
    ds_read_b64_tr_b16 v[54:55], v13 offset:2560
    v_xor_b32 v13, 0x6000, v12
    v_add_u32 v13, 0x18000, v13
    ds_read_b64_tr_b16 v[56:57], v13
    ds_read_b64_tr_b16 v[58:59], v13 offset:512
    ds_read_b64_tr_b16 v[60:61], v13 offset:2048
    ds_read_b64_tr_b16 v[62:63], v13 offset:2560
    s_waitcnt lgkmcnt(0)
    s_barrier
    ds_write_b128 v124, v[32:35] offset:32768
    ds_write_b128 v124, v[36:39] offset:33792
    ds_write_b128 v124, v[40:43] offset:34816
    ds_write_b128 v124, v[44:47] offset:35840
    ds_write_b128 v124, v[48:51] offset:36864
    ds_write_b128 v124, v[52:55] offset:37888
    ds_write_b128 v124, v[56:59] offset:38912
    ds_write_b128 v124, v[60:63] offset:39936
    s_waitcnt lgkmcnt(0)
    v_lshrrev_b32 v1, 4, v117
    v_and_b32 v2, 15, v1
    v_lshrrev_b32 v1, 4, v1
    v_lshlrev_b32 v1, 11, v1
    v_lshl_add_u32 v1, v2, 2, v1
    s_lshl_b32 s43, s20, 6
    s_add_u32 s43, s43, 0x2000
    s_cmp_lg_u32 s100, 0
    s_cbranch_scc1 L_polls_52
    s_mov_b32 exec_lo, 0x10001
    s_mov_b32 exec_hi, 0
    s_mov_b32 s96, 0
L_poll_50:
    buffer_load_dword v2, v1, s[8:11], s43 offen sc1
    s_waitcnt vmcnt(0)
    v_cmp_gt_u32 vcc, 1, v2
    s_cbranch_vccz L_polld_51
    s_sleep 4
    s_add_u32 s96, s96, 1
    s_cmp_lt_u32 s96, 0x10000
    s_cbranch_scc1 L_poll_50
L_polld_51:
    s_mov_b64 exec, -1
L_polls_52:
    s_barrier
    s_mov_b32 s22, 0
    s_mov_b32 s33, 0
    s_xor_b32 s53, s29, 1024
    s_mov_b32 s57, 0
    s_add_u32 s23, s51, 0x7010000
    s_add_u32 s48, s23, 4096
    s_mov_b32 s24, 0x7012000
    s_add_u32 s55, s24, 16384
    s_mov_b32 s25, 0x7100000
    s_mov_b32 s26, 0x7101000
    s_lshl_b32 s43, s20, 13
    v_mov_b32 v112, 0
    v_mov_b32 v113, 0
    v_mov_b32 v114, 0
    v_mov_b32 v115, 0
    s_add_u32 s43, s43, s52
    s_add_u32 s30, s43, 0x1000000
    s_add_u32 s31, s43, 0x2000000
    s_lshr_b32 s43, s43, 1
    s_add_u32 s32, s43, 0x220000
    s_add_u32 s27, s52, 8192
    s_mov_b32 m0, s27
    s_nop 0
    buffer_load_dwordx4 v117, s[8:11], s30 offen lds
    s_xor_b32 s27, s27, 0x6000
    buffer_load_dwordx4 v117, s[8:11], s30 offen offset:1024 lds
    s_add_u32 m0, s52, 0x6000
    s_nop 0
    buffer_load_dwordx4 v117, s[8:11], s31 offen lds
    buffer_load_dwordx4 v117, s[8:11], s31 offen offset:1024 lds
    s_add_u32 m0, s51, 4096
    v_add_u32 v126, 8192, v117
    v_bfe_u32 v1, v117, 4, 1
    v_lshlrev_b32 v1, 4, v1
    s_movk_i32 s43, 0x3f80
    v_lshlrev_b32 v125, v1, s43
    v_bfe_u32 v1, v117, 5, 3
    v_cmp_eq_u32 s[68:69], 0, v1
    v_cmp_eq_u32 s[70:71], 1, v1
    v_cmp_eq_u32 s[72:73], 2, v1
    v_cmp_eq_u32 s[74:75], 3, v1
    v_lshrrev_b32 v1, 2, v117
    s_cmp_lt_u32 s21, 2
    s_cselect_b64 vcc, -1, 0
    v_cndmask_b32 v119, v119, v1, vcc
    v_mov_b32 v32, 0
    v_mov_b32 v33, 0
    v_mov_b32 v34, 0
    v_mov_b32 v35, 0
    v_mov_b32 v36, 0
    v_mov_b32 v37, 0
    v_mov_b32 v38, 0
    v_mov_b32 v39, 0
    v_mov_b32 v40, 0
    v_mov_b32 v41, 0
    v_mov_b32 v42, 0
    v_mov_b32 v43, 0
    v_mov_b32 v44, 0
    v_mov_b32 v45, 0
    v_mov_b32 v46, 0
    v_mov_b32 v47, 0
    v_mov_b32 v48, 0
    v_mov_b32 v49, 0
    v_mov_b32 v50, 0
    v_mov_b32 v51, 0
    v_mov_b32 v52, 0
    v_mov_b32 v53, 0
    v_mov_b32 v54, 0
    v_mov_b32 v55, 0
    s_add_u32 s30, s30, 0x40000
    s_add_u32 s31, s31, 0x40000
    s_mov_b32 s45, 0
    s_mov_b32 s46, 0
    s_mov_b32 s47, 0
    s_and_b32 s43, s21, 1
    s_lshl_b32 s43, s43, 5
    s_add_u32 s43, s43, s20
    s_lshl_b32 s43, s43, 6
    s_add_u32 s28, s43, 0x2000
    s_mov_b32 s59, 0
    ds_read_b128 v[88:91], v123
    ds_read_b128 v[92:95], v123 offset:1024
    ds_read_b128 v[56:59], v123 offset:2048
    ds_read_b128 v[60:63], v123 offset:3072
    ds_read_b128 v[64:67], v123 offset:32768
    ds_read_b128 v[68:71], v123 offset:33792
    ds_read_b128 v[72:75], v123 offset:34816
    ds_read_b128 v[76:79], v123 offset:35840
    ds_read_b128 v[80:83], v123 offset:4096
    ds_read_b128 v[84:87], v123 offset:5120
    ds_read_b128 v[96:99], v123 offset:6144
    ds_read_b128 v[100:103], v123 offset:7168
    ds_read_b128 v[104:107], v123 offset:36864
    ds_read_b128 v[108:111], v123 offset:37888
    ds_read_b128 v[24:27], v123 offset:38912
    ds_read_b128 v[28:31], v123 offset:39936
    s_cmp_lg_u32 s21, 0
    s_cbranch_scc1 L_cb_skip_53
    v_mov_b32 v1, 8
    s_mov_b64 exec, 1
    s_mov_b32 s49, 0
L_cb_poll_54:
    buffer_load_dword v3, v1, s[16:19], 0 offen sc1
    s_waitcnt vmcnt(0)
    v_readfirstlane_b32 s43, v3
    s_nop 0
    s_cmp_ge_u32 s43, 32
    s_cbranch_scc1 L_cb_done_55
    s_sleep 2
    s_add_u32 s49, s49, 1
    s_cmp_lt_u32 s49, 0x40000
    s_cbranch_scc1 L_cb_poll_54
L_cb_done_55:
    s_mov_b64 exec, -1
L_cb_skip_53:
    s_mov_b32 s49, 0
    s_lshr_b32 s43, s20, 1
    s_lshl_b32 s43, s43, 7
    s_and_b32 s40, s20, 1
    s_lshl_b32 s40, s40, 4
    s_add_u32 s43, s43, s40
    s_add_u32 s44, s43, 0x1000
    s_cmp_eq_u32 s21, 0
    s_cselect_b32 s44, s44, 0x7ff00000
    s_waitcnt vmcnt(0) lgkmcnt(0)
    s_barrier
    buffer_load_dwordx4 v[0:3], v117, s[8:11], s23 offen sc1
    s_waitcnt vmcnt(0)
    s_cmp_eq_u32 s21, 1
    s_cbranch_scc1 L_chain_top1_s
    s_cmp_eq_u32 s21, 2
    s_cbranch_scc1 L_chain_top2_s
    s_cmp_eq_u32 s21, 3
    s_cbranch_scc1 L_chain_top3_s
.p2align 6
L_chain_top0_s:
    buffer_load_dwordx4 v[0:3], v117, s[8:11], s23 offen sc1
    v_mov_b32 v15, 0
    v_mov_b32 v15, 0
    v_mov_b32 v15, 0
    v_mov_b32 v15, 0
    v_mov_b32 v15, 0
    v_mov_b32 v15, 0
    v_mov_b32 v15, 0
    v_mov_b32 v15, 0
    v_mov_b32 v15, 0
    v_mov_b32 v15, 0
    v_mov_b32 v15, 0
    v_mov_b32 v15, 0
    v_mov_b32 v15, 0
    v_mov_b32 v15, 0
    v_mov_b32 v15, 0
    v_mov_b32 v15, 0
    buffer_load_dwordx4 v[0:3], v117, s[8:11], s23 offen sc1
    v_mov_b32 v15, 0
    v_mov_b32 v15, 0
    v_mov_b32 v15, 0
    v_mov_b32 v15, 0
    v_mov_b32 v15, 0
    v_mov_b32 v15, 0
    v_mov_b32 v15, 0
    v_mov_b32 v15, 0
    v_mov_b32 v15, 0
    v_mov_b32 v15, 0
    v_mov_b32 v15, 0
    v_mov_b32 v15, 0
    v_mov_b32 v15, 0
    v_mov_b32 v15, 0
    v_mov_b32 v15, 0
    v_mov_b32 v15, 0
L_mret_56:
    buffer_load_dwordx4 v[0:3], v117, s[8:11], s23 offen sc1
    s_add_u32 s45, s45, 1
    s_cmp_lt_u32 s45, 0x10000
    s_cselect_b32 s56, -2, -1
    s_waitcnt vmcnt(2)
    v_max3_u32 v15, v0, v1, v2
    v_max_u32 v15, v15, v3
    v_cmp_lt_u32 vcc, s56, v15
    s_cbranch_vccnz L_mret_56
    v_smfmac_f32_16x16x64_bf16 v[32:35], v[0:3], v[88:95], v116
    ds_write_b128 v117, v[0:3]
    v_smfmac_f32_16x16x64_bf16 v[36:39], v[0:3], v[56:63], v116
    buffer_load_dwordx4 v[4:7], v117, s[8:11], s48 offen sc1
    v_smfmac_f32_16x16x64_bf16 v[40:43], v[0:3], v[64:71], v116
    buffer_load_dwordx4 v117, s[8:11], s48 offen sc1 lds
    s_mov_b32 m0, s27
    v_smfmac_f32_16x16x64_bf16 v[44:47], v[0:3], v[72:79], v116
    s_waitcnt lgkmcnt(0)
    s_barrier
    v_smfmac_f32_16x16x64_bf16 v[48:51], v[0:3], a[192:199], v116
    ds_read_b128 v[8:11], v117 offset:1024
    ds_read_b128 v[16:19], v117 offset:2048
    ds_read_b128 v[20:23], v117 offset:3072
    v_smfmac_f32_16x16x64_bf16 v[52:55], v[0:3], a[200:207], v116
    ds_read_b128 v[88:91], v117 offset:24576
    ds_read_b128 v[92:95], v117 offset:25600
    s_waitcnt lgkmcnt(4)
    v_smfmac_f32_16x16x64_bf16 v[32:35], v[8:11], a[0:7], v116
    ds_read_b128 v[56:59], v126
    v_smfmac_f32_16x16x64_bf16 v[36:39], v[8:11], a[8:15], v116
    ds_read_b128 v[60:63], v126 offset:1024
    s_waitcnt lgkmcnt(5)
    v_smfmac_f32_16x16x64_bf16 v[32:35], v[16:19], a[32:39], v116
    ds_read_b128 v[64:67], v126 offset:2048
    v_smfmac_f32_16x16x64_bf16 v[36:39], v[16:19], a[40:47], v116
    ds_read_b128 v[68:71], v126 offset:3072
    s_waitcnt lgkmcnt(6)
    v_smfmac_f32_16x16x64_bf16 v[32:35], v[20:23], a[64:71], v116
    ds_read_b128 v[72:75], v126 offset:4096
    v_smfmac_f32_16x16x64_bf16 v[36:39], v[20:23], a[72:79], v116
    ds_read_b128 v[76:79], v126 offset:5120
    v_smfmac_f32_16x16x64_bf16 v[40:43], v[8:11], a[96:103], v116
    v_smfmac_f32_16x16x64_bf16 v[40:43], v[16:19], a[128:135], v116
    v_smfmac_f32_16x16x64_bf16 v[40:43], v[20:23], a[160:167], v116
    v_smfmac_f32_16x16x64_bf16 v[44:47], v[8:11], a[104:111], v116
    s_waitcnt vmcnt(1)
    v_max3_u32 v15, v4, v5, v6
    v_max_u32 v15, v15, v7
    v_smfmac_f32_16x16x64_bf16 v[44:47], v[16:19], a[136:143], v116
    v_cmp_lt_u32 vcc, s56, v15
    s_cbranch_vccnz L_mret_57
L_mgo_58:
    s_waitcnt vmcnt(0)
    s_barrier
    v_smfmac_f32_16x16x64_bf16 v[44:47], v[4:7], v[24:31], v116
    ds_read_b128 v[12:15], v117 offset:5120
    ds_read_b128 v[24:27], v117 offset:6144
    v_smfmac_f32_16x16x64_bf16 v[32:35], v[4:7], v[80:87], v116
    ds_read_b128 v[28:31], v117 offset:7168
    v_smfmac_f32_16x16x64_bf16 v[36:39], v[4:7], v[96:103], v116
    buffer_load_dword v125, v119, s[8:11], s28 offen sc1
    v_smfmac_f32_16x16x64_bf16 v[40:43], v[4:7], v[104:111], v116
    buffer_load_dwordx4 v117, s[8:11], s30 offen lds
    s_xor_b32 s27, s27, 0x6000
    v_mov_b32 v96, 0
    v_smfmac_f32_16x16x64_bf16 v[48:51], v[4:7], a[208:215], v116
    buffer_load_dwordx4 v117, s[8:11], s30 offen offset:1024 lds
    s_add_u32 m0, s52, 0x6000
    v_mov_b32 v97, 0
    v_smfmac_f32_16x16x64_bf16 v[52:55], v[4:7], a[216:223], v116
    s_waitcnt lgkmcnt(9)
    buffer_load_dwordx4 v117, s[8:11], s31 offen lds
    s_waitcnt lgkmcnt(2)
    v_mov_b32 v98, 0
    v_smfmac_f32_16x16x64_bf16 v[32:35], v[12:15], a[16:23], v116
    buffer_load_dwordx4 v117, s[8:11], s31 offen offset:1024 lds
    s_mov_b32 m0, 4096
    s_waitcnt lgkmcnt(1)
    v_mov_b32 v99, 0
    v_smfmac_f32_16x16x64_bf16 v[32:35], v[24:27], a[48:55], v116
    buffer_store_dwordx4 v[112:115], v117, s[8:11], s32 offen sc1
    s_waitcnt lgkmcnt(0)
    v_mov_b32 v100, 0
    v_smfmac_f32_16x16x64_bf16 v[32:35], v[28:31], a[80:87], v116
    ds_read_b128 v[80:83], v126 offset:6144
    v_mov_b32 v101, 0
    v_smfmac_f32_16x16x64_bf16 v[36:39], v[12:15], a[24:31], v116
    ds_read_b128 v[84:87], v126 offset:7168
    v_mov_b32 v102, 0
    v_smfmac_f32_16x16x64_bf16 v[36:39], v[24:27], a[56:63], v116
    ds_read_b128 v[0:3], v124
    v_add_f32 v32, v32, v34
    v_add_f32 v33, v33, v35
    v_smfmac_f32_16x16x64_bf16 v[36:39], v[28:31], a[88:95], v116
    ds_read_b128 v[4:7], v124 offset:1024
    v_mul_f32 v32, s34, v32
    v_mul_f32 v33, s34, v33
    v_smfmac_f32_16x16x64_bf16 v[40:43], v[12:15], a[112:119], v116
    v_mov_b32 v103, 0
    v_smfmac_f32_16x16x64_bf16 v[40:43], v[24:27], a[144:151], v116
    v_add_f32 v36, v36, v38
    v_add_f32 v37, v37, v39
    v_smfmac_f32_16x16x64_bf16 v[40:43], v[28:31], a[176:183], v116
    v_mul_f32 v36, s34, v36
    v_smfmac_f32_16x16x64_bf16 v[44:47], v[20:23], a[168:175], v116
    v_mul_f32 v37, s34, v37
    v_smfmac_f32_16x16x64_bf16 v[44:47], v[12:15], a[120:127], v116
    v_cvt_pk_bf16_f32 v34, v32, v36
    v_smfmac_f32_16x16x64_bf16 v[44:47], v[24:27], a[152:159], v116
    v_cvt_pk_bf16_f32 v35, v33, v37
    v_smfmac_f32_16x16x64_bf16 v[44:47], v[28:31], a[184:191], v116
    ds_write2_b32 v120, v34, v35 offset0:32 offset1:48
    v_add_f32 v40, v40, v42
    v_smfmac_f32_16x16x64_bf16 v[48:51], v[8:11], a[224:231], v116
    v_add_f32 v41, v41, v43
    v_smfmac_f32_16x16x64_bf16 v[52:55], v[8:11], a[232:239], v116
    v_add_f32 v44, v44, v46
    v_add_f32 v45, v45, v47
    v_cvt_pk_bf16_f32 v113, v40, v44
    v_cvt_pk_bf16_f32 v115, v41, v45
    v_smfmac_f32_16x16x64_bf16 v[48:51], v[12:15], a[240:247], v116
    ds_write2_b32 v120, v113, v115 offset0:0 offset1:16
    v_mov_b32 v36, s57
    v_smfmac_f32_16x16x64_bf16 v[52:55], v[12:15], a[248:255], v116
    v_mov_b32 v104, 0
    v_smfmac_f32_16x16x64_bf16 v[48:51], v[16:19], v[128:135], v116
    buffer_store_dword v36, off, s[8:11], s44 sc1
    v_mov_b32 v105, 0
    v_smfmac_f32_16x16x64_bf16 v[48:51], v[20:23], v[160:167], v116
    v_mov_b32 v106, 0
    v_smfmac_f32_16x16x64_bf16 v[48:51], v[24:27], v[144:151], v116
    s_cmp_eq_u32 s22, 63
    s_waitcnt lgkmcnt(0)
    s_barrier
    s_cbranch_scc1 L_chain_last_s
    ds_read_b128 v[32:35], v121
    v_smfmac_f32_16x16x64_bf16 v[48:51], v[28:31], v[176:183], v116
    ds_read_b128 v[36:39], v121 offset:1024
    ds_read_b128 v[40:43], v121 offset:2048
    v_mov_b32 v107, 0
    v_smfmac_f32_16x16x64_bf16 v[52:55], v[16:19], v[136:143], v116
    ds_read_b128 v[44:47], v121 offset:3072
    v_mov_b32 v108, 0
    v_smfmac_f32_16x16x64_bf16 v[52:55], v[20:23], v[168:175], v116
    ds_read_b128 v[8:11], v124 offset:32768
    v_add_f32 v48, v48, v50
    v_smfmac_f32_16x16x64_bf16 v[52:55], v[24:27], v[152:159], v116
    ds_read_b128 v[12:15], v124 offset:33792
    v_add_f32 v49, v49, v51
    v_smfmac_f32_16x16x64_bf16 v[52:55], v[28:31], v[184:191], v116
    ds_read_b128 v[16:19], v124 offset:2048
    s_waitcnt lgkmcnt(6)
    v_cvt_pk_bf16_f32 v112, v48, v49
    v_mov_b32 v109, 0
    v_mov_b32 v110, 0
    v_mov_b32 v111, 0
    v_mfma_f32_16x16x32_bf16 v[56:59], v[56:59], v[32:35], 0
    s_waitcnt lgkmcnt(5)
    v_mov_b32 v48, s50
    v_mov_b32 v49, s50
    v_mfma_f32_16x16x32_bf16 v[56:59], v[60:63], v[36:39], v[56:59]
    ds_read_b128 v[20:23], v124 offset:3072
    s_waitcnt lgkmcnt(5)
    v_mov_b32 v50, s50
    v_mfma_f32_16x16x32_bf16 v[56:59], v[64:67], v[40:43], v[56:59]
    ds_read_b128 v[24:27], v124 offset:4096
    s_waitcnt lgkmcnt(5)
    v_add_f32 v52, v52, v54
    v_mfma_f32_16x16x32_bf16 v[56:59], v[68:71], v[44:47], v[56:59]
    ds_read_b128 v[28:31], v124 offset:5120
    v_add_f32 v53, v53, v55
    v_mfma_f32_16x16x32_bf16 v[60:63], v[72:75], v[32:35], 0
    v_cvt_pk_bf16_f32 v114, v52, v53
    v_mfma_f32_16x16x32_bf16 v[60:63], v[76:79], v[36:39], v[60:63]
    v_exp_f32 v56, v56
    v_mfma_f32_16x16x32_bf16 v[60:63], v[80:83], v[40:43], v[60:63]
    v_exp_f32 v57, v57
    v_mfma_f32_16x16x32_bf16 v[60:63], v[84:87], v[44:47], v[60:63]
    v_exp_f32 v58, v58
    v_mfma_f32_16x16x32_bf16 v[64:67], v[32:35], v[32:35], 0
    v_exp_f32 v59, v59
    v_cvt_pk_bf16_f32 v68, v56, v57
    v_mfma_f32_16x16x32_bf16 v[64:67], v[36:39], v[36:39], v[64:67]
    v_exp_f32 v60, v60
    v_cvt_pk_bf16_f32 v69, v58, v59
    v_mfma_f32_16x16x32_bf16 v[64:67], v[40:43], v[40:43], v[64:67]
    v_exp_f32 v61, v61
    v_mfma_f32_16x16x32_bf16 v[64:67], v[44:47], v[44:47], v[64:67]
    v_exp_f32 v62, v62
    v_exp_f32 v63, v63
    v_cvt_pk_bf16_f32 v70, v60, v61
    v_cvt_pk_bf16_f32 v71, v62, v63
    v_mov_b32 v51, s50
    v_mov_b32 v53, 0
    v_mfma_f32_16x16x32_bf16 v[72:75], v[88:91], v[68:71], 0
    s_nop 0
    v_exp_f32 v64, v64
    v_mfma_f32_16x16x32_bf16 v[76:79], v[92:95], v[68:71], 0
    v_exp_f32 v65, v65
    v_mfma_f32_16x16x32_bf16 v[80:83], v[48:51], v[68:71], 0
    ds_read_b128 v[32:35], v124 offset:6144
    v_cvt_pk_bf16_f32 v52, v64, v65
    s_nop 1
    v_mfma_f32_16x16x16_bf16 v[72:75], v[112:113], v[52:53], v[72:75]
    ds_read_b128 v[36:39], v124 offset:7168
    v_mfma_f32_16x16x16_bf16 v[76:79], v[114:115], v[52:53], v[76:79]
    v_mfma_f32_16x16x16_bf16 v[80:83], v[48:49], v[52:53], v[80:83]
L_norm_59:
    s_mov_b64 vcc, s[36:37]
    s_nop 2
    v_cndmask_b32_dpp v76, v72, v76, vcc quad_perm:[2,3,2,3] row_mask:0xf bank_mask:0xf
    v_cndmask_b32_dpp v77, v73, v77, vcc quad_perm:[2,3,2,3] row_mask:0xf bank_mask:0xf
    v_cndmask_b32_dpp v78, v74, v78, vcc quad_perm:[2,3,2,3] row_mask:0xf bank_mask:0xf
    v_cndmask_b32_dpp v79, v75, v79, vcc quad_perm:[2,3,2,3] row_mask:0xf bank_mask:0xf
    v_rcp_f32_dpp v84, v80 quad_perm:[2,3,2,3] row_mask:0xf bank_mask:0xf
    s_nop 0
    v_pk_mul_f32 v[76:77], v[76:77], v[84:85] op_sel_hi:[1,0]
    v_pk_mul_f32 v[78:79], v[78:79], v[84:85] op_sel_hi:[1,0]
    v_cvt_pk_bf16_f32 v72, v76, v77
    v_cvt_pk_bf16_f32 v73, v78, v79
    ds_write_b64 v122, v[72:73] offset:4096
    v_max_f32_dpp v86, v80, v84 quad_perm:[2,3,2,3] row_mask:0xf bank_mask:0xf
    v_mov_b32_dpp v60, v72 quad_perm:[0,1,0,1] row_mask:0xf bank_mask:0xf
    v_mov_b32_dpp v61, v73 quad_perm:[0,1,0,1] row_mask:0xf bank_mask:0xf
    v_cmp_lt_f32 vcc, s35, v86
    v_mov_b32_dpp v62, v72 quad_perm:[2,3,2,3] row_mask:0xf bank_mask:0xf
    v_mov_b32_dpp v63, v73 quad_perm:[2,3,2,3] row_mask:0xf bank_mask:0xf
    s_cbranch_vccnz L_smax_60
    s_nop 0
    v_smfmac_f32_16x16x64_bf16 v[96:99], v[60:63], v[192:199], v116
    v_smfmac_f32_16x16x64_bf16 v[100:103], v[60:63], v[224:231], v116
    v_smfmac_f32_16x16x64_bf16 v[104:107], v[60:63], v[0:7], v116
    s_waitcnt lgkmcnt(0)
    s_barrier
    ds_read_b128 v[92:95], v127 offset:4608
    ds_read_b128 v[80:83], v127 offset:5120
    ds_read_b128 v[84:87], v127 offset:5632
    v_smfmac_f32_16x16x64_bf16 v[108:111], v[60:63], v[8:15], v116
    s_waitcnt lgkmcnt(2)
    v_smfmac_f32_16x16x64_bf16 v[96:99], v[92:95], v[200:207], v116
    s_waitcnt lgkmcnt(1)
    v_smfmac_f32_16x16x64_bf16 v[96:99], v[80:83], v[208:215], v116
    ds_read_b128 v[40:43], v124 offset:34816
    s_waitcnt lgkmcnt(1)
    v_smfmac_f32_16x16x64_bf16 v[96:99], v[84:87], v[216:223], v116
    ds_read_b128 v[44:47], v124 offset:35840
    v_smfmac_f32_16x16x64_bf16 v[100:103], v[92:95], v[232:239], v116
    ds_read_b128 v[56:59], v124 offset:36864
    v_smfmac_f32_16x16x64_bf16 v[100:103], v[80:83], v[240:247], v116
    ds_read_b128 v[60:63], v124 offset:37888
    v_cvt_pk_bf16_f32 v72, v96, v98
    v_smfmac_f32_16x16x64_bf16 v[100:103], v[84:87], v[248:255], v116
    ds_read_b128 v[64:67], v124 offset:38912
    v_and_or_b32 v72, v72, -2, s33
    v_smfmac_f32_16x16x64_bf16 v[104:107], v[92:95], v[16:23], v116
    ds_read_b128 v[68:71], v124 offset:39936
    v_cvt_pk_bf16_f32 v74, v97, v99
    v_smfmac_f32_16x16x64_bf16 v[104:107], v[80:83], v[24:31], v116
    v_cvt_pk_bf16_f32 v73, v100, v102
    v_cvt_pk_bf16_f32 v75, v101, v103
    v_smfmac_f32_16x16x64_bf16 v[104:107], v[84:87], v[32:39], v116
    buffer_store_dwordx4 v[72:75], v118, s[8:11], s25 offen sc1
    s_waitcnt lgkmcnt(4)
    v_smfmac_f32_16x16x64_bf16 v[108:111], v[92:95], v[40:47], v116
    s_waitcnt lgkmcnt(2)
    v_smfmac_f32_16x16x64_bf16 v[108:111], v[80:83], v[56:63], v116
    s_waitcnt lgkmcnt(0)
    v_cvt_pk_bf16_f32 v76, v104, v106
    v_smfmac_f32_16x16x64_bf16 v[108:111], v[84:87], v[64:71], v116
    v_and_or_b32 v76, v76, -2, s33
    v_cvt_pk_bf16_f32 v78, v105, v107
    s_nop 5
    v_cvt_pk_bf16_f32 v77, v108, v110
    v_cvt_pk_bf16_f32 v79, v109, v111
    buffer_store_dwordx4 v[76:79], v118, s[8:11], s26 offen sc1
    s_add_u32 s30, s30, 0x40000
    s_add_u32 s31, s31, 0x40000
    s_add_u32 s32, s32, 0x20000
    s_add_u32 s23, s24, 0
    s_add_u32 s48, s23, 4096
    s_xor_b32 s25, s25, 0x40000
    s_xor_b32 s26, s26, 0x40000
    s_mov_b32 s35, 0x49800000
    s_mov_b32 s57, s22
    s_add_u32 s22, s22, 1
    v_xor_b32 v126, 0x6000, v126
    v_mov_b32 v32, 0
    v_mov_b32 v33, 0
    v_mov_b32 v34, 0
    v_mov_b32 v35, 0
    v_mov_b32 v36, 0
    v_mov_b32 v37, 0
    v_mov_b32 v38, 0
    v_mov_b32 v39, 0
    v_mov_b32 v40, 0
    v_mov_b32 v41, 0
    v_mov_b32 v42, 0
    v_mov_b32 v43, 0
    v_mov_b32 v44, 0
    v_mov_b32 v45, 0
    v_mov_b32 v46, 0
    v_mov_b32 v47, 0
    v_mov_b32 v48, 0
    v_mov_b32 v49, 0
    v_mov_b32 v50, 0
    v_mov_b32 v51, 0
    v_mov_b32 v52, 0
    v_mov_b32 v53, 0
    v_mov_b32 v54, 0
    v_mov_b32 v55, 0
    ds_read_b128 v[88:91], v123
    ds_read_b128 v[92:95], v123 offset:1024
    ds_read_b128 v[56:59], v123 offset:2048
    ds_read_b128 v[60:63], v123 offset:3072
    ds_read_b128 v[64:67], v123 offset:32768
    ds_read_b128 v[68:71], v123 offset:33792
    ds_read_b128 v[72:75], v123 offset:34816
    ds_read_b128 v[76:79], v123 offset:35840
    ds_read_b128 v[80:83], v123 offset:4096
    ds_read_b128 v[84:87], v123 offset:5120
    ds_read_b128 v[96:99], v123 offset:6144
    ds_read_b128 v[100:103], v123 offset:7168
    ds_read_b128 v[104:107], v123 offset:36864
    ds_read_b128 v[108:111], v123 offset:37888
    ds_read_b128 v[24:27], v123 offset:38912
    ds_read_b128 v[28:31], v123 offset:39936
    s_add_u32 s24, s24, 8192
    s_bitset0_b32 s24, 15
    s_xor_b32 s55, s24, 16384
    s_xor_b32 s29, s29, 0x40000
    s_xor_b32 s53, s29, 1024
    s_bfe_u32 s33, s22, 0x10001
    s_add_u32 s40, s22, 5
    s_lshr_b32 s40, s40, 2
    s_min_u32 s40, s40, 16
    s_bfm_b32 s58, s40, 0
    s_waitcnt vmcnt(2)
    v_cmp_eq_u32 vcc, 0, v125
    s_nop 0
    s_and_b64 vcc, vcc, s[58:59]
    s_cbranch_scc1 L_kvw_61
L_kvb_62:
    v_mov_b32 v15, 0
    s_nop 2
    v_mov_b32 v15, 0
    s_nop 2
    v_mov_b32 v15, 0
    s_nop 2
    v_mov_b32 v15, 0
    s_nop 2
    v_mov_b32 v15, 0
    s_nop 2
    v_mov_b32 v15, 0
    s_nop 2
    v_mov_b32 v15, 0
    s_nop 2
    v_mov_b32 v15, 0
    s_nop 2
    v_mov_b32 v15, 0
    s_nop 2
    v_mov_b32 v15, 0
    s_nop 2
    v_mov_b32 v15, 0
    s_nop 2
    v_mov_b32 v15, 0
    s_nop 2
    v_mov_b32 v15, 0
    s_nop 2
    v_mov_b32 v15, 0
    s_nop 2
    v_mov_b32 v15, 0
    s_nop 2
    v_mov_b32 v15, 0
    s_nop 2
    v_mov_b32 v15, 0
    s_nop 2
    v_mov_b32 v15, 0
    s_nop 2
    v_mov_b32 v15, 0
    s_nop 2
    v_mov_b32 v15, 0
    s_nop 2
    v_mov_b32 v15, 0
    s_nop 2
    v_mov_b32 v15, 0
    s_nop 2
    v_mov_b32 v15, 0
    s_nop 2
    v_mov_b32 v15, 0
    s_nop 2
    v_mov_b32 v15, 0
    s_nop 2
    v_mov_b32 v15, 0
    s_nop 2
    v_mov_b32 v15, 0
    s_nop 2
    v_mov_b32 v15, 0
    s_nop 2
    v_mov_b32 v15, 0
    s_nop 2
    v_mov_b32 v15, 0
    s_nop 2
    s_waitcnt lgkmcnt(0)
    s_branch L_chain_top0_s
.p2align 6
L_chain_top1_s:
    buffer_load_dwordx4 v[0:3], v117, s[8:11], s23 offen sc1
    v_mov_b32 v15, 0
    v_mov_b32 v15, 0
    v_mov_b32 v15, 0
    v_mov_b32 v15, 0
    v_mov_b32 v15, 0
    v_mov_b32 v15, 0
    v_mov_b32 v15, 0
    v_mov_b32 v15, 0
    v_mov_b32 v15, 0
    v_mov_b32 v15, 0
    v_mov_b32 v15, 0
    v_mov_b32 v15, 0
    v_mov_b32 v15, 0
    v_mov_b32 v15, 0
    v_mov_b32 v15, 0
    v_mov_b32 v15, 0
    buffer_load_dwordx4 v[0:3], v117, s[8:11], s23 offen sc1
    v_mov_b32 v15, 0
    v_mov_b32 v15, 0
    v_mov_b32 v15, 0
    v_mov_b32 v15, 0
    v_mov_b32 v15, 0
    v_mov_b32 v15, 0
    v_mov_b32 v15, 0
    v_mov_b32 v15, 0
    v_mov_b32 v15, 0
    v_mov_b32 v15, 0
    v_mov_b32 v15, 0
    v_mov_b32 v15, 0
    v_mov_b32 v15, 0
    v_mov_b32 v15, 0
    v_mov_b32 v15, 0
    v_mov_b32 v15, 0
L_mret_63:
    buffer_load_dwordx4 v[0:3], v117, s[8:11], s23 offen sc1
    s_add_u32 s45, s45, 1
    s_cmp_lt_u32 s45, 0x10000
    s_cselect_b32 s56, -2, -1
    s_waitcnt vmcnt(2)
    v_max3_u32 v15, v0, v1, v2
    v_max_u32 v15, v15, v3
    v_cmp_lt_u32 vcc, s56, v15
    s_cbranch_vccnz L_mret_63
    v_smfmac_f32_16x16x64_bf16 v[32:35], v[0:3], v[88:95], v116
    ds_write_b128 v117, v[0:3] offset:1024
    v_smfmac_f32_16x16x64_bf16 v[36:39], v[0:3], v[56:63], v116
    buffer_load_dwordx4 v[4:7], v117, s[8:11], s48 offen sc1
    v_smfmac_f32_16x16x64_bf16 v[40:43], v[0:3], v[64:71], v116
    buffer_load_dwordx4 v117, s[8:11], s48 offen sc1 lds
    s_mov_b32 m0, s27
    v_smfmac_f32_16x16x64_bf16 v[44:47], v[0:3], v[72:79], v116
    s_waitcnt lgkmcnt(0)
    s_barrier
    v_smfmac_f32_16x16x64_bf16 v[48:51], v[0:3], a[192:199], v116
    ds_read_b128 v[8:11], v117
    ds_read_b128 v[16:19], v117 offset:3072
    ds_read_b128 v[20:23], v117 offset:2048
    v_smfmac_f32_16x16x64_bf16 v[52:55], v[0:3], a[200:207], v116
    ds_read_b128 v[88:91], v117 offset:26624
    ds_read_b128 v[92:95], v117 offset:27648
    s_waitcnt lgkmcnt(4)
    v_smfmac_f32_16x16x64_bf16 v[32:35], v[8:11], a[0:7], v116
    ds_read_b128 v[56:59], v126
    v_smfmac_f32_16x16x64_bf16 v[36:39], v[8:11], a[8:15], v116
    ds_read_b128 v[60:63], v126 offset:1024
    s_waitcnt lgkmcnt(5)
    v_smfmac_f32_16x16x64_bf16 v[32:35], v[16:19], a[32:39], v116
    ds_read_b128 v[64:67], v126 offset:2048
    v_smfmac_f32_16x16x64_bf16 v[36:39], v[16:19], a[40:47], v116
    ds_read_b128 v[68:71], v126 offset:3072
    s_waitcnt lgkmcnt(6)
    v_smfmac_f32_16x16x64_bf16 v[32:35], v[20:23], a[64:71], v116
    ds_read_b128 v[72:75], v126 offset:4096
    v_smfmac_f32_16x16x64_bf16 v[36:39], v[20:23], a[72:79], v116
    ds_read_b128 v[76:79], v126 offset:5120
    v_smfmac_f32_16x16x64_bf16 v[40:43], v[8:11], a[96:103], v116
    v_smfmac_f32_16x16x64_bf16 v[40:43], v[16:19], a[128:135], v116
    v_smfmac_f32_16x16x64_bf16 v[40:43], v[20:23], a[160:167], v116
    v_smfmac_f32_16x16x64_bf16 v[44:47], v[8:11], a[104:111], v116
    s_waitcnt vmcnt(1)
    v_max3_u32 v15, v4, v5, v6
    v_max_u32 v15, v15, v7
    v_smfmac_f32_16x16x64_bf16 v[44:47], v[16:19], a[136:143], v116
    v_cmp_lt_u32 vcc, s56, v15
    s_cbranch_vccnz L_mret_64
L_mgo_65:
    s_waitcnt vmcnt(0)
    s_barrier
    v_smfmac_f32_16x16x64_bf16 v[44:47], v[4:7], v[24:31], v116
    ds_read_b128 v[12:15], v117 offset:4096
    ds_read_b128 v[24:27], v117 offset:7168
    v_smfmac_f32_16x16x64_bf16 v[32:35], v[4:7], v[80:87], v116
    ds_read_b128 v[28:31], v117 offset:6144
    v_smfmac_f32_16x16x64_bf16 v[36:39], v[4:7], v[96:103], v116
    buffer_load_dword v125, v119, s[8:11], s28 offen sc1
    v_smfmac_f32_16x16x64_bf16 v[40:43], v[4:7], v[104:111], v116
    buffer_load_dwordx4 v117, s[8:11], s30 offen lds
    s_xor_b32 s27, s27, 0x6000
    v_mov_b32 v96, 0
    v_smfmac_f32_16x16x64_bf16 v[48:51], v[4:7], a[208:215], v116
    buffer_load_dwordx4 v117, s[8:11], s30 offen offset:1024 lds
    s_add_u32 m0, s52, 0x6000
    v_mov_b32 v97, 0
    v_smfmac_f32_16x16x64_bf16 v[52:55], v[4:7], a[216:223], v116
    s_waitcnt lgkmcnt(9)
    buffer_load_dwordx4 v117, s[8:11], s31 offen lds
    s_waitcnt lgkmcnt(2)
    v_mov_b32 v98, 0
    v_smfmac_f32_16x16x64_bf16 v[32:35], v[12:15], a[16:23], v116
    buffer_load_dwordx4 v117, s[8:11], s31 offen offset:1024 lds
    s_mov_b32 m0, 5120
    s_waitcnt lgkmcnt(1)
    v_mov_b32 v99, 0
    v_smfmac_f32_16x16x64_bf16 v[32:35], v[24:27], a[48:55], v116
    buffer_store_dwordx4 v[112:115], v117, s[8:11], s32 offen sc1
    s_waitcnt lgkmcnt(0)
    v_mov_b32 v100, 0
    v_smfmac_f32_16x16x64_bf16 v[32:35], v[28:31], a[80:87], v116
    ds_read_b128 v[80:83], v126 offset:6144
    v_mov_b32 v101, 0
    v_smfmac_f32_16x16x64_bf16 v[36:39], v[12:15], a[24:31], v116
    ds_read_b128 v[84:87], v126 offset:7168
    v_mov_b32 v102, 0
    v_smfmac_f32_16x16x64_bf16 v[36:39], v[24:27], a[56:63], v116
    ds_read_b128 v[0:3], v124
    v_add_f32 v32, v32, v34
    v_add_f32 v33, v33, v35
    v_smfmac_f32_16x16x64_bf16 v[36:39], v[28:31], a[88:95], v116
    ds_read_b128 v[4:7], v124 offset:1024
    v_mul_f32 v32, s34, v32
    v_mul_f32 v33, s34, v33
    v_smfmac_f32_16x16x64_bf16 v[40:43], v[12:15], a[112:119], v116
    v_mov_b32 v103, 0
    v_smfmac_f32_16x16x64_bf16 v[40:43], v[24:27], a[144:151], v116
    v_add_f32 v36, v36, v38
    v_add_f32 v37, v37, v39
    v_smfmac_f32_16x16x64_bf16 v[40:43], v[28:31], a[176:183], v116
    v_mul_f32 v36, s34, v36
    v_smfmac_f32_16x16x64_bf16 v[44:47], v[20:23], a[168:175], v116
    v_mul_f32 v37, s34, v37
    v_smfmac_f32_16x16x64_bf16 v[44:47], v[12:15], a[120:127], v116
    v_cvt_pk_bf16_f32 v34, v32, v36
    v_smfmac_f32_16x16x64_bf16 v[44:47], v[24:27], a[152:159], v116
    v_cvt_pk_bf16_f32 v35, v33, v37
    v_smfmac_f32_16x16x64_bf16 v[44:47], v[28:31], a[184:191], v116
    ds_write2_b32 v120, v34, v35 offset0:32 offset1:48
    v_add_f32 v40, v40, v42
    v_smfmac_f32_16x16x64_bf16 v[48:51], v[8:11], a[224:231], v116
    v_add_f32 v41, v41, v43
    v_smfmac_f32_16x16x64_bf16 v[52:55], v[8:11], a[232:239], v116
    v_add_f32 v44, v44, v46
    v_add_f32 v45, v45, v47
    v_cvt_pk_bf16_f32 v113, v40, v44
    v_cvt_pk_bf16_f32 v115, v41, v45
    v_smfmac_f32_16x16x64_bf16 v[48:51], v[12:15], a[240:247], v116
    ds_write2_b32 v120, v113, v115 offset0:0 offset1:16
    v_smfmac_f32_16x16x64_bf16 v[52:55], v[12:15], a[248:255], v116
    v_mov_b32 v104, 0
    v_smfmac_f32_16x16x64_bf16 v[48:51], v[16:19], v[128:135], v116
    v_mov_b32 v105, 0
    v_smfmac_f32_16x16x64_bf16 v[48:51], v[20:23], v[160:167], v116
    v_mov_b32 v106, 0
    v_smfmac_f32_16x16x64_bf16 v[48:51], v[24:27], v[144:151], v116
    s_cmp_eq_u32 s22, 63
    s_waitcnt lgkmcnt(0)
    s_barrier
    s_cbranch_scc1 L_chain_last_s
    ds_read_b128 v[32:35], v121
    v_smfmac_f32_16x16x64_bf16 v[48:51], v[28:31], v[176:183], v116
    ds_read_b128 v[36:39], v121 offset:1024
    ds_read_b128 v[40:43], v121 offset:2048
    v_mov_b32 v107, 0
    v_smfmac_f32_16x16x64_bf16 v[52:55], v[16:19], v[136:143], v116
    ds_read_b128 v[44:47], v121 offset:3072
    v_mov_b32 v108, 0
    v_smfmac_f32_16x16x64_bf16 v[52:55], v[20:23], v[168:175], v116
    ds_read_b128 v[8:11], v124 offset:32768
    v_add_f32 v48, v48, v50
    v_smfmac_f32_16x16x64_bf16 v[52:55], v[24:27], v[152:159], v116
    ds_read_b128 v[12:15], v124 offset:33792
    v_add_f32 v49, v49, v51
    v_smfmac_f32_16x16x64_bf16 v[52:55], v[28:31], v[184:191], v116
    ds_read_b128 v[16:19], v124 offset:2048
    s_waitcnt lgkmcnt(6)
    v_cvt_pk_bf16_f32 v112, v48, v49
    v_mov_b32 v109, 0
    v_mov_b32 v110, 0
    v_mov_b32 v111, 0
    v_mfma_f32_16x16x32_bf16 v[56:59], v[56:59], v[32:35], 0
    s_waitcnt lgkmcnt(5)
    v_mov_b32 v48, s50
    v_mov_b32 v49, s50
    v_mfma_f32_16x16x32_bf16 v[56:59], v[60:63], v[36:39], v[56:59]
    ds_read_b128 v[20:23], v124 offset:3072
    s_waitcnt lgkmcnt(5)
    v_mov_b32 v50, s50
    v_mfma_f32_16x16x32_bf16 v[56:59], v[64:67], v[40:43], v[56:59]
    ds_read_b128 v[24:27], v124 offset:4096
    s_waitcnt lgkmcnt(5)
    v_add_f32 v52, v52, v54
    v_mfma_f32_16x16x32_bf16 v[56:59], v[68:71], v[44:47], v[56:59]
    ds_read_b128 v[28:31], v124 offset:5120
    v_add_f32 v53, v53, v55
    v_mfma_f32_16x16x32_bf16 v[60:63], v[72:75], v[32:35], 0
    v_cvt_pk_bf16_f32 v114, v52, v53
    v_mfma_f32_16x16x32_bf16 v[60:63], v[76:79], v[36:39], v[60:63]
    v_exp_f32 v56, v56
    v_mfma_f32_16x16x32_bf16 v[60:63], v[80:83], v[40:43], v[60:63]
    v_exp_f32 v57, v57
    v_mfma_f32_16x16x32_bf16 v[60:63], v[84:87], v[44:47], v[60:63]
    v_exp_f32 v58, v58
    v_mfma_f32_16x16x32_bf16 v[64:67], v[32:35], v[32:35], 0
    v_exp_f32 v59, v59
    v_cvt_pk_bf16_f32 v68, v56, v57
    v_mfma_f32_16x16x32_bf16 v[64:67], v[36:39], v[36:39], v[64:67]
    v_exp_f32 v60, v60
    v_cvt_pk_bf16_f32 v69, v58, v59
    v_mfma_f32_16x16x32_bf16 v[64:67], v[40:43], v[40:43], v[64:67]
    v_exp_f32 v61, v61
    v_mfma_f32_16x16x32_bf16 v[64:67], v[44:47], v[44:47], v[64:67]
    v_exp_f32 v62, v62
    v_exp_f32 v63, v63
    v_cvt_pk_bf16_f32 v70, v60, v61
    v_cvt_pk_bf16_f32 v71, v62, v63
    v_mov_b32 v51, s50
    v_mov_b32 v53, 0
    v_mfma_f32_16x16x32_bf16 v[72:75], v[88:91], v[68:71], 0
    s_nop 0
    v_exp_f32 v64, v64
    v_mfma_f32_16x16x32_bf16 v[76:79], v[92:95], v[68:71], 0
    v_exp_f32 v65, v65
    v_mfma_f32_16x16x32_bf16 v[80:83], v[48:51], v[68:71], 0
    ds_read_b128 v[32:35], v124 offset:6144
    v_cvt_pk_bf16_f32 v52, v64, v65
    s_nop 1
    v_mfma_f32_16x16x16_bf16 v[72:75], v[112:113], v[52:53], v[72:75]
    ds_read_b128 v[36:39], v124 offset:7168
    v_mfma_f32_16x16x16_bf16 v[76:79], v[114:115], v[52:53], v[76:79]
    v_mfma_f32_16x16x16_bf16 v[80:83], v[48:49], v[52:53], v[80:83]
L_norm_66:
    s_mov_b64 vcc, s[36:37]
    s_nop 2
    v_cndmask_b32_dpp v76, v72, v76, vcc quad_perm:[2,3,2,3] row_mask:0xf bank_mask:0xf
    v_cndmask_b32_dpp v77, v73, v77, vcc quad_perm:[2,3,2,3] row_mask:0xf bank_mask:0xf
    v_cndmask_b32_dpp v78, v74, v78, vcc quad_perm:[2,3,2,3] row_mask:0xf bank_mask:0xf
    v_cndmask_b32_dpp v79, v75, v79, vcc quad_perm:[2,3,2,3] row_mask:0xf bank_mask:0xf
    v_rcp_f32_dpp v84, v80 quad_perm:[2,3,2,3] row_mask:0xf bank_mask:0xf
    s_nop 0
    v_pk_mul_f32 v[76:77], v[76:77], v[84:85] op_sel_hi:[1,0]
    v_pk_mul_f32 v[78:79], v[78:79], v[84:85] op_sel_hi:[1,0]
    v_cvt_pk_bf16_f32 v72, v76, v77
    v_cvt_pk_bf16_f32 v73, v78, v79
    ds_write_b64 v122, v[72:73] offset:4608
    v_max_f32_dpp v86, v80, v84 quad_perm:[2,3,2,3] row_mask:0xf bank_mask:0xf
    v_mov_b32_dpp v60, v72 quad_perm:[0,1,0,1] row_mask:0xf bank_mask:0xf
    v_mov_b32_dpp v61, v73 quad_perm:[0,1,0,1] row_mask:0xf bank_mask:0xf
    v_cmp_lt_f32 vcc, s35, v86
    v_mov_b32_dpp v62, v72 quad_perm:[2,3,2,3] row_mask:0xf bank_mask:0xf
    v_mov_b32_dpp v63, v73 quad_perm:[2,3,2,3] row_mask:0xf bank_mask:0xf
    s_cbranch_vccnz L_smax_67
    s_nop 0
    v_smfmac_f32_16x16x64_bf16 v[96:99], v[60:63], v[192:199], v116
    v_smfmac_f32_16x16x64_bf16 v[100:103], v[60:63], v[224:231], v116
    v_smfmac_f32_16x16x64_bf16 v[104:107], v[60:63], v[0:7], v116
    s_waitcnt lgkmcnt(0)
    s_barrier
    ds_read_b128 v[92:95], v127 offset:4096
    ds_read_b128 v[80:83], v127 offset:5632
    ds_read_b128 v[84:87], v127 offset:5120
    v_smfmac_f32_16x16x64_bf16 v[108:111], v[60:63], v[8:15], v116
    s_waitcnt lgkmcnt(2)
    v_smfmac_f32_16x16x64_bf16 v[96:99], v[92:95], v[200:207], v116
    s_waitcnt lgkmcnt(1)
    v_smfmac_f32_16x16x64_bf16 v[96:99], v[80:83], v[208:215], v116
    ds_read_b128 v[40:43], v124 offset:34816
    s_waitcnt lgkmcnt(1)
    v_smfmac_f32_16x16x64_bf16 v[96:99], v[84:87], v[216:223], v116
    ds_read_b128 v[44:47], v124 offset:35840
    v_smfmac_f32_16x16x64_bf16 v[100:103], v[92:95], v[232:239], v116
    ds_read_b128 v[56:59], v124 offset:36864
    v_smfmac_f32_16x16x64_bf16 v[100:103], v[80:83], v[240:247], v116
    ds_read_b128 v[60:63], v124 offset:37888
    v_cvt_pk_bf16_f32 v72, v96, v98
    v_smfmac_f32_16x16x64_bf16 v[100:103], v[84:87], v[248:255], v116
    ds_read_b128 v[64:67], v124 offset:38912
    v_and_or_b32 v72, v72, -2, s33
    v_smfmac_f32_16x16x64_bf16 v[104:107], v[92:95], v[16:23], v116
    ds_read_b128 v[68:71], v124 offset:39936
    v_cvt_pk_bf16_f32 v74, v97, v99
    v_smfmac_f32_16x16x64_bf16 v[104:107], v[80:83], v[24:31], v116
    v_cvt_pk_bf16_f32 v73, v100, v102
    v_cvt_pk_bf16_f32 v75, v101, v103
    v_smfmac_f32_16x16x64_bf16 v[104:107], v[84:87], v[32:39], v116
    buffer_store_dwordx4 v[72:75], v118, s[8:11], s25 offen sc1
    s_waitcnt lgkmcnt(4)
    v_smfmac_f32_16x16x64_bf16 v[108:111], v[92:95], v[40:47], v116
    s_waitcnt lgkmcnt(2)
    v_smfmac_f32_16x16x64_bf16 v[108:111], v[80:83], v[56:63], v116
    s_waitcnt lgkmcnt(0)
    v_cvt_pk_bf16_f32 v76, v104, v106
    v_smfmac_f32_16x16x64_bf16 v[108:111], v[84:87], v[64:71], v116
    v_and_or_b32 v76, v76, -2, s33
    v_cvt_pk_bf16_f32 v78, v105, v107
    s_nop 5
    v_cvt_pk_bf16_f32 v77, v108, v110
    v_cvt_pk_bf16_f32 v79, v109, v111
    buffer_store_dwordx4 v[76:79], v118, s[8:11], s26 offen sc1
    s_add_u32 s30, s30, 0x40000
    s_add_u32 s31, s31, 0x40000
    s_add_u32 s32, s32, 0x20000
    s_add_u32 s23, s24, 1024
    s_add_u32 s48, s23, 4096
    s_xor_b32 s25, s25, 0x40000
    s_xor_b32 s26, s26, 0x40000
    s_mov_b32 s35, 0x49800000
    s_mov_b32 s57, s22
    s_add_u32 s22, s22, 1
    v_xor_b32 v126, 0x6000, v126
    v_mov_b32 v32, 0
    v_mov_b32 v33, 0
    v_mov_b32 v34, 0
    v_mov_b32 v35, 0
    v_mov_b32 v36, 0
    v_mov_b32 v37, 0
    v_mov_b32 v38, 0
    v_mov_b32 v39, 0
    v_mov_b32 v40, 0
    v_mov_b32 v41, 0
    v_mov_b32 v42, 0
    v_mov_b32 v43, 0
    v_mov_b32 v44, 0
    v_mov_b32 v45, 0
    v_mov_b32 v46, 0
    v_mov_b32 v47, 0
    v_mov_b32 v48, 0
    v_mov_b32 v49, 0
    v_mov_b32 v50, 0
    v_mov_b32 v51, 0
    v_mov_b32 v52, 0
    v_mov_b32 v53, 0
    v_mov_b32 v54, 0
    v_mov_b32 v55, 0
    ds_read_b128 v[88:91], v123
    ds_read_b128 v[92:95], v123 offset:1024
    ds_read_b128 v[56:59], v123 offset:2048
    ds_read_b128 v[60:63], v123 offset:3072
    ds_read_b128 v[64:67], v123 offset:32768
    ds_read_b128 v[68:71], v123 offset:33792
    ds_read_b128 v[72:75], v123 offset:34816
    ds_read_b128 v[76:79], v123 offset:35840
    ds_read_b128 v[80:83], v123 offset:4096
    ds_read_b128 v[84:87], v123 offset:5120
    ds_read_b128 v[96:99], v123 offset:6144
    ds_read_b128 v[100:103], v123 offset:7168
    ds_read_b128 v[104:107], v123 offset:36864
    ds_read_b128 v[108:111], v123 offset:37888
    ds_read_b128 v[24:27], v123 offset:38912
    ds_read_b128 v[28:31], v123 offset:39936
    s_add_u32 s24, s24, 8192
    s_bitset0_b32 s24, 15
    s_xor_b32 s55, s24, 16384
    s_xor_b32 s29, s29, 0x40000
    s_xor_b32 s53, s29, 1024
    s_bfe_u32 s33, s22, 0x10001
    s_add_u32 s40, s22, 5
    s_lshr_b32 s40, s40, 2
    s_min_u32 s40, s40, 16
    s_bfm_b32 s58, s40, 0
    s_waitcnt vmcnt(2)
    v_cmp_eq_u32 vcc, 0, v125
    s_nop 0
    s_and_b64 vcc, vcc, s[58:59]
    s_cbranch_scc1 L_kvw_68
L_kvb_69:
    v_mov_b32 v15, 0
    s_nop 2
    v_mov_b32 v15, 0
    s_nop 2
    v_mov_b32 v15, 0
    s_nop 2
    v_mov_b32 v15, 0
    s_nop 2
    v_mov_b32 v15, 0
    s_nop 2
    v_mov_b32 v15, 0
    s_nop 2
    v_mov_b32 v15, 0
    s_nop 2
    v_mov_b32 v15, 0
    s_nop 2
    v_mov_b32 v15, 0
    s_nop 2
    v_mov_b32 v15, 0
    s_nop 2
    v_mov_b32 v15, 0
    s_nop 2
    v_mov_b32 v15, 0
    s_nop 2
    v_mov_b32 v15, 0
    s_nop 2
    v_mov_b32 v15, 0
    s_nop 2
    v_mov_b32 v15, 0
    s_nop 2
    v_mov_b32 v15, 0
    s_nop 2
    v_mov_b32 v15, 0
    s_nop 2
    v_mov_b32 v15, 0
    s_nop 2
    v_mov_b32 v15, 0
    s_nop 2
    v_mov_b32 v15, 0
    s_nop 2
    v_mov_b32 v15, 0
    s_nop 2
    v_mov_b32 v15, 0
    s_nop 2
    v_mov_b32 v15, 0
    s_nop 2
    v_mov_b32 v15, 0
    s_nop 2
    v_mov_b32 v15, 0
    s_nop 2
    v_mov_b32 v15, 0
    s_nop 2
    v_mov_b32 v15, 0
    s_nop 2
    v_mov_b32 v15, 0
    s_nop 2
    v_mov_b32 v15, 0
    s_nop 2
    v_mov_b32 v15, 0
    s_nop 2
    s_waitcnt lgkmcnt(0)
    s_branch L_chain_top1_s
.p2align 6
L_chain_top2_s:
    buffer_load_dwordx4 v[0:3], v117, s[8:11], s23 offen sc1
    v_mov_b32 v48, 0
    v_mov_b32 v49, 0
    v_mov_b32 v50, 0
    v_mov_b32 v51, 0
    v_mov_b32 v52, 0
    v_mov_b32 v53, 0
    v_mov_b32 v15, 0
    v_mov_b32 v15, 0
    v_mov_b32 v15, 0
    v_mov_b32 v15, 0
    v_mov_b32 v15, 0
    v_mov_b32 v15, 0
    v_mov_b32 v15, 0
    v_mov_b32 v15, 0
    v_mov_b32 v15, 0
    v_mov_b32 v15, 0
    buffer_load_dwordx4 v[0:3], v117, s[8:11], s23 offen sc1
    v_mov_b32 v15, 0
    v_mov_b32 v15, 0
    v_mov_b32 v15, 0
    v_mov_b32 v15, 0
    v_mov_b32 v15, 0
    v_mov_b32 v15, 0
    v_mov_b32 v15, 0
    v_mov_b32 v15, 0
    v_mov_b32 v15, 0
    v_mov_b32 v15, 0
    v_mov_b32 v15, 0
    v_mov_b32 v15, 0
    v_mov_b32 v15, 0
    v_mov_b32 v15, 0
    v_mov_b32 v15, 0
    v_mov_b32 v15, 0
L_mret_70:
    buffer_load_dwordx4 v[0:3], v117, s[8:11], s23 offen sc1
    s_add_u32 s45, s45, 1
    s_cmp_lt_u32 s45, 0x10000
    s_cselect_b32 s56, -2, -1
    s_waitcnt vmcnt(2)
    v_max3_u32 v15, v0, v1, v2
    v_max_u32 v15, v15, v3
    v_cmp_lt_u32 vcc, s56, v15
    s_cbranch_vccnz L_mret_70
    v_smfmac_f32_16x16x64_bf16 v[32:35], v[0:3], v[88:95], v116
    ds_write_b128 v117, v[0:3] offset:2048
    v_smfmac_f32_16x16x64_bf16 v[36:39], v[0:3], v[56:63], v116
    buffer_load_dwordx4 v[4:7], v117, s[8:11], s48 offen sc1
    v_smfmac_f32_16x16x64_bf16 v[40:43], v[0:3], v[64:71], v116
    buffer_load_dwordx4 v117, s[8:11], s48 offen sc1 lds
    s_mov_b32 m0, s27
    v_smfmac_f32_16x16x64_bf16 v[44:47], v[0:3], v[72:79], v116
    s_waitcnt lgkmcnt(0)
    s_barrier
    v_smfmac_f32_16x16x64_bf16 v[48:51], v[0:3], a[192:199], v116
    ds_read_b128 v[8:11], v117 offset:3072
    ds_read_b128 v[16:19], v117
    ds_read_b128 v[20:23], v117 offset:1024
    v_smfmac_f32_16x16x64_bf16 v[52:55], v[0:3], a[200:207], v116
    ds_read_b128 v[88:91], v117 offset:28672
    ds_read_b128 v[92:95], v117 offset:29696
    s_waitcnt lgkmcnt(4)
    v_smfmac_f32_16x16x64_bf16 v[32:35], v[8:11], a[0:7], v116
    ds_read_b128 v[56:59], v126
    v_smfmac_f32_16x16x64_bf16 v[36:39], v[8:11], a[8:15], v116
    ds_read_b128 v[60:63], v126 offset:1024
    s_waitcnt lgkmcnt(5)
    v_smfmac_f32_16x16x64_bf16 v[32:35], v[16:19], a[32:39], v116
    ds_read_b128 v[64:67], v126 offset:2048
    v_smfmac_f32_16x16x64_bf16 v[36:39], v[16:19], a[40:47], v116
    ds_read_b128 v[68:71], v126 offset:3072
    s_waitcnt lgkmcnt(6)
    v_smfmac_f32_16x16x64_bf16 v[32:35], v[20:23], a[64:71], v116
    ds_read_b128 v[72:75], v126 offset:4096
    v_smfmac_f32_16x16x64_bf16 v[36:39], v[20:23], a[72:79], v116
    ds_read_b128 v[76:79], v126 offset:5120
    v_smfmac_f32_16x16x64_bf16 v[40:43], v[8:11], a[96:103], v116
    v_smfmac_f32_16x16x64_bf16 v[40:43], v[16:19], a[128:135], v116
    v_smfmac_f32_16x16x64_bf16 v[40:43], v[20:23], a[160:167], v116
    v_smfmac_f32_16x16x64_bf16 v[44:47], v[8:11], a[104:111], v116
    s_waitcnt vmcnt(1)
    v_max3_u32 v15, v4, v5, v6
    v_max_u32 v15, v15, v7
    v_smfmac_f32_16x16x64_bf16 v[44:47], v[16:19], a[136:143], v116
    v_cmp_lt_u32 vcc, s56, v15
    s_cbranch_vccnz L_mret_71
L_mgo_72:
    s_waitcnt vmcnt(0)
    s_barrier
    v_smfmac_f32_16x16x64_bf16 v[44:47], v[4:7], v[24:31], v116
    ds_read_b128 v[12:15], v117 offset:7168
    ds_read_b128 v[24:27], v117 offset:4096
    v_smfmac_f32_16x16x64_bf16 v[32:35], v[4:7], v[80:87], v116
    ds_read_b128 v[28:31], v117 offset:5120
    v_smfmac_f32_16x16x64_bf16 v[36:39], v[4:7], v[96:103], v116
    buffer_load_dwordx4 v117, s[8:11], s30 offen lds
    s_xor_b32 s27, s27, 0x6000
    v_smfmac_f32_16x16x64_bf16 v[40:43], v[4:7], v[104:111], v116
    buffer_load_dwordx4 v117, s[8:11], s30 offen offset:1024 lds
    s_add_u32 m0, s52, 0x6000
    v_mov_b32 v96, 0
    v_smfmac_f32_16x16x64_bf16 v[48:51], v[4:7], a[208:215], v116
    s_waitcnt lgkmcnt(9)
    buffer_load_dwordx4 v117, s[8:11], s31 offen lds
    v_mov_b32 v97, 0
    v_smfmac_f32_16x16x64_bf16 v[52:55], v[4:7], a[216:223], v116
    buffer_load_dwordx4 v117, s[8:11], s31 offen offset:1024 lds
    s_mov_b32 m0, 6144
    s_waitcnt lgkmcnt(2)
    v_mov_b32 v98, 0
    v_smfmac_f32_16x16x64_bf16 v[32:35], v[12:15], a[16:23], v116
    buffer_store_dwordx4 v[112:115], v117, s[8:11], s32 offen sc1
    s_waitcnt lgkmcnt(1)
    v_mov_b32 v99, 0
    v_smfmac_f32_16x16x64_bf16 v[32:35], v[24:27], a[48:55], v116
    ds_read_b128 v[80:83], v126 offset:6144
    s_waitcnt lgkmcnt(1)
    v_mov_b32 v100, 0
    v_smfmac_f32_16x16x64_bf16 v[32:35], v[28:31], a[80:87], v116
    ds_read_b128 v[84:87], v126 offset:7168
    v_mov_b32 v101, 0
    v_smfmac_f32_16x16x64_bf16 v[36:39], v[12:15], a[24:31], v116
    ds_read_b128 v[0:3], v124
    v_mov_b32 v102, 0
    v_smfmac_f32_16x16x64_bf16 v[36:39], v[24:27], a[56:63], v116
    ds_read_b128 v[4:7], v124 offset:1024
    v_add_f32 v32, v32, v34
    v_add_f32 v33, v33, v35
    v_smfmac_f32_16x16x64_bf16 v[36:39], v[28:31], a[88:95], v116
    v_mul_f32 v32, s34, v32
    v_mul_f32 v33, s34, v33
    v_smfmac_f32_16x16x64_bf16 v[40:43], v[12:15], a[112:119], v116
    v_mov_b32 v103, 0
    v_smfmac_f32_16x16x64_bf16 v[40:43], v[24:27], a[144:151], v116
    v_add_f32 v36, v36, v38
    v_add_f32 v37, v37, v39
    v_smfmac_f32_16x16x64_bf16 v[40:43], v[28:31], a[176:183], v116
    v_mul_f32 v36, s34, v36
    v_smfmac_f32_16x16x64_bf16 v[44:47], v[20:23], a[168:175], v116
    v_mul_f32 v37, s34, v37
    v_smfmac_f32_16x16x64_bf16 v[44:47], v[12:15], a[120:127], v116
    v_cvt_pk_bf16_f32 v34, v32, v36
    v_smfmac_f32_16x16x64_bf16 v[44:47], v[24:27], a[152:159], v116
    v_cvt_pk_bf16_f32 v35, v33, v37
    v_smfmac_f32_16x16x64_bf16 v[44:47], v[28:31], a[184:191], v116
    ds_write2_b32 v120, v34, v35 offset0:32 offset1:48
    v_add_f32 v40, v40, v42
    v_smfmac_f32_16x16x64_bf16 v[48:51], v[8:11], a[224:231], v116
    v_add_f32 v41, v41, v43
    v_smfmac_f32_16x16x64_bf16 v[52:55], v[8:11], a[232:239], v116
    v_add_f32 v44, v44, v46
    v_add_f32 v45, v45, v47
    v_cvt_pk_bf16_f32 v113, v40, v44
    v_cvt_pk_bf16_f32 v115, v41, v45
    v_smfmac_f32_16x16x64_bf16 v[48:51], v[12:15], a[240:247], v116
    ds_write2_b32 v120, v113, v115 offset0:0 offset1:16
    v_mov_b32 v36, -1
    v_smfmac_f32_16x16x64_bf16 v[52:55], v[12:15], a[248:255], v116
    v_mov_b32 v104, 0
    v_smfmac_f32_16x16x64_bf16 v[48:51], v[16:19], v[128:135], v116
    buffer_store_dword v36, v119, s[8:11], s55 offen sc1
    v_mov_b32 v105, 0
    v_smfmac_f32_16x16x64_bf16 v[48:51], v[20:23], v[160:167], v116
    v_mov_b32 v106, 0
    v_smfmac_f32_16x16x64_bf16 v[48:51], v[24:27], v[144:151], v116
    s_cmp_eq_u32 s22, 63
    s_waitcnt lgkmcnt(0)
    s_barrier
    s_cbranch_scc1 L_chain_last_s
    ds_read_b128 v[32:35], v121
    v_smfmac_f32_16x16x64_bf16 v[48:51], v[28:31], v[176:183], v116
    ds_read_b128 v[36:39], v121 offset:1024
    ds_read_b128 v[40:43], v121 offset:2048
    v_mov_b32 v107, 0
    v_smfmac_f32_16x16x64_bf16 v[52:55], v[16:19], v[136:143], v116
    ds_read_b128 v[44:47], v121 offset:3072
    v_mov_b32 v108, 0
    v_smfmac_f32_16x16x64_bf16 v[52:55], v[20:23], v[168:175], v116
    ds_read_b128 v[8:11], v124 offset:32768
    v_add_f32 v48, v48, v50
    v_smfmac_f32_16x16x64_bf16 v[52:55], v[24:27], v[152:159], v116
    ds_read_b128 v[12:15], v124 offset:33792
    v_add_f32 v49, v49, v51
    v_smfmac_f32_16x16x64_bf16 v[52:55], v[28:31], v[184:191], v116
    ds_read_b128 v[16:19], v124 offset:2048
    s_waitcnt lgkmcnt(6)
    v_cvt_pk_bf16_f32 v112, v48, v49
    v_mov_b32 v109, 0
    v_mov_b32 v110, 0
    v_mov_b32 v111, 0
    v_mfma_f32_16x16x32_bf16 v[56:59], v[56:59], v[32:35], 0
    s_waitcnt lgkmcnt(5)
    v_mov_b32 v48, s50
    v_mov_b32 v49, s50
    v_mfma_f32_16x16x32_bf16 v[56:59], v[60:63], v[36:39], v[56:59]
    ds_read_b128 v[20:23], v124 offset:3072
    s_waitcnt lgkmcnt(5)
    v_mov_b32 v50, s50
    v_mfma_f32_16x16x32_bf16 v[56:59], v[64:67], v[40:43], v[56:59]
    ds_read_b128 v[24:27], v124 offset:4096
    s_waitcnt lgkmcnt(5)
    v_add_f32 v52, v52, v54
    v_mfma_f32_16x16x32_bf16 v[56:59], v[68:71], v[44:47], v[56:59]
    ds_read_b128 v[28:31], v124 offset:5120
    v_add_f32 v53, v53, v55
    v_mfma_f32_16x16x32_bf16 v[60:63], v[72:75], v[32:35], 0
    v_cvt_pk_bf16_f32 v114, v52, v53
    v_mfma_f32_16x16x32_bf16 v[60:63], v[76:79], v[36:39], v[60:63]
    v_exp_f32 v56, v56
    v_mfma_f32_16x16x32_bf16 v[60:63], v[80:83], v[40:43], v[60:63]
    v_exp_f32 v57, v57
    v_mfma_f32_16x16x32_bf16 v[60:63], v[84:87], v[44:47], v[60:63]
    v_exp_f32 v58, v58
    v_mfma_f32_16x16x32_bf16 v[64:67], v[32:35], v[32:35], 0
    v_exp_f32 v59, v59
    v_cvt_pk_bf16_f32 v68, v56, v57
    v_mfma_f32_16x16x32_bf16 v[64:67], v[36:39], v[36:39], v[64:67]
    v_exp_f32 v60, v60
    v_cvt_pk_bf16_f32 v69, v58, v59
    v_mfma_f32_16x16x32_bf16 v[64:67], v[40:43], v[40:43], v[64:67]
    v_exp_f32 v61, v61
    v_mfma_f32_16x16x32_bf16 v[64:67], v[44:47], v[44:47], v[64:67]
    v_exp_f32 v62, v62
    v_exp_f32 v63, v63
    v_cvt_pk_bf16_f32 v70, v60, v61
    v_cvt_pk_bf16_f32 v71, v62, v63
    v_mov_b32 v51, s50
    v_mov_b32 v53, 0
    v_mfma_f32_16x16x32_bf16 v[72:75], v[88:91], v[68:71], 0
    s_nop 0
    v_exp_f32 v64, v64
    v_mfma_f32_16x16x32_bf16 v[76:79], v[92:95], v[68:71], 0
    v_exp_f32 v65, v65
    v_mfma_f32_16x16x32_bf16 v[80:83], v[48:51], v[68:71], 0
    ds_read_b128 v[32:35], v124 offset:6144
    v_cvt_pk_bf16_f32 v52, v64, v65
    s_nop 1
    v_mfma_f32_16x16x16_bf16 v[72:75], v[112:113], v[52:53], v[72:75]
    ds_read_b128 v[36:39], v124 offset:7168
    v_mfma_f32_16x16x16_bf16 v[76:79], v[114:115], v[52:53], v[76:79]
    v_mfma_f32_16x16x16_bf16 v[80:83], v[48:49], v[52:53], v[80:83]
L_norm_73:
    s_mov_b64 vcc, s[36:37]
    s_nop 2
    v_cndmask_b32_dpp v76, v72, v76, vcc quad_perm:[2,3,2,3] row_mask:0xf bank_mask:0xf
    v_cndmask_b32_dpp v77, v73, v77, vcc quad_perm:[2,3,2,3] row_mask:0xf bank_mask:0xf
    v_cndmask_b32_dpp v78, v74, v78, vcc quad_perm:[2,3,2,3] row_mask:0xf bank_mask:0xf
    v_cndmask_b32_dpp v79, v75, v79, vcc quad_perm:[2,3,2,3] row_mask:0xf bank_mask:0xf
    v_rcp_f32_dpp v84, v80 quad_perm:[2,3,2,3] row_mask:0xf bank_mask:0xf
    s_nop 0
    v_pk_mul_f32 v[76:77], v[76:77], v[84:85] op_sel_hi:[1,0]
    v_pk_mul_f32 v[78:79], v[78:79], v[84:85] op_sel_hi:[1,0]
    v_cvt_pk_bf16_f32 v72, v76, v77
    v_cvt_pk_bf16_f32 v73, v78, v79
    ds_write_b64 v122, v[72:73] offset:5120
    v_max_f32_dpp v86, v80, v84 quad_perm:[2,3,2,3] row_mask:0xf bank_mask:0xf
    v_mov_b32_dpp v60, v72 quad_perm:[0,1,0,1] row_mask:0xf bank_mask:0xf
    v_mov_b32_dpp v61, v73 quad_perm:[0,1,0,1] row_mask:0xf bank_mask:0xf
    v_cmp_lt_f32 vcc, s35, v86
    v_mov_b32_dpp v62, v72 quad_perm:[2,3,2,3] row_mask:0xf bank_mask:0xf
    v_mov_b32_dpp v63, v73 quad_perm:[2,3,2,3] row_mask:0xf bank_mask:0xf
    s_cbranch_vccnz L_smax_74
    s_nop 0
    v_smfmac_f32_16x16x64_bf16 v[96:99], v[60:63], v[192:199], v116
    v_smfmac_f32_16x16x64_bf16 v[100:103], v[60:63], v[224:231], v116
    v_smfmac_f32_16x16x64_bf16 v[104:107], v[60:63], v[0:7], v116
    s_waitcnt lgkmcnt(0)
    s_barrier
    ds_read_b128 v[92:95], v127 offset:5632
    ds_read_b128 v[80:83], v127 offset:4096
    ds_read_b128 v[84:87], v127 offset:4608
    v_smfmac_f32_16x16x64_bf16 v[108:111], v[60:63], v[8:15], v116
    s_waitcnt lgkmcnt(2)
    v_smfmac_f32_16x16x64_bf16 v[96:99], v[92:95], v[200:207], v116
    s_waitcnt lgkmcnt(1)
    v_smfmac_f32_16x16x64_bf16 v[96:99], v[80:83], v[208:215], v116
    ds_read_b128 v[40:43], v124 offset:34816
    s_waitcnt lgkmcnt(1)
    v_smfmac_f32_16x16x64_bf16 v[96:99], v[84:87], v[216:223], v116
    ds_read_b128 v[44:47], v124 offset:35840
    v_smfmac_f32_16x16x64_bf16 v[100:103], v[92:95], v[232:239], v116
    ds_read_b128 v[56:59], v124 offset:36864
    v_smfmac_f32_16x16x64_bf16 v[100:103], v[80:83], v[240:247], v116
    ds_read_b128 v[60:63], v124 offset:37888
    v_cvt_pk_bf16_f32 v72, v96, v98
    v_smfmac_f32_16x16x64_bf16 v[100:103], v[84:87], v[248:255], v116
    ds_read_b128 v[64:67], v124 offset:38912
    v_and_or_b32 v72, v72, -2, s33
    v_smfmac_f32_16x16x64_bf16 v[104:107], v[92:95], v[16:23], v116
    ds_read_b128 v[68:71], v124 offset:39936
    v_cvt_pk_bf16_f32 v74, v97, v99
    v_smfmac_f32_16x16x64_bf16 v[104:107], v[80:83], v[24:31], v116
    v_cvt_pk_bf16_f32 v73, v100, v102
    v_cvt_pk_bf16_f32 v75, v101, v103
    v_smfmac_f32_16x16x64_bf16 v[104:107], v[84:87], v[32:39], v116
    buffer_store_dwordx4 v[72:75], v118, s[8:11], s25 offen sc1
    s_waitcnt lgkmcnt(4)
    v_smfmac_f32_16x16x64_bf16 v[108:111], v[92:95], v[40:47], v116
    s_waitcnt lgkmcnt(2)
    v_smfmac_f32_16x16x64_bf16 v[108:111], v[80:83], v[56:63], v116
    s_waitcnt lgkmcnt(0)
    v_cvt_pk_bf16_f32 v76, v104, v106
    v_smfmac_f32_16x16x64_bf16 v[108:111], v[84:87], v[64:71], v116
    v_and_or_b32 v76, v76, -2, s33
    v_cvt_pk_bf16_f32 v78, v105, v107
    s_nop 5
    v_cvt_pk_bf16_f32 v77, v108, v110
    v_cvt_pk_bf16_f32 v79, v109, v111
    buffer_store_dwordx4 v[76:79], v118, s[8:11], s26 offen sc1
    ds_read_b128 v[88:91], v123
    ds_read_b128 v[92:95], v123 offset:1024
    ds_read_b128 v[56:59], v123 offset:2048
    ds_read_b128 v[60:63], v123 offset:3072
    ds_read_b128 v[64:67], v123 offset:32768
    ds_read_b128 v[68:71], v123 offset:33792
    ds_read_b128 v[72:75], v123 offset:34816
    ds_read_b128 v[76:79], v123 offset:35840
    ds_read_b128 v[80:83], v123 offset:4096
    ds_read_b128 v[84:87], v123 offset:5120
    ds_read_b128 v[96:99], v123 offset:6144
    ds_read_b128 v[100:103], v123 offset:7168
    ds_read_b128 v[104:107], v123 offset:36864
    ds_read_b128 v[108:111], v123 offset:37888
    ds_read_b128 v[24:27], v123 offset:38912
    ds_read_b128 v[28:31], v123 offset:39936
    s_add_u32 s30, s30, 0x40000
    s_add_u32 s31, s31, 0x40000
    s_add_u32 s32, s32, 0x20000
    s_add_u32 s23, s24, 2048
    s_add_u32 s48, s23, 4096
    s_xor_b32 s25, s25, 0x40000
    s_xor_b32 s26, s26, 0x40000
    s_mov_b32 s35, 0x49800000
    s_mov_b32 s57, s22
    s_add_u32 s22, s22, 1
    v_xor_b32 v126, 0x6000, v126
    v_cndmask_b32 v12, 0, v125, s[68:69]
    v_cndmask_b32 v13, 0, v125, s[70:71]
    v_cndmask_b32 v14, 0, v125, s[72:73]
    v_cndmask_b32 v15, 0, v125, s[74:75]
    v_mov_b32 v32, 0
    v_mov_b32 v33, 0
    v_mov_b32 v34, 0
    v_mov_b32 v35, 0
    v_mov_b32 v36, 0
    v_mov_b32 v37, 0
    v_mov_b32 v38, 0
    v_mov_b32 v39, 0
    v_mov_b32 v40, 0
    v_mov_b32 v41, 0
    v_mov_b32 v42, 0
    v_mov_b32 v43, 0
    v_mov_b32 v44, 0
    v_mov_b32 v45, 0
    v_mov_b32 v46, 0
    v_mov_b32 v47, 0
    v_mov_b32 v54, 0
    v_mov_b32 v55, 0
    v_mov_b32 v52, 0
    v_mov_b32 v52, 0
    v_mov_b32 v52, 0
    v_mov_b32 v52, 0
    v_mov_b32 v52, 0
    v_mov_b32 v52, 0
    buffer_load_dwordx4 v[4:7], v117, s[8:11], s29 offen sc1
    buffer_load_dwordx4 v[8:11], v117, s[8:11], s53 offen sc1
    buffer_load_dwordx4 v[16:19], v117, s[8:11], s29 offen offset:2048 sc1
    buffer_load_dwordx4 v[20:23], v117, s[8:11], s53 offen offset:2048 sc1
    v_mov_b32 v52, 0
    s_waitcnt vmcnt(3)
L_rl_75:
    v_mfma_f32_16x16x32_bf16 v[48:51], v[4:7], v[12:15], 0
    v_xor_b32 v52, s33, v4
    s_waitcnt vmcnt(2)
    v_mfma_f32_16x16x32_bf16 v[48:51], v[8:11], v[12:15], v[48:51]
    v_xor_b32 v53, s33, v8
    v_or_b32 v52, v52, v53
    s_waitcnt vmcnt(1)
    v_mfma_f32_16x16x32_bf16 v[48:51], v[16:19], v[12:15], v[48:51]
    v_xor_b32 v53, s33, v16
    v_or_b32 v52, v52, v53
    s_waitcnt vmcnt(0)
    v_mfma_f32_16x16x32_bf16 v[48:51], v[20:23], v[12:15], v[48:51]
    v_xor_b32 v53, s33, v20
    v_or_b32 v52, v52, v53
    v_and_b32 v52, 1, v52
    v_cmp_ne_u32 vcc, 0, v52
    s_cbranch_vccnz L_rslow_76
L_rgo_77:
    s_nop 2
    v_permlane32_swap_b32 v48, v50
    v_permlane32_swap_b32 v49, v51
    v_pk_add_f32 v[48:49], v[48:49], v[50:51]
    s_mov_b64 exec, s[38:39]
    v_cvt_pk_bf16_f32 v12, v48, v49
    v_min_u32 v12, 0xfffffffe, v12
    buffer_store_dword v12, v119, s[8:11], s24 offen sc1
    s_mov_b64 exec, -1
    s_add_u32 s24, s24, 8192
    s_bitset0_b32 s24, 15
    s_xor_b32 s55, s24, 16384
    s_xor_b32 s29, s29, 0x40000
    s_xor_b32 s53, s29, 1024
    s_bfe_u32 s33, s22, 0x10001
    s_waitcnt lgkmcnt(0)
    s_branch L_chain_top2_s
.p2align 6
L_chain_top3_s:
    buffer_load_dwordx4 v[0:3], v117, s[8:11], s23 offen sc1
    v_mov_b32 v48, 0
    v_mov_b32 v49, 0
    v_mov_b32 v50, 0
    v_mov_b32 v51, 0
    v_mov_b32 v52, 0
    v_mov_b32 v53, 0
    v_mov_b32 v15, 0
    v_mov_b32 v15, 0
    v_mov_b32 v15, 0
    v_mov_b32 v15, 0
    v_mov_b32 v15, 0
    v_mov_b32 v15, 0
    v_mov_b32 v15, 0
    v_mov_b32 v15, 0
    v_mov_b32 v15, 0
    v_mov_b32 v15, 0
    buffer_load_dwordx4 v[0:3], v117, s[8:11], s23 offen sc1
    v_mov_b32 v15, 0
    v_mov_b32 v15, 0
    v_mov_b32 v15, 0
    v_mov_b32 v15, 0
    v_mov_b32 v15, 0
    v_mov_b32 v15, 0
    v_mov_b32 v15, 0
    v_mov_b32 v15, 0
    v_mov_b32 v15, 0
    v_mov_b32 v15, 0
    v_mov_b32 v15, 0
    v_mov_b32 v15, 0
    v_mov_b32 v15, 0
    v_mov_b32 v15, 0
    v_mov_b32 v15, 0
    v_mov_b32 v15, 0
L_mret_78:
    buffer_load_dwordx4 v[0:3], v117, s[8:11], s23 offen sc1
    s_add_u32 s45, s45, 1
    s_cmp_lt_u32 s45, 0x10000
    s_cselect_b32 s56, -2, -1
    s_waitcnt vmcnt(2)
    v_max3_u32 v15, v0, v1, v2
    v_max_u32 v15, v15, v3
    v_cmp_lt_u32 vcc, s56, v15
    s_cbranch_vccnz L_mret_78
    v_smfmac_f32_16x16x64_bf16 v[32:35], v[0:3], v[88:95], v116
    ds_write_b128 v117, v[0:3] offset:3072
    v_smfmac_f32_16x16x64_bf16 v[36:39], v[0:3], v[56:63], v116
    buffer_load_dwordx4 v[4:7], v117, s[8:11], s48 offen sc1
    v_smfmac_f32_16x16x64_bf16 v[40:43], v[0:3], v[64:71], v116
    buffer_load_dwordx4 v117, s[8:11], s48 offen sc1 lds
    s_mov_b32 m0, s27
    v_smfmac_f32_16x16x64_bf16 v[44:47], v[0:3], v[72:79], v116
    s_waitcnt lgkmcnt(0)
    s_barrier
    v_smfmac_f32_16x16x64_bf16 v[48:51], v[0:3], a[192:199], v116
    ds_read_b128 v[8:11], v117 offset:2048
    ds_read_b128 v[16:19], v117 offset:1024
    ds_read_b128 v[20:23], v117
    v_smfmac_f32_16x16x64_bf16 v[52:55], v[0:3], a[200:207], v116
    ds_read_b128 v[88:91], v117 offset:30720
    ds_read_b128 v[92:95], v117 offset:31744
    s_waitcnt lgkmcnt(4)
    v_smfmac_f32_16x16x64_bf16 v[32:35], v[8:11], a[0:7], v116
    ds_read_b128 v[56:59], v126
    v_smfmac_f32_16x16x64_bf16 v[36:39], v[8:11], a[8:15], v116
    ds_read_b128 v[60:63], v126 offset:1024
    s_waitcnt lgkmcnt(5)
    v_smfmac_f32_16x16x64_bf16 v[32:35], v[16:19], a[32:39], v116
    ds_read_b128 v[64:67], v126 offset:2048
    v_smfmac_f32_16x16x64_bf16 v[36:39], v[16:19], a[40:47], v116
    ds_read_b128 v[68:71], v126 offset:3072
    s_waitcnt lgkmcnt(6)
    v_smfmac_f32_16x16x64_bf16 v[32:35], v[20:23], a[64:71], v116
    ds_read_b128 v[72:75], v126 offset:4096
    v_smfmac_f32_16x16x64_bf16 v[36:39], v[20:23], a[72:79], v116
    ds_read_b128 v[76:79], v126 offset:5120
    v_smfmac_f32_16x16x64_bf16 v[40:43], v[8:11], a[96:103], v116
    v_smfmac_f32_16x16x64_bf16 v[40:43], v[16:19], a[128:135], v116
    v_smfmac_f32_16x16x64_bf16 v[40:43], v[20:23], a[160:167], v116
    v_smfmac_f32_16x16x64_bf16 v[44:47], v[8:11], a[104:111], v116
    s_waitcnt vmcnt(1)
    v_max3_u32 v15, v4, v5, v6
    v_max_u32 v15, v15, v7
    v_smfmac_f32_16x16x64_bf16 v[44:47], v[16:19], a[136:143], v116
    v_cmp_lt_u32 vcc, s56, v15
    s_cbranch_vccnz L_mret_79
L_mgo_80:
    s_waitcnt vmcnt(0)
    s_barrier
    v_smfmac_f32_16x16x64_bf16 v[44:47], v[4:7], v[24:31], v116
    ds_read_b128 v[12:15], v117 offset:6144
    ds_read_b128 v[24:27], v117 offset:5120
    v_smfmac_f32_16x16x64_bf16 v[32:35], v[4:7], v[80:87], v116
    ds_read_b128 v[28:31], v117 offset:4096
    v_smfmac_f32_16x16x64_bf16 v[36:39], v[4:7], v[96:103], v116
    buffer_load_dwordx4 v117, s[8:11], s30 offen lds
    s_xor_b32 s27, s27, 0x6000
    v_smfmac_f32_16x16x64_bf16 v[40:43], v[4:7], v[104:111], v116
    buffer_load_dwordx4 v117, s[8:11], s30 offen offset:1024 lds
    s_add_u32 m0, s52, 0x6000
    v_mov_b32 v96, 0
    v_smfmac_f32_16x16x64_bf16 v[48:51], v[4:7], a[208:215], v116
    s_waitcnt lgkmcnt(9)
    buffer_load_dwordx4 v117, s[8:11], s31 offen lds
    v_mov_b32 v97, 0
    v_smfmac_f32_16x16x64_bf16 v[52:55], v[4:7], a[216:223], v116
    buffer_load_dwordx4 v117, s[8:11], s31 offen offset:1024 lds
    s_mov_b32 m0, 7168
    s_waitcnt lgkmcnt(2)
    v_mov_b32 v98, 0
    v_smfmac_f32_16x16x64_bf16 v[32:35], v[12:15], a[16:23], v116
    buffer_store_dwordx4 v[112:115], v117, s[8:11], s32 offen sc1
    s_waitcnt lgkmcnt(1)
    v_mov_b32 v99, 0
    v_smfmac_f32_16x16x64_bf16 v[32:35], v[24:27], a[48:55], v116
    ds_read_b128 v[80:83], v126 offset:6144
    s_waitcnt lgkmcnt(1)
    v_mov_b32 v100, 0
    v_smfmac_f32_16x16x64_bf16 v[32:35], v[28:31], a[80:87], v116
    ds_read_b128 v[84:87], v126 offset:7168
    v_mov_b32 v101, 0
    v_smfmac_f32_16x16x64_bf16 v[36:39], v[12:15], a[24:31], v116
    ds_read_b128 v[0:3], v124
    v_mov_b32 v102, 0
    v_smfmac_f32_16x16x64_bf16 v[36:39], v[24:27], a[56:63], v116
    ds_read_b128 v[4:7], v124 offset:1024
    v_add_f32 v32, v32, v34
    v_add_f32 v33, v33, v35
    v_smfmac_f32_16x16x64_bf16 v[36:39], v[28:31], a[88:95], v116
    v_mul_f32 v32, s34, v32
    v_mul_f32 v33, s34, v33
    v_smfmac_f32_16x16x64_bf16 v[40:43], v[12:15], a[112:119], v116
    v_mov_b32 v103, 0
    v_smfmac_f32_16x16x64_bf16 v[40:43], v[24:27], a[144:151], v116
    v_add_f32 v36, v36, v38
    v_add_f32 v37, v37, v39
    v_smfmac_f32_16x16x64_bf16 v[40:43], v[28:31], a[176:183], v116
    v_mul_f32 v36, s34, v36
    v_smfmac_f32_16x16x64_bf16 v[44:47], v[20:23], a[168:175], v116
    v_mul_f32 v37, s34, v37
    v_smfmac_f32_16x16x64_bf16 v[44:47], v[12:15], a[120:127], v116
    v_cvt_pk_bf16_f32 v34, v32, v36
    v_smfmac_f32_16x16x64_bf16 v[44:47], v[24:27], a[152:159], v116
    v_cvt_pk_bf16_f32 v35, v33, v37
    v_smfmac_f32_16x16x64_bf16 v[44:47], v[28:31], a[184:191], v116
    ds_write2_b32 v120, v34, v35 offset0:32 offset1:48
    v_add_f32 v40, v40, v42
    v_smfmac_f32_16x16x64_bf16 v[48:51], v[8:11], a[224:231], v116
    v_add_f32 v41, v41, v43
    v_smfmac_f32_16x16x64_bf16 v[52:55], v[8:11], a[232:239], v116
    v_add_f32 v44, v44, v46
    v_add_f32 v45, v45, v47
    v_cvt_pk_bf16_f32 v113, v40, v44
    v_cvt_pk_bf16_f32 v115, v41, v45
    v_smfmac_f32_16x16x64_bf16 v[48:51], v[12:15], a[240:247], v116
    ds_write2_b32 v120, v113, v115 offset0:0 offset1:16
    v_mov_b32 v36, -1
    v_smfmac_f32_16x16x64_bf16 v[52:55], v[12:15], a[248:255], v116
    v_mov_b32 v104, 0
    v_smfmac_f32_16x16x64_bf16 v[48:51], v[16:19], v[128:135], v116
    v_mov_b32 v105, 0
    v_smfmac_f32_16x16x64_bf16 v[48:51], v[20:23], v[160:167], v116
    buffer_store_dword v36, v119, s[8:11], s55 offen sc1
    v_mov_b32 v106, 0
    v_smfmac_f32_16x16x64_bf16 v[48:51], v[24:27], v[144:151], v116
    s_cmp_eq_u32 s22, 63
    s_waitcnt lgkmcnt(0)
    s_barrier
    s_cbranch_scc1 L_chain_last_s
    ds_read_b128 v[32:35], v121
    v_smfmac_f32_16x16x64_bf16 v[48:51], v[28:31], v[176:183], v116
    ds_read_b128 v[36:39], v121 offset:1024
    ds_read_b128 v[40:43], v121 offset:2048
    v_mov_b32 v107, 0
    v_smfmac_f32_16x16x64_bf16 v[52:55], v[16:19], v[136:143], v116
    ds_read_b128 v[44:47], v121 offset:3072
    v_mov_b32 v108, 0
    v_smfmac_f32_16x16x64_bf16 v[52:55], v[20:23], v[168:175], v116
    ds_read_b128 v[8:11], v124 offset:32768
    v_add_f32 v48, v48, v50
    v_smfmac_f32_16x16x64_bf16 v[52:55], v[24:27], v[152:159], v116
    ds_read_b128 v[12:15], v124 offset:33792
    v_add_f32 v49, v49, v51
    v_smfmac_f32_16x16x64_bf16 v[52:55], v[28:31], v[184:191], v116
    ds_read_b128 v[16:19], v124 offset:2048
    s_waitcnt lgkmcnt(6)
    v_cvt_pk_bf16_f32 v112, v48, v49
    v_mov_b32 v109, 0
    v_mov_b32 v110, 0
    v_mov_b32 v111, 0
    v_mfma_f32_16x16x32_bf16 v[56:59], v[56:59], v[32:35], 0
    s_waitcnt lgkmcnt(5)
    v_mov_b32 v48, s50
    v_mov_b32 v49, s50
    v_mfma_f32_16x16x32_bf16 v[56:59], v[60:63], v[36:39], v[56:59]
    ds_read_b128 v[20:23], v124 offset:3072
    s_waitcnt lgkmcnt(5)
    v_mov_b32 v50, s50
    v_mfma_f32_16x16x32_bf16 v[56:59], v[64:67], v[40:43], v[56:59]
    ds_read_b128 v[24:27], v124 offset:4096
    s_waitcnt lgkmcnt(5)
    v_add_f32 v52, v52, v54
    v_mfma_f32_16x16x32_bf16 v[56:59], v[68:71], v[44:47], v[56:59]
    ds_read_b128 v[28:31], v124 offset:5120
    v_add_f32 v53, v53, v55
    v_mfma_f32_16x16x32_bf16 v[60:63], v[72:75], v[32:35], 0
    v_cvt_pk_bf16_f32 v114, v52, v53
    v_mfma_f32_16x16x32_bf16 v[60:63], v[76:79], v[36:39], v[60:63]
    v_exp_f32 v56, v56
    v_mfma_f32_16x16x32_bf16 v[60:63], v[80:83], v[40:43], v[60:63]
    v_exp_f32 v57, v57
    v_mfma_f32_16x16x32_bf16 v[60:63], v[84:87], v[44:47], v[60:63]
    v_exp_f32 v58, v58
    v_mfma_f32_16x16x32_bf16 v[64:67], v[32:35], v[32:35], 0
    v_exp_f32 v59, v59
    v_cvt_pk_bf16_f32 v68, v56, v57
    v_mfma_f32_16x16x32_bf16 v[64:67], v[36:39], v[36:39], v[64:67]
    v_exp_f32 v60, v60
    v_cvt_pk_bf16_f32 v69, v58, v59
    v_mfma_f32_16x16x32_bf16 v[64:67], v[40:43], v[40:43], v[64:67]
    v_exp_f32 v61, v61
    v_mfma_f32_16x16x32_bf16 v[64:67], v[44:47], v[44:47], v[64:67]
    v_exp_f32 v62, v62
    v_exp_f32 v63, v63
    v_cvt_pk_bf16_f32 v70, v60, v61
    v_cvt_pk_bf16_f32 v71, v62, v63
    v_mov_b32 v51, s50
    v_mov_b32 v53, 0
    v_mfma_f32_16x16x32_bf16 v[72:75], v[88:91], v[68:71], 0
    s_nop 0
    v_exp_f32 v64, v64
    v_mfma_f32_16x16x32_bf16 v[76:79], v[92:95], v[68:71], 0
    v_exp_f32 v65, v65
    v_mfma_f32_16x16x32_bf16 v[80:83], v[48:51], v[68:71], 0
    ds_read_b128 v[32:35], v124 offset:6144
    v_cvt_pk_bf16_f32 v52, v64, v65
    s_nop 1
    v_mfma_f32_16x16x16_bf16 v[72:75], v[112:113], v[52:53], v[72:75]
    ds_read_b128 v[36:39], v124 offset:7168
    v_mfma_f32_16x16x16_bf16 v[76:79], v[114:115], v[52:53], v[76:79]
    v_mfma_f32_16x16x16_bf16 v[80:83], v[48:49], v[52:53], v[80:83]
L_norm_81:
    s_mov_b64 vcc, s[36:37]
    s_nop 2
    v_cndmask_b32_dpp v76, v72, v76, vcc quad_perm:[2,3,2,3] row_mask:0xf bank_mask:0xf
    v_cndmask_b32_dpp v77, v73, v77, vcc quad_perm:[2,3,2,3] row_mask:0xf bank_mask:0xf
    v_cndmask_b32_dpp v78, v74, v78, vcc quad_perm:[2,3,2,3] row_mask:0xf bank_mask:0xf
    v_cndmask_b32_dpp v79, v75, v79, vcc quad_perm:[2,3,2,3] row_mask:0xf bank_mask:0xf
    v_rcp_f32_dpp v84, v80 quad_perm:[2,3,2,3] row_mask:0xf bank_mask:0xf
    s_nop 0
    v_pk_mul_f32 v[76:77], v[76:77], v[84:85] op_sel_hi:[1,0]
    v_pk_mul_f32 v[78:79], v[78:79], v[84:85] op_sel_hi:[1,0]
    v_cvt_pk_bf16_f32 v72, v76, v77
    v_cvt_pk_bf16_f32 v73, v78, v79
    ds_write_b64 v122, v[72:73] offset:5632
    v_max_f32_dpp v86, v80, v84 quad_perm:[2,3,2,3] row_mask:0xf bank_mask:0xf
    v_mov_b32_dpp v60, v72 quad_perm:[0,1,0,1] row_mask:0xf bank_mask:0xf
    v_mov_b32_dpp v61, v73 quad_perm:[0,1,0,1] row_mask:0xf bank_mask:0xf
    v_cmp_lt_f32 vcc, s35, v86
    v_mov_b32_dpp v62, v72 quad_perm:[2,3,2,3] row_mask:0xf bank_mask:0xf
    v_mov_b32_dpp v63, v73 quad_perm:[2,3,2,3] row_mask:0xf bank_mask:0xf
    s_cbranch_vccnz L_smax_82
    s_nop 0
    v_smfmac_f32_16x16x64_bf16 v[96:99], v[60:63], v[192:199], v116
    v_smfmac_f32_16x16x64_bf16 v[100:103], v[60:63], v[224:231], v116
    v_smfmac_f32_16x16x64_bf16 v[104:107], v[60:63], v[0:7], v116
    s_waitcnt lgkmcnt(0)
    s_barrier
    ds_read_b128 v[92:95], v127 offset:5120
    ds_read_b128 v[80:83], v127 offset:4608
    ds_read_b128 v[84:87], v127 offset:4096
    v_smfmac_f32_16x16x64_bf16 v[108:111], v[60:63], v[8:15], v116
    s_waitcnt lgkmcnt(2)
    v_smfmac_f32_16x16x64_bf16 v[96:99], v[92:95], v[200:207], v116
    s_waitcnt lgkmcnt(1)
    v_smfmac_f32_16x16x64_bf16 v[96:99], v[80:83], v[208:215], v116
    ds_read_b128 v[40:43], v124 offset:34816
    s_waitcnt lgkmcnt(1)
    v_smfmac_f32_16x16x64_bf16 v[96:99], v[84:87], v[216:223], v116
    ds_read_b128 v[44:47], v124 offset:35840
    v_smfmac_f32_16x16x64_bf16 v[100:103], v[92:95], v[232:239], v116
    ds_read_b128 v[56:59], v124 offset:36864
    v_smfmac_f32_16x16x64_bf16 v[100:103], v[80:83], v[240:247], v116
    ds_read_b128 v[60:63], v124 offset:37888
    v_cvt_pk_bf16_f32 v72, v96, v98
    v_smfmac_f32_16x16x64_bf16 v[100:103], v[84:87], v[248:255], v116
    ds_read_b128 v[64:67], v124 offset:38912
    v_and_or_b32 v72, v72, -2, s33
    v_smfmac_f32_16x16x64_bf16 v[104:107], v[92:95], v[16:23], v116
    ds_read_b128 v[68:71], v124 offset:39936
    v_cvt_pk_bf16_f32 v74, v97, v99
    v_smfmac_f32_16x16x64_bf16 v[104:107], v[80:83], v[24:31], v116
    v_cvt_pk_bf16_f32 v73, v100, v102
    v_cvt_pk_bf16_f32 v75, v101, v103
    v_smfmac_f32_16x16x64_bf16 v[104:107], v[84:87], v[32:39], v116
    buffer_store_dwordx4 v[72:75], v118, s[8:11], s25 offen sc1
    s_waitcnt lgkmcnt(4)
    v_smfmac_f32_16x16x64_bf16 v[108:111], v[92:95], v[40:47], v116
    s_waitcnt lgkmcnt(2)
    v_smfmac_f32_16x16x64_bf16 v[108:111], v[80:83], v[56:63], v116
    s_waitcnt lgkmcnt(0)
    v_cvt_pk_bf16_f32 v76, v104, v106
    v_smfmac_f32_16x16x64_bf16 v[108:111], v[84:87], v[64:71], v116
    v_and_or_b32 v76, v76, -2, s33
    v_cvt_pk_bf16_f32 v78, v105, v107
    s_nop 5
    v_cvt_pk_bf16_f32 v77, v108, v110
    v_cvt_pk_bf16_f32 v79, v109, v111
    buffer_store_dwordx4 v[76:79], v118, s[8:11], s26 offen sc1
    ds_read_b128 v[88:91], v123
    ds_read_b128 v[92:95], v123 offset:1024
    ds_read_b128 v[56:59], v123 offset:2048
    ds_read_b128 v[60:63], v123 offset:3072
    ds_read_b128 v[64:67], v123 offset:32768
    ds_read_b128 v[68:71], v123 offset:33792
    ds_read_b128 v[72:75], v123 offset:34816
    ds_read_b128 v[76:79], v123 offset:35840
    ds_read_b128 v[80:83], v123 offset:4096
    ds_read_b128 v[84:87], v123 offset:5120
    ds_read_b128 v[96:99], v123 offset:6144
    ds_read_b128 v[100:103], v123 offset:7168
    ds_read_b128 v[104:107], v123 offset:36864
    ds_read_b128 v[108:111], v123 offset:37888
    ds_read_b128 v[24:27], v123 offset:38912
    ds_read_b128 v[28:31], v123 offset:39936
    s_add_u32 s30, s30, 0x40000
    s_add_u32 s31, s31, 0x40000
    s_add_u32 s32, s32, 0x20000
    s_add_u32 s23, s24, 3072
    s_add_u32 s48, s23, 4096
    s_xor_b32 s25, s25, 0x40000
    s_xor_b32 s26, s26, 0x40000
    s_mov_b32 s35, 0x49800000
    s_mov_b32 s57, s22
    s_add_u32 s22, s22, 1
    v_xor_b32 v126, 0x6000, v126
    v_cndmask_b32 v12, 0, v125, s[68:69]
    v_cndmask_b32 v13, 0, v125, s[70:71]
    v_cndmask_b32 v14, 0, v125, s[72:73]
    v_cndmask_b32 v15, 0, v125, s[74:75]
    v_mov_b32 v32, 0
    v_mov_b32 v33, 0
    v_mov_b32 v34, 0
    v_mov_b32 v35, 0
    v_mov_b32 v36, 0
    v_mov_b32 v37, 0
    v_mov_b32 v38, 0
    v_mov_b32 v39, 0
    v_mov_b32 v40, 0
    v_mov_b32 v41, 0
    v_mov_b32 v42, 0
    v_mov_b32 v43, 0
    v_mov_b32 v44, 0
    v_mov_b32 v45, 0
    v_mov_b32 v46, 0
    v_mov_b32 v47, 0
    v_mov_b32 v54, 0
    v_mov_b32 v55, 0
    v_mov_b32 v52, 0
    v_mov_b32 v52, 0
    v_mov_b32 v52, 0
    v_mov_b32 v52, 0
    v_mov_b32 v52, 0
    v_mov_b32 v52, 0
    v_mov_b32 v52, 0
    v_mov_b32 v52, 0
    v_mov_b32 v52, 0
    v_mov_b32 v52, 0
    v_mov_b32 v52, 0
    v_mov_b32 v52, 0
    v_mov_b32 v52, 0
    v_mov_b32 v52, 0
    v_mov_b32 v52, 0
    v_mov_b32 v52, 0
    v_mov_b32 v52, 0
    v_mov_b32 v52, 0
    v_mov_b32 v52, 0
    v_mov_b32 v52, 0
    v_mov_b32 v52, 0
    v_mov_b32 v52, 0
    v_mov_b32 v52, 0
    v_mov_b32 v52, 0
    v_mov_b32 v52, 0
    v_mov_b32 v52, 0
    v_mov_b32 v52, 0
    v_mov_b32 v52, 0
    v_mov_b32 v52, 0
    v_mov_b32 v52, 0
    v_mov_b32 v52, 0
    v_mov_b32 v52, 0
    v_mov_b32 v52, 0
    v_mov_b32 v52, 0
    v_mov_b32 v52, 0
    v_mov_b32 v52, 0
    buffer_load_dwordx4 v[4:7], v117, s[8:11], s29 offen sc1
    buffer_load_dwordx4 v[8:11], v117, s[8:11], s53 offen sc1
    buffer_load_dwordx4 v[16:19], v117, s[8:11], s29 offen offset:2048 sc1
    buffer_load_dwordx4 v[20:23], v117, s[8:11], s53 offen offset:2048 sc1
    v_mov_b32 v52, 0
    s_waitcnt vmcnt(3)
L_rl_83:
    v_mfma_f32_16x16x32_bf16 v[48:51], v[4:7], v[12:15], 0
    v_xor_b32 v52, s33, v4
    s_waitcnt vmcnt(2)
    v_mfma_f32_16x16x32_bf16 v[48:51], v[8:11], v[12:15], v[48:51]
    v_xor_b32 v53, s33, v8
    v_or_b32 v52, v52, v53
    s_waitcnt vmcnt(1)
    v_mfma_f32_16x16x32_bf16 v[48:51], v[16:19], v[12:15], v[48:51]
    v_xor_b32 v53, s33, v16
    v_or_b32 v52, v52, v53
    s_waitcnt vmcnt(0)
    v_mfma_f32_16x16x32_bf16 v[48:51], v[20:23], v[12:15], v[48:51]
    v_xor_b32 v53, s33, v20
    v_or_b32 v52, v52, v53
    v_and_b32 v52, 1, v52
    v_cmp_ne_u32 vcc, 0, v52
    s_cbranch_vccnz L_rslow_84
L_rgo_85:
    s_nop 2
    v_permlane32_swap_b32 v48, v50
    v_permlane32_swap_b32 v49, v51
    v_pk_add_f32 v[48:49], v[48:49], v[50:51]
    s_mov_b64 exec, s[38:39]
    v_cvt_pk_bf16_f32 v12, v48, v49
    v_min_u32 v12, 0xfffffffe, v12
    buffer_store_dword v12, v119, s[8:11], s24 offen sc1
    s_mov_b64 exec, -1
    s_add_u32 s24, s24, 8192
    s_bitset0_b32 s24, 15
    s_xor_b32 s55, s24, 16384
    s_xor_b32 s29, s29, 0x40000
    s_xor_b32 s53, s29, 1024
    s_bfe_u32 s33, s22, 0x10001
    s_waitcnt lgkmcnt(0)
    s_branch L_chain_top3_s
L_chain_last_s:
    s_nop 1
    v_smfmac_f32_16x16x64_bf16 v[48:51], v[28:31], v[176:183], v116
    v_smfmac_f32_16x16x64_bf16 v[52:55], v[16:19], v[136:143], v116
    v_smfmac_f32_16x16x64_bf16 v[52:55], v[20:23], v[168:175], v116
    v_smfmac_f32_16x16x64_bf16 v[52:55], v[24:27], v[152:159], v116
    v_smfmac_f32_16x16x64_bf16 v[52:55], v[28:31], v[184:191], v116
    v_add_f32 v48, v48, v50
    v_add_f32 v49, v49, v51
    v_cvt_pk_bf16_f32 v112, v48, v49
    s_nop 4
    v_add_f32 v52, v52, v54
    v_add_f32 v53, v53, v55
    v_cvt_pk_bf16_f32 v114, v52, v53
    s_add_u32 s32, s32, 0x20000
    buffer_store_dwordx4 v[112:115], v117, s[8:11], s32 offen sc1
    v_mov_b32 v94, 64
    s_waitcnt vmcnt(0) lgkmcnt(0)
    s_barrier
    s_mov_b64 exec, 1
    buffer_store_dword v94, off, s[8:11], s44 sc1
    s_mov_b64 exec, -1
    s_endpgm
L_mret_57:
    s_mov_b32 s43, m0
    s_mov_b32 m0, 4096
    buffer_load_dwordx4 v[4:7], v117, s[8:11], s48 offen sc1
    buffer_load_dwordx4 v117, s[8:11], s48 offen sc1 lds
    s_mov_b32 m0, s27
    s_mov_b32 m0, s43
    s_waitcnt vmcnt(0)
    v_max3_u32 v15, v4, v5, v6
    v_max_u32 v15, v15, v7
    v_cmp_lt_u32 vcc, s56, v15
    s_add_u32 s47, s47, 1
    s_add_u32 s49, s49, 1
    s_cmp_ge_u32 s49, 0x10000
    s_cbranch_scc1 L_mgo_58
    s_cbranch_vccnz L_mret_57
    s_branch L_mgo_58
L_smax_60:
    s_add_u32 s47, s47, 1
    s_mov_b32 s35, 0x7f800000
    s_waitcnt lgkmcnt(0)
    ds_read_b128 v[56:59], v126
    ds_read_b128 v[60:63], v126 offset:1024
    ds_read_b128 v[64:67], v126 offset:2048
    ds_read_b128 v[68:71], v126 offset:3072
    ds_read_b128 v[72:75], v126 offset:4096
    ds_read_b128 v[76:79], v126 offset:5120
    ds_read_b128 v[80:83], v126 offset:6144
    ds_read_b128 v[84:87], v126 offset:7168
    ds_read_b128 v[32:35], v121
    ds_read_b128 v[36:39], v121 offset:1024
    ds_read_b128 v[40:43], v121 offset:2048
    ds_read_b128 v[44:47], v121 offset:3072
    s_waitcnt lgkmcnt(0)
    v_mfma_f32_16x16x32_bf16 v[56:59], v[56:59], v[32:35], 0
    v_mfma_f32_16x16x32_bf16 v[56:59], v[60:63], v[36:39], v[56:59]
    v_mfma_f32_16x16x32_bf16 v[56:59], v[64:67], v[40:43], v[56:59]
    v_mfma_f32_16x16x32_bf16 v[56:59], v[68:71], v[44:47], v[56:59]
    v_mfma_f32_16x16x32_bf16 v[60:63], v[72:75], v[32:35], 0
    v_mfma_f32_16x16x32_bf16 v[60:63], v[76:79], v[36:39], v[60:63]
    v_mfma_f32_16x16x32_bf16 v[60:63], v[80:83], v[40:43], v[60:63]
    v_mfma_f32_16x16x32_bf16 v[60:63], v[84:87], v[44:47], v[60:63]
    v_mfma_f32_16x16x32_bf16 v[64:67], v[32:35], v[32:35], 0
    v_mfma_f32_16x16x32_bf16 v[64:67], v[36:39], v[36:39], v[64:67]
    v_mfma_f32_16x16x32_bf16 v[64:67], v[40:43], v[40:43], v[64:67]
    v_mfma_f32_16x16x32_bf16 v[64:67], v[44:47], v[44:47], v[64:67]
    v_max3_f32 v84, v56, v57, v58
    v_max3_f32 v84, v84, v59, v60
    v_max3_f32 v84, v84, v61, v62
    s_nop 4
    v_max3_f32 v84, v84, v63, v64
    v_max_f32 v84, v84, v65
    v_mov_b32 v85, v84
    s_nop 1
    v_permlane32_swap_b32 v85, v84
    v_max_f32 v84, v85, v84
    v_mov_b32 v85, v84
    s_nop 1
    v_permlane16_swap_b32 v85, v84
    v_max_f32 v84, v85, v84
    v_sub_f32 v56, v56, v84
    v_sub_f32 v57, v57, v84
    v_sub_f32 v58, v58, v84
    v_sub_f32 v59, v59, v84
    v_sub_f32 v60, v60, v84
    v_sub_f32 v61, v61, v84
    v_sub_f32 v62, v62, v84
    v_sub_f32 v63, v63, v84
    v_sub_f32 v64, v64, v84
    v_sub_f32 v65, v65, v84
    v_exp_f32 v56, v56
    v_exp_f32 v57, v57
    v_exp_f32 v58, v58
    v_exp_f32 v59, v59
    v_exp_f32 v60, v60
    v_exp_f32 v61, v61
    v_exp_f32 v62, v62
    v_exp_f32 v63, v63
    v_exp_f32 v64, v64
    v_exp_f32 v65, v65
    v_cvt_pk_bf16_f32 v68, v56, v57
    v_cvt_pk_bf16_f32 v69, v58, v59
    v_cvt_pk_bf16_f32 v70, v60, v61
    v_cvt_pk_bf16_f32 v71, v62, v63
    v_cvt_pk_bf16_f32 v52, v64, v65
    s_nop 0
    v_mfma_f32_16x16x32_bf16 v[72:75], v[88:91], v[68:71], 0
    v_mfma_f32_16x16x32_bf16 v[76:79], v[92:95], v[68:71], 0
    v_mfma_f32_16x16x32_bf16 v[80:83], v[48:51], v[68:71], 0
    s_nop 5
    v_mfma_f32_16x16x16_bf16 v[80:83], v[48:49], v[52:53], v[80:83]
    v_mfma_f32_16x16x16_bf16 v[72:75], v[112:113], v[52:53], v[72:75]
    v_mfma_f32_16x16x16_bf16 v[76:79], v[114:115], v[52:53], v[76:79]
    ds_read_b128 v[32:35], v124 offset:6144
    ds_read_b128 v[36:39], v124 offset:7168
    ds_read_b128 v[40:43], v124 offset:34816
    ds_read_b128 v[44:47], v124 offset:35840
    s_waitcnt lgkmcnt(0)
    s_nop 2
    s_branch L_norm_59
L_kvw_61:
    s_add_u32 s47, s47, 1
    s_add_u32 s49, s49, 1
    s_cmp_ge_u32 s49, 0x10000
    s_cbranch_scc1 L_kvb_62
    s_sleep 4
    buffer_load_dword v125, v119, s[8:11], s28 offen sc1
    s_waitcnt vmcnt(0)
    v_cmp_eq_u32 vcc, 0, v125
    s_nop 0
    s_and_b64 vcc, vcc, s[58:59]
    s_cbranch_scc1 L_kvw_61
    s_branch L_kvb_62
L_mret_64:
    s_mov_b32 s43, m0
    s_mov_b32 m0, 5120
    buffer_load_dwordx4 v[4:7], v117, s[8:11], s48 offen sc1
    buffer_load_dwordx4 v117, s[8:11], s48 offen sc1 lds
    s_mov_b32 m0, s27
    s_mov_b32 m0, s43
    s_waitcnt vmcnt(0)
    v_max3_u32 v15, v4, v5, v6
    v_max_u32 v15, v15, v7
    v_cmp_lt_u32 vcc, s56, v15
    s_add_u32 s47, s47, 1
    s_add_u32 s49, s49, 1
    s_cmp_ge_u32 s49, 0x10000
    s_cbranch_scc1 L_mgo_65
    s_cbranch_vccnz L_mret_64
    s_branch L_mgo_65
L_smax_67:
    s_add_u32 s47, s47, 1
    s_mov_b32 s35, 0x7f800000
    s_waitcnt lgkmcnt(0)
    ds_read_b128 v[56:59], v126
    ds_read_b128 v[60:63], v126 offset:1024
    ds_read_b128 v[64:67], v126 offset:2048
    ds_read_b128 v[68:71], v126 offset:3072
    ds_read_b128 v[72:75], v126 offset:4096
    ds_read_b128 v[76:79], v126 offset:5120
    ds_read_b128 v[80:83], v126 offset:6144
    ds_read_b128 v[84:87], v126 offset:7168
    ds_read_b128 v[32:35], v121
    ds_read_b128 v[36:39], v121 offset:1024
    ds_read_b128 v[40:43], v121 offset:2048
    ds_read_b128 v[44:47], v121 offset:3072
    s_waitcnt lgkmcnt(0)
    v_mfma_f32_16x16x32_bf16 v[56:59], v[56:59], v[32:35], 0
    v_mfma_f32_16x16x32_bf16 v[56:59], v[60:63], v[36:39], v[56:59]
    v_mfma_f32_16x16x32_bf16 v[56:59], v[64:67], v[40:43], v[56:59]
    v_mfma_f32_16x16x32_bf16 v[56:59], v[68:71], v[44:47], v[56:59]
    v_mfma_f32_16x16x32_bf16 v[60:63], v[72:75], v[32:35], 0
    v_mfma_f32_16x16x32_bf16 v[60:63], v[76:79], v[36:39], v[60:63]
    v_mfma_f32_16x16x32_bf16 v[60:63], v[80:83], v[40:43], v[60:63]
    v_mfma_f32_16x16x32_bf16 v[60:63], v[84:87], v[44:47], v[60:63]
    v_mfma_f32_16x16x32_bf16 v[64:67], v[32:35], v[32:35], 0
    v_mfma_f32_16x16x32_bf16 v[64:67], v[36:39], v[36:39], v[64:67]
    v_mfma_f32_16x16x32_bf16 v[64:67], v[40:43], v[40:43], v[64:67]
    v_mfma_f32_16x16x32_bf16 v[64:67], v[44:47], v[44:47], v[64:67]
    v_max3_f32 v84, v56, v57, v58
    v_max3_f32 v84, v84, v59, v60
    v_max3_f32 v84, v84, v61, v62
    s_nop 4
    v_max3_f32 v84, v84, v63, v64
    v_max_f32 v84, v84, v65
    v_mov_b32 v85, v84
    s_nop 1
    v_permlane32_swap_b32 v85, v84
    v_max_f32 v84, v85, v84
    v_mov_b32 v85, v84
    s_nop 1
    v_permlane16_swap_b32 v85, v84
    v_max_f32 v84, v85, v84
    v_sub_f32 v56, v56, v84
    v_sub_f32 v57, v57, v84
    v_sub_f32 v58, v58, v84
    v_sub_f32 v59, v59, v84
    v_sub_f32 v60, v60, v84
    v_sub_f32 v61, v61, v84
    v_sub_f32 v62, v62, v84
    v_sub_f32 v63, v63, v84
    v_sub_f32 v64, v64, v84
    v_sub_f32 v65, v65, v84
    v_exp_f32 v56, v56
    v_exp_f32 v57, v57
    v_exp_f32 v58, v58
    v_exp_f32 v59, v59
    v_exp_f32 v60, v60
    v_exp_f32 v61, v61
    v_exp_f32 v62, v62
    v_exp_f32 v63, v63
    v_exp_f32 v64, v64
    v_exp_f32 v65, v65
    v_cvt_pk_bf16_f32 v68, v56, v57
    v_cvt_pk_bf16_f32 v69, v58, v59
    v_cvt_pk_bf16_f32 v70, v60, v61
    v_cvt_pk_bf16_f32 v71, v62, v63
    v_cvt_pk_bf16_f32 v52, v64, v65
    s_nop 0
    v_mfma_f32_16x16x32_bf16 v[72:75], v[88:91], v[68:71], 0
    v_mfma_f32_16x16x32_bf16 v[76:79], v[92:95], v[68:71], 0
    v_mfma_f32_16x16x32_bf16 v[80:83], v[48:51], v[68:71], 0
    s_nop 5
    v_mfma_f32_16x16x16_bf16 v[80:83], v[48:49], v[52:53], v[80:83]
    v_mfma_f32_16x16x16_bf16 v[72:75], v[112:113], v[52:53], v[72:75]
    v_mfma_f32_16x16x16_bf16 v[76:79], v[114:115], v[52:53], v[76:79]
    ds_read_b128 v[32:35], v124 offset:6144
    ds_read_b128 v[36:39], v124 offset:7168
    ds_read_b128 v[40:43], v124 offset:34816
    ds_read_b128 v[44:47], v124 offset:35840
    s_waitcnt lgkmcnt(0)
    s_nop 2
    s_branch L_norm_66
L_kvw_68:
    s_add_u32 s47, s47, 1
    s_add_u32 s49, s49, 1
    s_cmp_ge_u32 s49, 0x10000
    s_cbranch_scc1 L_kvb_69
    s_sleep 4
    buffer_load_dword v125, v119, s[8:11], s28 offen sc1
    s_waitcnt vmcnt(0)
    v_cmp_eq_u32 vcc, 0, v125
    s_nop 0
    s_and_b64 vcc, vcc, s[58:59]
    s_cbranch_scc1 L_kvw_68
    s_branch L_kvb_69
L_mret_71:
    s_mov_b32 s43, m0
    s_mov_b32 m0, 6144
    buffer_load_dwordx4 v[4:7], v117, s[8:11], s48 offen sc1
    buffer_load_dwordx4 v117, s[8:11], s48 offen sc1 lds
    s_mov_b32 m0, s27
    s_mov_b32 m0, s43
    s_waitcnt vmcnt(0)
    v_max3_u32 v15, v4, v5, v6
    v_max_u32 v15, v15, v7
    v_cmp_lt_u32 vcc, s56, v15
    s_add_u32 s47, s47, 1
    s_add_u32 s49, s49, 1
    s_cmp_ge_u32 s49, 0x10000
    s_cbranch_scc1 L_mgo_72
    s_cbranch_vccnz L_mret_71
    s_branch L_mgo_72
L_smax_74:
    s_add_u32 s47, s47, 1
    s_mov_b32 s35, 0x7f800000
    s_waitcnt lgkmcnt(0)
    ds_read_b128 v[56:59], v126
    ds_read_b128 v[60:63], v126 offset:1024
    ds_read_b128 v[64:67], v126 offset:2048
    ds_read_b128 v[68:71], v126 offset:3072
    ds_read_b128 v[72:75], v126 offset:4096
    ds_read_b128 v[76:79], v126 offset:5120
    ds_read_b128 v[80:83], v126 offset:6144
    ds_read_b128 v[84:87], v126 offset:7168
    ds_read_b128 v[32:35], v121
    ds_read_b128 v[36:39], v121 offset:1024
    ds_read_b128 v[40:43], v121 offset:2048
    ds_read_b128 v[44:47], v121 offset:3072
    s_waitcnt lgkmcnt(0)
    v_mfma_f32_16x16x32_bf16 v[56:59], v[56:59], v[32:35], 0
    v_mfma_f32_16x16x32_bf16 v[56:59], v[60:63], v[36:39], v[56:59]
    v_mfma_f32_16x16x32_bf16 v[56:59], v[64:67], v[40:43], v[56:59]
    v_mfma_f32_16x16x32_bf16 v[56:59], v[68:71], v[44:47], v[56:59]
    v_mfma_f32_16x16x32_bf16 v[60:63], v[72:75], v[32:35], 0
    v_mfma_f32_16x16x32_bf16 v[60:63], v[76:79], v[36:39], v[60:63]
    v_mfma_f32_16x16x32_bf16 v[60:63], v[80:83], v[40:43], v[60:63]
    v_mfma_f32_16x16x32_bf16 v[60:63], v[84:87], v[44:47], v[60:63]
    v_mfma_f32_16x16x32_bf16 v[64:67], v[32:35], v[32:35], 0
    v_mfma_f32_16x16x32_bf16 v[64:67], v[36:39], v[36:39], v[64:67]
    v_mfma_f32_16x16x32_bf16 v[64:67], v[40:43], v[40:43], v[64:67]
    v_mfma_f32_16x16x32_bf16 v[64:67], v[44:47], v[44:47], v[64:67]
    v_max3_f32 v84, v56, v57, v58
    v_max3_f32 v84, v84, v59, v60
    v_max3_f32 v84, v84, v61, v62
    s_nop 4
    v_max3_f32 v84, v84, v63, v64
    v_max_f32 v84, v84, v65
    v_mov_b32 v85, v84
    s_nop 1
    v_permlane32_swap_b32 v85, v84
    v_max_f32 v84, v85, v84
    v_mov_b32 v85, v84
    s_nop 1
    v_permlane16_swap_b32 v85, v84
    v_max_f32 v84, v85, v84
    v_sub_f32 v56, v56, v84
    v_sub_f32 v57, v57, v84
    v_sub_f32 v58, v58, v84
    v_sub_f32 v59, v59, v84
    v_sub_f32 v60, v60, v84
    v_sub_f32 v61, v61, v84
    v_sub_f32 v62, v62, v84
    v_sub_f32 v63, v63, v84
    v_sub_f32 v64, v64, v84
    v_sub_f32 v65, v65, v84
    v_exp_f32 v56, v56
    v_exp_f32 v57, v57
    v_exp_f32 v58, v58
    v_exp_f32 v59, v59
    v_exp_f32 v60, v60
    v_exp_f32 v61, v61
    v_exp_f32 v62, v62
    v_exp_f32 v63, v63
    v_exp_f32 v64, v64
    v_exp_f32 v65, v65
    v_cvt_pk_bf16_f32 v68, v56, v57
    v_cvt_pk_bf16_f32 v69, v58, v59
    v_cvt_pk_bf16_f32 v70, v60, v61
    v_cvt_pk_bf16_f32 v71, v62, v63
    v_cvt_pk_bf16_f32 v52, v64, v65
    s_nop 0
    v_mfma_f32_16x16x32_bf16 v[72:75], v[88:91], v[68:71], 0
    v_mfma_f32_16x16x32_bf16 v[76:79], v[92:95], v[68:71], 0
    v_mfma_f32_16x16x32_bf16 v[80:83], v[48:51], v[68:71], 0
    s_nop 5
    v_mfma_f32_16x16x16_bf16 v[80:83], v[48:49], v[52:53], v[80:83]
    v_mfma_f32_16x16x16_bf16 v[72:75], v[112:113], v[52:53], v[72:75]
    v_mfma_f32_16x16x16_bf16 v[76:79], v[114:115], v[52:53], v[76:79]
    ds_read_b128 v[32:35], v124 offset:6144
    ds_read_b128 v[36:39], v124 offset:7168
    ds_read_b128 v[40:43], v124 offset:34816
    ds_read_b128 v[44:47], v124 offset:35840
    s_waitcnt lgkmcnt(0)
    s_nop 2
    s_branch L_norm_73
L_rslow_76:
    buffer_load_dwordx4 v[4:7], v117, s[8:11], s29 offen sc1
    buffer_load_dwordx4 v[8:11], v117, s[8:11], s53 offen sc1
    buffer_load_dwordx4 v[16:19], v117, s[8:11], s29 offen offset:2048 sc1
    buffer_load_dwordx4 v[20:23], v117, s[8:11], s53 offen offset:2048 sc1
    s_add_u32 s46, s46, 1
    s_add_u32 s49, s49, 1
    s_cmp_ge_u32 s49, 0x10000
    s_cbranch_scc1 L_rgo_77
    s_waitcnt vmcnt(0)
    s_branch L_rl_75
L_mret_79:
    s_mov_b32 s43, m0
    s_mov_b32 m0, 7168
    buffer_load_dwordx4 v[4:7], v117, s[8:11], s48 offen sc1
    buffer_load_dwordx4 v117, s[8:11], s48 offen sc1 lds
    s_mov_b32 m0, s27
    s_mov_b32 m0, s43
    s_waitcnt vmcnt(0)
    v_max3_u32 v15, v4, v5, v6
    v_max_u32 v15, v15, v7
    v_cmp_lt_u32 vcc, s56, v15
    s_add_u32 s47, s47, 1
    s_add_u32 s49, s49, 1
    s_cmp_ge_u32 s49, 0x10000
    s_cbranch_scc1 L_mgo_80
    s_cbranch_vccnz L_mret_79
    s_branch L_mgo_80
L_smax_82:
    s_add_u32 s47, s47, 1
    s_mov_b32 s35, 0x7f800000
    s_waitcnt lgkmcnt(0)
    ds_read_b128 v[56:59], v126
    ds_read_b128 v[60:63], v126 offset:1024
    ds_read_b128 v[64:67], v126 offset:2048
    ds_read_b128 v[68:71], v126 offset:3072
    ds_read_b128 v[72:75], v126 offset:4096
    ds_read_b128 v[76:79], v126 offset:5120
    ds_read_b128 v[80:83], v126 offset:6144
    ds_read_b128 v[84:87], v126 offset:7168
    ds_read_b128 v[32:35], v121
    ds_read_b128 v[36:39], v121 offset:1024
    ds_read_b128 v[40:43], v121 offset:2048
    ds_read_b128 v[44:47], v121 offset:3072
    s_waitcnt lgkmcnt(0)
    v_mfma_f32_16x16x32_bf16 v[56:59], v[56:59], v[32:35], 0
    v_mfma_f32_16x16x32_bf16 v[56:59], v[60:63], v[36:39], v[56:59]
    v_mfma_f32_16x16x32_bf16 v[56:59], v[64:67], v[40:43], v[56:59]
    v_mfma_f32_16x16x32_bf16 v[56:59], v[68:71], v[44:47], v[56:59]
    v_mfma_f32_16x16x32_bf16 v[60:63], v[72:75], v[32:35], 0
    v_mfma_f32_16x16x32_bf16 v[60:63], v[76:79], v[36:39], v[60:63]
    v_mfma_f32_16x16x32_bf16 v[60:63], v[80:83], v[40:43], v[60:63]
    v_mfma_f32_16x16x32_bf16 v[60:63], v[84:87], v[44:47], v[60:63]
    v_mfma_f32_16x16x32_bf16 v[64:67], v[32:35], v[32:35], 0
    v_mfma_f32_16x16x32_bf16 v[64:67], v[36:39], v[36:39], v[64:67]
    v_mfma_f32_16x16x32_bf16 v[64:67], v[40:43], v[40:43], v[64:67]
    v_mfma_f32_16x16x32_bf16 v[64:67], v[44:47], v[44:47], v[64:67]
    v_max3_f32 v84, v56, v57, v58
    v_max3_f32 v84, v84, v59, v60
    v_max3_f32 v84, v84, v61, v62
    s_nop 4
    v_max3_f32 v84, v84, v63, v64
    v_max_f32 v84, v84, v65
    v_mov_b32 v85, v84
    s_nop 1
    v_permlane32_swap_b32 v85, v84
    v_max_f32 v84, v85, v84
    v_mov_b32 v85, v84
    s_nop 1
    v_permlane16_swap_b32 v85, v84
    v_max_f32 v84, v85, v84
    v_sub_f32 v56, v56, v84
    v_sub_f32 v57, v57, v84
    v_sub_f32 v58, v58, v84
    v_sub_f32 v59, v59, v84
    v_sub_f32 v60, v60, v84
    v_sub_f32 v61, v61, v84
    v_sub_f32 v62, v62, v84
    v_sub_f32 v63, v63, v84
    v_sub_f32 v64, v64, v84
    v_sub_f32 v65, v65, v84
    v_exp_f32 v56, v56
    v_exp_f32 v57, v57
    v_exp_f32 v58, v58
    v_exp_f32 v59, v59
    v_exp_f32 v60, v60
    v_exp_f32 v61, v61
    v_exp_f32 v62, v62
    v_exp_f32 v63, v63
    v_exp_f32 v64, v64
    v_exp_f32 v65, v65
    v_cvt_pk_bf16_f32 v68, v56, v57
    v_cvt_pk_bf16_f32 v69, v58, v59
    v_cvt_pk_bf16_f32 v70, v60, v61
    v_cvt_pk_bf16_f32 v71, v62, v63
    v_cvt_pk_bf16_f32 v52, v64, v65
    s_nop 0
    v_mfma_f32_16x16x32_bf16 v[72:75], v[88:91], v[68:71], 0
    v_mfma_f32_16x16x32_bf16 v[76:79], v[92:95], v[68:71], 0
    v_mfma_f32_16x16x32_bf16 v[80:83], v[48:51], v[68:71], 0
    s_nop 5
    v_mfma_f32_16x16x16_bf16 v[80:83], v[48:49], v[52:53], v[80:83]
    v_mfma_f32_16x16x16_bf16 v[72:75], v[112:113], v[52:53], v[72:75]
    v_mfma_f32_16x16x16_bf16 v[76:79], v[114:115], v[52:53], v[76:79]
    ds_read_b128 v[32:35], v124 offset:6144
    ds_read_b128 v[36:39], v124 offset:7168
    ds_read_b128 v[40:43], v124 offset:34816
    ds_read_b128 v[44:47], v124 offset:35840
    s_waitcnt lgkmcnt(0)
    s_nop 2
    s_branch L_norm_81
L_rslow_84:
    buffer_load_dwordx4 v[4:7], v117, s[8:11], s29 offen sc1
    buffer_load_dwordx4 v[8:11], v117, s[8:11], s53 offen sc1
    buffer_load_dwordx4 v[16:19], v117, s[8:11], s29 offen offset:2048 sc1
    buffer_load_dwordx4 v[20:23], v117, s[8:11], s53 offen offset:2048 sc1
    s_add_u32 s46, s46, 1
    s_add_u32 s49, s49, 1
    s_cmp_ge_u32 s49, 0x10000
    s_cbranch_scc1 L_rgo_85
    s_waitcnt vmcnt(0)
    s_branch L_rl_83
L_bulk:
    s_add_u32 s88, s101, 32
    s_mov_b32 s41, 0
    s_lshr_b32 s20, s101, 6
    s_and_b32 s22, s101, 63
    s_movk_i32 s37, 1000
L_p1go:
    s_mov_b32 s40, 0
    s_mov_b32 s80, 0
    s_mov_b32 s23, 0
L_p1_pass:
    v_mbcnt_lo_u32_b32 v0, -1, 0
    v_mbcnt_hi_u32_b32 v0, -1, v0
    s_lshl_b32 s96, s100, 6
    v_add_u32 v0, s96, v0
    s_load_dwordx2 s[34:35], s[0:1], 16
    s_load_dwordx2 s[30:31], s[0:1], 24
    s_load_dwordx2 s[32:33], s[0:1], 32
    s_load_dwordx2 s[42:43], s[0:1], 40
    s_load_dwordx2 s[12:13], s[0:1], 0
    s_waitcnt lgkmcnt(0)
    s_and_b32 s13, s13, 0xffff
    s_mov_b32 s14, 0x200000
    s_mov_b32 s15, 0x20000
    v_lshrrev_b32 v147, 6, v0
    s_nop 0
    v_readfirstlane_b32 s21, v147
    v_and_b32 v144, 63, v0
    v_lshrrev_b32 v145, 4, v144
    v_and_b32 v146, 15, v144
    v_lshrrev_b32 v149, 2, v146
    v_lshlrev_b32 v137, 4, v144
    s_lshl_b32 s29, s21, 10
    s_lshl_b32 s26, s20, 7
    s_lshl_b32 s27, s21, 5
    s_add_u32 s26, s26, s27
    v_add_u32 v147, s26, v146
    v_lshlrev_b32 v147, 10, v147
    v_lshl_add_u32 v139, v145, 4, v147
    s_mov_b32 s26, 0x0
    buffer_load_dwordx4 v[0:3], v139, s[12:15], s26 offen
    buffer_load_dwordx4 v[4:7], v139, s[12:15], s26 offen offset:64
    buffer_load_dwordx4 v[8:11], v139, s[12:15], s26 offen offset:128
    buffer_load_dwordx4 v[12:15], v139, s[12:15], s26 offen offset:192
    buffer_load_dwordx4 v[16:19], v139, s[12:15], s26 offen offset:256
    buffer_load_dwordx4 v[20:23], v139, s[12:15], s26 offen offset:320
    buffer_load_dwordx4 v[24:27], v139, s[12:15], s26 offen offset:384
    buffer_load_dwordx4 v[28:31], v139, s[12:15], s26 offen offset:448
    buffer_load_dwordx4 v[32:35], v139, s[12:15], s26 offen offset:512
    buffer_load_dwordx4 v[36:39], v139, s[12:15], s26 offen offset:576
    buffer_load_dwordx4 v[40:43], v139, s[12:15], s26 offen offset:640
    buffer_load_dwordx4 v[44:47], v139, s[12:15], s26 offen offset:704
    buffer_load_dwordx4 v[48:51], v139, s[12:15], s26 offen offset:768
    buffer_load_dwordx4 v[52:55], v139, s[12:15], s26 offen offset:832
    buffer_load_dwordx4 v[56:59], v139, s[12:15], s26 offen offset:896
    buffer_load_dwordx4 v[60:63], v139, s[12:15], s26 offen offset:960
    s_mov_b32 s26, 0x4000
    buffer_load_dwordx4 v[64:67], v139, s[12:15], s26 offen
    buffer_load_dwordx4 v[68:71], v139, s[12:15], s26 offen offset:64
    buffer_load_dwordx4 v[72:75], v139, s[12:15], s26 offen offset:128
    buffer_load_dwordx4 v[76:79], v139, s[12:15], s26 offen offset:192
    buffer_load_dwordx4 v[80:83], v139, s[12:15], s26 offen offset:256
    buffer_load_dwordx4 v[84:87], v139, s[12:15], s26 offen offset:320
    buffer_load_dwordx4 v[88:91], v139, s[12:15], s26 offen offset:384
    buffer_load_dwordx4 v[92:95], v139, s[12:15], s26 offen offset:448
    buffer_load_dwordx4 v[96:99], v139, s[12:15], s26 offen offset:512
    buffer_load_dwordx4 v[100:103], v139, s[12:15], s26 offen offset:576
    buffer_load_dwordx4 v[104:107], v139, s[12:15], s26 offen offset:640
    buffer_load_dwordx4 v[108:111], v139, s[12:15], s26 offen offset:704
    buffer_load_dwordx4 v[112:115], v139, s[12:15], s26 offen offset:768
    buffer_load_dwordx4 v[116:119], v139, s[12:15], s26 offen offset:832
    buffer_load_dwordx4 v[120:123], v139, s[12:15], s26 offen offset:896
    buffer_load_dwordx4 v[124:127], v139, s[12:15], s26 offen offset:960
    s_lshr_b32 s26, s21, 1
    s_lshl_b32 s26, s26, 2
    v_or_b32 v148, s26, v145
    v_lshlrev_b32 v148, 1, v148
    v_xor_b32 v148, v148, v146
    v_lshlrev_b32 v148, 4, v148
    s_lshl_b32 s26, s21, 2
    v_add_u32 v147, s26, v145
    v_lshl_add_u32 v136, v147, 13, v148
    v_lshl_add_u32 v147, v145, 3, v149
    v_lshlrev_b32 v147, 8, v147
    v_and_b32 v148, 1, v145
    v_lshl_or_b32 v148, v148, 2, v149
    v_lshl_add_u32 v147, v148, 5, v147
    v_and_b32 v148, 3, v146
    v_lshl_add_u32 v128, v148, 3, v147
    v_xor_b32 v129, 32, v128
    v_xor_b32 v130, 64, v128
    v_xor_b32 v131, 96, v128
    v_xor_b32 v132, 128, v128
    v_xor_b32 v133, 160, v128
    v_xor_b32 v134, 192, v128
    v_xor_b32 v135, 224, v128
    s_mov_b32 s19, 0x20000
    s_mov_b32 s38, s22
    s_mov_b32 s39, s22
    v_mov_b32 v158, 0x3f803f80
    s_waitcnt vmcnt(16)
    v_pk_mov_b32 v[150:151], 0, 0
    v_pk_mov_b32 v[152:153], 0, 0
    v_dot2_f32_bf16 v150, v0, v158, v150
    v_dot2_f32_bf16 v152, v0, v0, v152
    v_dot2_f32_bf16 v151, v1, v158, v151
    v_dot2_f32_bf16 v153, v1, v1, v153
    v_dot2_f32_bf16 v150, v2, v158, v150
    v_dot2_f32_bf16 v152, v2, v2, v152
    v_dot2_f32_bf16 v151, v3, v158, v151
    v_dot2_f32_bf16 v153, v3, v3, v153
    v_dot2_f32_bf16 v150, v4, v158, v150
    v_dot2_f32_bf16 v152, v4, v4, v152
    v_dot2_f32_bf16 v151, v5, v158, v151
    v_dot2_f32_bf16 v153, v5, v5, v153
    v_dot2_f32_bf16 v150, v6, v158, v150
    v_dot2_f32_bf16 v152, v6, v6, v152
    v_dot2_f32_bf16 v151, v7, v158, v151
    v_dot2_f32_bf16 v153, v7, v7, v153
    v_dot2_f32_bf16 v150, v8, v158, v150
    v_dot2_f32_bf16 v152, v8, v8, v152
    v_dot2_f32_bf16 v151, v9, v158, v151
    v_dot2_f32_bf16 v153, v9, v9, v153
    v_dot2_f32_bf16 v150, v10, v158, v150
    v_dot2_f32_bf16 v152, v10, v10, v152
    v_dot2_f32_bf16 v151, v11, v158, v151
    v_dot2_f32_bf16 v153, v11, v11, v153
    v_dot2_f32_bf16 v150, v12, v158, v150
    v_dot2_f32_bf16 v152, v12, v12, v152
    v_dot2_f32_bf16 v151, v13, v158, v151
    v_dot2_f32_bf16 v153, v13, v13, v153
    v_dot2_f32_bf16 v150, v14, v158, v150
    v_dot2_f32_bf16 v152, v14, v14, v152
    v_dot2_f32_bf16 v151, v15, v158, v151
    v_dot2_f32_bf16 v153, v15, v15, v153
    v_dot2_f32_bf16 v150, v16, v158, v150
    v_dot2_f32_bf16 v152, v16, v16, v152
    v_dot2_f32_bf16 v151, v17, v158, v151
    v_dot2_f32_bf16 v153, v17, v17, v153
    v_dot2_f32_bf16 v150, v18, v158, v150
    v_dot2_f32_bf16 v152, v18, v18, v152
    v_dot2_f32_bf16 v151, v19, v158, v151
    v_dot2_f32_bf16 v153, v19, v19, v153
    v_dot2_f32_bf16 v150, v20, v158, v150
    v_dot2_f32_bf16 v152, v20, v20, v152
    v_dot2_f32_bf16 v151, v21, v158, v151
    v_dot2_f32_bf16 v153, v21, v21, v153
    v_dot2_f32_bf16 v150, v22, v158, v150
    v_dot2_f32_bf16 v152, v22, v22, v152
    v_dot2_f32_bf16 v151, v23, v158, v151
    v_dot2_f32_bf16 v153, v23, v23, v153
    v_dot2_f32_bf16 v150, v24, v158, v150
    v_dot2_f32_bf16 v152, v24, v24, v152
    v_dot2_f32_bf16 v151, v25, v158, v151
    v_dot2_f32_bf16 v153, v25, v25, v153
    v_dot2_f32_bf16 v150, v26, v158, v150
    v_dot2_f32_bf16 v152, v26, v26, v152
    v_dot2_f32_bf16 v151, v27, v158, v151
    v_dot2_f32_bf16 v153, v27, v27, v153
    v_dot2_f32_bf16 v150, v28, v158, v150
    v_dot2_f32_bf16 v152, v28, v28, v152
    v_dot2_f32_bf16 v151, v29, v158, v151
    v_dot2_f32_bf16 v153, v29, v29, v153
    v_dot2_f32_bf16 v150, v30, v158, v150
    v_dot2_f32_bf16 v152, v30, v30, v152
    v_dot2_f32_bf16 v151, v31, v158, v151
    v_dot2_f32_bf16 v153, v31, v31, v153
    v_dot2_f32_bf16 v150, v32, v158, v150
    v_dot2_f32_bf16 v152, v32, v32, v152
    v_dot2_f32_bf16 v151, v33, v158, v151
    v_dot2_f32_bf16 v153, v33, v33, v153
    v_dot2_f32_bf16 v150, v34, v158, v150
    v_dot2_f32_bf16 v152, v34, v34, v152
    v_dot2_f32_bf16 v151, v35, v158, v151
    v_dot2_f32_bf16 v153, v35, v35, v153
    v_dot2_f32_bf16 v150, v36, v158, v150
    v_dot2_f32_bf16 v152, v36, v36, v152
    v_dot2_f32_bf16 v151, v37, v158, v151
    v_dot2_f32_bf16 v153, v37, v37, v153
    v_dot2_f32_bf16 v150, v38, v158, v150
    v_dot2_f32_bf16 v152, v38, v38, v152
    v_dot2_f32_bf16 v151, v39, v158, v151
    v_dot2_f32_bf16 v153, v39, v39, v153
    v_dot2_f32_bf16 v150, v40, v158, v150
    v_dot2_f32_bf16 v152, v40, v40, v152
    v_dot2_f32_bf16 v151, v41, v158, v151
    v_dot2_f32_bf16 v153, v41, v41, v153
    v_dot2_f32_bf16 v150, v42, v158, v150
    v_dot2_f32_bf16 v152, v42, v42, v152
    v_dot2_f32_bf16 v151, v43, v158, v151
    v_dot2_f32_bf16 v153, v43, v43, v153
    v_dot2_f32_bf16 v150, v44, v158, v150
    v_dot2_f32_bf16 v152, v44, v44, v152
    v_dot2_f32_bf16 v151, v45, v158, v151
    v_dot2_f32_bf16 v153, v45, v45, v153
    v_dot2_f32_bf16 v150, v46, v158, v150
    v_dot2_f32_bf16 v152, v46, v46, v152
    v_dot2_f32_bf16 v151, v47, v158, v151
    v_dot2_f32_bf16 v153, v47, v47, v153
    v_dot2_f32_bf16 v150, v48, v158, v150
    v_dot2_f32_bf16 v152, v48, v48, v152
    v_dot2_f32_bf16 v151, v49, v158, v151
    v_dot2_f32_bf16 v153, v49, v49, v153
    v_dot2_f32_bf16 v150, v50, v158, v150
    v_dot2_f32_bf16 v152, v50, v50, v152
    v_dot2_f32_bf16 v151, v51, v158, v151
    v_dot2_f32_bf16 v153, v51, v51, v153
    v_dot2_f32_bf16 v150, v52, v158, v150
    v_dot2_f32_bf16 v152, v52, v52, v152
    v_dot2_f32_bf16 v151, v53, v158, v151
    v_dot2_f32_bf16 v153, v53, v53, v153
    v_dot2_f32_bf16 v150, v54, v158, v150
    v_dot2_f32_bf16 v152, v54, v54, v152
    v_dot2_f32_bf16 v151, v55, v158, v151
    v_dot2_f32_bf16 v153, v55, v55, v153
    v_dot2_f32_bf16 v150, v56, v158, v150
    v_dot2_f32_bf16 v152, v56, v56, v152
    v_dot2_f32_bf16 v151, v57, v158, v151
    v_dot2_f32_bf16 v153, v57, v57, v153
    v_dot2_f32_bf16 v150, v58, v158, v150
    v_dot2_f32_bf16 v152, v58, v58, v152
    v_dot2_f32_bf16 v151, v59, v158, v151
    v_dot2_f32_bf16 v153, v59, v59, v153
    v_dot2_f32_bf16 v150, v60, v158, v150
    v_dot2_f32_bf16 v152, v60, v60, v152
    v_dot2_f32_bf16 v151, v61, v158, v151
    v_dot2_f32_bf16 v153, v61, v61, v153
    v_dot2_f32_bf16 v150, v62, v158, v150
    v_dot2_f32_bf16 v152, v62, v62, v152
    v_dot2_f32_bf16 v151, v63, v158, v151
    v_dot2_f32_bf16 v153, v63, v63, v153
    s_nop 1
    v_add_f32 v150, v150, v151
    v_add_f32 v152, v152, v153
    v_mov_b32 v157, v150
    s_nop 1
    v_permlane32_swap_b32 v157, v150
    v_add_f32 v150, v157, v150
    v_mov_b32 v157, v150
    s_nop 1
    v_permlane16_swap_b32 v157, v150
    v_add_f32 v150, v157, v150
    v_mov_b32 v157, v152
    s_nop 1
    v_permlane32_swap_b32 v157, v152
    v_add_f32 v152, v157, v152
    v_mov_b32 v157, v152
    s_nop 1
    v_permlane16_swap_b32 v157, v152
    v_add_f32 v152, v157, v152
    v_mul_f32 v150, 0x3b000000, v150
    v_cvt_pk_bf16_f32 v154, v150, v150
    v_and_b32 v154, 0xffff0000, v154
    v_sub_f32 v156, v150, v154
    v_mul_f32 v157, v150, v150
    v_mul_f32 v152, 0x3b000000, v152
    v_sub_f32 v152, v152, v157
    v_max_f32 v152, 0, v152
    v_cvt_pk_bf16_f32 v152, v152, v152
    v_and_b32 v152, 0xffff0000, v152
    v_add_f32 v152, 0x3727c5ac, v152
    v_cvt_pk_bf16_f32 v152, v152, v152
    v_and_b32 v152, 0xffff0000, v152
    v_sqrt_f32 v152, v152
    s_nop 0
    v_cvt_pk_bf16_f32 v152, v152, v152
    v_and_b32 v152, 0xffff0000, v152
    v_rcp_f32 v152, v152
    v_lshlrev_b32 v160, 16, v0
    v_and_b32 v161, 0xffff0000, v0
    v_lshlrev_b32 v162, 16, v1
    v_and_b32 v163, 0xffff0000, v1
    v_lshlrev_b32 v164, 16, v2
    v_and_b32 v165, 0xffff0000, v2
    v_lshlrev_b32 v166, 16, v3
    v_and_b32 v167, 0xffff0000, v3
    v_lshlrev_b32 v168, 16, v4
    v_and_b32 v169, 0xffff0000, v4
    v_lshlrev_b32 v170, 16, v5
    v_and_b32 v171, 0xffff0000, v5
    v_lshlrev_b32 v172, 16, v6
    v_and_b32 v173, 0xffff0000, v6
    v_lshlrev_b32 v174, 16, v7
    v_and_b32 v175, 0xffff0000, v7
    v_pk_add_f32 v[160:161], v[160:161], v[154:155] op_sel_hi:[1,0] neg_lo:[0,1] neg_hi:[0,1]
    v_pk_add_f32 v[162:163], v[162:163], v[154:155] op_sel_hi:[1,0] neg_lo:[0,1] neg_hi:[0,1]
    v_pk_add_f32 v[164:165], v[164:165], v[154:155] op_sel_hi:[1,0] neg_lo:[0,1] neg_hi:[0,1]
    v_pk_add_f32 v[166:167], v[166:167], v[154:155] op_sel_hi:[1,0] neg_lo:[0,1] neg_hi:[0,1]
    v_pk_add_f32 v[168:169], v[168:169], v[154:155] op_sel_hi:[1,0] neg_lo:[0,1] neg_hi:[0,1]
    v_pk_add_f32 v[170:171], v[170:171], v[154:155] op_sel_hi:[1,0] neg_lo:[0,1] neg_hi:[0,1]
    v_pk_add_f32 v[172:173], v[172:173], v[154:155] op_sel_hi:[1,0] neg_lo:[0,1] neg_hi:[0,1]
    v_pk_add_f32 v[174:175], v[174:175], v[154:155] op_sel_hi:[1,0] neg_lo:[0,1] neg_hi:[0,1]
    v_cvt_pk_bf16_f32 v0, v160, v161
    v_cvt_pk_bf16_f32 v1, v162, v163
    v_cvt_pk_bf16_f32 v2, v164, v165
    v_cvt_pk_bf16_f32 v3, v166, v167
    v_cvt_pk_bf16_f32 v4, v168, v169
    v_cvt_pk_bf16_f32 v5, v170, v171
    v_cvt_pk_bf16_f32 v6, v172, v173
    v_cvt_pk_bf16_f32 v7, v174, v175
    v_lshlrev_b32 v160, 16, v0
    v_and_b32 v161, 0xffff0000, v0
    v_lshlrev_b32 v162, 16, v1
    v_and_b32 v163, 0xffff0000, v1
    v_lshlrev_b32 v164, 16, v2
    v_and_b32 v165, 0xffff0000, v2
    v_lshlrev_b32 v166, 16, v3
    v_and_b32 v167, 0xffff0000, v3
    v_lshlrev_b32 v168, 16, v4
    v_and_b32 v169, 0xffff0000, v4
    v_lshlrev_b32 v170, 16, v5
    v_and_b32 v171, 0xffff0000, v5
    v_lshlrev_b32 v172, 16, v6
    v_and_b32 v173, 0xffff0000, v6
    v_lshlrev_b32 v174, 16, v7
    v_and_b32 v175, 0xffff0000, v7
    v_pk_mul_f32 v[160:161], v[160:161], v[152:153] op_sel_hi:[1,0]
    v_pk_mul_f32 v[162:163], v[162:163], v[152:153] op_sel_hi:[1,0]
    v_pk_mul_f32 v[164:165], v[164:165], v[152:153] op_sel_hi:[1,0]
    v_pk_mul_f32 v[166:167], v[166:167], v[152:153] op_sel_hi:[1,0]
    v_pk_mul_f32 v[168:169], v[168:169], v[152:153] op_sel_hi:[1,0]
    v_pk_mul_f32 v[170:171], v[170:171], v[152:153] op_sel_hi:[1,0]
    v_pk_mul_f32 v[172:173], v[172:173], v[152:153] op_sel_hi:[1,0]
    v_pk_mul_f32 v[174:175], v[174:175], v[152:153] op_sel_hi:[1,0]
    v_cvt_pk_bf16_f32 v160, v160, v161
    v_cvt_pk_bf16_f32 v162, v162, v163
    v_cvt_pk_bf16_f32 v164, v164, v165
    v_cvt_pk_bf16_f32 v166, v166, v167
    v_cvt_pk_bf16_f32 v168, v168, v169
    v_cvt_pk_bf16_f32 v170, v170, v171
    v_cvt_pk_bf16_f32 v172, v172, v173
    v_cvt_pk_bf16_f32 v174, v174, v175
    v_accvgpr_write_b32 a0, v160
    v_accvgpr_write_b32 a1, v162
    v_accvgpr_write_b32 a2, v164
    v_accvgpr_write_b32 a3, v166
    v_accvgpr_write_b32 a4, v168
    v_accvgpr_write_b32 a5, v170
    v_accvgpr_write_b32 a6, v172
    v_accvgpr_write_b32 a7, v174
    v_lshlrev_b32 v160, 16, v8
    v_and_b32 v161, 0xffff0000, v8
    v_lshlrev_b32 v162, 16, v9
    v_and_b32 v163, 0xffff0000, v9
    v_lshlrev_b32 v164, 16, v10
    v_and_b32 v165, 0xffff0000, v10
    v_lshlrev_b32 v166, 16, v11
    v_and_b32 v167, 0xffff0000, v11
    v_lshlrev_b32 v168, 16, v12
    v_and_b32 v169, 0xffff0000, v12
    v_lshlrev_b32 v170, 16, v13
    v_and_b32 v171, 0xffff0000, v13
    v_lshlrev_b32 v172, 16, v14
    v_and_b32 v173, 0xffff0000, v14
    v_lshlrev_b32 v174, 16, v15
    v_and_b32 v175, 0xffff0000, v15
    v_pk_add_f32 v[160:161], v[160:161], v[154:155] op_sel_hi:[1,0] neg_lo:[0,1] neg_hi:[0,1]
    v_pk_add_f32 v[162:163], v[162:163], v[154:155] op_sel_hi:[1,0] neg_lo:[0,1] neg_hi:[0,1]
    v_pk_add_f32 v[164:165], v[164:165], v[154:155] op_sel_hi:[1,0] neg_lo:[0,1] neg_hi:[0,1]
    v_pk_add_f32 v[166:167], v[166:167], v[154:155] op_sel_hi:[1,0] neg_lo:[0,1] neg_hi:[0,1]
    v_pk_add_f32 v[168:169], v[168:169], v[154:155] op_sel_hi:[1,0] neg_lo:[0,1] neg_hi:[0,1]
    v_pk_add_f32 v[170:171], v[170:171], v[154:155] op_sel_hi:[1,0] neg_lo:[0,1] neg_hi:[0,1]
    v_pk_add_f32 v[172:173], v[172:173], v[154:155] op_sel_hi:[1,0] neg_lo:[0,1] neg_hi:[0,1]
    v_pk_add_f32 v[174:175], v[174:175], v[154:155] op_sel_hi:[1,0] neg_lo:[0,1] neg_hi:[0,1]
    v_cvt_pk_bf16_f32 v8, v160, v161
    v_cvt_pk_bf16_f32 v9, v162, v163
    v_cvt_pk_bf16_f32 v10, v164, v165
    v_cvt_pk_bf16_f32 v11, v166, v167
    v_cvt_pk_bf16_f32 v12, v168, v169
    v_cvt_pk_bf16_f32 v13, v170, v171
    v_cvt_pk_bf16_f32 v14, v172, v173
    v_cvt_pk_bf16_f32 v15, v174, v175
    v_lshlrev_b32 v160, 16, v8
    v_and_b32 v161, 0xffff0000, v8
    v_lshlrev_b32 v162, 16, v9
    v_and_b32 v163, 0xffff0000, v9
    v_lshlrev_b32 v164, 16, v10
    v_and_b32 v165, 0xffff0000, v10
    v_lshlrev_b32 v166, 16, v11
    v_and_b32 v167, 0xffff0000, v11
    v_lshlrev_b32 v168, 16, v12
    v_and_b32 v169, 0xffff0000, v12
    v_lshlrev_b32 v170, 16, v13
    v_and_b32 v171, 0xffff0000, v13
    v_lshlrev_b32 v172, 16, v14
    v_and_b32 v173, 0xffff0000, v14
    v_lshlrev_b32 v174, 16, v15
    v_and_b32 v175, 0xffff0000, v15
    v_pk_mul_f32 v[160:161], v[160:161], v[152:153] op_sel_hi:[1,0]
    v_pk_mul_f32 v[162:163], v[162:163], v[152:153] op_sel_hi:[1,0]
    v_pk_mul_f32 v[164:165], v[164:165], v[152:153] op_sel_hi:[1,0]
    v_pk_mul_f32 v[166:167], v[166:167], v[152:153] op_sel_hi:[1,0]
    v_pk_mul_f32 v[168:169], v[168:169], v[152:153] op_sel_hi:[1,0]
    v_pk_mul_f32 v[170:171], v[170:171], v[152:153] op_sel_hi:[1,0]
    v_pk_mul_f32 v[172:173], v[172:173], v[152:153] op_sel_hi:[1,0]
    v_pk_mul_f32 v[174:175], v[174:175], v[152:153] op_sel_hi:[1,0]
    v_cvt_pk_bf16_f32 v160, v160, v161
    v_cvt_pk_bf16_f32 v162, v162, v163
    v_cvt_pk_bf16_f32 v164, v164, v165
    v_cvt_pk_bf16_f32 v166, v166, v167
    v_cvt_pk_bf16_f32 v168, v168, v169
    v_cvt_pk_bf16_f32 v170, v170, v171
    v_cvt_pk_bf16_f32 v172, v172, v173
    v_cvt_pk_bf16_f32 v174, v174, v175
    v_accvgpr_write_b32 a8, v160
    v_accvgpr_write_b32 a9, v162
    v_accvgpr_write_b32 a10, v164
    v_accvgpr_write_b32 a11, v166
    v_accvgpr_write_b32 a12, v168
    v_accvgpr_write_b32 a13, v170
    v_accvgpr_write_b32 a14, v172
    v_accvgpr_write_b32 a15, v174
    v_lshlrev_b32 v160, 16, v16
    v_and_b32 v161, 0xffff0000, v16
    v_lshlrev_b32 v162, 16, v17
    v_and_b32 v163, 0xffff0000, v17
    v_lshlrev_b32 v164, 16, v18
    v_and_b32 v165, 0xffff0000, v18
    v_lshlrev_b32 v166, 16, v19
    v_and_b32 v167, 0xffff0000, v19
    v_lshlrev_b32 v168, 16, v20
    v_and_b32 v169, 0xffff0000, v20
    v_lshlrev_b32 v170, 16, v21
    v_and_b32 v171, 0xffff0000, v21
    v_lshlrev_b32 v172, 16, v22
    v_and_b32 v173, 0xffff0000, v22
    v_lshlrev_b32 v174, 16, v23
    v_and_b32 v175, 0xffff0000, v23
    v_pk_add_f32 v[160:161], v[160:161], v[154:155] op_sel_hi:[1,0] neg_lo:[0,1] neg_hi:[0,1]
    v_pk_add_f32 v[162:163], v[162:163], v[154:155] op_sel_hi:[1,0] neg_lo:[0,1] neg_hi:[0,1]
    v_pk_add_f32 v[164:165], v[164:165], v[154:155] op_sel_hi:[1,0] neg_lo:[0,1] neg_hi:[0,1]
    v_pk_add_f32 v[166:167], v[166:167], v[154:155] op_sel_hi:[1,0] neg_lo:[0,1] neg_hi:[0,1]
    v_pk_add_f32 v[168:169], v[168:169], v[154:155] op_sel_hi:[1,0] neg_lo:[0,1] neg_hi:[0,1]
    v_pk_add_f32 v[170:171], v[170:171], v[154:155] op_sel_hi:[1,0] neg_lo:[0,1] neg_hi:[0,1]
    v_pk_add_f32 v[172:173], v[172:173], v[154:155] op_sel_hi:[1,0] neg_lo:[0,1] neg_hi:[0,1]
    v_pk_add_f32 v[174:175], v[174:175], v[154:155] op_sel_hi:[1,0] neg_lo:[0,1] neg_hi:[0,1]
    v_cvt_pk_bf16_f32 v16, v160, v161
    v_cvt_pk_bf16_f32 v17, v162, v163
    v_cvt_pk_bf16_f32 v18, v164, v165
    v_cvt_pk_bf16_f32 v19, v166, v167
    v_cvt_pk_bf16_f32 v20, v168, v169
    v_cvt_pk_bf16_f32 v21, v170, v171
    v_cvt_pk_bf16_f32 v22, v172, v173
    v_cvt_pk_bf16_f32 v23, v174, v175
    v_lshlrev_b32 v160, 16, v16
    v_and_b32 v161, 0xffff0000, v16
    v_lshlrev_b32 v162, 16, v17
    v_and_b32 v163, 0xffff0000, v17
    v_lshlrev_b32 v164, 16, v18
    v_and_b32 v165, 0xffff0000, v18
    v_lshlrev_b32 v166, 16, v19
    v_and_b32 v167, 0xffff0000, v19
    v_lshlrev_b32 v168, 16, v20
    v_and_b32 v169, 0xffff0000, v20
    v_lshlrev_b32 v170, 16, v21
    v_and_b32 v171, 0xffff0000, v21
    v_lshlrev_b32 v172, 16, v22
    v_and_b32 v173, 0xffff0000, v22
    v_lshlrev_b32 v174, 16, v23
    v_and_b32 v175, 0xffff0000, v23
    v_pk_mul_f32 v[160:161], v[160:161], v[152:153] op_sel_hi:[1,0]
    v_pk_mul_f32 v[162:163], v[162:163], v[152:153] op_sel_hi:[1,0]
    v_pk_mul_f32 v[164:165], v[164:165], v[152:153] op_sel_hi:[1,0]
    v_pk_mul_f32 v[166:167], v[166:167], v[152:153] op_sel_hi:[1,0]
    v_pk_mul_f32 v[168:169], v[168:169], v[152:153] op_sel_hi:[1,0]
    v_pk_mul_f32 v[170:171], v[170:171], v[152:153] op_sel_hi:[1,0]
    v_pk_mul_f32 v[172:173], v[172:173], v[152:153] op_sel_hi:[1,0]
    v_pk_mul_f32 v[174:175], v[174:175], v[152:153] op_sel_hi:[1,0]
    v_cvt_pk_bf16_f32 v160, v160, v161
    v_cvt_pk_bf16_f32 v162, v162, v163
    v_cvt_pk_bf16_f32 v164, v164, v165
    v_cvt_pk_bf16_f32 v166, v166, v167
    v_cvt_pk_bf16_f32 v168, v168, v169
    v_cvt_pk_bf16_f32 v170, v170, v171
    v_cvt_pk_bf16_f32 v172, v172, v173
    v_cvt_pk_bf16_f32 v174, v174, v175
    v_accvgpr_write_b32 a16, v160
    v_accvgpr_write_b32 a17, v162
    v_accvgpr_write_b32 a18, v164
    v_accvgpr_write_b32 a19, v166
    v_accvgpr_write_b32 a20, v168
    v_accvgpr_write_b32 a21, v170
    v_accvgpr_write_b32 a22, v172
    v_accvgpr_write_b32 a23, v174
    v_lshlrev_b32 v160, 16, v24
    v_and_b32 v161, 0xffff0000, v24
    v_lshlrev_b32 v162, 16, v25
    v_and_b32 v163, 0xffff0000, v25
    v_lshlrev_b32 v164, 16, v26
    v_and_b32 v165, 0xffff0000, v26
    v_lshlrev_b32 v166, 16, v27
    v_and_b32 v167, 0xffff0000, v27
    v_lshlrev_b32 v168, 16, v28
    v_and_b32 v169, 0xffff0000, v28
    v_lshlrev_b32 v170, 16, v29
    v_and_b32 v171, 0xffff0000, v29
    v_lshlrev_b32 v172, 16, v30
    v_and_b32 v173, 0xffff0000, v30
    v_lshlrev_b32 v174, 16, v31
    v_and_b32 v175, 0xffff0000, v31
    v_pk_add_f32 v[160:161], v[160:161], v[154:155] op_sel_hi:[1,0] neg_lo:[0,1] neg_hi:[0,1]
    v_pk_add_f32 v[162:163], v[162:163], v[154:155] op_sel_hi:[1,0] neg_lo:[0,1] neg_hi:[0,1]
    v_pk_add_f32 v[164:165], v[164:165], v[154:155] op_sel_hi:[1,0] neg_lo:[0,1] neg_hi:[0,1]
    v_pk_add_f32 v[166:167], v[166:167], v[154:155] op_sel_hi:[1,0] neg_lo:[0,1] neg_hi:[0,1]
    v_pk_add_f32 v[168:169], v[168:169], v[154:155] op_sel_hi:[1,0] neg_lo:[0,1] neg_hi:[0,1]
    v_pk_add_f32 v[170:171], v[170:171], v[154:155] op_sel_hi:[1,0] neg_lo:[0,1] neg_hi:[0,1]
    v_pk_add_f32 v[172:173], v[172:173], v[154:155] op_sel_hi:[1,0] neg_lo:[0,1] neg_hi:[0,1]
    v_pk_add_f32 v[174:175], v[174:175], v[154:155] op_sel_hi:[1,0] neg_lo:[0,1] neg_hi:[0,1]
    v_cvt_pk_bf16_f32 v24, v160, v161
    v_cvt_pk_bf16_f32 v25, v162, v163
    v_cvt_pk_bf16_f32 v26, v164, v165
    v_cvt_pk_bf16_f32 v27, v166, v167
    v_cvt_pk_bf16_f32 v28, v168, v169
    v_cvt_pk_bf16_f32 v29, v170, v171
    v_cvt_pk_bf16_f32 v30, v172, v173
    v_cvt_pk_bf16_f32 v31, v174, v175
    v_lshlrev_b32 v160, 16, v24
    v_and_b32 v161, 0xffff0000, v24
    v_lshlrev_b32 v162, 16, v25
    v_and_b32 v163, 0xffff0000, v25
    v_lshlrev_b32 v164, 16, v26
    v_and_b32 v165, 0xffff0000, v26
    v_lshlrev_b32 v166, 16, v27
    v_and_b32 v167, 0xffff0000, v27
    v_lshlrev_b32 v168, 16, v28
    v_and_b32 v169, 0xffff0000, v28
    v_lshlrev_b32 v170, 16, v29
    v_and_b32 v171, 0xffff0000, v29
    v_lshlrev_b32 v172, 16, v30
    v_and_b32 v173, 0xffff0000, v30
    v_lshlrev_b32 v174, 16, v31
    v_and_b32 v175, 0xffff0000, v31
    v_pk_mul_f32 v[160:161], v[160:161], v[152:153] op_sel_hi:[1,0]
    v_pk_mul_f32 v[162:163], v[162:163], v[152:153] op_sel_hi:[1,0]
    v_pk_mul_f32 v[164:165], v[164:165], v[152:153] op_sel_hi:[1,0]
    v_pk_mul_f32 v[166:167], v[166:167], v[152:153] op_sel_hi:[1,0]
    v_pk_mul_f32 v[168:169], v[168:169], v[152:153] op_sel_hi:[1,0]
    v_pk_mul_f32 v[170:171], v[170:171], v[152:153] op_sel_hi:[1,0]
    v_pk_mul_f32 v[172:173], v[172:173], v[152:153] op_sel_hi:[1,0]
    v_pk_mul_f32 v[174:175], v[174:175], v[152:153] op_sel_hi:[1,0]
    v_cvt_pk_bf16_f32 v160, v160, v161
    v_cvt_pk_bf16_f32 v162, v162, v163
    v_cvt_pk_bf16_f32 v164, v164, v165
    v_cvt_pk_bf16_f32 v166, v166, v167
    v_cvt_pk_bf16_f32 v168, v168, v169
    v_cvt_pk_bf16_f32 v170, v170, v171
    v_cvt_pk_bf16_f32 v172, v172, v173
    v_cvt_pk_bf16_f32 v174, v174, v175
    v_accvgpr_write_b32 a24, v160
    v_accvgpr_write_b32 a25, v162
    v_accvgpr_write_b32 a26, v164
    v_accvgpr_write_b32 a27, v166
    v_accvgpr_write_b32 a28, v168
    v_accvgpr_write_b32 a29, v170
    v_accvgpr_write_b32 a30, v172
    v_accvgpr_write_b32 a31, v174
    v_lshlrev_b32 v160, 16, v32
    v_and_b32 v161, 0xffff0000, v32
    v_lshlrev_b32 v162, 16, v33
    v_and_b32 v163, 0xffff0000, v33
    v_lshlrev_b32 v164, 16, v34
    v_and_b32 v165, 0xffff0000, v34
    v_lshlrev_b32 v166, 16, v35
    v_and_b32 v167, 0xffff0000, v35
    v_lshlrev_b32 v168, 16, v36
    v_and_b32 v169, 0xffff0000, v36
    v_lshlrev_b32 v170, 16, v37
    v_and_b32 v171, 0xffff0000, v37
    v_lshlrev_b32 v172, 16, v38
    v_and_b32 v173, 0xffff0000, v38
    v_lshlrev_b32 v174, 16, v39
    v_and_b32 v175, 0xffff0000, v39
    v_pk_add_f32 v[160:161], v[160:161], v[154:155] op_sel_hi:[1,0] neg_lo:[0,1] neg_hi:[0,1]
    v_pk_add_f32 v[162:163], v[162:163], v[154:155] op_sel_hi:[1,0] neg_lo:[0,1] neg_hi:[0,1]
    v_pk_add_f32 v[164:165], v[164:165], v[154:155] op_sel_hi:[1,0] neg_lo:[0,1] neg_hi:[0,1]
    v_pk_add_f32 v[166:167], v[166:167], v[154:155] op_sel_hi:[1,0] neg_lo:[0,1] neg_hi:[0,1]
    v_pk_add_f32 v[168:169], v[168:169], v[154:155] op_sel_hi:[1,0] neg_lo:[0,1] neg_hi:[0,1]
    v_pk_add_f32 v[170:171], v[170:171], v[154:155] op_sel_hi:[1,0] neg_lo:[0,1] neg_hi:[0,1]
    v_pk_add_f32 v[172:173], v[172:173], v[154:155] op_sel_hi:[1,0] neg_lo:[0,1] neg_hi:[0,1]
    v_pk_add_f32 v[174:175], v[174:175], v[154:155] op_sel_hi:[1,0] neg_lo:[0,1] neg_hi:[0,1]
    v_cvt_pk_bf16_f32 v32, v160, v161
    v_cvt_pk_bf16_f32 v33, v162, v163
    v_cvt_pk_bf16_f32 v34, v164, v165
    v_cvt_pk_bf16_f32 v35, v166, v167
    v_cvt_pk_bf16_f32 v36, v168, v169
    v_cvt_pk_bf16_f32 v37, v170, v171
    v_cvt_pk_bf16_f32 v38, v172, v173
    v_cvt_pk_bf16_f32 v39, v174, v175
    v_lshlrev_b32 v160, 16, v32
    v_and_b32 v161, 0xffff0000, v32
    v_lshlrev_b32 v162, 16, v33
    v_and_b32 v163, 0xffff0000, v33
    v_lshlrev_b32 v164, 16, v34
    v_and_b32 v165, 0xffff0000, v34
    v_lshlrev_b32 v166, 16, v35
    v_and_b32 v167, 0xffff0000, v35
    v_lshlrev_b32 v168, 16, v36
    v_and_b32 v169, 0xffff0000, v36
    v_lshlrev_b32 v170, 16, v37
    v_and_b32 v171, 0xffff0000, v37
    v_lshlrev_b32 v172, 16, v38
    v_and_b32 v173, 0xffff0000, v38
    v_lshlrev_b32 v174, 16, v39
    v_and_b32 v175, 0xffff0000, v39
    v_pk_mul_f32 v[160:161], v[160:161], v[152:153] op_sel_hi:[1,0]
    v_pk_mul_f32 v[162:163], v[162:163], v[152:153] op_sel_hi:[1,0]
    v_pk_mul_f32 v[164:165], v[164:165], v[152:153] op_sel_hi:[1,0]
    v_pk_mul_f32 v[166:167], v[166:167], v[152:153] op_sel_hi:[1,0]
    v_pk_mul_f32 v[168:169], v[168:169], v[152:153] op_sel_hi:[1,0]
    v_pk_mul_f32 v[170:171], v[170:171], v[152:153] op_sel_hi:[1,0]
    v_pk_mul_f32 v[172:173], v[172:173], v[152:153] op_sel_hi:[1,0]
    v_pk_mul_f32 v[174:175], v[174:175], v[152:153] op_sel_hi:[1,0]
    v_cvt_pk_bf16_f32 v160, v160, v161
    v_cvt_pk_bf16_f32 v162, v162, v163
    v_cvt_pk_bf16_f32 v164, v164, v165
    v_cvt_pk_bf16_f32 v166, v166, v167
    v_cvt_pk_bf16_f32 v168, v168, v169
    v_cvt_pk_bf16_f32 v170, v170, v171
    v_cvt_pk_bf16_f32 v172, v172, v173
    v_cvt_pk_bf16_f32 v174, v174, v175
    v_accvgpr_write_b32 a32, v160
    v_accvgpr_write_b32 a33, v162
    v_accvgpr_write_b32 a34, v164
    v_accvgpr_write_b32 a35, v166
    v_accvgpr_write_b32 a36, v168
    v_accvgpr_write_b32 a37, v170
    v_accvgpr_write_b32 a38, v172
    v_accvgpr_write_b32 a39, v174
    v_lshlrev_b32 v160, 16, v40
    v_and_b32 v161, 0xffff0000, v40
    v_lshlrev_b32 v162, 16, v41
    v_and_b32 v163, 0xffff0000, v41
    v_lshlrev_b32 v164, 16, v42
    v_and_b32 v165, 0xffff0000, v42
    v_lshlrev_b32 v166, 16, v43
    v_and_b32 v167, 0xffff0000, v43
    v_lshlrev_b32 v168, 16, v44
    v_and_b32 v169, 0xffff0000, v44
    v_lshlrev_b32 v170, 16, v45
    v_and_b32 v171, 0xffff0000, v45
    v_lshlrev_b32 v172, 16, v46
    v_and_b32 v173, 0xffff0000, v46
    v_lshlrev_b32 v174, 16, v47
    v_and_b32 v175, 0xffff0000, v47
    v_pk_add_f32 v[160:161], v[160:161], v[154:155] op_sel_hi:[1,0] neg_lo:[0,1] neg_hi:[0,1]
    v_pk_add_f32 v[162:163], v[162:163], v[154:155] op_sel_hi:[1,0] neg_lo:[0,1] neg_hi:[0,1]
    v_pk_add_f32 v[164:165], v[164:165], v[154:155] op_sel_hi:[1,0] neg_lo:[0,1] neg_hi:[0,1]
    v_pk_add_f32 v[166:167], v[166:167], v[154:155] op_sel_hi:[1,0] neg_lo:[0,1] neg_hi:[0,1]
    v_pk_add_f32 v[168:169], v[168:169], v[154:155] op_sel_hi:[1,0] neg_lo:[0,1] neg_hi:[0,1]
    v_pk_add_f32 v[170:171], v[170:171], v[154:155] op_sel_hi:[1,0] neg_lo:[0,1] neg_hi:[0,1]
    v_pk_add_f32 v[172:173], v[172:173], v[154:155] op_sel_hi:[1,0] neg_lo:[0,1] neg_hi:[0,1]
    v_pk_add_f32 v[174:175], v[174:175], v[154:155] op_sel_hi:[1,0] neg_lo:[0,1] neg_hi:[0,1]
    v_cvt_pk_bf16_f32 v40, v160, v161
    v_cvt_pk_bf16_f32 v41, v162, v163
    v_cvt_pk_bf16_f32 v42, v164, v165
    v_cvt_pk_bf16_f32 v43, v166, v167
    v_cvt_pk_bf16_f32 v44, v168, v169
    v_cvt_pk_bf16_f32 v45, v170, v171
    v_cvt_pk_bf16_f32 v46, v172, v173
    v_cvt_pk_bf16_f32 v47, v174, v175
    v_lshlrev_b32 v160, 16, v40
    v_and_b32 v161, 0xffff0000, v40
    v_lshlrev_b32 v162, 16, v41
    v_and_b32 v163, 0xffff0000, v41
    v_lshlrev_b32 v164, 16, v42
    v_and_b32 v165, 0xffff0000, v42
    v_lshlrev_b32 v166, 16, v43
    v_and_b32 v167, 0xffff0000, v43
    v_lshlrev_b32 v168, 16, v44
    v_and_b32 v169, 0xffff0000, v44
    v_lshlrev_b32 v170, 16, v45
    v_and_b32 v171, 0xffff0000, v45
    v_lshlrev_b32 v172, 16, v46
    v_and_b32 v173, 0xffff0000, v46
    v_lshlrev_b32 v174, 16, v47
    v_and_b32 v175, 0xffff0000, v47
    v_pk_mul_f32 v[160:161], v[160:161], v[152:153] op_sel_hi:[1,0]
    v_pk_mul_f32 v[162:163], v[162:163], v[152:153] op_sel_hi:[1,0]
    v_pk_mul_f32 v[164:165], v[164:165], v[152:153] op_sel_hi:[1,0]
    v_pk_mul_f32 v[166:167], v[166:167], v[152:153] op_sel_hi:[1,0]
    v_pk_mul_f32 v[168:169], v[168:169], v[152:153] op_sel_hi:[1,0]
    v_pk_mul_f32 v[170:171], v[170:171], v[152:153] op_sel_hi:[1,0]
    v_pk_mul_f32 v[172:173], v[172:173], v[152:153] op_sel_hi:[1,0]
    v_pk_mul_f32 v[174:175], v[174:175], v[152:153] op_sel_hi:[1,0]
    v_cvt_pk_bf16_f32 v160, v160, v161
    v_cvt_pk_bf16_f32 v162, v162, v163
    v_cvt_pk_bf16_f32 v164, v164, v165
    v_cvt_pk_bf16_f32 v166, v166, v167
    v_cvt_pk_bf16_f32 v168, v168, v169
    v_cvt_pk_bf16_f32 v170, v170, v171
    v_cvt_pk_bf16_f32 v172, v172, v173
    v_cvt_pk_bf16_f32 v174, v174, v175
    v_accvgpr_write_b32 a40, v160
    v_accvgpr_write_b32 a41, v162
    v_accvgpr_write_b32 a42, v164
    v_accvgpr_write_b32 a43, v166
    v_accvgpr_write_b32 a44, v168
    v_accvgpr_write_b32 a45, v170
    v_accvgpr_write_b32 a46, v172
    v_accvgpr_write_b32 a47, v174
    v_lshlrev_b32 v160, 16, v48
    v_and_b32 v161, 0xffff0000, v48
    v_lshlrev_b32 v162, 16, v49
    v_and_b32 v163, 0xffff0000, v49
    v_lshlrev_b32 v164, 16, v50
    v_and_b32 v165, 0xffff0000, v50
    v_lshlrev_b32 v166, 16, v51
    v_and_b32 v167, 0xffff0000, v51
    v_lshlrev_b32 v168, 16, v52
    v_and_b32 v169, 0xffff0000, v52
    v_lshlrev_b32 v170, 16, v53
    v_and_b32 v171, 0xffff0000, v53
    v_lshlrev_b32 v172, 16, v54
    v_and_b32 v173, 0xffff0000, v54
    v_lshlrev_b32 v174, 16, v55
    v_and_b32 v175, 0xffff0000, v55
    v_pk_add_f32 v[160:161], v[160:161], v[154:155] op_sel_hi:[1,0] neg_lo:[0,1] neg_hi:[0,1]
    v_pk_add_f32 v[162:163], v[162:163], v[154:155] op_sel_hi:[1,0] neg_lo:[0,1] neg_hi:[0,1]
    v_pk_add_f32 v[164:165], v[164:165], v[154:155] op_sel_hi:[1,0] neg_lo:[0,1] neg_hi:[0,1]
    v_pk_add_f32 v[166:167], v[166:167], v[154:155] op_sel_hi:[1,0] neg_lo:[0,1] neg_hi:[0,1]
    v_pk_add_f32 v[168:169], v[168:169], v[154:155] op_sel_hi:[1,0] neg_lo:[0,1] neg_hi:[0,1]
    v_pk_add_f32 v[170:171], v[170:171], v[154:155] op_sel_hi:[1,0] neg_lo:[0,1] neg_hi:[0,1]
    v_pk_add_f32 v[172:173], v[172:173], v[154:155] op_sel_hi:[1,0] neg_lo:[0,1] neg_hi:[0,1]
    v_pk_add_f32 v[174:175], v[174:175], v[154:155] op_sel_hi:[1,0] neg_lo:[0,1] neg_hi:[0,1]
    v_cvt_pk_bf16_f32 v48, v160, v161
    v_cvt_pk_bf16_f32 v49, v162, v163
    v_cvt_pk_bf16_f32 v50, v164, v165
    v_cvt_pk_bf16_f32 v51, v166, v167
    v_cvt_pk_bf16_f32 v52, v168, v169
    v_cvt_pk_bf16_f32 v53, v170, v171
    v_cvt_pk_bf16_f32 v54, v172, v173
    v_cvt_pk_bf16_f32 v55, v174, v175
    v_lshlrev_b32 v160, 16, v48
    v_and_b32 v161, 0xffff0000, v48
    v_lshlrev_b32 v162, 16, v49
    v_and_b32 v163, 0xffff0000, v49
    v_lshlrev_b32 v164, 16, v50
    v_and_b32 v165, 0xffff0000, v50
    v_lshlrev_b32 v166, 16, v51
    v_and_b32 v167, 0xffff0000, v51
    v_lshlrev_b32 v168, 16, v52
    v_and_b32 v169, 0xffff0000, v52
    v_lshlrev_b32 v170, 16, v53
    v_and_b32 v171, 0xffff0000, v53
    v_lshlrev_b32 v172, 16, v54
    v_and_b32 v173, 0xffff0000, v54
    v_lshlrev_b32 v174, 16, v55
    v_and_b32 v175, 0xffff0000, v55
    v_pk_mul_f32 v[160:161], v[160:161], v[152:153] op_sel_hi:[1,0]
    v_pk_mul_f32 v[162:163], v[162:163], v[152:153] op_sel_hi:[1,0]
    v_pk_mul_f32 v[164:165], v[164:165], v[152:153] op_sel_hi:[1,0]
    v_pk_mul_f32 v[166:167], v[166:167], v[152:153] op_sel_hi:[1,0]
    v_pk_mul_f32 v[168:169], v[168:169], v[152:153] op_sel_hi:[1,0]
    v_pk_mul_f32 v[170:171], v[170:171], v[152:153] op_sel_hi:[1,0]
    v_pk_mul_f32 v[172:173], v[172:173], v[152:153] op_sel_hi:[1,0]
    v_pk_mul_f32 v[174:175], v[174:175], v[152:153] op_sel_hi:[1,0]
    v_cvt_pk_bf16_f32 v160, v160, v161
    v_cvt_pk_bf16_f32 v162, v162, v163
    v_cvt_pk_bf16_f32 v164, v164, v165
    v_cvt_pk_bf16_f32 v166, v166, v167
    v_cvt_pk_bf16_f32 v168, v168, v169
    v_cvt_pk_bf16_f32 v170, v170, v171
    v_cvt_pk_bf16_f32 v172, v172, v173
    v_cvt_pk_bf16_f32 v174, v174, v175
    v_accvgpr_write_b32 a48, v160
    v_accvgpr_write_b32 a49, v162
    v_accvgpr_write_b32 a50, v164
    v_accvgpr_write_b32 a51, v166
    v_accvgpr_write_b32 a52, v168
    v_accvgpr_write_b32 a53, v170
    v_accvgpr_write_b32 a54, v172
    v_accvgpr_write_b32 a55, v174
    v_lshlrev_b32 v160, 16, v56
    v_and_b32 v161, 0xffff0000, v56
    v_lshlrev_b32 v162, 16, v57
    v_and_b32 v163, 0xffff0000, v57
    v_lshlrev_b32 v164, 16, v58
    v_and_b32 v165, 0xffff0000, v58
    v_lshlrev_b32 v166, 16, v59
    v_and_b32 v167, 0xffff0000, v59
    v_lshlrev_b32 v168, 16, v60
    v_and_b32 v169, 0xffff0000, v60
    v_lshlrev_b32 v170, 16, v61
    v_and_b32 v171, 0xffff0000, v61
    v_lshlrev_b32 v172, 16, v62
    v_and_b32 v173, 0xffff0000, v62
    v_lshlrev_b32 v174, 16, v63
    v_and_b32 v175, 0xffff0000, v63
    v_pk_add_f32 v[160:161], v[160:161], v[154:155] op_sel_hi:[1,0] neg_lo:[0,1] neg_hi:[0,1]
    v_pk_add_f32 v[162:163], v[162:163], v[154:155] op_sel_hi:[1,0] neg_lo:[0,1] neg_hi:[0,1]
    v_pk_add_f32 v[164:165], v[164:165], v[154:155] op_sel_hi:[1,0] neg_lo:[0,1] neg_hi:[0,1]
    v_pk_add_f32 v[166:167], v[166:167], v[154:155] op_sel_hi:[1,0] neg_lo:[0,1] neg_hi:[0,1]
    v_pk_add_f32 v[168:169], v[168:169], v[154:155] op_sel_hi:[1,0] neg_lo:[0,1] neg_hi:[0,1]
    v_pk_add_f32 v[170:171], v[170:171], v[154:155] op_sel_hi:[1,0] neg_lo:[0,1] neg_hi:[0,1]
    v_pk_add_f32 v[172:173], v[172:173], v[154:155] op_sel_hi:[1,0] neg_lo:[0,1] neg_hi:[0,1]
    v_pk_add_f32 v[174:175], v[174:175], v[154:155] op_sel_hi:[1,0] neg_lo:[0,1] neg_hi:[0,1]
    v_cvt_pk_bf16_f32 v56, v160, v161
    v_cvt_pk_bf16_f32 v57, v162, v163
    v_cvt_pk_bf16_f32 v58, v164, v165
    v_cvt_pk_bf16_f32 v59, v166, v167
    v_cvt_pk_bf16_f32 v60, v168, v169
    v_cvt_pk_bf16_f32 v61, v170, v171
    v_cvt_pk_bf16_f32 v62, v172, v173
    v_cvt_pk_bf16_f32 v63, v174, v175
    v_lshlrev_b32 v160, 16, v56
    v_and_b32 v161, 0xffff0000, v56
    v_lshlrev_b32 v162, 16, v57
    v_and_b32 v163, 0xffff0000, v57
    v_lshlrev_b32 v164, 16, v58
    v_and_b32 v165, 0xffff0000, v58
    v_lshlrev_b32 v166, 16, v59
    v_and_b32 v167, 0xffff0000, v59
    v_lshlrev_b32 v168, 16, v60
    v_and_b32 v169, 0xffff0000, v60
    v_lshlrev_b32 v170, 16, v61
    v_and_b32 v171, 0xffff0000, v61
    v_lshlrev_b32 v172, 16, v62
    v_and_b32 v173, 0xffff0000, v62
    v_lshlrev_b32 v174, 16, v63
    v_and_b32 v175, 0xffff0000, v63
    v_pk_mul_f32 v[160:161], v[160:161], v[152:153] op_sel_hi:[1,0]
    v_pk_mul_f32 v[162:163], v[162:163], v[152:153] op_sel_hi:[1,0]
    v_pk_mul_f32 v[164:165], v[164:165], v[152:153] op_sel_hi:[1,0]
    v_pk_mul_f32 v[166:167], v[166:167], v[152:153] op_sel_hi:[1,0]
    v_pk_mul_f32 v[168:169], v[168:169], v[152:153] op_sel_hi:[1,0]
    v_pk_mul_f32 v[170:171], v[170:171], v[152:153] op_sel_hi:[1,0]
    v_pk_mul_f32 v[172:173], v[172:173], v[152:153] op_sel_hi:[1,0]
    v_pk_mul_f32 v[174:175], v[174:175], v[152:153] op_sel_hi:[1,0]
    v_cvt_pk_bf16_f32 v160, v160, v161
    v_cvt_pk_bf16_f32 v162, v162, v163
    v_cvt_pk_bf16_f32 v164, v164, v165
    v_cvt_pk_bf16_f32 v166, v166, v167
    v_cvt_pk_bf16_f32 v168, v168, v169
    v_cvt_pk_bf16_f32 v170, v170, v171
    v_cvt_pk_bf16_f32 v172, v172, v173
    v_cvt_pk_bf16_f32 v174, v174, v175
    v_accvgpr_write_b32 a56, v160
    v_accvgpr_write_b32 a57, v162
    v_accvgpr_write_b32 a58, v164
    v_accvgpr_write_b32 a59, v166
    v_accvgpr_write_b32 a60, v168
    v_accvgpr_write_b32 a61, v170
    v_accvgpr_write_b32 a62, v172
    v_accvgpr_write_b32 a63, v174
    s_waitcnt vmcnt(0)
    s_lshr_b32 s26, s39, 5
    s_cmp_eq_u32 s26, 0
    s_cselect_b64 s[16:17], s[30:31], s[34:35]
    s_cmp_eq_u32 s26, 1
    s_cselect_b64 s[16:17], s[32:33], s[16:17]
    s_and_b32 s17, s17, 0xffff
    s_cmp_lt_u32 s39, 96
    s_cselect_b32 s18, 0x400000, 0
    s_and_b32 s24, s39, 31
    s_lshl_b32 s24, s24, 8
    s_add_u32 s26, s24, 0x0
    s_add_u32 m0, s29, 0x0
    s_nop 0
    buffer_load_dwordx4 v136, s[16:19], s26 offen lds
    s_add_u32 s26, s24, 0x20000
    s_add_u32 m0, s29, 0x1000
    s_nop 0
    buffer_load_dwordx4 v136, s[16:19], s26 offen lds
    s_add_u32 s26, s24, 0x40000
    s_add_u32 m0, s29, 0x2000
    s_nop 0
    buffer_load_dwordx4 v136, s[16:19], s26 offen lds
    s_add_u32 s26, s24, 0x60000
    s_add_u32 m0, s29, 0x3000
    s_nop 0
    buffer_load_dwordx4 v136, s[16:19], s26 offen lds
    s_add_u32 s26, s24, 0x80000
    s_add_u32 m0, s29, 0x4000
    s_nop 0
    buffer_load_dwordx4 v136, s[16:19], s26 offen lds
    s_add_u32 s26, s24, 0xa0000
    s_add_u32 m0, s29, 0x5000
    s_nop 0
    buffer_load_dwordx4 v136, s[16:19], s26 offen lds
    s_add_u32 s26, s24, 0xc0000
    s_add_u32 m0, s29, 0x6000
    s_nop 0
    buffer_load_dwordx4 v136, s[16:19], s26 offen lds
    s_add_u32 s26, s24, 0xe0000
    s_add_u32 m0, s29, 0x7000
    s_nop 0
    buffer_load_dwordx4 v136, s[16:19], s26 offen lds
    s_add_u32 s26, s24, 0x100000
    s_add_u32 m0, s29, 0x8000
    s_nop 0
    buffer_load_dwordx4 v136, s[16:19], s26 offen lds
    s_add_u32 s26, s24, 0x120000
    s_add_u32 m0, s29, 0x9000
    s_nop 0
    buffer_load_dwordx4 v136, s[16:19], s26 offen lds
    s_add_u32 s26, s24, 0x140000
    s_add_u32 m0, s29, 0xa000
    s_nop 0
    buffer_load_dwordx4 v136, s[16:19], s26 offen lds
    s_add_u32 s26, s24, 0x160000
    s_add_u32 m0, s29, 0xb000
    s_nop 0
    buffer_load_dwordx4 v136, s[16:19], s26 offen lds
    s_add_u32 s26, s24, 0x180000
    s_add_u32 m0, s29, 0xc000
    s_nop 0
    buffer_load_dwordx4 v136, s[16:19], s26 offen lds
    s_add_u32 s26, s24, 0x1a0000
    s_add_u32 m0, s29, 0xd000
    s_nop 0
    buffer_load_dwordx4 v136, s[16:19], s26 offen lds
    s_add_u32 s26, s24, 0x1c0000
    s_add_u32 m0, s29, 0xe000
    s_nop 0
    buffer_load_dwordx4 v136, s[16:19], s26 offen lds
    s_add_u32 s26, s24, 0x1e0000
    s_add_u32 m0, s29, 0xf000
    s_nop 0
    buffer_load_dwordx4 v136, s[16:19], s26 offen lds
    s_add_u32 s26, s24, 0x200000
    s_add_u32 m0, s29, 0x10000
    s_nop 0
    buffer_load_dwordx4 v136, s[16:19], s26 offen lds
    s_add_u32 s26, s24, 0x220000
    s_add_u32 m0, s29, 0x11000
    s_nop 0
    buffer_load_dwordx4 v136, s[16:19], s26 offen lds
    s_add_u32 s26, s24, 0x240000
    s_add_u32 m0, s29, 0x12000
    s_nop 0
    buffer_load_dwordx4 v136, s[16:19], s26 offen lds
    s_add_u32 s26, s24, 0x260000
    s_add_u32 m0, s29, 0x13000
    s_nop 0
    buffer_load_dwordx4 v136, s[16:19], s26 offen lds
    s_add_u32 s26, s24, 0x280000
    s_add_u32 m0, s29, 0x14000
    s_nop 0
    buffer_load_dwordx4 v136, s[16:19], s26 offen lds
    s_add_u32 s26, s24, 0x2a0000
    s_add_u32 m0, s29, 0x15000
    s_nop 0
    buffer_load_dwordx4 v136, s[16:19], s26 offen lds
    s_add_u32 s26, s24, 0x2c0000
    s_add_u32 m0, s29, 0x16000
    s_nop 0
    buffer_load_dwordx4 v136, s[16:19], s26 offen lds
    s_add_u32 s26, s24, 0x2e0000
    s_add_u32 m0, s29, 0x17000
    s_nop 0
    buffer_load_dwordx4 v136, s[16:19], s26 offen lds
    v_pk_mov_b32 v[150:151], 0, 0
    v_pk_mov_b32 v[152:153], 0, 0
    v_dot2_f32_bf16 v150, v64, v158, v150
    v_dot2_f32_bf16 v152, v64, v64, v152
    v_dot2_f32_bf16 v151, v65, v158, v151
    v_dot2_f32_bf16 v153, v65, v65, v153
    v_dot2_f32_bf16 v150, v66, v158, v150
    v_dot2_f32_bf16 v152, v66, v66, v152
    v_dot2_f32_bf16 v151, v67, v158, v151
    v_dot2_f32_bf16 v153, v67, v67, v153
    v_dot2_f32_bf16 v150, v68, v158, v150
    v_dot2_f32_bf16 v152, v68, v68, v152
    v_dot2_f32_bf16 v151, v69, v158, v151
    v_dot2_f32_bf16 v153, v69, v69, v153
    v_dot2_f32_bf16 v150, v70, v158, v150
    v_dot2_f32_bf16 v152, v70, v70, v152
    v_dot2_f32_bf16 v151, v71, v158, v151
    v_dot2_f32_bf16 v153, v71, v71, v153
    v_dot2_f32_bf16 v150, v72, v158, v150
    v_dot2_f32_bf16 v152, v72, v72, v152
    v_dot2_f32_bf16 v151, v73, v158, v151
    v_dot2_f32_bf16 v153, v73, v73, v153
    v_dot2_f32_bf16 v150, v74, v158, v150
    v_dot2_f32_bf16 v152, v74, v74, v152
    v_dot2_f32_bf16 v151, v75, v158, v151
    v_dot2_f32_bf16 v153, v75, v75, v153
    v_dot2_f32_bf16 v150, v76, v158, v150
    v_dot2_f32_bf16 v152, v76, v76, v152
    v_dot2_f32_bf16 v151, v77, v158, v151
    v_dot2_f32_bf16 v153, v77, v77, v153
    v_dot2_f32_bf16 v150, v78, v158, v150
    v_dot2_f32_bf16 v152, v78, v78, v152
    v_dot2_f32_bf16 v151, v79, v158, v151
    v_dot2_f32_bf16 v153, v79, v79, v153
    v_dot2_f32_bf16 v150, v80, v158, v150
    v_dot2_f32_bf16 v152, v80, v80, v152
    v_dot2_f32_bf16 v151, v81, v158, v151
    v_dot2_f32_bf16 v153, v81, v81, v153
    v_dot2_f32_bf16 v150, v82, v158, v150
    v_dot2_f32_bf16 v152, v82, v82, v152
    v_dot2_f32_bf16 v151, v83, v158, v151
    v_dot2_f32_bf16 v153, v83, v83, v153
    v_dot2_f32_bf16 v150, v84, v158, v150
    v_dot2_f32_bf16 v152, v84, v84, v152
    v_dot2_f32_bf16 v151, v85, v158, v151
    v_dot2_f32_bf16 v153, v85, v85, v153
    v_dot2_f32_bf16 v150, v86, v158, v150
    v_dot2_f32_bf16 v152, v86, v86, v152
    v_dot2_f32_bf16 v151, v87, v158, v151
    v_dot2_f32_bf16 v153, v87, v87, v153
    v_dot2_f32_bf16 v150, v88, v158, v150
    v_dot2_f32_bf16 v152, v88, v88, v152
    v_dot2_f32_bf16 v151, v89, v158, v151
    v_dot2_f32_bf16 v153, v89, v89, v153
    v_dot2_f32_bf16 v150, v90, v158, v150
    v_dot2_f32_bf16 v152, v90, v90, v152
    v_dot2_f32_bf16 v151, v91, v158, v151
    v_dot2_f32_bf16 v153, v91, v91, v153
    v_dot2_f32_bf16 v150, v92, v158, v150
    v_dot2_f32_bf16 v152, v92, v92, v152
    v_dot2_f32_bf16 v151, v93, v158, v151
    v_dot2_f32_bf16 v153, v93, v93, v153
    v_dot2_f32_bf16 v150, v94, v158, v150
    v_dot2_f32_bf16 v152, v94, v94, v152
    v_dot2_f32_bf16 v151, v95, v158, v151
    v_dot2_f32_bf16 v153, v95, v95, v153
    v_dot2_f32_bf16 v150, v96, v158, v150
    v_dot2_f32_bf16 v152, v96, v96, v152
    v_dot2_f32_bf16 v151, v97, v158, v151
    v_dot2_f32_bf16 v153, v97, v97, v153
    v_dot2_f32_bf16 v150, v98, v158, v150
    v_dot2_f32_bf16 v152, v98, v98, v152
    v_dot2_f32_bf16 v151, v99, v158, v151
    v_dot2_f32_bf16 v153, v99, v99, v153
    v_dot2_f32_bf16 v150, v100, v158, v150
    v_dot2_f32_bf16 v152, v100, v100, v152
    v_dot2_f32_bf16 v151, v101, v158, v151
    v_dot2_f32_bf16 v153, v101, v101, v153
    v_dot2_f32_bf16 v150, v102, v158, v150
    v_dot2_f32_bf16 v152, v102, v102, v152
    v_dot2_f32_bf16 v151, v103, v158, v151
    v_dot2_f32_bf16 v153, v103, v103, v153
    v_dot2_f32_bf16 v150, v104, v158, v150
    v_dot2_f32_bf16 v152, v104, v104, v152
    v_dot2_f32_bf16 v151, v105, v158, v151
    v_dot2_f32_bf16 v153, v105, v105, v153
    v_dot2_f32_bf16 v150, v106, v158, v150
    v_dot2_f32_bf16 v152, v106, v106, v152
    v_dot2_f32_bf16 v151, v107, v158, v151
    v_dot2_f32_bf16 v153, v107, v107, v153
    v_dot2_f32_bf16 v150, v108, v158, v150
    v_dot2_f32_bf16 v152, v108, v108, v152
    v_dot2_f32_bf16 v151, v109, v158, v151
    v_dot2_f32_bf16 v153, v109, v109, v153
    v_dot2_f32_bf16 v150, v110, v158, v150
    v_dot2_f32_bf16 v152, v110, v110, v152
    v_dot2_f32_bf16 v151, v111, v158, v151
    v_dot2_f32_bf16 v153, v111, v111, v153
    v_dot2_f32_bf16 v150, v112, v158, v150
    v_dot2_f32_bf16 v152, v112, v112, v152
    v_dot2_f32_bf16 v151, v113, v158, v151
    v_dot2_f32_bf16 v153, v113, v113, v153
    v_dot2_f32_bf16 v150, v114, v158, v150
    v_dot2_f32_bf16 v152, v114, v114, v152
    v_dot2_f32_bf16 v151, v115, v158, v151
    v_dot2_f32_bf16 v153, v115, v115, v153
    v_dot2_f32_bf16 v150, v116, v158, v150
    v_dot2_f32_bf16 v152, v116, v116, v152
    v_dot2_f32_bf16 v151, v117, v158, v151
    v_dot2_f32_bf16 v153, v117, v117, v153
    v_dot2_f32_bf16 v150, v118, v158, v150
    v_dot2_f32_bf16 v152, v118, v118, v152
    v_dot2_f32_bf16 v151, v119, v158, v151
    v_dot2_f32_bf16 v153, v119, v119, v153
    v_dot2_f32_bf16 v150, v120, v158, v150
    v_dot2_f32_bf16 v152, v120, v120, v152
    v_dot2_f32_bf16 v151, v121, v158, v151
    v_dot2_f32_bf16 v153, v121, v121, v153
    v_dot2_f32_bf16 v150, v122, v158, v150
    v_dot2_f32_bf16 v152, v122, v122, v152
    v_dot2_f32_bf16 v151, v123, v158, v151
    v_dot2_f32_bf16 v153, v123, v123, v153
    v_dot2_f32_bf16 v150, v124, v158, v150
    v_dot2_f32_bf16 v152, v124, v124, v152
    v_dot2_f32_bf16 v151, v125, v158, v151
    v_dot2_f32_bf16 v153, v125, v125, v153
    v_dot2_f32_bf16 v150, v126, v158, v150
    v_dot2_f32_bf16 v152, v126, v126, v152
    v_dot2_f32_bf16 v151, v127, v158, v151
    v_dot2_f32_bf16 v153, v127, v127, v153
    s_nop 1
    v_add_f32 v150, v150, v151
    v_add_f32 v152, v152, v153
    v_mov_b32 v157, v150
    s_nop 1
    v_permlane32_swap_b32 v157, v150
    v_add_f32 v150, v157, v150
    v_mov_b32 v157, v150
    s_nop 1
    v_permlane16_swap_b32 v157, v150
    v_add_f32 v150, v157, v150
    v_mov_b32 v157, v152
    s_nop 1
    v_permlane32_swap_b32 v157, v152
    v_add_f32 v152, v157, v152
    v_mov_b32 v157, v152
    s_nop 1
    v_permlane16_swap_b32 v157, v152
    v_add_f32 v152, v157, v152
    v_mul_f32 v150, 0x3b000000, v150
    v_cvt_pk_bf16_f32 v154, v150, v150
    v_and_b32 v154, 0xffff0000, v154
    v_sub_f32 v156, v150, v154
    v_mul_f32 v157, v150, v150
    v_mul_f32 v152, 0x3b000000, v152
    v_sub_f32 v152, v152, v157
    v_max_f32 v152, 0, v152
    v_cvt_pk_bf16_f32 v152, v152, v152
    v_and_b32 v152, 0xffff0000, v152
    v_add_f32 v152, 0x3727c5ac, v152
    v_cvt_pk_bf16_f32 v152, v152, v152
    v_and_b32 v152, 0xffff0000, v152
    v_sqrt_f32 v152, v152
    s_nop 0
    v_cvt_pk_bf16_f32 v152, v152, v152
    v_and_b32 v152, 0xffff0000, v152
    v_rcp_f32 v152, v152
    v_lshlrev_b32 v160, 16, v64
    v_and_b32 v161, 0xffff0000, v64
    v_lshlrev_b32 v162, 16, v65
    v_and_b32 v163, 0xffff0000, v65
    v_lshlrev_b32 v164, 16, v66
    v_and_b32 v165, 0xffff0000, v66
    v_lshlrev_b32 v166, 16, v67
    v_and_b32 v167, 0xffff0000, v67
    v_lshlrev_b32 v168, 16, v68
    v_and_b32 v169, 0xffff0000, v68
    v_lshlrev_b32 v170, 16, v69
    v_and_b32 v171, 0xffff0000, v69
    v_lshlrev_b32 v172, 16, v70
    v_and_b32 v173, 0xffff0000, v70
    v_lshlrev_b32 v174, 16, v71
    v_and_b32 v175, 0xffff0000, v71
    v_pk_add_f32 v[160:161], v[160:161], v[154:155] op_sel_hi:[1,0] neg_lo:[0,1] neg_hi:[0,1]
    v_pk_add_f32 v[162:163], v[162:163], v[154:155] op_sel_hi:[1,0] neg_lo:[0,1] neg_hi:[0,1]
    v_pk_add_f32 v[164:165], v[164:165], v[154:155] op_sel_hi:[1,0] neg_lo:[0,1] neg_hi:[0,1]
    v_pk_add_f32 v[166:167], v[166:167], v[154:155] op_sel_hi:[1,0] neg_lo:[0,1] neg_hi:[0,1]
    v_pk_add_f32 v[168:169], v[168:169], v[154:155] op_sel_hi:[1,0] neg_lo:[0,1] neg_hi:[0,1]
    v_pk_add_f32 v[170:171], v[170:171], v[154:155] op_sel_hi:[1,0] neg_lo:[0,1] neg_hi:[0,1]
    v_pk_add_f32 v[172:173], v[172:173], v[154:155] op_sel_hi:[1,0] neg_lo:[0,1] neg_hi:[0,1]
    v_pk_add_f32 v[174:175], v[174:175], v[154:155] op_sel_hi:[1,0] neg_lo:[0,1] neg_hi:[0,1]
    v_cvt_pk_bf16_f32 v64, v160, v161
    v_cvt_pk_bf16_f32 v65, v162, v163
    v_cvt_pk_bf16_f32 v66, v164, v165
    v_cvt_pk_bf16_f32 v67, v166, v167
    v_cvt_pk_bf16_f32 v68, v168, v169
    v_cvt_pk_bf16_f32 v69, v170, v171
    v_cvt_pk_bf16_f32 v70, v172, v173
    v_cvt_pk_bf16_f32 v71, v174, v175
    v_lshlrev_b32 v160, 16, v64
    v_and_b32 v161, 0xffff0000, v64
    v_lshlrev_b32 v162, 16, v65
    v_and_b32 v163, 0xffff0000, v65
    v_lshlrev_b32 v164, 16, v66
    v_and_b32 v165, 0xffff0000, v66
    v_lshlrev_b32 v166, 16, v67
    v_and_b32 v167, 0xffff0000, v67
    v_lshlrev_b32 v168, 16, v68
    v_and_b32 v169, 0xffff0000, v68
    v_lshlrev_b32 v170, 16, v69
    v_and_b32 v171, 0xffff0000, v69
    v_lshlrev_b32 v172, 16, v70
    v_and_b32 v173, 0xffff0000, v70
    v_lshlrev_b32 v174, 16, v71
    v_and_b32 v175, 0xffff0000, v71
    v_pk_mul_f32 v[160:161], v[160:161], v[152:153] op_sel_hi:[1,0]
    v_pk_mul_f32 v[162:163], v[162:163], v[152:153] op_sel_hi:[1,0]
    v_pk_mul_f32 v[164:165], v[164:165], v[152:153] op_sel_hi:[1,0]
    v_pk_mul_f32 v[166:167], v[166:167], v[152:153] op_sel_hi:[1,0]
    v_pk_mul_f32 v[168:169], v[168:169], v[152:153] op_sel_hi:[1,0]
    v_pk_mul_f32 v[170:171], v[170:171], v[152:153] op_sel_hi:[1,0]
    v_pk_mul_f32 v[172:173], v[172:173], v[152:153] op_sel_hi:[1,0]
    v_pk_mul_f32 v[174:175], v[174:175], v[152:153] op_sel_hi:[1,0]
    v_cvt_pk_bf16_f32 v160, v160, v161
    v_cvt_pk_bf16_f32 v162, v162, v163
    v_cvt_pk_bf16_f32 v164, v164, v165
    v_cvt_pk_bf16_f32 v166, v166, v167
    v_cvt_pk_bf16_f32 v168, v168, v169
    v_cvt_pk_bf16_f32 v170, v170, v171
    v_cvt_pk_bf16_f32 v172, v172, v173
    v_cvt_pk_bf16_f32 v174, v174, v175
    v_accvgpr_write_b32 a64, v160
    v_accvgpr_write_b32 a65, v162
    v_accvgpr_write_b32 a66, v164
    v_accvgpr_write_b32 a67, v166
    v_accvgpr_write_b32 a68, v168
    v_accvgpr_write_b32 a69, v170
    v_accvgpr_write_b32 a70, v172
    v_accvgpr_write_b32 a71, v174
    v_lshlrev_b32 v160, 16, v72
    v_and_b32 v161, 0xffff0000, v72
    v_lshlrev_b32 v162, 16, v73
    v_and_b32 v163, 0xffff0000, v73
    v_lshlrev_b32 v164, 16, v74
    v_and_b32 v165, 0xffff0000, v74
    v_lshlrev_b32 v166, 16, v75
    v_and_b32 v167, 0xffff0000, v75
    v_lshlrev_b32 v168, 16, v76
    v_and_b32 v169, 0xffff0000, v76
    v_lshlrev_b32 v170, 16, v77
    v_and_b32 v171, 0xffff0000, v77
    v_lshlrev_b32 v172, 16, v78
    v_and_b32 v173, 0xffff0000, v78
    v_lshlrev_b32 v174, 16, v79
    v_and_b32 v175, 0xffff0000, v79
    v_pk_add_f32 v[160:161], v[160:161], v[154:155] op_sel_hi:[1,0] neg_lo:[0,1] neg_hi:[0,1]
    v_pk_add_f32 v[162:163], v[162:163], v[154:155] op_sel_hi:[1,0] neg_lo:[0,1] neg_hi:[0,1]
    v_pk_add_f32 v[164:165], v[164:165], v[154:155] op_sel_hi:[1,0] neg_lo:[0,1] neg_hi:[0,1]
    v_pk_add_f32 v[166:167], v[166:167], v[154:155] op_sel_hi:[1,0] neg_lo:[0,1] neg_hi:[0,1]
    v_pk_add_f32 v[168:169], v[168:169], v[154:155] op_sel_hi:[1,0] neg_lo:[0,1] neg_hi:[0,1]
    v_pk_add_f32 v[170:171], v[170:171], v[154:155] op_sel_hi:[1,0] neg_lo:[0,1] neg_hi:[0,1]
    v_pk_add_f32 v[172:173], v[172:173], v[154:155] op_sel_hi:[1,0] neg_lo:[0,1] neg_hi:[0,1]
    v_pk_add_f32 v[174:175], v[174:175], v[154:155] op_sel_hi:[1,0] neg_lo:[0,1] neg_hi:[0,1]
    v_cvt_pk_bf16_f32 v72, v160, v161
    v_cvt_pk_bf16_f32 v73, v162, v163
    v_cvt_pk_bf16_f32 v74, v164, v165
    v_cvt_pk_bf16_f32 v75, v166, v167
    v_cvt_pk_bf16_f32 v76, v168, v169
    v_cvt_pk_bf16_f32 v77, v170, v171
    v_cvt_pk_bf16_f32 v78, v172, v173
    v_cvt_pk_bf16_f32 v79, v174, v175
    v_lshlrev_b32 v160, 16, v72
    v_and_b32 v161, 0xffff0000, v72
    v_lshlrev_b32 v162, 16, v73
    v_and_b32 v163, 0xffff0000, v73
    v_lshlrev_b32 v164, 16, v74
    v_and_b32 v165, 0xffff0000, v74
    v_lshlrev_b32 v166, 16, v75
    v_and_b32 v167, 0xffff0000, v75
    v_lshlrev_b32 v168, 16, v76
    v_and_b32 v169, 0xffff0000, v76
    v_lshlrev_b32 v170, 16, v77
    v_and_b32 v171, 0xffff0000, v77
    v_lshlrev_b32 v172, 16, v78
    v_and_b32 v173, 0xffff0000, v78
    v_lshlrev_b32 v174, 16, v79
    v_and_b32 v175, 0xffff0000, v79
    v_pk_mul_f32 v[160:161], v[160:161], v[152:153] op_sel_hi:[1,0]
    v_pk_mul_f32 v[162:163], v[162:163], v[152:153] op_sel_hi:[1,0]
    v_pk_mul_f32 v[164:165], v[164:165], v[152:153] op_sel_hi:[1,0]
    v_pk_mul_f32 v[166:167], v[166:167], v[152:153] op_sel_hi:[1,0]
    v_pk_mul_f32 v[168:169], v[168:169], v[152:153] op_sel_hi:[1,0]
    v_pk_mul_f32 v[170:171], v[170:171], v[152:153] op_sel_hi:[1,0]
    v_pk_mul_f32 v[172:173], v[172:173], v[152:153] op_sel_hi:[1,0]
    v_pk_mul_f32 v[174:175], v[174:175], v[152:153] op_sel_hi:[1,0]
    v_cvt_pk_bf16_f32 v160, v160, v161
    v_cvt_pk_bf16_f32 v162, v162, v163
    v_cvt_pk_bf16_f32 v164, v164, v165
    v_cvt_pk_bf16_f32 v166, v166, v167
    v_cvt_pk_bf16_f32 v168, v168, v169
    v_cvt_pk_bf16_f32 v170, v170, v171
    v_cvt_pk_bf16_f32 v172, v172, v173
    v_cvt_pk_bf16_f32 v174, v174, v175
    v_accvgpr_write_b32 a72, v160
    v_accvgpr_write_b32 a73, v162
    v_accvgpr_write_b32 a74, v164
    v_accvgpr_write_b32 a75, v166
    v_accvgpr_write_b32 a76, v168
    v_accvgpr_write_b32 a77, v170
    v_accvgpr_write_b32 a78, v172
    v_accvgpr_write_b32 a79, v174
    v_lshlrev_b32 v160, 16, v80
    v_and_b32 v161, 0xffff0000, v80
    v_lshlrev_b32 v162, 16, v81
    v_and_b32 v163, 0xffff0000, v81
    v_lshlrev_b32 v164, 16, v82
    v_and_b32 v165, 0xffff0000, v82
    v_lshlrev_b32 v166, 16, v83
    v_and_b32 v167, 0xffff0000, v83
    v_lshlrev_b32 v168, 16, v84
    v_and_b32 v169, 0xffff0000, v84
    v_lshlrev_b32 v170, 16, v85
    v_and_b32 v171, 0xffff0000, v85
    v_lshlrev_b32 v172, 16, v86
    v_and_b32 v173, 0xffff0000, v86
    v_lshlrev_b32 v174, 16, v87
    v_and_b32 v175, 0xffff0000, v87
    v_pk_add_f32 v[160:161], v[160:161], v[154:155] op_sel_hi:[1,0] neg_lo:[0,1] neg_hi:[0,1]
    v_pk_add_f32 v[162:163], v[162:163], v[154:155] op_sel_hi:[1,0] neg_lo:[0,1] neg_hi:[0,1]
    v_pk_add_f32 v[164:165], v[164:165], v[154:155] op_sel_hi:[1,0] neg_lo:[0,1] neg_hi:[0,1]
    v_pk_add_f32 v[166:167], v[166:167], v[154:155] op_sel_hi:[1,0] neg_lo:[0,1] neg_hi:[0,1]
    v_pk_add_f32 v[168:169], v[168:169], v[154:155] op_sel_hi:[1,0] neg_lo:[0,1] neg_hi:[0,1]
    v_pk_add_f32 v[170:171], v[170:171], v[154:155] op_sel_hi:[1,0] neg_lo:[0,1] neg_hi:[0,1]
    v_pk_add_f32 v[172:173], v[172:173], v[154:155] op_sel_hi:[1,0] neg_lo:[0,1] neg_hi:[0,1]
    v_pk_add_f32 v[174:175], v[174:175], v[154:155] op_sel_hi:[1,0] neg_lo:[0,1] neg_hi:[0,1]
    v_cvt_pk_bf16_f32 v80, v160, v161
    v_cvt_pk_bf16_f32 v81, v162, v163
    v_cvt_pk_bf16_f32 v82, v164, v165
    v_cvt_pk_bf16_f32 v83, v166, v167
    v_cvt_pk_bf16_f32 v84, v168, v169
    v_cvt_pk_bf16_f32 v85, v170, v171
    v_cvt_pk_bf16_f32 v86, v172, v173
    v_cvt_pk_bf16_f32 v87, v174, v175
    v_lshlrev_b32 v160, 16, v80
    v_and_b32 v161, 0xffff0000, v80
    v_lshlrev_b32 v162, 16, v81
    v_and_b32 v163, 0xffff0000, v81
    v_lshlrev_b32 v164, 16, v82
    v_and_b32 v165, 0xffff0000, v82
    v_lshlrev_b32 v166, 16, v83
    v_and_b32 v167, 0xffff0000, v83
    v_lshlrev_b32 v168, 16, v84
    v_and_b32 v169, 0xffff0000, v84
    v_lshlrev_b32 v170, 16, v85
    v_and_b32 v171, 0xffff0000, v85
    v_lshlrev_b32 v172, 16, v86
    v_and_b32 v173, 0xffff0000, v86
    v_lshlrev_b32 v174, 16, v87
    v_and_b32 v175, 0xffff0000, v87
    v_pk_mul_f32 v[160:161], v[160:161], v[152:153] op_sel_hi:[1,0]
    v_pk_mul_f32 v[162:163], v[162:163], v[152:153] op_sel_hi:[1,0]
    v_pk_mul_f32 v[164:165], v[164:165], v[152:153] op_sel_hi:[1,0]
    v_pk_mul_f32 v[166:167], v[166:167], v[152:153] op_sel_hi:[1,0]
    v_pk_mul_f32 v[168:169], v[168:169], v[152:153] op_sel_hi:[1,0]
    v_pk_mul_f32 v[170:171], v[170:171], v[152:153] op_sel_hi:[1,0]
    v_pk_mul_f32 v[172:173], v[172:173], v[152:153] op_sel_hi:[1,0]
    v_pk_mul_f32 v[174:175], v[174:175], v[152:153] op_sel_hi:[1,0]
    v_cvt_pk_bf16_f32 v160, v160, v161
    v_cvt_pk_bf16_f32 v162, v162, v163
    v_cvt_pk_bf16_f32 v164, v164, v165
    v_cvt_pk_bf16_f32 v166, v166, v167
    v_cvt_pk_bf16_f32 v168, v168, v169
    v_cvt_pk_bf16_f32 v170, v170, v171
    v_cvt_pk_bf16_f32 v172, v172, v173
    v_cvt_pk_bf16_f32 v174, v174, v175
    v_accvgpr_write_b32 a80, v160
    v_accvgpr_write_b32 a81, v162
    v_accvgpr_write_b32 a82, v164
    v_accvgpr_write_b32 a83, v166
    v_accvgpr_write_b32 a84, v168
    v_accvgpr_write_b32 a85, v170
    v_accvgpr_write_b32 a86, v172
    v_accvgpr_write_b32 a87, v174
    v_lshlrev_b32 v160, 16, v88
    v_and_b32 v161, 0xffff0000, v88
    v_lshlrev_b32 v162, 16, v89
    v_and_b32 v163, 0xffff0000, v89
    v_lshlrev_b32 v164, 16, v90
    v_and_b32 v165, 0xffff0000, v90
    v_lshlrev_b32 v166, 16, v91
    v_and_b32 v167, 0xffff0000, v91
    v_lshlrev_b32 v168, 16, v92
    v_and_b32 v169, 0xffff0000, v92
    v_lshlrev_b32 v170, 16, v93
    v_and_b32 v171, 0xffff0000, v93
    v_lshlrev_b32 v172, 16, v94
    v_and_b32 v173, 0xffff0000, v94
    v_lshlrev_b32 v174, 16, v95
    v_and_b32 v175, 0xffff0000, v95
    v_pk_add_f32 v[160:161], v[160:161], v[154:155] op_sel_hi:[1,0] neg_lo:[0,1] neg_hi:[0,1]
    v_pk_add_f32 v[162:163], v[162:163], v[154:155] op_sel_hi:[1,0] neg_lo:[0,1] neg_hi:[0,1]
    v_pk_add_f32 v[164:165], v[164:165], v[154:155] op_sel_hi:[1,0] neg_lo:[0,1] neg_hi:[0,1]
    v_pk_add_f32 v[166:167], v[166:167], v[154:155] op_sel_hi:[1,0] neg_lo:[0,1] neg_hi:[0,1]
    v_pk_add_f32 v[168:169], v[168:169], v[154:155] op_sel_hi:[1,0] neg_lo:[0,1] neg_hi:[0,1]
    v_pk_add_f32 v[170:171], v[170:171], v[154:155] op_sel_hi:[1,0] neg_lo:[0,1] neg_hi:[0,1]
    v_pk_add_f32 v[172:173], v[172:173], v[154:155] op_sel_hi:[1,0] neg_lo:[0,1] neg_hi:[0,1]
    v_pk_add_f32 v[174:175], v[174:175], v[154:155] op_sel_hi:[1,0] neg_lo:[0,1] neg_hi:[0,1]
    v_cvt_pk_bf16_f32 v88, v160, v161
    v_cvt_pk_bf16_f32 v89, v162, v163
    v_cvt_pk_bf16_f32 v90, v164, v165
    v_cvt_pk_bf16_f32 v91, v166, v167
    v_cvt_pk_bf16_f32 v92, v168, v169
    v_cvt_pk_bf16_f32 v93, v170, v171
    v_cvt_pk_bf16_f32 v94, v172, v173
    v_cvt_pk_bf16_f32 v95, v174, v175
    v_lshlrev_b32 v160, 16, v88
    v_and_b32 v161, 0xffff0000, v88
    v_lshlrev_b32 v162, 16, v89
    v_and_b32 v163, 0xffff0000, v89
    v_lshlrev_b32 v164, 16, v90
    v_and_b32 v165, 0xffff0000, v90
    v_lshlrev_b32 v166, 16, v91
    v_and_b32 v167, 0xffff0000, v91
    v_lshlrev_b32 v168, 16, v92
    v_and_b32 v169, 0xffff0000, v92
    v_lshlrev_b32 v170, 16, v93
    v_and_b32 v171, 0xffff0000, v93
    v_lshlrev_b32 v172, 16, v94
    v_and_b32 v173, 0xffff0000, v94
    v_lshlrev_b32 v174, 16, v95
    v_and_b32 v175, 0xffff0000, v95
    v_pk_mul_f32 v[160:161], v[160:161], v[152:153] op_sel_hi:[1,0]
    v_pk_mul_f32 v[162:163], v[162:163], v[152:153] op_sel_hi:[1,0]
    v_pk_mul_f32 v[164:165], v[164:165], v[152:153] op_sel_hi:[1,0]
    v_pk_mul_f32 v[166:167], v[166:167], v[152:153] op_sel_hi:[1,0]
    v_pk_mul_f32 v[168:169], v[168:169], v[152:153] op_sel_hi:[1,0]
    v_pk_mul_f32 v[170:171], v[170:171], v[152:153] op_sel_hi:[1,0]
    v_pk_mul_f32 v[172:173], v[172:173], v[152:153] op_sel_hi:[1,0]
    v_pk_mul_f32 v[174:175], v[174:175], v[152:153] op_sel_hi:[1,0]
    v_cvt_pk_bf16_f32 v160, v160, v161
    v_cvt_pk_bf16_f32 v162, v162, v163
    v_cvt_pk_bf16_f32 v164, v164, v165
    v_cvt_pk_bf16_f32 v166, v166, v167
    v_cvt_pk_bf16_f32 v168, v168, v169
    v_cvt_pk_bf16_f32 v170, v170, v171
    v_cvt_pk_bf16_f32 v172, v172, v173
    v_cvt_pk_bf16_f32 v174, v174, v175
    v_accvgpr_write_b32 a88, v160
    v_accvgpr_write_b32 a89, v162
    v_accvgpr_write_b32 a90, v164
    v_accvgpr_write_b32 a91, v166
    v_accvgpr_write_b32 a92, v168
    v_accvgpr_write_b32 a93, v170
    v_accvgpr_write_b32 a94, v172
    v_accvgpr_write_b32 a95, v174
    v_lshlrev_b32 v160, 16, v96
    v_and_b32 v161, 0xffff0000, v96
    v_lshlrev_b32 v162, 16, v97
    v_and_b32 v163, 0xffff0000, v97
    v_lshlrev_b32 v164, 16, v98
    v_and_b32 v165, 0xffff0000, v98
    v_lshlrev_b32 v166, 16, v99
    v_and_b32 v167, 0xffff0000, v99
    v_lshlrev_b32 v168, 16, v100
    v_and_b32 v169, 0xffff0000, v100
    v_lshlrev_b32 v170, 16, v101
    v_and_b32 v171, 0xffff0000, v101
    v_lshlrev_b32 v172, 16, v102
    v_and_b32 v173, 0xffff0000, v102
    v_lshlrev_b32 v174, 16, v103
    v_and_b32 v175, 0xffff0000, v103
    v_pk_add_f32 v[160:161], v[160:161], v[154:155] op_sel_hi:[1,0] neg_lo:[0,1] neg_hi:[0,1]
    v_pk_add_f32 v[162:163], v[162:163], v[154:155] op_sel_hi:[1,0] neg_lo:[0,1] neg_hi:[0,1]
    v_pk_add_f32 v[164:165], v[164:165], v[154:155] op_sel_hi:[1,0] neg_lo:[0,1] neg_hi:[0,1]
    v_pk_add_f32 v[166:167], v[166:167], v[154:155] op_sel_hi:[1,0] neg_lo:[0,1] neg_hi:[0,1]
    v_pk_add_f32 v[168:169], v[168:169], v[154:155] op_sel_hi:[1,0] neg_lo:[0,1] neg_hi:[0,1]
    v_pk_add_f32 v[170:171], v[170:171], v[154:155] op_sel_hi:[1,0] neg_lo:[0,1] neg_hi:[0,1]
    v_pk_add_f32 v[172:173], v[172:173], v[154:155] op_sel_hi:[1,0] neg_lo:[0,1] neg_hi:[0,1]
    v_pk_add_f32 v[174:175], v[174:175], v[154:155] op_sel_hi:[1,0] neg_lo:[0,1] neg_hi:[0,1]
    v_cvt_pk_bf16_f32 v96, v160, v161
    v_cvt_pk_bf16_f32 v97, v162, v163
    v_cvt_pk_bf16_f32 v98, v164, v165
    v_cvt_pk_bf16_f32 v99, v166, v167
    v_cvt_pk_bf16_f32 v100, v168, v169
    v_cvt_pk_bf16_f32 v101, v170, v171
    v_cvt_pk_bf16_f32 v102, v172, v173
    v_cvt_pk_bf16_f32 v103, v174, v175
    v_lshlrev_b32 v160, 16, v96
    v_and_b32 v161, 0xffff0000, v96
    v_lshlrev_b32 v162, 16, v97
    v_and_b32 v163, 0xffff0000, v97
    v_lshlrev_b32 v164, 16, v98
    v_and_b32 v165, 0xffff0000, v98
    v_lshlrev_b32 v166, 16, v99
    v_and_b32 v167, 0xffff0000, v99
    v_lshlrev_b32 v168, 16, v100
    v_and_b32 v169, 0xffff0000, v100
    v_lshlrev_b32 v170, 16, v101
    v_and_b32 v171, 0xffff0000, v101
    v_lshlrev_b32 v172, 16, v102
    v_and_b32 v173, 0xffff0000, v102
    v_lshlrev_b32 v174, 16, v103
    v_and_b32 v175, 0xffff0000, v103
    v_pk_mul_f32 v[160:161], v[160:161], v[152:153] op_sel_hi:[1,0]
    v_pk_mul_f32 v[162:163], v[162:163], v[152:153] op_sel_hi:[1,0]
    v_pk_mul_f32 v[164:165], v[164:165], v[152:153] op_sel_hi:[1,0]
    v_pk_mul_f32 v[166:167], v[166:167], v[152:153] op_sel_hi:[1,0]
    v_pk_mul_f32 v[168:169], v[168:169], v[152:153] op_sel_hi:[1,0]
    v_pk_mul_f32 v[170:171], v[170:171], v[152:153] op_sel_hi:[1,0]
    v_pk_mul_f32 v[172:173], v[172:173], v[152:153] op_sel_hi:[1,0]
    v_pk_mul_f32 v[174:175], v[174:175], v[152:153] op_sel_hi:[1,0]
    v_cvt_pk_bf16_f32 v160, v160, v161
    v_cvt_pk_bf16_f32 v162, v162, v163
    v_cvt_pk_bf16_f32 v164, v164, v165
    v_cvt_pk_bf16_f32 v166, v166, v167
    v_cvt_pk_bf16_f32 v168, v168, v169
    v_cvt_pk_bf16_f32 v170, v170, v171
    v_cvt_pk_bf16_f32 v172, v172, v173
    v_cvt_pk_bf16_f32 v174, v174, v175
    v_accvgpr_write_b32 a96, v160
    v_accvgpr_write_b32 a97, v162
    v_accvgpr_write_b32 a98, v164
    v_accvgpr_write_b32 a99, v166
    v_accvgpr_write_b32 a100, v168
    v_accvgpr_write_b32 a101, v170
    v_accvgpr_write_b32 a102, v172
    v_accvgpr_write_b32 a103, v174
    v_lshlrev_b32 v160, 16, v104
    v_and_b32 v161, 0xffff0000, v104
    v_lshlrev_b32 v162, 16, v105
    v_and_b32 v163, 0xffff0000, v105
    v_lshlrev_b32 v164, 16, v106
    v_and_b32 v165, 0xffff0000, v106
    v_lshlrev_b32 v166, 16, v107
    v_and_b32 v167, 0xffff0000, v107
    v_lshlrev_b32 v168, 16, v108
    v_and_b32 v169, 0xffff0000, v108
    v_lshlrev_b32 v170, 16, v109
    v_and_b32 v171, 0xffff0000, v109
    v_lshlrev_b32 v172, 16, v110
    v_and_b32 v173, 0xffff0000, v110
    v_lshlrev_b32 v174, 16, v111
    v_and_b32 v175, 0xffff0000, v111
    v_pk_add_f32 v[160:161], v[160:161], v[154:155] op_sel_hi:[1,0] neg_lo:[0,1] neg_hi:[0,1]
    v_pk_add_f32 v[162:163], v[162:163], v[154:155] op_sel_hi:[1,0] neg_lo:[0,1] neg_hi:[0,1]
    v_pk_add_f32 v[164:165], v[164:165], v[154:155] op_sel_hi:[1,0] neg_lo:[0,1] neg_hi:[0,1]
    v_pk_add_f32 v[166:167], v[166:167], v[154:155] op_sel_hi:[1,0] neg_lo:[0,1] neg_hi:[0,1]
    v_pk_add_f32 v[168:169], v[168:169], v[154:155] op_sel_hi:[1,0] neg_lo:[0,1] neg_hi:[0,1]
    v_pk_add_f32 v[170:171], v[170:171], v[154:155] op_sel_hi:[1,0] neg_lo:[0,1] neg_hi:[0,1]
    v_pk_add_f32 v[172:173], v[172:173], v[154:155] op_sel_hi:[1,0] neg_lo:[0,1] neg_hi:[0,1]
    v_pk_add_f32 v[174:175], v[174:175], v[154:155] op_sel_hi:[1,0] neg_lo:[0,1] neg_hi:[0,1]
    v_cvt_pk_bf16_f32 v104, v160, v161
    v_cvt_pk_bf16_f32 v105, v162, v163
    v_cvt_pk_bf16_f32 v106, v164, v165
    v_cvt_pk_bf16_f32 v107, v166, v167
    v_cvt_pk_bf16_f32 v108, v168, v169
    v_cvt_pk_bf16_f32 v109, v170, v171
    v_cvt_pk_bf16_f32 v110, v172, v173
    v_cvt_pk_bf16_f32 v111, v174, v175
    v_lshlrev_b32 v160, 16, v104
    v_and_b32 v161, 0xffff0000, v104
    v_lshlrev_b32 v162, 16, v105
    v_and_b32 v163, 0xffff0000, v105
    v_lshlrev_b32 v164, 16, v106
    v_and_b32 v165, 0xffff0000, v106
    v_lshlrev_b32 v166, 16, v107
    v_and_b32 v167, 0xffff0000, v107
    v_lshlrev_b32 v168, 16, v108
    v_and_b32 v169, 0xffff0000, v108
    v_lshlrev_b32 v170, 16, v109
    v_and_b32 v171, 0xffff0000, v109
    v_lshlrev_b32 v172, 16, v110
    v_and_b32 v173, 0xffff0000, v110
    v_lshlrev_b32 v174, 16, v111
    v_and_b32 v175, 0xffff0000, v111
    v_pk_mul_f32 v[160:161], v[160:161], v[152:153] op_sel_hi:[1,0]
    v_pk_mul_f32 v[162:163], v[162:163], v[152:153] op_sel_hi:[1,0]
    v_pk_mul_f32 v[164:165], v[164:165], v[152:153] op_sel_hi:[1,0]
    v_pk_mul_f32 v[166:167], v[166:167], v[152:153] op_sel_hi:[1,0]
    v_pk_mul_f32 v[168:169], v[168:169], v[152:153] op_sel_hi:[1,0]
    v_pk_mul_f32 v[170:171], v[170:171], v[152:153] op_sel_hi:[1,0]
    v_pk_mul_f32 v[172:173], v[172:173], v[152:153] op_sel_hi:[1,0]
    v_pk_mul_f32 v[174:175], v[174:175], v[152:153] op_sel_hi:[1,0]
    v_cvt_pk_bf16_f32 v160, v160, v161
    v_cvt_pk_bf16_f32 v162, v162, v163
    v_cvt_pk_bf16_f32 v164, v164, v165
    v_cvt_pk_bf16_f32 v166, v166, v167
    v_cvt_pk_bf16_f32 v168, v168, v169
    v_cvt_pk_bf16_f32 v170, v170, v171
    v_cvt_pk_bf16_f32 v172, v172, v173
    v_cvt_pk_bf16_f32 v174, v174, v175
    v_accvgpr_write_b32 a104, v160
    v_accvgpr_write_b32 a105, v162
    v_accvgpr_write_b32 a106, v164
    v_accvgpr_write_b32 a107, v166
    v_accvgpr_write_b32 a108, v168
    v_accvgpr_write_b32 a109, v170
    v_accvgpr_write_b32 a110, v172
    v_accvgpr_write_b32 a111, v174
    v_lshlrev_b32 v160, 16, v112
    v_and_b32 v161, 0xffff0000, v112
    v_lshlrev_b32 v162, 16, v113
    v_and_b32 v163, 0xffff0000, v113
    v_lshlrev_b32 v164, 16, v114
    v_and_b32 v165, 0xffff0000, v114
    v_lshlrev_b32 v166, 16, v115
    v_and_b32 v167, 0xffff0000, v115
    v_lshlrev_b32 v168, 16, v116
    v_and_b32 v169, 0xffff0000, v116
    v_lshlrev_b32 v170, 16, v117
    v_and_b32 v171, 0xffff0000, v117
    v_lshlrev_b32 v172, 16, v118
    v_and_b32 v173, 0xffff0000, v118
    v_lshlrev_b32 v174, 16, v119
    v_and_b32 v175, 0xffff0000, v119
    v_pk_add_f32 v[160:161], v[160:161], v[154:155] op_sel_hi:[1,0] neg_lo:[0,1] neg_hi:[0,1]
    v_pk_add_f32 v[162:163], v[162:163], v[154:155] op_sel_hi:[1,0] neg_lo:[0,1] neg_hi:[0,1]
    v_pk_add_f32 v[164:165], v[164:165], v[154:155] op_sel_hi:[1,0] neg_lo:[0,1] neg_hi:[0,1]
    v_pk_add_f32 v[166:167], v[166:167], v[154:155] op_sel_hi:[1,0] neg_lo:[0,1] neg_hi:[0,1]
    v_pk_add_f32 v[168:169], v[168:169], v[154:155] op_sel_hi:[1,0] neg_lo:[0,1] neg_hi:[0,1]
    v_pk_add_f32 v[170:171], v[170:171], v[154:155] op_sel_hi:[1,0] neg_lo:[0,1] neg_hi:[0,1]
    v_pk_add_f32 v[172:173], v[172:173], v[154:155] op_sel_hi:[1,0] neg_lo:[0,1] neg_hi:[0,1]
    v_pk_add_f32 v[174:175], v[174:175], v[154:155] op_sel_hi:[1,0] neg_lo:[0,1] neg_hi:[0,1]
    v_cvt_pk_bf16_f32 v112, v160, v161
    v_cvt_pk_bf16_f32 v113, v162, v163
    v_cvt_pk_bf16_f32 v114, v164, v165
    v_cvt_pk_bf16_f32 v115, v166, v167
    v_cvt_pk_bf16_f32 v116, v168, v169
    v_cvt_pk_bf16_f32 v117, v170, v171
    v_cvt_pk_bf16_f32 v118, v172, v173
    v_cvt_pk_bf16_f32 v119, v174, v175
    v_lshlrev_b32 v160, 16, v112
    v_and_b32 v161, 0xffff0000, v112
    v_lshlrev_b32 v162, 16, v113
    v_and_b32 v163, 0xffff0000, v113
    v_lshlrev_b32 v164, 16, v114
    v_and_b32 v165, 0xffff0000, v114
    v_lshlrev_b32 v166, 16, v115
    v_and_b32 v167, 0xffff0000, v115
    v_lshlrev_b32 v168, 16, v116
    v_and_b32 v169, 0xffff0000, v116
    v_lshlrev_b32 v170, 16, v117
    v_and_b32 v171, 0xffff0000, v117
    v_lshlrev_b32 v172, 16, v118
    v_and_b32 v173, 0xffff0000, v118
    v_lshlrev_b32 v174, 16, v119
    v_and_b32 v175, 0xffff0000, v119
    v_pk_mul_f32 v[160:161], v[160:161], v[152:153] op_sel_hi:[1,0]
    v_pk_mul_f32 v[162:163], v[162:163], v[152:153] op_sel_hi:[1,0]
    v_pk_mul_f32 v[164:165], v[164:165], v[152:153] op_sel_hi:[1,0]
    v_pk_mul_f32 v[166:167], v[166:167], v[152:153] op_sel_hi:[1,0]
    v_pk_mul_f32 v[168:169], v[168:169], v[152:153] op_sel_hi:[1,0]
    v_pk_mul_f32 v[170:171], v[170:171], v[152:153] op_sel_hi:[1,0]
    v_pk_mul_f32 v[172:173], v[172:173], v[152:153] op_sel_hi:[1,0]
    v_pk_mul_f32 v[174:175], v[174:175], v[152:153] op_sel_hi:[1,0]
    v_cvt_pk_bf16_f32 v160, v160, v161
    v_cvt_pk_bf16_f32 v162, v162, v163
    v_cvt_pk_bf16_f32 v164, v164, v165
    v_cvt_pk_bf16_f32 v166, v166, v167
    v_cvt_pk_bf16_f32 v168, v168, v169
    v_cvt_pk_bf16_f32 v170, v170, v171
    v_cvt_pk_bf16_f32 v172, v172, v173
    v_cvt_pk_bf16_f32 v174, v174, v175
    v_accvgpr_write_b32 a112, v160
    v_accvgpr_write_b32 a113, v162
    v_accvgpr_write_b32 a114, v164
    v_accvgpr_write_b32 a115, v166
    v_accvgpr_write_b32 a116, v168
    v_accvgpr_write_b32 a117, v170
    v_accvgpr_write_b32 a118, v172
    v_accvgpr_write_b32 a119, v174
    v_lshlrev_b32 v160, 16, v120
    v_and_b32 v161, 0xffff0000, v120
    v_lshlrev_b32 v162, 16, v121
    v_and_b32 v163, 0xffff0000, v121
    v_lshlrev_b32 v164, 16, v122
    v_and_b32 v165, 0xffff0000, v122
    v_lshlrev_b32 v166, 16, v123
    v_and_b32 v167, 0xffff0000, v123
    v_lshlrev_b32 v168, 16, v124
    v_and_b32 v169, 0xffff0000, v124
    v_lshlrev_b32 v170, 16, v125
    v_and_b32 v171, 0xffff0000, v125
    v_lshlrev_b32 v172, 16, v126
    v_and_b32 v173, 0xffff0000, v126
    v_lshlrev_b32 v174, 16, v127
    v_and_b32 v175, 0xffff0000, v127
    v_pk_add_f32 v[160:161], v[160:161], v[154:155] op_sel_hi:[1,0] neg_lo:[0,1] neg_hi:[0,1]
    v_pk_add_f32 v[162:163], v[162:163], v[154:155] op_sel_hi:[1,0] neg_lo:[0,1] neg_hi:[0,1]
    v_pk_add_f32 v[164:165], v[164:165], v[154:155] op_sel_hi:[1,0] neg_lo:[0,1] neg_hi:[0,1]
    v_pk_add_f32 v[166:167], v[166:167], v[154:155] op_sel_hi:[1,0] neg_lo:[0,1] neg_hi:[0,1]
    v_pk_add_f32 v[168:169], v[168:169], v[154:155] op_sel_hi:[1,0] neg_lo:[0,1] neg_hi:[0,1]
    v_pk_add_f32 v[170:171], v[170:171], v[154:155] op_sel_hi:[1,0] neg_lo:[0,1] neg_hi:[0,1]
    v_pk_add_f32 v[172:173], v[172:173], v[154:155] op_sel_hi:[1,0] neg_lo:[0,1] neg_hi:[0,1]
    v_pk_add_f32 v[174:175], v[174:175], v[154:155] op_sel_hi:[1,0] neg_lo:[0,1] neg_hi:[0,1]
    v_cvt_pk_bf16_f32 v120, v160, v161
    v_cvt_pk_bf16_f32 v121, v162, v163
    v_cvt_pk_bf16_f32 v122, v164, v165
    v_cvt_pk_bf16_f32 v123, v166, v167
    v_cvt_pk_bf16_f32 v124, v168, v169
    v_cvt_pk_bf16_f32 v125, v170, v171
    v_cvt_pk_bf16_f32 v126, v172, v173
    v_cvt_pk_bf16_f32 v127, v174, v175
    v_lshlrev_b32 v160, 16, v120
    v_and_b32 v161, 0xffff0000, v120
    v_lshlrev_b32 v162, 16, v121
    v_and_b32 v163, 0xffff0000, v121
    v_lshlrev_b32 v164, 16, v122
    v_and_b32 v165, 0xffff0000, v122
    v_lshlrev_b32 v166, 16, v123
    v_and_b32 v167, 0xffff0000, v123
    v_lshlrev_b32 v168, 16, v124
    v_and_b32 v169, 0xffff0000, v124
    v_lshlrev_b32 v170, 16, v125
    v_and_b32 v171, 0xffff0000, v125
    v_lshlrev_b32 v172, 16, v126
    v_and_b32 v173, 0xffff0000, v126
    v_lshlrev_b32 v174, 16, v127
    v_and_b32 v175, 0xffff0000, v127
    v_pk_mul_f32 v[160:161], v[160:161], v[152:153] op_sel_hi:[1,0]
    v_pk_mul_f32 v[162:163], v[162:163], v[152:153] op_sel_hi:[1,0]
    v_pk_mul_f32 v[164:165], v[164:165], v[152:153] op_sel_hi:[1,0]
    v_pk_mul_f32 v[166:167], v[166:167], v[152:153] op_sel_hi:[1,0]
    v_pk_mul_f32 v[168:169], v[168:169], v[152:153] op_sel_hi:[1,0]
    v_pk_mul_f32 v[170:171], v[170:171], v[152:153] op_sel_hi:[1,0]
    v_pk_mul_f32 v[172:173], v[172:173], v[152:153] op_sel_hi:[1,0]
    v_pk_mul_f32 v[174:175], v[174:175], v[152:153] op_sel_hi:[1,0]
    v_cvt_pk_bf16_f32 v160, v160, v161
    v_cvt_pk_bf16_f32 v162, v162, v163
    v_cvt_pk_bf16_f32 v164, v164, v165
    v_cvt_pk_bf16_f32 v166, v166, v167
    v_cvt_pk_bf16_f32 v168, v168, v169
    v_cvt_pk_bf16_f32 v170, v170, v171
    v_cvt_pk_bf16_f32 v172, v172, v173
    v_cvt_pk_bf16_f32 v174, v174, v175
    v_accvgpr_write_b32 a120, v160
    v_accvgpr_write_b32 a121, v162
    v_accvgpr_write_b32 a122, v164
    v_accvgpr_write_b32 a123, v166
    v_accvgpr_write_b32 a124, v168
    v_accvgpr_write_b32 a125, v170
    v_accvgpr_write_b32 a126, v172
    v_accvgpr_write_b32 a127, v174
    s_nop 4
L_p1_unit:
    s_cmp_ge_u32 s38, 96
    s_cbranch_scc1 L_p1_end
    s_lshr_b32 s26, s38, 5
    s_add_u32 s27, s26, 1
    s_lshl_b32 s25, s27, 24
    s_lshl_b32 s27, s20, 2
    s_add_u32 s27, s27, s21
    s_lshl_b32 s27, s27, 5
    s_and_b32 s28, s38, 31
    s_add_u32 s27, s27, s28
    s_lshl_b32 s27, s27, 13
    s_add_u32 s25, s25, s27
    s_lshr_b32 s26, s38, 5
    s_cmp_eq_u32 s26, 1
    s_cbranch_scc1 L_p1_v
    s_waitcnt vmcnt(16)
    s_barrier
    ds_read_b64_tr_b16 v[64:65], v128
    ds_read_b64_tr_b16 v[66:67], v128 offset:1024
    ds_read_b64_tr_b16 v[68:69], v129
    ds_read_b64_tr_b16 v[70:71], v129 offset:1024
    ds_read_b64_tr_b16 v[72:73], v130
    ds_read_b64_tr_b16 v[74:75], v130 offset:1024
    ds_read_b64_tr_b16 v[76:77], v131
    ds_read_b64_tr_b16 v[78:79], v131 offset:1024
    ds_read_b64_tr_b16 v[80:81], v132
    ds_read_b64_tr_b16 v[82:83], v132 offset:1024
    ds_read_b64_tr_b16 v[84:85], v133
    ds_read_b64_tr_b16 v[86:87], v133 offset:1024
    ds_read_b64_tr_b16 v[88:89], v134
    ds_read_b64_tr_b16 v[90:91], v134 offset:1024
    s_waitcnt lgkmcnt(12)
    v_mfma_f32_16x16x32_bf16 v[0:3], v[64:67], a[0:3], 0
    ds_read_b64_tr_b16 v[92:93], v135
    v_mfma_f32_16x16x32_bf16 v[4:7], v[64:67], a[64:67], 0
    ds_read_b64_tr_b16 v[94:95], v135 offset:1024
    s_add_u32 s26, s24, 0x300000
    s_add_u32 m0, s29, 0x18000
    s_nop 0
    buffer_load_dwordx4 v136, s[16:19], s26 offen lds
    s_waitcnt lgkmcnt(12)
    v_mfma_f32_16x16x32_bf16 v[8:11], v[68:71], a[0:3], 0
    ds_read_b64_tr_b16 v[96:97], v128 offset:8192
    v_mfma_f32_16x16x32_bf16 v[12:15], v[68:71], a[64:67], 0
    ds_read_b64_tr_b16 v[98:99], v128 offset:9216
    s_add_u32 s26, s24, 0x320000
    s_add_u32 m0, s29, 0x19000
    s_nop 0
    buffer_load_dwordx4 v136, s[16:19], s26 offen lds
    s_waitcnt lgkmcnt(12)
    v_mfma_f32_16x16x32_bf16 v[16:19], v[72:75], a[0:3], 0
    ds_read_b64_tr_b16 v[100:101], v129 offset:8192
    v_mfma_f32_16x16x32_bf16 v[20:23], v[72:75], a[64:67], 0
    ds_read_b64_tr_b16 v[102:103], v129 offset:9216
    s_add_u32 s26, s24, 0x340000
    s_add_u32 m0, s29, 0x1a000
    s_nop 0
    buffer_load_dwordx4 v136, s[16:19], s26 offen lds
    s_waitcnt lgkmcnt(12)
    v_mfma_f32_16x16x32_bf16 v[24:27], v[76:79], a[0:3], 0
    ds_read_b64_tr_b16 v[104:105], v130 offset:8192
    v_mfma_f32_16x16x32_bf16 v[28:31], v[76:79], a[64:67], 0
    ds_read_b64_tr_b16 v[106:107], v130 offset:9216
    s_add_u32 s26, s24, 0x360000
    s_add_u32 m0, s29, 0x1b000
    s_nop 0
    buffer_load_dwordx4 v136, s[16:19], s26 offen lds
    s_waitcnt lgkmcnt(12)
    v_mfma_f32_16x16x32_bf16 v[32:35], v[80:83], a[0:3], 0
    ds_read_b64_tr_b16 v[108:109], v131 offset:8192
    v_mfma_f32_16x16x32_bf16 v[36:39], v[80:83], a[64:67], 0
    ds_read_b64_tr_b16 v[110:111], v131 offset:9216
    s_add_u32 s26, s24, 0x380000
    s_add_u32 m0, s29, 0x1c000
    s_nop 0
    buffer_load_dwordx4 v136, s[16:19], s26 offen lds
    s_waitcnt lgkmcnt(12)
    v_mfma_f32_16x16x32_bf16 v[40:43], v[84:87], a[0:3], 0
    ds_read_b64_tr_b16 v[112:113], v132 offset:8192
    v_mfma_f32_16x16x32_bf16 v[44:47], v[84:87], a[64:67], 0
    ds_read_b64_tr_b16 v[114:115], v132 offset:9216
    s_add_u32 s26, s24, 0x3a0000
    s_add_u32 m0, s29, 0x1d000
    s_nop 0
    buffer_load_dwordx4 v136, s[16:19], s26 offen lds
    s_waitcnt lgkmcnt(12)
    v_mfma_f32_16x16x32_bf16 v[48:51], v[88:91], a[0:3], 0
    ds_read_b64_tr_b16 v[116:117], v133 offset:8192
    v_mfma_f32_16x16x32_bf16 v[52:55], v[88:91], a[64:67], 0
    ds_read_b64_tr_b16 v[118:119], v133 offset:9216
    s_add_u32 s26, s24, 0x3c0000
    s_add_u32 m0, s29, 0x1e000
    s_nop 0
    buffer_load_dwordx4 v136, s[16:19], s26 offen lds
    s_waitcnt lgkmcnt(12)
    v_mfma_f32_16x16x32_bf16 v[56:59], v[92:95], a[0:3], 0
    ds_read_b64_tr_b16 v[120:121], v134 offset:8192
    v_mfma_f32_16x16x32_bf16 v[60:63], v[92:95], a[64:67], 0
    ds_read_b64_tr_b16 v[122:123], v134 offset:9216
    s_add_u32 s26, s24, 0x3e0000
    s_add_u32 m0, s29, 0x1f000
    s_nop 0
    buffer_load_dwordx4 v136, s[16:19], s26 offen lds
    s_waitcnt lgkmcnt(12)
    v_mfma_f32_16x16x32_bf16 v[0:3], v[96:99], a[4:7], v[0:3]
    ds_read_b64_tr_b16 v[124:125], v135 offset:8192
    v_mfma_f32_16x16x32_bf16 v[4:7], v[96:99], a[68:71], v[4:7]
    ds_read_b64_tr_b16 v[126:127], v135 offset:9216
    s_waitcnt lgkmcnt(12)
    v_mfma_f32_16x16x32_bf16 v[8:11], v[100:103], a[4:7], v[8:11]
    ds_read_b64_tr_b16 v[64:65], v128 offset:16384
    v_mfma_f32_16x16x32_bf16 v[12:15], v[100:103], a[68:71], v[12:15]
    ds_read_b64_tr_b16 v[66:67], v128 offset:17408
    s_waitcnt lgkmcnt(12)
    v_mfma_f32_16x16x32_bf16 v[16:19], v[104:107], a[4:7], v[16:19]
    ds_read_b64_tr_b16 v[68:69], v129 offset:16384
    v_mfma_f32_16x16x32_bf16 v[20:23], v[104:107], a[68:71], v[20:23]
    ds_read_b64_tr_b16 v[70:71], v129 offset:17408
    s_waitcnt lgkmcnt(12)
    v_mfma_f32_16x16x32_bf16 v[24:27], v[108:111], a[4:7], v[24:27]
    ds_read_b64_tr_b16 v[72:73], v130 offset:16384
    v_mfma_f32_16x16x32_bf16 v[28:31], v[108:111], a[68:71], v[28:31]
    ds_read_b64_tr_b16 v[74:75], v130 offset:17408
    s_waitcnt lgkmcnt(12)
    v_mfma_f32_16x16x32_bf16 v[32:35], v[112:115], a[4:7], v[32:35]
    ds_read_b64_tr_b16 v[76:77], v131 offset:16384
    v_mfma_f32_16x16x32_bf16 v[36:39], v[112:115], a[68:71], v[36:39]
    ds_read_b64_tr_b16 v[78:79], v131 offset:17408
    s_waitcnt lgkmcnt(12)
    v_mfma_f32_16x16x32_bf16 v[40:43], v[116:119], a[4:7], v[40:43]
    ds_read_b64_tr_b16 v[80:81], v132 offset:16384
    v_mfma_f32_16x16x32_bf16 v[44:47], v[116:119], a[68:71], v[44:47]
    ds_read_b64_tr_b16 v[82:83], v132 offset:17408
    s_waitcnt lgkmcnt(12)
    v_mfma_f32_16x16x32_bf16 v[48:51], v[120:123], a[4:7], v[48:51]
    ds_read_b64_tr_b16 v[84:85], v133 offset:16384
    v_mfma_f32_16x16x32_bf16 v[52:55], v[120:123], a[68:71], v[52:55]
    ds_read_b64_tr_b16 v[86:87], v133 offset:17408
    s_waitcnt lgkmcnt(12)
    v_mfma_f32_16x16x32_bf16 v[56:59], v[124:127], a[4:7], v[56:59]
    ds_read_b64_tr_b16 v[88:89], v134 offset:16384
    v_mfma_f32_16x16x32_bf16 v[60:63], v[124:127], a[68:71], v[60:63]
    ds_read_b64_tr_b16 v[90:91], v134 offset:17408
    s_waitcnt lgkmcnt(12)
    v_mfma_f32_16x16x32_bf16 v[0:3], v[64:67], a[8:11], v[0:3]
    ds_read_b64_tr_b16 v[92:93], v135 offset:16384
    v_mfma_f32_16x16x32_bf16 v[4:7], v[64:67], a[72:75], v[4:7]
    ds_read_b64_tr_b16 v[94:95], v135 offset:17408
    s_waitcnt lgkmcnt(12)
    v_mfma_f32_16x16x32_bf16 v[8:11], v[68:71], a[8:11], v[8:11]
    ds_read_b64_tr_b16 v[96:97], v128 offset:24576
    v_mfma_f32_16x16x32_bf16 v[12:15], v[68:71], a[72:75], v[12:15]
    ds_read_b64_tr_b16 v[98:99], v128 offset:25600
    s_waitcnt lgkmcnt(12)
    v_mfma_f32_16x16x32_bf16 v[16:19], v[72:75], a[8:11], v[16:19]
    ds_read_b64_tr_b16 v[100:101], v129 offset:24576
    v_mfma_f32_16x16x32_bf16 v[20:23], v[72:75], a[72:75], v[20:23]
    ds_read_b64_tr_b16 v[102:103], v129 offset:25600
    s_waitcnt lgkmcnt(12)
    v_mfma_f32_16x16x32_bf16 v[24:27], v[76:79], a[8:11], v[24:27]
    ds_read_b64_tr_b16 v[104:105], v130 offset:24576
    v_mfma_f32_16x16x32_bf16 v[28:31], v[76:79], a[72:75], v[28:31]
    ds_read_b64_tr_b16 v[106:107], v130 offset:25600
    s_waitcnt lgkmcnt(12)
    v_mfma_f32_16x16x32_bf16 v[32:35], v[80:83], a[8:11], v[32:35]
    ds_read_b64_tr_b16 v[108:109], v131 offset:24576
    v_mfma_f32_16x16x32_bf16 v[36:39], v[80:83], a[72:75], v[36:39]
    ds_read_b64_tr_b16 v[110:111], v131 offset:25600
    s_waitcnt lgkmcnt(12)
    v_mfma_f32_16x16x32_bf16 v[40:43], v[84:87], a[8:11], v[40:43]
    ds_read_b64_tr_b16 v[112:113], v132 offset:24576
    v_mfma_f32_16x16x32_bf16 v[44:47], v[84:87], a[72:75], v[44:47]
    ds_read_b64_tr_b16 v[114:115], v132 offset:25600
    s_waitcnt lgkmcnt(12)
    v_mfma_f32_16x16x32_bf16 v[48:51], v[88:91], a[8:11], v[48:51]
    ds_read_b64_tr_b16 v[116:117], v133 offset:24576
    v_mfma_f32_16x16x32_bf16 v[52:55], v[88:91], a[72:75], v[52:55]
    ds_read_b64_tr_b16 v[118:119], v133 offset:25600
    s_waitcnt lgkmcnt(12)
    v_mfma_f32_16x16x32_bf16 v[56:59], v[92:95], a[8:11], v[56:59]
    ds_read_b64_tr_b16 v[120:121], v134 offset:24576
    v_mfma_f32_16x16x32_bf16 v[60:63], v[92:95], a[72:75], v[60:63]
    ds_read_b64_tr_b16 v[122:123], v134 offset:25600
    s_waitcnt lgkmcnt(12)
    v_mfma_f32_16x16x32_bf16 v[0:3], v[96:99], a[12:15], v[0:3]
    ds_read_b64_tr_b16 v[124:125], v135 offset:24576
    v_mfma_f32_16x16x32_bf16 v[4:7], v[96:99], a[76:79], v[4:7]
    ds_read_b64_tr_b16 v[126:127], v135 offset:25600
    s_waitcnt lgkmcnt(12)
    v_mfma_f32_16x16x32_bf16 v[8:11], v[100:103], a[12:15], v[8:11]
    v_mfma_f32_16x16x32_bf16 v[12:15], v[100:103], a[76:79], v[12:15]
    s_waitcnt lgkmcnt(10)
    v_mfma_f32_16x16x32_bf16 v[16:19], v[104:107], a[12:15], v[16:19]
    v_mfma_f32_16x16x32_bf16 v[20:23], v[104:107], a[76:79], v[20:23]
    s_waitcnt lgkmcnt(8)
    v_mfma_f32_16x16x32_bf16 v[24:27], v[108:111], a[12:15], v[24:27]
    v_mfma_f32_16x16x32_bf16 v[28:31], v[108:111], a[76:79], v[28:31]
    s_waitcnt lgkmcnt(6)
    v_mfma_f32_16x16x32_bf16 v[32:35], v[112:115], a[12:15], v[32:35]
    v_mfma_f32_16x16x32_bf16 v[36:39], v[112:115], a[76:79], v[36:39]
    s_waitcnt lgkmcnt(4)
    v_mfma_f32_16x16x32_bf16 v[40:43], v[116:119], a[12:15], v[40:43]
    v_mfma_f32_16x16x32_bf16 v[44:47], v[116:119], a[76:79], v[44:47]
    s_waitcnt lgkmcnt(2)
    v_mfma_f32_16x16x32_bf16 v[48:51], v[120:123], a[12:15], v[48:51]
    v_mfma_f32_16x16x32_bf16 v[52:55], v[120:123], a[76:79], v[52:55]
    s_waitcnt lgkmcnt(0)
    v_mfma_f32_16x16x32_bf16 v[56:59], v[124:127], a[12:15], v[56:59]
    v_mfma_f32_16x16x32_bf16 v[60:63], v[124:127], a[76:79], v[60:63]
    s_waitcnt vmcnt(16)
    s_barrier
    ds_read_b64_tr_b16 v[64:65], v128 offset:32768
    ds_read_b64_tr_b16 v[66:67], v128 offset:33792
    ds_read_b64_tr_b16 v[68:69], v129 offset:32768
    ds_read_b64_tr_b16 v[70:71], v129 offset:33792
    ds_read_b64_tr_b16 v[72:73], v130 offset:32768
    ds_read_b64_tr_b16 v[74:75], v130 offset:33792
    ds_read_b64_tr_b16 v[76:77], v131 offset:32768
    ds_read_b64_tr_b16 v[78:79], v131 offset:33792
    ds_read_b64_tr_b16 v[80:81], v132 offset:32768
    ds_read_b64_tr_b16 v[82:83], v132 offset:33792
    ds_read_b64_tr_b16 v[84:85], v133 offset:32768
    ds_read_b64_tr_b16 v[86:87], v133 offset:33792
    ds_read_b64_tr_b16 v[88:89], v134 offset:32768
    ds_read_b64_tr_b16 v[90:91], v134 offset:33792
    s_add_u32 s39, s39, s37
    s_lshr_b32 s26, s39, 5
    s_cmp_eq_u32 s26, 0
    s_cselect_b64 s[16:17], s[30:31], s[34:35]
    s_cmp_eq_u32 s26, 1
    s_cselect_b64 s[16:17], s[32:33], s[16:17]
    s_and_b32 s17, s17, 0xffff
    s_cmp_lt_u32 s39, 96
    s_cselect_b32 s18, 0x400000, 0
    s_and_b32 s24, s39, 31
    s_lshl_b32 s24, s24, 8
    s_waitcnt lgkmcnt(12)
    v_mfma_f32_16x16x32_bf16 v[0:3], v[64:67], a[16:19], v[0:3]
    ds_read_b64_tr_b16 v[92:93], v135 offset:32768
    v_mfma_f32_16x16x32_bf16 v[4:7], v[64:67], a[80:83], v[4:7]
    ds_read_b64_tr_b16 v[94:95], v135 offset:33792
    s_add_u32 s26, s24, 0x0
    s_add_u32 m0, s29, 0x0
    s_nop 0
    buffer_load_dwordx4 v136, s[16:19], s26 offen lds
    s_waitcnt lgkmcnt(12)
    v_mfma_f32_16x16x32_bf16 v[8:11], v[68:71], a[16:19], v[8:11]
    ds_read_b64_tr_b16 v[96:97], v128 offset:40960
    v_mfma_f32_16x16x32_bf16 v[12:15], v[68:71], a[80:83], v[12:15]
    ds_read_b64_tr_b16 v[98:99], v128 offset:41984
    s_add_u32 s26, s24, 0x20000
    s_add_u32 m0, s29, 0x1000
    s_nop 0
    buffer_load_dwordx4 v136, s[16:19], s26 offen lds
    s_waitcnt lgkmcnt(12)
    v_mfma_f32_16x16x32_bf16 v[16:19], v[72:75], a[16:19], v[16:19]
    ds_read_b64_tr_b16 v[100:101], v129 offset:40960
    v_mfma_f32_16x16x32_bf16 v[20:23], v[72:75], a[80:83], v[20:23]
    ds_read_b64_tr_b16 v[102:103], v129 offset:41984
    s_add_u32 s26, s24, 0x40000
    s_add_u32 m0, s29, 0x2000
    s_nop 0
    buffer_load_dwordx4 v136, s[16:19], s26 offen lds
    s_waitcnt lgkmcnt(12)
    v_mfma_f32_16x16x32_bf16 v[24:27], v[76:79], a[16:19], v[24:27]
    ds_read_b64_tr_b16 v[104:105], v130 offset:40960
    v_mfma_f32_16x16x32_bf16 v[28:31], v[76:79], a[80:83], v[28:31]
    ds_read_b64_tr_b16 v[106:107], v130 offset:41984
    s_add_u32 s26, s24, 0x60000
    s_add_u32 m0, s29, 0x3000
    s_nop 0
    buffer_load_dwordx4 v136, s[16:19], s26 offen lds
    s_waitcnt lgkmcnt(12)
    v_mfma_f32_16x16x32_bf16 v[32:35], v[80:83], a[16:19], v[32:35]
    ds_read_b64_tr_b16 v[108:109], v131 offset:40960
    v_mfma_f32_16x16x32_bf16 v[36:39], v[80:83], a[80:83], v[36:39]
    ds_read_b64_tr_b16 v[110:111], v131 offset:41984
    s_add_u32 s26, s24, 0x80000
    s_add_u32 m0, s29, 0x4000
    s_nop 0
    buffer_load_dwordx4 v136, s[16:19], s26 offen lds
    s_waitcnt lgkmcnt(12)
    v_mfma_f32_16x16x32_bf16 v[40:43], v[84:87], a[16:19], v[40:43]
    ds_read_b64_tr_b16 v[112:113], v132 offset:40960
    v_mfma_f32_16x16x32_bf16 v[44:47], v[84:87], a[80:83], v[44:47]
    ds_read_b64_tr_b16 v[114:115], v132 offset:41984
    s_add_u32 s26, s24, 0xa0000
    s_add_u32 m0, s29, 0x5000
    s_nop 0
    buffer_load_dwordx4 v136, s[16:19], s26 offen lds
    s_waitcnt lgkmcnt(12)
    v_mfma_f32_16x16x32_bf16 v[48:51], v[88:91], a[16:19], v[48:51]
    ds_read_b64_tr_b16 v[116:117], v133 offset:40960
    v_mfma_f32_16x16x32_bf16 v[52:55], v[88:91], a[80:83], v[52:55]
    ds_read_b64_tr_b16 v[118:119], v133 offset:41984
    s_add_u32 s26, s24, 0xc0000
    s_add_u32 m0, s29, 0x6000
    s_nop 0
    buffer_load_dwordx4 v136, s[16:19], s26 offen lds
    s_waitcnt lgkmcnt(12)
    v_mfma_f32_16x16x32_bf16 v[56:59], v[92:95], a[16:19], v[56:59]
    ds_read_b64_tr_b16 v[120:121], v134 offset:40960
    v_mfma_f32_16x16x32_bf16 v[60:63], v[92:95], a[80:83], v[60:63]
    ds_read_b64_tr_b16 v[122:123], v134 offset:41984
    s_add_u32 s26, s24, 0xe0000
    s_add_u32 m0, s29, 0x7000
    s_nop 0
    buffer_load_dwordx4 v136, s[16:19], s26 offen lds
    s_waitcnt lgkmcnt(12)
    v_mfma_f32_16x16x32_bf16 v[0:3], v[96:99], a[20:23], v[0:3]
    ds_read_b64_tr_b16 v[124:125], v135 offset:40960
    v_mfma_f32_16x16x32_bf16 v[4:7], v[96:99], a[84:87], v[4:7]
    ds_read_b64_tr_b16 v[126:127], v135 offset:41984
    s_waitcnt lgkmcnt(12)
    v_mfma_f32_16x16x32_bf16 v[8:11], v[100:103], a[20:23], v[8:11]
    ds_read_b64_tr_b16 v[64:65], v128 offset:49152
    v_mfma_f32_16x16x32_bf16 v[12:15], v[100:103], a[84:87], v[12:15]
    ds_read_b64_tr_b16 v[66:67], v128 offset:50176
    s_waitcnt lgkmcnt(12)
    v_mfma_f32_16x16x32_bf16 v[16:19], v[104:107], a[20:23], v[16:19]
    ds_read_b64_tr_b16 v[68:69], v129 offset:49152
    v_mfma_f32_16x16x32_bf16 v[20:23], v[104:107], a[84:87], v[20:23]
    ds_read_b64_tr_b16 v[70:71], v129 offset:50176
    s_waitcnt lgkmcnt(12)
    v_mfma_f32_16x16x32_bf16 v[24:27], v[108:111], a[20:23], v[24:27]
    ds_read_b64_tr_b16 v[72:73], v130 offset:49152
    v_mfma_f32_16x16x32_bf16 v[28:31], v[108:111], a[84:87], v[28:31]
    ds_read_b64_tr_b16 v[74:75], v130 offset:50176
    s_waitcnt lgkmcnt(12)
    v_mfma_f32_16x16x32_bf16 v[32:35], v[112:115], a[20:23], v[32:35]
    ds_read_b64_tr_b16 v[76:77], v131 offset:49152
    v_mfma_f32_16x16x32_bf16 v[36:39], v[112:115], a[84:87], v[36:39]
    ds_read_b64_tr_b16 v[78:79], v131 offset:50176
    s_waitcnt lgkmcnt(12)
    v_mfma_f32_16x16x32_bf16 v[40:43], v[116:119], a[20:23], v[40:43]
    ds_read_b64_tr_b16 v[80:81], v132 offset:49152
    v_mfma_f32_16x16x32_bf16 v[44:47], v[116:119], a[84:87], v[44:47]
    ds_read_b64_tr_b16 v[82:83], v132 offset:50176
    s_waitcnt lgkmcnt(12)
    v_mfma_f32_16x16x32_bf16 v[48:51], v[120:123], a[20:23], v[48:51]
    ds_read_b64_tr_b16 v[84:85], v133 offset:49152
    v_mfma_f32_16x16x32_bf16 v[52:55], v[120:123], a[84:87], v[52:55]
    ds_read_b64_tr_b16 v[86:87], v133 offset:50176
    s_waitcnt lgkmcnt(12)
    v_mfma_f32_16x16x32_bf16 v[56:59], v[124:127], a[20:23], v[56:59]
    ds_read_b64_tr_b16 v[88:89], v134 offset:49152
    v_mfma_f32_16x16x32_bf16 v[60:63], v[124:127], a[84:87], v[60:63]
    ds_read_b64_tr_b16 v[90:91], v134 offset:50176
    s_waitcnt lgkmcnt(12)
    v_mfma_f32_16x16x32_bf16 v[0:3], v[64:67], a[24:27], v[0:3]
    ds_read_b64_tr_b16 v[92:93], v135 offset:49152
    v_mfma_f32_16x16x32_bf16 v[4:7], v[64:67], a[88:91], v[4:7]
    ds_read_b64_tr_b16 v[94:95], v135 offset:50176
    s_waitcnt lgkmcnt(12)
    v_mfma_f32_16x16x32_bf16 v[8:11], v[68:71], a[24:27], v[8:11]
    ds_read_b64_tr_b16 v[96:97], v128 offset:57344
    v_mfma_f32_16x16x32_bf16 v[12:15], v[68:71], a[88:91], v[12:15]
    ds_read_b64_tr_b16 v[98:99], v128 offset:58368
    s_waitcnt lgkmcnt(12)
    v_mfma_f32_16x16x32_bf16 v[16:19], v[72:75], a[24:27], v[16:19]
    ds_read_b64_tr_b16 v[100:101], v129 offset:57344
    v_mfma_f32_16x16x32_bf16 v[20:23], v[72:75], a[88:91], v[20:23]
    ds_read_b64_tr_b16 v[102:103], v129 offset:58368
    s_waitcnt lgkmcnt(12)
    v_mfma_f32_16x16x32_bf16 v[24:27], v[76:79], a[24:27], v[24:27]
    ds_read_b64_tr_b16 v[104:105], v130 offset:57344
    v_mfma_f32_16x16x32_bf16 v[28:31], v[76:79], a[88:91], v[28:31]
    ds_read_b64_tr_b16 v[106:107], v130 offset:58368
    s_waitcnt lgkmcnt(12)
    v_mfma_f32_16x16x32_bf16 v[32:35], v[80:83], a[24:27], v[32:35]
    ds_read_b64_tr_b16 v[108:109], v131 offset:57344
    v_mfma_f32_16x16x32_bf16 v[36:39], v[80:83], a[88:91], v[36:39]
    ds_read_b64_tr_b16 v[110:111], v131 offset:58368
    s_waitcnt lgkmcnt(12)
    v_mfma_f32_16x16x32_bf16 v[40:43], v[84:87], a[24:27], v[40:43]
    ds_read_b64_tr_b16 v[112:113], v132 offset:57344
    v_mfma_f32_16x16x32_bf16 v[44:47], v[84:87], a[88:91], v[44:47]
    ds_read_b64_tr_b16 v[114:115], v132 offset:58368
    s_waitcnt lgkmcnt(12)
    v_mfma_f32_16x16x32_bf16 v[48:51], v[88:91], a[24:27], v[48:51]
    ds_read_b64_tr_b16 v[116:117], v133 offset:57344
    v_mfma_f32_16x16x32_bf16 v[52:55], v[88:91], a[88:91], v[52:55]
    ds_read_b64_tr_b16 v[118:119], v133 offset:58368
    s_waitcnt lgkmcnt(12)
    v_mfma_f32_16x16x32_bf16 v[56:59], v[92:95], a[24:27], v[56:59]
    ds_read_b64_tr_b16 v[120:121], v134 offset:57344
    v_mfma_f32_16x16x32_bf16 v[60:63], v[92:95], a[88:91], v[60:63]
    ds_read_b64_tr_b16 v[122:123], v134 offset:58368
    s_waitcnt lgkmcnt(12)
    v_mfma_f32_16x16x32_bf16 v[0:3], v[96:99], a[28:31], v[0:3]
    ds_read_b64_tr_b16 v[124:125], v135 offset:57344
    v_mfma_f32_16x16x32_bf16 v[4:7], v[96:99], a[92:95], v[4:7]
    ds_read_b64_tr_b16 v[126:127], v135 offset:58368
    s_waitcnt lgkmcnt(12)
    v_mfma_f32_16x16x32_bf16 v[8:11], v[100:103], a[28:31], v[8:11]
    v_mfma_f32_16x16x32_bf16 v[12:15], v[100:103], a[92:95], v[12:15]
    s_waitcnt lgkmcnt(10)
    v_mfma_f32_16x16x32_bf16 v[16:19], v[104:107], a[28:31], v[16:19]
    v_mfma_f32_16x16x32_bf16 v[20:23], v[104:107], a[92:95], v[20:23]
    s_waitcnt lgkmcnt(8)
    v_mfma_f32_16x16x32_bf16 v[24:27], v[108:111], a[28:31], v[24:27]
    v_mfma_f32_16x16x32_bf16 v[28:31], v[108:111], a[92:95], v[28:31]
    s_waitcnt lgkmcnt(6)
    v_mfma_f32_16x16x32_bf16 v[32:35], v[112:115], a[28:31], v[32:35]
    v_mfma_f32_16x16x32_bf16 v[36:39], v[112:115], a[92:95], v[36:39]
    s_waitcnt lgkmcnt(4)
    v_mfma_f32_16x16x32_bf16 v[40:43], v[116:119], a[28:31], v[40:43]
    v_mfma_f32_16x16x32_bf16 v[44:47], v[116:119], a[92:95], v[44:47]
    s_waitcnt lgkmcnt(2)
    v_mfma_f32_16x16x32_bf16 v[48:51], v[120:123], a[28:31], v[48:51]
    v_mfma_f32_16x16x32_bf16 v[52:55], v[120:123], a[92:95], v[52:55]
    s_waitcnt lgkmcnt(0)
    v_mfma_f32_16x16x32_bf16 v[56:59], v[124:127], a[28:31], v[56:59]
    v_mfma_f32_16x16x32_bf16 v[60:63], v[124:127], a[92:95], v[60:63]
    v_xor_b32 v128, 0x10000, v128
    v_xor_b32 v129, 0x10000, v129
    v_xor_b32 v130, 0x10000, v130
    v_xor_b32 v131, 0x10000, v131
    v_xor_b32 v132, 0x10000, v132
    v_xor_b32 v133, 0x10000, v133
    v_xor_b32 v134, 0x10000, v134
    v_xor_b32 v135, 0x10000, v135
    s_waitcnt vmcnt(16)
    s_barrier
    ds_read_b64_tr_b16 v[64:65], v128
    ds_read_b64_tr_b16 v[66:67], v128 offset:1024
    ds_read_b64_tr_b16 v[68:69], v129
    ds_read_b64_tr_b16 v[70:71], v129 offset:1024
    ds_read_b64_tr_b16 v[72:73], v130
    ds_read_b64_tr_b16 v[74:75], v130 offset:1024
    ds_read_b64_tr_b16 v[76:77], v131
    ds_read_b64_tr_b16 v[78:79], v131 offset:1024
    ds_read_b64_tr_b16 v[80:81], v132
    ds_read_b64_tr_b16 v[82:83], v132 offset:1024
    ds_read_b64_tr_b16 v[84:85], v133
    ds_read_b64_tr_b16 v[86:87], v133 offset:1024
    ds_read_b64_tr_b16 v[88:89], v134
    ds_read_b64_tr_b16 v[90:91], v134 offset:1024
    s_cmp_eq_u32 s40, 0
    s_cbranch_scc1 L_nopf_86
    s_cmp_lg_u32 s87, 0
    s_cbranch_scc1 L_modeok_87
    s_mov_b32 s96, 0
L_mode_88:
    buffer_load_dwordx2 v[140:141], off, s[92:95], 0 offset:36 sc1
    s_waitcnt vmcnt(0)
    v_readfirstlane_b32 s87, v140
    v_readfirstlane_b32 s97, v141
    s_nop 0
    s_min_u32 s97, s97, s87
    s_cmp_lg_u32 s97, 0
    s_cbranch_scc1 L_moded_89
    s_sleep 4
    s_add_u32 s96, s96, 1
    s_cmp_lg_u32 s96, 0x100
    s_cbranch_scc1 L_modef_90
    v_mov_b32 v140, 2
    v_mov_b32 v141, 0
    s_mov_b64 exec, 1
    buffer_atomic_cmpswap v[140:141], off, s[92:95], 0 offset:36
    s_mov_b64 exec, -1
L_modef_90:
    s_cmp_lt_u32 s96, 0x10000
    s_cbranch_scc1 L_mode_88
L_moded_89:
    s_cmp_lg_u32 s87, 1
    s_cbranch_scc1 L_fallback
L_modeok_87:
    s_cmp_lg_u32 s100, 0
    s_cbranch_scc1 L_flag_91
    v_mov_b32 v138, 1
    s_mov_b64 exec, 1
    buffer_store_dword v138, off, s[8:11], s40 sc1
    s_mov_b64 exec, -1
L_flag_91:
    s_mov_b32 s40, 0
L_nopf_86:
    s_waitcnt lgkmcnt(12)
    v_mfma_f32_16x16x32_bf16 v[0:3], v[64:67], a[32:35], v[0:3]
    ds_read_b64_tr_b16 v[92:93], v135
    v_mfma_f32_16x16x32_bf16 v[4:7], v[64:67], a[96:99], v[4:7]
    ds_read_b64_tr_b16 v[94:95], v135 offset:1024
    s_add_u32 s26, s24, 0x100000
    s_add_u32 m0, s29, 0x8000
    s_nop 0
    buffer_load_dwordx4 v136, s[16:19], s26 offen lds
    s_waitcnt lgkmcnt(12)
    v_mfma_f32_16x16x32_bf16 v[8:11], v[68:71], a[32:35], v[8:11]
    ds_read_b64_tr_b16 v[96:97], v128 offset:8192
    v_mfma_f32_16x16x32_bf16 v[12:15], v[68:71], a[96:99], v[12:15]
    ds_read_b64_tr_b16 v[98:99], v128 offset:9216
    s_add_u32 s26, s24, 0x120000
    s_add_u32 m0, s29, 0x9000
    s_nop 0
    buffer_load_dwordx4 v136, s[16:19], s26 offen lds
    s_waitcnt lgkmcnt(12)
    v_mfma_f32_16x16x32_bf16 v[16:19], v[72:75], a[32:35], v[16:19]
    ds_read_b64_tr_b16 v[100:101], v129 offset:8192
    v_mfma_f32_16x16x32_bf16 v[20:23], v[72:75], a[96:99], v[20:23]
    ds_read_b64_tr_b16 v[102:103], v129 offset:9216
    s_add_u32 s26, s24, 0x140000
    s_add_u32 m0, s29, 0xa000
    s_nop 0
    buffer_load_dwordx4 v136, s[16:19], s26 offen lds
    s_waitcnt lgkmcnt(12)
    v_mfma_f32_16x16x32_bf16 v[24:27], v[76:79], a[32:35], v[24:27]
    ds_read_b64_tr_b16 v[104:105], v130 offset:8192
    v_mfma_f32_16x16x32_bf16 v[28:31], v[76:79], a[96:99], v[28:31]
    ds_read_b64_tr_b16 v[106:107], v130 offset:9216
    s_add_u32 s26, s24, 0x160000
    s_add_u32 m0, s29, 0xb000
    s_nop 0
    buffer_load_dwordx4 v136, s[16:19], s26 offen lds
    s_waitcnt lgkmcnt(12)
    v_mfma_f32_16x16x32_bf16 v[32:35], v[80:83], a[32:35], v[32:35]
    ds_read_b64_tr_b16 v[108:109], v131 offset:8192
    v_mfma_f32_16x16x32_bf16 v[36:39], v[80:83], a[96:99], v[36:39]
    ds_read_b64_tr_b16 v[110:111], v131 offset:9216
    s_add_u32 s26, s24, 0x180000
    s_add_u32 m0, s29, 0xc000
    s_nop 0
    buffer_load_dwordx4 v136, s[16:19], s26 offen lds
    s_waitcnt lgkmcnt(12)
    v_mfma_f32_16x16x32_bf16 v[40:43], v[84:87], a[32:35], v[40:43]
    ds_read_b64_tr_b16 v[112:113], v132 offset:8192
    v_mfma_f32_16x16x32_bf16 v[44:47], v[84:87], a[96:99], v[44:47]
    ds_read_b64_tr_b16 v[114:115], v132 offset:9216
    s_add_u32 s26, s24, 0x1a0000
    s_add_u32 m0, s29, 0xd000
    s_nop 0
    buffer_load_dwordx4 v136, s[16:19], s26 offen lds
    s_waitcnt lgkmcnt(12)
    v_mfma_f32_16x16x32_bf16 v[48:51], v[88:91], a[32:35], v[48:51]
    ds_read_b64_tr_b16 v[116:117], v133 offset:8192
    v_mfma_f32_16x16x32_bf16 v[52:55], v[88:91], a[96:99], v[52:55]
    ds_read_b64_tr_b16 v[118:119], v133 offset:9216
    s_add_u32 s26, s24, 0x1c0000
    s_add_u32 m0, s29, 0xe000
    s_nop 0
    buffer_load_dwordx4 v136, s[16:19], s26 offen lds
    s_waitcnt lgkmcnt(12)
    v_mfma_f32_16x16x32_bf16 v[56:59], v[92:95], a[32:35], v[56:59]
    ds_read_b64_tr_b16 v[120:121], v134 offset:8192
    v_mfma_f32_16x16x32_bf16 v[60:63], v[92:95], a[96:99], v[60:63]
    ds_read_b64_tr_b16 v[122:123], v134 offset:9216
    s_add_u32 s26, s24, 0x1e0000
    s_add_u32 m0, s29, 0xf000
    s_nop 0
    buffer_load_dwordx4 v136, s[16:19], s26 offen lds
    s_waitcnt lgkmcnt(12)
    v_mfma_f32_16x16x32_bf16 v[0:3], v[96:99], a[36:39], v[0:3]
    ds_read_b64_tr_b16 v[124:125], v135 offset:8192
    v_mfma_f32_16x16x32_bf16 v[4:7], v[96:99], a[100:103], v[4:7]
    ds_read_b64_tr_b16 v[126:127], v135 offset:9216
    s_waitcnt lgkmcnt(12)
    v_mfma_f32_16x16x32_bf16 v[8:11], v[100:103], a[36:39], v[8:11]
    ds_read_b64_tr_b16 v[64:65], v128 offset:16384
    v_mfma_f32_16x16x32_bf16 v[12:15], v[100:103], a[100:103], v[12:15]
    ds_read_b64_tr_b16 v[66:67], v128 offset:17408
    s_waitcnt lgkmcnt(12)
    v_mfma_f32_16x16x32_bf16 v[16:19], v[104:107], a[36:39], v[16:19]
    ds_read_b64_tr_b16 v[68:69], v129 offset:16384
    v_mfma_f32_16x16x32_bf16 v[20:23], v[104:107], a[100:103], v[20:23]
    ds_read_b64_tr_b16 v[70:71], v129 offset:17408
    s_waitcnt lgkmcnt(12)
    v_mfma_f32_16x16x32_bf16 v[24:27], v[108:111], a[36:39], v[24:27]
    ds_read_b64_tr_b16 v[72:73], v130 offset:16384
    v_mfma_f32_16x16x32_bf16 v[28:31], v[108:111], a[100:103], v[28:31]
    ds_read_b64_tr_b16 v[74:75], v130 offset:17408
    s_waitcnt lgkmcnt(12)
    v_mfma_f32_16x16x32_bf16 v[32:35], v[112:115], a[36:39], v[32:35]
    ds_read_b64_tr_b16 v[76:77], v131 offset:16384
    v_mfma_f32_16x16x32_bf16 v[36:39], v[112:115], a[100:103], v[36:39]
    ds_read_b64_tr_b16 v[78:79], v131 offset:17408
    s_waitcnt lgkmcnt(12)
    v_mfma_f32_16x16x32_bf16 v[40:43], v[116:119], a[36:39], v[40:43]
    ds_read_b64_tr_b16 v[80:81], v132 offset:16384
    v_mfma_f32_16x16x32_bf16 v[44:47], v[116:119], a[100:103], v[44:47]
    ds_read_b64_tr_b16 v[82:83], v132 offset:17408
    s_waitcnt lgkmcnt(12)
    v_mfma_f32_16x16x32_bf16 v[48:51], v[120:123], a[36:39], v[48:51]
    ds_read_b64_tr_b16 v[84:85], v133 offset:16384
    v_mfma_f32_16x16x32_bf16 v[52:55], v[120:123], a[100:103], v[52:55]
    ds_read_b64_tr_b16 v[86:87], v133 offset:17408
    s_waitcnt lgkmcnt(12)
    v_mfma_f32_16x16x32_bf16 v[56:59], v[124:127], a[36:39], v[56:59]
    ds_read_b64_tr_b16 v[88:89], v134 offset:16384
    v_mfma_f32_16x16x32_bf16 v[60:63], v[124:127], a[100:103], v[60:63]
    ds_read_b64_tr_b16 v[90:91], v134 offset:17408
    s_waitcnt lgkmcnt(12)
    v_mfma_f32_16x16x32_bf16 v[0:3], v[64:67], a[40:43], v[0:3]
    ds_read_b64_tr_b16 v[92:93], v135 offset:16384
    v_mfma_f32_16x16x32_bf16 v[4:7], v[64:67], a[104:107], v[4:7]
    ds_read_b64_tr_b16 v[94:95], v135 offset:17408
    s_waitcnt lgkmcnt(12)
    v_mfma_f32_16x16x32_bf16 v[8:11], v[68:71], a[40:43], v[8:11]
    ds_read_b64_tr_b16 v[96:97], v128 offset:24576
    v_mfma_f32_16x16x32_bf16 v[12:15], v[68:71], a[104:107], v[12:15]
    ds_read_b64_tr_b16 v[98:99], v128 offset:25600
    s_waitcnt lgkmcnt(12)
    v_mfma_f32_16x16x32_bf16 v[16:19], v[72:75], a[40:43], v[16:19]
    ds_read_b64_tr_b16 v[100:101], v129 offset:24576
    v_mfma_f32_16x16x32_bf16 v[20:23], v[72:75], a[104:107], v[20:23]
    ds_read_b64_tr_b16 v[102:103], v129 offset:25600
    s_waitcnt lgkmcnt(12)
    v_mfma_f32_16x16x32_bf16 v[24:27], v[76:79], a[40:43], v[24:27]
    ds_read_b64_tr_b16 v[104:105], v130 offset:24576
    v_mfma_f32_16x16x32_bf16 v[28:31], v[76:79], a[104:107], v[28:31]
    ds_read_b64_tr_b16 v[106:107], v130 offset:25600
    s_waitcnt lgkmcnt(12)
    v_mfma_f32_16x16x32_bf16 v[32:35], v[80:83], a[40:43], v[32:35]
    ds_read_b64_tr_b16 v[108:109], v131 offset:24576
    v_mfma_f32_16x16x32_bf16 v[36:39], v[80:83], a[104:107], v[36:39]
    ds_read_b64_tr_b16 v[110:111], v131 offset:25600
    s_waitcnt lgkmcnt(12)
    v_mfma_f32_16x16x32_bf16 v[40:43], v[84:87], a[40:43], v[40:43]
    ds_read_b64_tr_b16 v[112:113], v132 offset:24576
    v_mfma_f32_16x16x32_bf16 v[44:47], v[84:87], a[104:107], v[44:47]
    ds_read_b64_tr_b16 v[114:115], v132 offset:25600
    s_waitcnt lgkmcnt(12)
    v_mfma_f32_16x16x32_bf16 v[48:51], v[88:91], a[40:43], v[48:51]
    ds_read_b64_tr_b16 v[116:117], v133 offset:24576
    v_mfma_f32_16x16x32_bf16 v[52:55], v[88:91], a[104:107], v[52:55]
    ds_read_b64_tr_b16 v[118:119], v133 offset:25600
    s_waitcnt lgkmcnt(12)
    v_mfma_f32_16x16x32_bf16 v[56:59], v[92:95], a[40:43], v[56:59]
    ds_read_b64_tr_b16 v[120:121], v134 offset:24576
    v_mfma_f32_16x16x32_bf16 v[60:63], v[92:95], a[104:107], v[60:63]
    ds_read_b64_tr_b16 v[122:123], v134 offset:25600
    s_waitcnt lgkmcnt(12)
    v_mfma_f32_16x16x32_bf16 v[0:3], v[96:99], a[44:47], v[0:3]
    ds_read_b64_tr_b16 v[124:125], v135 offset:24576
    v_mfma_f32_16x16x32_bf16 v[4:7], v[96:99], a[108:111], v[4:7]
    ds_read_b64_tr_b16 v[126:127], v135 offset:25600
    s_waitcnt lgkmcnt(12)
    v_mfma_f32_16x16x32_bf16 v[8:11], v[100:103], a[44:47], v[8:11]
    v_mfma_f32_16x16x32_bf16 v[12:15], v[100:103], a[108:111], v[12:15]
    s_waitcnt lgkmcnt(10)
    v_mfma_f32_16x16x32_bf16 v[16:19], v[104:107], a[44:47], v[16:19]
    v_mfma_f32_16x16x32_bf16 v[20:23], v[104:107], a[108:111], v[20:23]
    s_waitcnt lgkmcnt(8)
    v_mfma_f32_16x16x32_bf16 v[24:27], v[108:111], a[44:47], v[24:27]
    v_mfma_f32_16x16x32_bf16 v[28:31], v[108:111], a[108:111], v[28:31]
    s_waitcnt lgkmcnt(6)
    v_mfma_f32_16x16x32_bf16 v[32:35], v[112:115], a[44:47], v[32:35]
    v_mfma_f32_16x16x32_bf16 v[36:39], v[112:115], a[108:111], v[36:39]
    s_waitcnt lgkmcnt(4)
    v_mfma_f32_16x16x32_bf16 v[40:43], v[116:119], a[44:47], v[40:43]
    v_mfma_f32_16x16x32_bf16 v[44:47], v[116:119], a[108:111], v[44:47]
    s_waitcnt lgkmcnt(2)
    v_mfma_f32_16x16x32_bf16 v[48:51], v[120:123], a[44:47], v[48:51]
    v_mfma_f32_16x16x32_bf16 v[52:55], v[120:123], a[108:111], v[52:55]
    s_waitcnt lgkmcnt(0)
    v_mfma_f32_16x16x32_bf16 v[56:59], v[124:127], a[44:47], v[56:59]
    v_mfma_f32_16x16x32_bf16 v[60:63], v[124:127], a[108:111], v[60:63]
    s_waitcnt vmcnt(16)
    s_barrier
    ds_read_b64_tr_b16 v[64:65], v128 offset:32768
    ds_read_b64_tr_b16 v[66:67], v128 offset:33792
    ds_read_b64_tr_b16 v[68:69], v129 offset:32768
    ds_read_b64_tr_b16 v[70:71], v129 offset:33792
    ds_read_b64_tr_b16 v[72:73], v130 offset:32768
    ds_read_b64_tr_b16 v[74:75], v130 offset:33792
    ds_read_b64_tr_b16 v[76:77], v131 offset:32768
    ds_read_b64_tr_b16 v[78:79], v131 offset:33792
    ds_read_b64_tr_b16 v[80:81], v132 offset:32768
    ds_read_b64_tr_b16 v[82:83], v132 offset:33792
    ds_read_b64_tr_b16 v[84:85], v133 offset:32768
    ds_read_b64_tr_b16 v[86:87], v133 offset:33792
    ds_read_b64_tr_b16 v[88:89], v134 offset:32768
    ds_read_b64_tr_b16 v[90:91], v134 offset:33792
    s_waitcnt lgkmcnt(12)
    v_mfma_f32_16x16x32_bf16 v[0:3], v[64:67], a[48:51], v[0:3]
    ds_read_b64_tr_b16 v[92:93], v135 offset:32768
    v_mfma_f32_16x16x32_bf16 v[4:7], v[64:67], a[112:115], v[4:7]
    ds_read_b64_tr_b16 v[94:95], v135 offset:33792
    s_add_u32 s26, s24, 0x200000
    s_add_u32 m0, s29, 0x10000
    s_nop 0
    buffer_load_dwordx4 v136, s[16:19], s26 offen lds
    s_waitcnt lgkmcnt(12)
    v_mfma_f32_16x16x32_bf16 v[8:11], v[68:71], a[48:51], v[8:11]
    ds_read_b64_tr_b16 v[96:97], v128 offset:40960
    v_mfma_f32_16x16x32_bf16 v[12:15], v[68:71], a[112:115], v[12:15]
    ds_read_b64_tr_b16 v[98:99], v128 offset:41984
    s_add_u32 s26, s24, 0x220000
    s_add_u32 m0, s29, 0x11000
    s_nop 0
    buffer_load_dwordx4 v136, s[16:19], s26 offen lds
    s_waitcnt lgkmcnt(12)
    v_mfma_f32_16x16x32_bf16 v[16:19], v[72:75], a[48:51], v[16:19]
    ds_read_b64_tr_b16 v[100:101], v129 offset:40960
    v_mfma_f32_16x16x32_bf16 v[20:23], v[72:75], a[112:115], v[20:23]
    ds_read_b64_tr_b16 v[102:103], v129 offset:41984
    s_add_u32 s26, s24, 0x240000
    s_add_u32 m0, s29, 0x12000
    s_nop 0
    buffer_load_dwordx4 v136, s[16:19], s26 offen lds
    s_waitcnt lgkmcnt(12)
    v_mfma_f32_16x16x32_bf16 v[24:27], v[76:79], a[48:51], v[24:27]
    ds_read_b64_tr_b16 v[104:105], v130 offset:40960
    v_mfma_f32_16x16x32_bf16 v[28:31], v[76:79], a[112:115], v[28:31]
    ds_read_b64_tr_b16 v[106:107], v130 offset:41984
    s_add_u32 s26, s24, 0x260000
    s_add_u32 m0, s29, 0x13000
    s_nop 0
    buffer_load_dwordx4 v136, s[16:19], s26 offen lds
    s_waitcnt lgkmcnt(12)
    v_mfma_f32_16x16x32_bf16 v[32:35], v[80:83], a[48:51], v[32:35]
    ds_read_b64_tr_b16 v[108:109], v131 offset:40960
    v_mfma_f32_16x16x32_bf16 v[36:39], v[80:83], a[112:115], v[36:39]
    ds_read_b64_tr_b16 v[110:111], v131 offset:41984
    s_add_u32 s26, s24, 0x280000
    s_add_u32 m0, s29, 0x14000
    s_nop 0
    buffer_load_dwordx4 v136, s[16:19], s26 offen lds
    s_waitcnt lgkmcnt(12)
    v_mfma_f32_16x16x32_bf16 v[40:43], v[84:87], a[48:51], v[40:43]
    ds_read_b64_tr_b16 v[112:113], v132 offset:40960
    v_mfma_f32_16x16x32_bf16 v[44:47], v[84:87], a[112:115], v[44:47]
    ds_read_b64_tr_b16 v[114:115], v132 offset:41984
    s_add_u32 s26, s24, 0x2a0000
    s_add_u32 m0, s29, 0x15000
    s_nop 0
    buffer_load_dwordx4 v136, s[16:19], s26 offen lds
    s_waitcnt lgkmcnt(12)
    v_mfma_f32_16x16x32_bf16 v[48:51], v[88:91], a[48:51], v[48:51]
    ds_read_b64_tr_b16 v[116:117], v133 offset:40960
    v_mfma_f32_16x16x32_bf16 v[52:55], v[88:91], a[112:115], v[52:55]
    ds_read_b64_tr_b16 v[118:119], v133 offset:41984
    s_add_u32 s26, s24, 0x2c0000
    s_add_u32 m0, s29, 0x16000
    s_nop 0
    buffer_load_dwordx4 v136, s[16:19], s26 offen lds
    s_waitcnt lgkmcnt(12)
    v_mfma_f32_16x16x32_bf16 v[56:59], v[92:95], a[48:51], v[56:59]
    ds_read_b64_tr_b16 v[120:121], v134 offset:40960
    v_mfma_f32_16x16x32_bf16 v[60:63], v[92:95], a[112:115], v[60:63]
    ds_read_b64_tr_b16 v[122:123], v134 offset:41984
    s_add_u32 s26, s24, 0x2e0000
    s_add_u32 m0, s29, 0x17000
    s_nop 0
    buffer_load_dwordx4 v136, s[16:19], s26 offen lds
    s_waitcnt lgkmcnt(12)
    v_mfma_f32_16x16x32_bf16 v[0:3], v[96:99], a[52:55], v[0:3]
    ds_read_b64_tr_b16 v[124:125], v135 offset:40960
    v_mfma_f32_16x16x32_bf16 v[4:7], v[96:99], a[116:119], v[4:7]
    ds_read_b64_tr_b16 v[126:127], v135 offset:41984
    s_waitcnt lgkmcnt(12)
    v_mfma_f32_16x16x32_bf16 v[8:11], v[100:103], a[52:55], v[8:11]
    ds_read_b64_tr_b16 v[64:65], v128 offset:49152
    v_mfma_f32_16x16x32_bf16 v[12:15], v[100:103], a[116:119], v[12:15]
    ds_read_b64_tr_b16 v[66:67], v128 offset:50176
    s_waitcnt lgkmcnt(12)
    v_mfma_f32_16x16x32_bf16 v[16:19], v[104:107], a[52:55], v[16:19]
    ds_read_b64_tr_b16 v[68:69], v129 offset:49152
    v_mfma_f32_16x16x32_bf16 v[20:23], v[104:107], a[116:119], v[20:23]
    ds_read_b64_tr_b16 v[70:71], v129 offset:50176
    s_waitcnt lgkmcnt(12)
    v_mfma_f32_16x16x32_bf16 v[24:27], v[108:111], a[52:55], v[24:27]
    ds_read_b64_tr_b16 v[72:73], v130 offset:49152
    v_mfma_f32_16x16x32_bf16 v[28:31], v[108:111], a[116:119], v[28:31]
    ds_read_b64_tr_b16 v[74:75], v130 offset:50176
    s_waitcnt lgkmcnt(12)
    v_mfma_f32_16x16x32_bf16 v[32:35], v[112:115], a[52:55], v[32:35]
    ds_read_b64_tr_b16 v[76:77], v131 offset:49152
    v_mfma_f32_16x16x32_bf16 v[36:39], v[112:115], a[116:119], v[36:39]
    ds_read_b64_tr_b16 v[78:79], v131 offset:50176
    s_waitcnt lgkmcnt(12)
    v_mfma_f32_16x16x32_bf16 v[40:43], v[116:119], a[52:55], v[40:43]
    ds_read_b64_tr_b16 v[80:81], v132 offset:49152
    v_mfma_f32_16x16x32_bf16 v[44:47], v[116:119], a[116:119], v[44:47]
    ds_read_b64_tr_b16 v[82:83], v132 offset:50176
    s_waitcnt lgkmcnt(12)
    v_mfma_f32_16x16x32_bf16 v[48:51], v[120:123], a[52:55], v[48:51]
    ds_read_b64_tr_b16 v[84:85], v133 offset:49152
    v_mfma_f32_16x16x32_bf16 v[52:55], v[120:123], a[116:119], v[52:55]
    ds_read_b64_tr_b16 v[86:87], v133 offset:50176
    s_waitcnt lgkmcnt(12)
    v_mfma_f32_16x16x32_bf16 v[56:59], v[124:127], a[52:55], v[56:59]
    ds_read_b64_tr_b16 v[88:89], v134 offset:49152
    v_mfma_f32_16x16x32_bf16 v[60:63], v[124:127], a[116:119], v[60:63]
    ds_read_b64_tr_b16 v[90:91], v134 offset:50176
    s_waitcnt lgkmcnt(12)
    v_mfma_f32_16x16x32_bf16 v[0:3], v[64:67], a[56:59], v[0:3]
    ds_read_b64_tr_b16 v[92:93], v135 offset:49152
    v_mfma_f32_16x16x32_bf16 v[4:7], v[64:67], a[120:123], v[4:7]
    ds_read_b64_tr_b16 v[94:95], v135 offset:50176
    s_waitcnt lgkmcnt(12)
    v_mfma_f32_16x16x32_bf16 v[8:11], v[68:71], a[56:59], v[8:11]
    ds_read_b64_tr_b16 v[96:97], v128 offset:57344
    v_mfma_f32_16x16x32_bf16 v[12:15], v[68:71], a[120:123], v[12:15]
    ds_read_b64_tr_b16 v[98:99], v128 offset:58368
    s_waitcnt lgkmcnt(12)
    v_mfma_f32_16x16x32_bf16 v[16:19], v[72:75], a[56:59], v[16:19]
    ds_read_b64_tr_b16 v[100:101], v129 offset:57344
    v_mfma_f32_16x16x32_bf16 v[20:23], v[72:75], a[120:123], v[20:23]
    ds_read_b64_tr_b16 v[102:103], v129 offset:58368
    s_waitcnt lgkmcnt(12)
    v_mfma_f32_16x16x32_bf16 v[24:27], v[76:79], a[56:59], v[24:27]
    ds_read_b64_tr_b16 v[104:105], v130 offset:57344
    v_mfma_f32_16x16x32_bf16 v[28:31], v[76:79], a[120:123], v[28:31]
    ds_read_b64_tr_b16 v[106:107], v130 offset:58368
    s_waitcnt lgkmcnt(12)
    v_mfma_f32_16x16x32_bf16 v[32:35], v[80:83], a[56:59], v[32:35]
    ds_read_b64_tr_b16 v[108:109], v131 offset:57344
    v_mfma_f32_16x16x32_bf16 v[36:39], v[80:83], a[120:123], v[36:39]
    ds_read_b64_tr_b16 v[110:111], v131 offset:58368
    s_waitcnt lgkmcnt(12)
    v_mfma_f32_16x16x32_bf16 v[40:43], v[84:87], a[56:59], v[40:43]
    ds_read_b64_tr_b16 v[112:113], v132 offset:57344
    v_mfma_f32_16x16x32_bf16 v[44:47], v[84:87], a[120:123], v[44:47]
    ds_read_b64_tr_b16 v[114:115], v132 offset:58368
    s_waitcnt lgkmcnt(12)
    v_mfma_f32_16x16x32_bf16 v[48:51], v[88:91], a[56:59], v[48:51]
    ds_read_b64_tr_b16 v[116:117], v133 offset:57344
    v_mfma_f32_16x16x32_bf16 v[52:55], v[88:91], a[120:123], v[52:55]
    ds_read_b64_tr_b16 v[118:119], v133 offset:58368
    s_waitcnt lgkmcnt(12)
    v_mfma_f32_16x16x32_bf16 v[56:59], v[92:95], a[56:59], v[56:59]
    ds_read_b64_tr_b16 v[120:121], v134 offset:57344
    v_mfma_f32_16x16x32_bf16 v[60:63], v[92:95], a[120:123], v[60:63]
    ds_read_b64_tr_b16 v[122:123], v134 offset:58368
    s_waitcnt lgkmcnt(12)
    v_mfma_f32_16x16x32_bf16 v[0:3], v[96:99], a[60:63], v[0:3]
    ds_read_b64_tr_b16 v[124:125], v135 offset:57344
    v_mfma_f32_16x16x32_bf16 v[4:7], v[96:99], a[124:127], v[4:7]
    ds_read_b64_tr_b16 v[126:127], v135 offset:58368
    s_waitcnt lgkmcnt(12)
    v_mfma_f32_16x16x32_bf16 v[8:11], v[100:103], a[60:63], v[8:11]
    v_mfma_f32_16x16x32_bf16 v[12:15], v[100:103], a[124:127], v[12:15]
    s_waitcnt lgkmcnt(10)
    v_mfma_f32_16x16x32_bf16 v[16:19], v[104:107], a[60:63], v[16:19]
    v_mfma_f32_16x16x32_bf16 v[20:23], v[104:107], a[124:127], v[20:23]
    s_waitcnt lgkmcnt(8)
    v_mfma_f32_16x16x32_bf16 v[24:27], v[108:111], a[60:63], v[24:27]
    v_mfma_f32_16x16x32_bf16 v[28:31], v[108:111], a[124:127], v[28:31]
    s_waitcnt lgkmcnt(6)
    v_mfma_f32_16x16x32_bf16 v[32:35], v[112:115], a[60:63], v[32:35]
    v_mfma_f32_16x16x32_bf16 v[36:39], v[112:115], a[124:127], v[36:39]
    s_waitcnt lgkmcnt(4)
    v_mfma_f32_16x16x32_bf16 v[40:43], v[116:119], a[60:63], v[40:43]
    v_mfma_f32_16x16x32_bf16 v[44:47], v[116:119], a[124:127], v[44:47]
    s_waitcnt lgkmcnt(2)
    v_mfma_f32_16x16x32_bf16 v[48:51], v[120:123], a[60:63], v[48:51]
    v_mfma_f32_16x16x32_bf16 v[52:55], v[120:123], a[124:127], v[52:55]
    s_waitcnt lgkmcnt(0)
    v_mfma_f32_16x16x32_bf16 v[56:59], v[124:127], a[60:63], v[56:59]
    v_mfma_f32_16x16x32_bf16 v[60:63], v[124:127], a[124:127], v[60:63]
    v_xor_b32 v128, 0x10000, v128
    v_xor_b32 v129, 0x10000, v129
    v_xor_b32 v130, 0x10000, v130
    v_xor_b32 v131, 0x10000, v131
    v_xor_b32 v132, 0x10000, v132
    v_xor_b32 v133, 0x10000, v133
    v_xor_b32 v134, 0x10000, v134
    v_xor_b32 v135, 0x10000, v135
    v_cvt_pk_bf16_f32 v144, v0, v8
    v_cvt_pk_bf16_f32 v145, v1, v9
    v_cvt_pk_bf16_f32 v146, v2, v10
    v_cvt_pk_bf16_f32 v147, v3, v11
    buffer_store_dwordx4 v[144:147], v137, s[8:11], s25 offen sc1
    v_cvt_pk_bf16_f32 v148, v16, v24
    v_cvt_pk_bf16_f32 v149, v17, v25
    v_cvt_pk_bf16_f32 v150, v18, v26
    v_cvt_pk_bf16_f32 v151, v19, v27
    buffer_store_dwordx4 v[148:151], v137, s[8:11], s25 offen offset:1024 sc1
    v_cvt_pk_bf16_f32 v152, v32, v40
    v_cvt_pk_bf16_f32 v153, v33, v41
    v_cvt_pk_bf16_f32 v154, v34, v42
    v_cvt_pk_bf16_f32 v155, v35, v43
    buffer_store_dwordx4 v[152:155], v137, s[8:11], s25 offen offset:2048 sc1
    v_cvt_pk_bf16_f32 v156, v48, v56
    v_cvt_pk_bf16_f32 v157, v49, v57
    v_cvt_pk_bf16_f32 v158, v50, v58
    v_cvt_pk_bf16_f32 v159, v51, v59
    buffer_store_dwordx4 v[156:159], v137, s[8:11], s25 offen offset:3072 sc1
    v_cvt_pk_bf16_f32 v144, v4, v12
    v_cvt_pk_bf16_f32 v145, v5, v13
    v_cvt_pk_bf16_f32 v146, v6, v14
    v_cvt_pk_bf16_f32 v147, v7, v15
    s_add_u32 s25, s25, 4096
    buffer_store_dwordx4 v[144:147], v137, s[8:11], s25 offen sc1
    v_cvt_pk_bf16_f32 v148, v20, v28
    v_cvt_pk_bf16_f32 v149, v21, v29
    v_cvt_pk_bf16_f32 v150, v22, v30
    v_cvt_pk_bf16_f32 v151, v23, v31
    buffer_store_dwordx4 v[148:151], v137, s[8:11], s25 offen offset:1024 sc1
    v_cvt_pk_bf16_f32 v152, v36, v44
    v_cvt_pk_bf16_f32 v153, v37, v45
    v_cvt_pk_bf16_f32 v154, v38, v46
    v_cvt_pk_bf16_f32 v155, v39, v47
    buffer_store_dwordx4 v[152:155], v137, s[8:11], s25 offen offset:2048 sc1
    v_cvt_pk_bf16_f32 v156, v52, v60
    v_cvt_pk_bf16_f32 v157, v53, v61
    v_cvt_pk_bf16_f32 v158, v54, v62
    v_cvt_pk_bf16_f32 v159, v55, v63
    buffer_store_dwordx4 v[156:159], v137, s[8:11], s25 offen offset:3072 sc1
    s_branch L_p1_next
L_p1_v:
    s_waitcnt vmcnt(16)
    s_barrier
    ds_read_b64_tr_b16 v[64:65], v128
    ds_read_b64_tr_b16 v[66:67], v128 offset:1024
    ds_read_b64_tr_b16 v[68:69], v129
    ds_read_b64_tr_b16 v[70:71], v129 offset:1024
    ds_read_b64_tr_b16 v[72:73], v130
    ds_read_b64_tr_b16 v[74:75], v130 offset:1024
    ds_read_b64_tr_b16 v[76:77], v131
    ds_read_b64_tr_b16 v[78:79], v131 offset:1024
    ds_read_b64_tr_b16 v[80:81], v132
    ds_read_b64_tr_b16 v[82:83], v132 offset:1024
    ds_read_b64_tr_b16 v[84:85], v133
    ds_read_b64_tr_b16 v[86:87], v133 offset:1024
    ds_read_b64_tr_b16 v[88:89], v134
    ds_read_b64_tr_b16 v[90:91], v134 offset:1024
    s_waitcnt lgkmcnt(12)
    v_mfma_f32_16x16x32_bf16 v[0:3], a[0:3], v[64:67], 0
    ds_read_b64_tr_b16 v[92:93], v135
    v_mfma_f32_16x16x32_bf16 v[4:7], a[64:67], v[64:67], 0
    ds_read_b64_tr_b16 v[94:95], v135 offset:1024
    s_add_u32 s26, s24, 0x300000
    s_add_u32 m0, s29, 0x18000
    s_nop 0
    buffer_load_dwordx4 v136, s[16:19], s26 offen lds
    s_waitcnt lgkmcnt(12)
    v_mfma_f32_16x16x32_bf16 v[8:11], a[0:3], v[68:71], 0
    ds_read_b64_tr_b16 v[96:97], v128 offset:8192
    v_mfma_f32_16x16x32_bf16 v[12:15], a[64:67], v[68:71], 0
    ds_read_b64_tr_b16 v[98:99], v128 offset:9216
    s_add_u32 s26, s24, 0x320000
    s_add_u32 m0, s29, 0x19000
    s_nop 0
    buffer_load_dwordx4 v136, s[16:19], s26 offen lds
    s_waitcnt lgkmcnt(12)
    v_mfma_f32_16x16x32_bf16 v[16:19], a[0:3], v[72:75], 0
    ds_read_b64_tr_b16 v[100:101], v129 offset:8192
    v_mfma_f32_16x16x32_bf16 v[20:23], a[64:67], v[72:75], 0
    ds_read_b64_tr_b16 v[102:103], v129 offset:9216
    s_add_u32 s26, s24, 0x340000
    s_add_u32 m0, s29, 0x1a000
    s_nop 0
    buffer_load_dwordx4 v136, s[16:19], s26 offen lds
    s_waitcnt lgkmcnt(12)
    v_mfma_f32_16x16x32_bf16 v[24:27], a[0:3], v[76:79], 0
    ds_read_b64_tr_b16 v[104:105], v130 offset:8192
    v_mfma_f32_16x16x32_bf16 v[28:31], a[64:67], v[76:79], 0
    ds_read_b64_tr_b16 v[106:107], v130 offset:9216
    s_add_u32 s26, s24, 0x360000
    s_add_u32 m0, s29, 0x1b000
    s_nop 0
    buffer_load_dwordx4 v136, s[16:19], s26 offen lds
    s_waitcnt lgkmcnt(12)
    v_mfma_f32_16x16x32_bf16 v[32:35], a[0:3], v[80:83], 0
    ds_read_b64_tr_b16 v[108:109], v131 offset:8192
    v_mfma_f32_16x16x32_bf16 v[36:39], a[64:67], v[80:83], 0
    ds_read_b64_tr_b16 v[110:111], v131 offset:9216
    s_add_u32 s26, s24, 0x380000
    s_add_u32 m0, s29, 0x1c000
    s_nop 0
    buffer_load_dwordx4 v136, s[16:19], s26 offen lds
    s_waitcnt lgkmcnt(12)
    v_mfma_f32_16x16x32_bf16 v[40:43], a[0:3], v[84:87], 0
    ds_read_b64_tr_b16 v[112:113], v132 offset:8192
    v_mfma_f32_16x16x32_bf16 v[44:47], a[64:67], v[84:87], 0
    ds_read_b64_tr_b16 v[114:115], v132 offset:9216
    s_add_u32 s26, s24, 0x3a0000
    s_add_u32 m0, s29, 0x1d000
    s_nop 0
    buffer_load_dwordx4 v136, s[16:19], s26 offen lds
    s_waitcnt lgkmcnt(12)
    v_mfma_f32_16x16x32_bf16 v[48:51], a[0:3], v[88:91], 0
    ds_read_b64_tr_b16 v[116:117], v133 offset:8192
    v_mfma_f32_16x16x32_bf16 v[52:55], a[64:67], v[88:91], 0
    ds_read_b64_tr_b16 v[118:119], v133 offset:9216
    s_add_u32 s26, s24, 0x3c0000
    s_add_u32 m0, s29, 0x1e000
    s_nop 0
    buffer_load_dwordx4 v136, s[16:19], s26 offen lds
    s_waitcnt lgkmcnt(12)
    v_mfma_f32_16x16x32_bf16 v[56:59], a[0:3], v[92:95], 0
    ds_read_b64_tr_b16 v[120:121], v134 offset:8192
    v_mfma_f32_16x16x32_bf16 v[60:63], a[64:67], v[92:95], 0
    ds_read_b64_tr_b16 v[122:123], v134 offset:9216
    s_add_u32 s26, s24, 0x3e0000
    s_add_u32 m0, s29, 0x1f000
    s_nop 0
    buffer_load_dwordx4 v136, s[16:19], s26 offen lds
    s_waitcnt lgkmcnt(12)
    v_mfma_f32_16x16x32_bf16 v[0:3], a[4:7], v[96:99], v[0:3]
    ds_read_b64_tr_b16 v[124:125], v135 offset:8192
    v_mfma_f32_16x16x32_bf16 v[4:7], a[68:71], v[96:99], v[4:7]
    ds_read_b64_tr_b16 v[126:127], v135 offset:9216
    s_waitcnt lgkmcnt(12)
    v_mfma_f32_16x16x32_bf16 v[8:11], a[4:7], v[100:103], v[8:11]
    ds_read_b64_tr_b16 v[64:65], v128 offset:16384
    v_mfma_f32_16x16x32_bf16 v[12:15], a[68:71], v[100:103], v[12:15]
    ds_read_b64_tr_b16 v[66:67], v128 offset:17408
    s_waitcnt lgkmcnt(12)
    v_mfma_f32_16x16x32_bf16 v[16:19], a[4:7], v[104:107], v[16:19]
    ds_read_b64_tr_b16 v[68:69], v129 offset:16384
    v_mfma_f32_16x16x32_bf16 v[20:23], a[68:71], v[104:107], v[20:23]
    ds_read_b64_tr_b16 v[70:71], v129 offset:17408
    s_waitcnt lgkmcnt(12)
    v_mfma_f32_16x16x32_bf16 v[24:27], a[4:7], v[108:111], v[24:27]
    ds_read_b64_tr_b16 v[72:73], v130 offset:16384
    v_mfma_f32_16x16x32_bf16 v[28:31], a[68:71], v[108:111], v[28:31]
    ds_read_b64_tr_b16 v[74:75], v130 offset:17408
    s_waitcnt lgkmcnt(12)
    v_mfma_f32_16x16x32_bf16 v[32:35], a[4:7], v[112:115], v[32:35]
    ds_read_b64_tr_b16 v[76:77], v131 offset:16384
    v_mfma_f32_16x16x32_bf16 v[36:39], a[68:71], v[112:115], v[36:39]
    ds_read_b64_tr_b16 v[78:79], v131 offset:17408
    s_waitcnt lgkmcnt(12)
    v_mfma_f32_16x16x32_bf16 v[40:43], a[4:7], v[116:119], v[40:43]
    ds_read_b64_tr_b16 v[80:81], v132 offset:16384
    v_mfma_f32_16x16x32_bf16 v[44:47], a[68:71], v[116:119], v[44:47]
    ds_read_b64_tr_b16 v[82:83], v132 offset:17408
    s_waitcnt lgkmcnt(12)
    v_mfma_f32_16x16x32_bf16 v[48:51], a[4:7], v[120:123], v[48:51]
    ds_read_b64_tr_b16 v[84:85], v133 offset:16384
    v_mfma_f32_16x16x32_bf16 v[52:55], a[68:71], v[120:123], v[52:55]
    ds_read_b64_tr_b16 v[86:87], v133 offset:17408
    s_waitcnt lgkmcnt(12)
    v_mfma_f32_16x16x32_bf16 v[56:59], a[4:7], v[124:127], v[56:59]
    ds_read_b64_tr_b16 v[88:89], v134 offset:16384
    v_mfma_f32_16x16x32_bf16 v[60:63], a[68:71], v[124:127], v[60:63]
    ds_read_b64_tr_b16 v[90:91], v134 offset:17408
    s_waitcnt lgkmcnt(12)
    v_mfma_f32_16x16x32_bf16 v[0:3], a[8:11], v[64:67], v[0:3]
    ds_read_b64_tr_b16 v[92:93], v135 offset:16384
    v_mfma_f32_16x16x32_bf16 v[4:7], a[72:75], v[64:67], v[4:7]
    ds_read_b64_tr_b16 v[94:95], v135 offset:17408
    s_waitcnt lgkmcnt(12)
    v_mfma_f32_16x16x32_bf16 v[8:11], a[8:11], v[68:71], v[8:11]
    ds_read_b64_tr_b16 v[96:97], v128 offset:24576
    v_mfma_f32_16x16x32_bf16 v[12:15], a[72:75], v[68:71], v[12:15]
    ds_read_b64_tr_b16 v[98:99], v128 offset:25600
    s_waitcnt lgkmcnt(12)
    v_mfma_f32_16x16x32_bf16 v[16:19], a[8:11], v[72:75], v[16:19]
    ds_read_b64_tr_b16 v[100:101], v129 offset:24576
    v_mfma_f32_16x16x32_bf16 v[20:23], a[72:75], v[72:75], v[20:23]
    ds_read_b64_tr_b16 v[102:103], v129 offset:25600
    s_waitcnt lgkmcnt(12)
    v_mfma_f32_16x16x32_bf16 v[24:27], a[8:11], v[76:79], v[24:27]
    ds_read_b64_tr_b16 v[104:105], v130 offset:24576
    v_mfma_f32_16x16x32_bf16 v[28:31], a[72:75], v[76:79], v[28:31]
    ds_read_b64_tr_b16 v[106:107], v130 offset:25600
    s_waitcnt lgkmcnt(12)
    v_mfma_f32_16x16x32_bf16 v[32:35], a[8:11], v[80:83], v[32:35]
    ds_read_b64_tr_b16 v[108:109], v131 offset:24576
    v_mfma_f32_16x16x32_bf16 v[36:39], a[72:75], v[80:83], v[36:39]
    ds_read_b64_tr_b16 v[110:111], v131 offset:25600
    s_waitcnt lgkmcnt(12)
    v_mfma_f32_16x16x32_bf16 v[40:43], a[8:11], v[84:87], v[40:43]
    ds_read_b64_tr_b16 v[112:113], v132 offset:24576
    v_mfma_f32_16x16x32_bf16 v[44:47], a[72:75], v[84:87], v[44:47]
    ds_read_b64_tr_b16 v[114:115], v132 offset:25600
    s_waitcnt lgkmcnt(12)
    v_mfma_f32_16x16x32_bf16 v[48:51], a[8:11], v[88:91], v[48:51]
    ds_read_b64_tr_b16 v[116:117], v133 offset:24576
    v_mfma_f32_16x16x32_bf16 v[52:55], a[72:75], v[88:91], v[52:55]
    ds_read_b64_tr_b16 v[118:119], v133 offset:25600
    s_waitcnt lgkmcnt(12)
    v_mfma_f32_16x16x32_bf16 v[56:59], a[8:11], v[92:95], v[56:59]
    ds_read_b64_tr_b16 v[120:121], v134 offset:24576
    v_mfma_f32_16x16x32_bf16 v[60:63], a[72:75], v[92:95], v[60:63]
    ds_read_b64_tr_b16 v[122:123], v134 offset:25600
    s_waitcnt lgkmcnt(12)
    v_mfma_f32_16x16x32_bf16 v[0:3], a[12:15], v[96:99], v[0:3]
    ds_read_b64_tr_b16 v[124:125], v135 offset:24576
    v_mfma_f32_16x16x32_bf16 v[4:7], a[76:79], v[96:99], v[4:7]
    ds_read_b64_tr_b16 v[126:127], v135 offset:25600
    s_waitcnt lgkmcnt(12)
    v_mfma_f32_16x16x32_bf16 v[8:11], a[12:15], v[100:103], v[8:11]
    v_mfma_f32_16x16x32_bf16 v[12:15], a[76:79], v[100:103], v[12:15]
    s_waitcnt lgkmcnt(10)
    v_mfma_f32_16x16x32_bf16 v[16:19], a[12:15], v[104:107], v[16:19]
    v_mfma_f32_16x16x32_bf16 v[20:23], a[76:79], v[104:107], v[20:23]
    s_waitcnt lgkmcnt(8)
    v_mfma_f32_16x16x32_bf16 v[24:27], a[12:15], v[108:111], v[24:27]
    v_mfma_f32_16x16x32_bf16 v[28:31], a[76:79], v[108:111], v[28:31]
    s_waitcnt lgkmcnt(6)
    v_mfma_f32_16x16x32_bf16 v[32:35], a[12:15], v[112:115], v[32:35]
    v_mfma_f32_16x16x32_bf16 v[36:39], a[76:79], v[112:115], v[36:39]
    s_waitcnt lgkmcnt(4)
    v_mfma_f32_16x16x32_bf16 v[40:43], a[12:15], v[116:119], v[40:43]
    v_mfma_f32_16x16x32_bf16 v[44:47], a[76:79], v[116:119], v[44:47]
    s_waitcnt lgkmcnt(2)
    v_mfma_f32_16x16x32_bf16 v[48:51], a[12:15], v[120:123], v[48:51]
    v_mfma_f32_16x16x32_bf16 v[52:55], a[76:79], v[120:123], v[52:55]
    s_waitcnt lgkmcnt(0)
    v_mfma_f32_16x16x32_bf16 v[56:59], a[12:15], v[124:127], v[56:59]
    v_mfma_f32_16x16x32_bf16 v[60:63], a[76:79], v[124:127], v[60:63]
    s_waitcnt vmcnt(16)
    s_barrier
    ds_read_b64_tr_b16 v[64:65], v128 offset:32768
    ds_read_b64_tr_b16 v[66:67], v128 offset:33792
    ds_read_b64_tr_b16 v[68:69], v129 offset:32768
    ds_read_b64_tr_b16 v[70:71], v129 offset:33792
    ds_read_b64_tr_b16 v[72:73], v130 offset:32768
    ds_read_b64_tr_b16 v[74:75], v130 offset:33792
    ds_read_b64_tr_b16 v[76:77], v131 offset:32768
    ds_read_b64_tr_b16 v[78:79], v131 offset:33792
    ds_read_b64_tr_b16 v[80:81], v132 offset:32768
    ds_read_b64_tr_b16 v[82:83], v132 offset:33792
    ds_read_b64_tr_b16 v[84:85], v133 offset:32768
    ds_read_b64_tr_b16 v[86:87], v133 offset:33792
    ds_read_b64_tr_b16 v[88:89], v134 offset:32768
    ds_read_b64_tr_b16 v[90:91], v134 offset:33792
    s_add_u32 s39, s39, s37
    s_lshr_b32 s26, s39, 5
    s_cmp_eq_u32 s26, 0
    s_cselect_b64 s[16:17], s[30:31], s[34:35]
    s_cmp_eq_u32 s26, 1
    s_cselect_b64 s[16:17], s[32:33], s[16:17]
    s_and_b32 s17, s17, 0xffff
    s_cmp_lt_u32 s39, 96
    s_cselect_b32 s18, 0x400000, 0
    s_and_b32 s24, s39, 31
    s_lshl_b32 s24, s24, 8
    s_waitcnt lgkmcnt(12)
    v_mfma_f32_16x16x32_bf16 v[0:3], a[16:19], v[64:67], v[0:3]
    ds_read_b64_tr_b16 v[92:93], v135 offset:32768
    v_mfma_f32_16x16x32_bf16 v[4:7], a[80:83], v[64:67], v[4:7]
    ds_read_b64_tr_b16 v[94:95], v135 offset:33792
    s_add_u32 s26, s24, 0x0
    s_add_u32 m0, s29, 0x0
    s_nop 0
    buffer_load_dwordx4 v136, s[16:19], s26 offen lds
    s_waitcnt lgkmcnt(12)
    v_mfma_f32_16x16x32_bf16 v[8:11], a[16:19], v[68:71], v[8:11]
    ds_read_b64_tr_b16 v[96:97], v128 offset:40960
    v_mfma_f32_16x16x32_bf16 v[12:15], a[80:83], v[68:71], v[12:15]
    ds_read_b64_tr_b16 v[98:99], v128 offset:41984
    s_add_u32 s26, s24, 0x20000
    s_add_u32 m0, s29, 0x1000
    s_nop 0
    buffer_load_dwordx4 v136, s[16:19], s26 offen lds
    s_waitcnt lgkmcnt(12)
    v_mfma_f32_16x16x32_bf16 v[16:19], a[16:19], v[72:75], v[16:19]
    ds_read_b64_tr_b16 v[100:101], v129 offset:40960
    v_mfma_f32_16x16x32_bf16 v[20:23], a[80:83], v[72:75], v[20:23]
    ds_read_b64_tr_b16 v[102:103], v129 offset:41984
    s_add_u32 s26, s24, 0x40000
    s_add_u32 m0, s29, 0x2000
    s_nop 0
    buffer_load_dwordx4 v136, s[16:19], s26 offen lds
    s_waitcnt lgkmcnt(12)
    v_mfma_f32_16x16x32_bf16 v[24:27], a[16:19], v[76:79], v[24:27]
    ds_read_b64_tr_b16 v[104:105], v130 offset:40960
    v_mfma_f32_16x16x32_bf16 v[28:31], a[80:83], v[76:79], v[28:31]
    ds_read_b64_tr_b16 v[106:107], v130 offset:41984
    s_add_u32 s26, s24, 0x60000
    s_add_u32 m0, s29, 0x3000
    s_nop 0
    buffer_load_dwordx4 v136, s[16:19], s26 offen lds
    s_waitcnt lgkmcnt(12)
    v_mfma_f32_16x16x32_bf16 v[32:35], a[16:19], v[80:83], v[32:35]
    ds_read_b64_tr_b16 v[108:109], v131 offset:40960
    v_mfma_f32_16x16x32_bf16 v[36:39], a[80:83], v[80:83], v[36:39]
    ds_read_b64_tr_b16 v[110:111], v131 offset:41984
    s_add_u32 s26, s24, 0x80000
    s_add_u32 m0, s29, 0x4000
    s_nop 0
    buffer_load_dwordx4 v136, s[16:19], s26 offen lds
    s_waitcnt lgkmcnt(12)
    v_mfma_f32_16x16x32_bf16 v[40:43], a[16:19], v[84:87], v[40:43]
    ds_read_b64_tr_b16 v[112:113], v132 offset:40960
    v_mfma_f32_16x16x32_bf16 v[44:47], a[80:83], v[84:87], v[44:47]
    ds_read_b64_tr_b16 v[114:115], v132 offset:41984
    s_add_u32 s26, s24, 0xa0000
    s_add_u32 m0, s29, 0x5000
    s_nop 0
    buffer_load_dwordx4 v136, s[16:19], s26 offen lds
    s_waitcnt lgkmcnt(12)
    v_mfma_f32_16x16x32_bf16 v[48:51], a[16:19], v[88:91], v[48:51]
    ds_read_b64_tr_b16 v[116:117], v133 offset:40960
    v_mfma_f32_16x16x32_bf16 v[52:55], a[80:83], v[88:91], v[52:55]
    ds_read_b64_tr_b16 v[118:119], v133 offset:41984
    s_add_u32 s26, s24, 0xc0000
    s_add_u32 m0, s29, 0x6000
    s_nop 0
    buffer_load_dwordx4 v136, s[16:19], s26 offen lds
    s_waitcnt lgkmcnt(12)
    v_mfma_f32_16x16x32_bf16 v[56:59], a[16:19], v[92:95], v[56:59]
    ds_read_b64_tr_b16 v[120:121], v134 offset:40960
    v_mfma_f32_16x16x32_bf16 v[60:63], a[80:83], v[92:95], v[60:63]
    ds_read_b64_tr_b16 v[122:123], v134 offset:41984
    s_add_u32 s26, s24, 0xe0000
    s_add_u32 m0, s29, 0x7000
    s_nop 0
    buffer_load_dwordx4 v136, s[16:19], s26 offen lds
    s_waitcnt lgkmcnt(12)
    v_mfma_f32_16x16x32_bf16 v[0:3], a[20:23], v[96:99], v[0:3]
    ds_read_b64_tr_b16 v[124:125], v135 offset:40960
    v_mfma_f32_16x16x32_bf16 v[4:7], a[84:87], v[96:99], v[4:7]
    ds_read_b64_tr_b16 v[126:127], v135 offset:41984
    s_waitcnt lgkmcnt(12)
    v_mfma_f32_16x16x32_bf16 v[8:11], a[20:23], v[100:103], v[8:11]
    ds_read_b64_tr_b16 v[64:65], v128 offset:49152
    v_mfma_f32_16x16x32_bf16 v[12:15], a[84:87], v[100:103], v[12:15]
    ds_read_b64_tr_b16 v[66:67], v128 offset:50176
    s_waitcnt lgkmcnt(12)
    v_mfma_f32_16x16x32_bf16 v[16:19], a[20:23], v[104:107], v[16:19]
    ds_read_b64_tr_b16 v[68:69], v129 offset:49152
    v_mfma_f32_16x16x32_bf16 v[20:23], a[84:87], v[104:107], v[20:23]
    ds_read_b64_tr_b16 v[70:71], v129 offset:50176
    s_waitcnt lgkmcnt(12)
    v_mfma_f32_16x16x32_bf16 v[24:27], a[20:23], v[108:111], v[24:27]
    ds_read_b64_tr_b16 v[72:73], v130 offset:49152
    v_mfma_f32_16x16x32_bf16 v[28:31], a[84:87], v[108:111], v[28:31]
    ds_read_b64_tr_b16 v[74:75], v130 offset:50176
    s_waitcnt lgkmcnt(12)
    v_mfma_f32_16x16x32_bf16 v[32:35], a[20:23], v[112:115], v[32:35]
    ds_read_b64_tr_b16 v[76:77], v131 offset:49152
    v_mfma_f32_16x16x32_bf16 v[36:39], a[84:87], v[112:115], v[36:39]
    ds_read_b64_tr_b16 v[78:79], v131 offset:50176
    s_waitcnt lgkmcnt(12)
    v_mfma_f32_16x16x32_bf16 v[40:43], a[20:23], v[116:119], v[40:43]
    ds_read_b64_tr_b16 v[80:81], v132 offset:49152
    v_mfma_f32_16x16x32_bf16 v[44:47], a[84:87], v[116:119], v[44:47]
    ds_read_b64_tr_b16 v[82:83], v132 offset:50176
    s_waitcnt lgkmcnt(12)
    v_mfma_f32_16x16x32_bf16 v[48:51], a[20:23], v[120:123], v[48:51]
    ds_read_b64_tr_b16 v[84:85], v133 offset:49152
    v_mfma_f32_16x16x32_bf16 v[52:55], a[84:87], v[120:123], v[52:55]
    ds_read_b64_tr_b16 v[86:87], v133 offset:50176
    s_waitcnt lgkmcnt(12)
    v_mfma_f32_16x16x32_bf16 v[56:59], a[20:23], v[124:127], v[56:59]
    ds_read_b64_tr_b16 v[88:89], v134 offset:49152
    v_mfma_f32_16x16x32_bf16 v[60:63], a[84:87], v[124:127], v[60:63]
    ds_read_b64_tr_b16 v[90:91], v134 offset:50176
    s_waitcnt lgkmcnt(12)
    v_mfma_f32_16x16x32_bf16 v[0:3], a[24:27], v[64:67], v[0:3]
    ds_read_b64_tr_b16 v[92:93], v135 offset:49152
    v_mfma_f32_16x16x32_bf16 v[4:7], a[88:91], v[64:67], v[4:7]
    ds_read_b64_tr_b16 v[94:95], v135 offset:50176
    s_waitcnt lgkmcnt(12)
    v_mfma_f32_16x16x32_bf16 v[8:11], a[24:27], v[68:71], v[8:11]
    ds_read_b64_tr_b16 v[96:97], v128 offset:57344
    v_mfma_f32_16x16x32_bf16 v[12:15], a[88:91], v[68:71], v[12:15]
    ds_read_b64_tr_b16 v[98:99], v128 offset:58368
    s_waitcnt lgkmcnt(12)
    v_mfma_f32_16x16x32_bf16 v[16:19], a[24:27], v[72:75], v[16:19]
    ds_read_b64_tr_b16 v[100:101], v129 offset:57344
    v_mfma_f32_16x16x32_bf16 v[20:23], a[88:91], v[72:75], v[20:23]
    ds_read_b64_tr_b16 v[102:103], v129 offset:58368
    s_waitcnt lgkmcnt(12)
    v_mfma_f32_16x16x32_bf16 v[24:27], a[24:27], v[76:79], v[24:27]
    ds_read_b64_tr_b16 v[104:105], v130 offset:57344
    v_mfma_f32_16x16x32_bf16 v[28:31], a[88:91], v[76:79], v[28:31]
    ds_read_b64_tr_b16 v[106:107], v130 offset:58368
    s_waitcnt lgkmcnt(12)
    v_mfma_f32_16x16x32_bf16 v[32:35], a[24:27], v[80:83], v[32:35]
    ds_read_b64_tr_b16 v[108:109], v131 offset:57344
    v_mfma_f32_16x16x32_bf16 v[36:39], a[88:91], v[80:83], v[36:39]
    ds_read_b64_tr_b16 v[110:111], v131 offset:58368
    s_waitcnt lgkmcnt(12)
    v_mfma_f32_16x16x32_bf16 v[40:43], a[24:27], v[84:87], v[40:43]
    ds_read_b64_tr_b16 v[112:113], v132 offset:57344
    v_mfma_f32_16x16x32_bf16 v[44:47], a[88:91], v[84:87], v[44:47]
    ds_read_b64_tr_b16 v[114:115], v132 offset:58368
    s_waitcnt lgkmcnt(12)
    v_mfma_f32_16x16x32_bf16 v[48:51], a[24:27], v[88:91], v[48:51]
    ds_read_b64_tr_b16 v[116:117], v133 offset:57344
    v_mfma_f32_16x16x32_bf16 v[52:55], a[88:91], v[88:91], v[52:55]
    ds_read_b64_tr_b16 v[118:119], v133 offset:58368
    s_waitcnt lgkmcnt(12)
    v_mfma_f32_16x16x32_bf16 v[56:59], a[24:27], v[92:95], v[56:59]
    ds_read_b64_tr_b16 v[120:121], v134 offset:57344
    v_mfma_f32_16x16x32_bf16 v[60:63], a[88:91], v[92:95], v[60:63]
    ds_read_b64_tr_b16 v[122:123], v134 offset:58368
    s_waitcnt lgkmcnt(12)
    v_mfma_f32_16x16x32_bf16 v[0:3], a[28:31], v[96:99], v[0:3]
    ds_read_b64_tr_b16 v[124:125], v135 offset:57344
    v_mfma_f32_16x16x32_bf16 v[4:7], a[92:95], v[96:99], v[4:7]
    ds_read_b64_tr_b16 v[126:127], v135 offset:58368
    s_waitcnt lgkmcnt(12)
    v_mfma_f32_16x16x32_bf16 v[8:11], a[28:31], v[100:103], v[8:11]
    v_mfma_f32_16x16x32_bf16 v[12:15], a[92:95], v[100:103], v[12:15]
    s_waitcnt lgkmcnt(10)
    v_mfma_f32_16x16x32_bf16 v[16:19], a[28:31], v[104:107], v[16:19]
    v_mfma_f32_16x16x32_bf16 v[20:23], a[92:95], v[104:107], v[20:23]
    s_waitcnt lgkmcnt(8)
    v_mfma_f32_16x16x32_bf16 v[24:27], a[28:31], v[108:111], v[24:27]
    v_mfma_f32_16x16x32_bf16 v[28:31], a[92:95], v[108:111], v[28:31]
    s_waitcnt lgkmcnt(6)
    v_mfma_f32_16x16x32_bf16 v[32:35], a[28:31], v[112:115], v[32:35]
    v_mfma_f32_16x16x32_bf16 v[36:39], a[92:95], v[112:115], v[36:39]
    s_waitcnt lgkmcnt(4)
    v_mfma_f32_16x16x32_bf16 v[40:43], a[28:31], v[116:119], v[40:43]
    v_mfma_f32_16x16x32_bf16 v[44:47], a[92:95], v[116:119], v[44:47]
    s_waitcnt lgkmcnt(2)
    v_mfma_f32_16x16x32_bf16 v[48:51], a[28:31], v[120:123], v[48:51]
    v_mfma_f32_16x16x32_bf16 v[52:55], a[92:95], v[120:123], v[52:55]
    s_waitcnt lgkmcnt(0)
    v_mfma_f32_16x16x32_bf16 v[56:59], a[28:31], v[124:127], v[56:59]
    v_mfma_f32_16x16x32_bf16 v[60:63], a[92:95], v[124:127], v[60:63]
    v_xor_b32 v128, 0x10000, v128
    v_xor_b32 v129, 0x10000, v129
    v_xor_b32 v130, 0x10000, v130
    v_xor_b32 v131, 0x10000, v131
    v_xor_b32 v132, 0x10000, v132
    v_xor_b32 v133, 0x10000, v133
    v_xor_b32 v134, 0x10000, v134
    v_xor_b32 v135, 0x10000, v135
    s_waitcnt vmcnt(16)
    s_barrier
    ds_read_b64_tr_b16 v[64:65], v128
    ds_read_b64_tr_b16 v[66:67], v128 offset:1024
    ds_read_b64_tr_b16 v[68:69], v129
    ds_read_b64_tr_b16 v[70:71], v129 offset:1024
    ds_read_b64_tr_b16 v[72:73], v130
    ds_read_b64_tr_b16 v[74:75], v130 offset:1024
    ds_read_b64_tr_b16 v[76:77], v131
    ds_read_b64_tr_b16 v[78:79], v131 offset:1024
    ds_read_b64_tr_b16 v[80:81], v132
    ds_read_b64_tr_b16 v[82:83], v132 offset:1024
    ds_read_b64_tr_b16 v[84:85], v133
    ds_read_b64_tr_b16 v[86:87], v133 offset:1024
    ds_read_b64_tr_b16 v[88:89], v134
    ds_read_b64_tr_b16 v[90:91], v134 offset:1024
    s_cmp_eq_u32 s40, 0
    s_cbranch_scc1 L_nopf_92
    s_cmp_lg_u32 s87, 0
    s_cbranch_scc1 L_modeok_93
    s_mov_b32 s96, 0
L_mode_94:
    buffer_load_dwordx2 v[140:141], off, s[92:95], 0 offset:36 sc1
    s_waitcnt vmcnt(0)
    v_readfirstlane_b32 s87, v140
    v_readfirstlane_b32 s97, v141
    s_nop 0
    s_min_u32 s97, s97, s87
    s_cmp_lg_u32 s97, 0
    s_cbranch_scc1 L_moded_95
    s_sleep 4
    s_add_u32 s96, s96, 1
    s_cmp_lg_u32 s96, 0x100
    s_cbranch_scc1 L_modef_96
    v_mov_b32 v140, 2
    v_mov_b32 v141, 0
    s_mov_b64 exec, 1
    buffer_atomic_cmpswap v[140:141], off, s[92:95], 0 offset:36
    s_mov_b64 exec, -1
L_modef_96:
    s_cmp_lt_u32 s96, 0x10000
    s_cbranch_scc1 L_mode_94
L_moded_95:
    s_cmp_lg_u32 s87, 1
    s_cbranch_scc1 L_fallback
L_modeok_93:
    s_cmp_lg_u32 s100, 0
    s_cbranch_scc1 L_flag_97
    v_mov_b32 v138, 1
    s_mov_b64 exec, 1
    buffer_store_dword v138, off, s[8:11], s40 sc1
    s_mov_b64 exec, -1
L_flag_97:
    s_mov_b32 s40, 0
L_nopf_92:
    s_waitcnt lgkmcnt(12)
    v_mfma_f32_16x16x32_bf16 v[0:3], a[32:35], v[64:67], v[0:3]
    ds_read_b64_tr_b16 v[92:93], v135
    v_mfma_f32_16x16x32_bf16 v[4:7], a[96:99], v[64:67], v[4:7]
    ds_read_b64_tr_b16 v[94:95], v135 offset:1024
    s_add_u32 s26, s24, 0x100000
    s_add_u32 m0, s29, 0x8000
    s_nop 0
    buffer_load_dwordx4 v136, s[16:19], s26 offen lds
    s_waitcnt lgkmcnt(12)
    v_mfma_f32_16x16x32_bf16 v[8:11], a[32:35], v[68:71], v[8:11]
    ds_read_b64_tr_b16 v[96:97], v128 offset:8192
    v_mfma_f32_16x16x32_bf16 v[12:15], a[96:99], v[68:71], v[12:15]
    ds_read_b64_tr_b16 v[98:99], v128 offset:9216
    s_add_u32 s26, s24, 0x120000
    s_add_u32 m0, s29, 0x9000
    s_nop 0
    buffer_load_dwordx4 v136, s[16:19], s26 offen lds
    s_waitcnt lgkmcnt(12)
    v_mfma_f32_16x16x32_bf16 v[16:19], a[32:35], v[72:75], v[16:19]
    ds_read_b64_tr_b16 v[100:101], v129 offset:8192
    v_mfma_f32_16x16x32_bf16 v[20:23], a[96:99], v[72:75], v[20:23]
    ds_read_b64_tr_b16 v[102:103], v129 offset:9216
    s_add_u32 s26, s24, 0x140000
    s_add_u32 m0, s29, 0xa000
    s_nop 0
    buffer_load_dwordx4 v136, s[16:19], s26 offen lds
    s_waitcnt lgkmcnt(12)
    v_mfma_f32_16x16x32_bf16 v[24:27], a[32:35], v[76:79], v[24:27]
    ds_read_b64_tr_b16 v[104:105], v130 offset:8192
    v_mfma_f32_16x16x32_bf16 v[28:31], a[96:99], v[76:79], v[28:31]
    ds_read_b64_tr_b16 v[106:107], v130 offset:9216
    s_add_u32 s26, s24, 0x160000
    s_add_u32 m0, s29, 0xb000
    s_nop 0
    buffer_load_dwordx4 v136, s[16:19], s26 offen lds
    s_waitcnt lgkmcnt(12)
    v_mfma_f32_16x16x32_bf16 v[32:35], a[32:35], v[80:83], v[32:35]
    ds_read_b64_tr_b16 v[108:109], v131 offset:8192
    v_mfma_f32_16x16x32_bf16 v[36:39], a[96:99], v[80:83], v[36:39]
    ds_read_b64_tr_b16 v[110:111], v131 offset:9216
    s_add_u32 s26, s24, 0x180000
    s_add_u32 m0, s29, 0xc000
    s_nop 0
    buffer_load_dwordx4 v136, s[16:19], s26 offen lds
    s_waitcnt lgkmcnt(12)
    v_mfma_f32_16x16x32_bf16 v[40:43], a[32:35], v[84:87], v[40:43]
    ds_read_b64_tr_b16 v[112:113], v132 offset:8192
    v_mfma_f32_16x16x32_bf16 v[44:47], a[96:99], v[84:87], v[44:47]
    ds_read_b64_tr_b16 v[114:115], v132 offset:9216
    s_add_u32 s26, s24, 0x1a0000
    s_add_u32 m0, s29, 0xd000
    s_nop 0
    buffer_load_dwordx4 v136, s[16:19], s26 offen lds
    s_waitcnt lgkmcnt(12)
    v_mfma_f32_16x16x32_bf16 v[48:51], a[32:35], v[88:91], v[48:51]
    ds_read_b64_tr_b16 v[116:117], v133 offset:8192
    v_mfma_f32_16x16x32_bf16 v[52:55], a[96:99], v[88:91], v[52:55]
    ds_read_b64_tr_b16 v[118:119], v133 offset:9216
    s_add_u32 s26, s24, 0x1c0000
    s_add_u32 m0, s29, 0xe000
    s_nop 0
    buffer_load_dwordx4 v136, s[16:19], s26 offen lds
    s_waitcnt lgkmcnt(12)
    v_mfma_f32_16x16x32_bf16 v[56:59], a[32:35], v[92:95], v[56:59]
    ds_read_b64_tr_b16 v[120:121], v134 offset:8192
    v_mfma_f32_16x16x32_bf16 v[60:63], a[96:99], v[92:95], v[60:63]
    ds_read_b64_tr_b16 v[122:123], v134 offset:9216
    s_add_u32 s26, s24, 0x1e0000
    s_add_u32 m0, s29, 0xf000
    s_nop 0
    buffer_load_dwordx4 v136, s[16:19], s26 offen lds
    s_waitcnt lgkmcnt(12)
    v_mfma_f32_16x16x32_bf16 v[0:3], a[36:39], v[96:99], v[0:3]
    ds_read_b64_tr_b16 v[124:125], v135 offset:8192
    v_mfma_f32_16x16x32_bf16 v[4:7], a[100:103], v[96:99], v[4:7]
    ds_read_b64_tr_b16 v[126:127], v135 offset:9216
    s_waitcnt lgkmcnt(12)
    v_mfma_f32_16x16x32_bf16 v[8:11], a[36:39], v[100:103], v[8:11]
    ds_read_b64_tr_b16 v[64:65], v128 offset:16384
    v_mfma_f32_16x16x32_bf16 v[12:15], a[100:103], v[100:103], v[12:15]
    ds_read_b64_tr_b16 v[66:67], v128 offset:17408
    s_waitcnt lgkmcnt(12)
    v_mfma_f32_16x16x32_bf16 v[16:19], a[36:39], v[104:107], v[16:19]
    ds_read_b64_tr_b16 v[68:69], v129 offset:16384
    v_mfma_f32_16x16x32_bf16 v[20:23], a[100:103], v[104:107], v[20:23]
    ds_read_b64_tr_b16 v[70:71], v129 offset:17408
    s_waitcnt lgkmcnt(12)
    v_mfma_f32_16x16x32_bf16 v[24:27], a[36:39], v[108:111], v[24:27]
    ds_read_b64_tr_b16 v[72:73], v130 offset:16384
    v_mfma_f32_16x16x32_bf16 v[28:31], a[100:103], v[108:111], v[28:31]
    ds_read_b64_tr_b16 v[74:75], v130 offset:17408
    s_waitcnt lgkmcnt(12)
    v_mfma_f32_16x16x32_bf16 v[32:35], a[36:39], v[112:115], v[32:35]
    ds_read_b64_tr_b16 v[76:77], v131 offset:16384
    v_mfma_f32_16x16x32_bf16 v[36:39], a[100:103], v[112:115], v[36:39]
    ds_read_b64_tr_b16 v[78:79], v131 offset:17408
    s_waitcnt lgkmcnt(12)
    v_mfma_f32_16x16x32_bf16 v[40:43], a[36:39], v[116:119], v[40:43]
    ds_read_b64_tr_b16 v[80:81], v132 offset:16384
    v_mfma_f32_16x16x32_bf16 v[44:47], a[100:103], v[116:119], v[44:47]
    ds_read_b64_tr_b16 v[82:83], v132 offset:17408
    s_waitcnt lgkmcnt(12)
    v_mfma_f32_16x16x32_bf16 v[48:51], a[36:39], v[120:123], v[48:51]
    ds_read_b64_tr_b16 v[84:85], v133 offset:16384
    v_mfma_f32_16x16x32_bf16 v[52:55], a[100:103], v[120:123], v[52:55]
    ds_read_b64_tr_b16 v[86:87], v133 offset:17408
    s_waitcnt lgkmcnt(12)
    v_mfma_f32_16x16x32_bf16 v[56:59], a[36:39], v[124:127], v[56:59]
    ds_read_b64_tr_b16 v[88:89], v134 offset:16384
    v_mfma_f32_16x16x32_bf16 v[60:63], a[100:103], v[124:127], v[60:63]
    ds_read_b64_tr_b16 v[90:91], v134 offset:17408
    s_waitcnt lgkmcnt(12)
    v_mfma_f32_16x16x32_bf16 v[0:3], a[40:43], v[64:67], v[0:3]
    ds_read_b64_tr_b16 v[92:93], v135 offset:16384
    v_mfma_f32_16x16x32_bf16 v[4:7], a[104:107], v[64:67], v[4:7]
    ds_read_b64_tr_b16 v[94:95], v135 offset:17408
    s_waitcnt lgkmcnt(12)
    v_mfma_f32_16x16x32_bf16 v[8:11], a[40:43], v[68:71], v[8:11]
    ds_read_b64_tr_b16 v[96:97], v128 offset:24576
    v_mfma_f32_16x16x32_bf16 v[12:15], a[104:107], v[68:71], v[12:15]
    ds_read_b64_tr_b16 v[98:99], v128 offset:25600
    s_waitcnt lgkmcnt(12)
    v_mfma_f32_16x16x32_bf16 v[16:19], a[40:43], v[72:75], v[16:19]
    ds_read_b64_tr_b16 v[100:101], v129 offset:24576
    v_mfma_f32_16x16x32_bf16 v[20:23], a[104:107], v[72:75], v[20:23]
    ds_read_b64_tr_b16 v[102:103], v129 offset:25600
    s_waitcnt lgkmcnt(12)
    v_mfma_f32_16x16x32_bf16 v[24:27], a[40:43], v[76:79], v[24:27]
    ds_read_b64_tr_b16 v[104:105], v130 offset:24576
    v_mfma_f32_16x16x32_bf16 v[28:31], a[104:107], v[76:79], v[28:31]
    ds_read_b64_tr_b16 v[106:107], v130 offset:25600
    s_waitcnt lgkmcnt(12)
    v_mfma_f32_16x16x32_bf16 v[32:35], a[40:43], v[80:83], v[32:35]
    ds_read_b64_tr_b16 v[108:109], v131 offset:24576
    v_mfma_f32_16x16x32_bf16 v[36:39], a[104:107], v[80:83], v[36:39]
    ds_read_b64_tr_b16 v[110:111], v131 offset:25600
    s_waitcnt lgkmcnt(12)
    v_mfma_f32_16x16x32_bf16 v[40:43], a[40:43], v[84:87], v[40:43]
    ds_read_b64_tr_b16 v[112:113], v132 offset:24576
    v_mfma_f32_16x16x32_bf16 v[44:47], a[104:107], v[84:87], v[44:47]
    ds_read_b64_tr_b16 v[114:115], v132 offset:25600
    s_waitcnt lgkmcnt(12)
    v_mfma_f32_16x16x32_bf16 v[48:51], a[40:43], v[88:91], v[48:51]
    ds_read_b64_tr_b16 v[116:117], v133 offset:24576
    v_mfma_f32_16x16x32_bf16 v[52:55], a[104:107], v[88:91], v[52:55]
    ds_read_b64_tr_b16 v[118:119], v133 offset:25600
    s_waitcnt lgkmcnt(12)
    v_mfma_f32_16x16x32_bf16 v[56:59], a[40:43], v[92:95], v[56:59]
    ds_read_b64_tr_b16 v[120:121], v134 offset:24576
    v_mfma_f32_16x16x32_bf16 v[60:63], a[104:107], v[92:95], v[60:63]
    ds_read_b64_tr_b16 v[122:123], v134 offset:25600
    s_waitcnt lgkmcnt(12)
    v_mfma_f32_16x16x32_bf16 v[0:3], a[44:47], v[96:99], v[0:3]
    ds_read_b64_tr_b16 v[124:125], v135 offset:24576
    v_mfma_f32_16x16x32_bf16 v[4:7], a[108:111], v[96:99], v[4:7]
    ds_read_b64_tr_b16 v[126:127], v135 offset:25600
    s_waitcnt lgkmcnt(12)
    v_mfma_f32_16x16x32_bf16 v[8:11], a[44:47], v[100:103], v[8:11]
    v_mfma_f32_16x16x32_bf16 v[12:15], a[108:111], v[100:103], v[12:15]
    s_waitcnt lgkmcnt(10)
    v_mfma_f32_16x16x32_bf16 v[16:19], a[44:47], v[104:107], v[16:19]
    v_mfma_f32_16x16x32_bf16 v[20:23], a[108:111], v[104:107], v[20:23]
    s_waitcnt lgkmcnt(8)
    v_mfma_f32_16x16x32_bf16 v[24:27], a[44:47], v[108:111], v[24:27]
    v_mfma_f32_16x16x32_bf16 v[28:31], a[108:111], v[108:111], v[28:31]
    s_waitcnt lgkmcnt(6)
    v_mfma_f32_16x16x32_bf16 v[32:35], a[44:47], v[112:115], v[32:35]
    v_mfma_f32_16x16x32_bf16 v[36:39], a[108:111], v[112:115], v[36:39]
    s_waitcnt lgkmcnt(4)
    v_mfma_f32_16x16x32_bf16 v[40:43], a[44:47], v[116:119], v[40:43]
    v_mfma_f32_16x16x32_bf16 v[44:47], a[108:111], v[116:119], v[44:47]
    s_waitcnt lgkmcnt(2)
    v_mfma_f32_16x16x32_bf16 v[48:51], a[44:47], v[120:123], v[48:51]
    v_mfma_f32_16x16x32_bf16 v[52:55], a[108:111], v[120:123], v[52:55]
    s_waitcnt lgkmcnt(0)
    v_mfma_f32_16x16x32_bf16 v[56:59], a[44:47], v[124:127], v[56:59]
    v_mfma_f32_16x16x32_bf16 v[60:63], a[108:111], v[124:127], v[60:63]
    s_waitcnt vmcnt(16)
    s_barrier
    ds_read_b64_tr_b16 v[64:65], v128 offset:32768
    ds_read_b64_tr_b16 v[66:67], v128 offset:33792
    ds_read_b64_tr_b16 v[68:69], v129 offset:32768
    ds_read_b64_tr_b16 v[70:71], v129 offset:33792
    ds_read_b64_tr_b16 v[72:73], v130 offset:32768
    ds_read_b64_tr_b16 v[74:75], v130 offset:33792
    ds_read_b64_tr_b16 v[76:77], v131 offset:32768
    ds_read_b64_tr_b16 v[78:79], v131 offset:33792
    ds_read_b64_tr_b16 v[80:81], v132 offset:32768
    ds_read_b64_tr_b16 v[82:83], v132 offset:33792
    ds_read_b64_tr_b16 v[84:85], v133 offset:32768
    ds_read_b64_tr_b16 v[86:87], v133 offset:33792
    ds_read_b64_tr_b16 v[88:89], v134 offset:32768
    ds_read_b64_tr_b16 v[90:91], v134 offset:33792
    s_waitcnt lgkmcnt(12)
    v_mfma_f32_16x16x32_bf16 v[0:3], a[48:51], v[64:67], v[0:3]
    ds_read_b64_tr_b16 v[92:93], v135 offset:32768
    v_mfma_f32_16x16x32_bf16 v[4:7], a[112:115], v[64:67], v[4:7]
    ds_read_b64_tr_b16 v[94:95], v135 offset:33792
    s_add_u32 s26, s24, 0x200000
    s_add_u32 m0, s29, 0x10000
    s_nop 0
    buffer_load_dwordx4 v136, s[16:19], s26 offen lds
    s_waitcnt lgkmcnt(12)
    v_mfma_f32_16x16x32_bf16 v[8:11], a[48:51], v[68:71], v[8:11]
    ds_read_b64_tr_b16 v[96:97], v128 offset:40960
    v_mfma_f32_16x16x32_bf16 v[12:15], a[112:115], v[68:71], v[12:15]
    ds_read_b64_tr_b16 v[98:99], v128 offset:41984
    s_add_u32 s26, s24, 0x220000
    s_add_u32 m0, s29, 0x11000
    s_nop 0
    buffer_load_dwordx4 v136, s[16:19], s26 offen lds
    s_waitcnt lgkmcnt(12)
    v_mfma_f32_16x16x32_bf16 v[16:19], a[48:51], v[72:75], v[16:19]
    ds_read_b64_tr_b16 v[100:101], v129 offset:40960
    v_mfma_f32_16x16x32_bf16 v[20:23], a[112:115], v[72:75], v[20:23]
    ds_read_b64_tr_b16 v[102:103], v129 offset:41984
    s_add_u32 s26, s24, 0x240000
    s_add_u32 m0, s29, 0x12000
    s_nop 0
    buffer_load_dwordx4 v136, s[16:19], s26 offen lds
    s_waitcnt lgkmcnt(12)
    v_mfma_f32_16x16x32_bf16 v[24:27], a[48:51], v[76:79], v[24:27]
    ds_read_b64_tr_b16 v[104:105], v130 offset:40960
    v_mfma_f32_16x16x32_bf16 v[28:31], a[112:115], v[76:79], v[28:31]
    ds_read_b64_tr_b16 v[106:107], v130 offset:41984
    s_add_u32 s26, s24, 0x260000
    s_add_u32 m0, s29, 0x13000
    s_nop 0
    buffer_load_dwordx4 v136, s[16:19], s26 offen lds
    s_waitcnt lgkmcnt(12)
    v_mfma_f32_16x16x32_bf16 v[32:35], a[48:51], v[80:83], v[32:35]
    ds_read_b64_tr_b16 v[108:109], v131 offset:40960
    v_mfma_f32_16x16x32_bf16 v[36:39], a[112:115], v[80:83], v[36:39]
    ds_read_b64_tr_b16 v[110:111], v131 offset:41984
    s_add_u32 s26, s24, 0x280000
    s_add_u32 m0, s29, 0x14000
    s_nop 0
    buffer_load_dwordx4 v136, s[16:19], s26 offen lds
    s_waitcnt lgkmcnt(12)
    v_mfma_f32_16x16x32_bf16 v[40:43], a[48:51], v[84:87], v[40:43]
    ds_read_b64_tr_b16 v[112:113], v132 offset:40960
    v_mfma_f32_16x16x32_bf16 v[44:47], a[112:115], v[84:87], v[44:47]
    ds_read_b64_tr_b16 v[114:115], v132 offset:41984
    s_add_u32 s26, s24, 0x2a0000
    s_add_u32 m0, s29, 0x15000
    s_nop 0
    buffer_load_dwordx4 v136, s[16:19], s26 offen lds
    s_waitcnt lgkmcnt(12)
    v_mfma_f32_16x16x32_bf16 v[48:51], a[48:51], v[88:91], v[48:51]
    ds_read_b64_tr_b16 v[116:117], v133 offset:40960
    v_mfma_f32_16x16x32_bf16 v[52:55], a[112:115], v[88:91], v[52:55]
    ds_read_b64_tr_b16 v[118:119], v133 offset:41984
    s_add_u32 s26, s24, 0x2c0000
    s_add_u32 m0, s29, 0x16000
    s_nop 0
    buffer_load_dwordx4 v136, s[16:19], s26 offen lds
    s_waitcnt lgkmcnt(12)
    v_mfma_f32_16x16x32_bf16 v[56:59], a[48:51], v[92:95], v[56:59]
    ds_read_b64_tr_b16 v[120:121], v134 offset:40960
    v_mfma_f32_16x16x32_bf16 v[60:63], a[112:115], v[92:95], v[60:63]
    ds_read_b64_tr_b16 v[122:123], v134 offset:41984
    s_add_u32 s26, s24, 0x2e0000
    s_add_u32 m0, s29, 0x17000
    s_nop 0
    buffer_load_dwordx4 v136, s[16:19], s26 offen lds
    s_waitcnt lgkmcnt(12)
    v_mfma_f32_16x16x32_bf16 v[0:3], a[52:55], v[96:99], v[0:3]
    ds_read_b64_tr_b16 v[124:125], v135 offset:40960
    v_mfma_f32_16x16x32_bf16 v[4:7], a[116:119], v[96:99], v[4:7]
    ds_read_b64_tr_b16 v[126:127], v135 offset:41984
    s_waitcnt lgkmcnt(12)
    v_mfma_f32_16x16x32_bf16 v[8:11], a[52:55], v[100:103], v[8:11]
    ds_read_b64_tr_b16 v[64:65], v128 offset:49152
    v_mfma_f32_16x16x32_bf16 v[12:15], a[116:119], v[100:103], v[12:15]
    ds_read_b64_tr_b16 v[66:67], v128 offset:50176
    s_waitcnt lgkmcnt(12)
    v_mfma_f32_16x16x32_bf16 v[16:19], a[52:55], v[104:107], v[16:19]
    ds_read_b64_tr_b16 v[68:69], v129 offset:49152
    v_mfma_f32_16x16x32_bf16 v[20:23], a[116:119], v[104:107], v[20:23]
    ds_read_b64_tr_b16 v[70:71], v129 offset:50176
    s_waitcnt lgkmcnt(12)
    v_mfma_f32_16x16x32_bf16 v[24:27], a[52:55], v[108:111], v[24:27]
    ds_read_b64_tr_b16 v[72:73], v130 offset:49152
    v_mfma_f32_16x16x32_bf16 v[28:31], a[116:119], v[108:111], v[28:31]
    ds_read_b64_tr_b16 v[74:75], v130 offset:50176
    s_waitcnt lgkmcnt(12)
    v_mfma_f32_16x16x32_bf16 v[32:35], a[52:55], v[112:115], v[32:35]
    ds_read_b64_tr_b16 v[76:77], v131 offset:49152
    v_mfma_f32_16x16x32_bf16 v[36:39], a[116:119], v[112:115], v[36:39]
    ds_read_b64_tr_b16 v[78:79], v131 offset:50176
    s_waitcnt lgkmcnt(12)
    v_mfma_f32_16x16x32_bf16 v[40:43], a[52:55], v[116:119], v[40:43]
    ds_read_b64_tr_b16 v[80:81], v132 offset:49152
    v_mfma_f32_16x16x32_bf16 v[44:47], a[116:119], v[116:119], v[44:47]
    ds_read_b64_tr_b16 v[82:83], v132 offset:50176
    s_waitcnt lgkmcnt(12)
    v_mfma_f32_16x16x32_bf16 v[48:51], a[52:55], v[120:123], v[48:51]
    ds_read_b64_tr_b16 v[84:85], v133 offset:49152
    v_mfma_f32_16x16x32_bf16 v[52:55], a[116:119], v[120:123], v[52:55]
    ds_read_b64_tr_b16 v[86:87], v133 offset:50176
    s_waitcnt lgkmcnt(12)
    v_mfma_f32_16x16x32_bf16 v[56:59], a[52:55], v[124:127], v[56:59]
    ds_read_b64_tr_b16 v[88:89], v134 offset:49152
    v_mfma_f32_16x16x32_bf16 v[60:63], a[116:119], v[124:127], v[60:63]
    ds_read_b64_tr_b16 v[90:91], v134 offset:50176
    s_waitcnt lgkmcnt(12)
    v_mfma_f32_16x16x32_bf16 v[0:3], a[56:59], v[64:67], v[0:3]
    ds_read_b64_tr_b16 v[92:93], v135 offset:49152
    v_mfma_f32_16x16x32_bf16 v[4:7], a[120:123], v[64:67], v[4:7]
    ds_read_b64_tr_b16 v[94:95], v135 offset:50176
    s_waitcnt lgkmcnt(12)
    v_mfma_f32_16x16x32_bf16 v[8:11], a[56:59], v[68:71], v[8:11]
    ds_read_b64_tr_b16 v[96:97], v128 offset:57344
    v_mfma_f32_16x16x32_bf16 v[12:15], a[120:123], v[68:71], v[12:15]
    ds_read_b64_tr_b16 v[98:99], v128 offset:58368
    s_waitcnt lgkmcnt(12)
    v_mfma_f32_16x16x32_bf16 v[16:19], a[56:59], v[72:75], v[16:19]
    ds_read_b64_tr_b16 v[100:101], v129 offset:57344
    v_mfma_f32_16x16x32_bf16 v[20:23], a[120:123], v[72:75], v[20:23]
    ds_read_b64_tr_b16 v[102:103], v129 offset:58368
    s_waitcnt lgkmcnt(12)
    v_mfma_f32_16x16x32_bf16 v[24:27], a[56:59], v[76:79], v[24:27]
    ds_read_b64_tr_b16 v[104:105], v130 offset:57344
    v_mfma_f32_16x16x32_bf16 v[28:31], a[120:123], v[76:79], v[28:31]
    ds_read_b64_tr_b16 v[106:107], v130 offset:58368
    s_waitcnt lgkmcnt(12)
    v_mfma_f32_16x16x32_bf16 v[32:35], a[56:59], v[80:83], v[32:35]
    ds_read_b64_tr_b16 v[108:109], v131 offset:57344
    v_mfma_f32_16x16x32_bf16 v[36:39], a[120:123], v[80:83], v[36:39]
    ds_read_b64_tr_b16 v[110:111], v131 offset:58368
    s_waitcnt lgkmcnt(12)
    v_mfma_f32_16x16x32_bf16 v[40:43], a[56:59], v[84:87], v[40:43]
    ds_read_b64_tr_b16 v[112:113], v132 offset:57344
    v_mfma_f32_16x16x32_bf16 v[44:47], a[120:123], v[84:87], v[44:47]
    ds_read_b64_tr_b16 v[114:115], v132 offset:58368
    s_waitcnt lgkmcnt(12)
    v_mfma_f32_16x16x32_bf16 v[48:51], a[56:59], v[88:91], v[48:51]
    ds_read_b64_tr_b16 v[116:117], v133 offset:57344
    v_mfma_f32_16x16x32_bf16 v[52:55], a[120:123], v[88:91], v[52:55]
    ds_read_b64_tr_b16 v[118:119], v133 offset:58368
    s_waitcnt lgkmcnt(12)
    v_mfma_f32_16x16x32_bf16 v[56:59], a[56:59], v[92:95], v[56:59]
    ds_read_b64_tr_b16 v[120:121], v134 offset:57344
    v_mfma_f32_16x16x32_bf16 v[60:63], a[120:123], v[92:95], v[60:63]
    ds_read_b64_tr_b16 v[122:123], v134 offset:58368
    s_waitcnt lgkmcnt(12)
    v_mfma_f32_16x16x32_bf16 v[0:3], a[60:63], v[96:99], v[0:3]
    ds_read_b64_tr_b16 v[124:125], v135 offset:57344
    v_mfma_f32_16x16x32_bf16 v[4:7], a[124:127], v[96:99], v[4:7]
    ds_read_b64_tr_b16 v[126:127], v135 offset:58368
    s_waitcnt lgkmcnt(12)
    v_mfma_f32_16x16x32_bf16 v[8:11], a[60:63], v[100:103], v[8:11]
    v_mfma_f32_16x16x32_bf16 v[12:15], a[124:127], v[100:103], v[12:15]
    s_waitcnt lgkmcnt(10)
    v_mfma_f32_16x16x32_bf16 v[16:19], a[60:63], v[104:107], v[16:19]
    v_mfma_f32_16x16x32_bf16 v[20:23], a[124:127], v[104:107], v[20:23]
    s_waitcnt lgkmcnt(8)
    v_mfma_f32_16x16x32_bf16 v[24:27], a[60:63], v[108:111], v[24:27]
    v_mfma_f32_16x16x32_bf16 v[28:31], a[124:127], v[108:111], v[28:31]
    s_waitcnt lgkmcnt(6)
    v_mfma_f32_16x16x32_bf16 v[32:35], a[60:63], v[112:115], v[32:35]
    v_mfma_f32_16x16x32_bf16 v[36:39], a[124:127], v[112:115], v[36:39]
    s_waitcnt lgkmcnt(4)
    v_mfma_f32_16x16x32_bf16 v[40:43], a[60:63], v[116:119], v[40:43]
    v_mfma_f32_16x16x32_bf16 v[44:47], a[124:127], v[116:119], v[44:47]
    s_waitcnt lgkmcnt(2)
    v_mfma_f32_16x16x32_bf16 v[48:51], a[60:63], v[120:123], v[48:51]
    v_mfma_f32_16x16x32_bf16 v[52:55], a[124:127], v[120:123], v[52:55]
    s_waitcnt lgkmcnt(0)
    v_mfma_f32_16x16x32_bf16 v[56:59], a[60:63], v[124:127], v[56:59]
    v_mfma_f32_16x16x32_bf16 v[60:63], a[124:127], v[124:127], v[60:63]
    v_xor_b32 v128, 0x10000, v128
    v_xor_b32 v129, 0x10000, v129
    v_xor_b32 v130, 0x10000, v130
    v_xor_b32 v131, 0x10000, v131
    v_xor_b32 v132, 0x10000, v132
    v_xor_b32 v133, 0x10000, v133
    v_xor_b32 v134, 0x10000, v134
    v_xor_b32 v135, 0x10000, v135
    v_cvt_pk_bf16_f32 v144, v0, v1
    v_cvt_pk_bf16_f32 v145, v2, v3
    v_cvt_pk_bf16_f32 v146, v4, v5
    v_cvt_pk_bf16_f32 v147, v6, v7
    buffer_store_dwordx4 v[144:147], v137, s[8:11], s25 offen sc1
    v_cvt_pk_bf16_f32 v148, v8, v9
    v_cvt_pk_bf16_f32 v149, v10, v11
    v_cvt_pk_bf16_f32 v150, v12, v13
    v_cvt_pk_bf16_f32 v151, v14, v15
    buffer_store_dwordx4 v[148:151], v137, s[8:11], s25 offen offset:1024 sc1
    v_cvt_pk_bf16_f32 v152, v16, v17
    v_cvt_pk_bf16_f32 v153, v18, v19
    v_cvt_pk_bf16_f32 v154, v20, v21
    v_cvt_pk_bf16_f32 v155, v22, v23
    buffer_store_dwordx4 v[152:155], v137, s[8:11], s25 offen offset:2048 sc1
    v_cvt_pk_bf16_f32 v156, v24, v25
    v_cvt_pk_bf16_f32 v157, v26, v27
    v_cvt_pk_bf16_f32 v158, v28, v29
    v_cvt_pk_bf16_f32 v159, v30, v31
    buffer_store_dwordx4 v[156:159], v137, s[8:11], s25 offen offset:3072 sc1
    v_cvt_pk_bf16_f32 v144, v32, v33
    v_cvt_pk_bf16_f32 v145, v34, v35
    v_cvt_pk_bf16_f32 v146, v36, v37
    v_cvt_pk_bf16_f32 v147, v38, v39
    s_add_u32 s25, s25, 4096
    buffer_store_dwordx4 v[144:147], v137, s[8:11], s25 offen sc1
    v_cvt_pk_bf16_f32 v148, v40, v41
    v_cvt_pk_bf16_f32 v149, v42, v43
    v_cvt_pk_bf16_f32 v150, v44, v45
    v_cvt_pk_bf16_f32 v151, v46, v47
    buffer_store_dwordx4 v[148:151], v137, s[8:11], s25 offen offset:1024 sc1
    v_cvt_pk_bf16_f32 v152, v48, v49
    v_cvt_pk_bf16_f32 v153, v50, v51
    v_cvt_pk_bf16_f32 v154, v52, v53
    v_cvt_pk_bf16_f32 v155, v54, v55
    buffer_store_dwordx4 v[152:155], v137, s[8:11], s25 offen offset:2048 sc1
    v_cvt_pk_bf16_f32 v156, v56, v57
    v_cvt_pk_bf16_f32 v157, v58, v59
    v_cvt_pk_bf16_f32 v158, v60, v61
    v_cvt_pk_bf16_f32 v159, v62, v63
    buffer_store_dwordx4 v[156:159], v137, s[8:11], s25 offen offset:3072 sc1
L_p1_next:
    s_add_u32 s80, s80, 1
    s_lshl_b32 s40, s38, 4
    s_add_u32 s40, s40, s20
    s_lshl_b32 s40, s40, 2
    s_add_u32 s40, s40, 0x2000
    s_add_u32 s38, s38, s37
    s_branch L_p1_unit
L_p1_end:
    s_waitcnt vmcnt(0)
    s_barrier
    s_cmp_eq_u32 s40, 0
    s_cbranch_scc1 L_nopf_98
    s_cmp_lg_u32 s87, 0
    s_cbranch_scc1 L_modeok_99
    s_mov_b32 s96, 0
L_mode_100:
    buffer_load_dwordx2 v[140:141], off, s[92:95], 0 offset:36 sc1
    s_waitcnt vmcnt(0)
    v_readfirstlane_b32 s87, v140
    v_readfirstlane_b32 s97, v141
    s_nop 0
    s_min_u32 s97, s97, s87
    s_cmp_lg_u32 s97, 0
    s_cbranch_scc1 L_moded_101
    s_sleep 4
    s_add_u32 s96, s96, 1
    s_cmp_lg_u32 s96, 0x100
    s_cbranch_scc1 L_modef_102
    v_mov_b32 v140, 2
    v_mov_b32 v141, 0
    s_mov_b64 exec, 1
    buffer_atomic_cmpswap v[140:141], off, s[92:95], 0 offset:36
    s_mov_b64 exec, -1
L_modef_102:
    s_cmp_lt_u32 s96, 0x10000
    s_cbranch_scc1 L_mode_100
L_moded_101:
    s_cmp_lg_u32 s87, 1
    s_cbranch_scc1 L_fallback
L_modeok_99:
    s_cmp_lg_u32 s100, 0
    s_cbranch_scc1 L_flag_103
    v_mov_b32 v138, 1
    s_mov_b64 exec, 1
    buffer_store_dword v138, off, s[8:11], s40 sc1
    s_mov_b64 exec, -1
L_flag_103:
    s_mov_b32 s40, 0
L_nopf_98:
    s_cmp_lg_u32 s41, 0
    s_cbranch_scc1 L_p1done
    s_mov_b32 s41, 1
    s_and_b32 s20, s101, 15
    s_lshr_b32 s22, s101, 4
    s_mov_b32 s37, 14
    s_add_u32 s26, s22, 70
    s_add_u32 s27, s22, 56
    s_cmp_ge_u32 s27, 64
    s_cselect_b32 s26, s27, s26
    s_add_u32 s27, s22, 42
    s_add_u32 s28, s22, 28
    s_cmp_ge_u32 s28, 32
    s_cselect_b32 s27, s28, s27
    s_cmp_eq_u32 s20, 3
    s_cselect_b32 s22, s27, s22
    s_cmp_lt_u32 s20, 3
    s_cselect_b32 s22, s26, s22
    s_branch L_p1_pass
L_p1done:
    v_mbcnt_lo_u32_b32 v0, -1, 0
    v_mbcnt_hi_u32_b32 v0, -1, v0
    s_lshl_b32 s96, s100, 6
    v_add_u32 v0, s96, v0
    s_and_b32 s20, s101, 15
    s_lshr_b32 s22, s101, 4
    s_mov_b32 s23, 14
    s_load_dwordx2 s[12:13], s[0:1], 40
    s_waitcnt lgkmcnt(0)
    s_and_b32 s13, s13, 0xffff
    s_mov_b32 s14, 0x400000
    s_mov_b32 s15, 0x20000
    v_lshrrev_b32 v4, 6, v0
    s_nop 0
    v_readfirstlane_b32 s21, v4
    v_and_b32 v1, 63, v0
    v_lshrrev_b32 v2, 4, v1
    v_and_b32 v3, 15, v1
    v_lshrrev_b32 v6, 2, v3
    v_lshlrev_b32 v240, 4, v1
    v_lshlrev_b32 v241, 3, v1
    s_lshl_b32 s27, s21, 10
    s_lshl_b32 s24, s21, 5
    v_xor_b32 v4, s24, v240
    v_add_u32 v8, s27, v4
    v_xor_b32 v9, 128, v8
    v_lshl_add_u32 v4, v2, 2, v6
    v_and_b32 v5, 7, v4
    v_lshlrev_b32 v4, 10, v4
    v_lshl_add_u32 v4, v5, 5, v4
    v_and_b32 v5, 3, v3
    v_lshl_add_u32 v4, v5, 3, v4
    s_lshl_b32 s24, s21, 8
    v_add_u32 v10, s24, v4
    s_lshl_b32 s25, s20, 18
    s_add_u32 s24, s25, 0x0
    s_add_u32 m0, s27, 0x0
    s_nop 0
    buffer_load_dwordx4 v8, s[12:15], s24 offen lds
    s_add_u32 s24, s25, 0x1000
    s_add_u32 m0, s27, 0x1000
    s_nop 0
    buffer_load_dwordx4 v9, s[12:15], s24 offen lds
    s_add_u32 s24, s25, 0x2000
    s_add_u32 m0, s27, 0x2000
    s_nop 0
    buffer_load_dwordx4 v8, s[12:15], s24 offen lds
    s_add_u32 s24, s25, 0x3000
    s_add_u32 m0, s27, 0x3000
    s_nop 0
    buffer_load_dwordx4 v9, s[12:15], s24 offen lds
    s_add_u32 s24, s25, 0x4000
    s_add_u32 m0, s27, 0x4000
    s_nop 0
    buffer_load_dwordx4 v8, s[12:15], s24 offen lds
    s_add_u32 s24, s25, 0x5000
    s_add_u32 m0, s27, 0x5000
    s_nop 0
    buffer_load_dwordx4 v9, s[12:15], s24 offen lds
    s_add_u32 s24, s25, 0x6000
    s_add_u32 m0, s27, 0x6000
    s_nop 0
    buffer_load_dwordx4 v8, s[12:15], s24 offen lds
    s_add_u32 s24, s25, 0x7000
    s_add_u32 m0, s27, 0x7000
    s_nop 0
    buffer_load_dwordx4 v9, s[12:15], s24 offen lds
    s_add_u32 s24, s25, 0x8000
    s_add_u32 m0, s27, 0x8000
    s_nop 0
    buffer_load_dwordx4 v8, s[12:15], s24 offen lds
    s_add_u32 s24, s25, 0x9000
    s_add_u32 m0, s27, 0x9000
    s_nop 0
    buffer_load_dwordx4 v9, s[12:15], s24 offen lds
    s_add_u32 s24, s25, 0xa000
    s_add_u32 m0, s27, 0xa000
    s_nop 0
    buffer_load_dwordx4 v8, s[12:15], s24 offen lds
    s_add_u32 s24, s25, 0xb000
    s_add_u32 m0, s27, 0xb000
    s_nop 0
    buffer_load_dwordx4 v9, s[12:15], s24 offen lds
    s_add_u32 s24, s25, 0xc000
    s_add_u32 m0, s27, 0xc000
    s_nop 0
    buffer_load_dwordx4 v8, s[12:15], s24 offen lds
    s_add_u32 s24, s25, 0xd000
    s_add_u32 m0, s27, 0xd000
    s_nop 0
    buffer_load_dwordx4 v9, s[12:15], s24 offen lds
    s_add_u32 s24, s25, 0xe000
    s_add_u32 m0, s27, 0xe000
    s_nop 0
    buffer_load_dwordx4 v8, s[12:15], s24 offen lds
    s_add_u32 s24, s25, 0xf000
    s_add_u32 m0, s27, 0xf000
    s_nop 0
    buffer_load_dwordx4 v9, s[12:15], s24 offen lds
    s_add_u32 s24, s25, 0x10000
    s_add_u32 m0, s27, 0x10000
    s_nop 0
    buffer_load_dwordx4 v8, s[12:15], s24 offen lds
    s_add_u32 s24, s25, 0x11000
    s_add_u32 m0, s27, 0x11000
    s_nop 0
    buffer_load_dwordx4 v9, s[12:15], s24 offen lds
    s_add_u32 s24, s25, 0x12000
    s_add_u32 m0, s27, 0x12000
    s_nop 0
    buffer_load_dwordx4 v8, s[12:15], s24 offen lds
    s_add_u32 s24, s25, 0x13000
    s_add_u32 m0, s27, 0x13000
    s_nop 0
    buffer_load_dwordx4 v9, s[12:15], s24 offen lds
    s_add_u32 s24, s25, 0x14000
    s_add_u32 m0, s27, 0x14000
    s_nop 0
    buffer_load_dwordx4 v8, s[12:15], s24 offen lds
    s_add_u32 s24, s25, 0x15000
    s_add_u32 m0, s27, 0x15000
    s_nop 0
    buffer_load_dwordx4 v9, s[12:15], s24 offen lds
    s_add_u32 s24, s25, 0x16000
    s_add_u32 m0, s27, 0x16000
    s_nop 0
    buffer_load_dwordx4 v8, s[12:15], s24 offen lds
    s_add_u32 s24, s25, 0x17000
    s_add_u32 m0, s27, 0x17000
    s_nop 0
    buffer_load_dwordx4 v9, s[12:15], s24 offen lds
    s_add_u32 s24, s25, 0x18000
    s_add_u32 m0, s27, 0x18000
    s_nop 0
    buffer_load_dwordx4 v8, s[12:15], s24 offen lds
    s_add_u32 s24, s25, 0x19000
    s_add_u32 m0, s27, 0x19000
    s_nop 0
    buffer_load_dwordx4 v9, s[12:15], s24 offen lds
    s_add_u32 s24, s25, 0x1a000
    s_add_u32 m0, s27, 0x1a000
    s_nop 0
    buffer_load_dwordx4 v8, s[12:15], s24 offen lds
    s_add_u32 s24, s25, 0x1b000
    s_add_u32 m0, s27, 0x1b000
    s_nop 0
    buffer_load_dwordx4 v9, s[12:15], s24 offen lds
    s_add_u32 s24, s25, 0x1c000
    s_add_u32 m0, s27, 0x1c000
    s_nop 0
    buffer_load_dwordx4 v8, s[12:15], s24 offen lds
    s_add_u32 s24, s25, 0x1d000
    s_add_u32 m0, s27, 0x1d000
    s_nop 0
    buffer_load_dwordx4 v9, s[12:15], s24 offen lds
    s_add_u32 s24, s25, 0x1e000
    s_add_u32 m0, s27, 0x1e000
    s_nop 0
    buffer_load_dwordx4 v8, s[12:15], s24 offen lds
    s_add_u32 s24, s25, 0x1f000
    s_add_u32 m0, s27, 0x1f000
    s_nop 0
    buffer_load_dwordx4 v9, s[12:15], s24 offen lds
    s_waitcnt vmcnt(0)
    s_barrier
    v_xor_b32 v11, 0x0, v10
    ds_read_b64_tr_b16 a[0:1], v11
    ds_read_b64_tr_b16 a[2:3], v11 offset:16384
    ds_read_b64_tr_b16 a[32:33], v11 offset:32768
    ds_read_b64_tr_b16 a[34:35], v11 offset:49152
    v_xor_b32 v11, 0x20, v10
    ds_read_b64_tr_b16 a[4:5], v11
    ds_read_b64_tr_b16 a[6:7], v11 offset:16384
    ds_read_b64_tr_b16 a[36:37], v11 offset:32768
    ds_read_b64_tr_b16 a[38:39], v11 offset:49152
    s_waitcnt lgkmcnt(0)
    v_xor_b32 v11, 0x40, v10
    ds_read_b64_tr_b16 a[8:9], v11
    ds_read_b64_tr_b16 a[10:11], v11 offset:16384
    ds_read_b64_tr_b16 a[40:41], v11 offset:32768
    ds_read_b64_tr_b16 a[42:43], v11 offset:49152
    v_xor_b32 v11, 0x60, v10
    ds_read_b64_tr_b16 a[12:13], v11
    ds_read_b64_tr_b16 a[14:15], v11 offset:16384
    ds_read_b64_tr_b16 a[44:45], v11 offset:32768
    ds_read_b64_tr_b16 a[46:47], v11 offset:49152
    s_waitcnt lgkmcnt(0)
    v_xor_b32 v11, 0x80, v10
    ds_read_b64_tr_b16 a[16:17], v11
    ds_read_b64_tr_b16 a[18:19], v11 offset:16384
    ds_read_b64_tr_b16 a[48:49], v11 offset:32768
    ds_read_b64_tr_b16 a[50:51], v11 offset:49152
    v_xor_b32 v11, 0xa0, v10
    ds_read_b64_tr_b16 a[20:21], v11
    ds_read_b64_tr_b16 a[22:23], v11 offset:16384
    ds_read_b64_tr_b16 a[52:53], v11 offset:32768
    ds_read_b64_tr_b16 a[54:55], v11 offset:49152
    s_waitcnt lgkmcnt(0)
    v_xor_b32 v11, 0xc0, v10
    ds_read_b64_tr_b16 a[24:25], v11
    ds_read_b64_tr_b16 a[26:27], v11 offset:16384
    ds_read_b64_tr_b16 a[56:57], v11 offset:32768
    ds_read_b64_tr_b16 a[58:59], v11 offset:49152
    v_xor_b32 v11, 0xe0, v10
    ds_read_b64_tr_b16 a[28:29], v11
    ds_read_b64_tr_b16 a[30:31], v11 offset:16384
    ds_read_b64_tr_b16 a[60:61], v11 offset:32768
    ds_read_b64_tr_b16 a[62:63], v11 offset:49152
    s_waitcnt lgkmcnt(0)
    v_xor_b32 v11, 0x10000, v10
    ds_read_b64_tr_b16 a[64:65], v11
    ds_read_b64_tr_b16 a[66:67], v11 offset:16384
    ds_read_b64_tr_b16 a[96:97], v11 offset:32768
    ds_read_b64_tr_b16 a[98:99], v11 offset:49152
    v_xor_b32 v11, 0x10020, v10
    ds_read_b64_tr_b16 a[68:69], v11
    ds_read_b64_tr_b16 a[70:71], v11 offset:16384
    ds_read_b64_tr_b16 a[100:101], v11 offset:32768
    ds_read_b64_tr_b16 a[102:103], v11 offset:49152
    s_waitcnt lgkmcnt(0)
    v_xor_b32 v11, 0x10040, v10
    ds_read_b64_tr_b16 a[72:73], v11
    ds_read_b64_tr_b16 a[74:75], v11 offset:16384
    ds_read_b64_tr_b16 a[104:105], v11 offset:32768
    ds_read_b64_tr_b16 a[106:107], v11 offset:49152
    v_xor_b32 v11, 0x10060, v10
    ds_read_b64_tr_b16 a[76:77], v11
    ds_read_b64_tr_b16 a[78:79], v11 offset:16384
    ds_read_b64_tr_b16 a[108:109], v11 offset:32768
    ds_read_b64_tr_b16 a[110:111], v11 offset:49152
    s_waitcnt lgkmcnt(0)
    v_xor_b32 v11, 0x10080, v10
    ds_read_b64_tr_b16 a[80:81], v11
    ds_read_b64_tr_b16 a[82:83], v11 offset:16384
    ds_read_b64_tr_b16 a[112:113], v11 offset:32768
    ds_read_b64_tr_b16 a[114:115], v11 offset:49152
    v_xor_b32 v11, 0x100a0, v10
    ds_read_b64_tr_b16 a[84:85], v11
    ds_read_b64_tr_b16 a[86:87], v11 offset:16384
    ds_read_b64_tr_b16 a[116:117], v11 offset:32768
    ds_read_b64_tr_b16 a[118:119], v11 offset:49152
    s_waitcnt lgkmcnt(0)
    v_xor_b32 v11, 0x100c0, v10
    ds_read_b64_tr_b16 a[88:89], v11
    ds_read_b64_tr_b16 a[90:91], v11 offset:16384
    ds_read_b64_tr_b16 a[120:121], v11 offset:32768
    ds_read_b64_tr_b16 a[122:123], v11 offset:49152
    v_xor_b32 v11, 0x100e0, v10
    ds_read_b64_tr_b16 a[92:93], v11
    ds_read_b64_tr_b16 a[94:95], v11 offset:16384
    ds_read_b64_tr_b16 a[124:125], v11 offset:32768
    ds_read_b64_tr_b16 a[126:127], v11 offset:49152
    s_waitcnt lgkmcnt(0)
    s_barrier
    s_lshl_b32 s25, s20, 18
    s_add_u32 s24, s25, 0x20000
    s_add_u32 m0, s27, 0x0
    s_nop 0
    buffer_load_dwordx4 v8, s[12:15], s24 offen lds
    s_add_u32 s24, s25, 0x21000
    s_add_u32 m0, s27, 0x1000
    s_nop 0
    buffer_load_dwordx4 v9, s[12:15], s24 offen lds
    s_add_u32 s24, s25, 0x22000
    s_add_u32 m0, s27, 0x2000
    s_nop 0
    buffer_load_dwordx4 v8, s[12:15], s24 offen lds
    s_add_u32 s24, s25, 0x23000
    s_add_u32 m0, s27, 0x3000
    s_nop 0
    buffer_load_dwordx4 v9, s[12:15], s24 offen lds
    s_add_u32 s24, s25, 0x24000
    s_add_u32 m0, s27, 0x4000
    s_nop 0
    buffer_load_dwordx4 v8, s[12:15], s24 offen lds
    s_add_u32 s24, s25, 0x25000
    s_add_u32 m0, s27, 0x5000
    s_nop 0
    buffer_load_dwordx4 v9, s[12:15], s24 offen lds
    s_add_u32 s24, s25, 0x26000
    s_add_u32 m0, s27, 0x6000
    s_nop 0
    buffer_load_dwordx4 v8, s[12:15], s24 offen lds
    s_add_u32 s24, s25, 0x27000
    s_add_u32 m0, s27, 0x7000
    s_nop 0
    buffer_load_dwordx4 v9, s[12:15], s24 offen lds
    s_add_u32 s24, s25, 0x28000
    s_add_u32 m0, s27, 0x8000
    s_nop 0
    buffer_load_dwordx4 v8, s[12:15], s24 offen lds
    s_add_u32 s24, s25, 0x29000
    s_add_u32 m0, s27, 0x9000
    s_nop 0
    buffer_load_dwordx4 v9, s[12:15], s24 offen lds
    s_add_u32 s24, s25, 0x2a000
    s_add_u32 m0, s27, 0xa000
    s_nop 0
    buffer_load_dwordx4 v8, s[12:15], s24 offen lds
    s_add_u32 s24, s25, 0x2b000
    s_add_u32 m0, s27, 0xb000
    s_nop 0
    buffer_load_dwordx4 v9, s[12:15], s24 offen lds
    s_add_u32 s24, s25, 0x2c000
    s_add_u32 m0, s27, 0xc000
    s_nop 0
    buffer_load_dwordx4 v8, s[12:15], s24 offen lds
    s_add_u32 s24, s25, 0x2d000
    s_add_u32 m0, s27, 0xd000
    s_nop 0
    buffer_load_dwordx4 v9, s[12:15], s24 offen lds
    s_add_u32 s24, s25, 0x2e000
    s_add_u32 m0, s27, 0xe000
    s_nop 0
    buffer_load_dwordx4 v8, s[12:15], s24 offen lds
    s_add_u32 s24, s25, 0x2f000
    s_add_u32 m0, s27, 0xf000
    s_nop 0
    buffer_load_dwordx4 v9, s[12:15], s24 offen lds
    s_add_u32 s24, s25, 0x30000
    s_add_u32 m0, s27, 0x10000
    s_nop 0
    buffer_load_dwordx4 v8, s[12:15], s24 offen lds
    s_add_u32 s24, s25, 0x31000
    s_add_u32 m0, s27, 0x11000
    s_nop 0
    buffer_load_dwordx4 v9, s[12:15], s24 offen lds
    s_add_u32 s24, s25, 0x32000
    s_add_u32 m0, s27, 0x12000
    s_nop 0
    buffer_load_dwordx4 v8, s[12:15], s24 offen lds
    s_add_u32 s24, s25, 0x33000
    s_add_u32 m0, s27, 0x13000
    s_nop 0
    buffer_load_dwordx4 v9, s[12:15], s24 offen lds
    s_add_u32 s24, s25, 0x34000
    s_add_u32 m0, s27, 0x14000
    s_nop 0
    buffer_load_dwordx4 v8, s[12:15], s24 offen lds
    s_add_u32 s24, s25, 0x35000
    s_add_u32 m0, s27, 0x15000
    s_nop 0
    buffer_load_dwordx4 v9, s[12:15], s24 offen lds
    s_add_u32 s24, s25, 0x36000
    s_add_u32 m0, s27, 0x16000
    s_nop 0
    buffer_load_dwordx4 v8, s[12:15], s24 offen lds
    s_add_u32 s24, s25, 0x37000
    s_add_u32 m0, s27, 0x17000
    s_nop 0
    buffer_load_dwordx4 v9, s[12:15], s24 offen lds
    s_add_u32 s24, s25, 0x38000
    s_add_u32 m0, s27, 0x18000
    s_nop 0
    buffer_load_dwordx4 v8, s[12:15], s24 offen lds
    s_add_u32 s24, s25, 0x39000
    s_add_u32 m0, s27, 0x19000
    s_nop 0
    buffer_load_dwordx4 v9, s[12:15], s24 offen lds
    s_add_u32 s24, s25, 0x3a000
    s_add_u32 m0, s27, 0x1a000
    s_nop 0
    buffer_load_dwordx4 v8, s[12:15], s24 offen lds
    s_add_u32 s24, s25, 0x3b000
    s_add_u32 m0, s27, 0x1b000
    s_nop 0
    buffer_load_dwordx4 v9, s[12:15], s24 offen lds
    s_add_u32 s24, s25, 0x3c000
    s_add_u32 m0, s27, 0x1c000
    s_nop 0
    buffer_load_dwordx4 v8, s[12:15], s24 offen lds
    s_add_u32 s24, s25, 0x3d000
    s_add_u32 m0, s27, 0x1d000
    s_nop 0
    buffer_load_dwordx4 v9, s[12:15], s24 offen lds
    s_add_u32 s24, s25, 0x3e000
    s_add_u32 m0, s27, 0x1e000
    s_nop 0
    buffer_load_dwordx4 v8, s[12:15], s24 offen lds
    s_add_u32 s24, s25, 0x3f000
    s_add_u32 m0, s27, 0x1f000
    s_nop 0
    buffer_load_dwordx4 v9, s[12:15], s24 offen lds
    s_waitcnt vmcnt(0)
    s_barrier
    v_xor_b32 v11, 0x0, v10
    ds_read_b64_tr_b16 a[128:129], v11
    ds_read_b64_tr_b16 a[130:131], v11 offset:16384
    ds_read_b64_tr_b16 a[160:161], v11 offset:32768
    ds_read_b64_tr_b16 a[162:163], v11 offset:49152
    v_xor_b32 v11, 0x20, v10
    ds_read_b64_tr_b16 a[132:133], v11
    ds_read_b64_tr_b16 a[134:135], v11 offset:16384
    ds_read_b64_tr_b16 a[164:165], v11 offset:32768
    ds_read_b64_tr_b16 a[166:167], v11 offset:49152
    s_waitcnt lgkmcnt(0)
    v_xor_b32 v11, 0x40, v10
    ds_read_b64_tr_b16 a[136:137], v11
    ds_read_b64_tr_b16 a[138:139], v11 offset:16384
    ds_read_b64_tr_b16 a[168:169], v11 offset:32768
    ds_read_b64_tr_b16 a[170:171], v11 offset:49152
    v_xor_b32 v11, 0x60, v10
    ds_read_b64_tr_b16 a[140:141], v11
    ds_read_b64_tr_b16 a[142:143], v11 offset:16384
    ds_read_b64_tr_b16 a[172:173], v11 offset:32768
    ds_read_b64_tr_b16 a[174:175], v11 offset:49152
    s_waitcnt lgkmcnt(0)
    v_xor_b32 v11, 0x80, v10
    ds_read_b64_tr_b16 a[144:145], v11
    ds_read_b64_tr_b16 a[146:147], v11 offset:16384
    ds_read_b64_tr_b16 a[176:177], v11 offset:32768
    ds_read_b64_tr_b16 a[178:179], v11 offset:49152
    v_xor_b32 v11, 0xa0, v10
    ds_read_b64_tr_b16 a[148:149], v11
    ds_read_b64_tr_b16 a[150:151], v11 offset:16384
    ds_read_b64_tr_b16 a[180:181], v11 offset:32768
    ds_read_b64_tr_b16 a[182:183], v11 offset:49152
    s_waitcnt lgkmcnt(0)
    v_xor_b32 v11, 0xc0, v10
    ds_read_b64_tr_b16 a[152:153], v11
    ds_read_b64_tr_b16 a[154:155], v11 offset:16384
    ds_read_b64_tr_b16 a[184:185], v11 offset:32768
    ds_read_b64_tr_b16 a[186:187], v11 offset:49152
    v_xor_b32 v11, 0xe0, v10
    ds_read_b64_tr_b16 a[156:157], v11
    ds_read_b64_tr_b16 a[158:159], v11 offset:16384
    ds_read_b64_tr_b16 a[188:189], v11 offset:32768
    ds_read_b64_tr_b16 a[190:191], v11 offset:49152
    s_waitcnt lgkmcnt(0)
    v_xor_b32 v11, 0x10000, v10
    ds_read_b64_tr_b16 a[192:193], v11
    ds_read_b64_tr_b16 a[194:195], v11 offset:16384
    ds_read_b64_tr_b16 a[224:225], v11 offset:32768
    ds_read_b64_tr_b16 a[226:227], v11 offset:49152
    v_xor_b32 v11, 0x10020, v10
    ds_read_b64_tr_b16 a[196:197], v11
    ds_read_b64_tr_b16 a[198:199], v11 offset:16384
    ds_read_b64_tr_b16 a[228:229], v11 offset:32768
    ds_read_b64_tr_b16 a[230:231], v11 offset:49152
    s_waitcnt lgkmcnt(0)
    v_xor_b32 v11, 0x10040, v10
    ds_read_b64_tr_b16 a[200:201], v11
    ds_read_b64_tr_b16 a[202:203], v11 offset:16384
    ds_read_b64_tr_b16 a[232:233], v11 offset:32768
    ds_read_b64_tr_b16 a[234:235], v11 offset:49152
    v_xor_b32 v11, 0x10060, v10
    ds_read_b64_tr_b16 a[204:205], v11
    ds_read_b64_tr_b16 a[206:207], v11 offset:16384
    ds_read_b64_tr_b16 a[236:237], v11 offset:32768
    ds_read_b64_tr_b16 a[238:239], v11 offset:49152
    s_waitcnt lgkmcnt(0)
    v_xor_b32 v11, 0x10080, v10
    ds_read_b64_tr_b16 a[208:209], v11
    ds_read_b64_tr_b16 a[210:211], v11 offset:16384
    ds_read_b64_tr_b16 a[240:241], v11 offset:32768
    ds_read_b64_tr_b16 a[242:243], v11 offset:49152
    v_xor_b32 v11, 0x100a0, v10
    ds_read_b64_tr_b16 a[212:213], v11
    ds_read_b64_tr_b16 a[214:215], v11 offset:16384
    ds_read_b64_tr_b16 a[244:245], v11 offset:32768
    ds_read_b64_tr_b16 a[246:247], v11 offset:49152
    s_waitcnt lgkmcnt(0)
    v_xor_b32 v11, 0x100c0, v10
    ds_read_b64_tr_b16 a[216:217], v11
    ds_read_b64_tr_b16 a[218:219], v11 offset:16384
    ds_read_b64_tr_b16 a[248:249], v11 offset:32768
    ds_read_b64_tr_b16 a[250:251], v11 offset:49152
    v_xor_b32 v11, 0x100e0, v10
    ds_read_b64_tr_b16 a[220:221], v11
    ds_read_b64_tr_b16 a[222:223], v11 offset:16384
    ds_read_b64_tr_b16 a[252:253], v11 offset:32768
    ds_read_b64_tr_b16 a[254:255], v11 offset:49152
    s_waitcnt lgkmcnt(0)
    s_barrier
    s_and_b32 s24, s21, 1
    s_lshl_b32 s24, s24, 4
    v_add_u32 v4, s24, v3
    v_lshlrev_b32 v5, 2, v2
    v_sub_u32 v4, v4, v5
    v_cmp_le_i32 s[30:31], 0, v4
    v_cmp_le_i32 s[32:33], 1, v4
    v_cmp_le_i32 s[34:35], 2, v4
    v_cmp_le_i32 s[36:37], 3, v4
    v_cmp_le_i32 s[38:39], 16, v4
    v_cmp_le_i32 s[40:41], 17, v4
    v_cmp_le_i32 s[42:43], 18, v4
    v_cmp_le_i32 s[44:45], 19, v4
    s_mov_b32 s28, 0x3e0293ee
    s_mov_b32 s29, 0x3e0293ee
    s_mov_b32 s53, 0xff000000
    v_mov_b32 v136, 0x3f803f80
    v_mov_b32 v137, 0x3f803f80
    v_mov_b32 v138, 0x3f803f80
    v_mov_b32 v139, 0x3f803f80
    v_lshlrev_b32 v4, 10, v3
    v_lshl_add_u32 v4, v2, 4, v4
    s_lshl_b32 s24, s21, 8
    v_add_u32 v242, s24, v4
    s_lshl_b32 s24, s21, 12
    v_add_u32 v243, s24, v240
    v_mov_b32 v244, v240
    s_add_u32 s24, s24, 0x22000
    v_xor_b32 v7, v2, v6
    v_lshl_add_u32 v4, v2, 4, v7
    v_and_b32 v5, 3, v3
    v_lshl_add_u32 v4, v4, 2, v5
    v_lshl_add_u32 v253, v4, 2, s24
    v_lshl_add_u32 v4, v3, 2, v7
    v_lshl_add_u32 v254, v4, 4, s24
    s_load_dwordx2 s[12:13], s[0:1], 0
    s_waitcnt lgkmcnt(0)
    s_and_b32 s13, s13, 0xffff
    s_mov_b32 s14, 0x200000
    s_mov_b32 s15, 0x20000
    s_load_dwordx2 s[16:17], s[0:1], 96
    s_waitcnt lgkmcnt(0)
    s_and_b32 s17, s17, 0xffff
    s_mov_b32 s18, 0x200000
    s_mov_b32 s19, 0x20000
    s_load_dwordx2 s[56:57], s[0:1], 64
    s_waitcnt lgkmcnt(0)
    s_and_b32 s57, s57, 0xffff
    s_mov_b32 s58, 0x400
    s_mov_b32 s59, 0x20000
    v_and_b32 v100, 63, v0
    v_lshlrev_b32 v240, 4, v100
    v_lshrrev_b32 v101, 2, v100
    v_lshlrev_b32 v101, 6, v101
    v_and_b32 v102, 3, v100
    v_lshl_add_u32 v252, v102, 3, v101
    buffer_load_dwordx2 v[236:237], v252, s[56:59], 0 offen
    buffer_load_dwordx2 v[238:239], v252, s[56:59], 0 offen offset:32
    s_mov_b32 s65, 0x3f80
    s_mov_b32 s66, 0x3f800000
    s_waitcnt vmcnt(0)
    s_sub_u32 s67, s101, 128
    s_cmp_ge_u32 s67, 56
    s_cbranch_scc1 L_nostage_104
    v_lshrrev_b32 v2, 6, v0
    s_nop 0
    v_readfirstlane_b32 s68, v2
    v_and_b32 v1, 63, v0
    s_lshl_b32 s73, s68, 10
    v_lshrrev_b32 v2, 2, v1
    s_lshl_b32 s71, s68, 4
    v_add_u32 v2, s71, v2
    s_movk_i32 s71, 3584
    v_mul_lo_u32 v2, v2, s71
    v_and_b32 v3, 3, v1
    v_lshl_add_u32 v4, v3, 4, v2
    s_load_dwordx2 s[76:77], s[0:1], 72
    s_waitcnt lgkmcnt(0)
    s_and_b32 s77, s77, 0xffff
    s_mov_b32 s78, 0x1c0000
    s_mov_b32 s79, 0x20000
    s_lshl_b32 s71, s67, 6
    s_add_u32 s71, s71, 0x0
    s_add_u32 m0, s73, 0x8000
    s_nop 0
    buffer_load_dwordx4 v4, s[76:79], s71 offen lds
    s_lshl_b32 s71, s67, 6
    s_add_u32 s71, s71, 0x38000
    s_add_u32 m0, s73, 0x9000
    s_nop 0
    buffer_load_dwordx4 v4, s[76:79], s71 offen lds
    s_lshl_b32 s71, s67, 6
    s_add_u32 s71, s71, 0x70000
    s_add_u32 m0, s73, 0xa000
    s_nop 0
    buffer_load_dwordx4 v4, s[76:79], s71 offen lds
    s_lshl_b32 s71, s67, 6
    s_add_u32 s71, s71, 0xa8000
    s_add_u32 m0, s73, 0xb000
    s_nop 0
    buffer_load_dwordx4 v4, s[76:79], s71 offen lds
    s_lshl_b32 s71, s67, 6
    s_add_u32 s71, s71, 0xe0000
    s_add_u32 m0, s73, 0xc000
    s_nop 0
    buffer_load_dwordx4 v4, s[76:79], s71 offen lds
    s_lshl_b32 s71, s67, 6
    s_add_u32 s71, s71, 0x118000
    s_add_u32 m0, s73, 0xd000
    s_nop 0
    buffer_load_dwordx4 v4, s[76:79], s71 offen lds
    s_lshl_b32 s71, s67, 6
    s_add_u32 s71, s71, 0x150000
    s_add_u32 m0, s73, 0xe000
    s_nop 0
    buffer_load_dwordx4 v4, s[76:79], s71 offen lds
    s_lshl_b32 s71, s67, 6
    s_add_u32 s71, s71, 0x188000
    s_add_u32 m0, s73, 0xf000
    s_nop 0
    buffer_load_dwordx4 v4, s[76:79], s71 offen lds
    s_load_dwordx2 s[76:77], s[0:1], 80
    s_waitcnt lgkmcnt(0)
    s_and_b32 s77, s77, 0xffff
    s_mov_b32 s78, 0x1c0000
    s_mov_b32 s79, 0x20000
    s_lshl_b32 s71, s67, 6
    s_add_u32 s71, s71, 0x0
    s_add_u32 m0, s73, 0x10000
    s_nop 0
    buffer_load_dwordx4 v4, s[76:79], s71 offen lds
    s_lshl_b32 s71, s67, 6
    s_add_u32 s71, s71, 0x38000
    s_add_u32 m0, s73, 0x11000
    s_nop 0
    buffer_load_dwordx4 v4, s[76:79], s71 offen lds
    s_lshl_b32 s71, s67, 6
    s_add_u32 s71, s71, 0x70000
    s_add_u32 m0, s73, 0x12000
    s_nop 0
    buffer_load_dwordx4 v4, s[76:79], s71 offen lds
    s_lshl_b32 s71, s67, 6
    s_add_u32 s71, s71, 0xa8000
    s_add_u32 m0, s73, 0x13000
    s_nop 0
    buffer_load_dwordx4 v4, s[76:79], s71 offen lds
    s_lshl_b32 s71, s67, 6
    s_add_u32 s71, s71, 0xe0000
    s_add_u32 m0, s73, 0x14000
    s_nop 0
    buffer_load_dwordx4 v4, s[76:79], s71 offen lds
    s_lshl_b32 s71, s67, 6
    s_add_u32 s71, s71, 0x118000
    s_add_u32 m0, s73, 0x15000
    s_nop 0
    buffer_load_dwordx4 v4, s[76:79], s71 offen lds
    s_lshl_b32 s71, s67, 6
    s_add_u32 s71, s71, 0x150000
    s_add_u32 m0, s73, 0x16000
    s_nop 0
    buffer_load_dwordx4 v4, s[76:79], s71 offen lds
    s_lshl_b32 s71, s67, 6
    s_add_u32 s71, s71, 0x188000
    s_add_u32 m0, s73, 0x17000
    s_nop 0
    buffer_load_dwordx4 v4, s[76:79], s71 offen lds
    s_load_dwordx2 s[76:77], s[0:1], 88
    s_waitcnt lgkmcnt(0)
    s_and_b32 s77, s77, 0xffff
    s_mov_b32 s78, 0x1c0000
    s_mov_b32 s79, 0x20000
    v_lshlrev_b32 v5, 4, v1
    v_add_u32 v5, s73, v5
    s_lshl_b32 s71, s67, 15
    s_add_u32 s71, s71, 0
    s_add_u32 m0, s73, 0x18000
    s_nop 0
    buffer_load_dwordx4 v5, s[76:79], s71 offen lds
    s_lshl_b32 s71, s67, 15
    s_add_u32 s71, s71, 4096
    s_add_u32 m0, s73, 0x19000
    s_nop 0
    buffer_load_dwordx4 v5, s[76:79], s71 offen lds
    s_lshl_b32 s71, s67, 15
    s_add_u32 s71, s71, 8192
    s_add_u32 m0, s73, 0x1a000
    s_nop 0
    buffer_load_dwordx4 v5, s[76:79], s71 offen lds
    s_lshl_b32 s71, s67, 15
    s_add_u32 s71, s71, 12288
    s_add_u32 m0, s73, 0x1b000
    s_nop 0
    buffer_load_dwordx4 v5, s[76:79], s71 offen lds
    s_lshl_b32 s71, s67, 15
    s_add_u32 s71, s71, 16384
    s_add_u32 m0, s73, 0x1c000
    s_nop 0
    buffer_load_dwordx4 v5, s[76:79], s71 offen lds
    s_lshl_b32 s71, s67, 15
    s_add_u32 s71, s71, 20480
    s_add_u32 m0, s73, 0x1d000
    s_nop 0
    buffer_load_dwordx4 v5, s[76:79], s71 offen lds
    s_lshl_b32 s71, s67, 15
    s_add_u32 s71, s71, 24576
    s_add_u32 m0, s73, 0x1e000
    s_nop 0
    buffer_load_dwordx4 v5, s[76:79], s71 offen lds
    s_lshl_b32 s71, s67, 15
    s_add_u32 s71, s71, 28672
    s_add_u32 m0, s73, 0x1f000
    s_nop 0
    buffer_load_dwordx4 v5, s[76:79], s71 offen lds
L_nostage_104:
    v_lshrrev_b32 v246, 2, v240
    s_lshl_b32 s24, s20, 7
    s_add_u32 s24, s24, 0x2000
    s_cmp_lg_u32 s100, 0
    s_cbranch_scc1 L_polls_107
    s_mov_b32 exec_lo, 0xffffffff
    s_mov_b32 exec_hi, 0
    s_mov_b32 s96, 0
L_poll_105:
    buffer_load_dword v247, v246, s[8:11], s24 offen sc1
    s_waitcnt vmcnt(0)
    v_cmp_gt_u32 vcc, 1, v247
    s_cbranch_vccz L_polld_106
    s_sleep 32
    s_add_u32 s96, s96, 1
    s_cmp_lt_u32 s96, 0x10000
    s_cbranch_scc1 L_poll_105
L_polld_106:
    s_mov_b64 exec, -1
L_polls_107:
    s_barrier
    s_lshl_b32 s24, s20, 7
    s_add_u32 s24, s24, 0x2800
    s_cmp_lg_u32 s100, 0
    s_cbranch_scc1 L_polls_110
    s_mov_b32 exec_lo, 0xffffffff
    s_mov_b32 exec_hi, 0
    s_mov_b32 s96, 0
L_poll_108:
    buffer_load_dword v247, v246, s[8:11], s24 offen sc1
    s_waitcnt vmcnt(0)
    v_cmp_gt_u32 vcc, 1, v247
    s_cbranch_vccz L_polld_109
    s_sleep 32
    s_add_u32 s96, s96, 1
    s_cmp_lt_u32 s96, 0x10000
    s_cbranch_scc1 L_poll_108
L_polld_109:
    s_mov_b64 exec, -1
L_polls_110:
    s_barrier
    s_lshl_b32 s24, s20, 7
    s_add_u32 s24, s24, 0x3000
    s_cmp_lg_u32 s100, 0
    s_cbranch_scc1 L_polls_113
    s_mov_b32 exec_lo, 0xffffffff
    s_mov_b32 exec_hi, 0
    s_mov_b32 s96, 0
L_poll_111:
    buffer_load_dword v247, v246, s[8:11], s24 offen sc1
    s_waitcnt vmcnt(0)
    v_cmp_gt_u32 vcc, 1, v247
    s_cbranch_vccz L_polld_112
    s_sleep 32
    s_add_u32 s96, s96, 1
    s_cmp_lt_u32 s96, 0x10000
    s_cbranch_scc1 L_poll_111
L_polld_112:
    s_mov_b64 exec, -1
L_polls_113:
    s_barrier
    s_mov_b32 s80, 0
L_p2_seg:
    s_cmp_ge_u32 s22, 64
    s_cbranch_scc1 L_p2_end
    s_lshl_b32 s24, s22, 5
    s_lshl_b32 s25, s20, 1
    s_add_u32 s24, s24, s25
    s_lshr_b32 s25, s21, 1
    s_add_u32 s24, s24, s25
    s_lshl_b32 s25, s24, 13
    s_add_u32 s47, s25, 0x1000000
    s_add_u32 s54, s47, 4096
    s_add_u32 s48, s25, 0x2000000
    s_add_u32 s55, s48, 4096
    s_and_b32 s26, s21, 1
    s_lshl_b32 s26, s26, 12
    s_add_u32 s46, s25, s26
    s_add_u32 s46, s46, 0x3000000
    s_lshl_b32 s25, s24, 12
    s_add_u32 s49, s25, 0x240000
    s_lshl_b32 s24, s22, 4
    s_add_u32 s24, s24, s20
    s_lshl_b32 s24, s24, 15
    s_add_u32 s51, s24, 0x4000000
    buffer_load_dwordx4 v[0:3], v240, s[8:11], s46 offen
    buffer_load_dwordx4 v[4:7], v240, s[8:11], s46 offen offset:1024
    buffer_load_dwordx4 v[8:11], v240, s[8:11], s46 offen offset:2048
    buffer_load_dwordx4 v[12:15], v240, s[8:11], s46 offen offset:3072
    buffer_load_dwordx4 v[16:19], v240, s[8:11], s47 offen
    buffer_load_dwordx4 v[20:23], v240, s[8:11], s47 offen offset:1024
    buffer_load_dwordx4 v[24:27], v240, s[8:11], s47 offen offset:2048
    buffer_load_dwordx4 v[28:31], v240, s[8:11], s47 offen offset:3072
    buffer_load_dwordx4 v[32:35], v240, s[8:11], s54 offen
    buffer_load_dwordx4 v[36:39], v240, s[8:11], s54 offen offset:1024
    buffer_load_dwordx4 v[40:43], v240, s[8:11], s54 offen offset:2048
    buffer_load_dwordx4 v[44:47], v240, s[8:11], s54 offen offset:3072
    buffer_load_dwordx4 v[64:67], v240, s[8:11], s48 offen
    buffer_load_dwordx4 v[68:71], v240, s[8:11], s48 offen offset:1024
    buffer_load_dwordx4 v[72:75], v240, s[8:11], s48 offen offset:2048
    buffer_load_dwordx4 v[76:79], v240, s[8:11], s48 offen offset:3072
    buffer_load_dwordx4 v[80:83], v240, s[8:11], s55 offen
    buffer_load_dwordx4 v[84:87], v240, s[8:11], s55 offen offset:1024
    buffer_load_dwordx4 v[88:91], v240, s[8:11], s55 offen offset:2048
    buffer_load_dwordx4 v[92:95], v240, s[8:11], s55 offen offset:3072
    s_waitcnt vmcnt(8)
    v_mfma_f32_16x16x32_bf16 v[116:119], v[16:19], v[0:3], 0
    v_mfma_f32_16x16x32_bf16 v[116:119], v[20:23], v[4:7], v[116:119]
    v_mfma_f32_16x16x32_bf16 v[116:119], v[24:27], v[8:11], v[116:119]
    v_mfma_f32_16x16x32_bf16 v[116:119], v[28:31], v[12:15], v[116:119]
    v_mfma_f32_16x16x32_bf16 v[120:123], v[32:35], v[0:3], 0
    v_mfma_f32_16x16x32_bf16 v[120:123], v[36:39], v[4:7], v[120:123]
    v_mfma_f32_16x16x32_bf16 v[120:123], v[40:43], v[8:11], v[120:123]
    v_mfma_f32_16x16x32_bf16 v[120:123], v[44:47], v[12:15], v[120:123]
    v_mov_b32 v247, s53
    v_cndmask_b32 v116, v247, v116, s[30:31]
    v_cndmask_b32 v117, v247, v117, s[32:33]
    v_cndmask_b32 v118, v247, v118, s[34:35]
    v_cndmask_b32 v119, v247, v119, s[36:37]
    s_nop 2
    v_cndmask_b32 v120, v247, v120, s[38:39]
    v_cndmask_b32 v121, v247, v121, s[40:41]
    v_cndmask_b32 v122, v247, v122, s[42:43]
    v_cndmask_b32 v123, v247, v123, s[44:45]
    v_max3_f32 v251, v116, v117, v118
    v_max3_f32 v251, v251, v119, v120
    v_max3_f32 v251, v251, v121, v122
    v_lshrrev_b32 v246, 2, v240
    s_lshl_b32 s24, s20, 7
    s_add_u32 s24, s24, 0x1000
    s_add_u32 s25, s22, 1
    s_nop 1
    s_cmp_lg_u32 s100, 0
    s_cbranch_scc1 L_polls_116
    s_mov_b32 exec_lo, 0x11
    s_mov_b32 exec_hi, 0
    s_mov_b32 s96, 0
L_poll_114:
    buffer_load_dword v247, v246, s[8:11], s24 offen sc1
    s_waitcnt vmcnt(0)
    v_cmp_gt_u32 vcc, s25, v247
    s_cbranch_vccz L_polld_115
    v_readfirstlane_b32 s97, v247
    s_nop 0
    s_sub_u32 s97, s25, s97
    s_cmp_lt_i32 s97, 3
    s_cbranch_scc1 L_near_117
    s_sleep 40
    s_cmp_lt_i32 s97, 5
    s_cbranch_scc1 L_near_117
    s_sleep 100
L_near_117:
    s_sleep 8
    s_add_u32 s96, s96, 1
    s_cmp_lt_u32 s96, 0x10000
    s_cbranch_scc1 L_poll_114
L_polld_115:
    s_mov_b64 exec, -1
L_polls_116:
    s_barrier
    buffer_load_dwordx4 v[172:175], v240, s[8:11], s49 offen
    buffer_load_dwordx4 v[176:179], v240, s[8:11], s49 offen offset:1024
    buffer_load_dwordx4 v[180:183], v240, s[8:11], s49 offen offset:2048
    buffer_load_dwordx4 v[184:187], v240, s[8:11], s49 offen offset:3072
    s_waitcnt vmcnt(0)
    ds_write_b32 v253, v173
    ds_write_b32 v253, v175 offset:64
    ds_write_b32 v253, v177 offset:1024
    ds_write_b32 v253, v179 offset:1088
    ds_write_b32 v253, v181 offset:2048
    ds_write_b32 v253, v183 offset:2112
    ds_write_b32 v253, v185 offset:3072
    ds_write_b32 v253, v187 offset:3136
    ds_read_b128 v[48:51], v254
    ds_read_b128 v[52:55], v254 offset:1024
    ds_read_b128 v[56:59], v254 offset:2048
    ds_read_b128 v[60:63], v254 offset:3072
    s_waitcnt lgkmcnt(0)
    v_mfma_f32_16x16x32_bf16 v[112:115], v[48:51], v[0:3], 0
    v_mfma_f32_16x16x32_bf16 v[112:115], v[52:55], v[4:7], v[112:115]
    v_mfma_f32_16x16x32_bf16 v[112:115], v[56:59], v[8:11], v[112:115]
    v_mfma_f32_16x16x32_bf16 v[112:115], v[60:63], v[12:15], v[112:115]
    v_mov_b32 v246, v251
    s_nop 6
    v_max3_f32 v246, v246, v123, v112
    v_max_f32 v246, v246, v113
    v_mov_b32 v247, v246
    s_nop 1
    v_permlane32_swap_b32 v247, v246
    v_max_f32 v246, v247, v246
    v_mov_b32 v247, v246
    s_nop 1
    v_permlane16_swap_b32 v247, v246
    v_max_f32 v246, v247, v246
    v_mul_f32 v248, s28, v246
    v_pk_fma_f32 v[116:117], v[116:117], s[28:29], v[248:249] op_sel_hi:[1,1,0] neg_lo:[0,0,1] neg_hi:[0,0,1]
    v_pk_fma_f32 v[118:119], v[118:119], s[28:29], v[248:249] op_sel_hi:[1,1,0] neg_lo:[0,0,1] neg_hi:[0,0,1]
    v_pk_fma_f32 v[120:121], v[120:121], s[28:29], v[248:249] op_sel_hi:[1,1,0] neg_lo:[0,0,1] neg_hi:[0,0,1]
    v_pk_fma_f32 v[122:123], v[122:123], s[28:29], v[248:249] op_sel_hi:[1,1,0] neg_lo:[0,0,1] neg_hi:[0,0,1]
    v_pk_fma_f32 v[112:113], v[112:113], s[28:29], v[248:249] op_sel_hi:[1,1,0] neg_lo:[0,0,1] neg_hi:[0,0,1]
    v_exp_f32 v116, v116
    v_exp_f32 v117, v117
    v_exp_f32 v118, v118
    v_exp_f32 v119, v119
    v_exp_f32 v120, v120
    v_exp_f32 v121, v121
    v_exp_f32 v122, v122
    v_exp_f32 v123, v123
    v_exp_f32 v112, v112
    v_exp_f32 v113, v113
    v_cvt_pk_bf16_f32 v124, v116, v117
    v_cvt_pk_bf16_f32 v125, v118, v119
    v_cvt_pk_bf16_f32 v126, v120, v121
    v_cvt_pk_bf16_f32 v127, v122, v123
    v_cvt_pk_bf16_f32 v128, v112, v113
    v_mov_b32 v129, 0
    v_mfma_f32_16x16x32_bf16 v[132:135], v[136:139], v[124:127], 0
    v_mfma_f32_16x16x32_bf16 v[140:143], v[64:67], v[124:127], 0
    v_mfma_f32_16x16x32_bf16 v[144:147], v[68:71], v[124:127], 0
    v_mfma_f32_16x16x32_bf16 v[148:151], v[72:75], v[124:127], 0
    v_mfma_f32_16x16x32_bf16 v[152:155], v[76:79], v[124:127], 0
    v_mfma_f32_16x16x32_bf16 v[156:159], v[80:83], v[124:127], 0
    v_mfma_f32_16x16x32_bf16 v[160:163], v[84:87], v[124:127], 0
    v_mfma_f32_16x16x32_bf16 v[164:167], v[88:91], v[124:127], 0
    v_mfma_f32_16x16x32_bf16 v[168:171], v[92:95], v[124:127], 0
    v_mfma_f32_16x16x16_bf16 v[132:135], v[136:137], v[128:129], v[132:135]
    v_mfma_f32_16x16x16_bf16 v[140:143], v[172:173], v[128:129], v[140:143]
    v_mfma_f32_16x16x16_bf16 v[144:147], v[174:175], v[128:129], v[144:147]
    v_mfma_f32_16x16x16_bf16 v[148:151], v[176:177], v[128:129], v[148:151]
    v_mfma_f32_16x16x16_bf16 v[152:155], v[178:179], v[128:129], v[152:155]
    v_mfma_f32_16x16x16_bf16 v[156:159], v[180:181], v[128:129], v[156:159]
    v_mfma_f32_16x16x16_bf16 v[160:163], v[182:183], v[128:129], v[160:163]
    v_mfma_f32_16x16x16_bf16 v[164:167], v[184:185], v[128:129], v[164:167]
    v_mfma_f32_16x16x16_bf16 v[168:171], v[186:187], v[128:129], v[168:171]
    v_rcp_f32 v250, v132
    s_nop 0
    v_pk_mul_f32 v[140:141], v[140:141], v[250:251] op_sel_hi:[1,0]
    v_pk_mul_f32 v[142:143], v[142:143], v[250:251] op_sel_hi:[1,0]
    v_pk_mul_f32 v[144:145], v[144:145], v[250:251] op_sel_hi:[1,0]
    v_pk_mul_f32 v[146:147], v[146:147], v[250:251] op_sel_hi:[1,0]
    v_pk_mul_f32 v[148:149], v[148:149], v[250:251] op_sel_hi:[1,0]
    v_pk_mul_f32 v[150:151], v[150:151], v[250:251] op_sel_hi:[1,0]
    v_pk_mul_f32 v[152:153], v[152:153], v[250:251] op_sel_hi:[1,0]
    v_pk_mul_f32 v[154:155], v[154:155], v[250:251] op_sel_hi:[1,0]
    v_pk_mul_f32 v[156:157], v[156:157], v[250:251] op_sel_hi:[1,0]
    v_pk_mul_f32 v[158:159], v[158:159], v[250:251] op_sel_hi:[1,0]
    v_pk_mul_f32 v[160:161], v[160:161], v[250:251] op_sel_hi:[1,0]
    v_pk_mul_f32 v[162:163], v[162:163], v[250:251] op_sel_hi:[1,0]
    v_pk_mul_f32 v[164:165], v[164:165], v[250:251] op_sel_hi:[1,0]
    v_pk_mul_f32 v[166:167], v[166:167], v[250:251] op_sel_hi:[1,0]
    v_pk_mul_f32 v[168:169], v[168:169], v[250:251] op_sel_hi:[1,0]
    v_pk_mul_f32 v[170:171], v[170:171], v[250:251] op_sel_hi:[1,0]
    v_cvt_pk_bf16_f32 v140, v140, v141
    v_cvt_pk_bf16_f32 v141, v142, v143
    v_cvt_pk_bf16_f32 v142, v144, v145
    v_cvt_pk_bf16_f32 v143, v146, v147
    v_cvt_pk_bf16_f32 v144, v148, v149
    v_cvt_pk_bf16_f32 v145, v150, v151
    v_cvt_pk_bf16_f32 v146, v152, v153
    v_cvt_pk_bf16_f32 v147, v154, v155
    v_cvt_pk_bf16_f32 v148, v156, v157
    v_cvt_pk_bf16_f32 v149, v158, v159
    v_cvt_pk_bf16_f32 v150, v160, v161
    v_cvt_pk_bf16_f32 v151, v162, v163
    v_cvt_pk_bf16_f32 v152, v164, v165
    v_cvt_pk_bf16_f32 v153, v166, v167
    v_cvt_pk_bf16_f32 v154, v168, v169
    v_cvt_pk_bf16_f32 v155, v170, v171
    ds_write_b128 v243, v[140:143]
    ds_write_b128 v243, v[144:147] offset:1024
    ds_write_b128 v243, v[148:151] offset:2048
    ds_write_b128 v243, v[152:155] offset:3072
    s_waitcnt lgkmcnt(0)
    s_barrier
    ds_read_b128 v[0:3], v244
    ds_read_b128 v[4:7], v244 offset:1024
    ds_read_b128 v[8:11], v244 offset:2048
    ds_read_b128 v[12:15], v244 offset:3072
    ds_read_b128 v[16:19], v244 offset:4096
    ds_read_b128 v[20:23], v244 offset:5120
    ds_read_b128 v[24:27], v244 offset:6144
    ds_read_b128 v[28:31], v244 offset:7168
    s_waitcnt lgkmcnt(4)
    ds_read_b128 v[32:35], v244 offset:8192
    ds_read_b128 v[36:39], v244 offset:9216
    ds_read_b128 v[40:43], v244 offset:10240
    ds_read_b128 v[44:47], v244 offset:11264
    ds_read_b128 v[48:51], v244 offset:12288
    ds_read_b128 v[52:55], v244 offset:13312
    ds_read_b128 v[56:59], v244 offset:14336
    ds_read_b128 v[60:63], v244 offset:15360
    v_xor_b32 v243, 0x4000, v243
    v_xor_b32 v244, 0x4000, v244
    s_waitcnt lgkmcnt(0)
    v_mfma_f32_16x16x32_bf16 v[172:175], a[0:3], v[0:3], 0
    v_mfma_f32_16x16x32_bf16 v[176:179], a[4:7], v[0:3], 0
    v_mfma_f32_16x16x32_bf16 v[180:183], a[8:11], v[0:3], 0
    v_mfma_f32_16x16x32_bf16 v[184:187], a[12:15], v[0:3], 0
    v_mfma_f32_16x16x32_bf16 v[188:191], a[16:19], v[0:3], 0
    v_mfma_f32_16x16x32_bf16 v[192:195], a[20:23], v[0:3], 0
    v_mfma_f32_16x16x32_bf16 v[196:199], a[24:27], v[0:3], 0
    v_mfma_f32_16x16x32_bf16 v[200:203], a[28:31], v[0:3], 0
    v_mfma_f32_16x16x32_bf16 v[172:175], a[32:35], v[4:7], v[172:175]
    v_mfma_f32_16x16x32_bf16 v[176:179], a[36:39], v[4:7], v[176:179]
    v_mfma_f32_16x16x32_bf16 v[180:183], a[40:43], v[4:7], v[180:183]
    v_mfma_f32_16x16x32_bf16 v[184:187], a[44:47], v[4:7], v[184:187]
    v_mfma_f32_16x16x32_bf16 v[188:191], a[48:51], v[4:7], v[188:191]
    v_mfma_f32_16x16x32_bf16 v[192:195], a[52:55], v[4:7], v[192:195]
    v_mfma_f32_16x16x32_bf16 v[196:199], a[56:59], v[4:7], v[196:199]
    v_mfma_f32_16x16x32_bf16 v[200:203], a[60:63], v[4:7], v[200:203]
    v_mfma_f32_16x16x32_bf16 v[172:175], a[64:67], v[8:11], v[172:175]
    v_mfma_f32_16x16x32_bf16 v[176:179], a[68:71], v[8:11], v[176:179]
    v_mfma_f32_16x16x32_bf16 v[180:183], a[72:75], v[8:11], v[180:183]
    v_mfma_f32_16x16x32_bf16 v[184:187], a[76:79], v[8:11], v[184:187]
    v_mfma_f32_16x16x32_bf16 v[188:191], a[80:83], v[8:11], v[188:191]
    v_mfma_f32_16x16x32_bf16 v[192:195], a[84:87], v[8:11], v[192:195]
    v_mfma_f32_16x16x32_bf16 v[196:199], a[88:91], v[8:11], v[196:199]
    v_mfma_f32_16x16x32_bf16 v[200:203], a[92:95], v[8:11], v[200:203]
    v_mfma_f32_16x16x32_bf16 v[172:175], a[96:99], v[12:15], v[172:175]
    v_mfma_f32_16x16x32_bf16 v[176:179], a[100:103], v[12:15], v[176:179]
    v_mfma_f32_16x16x32_bf16 v[180:183], a[104:107], v[12:15], v[180:183]
    v_mfma_f32_16x16x32_bf16 v[184:187], a[108:111], v[12:15], v[184:187]
    v_mfma_f32_16x16x32_bf16 v[188:191], a[112:115], v[12:15], v[188:191]
    v_mfma_f32_16x16x32_bf16 v[192:195], a[116:119], v[12:15], v[192:195]
    v_mfma_f32_16x16x32_bf16 v[196:199], a[120:123], v[12:15], v[196:199]
    v_mfma_f32_16x16x32_bf16 v[200:203], a[124:127], v[12:15], v[200:203]
    v_mfma_f32_16x16x32_bf16 v[172:175], a[128:131], v[32:35], v[172:175]
    v_mfma_f32_16x16x32_bf16 v[176:179], a[132:135], v[32:35], v[176:179]
    v_mfma_f32_16x16x32_bf16 v[180:183], a[136:139], v[32:35], v[180:183]
    v_mfma_f32_16x16x32_bf16 v[184:187], a[140:143], v[32:35], v[184:187]
    v_mfma_f32_16x16x32_bf16 v[188:191], a[144:147], v[32:35], v[188:191]
    v_mfma_f32_16x16x32_bf16 v[192:195], a[148:151], v[32:35], v[192:195]
    v_mfma_f32_16x16x32_bf16 v[196:199], a[152:155], v[32:35], v[196:199]
    v_mfma_f32_16x16x32_bf16 v[200:203], a[156:159], v[32:35], v[200:203]
    v_mfma_f32_16x16x32_bf16 v[172:175], a[160:163], v[36:39], v[172:175]
    v_mfma_f32_16x16x32_bf16 v[176:179], a[164:167], v[36:39], v[176:179]
    v_mfma_f32_16x16x32_bf16 v[180:183], a[168:171], v[36:39], v[180:183]
    v_mfma_f32_16x16x32_bf16 v[184:187], a[172:175], v[36:39], v[184:187]
    v_mfma_f32_16x16x32_bf16 v[188:191], a[176:179], v[36:39], v[188:191]
    v_mfma_f32_16x16x32_bf16 v[192:195], a[180:183], v[36:39], v[192:195]
    v_mfma_f32_16x16x32_bf16 v[196:199], a[184:187], v[36:39], v[196:199]
    v_mfma_f32_16x16x32_bf16 v[200:203], a[188:191], v[36:39], v[200:203]
    v_mfma_f32_16x16x32_bf16 v[172:175], a[192:195], v[40:43], v[172:175]
    v_mfma_f32_16x16x32_bf16 v[176:179], a[196:199], v[40:43], v[176:179]
    v_mfma_f32_16x16x32_bf16 v[180:183], a[200:203], v[40:43], v[180:183]
    v_mfma_f32_16x16x32_bf16 v[184:187], a[204:207], v[40:43], v[184:187]
    v_mfma_f32_16x16x32_bf16 v[188:191], a[208:211], v[40:43], v[188:191]
    v_mfma_f32_16x16x32_bf16 v[192:195], a[212:215], v[40:43], v[192:195]
    v_mfma_f32_16x16x32_bf16 v[196:199], a[216:219], v[40:43], v[196:199]
    v_mfma_f32_16x16x32_bf16 v[200:203], a[220:223], v[40:43], v[200:203]
    v_mfma_f32_16x16x32_bf16 v[172:175], a[224:227], v[44:47], v[172:175]
    v_mfma_f32_16x16x32_bf16 v[176:179], a[228:231], v[44:47], v[176:179]
    v_mfma_f32_16x16x32_bf16 v[180:183], a[232:235], v[44:47], v[180:183]
    v_mfma_f32_16x16x32_bf16 v[184:187], a[236:239], v[44:47], v[184:187]
    v_mfma_f32_16x16x32_bf16 v[188:191], a[240:243], v[44:47], v[188:191]
    v_mfma_f32_16x16x32_bf16 v[192:195], a[244:247], v[44:47], v[192:195]
    v_mfma_f32_16x16x32_bf16 v[196:199], a[248:251], v[44:47], v[196:199]
    v_mfma_f32_16x16x32_bf16 v[200:203], a[252:255], v[44:47], v[200:203]
    v_mfma_f32_16x16x32_bf16 v[204:207], a[0:3], v[16:19], 0
    v_mfma_f32_16x16x32_bf16 v[208:211], a[4:7], v[16:19], 0
    v_mfma_f32_16x16x32_bf16 v[212:215], a[8:11], v[16:19], 0
    v_mfma_f32_16x16x32_bf16 v[216:219], a[12:15], v[16:19], 0
    v_mfma_f32_16x16x32_bf16 v[220:223], a[16:19], v[16:19], 0
    v_mfma_f32_16x16x32_bf16 v[224:227], a[20:23], v[16:19], 0
    v_mfma_f32_16x16x32_bf16 v[228:231], a[24:27], v[16:19], 0
    v_mfma_f32_16x16x32_bf16 v[232:235], a[28:31], v[16:19], 0
    v_cvt_pk_bf16_f32 v140, v172, v173
    v_cvt_pk_bf16_f32 v141, v174, v175
    v_cvt_pk_bf16_f32 v142, v176, v177
    v_cvt_pk_bf16_f32 v143, v178, v179
    s_add_u32 s24, s51, 0
    buffer_store_dwordx4 v[140:143], v242, s[8:11], s24 offen sc1
    v_mfma_f32_16x16x32_bf16 v[204:207], a[32:35], v[20:23], v[204:207]
    v_mfma_f32_16x16x32_bf16 v[208:211], a[36:39], v[20:23], v[208:211]
    v_mfma_f32_16x16x32_bf16 v[212:215], a[40:43], v[20:23], v[212:215]
    v_mfma_f32_16x16x32_bf16 v[216:219], a[44:47], v[20:23], v[216:219]
    v_mfma_f32_16x16x32_bf16 v[220:223], a[48:51], v[20:23], v[220:223]
    v_mfma_f32_16x16x32_bf16 v[224:227], a[52:55], v[20:23], v[224:227]
    v_mfma_f32_16x16x32_bf16 v[228:231], a[56:59], v[20:23], v[228:231]
    v_mfma_f32_16x16x32_bf16 v[232:235], a[60:63], v[20:23], v[232:235]
    v_cvt_pk_bf16_f32 v144, v180, v181
    v_cvt_pk_bf16_f32 v145, v182, v183
    v_cvt_pk_bf16_f32 v146, v184, v185
    v_cvt_pk_bf16_f32 v147, v186, v187
    buffer_store_dwordx4 v[144:147], v242, s[8:11], s24 offen offset:64 sc1
    v_mfma_f32_16x16x32_bf16 v[204:207], a[64:67], v[24:27], v[204:207]
    v_mfma_f32_16x16x32_bf16 v[208:211], a[68:71], v[24:27], v[208:211]
    v_mfma_f32_16x16x32_bf16 v[212:215], a[72:75], v[24:27], v[212:215]
    v_mfma_f32_16x16x32_bf16 v[216:219], a[76:79], v[24:27], v[216:219]
    v_mfma_f32_16x16x32_bf16 v[220:223], a[80:83], v[24:27], v[220:223]
    v_mfma_f32_16x16x32_bf16 v[224:227], a[84:87], v[24:27], v[224:227]
    v_mfma_f32_16x16x32_bf16 v[228:231], a[88:91], v[24:27], v[228:231]
    v_mfma_f32_16x16x32_bf16 v[232:235], a[92:95], v[24:27], v[232:235]
    v_cvt_pk_bf16_f32 v148, v188, v189
    v_cvt_pk_bf16_f32 v149, v190, v191
    v_cvt_pk_bf16_f32 v150, v192, v193
    v_cvt_pk_bf16_f32 v151, v194, v195
    buffer_store_dwordx4 v[148:151], v242, s[8:11], s24 offen offset:128 sc1
    v_mfma_f32_16x16x32_bf16 v[204:207], a[96:99], v[28:31], v[204:207]
    v_mfma_f32_16x16x32_bf16 v[208:211], a[100:103], v[28:31], v[208:211]
    v_mfma_f32_16x16x32_bf16 v[212:215], a[104:107], v[28:31], v[212:215]
    v_mfma_f32_16x16x32_bf16 v[216:219], a[108:111], v[28:31], v[216:219]
    v_mfma_f32_16x16x32_bf16 v[220:223], a[112:115], v[28:31], v[220:223]
    v_mfma_f32_16x16x32_bf16 v[224:227], a[116:119], v[28:31], v[224:227]
    v_mfma_f32_16x16x32_bf16 v[228:231], a[120:123], v[28:31], v[228:231]
    v_mfma_f32_16x16x32_bf16 v[232:235], a[124:127], v[28:31], v[232:235]
    v_cvt_pk_bf16_f32 v152, v196, v197
    v_cvt_pk_bf16_f32 v153, v198, v199
    v_cvt_pk_bf16_f32 v154, v200, v201
    v_cvt_pk_bf16_f32 v155, v202, v203
    buffer_store_dwordx4 v[152:155], v242, s[8:11], s24 offen offset:192 sc1
    v_mfma_f32_16x16x32_bf16 v[204:207], a[128:131], v[48:51], v[204:207]
    v_mfma_f32_16x16x32_bf16 v[208:211], a[132:135], v[48:51], v[208:211]
    v_mfma_f32_16x16x32_bf16 v[212:215], a[136:139], v[48:51], v[212:215]
    v_mfma_f32_16x16x32_bf16 v[216:219], a[140:143], v[48:51], v[216:219]
    v_mfma_f32_16x16x32_bf16 v[220:223], a[144:147], v[48:51], v[220:223]
    v_mfma_f32_16x16x32_bf16 v[224:227], a[148:151], v[48:51], v[224:227]
    v_mfma_f32_16x16x32_bf16 v[228:231], a[152:155], v[48:51], v[228:231]
    v_mfma_f32_16x16x32_bf16 v[232:235], a[156:159], v[48:51], v[232:235]
    v_mfma_f32_16x16x32_bf16 v[204:207], a[160:163], v[52:55], v[204:207]
    v_mfma_f32_16x16x32_bf16 v[208:211], a[164:167], v[52:55], v[208:211]
    v_mfma_f32_16x16x32_bf16 v[212:215], a[168:171], v[52:55], v[212:215]
    v_mfma_f32_16x16x32_bf16 v[216:219], a[172:175], v[52:55], v[216:219]
    v_mfma_f32_16x16x32_bf16 v[220:223], a[176:179], v[52:55], v[220:223]
    v_mfma_f32_16x16x32_bf16 v[224:227], a[180:183], v[52:55], v[224:227]
    v_mfma_f32_16x16x32_bf16 v[228:231], a[184:187], v[52:55], v[228:231]
    v_mfma_f32_16x16x32_bf16 v[232:235], a[188:191], v[52:55], v[232:235]
    v_mfma_f32_16x16x32_bf16 v[204:207], a[192:195], v[56:59], v[204:207]
    v_mfma_f32_16x16x32_bf16 v[208:211], a[196:199], v[56:59], v[208:211]
    v_mfma_f32_16x16x32_bf16 v[212:215], a[200:203], v[56:59], v[212:215]
    v_mfma_f32_16x16x32_bf16 v[216:219], a[204:207], v[56:59], v[216:219]
    v_mfma_f32_16x16x32_bf16 v[220:223], a[208:211], v[56:59], v[220:223]
    v_mfma_f32_16x16x32_bf16 v[224:227], a[212:215], v[56:59], v[224:227]
    v_mfma_f32_16x16x32_bf16 v[228:231], a[216:219], v[56:59], v[228:231]
    v_mfma_f32_16x16x32_bf16 v[232:235], a[220:223], v[56:59], v[232:235]
    v_mfma_f32_16x16x32_bf16 v[204:207], a[224:227], v[60:63], v[204:207]
    v_mfma_f32_16x16x32_bf16 v[208:211], a[228:231], v[60:63], v[208:211]
    v_mfma_f32_16x16x32_bf16 v[212:215], a[232:235], v[60:63], v[212:215]
    v_mfma_f32_16x16x32_bf16 v[216:219], a[236:239], v[60:63], v[216:219]
    v_mfma_f32_16x16x32_bf16 v[220:223], a[240:243], v[60:63], v[220:223]
    v_mfma_f32_16x16x32_bf16 v[224:227], a[244:247], v[60:63], v[224:227]
    v_mfma_f32_16x16x32_bf16 v[228:231], a[248:251], v[60:63], v[228:231]
    v_mfma_f32_16x16x32_bf16 v[232:235], a[252:255], v[60:63], v[232:235]
    v_cvt_pk_bf16_f32 v140, v204, v205
    v_cvt_pk_bf16_f32 v141, v206, v207
    v_cvt_pk_bf16_f32 v142, v208, v209
    v_cvt_pk_bf16_f32 v143, v210, v211
    s_add_u32 s24, s51, 16384
    buffer_store_dwordx4 v[140:143], v242, s[8:11], s24 offen sc1
    v_cvt_pk_bf16_f32 v144, v212, v213
    v_cvt_pk_bf16_f32 v145, v214, v215
    v_cvt_pk_bf16_f32 v146, v216, v217
    v_cvt_pk_bf16_f32 v147, v218, v219
    buffer_store_dwordx4 v[144:147], v242, s[8:11], s24 offen offset:64 sc1
    v_cvt_pk_bf16_f32 v148, v220, v221
    v_cvt_pk_bf16_f32 v149, v222, v223
    v_cvt_pk_bf16_f32 v150, v224, v225
    v_cvt_pk_bf16_f32 v151, v226, v227
    buffer_store_dwordx4 v[148:151], v242, s[8:11], s24 offen offset:128 sc1
    v_cvt_pk_bf16_f32 v152, v228, v229
    v_cvt_pk_bf16_f32 v153, v230, v231
    v_cvt_pk_bf16_f32 v154, v232, v233
    v_cvt_pk_bf16_f32 v155, v234, v235
    buffer_store_dwordx4 v[152:155], v242, s[8:11], s24 offen offset:192 sc1
    s_waitcnt vmcnt(0)
    s_barrier
    s_lshl_b32 s25, s22, 6
    s_add_u32 s25, s25, 0x4000
    s_lshl_b32 s24, s20, 2
    s_add_u32 s24, s24, s25
    s_cmp_lg_u32 s100, 0
    s_cbranch_scc1 L_flag_118
    v_mov_b32 v246, 1
    s_mov_b64 exec, 1
    buffer_store_dword v246, off, s[8:11], s24 sc1
    s_mov_b64 exec, -1
L_flag_118:
    v_lshrrev_b32 v246, 2, v240
    s_cmp_lg_u32 s100, 0
    s_cbranch_scc1 L_polls_121
    s_mov_b32 exec_lo, 0xffff
    s_mov_b32 exec_hi, 0
    s_mov_b32 s96, 0
L_poll_119:
    buffer_load_dword v247, v246, s[8:11], s25 offen sc1
    s_waitcnt vmcnt(0)
    v_cmp_gt_u32 vcc, 1, v247
    s_cbranch_vccz L_polld_120
    s_sleep 2
    s_add_u32 s96, s96, 1
    s_cmp_lt_u32 s96, 0x10000
    s_cbranch_scc1 L_poll_119
L_polld_120:
    s_mov_b64 exec, -1
L_polls_121:
    s_barrier
    s_cmp_ge_u32 s100, 2
    s_cbranch_scc1 L_nofin_122
    s_lshl_b32 s60, s22, 5
    s_lshl_b32 s24, s20, 1
    s_add_u32 s60, s60, s24
    s_add_u32 s60, s60, s100
    s_lshr_b32 s62, s60, 5
    s_lshl_b32 s62, s62, 19
    s_and_b32 s63, s60, 31
    s_lshl_b32 s63, s63, 10
    s_add_u32 s62, s62, s63
    s_add_u32 s62, s62, 0x4000000
    s_lshl_b32 s64, s60, 10
    buffer_load_dwordx2 v[64:65], v252, s[12:15], s64 offen
    buffer_load_dwordx2 v[66:67], v252, s[12:15], s64 offen offset:32
    buffer_load_dwordx4 v[0:3], v240, s[8:11], s62 offen
    s_add_u32 s62, s62, 32768
    buffer_load_dwordx4 v[4:7], v240, s[8:11], s62 offen
    s_add_u32 s62, s62, 32768
    buffer_load_dwordx4 v[8:11], v240, s[8:11], s62 offen
    s_add_u32 s62, s62, 32768
    buffer_load_dwordx4 v[12:15], v240, s[8:11], s62 offen
    s_add_u32 s62, s62, 32768
    buffer_load_dwordx4 v[16:19], v240, s[8:11], s62 offen
    s_add_u32 s62, s62, 32768
    buffer_load_dwordx4 v[20:23], v240, s[8:11], s62 offen
    s_add_u32 s62, s62, 32768
    buffer_load_dwordx4 v[24:27], v240, s[8:11], s62 offen
    s_add_u32 s62, s62, 32768
    buffer_load_dwordx4 v[28:31], v240, s[8:11], s62 offen
    s_add_u32 s62, s62, 32768
    buffer_load_dwordx4 v[32:35], v240, s[8:11], s62 offen
    s_add_u32 s62, s62, 32768
    buffer_load_dwordx4 v[36:39], v240, s[8:11], s62 offen
    s_add_u32 s62, s62, 32768
    buffer_load_dwordx4 v[40:43], v240, s[8:11], s62 offen
    s_add_u32 s62, s62, 32768
    buffer_load_dwordx4 v[44:47], v240, s[8:11], s62 offen
    s_add_u32 s62, s62, 32768
    buffer_load_dwordx4 v[48:51], v240, s[8:11], s62 offen
    s_add_u32 s62, s62, 32768
    buffer_load_dwordx4 v[52:55], v240, s[8:11], s62 offen
    s_add_u32 s62, s62, 32768
    buffer_load_dwordx4 v[56:59], v240, s[8:11], s62 offen
    s_add_u32 s62, s62, 32768
    buffer_load_dwordx4 v[60:63], v240, s[8:11], s62 offen
    v_mov_b32 v68, 0
    v_mov_b32 v69, 0
    v_mov_b32 v70, 0
    v_mov_b32 v71, 0
    v_mov_b32 v72, 0
    v_mov_b32 v73, 0
    v_mov_b32 v74, 0
    v_mov_b32 v75, 0
    s_waitcnt vmcnt(15)
    v_dot2_f32_bf16 v68, v0, s65, v68
    v_dot2_f32_bf16 v69, v0, s66, v69
    v_dot2_f32_bf16 v70, v1, s65, v70
    v_dot2_f32_bf16 v71, v1, s66, v71
    v_dot2_f32_bf16 v72, v2, s65, v72
    v_dot2_f32_bf16 v73, v2, s66, v73
    v_dot2_f32_bf16 v74, v3, s65, v74
    v_dot2_f32_bf16 v75, v3, s66, v75
    s_waitcnt vmcnt(14)
    v_dot2_f32_bf16 v68, v4, s65, v68
    v_dot2_f32_bf16 v69, v4, s66, v69
    v_dot2_f32_bf16 v70, v5, s65, v70
    v_dot2_f32_bf16 v71, v5, s66, v71
    v_dot2_f32_bf16 v72, v6, s65, v72
    v_dot2_f32_bf16 v73, v6, s66, v73
    v_dot2_f32_bf16 v74, v7, s65, v74
    v_dot2_f32_bf16 v75, v7, s66, v75
    s_waitcnt vmcnt(13)
    v_dot2_f32_bf16 v68, v8, s65, v68
    v_dot2_f32_bf16 v69, v8, s66, v69
    v_dot2_f32_bf16 v70, v9, s65, v70
    v_dot2_f32_bf16 v71, v9, s66, v71
    v_dot2_f32_bf16 v72, v10, s65, v72
    v_dot2_f32_bf16 v73, v10, s66, v73
    v_dot2_f32_bf16 v74, v11, s65, v74
    v_dot2_f32_bf16 v75, v11, s66, v75
    s_waitcnt vmcnt(12)
    v_dot2_f32_bf16 v68, v12, s65, v68
    v_dot2_f32_bf16 v69, v12, s66, v69
    v_dot2_f32_bf16 v70, v13, s65, v70
    v_dot2_f32_bf16 v71, v13, s66, v71
    v_dot2_f32_bf16 v72, v14, s65, v72
    v_dot2_f32_bf16 v73, v14, s66, v73
    v_dot2_f32_bf16 v74, v15, s65, v74
    v_dot2_f32_bf16 v75, v15, s66, v75
    s_waitcnt vmcnt(11)
    v_dot2_f32_bf16 v68, v16, s65, v68
    v_dot2_f32_bf16 v69, v16, s66, v69
    v_dot2_f32_bf16 v70, v17, s65, v70
    v_dot2_f32_bf16 v71, v17, s66, v71
    v_dot2_f32_bf16 v72, v18, s65, v72
    v_dot2_f32_bf16 v73, v18, s66, v73
    v_dot2_f32_bf16 v74, v19, s65, v74
    v_dot2_f32_bf16 v75, v19, s66, v75
    s_waitcnt vmcnt(10)
    v_dot2_f32_bf16 v68, v20, s65, v68
    v_dot2_f32_bf16 v69, v20, s66, v69
    v_dot2_f32_bf16 v70, v21, s65, v70
    v_dot2_f32_bf16 v71, v21, s66, v71
    v_dot2_f32_bf16 v72, v22, s65, v72
    v_dot2_f32_bf16 v73, v22, s66, v73
    v_dot2_f32_bf16 v74, v23, s65, v74
    v_dot2_f32_bf16 v75, v23, s66, v75
    s_waitcnt vmcnt(9)
    v_dot2_f32_bf16 v68, v24, s65, v68
    v_dot2_f32_bf16 v69, v24, s66, v69
    v_dot2_f32_bf16 v70, v25, s65, v70
    v_dot2_f32_bf16 v71, v25, s66, v71
    v_dot2_f32_bf16 v72, v26, s65, v72
    v_dot2_f32_bf16 v73, v26, s66, v73
    v_dot2_f32_bf16 v74, v27, s65, v74
    v_dot2_f32_bf16 v75, v27, s66, v75
    s_waitcnt vmcnt(8)
    v_dot2_f32_bf16 v68, v28, s65, v68
    v_dot2_f32_bf16 v69, v28, s66, v69
    v_dot2_f32_bf16 v70, v29, s65, v70
    v_dot2_f32_bf16 v71, v29, s66, v71
    v_dot2_f32_bf16 v72, v30, s65, v72
    v_dot2_f32_bf16 v73, v30, s66, v73
    v_dot2_f32_bf16 v74, v31, s65, v74
    v_dot2_f32_bf16 v75, v31, s66, v75
    s_waitcnt vmcnt(7)
    v_dot2_f32_bf16 v68, v32, s65, v68
    v_dot2_f32_bf16 v69, v32, s66, v69
    v_dot2_f32_bf16 v70, v33, s65, v70
    v_dot2_f32_bf16 v71, v33, s66, v71
    v_dot2_f32_bf16 v72, v34, s65, v72
    v_dot2_f32_bf16 v73, v34, s66, v73
    v_dot2_f32_bf16 v74, v35, s65, v74
    v_dot2_f32_bf16 v75, v35, s66, v75
    s_waitcnt vmcnt(6)
    v_dot2_f32_bf16 v68, v36, s65, v68
    v_dot2_f32_bf16 v69, v36, s66, v69
    v_dot2_f32_bf16 v70, v37, s65, v70
    v_dot2_f32_bf16 v71, v37, s66, v71
    v_dot2_f32_bf16 v72, v38, s65, v72
    v_dot2_f32_bf16 v73, v38, s66, v73
    v_dot2_f32_bf16 v74, v39, s65, v74
    v_dot2_f32_bf16 v75, v39, s66, v75
    s_waitcnt vmcnt(5)
    v_dot2_f32_bf16 v68, v40, s65, v68
    v_dot2_f32_bf16 v69, v40, s66, v69
    v_dot2_f32_bf16 v70, v41, s65, v70
    v_dot2_f32_bf16 v71, v41, s66, v71
    v_dot2_f32_bf16 v72, v42, s65, v72
    v_dot2_f32_bf16 v73, v42, s66, v73
    v_dot2_f32_bf16 v74, v43, s65, v74
    v_dot2_f32_bf16 v75, v43, s66, v75
    s_waitcnt vmcnt(4)
    v_dot2_f32_bf16 v68, v44, s65, v68
    v_dot2_f32_bf16 v69, v44, s66, v69
    v_dot2_f32_bf16 v70, v45, s65, v70
    v_dot2_f32_bf16 v71, v45, s66, v71
    v_dot2_f32_bf16 v72, v46, s65, v72
    v_dot2_f32_bf16 v73, v46, s66, v73
    v_dot2_f32_bf16 v74, v47, s65, v74
    v_dot2_f32_bf16 v75, v47, s66, v75
    s_waitcnt vmcnt(3)
    v_dot2_f32_bf16 v68, v48, s65, v68
    v_dot2_f32_bf16 v69, v48, s66, v69
    v_dot2_f32_bf16 v70, v49, s65, v70
    v_dot2_f32_bf16 v71, v49, s66, v71
    v_dot2_f32_bf16 v72, v50, s65, v72
    v_dot2_f32_bf16 v73, v50, s66, v73
    v_dot2_f32_bf16 v74, v51, s65, v74
    v_dot2_f32_bf16 v75, v51, s66, v75
    s_waitcnt vmcnt(2)
    v_dot2_f32_bf16 v68, v52, s65, v68
    v_dot2_f32_bf16 v69, v52, s66, v69
    v_dot2_f32_bf16 v70, v53, s65, v70
    v_dot2_f32_bf16 v71, v53, s66, v71
    v_dot2_f32_bf16 v72, v54, s65, v72
    v_dot2_f32_bf16 v73, v54, s66, v73
    v_dot2_f32_bf16 v74, v55, s65, v74
    v_dot2_f32_bf16 v75, v55, s66, v75
    s_waitcnt vmcnt(1)
    v_dot2_f32_bf16 v68, v56, s65, v68
    v_dot2_f32_bf16 v69, v56, s66, v69
    v_dot2_f32_bf16 v70, v57, s65, v70
    v_dot2_f32_bf16 v71, v57, s66, v71
    v_dot2_f32_bf16 v72, v58, s65, v72
    v_dot2_f32_bf16 v73, v58, s66, v73
    v_dot2_f32_bf16 v74, v59, s65, v74
    v_dot2_f32_bf16 v75, v59, s66, v75
    s_waitcnt vmcnt(0)
    v_dot2_f32_bf16 v68, v60, s65, v68
    v_dot2_f32_bf16 v69, v60, s66, v69
    v_dot2_f32_bf16 v70, v61, s65, v70
    v_dot2_f32_bf16 v71, v61, s66, v71
    v_dot2_f32_bf16 v72, v62, s65, v72
    v_dot2_f32_bf16 v73, v62, s66, v73
    v_dot2_f32_bf16 v74, v63, s65, v74
    v_dot2_f32_bf16 v75, v63, s66, v75
    v_cvt_pk_bf16_f32 v0, v68, v69
    v_cvt_pk_bf16_f32 v1, v70, v71
    v_cvt_pk_bf16_f32 v2, v72, v73
    v_cvt_pk_bf16_f32 v3, v74, v75
    v_lshlrev_b32 v68, 16, v0
    v_and_b32 v69, 0xffff0000, v0
    v_lshlrev_b32 v76, 16, v64
    v_and_b32 v77, 0xffff0000, v64
    v_lshlrev_b32 v70, 16, v1
    v_and_b32 v71, 0xffff0000, v1
    v_lshlrev_b32 v78, 16, v65
    v_and_b32 v79, 0xffff0000, v65
    v_lshlrev_b32 v72, 16, v2
    v_and_b32 v73, 0xffff0000, v2
    v_lshlrev_b32 v80, 16, v66
    v_and_b32 v81, 0xffff0000, v66
    v_lshlrev_b32 v74, 16, v3
    v_and_b32 v75, 0xffff0000, v3
    v_lshlrev_b32 v82, 16, v67
    v_and_b32 v83, 0xffff0000, v67
    v_pk_add_f32 v[68:69], v[68:69], v[76:77]
    v_pk_add_f32 v[70:71], v[70:71], v[78:79]
    v_pk_add_f32 v[72:73], v[72:73], v[80:81]
    v_pk_add_f32 v[74:75], v[74:75], v[82:83]
    v_cvt_pk_bf16_f32 v4, v68, v69
    v_cvt_pk_bf16_f32 v5, v70, v71
    v_cvt_pk_bf16_f32 v6, v72, v73
    v_cvt_pk_bf16_f32 v7, v74, v75
    v_lshlrev_b32 v68, 16, v4
    v_and_b32 v69, 0xffff0000, v4
    v_lshlrev_b32 v70, 16, v5
    v_and_b32 v71, 0xffff0000, v5
    v_lshlrev_b32 v72, 16, v6
    v_and_b32 v73, 0xffff0000, v6
    v_lshlrev_b32 v74, 16, v7
    v_and_b32 v75, 0xffff0000, v7
    s_add_u32 s62, s64, 0x6000000
    buffer_store_dwordx2 v[4:5], v252, s[8:11], s62 offen sc1
    buffer_store_dwordx2 v[6:7], v252, s[8:11], s62 offen offset:32 sc1
    v_add_f32 v84, v68, v69
    v_add_f32 v84, v84, v70
    v_add_f32 v84, v84, v71
    v_add_f32 v84, v84, v72
    v_add_f32 v84, v84, v73
    v_add_f32 v84, v84, v74
    v_add_f32 v84, v84, v75
    s_nop 1
    v_add_f32_dpp v84, v84, v84 row_ror:1 row_mask:0xf bank_mask:0xf
    s_nop 1
    v_add_f32_dpp v84, v84, v84 row_ror:2 row_mask:0xf bank_mask:0xf
    s_nop 1
    v_add_f32_dpp v84, v84, v84 row_ror:4 row_mask:0xf bank_mask:0xf
    s_nop 1
    v_add_f32_dpp v84, v84, v84 row_ror:8 row_mask:0xf bank_mask:0xf
    v_mov_b32 v85, v84
    s_nop 1
    v_permlane32_swap_b32 v85, v84
    v_add_f32 v84, v85, v84
    v_mov_b32 v85, v84
    s_nop 1
    v_permlane16_swap_b32 v85, v84
    v_add_f32 v84, v85, v84
    v_mul_f32 v84, 0x3b000000, v84
    v_cvt_pk_bf16_f32 v86, v84, v84
    v_and_b32 v86, 0xffff0000, v86
    v_sub_f32 v87, v84, v86
    v_sub_f32 v76, v68, v86
    v_sub_f32 v77, v69, v86
    v_sub_f32 v78, v70, v86
    v_sub_f32 v79, v71, v86
    v_sub_f32 v80, v72, v86
    v_sub_f32 v81, v73, v86
    v_sub_f32 v82, v74, v86
    v_sub_f32 v83, v75, v86
    v_mul_f32 v100, v76, v76
    v_fmac_f32 v100, v77, v77
    v_fmac_f32 v100, v78, v78
    v_fmac_f32 v100, v79, v79
    v_fmac_f32 v100, v80, v80
    v_fmac_f32 v100, v81, v81
    v_fmac_f32 v100, v82, v82
    v_fmac_f32 v100, v83, v83
    s_nop 1
    v_add_f32_dpp v100, v100, v100 row_ror:1 row_mask:0xf bank_mask:0xf
    s_nop 1
    v_add_f32_dpp v100, v100, v100 row_ror:2 row_mask:0xf bank_mask:0xf
    s_nop 1
    v_add_f32_dpp v100, v100, v100 row_ror:4 row_mask:0xf bank_mask:0xf
    s_nop 1
    v_add_f32_dpp v100, v100, v100 row_ror:8 row_mask:0xf bank_mask:0xf
    v_mov_b32 v85, v100
    s_nop 1
    v_permlane32_swap_b32 v85, v100
    v_add_f32 v100, v85, v100
    v_mov_b32 v85, v100
    s_nop 1
    v_permlane16_swap_b32 v85, v100
    v_add_f32 v100, v85, v100
    v_mul_f32 v85, v87, v87
    v_mul_f32 v100, 0x3b000000, v100
    v_sub_f32 v100, v100, v85
    v_max_f32 v100, 0, v100
    v_cvt_pk_bf16_f32 v100, v100, v100
    v_and_b32 v100, 0xffff0000, v100
    v_add_f32 v100, 0x3727c5ac, v100
    v_cvt_pk_bf16_f32 v100, v100, v100
    v_and_b32 v100, 0xffff0000, v100
    v_sqrt_f32 v100, v100
    s_nop 0
    v_cvt_pk_bf16_f32 v100, v100, v100
    v_and_b32 v100, 0xffff0000, v100
    v_rcp_f32 v100, v100
    v_cvt_pk_bf16_f32 v8, v76, v77
    v_cvt_pk_bf16_f32 v9, v78, v79
    v_cvt_pk_bf16_f32 v10, v80, v81
    v_cvt_pk_bf16_f32 v11, v82, v83
    v_lshlrev_b32 v76, 16, v8
    v_and_b32 v77, 0xffff0000, v8
    v_lshlrev_b32 v78, 16, v9
    v_and_b32 v79, 0xffff0000, v9
    v_lshlrev_b32 v80, 16, v10
    v_and_b32 v81, 0xffff0000, v10
    v_lshlrev_b32 v82, 16, v11
    v_and_b32 v83, 0xffff0000, v11
    v_mul_f32 v76, v100, v76
    v_mul_f32 v77, v100, v77
    v_mul_f32 v78, v100, v78
    v_mul_f32 v79, v100, v79
    v_mul_f32 v80, v100, v80
    v_mul_f32 v81, v100, v81
    v_mul_f32 v82, v100, v82
    v_mul_f32 v83, v100, v83
    v_cvt_pk_bf16_f32 v8, v76, v77
    v_cvt_pk_bf16_f32 v9, v78, v79
    v_cvt_pk_bf16_f32 v10, v80, v81
    v_cvt_pk_bf16_f32 v11, v82, v83
    v_lshlrev_b32 v76, 16, v8
    v_and_b32 v77, 0xffff0000, v8
    v_lshlrev_b32 v78, 16, v9
    v_and_b32 v79, 0xffff0000, v9
    v_lshlrev_b32 v80, 16, v10
    v_and_b32 v81, 0xffff0000, v10
    v_lshlrev_b32 v82, 16, v11
    v_and_b32 v83, 0xffff0000, v11
    s_add_u32 s62, s64, 0x6200000
    buffer_store_dwordx2 v[8:9], v252, s[8:11], s62 offen sc1
    buffer_store_dwordx2 v[10:11], v252, s[8:11], s62 offen offset:32 sc1
    v_pk_add_f32 v[68:69], v[68:69], v[76:77]
    v_pk_add_f32 v[70:71], v[70:71], v[78:79]
    v_pk_add_f32 v[72:73], v[72:73], v[80:81]
    v_pk_add_f32 v[74:75], v[74:75], v[82:83]
    v_cvt_pk_bf16_f32 v12, v68, v69
    v_cvt_pk_bf16_f32 v13, v70, v71
    v_cvt_pk_bf16_f32 v14, v72, v73
    v_cvt_pk_bf16_f32 v15, v74, v75
    buffer_store_dwordx2 v[12:13], v252, s[16:19], s64 offen sc1
    buffer_store_dwordx2 v[14:15], v252, s[16:19], s64 offen offset:32 sc1
    v_lshlrev_b32 v88, 16, v236
    v_and_b32 v89, 0xffff0000, v236
    v_lshlrev_b32 v90, 16, v237
    v_and_b32 v91, 0xffff0000, v237
    v_lshlrev_b32 v92, 16, v238
    v_and_b32 v93, 0xffff0000, v238
    v_lshlrev_b32 v94, 16, v239
    v_and_b32 v95, 0xffff0000, v239
    v_mul_f32 v84, v76, v88
    v_fmac_f32 v84, v77, v89
    v_fmac_f32 v84, v78, v90
    v_fmac_f32 v84, v79, v91
    v_fmac_f32 v84, v80, v92
    v_fmac_f32 v84, v81, v93
    v_fmac_f32 v84, v82, v94
    v_fmac_f32 v84, v83, v95
    s_nop 1
    v_add_f32_dpp v84, v84, v84 row_ror:1 row_mask:0xf bank_mask:0xf
    s_nop 1
    v_add_f32_dpp v84, v84, v84 row_ror:2 row_mask:0xf bank_mask:0xf
    s_nop 1
    v_add_f32_dpp v84, v84, v84 row_ror:4 row_mask:0xf bank_mask:0xf
    s_nop 1
    v_add_f32_dpp v84, v84, v84 row_ror:8 row_mask:0xf bank_mask:0xf
    v_mov_b32 v85, v84
    s_nop 1
    v_permlane32_swap_b32 v85, v84
    v_add_f32 v84, v85, v84
    v_mov_b32 v85, v84
    s_nop 1
    v_permlane16_swap_b32 v85, v84
    v_add_f32 v84, v85, v84
    v_cvt_pk_bf16_f32 v84, v84, v84
    v_and_b32 v84, 0xffff0000, v84
    v_ashrrev_i32 v85, 31, v84
    v_or_b32 v85, 0x80000000, v85
    v_xor_b32 v84, v84, v85
    v_and_b32 v84, 0xffff0000, v84
    s_sub_u32 s62, 0x87ff, s60
    v_or_b32 v84, s62, v84
    s_waitcnt vmcnt(0)
    s_lshl_b32 s62, s60, 2
    s_add_u32 s62, s62, 0x6000
    s_mov_b64 exec, 1
    buffer_store_dword v84, off, s[8:11], s62 sc1
    s_mov_b64 exec, -1
L_nofin_122:
    s_add_u32 s80, s80, 4
    s_add_u32 s22, s22, s23
    s_branch L_p2_seg
L_p2_end:
    s_cmp_ge_u32 s67, 56
    s_cbranch_scc1 L_exit
    s_mov_b32 s74, 0
    s_mov_b32 s75, 0
    v_mov_b32 v202, 0x7ffffff0
    v_mov_b32 v1, 0
    s_and_b32 s71, s101, 15
    s_lshl_b32 s71, s71, 7
    s_add_u32 s71, s71, 0x1000
    s_mov_b32 s72, 61
    s_cmp_lg_u32 s100, 0
    s_cbranch_scc1 L_polls_125
    s_mov_b32 exec_lo, 0x1
    s_mov_b32 exec_hi, 0
    s_mov_b32 s96, 0
L_poll_123:
    buffer_load_dword v2, v1, s[8:11], s71 offen sc1
    s_waitcnt vmcnt(0)
    v_cmp_gt_u32 vcc, s72, v2
    s_cbranch_vccz L_polld_124
    v_readfirstlane_b32 s97, v2
    s_nop 0
    s_sub_u32 s97, s72, s97
    s_cmp_lt_i32 s97, 3
    s_cbranch_scc1 L_near_126
    s_sleep 40
    s_cmp_lt_i32 s97, 5
    s_cbranch_scc1 L_near_126
    s_sleep 100
L_near_126:
    s_sleep 16
    s_add_u32 s96, s96, 1
    s_cmp_lt_u32 s96, 0x10000
    s_cbranch_scc1 L_poll_123
L_polld_124:
    s_mov_b64 exec, -1
L_polls_125:
    s_barrier
L_ffn_round:
    v_mbcnt_lo_u32_b32 v0, -1, 0
    v_mbcnt_hi_u32_b32 v0, -1, v0
    s_lshl_b32 s96, s100, 6
    v_add_u32 v0, s96, v0
    s_cmp_lg_u32 s75, 0
    s_cbranch_scc1 L_ffn_re
    v_lshlrev_b32 v30, 5, v0
    s_mov_b32 s69, 0x6000
    v_cmp_le_u32 vcc, 240, v0
    v_mov_b32 v29, s75
    v_add_u32 v29, -1, v29
    v_cndmask_b32 v19, 0, v29, vcc
    s_mov_b32 s70, 0
L_kpoll_127:
    buffer_load_dwordx4 v[20:23], v30, s[8:11], s69 offen sc1
    buffer_load_dwordx4 v[24:27], v30, s[8:11], s69 offen offset:16 sc1
    s_waitcnt vmcnt(0)
    v_min3_u32 v28, v20, v21, v22
    v_min3_u32 v28, v28, v23, v24
    v_min3_u32 v28, v28, v25, v26
    v_min_u32 v28, v28, v27
    v_or_b32 v28, v28, v19
    v_cmp_eq_u32 vcc, 0, v28
    s_cbranch_vccz L_kpolld_128
    s_sleep 6
    s_add_u32 s70, s70, 1
    s_cmp_lt_u32 s70, 0x10000
    s_cbranch_scc1 L_kpoll_127
L_kpolld_128:
    v_bfi_b32 v20, v19, 0, v20
    v_bfi_b32 v21, v19, 0, v21
    v_bfi_b32 v22, v19, 0, v22
    v_bfi_b32 v23, v19, 0, v23
    v_bfi_b32 v24, v19, 0, v24
    v_bfi_b32 v25, v19, 0, v25
    v_bfi_b32 v26, v19, 0, v26
    v_bfi_b32 v27, v19, 0, v27
    v_lshrrev_b32 v30, 6, v0
    v_lshlrev_b32 v30, 2, v30
    v_add_u32 v30, 0x20400, v30
    v_mov_b32 v31, 0x20400
    s_waitcnt vmcnt(0)
    v_max3_u32 v28, v20, v21, v22
    v_max3_u32 v28, v28, v23, v24
    v_max3_u32 v28, v28, v25, v26
    v_max_u32 v28, v28, v27
    s_nop 1
    v_max_u32_dpp v28, v28, v28 row_ror:1 row_mask:0xf bank_mask:0xf
    s_nop 1
    v_max_u32_dpp v28, v28, v28 row_ror:2 row_mask:0xf bank_mask:0xf
    s_nop 1
    v_max_u32_dpp v28, v28, v28 row_ror:4 row_mask:0xf bank_mask:0xf
    s_nop 1
    v_max_u32_dpp v28, v28, v28 row_ror:8 row_mask:0xf bank_mask:0xf
    v_mov_b32 v29, v28
    s_nop 1
    v_permlane32_swap_b32 v29, v28
    v_max_u32 v28, v29, v28
    v_mov_b32 v29, v28
    s_nop 1
    v_permlane16_swap_b32 v29, v28
    v_max_u32 v28, v29, v28
    ds_write_b32 v30, v28
    s_waitcnt lgkmcnt(0)
    s_barrier
    ds_read_b128 v[16:19], v31
    s_waitcnt lgkmcnt(0)
    v_max3_u32 v28, v16, v17, v18
    v_max_u32 v28, v28, v19
    s_nop 0
    v_readfirstlane_b32 s69, v28
    s_nop 1
    v_cmp_ne_u32 vcc, s69, v20
    s_nop 1
    v_cndmask_b32 v20, 0, v20, vcc
    v_cmp_ne_u32 vcc, s69, v21
    s_nop 1
    v_cndmask_b32 v21, 0, v21, vcc
    v_cmp_ne_u32 vcc, s69, v22
    s_nop 1
    v_cndmask_b32 v22, 0, v22, vcc
    v_cmp_ne_u32 vcc, s69, v23
    s_nop 1
    v_cndmask_b32 v23, 0, v23, vcc
    v_cmp_ne_u32 vcc, s69, v24
    s_nop 1
    v_cndmask_b32 v24, 0, v24, vcc
    v_cmp_ne_u32 vcc, s69, v25
    s_nop 1
    v_cndmask_b32 v25, 0, v25, vcc
    v_cmp_ne_u32 vcc, s69, v26
    s_nop 1
    v_cndmask_b32 v26, 0, v26, vcc
    v_cmp_ne_u32 vcc, s69, v27
    s_nop 1
    v_cndmask_b32 v27, 0, v27, vcc
    v_max3_u32 v28, v20, v21, v22
    v_max3_u32 v28, v28, v23, v24
    v_max3_u32 v28, v28, v25, v26
    v_max_u32 v28, v28, v27
    s_nop 1
    v_max_u32_dpp v28, v28, v28 row_ror:1 row_mask:0xf bank_mask:0xf
    s_nop 1
    v_max_u32_dpp v28, v28, v28 row_ror:2 row_mask:0xf bank_mask:0xf
    s_nop 1
    v_max_u32_dpp v28, v28, v28 row_ror:4 row_mask:0xf bank_mask:0xf
    s_nop 1
    v_max_u32_dpp v28, v28, v28 row_ror:8 row_mask:0xf bank_mask:0xf
    v_mov_b32 v29, v28
    s_nop 1
    v_permlane32_swap_b32 v29, v28
    v_max_u32 v28, v29, v28
    v_mov_b32 v29, v28
    s_nop 1
    v_permlane16_swap_b32 v29, v28
    v_max_u32 v28, v29, v28
    ds_write_b32 v30, v28 offset:16
    s_waitcnt lgkmcnt(0)
    s_barrier
    ds_read_b128 v[16:19], v31 offset:16
    s_waitcnt lgkmcnt(0)
    v_max3_u32 v28, v16, v17, v18
    v_max_u32 v28, v28, v19
    s_nop 0
    v_readfirstlane_b32 s70, v28
    s_barrier
    s_branch L_ffn_sel
L_ffn_re:
    v_and_b32 v24, 63, v0
    v_lshlrev_b32 v24, 3, v24
    s_mov_b32 s71, 0x7e00
    s_mov_b32 s72, 0
L_rsel_129:
    buffer_load_dwordx2 v[20:21], v24, s[8:11], s71 offen sc1
    s_waitcnt vmcnt(0)
    v_min_u32 v22, v20, v21
    v_cmp_eq_u32 vcc, 0, v22
    s_cbranch_vccz L_rseld_130
    s_sleep 3
    s_add_u32 s72, s72, 1
    s_cmp_lt_u32 s72, 0x10000
    s_cbranch_scc1 L_rsel_129
L_rseld_130:
    v_max_u32 v22, v20, v21
    v_cmp_lt_u32 vcc, s70, v22
    s_cbranch_vccz L_rsele_131
    v_max_u32_dpp v22, v22, v22 row_ror:1 row_mask:0xf bank_mask:0xf
    s_nop 1
    v_max_u32_dpp v22, v22, v22 row_ror:2 row_mask:0xf bank_mask:0xf
    s_nop 1
    v_max_u32_dpp v22, v22, v22 row_ror:4 row_mask:0xf bank_mask:0xf
    s_nop 1
    v_max_u32_dpp v22, v22, v22 row_ror:8 row_mask:0xf bank_mask:0xf
    v_mov_b32 v23, v22
    s_nop 1
    v_permlane32_swap_b32 v23, v22
    v_max_u32 v22, v23, v22
    v_mov_b32 v23, v22
    s_nop 1
    v_permlane16_swap_b32 v23, v22
    v_max_u32 v22, v23, v22
    s_nop 0
    v_readfirstlane_b32 s71, v22
    s_nop 1
    v_cmp_ne_u32 vcc, s71, v20
    s_nop 1
    v_cndmask_b32 v20, 0, v20, vcc
    v_cmp_ne_u32 vcc, s71, v21
    s_nop 1
    v_cndmask_b32 v21, 0, v21, vcc
    v_max_u32 v22, v20, v21
    s_nop 1
    v_max_u32_dpp v22, v22, v22 row_ror:1 row_mask:0xf bank_mask:0xf
    s_nop 1
    v_max_u32_dpp v22, v22, v22 row_ror:2 row_mask:0xf bank_mask:0xf
    s_nop 1
    v_max_u32_dpp v22, v22, v22 row_ror:4 row_mask:0xf bank_mask:0xf
    s_nop 1
    v_max_u32_dpp v22, v22, v22 row_ror:8 row_mask:0xf bank_mask:0xf
    v_mov_b32 v23, v22
    s_nop 1
    v_permlane32_swap_b32 v23, v22
    v_max_u32 v22, v23, v22
    v_mov_b32 v23, v22
    s_nop 1
    v_permlane16_swap_b32 v23, v22
    v_max_u32 v22, v23, v22
    s_nop 0
    v_readfirstlane_b32 s72, v22
    s_nop 0
    s_max_u32 s70, s70, s72
    s_min_u32 s72, s71, s69
    s_max_u32 s70, s70, s72
    s_max_u32 s69, s69, s71
L_rsele_131:
L_ffn_sel:
    s_and_b32 s71, s69, 2047
    s_lshl_b32 s71, s71, 11
    s_and_b32 s72, s70, 2047
    s_or_b32 s71, s71, s72
    s_add_u32 s71, s71, 1
    s_cmp_eq_u32 s71, s74
    s_cbranch_scc1 L_ffn_same
    s_mov_b32 s74, s71
    v_and_b32 v1, 63, v0
    v_lshrrev_b32 v2, 4, v1
    v_and_b32 v3, 15, v1
    v_lshrrev_b32 v6, 2, v3
    s_and_b32 s71, s69, 2047
    s_sub_u32 s71, 2047, s71
    s_and_b32 s72, s70, 2047
    s_sub_u32 s72, 2047, s72
    v_and_b32 v4, 1, v3
    v_cmp_eq_u32 vcc, 0, v4
    v_mov_b32 v4, s71
    v_mov_b32 v5, s72
    v_cndmask_b32 v4, v5, v4, vcc
    v_lshlrev_b32 v4, 10, v4
    v_lshl_add_u32 v4, v2, 4, v4
    s_mov_b32 s71, 0x6200000
    buffer_load_dwordx4 v[32:35], v4, s[8:11], s71 offen
    buffer_load_dwordx4 v[36:39], v4, s[8:11], s71 offen offset:64
    buffer_load_dwordx4 v[40:43], v4, s[8:11], s71 offen offset:128
    buffer_load_dwordx4 v[44:47], v4, s[8:11], s71 offen offset:192
    buffer_load_dwordx4 v[48:51], v4, s[8:11], s71 offen offset:256
    buffer_load_dwordx4 v[52:55], v4, s[8:11], s71 offen offset:320
    buffer_load_dwordx4 v[56:59], v4, s[8:11], s71 offen offset:384
    buffer_load_dwordx4 v[60:63], v4, s[8:11], s71 offen offset:448
    buffer_load_dwordx4 v[64:67], v4, s[8:11], s71 offen offset:512
    buffer_load_dwordx4 v[68:71], v4, s[8:11], s71 offen offset:576
    buffer_load_dwordx4 v[72:75], v4, s[8:11], s71 offen offset:640
    buffer_load_dwordx4 v[76:79], v4, s[8:11], s71 offen offset:704
    buffer_load_dwordx4 v[80:83], v4, s[8:11], s71 offen offset:768
    buffer_load_dwordx4 v[84:87], v4, s[8:11], s71 offen offset:832
    buffer_load_dwordx4 v[88:91], v4, s[8:11], s71 offen offset:896
    buffer_load_dwordx4 v[92:95], v4, s[8:11], s71 offen offset:960
    v_lshl_add_u32 v4, v2, 3, v6
    v_lshlrev_b32 v4, 6, v4
    v_and_b32 v5, 3, v3
    v_lshl_add_u32 v4, v5, 3, v4
    s_lshr_b32 s71, s68, 1
    s_lshl_b32 s71, s71, 15
    s_and_b32 s72, s68, 1
    s_lshl_b32 s72, s72, 5
    s_add_u32 s71, s71, s72
    s_add_u32 s71, s71, 0x8000
    v_add_u32 v7, s71, v4
    ds_read_b64_tr_b16 v[96:97], v7
    ds_read_b64_tr_b16 v[98:99], v7 offset:256
    ds_read_b64_tr_b16 v[100:101], v7 offset:2048
    ds_read_b64_tr_b16 v[102:103], v7 offset:2304
    ds_read_b64_tr_b16 v[104:105], v7 offset:4096
    ds_read_b64_tr_b16 v[106:107], v7 offset:4352
    ds_read_b64_tr_b16 v[108:109], v7 offset:6144
    ds_read_b64_tr_b16 v[110:111], v7 offset:6400
    s_waitcnt lgkmcnt(0)
    ds_read_b64_tr_b16 v[112:113], v7 offset:8192
    ds_read_b64_tr_b16 v[114:115], v7 offset:8448
    ds_read_b64_tr_b16 v[116:117], v7 offset:10240
    ds_read_b64_tr_b16 v[118:119], v7 offset:10496
    ds_read_b64_tr_b16 v[120:121], v7 offset:12288
    ds_read_b64_tr_b16 v[122:123], v7 offset:12544
    ds_read_b64_tr_b16 v[124:125], v7 offset:14336
    ds_read_b64_tr_b16 v[126:127], v7 offset:14592
    s_waitcnt lgkmcnt(0)
    ds_read_b64_tr_b16 v[128:129], v7 offset:16384
    ds_read_b64_tr_b16 v[130:131], v7 offset:16640
    ds_read_b64_tr_b16 v[132:133], v7 offset:18432
    ds_read_b64_tr_b16 v[134:135], v7 offset:18688
    ds_read_b64_tr_b16 v[136:137], v7 offset:20480
    ds_read_b64_tr_b16 v[138:139], v7 offset:20736
    ds_read_b64_tr_b16 v[140:141], v7 offset:22528
    ds_read_b64_tr_b16 v[142:143], v7 offset:22784
    s_waitcnt lgkmcnt(0)
    ds_read_b64_tr_b16 v[144:145], v7 offset:24576
    ds_read_b64_tr_b16 v[146:147], v7 offset:24832
    ds_read_b64_tr_b16 v[148:149], v7 offset:26624
    ds_read_b64_tr_b16 v[150:151], v7 offset:26880
    ds_read_b64_tr_b16 v[152:153], v7 offset:28672
    ds_read_b64_tr_b16 v[154:155], v7 offset:28928
    ds_read_b64_tr_b16 v[156:157], v7 offset:30720
    ds_read_b64_tr_b16 v[158:159], v7 offset:30976
    s_waitcnt lgkmcnt(0)
    s_waitcnt vmcnt(0)
    v_mfma_f32_16x16x32_bf16 v[8:11], v[32:35], v[96:99], 0
    v_mfma_f32_16x16x32_bf16 v[8:11], v[36:39], v[100:103], v[8:11]
    v_mfma_f32_16x16x32_bf16 v[8:11], v[40:43], v[104:107], v[8:11]
    v_mfma_f32_16x16x32_bf16 v[8:11], v[44:47], v[108:111], v[8:11]
    v_mfma_f32_16x16x32_bf16 v[8:11], v[48:51], v[112:115], v[8:11]
    v_mfma_f32_16x16x32_bf16 v[8:11], v[52:55], v[116:119], v[8:11]
    v_mfma_f32_16x16x32_bf16 v[8:11], v[56:59], v[120:123], v[8:11]
    v_mfma_f32_16x16x32_bf16 v[8:11], v[60:63], v[124:127], v[8:11]
    v_mfma_f32_16x16x32_bf16 v[8:11], v[64:67], v[128:131], v[8:11]
    v_mfma_f32_16x16x32_bf16 v[8:11], v[68:71], v[132:135], v[8:11]
    v_mfma_f32_16x16x32_bf16 v[8:11], v[72:75], v[136:139], v[8:11]
    v_mfma_f32_16x16x32_bf16 v[8:11], v[76:79], v[140:143], v[8:11]
    v_mfma_f32_16x16x32_bf16 v[8:11], v[80:83], v[144:147], v[8:11]
    v_mfma_f32_16x16x32_bf16 v[8:11], v[84:87], v[148:151], v[8:11]
    v_mfma_f32_16x16x32_bf16 v[8:11], v[88:91], v[152:155], v[8:11]
    v_mfma_f32_16x16x32_bf16 v[8:11], v[92:95], v[156:159], v[8:11]
    s_nop 7
    v_cvt_pk_bf16_f32 v8, v8, v8
    v_and_b32 v8, 0xffff0000, v8
    v_cvt_pk_bf16_f32 v9, v9, v9
    v_and_b32 v9, 0xffff0000, v9
    s_cmp_ge_u32 s68, 2
    s_cbranch_scc1 L_ffn_up_132
    v_mul_f32 v13, 0xbfb8aa3b, v8
    v_exp_f32 v13, v13
    s_nop 0
    v_add_f32 v13, 1.0, v13
    v_rcp_f32 v12, v13
    s_nop 0
    v_mul_f32 v8, v12, v8
    v_cvt_pk_bf16_f32 v8, v8, v8
    v_and_b32 v8, 0xffff0000, v8
    v_mul_f32 v13, 0xbfb8aa3b, v9
    v_exp_f32 v13, v13
    s_nop 0
    v_add_f32 v13, 1.0, v13
    v_rcp_f32 v12, v13
    s_nop 0
    v_mul_f32 v9, v12, v9
    v_cvt_pk_bf16_f32 v9, v9, v9
    v_and_b32 v9, 0xffff0000, v9
    s_nop 4
L_ffn_up_132:
    s_lshr_b32 s71, s68, 1
    s_lshl_b32 s71, s71, 8
    s_and_b32 s72, s68, 1
    s_lshl_b32 s72, s72, 6
    s_add_u32 s71, s71, s72
    s_add_u32 s71, s71, 0x20000
    v_lshlrev_b32 v4, 2, v3
    v_add_u32 v4, s71, v4
    ds_write_b32 v4, v8
    ds_write_b32 v4, v9 offset:128
    s_waitcnt lgkmcnt(0)
    s_barrier
    v_and_b32 v4, 1, v3
    v_lshlrev_b32 v4, 7, v4
    v_lshl_add_u32 v4, v2, 5, v4
    v_add_u32 v4, 0x20000, v4
    ds_read_b128 v[32:35], v4
    ds_read_b128 v[36:39], v4 offset:16
    ds_read_b128 v[40:43], v4 offset:256
    ds_read_b128 v[44:47], v4 offset:272
    v_lshl_add_u32 v5, v2, 3, v6
    v_lshlrev_b32 v5, 10, v5
    v_and_b32 v7, 3, v3
    v_lshl_add_u32 v5, v7, 3, v5
    s_lshl_b32 s71, s68, 8
    s_add_u32 s71, s71, 0x18000
    v_add_u32 v7, s71, v5
    s_waitcnt lgkmcnt(0)
    ds_read_b64_tr_b16 v[96:97], v7
    ds_read_b64_tr_b16 v[98:99], v7 offset:4096
    ds_read_b64_tr_b16 v[100:101], v7 offset:32
    ds_read_b64_tr_b16 v[102:103], v7 offset:4128
    ds_read_b64_tr_b16 v[104:105], v7 offset:64
    ds_read_b64_tr_b16 v[106:107], v7 offset:4160
    ds_read_b64_tr_b16 v[108:109], v7 offset:96
    ds_read_b64_tr_b16 v[110:111], v7 offset:4192
    s_waitcnt lgkmcnt(0)
    ds_read_b64_tr_b16 v[112:113], v7 offset:128
    ds_read_b64_tr_b16 v[114:115], v7 offset:4224
    ds_read_b64_tr_b16 v[116:117], v7 offset:160
    ds_read_b64_tr_b16 v[118:119], v7 offset:4256
    ds_read_b64_tr_b16 v[120:121], v7 offset:192
    ds_read_b64_tr_b16 v[122:123], v7 offset:4288
    ds_read_b64_tr_b16 v[124:125], v7 offset:224
    ds_read_b64_tr_b16 v[126:127], v7 offset:4320
    v_mul_f32 v32, v32, v40
    v_mul_f32 v33, v33, v41
    v_mul_f32 v34, v34, v42
    v_mul_f32 v35, v35, v43
    v_mul_f32 v36, v36, v44
    v_mul_f32 v37, v37, v45
    v_mul_f32 v38, v38, v46
    v_mul_f32 v39, v39, v47
    v_cvt_pk_bf16_f32 v48, v32, v33
    v_cvt_pk_bf16_f32 v49, v34, v35
    v_cvt_pk_bf16_f32 v50, v36, v37
    v_cvt_pk_bf16_f32 v51, v38, v39
    s_waitcnt lgkmcnt(0)
    s_nop 0
    v_mfma_f32_16x16x32_bf16 v[56:59], v[48:51], v[96:99], 0
    v_mfma_f32_16x16x32_bf16 v[60:63], v[48:51], v[100:103], 0
    v_mfma_f32_16x16x32_bf16 v[64:67], v[48:51], v[104:107], 0
    v_mfma_f32_16x16x32_bf16 v[68:71], v[48:51], v[108:111], 0
    v_mfma_f32_16x16x32_bf16 v[72:75], v[48:51], v[112:115], 0
    v_mfma_f32_16x16x32_bf16 v[76:79], v[48:51], v[116:119], 0
    v_mfma_f32_16x16x32_bf16 v[80:83], v[48:51], v[120:123], 0
    v_mfma_f32_16x16x32_bf16 v[84:87], v[48:51], v[124:127], 0
    v_cmp_eq_u32 vcc, 0, v2
    v_lshlrev_b32 v4, 11, v2
    v_lshl_add_u32 v4, v3, 2, v4
    s_lshl_b32 s71, s67, 12
    s_lshl_b32 s72, s68, 9
    s_add_u32 s71, s71, s72
    s_add_u32 s71, s71, 0x6410000
    v_cndmask_b32 v56, v57, v56, vcc
    v_cndmask_b32 v60, v61, v60, vcc
    v_cndmask_b32 v64, v65, v64, vcc
    v_cndmask_b32 v68, v69, v68, vcc
    v_cndmask_b32 v72, v73, v72, vcc
    v_cndmask_b32 v76, v77, v76, vcc
    v_cndmask_b32 v80, v81, v80, vcc
    v_cndmask_b32 v84, v85, v84, vcc
    s_mov_b32 exec_hi, 0
    buffer_store_dword v56, v4, s[8:11], s71 offen sc1
    buffer_store_dword v60, v4, s[8:11], s71 offen offset:64 sc1
    buffer_store_dword v64, v4, s[8:11], s71 offen offset:128 sc1
    buffer_store_dword v68, v4, s[8:11], s71 offen offset:192 sc1
    buffer_store_dword v72, v4, s[8:11], s71 offen offset:256 sc1
    buffer_store_dword v76, v4, s[8:11], s71 offen offset:320 sc1
    buffer_store_dword v80, v4, s[8:11], s71 offen offset:384 sc1
    buffer_store_dword v84, v4, s[8:11], s71 offen offset:448 sc1
    s_mov_b64 exec, -1
    s_waitcnt vmcnt(0)
    s_barrier
    s_lshl_b32 s71, s67, 2
    s_lshl_b32 s72, s75, 8
    s_add_u32 s71, s71, s72
    s_add_u32 s71, s71, 0x8000
    s_cmp_lg_u32 s100, 0
    s_cbranch_scc1 L_flag_133
    v_mov_b32 v2, s74
    s_mov_b64 exec, 1
    buffer_store_dword v2, off, s[8:11], s71 sc1
    s_mov_b64 exec, -1
L_flag_133:
    s_cmp_ge_u32 s67, 8
    s_cbranch_scc1 L_ffn_same
    s_load_dwordx2 s[16:17], s[0:1], 96
    s_waitcnt lgkmcnt(0)
    s_and_b32 s17, s17, 0xffff
    s_mov_b32 s18, 0x200000
    s_mov_b32 s19, 0x20000
    v_and_b32 v3, 63, v0
    s_cmp_lt_u32 s100, 2
    s_cselect_b32 s71, s69, s70
    v_mov_b32 v5, s71
    s_and_b32 s71, s71, 2047
    s_sub_u32 s71, 2047, s71
    s_lshl_b32 s71, s71, 10
    s_lshl_b32 s72, s67, 1
    s_and_b32 s96, s100, 1
    s_add_u32 s72, s72, s96
    s_lshl_b32 s96, s72, 6
    s_add_u32 s71, s71, s96
    v_and_b32 v4, 7, v3
    v_lshlrev_b32 v6, 3, v4
    v_add_u32 v6, s71, v6
    v_lshrrev_b32 v7, 3, v3
    v_lshlrev_b32 v7, 12, v7
    v_lshl_add_u32 v7, v4, 4, v7
    s_lshl_b32 s72, s72, 7
    s_lshr_b32 s96, s100, 1
    s_lshl_b32 s96, s96, 11
    s_add_u32 s72, s72, s96
    v_add_u32 v7, s72, v7
    s_mov_b32 s71, 0x6000000
    s_mov_b32 s72, 0x6200000
    buffer_load_dwordx2 v[8:9], v6, s[8:11], s71 offen sc1
    buffer_load_dwordx2 v[10:11], v6, s[8:11], s72 offen sc1
    v_and_b32 v5, 0xffff0000, v5
    v_ashrrev_i32 v4, 31, v5
    v_not_b32 v4, v4
    v_or_b32 v4, 0x80000000, v4
    v_xor_b32 v5, v5, v4
    v_and_b32 v5, 0xffff0000, v5
    v_mul_f32 v23, 0xbfb8aa3b, v5
    v_exp_f32 v23, v23
    s_nop 0
    v_add_f32 v23, 1.0, v23
    v_rcp_f32 v22, v23
    s_nop 0
    v_cvt_pk_bf16_f32 v22, v22, v22
    v_and_b32 v22, 0xffff0000, v22
    v_lshlrev_b32 v1, 2, v0
    s_lshl_b32 s71, s75, 8
    s_add_u32 s71, s71, 0x8000
    s_cmp_lg_u32 s100, 0
    s_cbranch_scc1 L_polls_136
    s_mov_b32 exec_hi, 0xffffff
    s_mov_b32 s96, 0
L_poll_134:
    buffer_load_dword v2, v1, s[8:11], s71 offen sc1
    s_waitcnt vmcnt(0)
    v_cmp_ne_u32 vcc, s74, v2
    s_cbranch_vccz L_polld_135
    s_sleep 2
    s_add_u32 s96, s96, 1
    s_cmp_lt_u32 s96, 0x10000
    s_cbranch_scc1 L_poll_134
L_polld_135:
    s_mov_b64 exec, -1
L_polls_136:
    s_barrier
    s_mov_b32 s71, 0x6410000
    buffer_load_dwordx4 v[32:35], v7, s[8:11], s71 offen sc1
    s_add_u32 s71, s71, 32768
    buffer_load_dwordx4 v[36:39], v7, s[8:11], s71 offen sc1
    s_add_u32 s71, s71, 32768
    buffer_load_dwordx4 v[40:43], v7, s[8:11], s71 offen sc1
    s_add_u32 s71, s71, 32768
    buffer_load_dwordx4 v[44:47], v7, s[8:11], s71 offen sc1
    s_add_u32 s71, s71, 32768
    buffer_load_dwordx4 v[48:51], v7, s[8:11], s71 offen sc1
    s_add_u32 s71, s71, 32768
    buffer_load_dwordx4 v[52:55], v7, s[8:11], s71 offen sc1
    s_add_u32 s71, s71, 32768
    buffer_load_dwordx4 v[56:59], v7, s[8:11], s71 offen sc1
    s_add_u32 s71, s71, 32768
    s_waitcnt vmcnt(7)
    v_lshlrev_b32 v12, 16, v8
    v_and_b32 v13, 0xffff0000, v8
    v_lshlrev_b32 v16, 16, v10
    v_and_b32 v17, 0xffff0000, v10
    v_lshlrev_b32 v14, 16, v9
    v_and_b32 v15, 0xffff0000, v9
    v_lshlrev_b32 v18, 16, v11
    v_and_b32 v19, 0xffff0000, v11
    s_waitcnt vmcnt(0)
    v_pk_add_f32 v[32:33], v[32:33], v[36:37]
    v_pk_add_f32 v[34:35], v[34:35], v[38:39]
    v_pk_add_f32 v[32:33], v[32:33], v[40:41]
    v_pk_add_f32 v[34:35], v[34:35], v[42:43]
    v_pk_add_f32 v[32:33], v[32:33], v[44:45]
    v_pk_add_f32 v[34:35], v[34:35], v[46:47]
    v_pk_add_f32 v[32:33], v[32:33], v[48:49]
    v_pk_add_f32 v[34:35], v[34:35], v[50:51]
    v_pk_add_f32 v[32:33], v[32:33], v[52:53]
    v_pk_add_f32 v[34:35], v[34:35], v[54:55]
    v_pk_add_f32 v[32:33], v[32:33], v[56:57]
    v_pk_add_f32 v[34:35], v[34:35], v[58:59]
    s_nop 0
    v_add_f32_dpp v32, v32, v32 row_ror:8 row_mask:0xf bank_mask:0xf
    v_add_f32_dpp v33, v33, v33 row_ror:8 row_mask:0xf bank_mask:0xf
    v_add_f32_dpp v34, v34, v34 row_ror:8 row_mask:0xf bank_mask:0xf
    v_add_f32_dpp v35, v35, v35 row_ror:8 row_mask:0xf bank_mask:0xf
    v_mov_b32 v24, v32
    s_nop 1
    v_permlane32_swap_b32 v24, v32
    v_add_f32 v32, v24, v32
    v_mov_b32 v24, v32
    s_nop 1
    v_permlane16_swap_b32 v24, v32
    v_add_f32 v32, v24, v32
    v_mov_b32 v24, v33
    s_nop 1
    v_permlane32_swap_b32 v24, v33
    v_add_f32 v33, v24, v33
    v_mov_b32 v24, v33
    s_nop 1
    v_permlane16_swap_b32 v24, v33
    v_add_f32 v33, v24, v33
    v_mov_b32 v24, v34
    s_nop 1
    v_permlane32_swap_b32 v24, v34
    v_add_f32 v34, v24, v34
    v_mov_b32 v24, v34
    s_nop 1
    v_permlane16_swap_b32 v24, v34
    v_add_f32 v34, v24, v34
    v_mov_b32 v24, v35
    s_nop 1
    v_permlane32_swap_b32 v24, v35
    v_add_f32 v35, v24, v35
    v_mov_b32 v24, v35
    s_nop 1
    v_permlane16_swap_b32 v24, v35
    v_add_f32 v35, v24, v35
    v_cvt_pk_bf16_f32 v32, v32, v32
    v_and_b32 v32, 0xffff0000, v32
    v_mul_f32 v32, v22, v32
    v_cvt_pk_bf16_f32 v32, v32, v32
    v_and_b32 v32, 0xffff0000, v32
    v_add_f32 v32, v16, v32
    v_cvt_pk_bf16_f32 v32, v32, v32
    v_and_b32 v32, 0xffff0000, v32
    v_add_f32 v32, v12, v32
    v_cvt_pk_bf16_f32 v33, v33, v33
    v_and_b32 v33, 0xffff0000, v33
    v_mul_f32 v33, v22, v33
    v_cvt_pk_bf16_f32 v33, v33, v33
    v_and_b32 v33, 0xffff0000, v33
    v_add_f32 v33, v17, v33
    v_cvt_pk_bf16_f32 v33, v33, v33
    v_and_b32 v33, 0xffff0000, v33
    v_add_f32 v33, v13, v33
    v_cvt_pk_bf16_f32 v34, v34, v34
    v_and_b32 v34, 0xffff0000, v34
    v_mul_f32 v34, v22, v34
    v_cvt_pk_bf16_f32 v34, v34, v34
    v_and_b32 v34, 0xffff0000, v34
    v_add_f32 v34, v18, v34
    v_cvt_pk_bf16_f32 v34, v34, v34
    v_and_b32 v34, 0xffff0000, v34
    v_add_f32 v34, v14, v34
    v_cvt_pk_bf16_f32 v35, v35, v35
    v_and_b32 v35, 0xffff0000, v35
    v_mul_f32 v35, v22, v35
    v_cvt_pk_bf16_f32 v35, v35, v35
    v_and_b32 v35, 0xffff0000, v35
    v_add_f32 v35, v19, v35
    v_cvt_pk_bf16_f32 v35, v35, v35
    v_and_b32 v35, 0xffff0000, v35
    v_add_f32 v35, v15, v35
    v_cvt_pk_bf16_f32 v200, v32, v33
    v_cvt_pk_bf16_f32 v201, v34, v35
    v_mov_b32 v202, v6
L_ffn_same:
    s_add_u32 s75, s75, 1
    s_cmp_lt_u32 s75, 2
    s_cbranch_scc1 L_ffn_round
    s_cmp_ge_u32 s67, 8
    s_cbranch_scc1 L_exit
    s_mov_b32 exec_lo, 0xff
    s_mov_b32 exec_hi, 0
    buffer_store_dwordx2 v[200:201], v202, s[16:19], 0 offen
    s_mov_b64 exec, -1
    s_waitcnt vmcnt(0)
L_exit:
    s_endpgm
.section .rodata,"a"
.p2align 6
.amdhsa_kernel sequential_preLN__memory_aug_recurrent_mem_tr__moe_arch_mod__prompt_kernel
  .amdhsa_next_free_vgpr 512
  .amdhsa_next_free_sgpr 102
  .amdhsa_accum_offset 256
  .amdhsa_group_segment_fixed_size 0
  .amdhsa_kernarg_size 120
  .amdhsa_user_sgpr_count 2
  .amdhsa_user_sgpr_kernarg_segment_ptr 1
  .amdhsa_system_sgpr_workgroup_id_x 1
  .amdhsa_float_denorm_mode_32 3
.end_amdhsa_kernel
```

```asm
; @launch grid=(256,1,1) block=(256,1,1) lds=163840
.amdgcn_target "amdgcn-amd-amdhsa--gfx950"
.text
.globl sequential_preLN__memory_aug_recurrent_mem_tr__moe_arch_mod__prompt_kernel
.p2align 8
.type sequential_preLN__memory_aug_recurrent_mem_tr__moe_arch_mod__prompt_kernel,@function
sequential_preLN__memory_aug_recurrent_mem_tr__moe_arch_mod__prompt_kernel:
    s_cmp_ge_u32 s2, 256
    s_cbranch_scc1 L_exit
    s_load_dwordx2 s[8:9], s[0:1], 112
    s_waitcnt lgkmcnt(0)
    s_and_b32 s9, s9, 0xffff
    s_mov_b32 s10, 0x10000000
    s_mov_b32 s11, 0x20000
    s_load_dwordx2 s[92:93], s[0:1], 104
    s_waitcnt lgkmcnt(0)
    s_and_b32 s93, s93, 0xffff
    s_mov_b32 s94, 0x100
    s_mov_b32 s95, 0x20000
    v_lshrrev_b32 v1, 6, v0
    s_nop 0
    v_readfirstlane_b32 s100, v1
    s_getreg_b32 s84, hwreg(HW_REG_XCC_ID)
    s_and_b32 s84, s84, 7
    s_lshl_b32 s97, s84, 4
    s_add_u32 s97, s97, 64
    s_cmp_lg_u32 s100, 0
    s_cbranch_scc1 L_at_1
    s_mov_b64 exec, 1
    v_mov_b32 v2, 1
    buffer_atomic_add v2, off, s[92:95], s97 sc0
    s_mov_b64 exec, -1
L_at_1:
    s_load_dwordx4 s[20:23], s[0:1], 16
    s_load_dwordx4 s[24:27], s[0:1], 32
    v_lshlrev_b32 v3, 6, v0
    s_lshl_b32 s28, s2, 14
    s_cmp_eq_u32 s84, 0
    s_cselect_b32 s14, 0, 0x400000
    s_mov_b32 s15, 0x20000
    s_waitcnt lgkmcnt(0)
    s_mov_b32 s12, s20
    s_and_b32 s13, s21, 0xffff
    buffer_load_dword v255, v3, s[12:15], s28 offen
    s_mov_b32 s12, s22
    s_and_b32 s13, s23, 0xffff
    buffer_load_dword v255, v3, s[12:15], s28 offen
    s_mov_b32 s12, s24
    s_and_b32 s13, s25, 0xffff
    buffer_load_dword v255, v3, s[12:15], s28 offen
    s_mov_b32 s12, s26
    s_and_b32 s13, s27, 0xffff
    buffer_load_dword v255, v3, s[12:15], s28 offen
    s_cmp_lg_u32 s100, 0
    s_cbranch_scc1 L_at2_2
    s_mov_b64 exec, 1
    v_mov_b32 v1, 0
    s_waitcnt vmcnt(4)
    ds_write_b32 v1, v2
    s_waitcnt lgkmcnt(0)
    s_mov_b64 exec, -1
L_at2_2:
    s_barrier
    v_mov_b32 v1, 0
    ds_read_b32 v2, v1
    s_waitcnt lgkmcnt(0)
    v_readfirstlane_b32 s85, v2
    s_mov_b32 s87, 0
    s_cmp_lg_u32 s2, 0
    s_cbranch_scc1 L_noz
    v_mov_b32 v4, 0
    v_mov_b32 v5, 0
    v_mov_b32 v6, 0
    v_mov_b32 v7, 0
    v_lshlrev_b32 v1, 4, v0
    s_mov_b32 s97, 0x0
    buffer_store_dwordx4 v[4:7], v1, s[8:11], s97 offen sc1
    s_mov_b32 s97, 0x1000
    buffer_store_dwordx4 v[4:7], v1, s[8:11], s97 offen sc1
    s_mov_b32 s97, 0x2000
    buffer_store_dwordx4 v[4:7], v1, s[8:11], s97 offen sc1
    s_mov_b32 s97, 0x3000
    buffer_store_dwordx4 v[4:7], v1, s[8:11], s97 offen sc1
    s_mov_b32 s97, 0x4000
    buffer_store_dwordx4 v[4:7], v1, s[8:11], s97 offen sc1
    s_mov_b32 s97, 0x5000
    buffer_store_dwordx4 v[4:7], v1, s[8:11], s97 offen sc1
    s_mov_b32 s97, 0x6000
    buffer_store_dwordx4 v[4:7], v1, s[8:11], s97 offen sc1
    s_mov_b32 s97, 0x7000
    buffer_store_dwordx4 v[4:7], v1, s[8:11], s97 offen sc1
    s_mov_b32 s97, 0x8000
    buffer_store_dwordx4 v[4:7], v1, s[8:11], s97 offen sc1
    s_waitcnt vmcnt(0)
    s_barrier
    s_cmp_lg_u32 s100, 0
    s_cbranch_scc1 L_flag_3
    v_mov_b32 v2, 1
    s_mov_b64 exec, 1
    buffer_store_dword v2, off, s[92:95], 40 sc1
    s_mov_b64 exec, -1
L_flag_3:
L_noz:
    s_cmp_lg_u32 s85, 31
    s_cbranch_scc1 L_nod
    s_cmp_lg_u32 s100, 0
    s_cbranch_scc1 L_nod
    s_mov_b64 exec, 1
    v_mov_b32 v2, 1
    buffer_atomic_add v2, off, s[92:95], 0 offset:32 sc0
    s_waitcnt vmcnt(0)
    v_readfirstlane_b32 s86, v2
    s_nop 0
    s_cmp_lg_u32 s86, 7
    s_cbranch_scc1 L_nod2
    v_mov_b32 v2, 1
    v_mov_b32 v3, 0
    buffer_atomic_cmpswap v[2:3], off, s[92:95], 0 offset:36
L_nod2:
    s_mov_b64 exec, -1
L_nod:
    s_cmp_ge_u32 s85, 32
    s_cbranch_scc1 L_odd
    s_cmp_lg_u32 s84, 0
    s_cbranch_scc1 L_other
    s_mov_b32 s20, s85
    s_mov_b32 s16, s92
    s_mov_b32 s17, s93
    s_mov_b32 s18, s94
    s_mov_b32 s19, s95
    s_mov_b32 s88, s20
    v_lshrrev_b32 v4, 6, v0
    s_nop 0
    v_readfirstlane_b32 s21, v4
    v_and_b32 v1, 63, v0
    v_lshrrev_b32 v2, 4, v1
    v_and_b32 v3, 15, v1
    v_lshrrev_b32 v6, 2, v3
    v_lshlrev_b32 v117, 4, v1
    s_lshl_b32 s51, s21, 10
    s_lshl_b32 s52, s21, 11
    s_load_dwordx8 s[60:67], s[0:1], 16
    s_mov_b32 s14, 0x400000
    s_mov_b32 s15, 0x20000
    s_lshl_b32 s41, s20, 8
    s_lshl_b32 s42, s20, 17
    s_lshr_b32 s43, s21, 1
    s_lshl_b32 s43, s43, 2
    v_or_b32 v5, s43, v2
    v_lshlrev_b32 v5, 1, v5
    v_xor_b32 v5, v5, v3
    v_lshrrev_b32 v14, 2, v5
    v_lshlrev_b32 v5, 4, v5
    s_lshl_b32 s43, s21, 4
    v_add_u32 v4, s43, v2
    v_lshl_add_u32 v8, v4, 13, v5
    s_waitcnt lgkmcnt(0)
    s_mov_b32 s12, s60
    s_and_b32 s13, s61, 0xffff
    v_xor_b32 v15, 1, v14
    v_lshl_add_u32 v15, v15, 15, v8
    s_add_u32 s43, s41, 0x0
    s_add_u32 m0, s51, 0x8000
    s_nop 0
    buffer_load_dwordx4 v15, s[12:15], s43 offen lds
    s_add_u32 s43, s41, 0x80000
    s_add_u32 m0, s51, 0x9000
    s_nop 0
    buffer_load_dwordx4 v15, s[12:15], s43 offen lds
    s_add_u32 s43, s41, 0x100000
    s_add_u32 m0, s51, 0xa000
    s_nop 0
    buffer_load_dwordx4 v15, s[12:15], s43 offen lds
    s_add_u32 s43, s41, 0x180000
    s_add_u32 m0, s51, 0xb000
    s_nop 0
    buffer_load_dwordx4 v15, s[12:15], s43 offen lds
    s_add_u32 s43, s41, 0x200000
    s_add_u32 m0, s51, 0xc000
    s_nop 0
    buffer_load_dwordx4 v15, s[12:15], s43 offen lds
    s_add_u32 s43, s41, 0x280000
    s_add_u32 m0, s51, 0xd000
    s_nop 0
    buffer_load_dwordx4 v15, s[12:15], s43 offen lds
    s_add_u32 s43, s41, 0x300000
    s_add_u32 m0, s51, 0xe000
    s_nop 0
    buffer_load_dwordx4 v15, s[12:15], s43 offen lds
    s_add_u32 s43, s41, 0x380000
    s_add_u32 m0, s51, 0xf000
    s_nop 0
    buffer_load_dwordx4 v15, s[12:15], s43 offen lds
    v_xor_b32 v15, 2, v14
    v_lshl_add_u32 v15, v15, 15, v8
    s_add_u32 s43, s41, 0x0
    s_add_u32 m0, s51, 0x10000
    s_nop 0
    buffer_load_dwordx4 v15, s[12:15], s43 offen lds
    s_add_u32 s43, s41, 0x80000
    s_add_u32 m0, s51, 0x11000
    s_nop 0
    buffer_load_dwordx4 v15, s[12:15], s43 offen lds
    s_add_u32 s43, s41, 0x100000
    s_add_u32 m0, s51, 0x12000
    s_nop 0
    buffer_load_dwordx4 v15, s[12:15], s43 offen lds
    s_add_u32 s43, s41, 0x180000
    s_add_u32 m0, s51, 0x13000
    s_nop 0
    buffer_load_dwordx4 v15, s[12:15], s43 offen lds
    s_add_u32 s43, s41, 0x200000
    s_add_u32 m0, s51, 0x14000
    s_nop 0
    buffer_load_dwordx4 v15, s[12:15], s43 offen lds
    s_add_u32 s43, s41, 0x280000
    s_add_u32 m0, s51, 0x15000
    s_nop 0
    buffer_load_dwordx4 v15, s[12:15], s43 offen lds
    s_add_u32 s43, s41, 0x300000
    s_add_u32 m0, s51, 0x16000
    s_nop 0
    buffer_load_dwordx4 v15, s[12:15], s43 offen lds
    s_add_u32 s43, s41, 0x380000
    s_add_u32 m0, s51, 0x17000
    s_nop 0
    buffer_load_dwordx4 v15, s[12:15], s43 offen lds
    v_xor_b32 v15, 3, v14
    v_lshl_add_u32 v15, v15, 15, v8
    s_add_u32 s43, s41, 0x0
    s_add_u32 m0, s51, 0x18000
    s_nop 0
    buffer_load_dwordx4 v15, s[12:15], s43 offen lds
    s_add_u32 s43, s41, 0x80000
    s_add_u32 m0, s51, 0x19000
    s_nop 0
    buffer_load_dwordx4 v15, s[12:15], s43 offen lds
    s_add_u32 s43, s41, 0x100000
    s_add_u32 m0, s51, 0x1a000
    s_nop 0
    buffer_load_dwordx4 v15, s[12:15], s43 offen lds
    s_add_u32 s43, s41, 0x180000
    s_add_u32 m0, s51, 0x1b000
    s_nop 0
    buffer_load_dwordx4 v15, s[12:15], s43 offen lds
    s_add_u32 s43, s41, 0x200000
    s_add_u32 m0, s51, 0x1c000
    s_nop 0
    buffer_load_dwordx4 v15, s[12:15], s43 offen lds
    s_add_u32 s43, s41, 0x280000
    s_add_u32 m0, s51, 0x1d000
    s_nop 0
    buffer_load_dwordx4 v15, s[12:15], s43 offen lds
    s_add_u32 s43, s41, 0x300000
    s_add_u32 m0, s51, 0x1e000
    s_nop 0
    buffer_load_dwordx4 v15, s[12:15], s43 offen lds
    s_add_u32 s43, s41, 0x380000
    s_add_u32 m0, s51, 0x1f000
    s_nop 0
    buffer_load_dwordx4 v15, s[12:15], s43 offen lds
    s_mov_b32 s12, s62
    s_and_b32 s13, s63, 0xffff
    v_xor_b32 v15, 1, v14
    v_lshl_add_u32 v15, v15, 15, v8
    s_add_u32 s43, s41, 0x0
    s_add_u32 m0, s51, 0x20000
    s_nop 0
    buffer_load_dwordx4 v15, s[12:15], s43 offen lds
    s_add_u32 s43, s41, 0x80000
    s_add_u32 m0, s51, 0x21000
    s_nop 0
    buffer_load_dwordx4 v15, s[12:15], s43 offen lds
    s_add_u32 s43, s41, 0x100000
    s_add_u32 m0, s51, 0x22000
    s_nop 0
    buffer_load_dwordx4 v15, s[12:15], s43 offen lds
    s_add_u32 s43, s41, 0x180000
    s_add_u32 m0, s51, 0x23000
    s_nop 0
    buffer_load_dwordx4 v15, s[12:15], s43 offen lds
    s_add_u32 s43, s41, 0x200000
    s_add_u32 m0, s51, 0x24000
    s_nop 0
    buffer_load_dwordx4 v15, s[12:15], s43 offen lds
    s_add_u32 s43, s41, 0x280000
    s_add_u32 m0, s51, 0x25000
    s_nop 0
    buffer_load_dwordx4 v15, s[12:15], s43 offen lds
    s_add_u32 s43, s41, 0x300000
    s_add_u32 m0, s51, 0x26000
    s_nop 0
    buffer_load_dwordx4 v15, s[12:15], s43 offen lds
    s_add_u32 s43, s41, 0x380000
    s_add_u32 m0, s51, 0x27000
    s_nop 0
    buffer_load_dwordx4 v15, s[12:15], s43 offen lds
    v_and_b32 v4, 2, v3
    v_cmp_ne_u32 vcc, 0, v4
    v_mov_b32 v4, 0x4444
    v_mov_b32 v5, 0xeeee
    v_cndmask_b32 v116, v4, v5, vcc
    v_lshrrev_b32 v5, 1, v2
    v_lshl_add_u32 v4, v6, 3, v5
    s_lshl_b32 s43, s21, 1
    v_add_u32 v4, s43, v4
    v_add_u32 v5, s20, v4
    v_and_b32 v5, 31, v5
    v_lshl_add_u32 v4, v4, 6, v5
    v_and_b32 v5, 1, v2
    v_lshl_add_u32 v4, v4, 1, v5
    v_and_b32 v5, 3, v3
    v_lshl_add_u32 v4, v4, 2, v5
    v_lshlrev_b32 v118, 4, v4
    v_and_b32 v4, 1, v2
    v_lshlrev_b32 v4, 2, v4
    v_and_b32 v7, 2, v2
    v_add_u32 v4, v4, v7
    v_and_b32 v7, 1, v6
    v_add_u32 v4, v4, v7
    v_lshl_add_u32 v4, v4, 2, v5
    v_lshlrev_b32 v4, 2, v4
    s_and_b32 s43, s21, 1
    s_lshl_b32 s43, s43, 12
    s_lshl_b32 s40, s20, 7
    s_add_u32 s43, s43, s40
    v_add_u32 v119, s43, v4
    v_sub_u32 v7, 0, v2
    v_and_b32 v7, 3, v7
    v_xor_b32 v7, v7, v6
    v_lshl_add_u32 v4, v2, 4, v7
    v_and_b32 v5, 3, v3
    v_lshl_add_u32 v4, v4, 2, v5
    s_add_u32 s43, s51, 16384
    v_lshl_add_u32 v120, v4, 2, s43
    v_sub_u32 v7, 0, v6
    v_and_b32 v7, 3, v7
    v_xor_b32 v7, v7, v2
    v_lshl_add_u32 v4, v3, 2, v7
    v_lshlrev_b32 v121, 4, v4
    v_and_b32 v5, 1, v3
    v_lshl_add_u32 v4, v6, 1, v5
    v_lshl_add_u32 v4, v2, 3, v4
    v_lshlrev_b32 v127, 4, v4
    v_and_or_b32 v122, v116, 8, v127
    s_lshl_b32 s43, s21, 13
    s_add_u32 s43, s43, 32768
    v_add_u32 v123, s43, v117
    v_add_u32 v124, 0x10000, v123
    s_mov_b32 s36, 0xcccccccc
    s_mov_b32 s37, 0xcccccccc
    s_mov_b32 s38, 0x00ff00ff
    s_mov_b32 s39, 0x00ff00ff
    s_mov_b32 s34, 0x3e0293ee
    s_mov_b32 s35, 0x49800000
    s_mov_b32 s50, 0x3f803f80
    v_and_b32 v5, 1, v2
    v_or_b32 v5, 0, v5
    v_xor_b32 v5, v5, v6
    v_lshlrev_b32 v5, 8, v5
    v_and_b32 v7, 3, v3
    v_lshl_add_u32 v7, v7, 4, v5
    s_lshl_b32 s43, s21, 2
    v_add_u32 v4, s43, v2
    v_lshl_add_u32 v10, v4, 10, v7
    v_and_b32 v5, 1, v2
    v_or_b32 v5, 2, v5
    v_xor_b32 v5, v5, v6
    v_lshlrev_b32 v5, 8, v5
    v_and_b32 v7, 3, v3
    v_lshl_add_u32 v7, v7, 4, v5
    s_lshl_b32 s43, s21, 2
    v_add_u32 v4, s43, v2
    v_lshl_add_u32 v9, v4, 10, v7
    v_and_b32 v5, 1, v2
    v_lshl_add_u32 v4, v5, 3, v6
    v_lshrrev_b32 v7, 1, v2
    v_lshl_add_u32 v4, v7, 5, v4
    v_lshlrev_b32 v4, 8, v4
    v_lshl_or_b32 v5, v5, 2, v6
    v_lshlrev_b32 v5, 5, v5
    s_lshl_b32 s43, s21, 6
    v_xor_b32 v5, s43, v5
    v_add_u32 v4, v4, v5
    v_and_b32 v5, 3, v3
    v_lshl_add_u32 v4, v5, 3, v4
    v_add_u32 v11, 32768, v4
    v_and_b32 v5, 1, v2
    v_lshlrev_b32 v4, 4, v5
    v_lshl_add_u32 v4, v7, 2, v4
    v_and_b32 v7, 1, v6
    v_add_u32 v4, v4, v7
    s_lshl_b32 s43, s21, 5
    v_add_u32 v4, s43, v4
    v_lshlrev_b32 v4, 8, v4
    v_lshl_or_b32 v5, v5, 1, v7
    v_xor_b32 v5, s21, v5
    v_lshl_add_u32 v4, v5, 6, v4
    v_lshrrev_b32 v5, 1, v6
    v_lshl_add_u32 v4, v5, 5, v4
    v_and_b32 v5, 3, v3
    v_lshl_add_u32 v4, v5, 3, v4
    v_add_u32 v12, 32768, v4
    v_mov_b32 v16, -1
    v_mov_b32 v17, -1
    v_mov_b32 v18, -1
    v_mov_b32 v19, -1
    s_lshl_b32 s43, s20, 13
    s_add_u32 s43, s43, 0x100000
    s_and_b32 s40, s21, 1
    s_lshl_b32 s40, s40, 12
    s_add_u32 s29, s43, s40
    s_add_u32 s43, s43, s52
    s_xor_b32 s40, s43, 0x40000
    buffer_store_dwordx4 v[16:19], v117, s[8:11], s43 offen
    buffer_store_dwordx4 v[16:19], v117, s[8:11], s43 offen offset:1024
    buffer_store_dwordx4 v[16:19], v117, s[8:11], s40 offen
    buffer_store_dwordx4 v[16:19], v117, s[8:11], s40 offen offset:1024
    s_mov_b32 s43, 0x12000
    buffer_store_dword v16, v119, s[8:11], s43 offen
    s_mov_b32 s43, 0x14000
    buffer_store_dword v16, v119, s[8:11], s43 offen
    s_mov_b32 s43, 0x16000
    buffer_store_dword v16, v119, s[8:11], s43 offen
    s_load_dwordx2 s[4:5], s[0:1], 8
    s_waitcnt lgkmcnt(0)
    s_and_b32 s5, s5, 0xffff
    s_mov_b32 s6, 8192
    s_mov_b32 s7, 0x20000
    v_and_b32 v20, 1, v2
    v_and_b32 v21, 1, v6
    v_lshl_add_u32 v20, v20, 1, v21
    v_lshlrev_b32 v20, 9, v20
    v_and_b32 v21, 3, v3
    v_lshl_add_u32 v20, v21, 4, v20
    v_and_b32 v21, 2, v2
    v_add_u32 v20, v20, v21
    s_and_b32 s43, s20, 1
    s_lshl_b32 s43, s43, 11
    s_bfe_u32 s40, s20, 0x20001
    s_lshl_b32 s40, s40, 7
    s_add_u32 s43, s43, s40
    s_and_b32 s40, s21, 1
    s_lshl_b32 s40, s40, 6
    s_add_u32 s43, s43, s40
    s_lshr_b32 s40, s20, 3
    s_lshl_b32 s40, s40, 2
    s_add_u32 s43, s43, s40
    v_add_u32 v20, s43, v20
    v_lshlrev_b32 v20, 1, v20
    buffer_load_dword v21, v20, s[4:7], 0 offen
    s_waitcnt vmcnt(32)
    s_barrier
    v_xor_b32 v13, 0, v11
    v_add_u32 v13, 0x0, v13
    ds_read_b64_tr_b16 a[0:1], v13
    ds_read_b64_tr_b16 a[2:3], v13 offset:1024
    ds_read_b64_tr_b16 a[4:5], v13 offset:16384
    ds_read_b64_tr_b16 a[6:7], v13 offset:17408
    ds_read_b64_tr_b16 a[16:17], v13 offset:4096
    ds_read_b64_tr_b16 a[18:19], v13 offset:5120
    ds_read_b64_tr_b16 a[20:21], v13 offset:20480
    ds_read_b64_tr_b16 a[22:23], v13 offset:21504
    s_waitcnt lgkmcnt(0)
    v_xor_b32 v13, 32, v11
    v_add_u32 v13, 0x0, v13
    ds_read_b64_tr_b16 a[8:9], v13
    ds_read_b64_tr_b16 a[10:11], v13 offset:1024
    ds_read_b64_tr_b16 a[12:13], v13 offset:16384
    ds_read_b64_tr_b16 a[14:15], v13 offset:17408
    ds_read_b64_tr_b16 a[24:25], v13 offset:4096
    ds_read_b64_tr_b16 a[26:27], v13 offset:5120
    ds_read_b64_tr_b16 a[28:29], v13 offset:20480
    ds_read_b64_tr_b16 a[30:31], v13 offset:21504
    s_waitcnt lgkmcnt(0)
    s_barrier
    v_xor_b32 v15, 2, v14
    v_lshl_add_u32 v15, v15, 15, v8
    s_add_u32 s43, s41, 0x0
    s_add_u32 m0, s51, 0x8000
    s_nop 0
    buffer_load_dwordx4 v15, s[12:15], s43 offen lds
    s_add_u32 s43, s41, 0x80000
    s_add_u32 m0, s51, 0x9000
    s_nop 0
    buffer_load_dwordx4 v15, s[12:15], s43 offen lds
    s_add_u32 s43, s41, 0x100000
    s_add_u32 m0, s51, 0xa000
    s_nop 0
    buffer_load_dwordx4 v15, s[12:15], s43 offen lds
    s_add_u32 s43, s41, 0x180000
    s_add_u32 m0, s51, 0xb000
    s_nop 0
    buffer_load_dwordx4 v15, s[12:15], s43 offen lds
    s_add_u32 s43, s41, 0x200000
    s_add_u32 m0, s51, 0xc000
    s_nop 0
    buffer_load_dwordx4 v15, s[12:15], s43 offen lds
    s_add_u32 s43, s41, 0x280000
    s_add_u32 m0, s51, 0xd000
    s_nop 0
    buffer_load_dwordx4 v15, s[12:15], s43 offen lds
    s_add_u32 s43, s41, 0x300000
    s_add_u32 m0, s51, 0xe000
    s_nop 0
    buffer_load_dwordx4 v15, s[12:15], s43 offen lds
    s_add_u32 s43, s41, 0x380000
    s_add_u32 m0, s51, 0xf000
    s_nop 0
    buffer_load_dwordx4 v15, s[12:15], s43 offen lds
    s_waitcnt vmcnt(32)
    s_barrier
    v_xor_b32 v13, 0, v11
    v_add_u32 v13, 0x8000, v13
    ds_read_b64_tr_b16 a[32:33], v13
    ds_read_b64_tr_b16 a[34:35], v13 offset:1024
    ds_read_b64_tr_b16 a[36:37], v13 offset:16384
    ds_read_b64_tr_b16 a[38:39], v13 offset:17408
    ds_read_b64_tr_b16 a[48:49], v13 offset:4096
    ds_read_b64_tr_b16 a[50:51], v13 offset:5120
    ds_read_b64_tr_b16 a[52:53], v13 offset:20480
    ds_read_b64_tr_b16 a[54:55], v13 offset:21504
    s_waitcnt lgkmcnt(0)
    v_xor_b32 v13, 32, v11
    v_add_u32 v13, 0x8000, v13
    ds_read_b64_tr_b16 a[40:41], v13
    ds_read_b64_tr_b16 a[42:43], v13 offset:1024
    ds_read_b64_tr_b16 a[44:45], v13 offset:16384
    ds_read_b64_tr_b16 a[46:47], v13 offset:17408
    ds_read_b64_tr_b16 a[56:57], v13 offset:4096
    ds_read_b64_tr_b16 a[58:59], v13 offset:5120
    ds_read_b64_tr_b16 a[60:61], v13 offset:20480
    ds_read_b64_tr_b16 a[62:63], v13 offset:21504
    s_waitcnt lgkmcnt(0)
    s_barrier
    v_xor_b32 v15, 3, v14
    v_lshl_add_u32 v15, v15, 15, v8
    s_add_u32 s43, s41, 0x0
    s_add_u32 m0, s51, 0x10000
    s_nop 0
    buffer_load_dwordx4 v15, s[12:15], s43 offen lds
    s_add_u32 s43, s41, 0x80000
    s_add_u32 m0, s51, 0x11000
    s_nop 0
    buffer_load_dwordx4 v15, s[12:15], s43 offen lds
    s_add_u32 s43, s41, 0x100000
    s_add_u32 m0, s51, 0x12000
    s_nop 0
    buffer_load_dwordx4 v15, s[12:15], s43 offen lds
    s_add_u32 s43, s41, 0x180000
    s_add_u32 m0, s51, 0x13000
    s_nop 0
    buffer_load_dwordx4 v15, s[12:15], s43 offen lds
    s_add_u32 s43, s41, 0x200000
    s_add_u32 m0, s51, 0x14000
    s_nop 0
    buffer_load_dwordx4 v15, s[12:15], s43 offen lds
    s_add_u32 s43, s41, 0x280000
    s_add_u32 m0, s51, 0x15000
    s_nop 0
    buffer_load_dwordx4 v15, s[12:15], s43 offen lds
    s_add_u32 s43, s41, 0x300000
    s_add_u32 m0, s51, 0x16000
    s_nop 0
    buffer_load_dwordx4 v15, s[12:15], s43 offen lds
    s_add_u32 s43, s41, 0x380000
    s_add_u32 m0, s51, 0x17000
    s_nop 0
    buffer_load_dwordx4 v15, s[12:15], s43 offen lds
    s_waitcnt vmcnt(32)
    s_barrier
    v_xor_b32 v13, 0, v11
    v_add_u32 v13, 0x10000, v13
    ds_read_b64_tr_b16 a[64:65], v13
    ds_read_b64_tr_b16 a[66:67], v13 offset:1024
    ds_read_b64_tr_b16 a[68:69], v13 offset:16384
    ds_read_b64_tr_b16 a[70:71], v13 offset:17408
    ds_read_b64_tr_b16 a[80:81], v13 offset:4096
    ds_read_b64_tr_b16 a[82:83], v13 offset:5120
    ds_read_b64_tr_b16 a[84:85], v13 offset:20480
    ds_read_b64_tr_b16 a[86:87], v13 offset:21504
    s_waitcnt lgkmcnt(0)
    v_xor_b32 v13, 32, v11
    v_add_u32 v13, 0x10000, v13
    ds_read_b64_tr_b16 a[72:73], v13
    ds_read_b64_tr_b16 a[74:75], v13 offset:1024
    ds_read_b64_tr_b16 a[76:77], v13 offset:16384
    ds_read_b64_tr_b16 a[78:79], v13 offset:17408
    ds_read_b64_tr_b16 a[88:89], v13 offset:4096
    ds_read_b64_tr_b16 a[90:91], v13 offset:5120
    ds_read_b64_tr_b16 a[92:93], v13 offset:20480
    ds_read_b64_tr_b16 a[94:95], v13 offset:21504
    s_waitcnt lgkmcnt(0)
    s_barrier
    s_mov_b32 s12, s64
    s_and_b32 s13, s65, 0xffff
    v_xor_b32 v15, 0, v14
    v_lshl_add_u32 v15, v15, 15, v8
    s_add_u32 s43, s41, 0x0
    s_add_u32 m0, s51, 0x18000
    s_nop 0
    buffer_load_dwordx4 v15, s[12:15], s43 offen lds
    s_add_u32 s43, s41, 0x80000
    s_add_u32 m0, s51, 0x19000
    s_nop 0
    buffer_load_dwordx4 v15, s[12:15], s43 offen lds
    s_add_u32 s43, s41, 0x100000
    s_add_u32 m0, s51, 0x1a000
    s_nop 0
    buffer_load_dwordx4 v15, s[12:15], s43 offen lds
    s_add_u32 s43, s41, 0x180000
    s_add_u32 m0, s51, 0x1b000
    s_nop 0
    buffer_load_dwordx4 v15, s[12:15], s43 offen lds
    s_add_u32 s43, s41, 0x200000
    s_add_u32 m0, s51, 0x1c000
    s_nop 0
    buffer_load_dwordx4 v15, s[12:15], s43 offen lds
    s_add_u32 s43, s41, 0x280000
    s_add_u32 m0, s51, 0x1d000
    s_nop 0
    buffer_load_dwordx4 v15, s[12:15], s43 offen lds
    s_add_u32 s43, s41, 0x300000
    s_add_u32 m0, s51, 0x1e000
    s_nop 0
    buffer_load_dwordx4 v15, s[12:15], s43 offen lds
    s_add_u32 s43, s41, 0x380000
    s_add_u32 m0, s51, 0x1f000
    s_nop 0
    buffer_load_dwordx4 v15, s[12:15], s43 offen lds
    s_waitcnt vmcnt(32)
    s_barrier
    v_xor_b32 v13, 0, v11
    v_add_u32 v13, 0x18000, v13
    ds_read_b64_tr_b16 a[96:97], v13
    ds_read_b64_tr_b16 a[98:99], v13 offset:1024
    ds_read_b64_tr_b16 a[100:101], v13 offset:16384
    ds_read_b64_tr_b16 a[102:103], v13 offset:17408
    ds_read_b64_tr_b16 a[112:113], v13 offset:4096
    ds_read_b64_tr_b16 a[114:115], v13 offset:5120
    ds_read_b64_tr_b16 a[116:117], v13 offset:20480
    ds_read_b64_tr_b16 a[118:119], v13 offset:21504
    s_waitcnt lgkmcnt(0)
    v_xor_b32 v13, 32, v11
    v_add_u32 v13, 0x18000, v13
    ds_read_b64_tr_b16 a[104:105], v13
    ds_read_b64_tr_b16 a[106:107], v13 offset:1024
    ds_read_b64_tr_b16 a[108:109], v13 offset:16384
    ds_read_b64_tr_b16 a[110:111], v13 offset:17408
    ds_read_b64_tr_b16 a[120:121], v13 offset:4096
    ds_read_b64_tr_b16 a[122:123], v13 offset:5120
    ds_read_b64_tr_b16 a[124:125], v13 offset:20480
    ds_read_b64_tr_b16 a[126:127], v13 offset:21504
    s_waitcnt lgkmcnt(0)
    s_barrier
    v_xor_b32 v15, 1, v14
    v_lshl_add_u32 v15, v15, 15, v8
    s_add_u32 s43, s41, 0x0
    s_add_u32 m0, s51, 0x20000
    s_nop 0
    buffer_load_dwordx4 v15, s[12:15], s43 offen lds
    s_add_u32 s43, s41, 0x80000
    s_add_u32 m0, s51, 0x21000
    s_nop 0
    buffer_load_dwordx4 v15, s[12:15], s43 offen lds
    s_add_u32 s43, s41, 0x100000
    s_add_u32 m0, s51, 0x22000
    s_nop 0
    buffer_load_dwordx4 v15, s[12:15], s43 offen lds
    s_add_u32 s43, s41, 0x180000
    s_add_u32 m0, s51, 0x23000
    s_nop 0
    buffer_load_dwordx4 v15, s[12:15], s43 offen lds
    s_add_u32 s43, s41, 0x200000
    s_add_u32 m0, s51, 0x24000
    s_nop 0
    buffer_load_dwordx4 v15, s[12:15], s43 offen lds
    s_add_u32 s43, s41, 0x280000
    s_add_u32 m0, s51, 0x25000
    s_nop 0
    buffer_load_dwordx4 v15, s[12:15], s43 offen lds
    s_add_u32 s43, s41, 0x300000
    s_add_u32 m0, s51, 0x26000
    s_nop 0
    buffer_load_dwordx4 v15, s[12:15], s43 offen lds
    s_add_u32 s43, s41, 0x380000
    s_add_u32 m0, s51, 0x27000
    s_nop 0
    buffer_load_dwordx4 v15, s[12:15], s43 offen lds
    s_waitcnt vmcnt(24)
    v_min_u32 v21, 0xfffffffe, v21
    s_mov_b32 s43, 0x10000
    s_mov_b64 exec, s[38:39]
    buffer_store_dword v21, v119, s[8:11], s43 offen
    s_mov_b64 exec, -1
    s_barrier
    v_xor_b32 v13, 0, v11
    v_add_u32 v13, 0x0, v13
    ds_read_b64_tr_b16 a[128:129], v13
    ds_read_b64_tr_b16 a[130:131], v13 offset:1024
    ds_read_b64_tr_b16 a[132:133], v13 offset:16384
    ds_read_b64_tr_b16 a[134:135], v13 offset:17408
    ds_read_b64_tr_b16 a[144:145], v13 offset:4096
    ds_read_b64_tr_b16 a[146:147], v13 offset:5120
    ds_read_b64_tr_b16 a[148:149], v13 offset:20480
    ds_read_b64_tr_b16 a[150:151], v13 offset:21504
    s_waitcnt lgkmcnt(0)
    v_xor_b32 v13, 32, v11
    v_add_u32 v13, 0x0, v13
    ds_read_b64_tr_b16 a[136:137], v13
    ds_read_b64_tr_b16 a[138:139], v13 offset:1024
    ds_read_b64_tr_b16 a[140:141], v13 offset:16384
    ds_read_b64_tr_b16 a[142:143], v13 offset:17408
    ds_read_b64_tr_b16 a[152:153], v13 offset:4096
    ds_read_b64_tr_b16 a[154:155], v13 offset:5120
    ds_read_b64_tr_b16 a[156:157], v13 offset:20480
    ds_read_b64_tr_b16 a[158:159], v13 offset:21504
    s_waitcnt lgkmcnt(0)
    s_barrier
    v_xor_b32 v15, 2, v14
    v_lshl_add_u32 v15, v15, 15, v8
    s_add_u32 s43, s41, 0x0
    s_add_u32 m0, s51, 0x8000
    s_nop 0
    buffer_load_dwordx4 v15, s[12:15], s43 offen lds
    s_add_u32 s43, s41, 0x80000
    s_add_u32 m0, s51, 0x9000
    s_nop 0
    buffer_load_dwordx4 v15, s[12:15], s43 offen lds
    s_add_u32 s43, s41, 0x100000
    s_add_u32 m0, s51, 0xa000
    s_nop 0
    buffer_load_dwordx4 v15, s[12:15], s43 offen lds
    s_add_u32 s43, s41, 0x180000
    s_add_u32 m0, s51, 0xb000
    s_nop 0
    buffer_load_dwordx4 v15, s[12:15], s43 offen lds
    s_add_u32 s43, s41, 0x200000
    s_add_u32 m0, s51, 0xc000
    s_nop 0
    buffer_load_dwordx4 v15, s[12:15], s43 offen lds
    s_add_u32 s43, s41, 0x280000
    s_add_u32 m0, s51, 0xd000
    s_nop 0
    buffer_load_dwordx4 v15, s[12:15], s43 offen lds
    s_add_u32 s43, s41, 0x300000
    s_add_u32 m0, s51, 0xe000
    s_nop 0
    buffer_load_dwordx4 v15, s[12:15], s43 offen lds
    s_add_u32 s43, s41, 0x380000
    s_add_u32 m0, s51, 0xf000
    s_nop 0
    buffer_load_dwordx4 v15, s[12:15], s43 offen lds
    s_waitcnt vmcnt(24)
    s_barrier
    v_xor_b32 v13, 0, v11
    v_add_u32 v13, 0x8000, v13
    ds_read_b64_tr_b16 a[160:161], v13
    ds_read_b64_tr_b16 a[162:163], v13 offset:1024
    ds_read_b64_tr_b16 a[164:165], v13 offset:16384
    ds_read_b64_tr_b16 a[166:167], v13 offset:17408
    ds_read_b64_tr_b16 a[176:177], v13 offset:4096
    ds_read_b64_tr_b16 a[178:179], v13 offset:5120
    ds_read_b64_tr_b16 a[180:181], v13 offset:20480
    ds_read_b64_tr_b16 a[182:183], v13 offset:21504
    s_waitcnt lgkmcnt(0)
    v_xor_b32 v13, 32, v11
    v_add_u32 v13, 0x8000, v13
    ds_read_b64_tr_b16 a[168:169], v13
    ds_read_b64_tr_b16 a[170:171], v13 offset:1024
    ds_read_b64_tr_b16 a[172:173], v13 offset:16384
    ds_read_b64_tr_b16 a[174:175], v13 offset:17408
    ds_read_b64_tr_b16 a[184:185], v13 offset:4096
    ds_read_b64_tr_b16 a[186:187], v13 offset:5120
    ds_read_b64_tr_b16 a[188:189], v13 offset:20480
    ds_read_b64_tr_b16 a[190:191], v13 offset:21504
    s_waitcnt lgkmcnt(0)
    s_barrier
    v_xor_b32 v15, 3, v14
    v_lshl_add_u32 v15, v15, 15, v8
    s_add_u32 s43, s41, 0x0
    s_add_u32 m0, s51, 0x10000
    s_nop 0
    buffer_load_dwordx4 v15, s[12:15], s43 offen lds
    s_add_u32 s43, s41, 0x80000
    s_add_u32 m0, s51, 0x11000
    s_nop 0
    buffer_load_dwordx4 v15, s[12:15], s43 offen lds
    s_add_u32 s43, s41, 0x100000
    s_add_u32 m0, s51, 0x12000
    s_nop 0
    buffer_load_dwordx4 v15, s[12:15], s43 offen lds
    s_add_u32 s43, s41, 0x180000
    s_add_u32 m0, s51, 0x13000
    s_nop 0
    buffer_load_dwordx4 v15, s[12:15], s43 offen lds
    s_add_u32 s43, s41, 0x200000
    s_add_u32 m0, s51, 0x14000
    s_nop 0
    buffer_load_dwordx4 v15, s[12:15], s43 offen lds
    s_add_u32 s43, s41, 0x280000
    s_add_u32 m0, s51, 0x15000
    s_nop 0
    buffer_load_dwordx4 v15, s[12:15], s43 offen lds
    s_add_u32 s43, s41, 0x300000
    s_add_u32 m0, s51, 0x16000
    s_nop 0
    buffer_load_dwordx4 v15, s[12:15], s43 offen lds
    s_add_u32 s43, s41, 0x380000
    s_add_u32 m0, s51, 0x17000
    s_nop 0
    buffer_load_dwordx4 v15, s[12:15], s43 offen lds
    s_waitcnt vmcnt(24)
    s_barrier
    v_xor_b32 v13, 0, v11
    v_add_u32 v13, 0x10000, v13
    ds_read_b64_tr_b16 a[192:193], v13
    ds_read_b64_tr_b16 a[194:195], v13 offset:1024
    ds_read_b64_tr_b16 a[196:197], v13 offset:16384
    ds_read_b64_tr_b16 a[198:199], v13 offset:17408
    ds_read_b64_tr_b16 a[208:209], v13 offset:4096
    ds_read_b64_tr_b16 a[210:211], v13 offset:5120
    ds_read_b64_tr_b16 a[212:213], v13 offset:20480
    ds_read_b64_tr_b16 a[214:215], v13 offset:21504
    s_waitcnt lgkmcnt(0)
    v_xor_b32 v13, 32, v11
    v_add_u32 v13, 0x10000, v13
    ds_read_b64_tr_b16 a[200:201], v13
    ds_read_b64_tr_b16 a[202:203], v13 offset:1024
    ds_read_b64_tr_b16 a[204:205], v13 offset:16384
    ds_read_b64_tr_b16 a[206:207], v13 offset:17408
    ds_read_b64_tr_b16 a[216:217], v13 offset:4096
    ds_read_b64_tr_b16 a[218:219], v13 offset:5120
    ds_read_b64_tr_b16 a[220:221], v13 offset:20480
    ds_read_b64_tr_b16 a[222:223], v13 offset:21504
    s_waitcnt lgkmcnt(0)
    s_barrier
    s_mov_b32 s12, s66
    s_and_b32 s13, s67, 0xffff
    s_add_u32 s43, s42, 0x0
    s_add_u32 m0, s51, 0x18000
    s_nop 0
    buffer_load_dwordx4 v10, s[12:15], s43 offen lds
    s_add_u32 s43, s42, 0x4000
    s_add_u32 m0, s51, 0x19000
    s_nop 0
    buffer_load_dwordx4 v9, s[12:15], s43 offen lds
    s_add_u32 s43, s42, 0x8000
    s_add_u32 m0, s51, 0x1a000
    s_nop 0
    buffer_load_dwordx4 v10, s[12:15], s43 offen lds
    s_add_u32 s43, s42, 0xc000
    s_add_u32 m0, s51, 0x1b000
    s_nop 0
    buffer_load_dwordx4 v9, s[12:15], s43 offen lds
    s_add_u32 s43, s42, 0x10000
    s_add_u32 m0, s51, 0x1c000
    s_nop 0
    buffer_load_dwordx4 v10, s[12:15], s43 offen lds
    s_add_u32 s43, s42, 0x14000
    s_add_u32 m0, s51, 0x1d000
    s_nop 0
    buffer_load_dwordx4 v9, s[12:15], s43 offen lds
    s_add_u32 s43, s42, 0x18000
    s_add_u32 m0, s51, 0x1e000
    s_nop 0
    buffer_load_dwordx4 v10, s[12:15], s43 offen lds
    s_add_u32 s43, s42, 0x1c000
    s_add_u32 m0, s51, 0x1f000
    s_nop 0
    buffer_load_dwordx4 v9, s[12:15], s43 offen lds
    s_waitcnt vmcnt(24)
    s_barrier
    v_xor_b32 v13, 0, v11
    v_add_u32 v13, 0x18000, v13
    ds_read_b64_tr_b16 a[224:225], v13
    ds_read_b64_tr_b16 a[226:227], v13 offset:1024
    ds_read_b64_tr_b16 a[228:229], v13 offset:16384
    ds_read_b64_tr_b16 a[230:231], v13 offset:17408
    ds_read_b64_tr_b16 a[240:241], v13 offset:4096
    ds_read_b64_tr_b16 a[242:243], v13 offset:5120
    ds_read_b64_tr_b16 a[244:245], v13 offset:20480
    ds_read_b64_tr_b16 a[246:247], v13 offset:21504
    s_waitcnt lgkmcnt(0)
    v_xor_b32 v13, 32, v11
    v_add_u32 v13, 0x18000, v13
    ds_read_b64_tr_b16 a[232:233], v13
    ds_read_b64_tr_b16 a[234:235], v13 offset:1024
    ds_read_b64_tr_b16 a[236:237], v13 offset:16384
    ds_read_b64_tr_b16 a[238:239], v13 offset:17408
    ds_read_b64_tr_b16 a[248:249], v13 offset:4096
    ds_read_b64_tr_b16 a[250:251], v13 offset:5120
    ds_read_b64_tr_b16 a[252:253], v13 offset:20480
    ds_read_b64_tr_b16 a[254:255], v13 offset:21504
    s_waitcnt lgkmcnt(0)
    s_barrier
    s_add_u32 s43, s42, 0x40
    s_add_u32 m0, s51, 0x20000
    s_nop 0
    buffer_load_dwordx4 v10, s[12:15], s43 offen lds
    s_add_u32 s43, s42, 0x4040
    s_add_u32 m0, s51, 0x21000
    s_nop 0
    buffer_load_dwordx4 v9, s[12:15], s43 offen lds
    s_add_u32 s43, s42, 0x8040
    s_add_u32 m0, s51, 0x22000
    s_nop 0
    buffer_load_dwordx4 v10, s[12:15], s43 offen lds
    s_add_u32 s43, s42, 0xc040
    s_add_u32 m0, s51, 0x23000
    s_nop 0
    buffer_load_dwordx4 v9, s[12:15], s43 offen lds
    s_add_u32 s43, s42, 0x10040
    s_add_u32 m0, s51, 0x24000
    s_nop 0
    buffer_load_dwordx4 v10, s[12:15], s43 offen lds
    s_add_u32 s43, s42, 0x14040
    s_add_u32 m0, s51, 0x25000
    s_nop 0
    buffer_load_dwordx4 v9, s[12:15], s43 offen lds
    s_add_u32 s43, s42, 0x18040
    s_add_u32 m0, s51, 0x26000
    s_nop 0
    buffer_load_dwordx4 v10, s[12:15], s43 offen lds
    s_add_u32 s43, s42, 0x1c040
    s_add_u32 m0, s51, 0x27000
    s_nop 0
    buffer_load_dwordx4 v9, s[12:15], s43 offen lds
    s_waitcnt vmcnt(24)
    s_barrier
    v_xor_b32 v13, 0, v11
    v_add_u32 v13, 0x0, v13
    ds_read_b64_tr_b16 v[128:129], v13
    ds_read_b64_tr_b16 v[130:131], v13 offset:1024
    ds_read_b64_tr_b16 v[132:133], v13 offset:16384
    ds_read_b64_tr_b16 v[134:135], v13 offset:17408
    ds_read_b64_tr_b16 v[144:145], v13 offset:4096
    ds_read_b64_tr_b16 v[146:147], v13 offset:5120
    ds_read_b64_tr_b16 v[148:149], v13 offset:20480
    ds_read_b64_tr_b16 v[150:151], v13 offset:21504
    s_waitcnt lgkmcnt(0)
    v_xor_b32 v13, 32, v11
    v_add_u32 v13, 0x0, v13
    ds_read_b64_tr_b16 v[136:137], v13
    ds_read_b64_tr_b16 v[138:139], v13 offset:1024
    ds_read_b64_tr_b16 v[140:141], v13 offset:16384
    ds_read_b64_tr_b16 v[142:143], v13 offset:17408
    ds_read_b64_tr_b16 v[152:153], v13 offset:4096
    ds_read_b64_tr_b16 v[154:155], v13 offset:5120
    ds_read_b64_tr_b16 v[156:157], v13 offset:20480
    ds_read_b64_tr_b16 v[158:159], v13 offset:21504
    s_waitcnt lgkmcnt(0)
    s_barrier
    s_mov_b32 s12, s60
    s_and_b32 s13, s61, 0xffff
    v_xor_b32 v15, 0, v14
    v_lshl_add_u32 v15, v15, 15, v8
    s_add_u32 s43, s41, 0x0
    s_add_u32 m0, s51, 0x8000
    s_nop 0
    buffer_load_dwordx4 v15, s[12:15], s43 offen lds
    s_add_u32 s43, s41, 0x80000
    s_add_u32 m0, s51, 0x9000
    s_nop 0
    buffer_load_dwordx4 v15, s[12:15], s43 offen lds
    s_add_u32 s43, s41, 0x100000
    s_add_u32 m0, s51, 0xa000
    s_nop 0
    buffer_load_dwordx4 v15, s[12:15], s43 offen lds
    s_add_u32 s43, s41, 0x180000
    s_add_u32 m0, s51, 0xb000
    s_nop 0
    buffer_load_dwordx4 v15, s[12:15], s43 offen lds
    s_add_u32 s43, s41, 0x200000
    s_add_u32 m0, s51, 0xc000
    s_nop 0
    buffer_load_dwordx4 v15, s[12:15], s43 offen lds
    s_add_u32 s43, s41, 0x280000
    s_add_u32 m0, s51, 0xd000
    s_nop 0
    buffer_load_dwordx4 v15, s[12:15], s43 offen lds
    s_add_u32 s43, s41, 0x300000
    s_add_u32 m0, s51, 0xe000
    s_nop 0
    buffer_load_dwordx4 v15, s[12:15], s43 offen lds
    s_add_u32 s43, s41, 0x380000
    s_add_u32 m0, s51, 0xf000
    s_nop 0
    buffer_load_dwordx4 v15, s[12:15], s43 offen lds
    s_waitcnt vmcnt(24)
    s_barrier
    s_cmp_lg_u32 s21, 0
    s_cbranch_scc1 L_arr_4
    v_mov_b32 v23, 1
    s_mov_b64 exec, 1
    buffer_atomic_add v23, off, s[16:19], 0 offset:4
    s_mov_b64 exec, -1
L_arr_4:
    v_xor_b32 v13, 0, v11
    v_add_u32 v13, 0x8000, v13
    ds_read_b64_tr_b16 v[160:161], v13
    ds_read_b64_tr_b16 v[162:163], v13 offset:1024
    ds_read_b64_tr_b16 v[164:165], v13 offset:16384
    ds_read_b64_tr_b16 v[166:167], v13 offset:17408
    ds_read_b64_tr_b16 v[176:177], v13 offset:4096
    ds_read_b64_tr_b16 v[178:179], v13 offset:5120
    ds_read_b64_tr_b16 v[180:181], v13 offset:20480
    ds_read_b64_tr_b16 v[182:183], v13 offset:21504
    s_waitcnt lgkmcnt(0)
    v_xor_b32 v13, 32, v11
    v_add_u32 v13, 0x8000, v13
    ds_read_b64_tr_b16 v[168:169], v13
    ds_read_b64_tr_b16 v[170:171], v13 offset:1024
    ds_read_b64_tr_b16 v[172:173], v13 offset:16384
    ds_read_b64_tr_b16 v[174:175], v13 offset:17408
    ds_read_b64_tr_b16 v[184:185], v13 offset:4096
    ds_read_b64_tr_b16 v[186:187], v13 offset:5120
    ds_read_b64_tr_b16 v[188:189], v13 offset:20480
    ds_read_b64_tr_b16 v[190:191], v13 offset:21504
    s_waitcnt lgkmcnt(0)
    s_barrier
    s_mov_b32 s12, s62
    s_and_b32 s13, s63, 0xffff
    v_xor_b32 v15, 0, v14
    v_lshl_add_u32 v15, v15, 15, v8
    s_add_u32 s43, s41, 0x0
    s_add_u32 m0, s51, 0x10000
    s_nop 0
    buffer_load_dwordx4 v15, s[12:15], s43 offen lds
    s_add_u32 s43, s41, 0x80000
    s_add_u32 m0, s51, 0x11000
    s_nop 0
    buffer_load_dwordx4 v15, s[12:15], s43 offen lds
    s_add_u32 s43, s41, 0x100000
    s_add_u32 m0, s51, 0x12000
    s_nop 0
    buffer_load_dwordx4 v15, s[12:15], s43 offen lds
    s_add_u32 s43, s41, 0x180000
    s_add_u32 m0, s51, 0x13000
    s_nop 0
    buffer_load_dwordx4 v15, s[12:15], s43 offen lds
    s_add_u32 s43, s41, 0x200000
    s_add_u32 m0, s51, 0x14000
    s_nop 0
    buffer_load_dwordx4 v15, s[12:15], s43 offen lds
    s_add_u32 s43, s41, 0x280000
    s_add_u32 m0, s51, 0x15000
    s_nop 0
    buffer_load_dwordx4 v15, s[12:15], s43 offen lds
    s_add_u32 s43, s41, 0x300000
    s_add_u32 m0, s51, 0x16000
    s_nop 0
    buffer_load_dwordx4 v15, s[12:15], s43 offen lds
    s_add_u32 s43, s41, 0x380000
    s_add_u32 m0, s51, 0x17000
    s_nop 0
    buffer_load_dwordx4 v15, s[12:15], s43 offen lds
    s_waitcnt vmcnt(24)
    s_barrier
    v_xor_b32 v13, 0x0, v12
    v_add_u32 v13, 0x10000, v13
    ds_read_b64_tr_b16 v[192:193], v13
    ds_read_b64_tr_b16 v[194:195], v13 offset:512
    ds_read_b64_tr_b16 v[196:197], v13 offset:2048
    ds_read_b64_tr_b16 v[198:199], v13 offset:2560
    v_xor_b32 v13, 0x2000, v12
    v_add_u32 v13, 0x10000, v13
    ds_read_b64_tr_b16 v[200:201], v13
    ds_read_b64_tr_b16 v[202:203], v13 offset:512
    ds_read_b64_tr_b16 v[204:205], v13 offset:2048
    ds_read_b64_tr_b16 v[206:207], v13 offset:2560
    s_waitcnt lgkmcnt(0)
    v_xor_b32 v13, 0x4000, v12
    v_add_u32 v13, 0x10000, v13
    ds_read_b64_tr_b16 v[208:209], v13
    ds_read_b64_tr_b16 v[210:211], v13 offset:512
    ds_read_b64_tr_b16 v[212:213], v13 offset:2048
    ds_read_b64_tr_b16 v[214:215], v13 offset:2560
    v_xor_b32 v13, 0x6000, v12
    v_add_u32 v13, 0x10000, v13
    ds_read_b64_tr_b16 v[216:217], v13
    ds_read_b64_tr_b16 v[218:219], v13 offset:512
    ds_read_b64_tr_b16 v[220:221], v13 offset:2048
    ds_read_b64_tr_b16 v[222:223], v13 offset:2560
    s_waitcnt lgkmcnt(0)
    s_barrier
    s_mov_b32 s12, s66
    s_and_b32 s13, s67, 0xffff
    s_add_u32 s43, s42, 0x80
    s_add_u32 m0, s51, 0x18000
    s_nop 0
    buffer_load_dwordx4 v10, s[12:15], s43 offen lds
    s_add_u32 s43, s42, 0x4080
    s_add_u32 m0, s51, 0x19000
    s_nop 0
    buffer_load_dwordx4 v9, s[12:15], s43 offen lds
    s_add_u32 s43, s42, 0x8080
    s_add_u32 m0, s51, 0x1a000
    s_nop 0
    buffer_load_dwordx4 v10, s[12:15], s43 offen lds
    s_add_u32 s43, s42, 0xc080
    s_add_u32 m0, s51, 0x1b000
    s_nop 0
    buffer_load_dwordx4 v9, s[12:15], s43 offen lds
    s_add_u32 s43, s42, 0x10080
    s_add_u32 m0, s51, 0x1c000
    s_nop 0
    buffer_load_dwordx4 v10, s[12:15], s43 offen lds
    s_add_u32 s43, s42, 0x14080
    s_add_u32 m0, s51, 0x1d000
    s_nop 0
    buffer_load_dwordx4 v9, s[12:15], s43 offen lds
    s_add_u32 s43, s42, 0x18080
    s_add_u32 m0, s51, 0x1e000
    s_nop 0
    buffer_load_dwordx4 v10, s[12:15], s43 offen lds
    s_add_u32 s43, s42, 0x1c080
    s_add_u32 m0, s51, 0x1f000
    s_nop 0
    buffer_load_dwordx4 v9, s[12:15], s43 offen lds
    s_waitcnt vmcnt(24)
    s_barrier
    v_xor_b32 v13, 0x0, v12
    v_add_u32 v13, 0x18000, v13
    ds_read_b64_tr_b16 v[224:225], v13
    ds_read_b64_tr_b16 v[226:227], v13 offset:512
    ds_read_b64_tr_b16 v[228:229], v13 offset:2048
    ds_read_b64_tr_b16 v[230:231], v13 offset:2560
    v_xor_b32 v13, 0x2000, v12
    v_add_u32 v13, 0x18000, v13
    ds_read_b64_tr_b16 v[232:233], v13
    ds_read_b64_tr_b16 v[234:235], v13 offset:512
    ds_read_b64_tr_b16 v[236:237], v13 offset:2048
    ds_read_b64_tr_b16 v[238:239], v13 offset:2560
    s_waitcnt lgkmcnt(0)
    v_xor_b32 v13, 0x4000, v12
    v_add_u32 v13, 0x18000, v13
    ds_read_b64_tr_b16 v[240:241], v13
    ds_read_b64_tr_b16 v[242:243], v13 offset:512
    ds_read_b64_tr_b16 v[244:245], v13 offset:2048
    ds_read_b64_tr_b16 v[246:247], v13 offset:2560
    v_xor_b32 v13, 0x6000, v12
    v_add_u32 v13, 0x18000, v13
    ds_read_b64_tr_b16 v[248:249], v13
    ds_read_b64_tr_b16 v[250:251], v13 offset:512
    ds_read_b64_tr_b16 v[252:253], v13 offset:2048
    ds_read_b64_tr_b16 v[254:255], v13 offset:2560
    s_waitcnt lgkmcnt(0)
    s_barrier
    s_add_u32 s43, s42, 0xc0
    s_add_u32 m0, s51, 0x20000
    s_nop 0
    buffer_load_dwordx4 v10, s[12:15], s43 offen lds
    s_add_u32 s43, s42, 0x40c0
    s_add_u32 m0, s51, 0x21000
    s_nop 0
    buffer_load_dwordx4 v9, s[12:15], s43 offen lds
    s_add_u32 s43, s42, 0x80c0
    s_add_u32 m0, s51, 0x22000
    s_nop 0
    buffer_load_dwordx4 v10, s[12:15], s43 offen lds
    s_add_u32 s43, s42, 0xc0c0
    s_add_u32 m0, s51, 0x23000
    s_nop 0
    buffer_load_dwordx4 v9, s[12:15], s43 offen lds
    s_add_u32 s43, s42, 0x100c0
    s_add_u32 m0, s51, 0x24000
    s_nop 0
    buffer_load_dwordx4 v10, s[12:15], s43 offen lds
    s_add_u32 s43, s42, 0x140c0
    s_add_u32 m0, s51, 0x25000
    s_nop 0
    buffer_load_dwordx4 v9, s[12:15], s43 offen lds
    s_add_u32 s43, s42, 0x180c0
    s_add_u32 m0, s51, 0x26000
    s_nop 0
    buffer_load_dwordx4 v10, s[12:15], s43 offen lds
    s_add_u32 s43, s42, 0x1c0c0
    s_add_u32 m0, s51, 0x27000
    s_nop 0
    buffer_load_dwordx4 v9, s[12:15], s43 offen lds
    s_waitcnt vmcnt(24)
    s_barrier
    v_xor_b32 v13, 0, v11
    v_add_u32 v13, 0x0, v13
    ds_read_b64_tr_b16 v[32:33], v13
    ds_read_b64_tr_b16 v[34:35], v13 offset:1024
    ds_read_b64_tr_b16 v[36:37], v13 offset:16384
    ds_read_b64_tr_b16 v[38:39], v13 offset:17408
    ds_read_b64_tr_b16 v[48:49], v13 offset:4096
    ds_read_b64_tr_b16 v[50:51], v13 offset:5120
    ds_read_b64_tr_b16 v[52:53], v13 offset:20480
    ds_read_b64_tr_b16 v[54:55], v13 offset:21504
    s_waitcnt lgkmcnt(0)
    v_xor_b32 v13, 32, v11
    v_add_u32 v13, 0x0, v13
    ds_read_b64_tr_b16 v[40:41], v13
    ds_read_b64_tr_b16 v[42:43], v13 offset:1024
    ds_read_b64_tr_b16 v[44:45], v13 offset:16384
    ds_read_b64_tr_b16 v[46:47], v13 offset:17408
    ds_read_b64_tr_b16 v[56:57], v13 offset:4096
    ds_read_b64_tr_b16 v[58:59], v13 offset:5120
    ds_read_b64_tr_b16 v[60:61], v13 offset:20480
    ds_read_b64_tr_b16 v[62:63], v13 offset:21504
    s_waitcnt lgkmcnt(0)
    s_barrier
    ds_write_b128 v123, v[32:35]
    ds_write_b128 v123, v[36:39] offset:1024
    ds_write_b128 v123, v[40:43] offset:2048
    ds_write_b128 v123, v[44:47] offset:3072
    ds_write_b128 v123, v[48:51] offset:4096
    ds_write_b128 v123, v[52:55] offset:5120
    ds_write_b128 v123, v[56:59] offset:6144
    ds_write_b128 v123, v[60:63] offset:7168
    s_waitcnt vmcnt(16)
    s_barrier
    v_xor_b32 v13, 0, v11
    v_add_u32 v13, 0x8000, v13
    ds_read_b64_tr_b16 v[32:33], v13
    ds_read_b64_tr_b16 v[34:35], v13 offset:1024
    ds_read_b64_tr_b16 v[36:37], v13 offset:16384
    ds_read_b64_tr_b16 v[38:39], v13 offset:17408
    ds_read_b64_tr_b16 v[48:49], v13 offset:4096
    ds_read_b64_tr_b16 v[50:51], v13 offset:5120
    ds_read_b64_tr_b16 v[52:53], v13 offset:20480
    ds_read_b64_tr_b16 v[54:55], v13 offset:21504
    s_waitcnt lgkmcnt(0)
    v_xor_b32 v13, 32, v11
    v_add_u32 v13, 0x8000, v13
    ds_read_b64_tr_b16 v[40:41], v13
    ds_read_b64_tr_b16 v[42:43], v13 offset:1024
    ds_read_b64_tr_b16 v[44:45], v13 offset:16384
    ds_read_b64_tr_b16 v[46:47], v13 offset:17408
    ds_read_b64_tr_b16 v[56:57], v13 offset:4096
    ds_read_b64_tr_b16 v[58:59], v13 offset:5120
    ds_read_b64_tr_b16 v[60:61], v13 offset:20480
    ds_read_b64_tr_b16 v[62:63], v13 offset:21504
    s_waitcnt lgkmcnt(0)
    s_barrier
    ds_write_b128 v123, v[32:35] offset:32768
    ds_write_b128 v123, v[36:39] offset:33792
    ds_write_b128 v123, v[40:43] offset:34816
    ds_write_b128 v123, v[44:47] offset:35840
    ds_write_b128 v123, v[48:51] offset:36864
    ds_write_b128 v123, v[52:55] offset:37888
    ds_write_b128 v123, v[56:59] offset:38912
    ds_write_b128 v123, v[60:63] offset:39936
    s_waitcnt vmcnt(8)
    s_barrier
    v_xor_b32 v13, 0x0, v12
    v_add_u32 v13, 0x10000, v13
    ds_read_b64_tr_b16 v[32:33], v13
    ds_read_b64_tr_b16 v[34:35], v13 offset:512
    ds_read_b64_tr_b16 v[36:37], v13 offset:2048
    ds_read_b64_tr_b16 v[38:39], v13 offset:2560
    v_xor_b32 v13, 0x2000, v12
    v_add_u32 v13, 0x10000, v13
    ds_read_b64_tr_b16 v[40:41], v13
    ds_read_b64_tr_b16 v[42:43], v13 offset:512
    ds_read_b64_tr_b16 v[44:45], v13 offset:2048
    ds_read_b64_tr_b16 v[46:47], v13 offset:2560
    s_waitcnt lgkmcnt(0)
    v_xor_b32 v13, 0x4000, v12
    v_add_u32 v13, 0x10000, v13
    ds_read_b64_tr_b16 v[48:49], v13
    ds_read_b64_tr_b16 v[50:51], v13 offset:512
    ds_read_b64_tr_b16 v[52:53], v13 offset:2048
    ds_read_b64_tr_b16 v[54:55], v13 offset:2560
    v_xor_b32 v13, 0x6000, v12
    v_add_u32 v13, 0x10000, v13
    ds_read_b64_tr_b16 v[56:57], v13
    ds_read_b64_tr_b16 v[58:59], v13 offset:512
    ds_read_b64_tr_b16 v[60:61], v13 offset:2048
    ds_read_b64_tr_b16 v[62:63], v13 offset:2560
    s_waitcnt lgkmcnt(0)
    s_barrier
    ds_write_b128 v124, v[32:35]
    ds_write_b128 v124, v[36:39] offset:1024
    ds_write_b128 v124, v[40:43] offset:2048
    ds_write_b128 v124, v[44:47] offset:3072
    ds_write_b128 v124, v[48:51] offset:4096
    ds_write_b128 v124, v[52:55] offset:5120
    ds_write_b128 v124, v[56:59] offset:6144
    ds_write_b128 v124, v[60:63] offset:7168
    s_waitcnt vmcnt(0)
    s_barrier
    v_xor_b32 v13, 0x0, v12
    v_add_u32 v13, 0x18000, v13
    ds_read_b64_tr_b16 v[32:33], v13
    ds_read_b64_tr_b16 v[34:35], v13 offset:512
    ds_read_b64_tr_b16 v[36:37], v13 offset:2048
    ds_read_b64_tr_b16 v[38:39], v13 offset:2560
    v_xor_b32 v13, 0x2000, v12
    v_add_u32 v13, 0x18000, v13
    ds_read_b64_tr_b16 v[40:41], v13
    ds_read_b64_tr_b16 v[42:43], v13 offset:512
    ds_read_b64_tr_b16 v[44:45], v13 offset:2048
    ds_read_b64_tr_b16 v[46:47], v13 offset:2560
    s_waitcnt lgkmcnt(0)
    v_xor_b32 v13, 0x4000, v12
    v_add_u32 v13, 0x18000, v13
    ds_read_b64_tr_b16 v[48:49], v13
    ds_read_b64_tr_b16 v[50:51], v13 offset:512
    ds_read_b64_tr_b16 v[52:53], v13 offset:2048
    ds_read_b64_tr_b16 v[54:55], v13 offset:2560
    v_xor_b32 v13, 0x6000, v12
    v_add_u32 v13, 0x18000, v13
    ds_read_b64_tr_b16 v[56:57], v13
    ds_read_b64_tr_b16 v[58:59], v13 offset:512
    ds_read_b64_tr_b16 v[60:61], v13 offset:2048
    ds_read_b64_tr_b16 v[62:63], v13 offset:2560
    s_waitcnt lgkmcnt(0)
    s_barrier
    ds_write_b128 v124, v[32:35] offset:32768
    ds_write_b128 v124, v[36:39] offset:33792
    ds_write_b128 v124, v[40:43] offset:34816
    ds_write_b128 v124, v[44:47] offset:35840
    ds_write_b128 v124, v[48:51] offset:36864
    ds_write_b128 v124, v[52:55] offset:37888
    ds_write_b128 v124, v[56:59] offset:38912
    ds_write_b128 v124, v[60:63] offset:39936
    s_waitcnt lgkmcnt(0)
    s_mov_b32 s96, 0
L_mode_5:
    buffer_load_dwordx2 v[2:3], off, s[92:95], 0 offset:36 sc1
    s_waitcnt vmcnt(0)
    v_readfirstlane_b32 s87, v2
    v_readfirstlane_b32 s97, v3
    s_nop 0
    s_min_u32 s97, s97, s87
    s_cmp_lg_u32 s97, 0
    s_cbranch_scc1 L_moded_6
    s_sleep 4
    s_add_u32 s96, s96, 1
    s_cmp_lg_u32 s96, 0x100
    s_cbranch_scc1 L_modef_7
    v_mov_b32 v2, 2
    v_mov_b32 v3, 0
    s_mov_b64 exec, 1
    buffer_atomic_cmpswap v[2:3], off, s[92:95], 0 offset:36
    s_mov_b64 exec, -1
L_modef_7:
    s_cmp_lt_u32 s96, 0x10000
    s_cbranch_scc1 L_mode_5
L_moded_6:
    s_cmp_lg_u32 s87, 1
    s_cbranch_scc1 L_fallback
    v_lshrrev_b32 v1, 4, v117
    v_and_b32 v2, 15, v1
    v_lshrrev_b32 v1, 4, v1
    v_lshlrev_b32 v1, 11, v1
    v_lshl_add_u32 v1, v2, 2, v1
    s_lshl_b32 s43, s20, 6
    s_add_u32 s43, s43, 0x2000
    s_cmp_lg_u32 s100, 0
    s_cbranch_scc1 L_polls_10
    s_mov_b32 exec_lo, 0x10001
    s_mov_b32 exec_hi, 0
    s_mov_b32 s96, 0
L_poll_8:
    buffer_load_dword v2, v1, s[8:11], s43 offen sc1
    s_waitcnt vmcnt(0)
    v_cmp_gt_u32 vcc, 1, v2
    s_cbranch_vccz L_polld_9
    s_sleep 4
    s_add_u32 s96, s96, 1
    s_cmp_lt_u32 s96, 0x10000
    s_cbranch_scc1 L_poll_8
L_polld_9:
    s_mov_b64 exec, -1
L_polls_10:
    s_barrier
    s_mov_b32 s22, 0
    s_mov_b32 s33, 0
    s_xor_b32 s53, s29, 1024
    s_add_u32 s23, s51, 0x10000
    s_add_u32 s48, s23, 4096
    s_mov_b32 s24, 0x12000
    s_add_u32 s55, s24, 16384
    s_mov_b32 s25, 0x100000
    s_mov_b32 s26, 0x101000
    s_lshl_b32 s43, s20, 13
    v_mov_b32 v112, 0
    v_mov_b32 v113, 0
    v_mov_b32 v114, 0
    v_mov_b32 v115, 0
    s_add_u32 s43, s43, s52
    s_add_u32 s30, s43, 0x1000000
    s_add_u32 s31, s43, 0x2000000
    s_lshr_b32 s43, s43, 1
    s_add_u32 s32, s43, 0x220000
    s_add_u32 m0, s52, 8192
    s_nop 0
    buffer_load_dwordx4 v117, s[8:11], s30 offen lds
    buffer_load_dwordx4 v117, s[8:11], s30 offen offset:1024 lds
    s_add_u32 m0, s52, 0x6000
    s_nop 0
    buffer_load_dwordx4 v117, s[8:11], s31 offen lds
    buffer_load_dwordx4 v117, s[8:11], s31 offen offset:1024 lds
    s_add_u32 m0, s51, 4096
    ds_write_b128 v117, v[112:115] offset:22528
    ds_write_b128 v117, v[112:115] offset:23552
    s_cmp_lg_u32 s21, 0
    s_cselect_b32 s40, -1, 0
    v_mov_b32 v126, s40
    v_bfe_u32 v1, v117, 4, 1
    v_lshlrev_b32 v1, 4, v1
    s_movk_i32 s43, 0x3f80
    v_lshlrev_b32 v125, v1, s43
    v_bfe_u32 v1, v117, 5, 3
    v_cmp_eq_u32 s[68:69], 0, v1
    v_cmp_eq_u32 s[70:71], 1, v1
    v_cmp_eq_u32 s[72:73], 2, v1
    v_cmp_eq_u32 s[74:75], 3, v1
    v_lshrrev_b32 v1, 2, v117
    s_cmp_lt_u32 s21, 2
    s_cselect_b64 vcc, -1, 0
    v_cndmask_b32 v119, v119, v1, vcc
    v_mov_b32 v32, 0
    v_mov_b32 v33, 0
    v_mov_b32 v34, 0
    v_mov_b32 v35, 0
    v_mov_b32 v36, 0
    v_mov_b32 v37, 0
    v_mov_b32 v38, 0
    v_mov_b32 v39, 0
    v_mov_b32 v40, 0
    v_mov_b32 v41, 0
    v_mov_b32 v42, 0
    v_mov_b32 v43, 0
    v_mov_b32 v44, 0
    v_mov_b32 v45, 0
    v_mov_b32 v46, 0
    v_mov_b32 v47, 0
    v_mov_b32 v48, 0
    v_mov_b32 v49, 0
    v_mov_b32 v50, 0
    v_mov_b32 v51, 0
    v_mov_b32 v52, 0
    v_mov_b32 v53, 0
    v_mov_b32 v54, 0
    v_mov_b32 v55, 0
    s_add_u32 s30, s30, 0x40000
    s_add_u32 s31, s31, 0x40000
    s_mov_b32 s45, 0
    s_mov_b32 s46, 0
    s_mov_b32 s47, 0
    s_mov_b32 s76, 0
    s_and_b32 s43, s21, 1
    s_lshl_b32 s43, s43, 5
    s_add_u32 s43, s43, s20
    s_lshl_b32 s43, s43, 6
    s_add_u32 s28, s43, 0x2000
    s_mov_b32 s59, 0
    ds_read_b128 v[80:83], v123
    ds_read_b128 v[84:87], v123 offset:1024
    ds_read_b128 v[56:59], v123 offset:2048
    ds_read_b128 v[60:63], v123 offset:3072
    ds_read_b128 v[64:67], v123 offset:32768
    ds_read_b128 v[68:71], v123 offset:33792
    ds_read_b128 v[72:75], v123 offset:34816
    ds_read_b128 v[76:79], v123 offset:35840
    ds_read_b128 v[88:91], v123 offset:4096
    ds_read_b128 v[92:95], v123 offset:5120
    ds_read_b128 v[96:99], v123 offset:6144
    ds_read_b128 v[100:103], v123 offset:7168
    ds_read_b128 v[104:107], v123 offset:36864
    ds_read_b128 v[108:111], v123 offset:37888
    ds_read_b128 v[24:27], v123 offset:38912
    ds_read_b128 v[28:31], v123 offset:39936
    s_cmp_lg_u32 s21, 0
    s_cbranch_scc1 L_cb_skip_11
    v_mov_b32 v1, 4
    s_mov_b64 exec, 1
    s_mov_b32 s49, 0
L_cb_poll_12:
    buffer_load_dword v3, v1, s[16:19], 0 offen sc1
    s_waitcnt vmcnt(0)
    v_readfirstlane_b32 s43, v3
    s_nop 0
    s_cmp_ge_u32 s43, 32
    s_cbranch_scc1 L_cb_done_13
    s_sleep 2
    s_add_u32 s49, s49, 1
    s_cmp_lt_u32 s49, 0x40000
    s_cbranch_scc1 L_cb_poll_12
L_cb_done_13:
    s_mov_b64 exec, -1
L_cb_skip_11:
    s_mov_b32 s49, 0
    s_lshr_b32 s43, s20, 1
    s_lshl_b32 s43, s43, 7
    s_and_b32 s40, s20, 1
    s_lshl_b32 s40, s40, 4
    s_add_u32 s43, s43, s40
    s_add_u32 s44, s43, 0x1000
    s_cmp_eq_u32 s21, 0
    s_cselect_b32 s44, s44, 0x7ff00000
    s_waitcnt vmcnt(0) lgkmcnt(0)
    s_barrier
    buffer_load_dwordx4 v[0:3], v117, s[8:11], s23 offen sc1
    s_waitcnt vmcnt(0)
    s_cmp_eq_u32 s21, 1
    s_cbranch_scc1 L_chain_top1_f
    s_cmp_eq_u32 s21, 2
    s_cbranch_scc1 L_chain_top2_f
    s_cmp_eq_u32 s21, 3
    s_cbranch_scc1 L_chain_top3_f
.p2align 6
L_chain_top0_f:
    buffer_load_dwordx4 v[0:3], v117, s[8:11], s23 offen nt
    v_mov_b32 v15, 0
    v_mov_b32 v15, 0
    v_mov_b32 v15, 0
    v_mov_b32 v15, 0
    v_mov_b32 v15, 0
    v_mov_b32 v15, 0
    v_mov_b32 v15, 0
    v_mov_b32 v15, 0
    v_mov_b32 v15, 0
    v_mov_b32 v15, 0
    v_mov_b32 v15, 0
    v_mov_b32 v15, 0
    v_mov_b32 v15, 0
    v_mov_b32 v15, 0
    v_mov_b32 v15, 0
    v_mov_b32 v15, 0
    buffer_load_dwordx4 v[0:3], v117, s[8:11], s23 offen sc1
    v_mov_b32 v15, 0
    v_mov_b32 v15, 0
    v_mov_b32 v15, 0
    v_mov_b32 v15, 0
    v_mov_b32 v15, 0
    v_mov_b32 v15, 0
    v_mov_b32 v15, 0
    v_mov_b32 v15, 0
    v_mov_b32 v15, 0
    v_mov_b32 v15, 0
    v_mov_b32 v15, 0
    v_mov_b32 v15, 0
    v_mov_b32 v15, 0
    v_mov_b32 v15, 0
    v_mov_b32 v15, 0
    v_mov_b32 v15, 0
L_mret_14:
    buffer_load_dwordx4 v[0:3], v117, s[8:11], s23 offen sc1
    s_add_u32 s45, s45, 1
    s_cmp_lt_u32 s45, 0x10000
    s_cselect_b32 s56, -2, -1
    s_nop 3
    v_mov_b32 v32, 0
    v_mov_b32 v33, 0
    v_mov_b32 v34, 0
    v_mov_b32 v35, 0
    s_waitcnt vmcnt(2)
    v_max3_u32 v15, v0, v1, v2
    v_max_u32 v15, v15, v3
    v_cmp_lt_u32 vcc, s56, v15
    v_smfmac_f32_16x16x64_bf16 v[32:35], v[0:3], v[80:87], v116
    s_cbranch_vccnz L_mret_14
    ds_write_b128 v117, v[0:3]
    v_smfmac_f32_16x16x64_bf16 v[36:39], v[0:3], v[56:63], v116
    buffer_load_dwordx4 v[4:7], v117, s[8:11], s48 offen nt
    v_smfmac_f32_16x16x64_bf16 v[40:43], v[0:3], v[64:71], v116
    buffer_load_dwordx4 v117, s[8:11], s48 offen nt lds
    s_mov_b32 m0, 8192
    v_smfmac_f32_16x16x64_bf16 v[44:47], v[0:3], v[72:79], v116
    s_waitcnt lgkmcnt(0)
    s_barrier
    ds_read_b128 v[8:11], v117 offset:1024
    v_smfmac_f32_16x16x64_bf16 v[48:51], v[0:3], a[192:199], v116
    ds_read_b128 v[16:19], v117 offset:2048
    ds_read_b128 v[20:23], v117 offset:3072
    v_smfmac_f32_16x16x64_bf16 v[52:55], v[0:3], a[200:207], v116
    ds_read_b128 v[80:83], v117 offset:14336
    s_waitcnt lgkmcnt(3)
    v_smfmac_f32_16x16x64_bf16 v[32:35], v[8:11], a[0:7], v116
    ds_read_b128 v[84:87], v117 offset:15360
    v_smfmac_f32_16x16x64_bf16 v[36:39], v[8:11], a[8:15], v116
    buffer_store_dwordx4 v[112:115], v117, s[8:11], s32 offen sc1
    s_waitcnt lgkmcnt(3)
    v_smfmac_f32_16x16x64_bf16 v[32:35], v[16:19], a[32:39], v116
    ds_read_b128 v[56:59], v117 offset:8192
    v_smfmac_f32_16x16x64_bf16 v[36:39], v[16:19], a[40:47], v116
    ds_read_b128 v[60:63], v117 offset:9216
    s_waitcnt lgkmcnt(4)
    v_smfmac_f32_16x16x64_bf16 v[32:35], v[20:23], a[64:71], v116
    ds_read_b128 v[64:67], v117 offset:10240
    v_smfmac_f32_16x16x64_bf16 v[36:39], v[20:23], a[72:79], v116
    ds_read_b128 v[68:71], v117 offset:11264
    v_smfmac_f32_16x16x64_bf16 v[40:43], v[8:11], a[96:103], v116
    ds_read_b128 v[72:75], v117 offset:12288
    v_smfmac_f32_16x16x64_bf16 v[40:43], v[16:19], a[128:135], v116
    ds_read_b128 v[76:79], v117 offset:13312
    v_smfmac_f32_16x16x64_bf16 v[40:43], v[20:23], a[160:167], v116
    s_waitcnt vmcnt(2)
    v_max3_u32 v15, v4, v5, v6
    v_smfmac_f32_16x16x64_bf16 v[44:47], v[8:11], a[104:111], v116
    v_max_u32 v15, v15, v7
    v_smfmac_f32_16x16x64_bf16 v[44:47], v[16:19], a[136:143], v116
    s_waitcnt vmcnt(1) lgkmcnt(0)
    v_cmp_lt_u32 vcc, s56, v15
    v_smfmac_f32_16x16x64_bf16 v[44:47], v[20:23], a[168:175], v116
    s_cbranch_vccnz L_mret_15
L_mgo_16:
    v_smfmac_f32_16x16x64_bf16 v[44:47], v[4:7], v[24:31], v116
    s_barrier
    ds_read_b128 v[12:15], v117 offset:5120
    v_smfmac_f32_16x16x64_bf16 v[32:35], v[4:7], v[88:95], v116
    ds_read_b128 v[24:27], v117 offset:6144
    v_smfmac_f32_16x16x64_bf16 v[36:39], v[4:7], v[96:103], v116
    ds_read_b128 v[28:31], v117 offset:7168
    v_smfmac_f32_16x16x64_bf16 v[40:43], v[4:7], v[104:111], v116
    ds_read_b128 v[88:91], v117 offset:24576
    s_waitcnt lgkmcnt(3)
    v_smfmac_f32_16x16x64_bf16 v[32:35], v[12:15], a[16:23], v116
    ds_read_b128 v[92:95], v117 offset:25600
    s_waitcnt lgkmcnt(3)
    v_smfmac_f32_16x16x64_bf16 v[32:35], v[24:27], a[48:55], v116
    buffer_load_dwordx4 v117, s[8:11], s30 offen lds
    s_waitcnt lgkmcnt(2)
    v_smfmac_f32_16x16x64_bf16 v[32:35], v[28:31], a[80:87], v116
    ds_read_b128 v[96:99], v117 offset:23552
    v_smfmac_f32_16x16x64_bf16 v[36:39], v[12:15], a[24:31], v116
    ds_read_b128 v[100:103], v117 offset:23552
    v_smfmac_f32_16x16x64_bf16 v[36:39], v[24:27], a[56:63], v116
    buffer_load_dwordx4 v117, s[8:11], s30 offen offset:1024 lds
    s_add_u32 m0, s52, 0x6000
    v_add_f32 v32, v32, v34
    v_smfmac_f32_16x16x64_bf16 v[36:39], v[28:31], a[88:95], v116
    ds_read_b128 v[104:107], v117 offset:23552
    v_add_f32 v33, v33, v35
    v_smfmac_f32_16x16x64_bf16 v[40:43], v[12:15], a[112:119], v116
    ds_read_b128 v[108:111], v117 offset:23552
    v_mul_f32 v32, s34, v32
    v_smfmac_f32_16x16x64_bf16 v[40:43], v[24:27], a[144:151], v116
    buffer_load_dword v125, v119, s[8:11], s28 offen sc1
    v_mul_f32 v33, s34, v33
    v_smfmac_f32_16x16x64_bf16 v[40:43], v[28:31], a[176:183], v116
    ds_read_b128 v[0:3], v124
    v_add_f32 v36, v36, v38
    v_smfmac_f32_16x16x64_bf16 v[48:51], v[4:7], a[208:215], v116
    v_add_f32 v37, v37, v39
    v_smfmac_f32_16x16x64_bf16 v[52:55], v[4:7], a[216:223], v116
    s_waitcnt lgkmcnt(5)
    buffer_load_dwordx4 v117, s[8:11], s31 offen lds
    v_mul_f32 v36, s34, v36
    v_smfmac_f32_16x16x64_bf16 v[44:47], v[12:15], a[120:127], v116
    ds_read_b128 v[4:7], v124 offset:1024
    v_mul_f32 v37, s34, v37
    v_smfmac_f32_16x16x64_bf16 v[44:47], v[24:27], a[152:159], v116
    v_cvt_pk_bf16_f32 v34, v32, v36
    v_smfmac_f32_16x16x64_bf16 v[44:47], v[28:31], a[184:191], v116
    buffer_load_dwordx4 v117, s[8:11], s31 offen offset:1024 lds
    s_mov_b32 m0, 4096
    v_cvt_pk_bf16_f32 v35, v33, v37
    v_add_f32 v40, v40, v42
    v_smfmac_f32_16x16x64_bf16 v[48:51], v[8:11], a[224:231], v116
    ds_write2_b32 v120, v34, v35 offset0:32 offset1:48
    v_add_f32 v41, v41, v43
    v_smfmac_f32_16x16x64_bf16 v[52:55], v[8:11], a[232:239], v116
    v_add_f32 v44, v44, v46
    v_add_f32 v45, v45, v47
    v_cvt_pk_bf16_f32 v113, v40, v44
    v_cvt_pk_bf16_f32 v115, v41, v45
    v_smfmac_f32_16x16x64_bf16 v[48:51], v[12:15], a[240:247], v116
    ds_write2_b32 v120, v113, v115 offset0:0 offset1:16
    v_smfmac_f32_16x16x64_bf16 v[52:55], v[12:15], a[248:255], v116
    s_cmp_eq_u32 s22, 63
    s_cbranch_scc1 L_chain_last_f
    buffer_store_dword v126, off, s[8:11], s44 sc1
    v_smfmac_f32_16x16x64_bf16 v[48:51], v[16:19], v[128:135], v116
    v_smfmac_f32_16x16x64_bf16 v[48:51], v[20:23], v[160:167], v116
    v_smfmac_f32_16x16x64_bf16 v[48:51], v[24:27], v[144:151], v116
    s_waitcnt lgkmcnt(0)
    s_barrier
    v_smfmac_f32_16x16x64_bf16 v[48:51], v[28:31], v[176:183], v116
    ds_read_b128 v[32:35], v121 offset:16384
    ds_read_b128 v[36:39], v121 offset:17408
    v_smfmac_f32_16x16x64_bf16 v[52:55], v[16:19], v[136:143], v116
    ds_read_b128 v[40:43], v121 offset:18432
    ds_read_b128 v[44:47], v121 offset:19456
    v_smfmac_f32_16x16x64_bf16 v[52:55], v[20:23], v[168:175], v116
    ds_read_b128 v[8:11], v124 offset:32768
    v_add_f32 v48, v48, v50
    v_smfmac_f32_16x16x64_bf16 v[52:55], v[24:27], v[152:159], v116
    ds_read_b128 v[12:15], v124 offset:33792
    v_add_f32 v49, v49, v51
    v_smfmac_f32_16x16x64_bf16 v[52:55], v[28:31], v[184:191], v116
    s_waitcnt lgkmcnt(5)
    v_cvt_pk_bf16_f32 v112, v48, v49
    v_mfma_f32_16x16x32_bf16 v[56:59], v[56:59], v[32:35], 0
    s_waitcnt lgkmcnt(4)
    v_mov_b32 v48, s50
    v_mov_b32 v49, s50
    v_mfma_f32_16x16x32_bf16 v[56:59], v[60:63], v[36:39], v[56:59]
    ds_read_b128 v[16:19], v124 offset:2048
    s_waitcnt lgkmcnt(4)
    v_mov_b32 v50, s50
    v_mov_b32 v51, s50
    v_mfma_f32_16x16x32_bf16 v[56:59], v[64:67], v[40:43], v[56:59]
    ds_read_b128 v[20:23], v124 offset:3072
    s_waitcnt lgkmcnt(4)
    v_add_f32 v52, v52, v54
    v_mfma_f32_16x16x32_bf16 v[56:59], v[68:71], v[44:47], v[56:59]
    ds_read_b128 v[24:27], v124 offset:4096
    v_add_f32 v53, v53, v55
    v_mfma_f32_16x16x32_bf16 v[60:63], v[72:75], v[32:35], 0
    ds_read_b128 v[28:31], v124 offset:5120
    v_cvt_pk_bf16_f32 v114, v52, v53
    v_mov_b32 v53, 0
    v_mfma_f32_16x16x32_bf16 v[60:63], v[76:79], v[36:39], v[60:63]
    v_exp_f32 v56, v56
    v_mfma_f32_16x16x32_bf16 v[60:63], v[80:83], v[40:43], v[60:63]
    v_exp_f32 v57, v57
    v_mfma_f32_16x16x32_bf16 v[60:63], v[84:87], v[44:47], v[60:63]
    v_exp_f32 v58, v58
    v_mfma_f32_16x16x32_bf16 v[64:67], v[32:35], v[32:35], 0
    v_exp_f32 v59, v59
    v_cvt_pk_bf16_f32 v68, v56, v57
    v_mfma_f32_16x16x32_bf16 v[64:67], v[36:39], v[36:39], v[64:67]
    v_exp_f32 v60, v60
    v_cvt_pk_bf16_f32 v69, v58, v59
    v_mfma_f32_16x16x32_bf16 v[64:67], v[40:43], v[40:43], v[64:67]
    v_exp_f32 v61, v61
    v_mfma_f32_16x16x32_bf16 v[64:67], v[44:47], v[44:47], v[64:67]
    v_exp_f32 v62, v62
    v_exp_f32 v63, v63
    v_cvt_pk_bf16_f32 v70, v60, v61
    v_cvt_pk_bf16_f32 v71, v62, v63
    s_nop 1
    v_mfma_f32_16x16x32_bf16 v[72:75], v[88:91], v[68:71], 0
    s_nop 0
    v_exp_f32 v64, v64
    v_mfma_f32_16x16x32_bf16 v[76:79], v[92:95], v[68:71], 0
    v_exp_f32 v65, v65
    v_mfma_f32_16x16x32_bf16 v[80:83], v[48:51], v[68:71], 0
    v_cvt_pk_bf16_f32 v52, v64, v65
    s_nop 1
    v_mfma_f32_16x16x16_bf16 v[72:75], v[112:113], v[52:53], v[72:75]
    ds_read_b128 v[32:35], v124 offset:6144
    v_mfma_f32_16x16x16_bf16 v[76:79], v[114:115], v[52:53], v[76:79]
    ds_read_b128 v[36:39], v124 offset:7168
    v_mfma_f32_16x16x16_bf16 v[80:83], v[48:49], v[52:53], v[80:83]
L_norm_17:
    s_mov_b64 vcc, s[36:37]
    v_mov_b32 v122, v122
    v_mov_b32 v122, v122
    v_mov_b32 v122, v122
    v_cndmask_b32_dpp v76, v72, v76, vcc quad_perm:[2,3,2,3] row_mask:0xf bank_mask:0xf
    v_cndmask_b32_dpp v77, v73, v77, vcc quad_perm:[2,3,2,3] row_mask:0xf bank_mask:0xf
    v_cndmask_b32_dpp v78, v74, v78, vcc quad_perm:[2,3,2,3] row_mask:0xf bank_mask:0xf
    v_cndmask_b32_dpp v79, v75, v79, vcc quad_perm:[2,3,2,3] row_mask:0xf bank_mask:0xf
    v_rcp_f32_dpp v84, v80 quad_perm:[2,3,2,3] row_mask:0xf bank_mask:0xf
    s_nop 0
    v_pk_mul_f32 v[76:77], v[76:77], v[84:85] op_sel_hi:[1,0]
    v_pk_mul_f32 v[78:79], v[78:79], v[84:85] op_sel_hi:[1,0]
    v_cvt_pk_bf16_f32 v72, v76, v77
    v_cvt_pk_bf16_f32 v73, v78, v79
    ds_write_b64 v122, v[72:73] offset:20480
    v_max_f32_dpp v86, v80, v84 quad_perm:[2,3,2,3] row_mask:0xf bank_mask:0xf
    v_mov_b32_dpp v60, v72 quad_perm:[0,1,0,1] row_mask:0xf bank_mask:0xf
    v_mov_b32_dpp v61, v73 quad_perm:[0,1,0,1] row_mask:0xf bank_mask:0xf
    v_cmp_lt_f32 vcc, s35, v86
    v_mov_b32_dpp v62, v72 quad_perm:[2,3,2,3] row_mask:0xf bank_mask:0xf
    v_mov_b32_dpp v63, v73 quad_perm:[2,3,2,3] row_mask:0xf bank_mask:0xf
    s_nop 1
    v_smfmac_f32_16x16x64_bf16 v[96:99], v[60:63], v[192:199], v116
    s_cbranch_vccnz L_smax_18
    v_smfmac_f32_16x16x64_bf16 v[100:103], v[60:63], v[224:231], v116
    s_waitcnt lgkmcnt(0)
    s_barrier
    ds_read_b128 v[92:95], v127 offset:20992
    ds_read_b128 v[80:83], v127 offset:21504
    ds_read_b128 v[84:87], v127 offset:22016
    v_smfmac_f32_16x16x64_bf16 v[104:107], v[60:63], v[0:7], v116
    ds_read_b128 v[40:43], v124 offset:34816
    v_smfmac_f32_16x16x64_bf16 v[108:111], v[60:63], v[8:15], v116
    ds_read_b128 v[56:59], v124 offset:36864
    s_waitcnt lgkmcnt(4)
    v_smfmac_f32_16x16x64_bf16 v[96:99], v[92:95], v[200:207], v116
    s_waitcnt lgkmcnt(3)
    v_smfmac_f32_16x16x64_bf16 v[96:99], v[80:83], v[208:215], v116
    ds_read_b128 v[44:47], v124 offset:35840
    s_waitcnt lgkmcnt(3)
    v_smfmac_f32_16x16x64_bf16 v[96:99], v[84:87], v[216:223], v116
    ds_read_b128 v[68:71], v124 offset:39936
    v_smfmac_f32_16x16x64_bf16 v[100:103], v[92:95], v[232:239], v116
    ds_read_b128 v[64:67], v124 offset:38912
    v_smfmac_f32_16x16x64_bf16 v[100:103], v[80:83], v[240:247], v116
    ds_read_b128 v[60:63], v124 offset:37888
    v_cvt_pk_bf16_f32 v72, v96, v98
    v_smfmac_f32_16x16x64_bf16 v[100:103], v[84:87], v[248:255], v116
    v_and_or_b32 v72, v72, -2, s33
    v_smfmac_f32_16x16x64_bf16 v[104:107], v[92:95], v[16:23], v116
    v_cvt_pk_bf16_f32 v74, v97, v99
    v_smfmac_f32_16x16x64_bf16 v[104:107], v[80:83], v[24:31], v116
    v_cvt_pk_bf16_f32 v73, v100, v102
    v_cvt_pk_bf16_f32 v75, v101, v103
    v_smfmac_f32_16x16x64_bf16 v[104:107], v[84:87], v[32:39], v116
    buffer_store_dwordx4 v[72:75], v118, s[8:11], s25 offen
    s_waitcnt lgkmcnt(3)
    v_smfmac_f32_16x16x64_bf16 v[108:111], v[92:95], v[40:47], v116
    s_waitcnt lgkmcnt(0)
    v_smfmac_f32_16x16x64_bf16 v[108:111], v[80:83], v[56:63], v116
    v_cvt_pk_bf16_f32 v76, v104, v106
    v_smfmac_f32_16x16x64_bf16 v[108:111], v[84:87], v[64:71], v116
    v_and_or_b32 v76, v76, -2, s33
    v_cvt_pk_bf16_f32 v78, v105, v107
    v_mov_b32 v122, v122
    v_mov_b32 v122, v122
    v_mov_b32 v122, v122
    v_mov_b32 v122, v122
    v_mov_b32 v122, v122
    v_mov_b32 v122, v122
    v_cvt_pk_bf16_f32 v77, v108, v110
    v_cvt_pk_bf16_f32 v79, v109, v111
    buffer_store_dwordx4 v[76:79], v118, s[8:11], s26 offen
    s_add_u32 s30, s30, 0x40000
    s_add_u32 s31, s31, 0x40000
    s_add_u32 s32, s32, 0x20000
    s_add_u32 s23, s24, 0
    s_add_u32 s48, s23, 4096
    s_xor_b32 s25, s25, 0x40000
    s_xor_b32 s26, s26, 0x40000
    s_mov_b32 s35, 0x49800000
    v_mov_b32 v126, s22
    s_add_u32 s22, s22, 1
    v_mov_b32 v32, 0
    v_mov_b32 v33, 0
    v_mov_b32 v34, 0
    v_mov_b32 v35, 0
    v_mov_b32 v36, 0
    v_mov_b32 v37, 0
    v_mov_b32 v38, 0
    v_mov_b32 v39, 0
    v_mov_b32 v40, 0
    v_mov_b32 v41, 0
    v_mov_b32 v42, 0
    v_mov_b32 v43, 0
    v_mov_b32 v44, 0
    v_mov_b32 v45, 0
    v_mov_b32 v46, 0
    v_mov_b32 v47, 0
    v_mov_b32 v48, 0
    v_mov_b32 v49, 0
    v_mov_b32 v50, 0
    v_mov_b32 v51, 0
    v_mov_b32 v52, 0
    v_mov_b32 v53, 0
    v_mov_b32 v54, 0
    v_mov_b32 v55, 0
    ds_read_b128 v[80:83], v123
    ds_read_b128 v[84:87], v123 offset:1024
    ds_read_b128 v[56:59], v123 offset:2048
    ds_read_b128 v[60:63], v123 offset:3072
    ds_read_b128 v[64:67], v123 offset:32768
    ds_read_b128 v[68:71], v123 offset:33792
    ds_read_b128 v[72:75], v123 offset:34816
    ds_read_b128 v[76:79], v123 offset:35840
    ds_read_b128 v[88:91], v123 offset:4096
    ds_read_b128 v[92:95], v123 offset:5120
    ds_read_b128 v[96:99], v123 offset:6144
    ds_read_b128 v[100:103], v123 offset:7168
    ds_read_b128 v[104:107], v123 offset:36864
    ds_read_b128 v[108:111], v123 offset:37888
    ds_read_b128 v[24:27], v123 offset:38912
    ds_read_b128 v[28:31], v123 offset:39936
    s_add_u32 s24, s24, 8192
    s_bitset0_b32 s24, 15
    s_xor_b32 s55, s24, 16384
    s_xor_b32 s29, s29, 0x40000
    s_xor_b32 s53, s29, 1024
    s_bfe_u32 s33, s22, 0x10001
    s_add_u32 s40, s22, 5
    s_lshr_b32 s40, s40, 2
    s_min_u32 s40, s40, 16
    s_bfm_b32 s58, s40, 0
    s_waitcnt vmcnt(5)
    v_cmp_eq_u32 vcc, 0, v125
    s_nop 0
    s_and_b64 vcc, vcc, s[58:59]
    s_cbranch_scc1 L_kvw_19
L_kvb_20:
    v_mov_b32 v15, 0
    s_nop 2
    v_mov_b32 v15, 0
    s_nop 2
    v_mov_b32 v15, 0
    s_nop 2
    v_mov_b32 v15, 0
    s_nop 2
    v_mov_b32 v15, 0
    s_nop 2
    v_mov_b32 v15, 0
    s_nop 2
    v_mov_b32 v15, 0
    s_nop 2
    v_mov_b32 v15, 0
    s_nop 2
    v_mov_b32 v15, 0
    s_nop 2
    v_mov_b32 v15, 0
    s_nop 2
    v_mov_b32 v15, 0
    s_nop 2
    v_mov_b32 v15, 0
    s_nop 2
    v_mov_b32 v15, 0
    s_nop 2
    v_mov_b32 v15, 0
    s_nop 2
    v_mov_b32 v15, 0
    s_nop 2
    v_mov_b32 v15, 0
    s_nop 2
    v_mov_b32 v15, 0
    s_nop 2
    v_mov_b32 v15, 0
    s_nop 2
    v_mov_b32 v15, 0
    s_nop 2
    v_mov_b32 v15, 0
    s_nop 2
    v_mov_b32 v15, 0
    s_nop 2
    v_mov_b32 v15, 0
    s_nop 2
    v_mov_b32 v15, 0
    s_nop 2
    v_mov_b32 v15, 0
    s_nop 2
    v_mov_b32 v15, 0
    s_nop 2
    v_mov_b32 v15, 0
    s_nop 2
    v_mov_b32 v15, 0
    s_nop 2
    v_mov_b32 v15, 0
    s_nop 2
    v_mov_b32 v15, 0
    s_nop 2
    v_mov_b32 v15, 0
    s_nop 2
    v_mov_b32 v15, 0
    s_nop 2
    s_waitcnt lgkmcnt(0)
    s_branch L_chain_top0_f
.p2align 6
L_chain_top1_f:
    buffer_load_dwordx4 v[0:3], v117, s[8:11], s23 offen nt
    v_mov_b32 v15, 0
    v_mov_b32 v15, 0
    v_mov_b32 v15, 0
    v_mov_b32 v15, 0
    v_mov_b32 v15, 0
    v_mov_b32 v15, 0
    v_mov_b32 v15, 0
    v_mov_b32 v15, 0
    v_mov_b32 v15, 0
    v_mov_b32 v15, 0
    v_mov_b32 v15, 0
    v_mov_b32 v15, 0
    v_mov_b32 v15, 0
    v_mov_b32 v15, 0
    v_mov_b32 v15, 0
    v_mov_b32 v15, 0
    buffer_load_dwordx4 v[0:3], v117, s[8:11], s23 offen sc1
    v_mov_b32 v15, 0
    v_mov_b32 v15, 0
    v_mov_b32 v15, 0
    v_mov_b32 v15, 0
    v_mov_b32 v15, 0
    v_mov_b32 v15, 0
    v_mov_b32 v15, 0
    v_mov_b32 v15, 0
    v_mov_b32 v15, 0
    v_mov_b32 v15, 0
    v_mov_b32 v15, 0
    v_mov_b32 v15, 0
    v_mov_b32 v15, 0
    v_mov_b32 v15, 0
    v_mov_b32 v15, 0
    v_mov_b32 v15, 0
L_mret_21:
    buffer_load_dwordx4 v[0:3], v117, s[8:11], s23 offen sc1
    s_add_u32 s45, s45, 1
    s_cmp_lt_u32 s45, 0x10000
    s_cselect_b32 s56, -2, -1
    s_nop 3
    v_mov_b32 v32, 0
    v_mov_b32 v33, 0
    v_mov_b32 v34, 0
    v_mov_b32 v35, 0
    s_waitcnt vmcnt(2)
    v_max3_u32 v15, v0, v1, v2
    v_max_u32 v15, v15, v3
    v_cmp_lt_u32 vcc, s56, v15
    v_smfmac_f32_16x16x64_bf16 v[32:35], v[0:3], v[80:87], v116
    s_cbranch_vccnz L_mret_21
    ds_write_b128 v117, v[0:3] offset:1024
    v_smfmac_f32_16x16x64_bf16 v[36:39], v[0:3], v[56:63], v116
    buffer_load_dwordx4 v[4:7], v117, s[8:11], s48 offen nt
    v_smfmac_f32_16x16x64_bf16 v[40:43], v[0:3], v[64:71], v116
    buffer_load_dwordx4 v117, s[8:11], s48 offen nt lds
    s_mov_b32 m0, 10240
    v_smfmac_f32_16x16x64_bf16 v[44:47], v[0:3], v[72:79], v116
    s_waitcnt lgkmcnt(0)
    s_barrier
    ds_read_b128 v[8:11], v117
    v_smfmac_f32_16x16x64_bf16 v[48:51], v[0:3], a[192:199], v116
    ds_read_b128 v[16:19], v117 offset:3072
    ds_read_b128 v[20:23], v117 offset:2048
    v_smfmac_f32_16x16x64_bf16 v[52:55], v[0:3], a[200:207], v116
    ds_read_b128 v[80:83], v117 offset:14336
    s_waitcnt lgkmcnt(3)
    v_smfmac_f32_16x16x64_bf16 v[32:35], v[8:11], a[0:7], v116
    ds_read_b128 v[84:87], v117 offset:15360
    v_smfmac_f32_16x16x64_bf16 v[36:39], v[8:11], a[8:15], v116
    ds_read_b128 v[56:59], v117 offset:8192
    s_waitcnt lgkmcnt(4)
    v_smfmac_f32_16x16x64_bf16 v[32:35], v[16:19], a[32:39], v116
    ds_read_b128 v[60:63], v117 offset:9216
    v_smfmac_f32_16x16x64_bf16 v[36:39], v[16:19], a[40:47], v116
    buffer_store_dwordx4 v[112:115], v117, s[8:11], s32 offen sc1
    s_waitcnt lgkmcnt(4)
    v_smfmac_f32_16x16x64_bf16 v[32:35], v[20:23], a[64:71], v116
    ds_read_b128 v[64:67], v117 offset:10240
    v_smfmac_f32_16x16x64_bf16 v[36:39], v[20:23], a[72:79], v116
    ds_read_b128 v[68:71], v117 offset:11264
    v_smfmac_f32_16x16x64_bf16 v[40:43], v[8:11], a[96:103], v116
    ds_read_b128 v[72:75], v117 offset:12288
    v_smfmac_f32_16x16x64_bf16 v[40:43], v[16:19], a[128:135], v116
    ds_read_b128 v[76:79], v117 offset:13312
    v_smfmac_f32_16x16x64_bf16 v[40:43], v[20:23], a[160:167], v116
    s_waitcnt vmcnt(2)
    v_max3_u32 v15, v4, v5, v6
    v_smfmac_f32_16x16x64_bf16 v[44:47], v[8:11], a[104:111], v116
    v_max_u32 v15, v15, v7
    v_smfmac_f32_16x16x64_bf16 v[44:47], v[16:19], a[136:143], v116
    s_waitcnt vmcnt(1) lgkmcnt(0)
    v_cmp_lt_u32 vcc, s56, v15
    v_smfmac_f32_16x16x64_bf16 v[44:47], v[20:23], a[168:175], v116
    s_cbranch_vccnz L_mret_22
L_mgo_23:
    v_smfmac_f32_16x16x64_bf16 v[44:47], v[4:7], v[24:31], v116
    s_barrier
    ds_read_b128 v[12:15], v117 offset:4096
    v_smfmac_f32_16x16x64_bf16 v[32:35], v[4:7], v[88:95], v116
    ds_read_b128 v[24:27], v117 offset:7168
    v_smfmac_f32_16x16x64_bf16 v[36:39], v[4:7], v[96:103], v116
    ds_read_b128 v[28:31], v117 offset:6144
    v_smfmac_f32_16x16x64_bf16 v[40:43], v[4:7], v[104:111], v116
    ds_read_b128 v[88:91], v117 offset:26624
    s_waitcnt lgkmcnt(3)
    v_smfmac_f32_16x16x64_bf16 v[32:35], v[12:15], a[16:23], v116
    ds_read_b128 v[92:95], v117 offset:27648
    s_waitcnt lgkmcnt(3)
    v_smfmac_f32_16x16x64_bf16 v[32:35], v[24:27], a[48:55], v116
    buffer_load_dwordx4 v117, s[8:11], s30 offen lds
    s_waitcnt lgkmcnt(2)
    v_smfmac_f32_16x16x64_bf16 v[32:35], v[28:31], a[80:87], v116
    ds_read_b128 v[96:99], v117 offset:23552
    v_smfmac_f32_16x16x64_bf16 v[36:39], v[12:15], a[24:31], v116
    ds_read_b128 v[100:103], v117 offset:23552
    v_smfmac_f32_16x16x64_bf16 v[36:39], v[24:27], a[56:63], v116
    buffer_load_dwordx4 v117, s[8:11], s30 offen offset:1024 lds
    s_add_u32 m0, s52, 0x6000
    v_add_f32 v32, v32, v34
    v_smfmac_f32_16x16x64_bf16 v[36:39], v[28:31], a[88:95], v116
    ds_read_b128 v[104:107], v117 offset:23552
    v_add_f32 v33, v33, v35
    v_smfmac_f32_16x16x64_bf16 v[40:43], v[12:15], a[112:119], v116
    ds_read_b128 v[108:111], v117 offset:23552
    v_mul_f32 v32, s34, v32
    v_smfmac_f32_16x16x64_bf16 v[40:43], v[24:27], a[144:151], v116
    buffer_load_dword v125, v119, s[8:11], s28 offen sc1
    v_mul_f32 v33, s34, v33
    v_smfmac_f32_16x16x64_bf16 v[40:43], v[28:31], a[176:183], v116
    ds_read_b128 v[0:3], v124
    v_add_f32 v36, v36, v38
    v_smfmac_f32_16x16x64_bf16 v[48:51], v[4:7], a[208:215], v116
    v_add_f32 v37, v37, v39
    v_smfmac_f32_16x16x64_bf16 v[52:55], v[4:7], a[216:223], v116
    s_waitcnt lgkmcnt(5)
    buffer_load_dwordx4 v117, s[8:11], s31 offen lds
    v_mul_f32 v36, s34, v36
    v_smfmac_f32_16x16x64_bf16 v[44:47], v[12:15], a[120:127], v116
    ds_read_b128 v[4:7], v124 offset:1024
    v_mul_f32 v37, s34, v37
    v_smfmac_f32_16x16x64_bf16 v[44:47], v[24:27], a[152:159], v116
    v_cvt_pk_bf16_f32 v34, v32, v36
    v_smfmac_f32_16x16x64_bf16 v[44:47], v[28:31], a[184:191], v116
    buffer_load_dwordx4 v117, s[8:11], s31 offen offset:1024 lds
    s_mov_b32 m0, 5120
    v_cvt_pk_bf16_f32 v35, v33, v37
    v_add_f32 v40, v40, v42
    v_smfmac_f32_16x16x64_bf16 v[48:51], v[8:11], a[224:231], v116
    ds_write2_b32 v120, v34, v35 offset0:32 offset1:48
    v_add_f32 v41, v41, v43
    v_smfmac_f32_16x16x64_bf16 v[52:55], v[8:11], a[232:239], v116
    v_add_f32 v44, v44, v46
    v_add_f32 v45, v45, v47
    v_cvt_pk_bf16_f32 v113, v40, v44
    v_cvt_pk_bf16_f32 v115, v41, v45
    v_smfmac_f32_16x16x64_bf16 v[48:51], v[12:15], a[240:247], v116
    ds_write2_b32 v120, v113, v115 offset0:0 offset1:16
    v_smfmac_f32_16x16x64_bf16 v[52:55], v[12:15], a[248:255], v116
    s_cmp_eq_u32 s22, 63
    s_cbranch_scc1 L_chain_last_f
    v_smfmac_f32_16x16x64_bf16 v[48:51], v[16:19], v[128:135], v116
    v_smfmac_f32_16x16x64_bf16 v[48:51], v[20:23], v[160:167], v116
    v_smfmac_f32_16x16x64_bf16 v[48:51], v[24:27], v[144:151], v116
    s_waitcnt lgkmcnt(0)
    s_barrier
    v_smfmac_f32_16x16x64_bf16 v[48:51], v[28:31], v[176:183], v116
    ds_read_b128 v[32:35], v121 offset:16384
    ds_read_b128 v[36:39], v121 offset:17408
    v_smfmac_f32_16x16x64_bf16 v[52:55], v[16:19], v[136:143], v116
    ds_read_b128 v[40:43], v121 offset:18432
    ds_read_b128 v[44:47], v121 offset:19456
    v_smfmac_f32_16x16x64_bf16 v[52:55], v[20:23], v[168:175], v116
    ds_read_b128 v[8:11], v124 offset:32768
    v_add_f32 v48, v48, v50
    v_smfmac_f32_16x16x64_bf16 v[52:55], v[24:27], v[152:159], v116
    ds_read_b128 v[12:15], v124 offset:33792
    v_add_f32 v49, v49, v51
    v_smfmac_f32_16x16x64_bf16 v[52:55], v[28:31], v[184:191], v116
    s_waitcnt lgkmcnt(5)
    v_cvt_pk_bf16_f32 v112, v48, v49
    v_mfma_f32_16x16x32_bf16 v[56:59], v[56:59], v[32:35], 0
    s_waitcnt lgkmcnt(4)
    v_mov_b32 v48, s50
    v_mov_b32 v49, s50
    v_mfma_f32_16x16x32_bf16 v[56:59], v[60:63], v[36:39], v[56:59]
    ds_read_b128 v[16:19], v124 offset:2048
    s_waitcnt lgkmcnt(4)
    v_mov_b32 v50, s50
    v_mov_b32 v51, s50
    v_mfma_f32_16x16x32_bf16 v[56:59], v[64:67], v[40:43], v[56:59]
    ds_read_b128 v[20:23], v124 offset:3072
    s_waitcnt lgkmcnt(4)
    v_add_f32 v52, v52, v54
    v_mfma_f32_16x16x32_bf16 v[56:59], v[68:71], v[44:47], v[56:59]
    ds_read_b128 v[24:27], v124 offset:4096
    v_add_f32 v53, v53, v55
    v_mfma_f32_16x16x32_bf16 v[60:63], v[72:75], v[32:35], 0
    ds_read_b128 v[28:31], v124 offset:5120
    v_cvt_pk_bf16_f32 v114, v52, v53
    v_mov_b32 v53, 0
    v_mfma_f32_16x16x32_bf16 v[60:63], v[76:79], v[36:39], v[60:63]
    v_exp_f32 v56, v56
    v_mfma_f32_16x16x32_bf16 v[60:63], v[80:83], v[40:43], v[60:63]
    v_exp_f32 v57, v57
    v_mfma_f32_16x16x32_bf16 v[60:63], v[84:87], v[44:47], v[60:63]
    v_exp_f32 v58, v58
    v_mfma_f32_16x16x32_bf16 v[64:67], v[32:35], v[32:35], 0
    v_exp_f32 v59, v59
    v_cvt_pk_bf16_f32 v68, v56, v57
    v_mfma_f32_16x16x32_bf16 v[64:67], v[36:39], v[36:39], v[64:67]
    v_exp_f32 v60, v60
    v_cvt_pk_bf16_f32 v69, v58, v59
    v_mfma_f32_16x16x32_bf16 v[64:67], v[40:43], v[40:43], v[64:67]
    v_exp_f32 v61, v61
    v_mfma_f32_16x16x32_bf16 v[64:67], v[44:47], v[44:47], v[64:67]
    v_exp_f32 v62, v62
    v_exp_f32 v63, v63
    v_cvt_pk_bf16_f32 v70, v60, v61
    v_cvt_pk_bf16_f32 v71, v62, v63
    s_nop 1
    v_mfma_f32_16x16x32_bf16 v[72:75], v[88:91], v[68:71], 0
    s_nop 0
    v_exp_f32 v64, v64
    v_mfma_f32_16x16x32_bf16 v[76:79], v[92:95], v[68:71], 0
    v_exp_f32 v65, v65
    v_mfma_f32_16x16x32_bf16 v[80:83], v[48:51], v[68:71], 0
    v_cvt_pk_bf16_f32 v52, v64, v65
    s_nop 1
    v_mfma_f32_16x16x16_bf16 v[72:75], v[112:113], v[52:53], v[72:75]
    ds_read_b128 v[32:35], v124 offset:6144
    v_mfma_f32_16x16x16_bf16 v[76:79], v[114:115], v[52:53], v[76:79]
    ds_read_b128 v[36:39], v124 offset:7168
    v_mfma_f32_16x16x16_bf16 v[80:83], v[48:49], v[52:53], v[80:83]
L_norm_24:
    s_mov_b64 vcc, s[36:37]
    v_mov_b32 v122, v122
    v_mov_b32 v122, v122
    v_mov_b32 v122, v122
    v_cndmask_b32_dpp v76, v72, v76, vcc quad_perm:[2,3,2,3] row_mask:0xf bank_mask:0xf
    v_cndmask_b32_dpp v77, v73, v77, vcc quad_perm:[2,3,2,3] row_mask:0xf bank_mask:0xf
    v_cndmask_b32_dpp v78, v74, v78, vcc quad_perm:[2,3,2,3] row_mask:0xf bank_mask:0xf
    v_cndmask_b32_dpp v79, v75, v79, vcc quad_perm:[2,3,2,3] row_mask:0xf bank_mask:0xf
    v_rcp_f32_dpp v84, v80 quad_perm:[2,3,2,3] row_mask:0xf bank_mask:0xf
    s_nop 0
    v_pk_mul_f32 v[76:77], v[76:77], v[84:85] op_sel_hi:[1,0]
    v_pk_mul_f32 v[78:79], v[78:79], v[84:85] op_sel_hi:[1,0]
    v_cvt_pk_bf16_f32 v72, v76, v77
    v_cvt_pk_bf16_f32 v73, v78, v79
    ds_write_b64 v122, v[72:73] offset:20992
    v_max_f32_dpp v86, v80, v84 quad_perm:[2,3,2,3] row_mask:0xf bank_mask:0xf
    v_mov_b32_dpp v60, v72 quad_perm:[0,1,0,1] row_mask:0xf bank_mask:0xf
    v_mov_b32_dpp v61, v73 quad_perm:[0,1,0,1] row_mask:0xf bank_mask:0xf
    v_cmp_lt_f32 vcc, s35, v86
    v_mov_b32_dpp v62, v72 quad_perm:[2,3,2,3] row_mask:0xf bank_mask:0xf
    v_mov_b32_dpp v63, v73 quad_perm:[2,3,2,3] row_mask:0xf bank_mask:0xf
    s_nop 1
    v_smfmac_f32_16x16x64_bf16 v[96:99], v[60:63], v[192:199], v116
    s_cbranch_vccnz L_smax_25
    v_smfmac_f32_16x16x64_bf16 v[100:103], v[60:63], v[224:231], v116
    s_waitcnt lgkmcnt(0)
    s_barrier
    ds_read_b128 v[92:95], v127 offset:20480
    ds_read_b128 v[80:83], v127 offset:22016
    ds_read_b128 v[84:87], v127 offset:21504
    v_smfmac_f32_16x16x64_bf16 v[104:107], v[60:63], v[0:7], v116
    ds_read_b128 v[40:43], v124 offset:34816
    v_smfmac_f32_16x16x64_bf16 v[108:111], v[60:63], v[8:15], v116
    ds_read_b128 v[56:59], v124 offset:36864
    s_waitcnt lgkmcnt(4)
    v_smfmac_f32_16x16x64_bf16 v[96:99], v[92:95], v[200:207], v116
    s_waitcnt lgkmcnt(3)
    v_smfmac_f32_16x16x64_bf16 v[96:99], v[80:83], v[208:215], v116
    ds_read_b128 v[44:47], v124 offset:35840
    s_waitcnt lgkmcnt(3)
    v_smfmac_f32_16x16x64_bf16 v[96:99], v[84:87], v[216:223], v116
    ds_read_b128 v[68:71], v124 offset:39936
    v_smfmac_f32_16x16x64_bf16 v[100:103], v[92:95], v[232:239], v116
    ds_read_b128 v[64:67], v124 offset:38912
    v_smfmac_f32_16x16x64_bf16 v[100:103], v[80:83], v[240:247], v116
    ds_read_b128 v[60:63], v124 offset:37888
    v_cvt_pk_bf16_f32 v72, v96, v98
    v_smfmac_f32_16x16x64_bf16 v[100:103], v[84:87], v[248:255], v116
    v_and_or_b32 v72, v72, -2, s33
    v_smfmac_f32_16x16x64_bf16 v[104:107], v[92:95], v[16:23], v116
    v_cvt_pk_bf16_f32 v74, v97, v99
    v_smfmac_f32_16x16x64_bf16 v[104:107], v[80:83], v[24:31], v116
    v_cvt_pk_bf16_f32 v73, v100, v102
    v_cvt_pk_bf16_f32 v75, v101, v103
    v_smfmac_f32_16x16x64_bf16 v[104:107], v[84:87], v[32:39], v116
    buffer_store_dwordx4 v[72:75], v118, s[8:11], s25 offen
    s_waitcnt lgkmcnt(3)
    v_smfmac_f32_16x16x64_bf16 v[108:111], v[92:95], v[40:47], v116
    s_waitcnt lgkmcnt(0)
    v_smfmac_f32_16x16x64_bf16 v[108:111], v[80:83], v[56:63], v116
    v_cvt_pk_bf16_f32 v76, v104, v106
    v_smfmac_f32_16x16x64_bf16 v[108:111], v[84:87], v[64:71], v116
    v_and_or_b32 v76, v76, -2, s33
    v_cvt_pk_bf16_f32 v78, v105, v107
    v_mov_b32 v122, v122
    v_mov_b32 v122, v122
    v_mov_b32 v122, v122
    v_mov_b32 v122, v122
    v_mov_b32 v122, v122
    v_mov_b32 v122, v122
    v_cvt_pk_bf16_f32 v77, v108, v110
    v_cvt_pk_bf16_f32 v79, v109, v111
    buffer_store_dwordx4 v[76:79], v118, s[8:11], s26 offen
    s_add_u32 s30, s30, 0x40000
    s_add_u32 s31, s31, 0x40000
    s_add_u32 s32, s32, 0x20000
    s_add_u32 s23, s24, 1024
    s_add_u32 s48, s23, 4096
    s_xor_b32 s25, s25, 0x40000
    s_xor_b32 s26, s26, 0x40000
    s_mov_b32 s35, 0x49800000
    s_add_u32 s22, s22, 1
    v_mov_b32 v32, 0
    v_mov_b32 v33, 0
    v_mov_b32 v34, 0
    v_mov_b32 v35, 0
    v_mov_b32 v36, 0
    v_mov_b32 v37, 0
    v_mov_b32 v38, 0
    v_mov_b32 v39, 0
    v_mov_b32 v40, 0
    v_mov_b32 v41, 0
    v_mov_b32 v42, 0
    v_mov_b32 v43, 0
    v_mov_b32 v44, 0
    v_mov_b32 v45, 0
    v_mov_b32 v46, 0
    v_mov_b32 v47, 0
    v_mov_b32 v48, 0
    v_mov_b32 v49, 0
    v_mov_b32 v50, 0
    v_mov_b32 v51, 0
    v_mov_b32 v52, 0
    v_mov_b32 v53, 0
    v_mov_b32 v54, 0
    v_mov_b32 v55, 0
    ds_read_b128 v[80:83], v123
    ds_read_b128 v[84:87], v123 offset:1024
    ds_read_b128 v[56:59], v123 offset:2048
    ds_read_b128 v[60:63], v123 offset:3072
    ds_read_b128 v[64:67], v123 offset:32768
    ds_read_b128 v[68:71], v123 offset:33792
    ds_read_b128 v[72:75], v123 offset:34816
    ds_read_b128 v[76:79], v123 offset:35840
    ds_read_b128 v[88:91], v123 offset:4096
    ds_read_b128 v[92:95], v123 offset:5120
    ds_read_b128 v[96:99], v123 offset:6144
    ds_read_b128 v[100:103], v123 offset:7168
    ds_read_b128 v[104:107], v123 offset:36864
    ds_read_b128 v[108:111], v123 offset:37888
    ds_read_b128 v[24:27], v123 offset:38912
    ds_read_b128 v[28:31], v123 offset:39936
    s_add_u32 s24, s24, 8192
    s_bitset0_b32 s24, 15
    s_xor_b32 s55, s24, 16384
    s_xor_b32 s29, s29, 0x40000
    s_xor_b32 s53, s29, 1024
    s_bfe_u32 s33, s22, 0x10001
    s_add_u32 s40, s22, 5
    s_lshr_b32 s40, s40, 2
    s_min_u32 s40, s40, 16
    s_bfm_b32 s58, s40, 0
    s_waitcnt vmcnt(4)
    v_cmp_eq_u32 vcc, 0, v125
    s_nop 0
    s_and_b64 vcc, vcc, s[58:59]
    s_cbranch_scc1 L_kvw_26
L_kvb_27:
    v_mov_b32 v15, 0
    s_nop 2
    v_mov_b32 v15, 0
    s_nop 2
    v_mov_b32 v15, 0
    s_nop 2
    v_mov_b32 v15, 0
    s_nop 2
    v_mov_b32 v15, 0
    s_nop 2
    v_mov_b32 v15, 0
    s_nop 2
    v_mov_b32 v15, 0
    s_nop 2
    v_mov_b32 v15, 0
    s_nop 2
    v_mov_b32 v15, 0
    s_nop 2
    v_mov_b32 v15, 0
    s_nop 2
    v_mov_b32 v15, 0
    s_nop 2
    v_mov_b32 v15, 0
    s_nop 2
    v_mov_b32 v15, 0
    s_nop 2
    v_mov_b32 v15, 0
    s_nop 2
    v_mov_b32 v15, 0
    s_nop 2
    v_mov_b32 v15, 0
    s_nop 2
    v_mov_b32 v15, 0
    s_nop 2
    v_mov_b32 v15, 0
    s_nop 2
    v_mov_b32 v15, 0
    s_nop 2
    v_mov_b32 v15, 0
    s_nop 2
    v_mov_b32 v15, 0
    s_nop 2
    v_mov_b32 v15, 0
    s_nop 2
    v_mov_b32 v15, 0
    s_nop 2
    v_mov_b32 v15, 0
    s_nop 2
    v_mov_b32 v15, 0
    s_nop 2
    v_mov_b32 v15, 0
    s_nop 2
    v_mov_b32 v15, 0
    s_nop 2
    v_mov_b32 v15, 0
    s_nop 2
    v_mov_b32 v15, 0
    s_nop 2
    v_mov_b32 v15, 0
    s_nop 2
    v_mov_b32 v15, 0
    s_nop 2
    s_waitcnt lgkmcnt(0)
    s_branch L_chain_top1_f
.p2align 6
L_chain_top2_f:
    buffer_load_dwordx4 v[0:3], v117, s[8:11], s23 offen nt
    v_mov_b32 v48, 0
    v_mov_b32 v49, 0
    v_mov_b32 v50, 0
    v_mov_b32 v51, 0
    v_mov_b32 v52, 0
    v_mov_b32 v53, 0
    v_mov_b32 v15, 0
    v_mov_b32 v15, 0
    v_mov_b32 v15, 0
    v_mov_b32 v15, 0
    v_mov_b32 v15, 0
    v_mov_b32 v15, 0
    v_mov_b32 v15, 0
    v_mov_b32 v15, 0
    v_mov_b32 v15, 0
    v_mov_b32 v15, 0
    buffer_load_dwordx4 v[0:3], v117, s[8:11], s23 offen sc1
    v_mov_b32 v15, 0
    v_mov_b32 v15, 0
    v_mov_b32 v15, 0
    v_mov_b32 v15, 0
    v_mov_b32 v15, 0
    v_mov_b32 v15, 0
    v_mov_b32 v15, 0
    v_mov_b32 v15, 0
    v_mov_b32 v15, 0
    v_mov_b32 v15, 0
    v_mov_b32 v15, 0
    v_mov_b32 v15, 0
    v_mov_b32 v15, 0
    v_mov_b32 v15, 0
    v_mov_b32 v15, 0
    v_mov_b32 v15, 0
L_mret_28:
    buffer_load_dwordx4 v[0:3], v117, s[8:11], s23 offen sc1
    s_add_u32 s45, s45, 1
    s_cmp_lt_u32 s45, 0x10000
    s_cselect_b32 s56, -2, -1
    s_nop 3
    v_mov_b32 v32, 0
    v_mov_b32 v33, 0
    v_mov_b32 v34, 0
    v_mov_b32 v35, 0
    s_waitcnt vmcnt(2)
    v_max3_u32 v15, v0, v1, v2
    v_max_u32 v15, v15, v3
    v_cmp_lt_u32 vcc, s56, v15
    v_smfmac_f32_16x16x64_bf16 v[32:35], v[0:3], v[80:87], v116
    s_cbranch_vccnz L_mret_28
    ds_write_b128 v117, v[0:3] offset:2048
    v_smfmac_f32_16x16x64_bf16 v[36:39], v[0:3], v[56:63], v116
    buffer_load_dwordx4 v[4:7], v117, s[8:11], s48 offen nt
    v_smfmac_f32_16x16x64_bf16 v[40:43], v[0:3], v[64:71], v116
    buffer_load_dwordx4 v117, s[8:11], s48 offen nt lds
    s_mov_b32 m0, 12288
    v_smfmac_f32_16x16x64_bf16 v[44:47], v[0:3], v[72:79], v116
    s_waitcnt lgkmcnt(0)
    s_barrier
    ds_read_b128 v[8:11], v117 offset:3072
    v_smfmac_f32_16x16x64_bf16 v[48:51], v[0:3], a[192:199], v116
    ds_read_b128 v[16:19], v117
    ds_read_b128 v[20:23], v117 offset:1024
    v_smfmac_f32_16x16x64_bf16 v[52:55], v[0:3], a[200:207], v116
    ds_read_b128 v[80:83], v117 offset:14336
    s_waitcnt lgkmcnt(3)
    v_smfmac_f32_16x16x64_bf16 v[32:35], v[8:11], a[0:7], v116
    ds_read_b128 v[84:87], v117 offset:15360
    v_smfmac_f32_16x16x64_bf16 v[36:39], v[8:11], a[8:15], v116
    ds_read_b128 v[56:59], v117 offset:8192
    s_waitcnt lgkmcnt(4)
    v_smfmac_f32_16x16x64_bf16 v[32:35], v[16:19], a[32:39], v116
    ds_read_b128 v[60:63], v117 offset:9216
    v_smfmac_f32_16x16x64_bf16 v[36:39], v[16:19], a[40:47], v116
    ds_read_b128 v[64:67], v117 offset:10240
    s_waitcnt lgkmcnt(5)
    v_smfmac_f32_16x16x64_bf16 v[32:35], v[20:23], a[64:71], v116
    ds_read_b128 v[68:71], v117 offset:11264
    v_smfmac_f32_16x16x64_bf16 v[36:39], v[20:23], a[72:79], v116
    buffer_store_dwordx4 v[112:115], v117, s[8:11], s32 offen sc1
    v_smfmac_f32_16x16x64_bf16 v[40:43], v[8:11], a[96:103], v116
    ds_read_b128 v[72:75], v117 offset:12288
    v_smfmac_f32_16x16x64_bf16 v[40:43], v[16:19], a[128:135], v116
    ds_read_b128 v[76:79], v117 offset:13312
    v_smfmac_f32_16x16x64_bf16 v[40:43], v[20:23], a[160:167], v116
    s_waitcnt vmcnt(2)
    v_max3_u32 v15, v4, v5, v6
    v_smfmac_f32_16x16x64_bf16 v[44:47], v[8:11], a[104:111], v116
    v_max_u32 v15, v15, v7
    v_smfmac_f32_16x16x64_bf16 v[44:47], v[16:19], a[136:143], v116
    s_waitcnt vmcnt(1) lgkmcnt(0)
    v_cmp_lt_u32 vcc, s56, v15
    v_smfmac_f32_16x16x64_bf16 v[44:47], v[20:23], a[168:175], v116
    s_cbranch_vccnz L_mret_29
L_mgo_30:
    v_smfmac_f32_16x16x64_bf16 v[44:47], v[4:7], v[24:31], v116
    s_barrier
    ds_read_b128 v[12:15], v117 offset:7168
    v_smfmac_f32_16x16x64_bf16 v[32:35], v[4:7], v[88:95], v116
    ds_read_b128 v[24:27], v117 offset:4096
    v_smfmac_f32_16x16x64_bf16 v[36:39], v[4:7], v[96:103], v116
    ds_read_b128 v[28:31], v117 offset:5120
    v_smfmac_f32_16x16x64_bf16 v[40:43], v[4:7], v[104:111], v116
    ds_read_b128 v[88:91], v117 offset:28672
    s_waitcnt lgkmcnt(3)
    v_smfmac_f32_16x16x64_bf16 v[32:35], v[12:15], a[16:23], v116
    ds_read_b128 v[92:95], v117 offset:29696
    s_waitcnt lgkmcnt(3)
    v_smfmac_f32_16x16x64_bf16 v[32:35], v[24:27], a[48:55], v116
    buffer_load_dwordx4 v117, s[8:11], s30 offen lds
    s_waitcnt lgkmcnt(2)
    v_smfmac_f32_16x16x64_bf16 v[32:35], v[28:31], a[80:87], v116
    ds_read_b128 v[96:99], v117 offset:23552
    v_smfmac_f32_16x16x64_bf16 v[36:39], v[12:15], a[24:31], v116
    ds_read_b128 v[100:103], v117 offset:23552
    v_smfmac_f32_16x16x64_bf16 v[36:39], v[24:27], a[56:63], v116
    buffer_load_dwordx4 v117, s[8:11], s30 offen offset:1024 lds
    s_add_u32 m0, s52, 0x6000
    v_add_f32 v32, v32, v34
    v_smfmac_f32_16x16x64_bf16 v[36:39], v[28:31], a[88:95], v116
    ds_read_b128 v[104:107], v117 offset:23552
    v_add_f32 v33, v33, v35
    v_smfmac_f32_16x16x64_bf16 v[40:43], v[12:15], a[112:119], v116
    ds_read_b128 v[108:111], v117 offset:23552
    v_mul_f32 v32, s34, v32
    v_smfmac_f32_16x16x64_bf16 v[40:43], v[24:27], a[144:151], v116
    s_waitcnt lgkmcnt(4)
    buffer_load_dwordx4 v117, s[8:11], s31 offen lds
    v_mul_f32 v33, s34, v33
    v_smfmac_f32_16x16x64_bf16 v[40:43], v[28:31], a[176:183], v116
    ds_read_b128 v[0:3], v124
    v_add_f32 v36, v36, v38
    v_smfmac_f32_16x16x64_bf16 v[48:51], v[4:7], a[208:215], v116
    v_add_f32 v37, v37, v39
    v_smfmac_f32_16x16x64_bf16 v[52:55], v[4:7], a[216:223], v116
    buffer_load_dwordx4 v117, s[8:11], s31 offen offset:1024 lds
    s_mov_b32 m0, 6144
    v_mul_f32 v36, s34, v36
    v_smfmac_f32_16x16x64_bf16 v[44:47], v[12:15], a[120:127], v116
    ds_read_b128 v[4:7], v124 offset:1024
    v_mul_f32 v37, s34, v37
    v_smfmac_f32_16x16x64_bf16 v[44:47], v[24:27], a[152:159], v116
    v_cvt_pk_bf16_f32 v34, v32, v36
    v_smfmac_f32_16x16x64_bf16 v[44:47], v[28:31], a[184:191], v116
    v_cvt_pk_bf16_f32 v35, v33, v37
    v_add_f32 v40, v40, v42
    v_smfmac_f32_16x16x64_bf16 v[48:51], v[8:11], a[224:231], v116
    ds_write2_b32 v120, v34, v35 offset0:32 offset1:48
    v_add_f32 v41, v41, v43
    v_smfmac_f32_16x16x64_bf16 v[52:55], v[8:11], a[232:239], v116
    v_add_f32 v44, v44, v46
    v_add_f32 v45, v45, v47
    v_cvt_pk_bf16_f32 v113, v40, v44
    v_cvt_pk_bf16_f32 v115, v41, v45
    v_smfmac_f32_16x16x64_bf16 v[48:51], v[12:15], a[240:247], v116
    ds_write2_b32 v120, v113, v115 offset0:0 offset1:16
    v_smfmac_f32_16x16x64_bf16 v[52:55], v[12:15], a[248:255], v116
    s_cmp_eq_u32 s22, 63
    s_cbranch_scc1 L_chain_last_f
    v_smfmac_f32_16x16x64_bf16 v[48:51], v[16:19], v[128:135], v116
    buffer_store_dword v126, v119, s[8:11], s55 offen
    v_smfmac_f32_16x16x64_bf16 v[48:51], v[20:23], v[160:167], v116
    v_smfmac_f32_16x16x64_bf16 v[48:51], v[24:27], v[144:151], v116
    s_waitcnt lgkmcnt(0)
    s_barrier
    v_smfmac_f32_16x16x64_bf16 v[48:51], v[28:31], v[176:183], v116
    ds_read_b128 v[32:35], v121 offset:16384
    ds_read_b128 v[36:39], v121 offset:17408
    v_smfmac_f32_16x16x64_bf16 v[52:55], v[16:19], v[136:143], v116
    ds_read_b128 v[40:43], v121 offset:18432
    ds_read_b128 v[44:47], v121 offset:19456
    v_smfmac_f32_16x16x64_bf16 v[52:55], v[20:23], v[168:175], v116
    ds_read_b128 v[8:11], v124 offset:32768
    v_add_f32 v48, v48, v50
    v_smfmac_f32_16x16x64_bf16 v[52:55], v[24:27], v[152:159], v116
    ds_read_b128 v[12:15], v124 offset:33792
    v_add_f32 v49, v49, v51
    v_smfmac_f32_16x16x64_bf16 v[52:55], v[28:31], v[184:191], v116
    s_waitcnt lgkmcnt(5)
    v_cvt_pk_bf16_f32 v112, v48, v49
    v_mfma_f32_16x16x32_bf16 v[56:59], v[56:59], v[32:35], 0
    s_waitcnt lgkmcnt(4)
    v_mov_b32 v48, s50
    v_mov_b32 v49, s50
    v_mfma_f32_16x16x32_bf16 v[56:59], v[60:63], v[36:39], v[56:59]
    ds_read_b128 v[16:19], v124 offset:2048
    s_waitcnt lgkmcnt(4)
    v_mov_b32 v50, s50
    v_mov_b32 v51, s50
    v_mfma_f32_16x16x32_bf16 v[56:59], v[64:67], v[40:43], v[56:59]
    ds_read_b128 v[20:23], v124 offset:3072
    s_waitcnt lgkmcnt(4)
    v_add_f32 v52, v52, v54
    v_mfma_f32_16x16x32_bf16 v[56:59], v[68:71], v[44:47], v[56:59]
    ds_read_b128 v[24:27], v124 offset:4096
    v_add_f32 v53, v53, v55
    v_mfma_f32_16x16x32_bf16 v[60:63], v[72:75], v[32:35], 0
    ds_read_b128 v[28:31], v124 offset:5120
    v_cvt_pk_bf16_f32 v114, v52, v53
    v_mov_b32 v53, 0
    v_mfma_f32_16x16x32_bf16 v[60:63], v[76:79], v[36:39], v[60:63]
    v_exp_f32 v56, v56
    v_mfma_f32_16x16x32_bf16 v[60:63], v[80:83], v[40:43], v[60:63]
    v_exp_f32 v57, v57
    v_mfma_f32_16x16x32_bf16 v[60:63], v[84:87], v[44:47], v[60:63]
    v_exp_f32 v58, v58
    v_mfma_f32_16x16x32_bf16 v[64:67], v[32:35], v[32:35], 0
    v_exp_f32 v59, v59
    v_cvt_pk_bf16_f32 v68, v56, v57
    v_mfma_f32_16x16x32_bf16 v[64:67], v[36:39], v[36:39], v[64:67]
    v_exp_f32 v60, v60
    v_cvt_pk_bf16_f32 v69, v58, v59
    v_mfma_f32_16x16x32_bf16 v[64:67], v[40:43], v[40:43], v[64:67]
    v_exp_f32 v61, v61
    v_mfma_f32_16x16x32_bf16 v[64:67], v[44:47], v[44:47], v[64:67]
    v_exp_f32 v62, v62
    v_exp_f32 v63, v63
    v_cvt_pk_bf16_f32 v70, v60, v61
    v_cvt_pk_bf16_f32 v71, v62, v63
    s_nop 1
    v_mfma_f32_16x16x32_bf16 v[72:75], v[88:91], v[68:71], 0
    s_nop 0
    v_exp_f32 v64, v64
    v_mfma_f32_16x16x32_bf16 v[76:79], v[92:95], v[68:71], 0
    v_exp_f32 v65, v65
    v_mfma_f32_16x16x32_bf16 v[80:83], v[48:51], v[68:71], 0
    v_cvt_pk_bf16_f32 v52, v64, v65
    s_nop 1
    v_mfma_f32_16x16x16_bf16 v[72:75], v[112:113], v[52:53], v[72:75]
    ds_read_b128 v[32:35], v124 offset:6144
    v_mfma_f32_16x16x16_bf16 v[76:79], v[114:115], v[52:53], v[76:79]
    ds_read_b128 v[36:39], v124 offset:7168
    v_mfma_f32_16x16x16_bf16 v[80:83], v[48:49], v[52:53], v[80:83]
L_norm_31:
    s_mov_b64 vcc, s[36:37]
    v_mov_b32 v122, v122
    v_mov_b32 v122, v122
    v_mov_b32 v122, v122
    v_cndmask_b32_dpp v76, v72, v76, vcc quad_perm:[2,3,2,3] row_mask:0xf bank_mask:0xf
    v_cndmask_b32_dpp v77, v73, v77, vcc quad_perm:[2,3,2,3] row_mask:0xf bank_mask:0xf
    v_cndmask_b32_dpp v78, v74, v78, vcc quad_perm:[2,3,2,3] row_mask:0xf bank_mask:0xf
    v_cndmask_b32_dpp v79, v75, v79, vcc quad_perm:[2,3,2,3] row_mask:0xf bank_mask:0xf
    v_rcp_f32_dpp v84, v80 quad_perm:[2,3,2,3] row_mask:0xf bank_mask:0xf
    s_nop 0
    v_pk_mul_f32 v[76:77], v[76:77], v[84:85] op_sel_hi:[1,0]
    v_pk_mul_f32 v[78:79], v[78:79], v[84:85] op_sel_hi:[1,0]
    v_cvt_pk_bf16_f32 v72, v76, v77
    v_cvt_pk_bf16_f32 v73, v78, v79
    ds_write_b64 v122, v[72:73] offset:21504
    v_max_f32_dpp v86, v80, v84 quad_perm:[2,3,2,3] row_mask:0xf bank_mask:0xf
    v_mov_b32_dpp v60, v72 quad_perm:[0,1,0,1] row_mask:0xf bank_mask:0xf
    v_mov_b32_dpp v61, v73 quad_perm:[0,1,0,1] row_mask:0xf bank_mask:0xf
    v_cmp_lt_f32 vcc, s35, v86
    v_mov_b32_dpp v62, v72 quad_perm:[2,3,2,3] row_mask:0xf bank_mask:0xf
    v_mov_b32_dpp v63, v73 quad_perm:[2,3,2,3] row_mask:0xf bank_mask:0xf
    s_nop 1
    v_smfmac_f32_16x16x64_bf16 v[96:99], v[60:63], v[192:199], v116
    s_cbranch_vccnz L_smax_32
    v_smfmac_f32_16x16x64_bf16 v[100:103], v[60:63], v[224:231], v116
    s_waitcnt lgkmcnt(0)
    s_barrier
    ds_read_b128 v[92:95], v127 offset:22016
    ds_read_b128 v[80:83], v127 offset:20480
    ds_read_b128 v[84:87], v127 offset:20992
    v_smfmac_f32_16x16x64_bf16 v[104:107], v[60:63], v[0:7], v116
    ds_read_b128 v[40:43], v124 offset:34816
    v_smfmac_f32_16x16x64_bf16 v[108:111], v[60:63], v[8:15], v116
    ds_read_b128 v[56:59], v124 offset:36864
    s_waitcnt lgkmcnt(4)
    v_smfmac_f32_16x16x64_bf16 v[96:99], v[92:95], v[200:207], v116
    s_waitcnt lgkmcnt(3)
    v_smfmac_f32_16x16x64_bf16 v[96:99], v[80:83], v[208:215], v116
    ds_read_b128 v[44:47], v124 offset:35840
    s_waitcnt lgkmcnt(3)
    v_smfmac_f32_16x16x64_bf16 v[96:99], v[84:87], v[216:223], v116
    ds_read_b128 v[68:71], v124 offset:39936
    v_smfmac_f32_16x16x64_bf16 v[100:103], v[92:95], v[232:239], v116
    ds_read_b128 v[64:67], v124 offset:38912
    v_smfmac_f32_16x16x64_bf16 v[100:103], v[80:83], v[240:247], v116
    ds_read_b128 v[60:63], v124 offset:37888
    v_cvt_pk_bf16_f32 v72, v96, v98
    v_smfmac_f32_16x16x64_bf16 v[100:103], v[84:87], v[248:255], v116
    v_and_or_b32 v72, v72, -2, s33
    v_smfmac_f32_16x16x64_bf16 v[104:107], v[92:95], v[16:23], v116
    v_cvt_pk_bf16_f32 v74, v97, v99
    v_smfmac_f32_16x16x64_bf16 v[104:107], v[80:83], v[24:31], v116
    v_cvt_pk_bf16_f32 v73, v100, v102
    v_cvt_pk_bf16_f32 v75, v101, v103
    v_smfmac_f32_16x16x64_bf16 v[104:107], v[84:87], v[32:39], v116
    buffer_store_dwordx4 v[72:75], v118, s[8:11], s25 offen
    s_waitcnt lgkmcnt(3)
    v_smfmac_f32_16x16x64_bf16 v[108:111], v[92:95], v[40:47], v116
    s_waitcnt lgkmcnt(0)
    v_smfmac_f32_16x16x64_bf16 v[108:111], v[80:83], v[56:63], v116
    v_cvt_pk_bf16_f32 v76, v104, v106
    v_smfmac_f32_16x16x64_bf16 v[108:111], v[84:87], v[64:71], v116
    v_and_or_b32 v76, v76, -2, s33
    v_cvt_pk_bf16_f32 v78, v105, v107
    v_mov_b32 v122, v122
    v_mov_b32 v122, v122
    v_mov_b32 v122, v122
    v_mov_b32 v122, v122
    v_mov_b32 v122, v122
    v_mov_b32 v122, v122
    v_cvt_pk_bf16_f32 v77, v108, v110
    v_cvt_pk_bf16_f32 v79, v109, v111
    buffer_store_dwordx4 v[76:79], v118, s[8:11], s26 offen
    ds_read_b128 v[80:83], v123
    ds_read_b128 v[84:87], v123 offset:1024
    ds_read_b128 v[56:59], v123 offset:2048
    ds_read_b128 v[60:63], v123 offset:3072
    ds_read_b128 v[64:67], v123 offset:32768
    ds_read_b128 v[68:71], v123 offset:33792
    ds_read_b128 v[72:75], v123 offset:34816
    ds_read_b128 v[76:79], v123 offset:35840
    ds_read_b128 v[88:91], v123 offset:4096
    ds_read_b128 v[92:95], v123 offset:5120
    ds_read_b128 v[96:99], v123 offset:6144
    ds_read_b128 v[100:103], v123 offset:7168
    ds_read_b128 v[104:107], v123 offset:36864
    ds_read_b128 v[108:111], v123 offset:37888
    ds_read_b128 v[24:27], v123 offset:38912
    ds_read_b128 v[28:31], v123 offset:39936
    s_add_u32 s30, s30, 0x40000
    s_add_u32 s31, s31, 0x40000
    s_add_u32 s32, s32, 0x20000
    s_add_u32 s23, s24, 2048
    s_add_u32 s48, s23, 4096
    s_xor_b32 s25, s25, 0x40000
    s_xor_b32 s26, s26, 0x40000
    s_mov_b32 s35, 0x49800000
    s_add_u32 s22, s22, 1
    v_cndmask_b32 v12, 0, v125, s[68:69]
    v_cndmask_b32 v13, 0, v125, s[70:71]
    v_cndmask_b32 v14, 0, v125, s[72:73]
    v_cndmask_b32 v15, 0, v125, s[74:75]
    v_mov_b32 v32, 0
    v_mov_b32 v33, 0
    v_mov_b32 v34, 0
    v_mov_b32 v35, 0
    v_mov_b32 v36, 0
    v_mov_b32 v37, 0
    v_mov_b32 v38, 0
    v_mov_b32 v39, 0
    v_mov_b32 v40, 0
    v_mov_b32 v41, 0
    v_mov_b32 v42, 0
    v_mov_b32 v43, 0
    v_mov_b32 v44, 0
    v_mov_b32 v45, 0
    v_mov_b32 v46, 0
    v_mov_b32 v47, 0
    v_mov_b32 v54, 0
    v_mov_b32 v55, 0
    v_mov_b32 v52, 0
    v_mov_b32 v52, 0
    v_mov_b32 v52, 0
    v_mov_b32 v52, 0
    v_mov_b32 v52, 0
    v_mov_b32 v52, 0
    v_mov_b32 v52, 0
    v_mov_b32 v52, 0
    v_mov_b32 v52, 0
    v_mov_b32 v52, 0
    v_mov_b32 v52, 0
    v_mov_b32 v52, 0
    v_mov_b32 v52, 0
    buffer_load_dwordx4 v[4:7], v117, s[8:11], s29 offen nt
    buffer_load_dwordx4 v[8:11], v117, s[8:11], s53 offen nt
    buffer_load_dwordx4 v[16:19], v117, s[8:11], s29 offen offset:2048 nt
    buffer_load_dwordx4 v[20:23], v117, s[8:11], s53 offen offset:2048 nt
    v_mov_b32 v52, 0
    s_waitcnt vmcnt(3)
L_rl_33:
    v_mfma_f32_16x16x32_bf16 v[48:51], v[4:7], v[12:15], 0
    v_xor_b32 v52, s33, v4
    s_waitcnt vmcnt(2)
    v_mfma_f32_16x16x32_bf16 v[48:51], v[8:11], v[12:15], v[48:51]
    v_xor_b32 v53, s33, v8
    v_or_b32 v52, v52, v53
    s_waitcnt vmcnt(1)
    v_mfma_f32_16x16x32_bf16 v[48:51], v[16:19], v[12:15], v[48:51]
    v_xor_b32 v53, s33, v16
    v_or_b32 v52, v52, v53
    s_waitcnt vmcnt(0)
    v_mfma_f32_16x16x32_bf16 v[48:51], v[20:23], v[12:15], v[48:51]
    v_xor_b32 v53, s33, v20
    v_or_b32 v52, v52, v53
    v_and_b32 v52, 1, v52
    v_cmp_ne_u32 vcc, 0, v52
    s_cbranch_vccnz L_rslow_34
L_rgo_35:
    s_nop 2
    v_permlane32_swap_b32 v48, v50
    v_permlane32_swap_b32 v49, v51
    v_pk_add_f32 v[48:49], v[48:49], v[50:51]
    s_mov_b64 exec, s[38:39]
    v_cvt_pk_bf16_f32 v12, v48, v49
    v_min_u32 v12, 0xfffffffe, v12
    buffer_store_dword v12, v119, s[8:11], s24 offen
    s_mov_b64 exec, -1
    s_add_u32 s24, s24, 8192
    s_bitset0_b32 s24, 15
    s_xor_b32 s55, s24, 16384
    s_xor_b32 s29, s29, 0x40000
    s_xor_b32 s53, s29, 1024
    s_bfe_u32 s33, s22, 0x10001
    s_waitcnt lgkmcnt(0)
    s_branch L_chain_top2_f
.p2align 6
L_chain_top3_f:
    buffer_load_dwordx4 v[0:3], v117, s[8:11], s23 offen nt
    v_mov_b32 v48, 0
    v_mov_b32 v49, 0
    v_mov_b32 v50, 0
    v_mov_b32 v51, 0
    v_mov_b32 v52, 0
    v_mov_b32 v53, 0
    v_mov_b32 v15, 0
    v_mov_b32 v15, 0
    v_mov_b32 v15, 0
    v_mov_b32 v15, 0
    v_mov_b32 v15, 0
    v_mov_b32 v15, 0
    v_mov_b32 v15, 0
    v_mov_b32 v15, 0
    v_mov_b32 v15, 0
    v_mov_b32 v15, 0
    buffer_load_dwordx4 v[0:3], v117, s[8:11], s23 offen sc1
    v_mov_b32 v15, 0
    v_mov_b32 v15, 0
    v_mov_b32 v15, 0
    v_mov_b32 v15, 0
    v_mov_b32 v15, 0
    v_mov_b32 v15, 0
    v_mov_b32 v15, 0
    v_mov_b32 v15, 0
    v_mov_b32 v15, 0
    v_mov_b32 v15, 0
    v_mov_b32 v15, 0
    v_mov_b32 v15, 0
    v_mov_b32 v15, 0
    v_mov_b32 v15, 0
    v_mov_b32 v15, 0
    v_mov_b32 v15, 0
L_mret_36:
    buffer_load_dwordx4 v[0:3], v117, s[8:11], s23 offen sc1
    s_add_u32 s45, s45, 1
    s_cmp_lt_u32 s45, 0x10000
    s_cselect_b32 s56, -2, -1
    s_nop 3
    v_mov_b32 v32, 0
    v_mov_b32 v33, 0
    v_mov_b32 v34, 0
    v_mov_b32 v35, 0
    s_waitcnt vmcnt(2)
    v_max3_u32 v15, v0, v1, v2
    v_max_u32 v15, v15, v3
    v_cmp_lt_u32 vcc, s56, v15
    v_smfmac_f32_16x16x64_bf16 v[32:35], v[0:3], v[80:87], v116
    s_cbranch_vccnz L_mret_36
    ds_write_b128 v117, v[0:3] offset:3072
    v_smfmac_f32_16x16x64_bf16 v[36:39], v[0:3], v[56:63], v116
    buffer_load_dwordx4 v[4:7], v117, s[8:11], s48 offen nt
    v_smfmac_f32_16x16x64_bf16 v[40:43], v[0:3], v[64:71], v116
    buffer_load_dwordx4 v117, s[8:11], s48 offen nt lds
    s_mov_b32 m0, 14336
    v_smfmac_f32_16x16x64_bf16 v[44:47], v[0:3], v[72:79], v116
    s_waitcnt lgkmcnt(0)
    s_barrier
    ds_read_b128 v[8:11], v117 offset:2048
    v_smfmac_f32_16x16x64_bf16 v[48:51], v[0:3], a[192:199], v116
    ds_read_b128 v[16:19], v117 offset:1024
    ds_read_b128 v[20:23], v117
    v_smfmac_f32_16x16x64_bf16 v[52:55], v[0:3], a[200:207], v116
    ds_read_b128 v[80:83], v117 offset:14336
    s_waitcnt lgkmcnt(3)
    v_smfmac_f32_16x16x64_bf16 v[32:35], v[8:11], a[0:7], v116
    ds_read_b128 v[84:87], v117 offset:15360
    v_smfmac_f32_16x16x64_bf16 v[36:39], v[8:11], a[8:15], v116
    ds_read_b128 v[56:59], v117 offset:8192
    s_waitcnt lgkmcnt(4)
    v_smfmac_f32_16x16x64_bf16 v[32:35], v[16:19], a[32:39], v116
    ds_read_b128 v[60:63], v117 offset:9216
    v_smfmac_f32_16x16x64_bf16 v[36:39], v[16:19], a[40:47], v116
    ds_read_b128 v[64:67], v117 offset:10240
    s_waitcnt lgkmcnt(5)
    v_smfmac_f32_16x16x64_bf16 v[32:35], v[20:23], a[64:71], v116
    ds_read_b128 v[68:71], v117 offset:11264
    v_smfmac_f32_16x16x64_bf16 v[36:39], v[20:23], a[72:79], v116
    ds_read_b128 v[72:75], v117 offset:12288
    v_smfmac_f32_16x16x64_bf16 v[40:43], v[8:11], a[96:103], v116
    ds_read_b128 v[76:79], v117 offset:13312
    v_smfmac_f32_16x16x64_bf16 v[40:43], v[16:19], a[128:135], v116
    buffer_store_dwordx4 v[112:115], v117, s[8:11], s32 offen sc1
    v_smfmac_f32_16x16x64_bf16 v[40:43], v[20:23], a[160:167], v116
    s_waitcnt vmcnt(2)
    v_max3_u32 v15, v4, v5, v6
    v_smfmac_f32_16x16x64_bf16 v[44:47], v[8:11], a[104:111], v116
    v_max_u32 v15, v15, v7
    v_smfmac_f32_16x16x64_bf16 v[44:47], v[16:19], a[136:143], v116
    s_waitcnt vmcnt(1) lgkmcnt(0)
    v_cmp_lt_u32 vcc, s56, v15
    v_smfmac_f32_16x16x64_bf16 v[44:47], v[20:23], a[168:175], v116
    s_cbranch_vccnz L_mret_37
L_mgo_38:
    v_smfmac_f32_16x16x64_bf16 v[44:47], v[4:7], v[24:31], v116
    s_barrier
    ds_read_b128 v[12:15], v117 offset:6144
    v_smfmac_f32_16x16x64_bf16 v[32:35], v[4:7], v[88:95], v116
    ds_read_b128 v[24:27], v117 offset:5120
    v_smfmac_f32_16x16x64_bf16 v[36:39], v[4:7], v[96:103], v116
    ds_read_b128 v[28:31], v117 offset:4096
    v_smfmac_f32_16x16x64_bf16 v[40:43], v[4:7], v[104:111], v116
    ds_read_b128 v[88:91], v117 offset:30720
    s_waitcnt lgkmcnt(3)
    v_smfmac_f32_16x16x64_bf16 v[32:35], v[12:15], a[16:23], v116
    ds_read_b128 v[92:95], v117 offset:31744
    s_waitcnt lgkmcnt(3)
    v_smfmac_f32_16x16x64_bf16 v[32:35], v[24:27], a[48:55], v116
    ds_read_b128 v[96:99], v117 offset:23552
    s_waitcnt lgkmcnt(3)
    v_smfmac_f32_16x16x64_bf16 v[32:35], v[28:31], a[80:87], v116
    buffer_load_dwordx4 v117, s[8:11], s30 offen lds
    v_smfmac_f32_16x16x64_bf16 v[36:39], v[12:15], a[24:31], v116
    ds_read_b128 v[100:103], v117 offset:23552
    v_smfmac_f32_16x16x64_bf16 v[36:39], v[24:27], a[56:63], v116
    ds_read_b128 v[104:107], v117 offset:23552
    v_add_f32 v32, v32, v34
    v_smfmac_f32_16x16x64_bf16 v[36:39], v[28:31], a[88:95], v116
    buffer_load_dwordx4 v117, s[8:11], s30 offen offset:1024 lds
    s_add_u32 m0, s52, 0x6000
    v_add_f32 v33, v33, v35
    v_smfmac_f32_16x16x64_bf16 v[40:43], v[12:15], a[112:119], v116
    ds_read_b128 v[108:111], v117 offset:23552
    v_mul_f32 v32, s34, v32
    v_smfmac_f32_16x16x64_bf16 v[40:43], v[24:27], a[144:151], v116
    ds_read_b128 v[0:3], v124
    v_mul_f32 v33, s34, v33
    v_smfmac_f32_16x16x64_bf16 v[40:43], v[28:31], a[176:183], v116
    s_waitcnt lgkmcnt(5)
    buffer_load_dwordx4 v117, s[8:11], s31 offen lds
    v_add_f32 v36, v36, v38
    v_smfmac_f32_16x16x64_bf16 v[48:51], v[4:7], a[208:215], v116
    v_add_f32 v37, v37, v39
    v_smfmac_f32_16x16x64_bf16 v[52:55], v[4:7], a[216:223], v116
    ds_read_b128 v[4:7], v124 offset:1024
    v_mul_f32 v36, s34, v36
    v_smfmac_f32_16x16x64_bf16 v[44:47], v[12:15], a[120:127], v116
    buffer_load_dwordx4 v117, s[8:11], s31 offen offset:1024 lds
    s_mov_b32 m0, 7168
    v_mul_f32 v37, s34, v37
    v_smfmac_f32_16x16x64_bf16 v[44:47], v[24:27], a[152:159], v116
    v_cvt_pk_bf16_f32 v34, v32, v36
    v_smfmac_f32_16x16x64_bf16 v[44:47], v[28:31], a[184:191], v116
    v_cvt_pk_bf16_f32 v35, v33, v37
    v_add_f32 v40, v40, v42
    v_smfmac_f32_16x16x64_bf16 v[48:51], v[8:11], a[224:231], v116
    ds_write2_b32 v120, v34, v35 offset0:32 offset1:48
    v_add_f32 v41, v41, v43
    v_smfmac_f32_16x16x64_bf16 v[52:55], v[8:11], a[232:239], v116
    v_add_f32 v44, v44, v46
    v_add_f32 v45, v45, v47
    v_cvt_pk_bf16_f32 v113, v40, v44
    v_cvt_pk_bf16_f32 v115, v41, v45
    v_smfmac_f32_16x16x64_bf16 v[48:51], v[12:15], a[240:247], v116
    ds_write2_b32 v120, v113, v115 offset0:0 offset1:16
    v_smfmac_f32_16x16x64_bf16 v[52:55], v[12:15], a[248:255], v116
    s_cmp_eq_u32 s22, 63
    s_cbranch_scc1 L_chain_last_f
    v_smfmac_f32_16x16x64_bf16 v[48:51], v[16:19], v[128:135], v116
    v_smfmac_f32_16x16x64_bf16 v[48:51], v[20:23], v[160:167], v116
    buffer_store_dword v126, v119, s[8:11], s55 offen
    v_smfmac_f32_16x16x64_bf16 v[48:51], v[24:27], v[144:151], v116
    s_waitcnt lgkmcnt(0)
    s_barrier
    v_smfmac_f32_16x16x64_bf16 v[48:51], v[28:31], v[176:183], v116
    ds_read_b128 v[32:35], v121 offset:16384
    ds_read_b128 v[36:39], v121 offset:17408
    v_smfmac_f32_16x16x64_bf16 v[52:55], v[16:19], v[136:143], v116
    ds_read_b128 v[40:43], v121 offset:18432
    ds_read_b128 v[44:47], v121 offset:19456
    v_smfmac_f32_16x16x64_bf16 v[52:55], v[20:23], v[168:175], v116
    ds_read_b128 v[8:11], v124 offset:32768
    v_add_f32 v48, v48, v50
    v_smfmac_f32_16x16x64_bf16 v[52:55], v[24:27], v[152:159], v116
    ds_read_b128 v[12:15], v124 offset:33792
    v_add_f32 v49, v49, v51
    v_smfmac_f32_16x16x64_bf16 v[52:55], v[28:31], v[184:191], v116
    s_waitcnt lgkmcnt(5)
    v_cvt_pk_bf16_f32 v112, v48, v49
    v_mfma_f32_16x16x32_bf16 v[56:59], v[56:59], v[32:35], 0
    s_waitcnt lgkmcnt(4)
    v_mov_b32 v48, s50
    v_mov_b32 v49, s50
    v_mfma_f32_16x16x32_bf16 v[56:59], v[60:63], v[36:39], v[56:59]
    ds_read_b128 v[16:19], v124 offset:2048
    s_waitcnt lgkmcnt(4)
    v_mov_b32 v50, s50
    v_mov_b32 v51, s50
    v_mfma_f32_16x16x32_bf16 v[56:59], v[64:67], v[40:43], v[56:59]
    ds_read_b128 v[20:23], v124 offset:3072
    s_waitcnt lgkmcnt(4)
    v_add_f32 v52, v52, v54
    v_mfma_f32_16x16x32_bf16 v[56:59], v[68:71], v[44:47], v[56:59]
    ds_read_b128 v[24:27], v124 offset:4096
    v_add_f32 v53, v53, v55
    v_mfma_f32_16x16x32_bf16 v[60:63], v[72:75], v[32:35], 0
    ds_read_b128 v[28:31], v124 offset:5120
    v_cvt_pk_bf16_f32 v114, v52, v53
    v_mov_b32 v53, 0
    v_mfma_f32_16x16x32_bf16 v[60:63], v[76:79], v[36:39], v[60:63]
    v_exp_f32 v56, v56
    v_mfma_f32_16x16x32_bf16 v[60:63], v[80:83], v[40:43], v[60:63]
    v_exp_f32 v57, v57
    v_mfma_f32_16x16x32_bf16 v[60:63], v[84:87], v[44:47], v[60:63]
    v_exp_f32 v58, v58
    v_mfma_f32_16x16x32_bf16 v[64:67], v[32:35], v[32:35], 0
    v_exp_f32 v59, v59
    v_cvt_pk_bf16_f32 v68, v56, v57
    v_mfma_f32_16x16x32_bf16 v[64:67], v[36:39], v[36:39], v[64:67]
    v_exp_f32 v60, v60
    v_cvt_pk_bf16_f32 v69, v58, v59
    v_mfma_f32_16x16x32_bf16 v[64:67], v[40:43], v[40:43], v[64:67]
    v_exp_f32 v61, v61
    v_mfma_f32_16x16x32_bf16 v[64:67], v[44:47], v[44:47], v[64:67]
    v_exp_f32 v62, v62
    v_exp_f32 v63, v63
    v_cvt_pk_bf16_f32 v70, v60, v61
    v_cvt_pk_bf16_f32 v71, v62, v63
    s_nop 1
    v_mfma_f32_16x16x32_bf16 v[72:75], v[88:91], v[68:71], 0
    s_nop 0
    v_exp_f32 v64, v64
    v_mfma_f32_16x16x32_bf16 v[76:79], v[92:95], v[68:71], 0
    v_exp_f32 v65, v65
    v_mfma_f32_16x16x32_bf16 v[80:83], v[48:51], v[68:71], 0
    v_cvt_pk_bf16_f32 v52, v64, v65
    s_nop 1
    v_mfma_f32_16x16x16_bf16 v[72:75], v[112:113], v[52:53], v[72:75]
    ds_read_b128 v[32:35], v124 offset:6144
    v_mfma_f32_16x16x16_bf16 v[76:79], v[114:115], v[52:53], v[76:79]
    ds_read_b128 v[36:39], v124 offset:7168
    v_mfma_f32_16x16x16_bf16 v[80:83], v[48:49], v[52:53], v[80:83]
L_norm_39:
    s_mov_b64 vcc, s[36:37]
    v_mov_b32 v122, v122
    v_mov_b32 v122, v122
    v_mov_b32 v122, v122
    v_cndmask_b32_dpp v76, v72, v76, vcc quad_perm:[2,3,2,3] row_mask:0xf bank_mask:0xf
    v_cndmask_b32_dpp v77, v73, v77, vcc quad_perm:[2,3,2,3] row_mask:0xf bank_mask:0xf
    v_cndmask_b32_dpp v78, v74, v78, vcc quad_perm:[2,3,2,3] row_mask:0xf bank_mask:0xf
    v_cndmask_b32_dpp v79, v75, v79, vcc quad_perm:[2,3,2,3] row_mask:0xf bank_mask:0xf
    v_rcp_f32_dpp v84, v80 quad_perm:[2,3,2,3] row_mask:0xf bank_mask:0xf
    s_nop 0
    v_pk_mul_f32 v[76:77], v[76:77], v[84:85] op_sel_hi:[1,0]
    v_pk_mul_f32 v[78:79], v[78:79], v[84:85] op_sel_hi:[1,0]
    v_cvt_pk_bf16_f32 v72, v76, v77
    v_cvt_pk_bf16_f32 v73, v78, v79
    ds_write_b64 v122, v[72:73] offset:22016
    v_max_f32_dpp v86, v80, v84 quad_perm:[2,3,2,3] row_mask:0xf bank_mask:0xf
    v_mov_b32_dpp v60, v72 quad_perm:[0,1,0,1] row_mask:0xf bank_mask:0xf
    v_mov_b32_dpp v61, v73 quad_perm:[0,1,0,1] row_mask:0xf bank_mask:0xf
    v_cmp_lt_f32 vcc, s35, v86
    v_mov_b32_dpp v62, v72 quad_perm:[2,3,2,3] row_mask:0xf bank_mask:0xf
    v_mov_b32_dpp v63, v73 quad_perm:[2,3,2,3] row_mask:0xf bank_mask:0xf
    s_nop 1
    v_smfmac_f32_16x16x64_bf16 v[96:99], v[60:63], v[192:199], v116
    s_cbranch_vccnz L_smax_40
    v_smfmac_f32_16x16x64_bf16 v[100:103], v[60:63], v[224:231], v116
    s_waitcnt lgkmcnt(0)
    s_barrier
    ds_read_b128 v[92:95], v127 offset:21504
    ds_read_b128 v[80:83], v127 offset:20992
    ds_read_b128 v[84:87], v127 offset:20480
    v_smfmac_f32_16x16x64_bf16 v[104:107], v[60:63], v[0:7], v116
    ds_read_b128 v[40:43], v124 offset:34816
    v_smfmac_f32_16x16x64_bf16 v[108:111], v[60:63], v[8:15], v116
    ds_read_b128 v[56:59], v124 offset:36864
    s_waitcnt lgkmcnt(4)
    v_smfmac_f32_16x16x64_bf16 v[96:99], v[92:95], v[200:207], v116
    s_waitcnt lgkmcnt(3)
    v_smfmac_f32_16x16x64_bf16 v[96:99], v[80:83], v[208:215], v116
    ds_read_b128 v[44:47], v124 offset:35840
    s_waitcnt lgkmcnt(3)
    v_smfmac_f32_16x16x64_bf16 v[96:99], v[84:87], v[216:223], v116
    ds_read_b128 v[68:71], v124 offset:39936
    v_smfmac_f32_16x16x64_bf16 v[100:103], v[92:95], v[232:239], v116
    ds_read_b128 v[64:67], v124 offset:38912
    v_smfmac_f32_16x16x64_bf16 v[100:103], v[80:83], v[240:247], v116
    ds_read_b128 v[60:63], v124 offset:37888
    v_cvt_pk_bf16_f32 v72, v96, v98
    v_smfmac_f32_16x16x64_bf16 v[100:103], v[84:87], v[248:255], v116
    v_and_or_b32 v72, v72, -2, s33
    v_smfmac_f32_16x16x64_bf16 v[104:107], v[92:95], v[16:23], v116
    v_cvt_pk_bf16_f32 v74, v97, v99
    v_smfmac_f32_16x16x64_bf16 v[104:107], v[80:83], v[24:31], v116
    v_cvt_pk_bf16_f32 v73, v100, v102
    v_cvt_pk_bf16_f32 v75, v101, v103
    v_smfmac_f32_16x16x64_bf16 v[104:107], v[84:87], v[32:39], v116
    buffer_store_dwordx4 v[72:75], v118, s[8:11], s25 offen
    s_waitcnt lgkmcnt(3)
    v_smfmac_f32_16x16x64_bf16 v[108:111], v[92:95], v[40:47], v116
    s_waitcnt lgkmcnt(0)
    v_smfmac_f32_16x16x64_bf16 v[108:111], v[80:83], v[56:63], v116
    v_cvt_pk_bf16_f32 v76, v104, v106
    v_smfmac_f32_16x16x64_bf16 v[108:111], v[84:87], v[64:71], v116
    v_and_or_b32 v76, v76, -2, s33
    v_cvt_pk_bf16_f32 v78, v105, v107
    v_mov_b32 v122, v122
    v_mov_b32 v122, v122
    v_mov_b32 v122, v122
    v_mov_b32 v122, v122
    v_mov_b32 v122, v122
    v_mov_b32 v122, v122
    v_cvt_pk_bf16_f32 v77, v108, v110
    v_cvt_pk_bf16_f32 v79, v109, v111
    buffer_store_dwordx4 v[76:79], v118, s[8:11], s26 offen
    ds_read_b128 v[80:83], v123
    ds_read_b128 v[84:87], v123 offset:1024
    ds_read_b128 v[56:59], v123 offset:2048
    ds_read_b128 v[60:63], v123 offset:3072
    ds_read_b128 v[64:67], v123 offset:32768
    ds_read_b128 v[68:71], v123 offset:33792
    ds_read_b128 v[72:75], v123 offset:34816
    ds_read_b128 v[76:79], v123 offset:35840
    ds_read_b128 v[88:91], v123 offset:4096
    ds_read_b128 v[92:95], v123 offset:5120
    ds_read_b128 v[96:99], v123 offset:6144
    ds_read_b128 v[100:103], v123 offset:7168
    ds_read_b128 v[104:107], v123 offset:36864
    ds_read_b128 v[108:111], v123 offset:37888
    ds_read_b128 v[24:27], v123 offset:38912
    ds_read_b128 v[28:31], v123 offset:39936
    s_add_u32 s30, s30, 0x40000
    s_add_u32 s31, s31, 0x40000
    s_add_u32 s32, s32, 0x20000
    s_add_u32 s23, s24, 3072
    s_add_u32 s48, s23, 4096
    s_xor_b32 s25, s25, 0x40000
    s_xor_b32 s26, s26, 0x40000
    s_mov_b32 s35, 0x49800000
    s_add_u32 s22, s22, 1
    v_cndmask_b32 v12, 0, v125, s[68:69]
    v_cndmask_b32 v13, 0, v125, s[70:71]
    v_cndmask_b32 v14, 0, v125, s[72:73]
    v_cndmask_b32 v15, 0, v125, s[74:75]
    v_mov_b32 v32, 0
    v_mov_b32 v33, 0
    v_mov_b32 v34, 0
    v_mov_b32 v35, 0
    v_mov_b32 v36, 0
    v_mov_b32 v37, 0
    v_mov_b32 v38, 0
    v_mov_b32 v39, 0
    v_mov_b32 v40, 0
    v_mov_b32 v41, 0
    v_mov_b32 v42, 0
    v_mov_b32 v43, 0
    v_mov_b32 v44, 0
    v_mov_b32 v45, 0
    v_mov_b32 v46, 0
    v_mov_b32 v47, 0
    v_mov_b32 v54, 0
    v_mov_b32 v55, 0
    v_mov_b32 v52, 0
    v_mov_b32 v52, 0
    v_mov_b32 v52, 0
    v_mov_b32 v52, 0
    v_mov_b32 v52, 0
    v_mov_b32 v52, 0
    v_mov_b32 v52, 0
    v_mov_b32 v52, 0
    v_mov_b32 v52, 0
    v_mov_b32 v52, 0
    v_mov_b32 v52, 0
    v_mov_b32 v52, 0
    v_mov_b32 v52, 0
    v_mov_b32 v52, 0
    v_mov_b32 v52, 0
    v_mov_b32 v52, 0
    v_mov_b32 v52, 0
    v_mov_b32 v52, 0
    v_mov_b32 v52, 0
    v_mov_b32 v52, 0
    v_mov_b32 v52, 0
    v_mov_b32 v52, 0
    v_mov_b32 v52, 0
    v_mov_b32 v52, 0
    v_mov_b32 v52, 0
    v_mov_b32 v52, 0
    v_mov_b32 v52, 0
    v_mov_b32 v52, 0
    v_mov_b32 v52, 0
    v_mov_b32 v52, 0
    v_mov_b32 v52, 0
    v_mov_b32 v52, 0
    v_mov_b32 v52, 0
    v_mov_b32 v52, 0
    v_mov_b32 v52, 0
    v_mov_b32 v52, 0
    v_mov_b32 v52, 0
    v_mov_b32 v52, 0
    v_mov_b32 v52, 0
    v_mov_b32 v52, 0
    v_mov_b32 v52, 0
    v_mov_b32 v52, 0
    v_mov_b32 v52, 0
    buffer_load_dwordx4 v[4:7], v117, s[8:11], s29 offen nt
    buffer_load_dwordx4 v[8:11], v117, s[8:11], s53 offen nt
    buffer_load_dwordx4 v[16:19], v117, s[8:11], s29 offen offset:2048 nt
    buffer_load_dwordx4 v[20:23], v117, s[8:11], s53 offen offset:2048 nt
    v_mov_b32 v52, 0
    s_waitcnt vmcnt(3)
L_rl_41:
    v_mfma_f32_16x16x32_bf16 v[48:51], v[4:7], v[12:15], 0
    v_xor_b32 v52, s33, v4
    s_waitcnt vmcnt(2)
    v_mfma_f32_16x16x32_bf16 v[48:51], v[8:11], v[12:15], v[48:51]
    v_xor_b32 v53, s33, v8
    v_or_b32 v52, v52, v53
    s_waitcnt vmcnt(1)
    v_mfma_f32_16x16x32_bf16 v[48:51], v[16:19], v[12:15], v[48:51]
    v_xor_b32 v53, s33, v16
    v_or_b32 v52, v52, v53
    s_waitcnt vmcnt(0)
    v_mfma_f32_16x16x32_bf16 v[48:51], v[20:23], v[12:15], v[48:51]
    v_xor_b32 v53, s33, v20
    v_or_b32 v52, v52, v53
    v_and_b32 v52, 1, v52
    v_cmp_ne_u32 vcc, 0, v52
    s_cbranch_vccnz L_rslow_42
L_rgo_43:
    s_nop 2
    v_permlane32_swap_b32 v48, v50
    v_permlane32_swap_b32 v49, v51
    v_pk_add_f32 v[48:49], v[48:49], v[50:51]
    s_mov_b64 exec, s[38:39]
    v_cvt_pk_bf16_f32 v12, v48, v49
    v_min_u32 v12, 0xfffffffe, v12
    buffer_store_dword v12, v119, s[8:11], s24 offen
    s_mov_b64 exec, -1
    s_add_u32 s24, s24, 8192
    s_bitset0_b32 s24, 15
    s_xor_b32 s55, s24, 16384
    s_xor_b32 s29, s29, 0x40000
    s_xor_b32 s53, s29, 1024
    s_bfe_u32 s33, s22, 0x10001
    s_waitcnt lgkmcnt(0)
    s_branch L_chain_top3_f
L_chain_last_f:
    s_nop 1
    v_smfmac_f32_16x16x64_bf16 v[48:51], v[16:19], v[128:135], v116
    v_smfmac_f32_16x16x64_bf16 v[48:51], v[20:23], v[160:167], v116
    v_smfmac_f32_16x16x64_bf16 v[48:51], v[24:27], v[144:151], v116
    v_smfmac_f32_16x16x64_bf16 v[48:51], v[28:31], v[176:183], v116
    v_smfmac_f32_16x16x64_bf16 v[52:55], v[16:19], v[136:143], v116
    v_smfmac_f32_16x16x64_bf16 v[52:55], v[20:23], v[168:175], v116
    v_smfmac_f32_16x16x64_bf16 v[52:55], v[24:27], v[152:159], v116
    v_smfmac_f32_16x16x64_bf16 v[52:55], v[28:31], v[184:191], v116
    v_add_f32 v48, v48, v50
    v_add_f32 v49, v49, v51
    v_cvt_pk_bf16_f32 v112, v48, v49
    s_nop 4
    v_add_f32 v52, v52, v54
    v_add_f32 v53, v53, v55
    v_cvt_pk_bf16_f32 v114, v52, v53
    s_add_u32 s32, s32, 0x20000
    buffer_store_dwordx4 v[112:115], v117, s[8:11], s32 offen sc1
    v_mov_b32 v94, 64
    s_waitcnt vmcnt(0) lgkmcnt(0)
    s_barrier
    s_mov_b64 exec, 1
    buffer_store_dword v94, off, s[8:11], s44 sc1
    s_mov_b64 exec, -1
    s_endpgm
L_mret_15:
    s_mov_b32 s43, m0
    s_mov_b32 m0, 4096
    buffer_load_dwordx4 v[4:7], v117, s[8:11], s48 offen sc1
    buffer_load_dwordx4 v117, s[8:11], s48 offen sc1 lds
    s_mov_b32 m0, 8192
    s_mov_b32 m0, s43
    s_waitcnt vmcnt(0)
    v_max3_u32 v15, v4, v5, v6
    v_max_u32 v15, v15, v7
    v_cmp_lt_u32 vcc, s56, v15
    s_add_u32 s47, s47, 1
    s_add_u32 s49, s49, 1
    s_cmp_ge_u32 s49, 0x10000
    s_cbranch_scc1 L_mgo_16
    s_cbranch_vccnz L_mret_15
    s_branch L_mgo_16
L_smax_18:
    s_add_u32 s47, s47, 1
    s_mov_b32 s35, 0x7f800000
    s_waitcnt lgkmcnt(0)
    s_sub_u32 s43, s30, 0x40000
    s_add_u32 s40, s43, 4096
    s_nop 7
    buffer_load_dwordx4 v[56:59], v117, s[8:11], s43 offen
    buffer_load_dwordx4 v[60:63], v117, s[8:11], s43 offen offset:1024
    buffer_load_dwordx4 v[64:67], v117, s[8:11], s43 offen offset:2048
    buffer_load_dwordx4 v[68:71], v117, s[8:11], s43 offen offset:3072
    buffer_load_dwordx4 v[72:75], v117, s[8:11], s40 offen
    buffer_load_dwordx4 v[76:79], v117, s[8:11], s40 offen offset:1024
    buffer_load_dwordx4 v[80:83], v117, s[8:11], s40 offen offset:2048
    buffer_load_dwordx4 v[84:87], v117, s[8:11], s40 offen offset:3072
    ds_read_b128 v[32:35], v121 offset:16384
    ds_read_b128 v[36:39], v121 offset:17408
    ds_read_b128 v[40:43], v121 offset:18432
    ds_read_b128 v[44:47], v121 offset:19456
    v_mov_b32 v96, 0
    v_mov_b32 v97, 0
    v_mov_b32 v98, 0
    v_mov_b32 v99, 0
    v_mov_b32 v100, 0
    v_mov_b32 v101, 0
    v_mov_b32 v102, 0
    v_mov_b32 v103, 0
    v_mov_b32 v104, 0
    v_mov_b32 v105, 0
    v_mov_b32 v106, 0
    v_mov_b32 v107, 0
    v_mov_b32 v108, 0
    v_mov_b32 v109, 0
    v_mov_b32 v110, 0
    v_mov_b32 v111, 0
    s_waitcnt vmcnt(0) lgkmcnt(0)
    v_mfma_f32_16x16x32_bf16 v[56:59], v[56:59], v[32:35], 0
    v_mfma_f32_16x16x32_bf16 v[56:59], v[60:63], v[36:39], v[56:59]
    v_mfma_f32_16x16x32_bf16 v[56:59], v[64:67], v[40:43], v[56:59]
    v_mfma_f32_16x16x32_bf16 v[56:59], v[68:71], v[44:47], v[56:59]
    v_mfma_f32_16x16x32_bf16 v[60:63], v[72:75], v[32:35], 0
    v_mfma_f32_16x16x32_bf16 v[60:63], v[76:79], v[36:39], v[60:63]
    v_mfma_f32_16x16x32_bf16 v[60:63], v[80:83], v[40:43], v[60:63]
    v_mfma_f32_16x16x32_bf16 v[60:63], v[84:87], v[44:47], v[60:63]
    v_mfma_f32_16x16x32_bf16 v[64:67], v[32:35], v[32:35], 0
    v_mfma_f32_16x16x32_bf16 v[64:67], v[36:39], v[36:39], v[64:67]
    v_mfma_f32_16x16x32_bf16 v[64:67], v[40:43], v[40:43], v[64:67]
    v_mfma_f32_16x16x32_bf16 v[64:67], v[44:47], v[44:47], v[64:67]
    v_max3_f32 v84, v56, v57, v58
    v_max3_f32 v84, v84, v59, v60
    v_max3_f32 v84, v84, v61, v62
    s_nop 4
    v_max3_f32 v84, v84, v63, v64
    v_max_f32 v84, v84, v65
    v_mov_b32 v85, v84
    s_nop 1
    v_permlane32_swap_b32 v85, v84
    v_max_f32 v84, v85, v84
    v_mov_b32 v85, v84
    s_nop 1
    v_permlane16_swap_b32 v85, v84
    v_max_f32 v84, v85, v84
    v_sub_f32 v56, v56, v84
    v_sub_f32 v57, v57, v84
    v_sub_f32 v58, v58, v84
    v_sub_f32 v59, v59, v84
    v_sub_f32 v60, v60, v84
    v_sub_f32 v61, v61, v84
    v_sub_f32 v62, v62, v84
    v_sub_f32 v63, v63, v84
    v_sub_f32 v64, v64, v84
    v_sub_f32 v65, v65, v84
    v_exp_f32 v56, v56
    v_exp_f32 v57, v57
    v_exp_f32 v58, v58
    v_exp_f32 v59, v59
    v_exp_f32 v60, v60
    v_exp_f32 v61, v61
    v_exp_f32 v62, v62
    v_exp_f32 v63, v63
    v_exp_f32 v64, v64
    v_exp_f32 v65, v65
    v_cvt_pk_bf16_f32 v68, v56, v57
    v_cvt_pk_bf16_f32 v69, v58, v59
    v_cvt_pk_bf16_f32 v70, v60, v61
    v_cvt_pk_bf16_f32 v71, v62, v63
    v_cvt_pk_bf16_f32 v52, v64, v65
    s_nop 0
    v_mfma_f32_16x16x32_bf16 v[72:75], v[88:91], v[68:71], 0
    v_mfma_f32_16x16x32_bf16 v[76:79], v[92:95], v[68:71], 0
    v_mfma_f32_16x16x32_bf16 v[80:83], v[48:51], v[68:71], 0
    v_mfma_f32_16x16x16_bf16 v[72:75], v[112:113], v[52:53], v[72:75]
    v_mfma_f32_16x16x16_bf16 v[76:79], v[114:115], v[52:53], v[76:79]
    v_mfma_f32_16x16x16_bf16 v[80:83], v[48:49], v[52:53], v[80:83]
    ds_read_b128 v[32:35], v124 offset:6144
    ds_read_b128 v[36:39], v124 offset:7168
    ds_read_b128 v[40:43], v124 offset:34816
    ds_read_b128 v[44:47], v124 offset:35840
    ds_read_b128 v[56:59], v124 offset:36864
    ds_read_b128 v[64:67], v124 offset:38912
    ds_read_b128 v[68:71], v124 offset:39936
    s_waitcnt lgkmcnt(0)
    s_branch L_norm_17
L_kvw_19:
    s_add_u32 s47, s47, 1
    s_add_u32 s49, s49, 1
    s_cmp_ge_u32 s49, 0x10000
    s_cbranch_scc1 L_kvb_20
    s_sleep 4
    buffer_load_dword v125, v119, s[8:11], s28 offen sc1
    s_waitcnt vmcnt(0)
    v_cmp_eq_u32 vcc, 0, v125
    s_nop 0
    s_and_b64 vcc, vcc, s[58:59]
    s_cbranch_scc1 L_kvw_19
    s_branch L_kvb_20
L_mret_22:
    s_mov_b32 s43, m0
    s_mov_b32 m0, 5120
    buffer_load_dwordx4 v[4:7], v117, s[8:11], s48 offen sc1
    buffer_load_dwordx4 v117, s[8:11], s48 offen sc1 lds
    s_mov_b32 m0, 10240
    s_mov_b32 m0, s43
    s_waitcnt vmcnt(0)
    v_max3_u32 v15, v4, v5, v6
    v_max_u32 v15, v15, v7
    v_cmp_lt_u32 vcc, s56, v15
    s_add_u32 s47, s47, 1
    s_add_u32 s49, s49, 1
    s_cmp_ge_u32 s49, 0x10000
    s_cbranch_scc1 L_mgo_23
    s_cbranch_vccnz L_mret_22
    s_branch L_mgo_23
L_smax_25:
    s_add_u32 s47, s47, 1
    s_mov_b32 s35, 0x7f800000
    s_waitcnt lgkmcnt(0)
    s_sub_u32 s43, s30, 0x40800
    s_add_u32 s40, s43, 4096
    s_nop 7
    buffer_load_dwordx4 v[56:59], v117, s[8:11], s43 offen
    buffer_load_dwordx4 v[60:63], v117, s[8:11], s43 offen offset:1024
    buffer_load_dwordx4 v[64:67], v117, s[8:11], s43 offen offset:2048
    buffer_load_dwordx4 v[68:71], v117, s[8:11], s43 offen offset:3072
    buffer_load_dwordx4 v[72:75], v117, s[8:11], s40 offen
    buffer_load_dwordx4 v[76:79], v117, s[8:11], s40 offen offset:1024
    buffer_load_dwordx4 v[80:83], v117, s[8:11], s40 offen offset:2048
    buffer_load_dwordx4 v[84:87], v117, s[8:11], s40 offen offset:3072
    ds_read_b128 v[32:35], v121 offset:16384
    ds_read_b128 v[36:39], v121 offset:17408
    ds_read_b128 v[40:43], v121 offset:18432
    ds_read_b128 v[44:47], v121 offset:19456
    v_mov_b32 v96, 0
    v_mov_b32 v97, 0
    v_mov_b32 v98, 0
    v_mov_b32 v99, 0
    v_mov_b32 v100, 0
    v_mov_b32 v101, 0
    v_mov_b32 v102, 0
    v_mov_b32 v103, 0
    v_mov_b32 v104, 0
    v_mov_b32 v105, 0
    v_mov_b32 v106, 0
    v_mov_b32 v107, 0
    v_mov_b32 v108, 0
    v_mov_b32 v109, 0
    v_mov_b32 v110, 0
    v_mov_b32 v111, 0
    s_waitcnt vmcnt(0) lgkmcnt(0)
    v_mfma_f32_16x16x32_bf16 v[56:59], v[56:59], v[32:35], 0
    v_mfma_f32_16x16x32_bf16 v[56:59], v[60:63], v[36:39], v[56:59]
    v_mfma_f32_16x16x32_bf16 v[56:59], v[64:67], v[40:43], v[56:59]
    v_mfma_f32_16x16x32_bf16 v[56:59], v[68:71], v[44:47], v[56:59]
    v_mfma_f32_16x16x32_bf16 v[60:63], v[72:75], v[32:35], 0
    v_mfma_f32_16x16x32_bf16 v[60:63], v[76:79], v[36:39], v[60:63]
    v_mfma_f32_16x16x32_bf16 v[60:63], v[80:83], v[40:43], v[60:63]
    v_mfma_f32_16x16x32_bf16 v[60:63], v[84:87], v[44:47], v[60:63]
    v_mfma_f32_16x16x32_bf16 v[64:67], v[32:35], v[32:35], 0
    v_mfma_f32_16x16x32_bf16 v[64:67], v[36:39], v[36:39], v[64:67]
    v_mfma_f32_16x16x32_bf16 v[64:67], v[40:43], v[40:43], v[64:67]
    v_mfma_f32_16x16x32_bf16 v[64:67], v[44:47], v[44:47], v[64:67]
    v_max3_f32 v84, v56, v57, v58
    v_max3_f32 v84, v84, v59, v60
    v_max3_f32 v84, v84, v61, v62
    s_nop 4
    v_max3_f32 v84, v84, v63, v64
    v_max_f32 v84, v84, v65
    v_mov_b32 v85, v84
    s_nop 1
    v_permlane32_swap_b32 v85, v84
    v_max_f32 v84, v85, v84
    v_mov_b32 v85, v84
    s_nop 1
    v_permlane16_swap_b32 v85, v84
    v_max_f32 v84, v85, v84
    v_sub_f32 v56, v56, v84
    v_sub_f32 v57, v57, v84
    v_sub_f32 v58, v58, v84
    v_sub_f32 v59, v59, v84
    v_sub_f32 v60, v60, v84
    v_sub_f32 v61, v61, v84
    v_sub_f32 v62, v62, v84
    v_sub_f32 v63, v63, v84
    v_sub_f32 v64, v64, v84
    v_sub_f32 v65, v65, v84
    v_exp_f32 v56, v56
    v_exp_f32 v57, v57
    v_exp_f32 v58, v58
    v_exp_f32 v59, v59
    v_exp_f32 v60, v60
    v_exp_f32 v61, v61
    v_exp_f32 v62, v62
    v_exp_f32 v63, v63
    v_exp_f32 v64, v64
    v_exp_f32 v65, v65
    v_cvt_pk_bf16_f32 v68, v56, v57
    v_cvt_pk_bf16_f32 v69, v58, v59
    v_cvt_pk_bf16_f32 v70, v60, v61
    v_cvt_pk_bf16_f32 v71, v62, v63
    v_cvt_pk_bf16_f32 v52, v64, v65
    s_nop 0
    v_mfma_f32_16x16x32_bf16 v[72:75], v[88:91], v[68:71], 0
    v_mfma_f32_16x16x32_bf16 v[76:79], v[92:95], v[68:71], 0
    v_mfma_f32_16x16x32_bf16 v[80:83], v[48:51], v[68:71], 0
    v_mfma_f32_16x16x16_bf16 v[72:75], v[112:113], v[52:53], v[72:75]
    v_mfma_f32_16x16x16_bf16 v[76:79], v[114:115], v[52:53], v[76:79]
    v_mfma_f32_16x16x16_bf16 v[80:83], v[48:49], v[52:53], v[80:83]
    ds_read_b128 v[32:35], v124 offset:6144
    ds_read_b128 v[36:39], v124 offset:7168
    ds_read_b128 v[40:43], v124 offset:34816
    ds_read_b128 v[44:47], v124 offset:35840
    ds_read_b128 v[56:59], v124 offset:36864
    ds_read_b128 v[64:67], v124 offset:38912
    ds_read_b128 v[68:71], v124 offset:39936
    s_waitcnt lgkmcnt(0)
    s_branch L_norm_24
L_kvw_26:
    s_add_u32 s47, s47, 1
    s_add_u32 s49, s49, 1
    s_cmp_ge_u32 s49, 0x10000
    s_cbranch_scc1 L_kvb_27
    s_sleep 4
    buffer_load_dword v125, v119, s[8:11], s28 offen sc1
    s_waitcnt vmcnt(0)
    v_cmp_eq_u32 vcc, 0, v125
    s_nop 0
    s_and_b64 vcc, vcc, s[58:59]
    s_cbranch_scc1 L_kvw_26
    s_branch L_kvb_27
L_mret_29:
    s_mov_b32 s43, m0
    s_mov_b32 m0, 6144
    buffer_load_dwordx4 v[4:7], v117, s[8:11], s48 offen sc1
    buffer_load_dwordx4 v117, s[8:11], s48 offen sc1 lds
    s_mov_b32 m0, 12288
    s_mov_b32 m0, s43
    s_waitcnt vmcnt(0)
    v_max3_u32 v15, v4, v5, v6
    v_max_u32 v15, v15, v7
    v_cmp_lt_u32 vcc, s56, v15
    s_add_u32 s47, s47, 1
    s_add_u32 s49, s49, 1
    s_cmp_ge_u32 s49, 0x10000
    s_cbranch_scc1 L_mgo_30
    s_cbranch_vccnz L_mret_29
    s_branch L_mgo_30
L_smax_32:
    s_add_u32 s47, s47, 1
    s_mov_b32 s35, 0x7f800000
    s_waitcnt lgkmcnt(0)
    s_sub_u32 s43, s30, 0x41000
    s_add_u32 s40, s43, 4096
    s_nop 7
    buffer_load_dwordx4 v[56:59], v117, s[8:11], s43 offen
    buffer_load_dwordx4 v[60:63], v117, s[8:11], s43 offen offset:1024
    buffer_load_dwordx4 v[64:67], v117, s[8:11], s43 offen offset:2048
    buffer_load_dwordx4 v[68:71], v117, s[8:11], s43 offen offset:3072
    buffer_load_dwordx4 v[72:75], v117, s[8:11], s40 offen
    buffer_load_dwordx4 v[76:79], v117, s[8:11], s40 offen offset:1024
    buffer_load_dwordx4 v[80:83], v117, s[8:11], s40 offen offset:2048
    buffer_load_dwordx4 v[84:87], v117, s[8:11], s40 offen offset:3072
    ds_read_b128 v[32:35], v121 offset:16384
    ds_read_b128 v[36:39], v121 offset:17408
    ds_read_b128 v[40:43], v121 offset:18432
    ds_read_b128 v[44:47], v121 offset:19456
    v_mov_b32 v96, 0
    v_mov_b32 v97, 0
    v_mov_b32 v98, 0
    v_mov_b32 v99, 0
    v_mov_b32 v100, 0
    v_mov_b32 v101, 0
    v_mov_b32 v102, 0
    v_mov_b32 v103, 0
    v_mov_b32 v104, 0
    v_mov_b32 v105, 0
    v_mov_b32 v106, 0
    v_mov_b32 v107, 0
    v_mov_b32 v108, 0
    v_mov_b32 v109, 0
    v_mov_b32 v110, 0
    v_mov_b32 v111, 0
    s_waitcnt vmcnt(0) lgkmcnt(0)
    v_mfma_f32_16x16x32_bf16 v[56:59], v[56:59], v[32:35], 0
    v_mfma_f32_16x16x32_bf16 v[56:59], v[60:63], v[36:39], v[56:59]
    v_mfma_f32_16x16x32_bf16 v[56:59], v[64:67], v[40:43], v[56:59]
    v_mfma_f32_16x16x32_bf16 v[56:59], v[68:71], v[44:47], v[56:59]
    v_mfma_f32_16x16x32_bf16 v[60:63], v[72:75], v[32:35], 0
    v_mfma_f32_16x16x32_bf16 v[60:63], v[76:79], v[36:39], v[60:63]
    v_mfma_f32_16x16x32_bf16 v[60:63], v[80:83], v[40:43], v[60:63]
    v_mfma_f32_16x16x32_bf16 v[60:63], v[84:87], v[44:47], v[60:63]
    v_mfma_f32_16x16x32_bf16 v[64:67], v[32:35], v[32:35], 0
    v_mfma_f32_16x16x32_bf16 v[64:67], v[36:39], v[36:39], v[64:67]
    v_mfma_f32_16x16x32_bf16 v[64:67], v[40:43], v[40:43], v[64:67]
    v_mfma_f32_16x16x32_bf16 v[64:67], v[44:47], v[44:47], v[64:67]
    v_max3_f32 v84, v56, v57, v58
    v_max3_f32 v84, v84, v59, v60
    v_max3_f32 v84, v84, v61, v62
    s_nop 4
    v_max3_f32 v84, v84, v63, v64
    v_max_f32 v84, v84, v65
    v_mov_b32 v85, v84
    s_nop 1
    v_permlane32_swap_b32 v85, v84
    v_max_f32 v84, v85, v84
    v_mov_b32 v85, v84
    s_nop 1
    v_permlane16_swap_b32 v85, v84
    v_max_f32 v84, v85, v84
    v_sub_f32 v56, v56, v84
    v_sub_f32 v57, v57, v84
    v_sub_f32 v58, v58, v84
    v_sub_f32 v59, v59, v84
    v_sub_f32 v60, v60, v84
    v_sub_f32 v61, v61, v84
    v_sub_f32 v62, v62, v84
    v_sub_f32 v63, v63, v84
    v_sub_f32 v64, v64, v84
    v_sub_f32 v65, v65, v84
    v_exp_f32 v56, v56
    v_exp_f32 v57, v57
    v_exp_f32 v58, v58
    v_exp_f32 v59, v59
    v_exp_f32 v60, v60
    v_exp_f32 v61, v61
    v_exp_f32 v62, v62
    v_exp_f32 v63, v63
    v_exp_f32 v64, v64
    v_exp_f32 v65, v65
    v_cvt_pk_bf16_f32 v68, v56, v57
    v_cvt_pk_bf16_f32 v69, v58, v59
    v_cvt_pk_bf16_f32 v70, v60, v61
    v_cvt_pk_bf16_f32 v71, v62, v63
    v_cvt_pk_bf16_f32 v52, v64, v65
    s_nop 0
    v_mfma_f32_16x16x32_bf16 v[72:75], v[88:91], v[68:71], 0
    v_mfma_f32_16x16x32_bf16 v[76:79], v[92:95], v[68:71], 0
    v_mfma_f32_16x16x32_bf16 v[80:83], v[48:51], v[68:71], 0
    v_mfma_f32_16x16x16_bf16 v[72:75], v[112:113], v[52:53], v[72:75]
    v_mfma_f32_16x16x16_bf16 v[76:79], v[114:115], v[52:53], v[76:79]
    v_mfma_f32_16x16x16_bf16 v[80:83], v[48:49], v[52:53], v[80:83]
    ds_read_b128 v[32:35], v124 offset:6144
    ds_read_b128 v[36:39], v124 offset:7168
    ds_read_b128 v[40:43], v124 offset:34816
    ds_read_b128 v[44:47], v124 offset:35840
    ds_read_b128 v[56:59], v124 offset:36864
    ds_read_b128 v[64:67], v124 offset:38912
    ds_read_b128 v[68:71], v124 offset:39936
    s_waitcnt lgkmcnt(0)
    s_branch L_norm_31
L_rslow_34:
    buffer_load_dwordx4 v[4:7], v117, s[8:11], s29 offen sc1
    buffer_load_dwordx4 v[8:11], v117, s[8:11], s53 offen sc1
    buffer_load_dwordx4 v[16:19], v117, s[8:11], s29 offen offset:2048 sc1
    buffer_load_dwordx4 v[20:23], v117, s[8:11], s53 offen offset:2048 sc1
    s_add_u32 s46, s46, 1
    s_add_u32 s49, s49, 1
    s_cmp_ge_u32 s49, 0x10000
    s_cbranch_scc1 L_rgo_35
    s_waitcnt vmcnt(0)
    s_branch L_rl_33
L_mret_37:
    s_mov_b32 s43, m0
    s_mov_b32 m0, 7168
    buffer_load_dwordx4 v[4:7], v117, s[8:11], s48 offen sc1
    buffer_load_dwordx4 v117, s[8:11], s48 offen sc1 lds
    s_mov_b32 m0, 14336
    s_mov_b32 m0, s43
    s_waitcnt vmcnt(0)
    v_max3_u32 v15, v4, v5, v6
    v_max_u32 v15, v15, v7
    v_cmp_lt_u32 vcc, s56, v15
    s_add_u32 s47, s47, 1
    s_add_u32 s49, s49, 1
    s_cmp_ge_u32 s49, 0x10000
    s_cbranch_scc1 L_mgo_38
    s_cbranch_vccnz L_mret_37
    s_branch L_mgo_38
L_smax_40:
    s_add_u32 s47, s47, 1
    s_mov_b32 s35, 0x7f800000
    s_waitcnt lgkmcnt(0)
    s_sub_u32 s43, s30, 0x41800
    s_add_u32 s40, s43, 4096
    s_nop 7
    buffer_load_dwordx4 v[56:59], v117, s[8:11], s43 offen
    buffer_load_dwordx4 v[60:63], v117, s[8:11], s43 offen offset:1024
    buffer_load_dwordx4 v[64:67], v117, s[8:11], s43 offen offset:2048
    buffer_load_dwordx4 v[68:71], v117, s[8:11], s43 offen offset:3072
    buffer_load_dwordx4 v[72:75], v117, s[8:11], s40 offen
    buffer_load_dwordx4 v[76:79], v117, s[8:11], s40 offen offset:1024
    buffer_load_dwordx4 v[80:83], v117, s[8:11], s40 offen offset:2048
    buffer_load_dwordx4 v[84:87], v117, s[8:11], s40 offen offset:3072
    ds_read_b128 v[32:35], v121 offset:16384
    ds_read_b128 v[36:39], v121 offset:17408
    ds_read_b128 v[40:43], v121 offset:18432
    ds_read_b128 v[44:47], v121 offset:19456
    v_mov_b32 v96, 0
    v_mov_b32 v97, 0
    v_mov_b32 v98, 0
    v_mov_b32 v99, 0
    v_mov_b32 v100, 0
    v_mov_b32 v101, 0
    v_mov_b32 v102, 0
    v_mov_b32 v103, 0
    v_mov_b32 v104, 0
    v_mov_b32 v105, 0
    v_mov_b32 v106, 0
    v_mov_b32 v107, 0
    v_mov_b32 v108, 0
    v_mov_b32 v109, 0
    v_mov_b32 v110, 0
    v_mov_b32 v111, 0
    s_waitcnt vmcnt(0) lgkmcnt(0)
    v_mfma_f32_16x16x32_bf16 v[56:59], v[56:59], v[32:35], 0
    v_mfma_f32_16x16x32_bf16 v[56:59], v[60:63], v[36:39], v[56:59]
    v_mfma_f32_16x16x32_bf16 v[56:59], v[64:67], v[40:43], v[56:59]
    v_mfma_f32_16x16x32_bf16 v[56:59], v[68:71], v[44:47], v[56:59]
    v_mfma_f32_16x16x32_bf16 v[60:63], v[72:75], v[32:35], 0
    v_mfma_f32_16x16x32_bf16 v[60:63], v[76:79], v[36:39], v[60:63]
    v_mfma_f32_16x16x32_bf16 v[60:63], v[80:83], v[40:43], v[60:63]
    v_mfma_f32_16x16x32_bf16 v[60:63], v[84:87], v[44:47], v[60:63]
    v_mfma_f32_16x16x32_bf16 v[64:67], v[32:35], v[32:35], 0
    v_mfma_f32_16x16x32_bf16 v[64:67], v[36:39], v[36:39], v[64:67]
    v_mfma_f32_16x16x32_bf16 v[64:67], v[40:43], v[40:43], v[64:67]
    v_mfma_f32_16x16x32_bf16 v[64:67], v[44:47], v[44:47], v[64:67]
    v_max3_f32 v84, v56, v57, v58
    v_max3_f32 v84, v84, v59, v60
    v_max3_f32 v84, v84, v61, v62
    s_nop 4
    v_max3_f32 v84, v84, v63, v64
    v_max_f32 v84, v84, v65
    v_mov_b32 v85, v84
    s_nop 1
    v_permlane32_swap_b32 v85, v84
    v_max_f32 v84, v85, v84
    v_mov_b32 v85, v84
    s_nop 1
    v_permlane16_swap_b32 v85, v84
    v_max_f32 v84, v85, v84
    v_sub_f32 v56, v56, v84
    v_sub_f32 v57, v57, v84
    v_sub_f32 v58, v58, v84
    v_sub_f32 v59, v59, v84
    v_sub_f32 v60, v60, v84
    v_sub_f32 v61, v61, v84
    v_sub_f32 v62, v62, v84
    v_sub_f32 v63, v63, v84
    v_sub_f32 v64, v64, v84
    v_sub_f32 v65, v65, v84
    v_exp_f32 v56, v56
    v_exp_f32 v57, v57
    v_exp_f32 v58, v58
    v_exp_f32 v59, v59
    v_exp_f32 v60, v60
    v_exp_f32 v61, v61
    v_exp_f32 v62, v62
    v_exp_f32 v63, v63
    v_exp_f32 v64, v64
    v_exp_f32 v65, v65
    v_cvt_pk_bf16_f32 v68, v56, v57
    v_cvt_pk_bf16_f32 v69, v58, v59
    v_cvt_pk_bf16_f32 v70, v60, v61
    v_cvt_pk_bf16_f32 v71, v62, v63
    v_cvt_pk_bf16_f32 v52, v64, v65
    s_nop 0
    v_mfma_f32_16x16x32_bf16 v[72:75], v[88:91], v[68:71], 0
    v_mfma_f32_16x16x32_bf16 v[76:79], v[92:95], v[68:71], 0
    v_mfma_f32_16x16x32_bf16 v[80:83], v[48:51], v[68:71], 0
    v_mfma_f32_16x16x16_bf16 v[72:75], v[112:113], v[52:53], v[72:75]
    v_mfma_f32_16x16x16_bf16 v[76:79], v[114:115], v[52:53], v[76:79]
    v_mfma_f32_16x16x16_bf16 v[80:83], v[48:49], v[52:53], v[80:83]
    ds_read_b128 v[32:35], v124 offset:6144
    ds_read_b128 v[36:39], v124 offset:7168
    ds_read_b128 v[40:43], v124 offset:34816
    ds_read_b128 v[44:47], v124 offset:35840
    ds_read_b128 v[56:59], v124 offset:36864
    ds_read_b128 v[64:67], v124 offset:38912
    ds_read_b128 v[68:71], v124 offset:39936
    s_waitcnt lgkmcnt(0)
    s_branch L_norm_39
L_rslow_42:
    buffer_load_dwordx4 v[4:7], v117, s[8:11], s29 offen sc1
    buffer_load_dwordx4 v[8:11], v117, s[8:11], s53 offen sc1
    buffer_load_dwordx4 v[16:19], v117, s[8:11], s29 offen offset:2048 sc1
    buffer_load_dwordx4 v[20:23], v117, s[8:11], s53 offen offset:2048 sc1
    s_add_u32 s46, s46, 1
    s_add_u32 s49, s49, 1
    s_cmp_ge_u32 s49, 0x10000
    s_cbranch_scc1 L_rgo_43
    s_waitcnt vmcnt(0)
    s_branch L_rl_41
L_other:
    s_sub_u32 s101, s84, 1
    s_lshl_b32 s101, s101, 5
    s_add_u32 s101, s101, s85
    s_branch L_bulk
L_odd:
    s_mov_b32 s96, 0
L_mode_44:
    buffer_load_dwordx2 v[2:3], off, s[92:95], 0 offset:36 sc1
    s_waitcnt vmcnt(0)
    v_readfirstlane_b32 s87, v2
    v_readfirstlane_b32 s97, v3
    s_nop 0
    s_min_u32 s97, s97, s87
    s_cmp_lg_u32 s97, 0
    s_cbranch_scc1 L_moded_45
    s_sleep 4
    s_add_u32 s96, s96, 1
    s_cmp_lg_u32 s96, 0x100
    s_cbranch_scc1 L_modef_46
    v_mov_b32 v2, 2
    v_mov_b32 v3, 0
    s_mov_b64 exec, 1
    buffer_atomic_cmpswap v[2:3], off, s[92:95], 0 offset:36
    s_mov_b64 exec, -1
L_modef_46:
    s_cmp_lt_u32 s96, 0x10000
    s_cbranch_scc1 L_mode_44
L_moded_45:
    s_cmp_eq_u32 s87, 1
    s_cbranch_scc1 L_exit
L_fallback:
    s_waitcnt vmcnt(0) lgkmcnt(0)
    s_barrier
    v_mbcnt_lo_u32_b32 v0, -1, 0
    v_mbcnt_hi_u32_b32 v0, -1, v0
    s_lshl_b32 s96, s100, 6
    v_add_u32 v0, s96, v0
    s_mov_b32 s97, 44
    s_cmp_lg_u32 s100, 0
    s_cbranch_scc1 L_at_47
    s_mov_b64 exec, 1
    v_mov_b32 v2, 1
    buffer_atomic_add v2, off, s[92:95], s97 sc0
    s_mov_b64 exec, -1
L_at_47:
    s_cmp_lg_u32 s100, 0
    s_cbranch_scc1 L_at2_48
    s_mov_b64 exec, 1
    v_mov_b32 v1, 8
    s_waitcnt vmcnt(0)
    ds_write_b32 v1, v2
    s_waitcnt lgkmcnt(0)
    s_mov_b64 exec, -1
L_at2_48:
    s_barrier
    v_mov_b32 v1, 8
    ds_read_b32 v2, v1
    s_waitcnt lgkmcnt(0)
    v_readfirstlane_b32 s85, v2
    s_barrier
    s_sub_u32 s101, s85, 32
    s_cmp_ge_u32 s85, 32
    s_cbranch_scc1 L_bulk
    s_mov_b32 s20, s85
    s_mov_b32 s16, s92
    s_mov_b32 s17, s93
    s_mov_b32 s18, s94
    s_mov_b32 s19, s95
    s_mov_b32 s88, s20
    v_lshrrev_b32 v4, 6, v0
    s_nop 0
    v_readfirstlane_b32 s21, v4
    v_and_b32 v1, 63, v0
    v_lshrrev_b32 v2, 4, v1
    v_and_b32 v3, 15, v1
    v_lshrrev_b32 v6, 2, v3
    v_lshlrev_b32 v117, 4, v1
    s_lshl_b32 s51, s21, 10
    s_lshl_b32 s52, s21, 11
    s_load_dwordx8 s[60:67], s[0:1], 16
    s_mov_b32 s14, 0x400000
    s_mov_b32 s15, 0x20000
    s_lshl_b32 s41, s20, 8
    s_lshl_b32 s42, s20, 17
    s_lshr_b32 s43, s21, 1
    s_lshl_b32 s43, s43, 2
    v_or_b32 v5, s43, v2
    v_lshlrev_b32 v5, 1, v5
    v_xor_b32 v5, v5, v3
    v_lshrrev_b32 v14, 2, v5
    v_lshlrev_b32 v5, 4, v5
    s_lshl_b32 s43, s21, 4
    v_add_u32 v4, s43, v2
    v_lshl_add_u32 v8, v4, 13, v5
    s_waitcnt lgkmcnt(0)
    s_mov_b32 s12, s60
    s_and_b32 s13, s61, 0xffff
    v_xor_b32 v15, 1, v14
    v_lshl_add_u32 v15, v15, 15, v8
    s_add_u32 s43, s41, 0x0
    s_add_u32 m0, s51, 0x8000
    s_nop 0
    buffer_load_dwordx4 v15, s[12:15], s43 offen lds
    s_add_u32 s43, s41, 0x80000
    s_add_u32 m0, s51, 0x9000
    s_nop 0
    buffer_load_dwordx4 v15, s[12:15], s43 offen lds
    s_add_u32 s43, s41, 0x100000
    s_add_u32 m0, s51, 0xa000
    s_nop 0
    buffer_load_dwordx4 v15, s[12:15], s43 offen lds
    s_add_u32 s43, s41, 0x180000
    s_add_u32 m0, s51, 0xb000
    s_nop 0
    buffer_load_dwordx4 v15, s[12:15], s43 offen lds
    s_add_u32 s43, s41, 0x200000
    s_add_u32 m0, s51, 0xc000
    s_nop 0
    buffer_load_dwordx4 v15, s[12:15], s43 offen lds
    s_add_u32 s43, s41, 0x280000
    s_add_u32 m0, s51, 0xd000
    s_nop 0
    buffer_load_dwordx4 v15, s[12:15], s43 offen lds
    s_add_u32 s43, s41, 0x300000
    s_add_u32 m0, s51, 0xe000
    s_nop 0
    buffer_load_dwordx4 v15, s[12:15], s43 offen lds
    s_add_u32 s43, s41, 0x380000
    s_add_u32 m0, s51, 0xf000
    s_nop 0
    buffer_load_dwordx4 v15, s[12:15], s43 offen lds
    v_xor_b32 v15, 2, v14
    v_lshl_add_u32 v15, v15, 15, v8
    s_add_u32 s43, s41, 0x0
    s_add_u32 m0, s51, 0x10000
    s_nop 0
    buffer_load_dwordx4 v15, s[12:15], s43 offen lds
    s_add_u32 s43, s41, 0x80000
    s_add_u32 m0, s51, 0x11000
    s_nop 0
    buffer_load_dwordx4 v15, s[12:15], s43 offen lds
    s_add_u32 s43, s41, 0x100000
    s_add_u32 m0, s51, 0x12000
    s_nop 0
    buffer_load_dwordx4 v15, s[12:15], s43 offen lds
    s_add_u32 s43, s41, 0x180000
    s_add_u32 m0, s51, 0x13000
    s_nop 0
    buffer_load_dwordx4 v15, s[12:15], s43 offen lds
    s_add_u32 s43, s41, 0x200000
    s_add_u32 m0, s51, 0x14000
    s_nop 0
    buffer_load_dwordx4 v15, s[12:15], s43 offen lds
    s_add_u32 s43, s41, 0x280000
    s_add_u32 m0, s51, 0x15000
    s_nop 0
    buffer_load_dwordx4 v15, s[12:15], s43 offen lds
    s_add_u32 s43, s41, 0x300000
    s_add_u32 m0, s51, 0x16000
    s_nop 0
    buffer_load_dwordx4 v15, s[12:15], s43 offen lds
    s_add_u32 s43, s41, 0x380000
    s_add_u32 m0, s51, 0x17000
    s_nop 0
    buffer_load_dwordx4 v15, s[12:15], s43 offen lds
    v_xor_b32 v15, 3, v14
    v_lshl_add_u32 v15, v15, 15, v8
    s_add_u32 s43, s41, 0x0
    s_add_u32 m0, s51, 0x18000
    s_nop 0
    buffer_load_dwordx4 v15, s[12:15], s43 offen lds
    s_add_u32 s43, s41, 0x80000
    s_add_u32 m0, s51, 0x19000
    s_nop 0
    buffer_load_dwordx4 v15, s[12:15], s43 offen lds
    s_add_u32 s43, s41, 0x100000
    s_add_u32 m0, s51, 0x1a000
    s_nop 0
    buffer_load_dwordx4 v15, s[12:15], s43 offen lds
    s_add_u32 s43, s41, 0x180000
    s_add_u32 m0, s51, 0x1b000
    s_nop 0
    buffer_load_dwordx4 v15, s[12:15], s43 offen lds
    s_add_u32 s43, s41, 0x200000
    s_add_u32 m0, s51, 0x1c000
    s_nop 0
    buffer_load_dwordx4 v15, s[12:15], s43 offen lds
    s_add_u32 s43, s41, 0x280000
    s_add_u32 m0, s51, 0x1d000
    s_nop 0
    buffer_load_dwordx4 v15, s[12:15], s43 offen lds
    s_add_u32 s43, s41, 0x300000
    s_add_u32 m0, s51, 0x1e000
    s_nop 0
    buffer_load_dwordx4 v15, s[12:15], s43 offen lds
    s_add_u32 s43, s41, 0x380000
    s_add_u32 m0, s51, 0x1f000
    s_nop 0
    buffer_load_dwordx4 v15, s[12:15], s43 offen lds
    s_mov_b32 s12, s62
    s_and_b32 s13, s63, 0xffff
    v_xor_b32 v15, 1, v14
    v_lshl_add_u32 v15, v15, 15, v8
    s_add_u32 s43, s41, 0x0
    s_add_u32 m0, s51, 0x20000
    s_nop 0
    buffer_load_dwordx4 v15, s[12:15], s43 offen lds
    s_add_u32 s43, s41, 0x80000
    s_add_u32 m0, s51, 0x21000
    s_nop 0
    buffer_load_dwordx4 v15, s[12:15], s43 offen lds
    s_add_u32 s43, s41, 0x100000
    s_add_u32 m0, s51, 0x22000
    s_nop 0
    buffer_load_dwordx4 v15, s[12:15], s43 offen lds
    s_add_u32 s43, s41, 0x180000
    s_add_u32 m0, s51, 0x23000
    s_nop 0
    buffer_load_dwordx4 v15, s[12:15], s43 offen lds
    s_add_u32 s43, s41, 0x200000
    s_add_u32 m0, s51, 0x24000
    s_nop 0
    buffer_load_dwordx4 v15, s[12:15], s43 offen lds
    s_add_u32 s43, s41, 0x280000
    s_add_u32 m0, s51, 0x25000
    s_nop 0
    buffer_load_dwordx4 v15, s[12:15], s43 offen lds
    s_add_u32 s43, s41, 0x300000
    s_add_u32 m0, s51, 0x26000
    s_nop 0
    buffer_load_dwordx4 v15, s[12:15], s43 offen lds
    s_add_u32 s43, s41, 0x380000
    s_add_u32 m0, s51, 0x27000
    s_nop 0
    buffer_load_dwordx4 v15, s[12:15], s43 offen lds
    v_and_b32 v4, 2, v3
    v_cmp_ne_u32 vcc, 0, v4
    v_mov_b32 v4, 0x4444
    v_mov_b32 v5, 0xeeee
    v_cndmask_b32 v116, v4, v5, vcc
    v_lshrrev_b32 v5, 1, v2
    v_lshl_add_u32 v4, v6, 3, v5
    s_lshl_b32 s43, s21, 1
    v_add_u32 v4, s43, v4
    v_add_u32 v5, s20, v4
    v_and_b32 v5, 31, v5
    v_lshl_add_u32 v4, v4, 6, v5
    v_and_b32 v5, 1, v2
    v_lshl_add_u32 v4, v4, 1, v5
    v_and_b32 v5, 3, v3
    v_lshl_add_u32 v4, v4, 2, v5
    v_lshlrev_b32 v118, 4, v4
    v_and_b32 v4, 1, v2
    v_lshlrev_b32 v4, 2, v4
    v_and_b32 v7, 2, v2
    v_add_u32 v4, v4, v7
    v_and_b32 v7, 1, v6
    v_add_u32 v4, v4, v7
    v_lshl_add_u32 v4, v4, 2, v5
    v_lshlrev_b32 v4, 2, v4
    s_and_b32 s43, s21, 1
    s_lshl_b32 s43, s43, 12
    s_lshl_b32 s40, s20, 7
    s_add_u32 s43, s43, s40
    v_add_u32 v119, s43, v4
    v_sub_u32 v7, 0, v2
    v_and_b32 v7, 3, v7
    v_xor_b32 v7, v7, v6
    v_lshl_add_u32 v4, v2, 4, v7
    v_and_b32 v5, 3, v3
    v_lshl_add_u32 v4, v4, 2, v5
    s_add_u32 s43, s51, 16384
    v_lshl_add_u32 v120, v4, 2, s43
    v_sub_u32 v7, 0, v6
    v_and_b32 v7, 3, v7
    v_xor_b32 v7, v7, v2
    v_lshl_add_u32 v4, v3, 2, v7
    v_lshlrev_b32 v121, 4, v4
    v_and_b32 v5, 1, v3
    v_lshl_add_u32 v4, v6, 1, v5
    v_lshl_add_u32 v4, v2, 3, v4
    v_lshlrev_b32 v127, 4, v4
    v_and_or_b32 v122, v116, 8, v127
    s_lshl_b32 s43, s21, 13
    s_add_u32 s43, s43, 32768
    v_add_u32 v123, s43, v117
    v_add_u32 v124, 0x10000, v123
    s_mov_b32 s36, 0xcccccccc
    s_mov_b32 s37, 0xcccccccc
    s_mov_b32 s38, 0x00ff00ff
    s_mov_b32 s39, 0x00ff00ff
    s_mov_b32 s34, 0x3e0293ee
    s_mov_b32 s35, 0x49800000
    s_mov_b32 s50, 0x3f803f80
    v_and_b32 v5, 1, v2
    v_or_b32 v5, 0, v5
    v_xor_b32 v5, v5, v6
    v_lshlrev_b32 v5, 8, v5
    v_and_b32 v7, 3, v3
    v_lshl_add_u32 v7, v7, 4, v5
    s_lshl_b32 s43, s21, 2
    v_add_u32 v4, s43, v2
    v_lshl_add_u32 v10, v4, 10, v7
    v_and_b32 v5, 1, v2
    v_or_b32 v5, 2, v5
    v_xor_b32 v5, v5, v6
    v_lshlrev_b32 v5, 8, v5
    v_and_b32 v7, 3, v3
    v_lshl_add_u32 v7, v7, 4, v5
    s_lshl_b32 s43, s21, 2
    v_add_u32 v4, s43, v2
    v_lshl_add_u32 v9, v4, 10, v7
    v_and_b32 v5, 1, v2
    v_lshl_add_u32 v4, v5, 3, v6
    v_lshrrev_b32 v7, 1, v2
    v_lshl_add_u32 v4, v7, 5, v4
    v_lshlrev_b32 v4, 8, v4
    v_lshl_or_b32 v5, v5, 2, v6
    v_lshlrev_b32 v5, 5, v5
    s_lshl_b32 s43, s21, 6
    v_xor_b32 v5, s43, v5
    v_add_u32 v4, v4, v5
    v_and_b32 v5, 3, v3
    v_lshl_add_u32 v4, v5, 3, v4
    v_add_u32 v11, 32768, v4
    v_and_b32 v5, 1, v2
    v_lshlrev_b32 v4, 4, v5
    v_lshl_add_u32 v4, v7, 2, v4
    v_and_b32 v7, 1, v6
    v_add_u32 v4, v4, v7
    s_lshl_b32 s43, s21, 5
    v_add_u32 v4, s43, v4
    v_lshlrev_b32 v4, 8, v4
    v_lshl_or_b32 v5, v5, 1, v7
    v_xor_b32 v5, s21, v5
    v_lshl_add_u32 v4, v5, 6, v4
    v_lshrrev_b32 v5, 1, v6
    v_lshl_add_u32 v4, v5, 5, v4
    v_and_b32 v5, 3, v3
    v_lshl_add_u32 v4, v5, 3, v4
    v_add_u32 v12, 32768, v4
    v_mov_b32 v16, -1
    v_mov_b32 v17, -1
    v_mov_b32 v18, -1
    v_mov_b32 v19, -1
    s_lshl_b32 s43, s20, 13
    s_add_u32 s43, s43, 0x7100000
    s_and_b32 s40, s21, 1
    s_lshl_b32 s40, s40, 12
    s_add_u32 s29, s43, s40
    s_add_u32 s43, s43, s52
    s_xor_b32 s40, s43, 0x40000
    buffer_store_dwordx4 v[16:19], v117, s[8:11], s43 offen sc1
    buffer_store_dwordx4 v[16:19], v117, s[8:11], s43 offen offset:1024 sc1
    buffer_store_dwordx4 v[16:19], v117, s[8:11], s40 offen sc1
    buffer_store_dwordx4 v[16:19], v117, s[8:11], s40 offen offset:1024 sc1
    s_mov_b32 s43, 0x7012000
    buffer_store_dword v16, v119, s[8:11], s43 offen sc1
    s_mov_b32 s43, 0x7014000
    buffer_store_dword v16, v119, s[8:11], s43 offen sc1
    s_mov_b32 s43, 0x7016000
    buffer_store_dword v16, v119, s[8:11], s43 offen sc1
    s_load_dwordx2 s[4:5], s[0:1], 8
    s_waitcnt lgkmcnt(0)
    s_and_b32 s5, s5, 0xffff
    s_mov_b32 s6, 8192
    s_mov_b32 s7, 0x20000
    v_and_b32 v20, 1, v2
    v_and_b32 v21, 1, v6
    v_lshl_add_u32 v20, v20, 1, v21
    v_lshlrev_b32 v20, 9, v20
    v_and_b32 v21, 3, v3
    v_lshl_add_u32 v20, v21, 4, v20
    v_and_b32 v21, 2, v2
    v_add_u32 v20, v20, v21
    s_and_b32 s43, s20, 1
    s_lshl_b32 s43, s43, 11
    s_bfe_u32 s40, s20, 0x20001
    s_lshl_b32 s40, s40, 7
    s_add_u32 s43, s43, s40
    s_and_b32 s40, s21, 1
    s_lshl_b32 s40, s40, 6
    s_add_u32 s43, s43, s40
    s_lshr_b32 s40, s20, 3
    s_lshl_b32 s40, s40, 2
    s_add_u32 s43, s43, s40
    v_add_u32 v20, s43, v20
    v_lshlrev_b32 v20, 1, v20
    buffer_load_dword v21, v20, s[4:7], 0 offen
    s_waitcnt vmcnt(32)
    s_barrier
    v_xor_b32 v13, 0, v11
    v_add_u32 v13, 0x0, v13
    ds_read_b64_tr_b16 a[0:1], v13
    ds_read_b64_tr_b16 a[2:3], v13 offset:1024
    ds_read_b64_tr_b16 a[4:5], v13 offset:16384
    ds_read_b64_tr_b16 a[6:7], v13 offset:17408
    ds_read_b64_tr_b16 a[16:17], v13 offset:4096
    ds_read_b64_tr_b16 a[18:19], v13 offset:5120
    ds_read_b64_tr_b16 a[20:21], v13 offset:20480
    ds_read_b64_tr_b16 a[22:23], v13 offset:21504
    s_waitcnt lgkmcnt(0)
    v_xor_b32 v13, 32, v11
    v_add_u32 v13, 0x0, v13
    ds_read_b64_tr_b16 a[8:9], v13
    ds_read_b64_tr_b16 a[10:11], v13 offset:1024
    ds_read_b64_tr_b16 a[12:13], v13 offset:16384
    ds_read_b64_tr_b16 a[14:15], v13 offset:17408
    ds_read_b64_tr_b16 a[24:25], v13 offset:4096
    ds_read_b64_tr_b16 a[26:27], v13 offset:5120
    ds_read_b64_tr_b16 a[28:29], v13 offset:20480
    ds_read_b64_tr_b16 a[30:31], v13 offset:21504
    s_waitcnt lgkmcnt(0)
    s_barrier
    v_xor_b32 v15, 2, v14
    v_lshl_add_u32 v15, v15, 15, v8
    s_add_u32 s43, s41, 0x0
    s_add_u32 m0, s51, 0x8000
    s_nop 0
    buffer_load_dwordx4 v15, s[12:15], s43 offen lds
    s_add_u32 s43, s41, 0x80000
    s_add_u32 m0, s51, 0x9000
    s_nop 0
    buffer_load_dwordx4 v15, s[12:15], s43 offen lds
    s_add_u32 s43, s41, 0x100000
    s_add_u32 m0, s51, 0xa000
    s_nop 0
    buffer_load_dwordx4 v15, s[12:15], s43 offen lds
    s_add_u32 s43, s41, 0x180000
    s_add_u32 m0, s51, 0xb000
    s_nop 0
    buffer_load_dwordx4 v15, s[12:15], s43 offen lds
    s_add_u32 s43, s41, 0x200000
    s_add_u32 m0, s51, 0xc000
    s_nop 0
    buffer_load_dwordx4 v15, s[12:15], s43 offen lds
    s_add_u32 s43, s41, 0x280000
    s_add_u32 m0, s51, 0xd000
    s_nop 0
    buffer_load_dwordx4 v15, s[12:15], s43 offen lds
    s_add_u32 s43, s41, 0x300000
    s_add_u32 m0, s51, 0xe000
    s_nop 0
    buffer_load_dwordx4 v15, s[12:15], s43 offen lds
    s_add_u32 s43, s41, 0x380000
    s_add_u32 m0, s51, 0xf000
    s_nop 0
    buffer_load_dwordx4 v15, s[12:15], s43 offen lds
    s_waitcnt vmcnt(32)
    s_barrier
    v_xor_b32 v13, 0, v11
    v_add_u32 v13, 0x8000, v13
    ds_read_b64_tr_b16 a[32:33], v13
    ds_read_b64_tr_b16 a[34:35], v13 offset:1024
    ds_read_b64_tr_b16 a[36:37], v13 offset:16384
    ds_read_b64_tr_b16 a[38:39], v13 offset:17408
    ds_read_b64_tr_b16 a[48:49], v13 offset:4096
    ds_read_b64_tr_b16 a[50:51], v13 offset:5120
    ds_read_b64_tr_b16 a[52:53], v13 offset:20480
    ds_read_b64_tr_b16 a[54:55], v13 offset:21504
    s_waitcnt lgkmcnt(0)
    v_xor_b32 v13, 32, v11
    v_add_u32 v13, 0x8000, v13
    ds_read_b64_tr_b16 a[40:41], v13
    ds_read_b64_tr_b16 a[42:43], v13 offset:1024
    ds_read_b64_tr_b16 a[44:45], v13 offset:16384
    ds_read_b64_tr_b16 a[46:47], v13 offset:17408
    ds_read_b64_tr_b16 a[56:57], v13 offset:4096
    ds_read_b64_tr_b16 a[58:59], v13 offset:5120
    ds_read_b64_tr_b16 a[60:61], v13 offset:20480
    ds_read_b64_tr_b16 a[62:63], v13 offset:21504
    s_waitcnt lgkmcnt(0)
    s_barrier
    v_xor_b32 v15, 3, v14
    v_lshl_add_u32 v15, v15, 15, v8
    s_add_u32 s43, s41, 0x0
    s_add_u32 m0, s51, 0x10000
    s_nop 0
    buffer_load_dwordx4 v15, s[12:15], s43 offen lds
    s_add_u32 s43, s41, 0x80000
    s_add_u32 m0, s51, 0x11000
    s_nop 0
    buffer_load_dwordx4 v15, s[12:15], s43 offen lds
    s_add_u32 s43, s41, 0x100000
    s_add_u32 m0, s51, 0x12000
    s_nop 0
    buffer_load_dwordx4 v15, s[12:15], s43 offen lds
    s_add_u32 s43, s41, 0x180000
    s_add_u32 m0, s51, 0x13000
    s_nop 0
    buffer_load_dwordx4 v15, s[12:15], s43 offen lds
    s_add_u32 s43, s41, 0x200000
    s_add_u32 m0, s51, 0x14000
    s_nop 0
    buffer_load_dwordx4 v15, s[12:15], s43 offen lds
    s_add_u32 s43, s41, 0x280000
    s_add_u32 m0, s51, 0x15000
    s_nop 0
    buffer_load_dwordx4 v15, s[12:15], s43 offen lds
    s_add_u32 s43, s41, 0x300000
    s_add_u32 m0, s51, 0x16000
    s_nop 0
    buffer_load_dwordx4 v15, s[12:15], s43 offen lds
    s_add_u32 s43, s41, 0x380000
    s_add_u32 m0, s51, 0x17000
    s_nop 0
    buffer_load_dwordx4 v15, s[12:15], s43 offen lds
    s_waitcnt vmcnt(32)
    s_barrier
    v_xor_b32 v13, 0, v11
    v_add_u32 v13, 0x10000, v13
    ds_read_b64_tr_b16 a[64:65], v13
    ds_read_b64_tr_b16 a[66:67], v13 offset:1024
    ds_read_b64_tr_b16 a[68:69], v13 offset:16384
    ds_read_b64_tr_b16 a[70:71], v13 offset:17408
    ds_read_b64_tr_b16 a[80:81], v13 offset:4096
    ds_read_b64_tr_b16 a[82:83], v13 offset:5120
    ds_read_b64_tr_b16 a[84:85], v13 offset:20480
    ds_read_b64_tr_b16 a[86:87], v13 offset:21504
    s_waitcnt lgkmcnt(0)
    v_xor_b32 v13, 32, v11
    v_add_u32 v13, 0x10000, v13
    ds_read_b64_tr_b16 a[72:73], v13
    ds_read_b64_tr_b16 a[74:75], v13 offset:1024
    ds_read_b64_tr_b16 a[76:77], v13 offset:16384
    ds_read_b64_tr_b16 a[78:79], v13 offset:17408
    ds_read_b64_tr_b16 a[88:89], v13 offset:4096
    ds_read_b64_tr_b16 a[90:91], v13 offset:5120
    ds_read_b64_tr_b16 a[92:93], v13 offset:20480
    ds_read_b64_tr_b16 a[94:95], v13 offset:21504
    s_waitcnt lgkmcnt(0)
    s_barrier
    s_mov_b32 s12, s64
    s_and_b32 s13, s65, 0xffff
    v_xor_b32 v15, 0, v14
    v_lshl_add_u32 v15, v15, 15, v8
    s_add_u32 s43, s41, 0x0
    s_add_u32 m0, s51, 0x18000
    s_nop 0
    buffer_load_dwordx4 v15, s[12:15], s43 offen lds
    s_add_u32 s43, s41, 0x80000
    s_add_u32 m0, s51, 0x19000
    s_nop 0
    buffer_load_dwordx4 v15, s[12:15], s43 offen lds
    s_add_u32 s43, s41, 0x100000
    s_add_u32 m0, s51, 0x1a000
    s_nop 0
    buffer_load_dwordx4 v15, s[12:15], s43 offen lds
    s_add_u32 s43, s41, 0x180000
    s_add_u32 m0, s51, 0x1b000
    s_nop 0
    buffer_load_dwordx4 v15, s[12:15], s43 offen lds
    s_add_u32 s43, s41, 0x200000
    s_add_u32 m0, s51, 0x1c000
    s_nop 0
    buffer_load_dwordx4 v15, s[12:15], s43 offen lds
    s_add_u32 s43, s41, 0x280000
    s_add_u32 m0, s51, 0x1d000
    s_nop 0
    buffer_load_dwordx4 v15, s[12:15], s43 offen lds
    s_add_u32 s43, s41, 0x300000
    s_add_u32 m0, s51, 0x1e000
    s_nop 0
    buffer_load_dwordx4 v15, s[12:15], s43 offen lds
    s_add_u32 s43, s41, 0x380000
    s_add_u32 m0, s51, 0x1f000
    s_nop 0
    buffer_load_dwordx4 v15, s[12:15], s43 offen lds
    s_waitcnt vmcnt(32)
    s_barrier
    v_xor_b32 v13, 0, v11
    v_add_u32 v13, 0x18000, v13
    ds_read_b64_tr_b16 a[96:97], v13
    ds_read_b64_tr_b16 a[98:99], v13 offset:1024
    ds_read_b64_tr_b16 a[100:101], v13 offset:16384
    ds_read_b64_tr_b16 a[102:103], v13 offset:17408
    ds_read_b64_tr_b16 a[112:113], v13 offset:4096
    ds_read_b64_tr_b16 a[114:115], v13 offset:5120
    ds_read_b64_tr_b16 a[116:117], v13 offset:20480
    ds_read_b64_tr_b16 a[118:119], v13 offset:21504
    s_waitcnt lgkmcnt(0)
    v_xor_b32 v13, 32, v11
    v_add_u32 v13, 0x18000, v13
    ds_read_b64_tr_b16 a[104:105], v13
    ds_read_b64_tr_b16 a[106:107], v13 offset:1024
    ds_read_b64_tr_b16 a[108:109], v13 offset:16384
    ds_read_b64_tr_b16 a[110:111], v13 offset:17408
    ds_read_b64_tr_b16 a[120:121], v13 offset:4096
    ds_read_b64_tr_b16 a[122:123], v13 offset:5120
    ds_read_b64_tr_b16 a[124:125], v13 offset:20480
    ds_read_b64_tr_b16 a[126:127], v13 offset:21504
    s_waitcnt lgkmcnt(0)
    s_barrier
    v_xor_b32 v15, 1, v14
    v_lshl_add_u32 v15, v15, 15, v8
    s_add_u32 s43, s41, 0x0
    s_add_u32 m0, s51, 0x20000
    s_nop 0
    buffer_load_dwordx4 v15, s[12:15], s43 offen lds
    s_add_u32 s43, s41, 0x80000
    s_add_u32 m0, s51, 0x21000
    s_nop 0
    buffer_load_dwordx4 v15, s[12:15], s43 offen lds
    s_add_u32 s43, s41, 0x100000
    s_add_u32 m0, s51, 0x22000
    s_nop 0
    buffer_load_dwordx4 v15, s[12:15], s43 offen lds
    s_add_u32 s43, s41, 0x180000
    s_add_u32 m0, s51, 0x23000
    s_nop 0
    buffer_load_dwordx4 v15, s[12:15], s43 offen lds
    s_add_u32 s43, s41, 0x200000
    s_add_u32 m0, s51, 0x24000
    s_nop 0
    buffer_load_dwordx4 v15, s[12:15], s43 offen lds
    s_add_u32 s43, s41, 0x280000
    s_add_u32 m0, s51, 0x25000
    s_nop 0
    buffer_load_dwordx4 v15, s[12:15], s43 offen lds
    s_add_u32 s43, s41, 0x300000
    s_add_u32 m0, s51, 0x26000
    s_nop 0
    buffer_load_dwordx4 v15, s[12:15], s43 offen lds
    s_add_u32 s43, s41, 0x380000
    s_add_u32 m0, s51, 0x27000
    s_nop 0
    buffer_load_dwordx4 v15, s[12:15], s43 offen lds
    s_waitcnt vmcnt(24)
    v_min_u32 v21, 0xfffffffe, v21
    s_mov_b32 s43, 0x7010000
    s_mov_b64 exec, s[38:39]
    buffer_store_dword v21, v119, s[8:11], s43 offen sc1
    s_mov_b64 exec, -1
    s_barrier
    v_xor_b32 v13, 0, v11
    v_add_u32 v13, 0x0, v13
    ds_read_b64_tr_b16 a[128:129], v13
    ds_read_b64_tr_b16 a[130:131], v13 offset:1024
    ds_read_b64_tr_b16 a[132:133], v13 offset:16384
    ds_read_b64_tr_b16 a[134:135], v13 offset:17408
    ds_read_b64_tr_b16 a[144:145], v13 offset:4096
    ds_read_b64_tr_b16 a[146:147], v13 offset:5120
    ds_read_b64_tr_b16 a[148:149], v13 offset:20480
    ds_read_b64_tr_b16 a[150:151], v13 offset:21504
    s_waitcnt lgkmcnt(0)
    v_xor_b32 v13, 32, v11
    v_add_u32 v13, 0x0, v13
    ds_read_b64_tr_b16 a[136:137], v13
    ds_read_b64_tr_b16 a[138:139], v13 offset:1024
    ds_read_b64_tr_b16 a[140:141], v13 offset:16384
    ds_read_b64_tr_b16 a[142:143], v13 offset:17408
    ds_read_b64_tr_b16 a[152:153], v13 offset:4096
    ds_read_b64_tr_b16 a[154:155], v13 offset:5120
    ds_read_b64_tr_b16 a[156:157], v13 offset:20480
    ds_read_b64_tr_b16 a[158:159], v13 offset:21504
    s_waitcnt lgkmcnt(0)
    s_barrier
    v_xor_b32 v15, 2, v14
    v_lshl_add_u32 v15, v15, 15, v8
    s_add_u32 s43, s41, 0x0
    s_add_u32 m0, s51, 0x8000
    s_nop 0
    buffer_load_dwordx4 v15, s[12:15], s43 offen lds
    s_add_u32 s43, s41, 0x80000
    s_add_u32 m0, s51, 0x9000
    s_nop 0
    buffer_load_dwordx4 v15, s[12:15], s43 offen lds
    s_add_u32 s43, s41, 0x100000
    s_add_u32 m0, s51, 0xa000
    s_nop 0
    buffer_load_dwordx4 v15, s[12:15], s43 offen lds
    s_add_u32 s43, s41, 0x180000
    s_add_u32 m0, s51, 0xb000
    s_nop 0
    buffer_load_dwordx4 v15, s[12:15], s43 offen lds
    s_add_u32 s43, s41, 0x200000
    s_add_u32 m0, s51, 0xc000
    s_nop 0
    buffer_load_dwordx4 v15, s[12:15], s43 offen lds
    s_add_u32 s43, s41, 0x280000
    s_add_u32 m0, s51, 0xd000
    s_nop 0
    buffer_load_dwordx4 v15, s[12:15], s43 offen lds
    s_add_u32 s43, s41, 0x300000
    s_add_u32 m0, s51, 0xe000
    s_nop 0
    buffer_load_dwordx4 v15, s[12:15], s43 offen lds
    s_add_u32 s43, s41, 0x380000
    s_add_u32 m0, s51, 0xf000
    s_nop 0
    buffer_load_dwordx4 v15, s[12:15], s43 offen lds
    s_waitcnt vmcnt(24)
    s_barrier
    v_xor_b32 v13, 0, v11
    v_add_u32 v13, 0x8000, v13
    ds_read_b64_tr_b16 a[160:161], v13
    ds_read_b64_tr_b16 a[162:163], v13 offset:1024
    ds_read_b64_tr_b16 a[164:165], v13 offset:16384
    ds_read_b64_tr_b16 a[166:167], v13 offset:17408
    ds_read_b64_tr_b16 a[176:177], v13 offset:4096
    ds_read_b64_tr_b16 a[178:179], v13 offset:5120
    ds_read_b64_tr_b16 a[180:181], v13 offset:20480
    ds_read_b64_tr_b16 a[182:183], v13 offset:21504
    s_waitcnt lgkmcnt(0)
    v_xor_b32 v13, 32, v11
    v_add_u32 v13, 0x8000, v13
    ds_read_b64_tr_b16 a[168:169], v13
    ds_read_b64_tr_b16 a[170:171], v13 offset:1024
    ds_read_b64_tr_b16 a[172:173], v13 offset:16384
    ds_read_b64_tr_b16 a[174:175], v13 offset:17408
    ds_read_b64_tr_b16 a[184:185], v13 offset:4096
    ds_read_b64_tr_b16 a[186:187], v13 offset:5120
    ds_read_b64_tr_b16 a[188:189], v13 offset:20480
    ds_read_b64_tr_b16 a[190:191], v13 offset:21504
    s_waitcnt lgkmcnt(0)
    s_barrier
    v_xor_b32 v15, 3, v14
    v_lshl_add_u32 v15, v15, 15, v8
    s_add_u32 s43, s41, 0x0
    s_add_u32 m0, s51, 0x10000
    s_nop 0
    buffer_load_dwordx4 v15, s[12:15], s43 offen lds
    s_add_u32 s43, s41, 0x80000
    s_add_u32 m0, s51, 0x11000
    s_nop 0
    buffer_load_dwordx4 v15, s[12:15], s43 offen lds
    s_add_u32 s43, s41, 0x100000
    s_add_u32 m0, s51, 0x12000
    s_nop 0
    buffer_load_dwordx4 v15, s[12:15], s43 offen lds
    s_add_u32 s43, s41, 0x180000
    s_add_u32 m0, s51, 0x13000
    s_nop 0
    buffer_load_dwordx4 v15, s[12:15], s43 offen lds
    s_add_u32 s43, s41, 0x200000
    s_add_u32 m0, s51, 0x14000
    s_nop 0
    buffer_load_dwordx4 v15, s[12:15], s43 offen lds
    s_add_u32 s43, s41, 0x280000
    s_add_u32 m0, s51, 0x15000
    s_nop 0
    buffer_load_dwordx4 v15, s[12:15], s43 offen lds
    s_add_u32 s43, s41, 0x300000
    s_add_u32 m0, s51, 0x16000
    s_nop 0
    buffer_load_dwordx4 v15, s[12:15], s43 offen lds
    s_add_u32 s43, s41, 0x380000
    s_add_u32 m0, s51, 0x17000
    s_nop 0
    buffer_load_dwordx4 v15, s[12:15], s43 offen lds
    s_waitcnt vmcnt(24)
    s_barrier
    v_xor_b32 v13, 0, v11
    v_add_u32 v13, 0x10000, v13
    ds_read_b64_tr_b16 a[192:193], v13
    ds_read_b64_tr_b16 a[194:195], v13 offset:1024
    ds_read_b64_tr_b16 a[196:197], v13 offset:16384
    ds_read_b64_tr_b16 a[198:199], v13 offset:17408
    ds_read_b64_tr_b16 a[208:209], v13 offset:4096
    ds_read_b64_tr_b16 a[210:211], v13 offset:5120
    ds_read_b64_tr_b16 a[212:213], v13 offset:20480
    ds_read_b64_tr_b16 a[214:215], v13 offset:21504
    s_waitcnt lgkmcnt(0)
    v_xor_b32 v13, 32, v11
    v_add_u32 v13, 0x10000, v13
    ds_read_b64_tr_b16 a[200:201], v13
    ds_read_b64_tr_b16 a[202:203], v13 offset:1024
    ds_read_b64_tr_b16 a[204:205], v13 offset:16384
    ds_read_b64_tr_b16 a[206:207], v13 offset:17408
    ds_read_b64_tr_b16 a[216:217], v13 offset:4096
    ds_read_b64_tr_b16 a[218:219], v13 offset:5120
    ds_read_b64_tr_b16 a[220:221], v13 offset:20480
    ds_read_b64_tr_b16 a[222:223], v13 offset:21504
    s_waitcnt lgkmcnt(0)
    s_barrier
    s_mov_b32 s12, s66
    s_and_b32 s13, s67, 0xffff
    s_add_u32 s43, s42, 0x0
    s_add_u32 m0, s51, 0x18000
    s_nop 0
    buffer_load_dwordx4 v10, s[12:15], s43 offen lds
    s_add_u32 s43, s42, 0x4000
    s_add_u32 m0, s51, 0x19000
    s_nop 0
    buffer_load_dwordx4 v9, s[12:15], s43 offen lds
    s_add_u32 s43, s42, 0x8000
    s_add_u32 m0, s51, 0x1a000
    s_nop 0
    buffer_load_dwordx4 v10, s[12:15], s43 offen lds
    s_add_u32 s43, s42, 0xc000
    s_add_u32 m0, s51, 0x1b000
    s_nop 0
    buffer_load_dwordx4 v9, s[12:15], s43 offen lds
    s_add_u32 s43, s42, 0x10000
    s_add_u32 m0, s51, 0x1c000
    s_nop 0
    buffer_load_dwordx4 v10, s[12:15], s43 offen lds
    s_add_u32 s43, s42, 0x14000
    s_add_u32 m0, s51, 0x1d000
    s_nop 0
    buffer_load_dwordx4 v9, s[12:15], s43 offen lds
    s_add_u32 s43, s42, 0x18000
    s_add_u32 m0, s51, 0x1e000
    s_nop 0
    buffer_load_dwordx4 v10, s[12:15], s43 offen lds
    s_add_u32 s43, s42, 0x1c000
    s_add_u32 m0, s51, 0x1f000
    s_nop 0
    buffer_load_dwordx4 v9, s[12:15], s43 offen lds
    s_waitcnt vmcnt(24)
    s_barrier
    v_xor_b32 v13, 0, v11
    v_add_u32 v13, 0x18000, v13
    ds_read_b64_tr_b16 a[224:225], v13
    ds_read_b64_tr_b16 a[226:227], v13 offset:1024
    ds_read_b64_tr_b16 a[228:229], v13 offset:16384
    ds_read_b64_tr_b16 a[230:231], v13 offset:17408
    ds_read_b64_tr_b16 a[240:241], v13 offset:4096
    ds_read_b64_tr_b16 a[242:243], v13 offset:5120
    ds_read_b64_tr_b16 a[244:245], v13 offset:20480
    ds_read_b64_tr_b16 a[246:247], v13 offset:21504
    s_waitcnt lgkmcnt(0)
    v_xor_b32 v13, 32, v11
    v_add_u32 v13, 0x18000, v13
    ds_read_b64_tr_b16 a[232:233], v13
    ds_read_b64_tr_b16 a[234:235], v13 offset:1024
    ds_read_b64_tr_b16 a[236:237], v13 offset:16384
    ds_read_b64_tr_b16 a[238:239], v13 offset:17408
    ds_read_b64_tr_b16 a[248:249], v13 offset:4096
    ds_read_b64_tr_b16 a[250:251], v13 offset:5120
    ds_read_b64_tr_b16 a[252:253], v13 offset:20480
    ds_read_b64_tr_b16 a[254:255], v13 offset:21504
    s_waitcnt lgkmcnt(0)
    s_barrier
    s_add_u32 s43, s42, 0x40
    s_add_u32 m0, s51, 0x20000
    s_nop 0
    buffer_load_dwordx4 v10, s[12:15], s43 offen lds
    s_add_u32 s43, s42, 0x4040
    s_add_u32 m0, s51, 0x21000
    s_nop 0
    buffer_load_dwordx4 v9, s[12:15], s43 offen lds
    s_add_u32 s43, s42, 0x8040
    s_add_u32 m0, s51, 0x22000
    s_nop 0
    buffer_load_dwordx4 v10, s[12:15], s43 offen lds
    s_add_u32 s43, s42, 0xc040
    s_add_u32 m0, s51, 0x23000
    s_nop 0
    buffer_load_dwordx4 v9, s[12:15], s43 offen lds
    s_add_u32 s43, s42, 0x10040
    s_add_u32 m0, s51, 0x24000
    s_nop 0
    buffer_load_dwordx4 v10, s[12:15], s43 offen lds
    s_add_u32 s43, s42, 0x14040
    s_add_u32 m0, s51, 0x25000
    s_nop 0
    buffer_load_dwordx4 v9, s[12:15], s43 offen lds
    s_add_u32 s43, s42, 0x18040
    s_add_u32 m0, s51, 0x26000
    s_nop 0
    buffer_load_dwordx4 v10, s[12:15], s43 offen lds
    s_add_u32 s43, s42, 0x1c040
    s_add_u32 m0, s51, 0x27000
    s_nop 0
    buffer_load_dwordx4 v9, s[12:15], s43 offen lds
    s_waitcnt vmcnt(24)
    s_barrier
    v_xor_b32 v13, 0, v11
    v_add_u32 v13, 0x0, v13
    ds_read_b64_tr_b16 v[128:129], v13
    ds_read_b64_tr_b16 v[130:131], v13 offset:1024
    ds_read_b64_tr_b16 v[132:133], v13 offset:16384
    ds_read_b64_tr_b16 v[134:135], v13 offset:17408
    ds_read_b64_tr_b16 v[144:145], v13 offset:4096
    ds_read_b64_tr_b16 v[146:147], v13 offset:5120
    ds_read_b64_tr_b16 v[148:149], v13 offset:20480
    ds_read_b64_tr_b16 v[150:151], v13 offset:21504
    s_waitcnt lgkmcnt(0)
    v_xor_b32 v13, 32, v11
    v_add_u32 v13, 0x0, v13
    ds_read_b64_tr_b16 v[136:137], v13
    ds_read_b64_tr_b16 v[138:139], v13 offset:1024
    ds_read_b64_tr_b16 v[140:141], v13 offset:16384
    ds_read_b64_tr_b16 v[142:143], v13 offset:17408
    ds_read_b64_tr_b16 v[152:153], v13 offset:4096
    ds_read_b64_tr_b16 v[154:155], v13 offset:5120
    ds_read_b64_tr_b16 v[156:157], v13 offset:20480
    ds_read_b64_tr_b16 v[158:159], v13 offset:21504
    s_waitcnt lgkmcnt(0)
    s_barrier
    s_mov_b32 s12, s60
    s_and_b32 s13, s61, 0xffff
    v_xor_b32 v15, 0, v14
    v_lshl_add_u32 v15, v15, 15, v8
    s_add_u32 s43, s41, 0x0
    s_add_u32 m0, s51, 0x8000
    s_nop 0
    buffer_load_dwordx4 v15, s[12:15], s43 offen lds
    s_add_u32 s43, s41, 0x80000
    s_add_u32 m0, s51, 0x9000
    s_nop 0
    buffer_load_dwordx4 v15, s[12:15], s43 offen lds
    s_add_u32 s43, s41, 0x100000
    s_add_u32 m0, s51, 0xa000
    s_nop 0
    buffer_load_dwordx4 v15, s[12:15], s43 offen lds
    s_add_u32 s43, s41, 0x180000
    s_add_u32 m0, s51, 0xb000
    s_nop 0
    buffer_load_dwordx4 v15, s[12:15], s43 offen lds
    s_add_u32 s43, s41, 0x200000
    s_add_u32 m0, s51, 0xc000
    s_nop 0
    buffer_load_dwordx4 v15, s[12:15], s43 offen lds
    s_add_u32 s43, s41, 0x280000
    s_add_u32 m0, s51, 0xd000
    s_nop 0
    buffer_load_dwordx4 v15, s[12:15], s43 offen lds
    s_add_u32 s43, s41, 0x300000
    s_add_u32 m0, s51, 0xe000
    s_nop 0
    buffer_load_dwordx4 v15, s[12:15], s43 offen lds
    s_add_u32 s43, s41, 0x380000
    s_add_u32 m0, s51, 0xf000
    s_nop 0
    buffer_load_dwordx4 v15, s[12:15], s43 offen lds
    s_waitcnt vmcnt(24)
    s_barrier
    s_cmp_lg_u32 s21, 0
    s_cbranch_scc1 L_arr_49
    v_mov_b32 v23, 1
    s_mov_b64 exec, 1
    buffer_atomic_add v23, off, s[16:19], 0 offset:8
    s_mov_b64 exec, -1
L_arr_49:
    v_xor_b32 v13, 0, v11
    v_add_u32 v13, 0x8000, v13
    ds_read_b64_tr_b16 v[160:161], v13
    ds_read_b64_tr_b16 v[162:163], v13 offset:1024
    ds_read_b64_tr_b16 v[164:165], v13 offset:16384
    ds_read_b64_tr_b16 v[166:167], v13 offset:17408
    ds_read_b64_tr_b16 v[176:177], v13 offset:4096
    ds_read_b64_tr_b16 v[178:179], v13 offset:5120
    ds_read_b64_tr_b16 v[180:181], v13 offset:20480
    ds_read_b64_tr_b16 v[182:183], v13 offset:21504
    s_waitcnt lgkmcnt(0)
    v_xor_b32 v13, 32, v11
    v_add_u32 v13, 0x8000, v13
    ds_read_b64_tr_b16 v[168:169], v13
    ds_read_b64_tr_b16 v[170:171], v13 offset:1024
    ds_read_b64_tr_b16 v[172:173], v13 offset:16384
    ds_read_b64_tr_b16 v[174:175], v13 offset:17408
    ds_read_b64_tr_b16 v[184:185], v13 offset:4096
    ds_read_b64_tr_b16 v[186:187], v13 offset:5120
    ds_read_b64_tr_b16 v[188:189], v13 offset:20480
    ds_read_b64_tr_b16 v[190:191], v13 offset:21504
    s_waitcnt lgkmcnt(0)
    s_barrier
    s_mov_b32 s12, s62
    s_and_b32 s13, s63, 0xffff
    v_xor_b32 v15, 0, v14
    v_lshl_add_u32 v15, v15, 15, v8
    s_add_u32 s43, s41, 0x0
    s_add_u32 m0, s51, 0x10000
    s_nop 0
    buffer_load_dwordx4 v15, s[12:15], s43 offen lds
    s_add_u32 s43, s41, 0x80000
    s_add_u32 m0, s51, 0x11000
    s_nop 0
    buffer_load_dwordx4 v15, s[12:15], s43 offen lds
    s_add_u32 s43, s41, 0x100000
    s_add_u32 m0, s51, 0x12000
    s_nop 0
    buffer_load_dwordx4 v15, s[12:15], s43 offen lds
    s_add_u32 s43, s41, 0x180000
    s_add_u32 m0, s51, 0x13000
    s_nop 0
    buffer_load_dwordx4 v15, s[12:15], s43 offen lds
    s_add_u32 s43, s41, 0x200000
    s_add_u32 m0, s51, 0x14000
    s_nop 0
    buffer_load_dwordx4 v15, s[12:15], s43 offen lds
    s_add_u32 s43, s41, 0x280000
    s_add_u32 m0, s51, 0x15000
    s_nop 0
    buffer_load_dwordx4 v15, s[12:15], s43 offen lds
    s_add_u32 s43, s41, 0x300000
    s_add_u32 m0, s51, 0x16000
    s_nop 0
    buffer_load_dwordx4 v15, s[12:15], s43 offen lds
    s_add_u32 s43, s41, 0x380000
    s_add_u32 m0, s51, 0x17000
    s_nop 0
    buffer_load_dwordx4 v15, s[12:15], s43 offen lds
    s_waitcnt vmcnt(24)
    s_barrier
    v_xor_b32 v13, 0x0, v12
    v_add_u32 v13, 0x10000, v13
    ds_read_b64_tr_b16 v[192:193], v13
    ds_read_b64_tr_b16 v[194:195], v13 offset:512
    ds_read_b64_tr_b16 v[196:197], v13 offset:2048
    ds_read_b64_tr_b16 v[198:199], v13 offset:2560
    v_xor_b32 v13, 0x2000, v12
    v_add_u32 v13, 0x10000, v13
    ds_read_b64_tr_b16 v[200:201], v13
    ds_read_b64_tr_b16 v[202:203], v13 offset:512
    ds_read_b64_tr_b16 v[204:205], v13 offset:2048
    ds_read_b64_tr_b16 v[206:207], v13 offset:2560
    s_waitcnt lgkmcnt(0)
    v_xor_b32 v13, 0x4000, v12
    v_add_u32 v13, 0x10000, v13
    ds_read_b64_tr_b16 v[208:209], v13
    ds_read_b64_tr_b16 v[210:211], v13 offset:512
    ds_read_b64_tr_b16 v[212:213], v13 offset:2048
    ds_read_b64_tr_b16 v[214:215], v13 offset:2560
    v_xor_b32 v13, 0x6000, v12
    v_add_u32 v13, 0x10000, v13
    ds_read_b64_tr_b16 v[216:217], v13
    ds_read_b64_tr_b16 v[218:219], v13 offset:512
    ds_read_b64_tr_b16 v[220:221], v13 offset:2048
    ds_read_b64_tr_b16 v[222:223], v13 offset:2560
    s_waitcnt lgkmcnt(0)
    s_barrier
    s_mov_b32 s12, s66
    s_and_b32 s13, s67, 0xffff
    s_add_u32 s43, s42, 0x80
    s_add_u32 m0, s51, 0x18000
    s_nop 0
    buffer_load_dwordx4 v10, s[12:15], s43 offen lds
    s_add_u32 s43, s42, 0x4080
    s_add_u32 m0, s51, 0x19000
    s_nop 0
    buffer_load_dwordx4 v9, s[12:15], s43 offen lds
    s_add_u32 s43, s42, 0x8080
    s_add_u32 m0, s51, 0x1a000
    s_nop 0
    buffer_load_dwordx4 v10, s[12:15], s43 offen lds
    s_add_u32 s43, s42, 0xc080
    s_add_u32 m0, s51, 0x1b000
    s_nop 0
    buffer_load_dwordx4 v9, s[12:15], s43 offen lds
    s_add_u32 s43, s42, 0x10080
    s_add_u32 m0, s51, 0x1c000
    s_nop 0
    buffer_load_dwordx4 v10, s[12:15], s43 offen lds
    s_add_u32 s43, s42, 0x14080
    s_add_u32 m0, s51, 0x1d000
    s_nop 0
    buffer_load_dwordx4 v9, s[12:15], s43 offen lds
    s_add_u32 s43, s42, 0x18080
    s_add_u32 m0, s51, 0x1e000
    s_nop 0
    buffer_load_dwordx4 v10, s[12:15], s43 offen lds
    s_add_u32 s43, s42, 0x1c080
    s_add_u32 m0, s51, 0x1f000
    s_nop 0
    buffer_load_dwordx4 v9, s[12:15], s43 offen lds
    s_waitcnt vmcnt(24)
    s_barrier
    v_xor_b32 v13, 0x0, v12
    v_add_u32 v13, 0x18000, v13
    ds_read_b64_tr_b16 v[224:225], v13
    ds_read_b64_tr_b16 v[226:227], v13 offset:512
    ds_read_b64_tr_b16 v[228:229], v13 offset:2048
    ds_read_b64_tr_b16 v[230:231], v13 offset:2560
    v_xor_b32 v13, 0x2000, v12
    v_add_u32 v13, 0x18000, v13
    ds_read_b64_tr_b16 v[232:233], v13
    ds_read_b64_tr_b16 v[234:235], v13 offset:512
    ds_read_b64_tr_b16 v[236:237], v13 offset:2048
    ds_read_b64_tr_b16 v[238:239], v13 offset:2560
    s_waitcnt lgkmcnt(0)
    v_xor_b32 v13, 0x4000, v12
    v_add_u32 v13, 0x18000, v13
    ds_read_b64_tr_b16 v[240:241], v13
    ds_read_b64_tr_b16 v[242:243], v13 offset:512
    ds_read_b64_tr_b16 v[244:245], v13 offset:2048
    ds_read_b64_tr_b16 v[246:247], v13 offset:2560
    v_xor_b32 v13, 0x6000, v12
    v_add_u32 v13, 0x18000, v13
    ds_read_b64_tr_b16 v[248:249], v13
    ds_read_b64_tr_b16 v[250:251], v13 offset:512
    ds_read_b64_tr_b16 v[252:253], v13 offset:2048
    ds_read_b64_tr_b16 v[254:255], v13 offset:2560
    s_waitcnt lgkmcnt(0)
    s_barrier
    s_add_u32 s43, s42, 0xc0
    s_add_u32 m0, s51, 0x20000
    s_nop 0
    buffer_load_dwordx4 v10, s[12:15], s43 offen lds
    s_add_u32 s43, s42, 0x40c0
    s_add_u32 m0, s51, 0x21000
    s_nop 0
    buffer_load_dwordx4 v9, s[12:15], s43 offen lds
    s_add_u32 s43, s42, 0x80c0
    s_add_u32 m0, s51, 0x22000
    s_nop 0
    buffer_load_dwordx4 v10, s[12:15], s43 offen lds
    s_add_u32 s43, s42, 0xc0c0
    s_add_u32 m0, s51, 0x23000
    s_nop 0
    buffer_load_dwordx4 v9, s[12:15], s43 offen lds
    s_add_u32 s43, s42, 0x100c0
    s_add_u32 m0, s51, 0x24000
    s_nop 0
    buffer_load_dwordx4 v10, s[12:15], s43 offen lds
    s_add_u32 s43, s42, 0x140c0
    s_add_u32 m0, s51, 0x25000
    s_nop 0
    buffer_load_dwordx4 v9, s[12:15], s43 offen lds
    s_add_u32 s43, s42, 0x180c0
    s_add_u32 m0, s51, 0x26000
    s_nop 0
    buffer_load_dwordx4 v10, s[12:15], s43 offen lds
    s_add_u32 s43, s42, 0x1c0c0
    s_add_u32 m0, s51, 0x27000
    s_nop 0
    buffer_load_dwordx4 v9, s[12:15], s43 offen lds
    s_waitcnt vmcnt(24)
    s_barrier
    v_xor_b32 v13, 0, v11
    v_add_u32 v13, 0x0, v13
    ds_read_b64_tr_b16 v[32:33], v13
    ds_read_b64_tr_b16 v[34:35], v13 offset:1024
    ds_read_b64_tr_b16 v[36:37], v13 offset:16384
    ds_read_b64_tr_b16 v[38:39], v13 offset:17408
    ds_read_b64_tr_b16 v[48:49], v13 offset:4096
    ds_read_b64_tr_b16 v[50:51], v13 offset:5120
    ds_read_b64_tr_b16 v[52:53], v13 offset:20480
    ds_read_b64_tr_b16 v[54:55], v13 offset:21504
    s_waitcnt lgkmcnt(0)
    v_xor_b32 v13, 32, v11
    v_add_u32 v13, 0x0, v13
    ds_read_b64_tr_b16 v[40:41], v13
    ds_read_b64_tr_b16 v[42:43], v13 offset:1024
    ds_read_b64_tr_b16 v[44:45], v13 offset:16384
    ds_read_b64_tr_b16 v[46:47], v13 offset:17408
    ds_read_b64_tr_b16 v[56:57], v13 offset:4096
    ds_read_b64_tr_b16 v[58:59], v13 offset:5120
    ds_read_b64_tr_b16 v[60:61], v13 offset:20480
    ds_read_b64_tr_b16 v[62:63], v13 offset:21504
    s_waitcnt lgkmcnt(0)
    s_barrier
    ds_write_b128 v123, v[32:35]
    ds_write_b128 v123, v[36:39] offset:1024
    ds_write_b128 v123, v[40:43] offset:2048
    ds_write_b128 v123, v[44:47] offset:3072
    ds_write_b128 v123, v[48:51] offset:4096
    ds_write_b128 v123, v[52:55] offset:5120
    ds_write_b128 v123, v[56:59] offset:6144
    ds_write_b128 v123, v[60:63] offset:7168
    s_waitcnt vmcnt(16)
    s_barrier
    v_xor_b32 v13, 0, v11
    v_add_u32 v13, 0x8000, v13
    ds_read_b64_tr_b16 v[32:33], v13
    ds_read_b64_tr_b16 v[34:35], v13 offset:1024
    ds_read_b64_tr_b16 v[36:37], v13 offset:16384
    ds_read_b64_tr_b16 v[38:39], v13 offset:17408
    ds_read_b64_tr_b16 v[48:49], v13 offset:4096
    ds_read_b64_tr_b16 v[50:51], v13 offset:5120
    ds_read_b64_tr_b16 v[52:53], v13 offset:20480
    ds_read_b64_tr_b16 v[54:55], v13 offset:21504
    s_waitcnt lgkmcnt(0)
    v_xor_b32 v13, 32, v11
    v_add_u32 v13, 0x8000, v13
    ds_read_b64_tr_b16 v[40:41], v13
    ds_read_b64_tr_b16 v[42:43], v13 offset:1024
    ds_read_b64_tr_b16 v[44:45], v13 offset:16384
    ds_read_b64_tr_b16 v[46:47], v13 offset:17408
    ds_read_b64_tr_b16 v[56:57], v13 offset:4096
    ds_read_b64_tr_b16 v[58:59], v13 offset:5120
    ds_read_b64_tr_b16 v[60:61], v13 offset:20480
    ds_read_b64_tr_b16 v[62:63], v13 offset:21504
    s_waitcnt lgkmcnt(0)
    s_barrier
    ds_write_b128 v123, v[32:35] offset:32768
    ds_write_b128 v123, v[36:39] offset:33792
    ds_write_b128 v123, v[40:43] offset:34816
    ds_write_b128 v123, v[44:47] offset:35840
    ds_write_b128 v123, v[48:51] offset:36864
    ds_write_b128 v123, v[52:55] offset:37888
    ds_write_b128 v123, v[56:59] offset:38912
    ds_write_b128 v123, v[60:63] offset:39936
    s_waitcnt vmcnt(8)
    s_barrier
    v_xor_b32 v13, 0x0, v12
    v_add_u32 v13, 0x10000, v13
    ds_read_b64_tr_b16 v[32:33], v13
    ds_read_b64_tr_b16 v[34:35], v13 offset:512
    ds_read_b64_tr_b16 v[36:37], v13 offset:2048
    ds_read_b64_tr_b16 v[38:39], v13 offset:2560
    v_xor_b32 v13, 0x2000, v12
    v_add_u32 v13, 0x10000, v13
    ds_read_b64_tr_b16 v[40:41], v13
    ds_read_b64_tr_b16 v[42:43], v13 offset:512
    ds_read_b64_tr_b16 v[44:45], v13 offset:2048
    ds_read_b64_tr_b16 v[46:47], v13 offset:2560
    s_waitcnt lgkmcnt(0)
    v_xor_b32 v13, 0x4000, v12
    v_add_u32 v13, 0x10000, v13
    ds_read_b64_tr_b16 v[48:49], v13
    ds_read_b64_tr_b16 v[50:51], v13 offset:512
    ds_read_b64_tr_b16 v[52:53], v13 offset:2048
    ds_read_b64_tr_b16 v[54:55], v13 offset:2560
    v_xor_b32 v13, 0x6000, v12
    v_add_u32 v13, 0x10000, v13
    ds_read_b64_tr_b16 v[56:57], v13
    ds_read_b64_tr_b16 v[58:59], v13 offset:512
    ds_read_b64_tr_b16 v[60:61], v13 offset:2048
    ds_read_b64_tr_b16 v[62:63], v13 offset:2560
    s_waitcnt lgkmcnt(0)
    s_barrier
    ds_write_b128 v124, v[32:35]
    ds_write_b128 v124, v[36:39] offset:1024
    ds_write_b128 v124, v[40:43] offset:2048
    ds_write_b128 v124, v[44:47] offset:3072
    ds_write_b128 v124, v[48:51] offset:4096
    ds_write_b128 v124, v[52:55] offset:5120
    ds_write_b128 v124, v[56:59] offset:6144
    ds_write_b128 v124, v[60:63] offset:7168
    s_waitcnt vmcnt(0)
    s_barrier
    v_xor_b32 v13, 0x0, v12
    v_add_u32 v13, 0x18000, v13
    ds_read_b64_tr_b16 v[32:33], v13
    ds_read_b64_tr_b16 v[34:35], v13 offset:512
    ds_read_b64_tr_b16 v[36:37], v13 offset:2048
    ds_read_b64_tr_b16 v[38:39], v13 offset:2560
    v_xor_b32 v13, 0x2000, v12
    v_add_u32 v13, 0x18000, v13
    ds_read_b64_tr_b16 v[40:41], v13
    ds_read_b64_tr_b16 v[42:43], v13 offset:512
    ds_read_b64_tr_b16 v[44:45], v13 offset:2048
    ds_read_b64_tr_b16 v[46:47], v13 offset:2560
    s_waitcnt lgkmcnt(0)
    v_xor_b32 v13, 0x4000, v12
    v_add_u32 v13, 0x18000, v13
    ds_read_b64_tr_b16 v[48:49], v13
    ds_read_b64_tr_b16 v[50:51], v13 offset:512
    ds_read_b64_tr_b16 v[52:53], v13 offset:2048
    ds_read_b64_tr_b16 v[54:55], v13 offset:2560
    v_xor_b32 v13, 0x6000, v12
    v_add_u32 v13, 0x18000, v13
    ds_read_b64_tr_b16 v[56:57], v13
    ds_read_b64_tr_b16 v[58:59], v13 offset:512
    ds_read_b64_tr_b16 v[60:61], v13 offset:2048
    ds_read_b64_tr_b16 v[62:63], v13 offset:2560
    s_waitcnt lgkmcnt(0)
    s_barrier
    ds_write_b128 v124, v[32:35] offset:32768
    ds_write_b128 v124, v[36:39] offset:33792
    ds_write_b128 v124, v[40:43] offset:34816
    ds_write_b128 v124, v[44:47] offset:35840
    ds_write_b128 v124, v[48:51] offset:36864
    ds_write_b128 v124, v[52:55] offset:37888
    ds_write_b128 v124, v[56:59] offset:38912
    ds_write_b128 v124, v[60:63] offset:39936
    s_waitcnt lgkmcnt(0)
    v_lshrrev_b32 v1, 4, v117
    v_and_b32 v2, 15, v1
    v_lshrrev_b32 v1, 4, v1
    v_lshlrev_b32 v1, 11, v1
    v_lshl_add_u32 v1, v2, 2, v1
    s_lshl_b32 s43, s20, 6
    s_add_u32 s43, s43, 0x2000
    s_cmp_lg_u32 s100, 0
    s_cbranch_scc1 L_polls_52
    s_mov_b32 exec_lo, 0x10001
    s_mov_b32 exec_hi, 0
    s_mov_b32 s96, 0
L_poll_50:
    buffer_load_dword v2, v1, s[8:11], s43 offen sc1
    s_waitcnt vmcnt(0)
    v_cmp_gt_u32 vcc, 1, v2
    s_cbranch_vccz L_polld_51
    s_sleep 4
    s_add_u32 s96, s96, 1
    s_cmp_lt_u32 s96, 0x10000
    s_cbranch_scc1 L_poll_50
L_polld_51:
    s_mov_b64 exec, -1
L_polls_52:
    s_barrier
    s_mov_b32 s22, 0
    s_mov_b32 s33, 0
    s_xor_b32 s53, s29, 1024
    s_add_u32 s23, s51, 0x7010000
    s_add_u32 s48, s23, 4096
    s_mov_b32 s24, 0x7012000
    s_add_u32 s55, s24, 16384
    s_mov_b32 s25, 0x7100000
    s_mov_b32 s26, 0x7101000
    s_lshl_b32 s43, s20, 13
    v_mov_b32 v112, 0
    v_mov_b32 v113, 0
    v_mov_b32 v114, 0
    v_mov_b32 v115, 0
    s_add_u32 s43, s43, s52
    s_add_u32 s30, s43, 0x1000000
    s_add_u32 s31, s43, 0x2000000
    s_lshr_b32 s43, s43, 1
    s_add_u32 s32, s43, 0x220000
    s_add_u32 m0, s52, 8192
    s_nop 0
    buffer_load_dwordx4 v117, s[8:11], s30 offen lds
    buffer_load_dwordx4 v117, s[8:11], s30 offen offset:1024 lds
    s_add_u32 m0, s52, 0x6000
    s_nop 0
    buffer_load_dwordx4 v117, s[8:11], s31 offen lds
    buffer_load_dwordx4 v117, s[8:11], s31 offen offset:1024 lds
    s_add_u32 m0, s51, 4096
    ds_write_b128 v117, v[112:115] offset:22528
    ds_write_b128 v117, v[112:115] offset:23552
    s_cmp_lg_u32 s21, 0
    s_cselect_b32 s40, -1, 0
    v_mov_b32 v126, s40
    v_bfe_u32 v1, v117, 4, 1
    v_lshlrev_b32 v1, 4, v1
    s_movk_i32 s43, 0x3f80
    v_lshlrev_b32 v125, v1, s43
    v_bfe_u32 v1, v117, 5, 3
    v_cmp_eq_u32 s[68:69], 0, v1
    v_cmp_eq_u32 s[70:71], 1, v1
    v_cmp_eq_u32 s[72:73], 2, v1
    v_cmp_eq_u32 s[74:75], 3, v1
    v_lshrrev_b32 v1, 2, v117
    s_cmp_lt_u32 s21, 2
    s_cselect_b64 vcc, -1, 0
    v_cndmask_b32 v119, v119, v1, vcc
    v_mov_b32 v32, 0
    v_mov_b32 v33, 0
    v_mov_b32 v34, 0
    v_mov_b32 v35, 0
    v_mov_b32 v36, 0
    v_mov_b32 v37, 0
    v_mov_b32 v38, 0
    v_mov_b32 v39, 0
    v_mov_b32 v40, 0
    v_mov_b32 v41, 0
    v_mov_b32 v42, 0
    v_mov_b32 v43, 0
    v_mov_b32 v44, 0
    v_mov_b32 v45, 0
    v_mov_b32 v46, 0
    v_mov_b32 v47, 0
    v_mov_b32 v48, 0
    v_mov_b32 v49, 0
    v_mov_b32 v50, 0
    v_mov_b32 v51, 0
    v_mov_b32 v52, 0
    v_mov_b32 v53, 0
    v_mov_b32 v54, 0
    v_mov_b32 v55, 0
    s_add_u32 s30, s30, 0x40000
    s_add_u32 s31, s31, 0x40000
    s_mov_b32 s45, 0
    s_mov_b32 s46, 0
    s_mov_b32 s47, 0
    s_mov_b32 s76, 0
    s_and_b32 s43, s21, 1
    s_lshl_b32 s43, s43, 5
    s_add_u32 s43, s43, s20
    s_lshl_b32 s43, s43, 6
    s_add_u32 s28, s43, 0x2000
    s_mov_b32 s59, 0
    ds_read_b128 v[80:83], v123
    ds_read_b128 v[84:87], v123 offset:1024
    ds_read_b128 v[56:59], v123 offset:2048
    ds_read_b128 v[60:63], v123 offset:3072
    ds_read_b128 v[64:67], v123 offset:32768
    ds_read_b128 v[68:71], v123 offset:33792
    ds_read_b128 v[72:75], v123 offset:34816
    ds_read_b128 v[76:79], v123 offset:35840
    ds_read_b128 v[88:91], v123 offset:4096
    ds_read_b128 v[92:95], v123 offset:5120
    ds_read_b128 v[96:99], v123 offset:6144
    ds_read_b128 v[100:103], v123 offset:7168
    ds_read_b128 v[104:107], v123 offset:36864
    ds_read_b128 v[108:111], v123 offset:37888
    ds_read_b128 v[24:27], v123 offset:38912
    ds_read_b128 v[28:31], v123 offset:39936
    s_cmp_lg_u32 s21, 0
    s_cbranch_scc1 L_cb_skip_53
    v_mov_b32 v1, 8
    s_mov_b64 exec, 1
    s_mov_b32 s49, 0
L_cb_poll_54:
    buffer_load_dword v3, v1, s[16:19], 0 offen sc1
    s_waitcnt vmcnt(0)
    v_readfirstlane_b32 s43, v3
    s_nop 0
    s_cmp_ge_u32 s43, 32
    s_cbranch_scc1 L_cb_done_55
    s_sleep 2
    s_add_u32 s49, s49, 1
    s_cmp_lt_u32 s49, 0x40000
    s_cbranch_scc1 L_cb_poll_54
L_cb_done_55:
    s_mov_b64 exec, -1
L_cb_skip_53:
    s_mov_b32 s49, 0
    s_lshr_b32 s43, s20, 1
    s_lshl_b32 s43, s43, 7
    s_and_b32 s40, s20, 1
    s_lshl_b32 s40, s40, 4
    s_add_u32 s43, s43, s40
    s_add_u32 s44, s43, 0x1000
    s_cmp_eq_u32 s21, 0
    s_cselect_b32 s44, s44, 0x7ff00000
    s_waitcnt vmcnt(0) lgkmcnt(0)
    s_barrier
    buffer_load_dwordx4 v[0:3], v117, s[8:11], s23 offen sc1
    s_waitcnt vmcnt(0)
    s_cmp_eq_u32 s21, 1
    s_cbranch_scc1 L_chain_top1_s
    s_cmp_eq_u32 s21, 2
    s_cbranch_scc1 L_chain_top2_s
    s_cmp_eq_u32 s21, 3
    s_cbranch_scc1 L_chain_top3_s
.p2align 6
L_chain_top0_s:
    buffer_load_dwordx4 v[0:3], v117, s[8:11], s23 offen sc1
    v_mov_b32 v15, 0
    v_mov_b32 v15, 0
    v_mov_b32 v15, 0
    v_mov_b32 v15, 0
    v_mov_b32 v15, 0
    v_mov_b32 v15, 0
    v_mov_b32 v15, 0
    v_mov_b32 v15, 0
    v_mov_b32 v15, 0
    v_mov_b32 v15, 0
    v_mov_b32 v15, 0
    v_mov_b32 v15, 0
    v_mov_b32 v15, 0
    v_mov_b32 v15, 0
    v_mov_b32 v15, 0
    v_mov_b32 v15, 0
    buffer_load_dwordx4 v[0:3], v117, s[8:11], s23 offen sc1
    v_mov_b32 v15, 0
    v_mov_b32 v15, 0
    v_mov_b32 v15, 0
    v_mov_b32 v15, 0
    v_mov_b32 v15, 0
    v_mov_b32 v15, 0
    v_mov_b32 v15, 0
    v_mov_b32 v15, 0
    v_mov_b32 v15, 0
    v_mov_b32 v15, 0
    v_mov_b32 v15, 0
    v_mov_b32 v15, 0
    v_mov_b32 v15, 0
    v_mov_b32 v15, 0
    v_mov_b32 v15, 0
    v_mov_b32 v15, 0
L_mret_56:
    buffer_load_dwordx4 v[0:3], v117, s[8:11], s23 offen sc1
    s_add_u32 s45, s45, 1
    s_cmp_lt_u32 s45, 0x10000
    s_cselect_b32 s56, -2, -1
    s_nop 3
    v_mov_b32 v32, 0
    v_mov_b32 v33, 0
    v_mov_b32 v34, 0
    v_mov_b32 v35, 0
    s_waitcnt vmcnt(2)
    v_max3_u32 v15, v0, v1, v2
    v_max_u32 v15, v15, v3
    v_cmp_lt_u32 vcc, s56, v15
    v_smfmac_f32_16x16x64_bf16 v[32:35], v[0:3], v[80:87], v116
    s_cbranch_vccnz L_mret_56
    ds_write_b128 v117, v[0:3]
    v_smfmac_f32_16x16x64_bf16 v[36:39], v[0:3], v[56:63], v116
    buffer_load_dwordx4 v[4:7], v117, s[8:11], s48 offen sc1
    v_smfmac_f32_16x16x64_bf16 v[40:43], v[0:3], v[64:71], v116
    buffer_load_dwordx4 v117, s[8:11], s48 offen sc1 lds
    s_mov_b32 m0, 8192
    v_smfmac_f32_16x16x64_bf16 v[44:47], v[0:3], v[72:79], v116
    s_waitcnt lgkmcnt(0)
    s_barrier
    ds_read_b128 v[8:11], v117 offset:1024
    v_smfmac_f32_16x16x64_bf16 v[48:51], v[0:3], a[192:199], v116
    ds_read_b128 v[16:19], v117 offset:2048
    ds_read_b128 v[20:23], v117 offset:3072
    v_smfmac_f32_16x16x64_bf16 v[52:55], v[0:3], a[200:207], v116
    ds_read_b128 v[80:83], v117 offset:14336
    s_waitcnt lgkmcnt(3)
    v_smfmac_f32_16x16x64_bf16 v[32:35], v[8:11], a[0:7], v116
    ds_read_b128 v[84:87], v117 offset:15360
    v_smfmac_f32_16x16x64_bf16 v[36:39], v[8:11], a[8:15], v116
    buffer_store_dwordx4 v[112:115], v117, s[8:11], s32 offen sc1
    s_waitcnt lgkmcnt(3)
    v_smfmac_f32_16x16x64_bf16 v[32:35], v[16:19], a[32:39], v116
    ds_read_b128 v[56:59], v117 offset:8192
    v_smfmac_f32_16x16x64_bf16 v[36:39], v[16:19], a[40:47], v116
    ds_read_b128 v[60:63], v117 offset:9216
    s_waitcnt lgkmcnt(4)
    v_smfmac_f32_16x16x64_bf16 v[32:35], v[20:23], a[64:71], v116
    ds_read_b128 v[64:67], v117 offset:10240
    v_smfmac_f32_16x16x64_bf16 v[36:39], v[20:23], a[72:79], v116
    ds_read_b128 v[68:71], v117 offset:11264
    v_smfmac_f32_16x16x64_bf16 v[40:43], v[8:11], a[96:103], v116
    ds_read_b128 v[72:75], v117 offset:12288
    v_smfmac_f32_16x16x64_bf16 v[40:43], v[16:19], a[128:135], v116
    ds_read_b128 v[76:79], v117 offset:13312
    v_smfmac_f32_16x16x64_bf16 v[40:43], v[20:23], a[160:167], v116
    s_waitcnt vmcnt(2)
    v_max3_u32 v15, v4, v5, v6
    v_smfmac_f32_16x16x64_bf16 v[44:47], v[8:11], a[104:111], v116
    v_max_u32 v15, v15, v7
    v_smfmac_f32_16x16x64_bf16 v[44:47], v[16:19], a[136:143], v116
    s_waitcnt vmcnt(1) lgkmcnt(0)
    v_cmp_lt_u32 vcc, s56, v15
    v_smfmac_f32_16x16x64_bf16 v[44:47], v[20:23], a[168:175], v116
    s_cbranch_vccnz L_mret_57
L_mgo_58:
    v_smfmac_f32_16x16x64_bf16 v[44:47], v[4:7], v[24:31], v116
    s_barrier
    ds_read_b128 v[12:15], v117 offset:5120
    v_smfmac_f32_16x16x64_bf16 v[32:35], v[4:7], v[88:95], v116
    ds_read_b128 v[24:27], v117 offset:6144
    v_smfmac_f32_16x16x64_bf16 v[36:39], v[4:7], v[96:103], v116
    ds_read_b128 v[28:31], v117 offset:7168
    v_smfmac_f32_16x16x64_bf16 v[40:43], v[4:7], v[104:111], v116
    ds_read_b128 v[88:91], v117 offset:24576
    s_waitcnt lgkmcnt(3)
    v_smfmac_f32_16x16x64_bf16 v[32:35], v[12:15], a[16:23], v116
    ds_read_b128 v[92:95], v117 offset:25600
    s_waitcnt lgkmcnt(3)
    v_smfmac_f32_16x16x64_bf16 v[32:35], v[24:27], a[48:55], v116
    buffer_load_dwordx4 v117, s[8:11], s30 offen lds
    s_waitcnt lgkmcnt(2)
    v_smfmac_f32_16x16x64_bf16 v[32:35], v[28:31], a[80:87], v116
    ds_read_b128 v[96:99], v117 offset:23552
    v_smfmac_f32_16x16x64_bf16 v[36:39], v[12:15], a[24:31], v116
    ds_read_b128 v[100:103], v117 offset:23552
    v_smfmac_f32_16x16x64_bf16 v[36:39], v[24:27], a[56:63], v116
    buffer_load_dwordx4 v117, s[8:11], s30 offen offset:1024 lds
    s_add_u32 m0, s52, 0x6000
    v_add_f32 v32, v32, v34
    v_smfmac_f32_16x16x64_bf16 v[36:39], v[28:31], a[88:95], v116
    ds_read_b128 v[104:107], v117 offset:23552
    v_add_f32 v33, v33, v35
    v_smfmac_f32_16x16x64_bf16 v[40:43], v[12:15], a[112:119], v116
    ds_read_b128 v[108:111], v117 offset:23552
    v_mul_f32 v32, s34, v32
    v_smfmac_f32_16x16x64_bf16 v[40:43], v[24:27], a[144:151], v116
    buffer_load_dword v125, v119, s[8:11], s28 offen sc1
    v_mul_f32 v33, s34, v33
    v_smfmac_f32_16x16x64_bf16 v[40:43], v[28:31], a[176:183], v116
    ds_read_b128 v[0:3], v124
    v_add_f32 v36, v36, v38
    v_smfmac_f32_16x16x64_bf16 v[48:51], v[4:7], a[208:215], v116
    v_add_f32 v37, v37, v39
    v_smfmac_f32_16x16x64_bf16 v[52:55], v[4:7], a[216:223], v116
    s_waitcnt lgkmcnt(5)
    buffer_load_dwordx4 v117, s[8:11], s31 offen lds
    v_mul_f32 v36, s34, v36
    v_smfmac_f32_16x16x64_bf16 v[44:47], v[12:15], a[120:127], v116
    ds_read_b128 v[4:7], v124 offset:1024
    v_mul_f32 v37, s34, v37
    v_smfmac_f32_16x16x64_bf16 v[44:47], v[24:27], a[152:159], v116
    v_cvt_pk_bf16_f32 v34, v32, v36
    v_smfmac_f32_16x16x64_bf16 v[44:47], v[28:31], a[184:191], v116
    buffer_load_dwordx4 v117, s[8:11], s31 offen offset:1024 lds
    s_mov_b32 m0, 4096
    v_cvt_pk_bf16_f32 v35, v33, v37
    v_add_f32 v40, v40, v42
    v_smfmac_f32_16x16x64_bf16 v[48:51], v[8:11], a[224:231], v116
    ds_write2_b32 v120, v34, v35 offset0:32 offset1:48
    v_add_f32 v41, v41, v43
    v_smfmac_f32_16x16x64_bf16 v[52:55], v[8:11], a[232:239], v116
    v_add_f32 v44, v44, v46
    v_add_f32 v45, v45, v47
    v_cvt_pk_bf16_f32 v113, v40, v44
    v_cvt_pk_bf16_f32 v115, v41, v45
    v_smfmac_f32_16x16x64_bf16 v[48:51], v[12:15], a[240:247], v116
    ds_write2_b32 v120, v113, v115 offset0:0 offset1:16
    v_smfmac_f32_16x16x64_bf16 v[52:55], v[12:15], a[248:255], v116
    s_cmp_eq_u32 s22, 63
    s_cbranch_scc1 L_chain_last_s
    buffer_store_dword v126, off, s[8:11], s44 sc1
    v_smfmac_f32_16x16x64_bf16 v[48:51], v[16:19], v[128:135], v116
    v_smfmac_f32_16x16x64_bf16 v[48:51], v[20:23], v[160:167], v116
    v_smfmac_f32_16x16x64_bf16 v[48:51], v[24:27], v[144:151], v116
    s_waitcnt lgkmcnt(0)
    s_barrier
    v_smfmac_f32_16x16x64_bf16 v[48:51], v[28:31], v[176:183], v116
    ds_read_b128 v[32:35], v121 offset:16384
    ds_read_b128 v[36:39], v121 offset:17408
    v_smfmac_f32_16x16x64_bf16 v[52:55], v[16:19], v[136:143], v116
    ds_read_b128 v[40:43], v121 offset:18432
    ds_read_b128 v[44:47], v121 offset:19456
    v_smfmac_f32_16x16x64_bf16 v[52:55], v[20:23], v[168:175], v116
    ds_read_b128 v[8:11], v124 offset:32768
    v_add_f32 v48, v48, v50
    v_smfmac_f32_16x16x64_bf16 v[52:55], v[24:27], v[152:159], v116
    ds_read_b128 v[12:15], v124 offset:33792
    v_add_f32 v49, v49, v51
    v_smfmac_f32_16x16x64_bf16 v[52:55], v[28:31], v[184:191], v116
    s_waitcnt lgkmcnt(5)
    v_cvt_pk_bf16_f32 v112, v48, v49
    v_mfma_f32_16x16x32_bf16 v[56:59], v[56:59], v[32:35], 0
    s_waitcnt lgkmcnt(4)
    v_mov_b32 v48, s50
    v_mov_b32 v49, s50
    v_mfma_f32_16x16x32_bf16 v[56:59], v[60:63], v[36:39], v[56:59]
    ds_read_b128 v[16:19], v124 offset:2048
    s_waitcnt lgkmcnt(4)
    v_mov_b32 v50, s50
    v_mov_b32 v51, s50
    v_mfma_f32_16x16x32_bf16 v[56:59], v[64:67], v[40:43], v[56:59]
    ds_read_b128 v[20:23], v124 offset:3072
    s_waitcnt lgkmcnt(4)
    v_add_f32 v52, v52, v54
    v_mfma_f32_16x16x32_bf16 v[56:59], v[68:71], v[44:47], v[56:59]
    ds_read_b128 v[24:27], v124 offset:4096
    v_add_f32 v53, v53, v55
    v_mfma_f32_16x16x32_bf16 v[60:63], v[72:75], v[32:35], 0
    ds_read_b128 v[28:31], v124 offset:5120
    v_cvt_pk_bf16_f32 v114, v52, v53
    v_mov_b32 v53, 0
    v_mfma_f32_16x16x32_bf16 v[60:63], v[76:79], v[36:39], v[60:63]
    v_exp_f32 v56, v56
    v_mfma_f32_16x16x32_bf16 v[60:63], v[80:83], v[40:43], v[60:63]
    v_exp_f32 v57, v57
    v_mfma_f32_16x16x32_bf16 v[60:63], v[84:87], v[44:47], v[60:63]
    v_exp_f32 v58, v58
    v_mfma_f32_16x16x32_bf16 v[64:67], v[32:35], v[32:35], 0
    v_exp_f32 v59, v59
    v_cvt_pk_bf16_f32 v68, v56, v57
    v_mfma_f32_16x16x32_bf16 v[64:67], v[36:39], v[36:39], v[64:67]
    v_exp_f32 v60, v60
    v_cvt_pk_bf16_f32 v69, v58, v59
    v_mfma_f32_16x16x32_bf16 v[64:67], v[40:43], v[40:43], v[64:67]
    v_exp_f32 v61, v61
    v_mfma_f32_16x16x32_bf16 v[64:67], v[44:47], v[44:47], v[64:67]
    v_exp_f32 v62, v62
    v_exp_f32 v63, v63
    v_cvt_pk_bf16_f32 v70, v60, v61
    v_cvt_pk_bf16_f32 v71, v62, v63
    s_nop 1
    v_mfma_f32_16x16x32_bf16 v[72:75], v[88:91], v[68:71], 0
    s_nop 0
    v_exp_f32 v64, v64
    v_mfma_f32_16x16x32_bf16 v[76:79], v[92:95], v[68:71], 0
    v_exp_f32 v65, v65
    v_mfma_f32_16x16x32_bf16 v[80:83], v[48:51], v[68:71], 0
    v_cvt_pk_bf16_f32 v52, v64, v65
    s_nop 1
    v_mfma_f32_16x16x16_bf16 v[72:75], v[112:113], v[52:53], v[72:75]
    ds_read_b128 v[32:35], v124 offset:6144
    v_mfma_f32_16x16x16_bf16 v[76:79], v[114:115], v[52:53], v[76:79]
    ds_read_b128 v[36:39], v124 offset:7168
    v_mfma_f32_16x16x16_bf16 v[80:83], v[48:49], v[52:53], v[80:83]
L_norm_59:
    s_mov_b64 vcc, s[36:37]
    v_mov_b32 v122, v122
    v_mov_b32 v122, v122
    v_mov_b32 v122, v122
    v_cndmask_b32_dpp v76, v72, v76, vcc quad_perm:[2,3,2,3] row_mask:0xf bank_mask:0xf
    v_cndmask_b32_dpp v77, v73, v77, vcc quad_perm:[2,3,2,3] row_mask:0xf bank_mask:0xf
    v_cndmask_b32_dpp v78, v74, v78, vcc quad_perm:[2,3,2,3] row_mask:0xf bank_mask:0xf
    v_cndmask_b32_dpp v79, v75, v79, vcc quad_perm:[2,3,2,3] row_mask:0xf bank_mask:0xf
    v_rcp_f32_dpp v84, v80 quad_perm:[2,3,2,3] row_mask:0xf bank_mask:0xf
    s_nop 0
    v_pk_mul_f32 v[76:77], v[76:77], v[84:85] op_sel_hi:[1,0]
    v_pk_mul_f32 v[78:79], v[78:79], v[84:85] op_sel_hi:[1,0]
    v_cvt_pk_bf16_f32 v72, v76, v77
    v_cvt_pk_bf16_f32 v73, v78, v79
    ds_write_b64 v122, v[72:73] offset:20480
    v_max_f32_dpp v86, v80, v84 quad_perm:[2,3,2,3] row_mask:0xf bank_mask:0xf
    v_mov_b32_dpp v60, v72 quad_perm:[0,1,0,1] row_mask:0xf bank_mask:0xf
    v_mov_b32_dpp v61, v73 quad_perm:[0,1,0,1] row_mask:0xf bank_mask:0xf
    v_cmp_lt_f32 vcc, s35, v86
    v_mov_b32_dpp v62, v72 quad_perm:[2,3,2,3] row_mask:0xf bank_mask:0xf
    v_mov_b32_dpp v63, v73 quad_perm:[2,3,2,3] row_mask:0xf bank_mask:0xf
    s_nop 1
    v_smfmac_f32_16x16x64_bf16 v[96:99], v[60:63], v[192:199], v116
    s_cbranch_vccnz L_smax_60
    v_smfmac_f32_16x16x64_bf16 v[100:103], v[60:63], v[224:231], v116
    s_waitcnt lgkmcnt(0)
    s_barrier
    ds_read_b128 v[92:95], v127 offset:20992
    ds_read_b128 v[80:83], v127 offset:21504
    ds_read_b128 v[84:87], v127 offset:22016
    v_smfmac_f32_16x16x64_bf16 v[104:107], v[60:63], v[0:7], v116
    ds_read_b128 v[40:43], v124 offset:34816
    v_smfmac_f32_16x16x64_bf16 v[108:111], v[60:63], v[8:15], v116
    ds_read_b128 v[56:59], v124 offset:36864
    s_waitcnt lgkmcnt(4)
    v_smfmac_f32_16x16x64_bf16 v[96:99], v[92:95], v[200:207], v116
    s_waitcnt lgkmcnt(3)
    v_smfmac_f32_16x16x64_bf16 v[96:99], v[80:83], v[208:215], v116
    ds_read_b128 v[44:47], v124 offset:35840
    s_waitcnt lgkmcnt(3)
    v_smfmac_f32_16x16x64_bf16 v[96:99], v[84:87], v[216:223], v116
    ds_read_b128 v[68:71], v124 offset:39936
    v_smfmac_f32_16x16x64_bf16 v[100:103], v[92:95], v[232:239], v116
    ds_read_b128 v[64:67], v124 offset:38912
    v_smfmac_f32_16x16x64_bf16 v[100:103], v[80:83], v[240:247], v116
    ds_read_b128 v[60:63], v124 offset:37888
    v_cvt_pk_bf16_f32 v72, v96, v98
    v_smfmac_f32_16x16x64_bf16 v[100:103], v[84:87], v[248:255], v116
    v_and_or_b32 v72, v72, -2, s33
    v_smfmac_f32_16x16x64_bf16 v[104:107], v[92:95], v[16:23], v116
    v_cvt_pk_bf16_f32 v74, v97, v99
    v_smfmac_f32_16x16x64_bf16 v[104:107], v[80:83], v[24:31], v116
    v_cvt_pk_bf16_f32 v73, v100, v102
    v_cvt_pk_bf16_f32 v75, v101, v103
    v_smfmac_f32_16x16x64_bf16 v[104:107], v[84:87], v[32:39], v116
    buffer_store_dwordx4 v[72:75], v118, s[8:11], s25 offen sc1
    s_waitcnt lgkmcnt(3)
    v_smfmac_f32_16x16x64_bf16 v[108:111], v[92:95], v[40:47], v116
    s_waitcnt lgkmcnt(0)
    v_smfmac_f32_16x16x64_bf16 v[108:111], v[80:83], v[56:63], v116
    v_cvt_pk_bf16_f32 v76, v104, v106
    v_smfmac_f32_16x16x64_bf16 v[108:111], v[84:87], v[64:71], v116
    v_and_or_b32 v76, v76, -2, s33
    v_cvt_pk_bf16_f32 v78, v105, v107
    v_mov_b32 v122, v122
    v_mov_b32 v122, v122
    v_mov_b32 v122, v122
    v_mov_b32 v122, v122
    v_mov_b32 v122, v122
    v_mov_b32 v122, v122
    v_cvt_pk_bf16_f32 v77, v108, v110
    v_cvt_pk_bf16_f32 v79, v109, v111
    buffer_store_dwordx4 v[76:79], v118, s[8:11], s26 offen sc1
    s_add_u32 s30, s30, 0x40000
    s_add_u32 s31, s31, 0x40000
    s_add_u32 s32, s32, 0x20000
    s_add_u32 s23, s24, 0
    s_add_u32 s48, s23, 4096
    s_xor_b32 s25, s25, 0x40000
    s_xor_b32 s26, s26, 0x40000
    s_mov_b32 s35, 0x49800000
    v_mov_b32 v126, s22
    s_add_u32 s22, s22, 1
    v_mov_b32 v32, 0
    v_mov_b32 v33, 0
    v_mov_b32 v34, 0
    v_mov_b32 v35, 0
    v_mov_b32 v36, 0
    v_mov_b32 v37, 0
    v_mov_b32 v38, 0
    v_mov_b32 v39, 0
    v_mov_b32 v40, 0
    v_mov_b32 v41, 0
    v_mov_b32 v42, 0
    v_mov_b32 v43, 0
    v_mov_b32 v44, 0
    v_mov_b32 v45, 0
    v_mov_b32 v46, 0
    v_mov_b32 v47, 0
    v_mov_b32 v48, 0
    v_mov_b32 v49, 0
    v_mov_b32 v50, 0
    v_mov_b32 v51, 0
    v_mov_b32 v52, 0
    v_mov_b32 v53, 0
    v_mov_b32 v54, 0
    v_mov_b32 v55, 0
    ds_read_b128 v[80:83], v123
    ds_read_b128 v[84:87], v123 offset:1024
    ds_read_b128 v[56:59], v123 offset:2048
    ds_read_b128 v[60:63], v123 offset:3072
    ds_read_b128 v[64:67], v123 offset:32768
    ds_read_b128 v[68:71], v123 offset:33792
    ds_read_b128 v[72:75], v123 offset:34816
    ds_read_b128 v[76:79], v123 offset:35840
    ds_read_b128 v[88:91], v123 offset:4096
    ds_read_b128 v[92:95], v123 offset:5120
    ds_read_b128 v[96:99], v123 offset:6144
    ds_read_b128 v[100:103], v123 offset:7168
    ds_read_b128 v[104:107], v123 offset:36864
    ds_read_b128 v[108:111], v123 offset:37888
    ds_read_b128 v[24:27], v123 offset:38912
    ds_read_b128 v[28:31], v123 offset:39936
    s_add_u32 s24, s24, 8192
    s_bitset0_b32 s24, 15
    s_xor_b32 s55, s24, 16384
    s_xor_b32 s29, s29, 0x40000
    s_xor_b32 s53, s29, 1024
    s_bfe_u32 s33, s22, 0x10001
    s_add_u32 s40, s22, 5
    s_lshr_b32 s40, s40, 2
    s_min_u32 s40, s40, 16
    s_bfm_b32 s58, s40, 0
    s_waitcnt vmcnt(5)
    v_cmp_eq_u32 vcc, 0, v125
    s_nop 0
    s_and_b64 vcc, vcc, s[58:59]
    s_cbranch_scc1 L_kvw_61
L_kvb_62:
    v_mov_b32 v15, 0
    s_nop 2
    v_mov_b32 v15, 0
    s_nop 2
    v_mov_b32 v15, 0
    s_nop 2
    v_mov_b32 v15, 0
    s_nop 2
    v_mov_b32 v15, 0
    s_nop 2
    v_mov_b32 v15, 0
    s_nop 2
    v_mov_b32 v15, 0
    s_nop 2
    v_mov_b32 v15, 0
    s_nop 2
    v_mov_b32 v15, 0
    s_nop 2
    v_mov_b32 v15, 0
    s_nop 2
    v_mov_b32 v15, 0
    s_nop 2
    v_mov_b32 v15, 0
    s_nop 2
    v_mov_b32 v15, 0
    s_nop 2
    v_mov_b32 v15, 0
    s_nop 2
    v_mov_b32 v15, 0
    s_nop 2
    v_mov_b32 v15, 0
    s_nop 2
    v_mov_b32 v15, 0
    s_nop 2
    v_mov_b32 v15, 0
    s_nop 2
    v_mov_b32 v15, 0
    s_nop 2
    v_mov_b32 v15, 0
    s_nop 2
    v_mov_b32 v15, 0
    s_nop 2
    v_mov_b32 v15, 0
    s_nop 2
    v_mov_b32 v15, 0
    s_nop 2
    v_mov_b32 v15, 0
    s_nop 2
    v_mov_b32 v15, 0
    s_nop 2
    v_mov_b32 v15, 0
    s_nop 2
    v_mov_b32 v15, 0
    s_nop 2
    v_mov_b32 v15, 0
    s_nop 2
    v_mov_b32 v15, 0
    s_nop 2
    v_mov_b32 v15, 0
    s_nop 2
    v_mov_b32 v15, 0
    s_nop 2
    s_waitcnt lgkmcnt(0)
    s_branch L_chain_top0_s
.p2align 6
L_chain_top1_s:
    buffer_load_dwordx4 v[0:3], v117, s[8:11], s23 offen sc1
    v_mov_b32 v15, 0
    v_mov_b32 v15, 0
    v_mov_b32 v15, 0
    v_mov_b32 v15, 0
    v_mov_b32 v15, 0
    v_mov_b32 v15, 0
    v_mov_b32 v15, 0
    v_mov_b32 v15, 0
    v_mov_b32 v15, 0
    v_mov_b32 v15, 0
    v_mov_b32 v15, 0
    v_mov_b32 v15, 0
    v_mov_b32 v15, 0
    v_mov_b32 v15, 0
    v_mov_b32 v15, 0
    v_mov_b32 v15, 0
    buffer_load_dwordx4 v[0:3], v117, s[8:11], s23 offen sc1
    v_mov_b32 v15, 0
    v_mov_b32 v15, 0
    v_mov_b32 v15, 0
    v_mov_b32 v15, 0
    v_mov_b32 v15, 0
    v_mov_b32 v15, 0
    v_mov_b32 v15, 0
    v_mov_b32 v15, 0
    v_mov_b32 v15, 0
    v_mov_b32 v15, 0
    v_mov_b32 v15, 0
    v_mov_b32 v15, 0
    v_mov_b32 v15, 0
    v_mov_b32 v15, 0
    v_mov_b32 v15, 0
    v_mov_b32 v15, 0
L_mret_63:
    buffer_load_dwordx4 v[0:3], v117, s[8:11], s23 offen sc1
    s_add_u32 s45, s45, 1
    s_cmp_lt_u32 s45, 0x10000
    s_cselect_b32 s56, -2, -1
    s_nop 3
    v_mov_b32 v32, 0
    v_mov_b32 v33, 0
    v_mov_b32 v34, 0
    v_mov_b32 v35, 0
    s_waitcnt vmcnt(2)
    v_max3_u32 v15, v0, v1, v2
    v_max_u32 v15, v15, v3
    v_cmp_lt_u32 vcc, s56, v15
    v_smfmac_f32_16x16x64_bf16 v[32:35], v[0:3], v[80:87], v116
    s_cbranch_vccnz L_mret_63
    ds_write_b128 v117, v[0:3] offset:1024
    v_smfmac_f32_16x16x64_bf16 v[36:39], v[0:3], v[56:63], v116
    buffer_load_dwordx4 v[4:7], v117, s[8:11], s48 offen sc1
    v_smfmac_f32_16x16x64_bf16 v[40:43], v[0:3], v[64:71], v116
    buffer_load_dwordx4 v117, s[8:11], s48 offen sc1 lds
    s_mov_b32 m0, 10240
    v_smfmac_f32_16x16x64_bf16 v[44:47], v[0:3], v[72:79], v116
    s_waitcnt lgkmcnt(0)
    s_barrier
    ds_read_b128 v[8:11], v117
    v_smfmac_f32_16x16x64_bf16 v[48:51], v[0:3], a[192:199], v116
    ds_read_b128 v[16:19], v117 offset:3072
    ds_read_b128 v[20:23], v117 offset:2048
    v_smfmac_f32_16x16x64_bf16 v[52:55], v[0:3], a[200:207], v116
    ds_read_b128 v[80:83], v117 offset:14336
    s_waitcnt lgkmcnt(3)
    v_smfmac_f32_16x16x64_bf16 v[32:35], v[8:11], a[0:7], v116
    ds_read_b128 v[84:87], v117 offset:15360
    v_smfmac_f32_16x16x64_bf16 v[36:39], v[8:11], a[8:15], v116
    ds_read_b128 v[56:59], v117 offset:8192
    s_waitcnt lgkmcnt(4)
    v_smfmac_f32_16x16x64_bf16 v[32:35], v[16:19], a[32:39], v116
    ds_read_b128 v[60:63], v117 offset:9216
    v_smfmac_f32_16x16x64_bf16 v[36:39], v[16:19], a[40:47], v116
    buffer_store_dwordx4 v[112:115], v117, s[8:11], s32 offen sc1
    s_waitcnt lgkmcnt(4)
    v_smfmac_f32_16x16x64_bf16 v[32:35], v[20:23], a[64:71], v116
    ds_read_b128 v[64:67], v117 offset:10240
    v_smfmac_f32_16x16x64_bf16 v[36:39], v[20:23], a[72:79], v116
    ds_read_b128 v[68:71], v117 offset:11264
    v_smfmac_f32_16x16x64_bf16 v[40:43], v[8:11], a[96:103], v116
    ds_read_b128 v[72:75], v117 offset:12288
    v_smfmac_f32_16x16x64_bf16 v[40:43], v[16:19], a[128:135], v116
    ds_read_b128 v[76:79], v117 offset:13312
    v_smfmac_f32_16x16x64_bf16 v[40:43], v[20:23], a[160:167], v116
    s_waitcnt vmcnt(2)
    v_max3_u32 v15, v4, v5, v6
    v_smfmac_f32_16x16x64_bf16 v[44:47], v[8:11], a[104:111], v116
    v_max_u32 v15, v15, v7
    v_smfmac_f32_16x16x64_bf16 v[44:47], v[16:19], a[136:143], v116
    s_waitcnt vmcnt(1) lgkmcnt(0)
    v_cmp_lt_u32 vcc, s56, v15
    v_smfmac_f32_16x16x64_bf16 v[44:47], v[20:23], a[168:175], v116
    s_cbranch_vccnz L_mret_64
L_mgo_65:
    v_smfmac_f32_16x16x64_bf16 v[44:47], v[4:7], v[24:31], v116
    s_barrier
    ds_read_b128 v[12:15], v117 offset:4096
    v_smfmac_f32_16x16x64_bf16 v[32:35], v[4:7], v[88:95], v116
    ds_read_b128 v[24:27], v117 offset:7168
    v_smfmac_f32_16x16x64_bf16 v[36:39], v[4:7], v[96:103], v116
    ds_read_b128 v[28:31], v117 offset:6144
    v_smfmac_f32_16x16x64_bf16 v[40:43], v[4:7], v[104:111], v116
    ds_read_b128 v[88:91], v117 offset:26624
    s_waitcnt lgkmcnt(3)
    v_smfmac_f32_16x16x64_bf16 v[32:35], v[12:15], a[16:23], v116
    ds_read_b128 v[92:95], v117 offset:27648
    s_waitcnt lgkmcnt(3)
    v_smfmac_f32_16x16x64_bf16 v[32:35], v[24:27], a[48:55], v116
    buffer_load_dwordx4 v117, s[8:11], s30 offen lds
    s_waitcnt lgkmcnt(2)
    v_smfmac_f32_16x16x64_bf16 v[32:35], v[28:31], a[80:87], v116
    ds_read_b128 v[96:99], v117 offset:23552
    v_smfmac_f32_16x16x64_bf16 v[36:39], v[12:15], a[24:31], v116
    ds_read_b128 v[100:103], v117 offset:23552
    v_smfmac_f32_16x16x64_bf16 v[36:39], v[24:27], a[56:63], v116
    buffer_load_dwordx4 v117, s[8:11], s30 offen offset:1024 lds
    s_add_u32 m0, s52, 0x6000
    v_add_f32 v32, v32, v34
    v_smfmac_f32_16x16x64_bf16 v[36:39], v[28:31], a[88:95], v116
    ds_read_b128 v[104:107], v117 offset:23552
    v_add_f32 v33, v33, v35
    v_smfmac_f32_16x16x64_bf16 v[40:43], v[12:15], a[112:119], v116
    ds_read_b128 v[108:111], v117 offset:23552
    v_mul_f32 v32, s34, v32
    v_smfmac_f32_16x16x64_bf16 v[40:43], v[24:27], a[144:151], v116
    buffer_load_dword v125, v119, s[8:11], s28 offen sc1
    v_mul_f32 v33, s34, v33
    v_smfmac_f32_16x16x64_bf16 v[40:43], v[28:31], a[176:183], v116
    ds_read_b128 v[0:3], v124
    v_add_f32 v36, v36, v38
    v_smfmac_f32_16x16x64_bf16 v[48:51], v[4:7], a[208:215], v116
    v_add_f32 v37, v37, v39
    v_smfmac_f32_16x16x64_bf16 v[52:55], v[4:7], a[216:223], v116
    s_waitcnt lgkmcnt(5)
    buffer_load_dwordx4 v117, s[8:11], s31 offen lds
    v_mul_f32 v36, s34, v36
    v_smfmac_f32_16x16x64_bf16 v[44:47], v[12:15], a[120:127], v116
    ds_read_b128 v[4:7], v124 offset:1024
    v_mul_f32 v37, s34, v37
    v_smfmac_f32_16x16x64_bf16 v[44:47], v[24:27], a[152:159], v116
    v_cvt_pk_bf16_f32 v34, v32, v36
    v_smfmac_f32_16x16x64_bf16 v[44:47], v[28:31], a[184:191], v116
    buffer_load_dwordx4 v117, s[8:11], s31 offen offset:1024 lds
    s_mov_b32 m0, 5120
    v_cvt_pk_bf16_f32 v35, v33, v37
    v_add_f32 v40, v40, v42
    v_smfmac_f32_16x16x64_bf16 v[48:51], v[8:11], a[224:231], v116
    ds_write2_b32 v120, v34, v35 offset0:32 offset1:48
    v_add_f32 v41, v41, v43
    v_smfmac_f32_16x16x64_bf16 v[52:55], v[8:11], a[232:239], v116
    v_add_f32 v44, v44, v46
    v_add_f32 v45, v45, v47
    v_cvt_pk_bf16_f32 v113, v40, v44
    v_cvt_pk_bf16_f32 v115, v41, v45
    v_smfmac_f32_16x16x64_bf16 v[48:51], v[12:15], a[240:247], v116
    ds_write2_b32 v120, v113, v115 offset0:0 offset1:16
    v_smfmac_f32_16x16x64_bf16 v[52:55], v[12:15], a[248:255], v116
    s_cmp_eq_u32 s22, 63
    s_cbranch_scc1 L_chain_last_s
    v_smfmac_f32_16x16x64_bf16 v[48:51], v[16:19], v[128:135], v116
    v_smfmac_f32_16x16x64_bf16 v[48:51], v[20:23], v[160:167], v116
    v_smfmac_f32_16x16x64_bf16 v[48:51], v[24:27], v[144:151], v116
    s_waitcnt lgkmcnt(0)
    s_barrier
    v_smfmac_f32_16x16x64_bf16 v[48:51], v[28:31], v[176:183], v116
    ds_read_b128 v[32:35], v121 offset:16384
    ds_read_b128 v[36:39], v121 offset:17408
    v_smfmac_f32_16x16x64_bf16 v[52:55], v[16:19], v[136:143], v116
    ds_read_b128 v[40:43], v121 offset:18432
    ds_read_b128 v[44:47], v121 offset:19456
    v_smfmac_f32_16x16x64_bf16 v[52:55], v[20:23], v[168:175], v116
    ds_read_b128 v[8:11], v124 offset:32768
    v_add_f32 v48, v48, v50
    v_smfmac_f32_16x16x64_bf16 v[52:55], v[24:27], v[152:159], v116
    ds_read_b128 v[12:15], v124 offset:33792
    v_add_f32 v49, v49, v51
    v_smfmac_f32_16x16x64_bf16 v[52:55], v[28:31], v[184:191], v116
    s_waitcnt lgkmcnt(5)
    v_cvt_pk_bf16_f32 v112, v48, v49
    v_mfma_f32_16x16x32_bf16 v[56:59], v[56:59], v[32:35], 0
    s_waitcnt lgkmcnt(4)
    v_mov_b32 v48, s50
    v_mov_b32 v49, s50
    v_mfma_f32_16x16x32_bf16 v[56:59], v[60:63], v[36:39], v[56:59]
    ds_read_b128 v[16:19], v124 offset:2048
    s_waitcnt lgkmcnt(4)
    v_mov_b32 v50, s50
    v_mov_b32 v51, s50
    v_mfma_f32_16x16x32_bf16 v[56:59], v[64:67], v[40:43], v[56:59]
    ds_read_b128 v[20:23], v124 offset:3072
    s_waitcnt lgkmcnt(4)
    v_add_f32 v52, v52, v54
    v_mfma_f32_16x16x32_bf16 v[56:59], v[68:71], v[44:47], v[56:59]
    ds_read_b128 v[24:27], v124 offset:4096
    v_add_f32 v53, v53, v55
    v_mfma_f32_16x16x32_bf16 v[60:63], v[72:75], v[32:35], 0
    ds_read_b128 v[28:31], v124 offset:5120
    v_cvt_pk_bf16_f32 v114, v52, v53
    v_mov_b32 v53, 0
    v_mfma_f32_16x16x32_bf16 v[60:63], v[76:79], v[36:39], v[60:63]
    v_exp_f32 v56, v56
    v_mfma_f32_16x16x32_bf16 v[60:63], v[80:83], v[40:43], v[60:63]
    v_exp_f32 v57, v57
    v_mfma_f32_16x16x32_bf16 v[60:63], v[84:87], v[44:47], v[60:63]
    v_exp_f32 v58, v58
    v_mfma_f32_16x16x32_bf16 v[64:67], v[32:35], v[32:35], 0
    v_exp_f32 v59, v59
    v_cvt_pk_bf16_f32 v68, v56, v57
    v_mfma_f32_16x16x32_bf16 v[64:67], v[36:39], v[36:39], v[64:67]
    v_exp_f32 v60, v60
    v_cvt_pk_bf16_f32 v69, v58, v59
    v_mfma_f32_16x16x32_bf16 v[64:67], v[40:43], v[40:43], v[64:67]
    v_exp_f32 v61, v61
    v_mfma_f32_16x16x32_bf16 v[64:67], v[44:47], v[44:47], v[64:67]
    v_exp_f32 v62, v62
    v_exp_f32 v63, v63
    v_cvt_pk_bf16_f32 v70, v60, v61
    v_cvt_pk_bf16_f32 v71, v62, v63
    s_nop 1
    v_mfma_f32_16x16x32_bf16 v[72:75], v[88:91], v[68:71], 0
    s_nop 0
    v_exp_f32 v64, v64
    v_mfma_f32_16x16x32_bf16 v[76:79], v[92:95], v[68:71], 0
    v_exp_f32 v65, v65
    v_mfma_f32_16x16x32_bf16 v[80:83], v[48:51], v[68:71], 0
    v_cvt_pk_bf16_f32 v52, v64, v65
    s_nop 1
    v_mfma_f32_16x16x16_bf16 v[72:75], v[112:113], v[52:53], v[72:75]
    ds_read_b128 v[32:35], v124 offset:6144
    v_mfma_f32_16x16x16_bf16 v[76:79], v[114:115], v[52:53], v[76:79]
    ds_read_b128 v[36:39], v124 offset:7168
    v_mfma_f32_16x16x16_bf16 v[80:83], v[48:49], v[52:53], v[80:83]
L_norm_66:
    s_mov_b64 vcc, s[36:37]
    v_mov_b32 v122, v122
    v_mov_b32 v122, v122
    v_mov_b32 v122, v122
    v_cndmask_b32_dpp v76, v72, v76, vcc quad_perm:[2,3,2,3] row_mask:0xf bank_mask:0xf
    v_cndmask_b32_dpp v77, v73, v77, vcc quad_perm:[2,3,2,3] row_mask:0xf bank_mask:0xf
    v_cndmask_b32_dpp v78, v74, v78, vcc quad_perm:[2,3,2,3] row_mask:0xf bank_mask:0xf
    v_cndmask_b32_dpp v79, v75, v79, vcc quad_perm:[2,3,2,3] row_mask:0xf bank_mask:0xf
    v_rcp_f32_dpp v84, v80 quad_perm:[2,3,2,3] row_mask:0xf bank_mask:0xf
    s_nop 0
    v_pk_mul_f32 v[76:77], v[76:77], v[84:85] op_sel_hi:[1,0]
    v_pk_mul_f32 v[78:79], v[78:79], v[84:85] op_sel_hi:[1,0]
    v_cvt_pk_bf16_f32 v72, v76, v77
    v_cvt_pk_bf16_f32 v73, v78, v79
    ds_write_b64 v122, v[72:73] offset:20992
    v_max_f32_dpp v86, v80, v84 quad_perm:[2,3,2,3] row_mask:0xf bank_mask:0xf
    v_mov_b32_dpp v60, v72 quad_perm:[0,1,0,1] row_mask:0xf bank_mask:0xf
    v_mov_b32_dpp v61, v73 quad_perm:[0,1,0,1] row_mask:0xf bank_mask:0xf
    v_cmp_lt_f32 vcc, s35, v86
    v_mov_b32_dpp v62, v72 quad_perm:[2,3,2,3] row_mask:0xf bank_mask:0xf
    v_mov_b32_dpp v63, v73 quad_perm:[2,3,2,3] row_mask:0xf bank_mask:0xf
    s_nop 1
    v_smfmac_f32_16x16x64_bf16 v[96:99], v[60:63], v[192:199], v116
    s_cbranch_vccnz L_smax_67
    v_smfmac_f32_16x16x64_bf16 v[100:103], v[60:63], v[224:231], v116
    s_waitcnt lgkmcnt(0)
    s_barrier
    ds_read_b128 v[92:95], v127 offset:20480
    ds_read_b128 v[80:83], v127 offset:22016
    ds_read_b128 v[84:87], v127 offset:21504
    v_smfmac_f32_16x16x64_bf16 v[104:107], v[60:63], v[0:7], v116
    ds_read_b128 v[40:43], v124 offset:34816
    v_smfmac_f32_16x16x64_bf16 v[108:111], v[60:63], v[8:15], v116
    ds_read_b128 v[56:59], v124 offset:36864
    s_waitcnt lgkmcnt(4)
    v_smfmac_f32_16x16x64_bf16 v[96:99], v[92:95], v[200:207], v116
    s_waitcnt lgkmcnt(3)
    v_smfmac_f32_16x16x64_bf16 v[96:99], v[80:83], v[208:215], v116
    ds_read_b128 v[44:47], v124 offset:35840
    s_waitcnt lgkmcnt(3)
    v_smfmac_f32_16x16x64_bf16 v[96:99], v[84:87], v[216:223], v116
    ds_read_b128 v[68:71], v124 offset:39936
    v_smfmac_f32_16x16x64_bf16 v[100:103], v[92:95], v[232:239], v116
    ds_read_b128 v[64:67], v124 offset:38912
    v_smfmac_f32_16x16x64_bf16 v[100:103], v[80:83], v[240:247], v116
    ds_read_b128 v[60:63], v124 offset:37888
    v_cvt_pk_bf16_f32 v72, v96, v98
    v_smfmac_f32_16x16x64_bf16 v[100:103], v[84:87], v[248:255], v116
    v_and_or_b32 v72, v72, -2, s33
    v_smfmac_f32_16x16x64_bf16 v[104:107], v[92:95], v[16:23], v116
    v_cvt_pk_bf16_f32 v74, v97, v99
    v_smfmac_f32_16x16x64_bf16 v[104:107], v[80:83], v[24:31], v116
    v_cvt_pk_bf16_f32 v73, v100, v102
    v_cvt_pk_bf16_f32 v75, v101, v103
    v_smfmac_f32_16x16x64_bf16 v[104:107], v[84:87], v[32:39], v116
    buffer_store_dwordx4 v[72:75], v118, s[8:11], s25 offen sc1
    s_waitcnt lgkmcnt(3)
    v_smfmac_f32_16x16x64_bf16 v[108:111], v[92:95], v[40:47], v116
    s_waitcnt lgkmcnt(0)
    v_smfmac_f32_16x16x64_bf16 v[108:111], v[80:83], v[56:63], v116
    v_cvt_pk_bf16_f32 v76, v104, v106
    v_smfmac_f32_16x16x64_bf16 v[108:111], v[84:87], v[64:71], v116
    v_and_or_b32 v76, v76, -2, s33
    v_cvt_pk_bf16_f32 v78, v105, v107
    v_mov_b32 v122, v122
    v_mov_b32 v122, v122
    v_mov_b32 v122, v122
    v_mov_b32 v122, v122
    v_mov_b32 v122, v122
    v_mov_b32 v122, v122
    v_cvt_pk_bf16_f32 v77, v108, v110
    v_cvt_pk_bf16_f32 v79, v109, v111
    buffer_store_dwordx4 v[76:79], v118, s[8:11], s26 offen sc1
    s_add_u32 s30, s30, 0x40000
    s_add_u32 s31, s31, 0x40000
    s_add_u32 s32, s32, 0x20000
    s_add_u32 s23, s24, 1024
    s_add_u32 s48, s23, 4096
    s_xor_b32 s25, s25, 0x40000
    s_xor_b32 s26, s26, 0x40000
    s_mov_b32 s35, 0x49800000
    s_add_u32 s22, s22, 1
    v_mov_b32 v32, 0
    v_mov_b32 v33, 0
    v_mov_b32 v34, 0
    v_mov_b32 v35, 0
    v_mov_b32 v36, 0
    v_mov_b32 v37, 0
    v_mov_b32 v38, 0
    v_mov_b32 v39, 0
    v_mov_b32 v40, 0
    v_mov_b32 v41, 0
    v_mov_b32 v42, 0
    v_mov_b32 v43, 0
    v_mov_b32 v44, 0
    v_mov_b32 v45, 0
    v_mov_b32 v46, 0
    v_mov_b32 v47, 0
    v_mov_b32 v48, 0
    v_mov_b32 v49, 0
    v_mov_b32 v50, 0
    v_mov_b32 v51, 0
    v_mov_b32 v52, 0
    v_mov_b32 v53, 0
    v_mov_b32 v54, 0
    v_mov_b32 v55, 0
    ds_read_b128 v[80:83], v123
    ds_read_b128 v[84:87], v123 offset:1024
    ds_read_b128 v[56:59], v123 offset:2048
    ds_read_b128 v[60:63], v123 offset:3072
    ds_read_b128 v[64:67], v123 offset:32768
    ds_read_b128 v[68:71], v123 offset:33792
    ds_read_b128 v[72:75], v123 offset:34816
    ds_read_b128 v[76:79], v123 offset:35840
    ds_read_b128 v[88:91], v123 offset:4096
    ds_read_b128 v[92:95], v123 offset:5120
    ds_read_b128 v[96:99], v123 offset:6144
    ds_read_b128 v[100:103], v123 offset:7168
    ds_read_b128 v[104:107], v123 offset:36864
    ds_read_b128 v[108:111], v123 offset:37888
    ds_read_b128 v[24:27], v123 offset:38912
    ds_read_b128 v[28:31], v123 offset:39936
    s_add_u32 s24, s24, 8192
    s_bitset0_b32 s24, 15
    s_xor_b32 s55, s24, 16384
    s_xor_b32 s29, s29, 0x40000
    s_xor_b32 s53, s29, 1024
    s_bfe_u32 s33, s22, 0x10001
    s_add_u32 s40, s22, 5
    s_lshr_b32 s40, s40, 2
    s_min_u32 s40, s40, 16
    s_bfm_b32 s58, s40, 0
    s_waitcnt vmcnt(4)
    v_cmp_eq_u32 vcc, 0, v125
    s_nop 0
    s_and_b64 vcc, vcc, s[58:59]
    s_cbranch_scc1 L_kvw_68
L_kvb_69:
    v_mov_b32 v15, 0
    s_nop 2
    v_mov_b32 v15, 0
    s_nop 2
    v_mov_b32 v15, 0
    s_nop 2
    v_mov_b32 v15, 0
    s_nop 2
    v_mov_b32 v15, 0
    s_nop 2
    v_mov_b32 v15, 0
    s_nop 2
    v_mov_b32 v15, 0
    s_nop 2
    v_mov_b32 v15, 0
    s_nop 2
    v_mov_b32 v15, 0
    s_nop 2
    v_mov_b32 v15, 0
    s_nop 2
    v_mov_b32 v15, 0
    s_nop 2
    v_mov_b32 v15, 0
    s_nop 2
    v_mov_b32 v15, 0
    s_nop 2
    v_mov_b32 v15, 0
    s_nop 2
    v_mov_b32 v15, 0
    s_nop 2
    v_mov_b32 v15, 0
    s_nop 2
    v_mov_b32 v15, 0
    s_nop 2
    v_mov_b32 v15, 0
    s_nop 2
    v_mov_b32 v15, 0
    s_nop 2
    v_mov_b32 v15, 0
    s_nop 2
    v_mov_b32 v15, 0
    s_nop 2
    v_mov_b32 v15, 0
    s_nop 2
    v_mov_b32 v15, 0
    s_nop 2
    v_mov_b32 v15, 0
    s_nop 2
    v_mov_b32 v15, 0
    s_nop 2
    v_mov_b32 v15, 0
    s_nop 2
    v_mov_b32 v15, 0
    s_nop 2
    v_mov_b32 v15, 0
    s_nop 2
    v_mov_b32 v15, 0
    s_nop 2
    v_mov_b32 v15, 0
    s_nop 2
    v_mov_b32 v15, 0
    s_nop 2
    s_waitcnt lgkmcnt(0)
    s_branch L_chain_top1_s
.p2align 6
L_chain_top2_s:
    buffer_load_dwordx4 v[0:3], v117, s[8:11], s23 offen sc1
    v_mov_b32 v48, 0
    v_mov_b32 v49, 0
    v_mov_b32 v50, 0
    v_mov_b32 v51, 0
    v_mov_b32 v52, 0
    v_mov_b32 v53, 0
    v_mov_b32 v15, 0
    v_mov_b32 v15, 0
    v_mov_b32 v15, 0
    v_mov_b32 v15, 0
    v_mov_b32 v15, 0
    v_mov_b32 v15, 0
    v_mov_b32 v15, 0
    v_mov_b32 v15, 0
    v_mov_b32 v15, 0
    v_mov_b32 v15, 0
    buffer_load_dwordx4 v[0:3], v117, s[8:11], s23 offen sc1
    v_mov_b32 v15, 0
    v_mov_b32 v15, 0
    v_mov_b32 v15, 0
    v_mov_b32 v15, 0
    v_mov_b32 v15, 0
    v_mov_b32 v15, 0
    v_mov_b32 v15, 0
    v_mov_b32 v15, 0
    v_mov_b32 v15, 0
    v_mov_b32 v15, 0
    v_mov_b32 v15, 0
    v_mov_b32 v15, 0
    v_mov_b32 v15, 0
    v_mov_b32 v15, 0
    v_mov_b32 v15, 0
    v_mov_b32 v15, 0
L_mret_70:
    buffer_load_dwordx4 v[0:3], v117, s[8:11], s23 offen sc1
    s_add_u32 s45, s45, 1
    s_cmp_lt_u32 s45, 0x10000
    s_cselect_b32 s56, -2, -1
    s_nop 3
    v_mov_b32 v32, 0
    v_mov_b32 v33, 0
    v_mov_b32 v34, 0
    v_mov_b32 v35, 0
    s_waitcnt vmcnt(2)
    v_max3_u32 v15, v0, v1, v2
    v_max_u32 v15, v15, v3
    v_cmp_lt_u32 vcc, s56, v15
    v_smfmac_f32_16x16x64_bf16 v[32:35], v[0:3], v[80:87], v116
    s_cbranch_vccnz L_mret_70
    ds_write_b128 v117, v[0:3] offset:2048
    v_smfmac_f32_16x16x64_bf16 v[36:39], v[0:3], v[56:63], v116
    buffer_load_dwordx4 v[4:7], v117, s[8:11], s48 offen sc1
    v_smfmac_f32_16x16x64_bf16 v[40:43], v[0:3], v[64:71], v116
    buffer_load_dwordx4 v117, s[8:11], s48 offen sc1 lds
    s_mov_b32 m0, 12288
    v_smfmac_f32_16x16x64_bf16 v[44:47], v[0:3], v[72:79], v116
    s_waitcnt lgkmcnt(0)
    s_barrier
    ds_read_b128 v[8:11], v117 offset:3072
    v_smfmac_f32_16x16x64_bf16 v[48:51], v[0:3], a[192:199], v116
    ds_read_b128 v[16:19], v117
    ds_read_b128 v[20:23], v117 offset:1024
    v_smfmac_f32_16x16x64_bf16 v[52:55], v[0:3], a[200:207], v116
    ds_read_b128 v[80:83], v117 offset:14336
    s_waitcnt lgkmcnt(3)
    v_smfmac_f32_16x16x64_bf16 v[32:35], v[8:11], a[0:7], v116
    ds_read_b128 v[84:87], v117 offset:15360
    v_smfmac_f32_16x16x64_bf16 v[36:39], v[8:11], a[8:15], v116
    ds_read_b128 v[56:59], v117 offset:8192
    s_waitcnt lgkmcnt(4)
    v_smfmac_f32_16x16x64_bf16 v[32:35], v[16:19], a[32:39], v116
    ds_read_b128 v[60:63], v117 offset:9216
    v_smfmac_f32_16x16x64_bf16 v[36:39], v[16:19], a[40:47], v116
    ds_read_b128 v[64:67], v117 offset:10240
    s_waitcnt lgkmcnt(5)
    v_smfmac_f32_16x16x64_bf16 v[32:35], v[20:23], a[64:71], v116
    ds_read_b128 v[68:71], v117 offset:11264
    v_smfmac_f32_16x16x64_bf16 v[36:39], v[20:23], a[72:79], v116
    buffer_store_dwordx4 v[112:115], v117, s[8:11], s32 offen sc1
    v_smfmac_f32_16x16x64_bf16 v[40:43], v[8:11], a[96:103], v116
    ds_read_b128 v[72:75], v117 offset:12288
    v_smfmac_f32_16x16x64_bf16 v[40:43], v[16:19], a[128:135], v116
    ds_read_b128 v[76:79], v117 offset:13312
    v_smfmac_f32_16x16x64_bf16 v[40:43], v[20:23], a[160:167], v116
    s_waitcnt vmcnt(2)
    v_max3_u32 v15, v4, v5, v6
    v_smfmac_f32_16x16x64_bf16 v[44:47], v[8:11], a[104:111], v116
    v_max_u32 v15, v15, v7
    v_smfmac_f32_16x16x64_bf16 v[44:47], v[16:19], a[136:143], v116
    s_waitcnt vmcnt(1) lgkmcnt(0)
    v_cmp_lt_u32 vcc, s56, v15
    v_smfmac_f32_16x16x64_bf16 v[44:47], v[20:23], a[168:175], v116
    s_cbranch_vccnz L_mret_71
L_mgo_72:
    v_smfmac_f32_16x16x64_bf16 v[44:47], v[4:7], v[24:31], v116
    s_barrier
    ds_read_b128 v[12:15], v117 offset:7168
    v_smfmac_f32_16x16x64_bf16 v[32:35], v[4:7], v[88:95], v116
    ds_read_b128 v[24:27], v117 offset:4096
    v_smfmac_f32_16x16x64_bf16 v[36:39], v[4:7], v[96:103], v116
    ds_read_b128 v[28:31], v117 offset:5120
    v_smfmac_f32_16x16x64_bf16 v[40:43], v[4:7], v[104:111], v116
    ds_read_b128 v[88:91], v117 offset:28672
    s_waitcnt lgkmcnt(3)
    v_smfmac_f32_16x16x64_bf16 v[32:35], v[12:15], a[16:23], v116
    ds_read_b128 v[92:95], v117 offset:29696
    s_waitcnt lgkmcnt(3)
    v_smfmac_f32_16x16x64_bf16 v[32:35], v[24:27], a[48:55], v116
    buffer_load_dwordx4 v117, s[8:11], s30 offen lds
    s_waitcnt lgkmcnt(2)
    v_smfmac_f32_16x16x64_bf16 v[32:35], v[28:31], a[80:87], v116
    ds_read_b128 v[96:99], v117 offset:23552
    v_smfmac_f32_16x16x64_bf16 v[36:39], v[12:15], a[24:31], v116
    ds_read_b128 v[100:103], v117 offset:23552
    v_smfmac_f32_16x16x64_bf16 v[36:39], v[24:27], a[56:63], v116
    buffer_load_dwordx4 v117, s[8:11], s30 offen offset:1024 lds
    s_add_u32 m0, s52, 0x6000
    v_add_f32 v32, v32, v34
    v_smfmac_f32_16x16x64_bf16 v[36:39], v[28:31], a[88:95], v116
    ds_read_b128 v[104:107], v117 offset:23552
    v_add_f32 v33, v33, v35
    v_smfmac_f32_16x16x64_bf16 v[40:43], v[12:15], a[112:119], v116
    ds_read_b128 v[108:111], v117 offset:23552
    v_mul_f32 v32, s34, v32
    v_smfmac_f32_16x16x64_bf16 v[40:43], v[24:27], a[144:151], v116
    s_waitcnt lgkmcnt(4)
    buffer_load_dwordx4 v117, s[8:11], s31 offen lds
    v_mul_f32 v33, s34, v33
    v_smfmac_f32_16x16x64_bf16 v[40:43], v[28:31], a[176:183], v116
    ds_read_b128 v[0:3], v124
    v_add_f32 v36, v36, v38
    v_smfmac_f32_16x16x64_bf16 v[48:51], v[4:7], a[208:215], v116
    v_add_f32 v37, v37, v39
    v_smfmac_f32_16x16x64_bf16 v[52:55], v[4:7], a[216:223], v116
    buffer_load_dwordx4 v117, s[8:11], s31 offen offset:1024 lds
    s_mov_b32 m0, 6144
    v_mul_f32 v36, s34, v36
    v_smfmac_f32_16x16x64_bf16 v[44:47], v[12:15], a[120:127], v116
    ds_read_b128 v[4:7], v124 offset:1024
    v_mul_f32 v37, s34, v37
    v_smfmac_f32_16x16x64_bf16 v[44:47], v[24:27], a[152:159], v116
    v_cvt_pk_bf16_f32 v34, v32, v36
    v_smfmac_f32_16x16x64_bf16 v[44:47], v[28:31], a[184:191], v116
    v_cvt_pk_bf16_f32 v35, v33, v37
    v_add_f32 v40, v40, v42
    v_smfmac_f32_16x16x64_bf16 v[48:51], v[8:11], a[224:231], v116
    ds_write2_b32 v120, v34, v35 offset0:32 offset1:48
    v_add_f32 v41, v41, v43
    v_smfmac_f32_16x16x64_bf16 v[52:55], v[8:11], a[232:239], v116
    v_add_f32 v44, v44, v46
    v_add_f32 v45, v45, v47
    v_cvt_pk_bf16_f32 v113, v40, v44
    v_cvt_pk_bf16_f32 v115, v41, v45
    v_smfmac_f32_16x16x64_bf16 v[48:51], v[12:15], a[240:247], v116
    ds_write2_b32 v120, v113, v115 offset0:0 offset1:16
    v_smfmac_f32_16x16x64_bf16 v[52:55], v[12:15], a[248:255], v116
    s_cmp_eq_u32 s22, 63
    s_cbranch_scc1 L_chain_last_s
    v_smfmac_f32_16x16x64_bf16 v[48:51], v[16:19], v[128:135], v116
    buffer_store_dword v126, v119, s[8:11], s55 offen sc1
    v_smfmac_f32_16x16x64_bf16 v[48:51], v[20:23], v[160:167], v116
    v_smfmac_f32_16x16x64_bf16 v[48:51], v[24:27], v[144:151], v116
    s_waitcnt lgkmcnt(0)
    s_barrier
    v_smfmac_f32_16x16x64_bf16 v[48:51], v[28:31], v[176:183], v116
    ds_read_b128 v[32:35], v121 offset:16384
    ds_read_b128 v[36:39], v121 offset:17408
    v_smfmac_f32_16x16x64_bf16 v[52:55], v[16:19], v[136:143], v116
    ds_read_b128 v[40:43], v121 offset:18432
    ds_read_b128 v[44:47], v121 offset:19456
    v_smfmac_f32_16x16x64_bf16 v[52:55], v[20:23], v[168:175], v116
    ds_read_b128 v[8:11], v124 offset:32768
    v_add_f32 v48, v48, v50
    v_smfmac_f32_16x16x64_bf16 v[52:55], v[24:27], v[152:159], v116
    ds_read_b128 v[12:15], v124 offset:33792
    v_add_f32 v49, v49, v51
    v_smfmac_f32_16x16x64_bf16 v[52:55], v[28:31], v[184:191], v116
    s_waitcnt lgkmcnt(5)
    v_cvt_pk_bf16_f32 v112, v48, v49
    v_mfma_f32_16x16x32_bf16 v[56:59], v[56:59], v[32:35], 0
    s_waitcnt lgkmcnt(4)
    v_mov_b32 v48, s50
    v_mov_b32 v49, s50
    v_mfma_f32_16x16x32_bf16 v[56:59], v[60:63], v[36:39], v[56:59]
    ds_read_b128 v[16:19], v124 offset:2048
    s_waitcnt lgkmcnt(4)
    v_mov_b32 v50, s50
    v_mov_b32 v51, s50
    v_mfma_f32_16x16x32_bf16 v[56:59], v[64:67], v[40:43], v[56:59]
    ds_read_b128 v[20:23], v124 offset:3072
    s_waitcnt lgkmcnt(4)
    v_add_f32 v52, v52, v54
    v_mfma_f32_16x16x32_bf16 v[56:59], v[68:71], v[44:47], v[56:59]
    ds_read_b128 v[24:27], v124 offset:4096
    v_add_f32 v53, v53, v55
    v_mfma_f32_16x16x32_bf16 v[60:63], v[72:75], v[32:35], 0
    ds_read_b128 v[28:31], v124 offset:5120
    v_cvt_pk_bf16_f32 v114, v52, v53
    v_mov_b32 v53, 0
    v_mfma_f32_16x16x32_bf16 v[60:63], v[76:79], v[36:39], v[60:63]
    v_exp_f32 v56, v56
    v_mfma_f32_16x16x32_bf16 v[60:63], v[80:83], v[40:43], v[60:63]
    v_exp_f32 v57, v57
    v_mfma_f32_16x16x32_bf16 v[60:63], v[84:87], v[44:47], v[60:63]
    v_exp_f32 v58, v58
    v_mfma_f32_16x16x32_bf16 v[64:67], v[32:35], v[32:35], 0
    v_exp_f32 v59, v59
    v_cvt_pk_bf16_f32 v68, v56, v57
    v_mfma_f32_16x16x32_bf16 v[64:67], v[36:39], v[36:39], v[64:67]
    v_exp_f32 v60, v60
    v_cvt_pk_bf16_f32 v69, v58, v59
    v_mfma_f32_16x16x32_bf16 v[64:67], v[40:43], v[40:43], v[64:67]
    v_exp_f32 v61, v61
    v_mfma_f32_16x16x32_bf16 v[64:67], v[44:47], v[44:47], v[64:67]
    v_exp_f32 v62, v62
    v_exp_f32 v63, v63
    v_cvt_pk_bf16_f32 v70, v60, v61
    v_cvt_pk_bf16_f32 v71, v62, v63
    s_nop 1
    v_mfma_f32_16x16x32_bf16 v[72:75], v[88:91], v[68:71], 0
    s_nop 0
    v_exp_f32 v64, v64
    v_mfma_f32_16x16x32_bf16 v[76:79], v[92:95], v[68:71], 0
    v_exp_f32 v65, v65
    v_mfma_f32_16x16x32_bf16 v[80:83], v[48:51], v[68:71], 0
    v_cvt_pk_bf16_f32 v52, v64, v65
    s_nop 1
    v_mfma_f32_16x16x16_bf16 v[72:75], v[112:113], v[52:53], v[72:75]
    ds_read_b128 v[32:35], v124 offset:6144
    v_mfma_f32_16x16x16_bf16 v[76:79], v[114:115], v[52:53], v[76:79]
    ds_read_b128 v[36:39], v124 offset:7168
    v_mfma_f32_16x16x16_bf16 v[80:83], v[48:49], v[52:53], v[80:83]
L_norm_73:
    s_mov_b64 vcc, s[36:37]
    v_mov_b32 v122, v122
    v_mov_b32 v122, v122
    v_mov_b32 v122, v122
    v_cndmask_b32_dpp v76, v72, v76, vcc quad_perm:[2,3,2,3] row_mask:0xf bank_mask:0xf
    v_cndmask_b32_dpp v77, v73, v77, vcc quad_perm:[2,3,2,3] row_mask:0xf bank_mask:0xf
    v_cndmask_b32_dpp v78, v74, v78, vcc quad_perm:[2,3,2,3] row_mask:0xf bank_mask:0xf
    v_cndmask_b32_dpp v79, v75, v79, vcc quad_perm:[2,3,2,3] row_mask:0xf bank_mask:0xf
    v_rcp_f32_dpp v84, v80 quad_perm:[2,3,2,3] row_mask:0xf bank_mask:0xf
    s_nop 0
    v_pk_mul_f32 v[76:77], v[76:77], v[84:85] op_sel_hi:[1,0]
    v_pk_mul_f32 v[78:79], v[78:79], v[84:85] op_sel_hi:[1,0]
    v_cvt_pk_bf16_f32 v72, v76, v77
    v_cvt_pk_bf16_f32 v73, v78, v79
    ds_write_b64 v122, v[72:73] offset:21504
    v_max_f32_dpp v86, v80, v84 quad_perm:[2,3,2,3] row_mask:0xf bank_mask:0xf
    v_mov_b32_dpp v60, v72 quad_perm:[0,1,0,1] row_mask:0xf bank_mask:0xf
    v_mov_b32_dpp v61, v73 quad_perm:[0,1,0,1] row_mask:0xf bank_mask:0xf
    v_cmp_lt_f32 vcc, s35, v86
    v_mov_b32_dpp v62, v72 quad_perm:[2,3,2,3] row_mask:0xf bank_mask:0xf
    v_mov_b32_dpp v63, v73 quad_perm:[2,3,2,3] row_mask:0xf bank_mask:0xf
    s_nop 1
    v_smfmac_f32_16x16x64_bf16 v[96:99], v[60:63], v[192:199], v116
    s_cbranch_vccnz L_smax_74
    v_smfmac_f32_16x16x64_bf16 v[100:103], v[60:63], v[224:231], v116
    s_waitcnt lgkmcnt(0)
    s_barrier
    ds_read_b128 v[92:95], v127 offset:22016
    ds_read_b128 v[80:83], v127 offset:20480
    ds_read_b128 v[84:87], v127 offset:20992
    v_smfmac_f32_16x16x64_bf16 v[104:107], v[60:63], v[0:7], v116
    ds_read_b128 v[40:43], v124 offset:34816
    v_smfmac_f32_16x16x64_bf16 v[108:111], v[60:63], v[8:15], v116
    ds_read_b128 v[56:59], v124 offset:36864
    s_waitcnt lgkmcnt(4)
    v_smfmac_f32_16x16x64_bf16 v[96:99], v[92:95], v[200:207], v116
    s_waitcnt lgkmcnt(3)
    v_smfmac_f32_16x16x64_bf16 v[96:99], v[80:83], v[208:215], v116
    ds_read_b128 v[44:47], v124 offset:35840
    s_waitcnt lgkmcnt(3)
    v_smfmac_f32_16x16x64_bf16 v[96:99], v[84:87], v[216:223], v116
    ds_read_b128 v[68:71], v124 offset:39936
    v_smfmac_f32_16x16x64_bf16 v[100:103], v[92:95], v[232:239], v116
    ds_read_b128 v[64:67], v124 offset:38912
    v_smfmac_f32_16x16x64_bf16 v[100:103], v[80:83], v[240:247], v116
    ds_read_b128 v[60:63], v124 offset:37888
    v_cvt_pk_bf16_f32 v72, v96, v98
    v_smfmac_f32_16x16x64_bf16 v[100:103], v[84:87], v[248:255], v116
    v_and_or_b32 v72, v72, -2, s33
    v_smfmac_f32_16x16x64_bf16 v[104:107], v[92:95], v[16:23], v116
    v_cvt_pk_bf16_f32 v74, v97, v99
    v_smfmac_f32_16x16x64_bf16 v[104:107], v[80:83], v[24:31], v116
    v_cvt_pk_bf16_f32 v73, v100, v102
    v_cvt_pk_bf16_f32 v75, v101, v103
    v_smfmac_f32_16x16x64_bf16 v[104:107], v[84:87], v[32:39], v116
    buffer_store_dwordx4 v[72:75], v118, s[8:11], s25 offen sc1
    s_waitcnt lgkmcnt(3)
    v_smfmac_f32_16x16x64_bf16 v[108:111], v[92:95], v[40:47], v116
    s_waitcnt lgkmcnt(0)
    v_smfmac_f32_16x16x64_bf16 v[108:111], v[80:83], v[56:63], v116
    v_cvt_pk_bf16_f32 v76, v104, v106
    v_smfmac_f32_16x16x64_bf16 v[108:111], v[84:87], v[64:71], v116
    v_and_or_b32 v76, v76, -2, s33
    v_cvt_pk_bf16_f32 v78, v105, v107
    v_mov_b32 v122, v122
    v_mov_b32 v122, v122
    v_mov_b32 v122, v122
    v_mov_b32 v122, v122
    v_mov_b32 v122, v122
    v_mov_b32 v122, v122
    v_cvt_pk_bf16_f32 v77, v108, v110
    v_cvt_pk_bf16_f32 v79, v109, v111
    buffer_store_dwordx4 v[76:79], v118, s[8:11], s26 offen sc1
    ds_read_b128 v[80:83], v123
    ds_read_b128 v[84:87], v123 offset:1024
    ds_read_b128 v[56:59], v123 offset:2048
    ds_read_b128 v[60:63], v123 offset:3072
    ds_read_b128 v[64:67], v123 offset:32768
    ds_read_b128 v[68:71], v123 offset:33792
    ds_read_b128 v[72:75], v123 offset:34816
    ds_read_b128 v[76:79], v123 offset:35840
    ds_read_b128 v[88:91], v123 offset:4096
    ds_read_b128 v[92:95], v123 offset:5120
    ds_read_b128 v[96:99], v123 offset:6144
    ds_read_b128 v[100:103], v123 offset:7168
    ds_read_b128 v[104:107], v123 offset:36864
    ds_read_b128 v[108:111], v123 offset:37888
    ds_read_b128 v[24:27], v123 offset:38912
    ds_read_b128 v[28:31], v123 offset:39936
    s_add_u32 s30, s30, 0x40000
    s_add_u32 s31, s31, 0x40000
    s_add_u32 s32, s32, 0x20000
    s_add_u32 s23, s24, 2048
    s_add_u32 s48, s23, 4096
    s_xor_b32 s25, s25, 0x40000
    s_xor_b32 s26, s26, 0x40000
    s_mov_b32 s35, 0x49800000
    s_add_u32 s22, s22, 1
    v_cndmask_b32 v12, 0, v125, s[68:69]
    v_cndmask_b32 v13, 0, v125, s[70:71]
    v_cndmask_b32 v14, 0, v125, s[72:73]
    v_cndmask_b32 v15, 0, v125, s[74:75]
    v_mov_b32 v32, 0
    v_mov_b32 v33, 0
    v_mov_b32 v34, 0
    v_mov_b32 v35, 0
    v_mov_b32 v36, 0
    v_mov_b32 v37, 0
    v_mov_b32 v38, 0
    v_mov_b32 v39, 0
    v_mov_b32 v40, 0
    v_mov_b32 v41, 0
    v_mov_b32 v42, 0
    v_mov_b32 v43, 0
    v_mov_b32 v44, 0
    v_mov_b32 v45, 0
    v_mov_b32 v46, 0
    v_mov_b32 v47, 0
    v_mov_b32 v54, 0
    v_mov_b32 v55, 0
    v_mov_b32 v52, 0
    v_mov_b32 v52, 0
    v_mov_b32 v52, 0
    v_mov_b32 v52, 0
    v_mov_b32 v52, 0
    v_mov_b32 v52, 0
    v_mov_b32 v52, 0
    v_mov_b32 v52, 0
    v_mov_b32 v52, 0
    v_mov_b32 v52, 0
    v_mov_b32 v52, 0
    v_mov_b32 v52, 0
    v_mov_b32 v52, 0
    buffer_load_dwordx4 v[4:7], v117, s[8:11], s29 offen sc1
    buffer_load_dwordx4 v[8:11], v117, s[8:11], s53 offen sc1
    buffer_load_dwordx4 v[16:19], v117, s[8:11], s29 offen offset:2048 sc1
    buffer_load_dwordx4 v[20:23], v117, s[8:11], s53 offen offset:2048 sc1
    v_mov_b32 v52, 0
    s_waitcnt vmcnt(3)
L_rl_75:
    v_mfma_f32_16x16x32_bf16 v[48:51], v[4:7], v[12:15], 0
    v_xor_b32 v52, s33, v4
    s_waitcnt vmcnt(2)
    v_mfma_f32_16x16x32_bf16 v[48:51], v[8:11], v[12:15], v[48:51]
    v_xor_b32 v53, s33, v8
    v_or_b32 v52, v52, v53
    s_waitcnt vmcnt(1)
    v_mfma_f32_16x16x32_bf16 v[48:51], v[16:19], v[12:15], v[48:51]
    v_xor_b32 v53, s33, v16
    v_or_b32 v52, v52, v53
    s_waitcnt vmcnt(0)
    v_mfma_f32_16x16x32_bf16 v[48:51], v[20:23], v[12:15], v[48:51]
    v_xor_b32 v53, s33, v20
    v_or_b32 v52, v52, v53
    v_and_b32 v52, 1, v52
    v_cmp_ne_u32 vcc, 0, v52
    s_cbranch_vccnz L_rslow_76
L_rgo_77:
    s_nop 2
    v_permlane32_swap_b32 v48, v50
    v_permlane32_swap_b32 v49, v51
    v_pk_add_f32 v[48:49], v[48:49], v[50:51]
    s_mov_b64 exec, s[38:39]
    v_cvt_pk_bf16_f32 v12, v48, v49
    v_min_u32 v12, 0xfffffffe, v12
    buffer_store_dword v12, v119, s[8:11], s24 offen sc1
    s_mov_b64 exec, -1
    s_add_u32 s24, s24, 8192
    s_bitset0_b32 s24, 15
    s_xor_b32 s55, s24, 16384
    s_xor_b32 s29, s29, 0x40000
    s_xor_b32 s53, s29, 1024
    s_bfe_u32 s33, s22, 0x10001
    s_waitcnt lgkmcnt(0)
    s_branch L_chain_top2_s
.p2align 6
L_chain_top3_s:
    buffer_load_dwordx4 v[0:3], v117, s[8:11], s23 offen sc1
    v_mov_b32 v48, 0
    v_mov_b32 v49, 0
    v_mov_b32 v50, 0
    v_mov_b32 v51, 0
    v_mov_b32 v52, 0
    v_mov_b32 v53, 0
    v_mov_b32 v15, 0
    v_mov_b32 v15, 0
    v_mov_b32 v15, 0
    v_mov_b32 v15, 0
    v_mov_b32 v15, 0
    v_mov_b32 v15, 0
    v_mov_b32 v15, 0
    v_mov_b32 v15, 0
    v_mov_b32 v15, 0
    v_mov_b32 v15, 0
    buffer_load_dwordx4 v[0:3], v117, s[8:11], s23 offen sc1
    v_mov_b32 v15, 0
    v_mov_b32 v15, 0
    v_mov_b32 v15, 0
    v_mov_b32 v15, 0
    v_mov_b32 v15, 0
    v_mov_b32 v15, 0
    v_mov_b32 v15, 0
    v_mov_b32 v15, 0
    v_mov_b32 v15, 0
    v_mov_b32 v15, 0
    v_mov_b32 v15, 0
    v_mov_b32 v15, 0
    v_mov_b32 v15, 0
    v_mov_b32 v15, 0
    v_mov_b32 v15, 0
    v_mov_b32 v15, 0
L_mret_78:
    buffer_load_dwordx4 v[0:3], v117, s[8:11], s23 offen sc1
    s_add_u32 s45, s45, 1
    s_cmp_lt_u32 s45, 0x10000
    s_cselect_b32 s56, -2, -1
    s_nop 3
    v_mov_b32 v32, 0
    v_mov_b32 v33, 0
    v_mov_b32 v34, 0
    v_mov_b32 v35, 0
    s_waitcnt vmcnt(2)
    v_max3_u32 v15, v0, v1, v2
    v_max_u32 v15, v15, v3
    v_cmp_lt_u32 vcc, s56, v15
    v_smfmac_f32_16x16x64_bf16 v[32:35], v[0:3], v[80:87], v116
    s_cbranch_vccnz L_mret_78
    ds_write_b128 v117, v[0:3] offset:3072
    v_smfmac_f32_16x16x64_bf16 v[36:39], v[0:3], v[56:63], v116
    buffer_load_dwordx4 v[4:7], v117, s[8:11], s48 offen sc1
    v_smfmac_f32_16x16x64_bf16 v[40:43], v[0:3], v[64:71], v116
    buffer_load_dwordx4 v117, s[8:11], s48 offen sc1 lds
    s_mov_b32 m0, 14336
    v_smfmac_f32_16x16x64_bf16 v[44:47], v[0:3], v[72:79], v116
    s_waitcnt lgkmcnt(0)
    s_barrier
    ds_read_b128 v[8:11], v117 offset:2048
    v_smfmac_f32_16x16x64_bf16 v[48:51], v[0:3], a[192:199], v116
    ds_read_b128 v[16:19], v117 offset:1024
    ds_read_b128 v[20:23], v117
    v_smfmac_f32_16x16x64_bf16 v[52:55], v[0:3], a[200:207], v116
    ds_read_b128 v[80:83], v117 offset:14336
    s_waitcnt lgkmcnt(3)
    v_smfmac_f32_16x16x64_bf16 v[32:35], v[8:11], a[0:7], v116
    ds_read_b128 v[84:87], v117 offset:15360
    v_smfmac_f32_16x16x64_bf16 v[36:39], v[8:11], a[8:15], v116
    ds_read_b128 v[56:59], v117 offset:8192
    s_waitcnt lgkmcnt(4)
    v_smfmac_f32_16x16x64_bf16 v[32:35], v[16:19], a[32:39], v116
    ds_read_b128 v[60:63], v117 offset:9216
    v_smfmac_f32_16x16x64_bf16 v[36:39], v[16:19], a[40:47], v116
    ds_read_b128 v[64:67], v117 offset:10240
    s_waitcnt lgkmcnt(5)
    v_smfmac_f32_16x16x64_bf16 v[32:35], v[20:23], a[64:71], v116
    ds_read_b128 v[68:71], v117 offset:11264
    v_smfmac_f32_16x16x64_bf16 v[36:39], v[20:23], a[72:79], v116
    ds_read_b128 v[72:75], v117 offset:12288
    v_smfmac_f32_16x16x64_bf16 v[40:43], v[8:11], a[96:103], v116
    ds_read_b128 v[76:79], v117 offset:13312
    v_smfmac_f32_16x16x64_bf16 v[40:43], v[16:19], a[128:135], v116
    buffer_store_dwordx4 v[112:115], v117, s[8:11], s32 offen sc1
    v_smfmac_f32_16x16x64_bf16 v[40:43], v[20:23], a[160:167], v116
    s_waitcnt vmcnt(2)
    v_max3_u32 v15, v4, v5, v6
    v_smfmac_f32_16x16x64_bf16 v[44:47], v[8:11], a[104:111], v116
    v_max_u32 v15, v15, v7
    v_smfmac_f32_16x16x64_bf16 v[44:47], v[16:19], a[136:143], v116
    s_waitcnt vmcnt(1) lgkmcnt(0)
    v_cmp_lt_u32 vcc, s56, v15
    v_smfmac_f32_16x16x64_bf16 v[44:47], v[20:23], a[168:175], v116
    s_cbranch_vccnz L_mret_79
L_mgo_80:
    v_smfmac_f32_16x16x64_bf16 v[44:47], v[4:7], v[24:31], v116
    s_barrier
    ds_read_b128 v[12:15], v117 offset:6144
    v_smfmac_f32_16x16x64_bf16 v[32:35], v[4:7], v[88:95], v116
    ds_read_b128 v[24:27], v117 offset:5120
    v_smfmac_f32_16x16x64_bf16 v[36:39], v[4:7], v[96:103], v116
    ds_read_b128 v[28:31], v117 offset:4096
    v_smfmac_f32_16x16x64_bf16 v[40:43], v[4:7], v[104:111], v116
    ds_read_b128 v[88:91], v117 offset:30720
    s_waitcnt lgkmcnt(3)
    v_smfmac_f32_16x16x64_bf16 v[32:35], v[12:15], a[16:23], v116
    ds_read_b128 v[92:95], v117 offset:31744
    s_waitcnt lgkmcnt(3)
    v_smfmac_f32_16x16x64_bf16 v[32:35], v[24:27], a[48:55], v116
    ds_read_b128 v[96:99], v117 offset:23552
    s_waitcnt lgkmcnt(3)
    v_smfmac_f32_16x16x64_bf16 v[32:35], v[28:31], a[80:87], v116
    buffer_load_dwordx4 v117, s[8:11], s30 offen lds
    v_smfmac_f32_16x16x64_bf16 v[36:39], v[12:15], a[24:31], v116
    ds_read_b128 v[100:103], v117 offset:23552
    v_smfmac_f32_16x16x64_bf16 v[36:39], v[24:27], a[56:63], v116
    ds_read_b128 v[104:107], v117 offset:23552
    v_add_f32 v32, v32, v34
    v_smfmac_f32_16x16x64_bf16 v[36:39], v[28:31], a[88:95], v116
    buffer_load_dwordx4 v117, s[8:11], s30 offen offset:1024 lds
    s_add_u32 m0, s52, 0x6000
    v_add_f32 v33, v33, v35
    v_smfmac_f32_16x16x64_bf16 v[40:43], v[12:15], a[112:119], v116
    ds_read_b128 v[108:111], v117 offset:23552
    v_mul_f32 v32, s34, v32
    v_smfmac_f32_16x16x64_bf16 v[40:43], v[24:27], a[144:151], v116
    ds_read_b128 v[0:3], v124
    v_mul_f32 v33, s34, v33
    v_smfmac_f32_16x16x64_bf16 v[40:43], v[28:31], a[176:183], v116
    s_waitcnt lgkmcnt(5)
    buffer_load_dwordx4 v117, s[8:11], s31 offen lds
    v_add_f32 v36, v36, v38
    v_smfmac_f32_16x16x64_bf16 v[48:51], v[4:7], a[208:215], v116
    v_add_f32 v37, v37, v39
    v_smfmac_f32_16x16x64_bf16 v[52:55], v[4:7], a[216:223], v116
    ds_read_b128 v[4:7], v124 offset:1024
    v_mul_f32 v36, s34, v36
    v_smfmac_f32_16x16x64_bf16 v[44:47], v[12:15], a[120:127], v116
    buffer_load_dwordx4 v117, s[8:11], s31 offen offset:1024 lds
    s_mov_b32 m0, 7168
    v_mul_f32 v37, s34, v37
    v_smfmac_f32_16x16x64_bf16 v[44:47], v[24:27], a[152:159], v116
    v_cvt_pk_bf16_f32 v34, v32, v36
    v_smfmac_f32_16x16x64_bf16 v[44:47], v[28:31], a[184:191], v116
    v_cvt_pk_bf16_f32 v35, v33, v37
    v_add_f32 v40, v40, v42
    v_smfmac_f32_16x16x64_bf16 v[48:51], v[8:11], a[224:231], v116
    ds_write2_b32 v120, v34, v35 offset0:32 offset1:48
    v_add_f32 v41, v41, v43
    v_smfmac_f32_16x16x64_bf16 v[52:55], v[8:11], a[232:239], v116
    v_add_f32 v44, v44, v46
    v_add_f32 v45, v45, v47
    v_cvt_pk_bf16_f32 v113, v40, v44
    v_cvt_pk_bf16_f32 v115, v41, v45
    v_smfmac_f32_16x16x64_bf16 v[48:51], v[12:15], a[240:247], v116
    ds_write2_b32 v120, v113, v115 offset0:0 offset1:16
    v_smfmac_f32_16x16x64_bf16 v[52:55], v[12:15], a[248:255], v116
    s_cmp_eq_u32 s22, 63
    s_cbranch_scc1 L_chain_last_s
    v_smfmac_f32_16x16x64_bf16 v[48:51], v[16:19], v[128:135], v116
    v_smfmac_f32_16x16x64_bf16 v[48:51], v[20:23], v[160:167], v116
    buffer_store_dword v126, v119, s[8:11], s55 offen sc1
    v_smfmac_f32_16x16x64_bf16 v[48:51], v[24:27], v[144:151], v116
    s_waitcnt lgkmcnt(0)
    s_barrier
    v_smfmac_f32_16x16x64_bf16 v[48:51], v[28:31], v[176:183], v116
    ds_read_b128 v[32:35], v121 offset:16384
    ds_read_b128 v[36:39], v121 offset:17408
    v_smfmac_f32_16x16x64_bf16 v[52:55], v[16:19], v[136:143], v116
    ds_read_b128 v[40:43], v121 offset:18432
    ds_read_b128 v[44:47], v121 offset:19456
    v_smfmac_f32_16x16x64_bf16 v[52:55], v[20:23], v[168:175], v116
    ds_read_b128 v[8:11], v124 offset:32768
    v_add_f32 v48, v48, v50
    v_smfmac_f32_16x16x64_bf16 v[52:55], v[24:27], v[152:159], v116
    ds_read_b128 v[12:15], v124 offset:33792
    v_add_f32 v49, v49, v51
    v_smfmac_f32_16x16x64_bf16 v[52:55], v[28:31], v[184:191], v116
    s_waitcnt lgkmcnt(5)
    v_cvt_pk_bf16_f32 v112, v48, v49
    v_mfma_f32_16x16x32_bf16 v[56:59], v[56:59], v[32:35], 0
    s_waitcnt lgkmcnt(4)
    v_mov_b32 v48, s50
    v_mov_b32 v49, s50
    v_mfma_f32_16x16x32_bf16 v[56:59], v[60:63], v[36:39], v[56:59]
    ds_read_b128 v[16:19], v124 offset:2048
    s_waitcnt lgkmcnt(4)
    v_mov_b32 v50, s50
    v_mov_b32 v51, s50
    v_mfma_f32_16x16x32_bf16 v[56:59], v[64:67], v[40:43], v[56:59]
    ds_read_b128 v[20:23], v124 offset:3072
    s_waitcnt lgkmcnt(4)
    v_add_f32 v52, v52, v54
    v_mfma_f32_16x16x32_bf16 v[56:59], v[68:71], v[44:47], v[56:59]
    ds_read_b128 v[24:27], v124 offset:4096
    v_add_f32 v53, v53, v55
    v_mfma_f32_16x16x32_bf16 v[60:63], v[72:75], v[32:35], 0
    ds_read_b128 v[28:31], v124 offset:5120
    v_cvt_pk_bf16_f32 v114, v52, v53
    v_mov_b32 v53, 0
    v_mfma_f32_16x16x32_bf16 v[60:63], v[76:79], v[36:39], v[60:63]
    v_exp_f32 v56, v56
    v_mfma_f32_16x16x32_bf16 v[60:63], v[80:83], v[40:43], v[60:63]
    v_exp_f32 v57, v57
    v_mfma_f32_16x16x32_bf16 v[60:63], v[84:87], v[44:47], v[60:63]
    v_exp_f32 v58, v58
    v_mfma_f32_16x16x32_bf16 v[64:67], v[32:35], v[32:35], 0
    v_exp_f32 v59, v59
    v_cvt_pk_bf16_f32 v68, v56, v57
    v_mfma_f32_16x16x32_bf16 v[64:67], v[36:39], v[36:39], v[64:67]
    v_exp_f32 v60, v60
    v_cvt_pk_bf16_f32 v69, v58, v59
    v_mfma_f32_16x16x32_bf16 v[64:67], v[40:43], v[40:43], v[64:67]
    v_exp_f32 v61, v61
    v_mfma_f32_16x16x32_bf16 v[64:67], v[44:47], v[44:47], v[64:67]
    v_exp_f32 v62, v62
    v_exp_f32 v63, v63
    v_cvt_pk_bf16_f32 v70, v60, v61
    v_cvt_pk_bf16_f32 v71, v62, v63
    s_nop 1
    v_mfma_f32_16x16x32_bf16 v[72:75], v[88:91], v[68:71], 0
    s_nop 0
    v_exp_f32 v64, v64
    v_mfma_f32_16x16x32_bf16 v[76:79], v[92:95], v[68:71], 0
    v_exp_f32 v65, v65
    v_mfma_f32_16x16x32_bf16 v[80:83], v[48:51], v[68:71], 0
    v_cvt_pk_bf16_f32 v52, v64, v65
    s_nop 1
    v_mfma_f32_16x16x16_bf16 v[72:75], v[112:113], v[52:53], v[72:75]
    ds_read_b128 v[32:35], v124 offset:6144
    v_mfma_f32_16x16x16_bf16 v[76:79], v[114:115], v[52:53], v[76:79]
    ds_read_b128 v[36:39], v124 offset:7168
    v_mfma_f32_16x16x16_bf16 v[80:83], v[48:49], v[52:53], v[80:83]
L_norm_81:
    s_mov_b64 vcc, s[36:37]
    v_mov_b32 v122, v122
    v_mov_b32 v122, v122
    v_mov_b32 v122, v122
    v_cndmask_b32_dpp v76, v72, v76, vcc quad_perm:[2,3,2,3] row_mask:0xf bank_mask:0xf
    v_cndmask_b32_dpp v77, v73, v77, vcc quad_perm:[2,3,2,3] row_mask:0xf bank_mask:0xf
    v_cndmask_b32_dpp v78, v74, v78, vcc quad_perm:[2,3,2,3] row_mask:0xf bank_mask:0xf
    v_cndmask_b32_dpp v79, v75, v79, vcc quad_perm:[2,3,2,3] row_mask:0xf bank_mask:0xf
    v_rcp_f32_dpp v84, v80 quad_perm:[2,3,2,3] row_mask:0xf bank_mask:0xf
    s_nop 0
    v_pk_mul_f32 v[76:77], v[76:77], v[84:85] op_sel_hi:[1,0]
    v_pk_mul_f32 v[78:79], v[78:79], v[84:85] op_sel_hi:[1,0]
    v_cvt_pk_bf16_f32 v72, v76, v77
    v_cvt_pk_bf16_f32 v73, v78, v79
    ds_write_b64 v122, v[72:73] offset:22016
    v_max_f32_dpp v86, v80, v84 quad_perm:[2,3,2,3] row_mask:0xf bank_mask:0xf
    v_mov_b32_dpp v60, v72 quad_perm:[0,1,0,1] row_mask:0xf bank_mask:0xf
    v_mov_b32_dpp v61, v73 quad_perm:[0,1,0,1] row_mask:0xf bank_mask:0xf
    v_cmp_lt_f32 vcc, s35, v86
    v_mov_b32_dpp v62, v72 quad_perm:[2,3,2,3] row_mask:0xf bank_mask:0xf
    v_mov_b32_dpp v63, v73 quad_perm:[2,3,2,3] row_mask:0xf bank_mask:0xf
    s_nop 1
    v_smfmac_f32_16x16x64_bf16 v[96:99], v[60:63], v[192:199], v116
    s_cbranch_vccnz L_smax_82
    v_smfmac_f32_16x16x64_bf16 v[100:103], v[60:63], v[224:231], v116
    s_waitcnt lgkmcnt(0)
    s_barrier
    ds_read_b128 v[92:95], v127 offset:21504
    ds_read_b128 v[80:83], v127 offset:20992
    ds_read_b128 v[84:87], v127 offset:20480
    v_smfmac_f32_16x16x64_bf16 v[104:107], v[60:63], v[0:7], v116
    ds_read_b128 v[40:43], v124 offset:34816
    v_smfmac_f32_16x16x64_bf16 v[108:111], v[60:63], v[8:15], v116
    ds_read_b128 v[56:59], v124 offset:36864
    s_waitcnt lgkmcnt(4)
    v_smfmac_f32_16x16x64_bf16 v[96:99], v[92:95], v[200:207], v116
    s_waitcnt lgkmcnt(3)
    v_smfmac_f32_16x16x64_bf16 v[96:99], v[80:83], v[208:215], v116
    ds_read_b128 v[44:47], v124 offset:35840
    s_waitcnt lgkmcnt(3)
    v_smfmac_f32_16x16x64_bf16 v[96:99], v[84:87], v[216:223], v116
    ds_read_b128 v[68:71], v124 offset:39936
    v_smfmac_f32_16x16x64_bf16 v[100:103], v[92:95], v[232:239], v116
    ds_read_b128 v[64:67], v124 offset:38912
    v_smfmac_f32_16x16x64_bf16 v[100:103], v[80:83], v[240:247], v116
    ds_read_b128 v[60:63], v124 offset:37888
    v_cvt_pk_bf16_f32 v72, v96, v98
    v_smfmac_f32_16x16x64_bf16 v[100:103], v[84:87], v[248:255], v116
    v_and_or_b32 v72, v72, -2, s33
    v_smfmac_f32_16x16x64_bf16 v[104:107], v[92:95], v[16:23], v116
    v_cvt_pk_bf16_f32 v74, v97, v99
    v_smfmac_f32_16x16x64_bf16 v[104:107], v[80:83], v[24:31], v116
    v_cvt_pk_bf16_f32 v73, v100, v102
    v_cvt_pk_bf16_f32 v75, v101, v103
    v_smfmac_f32_16x16x64_bf16 v[104:107], v[84:87], v[32:39], v116
    buffer_store_dwordx4 v[72:75], v118, s[8:11], s25 offen sc1
    s_waitcnt lgkmcnt(3)
    v_smfmac_f32_16x16x64_bf16 v[108:111], v[92:95], v[40:47], v116
    s_waitcnt lgkmcnt(0)
    v_smfmac_f32_16x16x64_bf16 v[108:111], v[80:83], v[56:63], v116
    v_cvt_pk_bf16_f32 v76, v104, v106
    v_smfmac_f32_16x16x64_bf16 v[108:111], v[84:87], v[64:71], v116
    v_and_or_b32 v76, v76, -2, s33
    v_cvt_pk_bf16_f32 v78, v105, v107
    v_mov_b32 v122, v122
    v_mov_b32 v122, v122
    v_mov_b32 v122, v122
    v_mov_b32 v122, v122
    v_mov_b32 v122, v122
    v_mov_b32 v122, v122
    v_cvt_pk_bf16_f32 v77, v108, v110
    v_cvt_pk_bf16_f32 v79, v109, v111
    buffer_store_dwordx4 v[76:79], v118, s[8:11], s26 offen sc1
    ds_read_b128 v[80:83], v123
    ds_read_b128 v[84:87], v123 offset:1024
    ds_read_b128 v[56:59], v123 offset:2048
    ds_read_b128 v[60:63], v123 offset:3072
    ds_read_b128 v[64:67], v123 offset:32768
    ds_read_b128 v[68:71], v123 offset:33792
    ds_read_b128 v[72:75], v123 offset:34816
    ds_read_b128 v[76:79], v123 offset:35840
    ds_read_b128 v[88:91], v123 offset:4096
    ds_read_b128 v[92:95], v123 offset:5120
    ds_read_b128 v[96:99], v123 offset:6144
    ds_read_b128 v[100:103], v123 offset:7168
    ds_read_b128 v[104:107], v123 offset:36864
    ds_read_b128 v[108:111], v123 offset:37888
    ds_read_b128 v[24:27], v123 offset:38912
    ds_read_b128 v[28:31], v123 offset:39936
    s_add_u32 s30, s30, 0x40000
    s_add_u32 s31, s31, 0x40000
    s_add_u32 s32, s32, 0x20000
    s_add_u32 s23, s24, 3072
    s_add_u32 s48, s23, 4096
    s_xor_b32 s25, s25, 0x40000
    s_xor_b32 s26, s26, 0x40000
    s_mov_b32 s35, 0x49800000
    s_add_u32 s22, s22, 1
    v_cndmask_b32 v12, 0, v125, s[68:69]
    v_cndmask_b32 v13, 0, v125, s[70:71]
    v_cndmask_b32 v14, 0, v125, s[72:73]
    v_cndmask_b32 v15, 0, v125, s[74:75]
    v_mov_b32 v32, 0
    v_mov_b32 v33, 0
    v_mov_b32 v34, 0
    v_mov_b32 v35, 0
    v_mov_b32 v36, 0
    v_mov_b32 v37, 0
    v_mov_b32 v38, 0
    v_mov_b32 v39, 0
    v_mov_b32 v40, 0
    v_mov_b32 v41, 0
    v_mov_b32 v42, 0
    v_mov_b32 v43, 0
    v_mov_b32 v44, 0
    v_mov_b32 v45, 0
    v_mov_b32 v46, 0
    v_mov_b32 v47, 0
    v_mov_b32 v54, 0
    v_mov_b32 v55, 0
    v_mov_b32 v52, 0
    v_mov_b32 v52, 0
    v_mov_b32 v52, 0
    v_mov_b32 v52, 0
    v_mov_b32 v52, 0
    v_mov_b32 v52, 0
    v_mov_b32 v52, 0
    v_mov_b32 v52, 0
    v_mov_b32 v52, 0
    v_mov_b32 v52, 0
    v_mov_b32 v52, 0
    v_mov_b32 v52, 0
    v_mov_b32 v52, 0
    v_mov_b32 v52, 0
    v_mov_b32 v52, 0
    v_mov_b32 v52, 0
    v_mov_b32 v52, 0
    v_mov_b32 v52, 0
    v_mov_b32 v52, 0
    v_mov_b32 v52, 0
    v_mov_b32 v52, 0
    v_mov_b32 v52, 0
    v_mov_b32 v52, 0
    v_mov_b32 v52, 0
    v_mov_b32 v52, 0
    v_mov_b32 v52, 0
    v_mov_b32 v52, 0
    v_mov_b32 v52, 0
    v_mov_b32 v52, 0
    v_mov_b32 v52, 0
    v_mov_b32 v52, 0
    v_mov_b32 v52, 0
    v_mov_b32 v52, 0
    v_mov_b32 v52, 0
    v_mov_b32 v52, 0
    v_mov_b32 v52, 0
    v_mov_b32 v52, 0
    v_mov_b32 v52, 0
    v_mov_b32 v52, 0
    v_mov_b32 v52, 0
    v_mov_b32 v52, 0
    v_mov_b32 v52, 0
    v_mov_b32 v52, 0
    buffer_load_dwordx4 v[4:7], v117, s[8:11], s29 offen sc1
    buffer_load_dwordx4 v[8:11], v117, s[8:11], s53 offen sc1
    buffer_load_dwordx4 v[16:19], v117, s[8:11], s29 offen offset:2048 sc1
    buffer_load_dwordx4 v[20:23], v117, s[8:11], s53 offen offset:2048 sc1
    v_mov_b32 v52, 0
    s_waitcnt vmcnt(3)
L_rl_83:
    v_mfma_f32_16x16x32_bf16 v[48:51], v[4:7], v[12:15], 0
    v_xor_b32 v52, s33, v4
    s_waitcnt vmcnt(2)
    v_mfma_f32_16x16x32_bf16 v[48:51], v[8:11], v[12:15], v[48:51]
    v_xor_b32 v53, s33, v8
    v_or_b32 v52, v52, v53
    s_waitcnt vmcnt(1)
    v_mfma_f32_16x16x32_bf16 v[48:51], v[16:19], v[12:15], v[48:51]
    v_xor_b32 v53, s33, v16
    v_or_b32 v52, v52, v53
    s_waitcnt vmcnt(0)
    v_mfma_f32_16x16x32_bf16 v[48:51], v[20:23], v[12:15], v[48:51]
    v_xor_b32 v53, s33, v20
    v_or_b32 v52, v52, v53
    v_and_b32 v52, 1, v52
    v_cmp_ne_u32 vcc, 0, v52
    s_cbranch_vccnz L_rslow_84
L_rgo_85:
    s_nop 2
    v_permlane32_swap_b32 v48, v50
    v_permlane32_swap_b32 v49, v51
    v_pk_add_f32 v[48:49], v[48:49], v[50:51]
    s_mov_b64 exec, s[38:39]
    v_cvt_pk_bf16_f32 v12, v48, v49
    v_min_u32 v12, 0xfffffffe, v12
    buffer_store_dword v12, v119, s[8:11], s24 offen sc1
    s_mov_b64 exec, -1
    s_add_u32 s24, s24, 8192
    s_bitset0_b32 s24, 15
    s_xor_b32 s55, s24, 16384
    s_xor_b32 s29, s29, 0x40000
    s_xor_b32 s53, s29, 1024
    s_bfe_u32 s33, s22, 0x10001
    s_waitcnt lgkmcnt(0)
    s_branch L_chain_top3_s
L_chain_last_s:
    s_nop 1
    v_smfmac_f32_16x16x64_bf16 v[48:51], v[16:19], v[128:135], v116
    v_smfmac_f32_16x16x64_bf16 v[48:51], v[20:23], v[160:167], v116
    v_smfmac_f32_16x16x64_bf16 v[48:51], v[24:27], v[144:151], v116
    v_smfmac_f32_16x16x64_bf16 v[48:51], v[28:31], v[176:183], v116
    v_smfmac_f32_16x16x64_bf16 v[52:55], v[16:19], v[136:143], v116
    v_smfmac_f32_16x16x64_bf16 v[52:55], v[20:23], v[168:175], v116
    v_smfmac_f32_16x16x64_bf16 v[52:55], v[24:27], v[152:159], v116
    v_smfmac_f32_16x16x64_bf16 v[52:55], v[28:31], v[184:191], v116
    v_add_f32 v48, v48, v50
    v_add_f32 v49, v49, v51
    v_cvt_pk_bf16_f32 v112, v48, v49
    s_nop 4
    v_add_f32 v52, v52, v54
    v_add_f32 v53, v53, v55
    v_cvt_pk_bf16_f32 v114, v52, v53
    s_add_u32 s32, s32, 0x20000
    buffer_store_dwordx4 v[112:115], v117, s[8:11], s32 offen sc1
    v_mov_b32 v94, 64
    s_waitcnt vmcnt(0) lgkmcnt(0)
    s_barrier
    s_mov_b64 exec, 1
    buffer_store_dword v94, off, s[8:11], s44 sc1
    s_mov_b64 exec, -1
    s_endpgm
L_mret_57:
    s_mov_b32 s43, m0
    s_mov_b32 m0, 4096
    buffer_load_dwordx4 v[4:7], v117, s[8:11], s48 offen sc1
    buffer_load_dwordx4 v117, s[8:11], s48 offen sc1 lds
    s_mov_b32 m0, 8192
    s_mov_b32 m0, s43
    s_waitcnt vmcnt(0)
    v_max3_u32 v15, v4, v5, v6
    v_max_u32 v15, v15, v7
    v_cmp_lt_u32 vcc, s56, v15
    s_add_u32 s47, s47, 1
    s_add_u32 s49, s49, 1
    s_cmp_ge_u32 s49, 0x10000
    s_cbranch_scc1 L_mgo_58
    s_cbranch_vccnz L_mret_57
    s_branch L_mgo_58
L_smax_60:
    s_add_u32 s47, s47, 1
    s_mov_b32 s35, 0x7f800000
    s_waitcnt lgkmcnt(0)
    s_sub_u32 s43, s30, 0x40000
    s_add_u32 s40, s43, 4096
    s_nop 7
    buffer_load_dwordx4 v[56:59], v117, s[8:11], s43 offen
    buffer_load_dwordx4 v[60:63], v117, s[8:11], s43 offen offset:1024
    buffer_load_dwordx4 v[64:67], v117, s[8:11], s43 offen offset:2048
    buffer_load_dwordx4 v[68:71], v117, s[8:11], s43 offen offset:3072
    buffer_load_dwordx4 v[72:75], v117, s[8:11], s40 offen
    buffer_load_dwordx4 v[76:79], v117, s[8:11], s40 offen offset:1024
    buffer_load_dwordx4 v[80:83], v117, s[8:11], s40 offen offset:2048
    buffer_load_dwordx4 v[84:87], v117, s[8:11], s40 offen offset:3072
    ds_read_b128 v[32:35], v121 offset:16384
    ds_read_b128 v[36:39], v121 offset:17408
    ds_read_b128 v[40:43], v121 offset:18432
    ds_read_b128 v[44:47], v121 offset:19456
    v_mov_b32 v96, 0
    v_mov_b32 v97, 0
    v_mov_b32 v98, 0
    v_mov_b32 v99, 0
    v_mov_b32 v100, 0
    v_mov_b32 v101, 0
    v_mov_b32 v102, 0
    v_mov_b32 v103, 0
    v_mov_b32 v104, 0
    v_mov_b32 v105, 0
    v_mov_b32 v106, 0
    v_mov_b32 v107, 0
    v_mov_b32 v108, 0
    v_mov_b32 v109, 0
    v_mov_b32 v110, 0
    v_mov_b32 v111, 0
    s_waitcnt vmcnt(0) lgkmcnt(0)
    v_mfma_f32_16x16x32_bf16 v[56:59], v[56:59], v[32:35], 0
    v_mfma_f32_16x16x32_bf16 v[56:59], v[60:63], v[36:39], v[56:59]
    v_mfma_f32_16x16x32_bf16 v[56:59], v[64:67], v[40:43], v[56:59]
    v_mfma_f32_16x16x32_bf16 v[56:59], v[68:71], v[44:47], v[56:59]
    v_mfma_f32_16x16x32_bf16 v[60:63], v[72:75], v[32:35], 0
    v_mfma_f32_16x16x32_bf16 v[60:63], v[76:79], v[36:39], v[60:63]
    v_mfma_f32_16x16x32_bf16 v[60:63], v[80:83], v[40:43], v[60:63]
    v_mfma_f32_16x16x32_bf16 v[60:63], v[84:87], v[44:47], v[60:63]
    v_mfma_f32_16x16x32_bf16 v[64:67], v[32:35], v[32:35], 0
    v_mfma_f32_16x16x32_bf16 v[64:67], v[36:39], v[36:39], v[64:67]
    v_mfma_f32_16x16x32_bf16 v[64:67], v[40:43], v[40:43], v[64:67]
    v_mfma_f32_16x16x32_bf16 v[64:67], v[44:47], v[44:47], v[64:67]
    v_max3_f32 v84, v56, v57, v58
    v_max3_f32 v84, v84, v59, v60
    v_max3_f32 v84, v84, v61, v62
    s_nop 4
    v_max3_f32 v84, v84, v63, v64
    v_max_f32 v84, v84, v65
    v_mov_b32 v85, v84
    s_nop 1
    v_permlane32_swap_b32 v85, v84
    v_max_f32 v84, v85, v84
    v_mov_b32 v85, v84
    s_nop 1
    v_permlane16_swap_b32 v85, v84
    v_max_f32 v84, v85, v84
    v_sub_f32 v56, v56, v84
    v_sub_f32 v57, v57, v84
    v_sub_f32 v58, v58, v84
    v_sub_f32 v59, v59, v84
    v_sub_f32 v60, v60, v84
    v_sub_f32 v61, v61, v84
    v_sub_f32 v62, v62, v84
    v_sub_f32 v63, v63, v84
    v_sub_f32 v64, v64, v84
    v_sub_f32 v65, v65, v84
    v_exp_f32 v56, v56
    v_exp_f32 v57, v57
    v_exp_f32 v58, v58
    v_exp_f32 v59, v59
    v_exp_f32 v60, v60
    v_exp_f32 v61, v61
    v_exp_f32 v62, v62
    v_exp_f32 v63, v63
    v_exp_f32 v64, v64
    v_exp_f32 v65, v65
    v_cvt_pk_bf16_f32 v68, v56, v57
    v_cvt_pk_bf16_f32 v69, v58, v59
    v_cvt_pk_bf16_f32 v70, v60, v61
    v_cvt_pk_bf16_f32 v71, v62, v63
    v_cvt_pk_bf16_f32 v52, v64, v65
    s_nop 0
    v_mfma_f32_16x16x32_bf16 v[72:75], v[88:91], v[68:71], 0
    v_mfma_f32_16x16x32_bf16 v[76:79], v[92:95], v[68:71], 0
    v_mfma_f32_16x16x32_bf16 v[80:83], v[48:51], v[68:71], 0
    v_mfma_f32_16x16x16_bf16 v[72:75], v[112:113], v[52:53], v[72:75]
    v_mfma_f32_16x16x16_bf16 v[76:79], v[114:115], v[52:53], v[76:79]
    v_mfma_f32_16x16x16_bf16 v[80:83], v[48:49], v[52:53], v[80:83]
    ds_read_b128 v[32:35], v124 offset:6144
    ds_read_b128 v[36:39], v124 offset:7168
    ds_read_b128 v[40:43], v124 offset:34816
    ds_read_b128 v[44:47], v124 offset:35840
    ds_read_b128 v[56:59], v124 offset:36864
    ds_read_b128 v[64:67], v124 offset:38912
    ds_read_b128 v[68:71], v124 offset:39936
    s_waitcnt lgkmcnt(0)
    s_branch L_norm_59
L_kvw_61:
    s_add_u32 s47, s47, 1
    s_add_u32 s49, s49, 1
    s_cmp_ge_u32 s49, 0x10000
    s_cbranch_scc1 L_kvb_62
    s_sleep 4
    buffer_load_dword v125, v119, s[8:11], s28 offen sc1
    s_waitcnt vmcnt(0)
    v_cmp_eq_u32 vcc, 0, v125
    s_nop 0
    s_and_b64 vcc, vcc, s[58:59]
    s_cbranch_scc1 L_kvw_61
    s_branch L_kvb_62
L_mret_64:
    s_mov_b32 s43, m0
    s_mov_b32 m0, 5120
    buffer_load_dwordx4 v[4:7], v117, s[8:11], s48 offen sc1
    buffer_load_dwordx4 v117, s[8:11], s48 offen sc1 lds
    s_mov_b32 m0, 10240
    s_mov_b32 m0, s43
    s_waitcnt vmcnt(0)
    v_max3_u32 v15, v4, v5, v6
    v_max_u32 v15, v15, v7
    v_cmp_lt_u32 vcc, s56, v15
    s_add_u32 s47, s47, 1
    s_add_u32 s49, s49, 1
    s_cmp_ge_u32 s49, 0x10000
    s_cbranch_scc1 L_mgo_65
    s_cbranch_vccnz L_mret_64
    s_branch L_mgo_65
L_smax_67:
    s_add_u32 s47, s47, 1
    s_mov_b32 s35, 0x7f800000
    s_waitcnt lgkmcnt(0)
    s_sub_u32 s43, s30, 0x40800
    s_add_u32 s40, s43, 4096
    s_nop 7
    buffer_load_dwordx4 v[56:59], v117, s[8:11], s43 offen
    buffer_load_dwordx4 v[60:63], v117, s[8:11], s43 offen offset:1024
    buffer_load_dwordx4 v[64:67], v117, s[8:11], s43 offen offset:2048
    buffer_load_dwordx4 v[68:71], v117, s[8:11], s43 offen offset:3072
    buffer_load_dwordx4 v[72:75], v117, s[8:11], s40 offen
    buffer_load_dwordx4 v[76:79], v117, s[8:11], s40 offen offset:1024
    buffer_load_dwordx4 v[80:83], v117, s[8:11], s40 offen offset:2048
    buffer_load_dwordx4 v[84:87], v117, s[8:11], s40 offen offset:3072
    ds_read_b128 v[32:35], v121 offset:16384
    ds_read_b128 v[36:39], v121 offset:17408
    ds_read_b128 v[40:43], v121 offset:18432
    ds_read_b128 v[44:47], v121 offset:19456
    v_mov_b32 v96, 0
    v_mov_b32 v97, 0
    v_mov_b32 v98, 0
    v_mov_b32 v99, 0
    v_mov_b32 v100, 0
    v_mov_b32 v101, 0
    v_mov_b32 v102, 0
    v_mov_b32 v103, 0
    v_mov_b32 v104, 0
    v_mov_b32 v105, 0
    v_mov_b32 v106, 0
    v_mov_b32 v107, 0
    v_mov_b32 v108, 0
    v_mov_b32 v109, 0
    v_mov_b32 v110, 0
    v_mov_b32 v111, 0
    s_waitcnt vmcnt(0) lgkmcnt(0)
    v_mfma_f32_16x16x32_bf16 v[56:59], v[56:59], v[32:35], 0
    v_mfma_f32_16x16x32_bf16 v[56:59], v[60:63], v[36:39], v[56:59]
    v_mfma_f32_16x16x32_bf16 v[56:59], v[64:67], v[40:43], v[56:59]
    v_mfma_f32_16x16x32_bf16 v[56:59], v[68:71], v[44:47], v[56:59]
    v_mfma_f32_16x16x32_bf16 v[60:63], v[72:75], v[32:35], 0
    v_mfma_f32_16x16x32_bf16 v[60:63], v[76:79], v[36:39], v[60:63]
    v_mfma_f32_16x16x32_bf16 v[60:63], v[80:83], v[40:43], v[60:63]
    v_mfma_f32_16x16x32_bf16 v[60:63], v[84:87], v[44:47], v[60:63]
    v_mfma_f32_16x16x32_bf16 v[64:67], v[32:35], v[32:35], 0
    v_mfma_f32_16x16x32_bf16 v[64:67], v[36:39], v[36:39], v[64:67]
    v_mfma_f32_16x16x32_bf16 v[64:67], v[40:43], v[40:43], v[64:67]
    v_mfma_f32_16x16x32_bf16 v[64:67], v[44:47], v[44:47], v[64:67]
    v_max3_f32 v84, v56, v57, v58
    v_max3_f32 v84, v84, v59, v60
    v_max3_f32 v84, v84, v61, v62
    s_nop 4
    v_max3_f32 v84, v84, v63, v64
    v_max_f32 v84, v84, v65
    v_mov_b32 v85, v84
    s_nop 1
    v_permlane32_swap_b32 v85, v84
    v_max_f32 v84, v85, v84
    v_mov_b32 v85, v84
    s_nop 1
    v_permlane16_swap_b32 v85, v84
    v_max_f32 v84, v85, v84
    v_sub_f32 v56, v56, v84
    v_sub_f32 v57, v57, v84
    v_sub_f32 v58, v58, v84
    v_sub_f32 v59, v59, v84
    v_sub_f32 v60, v60, v84
    v_sub_f32 v61, v61, v84
    v_sub_f32 v62, v62, v84
    v_sub_f32 v63, v63, v84
    v_sub_f32 v64, v64, v84
    v_sub_f32 v65, v65, v84
    v_exp_f32 v56, v56
    v_exp_f32 v57, v57
    v_exp_f32 v58, v58
    v_exp_f32 v59, v59
    v_exp_f32 v60, v60
    v_exp_f32 v61, v61
    v_exp_f32 v62, v62
    v_exp_f32 v63, v63
    v_exp_f32 v64, v64
    v_exp_f32 v65, v65
    v_cvt_pk_bf16_f32 v68, v56, v57
    v_cvt_pk_bf16_f32 v69, v58, v59
    v_cvt_pk_bf16_f32 v70, v60, v61
    v_cvt_pk_bf16_f32 v71, v62, v63
    v_cvt_pk_bf16_f32 v52, v64, v65
    s_nop 0
    v_mfma_f32_16x16x32_bf16 v[72:75], v[88:91], v[68:71], 0
    v_mfma_f32_16x16x32_bf16 v[76:79], v[92:95], v[68:71], 0
    v_mfma_f32_16x16x32_bf16 v[80:83], v[48:51], v[68:71], 0
    v_mfma_f32_16x16x16_bf16 v[72:75], v[112:113], v[52:53], v[72:75]
    v_mfma_f32_16x16x16_bf16 v[76:79], v[114:115], v[52:53], v[76:79]
    v_mfma_f32_16x16x16_bf16 v[80:83], v[48:49], v[52:53], v[80:83]
    ds_read_b128 v[32:35], v124 offset:6144
    ds_read_b128 v[36:39], v124 offset:7168
    ds_read_b128 v[40:43], v124 offset:34816
    ds_read_b128 v[44:47], v124 offset:35840
    ds_read_b128 v[56:59], v124 offset:36864
    ds_read_b128 v[64:67], v124 offset:38912
    ds_read_b128 v[68:71], v124 offset:39936
    s_waitcnt lgkmcnt(0)
    s_branch L_norm_66
L_kvw_68:
    s_add_u32 s47, s47, 1
    s_add_u32 s49, s49, 1
    s_cmp_ge_u32 s49, 0x10000
    s_cbranch_scc1 L_kvb_69
    s_sleep 4
    buffer_load_dword v125, v119, s[8:11], s28 offen sc1
    s_waitcnt vmcnt(0)
    v_cmp_eq_u32 vcc, 0, v125
    s_nop 0
    s_and_b64 vcc, vcc, s[58:59]
    s_cbranch_scc1 L_kvw_68
    s_branch L_kvb_69
L_mret_71:
    s_mov_b32 s43, m0
    s_mov_b32 m0, 6144
    buffer_load_dwordx4 v[4:7], v117, s[8:11], s48 offen sc1
    buffer_load_dwordx4 v117, s[8:11], s48 offen sc1 lds
    s_mov_b32 m0, 12288
    s_mov_b32 m0, s43
    s_waitcnt vmcnt(0)
    v_max3_u32 v15, v4, v5, v6
    v_max_u32 v15, v15, v7
    v_cmp_lt_u32 vcc, s56, v15
    s_add_u32 s47, s47, 1
    s_add_u32 s49, s49, 1
    s_cmp_ge_u32 s49, 0x10000
    s_cbranch_scc1 L_mgo_72
    s_cbranch_vccnz L_mret_71
    s_branch L_mgo_72
L_smax_74:
    s_add_u32 s47, s47, 1
    s_mov_b32 s35, 0x7f800000
    s_waitcnt lgkmcnt(0)
    s_sub_u32 s43, s30, 0x41000
    s_add_u32 s40, s43, 4096
    s_nop 7
    buffer_load_dwordx4 v[56:59], v117, s[8:11], s43 offen
    buffer_load_dwordx4 v[60:63], v117, s[8:11], s43 offen offset:1024
    buffer_load_dwordx4 v[64:67], v117, s[8:11], s43 offen offset:2048
    buffer_load_dwordx4 v[68:71], v117, s[8:11], s43 offen offset:3072
    buffer_load_dwordx4 v[72:75], v117, s[8:11], s40 offen
    buffer_load_dwordx4 v[76:79], v117, s[8:11], s40 offen offset:1024
    buffer_load_dwordx4 v[80:83], v117, s[8:11], s40 offen offset:2048
    buffer_load_dwordx4 v[84:87], v117, s[8:11], s40 offen offset:3072
    ds_read_b128 v[32:35], v121 offset:16384
    ds_read_b128 v[36:39], v121 offset:17408
    ds_read_b128 v[40:43], v121 offset:18432
    ds_read_b128 v[44:47], v121 offset:19456
    v_mov_b32 v96, 0
    v_mov_b32 v97, 0
    v_mov_b32 v98, 0
    v_mov_b32 v99, 0
    v_mov_b32 v100, 0
    v_mov_b32 v101, 0
    v_mov_b32 v102, 0
    v_mov_b32 v103, 0
    v_mov_b32 v104, 0
    v_mov_b32 v105, 0
    v_mov_b32 v106, 0
    v_mov_b32 v107, 0
    v_mov_b32 v108, 0
    v_mov_b32 v109, 0
    v_mov_b32 v110, 0
    v_mov_b32 v111, 0
    s_waitcnt vmcnt(0) lgkmcnt(0)
    v_mfma_f32_16x16x32_bf16 v[56:59], v[56:59], v[32:35], 0
    v_mfma_f32_16x16x32_bf16 v[56:59], v[60:63], v[36:39], v[56:59]
    v_mfma_f32_16x16x32_bf16 v[56:59], v[64:67], v[40:43], v[56:59]
    v_mfma_f32_16x16x32_bf16 v[56:59], v[68:71], v[44:47], v[56:59]
    v_mfma_f32_16x16x32_bf16 v[60:63], v[72:75], v[32:35], 0
    v_mfma_f32_16x16x32_bf16 v[60:63], v[76:79], v[36:39], v[60:63]
    v_mfma_f32_16x16x32_bf16 v[60:63], v[80:83], v[40:43], v[60:63]
    v_mfma_f32_16x16x32_bf16 v[60:63], v[84:87], v[44:47], v[60:63]
    v_mfma_f32_16x16x32_bf16 v[64:67], v[32:35], v[32:35], 0
    v_mfma_f32_16x16x32_bf16 v[64:67], v[36:39], v[36:39], v[64:67]
    v_mfma_f32_16x16x32_bf16 v[64:67], v[40:43], v[40:43], v[64:67]
    v_mfma_f32_16x16x32_bf16 v[64:67], v[44:47], v[44:47], v[64:67]
    v_max3_f32 v84, v56, v57, v58
    v_max3_f32 v84, v84, v59, v60
    v_max3_f32 v84, v84, v61, v62
    s_nop 4
    v_max3_f32 v84, v84, v63, v64
    v_max_f32 v84, v84, v65
    v_mov_b32 v85, v84
    s_nop 1
    v_permlane32_swap_b32 v85, v84
    v_max_f32 v84, v85, v84
    v_mov_b32 v85, v84
    s_nop 1
    v_permlane16_swap_b32 v85, v84
    v_max_f32 v84, v85, v84
    v_sub_f32 v56, v56, v84
    v_sub_f32 v57, v57, v84
    v_sub_f32 v58, v58, v84
    v_sub_f32 v59, v59, v84
    v_sub_f32 v60, v60, v84
    v_sub_f32 v61, v61, v84
    v_sub_f32 v62, v62, v84
    v_sub_f32 v63, v63, v84
    v_sub_f32 v64, v64, v84
    v_sub_f32 v65, v65, v84
    v_exp_f32 v56, v56
    v_exp_f32 v57, v57
    v_exp_f32 v58, v58
    v_exp_f32 v59, v59
    v_exp_f32 v60, v60
    v_exp_f32 v61, v61
    v_exp_f32 v62, v62
    v_exp_f32 v63, v63
    v_exp_f32 v64, v64
    v_exp_f32 v65, v65
    v_cvt_pk_bf16_f32 v68, v56, v57
    v_cvt_pk_bf16_f32 v69, v58, v59
    v_cvt_pk_bf16_f32 v70, v60, v61
    v_cvt_pk_bf16_f32 v71, v62, v63
    v_cvt_pk_bf16_f32 v52, v64, v65
    s_nop 0
    v_mfma_f32_16x16x32_bf16 v[72:75], v[88:91], v[68:71], 0
    v_mfma_f32_16x16x32_bf16 v[76:79], v[92:95], v[68:71], 0
    v_mfma_f32_16x16x32_bf16 v[80:83], v[48:51], v[68:71], 0
    v_mfma_f32_16x16x16_bf16 v[72:75], v[112:113], v[52:53], v[72:75]
    v_mfma_f32_16x16x16_bf16 v[76:79], v[114:115], v[52:53], v[76:79]
    v_mfma_f32_16x16x16_bf16 v[80:83], v[48:49], v[52:53], v[80:83]
    ds_read_b128 v[32:35], v124 offset:6144
    ds_read_b128 v[36:39], v124 offset:7168
    ds_read_b128 v[40:43], v124 offset:34816
    ds_read_b128 v[44:47], v124 offset:35840
    ds_read_b128 v[56:59], v124 offset:36864
    ds_read_b128 v[64:67], v124 offset:38912
    ds_read_b128 v[68:71], v124 offset:39936
    s_waitcnt lgkmcnt(0)
    s_branch L_norm_73
L_rslow_76:
    buffer_load_dwordx4 v[4:7], v117, s[8:11], s29 offen sc1
    buffer_load_dwordx4 v[8:11], v117, s[8:11], s53 offen sc1
    buffer_load_dwordx4 v[16:19], v117, s[8:11], s29 offen offset:2048 sc1
    buffer_load_dwordx4 v[20:23], v117, s[8:11], s53 offen offset:2048 sc1
    s_add_u32 s46, s46, 1
    s_add_u32 s49, s49, 1
    s_cmp_ge_u32 s49, 0x10000
    s_cbranch_scc1 L_rgo_77
    s_waitcnt vmcnt(0)
    s_branch L_rl_75
L_mret_79:
    s_mov_b32 s43, m0
    s_mov_b32 m0, 7168
    buffer_load_dwordx4 v[4:7], v117, s[8:11], s48 offen sc1
    buffer_load_dwordx4 v117, s[8:11], s48 offen sc1 lds
    s_mov_b32 m0, 14336
    s_mov_b32 m0, s43
    s_waitcnt vmcnt(0)
    v_max3_u32 v15, v4, v5, v6
    v_max_u32 v15, v15, v7
    v_cmp_lt_u32 vcc, s56, v15
    s_add_u32 s47, s47, 1
    s_add_u32 s49, s49, 1
    s_cmp_ge_u32 s49, 0x10000
    s_cbranch_scc1 L_mgo_80
    s_cbranch_vccnz L_mret_79
    s_branch L_mgo_80
L_smax_82:
    s_add_u32 s47, s47, 1
    s_mov_b32 s35, 0x7f800000
    s_waitcnt lgkmcnt(0)
    s_sub_u32 s43, s30, 0x41800
    s_add_u32 s40, s43, 4096
    s_nop 7
    buffer_load_dwordx4 v[56:59], v117, s[8:11], s43 offen
    buffer_load_dwordx4 v[60:63], v117, s[8:11], s43 offen offset:1024
    buffer_load_dwordx4 v[64:67], v117, s[8:11], s43 offen offset:2048
    buffer_load_dwordx4 v[68:71], v117, s[8:11], s43 offen offset:3072
    buffer_load_dwordx4 v[72:75], v117, s[8:11], s40 offen
    buffer_load_dwordx4 v[76:79], v117, s[8:11], s40 offen offset:1024
    buffer_load_dwordx4 v[80:83], v117, s[8:11], s40 offen offset:2048
    buffer_load_dwordx4 v[84:87], v117, s[8:11], s40 offen offset:3072
    ds_read_b128 v[32:35], v121 offset:16384
    ds_read_b128 v[36:39], v121 offset:17408
    ds_read_b128 v[40:43], v121 offset:18432
    ds_read_b128 v[44:47], v121 offset:19456
    v_mov_b32 v96, 0
    v_mov_b32 v97, 0
    v_mov_b32 v98, 0
    v_mov_b32 v99, 0
    v_mov_b32 v100, 0
    v_mov_b32 v101, 0
    v_mov_b32 v102, 0
    v_mov_b32 v103, 0
    v_mov_b32 v104, 0
    v_mov_b32 v105, 0
    v_mov_b32 v106, 0
    v_mov_b32 v107, 0
    v_mov_b32 v108, 0
    v_mov_b32 v109, 0
    v_mov_b32 v110, 0
    v_mov_b32 v111, 0
    s_waitcnt vmcnt(0) lgkmcnt(0)
    v_mfma_f32_16x16x32_bf16 v[56:59], v[56:59], v[32:35], 0
    v_mfma_f32_16x16x32_bf16 v[56:59], v[60:63], v[36:39], v[56:59]
    v_mfma_f32_16x16x32_bf16 v[56:59], v[64:67], v[40:43], v[56:59]
    v_mfma_f32_16x16x32_bf16 v[56:59], v[68:71], v[44:47], v[56:59]
    v_mfma_f32_16x16x32_bf16 v[60:63], v[72:75], v[32:35], 0
    v_mfma_f32_16x16x32_bf16 v[60:63], v[76:79], v[36:39], v[60:63]
    v_mfma_f32_16x16x32_bf16 v[60:63], v[80:83], v[40:43], v[60:63]
    v_mfma_f32_16x16x32_bf16 v[60:63], v[84:87], v[44:47], v[60:63]
    v_mfma_f32_16x16x32_bf16 v[64:67], v[32:35], v[32:35], 0
    v_mfma_f32_16x16x32_bf16 v[64:67], v[36:39], v[36:39], v[64:67]
    v_mfma_f32_16x16x32_bf16 v[64:67], v[40:43], v[40:43], v[64:67]
    v_mfma_f32_16x16x32_bf16 v[64:67], v[44:47], v[44:47], v[64:67]
    v_max3_f32 v84, v56, v57, v58
    v_max3_f32 v84, v84, v59, v60
    v_max3_f32 v84, v84, v61, v62
    s_nop 4
    v_max3_f32 v84, v84, v63, v64
    v_max_f32 v84, v84, v65
    v_mov_b32 v85, v84
    s_nop 1
    v_permlane32_swap_b32 v85, v84
    v_max_f32 v84, v85, v84
    v_mov_b32 v85, v84
    s_nop 1
    v_permlane16_swap_b32 v85, v84
    v_max_f32 v84, v85, v84
    v_sub_f32 v56, v56, v84
    v_sub_f32 v57, v57, v84
    v_sub_f32 v58, v58, v84
    v_sub_f32 v59, v59, v84
    v_sub_f32 v60, v60, v84
    v_sub_f32 v61, v61, v84
    v_sub_f32 v62, v62, v84
    v_sub_f32 v63, v63, v84
    v_sub_f32 v64, v64, v84
    v_sub_f32 v65, v65, v84
    v_exp_f32 v56, v56
    v_exp_f32 v57, v57
    v_exp_f32 v58, v58
    v_exp_f32 v59, v59
    v_exp_f32 v60, v60
    v_exp_f32 v61, v61
    v_exp_f32 v62, v62
    v_exp_f32 v63, v63
    v_exp_f32 v64, v64
    v_exp_f32 v65, v65
    v_cvt_pk_bf16_f32 v68, v56, v57
    v_cvt_pk_bf16_f32 v69, v58, v59
    v_cvt_pk_bf16_f32 v70, v60, v61
    v_cvt_pk_bf16_f32 v71, v62, v63
    v_cvt_pk_bf16_f32 v52, v64, v65
    s_nop 0
    v_mfma_f32_16x16x32_bf16 v[72:75], v[88:91], v[68:71], 0
    v_mfma_f32_16x16x32_bf16 v[76:79], v[92:95], v[68:71], 0
    v_mfma_f32_16x16x32_bf16 v[80:83], v[48:51], v[68:71], 0
    v_mfma_f32_16x16x16_bf16 v[72:75], v[112:113], v[52:53], v[72:75]
    v_mfma_f32_16x16x16_bf16 v[76:79], v[114:115], v[52:53], v[76:79]
    v_mfma_f32_16x16x16_bf16 v[80:83], v[48:49], v[52:53], v[80:83]
    ds_read_b128 v[32:35], v124 offset:6144
    ds_read_b128 v[36:39], v124 offset:7168
    ds_read_b128 v[40:43], v124 offset:34816
    ds_read_b128 v[44:47], v124 offset:35840
    ds_read_b128 v[56:59], v124 offset:36864
    ds_read_b128 v[64:67], v124 offset:38912
    ds_read_b128 v[68:71], v124 offset:39936
    s_waitcnt lgkmcnt(0)
    s_branch L_norm_81
L_rslow_84:
    buffer_load_dwordx4 v[4:7], v117, s[8:11], s29 offen sc1
    buffer_load_dwordx4 v[8:11], v117, s[8:11], s53 offen sc1
    buffer_load_dwordx4 v[16:19], v117, s[8:11], s29 offen offset:2048 sc1
    buffer_load_dwordx4 v[20:23], v117, s[8:11], s53 offen offset:2048 sc1
    s_add_u32 s46, s46, 1
    s_add_u32 s49, s49, 1
    s_cmp_ge_u32 s49, 0x10000
    s_cbranch_scc1 L_rgo_85
    s_waitcnt vmcnt(0)
    s_branch L_rl_83
L_bulk:
    s_add_u32 s88, s101, 32
    s_mov_b32 s41, 0
    s_lshr_b32 s20, s101, 6
    s_and_b32 s22, s101, 63
    s_movk_i32 s37, 1000
L_p1go:
    s_mov_b32 s40, 0
    s_mov_b32 s80, 0
    s_mov_b32 s23, 0
L_p1_pass:
    v_mbcnt_lo_u32_b32 v0, -1, 0
    v_mbcnt_hi_u32_b32 v0, -1, v0
    s_lshl_b32 s96, s100, 6
    v_add_u32 v0, s96, v0
    s_load_dwordx2 s[34:35], s[0:1], 16
    s_load_dwordx2 s[30:31], s[0:1], 24
    s_load_dwordx2 s[32:33], s[0:1], 32
    s_load_dwordx2 s[42:43], s[0:1], 40
    s_load_dwordx2 s[12:13], s[0:1], 0
    s_waitcnt lgkmcnt(0)
    s_and_b32 s13, s13, 0xffff
    s_mov_b32 s14, 0x200000
    s_mov_b32 s15, 0x20000
    v_lshrrev_b32 v147, 6, v0
    s_nop 0
    v_readfirstlane_b32 s21, v147
    v_and_b32 v144, 63, v0
    v_lshrrev_b32 v145, 4, v144
    v_and_b32 v146, 15, v144
    v_lshrrev_b32 v149, 2, v146
    v_lshlrev_b32 v137, 4, v144
    s_lshl_b32 s29, s21, 10
    s_lshl_b32 s26, s20, 7
    s_lshl_b32 s27, s21, 5
    s_add_u32 s26, s26, s27
    v_add_u32 v147, s26, v146
    v_lshlrev_b32 v147, 10, v147
    v_lshl_add_u32 v139, v145, 4, v147
    s_mov_b32 s26, 0x0
    buffer_load_dwordx4 v[0:3], v139, s[12:15], s26 offen
    buffer_load_dwordx4 v[4:7], v139, s[12:15], s26 offen offset:64
    buffer_load_dwordx4 v[8:11], v139, s[12:15], s26 offen offset:128
    buffer_load_dwordx4 v[12:15], v139, s[12:15], s26 offen offset:192
    buffer_load_dwordx4 v[16:19], v139, s[12:15], s26 offen offset:256
    buffer_load_dwordx4 v[20:23], v139, s[12:15], s26 offen offset:320
    buffer_load_dwordx4 v[24:27], v139, s[12:15], s26 offen offset:384
    buffer_load_dwordx4 v[28:31], v139, s[12:15], s26 offen offset:448
    buffer_load_dwordx4 v[32:35], v139, s[12:15], s26 offen offset:512
    buffer_load_dwordx4 v[36:39], v139, s[12:15], s26 offen offset:576
    buffer_load_dwordx4 v[40:43], v139, s[12:15], s26 offen offset:640
    buffer_load_dwordx4 v[44:47], v139, s[12:15], s26 offen offset:704
    buffer_load_dwordx4 v[48:51], v139, s[12:15], s26 offen offset:768
    buffer_load_dwordx4 v[52:55], v139, s[12:15], s26 offen offset:832
    buffer_load_dwordx4 v[56:59], v139, s[12:15], s26 offen offset:896
    buffer_load_dwordx4 v[60:63], v139, s[12:15], s26 offen offset:960
    s_mov_b32 s26, 0x4000
    buffer_load_dwordx4 v[64:67], v139, s[12:15], s26 offen
    buffer_load_dwordx4 v[68:71], v139, s[12:15], s26 offen offset:64
    buffer_load_dwordx4 v[72:75], v139, s[12:15], s26 offen offset:128
    buffer_load_dwordx4 v[76:79], v139, s[12:15], s26 offen offset:192
    buffer_load_dwordx4 v[80:83], v139, s[12:15], s26 offen offset:256
    buffer_load_dwordx4 v[84:87], v139, s[12:15], s26 offen offset:320
    buffer_load_dwordx4 v[88:91], v139, s[12:15], s26 offen offset:384
    buffer_load_dwordx4 v[92:95], v139, s[12:15], s26 offen offset:448
    buffer_load_dwordx4 v[96:99], v139, s[12:15], s26 offen offset:512
    buffer_load_dwordx4 v[100:103], v139, s[12:15], s26 offen offset:576
    buffer_load_dwordx4 v[104:107], v139, s[12:15], s26 offen offset:640
    buffer_load_dwordx4 v[108:111], v139, s[12:15], s26 offen offset:704
    buffer_load_dwordx4 v[112:115], v139, s[12:15], s26 offen offset:768
    buffer_load_dwordx4 v[116:119], v139, s[12:15], s26 offen offset:832
    buffer_load_dwordx4 v[120:123], v139, s[12:15], s26 offen offset:896
    buffer_load_dwordx4 v[124:127], v139, s[12:15], s26 offen offset:960
    s_lshr_b32 s26, s21, 1
    s_lshl_b32 s26, s26, 2
    v_or_b32 v148, s26, v145
    v_lshlrev_b32 v148, 1, v148
    v_xor_b32 v148, v148, v146
    v_lshlrev_b32 v148, 4, v148
    s_lshl_b32 s26, s21, 2
    v_add_u32 v147, s26, v145
    v_lshl_add_u32 v136, v147, 13, v148
    v_lshl_add_u32 v147, v145, 3, v149
    v_lshlrev_b32 v147, 8, v147
    v_and_b32 v148, 1, v145
    v_lshl_or_b32 v148, v148, 2, v149
    v_lshl_add_u32 v147, v148, 5, v147
    v_and_b32 v148, 3, v146
    v_lshl_add_u32 v128, v148, 3, v147
    v_xor_b32 v129, 32, v128
    v_xor_b32 v130, 64, v128
    v_xor_b32 v131, 96, v128
    v_xor_b32 v132, 128, v128
    v_xor_b32 v133, 160, v128
    v_xor_b32 v134, 192, v128
    v_xor_b32 v135, 224, v128
    s_mov_b32 s19, 0x20000
    s_mov_b32 s38, s22
    s_mov_b32 s39, s22
    v_mov_b32 v158, 0x3f803f80
    s_waitcnt vmcnt(16)
    v_pk_mov_b32 v[150:151], 0, 0
    v_pk_mov_b32 v[152:153], 0, 0
    v_dot2_f32_bf16 v150, v0, v158, v150
    v_dot2_f32_bf16 v152, v0, v0, v152
    v_dot2_f32_bf16 v151, v1, v158, v151
    v_dot2_f32_bf16 v153, v1, v1, v153
    v_dot2_f32_bf16 v150, v2, v158, v150
    v_dot2_f32_bf16 v152, v2, v2, v152
    v_dot2_f32_bf16 v151, v3, v158, v151
    v_dot2_f32_bf16 v153, v3, v3, v153
    v_dot2_f32_bf16 v150, v4, v158, v150
    v_dot2_f32_bf16 v152, v4, v4, v152
    v_dot2_f32_bf16 v151, v5, v158, v151
    v_dot2_f32_bf16 v153, v5, v5, v153
    v_dot2_f32_bf16 v150, v6, v158, v150
    v_dot2_f32_bf16 v152, v6, v6, v152
    v_dot2_f32_bf16 v151, v7, v158, v151
    v_dot2_f32_bf16 v153, v7, v7, v153
    v_dot2_f32_bf16 v150, v8, v158, v150
    v_dot2_f32_bf16 v152, v8, v8, v152
    v_dot2_f32_bf16 v151, v9, v158, v151
    v_dot2_f32_bf16 v153, v9, v9, v153
    v_dot2_f32_bf16 v150, v10, v158, v150
    v_dot2_f32_bf16 v152, v10, v10, v152
    v_dot2_f32_bf16 v151, v11, v158, v151
    v_dot2_f32_bf16 v153, v11, v11, v153
    v_dot2_f32_bf16 v150, v12, v158, v150
    v_dot2_f32_bf16 v152, v12, v12, v152
    v_dot2_f32_bf16 v151, v13, v158, v151
    v_dot2_f32_bf16 v153, v13, v13, v153
    v_dot2_f32_bf16 v150, v14, v158, v150
    v_dot2_f32_bf16 v152, v14, v14, v152
    v_dot2_f32_bf16 v151, v15, v158, v151
    v_dot2_f32_bf16 v153, v15, v15, v153
    v_dot2_f32_bf16 v150, v16, v158, v150
    v_dot2_f32_bf16 v152, v16, v16, v152
    v_dot2_f32_bf16 v151, v17, v158, v151
    v_dot2_f32_bf16 v153, v17, v17, v153
    v_dot2_f32_bf16 v150, v18, v158, v150
    v_dot2_f32_bf16 v152, v18, v18, v152
    v_dot2_f32_bf16 v151, v19, v158, v151
    v_dot2_f32_bf16 v153, v19, v19, v153
    v_dot2_f32_bf16 v150, v20, v158, v150
    v_dot2_f32_bf16 v152, v20, v20, v152
    v_dot2_f32_bf16 v151, v21, v158, v151
    v_dot2_f32_bf16 v153, v21, v21, v153
    v_dot2_f32_bf16 v150, v22, v158, v150
    v_dot2_f32_bf16 v152, v22, v22, v152
    v_dot2_f32_bf16 v151, v23, v158, v151
    v_dot2_f32_bf16 v153, v23, v23, v153
    v_dot2_f32_bf16 v150, v24, v158, v150
    v_dot2_f32_bf16 v152, v24, v24, v152
    v_dot2_f32_bf16 v151, v25, v158, v151
    v_dot2_f32_bf16 v153, v25, v25, v153
    v_dot2_f32_bf16 v150, v26, v158, v150
    v_dot2_f32_bf16 v152, v26, v26, v152
    v_dot2_f32_bf16 v151, v27, v158, v151
    v_dot2_f32_bf16 v153, v27, v27, v153
    v_dot2_f32_bf16 v150, v28, v158, v150
    v_dot2_f32_bf16 v152, v28, v28, v152
    v_dot2_f32_bf16 v151, v29, v158, v151
    v_dot2_f32_bf16 v153, v29, v29, v153
    v_dot2_f32_bf16 v150, v30, v158, v150
    v_dot2_f32_bf16 v152, v30, v30, v152
    v_dot2_f32_bf16 v151, v31, v158, v151
    v_dot2_f32_bf16 v153, v31, v31, v153
    v_dot2_f32_bf16 v150, v32, v158, v150
    v_dot2_f32_bf16 v152, v32, v32, v152
    v_dot2_f32_bf16 v151, v33, v158, v151
    v_dot2_f32_bf16 v153, v33, v33, v153
    v_dot2_f32_bf16 v150, v34, v158, v150
    v_dot2_f32_bf16 v152, v34, v34, v152
    v_dot2_f32_bf16 v151, v35, v158, v151
    v_dot2_f32_bf16 v153, v35, v35, v153
    v_dot2_f32_bf16 v150, v36, v158, v150
    v_dot2_f32_bf16 v152, v36, v36, v152
    v_dot2_f32_bf16 v151, v37, v158, v151
    v_dot2_f32_bf16 v153, v37, v37, v153
    v_dot2_f32_bf16 v150, v38, v158, v150
    v_dot2_f32_bf16 v152, v38, v38, v152
    v_dot2_f32_bf16 v151, v39, v158, v151
    v_dot2_f32_bf16 v153, v39, v39, v153
    v_dot2_f32_bf16 v150, v40, v158, v150
    v_dot2_f32_bf16 v152, v40, v40, v152
    v_dot2_f32_bf16 v151, v41, v158, v151
    v_dot2_f32_bf16 v153, v41, v41, v153
    v_dot2_f32_bf16 v150, v42, v158, v150
    v_dot2_f32_bf16 v152, v42, v42, v152
    v_dot2_f32_bf16 v151, v43, v158, v151
    v_dot2_f32_bf16 v153, v43, v43, v153
    v_dot2_f32_bf16 v150, v44, v158, v150
    v_dot2_f32_bf16 v152, v44, v44, v152
    v_dot2_f32_bf16 v151, v45, v158, v151
    v_dot2_f32_bf16 v153, v45, v45, v153
    v_dot2_f32_bf16 v150, v46, v158, v150
    v_dot2_f32_bf16 v152, v46, v46, v152
    v_dot2_f32_bf16 v151, v47, v158, v151
    v_dot2_f32_bf16 v153, v47, v47, v153
    v_dot2_f32_bf16 v150, v48, v158, v150
    v_dot2_f32_bf16 v152, v48, v48, v152
    v_dot2_f32_bf16 v151, v49, v158, v151
    v_dot2_f32_bf16 v153, v49, v49, v153
    v_dot2_f32_bf16 v150, v50, v158, v150
    v_dot2_f32_bf16 v152, v50, v50, v152
    v_dot2_f32_bf16 v151, v51, v158, v151
    v_dot2_f32_bf16 v153, v51, v51, v153
    v_dot2_f32_bf16 v150, v52, v158, v150
    v_dot2_f32_bf16 v152, v52, v52, v152
    v_dot2_f32_bf16 v151, v53, v158, v151
    v_dot2_f32_bf16 v153, v53, v53, v153
    v_dot2_f32_bf16 v150, v54, v158, v150
    v_dot2_f32_bf16 v152, v54, v54, v152
    v_dot2_f32_bf16 v151, v55, v158, v151
    v_dot2_f32_bf16 v153, v55, v55, v153
    v_dot2_f32_bf16 v150, v56, v158, v150
    v_dot2_f32_bf16 v152, v56, v56, v152
    v_dot2_f32_bf16 v151, v57, v158, v151
    v_dot2_f32_bf16 v153, v57, v57, v153
    v_dot2_f32_bf16 v150, v58, v158, v150
    v_dot2_f32_bf16 v152, v58, v58, v152
    v_dot2_f32_bf16 v151, v59, v158, v151
    v_dot2_f32_bf16 v153, v59, v59, v153
    v_dot2_f32_bf16 v150, v60, v158, v150
    v_dot2_f32_bf16 v152, v60, v60, v152
    v_dot2_f32_bf16 v151, v61, v158, v151
    v_dot2_f32_bf16 v153, v61, v61, v153
    v_dot2_f32_bf16 v150, v62, v158, v150
    v_dot2_f32_bf16 v152, v62, v62, v152
    v_dot2_f32_bf16 v151, v63, v158, v151
    v_dot2_f32_bf16 v153, v63, v63, v153
    s_nop 1
    v_add_f32 v150, v150, v151
    v_add_f32 v152, v152, v153
    v_mov_b32 v157, v150
    s_nop 1
    v_permlane32_swap_b32 v157, v150
    v_add_f32 v150, v157, v150
    v_mov_b32 v157, v150
    s_nop 1
    v_permlane16_swap_b32 v157, v150
    v_add_f32 v150, v157, v150
    v_mov_b32 v157, v152
    s_nop 1
    v_permlane32_swap_b32 v157, v152
    v_add_f32 v152, v157, v152
    v_mov_b32 v157, v152
    s_nop 1
    v_permlane16_swap_b32 v157, v152
    v_add_f32 v152, v157, v152
    v_mul_f32 v150, 0x3b000000, v150
    v_cvt_pk_bf16_f32 v154, v150, v150
    v_and_b32 v154, 0xffff0000, v154
    v_sub_f32 v156, v150, v154
    v_mul_f32 v157, v150, v150
    v_mul_f32 v152, 0x3b000000, v152
    v_sub_f32 v152, v152, v157
    v_max_f32 v152, 0, v152
    v_cvt_pk_bf16_f32 v152, v152, v152
    v_and_b32 v152, 0xffff0000, v152
    v_add_f32 v152, 0x3727c5ac, v152
    v_cvt_pk_bf16_f32 v152, v152, v152
    v_and_b32 v152, 0xffff0000, v152
    v_sqrt_f32 v152, v152
    s_nop 0
    v_cvt_pk_bf16_f32 v152, v152, v152
    v_and_b32 v152, 0xffff0000, v152
    v_rcp_f32 v152, v152
    v_lshlrev_b32 v160, 16, v0
    v_and_b32 v161, 0xffff0000, v0
    v_lshlrev_b32 v162, 16, v1
    v_and_b32 v163, 0xffff0000, v1
    v_lshlrev_b32 v164, 16, v2
    v_and_b32 v165, 0xffff0000, v2
    v_lshlrev_b32 v166, 16, v3
    v_and_b32 v167, 0xffff0000, v3
    v_lshlrev_b32 v168, 16, v4
    v_and_b32 v169, 0xffff0000, v4
    v_lshlrev_b32 v170, 16, v5
    v_and_b32 v171, 0xffff0000, v5
    v_lshlrev_b32 v172, 16, v6
    v_and_b32 v173, 0xffff0000, v6
    v_lshlrev_b32 v174, 16, v7
    v_and_b32 v175, 0xffff0000, v7
    v_pk_add_f32 v[160:161], v[160:161], v[154:155] op_sel_hi:[1,0] neg_lo:[0,1] neg_hi:[0,1]
    v_pk_add_f32 v[162:163], v[162:163], v[154:155] op_sel_hi:[1,0] neg_lo:[0,1] neg_hi:[0,1]
    v_pk_add_f32 v[164:165], v[164:165], v[154:155] op_sel_hi:[1,0] neg_lo:[0,1] neg_hi:[0,1]
    v_pk_add_f32 v[166:167], v[166:167], v[154:155] op_sel_hi:[1,0] neg_lo:[0,1] neg_hi:[0,1]
    v_pk_add_f32 v[168:169], v[168:169], v[154:155] op_sel_hi:[1,0] neg_lo:[0,1] neg_hi:[0,1]
    v_pk_add_f32 v[170:171], v[170:171], v[154:155] op_sel_hi:[1,0] neg_lo:[0,1] neg_hi:[0,1]
    v_pk_add_f32 v[172:173], v[172:173], v[154:155] op_sel_hi:[1,0] neg_lo:[0,1] neg_hi:[0,1]
    v_pk_add_f32 v[174:175], v[174:175], v[154:155] op_sel_hi:[1,0] neg_lo:[0,1] neg_hi:[0,1]
    v_cvt_pk_bf16_f32 v0, v160, v161
    v_cvt_pk_bf16_f32 v1, v162, v163
    v_cvt_pk_bf16_f32 v2, v164, v165
    v_cvt_pk_bf16_f32 v3, v166, v167
    v_cvt_pk_bf16_f32 v4, v168, v169
    v_cvt_pk_bf16_f32 v5, v170, v171
    v_cvt_pk_bf16_f32 v6, v172, v173
    v_cvt_pk_bf16_f32 v7, v174, v175
    v_lshlrev_b32 v160, 16, v0
    v_and_b32 v161, 0xffff0000, v0
    v_lshlrev_b32 v162, 16, v1
    v_and_b32 v163, 0xffff0000, v1
    v_lshlrev_b32 v164, 16, v2
    v_and_b32 v165, 0xffff0000, v2
    v_lshlrev_b32 v166, 16, v3
    v_and_b32 v167, 0xffff0000, v3
    v_lshlrev_b32 v168, 16, v4
    v_and_b32 v169, 0xffff0000, v4
    v_lshlrev_b32 v170, 16, v5
    v_and_b32 v171, 0xffff0000, v5
    v_lshlrev_b32 v172, 16, v6
    v_and_b32 v173, 0xffff0000, v6
    v_lshlrev_b32 v174, 16, v7
    v_and_b32 v175, 0xffff0000, v7
    v_pk_mul_f32 v[160:161], v[160:161], v[152:153] op_sel_hi:[1,0]
    v_pk_mul_f32 v[162:163], v[162:163], v[152:153] op_sel_hi:[1,0]
    v_pk_mul_f32 v[164:165], v[164:165], v[152:153] op_sel_hi:[1,0]
    v_pk_mul_f32 v[166:167], v[166:167], v[152:153] op_sel_hi:[1,0]
    v_pk_mul_f32 v[168:169], v[168:169], v[152:153] op_sel_hi:[1,0]
    v_pk_mul_f32 v[170:171], v[170:171], v[152:153] op_sel_hi:[1,0]
    v_pk_mul_f32 v[172:173], v[172:173], v[152:153] op_sel_hi:[1,0]
    v_pk_mul_f32 v[174:175], v[174:175], v[152:153] op_sel_hi:[1,0]
    v_cvt_pk_bf16_f32 v160, v160, v161
    v_cvt_pk_bf16_f32 v162, v162, v163
    v_cvt_pk_bf16_f32 v164, v164, v165
    v_cvt_pk_bf16_f32 v166, v166, v167
    v_cvt_pk_bf16_f32 v168, v168, v169
    v_cvt_pk_bf16_f32 v170, v170, v171
    v_cvt_pk_bf16_f32 v172, v172, v173
    v_cvt_pk_bf16_f32 v174, v174, v175
    v_accvgpr_write_b32 a0, v160
    v_accvgpr_write_b32 a1, v162
    v_accvgpr_write_b32 a2, v164
    v_accvgpr_write_b32 a3, v166
    v_accvgpr_write_b32 a4, v168
    v_accvgpr_write_b32 a5, v170
    v_accvgpr_write_b32 a6, v172
    v_accvgpr_write_b32 a7, v174
    v_lshlrev_b32 v160, 16, v8
    v_and_b32 v161, 0xffff0000, v8
    v_lshlrev_b32 v162, 16, v9
    v_and_b32 v163, 0xffff0000, v9
    v_lshlrev_b32 v164, 16, v10
    v_and_b32 v165, 0xffff0000, v10
    v_lshlrev_b32 v166, 16, v11
    v_and_b32 v167, 0xffff0000, v11
    v_lshlrev_b32 v168, 16, v12
    v_and_b32 v169, 0xffff0000, v12
    v_lshlrev_b32 v170, 16, v13
    v_and_b32 v171, 0xffff0000, v13
    v_lshlrev_b32 v172, 16, v14
    v_and_b32 v173, 0xffff0000, v14
    v_lshlrev_b32 v174, 16, v15
    v_and_b32 v175, 0xffff0000, v15
    v_pk_add_f32 v[160:161], v[160:161], v[154:155] op_sel_hi:[1,0] neg_lo:[0,1] neg_hi:[0,1]
    v_pk_add_f32 v[162:163], v[162:163], v[154:155] op_sel_hi:[1,0] neg_lo:[0,1] neg_hi:[0,1]
    v_pk_add_f32 v[164:165], v[164:165], v[154:155] op_sel_hi:[1,0] neg_lo:[0,1] neg_hi:[0,1]
    v_pk_add_f32 v[166:167], v[166:167], v[154:155] op_sel_hi:[1,0] neg_lo:[0,1] neg_hi:[0,1]
    v_pk_add_f32 v[168:169], v[168:169], v[154:155] op_sel_hi:[1,0] neg_lo:[0,1] neg_hi:[0,1]
    v_pk_add_f32 v[170:171], v[170:171], v[154:155] op_sel_hi:[1,0] neg_lo:[0,1] neg_hi:[0,1]
    v_pk_add_f32 v[172:173], v[172:173], v[154:155] op_sel_hi:[1,0] neg_lo:[0,1] neg_hi:[0,1]
    v_pk_add_f32 v[174:175], v[174:175], v[154:155] op_sel_hi:[1,0] neg_lo:[0,1] neg_hi:[0,1]
    v_cvt_pk_bf16_f32 v8, v160, v161
    v_cvt_pk_bf16_f32 v9, v162, v163
    v_cvt_pk_bf16_f32 v10, v164, v165
    v_cvt_pk_bf16_f32 v11, v166, v167
    v_cvt_pk_bf16_f32 v12, v168, v169
    v_cvt_pk_bf16_f32 v13, v170, v171
    v_cvt_pk_bf16_f32 v14, v172, v173
    v_cvt_pk_bf16_f32 v15, v174, v175
    v_lshlrev_b32 v160, 16, v8
    v_and_b32 v161, 0xffff0000, v8
    v_lshlrev_b32 v162, 16, v9
    v_and_b32 v163, 0xffff0000, v9
    v_lshlrev_b32 v164, 16, v10
    v_and_b32 v165, 0xffff0000, v10
    v_lshlrev_b32 v166, 16, v11
    v_and_b32 v167, 0xffff0000, v11
    v_lshlrev_b32 v168, 16, v12
    v_and_b32 v169, 0xffff0000, v12
    v_lshlrev_b32 v170, 16, v13
    v_and_b32 v171, 0xffff0000, v13
    v_lshlrev_b32 v172, 16, v14
    v_and_b32 v173, 0xffff0000, v14
    v_lshlrev_b32 v174, 16, v15
    v_and_b32 v175, 0xffff0000, v15
    v_pk_mul_f32 v[160:161], v[160:161], v[152:153] op_sel_hi:[1,0]
    v_pk_mul_f32 v[162:163], v[162:163], v[152:153] op_sel_hi:[1,0]
    v_pk_mul_f32 v[164:165], v[164:165], v[152:153] op_sel_hi:[1,0]
    v_pk_mul_f32 v[166:167], v[166:167], v[152:153] op_sel_hi:[1,0]
    v_pk_mul_f32 v[168:169], v[168:169], v[152:153] op_sel_hi:[1,0]
    v_pk_mul_f32 v[170:171], v[170:171], v[152:153] op_sel_hi:[1,0]
    v_pk_mul_f32 v[172:173], v[172:173], v[152:153] op_sel_hi:[1,0]
    v_pk_mul_f32 v[174:175], v[174:175], v[152:153] op_sel_hi:[1,0]
    v_cvt_pk_bf16_f32 v160, v160, v161
    v_cvt_pk_bf16_f32 v162, v162, v163
    v_cvt_pk_bf16_f32 v164, v164, v165
    v_cvt_pk_bf16_f32 v166, v166, v167
    v_cvt_pk_bf16_f32 v168, v168, v169
    v_cvt_pk_bf16_f32 v170, v170, v171
    v_cvt_pk_bf16_f32 v172, v172, v173
    v_cvt_pk_bf16_f32 v174, v174, v175
    v_accvgpr_write_b32 a8, v160
    v_accvgpr_write_b32 a9, v162
    v_accvgpr_write_b32 a10, v164
    v_accvgpr_write_b32 a11, v166
    v_accvgpr_write_b32 a12, v168
    v_accvgpr_write_b32 a13, v170
    v_accvgpr_write_b32 a14, v172
    v_accvgpr_write_b32 a15, v174
    v_lshlrev_b32 v160, 16, v16
    v_and_b32 v161, 0xffff0000, v16
    v_lshlrev_b32 v162, 16, v17
    v_and_b32 v163, 0xffff0000, v17
    v_lshlrev_b32 v164, 16, v18
    v_and_b32 v165, 0xffff0000, v18
    v_lshlrev_b32 v166, 16, v19
    v_and_b32 v167, 0xffff0000, v19
    v_lshlrev_b32 v168, 16, v20
    v_and_b32 v169, 0xffff0000, v20
    v_lshlrev_b32 v170, 16, v21
    v_and_b32 v171, 0xffff0000, v21
    v_lshlrev_b32 v172, 16, v22
    v_and_b32 v173, 0xffff0000, v22
    v_lshlrev_b32 v174, 16, v23
    v_and_b32 v175, 0xffff0000, v23
    v_pk_add_f32 v[160:161], v[160:161], v[154:155] op_sel_hi:[1,0] neg_lo:[0,1] neg_hi:[0,1]
    v_pk_add_f32 v[162:163], v[162:163], v[154:155] op_sel_hi:[1,0] neg_lo:[0,1] neg_hi:[0,1]
    v_pk_add_f32 v[164:165], v[164:165], v[154:155] op_sel_hi:[1,0] neg_lo:[0,1] neg_hi:[0,1]
    v_pk_add_f32 v[166:167], v[166:167], v[154:155] op_sel_hi:[1,0] neg_lo:[0,1] neg_hi:[0,1]
    v_pk_add_f32 v[168:169], v[168:169], v[154:155] op_sel_hi:[1,0] neg_lo:[0,1] neg_hi:[0,1]
    v_pk_add_f32 v[170:171], v[170:171], v[154:155] op_sel_hi:[1,0] neg_lo:[0,1] neg_hi:[0,1]
    v_pk_add_f32 v[172:173], v[172:173], v[154:155] op_sel_hi:[1,0] neg_lo:[0,1] neg_hi:[0,1]
    v_pk_add_f32 v[174:175], v[174:175], v[154:155] op_sel_hi:[1,0] neg_lo:[0,1] neg_hi:[0,1]
    v_cvt_pk_bf16_f32 v16, v160, v161
    v_cvt_pk_bf16_f32 v17, v162, v163
    v_cvt_pk_bf16_f32 v18, v164, v165
    v_cvt_pk_bf16_f32 v19, v166, v167
    v_cvt_pk_bf16_f32 v20, v168, v169
    v_cvt_pk_bf16_f32 v21, v170, v171
    v_cvt_pk_bf16_f32 v22, v172, v173
    v_cvt_pk_bf16_f32 v23, v174, v175
    v_lshlrev_b32 v160, 16, v16
    v_and_b32 v161, 0xffff0000, v16
    v_lshlrev_b32 v162, 16, v17
    v_and_b32 v163, 0xffff0000, v17
    v_lshlrev_b32 v164, 16, v18
    v_and_b32 v165, 0xffff0000, v18
    v_lshlrev_b32 v166, 16, v19
    v_and_b32 v167, 0xffff0000, v19
    v_lshlrev_b32 v168, 16, v20
    v_and_b32 v169, 0xffff0000, v20
    v_lshlrev_b32 v170, 16, v21
    v_and_b32 v171, 0xffff0000, v21
    v_lshlrev_b32 v172, 16, v22
    v_and_b32 v173, 0xffff0000, v22
    v_lshlrev_b32 v174, 16, v23
    v_and_b32 v175, 0xffff0000, v23
    v_pk_mul_f32 v[160:161], v[160:161], v[152:153] op_sel_hi:[1,0]
    v_pk_mul_f32 v[162:163], v[162:163], v[152:153] op_sel_hi:[1,0]
    v_pk_mul_f32 v[164:165], v[164:165], v[152:153] op_sel_hi:[1,0]
    v_pk_mul_f32 v[166:167], v[166:167], v[152:153] op_sel_hi:[1,0]
    v_pk_mul_f32 v[168:169], v[168:169], v[152:153] op_sel_hi:[1,0]
    v_pk_mul_f32 v[170:171], v[170:171], v[152:153] op_sel_hi:[1,0]
    v_pk_mul_f32 v[172:173], v[172:173], v[152:153] op_sel_hi:[1,0]
    v_pk_mul_f32 v[174:175], v[174:175], v[152:153] op_sel_hi:[1,0]
    v_cvt_pk_bf16_f32 v160, v160, v161
    v_cvt_pk_bf16_f32 v162, v162, v163
    v_cvt_pk_bf16_f32 v164, v164, v165
    v_cvt_pk_bf16_f32 v166, v166, v167
    v_cvt_pk_bf16_f32 v168, v168, v169
    v_cvt_pk_bf16_f32 v170, v170, v171
    v_cvt_pk_bf16_f32 v172, v172, v173
    v_cvt_pk_bf16_f32 v174, v174, v175
    v_accvgpr_write_b32 a16, v160
    v_accvgpr_write_b32 a17, v162
    v_accvgpr_write_b32 a18, v164
    v_accvgpr_write_b32 a19, v166
    v_accvgpr_write_b32 a20, v168
    v_accvgpr_write_b32 a21, v170
    v_accvgpr_write_b32 a22, v172
    v_accvgpr_write_b32 a23, v174
    v_lshlrev_b32 v160, 16, v24
    v_and_b32 v161, 0xffff0000, v24
    v_lshlrev_b32 v162, 16, v25
    v_and_b32 v163, 0xffff0000, v25
    v_lshlrev_b32 v164, 16, v26
    v_and_b32 v165, 0xffff0000, v26
    v_lshlrev_b32 v166, 16, v27
    v_and_b32 v167, 0xffff0000, v27
    v_lshlrev_b32 v168, 16, v28
    v_and_b32 v169, 0xffff0000, v28
    v_lshlrev_b32 v170, 16, v29
    v_and_b32 v171, 0xffff0000, v29
    v_lshlrev_b32 v172, 16, v30
    v_and_b32 v173, 0xffff0000, v30
    v_lshlrev_b32 v174, 16, v31
    v_and_b32 v175, 0xffff0000, v31
    v_pk_add_f32 v[160:161], v[160:161], v[154:155] op_sel_hi:[1,0] neg_lo:[0,1] neg_hi:[0,1]
    v_pk_add_f32 v[162:163], v[162:163], v[154:155] op_sel_hi:[1,0] neg_lo:[0,1] neg_hi:[0,1]
    v_pk_add_f32 v[164:165], v[164:165], v[154:155] op_sel_hi:[1,0] neg_lo:[0,1] neg_hi:[0,1]
    v_pk_add_f32 v[166:167], v[166:167], v[154:155] op_sel_hi:[1,0] neg_lo:[0,1] neg_hi:[0,1]
    v_pk_add_f32 v[168:169], v[168:169], v[154:155] op_sel_hi:[1,0] neg_lo:[0,1] neg_hi:[0,1]
    v_pk_add_f32 v[170:171], v[170:171], v[154:155] op_sel_hi:[1,0] neg_lo:[0,1] neg_hi:[0,1]
    v_pk_add_f32 v[172:173], v[172:173], v[154:155] op_sel_hi:[1,0] neg_lo:[0,1] neg_hi:[0,1]
    v_pk_add_f32 v[174:175], v[174:175], v[154:155] op_sel_hi:[1,0] neg_lo:[0,1] neg_hi:[0,1]
    v_cvt_pk_bf16_f32 v24, v160, v161
    v_cvt_pk_bf16_f32 v25, v162, v163
    v_cvt_pk_bf16_f32 v26, v164, v165
    v_cvt_pk_bf16_f32 v27, v166, v167
    v_cvt_pk_bf16_f32 v28, v168, v169
    v_cvt_pk_bf16_f32 v29, v170, v171
    v_cvt_pk_bf16_f32 v30, v172, v173
    v_cvt_pk_bf16_f32 v31, v174, v175
    v_lshlrev_b32 v160, 16, v24
    v_and_b32 v161, 0xffff0000, v24
    v_lshlrev_b32 v162, 16, v25
    v_and_b32 v163, 0xffff0000, v25
    v_lshlrev_b32 v164, 16, v26
    v_and_b32 v165, 0xffff0000, v26
    v_lshlrev_b32 v166, 16, v27
    v_and_b32 v167, 0xffff0000, v27
    v_lshlrev_b32 v168, 16, v28
    v_and_b32 v169, 0xffff0000, v28
    v_lshlrev_b32 v170, 16, v29
    v_and_b32 v171, 0xffff0000, v29
    v_lshlrev_b32 v172, 16, v30
    v_and_b32 v173, 0xffff0000, v30
    v_lshlrev_b32 v174, 16, v31
    v_and_b32 v175, 0xffff0000, v31
    v_pk_mul_f32 v[160:161], v[160:161], v[152:153] op_sel_hi:[1,0]
    v_pk_mul_f32 v[162:163], v[162:163], v[152:153] op_sel_hi:[1,0]
    v_pk_mul_f32 v[164:165], v[164:165], v[152:153] op_sel_hi:[1,0]
    v_pk_mul_f32 v[166:167], v[166:167], v[152:153] op_sel_hi:[1,0]
    v_pk_mul_f32 v[168:169], v[168:169], v[152:153] op_sel_hi:[1,0]
    v_pk_mul_f32 v[170:171], v[170:171], v[152:153] op_sel_hi:[1,0]
    v_pk_mul_f32 v[172:173], v[172:173], v[152:153] op_sel_hi:[1,0]
    v_pk_mul_f32 v[174:175], v[174:175], v[152:153] op_sel_hi:[1,0]
    v_cvt_pk_bf16_f32 v160, v160, v161
    v_cvt_pk_bf16_f32 v162, v162, v163
    v_cvt_pk_bf16_f32 v164, v164, v165
    v_cvt_pk_bf16_f32 v166, v166, v167
    v_cvt_pk_bf16_f32 v168, v168, v169
    v_cvt_pk_bf16_f32 v170, v170, v171
    v_cvt_pk_bf16_f32 v172, v172, v173
    v_cvt_pk_bf16_f32 v174, v174, v175
    v_accvgpr_write_b32 a24, v160
    v_accvgpr_write_b32 a25, v162
    v_accvgpr_write_b32 a26, v164
    v_accvgpr_write_b32 a27, v166
    v_accvgpr_write_b32 a28, v168
    v_accvgpr_write_b32 a29, v170
    v_accvgpr_write_b32 a30, v172
    v_accvgpr_write_b32 a31, v174
    v_lshlrev_b32 v160, 16, v32
    v_and_b32 v161, 0xffff0000, v32
    v_lshlrev_b32 v162, 16, v33
    v_and_b32 v163, 0xffff0000, v33
    v_lshlrev_b32 v164, 16, v34
    v_and_b32 v165, 0xffff0000, v34
    v_lshlrev_b32 v166, 16, v35
    v_and_b32 v167, 0xffff0000, v35
    v_lshlrev_b32 v168, 16, v36
    v_and_b32 v169, 0xffff0000, v36
    v_lshlrev_b32 v170, 16, v37
    v_and_b32 v171, 0xffff0000, v37
    v_lshlrev_b32 v172, 16, v38
    v_and_b32 v173, 0xffff0000, v38
    v_lshlrev_b32 v174, 16, v39
    v_and_b32 v175, 0xffff0000, v39
    v_pk_add_f32 v[160:161], v[160:161], v[154:155] op_sel_hi:[1,0] neg_lo:[0,1] neg_hi:[0,1]
    v_pk_add_f32 v[162:163], v[162:163], v[154:155] op_sel_hi:[1,0] neg_lo:[0,1] neg_hi:[0,1]
    v_pk_add_f32 v[164:165], v[164:165], v[154:155] op_sel_hi:[1,0] neg_lo:[0,1] neg_hi:[0,1]
    v_pk_add_f32 v[166:167], v[166:167], v[154:155] op_sel_hi:[1,0] neg_lo:[0,1] neg_hi:[0,1]
    v_pk_add_f32 v[168:169], v[168:169], v[154:155] op_sel_hi:[1,0] neg_lo:[0,1] neg_hi:[0,1]
    v_pk_add_f32 v[170:171], v[170:171], v[154:155] op_sel_hi:[1,0] neg_lo:[0,1] neg_hi:[0,1]
    v_pk_add_f32 v[172:173], v[172:173], v[154:155] op_sel_hi:[1,0] neg_lo:[0,1] neg_hi:[0,1]
    v_pk_add_f32 v[174:175], v[174:175], v[154:155] op_sel_hi:[1,0] neg_lo:[0,1] neg_hi:[0,1]
    v_cvt_pk_bf16_f32 v32, v160, v161
    v_cvt_pk_bf16_f32 v33, v162, v163
    v_cvt_pk_bf16_f32 v34, v164, v165
    v_cvt_pk_bf16_f32 v35, v166, v167
    v_cvt_pk_bf16_f32 v36, v168, v169
    v_cvt_pk_bf16_f32 v37, v170, v171
    v_cvt_pk_bf16_f32 v38, v172, v173
    v_cvt_pk_bf16_f32 v39, v174, v175
    v_lshlrev_b32 v160, 16, v32
    v_and_b32 v161, 0xffff0000, v32
    v_lshlrev_b32 v162, 16, v33
    v_and_b32 v163, 0xffff0000, v33
    v_lshlrev_b32 v164, 16, v34
    v_and_b32 v165, 0xffff0000, v34
    v_lshlrev_b32 v166, 16, v35
    v_and_b32 v167, 0xffff0000, v35
    v_lshlrev_b32 v168, 16, v36
    v_and_b32 v169, 0xffff0000, v36
    v_lshlrev_b32 v170, 16, v37
    v_and_b32 v171, 0xffff0000, v37
    v_lshlrev_b32 v172, 16, v38
    v_and_b32 v173, 0xffff0000, v38
    v_lshlrev_b32 v174, 16, v39
    v_and_b32 v175, 0xffff0000, v39
    v_pk_mul_f32 v[160:161], v[160:161], v[152:153] op_sel_hi:[1,0]
    v_pk_mul_f32 v[162:163], v[162:163], v[152:153] op_sel_hi:[1,0]
    v_pk_mul_f32 v[164:165], v[164:165], v[152:153] op_sel_hi:[1,0]
    v_pk_mul_f32 v[166:167], v[166:167], v[152:153] op_sel_hi:[1,0]
    v_pk_mul_f32 v[168:169], v[168:169], v[152:153] op_sel_hi:[1,0]
    v_pk_mul_f32 v[170:171], v[170:171], v[152:153] op_sel_hi:[1,0]
    v_pk_mul_f32 v[172:173], v[172:173], v[152:153] op_sel_hi:[1,0]
    v_pk_mul_f32 v[174:175], v[174:175], v[152:153] op_sel_hi:[1,0]
    v_cvt_pk_bf16_f32 v160, v160, v161
    v_cvt_pk_bf16_f32 v162, v162, v163
    v_cvt_pk_bf16_f32 v164, v164, v165
    v_cvt_pk_bf16_f32 v166, v166, v167
    v_cvt_pk_bf16_f32 v168, v168, v169
    v_cvt_pk_bf16_f32 v170, v170, v171
    v_cvt_pk_bf16_f32 v172, v172, v173
    v_cvt_pk_bf16_f32 v174, v174, v175
    v_accvgpr_write_b32 a32, v160
    v_accvgpr_write_b32 a33, v162
    v_accvgpr_write_b32 a34, v164
    v_accvgpr_write_b32 a35, v166
    v_accvgpr_write_b32 a36, v168
    v_accvgpr_write_b32 a37, v170
    v_accvgpr_write_b32 a38, v172
    v_accvgpr_write_b32 a39, v174
    v_lshlrev_b32 v160, 16, v40
    v_and_b32 v161, 0xffff0000, v40
    v_lshlrev_b32 v162, 16, v41
    v_and_b32 v163, 0xffff0000, v41
    v_lshlrev_b32 v164, 16, v42
    v_and_b32 v165, 0xffff0000, v42
    v_lshlrev_b32 v166, 16, v43
    v_and_b32 v167, 0xffff0000, v43
    v_lshlrev_b32 v168, 16, v44
    v_and_b32 v169, 0xffff0000, v44
    v_lshlrev_b32 v170, 16, v45
    v_and_b32 v171, 0xffff0000, v45
    v_lshlrev_b32 v172, 16, v46
    v_and_b32 v173, 0xffff0000, v46
    v_lshlrev_b32 v174, 16, v47
    v_and_b32 v175, 0xffff0000, v47
    v_pk_add_f32 v[160:161], v[160:161], v[154:155] op_sel_hi:[1,0] neg_lo:[0,1] neg_hi:[0,1]
    v_pk_add_f32 v[162:163], v[162:163], v[154:155] op_sel_hi:[1,0] neg_lo:[0,1] neg_hi:[0,1]
    v_pk_add_f32 v[164:165], v[164:165], v[154:155] op_sel_hi:[1,0] neg_lo:[0,1] neg_hi:[0,1]
    v_pk_add_f32 v[166:167], v[166:167], v[154:155] op_sel_hi:[1,0] neg_lo:[0,1] neg_hi:[0,1]
    v_pk_add_f32 v[168:169], v[168:169], v[154:155] op_sel_hi:[1,0] neg_lo:[0,1] neg_hi:[0,1]
    v_pk_add_f32 v[170:171], v[170:171], v[154:155] op_sel_hi:[1,0] neg_lo:[0,1] neg_hi:[0,1]
    v_pk_add_f32 v[172:173], v[172:173], v[154:155] op_sel_hi:[1,0] neg_lo:[0,1] neg_hi:[0,1]
    v_pk_add_f32 v[174:175], v[174:175], v[154:155] op_sel_hi:[1,0] neg_lo:[0,1] neg_hi:[0,1]
    v_cvt_pk_bf16_f32 v40, v160, v161
    v_cvt_pk_bf16_f32 v41, v162, v163
    v_cvt_pk_bf16_f32 v42, v164, v165
    v_cvt_pk_bf16_f32 v43, v166, v167
    v_cvt_pk_bf16_f32 v44, v168, v169
    v_cvt_pk_bf16_f32 v45, v170, v171
    v_cvt_pk_bf16_f32 v46, v172, v173
    v_cvt_pk_bf16_f32 v47, v174, v175
    v_lshlrev_b32 v160, 16, v40
    v_and_b32 v161, 0xffff0000, v40
    v_lshlrev_b32 v162, 16, v41
    v_and_b32 v163, 0xffff0000, v41
    v_lshlrev_b32 v164, 16, v42
    v_and_b32 v165, 0xffff0000, v42
    v_lshlrev_b32 v166, 16, v43
    v_and_b32 v167, 0xffff0000, v43
    v_lshlrev_b32 v168, 16, v44
    v_and_b32 v169, 0xffff0000, v44
    v_lshlrev_b32 v170, 16, v45
    v_and_b32 v171, 0xffff0000, v45
    v_lshlrev_b32 v172, 16, v46
    v_and_b32 v173, 0xffff0000, v46
    v_lshlrev_b32 v174, 16, v47
    v_and_b32 v175, 0xffff0000, v47
    v_pk_mul_f32 v[160:161], v[160:161], v[152:153] op_sel_hi:[1,0]
    v_pk_mul_f32 v[162:163], v[162:163], v[152:153] op_sel_hi:[1,0]
    v_pk_mul_f32 v[164:165], v[164:165], v[152:153] op_sel_hi:[1,0]
    v_pk_mul_f32 v[166:167], v[166:167], v[152:153] op_sel_hi:[1,0]
    v_pk_mul_f32 v[168:169], v[168:169], v[152:153] op_sel_hi:[1,0]
    v_pk_mul_f32 v[170:171], v[170:171], v[152:153] op_sel_hi:[1,0]
    v_pk_mul_f32 v[172:173], v[172:173], v[152:153] op_sel_hi:[1,0]
    v_pk_mul_f32 v[174:175], v[174:175], v[152:153] op_sel_hi:[1,0]
    v_cvt_pk_bf16_f32 v160, v160, v161
    v_cvt_pk_bf16_f32 v162, v162, v163
    v_cvt_pk_bf16_f32 v164, v164, v165
    v_cvt_pk_bf16_f32 v166, v166, v167
    v_cvt_pk_bf16_f32 v168, v168, v169
    v_cvt_pk_bf16_f32 v170, v170, v171
    v_cvt_pk_bf16_f32 v172, v172, v173
    v_cvt_pk_bf16_f32 v174, v174, v175
    v_accvgpr_write_b32 a40, v160
    v_accvgpr_write_b32 a41, v162
    v_accvgpr_write_b32 a42, v164
    v_accvgpr_write_b32 a43, v166
    v_accvgpr_write_b32 a44, v168
    v_accvgpr_write_b32 a45, v170
    v_accvgpr_write_b32 a46, v172
    v_accvgpr_write_b32 a47, v174
    v_lshlrev_b32 v160, 16, v48
    v_and_b32 v161, 0xffff0000, v48
    v_lshlrev_b32 v162, 16, v49
    v_and_b32 v163, 0xffff0000, v49
    v_lshlrev_b32 v164, 16, v50
    v_and_b32 v165, 0xffff0000, v50
    v_lshlrev_b32 v166, 16, v51
    v_and_b32 v167, 0xffff0000, v51
    v_lshlrev_b32 v168, 16, v52
    v_and_b32 v169, 0xffff0000, v52
    v_lshlrev_b32 v170, 16, v53
    v_and_b32 v171, 0xffff0000, v53
    v_lshlrev_b32 v172, 16, v54
    v_and_b32 v173, 0xffff0000, v54
    v_lshlrev_b32 v174, 16, v55
    v_and_b32 v175, 0xffff0000, v55
    v_pk_add_f32 v[160:161], v[160:161], v[154:155] op_sel_hi:[1,0] neg_lo:[0,1] neg_hi:[0,1]
    v_pk_add_f32 v[162:163], v[162:163], v[154:155] op_sel_hi:[1,0] neg_lo:[0,1] neg_hi:[0,1]
    v_pk_add_f32 v[164:165], v[164:165], v[154:155] op_sel_hi:[1,0] neg_lo:[0,1] neg_hi:[0,1]
    v_pk_add_f32 v[166:167], v[166:167], v[154:155] op_sel_hi:[1,0] neg_lo:[0,1] neg_hi:[0,1]
    v_pk_add_f32 v[168:169], v[168:169], v[154:155] op_sel_hi:[1,0] neg_lo:[0,1] neg_hi:[0,1]
    v_pk_add_f32 v[170:171], v[170:171], v[154:155] op_sel_hi:[1,0] neg_lo:[0,1] neg_hi:[0,1]
    v_pk_add_f32 v[172:173], v[172:173], v[154:155] op_sel_hi:[1,0] neg_lo:[0,1] neg_hi:[0,1]
    v_pk_add_f32 v[174:175], v[174:175], v[154:155] op_sel_hi:[1,0] neg_lo:[0,1] neg_hi:[0,1]
    v_cvt_pk_bf16_f32 v48, v160, v161
    v_cvt_pk_bf16_f32 v49, v162, v163
    v_cvt_pk_bf16_f32 v50, v164, v165
    v_cvt_pk_bf16_f32 v51, v166, v167
    v_cvt_pk_bf16_f32 v52, v168, v169
    v_cvt_pk_bf16_f32 v53, v170, v171
    v_cvt_pk_bf16_f32 v54, v172, v173
    v_cvt_pk_bf16_f32 v55, v174, v175
    v_lshlrev_b32 v160, 16, v48
    v_and_b32 v161, 0xffff0000, v48
    v_lshlrev_b32 v162, 16, v49
    v_and_b32 v163, 0xffff0000, v49
    v_lshlrev_b32 v164, 16, v50
    v_and_b32 v165, 0xffff0000, v50
    v_lshlrev_b32 v166, 16, v51
    v_and_b32 v167, 0xffff0000, v51
    v_lshlrev_b32 v168, 16, v52
    v_and_b32 v169, 0xffff0000, v52
    v_lshlrev_b32 v170, 16, v53
    v_and_b32 v171, 0xffff0000, v53
    v_lshlrev_b32 v172, 16, v54
    v_and_b32 v173, 0xffff0000, v54
    v_lshlrev_b32 v174, 16, v55
    v_and_b32 v175, 0xffff0000, v55
    v_pk_mul_f32 v[160:161], v[160:161], v[152:153] op_sel_hi:[1,0]
    v_pk_mul_f32 v[162:163], v[162:163], v[152:153] op_sel_hi:[1,0]
    v_pk_mul_f32 v[164:165], v[164:165], v[152:153] op_sel_hi:[1,0]
    v_pk_mul_f32 v[166:167], v[166:167], v[152:153] op_sel_hi:[1,0]
    v_pk_mul_f32 v[168:169], v[168:169], v[152:153] op_sel_hi:[1,0]
    v_pk_mul_f32 v[170:171], v[170:171], v[152:153] op_sel_hi:[1,0]
    v_pk_mul_f32 v[172:173], v[172:173], v[152:153] op_sel_hi:[1,0]
    v_pk_mul_f32 v[174:175], v[174:175], v[152:153] op_sel_hi:[1,0]
    v_cvt_pk_bf16_f32 v160, v160, v161
    v_cvt_pk_bf16_f32 v162, v162, v163
    v_cvt_pk_bf16_f32 v164, v164, v165
    v_cvt_pk_bf16_f32 v166, v166, v167
    v_cvt_pk_bf16_f32 v168, v168, v169
    v_cvt_pk_bf16_f32 v170, v170, v171
    v_cvt_pk_bf16_f32 v172, v172, v173
    v_cvt_pk_bf16_f32 v174, v174, v175
    v_accvgpr_write_b32 a48, v160
    v_accvgpr_write_b32 a49, v162
    v_accvgpr_write_b32 a50, v164
    v_accvgpr_write_b32 a51, v166
    v_accvgpr_write_b32 a52, v168
    v_accvgpr_write_b32 a53, v170
    v_accvgpr_write_b32 a54, v172
    v_accvgpr_write_b32 a55, v174
    v_lshlrev_b32 v160, 16, v56
    v_and_b32 v161, 0xffff0000, v56
    v_lshlrev_b32 v162, 16, v57
    v_and_b32 v163, 0xffff0000, v57
    v_lshlrev_b32 v164, 16, v58
    v_and_b32 v165, 0xffff0000, v58
    v_lshlrev_b32 v166, 16, v59
    v_and_b32 v167, 0xffff0000, v59
    v_lshlrev_b32 v168, 16, v60
    v_and_b32 v169, 0xffff0000, v60
    v_lshlrev_b32 v170, 16, v61
    v_and_b32 v171, 0xffff0000, v61
    v_lshlrev_b32 v172, 16, v62
    v_and_b32 v173, 0xffff0000, v62
    v_lshlrev_b32 v174, 16, v63
    v_and_b32 v175, 0xffff0000, v63
    v_pk_add_f32 v[160:161], v[160:161], v[154:155] op_sel_hi:[1,0] neg_lo:[0,1] neg_hi:[0,1]
    v_pk_add_f32 v[162:163], v[162:163], v[154:155] op_sel_hi:[1,0] neg_lo:[0,1] neg_hi:[0,1]
    v_pk_add_f32 v[164:165], v[164:165], v[154:155] op_sel_hi:[1,0] neg_lo:[0,1] neg_hi:[0,1]
    v_pk_add_f32 v[166:167], v[166:167], v[154:155] op_sel_hi:[1,0] neg_lo:[0,1] neg_hi:[0,1]
    v_pk_add_f32 v[168:169], v[168:169], v[154:155] op_sel_hi:[1,0] neg_lo:[0,1] neg_hi:[0,1]
    v_pk_add_f32 v[170:171], v[170:171], v[154:155] op_sel_hi:[1,0] neg_lo:[0,1] neg_hi:[0,1]
    v_pk_add_f32 v[172:173], v[172:173], v[154:155] op_sel_hi:[1,0] neg_lo:[0,1] neg_hi:[0,1]
    v_pk_add_f32 v[174:175], v[174:175], v[154:155] op_sel_hi:[1,0] neg_lo:[0,1] neg_hi:[0,1]
    v_cvt_pk_bf16_f32 v56, v160, v161
    v_cvt_pk_bf16_f32 v57, v162, v163
    v_cvt_pk_bf16_f32 v58, v164, v165
    v_cvt_pk_bf16_f32 v59, v166, v167
    v_cvt_pk_bf16_f32 v60, v168, v169
    v_cvt_pk_bf16_f32 v61, v170, v171
    v_cvt_pk_bf16_f32 v62, v172, v173
    v_cvt_pk_bf16_f32 v63, v174, v175
    v_lshlrev_b32 v160, 16, v56
    v_and_b32 v161, 0xffff0000, v56
    v_lshlrev_b32 v162, 16, v57
    v_and_b32 v163, 0xffff0000, v57
    v_lshlrev_b32 v164, 16, v58
    v_and_b32 v165, 0xffff0000, v58
    v_lshlrev_b32 v166, 16, v59
    v_and_b32 v167, 0xffff0000, v59
    v_lshlrev_b32 v168, 16, v60
    v_and_b32 v169, 0xffff0000, v60
    v_lshlrev_b32 v170, 16, v61
    v_and_b32 v171, 0xffff0000, v61
    v_lshlrev_b32 v172, 16, v62
    v_and_b32 v173, 0xffff0000, v62
    v_lshlrev_b32 v174, 16, v63
    v_and_b32 v175, 0xffff0000, v63
    v_pk_mul_f32 v[160:161], v[160:161], v[152:153] op_sel_hi:[1,0]
    v_pk_mul_f32 v[162:163], v[162:163], v[152:153] op_sel_hi:[1,0]
    v_pk_mul_f32 v[164:165], v[164:165], v[152:153] op_sel_hi:[1,0]
    v_pk_mul_f32 v[166:167], v[166:167], v[152:153] op_sel_hi:[1,0]
    v_pk_mul_f32 v[168:169], v[168:169], v[152:153] op_sel_hi:[1,0]
    v_pk_mul_f32 v[170:171], v[170:171], v[152:153] op_sel_hi:[1,0]
    v_pk_mul_f32 v[172:173], v[172:173], v[152:153] op_sel_hi:[1,0]
    v_pk_mul_f32 v[174:175], v[174:175], v[152:153] op_sel_hi:[1,0]
    v_cvt_pk_bf16_f32 v160, v160, v161
    v_cvt_pk_bf16_f32 v162, v162, v163
    v_cvt_pk_bf16_f32 v164, v164, v165
    v_cvt_pk_bf16_f32 v166, v166, v167
    v_cvt_pk_bf16_f32 v168, v168, v169
    v_cvt_pk_bf16_f32 v170, v170, v171
    v_cvt_pk_bf16_f32 v172, v172, v173
    v_cvt_pk_bf16_f32 v174, v174, v175
    v_accvgpr_write_b32 a56, v160
    v_accvgpr_write_b32 a57, v162
    v_accvgpr_write_b32 a58, v164
    v_accvgpr_write_b32 a59, v166
    v_accvgpr_write_b32 a60, v168
    v_accvgpr_write_b32 a61, v170
    v_accvgpr_write_b32 a62, v172
    v_accvgpr_write_b32 a63, v174
    s_waitcnt vmcnt(0)
    s_lshr_b32 s26, s39, 5
    s_cmp_eq_u32 s26, 0
    s_cselect_b64 s[16:17], s[30:31], s[34:35]
    s_cmp_eq_u32 s26, 1
    s_cselect_b64 s[16:17], s[32:33], s[16:17]
    s_and_b32 s17, s17, 0xffff
    s_cmp_lt_u32 s39, 96
    s_cselect_b32 s18, 0x400000, 0
    s_and_b32 s24, s39, 31
    s_lshl_b32 s24, s24, 8
    s_add_u32 s26, s24, 0x0
    s_add_u32 m0, s29, 0x0
    s_nop 0
    buffer_load_dwordx4 v136, s[16:19], s26 offen lds
    s_add_u32 s26, s24, 0x20000
    s_add_u32 m0, s29, 0x1000
    s_nop 0
    buffer_load_dwordx4 v136, s[16:19], s26 offen lds
    s_add_u32 s26, s24, 0x40000
    s_add_u32 m0, s29, 0x2000
    s_nop 0
    buffer_load_dwordx4 v136, s[16:19], s26 offen lds
    s_add_u32 s26, s24, 0x60000
    s_add_u32 m0, s29, 0x3000
    s_nop 0
    buffer_load_dwordx4 v136, s[16:19], s26 offen lds
    s_add_u32 s26, s24, 0x80000
    s_add_u32 m0, s29, 0x4000
    s_nop 0
    buffer_load_dwordx4 v136, s[16:19], s26 offen lds
    s_add_u32 s26, s24, 0xa0000
    s_add_u32 m0, s29, 0x5000
    s_nop 0
    buffer_load_dwordx4 v136, s[16:19], s26 offen lds
    s_add_u32 s26, s24, 0xc0000
    s_add_u32 m0, s29, 0x6000
    s_nop 0
    buffer_load_dwordx4 v136, s[16:19], s26 offen lds
    s_add_u32 s26, s24, 0xe0000
    s_add_u32 m0, s29, 0x7000
    s_nop 0
    buffer_load_dwordx4 v136, s[16:19], s26 offen lds
    s_add_u32 s26, s24, 0x100000
    s_add_u32 m0, s29, 0x8000
    s_nop 0
    buffer_load_dwordx4 v136, s[16:19], s26 offen lds
    s_add_u32 s26, s24, 0x120000
    s_add_u32 m0, s29, 0x9000
    s_nop 0
    buffer_load_dwordx4 v136, s[16:19], s26 offen lds
    s_add_u32 s26, s24, 0x140000
    s_add_u32 m0, s29, 0xa000
    s_nop 0
    buffer_load_dwordx4 v136, s[16:19], s26 offen lds
    s_add_u32 s26, s24, 0x160000
    s_add_u32 m0, s29, 0xb000
    s_nop 0
    buffer_load_dwordx4 v136, s[16:19], s26 offen lds
    s_add_u32 s26, s24, 0x180000
    s_add_u32 m0, s29, 0xc000
    s_nop 0
    buffer_load_dwordx4 v136, s[16:19], s26 offen lds
    s_add_u32 s26, s24, 0x1a0000
    s_add_u32 m0, s29, 0xd000
    s_nop 0
    buffer_load_dwordx4 v136, s[16:19], s26 offen lds
    s_add_u32 s26, s24, 0x1c0000
    s_add_u32 m0, s29, 0xe000
    s_nop 0
    buffer_load_dwordx4 v136, s[16:19], s26 offen lds
    s_add_u32 s26, s24, 0x1e0000
    s_add_u32 m0, s29, 0xf000
    s_nop 0
    buffer_load_dwordx4 v136, s[16:19], s26 offen lds
    s_add_u32 s26, s24, 0x200000
    s_add_u32 m0, s29, 0x10000
    s_nop 0
    buffer_load_dwordx4 v136, s[16:19], s26 offen lds
    s_add_u32 s26, s24, 0x220000
    s_add_u32 m0, s29, 0x11000
    s_nop 0
    buffer_load_dwordx4 v136, s[16:19], s26 offen lds
    s_add_u32 s26, s24, 0x240000
    s_add_u32 m0, s29, 0x12000
    s_nop 0
    buffer_load_dwordx4 v136, s[16:19], s26 offen lds
    s_add_u32 s26, s24, 0x260000
    s_add_u32 m0, s29, 0x13000
    s_nop 0
    buffer_load_dwordx4 v136, s[16:19], s26 offen lds
    s_add_u32 s26, s24, 0x280000
    s_add_u32 m0, s29, 0x14000
    s_nop 0
    buffer_load_dwordx4 v136, s[16:19], s26 offen lds
    s_add_u32 s26, s24, 0x2a0000
    s_add_u32 m0, s29, 0x15000
    s_nop 0
    buffer_load_dwordx4 v136, s[16:19], s26 offen lds
    s_add_u32 s26, s24, 0x2c0000
    s_add_u32 m0, s29, 0x16000
    s_nop 0
    buffer_load_dwordx4 v136, s[16:19], s26 offen lds
    s_add_u32 s26, s24, 0x2e0000
    s_add_u32 m0, s29, 0x17000
    s_nop 0
    buffer_load_dwordx4 v136, s[16:19], s26 offen lds
    v_pk_mov_b32 v[150:151], 0, 0
    v_pk_mov_b32 v[152:153], 0, 0
    v_dot2_f32_bf16 v150, v64, v158, v150
    v_dot2_f32_bf16 v152, v64, v64, v152
    v_dot2_f32_bf16 v151, v65, v158, v151
    v_dot2_f32_bf16 v153, v65, v65, v153
    v_dot2_f32_bf16 v150, v66, v158, v150
    v_dot2_f32_bf16 v152, v66, v66, v152
    v_dot2_f32_bf16 v151, v67, v158, v151
    v_dot2_f32_bf16 v153, v67, v67, v153
    v_dot2_f32_bf16 v150, v68, v158, v150
    v_dot2_f32_bf16 v152, v68, v68, v152
    v_dot2_f32_bf16 v151, v69, v158, v151
    v_dot2_f32_bf16 v153, v69, v69, v153
    v_dot2_f32_bf16 v150, v70, v158, v150
    v_dot2_f32_bf16 v152, v70, v70, v152
    v_dot2_f32_bf16 v151, v71, v158, v151
    v_dot2_f32_bf16 v153, v71, v71, v153
    v_dot2_f32_bf16 v150, v72, v158, v150
    v_dot2_f32_bf16 v152, v72, v72, v152
    v_dot2_f32_bf16 v151, v73, v158, v151
    v_dot2_f32_bf16 v153, v73, v73, v153
    v_dot2_f32_bf16 v150, v74, v158, v150
    v_dot2_f32_bf16 v152, v74, v74, v152
    v_dot2_f32_bf16 v151, v75, v158, v151
    v_dot2_f32_bf16 v153, v75, v75, v153
    v_dot2_f32_bf16 v150, v76, v158, v150
    v_dot2_f32_bf16 v152, v76, v76, v152
    v_dot2_f32_bf16 v151, v77, v158, v151
    v_dot2_f32_bf16 v153, v77, v77, v153
    v_dot2_f32_bf16 v150, v78, v158, v150
    v_dot2_f32_bf16 v152, v78, v78, v152
    v_dot2_f32_bf16 v151, v79, v158, v151
    v_dot2_f32_bf16 v153, v79, v79, v153
    v_dot2_f32_bf16 v150, v80, v158, v150
    v_dot2_f32_bf16 v152, v80, v80, v152
    v_dot2_f32_bf16 v151, v81, v158, v151
    v_dot2_f32_bf16 v153, v81, v81, v153
    v_dot2_f32_bf16 v150, v82, v158, v150
    v_dot2_f32_bf16 v152, v82, v82, v152
    v_dot2_f32_bf16 v151, v83, v158, v151
    v_dot2_f32_bf16 v153, v83, v83, v153
    v_dot2_f32_bf16 v150, v84, v158, v150
    v_dot2_f32_bf16 v152, v84, v84, v152
    v_dot2_f32_bf16 v151, v85, v158, v151
    v_dot2_f32_bf16 v153, v85, v85, v153
    v_dot2_f32_bf16 v150, v86, v158, v150
    v_dot2_f32_bf16 v152, v86, v86, v152
    v_dot2_f32_bf16 v151, v87, v158, v151
    v_dot2_f32_bf16 v153, v87, v87, v153
    v_dot2_f32_bf16 v150, v88, v158, v150
    v_dot2_f32_bf16 v152, v88, v88, v152
    v_dot2_f32_bf16 v151, v89, v158, v151
    v_dot2_f32_bf16 v153, v89, v89, v153
    v_dot2_f32_bf16 v150, v90, v158, v150
    v_dot2_f32_bf16 v152, v90, v90, v152
    v_dot2_f32_bf16 v151, v91, v158, v151
    v_dot2_f32_bf16 v153, v91, v91, v153
    v_dot2_f32_bf16 v150, v92, v158, v150
    v_dot2_f32_bf16 v152, v92, v92, v152
    v_dot2_f32_bf16 v151, v93, v158, v151
    v_dot2_f32_bf16 v153, v93, v93, v153
    v_dot2_f32_bf16 v150, v94, v158, v150
    v_dot2_f32_bf16 v152, v94, v94, v152
    v_dot2_f32_bf16 v151, v95, v158, v151
    v_dot2_f32_bf16 v153, v95, v95, v153
    v_dot2_f32_bf16 v150, v96, v158, v150
    v_dot2_f32_bf16 v152, v96, v96, v152
    v_dot2_f32_bf16 v151, v97, v158, v151
    v_dot2_f32_bf16 v153, v97, v97, v153
    v_dot2_f32_bf16 v150, v98, v158, v150
    v_dot2_f32_bf16 v152, v98, v98, v152
    v_dot2_f32_bf16 v151, v99, v158, v151
    v_dot2_f32_bf16 v153, v99, v99, v153
    v_dot2_f32_bf16 v150, v100, v158, v150
    v_dot2_f32_bf16 v152, v100, v100, v152
    v_dot2_f32_bf16 v151, v101, v158, v151
    v_dot2_f32_bf16 v153, v101, v101, v153
    v_dot2_f32_bf16 v150, v102, v158, v150
    v_dot2_f32_bf16 v152, v102, v102, v152
    v_dot2_f32_bf16 v151, v103, v158, v151
    v_dot2_f32_bf16 v153, v103, v103, v153
    v_dot2_f32_bf16 v150, v104, v158, v150
    v_dot2_f32_bf16 v152, v104, v104, v152
    v_dot2_f32_bf16 v151, v105, v158, v151
    v_dot2_f32_bf16 v153, v105, v105, v153
    v_dot2_f32_bf16 v150, v106, v158, v150
    v_dot2_f32_bf16 v152, v106, v106, v152
    v_dot2_f32_bf16 v151, v107, v158, v151
    v_dot2_f32_bf16 v153, v107, v107, v153
    v_dot2_f32_bf16 v150, v108, v158, v150
    v_dot2_f32_bf16 v152, v108, v108, v152
    v_dot2_f32_bf16 v151, v109, v158, v151
    v_dot2_f32_bf16 v153, v109, v109, v153
    v_dot2_f32_bf16 v150, v110, v158, v150
    v_dot2_f32_bf16 v152, v110, v110, v152
    v_dot2_f32_bf16 v151, v111, v158, v151
    v_dot2_f32_bf16 v153, v111, v111, v153
    v_dot2_f32_bf16 v150, v112, v158, v150
    v_dot2_f32_bf16 v152, v112, v112, v152
    v_dot2_f32_bf16 v151, v113, v158, v151
    v_dot2_f32_bf16 v153, v113, v113, v153
    v_dot2_f32_bf16 v150, v114, v158, v150
    v_dot2_f32_bf16 v152, v114, v114, v152
    v_dot2_f32_bf16 v151, v115, v158, v151
    v_dot2_f32_bf16 v153, v115, v115, v153
    v_dot2_f32_bf16 v150, v116, v158, v150
    v_dot2_f32_bf16 v152, v116, v116, v152
    v_dot2_f32_bf16 v151, v117, v158, v151
    v_dot2_f32_bf16 v153, v117, v117, v153
    v_dot2_f32_bf16 v150, v118, v158, v150
    v_dot2_f32_bf16 v152, v118, v118, v152
    v_dot2_f32_bf16 v151, v119, v158, v151
    v_dot2_f32_bf16 v153, v119, v119, v153
    v_dot2_f32_bf16 v150, v120, v158, v150
    v_dot2_f32_bf16 v152, v120, v120, v152
    v_dot2_f32_bf16 v151, v121, v158, v151
    v_dot2_f32_bf16 v153, v121, v121, v153
    v_dot2_f32_bf16 v150, v122, v158, v150
    v_dot2_f32_bf16 v152, v122, v122, v152
    v_dot2_f32_bf16 v151, v123, v158, v151
    v_dot2_f32_bf16 v153, v123, v123, v153
    v_dot2_f32_bf16 v150, v124, v158, v150
    v_dot2_f32_bf16 v152, v124, v124, v152
    v_dot2_f32_bf16 v151, v125, v158, v151
    v_dot2_f32_bf16 v153, v125, v125, v153
    v_dot2_f32_bf16 v150, v126, v158, v150
    v_dot2_f32_bf16 v152, v126, v126, v152
    v_dot2_f32_bf16 v151, v127, v158, v151
    v_dot2_f32_bf16 v153, v127, v127, v153
    s_nop 1
    v_add_f32 v150, v150, v151
    v_add_f32 v152, v152, v153
    v_mov_b32 v157, v150
    s_nop 1
    v_permlane32_swap_b32 v157, v150
    v_add_f32 v150, v157, v150
    v_mov_b32 v157, v150
    s_nop 1
    v_permlane16_swap_b32 v157, v150
    v_add_f32 v150, v157, v150
    v_mov_b32 v157, v152
    s_nop 1
    v_permlane32_swap_b32 v157, v152
    v_add_f32 v152, v157, v152
    v_mov_b32 v157, v152
    s_nop 1
    v_permlane16_swap_b32 v157, v152
    v_add_f32 v152, v157, v152
    v_mul_f32 v150, 0x3b000000, v150
    v_cvt_pk_bf16_f32 v154, v150, v150
    v_and_b32 v154, 0xffff0000, v154
    v_sub_f32 v156, v150, v154
    v_mul_f32 v157, v150, v150
    v_mul_f32 v152, 0x3b000000, v152
    v_sub_f32 v152, v152, v157
    v_max_f32 v152, 0, v152
    v_cvt_pk_bf16_f32 v152, v152, v152
    v_and_b32 v152, 0xffff0000, v152
    v_add_f32 v152, 0x3727c5ac, v152
    v_cvt_pk_bf16_f32 v152, v152, v152
    v_and_b32 v152, 0xffff0000, v152
    v_sqrt_f32 v152, v152
    s_nop 0
    v_cvt_pk_bf16_f32 v152, v152, v152
    v_and_b32 v152, 0xffff0000, v152
    v_rcp_f32 v152, v152
    v_lshlrev_b32 v160, 16, v64
    v_and_b32 v161, 0xffff0000, v64
    v_lshlrev_b32 v162, 16, v65
    v_and_b32 v163, 0xffff0000, v65
    v_lshlrev_b32 v164, 16, v66
    v_and_b32 v165, 0xffff0000, v66
    v_lshlrev_b32 v166, 16, v67
    v_and_b32 v167, 0xffff0000, v67
    v_lshlrev_b32 v168, 16, v68
    v_and_b32 v169, 0xffff0000, v68
    v_lshlrev_b32 v170, 16, v69
    v_and_b32 v171, 0xffff0000, v69
    v_lshlrev_b32 v172, 16, v70
    v_and_b32 v173, 0xffff0000, v70
    v_lshlrev_b32 v174, 16, v71
    v_and_b32 v175, 0xffff0000, v71
    v_pk_add_f32 v[160:161], v[160:161], v[154:155] op_sel_hi:[1,0] neg_lo:[0,1] neg_hi:[0,1]
    v_pk_add_f32 v[162:163], v[162:163], v[154:155] op_sel_hi:[1,0] neg_lo:[0,1] neg_hi:[0,1]
    v_pk_add_f32 v[164:165], v[164:165], v[154:155] op_sel_hi:[1,0] neg_lo:[0,1] neg_hi:[0,1]
    v_pk_add_f32 v[166:167], v[166:167], v[154:155] op_sel_hi:[1,0] neg_lo:[0,1] neg_hi:[0,1]
    v_pk_add_f32 v[168:169], v[168:169], v[154:155] op_sel_hi:[1,0] neg_lo:[0,1] neg_hi:[0,1]
    v_pk_add_f32 v[170:171], v[170:171], v[154:155] op_sel_hi:[1,0] neg_lo:[0,1] neg_hi:[0,1]
    v_pk_add_f32 v[172:173], v[172:173], v[154:155] op_sel_hi:[1,0] neg_lo:[0,1] neg_hi:[0,1]
    v_pk_add_f32 v[174:175], v[174:175], v[154:155] op_sel_hi:[1,0] neg_lo:[0,1] neg_hi:[0,1]
    v_cvt_pk_bf16_f32 v64, v160, v161
    v_cvt_pk_bf16_f32 v65, v162, v163
    v_cvt_pk_bf16_f32 v66, v164, v165
    v_cvt_pk_bf16_f32 v67, v166, v167
    v_cvt_pk_bf16_f32 v68, v168, v169
    v_cvt_pk_bf16_f32 v69, v170, v171
    v_cvt_pk_bf16_f32 v70, v172, v173
    v_cvt_pk_bf16_f32 v71, v174, v175
    v_lshlrev_b32 v160, 16, v64
    v_and_b32 v161, 0xffff0000, v64
    v_lshlrev_b32 v162, 16, v65
    v_and_b32 v163, 0xffff0000, v65
    v_lshlrev_b32 v164, 16, v66
    v_and_b32 v165, 0xffff0000, v66
    v_lshlrev_b32 v166, 16, v67
    v_and_b32 v167, 0xffff0000, v67
    v_lshlrev_b32 v168, 16, v68
    v_and_b32 v169, 0xffff0000, v68
    v_lshlrev_b32 v170, 16, v69
    v_and_b32 v171, 0xffff0000, v69
    v_lshlrev_b32 v172, 16, v70
    v_and_b32 v173, 0xffff0000, v70
    v_lshlrev_b32 v174, 16, v71
    v_and_b32 v175, 0xffff0000, v71
    v_pk_mul_f32 v[160:161], v[160:161], v[152:153] op_sel_hi:[1,0]
    v_pk_mul_f32 v[162:163], v[162:163], v[152:153] op_sel_hi:[1,0]
    v_pk_mul_f32 v[164:165], v[164:165], v[152:153] op_sel_hi:[1,0]
    v_pk_mul_f32 v[166:167], v[166:167], v[152:153] op_sel_hi:[1,0]
    v_pk_mul_f32 v[168:169], v[168:169], v[152:153] op_sel_hi:[1,0]
    v_pk_mul_f32 v[170:171], v[170:171], v[152:153] op_sel_hi:[1,0]
    v_pk_mul_f32 v[172:173], v[172:173], v[152:153] op_sel_hi:[1,0]
    v_pk_mul_f32 v[174:175], v[174:175], v[152:153] op_sel_hi:[1,0]
    v_cvt_pk_bf16_f32 v160, v160, v161
    v_cvt_pk_bf16_f32 v162, v162, v163
    v_cvt_pk_bf16_f32 v164, v164, v165
    v_cvt_pk_bf16_f32 v166, v166, v167
    v_cvt_pk_bf16_f32 v168, v168, v169
    v_cvt_pk_bf16_f32 v170, v170, v171
    v_cvt_pk_bf16_f32 v172, v172, v173
    v_cvt_pk_bf16_f32 v174, v174, v175
    v_accvgpr_write_b32 a64, v160
    v_accvgpr_write_b32 a65, v162
    v_accvgpr_write_b32 a66, v164
    v_accvgpr_write_b32 a67, v166
    v_accvgpr_write_b32 a68, v168
    v_accvgpr_write_b32 a69, v170
    v_accvgpr_write_b32 a70, v172
    v_accvgpr_write_b32 a71, v174
    v_lshlrev_b32 v160, 16, v72
    v_and_b32 v161, 0xffff0000, v72
    v_lshlrev_b32 v162, 16, v73
    v_and_b32 v163, 0xffff0000, v73
    v_lshlrev_b32 v164, 16, v74
    v_and_b32 v165, 0xffff0000, v74
    v_lshlrev_b32 v166, 16, v75
    v_and_b32 v167, 0xffff0000, v75
    v_lshlrev_b32 v168, 16, v76
    v_and_b32 v169, 0xffff0000, v76
    v_lshlrev_b32 v170, 16, v77
    v_and_b32 v171, 0xffff0000, v77
    v_lshlrev_b32 v172, 16, v78
    v_and_b32 v173, 0xffff0000, v78
    v_lshlrev_b32 v174, 16, v79
    v_and_b32 v175, 0xffff0000, v79
    v_pk_add_f32 v[160:161], v[160:161], v[154:155] op_sel_hi:[1,0] neg_lo:[0,1] neg_hi:[0,1]
    v_pk_add_f32 v[162:163], v[162:163], v[154:155] op_sel_hi:[1,0] neg_lo:[0,1] neg_hi:[0,1]
    v_pk_add_f32 v[164:165], v[164:165], v[154:155] op_sel_hi:[1,0] neg_lo:[0,1] neg_hi:[0,1]
    v_pk_add_f32 v[166:167], v[166:167], v[154:155] op_sel_hi:[1,0] neg_lo:[0,1] neg_hi:[0,1]
    v_pk_add_f32 v[168:169], v[168:169], v[154:155] op_sel_hi:[1,0] neg_lo:[0,1] neg_hi:[0,1]
    v_pk_add_f32 v[170:171], v[170:171], v[154:155] op_sel_hi:[1,0] neg_lo:[0,1] neg_hi:[0,1]
    v_pk_add_f32 v[172:173], v[172:173], v[154:155] op_sel_hi:[1,0] neg_lo:[0,1] neg_hi:[0,1]
    v_pk_add_f32 v[174:175], v[174:175], v[154:155] op_sel_hi:[1,0] neg_lo:[0,1] neg_hi:[0,1]
    v_cvt_pk_bf16_f32 v72, v160, v161
    v_cvt_pk_bf16_f32 v73, v162, v163
    v_cvt_pk_bf16_f32 v74, v164, v165
    v_cvt_pk_bf16_f32 v75, v166, v167
    v_cvt_pk_bf16_f32 v76, v168, v169
    v_cvt_pk_bf16_f32 v77, v170, v171
    v_cvt_pk_bf16_f32 v78, v172, v173
    v_cvt_pk_bf16_f32 v79, v174, v175
    v_lshlrev_b32 v160, 16, v72
    v_and_b32 v161, 0xffff0000, v72
    v_lshlrev_b32 v162, 16, v73
    v_and_b32 v163, 0xffff0000, v73
    v_lshlrev_b32 v164, 16, v74
    v_and_b32 v165, 0xffff0000, v74
    v_lshlrev_b32 v166, 16, v75
    v_and_b32 v167, 0xffff0000, v75
    v_lshlrev_b32 v168, 16, v76
    v_and_b32 v169, 0xffff0000, v76
    v_lshlrev_b32 v170, 16, v77
    v_and_b32 v171, 0xffff0000, v77
    v_lshlrev_b32 v172, 16, v78
    v_and_b32 v173, 0xffff0000, v78
    v_lshlrev_b32 v174, 16, v79
    v_and_b32 v175, 0xffff0000, v79
    v_pk_mul_f32 v[160:161], v[160:161], v[152:153] op_sel_hi:[1,0]
    v_pk_mul_f32 v[162:163], v[162:163], v[152:153] op_sel_hi:[1,0]
    v_pk_mul_f32 v[164:165], v[164:165], v[152:153] op_sel_hi:[1,0]
    v_pk_mul_f32 v[166:167], v[166:167], v[152:153] op_sel_hi:[1,0]
    v_pk_mul_f32 v[168:169], v[168:169], v[152:153] op_sel_hi:[1,0]
    v_pk_mul_f32 v[170:171], v[170:171], v[152:153] op_sel_hi:[1,0]
    v_pk_mul_f32 v[172:173], v[172:173], v[152:153] op_sel_hi:[1,0]
    v_pk_mul_f32 v[174:175], v[174:175], v[152:153] op_sel_hi:[1,0]
    v_cvt_pk_bf16_f32 v160, v160, v161
    v_cvt_pk_bf16_f32 v162, v162, v163
    v_cvt_pk_bf16_f32 v164, v164, v165
    v_cvt_pk_bf16_f32 v166, v166, v167
    v_cvt_pk_bf16_f32 v168, v168, v169
    v_cvt_pk_bf16_f32 v170, v170, v171
    v_cvt_pk_bf16_f32 v172, v172, v173
    v_cvt_pk_bf16_f32 v174, v174, v175
    v_accvgpr_write_b32 a72, v160
    v_accvgpr_write_b32 a73, v162
    v_accvgpr_write_b32 a74, v164
    v_accvgpr_write_b32 a75, v166
    v_accvgpr_write_b32 a76, v168
    v_accvgpr_write_b32 a77, v170
    v_accvgpr_write_b32 a78, v172
    v_accvgpr_write_b32 a79, v174
    v_lshlrev_b32 v160, 16, v80
    v_and_b32 v161, 0xffff0000, v80
    v_lshlrev_b32 v162, 16, v81
    v_and_b32 v163, 0xffff0000, v81
    v_lshlrev_b32 v164, 16, v82
    v_and_b32 v165, 0xffff0000, v82
    v_lshlrev_b32 v166, 16, v83
    v_and_b32 v167, 0xffff0000, v83
    v_lshlrev_b32 v168, 16, v84
    v_and_b32 v169, 0xffff0000, v84
    v_lshlrev_b32 v170, 16, v85
    v_and_b32 v171, 0xffff0000, v85
    v_lshlrev_b32 v172, 16, v86
    v_and_b32 v173, 0xffff0000, v86
    v_lshlrev_b32 v174, 16, v87
    v_and_b32 v175, 0xffff0000, v87
    v_pk_add_f32 v[160:161], v[160:161], v[154:155] op_sel_hi:[1,0] neg_lo:[0,1] neg_hi:[0,1]
    v_pk_add_f32 v[162:163], v[162:163], v[154:155] op_sel_hi:[1,0] neg_lo:[0,1] neg_hi:[0,1]
    v_pk_add_f32 v[164:165], v[164:165], v[154:155] op_sel_hi:[1,0] neg_lo:[0,1] neg_hi:[0,1]
    v_pk_add_f32 v[166:167], v[166:167], v[154:155] op_sel_hi:[1,0] neg_lo:[0,1] neg_hi:[0,1]
    v_pk_add_f32 v[168:169], v[168:169], v[154:155] op_sel_hi:[1,0] neg_lo:[0,1] neg_hi:[0,1]
    v_pk_add_f32 v[170:171], v[170:171], v[154:155] op_sel_hi:[1,0] neg_lo:[0,1] neg_hi:[0,1]
    v_pk_add_f32 v[172:173], v[172:173], v[154:155] op_sel_hi:[1,0] neg_lo:[0,1] neg_hi:[0,1]
    v_pk_add_f32 v[174:175], v[174:175], v[154:155] op_sel_hi:[1,0] neg_lo:[0,1] neg_hi:[0,1]
    v_cvt_pk_bf16_f32 v80, v160, v161
    v_cvt_pk_bf16_f32 v81, v162, v163
    v_cvt_pk_bf16_f32 v82, v164, v165
    v_cvt_pk_bf16_f32 v83, v166, v167
    v_cvt_pk_bf16_f32 v84, v168, v169
    v_cvt_pk_bf16_f32 v85, v170, v171
    v_cvt_pk_bf16_f32 v86, v172, v173
    v_cvt_pk_bf16_f32 v87, v174, v175
    v_lshlrev_b32 v160, 16, v80
    v_and_b32 v161, 0xffff0000, v80
    v_lshlrev_b32 v162, 16, v81
    v_and_b32 v163, 0xffff0000, v81
    v_lshlrev_b32 v164, 16, v82
    v_and_b32 v165, 0xffff0000, v82
    v_lshlrev_b32 v166, 16, v83
    v_and_b32 v167, 0xffff0000, v83
    v_lshlrev_b32 v168, 16, v84
    v_and_b32 v169, 0xffff0000, v84
    v_lshlrev_b32 v170, 16, v85
    v_and_b32 v171, 0xffff0000, v85
    v_lshlrev_b32 v172, 16, v86
    v_and_b32 v173, 0xffff0000, v86
    v_lshlrev_b32 v174, 16, v87
    v_and_b32 v175, 0xffff0000, v87
    v_pk_mul_f32 v[160:161], v[160:161], v[152:153] op_sel_hi:[1,0]
    v_pk_mul_f32 v[162:163], v[162:163], v[152:153] op_sel_hi:[1,0]
    v_pk_mul_f32 v[164:165], v[164:165], v[152:153] op_sel_hi:[1,0]
    v_pk_mul_f32 v[166:167], v[166:167], v[152:153] op_sel_hi:[1,0]
    v_pk_mul_f32 v[168:169], v[168:169], v[152:153] op_sel_hi:[1,0]
    v_pk_mul_f32 v[170:171], v[170:171], v[152:153] op_sel_hi:[1,0]
    v_pk_mul_f32 v[172:173], v[172:173], v[152:153] op_sel_hi:[1,0]
    v_pk_mul_f32 v[174:175], v[174:175], v[152:153] op_sel_hi:[1,0]
    v_cvt_pk_bf16_f32 v160, v160, v161
    v_cvt_pk_bf16_f32 v162, v162, v163
    v_cvt_pk_bf16_f32 v164, v164, v165
    v_cvt_pk_bf16_f32 v166, v166, v167
    v_cvt_pk_bf16_f32 v168, v168, v169
    v_cvt_pk_bf16_f32 v170, v170, v171
    v_cvt_pk_bf16_f32 v172, v172, v173
    v_cvt_pk_bf16_f32 v174, v174, v175
    v_accvgpr_write_b32 a80, v160
    v_accvgpr_write_b32 a81, v162
    v_accvgpr_write_b32 a82, v164
    v_accvgpr_write_b32 a83, v166
    v_accvgpr_write_b32 a84, v168
    v_accvgpr_write_b32 a85, v170
    v_accvgpr_write_b32 a86, v172
    v_accvgpr_write_b32 a87, v174
    v_lshlrev_b32 v160, 16, v88
    v_and_b32 v161, 0xffff0000, v88
    v_lshlrev_b32 v162, 16, v89
    v_and_b32 v163, 0xffff0000, v89
    v_lshlrev_b32 v164, 16, v90
    v_and_b32 v165, 0xffff0000, v90
    v_lshlrev_b32 v166, 16, v91
    v_and_b32 v167, 0xffff0000, v91
    v_lshlrev_b32 v168, 16, v92
    v_and_b32 v169, 0xffff0000, v92
    v_lshlrev_b32 v170, 16, v93
    v_and_b32 v171, 0xffff0000, v93
    v_lshlrev_b32 v172, 16, v94
    v_and_b32 v173, 0xffff0000, v94
    v_lshlrev_b32 v174, 16, v95
    v_and_b32 v175, 0xffff0000, v95
    v_pk_add_f32 v[160:161], v[160:161], v[154:155] op_sel_hi:[1,0] neg_lo:[0,1] neg_hi:[0,1]
    v_pk_add_f32 v[162:163], v[162:163], v[154:155] op_sel_hi:[1,0] neg_lo:[0,1] neg_hi:[0,1]
    v_pk_add_f32 v[164:165], v[164:165], v[154:155] op_sel_hi:[1,0] neg_lo:[0,1] neg_hi:[0,1]
    v_pk_add_f32 v[166:167], v[166:167], v[154:155] op_sel_hi:[1,0] neg_lo:[0,1] neg_hi:[0,1]
    v_pk_add_f32 v[168:169], v[168:169], v[154:155] op_sel_hi:[1,0] neg_lo:[0,1] neg_hi:[0,1]
    v_pk_add_f32 v[170:171], v[170:171], v[154:155] op_sel_hi:[1,0] neg_lo:[0,1] neg_hi:[0,1]
    v_pk_add_f32 v[172:173], v[172:173], v[154:155] op_sel_hi:[1,0] neg_lo:[0,1] neg_hi:[0,1]
    v_pk_add_f32 v[174:175], v[174:175], v[154:155] op_sel_hi:[1,0] neg_lo:[0,1] neg_hi:[0,1]
    v_cvt_pk_bf16_f32 v88, v160, v161
    v_cvt_pk_bf16_f32 v89, v162, v163
    v_cvt_pk_bf16_f32 v90, v164, v165
    v_cvt_pk_bf16_f32 v91, v166, v167
    v_cvt_pk_bf16_f32 v92, v168, v169
    v_cvt_pk_bf16_f32 v93, v170, v171
    v_cvt_pk_bf16_f32 v94, v172, v173
    v_cvt_pk_bf16_f32 v95, v174, v175
    v_lshlrev_b32 v160, 16, v88
    v_and_b32 v161, 0xffff0000, v88
    v_lshlrev_b32 v162, 16, v89
    v_and_b32 v163, 0xffff0000, v89
    v_lshlrev_b32 v164, 16, v90
    v_and_b32 v165, 0xffff0000, v90
    v_lshlrev_b32 v166, 16, v91
    v_and_b32 v167, 0xffff0000, v91
    v_lshlrev_b32 v168, 16, v92
    v_and_b32 v169, 0xffff0000, v92
    v_lshlrev_b32 v170, 16, v93
    v_and_b32 v171, 0xffff0000, v93
    v_lshlrev_b32 v172, 16, v94
    v_and_b32 v173, 0xffff0000, v94
    v_lshlrev_b32 v174, 16, v95
    v_and_b32 v175, 0xffff0000, v95
    v_pk_mul_f32 v[160:161], v[160:161], v[152:153] op_sel_hi:[1,0]
    v_pk_mul_f32 v[162:163], v[162:163], v[152:153] op_sel_hi:[1,0]
    v_pk_mul_f32 v[164:165], v[164:165], v[152:153] op_sel_hi:[1,0]
    v_pk_mul_f32 v[166:167], v[166:167], v[152:153] op_sel_hi:[1,0]
    v_pk_mul_f32 v[168:169], v[168:169], v[152:153] op_sel_hi:[1,0]
    v_pk_mul_f32 v[170:171], v[170:171], v[152:153] op_sel_hi:[1,0]
    v_pk_mul_f32 v[172:173], v[172:173], v[152:153] op_sel_hi:[1,0]
    v_pk_mul_f32 v[174:175], v[174:175], v[152:153] op_sel_hi:[1,0]
    v_cvt_pk_bf16_f32 v160, v160, v161
    v_cvt_pk_bf16_f32 v162, v162, v163
    v_cvt_pk_bf16_f32 v164, v164, v165
    v_cvt_pk_bf16_f32 v166, v166, v167
    v_cvt_pk_bf16_f32 v168, v168, v169
    v_cvt_pk_bf16_f32 v170, v170, v171
    v_cvt_pk_bf16_f32 v172, v172, v173
    v_cvt_pk_bf16_f32 v174, v174, v175
    v_accvgpr_write_b32 a88, v160
    v_accvgpr_write_b32 a89, v162
    v_accvgpr_write_b32 a90, v164
    v_accvgpr_write_b32 a91, v166
    v_accvgpr_write_b32 a92, v168
    v_accvgpr_write_b32 a93, v170
    v_accvgpr_write_b32 a94, v172
    v_accvgpr_write_b32 a95, v174
    v_lshlrev_b32 v160, 16, v96
    v_and_b32 v161, 0xffff0000, v96
    v_lshlrev_b32 v162, 16, v97
    v_and_b32 v163, 0xffff0000, v97
    v_lshlrev_b32 v164, 16, v98
    v_and_b32 v165, 0xffff0000, v98
    v_lshlrev_b32 v166, 16, v99
    v_and_b32 v167, 0xffff0000, v99
    v_lshlrev_b32 v168, 16, v100
    v_and_b32 v169, 0xffff0000, v100
    v_lshlrev_b32 v170, 16, v101
    v_and_b32 v171, 0xffff0000, v101
    v_lshlrev_b32 v172, 16, v102
    v_and_b32 v173, 0xffff0000, v102
    v_lshlrev_b32 v174, 16, v103
    v_and_b32 v175, 0xffff0000, v103
    v_pk_add_f32 v[160:161], v[160:161], v[154:155] op_sel_hi:[1,0] neg_lo:[0,1] neg_hi:[0,1]
    v_pk_add_f32 v[162:163], v[162:163], v[154:155] op_sel_hi:[1,0] neg_lo:[0,1] neg_hi:[0,1]
    v_pk_add_f32 v[164:165], v[164:165], v[154:155] op_sel_hi:[1,0] neg_lo:[0,1] neg_hi:[0,1]
    v_pk_add_f32 v[166:167], v[166:167], v[154:155] op_sel_hi:[1,0] neg_lo:[0,1] neg_hi:[0,1]
    v_pk_add_f32 v[168:169], v[168:169], v[154:155] op_sel_hi:[1,0] neg_lo:[0,1] neg_hi:[0,1]
    v_pk_add_f32 v[170:171], v[170:171], v[154:155] op_sel_hi:[1,0] neg_lo:[0,1] neg_hi:[0,1]
    v_pk_add_f32 v[172:173], v[172:173], v[154:155] op_sel_hi:[1,0] neg_lo:[0,1] neg_hi:[0,1]
    v_pk_add_f32 v[174:175], v[174:175], v[154:155] op_sel_hi:[1,0] neg_lo:[0,1] neg_hi:[0,1]
    v_cvt_pk_bf16_f32 v96, v160, v161
    v_cvt_pk_bf16_f32 v97, v162, v163
    v_cvt_pk_bf16_f32 v98, v164, v165
    v_cvt_pk_bf16_f32 v99, v166, v167
    v_cvt_pk_bf16_f32 v100, v168, v169
    v_cvt_pk_bf16_f32 v101, v170, v171
    v_cvt_pk_bf16_f32 v102, v172, v173
    v_cvt_pk_bf16_f32 v103, v174, v175
    v_lshlrev_b32 v160, 16, v96
    v_and_b32 v161, 0xffff0000, v96
    v_lshlrev_b32 v162, 16, v97
    v_and_b32 v163, 0xffff0000, v97
    v_lshlrev_b32 v164, 16, v98
    v_and_b32 v165, 0xffff0000, v98
    v_lshlrev_b32 v166, 16, v99
    v_and_b32 v167, 0xffff0000, v99
    v_lshlrev_b32 v168, 16, v100
    v_and_b32 v169, 0xffff0000, v100
    v_lshlrev_b32 v170, 16, v101
    v_and_b32 v171, 0xffff0000, v101
    v_lshlrev_b32 v172, 16, v102
    v_and_b32 v173, 0xffff0000, v102
    v_lshlrev_b32 v174, 16, v103
    v_and_b32 v175, 0xffff0000, v103
    v_pk_mul_f32 v[160:161], v[160:161], v[152:153] op_sel_hi:[1,0]
    v_pk_mul_f32 v[162:163], v[162:163], v[152:153] op_sel_hi:[1,0]
    v_pk_mul_f32 v[164:165], v[164:165], v[152:153] op_sel_hi:[1,0]
    v_pk_mul_f32 v[166:167], v[166:167], v[152:153] op_sel_hi:[1,0]
    v_pk_mul_f32 v[168:169], v[168:169], v[152:153] op_sel_hi:[1,0]
    v_pk_mul_f32 v[170:171], v[170:171], v[152:153] op_sel_hi:[1,0]
    v_pk_mul_f32 v[172:173], v[172:173], v[152:153] op_sel_hi:[1,0]
    v_pk_mul_f32 v[174:175], v[174:175], v[152:153] op_sel_hi:[1,0]
    v_cvt_pk_bf16_f32 v160, v160, v161
    v_cvt_pk_bf16_f32 v162, v162, v163
    v_cvt_pk_bf16_f32 v164, v164, v165
    v_cvt_pk_bf16_f32 v166, v166, v167
    v_cvt_pk_bf16_f32 v168, v168, v169
    v_cvt_pk_bf16_f32 v170, v170, v171
    v_cvt_pk_bf16_f32 v172, v172, v173
    v_cvt_pk_bf16_f32 v174, v174, v175
    v_accvgpr_write_b32 a96, v160
    v_accvgpr_write_b32 a97, v162
    v_accvgpr_write_b32 a98, v164
    v_accvgpr_write_b32 a99, v166
    v_accvgpr_write_b32 a100, v168
    v_accvgpr_write_b32 a101, v170
    v_accvgpr_write_b32 a102, v172
    v_accvgpr_write_b32 a103, v174
    v_lshlrev_b32 v160, 16, v104
    v_and_b32 v161, 0xffff0000, v104
    v_lshlrev_b32 v162, 16, v105
    v_and_b32 v163, 0xffff0000, v105
    v_lshlrev_b32 v164, 16, v106
    v_and_b32 v165, 0xffff0000, v106
    v_lshlrev_b32 v166, 16, v107
    v_and_b32 v167, 0xffff0000, v107
    v_lshlrev_b32 v168, 16, v108
    v_and_b32 v169, 0xffff0000, v108
    v_lshlrev_b32 v170, 16, v109
    v_and_b32 v171, 0xffff0000, v109
    v_lshlrev_b32 v172, 16, v110
    v_and_b32 v173, 0xffff0000, v110
    v_lshlrev_b32 v174, 16, v111
    v_and_b32 v175, 0xffff0000, v111
    v_pk_add_f32 v[160:161], v[160:161], v[154:155] op_sel_hi:[1,0] neg_lo:[0,1] neg_hi:[0,1]
    v_pk_add_f32 v[162:163], v[162:163], v[154:155] op_sel_hi:[1,0] neg_lo:[0,1] neg_hi:[0,1]
    v_pk_add_f32 v[164:165], v[164:165], v[154:155] op_sel_hi:[1,0] neg_lo:[0,1] neg_hi:[0,1]
    v_pk_add_f32 v[166:167], v[166:167], v[154:155] op_sel_hi:[1,0] neg_lo:[0,1] neg_hi:[0,1]
    v_pk_add_f32 v[168:169], v[168:169], v[154:155] op_sel_hi:[1,0] neg_lo:[0,1] neg_hi:[0,1]
    v_pk_add_f32 v[170:171], v[170:171], v[154:155] op_sel_hi:[1,0] neg_lo:[0,1] neg_hi:[0,1]
    v_pk_add_f32 v[172:173], v[172:173], v[154:155] op_sel_hi:[1,0] neg_lo:[0,1] neg_hi:[0,1]
    v_pk_add_f32 v[174:175], v[174:175], v[154:155] op_sel_hi:[1,0] neg_lo:[0,1] neg_hi:[0,1]
    v_cvt_pk_bf16_f32 v104, v160, v161
    v_cvt_pk_bf16_f32 v105, v162, v163
    v_cvt_pk_bf16_f32 v106, v164, v165
    v_cvt_pk_bf16_f32 v107, v166, v167
    v_cvt_pk_bf16_f32 v108, v168, v169
    v_cvt_pk_bf16_f32 v109, v170, v171
    v_cvt_pk_bf16_f32 v110, v172, v173
    v_cvt_pk_bf16_f32 v111, v174, v175
    v_lshlrev_b32 v160, 16, v104
    v_and_b32 v161, 0xffff0000, v104
    v_lshlrev_b32 v162, 16, v105
    v_and_b32 v163, 0xffff0000, v105
    v_lshlrev_b32 v164, 16, v106
    v_and_b32 v165, 0xffff0000, v106
    v_lshlrev_b32 v166, 16, v107
    v_and_b32 v167, 0xffff0000, v107
    v_lshlrev_b32 v168, 16, v108
    v_and_b32 v169, 0xffff0000, v108
    v_lshlrev_b32 v170, 16, v109
    v_and_b32 v171, 0xffff0000, v109
    v_lshlrev_b32 v172, 16, v110
    v_and_b32 v173, 0xffff0000, v110
    v_lshlrev_b32 v174, 16, v111
    v_and_b32 v175, 0xffff0000, v111
    v_pk_mul_f32 v[160:161], v[160:161], v[152:153] op_sel_hi:[1,0]
    v_pk_mul_f32 v[162:163], v[162:163], v[152:153] op_sel_hi:[1,0]
    v_pk_mul_f32 v[164:165], v[164:165], v[152:153] op_sel_hi:[1,0]
    v_pk_mul_f32 v[166:167], v[166:167], v[152:153] op_sel_hi:[1,0]
    v_pk_mul_f32 v[168:169], v[168:169], v[152:153] op_sel_hi:[1,0]
    v_pk_mul_f32 v[170:171], v[170:171], v[152:153] op_sel_hi:[1,0]
    v_pk_mul_f32 v[172:173], v[172:173], v[152:153] op_sel_hi:[1,0]
    v_pk_mul_f32 v[174:175], v[174:175], v[152:153] op_sel_hi:[1,0]
    v_cvt_pk_bf16_f32 v160, v160, v161
    v_cvt_pk_bf16_f32 v162, v162, v163
    v_cvt_pk_bf16_f32 v164, v164, v165
    v_cvt_pk_bf16_f32 v166, v166, v167
    v_cvt_pk_bf16_f32 v168, v168, v169
    v_cvt_pk_bf16_f32 v170, v170, v171
    v_cvt_pk_bf16_f32 v172, v172, v173
    v_cvt_pk_bf16_f32 v174, v174, v175
    v_accvgpr_write_b32 a104, v160
    v_accvgpr_write_b32 a105, v162
    v_accvgpr_write_b32 a106, v164
    v_accvgpr_write_b32 a107, v166
    v_accvgpr_write_b32 a108, v168
    v_accvgpr_write_b32 a109, v170
    v_accvgpr_write_b32 a110, v172
    v_accvgpr_write_b32 a111, v174
    v_lshlrev_b32 v160, 16, v112
    v_and_b32 v161, 0xffff0000, v112
    v_lshlrev_b32 v162, 16, v113
    v_and_b32 v163, 0xffff0000, v113
    v_lshlrev_b32 v164, 16, v114
    v_and_b32 v165, 0xffff0000, v114
    v_lshlrev_b32 v166, 16, v115
    v_and_b32 v167, 0xffff0000, v115
    v_lshlrev_b32 v168, 16, v116
    v_and_b32 v169, 0xffff0000, v116
    v_lshlrev_b32 v170, 16, v117
    v_and_b32 v171, 0xffff0000, v117
    v_lshlrev_b32 v172, 16, v118
    v_and_b32 v173, 0xffff0000, v118
    v_lshlrev_b32 v174, 16, v119
    v_and_b32 v175, 0xffff0000, v119
    v_pk_add_f32 v[160:161], v[160:161], v[154:155] op_sel_hi:[1,0] neg_lo:[0,1] neg_hi:[0,1]
    v_pk_add_f32 v[162:163], v[162:163], v[154:155] op_sel_hi:[1,0] neg_lo:[0,1] neg_hi:[0,1]
    v_pk_add_f32 v[164:165], v[164:165], v[154:155] op_sel_hi:[1,0] neg_lo:[0,1] neg_hi:[0,1]
    v_pk_add_f32 v[166:167], v[166:167], v[154:155] op_sel_hi:[1,0] neg_lo:[0,1] neg_hi:[0,1]
    v_pk_add_f32 v[168:169], v[168:169], v[154:155] op_sel_hi:[1,0] neg_lo:[0,1] neg_hi:[0,1]
    v_pk_add_f32 v[170:171], v[170:171], v[154:155] op_sel_hi:[1,0] neg_lo:[0,1] neg_hi:[0,1]
    v_pk_add_f32 v[172:173], v[172:173], v[154:155] op_sel_hi:[1,0] neg_lo:[0,1] neg_hi:[0,1]
    v_pk_add_f32 v[174:175], v[174:175], v[154:155] op_sel_hi:[1,0] neg_lo:[0,1] neg_hi:[0,1]
    v_cvt_pk_bf16_f32 v112, v160, v161
    v_cvt_pk_bf16_f32 v113, v162, v163
    v_cvt_pk_bf16_f32 v114, v164, v165
    v_cvt_pk_bf16_f32 v115, v166, v167
    v_cvt_pk_bf16_f32 v116, v168, v169
    v_cvt_pk_bf16_f32 v117, v170, v171
    v_cvt_pk_bf16_f32 v118, v172, v173
    v_cvt_pk_bf16_f32 v119, v174, v175
    v_lshlrev_b32 v160, 16, v112
    v_and_b32 v161, 0xffff0000, v112
    v_lshlrev_b32 v162, 16, v113
    v_and_b32 v163, 0xffff0000, v113
    v_lshlrev_b32 v164, 16, v114
    v_and_b32 v165, 0xffff0000, v114
    v_lshlrev_b32 v166, 16, v115
    v_and_b32 v167, 0xffff0000, v115
    v_lshlrev_b32 v168, 16, v116
    v_and_b32 v169, 0xffff0000, v116
    v_lshlrev_b32 v170, 16, v117
    v_and_b32 v171, 0xffff0000, v117
    v_lshlrev_b32 v172, 16, v118
    v_and_b32 v173, 0xffff0000, v118
    v_lshlrev_b32 v174, 16, v119
    v_and_b32 v175, 0xffff0000, v119
    v_pk_mul_f32 v[160:161], v[160:161], v[152:153] op_sel_hi:[1,0]
    v_pk_mul_f32 v[162:163], v[162:163], v[152:153] op_sel_hi:[1,0]
    v_pk_mul_f32 v[164:165], v[164:165], v[152:153] op_sel_hi:[1,0]
    v_pk_mul_f32 v[166:167], v[166:167], v[152:153] op_sel_hi:[1,0]
    v_pk_mul_f32 v[168:169], v[168:169], v[152:153] op_sel_hi:[1,0]
    v_pk_mul_f32 v[170:171], v[170:171], v[152:153] op_sel_hi:[1,0]
    v_pk_mul_f32 v[172:173], v[172:173], v[152:153] op_sel_hi:[1,0]
    v_pk_mul_f32 v[174:175], v[174:175], v[152:153] op_sel_hi:[1,0]
    v_cvt_pk_bf16_f32 v160, v160, v161
    v_cvt_pk_bf16_f32 v162, v162, v163
    v_cvt_pk_bf16_f32 v164, v164, v165
    v_cvt_pk_bf16_f32 v166, v166, v167
    v_cvt_pk_bf16_f32 v168, v168, v169
    v_cvt_pk_bf16_f32 v170, v170, v171
    v_cvt_pk_bf16_f32 v172, v172, v173
    v_cvt_pk_bf16_f32 v174, v174, v175
    v_accvgpr_write_b32 a112, v160
    v_accvgpr_write_b32 a113, v162
    v_accvgpr_write_b32 a114, v164
    v_accvgpr_write_b32 a115, v166
    v_accvgpr_write_b32 a116, v168
    v_accvgpr_write_b32 a117, v170
    v_accvgpr_write_b32 a118, v172
    v_accvgpr_write_b32 a119, v174
    v_lshlrev_b32 v160, 16, v120
    v_and_b32 v161, 0xffff0000, v120
    v_lshlrev_b32 v162, 16, v121
    v_and_b32 v163, 0xffff0000, v121
    v_lshlrev_b32 v164, 16, v122
    v_and_b32 v165, 0xffff0000, v122
    v_lshlrev_b32 v166, 16, v123
    v_and_b32 v167, 0xffff0000, v123
    v_lshlrev_b32 v168, 16, v124
    v_and_b32 v169, 0xffff0000, v124
    v_lshlrev_b32 v170, 16, v125
    v_and_b32 v171, 0xffff0000, v125
    v_lshlrev_b32 v172, 16, v126
    v_and_b32 v173, 0xffff0000, v126
    v_lshlrev_b32 v174, 16, v127
    v_and_b32 v175, 0xffff0000, v127
    v_pk_add_f32 v[160:161], v[160:161], v[154:155] op_sel_hi:[1,0] neg_lo:[0,1] neg_hi:[0,1]
    v_pk_add_f32 v[162:163], v[162:163], v[154:155] op_sel_hi:[1,0] neg_lo:[0,1] neg_hi:[0,1]
    v_pk_add_f32 v[164:165], v[164:165], v[154:155] op_sel_hi:[1,0] neg_lo:[0,1] neg_hi:[0,1]
    v_pk_add_f32 v[166:167], v[166:167], v[154:155] op_sel_hi:[1,0] neg_lo:[0,1] neg_hi:[0,1]
    v_pk_add_f32 v[168:169], v[168:169], v[154:155] op_sel_hi:[1,0] neg_lo:[0,1] neg_hi:[0,1]
    v_pk_add_f32 v[170:171], v[170:171], v[154:155] op_sel_hi:[1,0] neg_lo:[0,1] neg_hi:[0,1]
    v_pk_add_f32 v[172:173], v[172:173], v[154:155] op_sel_hi:[1,0] neg_lo:[0,1] neg_hi:[0,1]
    v_pk_add_f32 v[174:175], v[174:175], v[154:155] op_sel_hi:[1,0] neg_lo:[0,1] neg_hi:[0,1]
    v_cvt_pk_bf16_f32 v120, v160, v161
    v_cvt_pk_bf16_f32 v121, v162, v163
    v_cvt_pk_bf16_f32 v122, v164, v165
    v_cvt_pk_bf16_f32 v123, v166, v167
    v_cvt_pk_bf16_f32 v124, v168, v169
    v_cvt_pk_bf16_f32 v125, v170, v171
    v_cvt_pk_bf16_f32 v126, v172, v173
    v_cvt_pk_bf16_f32 v127, v174, v175
    v_lshlrev_b32 v160, 16, v120
    v_and_b32 v161, 0xffff0000, v120
    v_lshlrev_b32 v162, 16, v121
    v_and_b32 v163, 0xffff0000, v121
    v_lshlrev_b32 v164, 16, v122
    v_and_b32 v165, 0xffff0000, v122
    v_lshlrev_b32 v166, 16, v123
    v_and_b32 v167, 0xffff0000, v123
    v_lshlrev_b32 v168, 16, v124
    v_and_b32 v169, 0xffff0000, v124
    v_lshlrev_b32 v170, 16, v125
    v_and_b32 v171, 0xffff0000, v125
    v_lshlrev_b32 v172, 16, v126
    v_and_b32 v173, 0xffff0000, v126
    v_lshlrev_b32 v174, 16, v127
    v_and_b32 v175, 0xffff0000, v127
    v_pk_mul_f32 v[160:161], v[160:161], v[152:153] op_sel_hi:[1,0]
    v_pk_mul_f32 v[162:163], v[162:163], v[152:153] op_sel_hi:[1,0]
    v_pk_mul_f32 v[164:165], v[164:165], v[152:153] op_sel_hi:[1,0]
    v_pk_mul_f32 v[166:167], v[166:167], v[152:153] op_sel_hi:[1,0]
    v_pk_mul_f32 v[168:169], v[168:169], v[152:153] op_sel_hi:[1,0]
    v_pk_mul_f32 v[170:171], v[170:171], v[152:153] op_sel_hi:[1,0]
    v_pk_mul_f32 v[172:173], v[172:173], v[152:153] op_sel_hi:[1,0]
    v_pk_mul_f32 v[174:175], v[174:175], v[152:153] op_sel_hi:[1,0]
    v_cvt_pk_bf16_f32 v160, v160, v161
    v_cvt_pk_bf16_f32 v162, v162, v163
    v_cvt_pk_bf16_f32 v164, v164, v165
    v_cvt_pk_bf16_f32 v166, v166, v167
    v_cvt_pk_bf16_f32 v168, v168, v169
    v_cvt_pk_bf16_f32 v170, v170, v171
    v_cvt_pk_bf16_f32 v172, v172, v173
    v_cvt_pk_bf16_f32 v174, v174, v175
    v_accvgpr_write_b32 a120, v160
    v_accvgpr_write_b32 a121, v162
    v_accvgpr_write_b32 a122, v164
    v_accvgpr_write_b32 a123, v166
    v_accvgpr_write_b32 a124, v168
    v_accvgpr_write_b32 a125, v170
    v_accvgpr_write_b32 a126, v172
    v_accvgpr_write_b32 a127, v174
    s_nop 4
L_p1_unit:
    s_cmp_ge_u32 s38, 96
    s_cbranch_scc1 L_p1_end
    s_lshr_b32 s26, s38, 5
    s_add_u32 s27, s26, 1
    s_lshl_b32 s25, s27, 24
    s_lshl_b32 s27, s20, 2
    s_add_u32 s27, s27, s21
    s_lshl_b32 s27, s27, 5
    s_and_b32 s28, s38, 31
    s_add_u32 s27, s27, s28
    s_lshl_b32 s27, s27, 13
    s_add_u32 s25, s25, s27
    s_lshr_b32 s26, s38, 5
    s_cmp_eq_u32 s26, 1
    s_cbranch_scc1 L_p1_v
    s_waitcnt vmcnt(16)
    s_barrier
    ds_read_b64_tr_b16 v[64:65], v128
    ds_read_b64_tr_b16 v[66:67], v128 offset:1024
    ds_read_b64_tr_b16 v[68:69], v129
    ds_read_b64_tr_b16 v[70:71], v129 offset:1024
    ds_read_b64_tr_b16 v[72:73], v130
    ds_read_b64_tr_b16 v[74:75], v130 offset:1024
    ds_read_b64_tr_b16 v[76:77], v131
    ds_read_b64_tr_b16 v[78:79], v131 offset:1024
    ds_read_b64_tr_b16 v[80:81], v132
    ds_read_b64_tr_b16 v[82:83], v132 offset:1024
    ds_read_b64_tr_b16 v[84:85], v133
    ds_read_b64_tr_b16 v[86:87], v133 offset:1024
    ds_read_b64_tr_b16 v[88:89], v134
    ds_read_b64_tr_b16 v[90:91], v134 offset:1024
    s_waitcnt lgkmcnt(12)
    v_mfma_f32_16x16x32_bf16 v[0:3], v[64:67], a[0:3], 0
    ds_read_b64_tr_b16 v[92:93], v135
    v_mfma_f32_16x16x32_bf16 v[4:7], v[64:67], a[64:67], 0
    ds_read_b64_tr_b16 v[94:95], v135 offset:1024
    s_add_u32 s26, s24, 0x300000
    s_add_u32 m0, s29, 0x18000
    s_nop 0
    buffer_load_dwordx4 v136, s[16:19], s26 offen lds
    s_waitcnt lgkmcnt(12)
    v_mfma_f32_16x16x32_bf16 v[8:11], v[68:71], a[0:3], 0
    ds_read_b64_tr_b16 v[96:97], v128 offset:8192
    v_mfma_f32_16x16x32_bf16 v[12:15], v[68:71], a[64:67], 0
    ds_read_b64_tr_b16 v[98:99], v128 offset:9216
    s_add_u32 s26, s24, 0x320000
    s_add_u32 m0, s29, 0x19000
    s_nop 0
    buffer_load_dwordx4 v136, s[16:19], s26 offen lds
    s_waitcnt lgkmcnt(12)
    v_mfma_f32_16x16x32_bf16 v[16:19], v[72:75], a[0:3], 0
    ds_read_b64_tr_b16 v[100:101], v129 offset:8192
    v_mfma_f32_16x16x32_bf16 v[20:23], v[72:75], a[64:67], 0
    ds_read_b64_tr_b16 v[102:103], v129 offset:9216
    s_add_u32 s26, s24, 0x340000
    s_add_u32 m0, s29, 0x1a000
    s_nop 0
    buffer_load_dwordx4 v136, s[16:19], s26 offen lds
    s_waitcnt lgkmcnt(12)
    v_mfma_f32_16x16x32_bf16 v[24:27], v[76:79], a[0:3], 0
    ds_read_b64_tr_b16 v[104:105], v130 offset:8192
    v_mfma_f32_16x16x32_bf16 v[28:31], v[76:79], a[64:67], 0
    ds_read_b64_tr_b16 v[106:107], v130 offset:9216
    s_add_u32 s26, s24, 0x360000
    s_add_u32 m0, s29, 0x1b000
    s_nop 0
    buffer_load_dwordx4 v136, s[16:19], s26 offen lds
    s_waitcnt lgkmcnt(12)
    v_mfma_f32_16x16x32_bf16 v[32:35], v[80:83], a[0:3], 0
    ds_read_b64_tr_b16 v[108:109], v131 offset:8192
    v_mfma_f32_16x16x32_bf16 v[36:39], v[80:83], a[64:67], 0
    ds_read_b64_tr_b16 v[110:111], v131 offset:9216
    s_add_u32 s26, s24, 0x380000
    s_add_u32 m0, s29, 0x1c000
    s_nop 0
    buffer_load_dwordx4 v136, s[16:19], s26 offen lds
    s_waitcnt lgkmcnt(12)
    v_mfma_f32_16x16x32_bf16 v[40:43], v[84:87], a[0:3], 0
    ds_read_b64_tr_b16 v[112:113], v132 offset:8192
    v_mfma_f32_16x16x32_bf16 v[44:47], v[84:87], a[64:67], 0
    ds_read_b64_tr_b16 v[114:115], v132 offset:9216
    s_add_u32 s26, s24, 0x3a0000
    s_add_u32 m0, s29, 0x1d000
    s_nop 0
    buffer_load_dwordx4 v136, s[16:19], s26 offen lds
    s_waitcnt lgkmcnt(12)
    v_mfma_f32_16x16x32_bf16 v[48:51], v[88:91], a[0:3], 0
    ds_read_b64_tr_b16 v[116:117], v133 offset:8192
    v_mfma_f32_16x16x32_bf16 v[52:55], v[88:91], a[64:67], 0
    ds_read_b64_tr_b16 v[118:119], v133 offset:9216
    s_add_u32 s26, s24, 0x3c0000
    s_add_u32 m0, s29, 0x1e000
    s_nop 0
    buffer_load_dwordx4 v136, s[16:19], s26 offen lds
    s_waitcnt lgkmcnt(12)
    v_mfma_f32_16x16x32_bf16 v[56:59], v[92:95], a[0:3], 0
    ds_read_b64_tr_b16 v[120:121], v134 offset:8192
    v_mfma_f32_16x16x32_bf16 v[60:63], v[92:95], a[64:67], 0
    ds_read_b64_tr_b16 v[122:123], v134 offset:9216
    s_add_u32 s26, s24, 0x3e0000
    s_add_u32 m0, s29, 0x1f000
    s_nop 0
    buffer_load_dwordx4 v136, s[16:19], s26 offen lds
    s_waitcnt lgkmcnt(12)
    v_mfma_f32_16x16x32_bf16 v[0:3], v[96:99], a[4:7], v[0:3]
    ds_read_b64_tr_b16 v[124:125], v135 offset:8192
    v_mfma_f32_16x16x32_bf16 v[4:7], v[96:99], a[68:71], v[4:7]
    ds_read_b64_tr_b16 v[126:127], v135 offset:9216
    s_waitcnt lgkmcnt(12)
    v_mfma_f32_16x16x32_bf16 v[8:11], v[100:103], a[4:7], v[8:11]
    ds_read_b64_tr_b16 v[64:65], v128 offset:16384
    v_mfma_f32_16x16x32_bf16 v[12:15], v[100:103], a[68:71], v[12:15]
    ds_read_b64_tr_b16 v[66:67], v128 offset:17408
    s_waitcnt lgkmcnt(12)
    v_mfma_f32_16x16x32_bf16 v[16:19], v[104:107], a[4:7], v[16:19]
    ds_read_b64_tr_b16 v[68:69], v129 offset:16384
    v_mfma_f32_16x16x32_bf16 v[20:23], v[104:107], a[68:71], v[20:23]
    ds_read_b64_tr_b16 v[70:71], v129 offset:17408
    s_waitcnt lgkmcnt(12)
    v_mfma_f32_16x16x32_bf16 v[24:27], v[108:111], a[4:7], v[24:27]
    ds_read_b64_tr_b16 v[72:73], v130 offset:16384
    v_mfma_f32_16x16x32_bf16 v[28:31], v[108:111], a[68:71], v[28:31]
    ds_read_b64_tr_b16 v[74:75], v130 offset:17408
    s_waitcnt lgkmcnt(12)
    v_mfma_f32_16x16x32_bf16 v[32:35], v[112:115], a[4:7], v[32:35]
    ds_read_b64_tr_b16 v[76:77], v131 offset:16384
    v_mfma_f32_16x16x32_bf16 v[36:39], v[112:115], a[68:71], v[36:39]
    ds_read_b64_tr_b16 v[78:79], v131 offset:17408
    s_waitcnt lgkmcnt(12)
    v_mfma_f32_16x16x32_bf16 v[40:43], v[116:119], a[4:7], v[40:43]
    ds_read_b64_tr_b16 v[80:81], v132 offset:16384
    v_mfma_f32_16x16x32_bf16 v[44:47], v[116:119], a[68:71], v[44:47]
    ds_read_b64_tr_b16 v[82:83], v132 offset:17408
    s_waitcnt lgkmcnt(12)
    v_mfma_f32_16x16x32_bf16 v[48:51], v[120:123], a[4:7], v[48:51]
    ds_read_b64_tr_b16 v[84:85], v133 offset:16384
    v_mfma_f32_16x16x32_bf16 v[52:55], v[120:123], a[68:71], v[52:55]
    ds_read_b64_tr_b16 v[86:87], v133 offset:17408
    s_waitcnt lgkmcnt(12)
    v_mfma_f32_16x16x32_bf16 v[56:59], v[124:127], a[4:7], v[56:59]
    ds_read_b64_tr_b16 v[88:89], v134 offset:16384
    v_mfma_f32_16x16x32_bf16 v[60:63], v[124:127], a[68:71], v[60:63]
    ds_read_b64_tr_b16 v[90:91], v134 offset:17408
    s_waitcnt lgkmcnt(12)
    v_mfma_f32_16x16x32_bf16 v[0:3], v[64:67], a[8:11], v[0:3]
    ds_read_b64_tr_b16 v[92:93], v135 offset:16384
    v_mfma_f32_16x16x32_bf16 v[4:7], v[64:67], a[72:75], v[4:7]
    ds_read_b64_tr_b16 v[94:95], v135 offset:17408
    s_waitcnt lgkmcnt(12)
    v_mfma_f32_16x16x32_bf16 v[8:11], v[68:71], a[8:11], v[8:11]
    ds_read_b64_tr_b16 v[96:97], v128 offset:24576
    v_mfma_f32_16x16x32_bf16 v[12:15], v[68:71], a[72:75], v[12:15]
    ds_read_b64_tr_b16 v[98:99], v128 offset:25600
    s_waitcnt lgkmcnt(12)
    v_mfma_f32_16x16x32_bf16 v[16:19], v[72:75], a[8:11], v[16:19]
    ds_read_b64_tr_b16 v[100:101], v129 offset:24576
    v_mfma_f32_16x16x32_bf16 v[20:23], v[72:75], a[72:75], v[20:23]
    ds_read_b64_tr_b16 v[102:103], v129 offset:25600
    s_waitcnt lgkmcnt(12)
    v_mfma_f32_16x16x32_bf16 v[24:27], v[76:79], a[8:11], v[24:27]
    ds_read_b64_tr_b16 v[104:105], v130 offset:24576
    v_mfma_f32_16x16x32_bf16 v[28:31], v[76:79], a[72:75], v[28:31]
    ds_read_b64_tr_b16 v[106:107], v130 offset:25600
    s_waitcnt lgkmcnt(12)
    v_mfma_f32_16x16x32_bf16 v[32:35], v[80:83], a[8:11], v[32:35]
    ds_read_b64_tr_b16 v[108:109], v131 offset:24576
    v_mfma_f32_16x16x32_bf16 v[36:39], v[80:83], a[72:75], v[36:39]
    ds_read_b64_tr_b16 v[110:111], v131 offset:25600
    s_waitcnt lgkmcnt(12)
    v_mfma_f32_16x16x32_bf16 v[40:43], v[84:87], a[8:11], v[40:43]
    ds_read_b64_tr_b16 v[112:113], v132 offset:24576
    v_mfma_f32_16x16x32_bf16 v[44:47], v[84:87], a[72:75], v[44:47]
    ds_read_b64_tr_b16 v[114:115], v132 offset:25600
    s_waitcnt lgkmcnt(12)
    v_mfma_f32_16x16x32_bf16 v[48:51], v[88:91], a[8:11], v[48:51]
    ds_read_b64_tr_b16 v[116:117], v133 offset:24576
    v_mfma_f32_16x16x32_bf16 v[52:55], v[88:91], a[72:75], v[52:55]
    ds_read_b64_tr_b16 v[118:119], v133 offset:25600
    s_waitcnt lgkmcnt(12)
    v_mfma_f32_16x16x32_bf16 v[56:59], v[92:95], a[8:11], v[56:59]
    ds_read_b64_tr_b16 v[120:121], v134 offset:24576
    v_mfma_f32_16x16x32_bf16 v[60:63], v[92:95], a[72:75], v[60:63]
    ds_read_b64_tr_b16 v[122:123], v134 offset:25600
    s_waitcnt lgkmcnt(12)
    v_mfma_f32_16x16x32_bf16 v[0:3], v[96:99], a[12:15], v[0:3]
    ds_read_b64_tr_b16 v[124:125], v135 offset:24576
    v_mfma_f32_16x16x32_bf16 v[4:7], v[96:99], a[76:79], v[4:7]
    ds_read_b64_tr_b16 v[126:127], v135 offset:25600
    s_waitcnt lgkmcnt(12)
    v_mfma_f32_16x16x32_bf16 v[8:11], v[100:103], a[12:15], v[8:11]
    v_mfma_f32_16x16x32_bf16 v[12:15], v[100:103], a[76:79], v[12:15]
    s_waitcnt lgkmcnt(10)
    v_mfma_f32_16x16x32_bf16 v[16:19], v[104:107], a[12:15], v[16:19]
    v_mfma_f32_16x16x32_bf16 v[20:23], v[104:107], a[76:79], v[20:23]
    s_waitcnt lgkmcnt(8)
    v_mfma_f32_16x16x32_bf16 v[24:27], v[108:111], a[12:15], v[24:27]
    v_mfma_f32_16x16x32_bf16 v[28:31], v[108:111], a[76:79], v[28:31]
    s_waitcnt lgkmcnt(6)
    v_mfma_f32_16x16x32_bf16 v[32:35], v[112:115], a[12:15], v[32:35]
    v_mfma_f32_16x16x32_bf16 v[36:39], v[112:115], a[76:79], v[36:39]
    s_waitcnt lgkmcnt(4)
    v_mfma_f32_16x16x32_bf16 v[40:43], v[116:119], a[12:15], v[40:43]
    v_mfma_f32_16x16x32_bf16 v[44:47], v[116:119], a[76:79], v[44:47]
    s_waitcnt lgkmcnt(2)
    v_mfma_f32_16x16x32_bf16 v[48:51], v[120:123], a[12:15], v[48:51]
    v_mfma_f32_16x16x32_bf16 v[52:55], v[120:123], a[76:79], v[52:55]
    s_waitcnt lgkmcnt(0)
    v_mfma_f32_16x16x32_bf16 v[56:59], v[124:127], a[12:15], v[56:59]
    v_mfma_f32_16x16x32_bf16 v[60:63], v[124:127], a[76:79], v[60:63]
    s_waitcnt vmcnt(16)
    s_barrier
    ds_read_b64_tr_b16 v[64:65], v128 offset:32768
    ds_read_b64_tr_b16 v[66:67], v128 offset:33792
    ds_read_b64_tr_b16 v[68:69], v129 offset:32768
    ds_read_b64_tr_b16 v[70:71], v129 offset:33792
    ds_read_b64_tr_b16 v[72:73], v130 offset:32768
    ds_read_b64_tr_b16 v[74:75], v130 offset:33792
    ds_read_b64_tr_b16 v[76:77], v131 offset:32768
    ds_read_b64_tr_b16 v[78:79], v131 offset:33792
    ds_read_b64_tr_b16 v[80:81], v132 offset:32768
    ds_read_b64_tr_b16 v[82:83], v132 offset:33792
    ds_read_b64_tr_b16 v[84:85], v133 offset:32768
    ds_read_b64_tr_b16 v[86:87], v133 offset:33792
    ds_read_b64_tr_b16 v[88:89], v134 offset:32768
    ds_read_b64_tr_b16 v[90:91], v134 offset:33792
    s_add_u32 s39, s39, s37
    s_lshr_b32 s26, s39, 5
    s_cmp_eq_u32 s26, 0
    s_cselect_b64 s[16:17], s[30:31], s[34:35]
    s_cmp_eq_u32 s26, 1
    s_cselect_b64 s[16:17], s[32:33], s[16:17]
    s_and_b32 s17, s17, 0xffff
    s_cmp_lt_u32 s39, 96
    s_cselect_b32 s18, 0x400000, 0
    s_and_b32 s24, s39, 31
    s_lshl_b32 s24, s24, 8
    s_waitcnt lgkmcnt(12)
    v_mfma_f32_16x16x32_bf16 v[0:3], v[64:67], a[16:19], v[0:3]
    ds_read_b64_tr_b16 v[92:93], v135 offset:32768
    v_mfma_f32_16x16x32_bf16 v[4:7], v[64:67], a[80:83], v[4:7]
    ds_read_b64_tr_b16 v[94:95], v135 offset:33792
    s_add_u32 s26, s24, 0x0
    s_add_u32 m0, s29, 0x0
    s_nop 0
    buffer_load_dwordx4 v136, s[16:19], s26 offen lds
    s_waitcnt lgkmcnt(12)
    v_mfma_f32_16x16x32_bf16 v[8:11], v[68:71], a[16:19], v[8:11]
    ds_read_b64_tr_b16 v[96:97], v128 offset:40960
    v_mfma_f32_16x16x32_bf16 v[12:15], v[68:71], a[80:83], v[12:15]
    ds_read_b64_tr_b16 v[98:99], v128 offset:41984
    s_add_u32 s26, s24, 0x20000
    s_add_u32 m0, s29, 0x1000
    s_nop 0
    buffer_load_dwordx4 v136, s[16:19], s26 offen lds
    s_waitcnt lgkmcnt(12)
    v_mfma_f32_16x16x32_bf16 v[16:19], v[72:75], a[16:19], v[16:19]
    ds_read_b64_tr_b16 v[100:101], v129 offset:40960
    v_mfma_f32_16x16x32_bf16 v[20:23], v[72:75], a[80:83], v[20:23]
    ds_read_b64_tr_b16 v[102:103], v129 offset:41984
    s_add_u32 s26, s24, 0x40000
    s_add_u32 m0, s29, 0x2000
    s_nop 0
    buffer_load_dwordx4 v136, s[16:19], s26 offen lds
    s_waitcnt lgkmcnt(12)
    v_mfma_f32_16x16x32_bf16 v[24:27], v[76:79], a[16:19], v[24:27]
    ds_read_b64_tr_b16 v[104:105], v130 offset:40960
    v_mfma_f32_16x16x32_bf16 v[28:31], v[76:79], a[80:83], v[28:31]
    ds_read_b64_tr_b16 v[106:107], v130 offset:41984
    s_add_u32 s26, s24, 0x60000
    s_add_u32 m0, s29, 0x3000
    s_nop 0
    buffer_load_dwordx4 v136, s[16:19], s26 offen lds
    s_waitcnt lgkmcnt(12)
    v_mfma_f32_16x16x32_bf16 v[32:35], v[80:83], a[16:19], v[32:35]
    ds_read_b64_tr_b16 v[108:109], v131 offset:40960
    v_mfma_f32_16x16x32_bf16 v[36:39], v[80:83], a[80:83], v[36:39]
    ds_read_b64_tr_b16 v[110:111], v131 offset:41984
    s_add_u32 s26, s24, 0x80000
    s_add_u32 m0, s29, 0x4000
    s_nop 0
    buffer_load_dwordx4 v136, s[16:19], s26 offen lds
    s_waitcnt lgkmcnt(12)
    v_mfma_f32_16x16x32_bf16 v[40:43], v[84:87], a[16:19], v[40:43]
    ds_read_b64_tr_b16 v[112:113], v132 offset:40960
    v_mfma_f32_16x16x32_bf16 v[44:47], v[84:87], a[80:83], v[44:47]
    ds_read_b64_tr_b16 v[114:115], v132 offset:41984
    s_add_u32 s26, s24, 0xa0000
    s_add_u32 m0, s29, 0x5000
    s_nop 0
    buffer_load_dwordx4 v136, s[16:19], s26 offen lds
    s_waitcnt lgkmcnt(12)
    v_mfma_f32_16x16x32_bf16 v[48:51], v[88:91], a[16:19], v[48:51]
    ds_read_b64_tr_b16 v[116:117], v133 offset:40960
    v_mfma_f32_16x16x32_bf16 v[52:55], v[88:91], a[80:83], v[52:55]
    ds_read_b64_tr_b16 v[118:119], v133 offset:41984
    s_add_u32 s26, s24, 0xc0000
    s_add_u32 m0, s29, 0x6000
    s_nop 0
    buffer_load_dwordx4 v136, s[16:19], s26 offen lds
    s_waitcnt lgkmcnt(12)
    v_mfma_f32_16x16x32_bf16 v[56:59], v[92:95], a[16:19], v[56:59]
    ds_read_b64_tr_b16 v[120:121], v134 offset:40960
    v_mfma_f32_16x16x32_bf16 v[60:63], v[92:95], a[80:83], v[60:63]
    ds_read_b64_tr_b16 v[122:123], v134 offset:41984
    s_add_u32 s26, s24, 0xe0000
    s_add_u32 m0, s29, 0x7000
    s_nop 0
    buffer_load_dwordx4 v136, s[16:19], s26 offen lds
    s_waitcnt lgkmcnt(12)
    v_mfma_f32_16x16x32_bf16 v[0:3], v[96:99], a[20:23], v[0:3]
    ds_read_b64_tr_b16 v[124:125], v135 offset:40960
    v_mfma_f32_16x16x32_bf16 v[4:7], v[96:99], a[84:87], v[4:7]
    ds_read_b64_tr_b16 v[126:127], v135 offset:41984
    s_waitcnt lgkmcnt(12)
    v_mfma_f32_16x16x32_bf16 v[8:11], v[100:103], a[20:23], v[8:11]
    ds_read_b64_tr_b16 v[64:65], v128 offset:49152
    v_mfma_f32_16x16x32_bf16 v[12:15], v[100:103], a[84:87], v[12:15]
    ds_read_b64_tr_b16 v[66:67], v128 offset:50176
    s_waitcnt lgkmcnt(12)
    v_mfma_f32_16x16x32_bf16 v[16:19], v[104:107], a[20:23], v[16:19]
    ds_read_b64_tr_b16 v[68:69], v129 offset:49152
    v_mfma_f32_16x16x32_bf16 v[20:23], v[104:107], a[84:87], v[20:23]
    ds_read_b64_tr_b16 v[70:71], v129 offset:50176
    s_waitcnt lgkmcnt(12)
    v_mfma_f32_16x16x32_bf16 v[24:27], v[108:111], a[20:23], v[24:27]
    ds_read_b64_tr_b16 v[72:73], v130 offset:49152
    v_mfma_f32_16x16x32_bf16 v[28:31], v[108:111], a[84:87], v[28:31]
    ds_read_b64_tr_b16 v[74:75], v130 offset:50176
    s_waitcnt lgkmcnt(12)
    v_mfma_f32_16x16x32_bf16 v[32:35], v[112:115], a[20:23], v[32:35]
    ds_read_b64_tr_b16 v[76:77], v131 offset:49152
    v_mfma_f32_16x16x32_bf16 v[36:39], v[112:115], a[84:87], v[36:39]
    ds_read_b64_tr_b16 v[78:79], v131 offset:50176
    s_waitcnt lgkmcnt(12)
    v_mfma_f32_16x16x32_bf16 v[40:43], v[116:119], a[20:23], v[40:43]
    ds_read_b64_tr_b16 v[80:81], v132 offset:49152
    v_mfma_f32_16x16x32_bf16 v[44:47], v[116:119], a[84:87], v[44:47]
    ds_read_b64_tr_b16 v[82:83], v132 offset:50176
    s_waitcnt lgkmcnt(12)
    v_mfma_f32_16x16x32_bf16 v[48:51], v[120:123], a[20:23], v[48:51]
    ds_read_b64_tr_b16 v[84:85], v133 offset:49152
    v_mfma_f32_16x16x32_bf16 v[52:55], v[120:123], a[84:87], v[52:55]
    ds_read_b64_tr_b16 v[86:87], v133 offset:50176
    s_waitcnt lgkmcnt(12)
    v_mfma_f32_16x16x32_bf16 v[56:59], v[124:127], a[20:23], v[56:59]
    ds_read_b64_tr_b16 v[88:89], v134 offset:49152
    v_mfma_f32_16x16x32_bf16 v[60:63], v[124:127], a[84:87], v[60:63]
    ds_read_b64_tr_b16 v[90:91], v134 offset:50176
    s_waitcnt lgkmcnt(12)
    v_mfma_f32_16x16x32_bf16 v[0:3], v[64:67], a[24:27], v[0:3]
    ds_read_b64_tr_b16 v[92:93], v135 offset:49152
    v_mfma_f32_16x16x32_bf16 v[4:7], v[64:67], a[88:91], v[4:7]
    ds_read_b64_tr_b16 v[94:95], v135 offset:50176
    s_waitcnt lgkmcnt(12)
    v_mfma_f32_16x16x32_bf16 v[8:11], v[68:71], a[24:27], v[8:11]
    ds_read_b64_tr_b16 v[96:97], v128 offset:57344
    v_mfma_f32_16x16x32_bf16 v[12:15], v[68:71], a[88:91], v[12:15]
    ds_read_b64_tr_b16 v[98:99], v128 offset:58368
    s_waitcnt lgkmcnt(12)
    v_mfma_f32_16x16x32_bf16 v[16:19], v[72:75], a[24:27], v[16:19]
    ds_read_b64_tr_b16 v[100:101], v129 offset:57344
    v_mfma_f32_16x16x32_bf16 v[20:23], v[72:75], a[88:91], v[20:23]
    ds_read_b64_tr_b16 v[102:103], v129 offset:58368
    s_waitcnt lgkmcnt(12)
    v_mfma_f32_16x16x32_bf16 v[24:27], v[76:79], a[24:27], v[24:27]
    ds_read_b64_tr_b16 v[104:105], v130 offset:57344
    v_mfma_f32_16x16x32_bf16 v[28:31], v[76:79], a[88:91], v[28:31]
    ds_read_b64_tr_b16 v[106:107], v130 offset:58368
    s_waitcnt lgkmcnt(12)
    v_mfma_f32_16x16x32_bf16 v[32:35], v[80:83], a[24:27], v[32:35]
    ds_read_b64_tr_b16 v[108:109], v131 offset:57344
    v_mfma_f32_16x16x32_bf16 v[36:39], v[80:83], a[88:91], v[36:39]
    ds_read_b64_tr_b16 v[110:111], v131 offset:58368
    s_waitcnt lgkmcnt(12)
    v_mfma_f32_16x16x32_bf16 v[40:43], v[84:87], a[24:27], v[40:43]
    ds_read_b64_tr_b16 v[112:113], v132 offset:57344
    v_mfma_f32_16x16x32_bf16 v[44:47], v[84:87], a[88:91], v[44:47]
    ds_read_b64_tr_b16 v[114:115], v132 offset:58368
    s_waitcnt lgkmcnt(12)
    v_mfma_f32_16x16x32_bf16 v[48:51], v[88:91], a[24:27], v[48:51]
    ds_read_b64_tr_b16 v[116:117], v133 offset:57344
    v_mfma_f32_16x16x32_bf16 v[52:55], v[88:91], a[88:91], v[52:55]
    ds_read_b64_tr_b16 v[118:119], v133 offset:58368
    s_waitcnt lgkmcnt(12)
    v_mfma_f32_16x16x32_bf16 v[56:59], v[92:95], a[24:27], v[56:59]
    ds_read_b64_tr_b16 v[120:121], v134 offset:57344
    v_mfma_f32_16x16x32_bf16 v[60:63], v[92:95], a[88:91], v[60:63]
    ds_read_b64_tr_b16 v[122:123], v134 offset:58368
    s_waitcnt lgkmcnt(12)
    v_mfma_f32_16x16x32_bf16 v[0:3], v[96:99], a[28:31], v[0:3]
    ds_read_b64_tr_b16 v[124:125], v135 offset:57344
    v_mfma_f32_16x16x32_bf16 v[4:7], v[96:99], a[92:95], v[4:7]
    ds_read_b64_tr_b16 v[126:127], v135 offset:58368
    s_waitcnt lgkmcnt(12)
    v_mfma_f32_16x16x32_bf16 v[8:11], v[100:103], a[28:31], v[8:11]
    v_mfma_f32_16x16x32_bf16 v[12:15], v[100:103], a[92:95], v[12:15]
    s_waitcnt lgkmcnt(10)
    v_mfma_f32_16x16x32_bf16 v[16:19], v[104:107], a[28:31], v[16:19]
    v_mfma_f32_16x16x32_bf16 v[20:23], v[104:107], a[92:95], v[20:23]
    s_waitcnt lgkmcnt(8)
    v_mfma_f32_16x16x32_bf16 v[24:27], v[108:111], a[28:31], v[24:27]
    v_mfma_f32_16x16x32_bf16 v[28:31], v[108:111], a[92:95], v[28:31]
    s_waitcnt lgkmcnt(6)
    v_mfma_f32_16x16x32_bf16 v[32:35], v[112:115], a[28:31], v[32:35]
    v_mfma_f32_16x16x32_bf16 v[36:39], v[112:115], a[92:95], v[36:39]
    s_waitcnt lgkmcnt(4)
    v_mfma_f32_16x16x32_bf16 v[40:43], v[116:119], a[28:31], v[40:43]
    v_mfma_f32_16x16x32_bf16 v[44:47], v[116:119], a[92:95], v[44:47]
    s_waitcnt lgkmcnt(2)
    v_mfma_f32_16x16x32_bf16 v[48:51], v[120:123], a[28:31], v[48:51]
    v_mfma_f32_16x16x32_bf16 v[52:55], v[120:123], a[92:95], v[52:55]
    s_waitcnt lgkmcnt(0)
    v_mfma_f32_16x16x32_bf16 v[56:59], v[124:127], a[28:31], v[56:59]
    v_mfma_f32_16x16x32_bf16 v[60:63], v[124:127], a[92:95], v[60:63]
    v_xor_b32 v128, 0x10000, v128
    v_xor_b32 v129, 0x10000, v129
    v_xor_b32 v130, 0x10000, v130
    v_xor_b32 v131, 0x10000, v131
    v_xor_b32 v132, 0x10000, v132
    v_xor_b32 v133, 0x10000, v133
    v_xor_b32 v134, 0x10000, v134
    v_xor_b32 v135, 0x10000, v135
    s_waitcnt vmcnt(16)
    s_barrier
    ds_read_b64_tr_b16 v[64:65], v128
    ds_read_b64_tr_b16 v[66:67], v128 offset:1024
    ds_read_b64_tr_b16 v[68:69], v129
    ds_read_b64_tr_b16 v[70:71], v129 offset:1024
    ds_read_b64_tr_b16 v[72:73], v130
    ds_read_b64_tr_b16 v[74:75], v130 offset:1024
    ds_read_b64_tr_b16 v[76:77], v131
    ds_read_b64_tr_b16 v[78:79], v131 offset:1024
    ds_read_b64_tr_b16 v[80:81], v132
    ds_read_b64_tr_b16 v[82:83], v132 offset:1024
    ds_read_b64_tr_b16 v[84:85], v133
    ds_read_b64_tr_b16 v[86:87], v133 offset:1024
    ds_read_b64_tr_b16 v[88:89], v134
    ds_read_b64_tr_b16 v[90:91], v134 offset:1024
    s_cmp_eq_u32 s40, 0
    s_cbranch_scc1 L_nopf_86
    s_cmp_lg_u32 s87, 0
    s_cbranch_scc1 L_modeok_87
    s_mov_b32 s96, 0
L_mode_88:
    buffer_load_dwordx2 v[140:141], off, s[92:95], 0 offset:36 sc1
    s_waitcnt vmcnt(0)
    v_readfirstlane_b32 s87, v140
    v_readfirstlane_b32 s97, v141
    s_nop 0
    s_min_u32 s97, s97, s87
    s_cmp_lg_u32 s97, 0
    s_cbranch_scc1 L_moded_89
    s_sleep 4
    s_add_u32 s96, s96, 1
    s_cmp_lg_u32 s96, 0x100
    s_cbranch_scc1 L_modef_90
    v_mov_b32 v140, 2
    v_mov_b32 v141, 0
    s_mov_b64 exec, 1
    buffer_atomic_cmpswap v[140:141], off, s[92:95], 0 offset:36
    s_mov_b64 exec, -1
L_modef_90:
    s_cmp_lt_u32 s96, 0x10000
    s_cbranch_scc1 L_mode_88
L_moded_89:
    s_cmp_lg_u32 s87, 1
    s_cbranch_scc1 L_fallback
L_modeok_87:
    s_cmp_lg_u32 s100, 0
    s_cbranch_scc1 L_flag_91
    v_mov_b32 v138, 1
    s_mov_b64 exec, 1
    buffer_store_dword v138, off, s[8:11], s40 sc1
    s_mov_b64 exec, -1
L_flag_91:
    s_mov_b32 s40, 0
L_nopf_86:
    s_waitcnt lgkmcnt(12)
    v_mfma_f32_16x16x32_bf16 v[0:3], v[64:67], a[32:35], v[0:3]
    ds_read_b64_tr_b16 v[92:93], v135
    v_mfma_f32_16x16x32_bf16 v[4:7], v[64:67], a[96:99], v[4:7]
    ds_read_b64_tr_b16 v[94:95], v135 offset:1024
    s_add_u32 s26, s24, 0x100000
    s_add_u32 m0, s29, 0x8000
    s_nop 0
    buffer_load_dwordx4 v136, s[16:19], s26 offen lds
    s_waitcnt lgkmcnt(12)
    v_mfma_f32_16x16x32_bf16 v[8:11], v[68:71], a[32:35], v[8:11]
    ds_read_b64_tr_b16 v[96:97], v128 offset:8192
    v_mfma_f32_16x16x32_bf16 v[12:15], v[68:71], a[96:99], v[12:15]
    ds_read_b64_tr_b16 v[98:99], v128 offset:9216
    s_add_u32 s26, s24, 0x120000
    s_add_u32 m0, s29, 0x9000
    s_nop 0
    buffer_load_dwordx4 v136, s[16:19], s26 offen lds
    s_waitcnt lgkmcnt(12)
    v_mfma_f32_16x16x32_bf16 v[16:19], v[72:75], a[32:35], v[16:19]
    ds_read_b64_tr_b16 v[100:101], v129 offset:8192
    v_mfma_f32_16x16x32_bf16 v[20:23], v[72:75], a[96:99], v[20:23]
    ds_read_b64_tr_b16 v[102:103], v129 offset:9216
    s_add_u32 s26, s24, 0x140000
    s_add_u32 m0, s29, 0xa000
    s_nop 0
    buffer_load_dwordx4 v136, s[16:19], s26 offen lds
    s_waitcnt lgkmcnt(12)
    v_mfma_f32_16x16x32_bf16 v[24:27], v[76:79], a[32:35], v[24:27]
    ds_read_b64_tr_b16 v[104:105], v130 offset:8192
    v_mfma_f32_16x16x32_bf16 v[28:31], v[76:79], a[96:99], v[28:31]
    ds_read_b64_tr_b16 v[106:107], v130 offset:9216
    s_add_u32 s26, s24, 0x160000
    s_add_u32 m0, s29, 0xb000
    s_nop 0
    buffer_load_dwordx4 v136, s[16:19], s26 offen lds
    s_waitcnt lgkmcnt(12)
    v_mfma_f32_16x16x32_bf16 v[32:35], v[80:83], a[32:35], v[32:35]
    ds_read_b64_tr_b16 v[108:109], v131 offset:8192
    v_mfma_f32_16x16x32_bf16 v[36:39], v[80:83], a[96:99], v[36:39]
    ds_read_b64_tr_b16 v[110:111], v131 offset:9216
    s_add_u32 s26, s24, 0x180000
    s_add_u32 m0, s29, 0xc000
    s_nop 0
    buffer_load_dwordx4 v136, s[16:19], s26 offen lds
    s_waitcnt lgkmcnt(12)
    v_mfma_f32_16x16x32_bf16 v[40:43], v[84:87], a[32:35], v[40:43]
    ds_read_b64_tr_b16 v[112:113], v132 offset:8192
    v_mfma_f32_16x16x32_bf16 v[44:47], v[84:87], a[96:99], v[44:47]
    ds_read_b64_tr_b16 v[114:115], v132 offset:9216
    s_add_u32 s26, s24, 0x1a0000
    s_add_u32 m0, s29, 0xd000
    s_nop 0
    buffer_load_dwordx4 v136, s[16:19], s26 offen lds
    s_waitcnt lgkmcnt(12)
    v_mfma_f32_16x16x32_bf16 v[48:51], v[88:91], a[32:35], v[48:51]
    ds_read_b64_tr_b16 v[116:117], v133 offset:8192
    v_mfma_f32_16x16x32_bf16 v[52:55], v[88:91], a[96:99], v[52:55]
    ds_read_b64_tr_b16 v[118:119], v133 offset:9216
    s_add_u32 s26, s24, 0x1c0000
    s_add_u32 m0, s29, 0xe000
    s_nop 0
    buffer_load_dwordx4 v136, s[16:19], s26 offen lds
    s_waitcnt lgkmcnt(12)
    v_mfma_f32_16x16x32_bf16 v[56:59], v[92:95], a[32:35], v[56:59]
    ds_read_b64_tr_b16 v[120:121], v134 offset:8192
    v_mfma_f32_16x16x32_bf16 v[60:63], v[92:95], a[96:99], v[60:63]
    ds_read_b64_tr_b16 v[122:123], v134 offset:9216
    s_add_u32 s26, s24, 0x1e0000
    s_add_u32 m0, s29, 0xf000
    s_nop 0
    buffer_load_dwordx4 v136, s[16:19], s26 offen lds
    s_waitcnt lgkmcnt(12)
    v_mfma_f32_16x16x32_bf16 v[0:3], v[96:99], a[36:39], v[0:3]
    ds_read_b64_tr_b16 v[124:125], v135 offset:8192
    v_mfma_f32_16x16x32_bf16 v[4:7], v[96:99], a[100:103], v[4:7]
    ds_read_b64_tr_b16 v[126:127], v135 offset:9216
    s_waitcnt lgkmcnt(12)
    v_mfma_f32_16x16x32_bf16 v[8:11], v[100:103], a[36:39], v[8:11]
    ds_read_b64_tr_b16 v[64:65], v128 offset:16384
    v_mfma_f32_16x16x32_bf16 v[12:15], v[100:103], a[100:103], v[12:15]
    ds_read_b64_tr_b16 v[66:67], v128 offset:17408
    s_waitcnt lgkmcnt(12)
    v_mfma_f32_16x16x32_bf16 v[16:19], v[104:107], a[36:39], v[16:19]
    ds_read_b64_tr_b16 v[68:69], v129 offset:16384
    v_mfma_f32_16x16x32_bf16 v[20:23], v[104:107], a[100:103], v[20:23]
    ds_read_b64_tr_b16 v[70:71], v129 offset:17408
    s_waitcnt lgkmcnt(12)
    v_mfma_f32_16x16x32_bf16 v[24:27], v[108:111], a[36:39], v[24:27]
    ds_read_b64_tr_b16 v[72:73], v130 offset:16384
    v_mfma_f32_16x16x32_bf16 v[28:31], v[108:111], a[100:103], v[28:31]
    ds_read_b64_tr_b16 v[74:75], v130 offset:17408
    s_waitcnt lgkmcnt(12)
    v_mfma_f32_16x16x32_bf16 v[32:35], v[112:115], a[36:39], v[32:35]
    ds_read_b64_tr_b16 v[76:77], v131 offset:16384
    v_mfma_f32_16x16x32_bf16 v[36:39], v[112:115], a[100:103], v[36:39]
    ds_read_b64_tr_b16 v[78:79], v131 offset:17408
    s_waitcnt lgkmcnt(12)
    v_mfma_f32_16x16x32_bf16 v[40:43], v[116:119], a[36:39], v[40:43]
    ds_read_b64_tr_b16 v[80:81], v132 offset:16384
    v_mfma_f32_16x16x32_bf16 v[44:47], v[116:119], a[100:103], v[44:47]
    ds_read_b64_tr_b16 v[82:83], v132 offset:17408
    s_waitcnt lgkmcnt(12)
    v_mfma_f32_16x16x32_bf16 v[48:51], v[120:123], a[36:39], v[48:51]
    ds_read_b64_tr_b16 v[84:85], v133 offset:16384
    v_mfma_f32_16x16x32_bf16 v[52:55], v[120:123], a[100:103], v[52:55]
    ds_read_b64_tr_b16 v[86:87], v133 offset:17408
    s_waitcnt lgkmcnt(12)
    v_mfma_f32_16x16x32_bf16 v[56:59], v[124:127], a[36:39], v[56:59]
    ds_read_b64_tr_b16 v[88:89], v134 offset:16384
    v_mfma_f32_16x16x32_bf16 v[60:63], v[124:127], a[100:103], v[60:63]
    ds_read_b64_tr_b16 v[90:91], v134 offset:17408
    s_waitcnt lgkmcnt(12)
    v_mfma_f32_16x16x32_bf16 v[0:3], v[64:67], a[40:43], v[0:3]
    ds_read_b64_tr_b16 v[92:93], v135 offset:16384
    v_mfma_f32_16x16x32_bf16 v[4:7], v[64:67], a[104:107], v[4:7]
    ds_read_b64_tr_b16 v[94:95], v135 offset:17408
    s_waitcnt lgkmcnt(12)
    v_mfma_f32_16x16x32_bf16 v[8:11], v[68:71], a[40:43], v[8:11]
    ds_read_b64_tr_b16 v[96:97], v128 offset:24576
    v_mfma_f32_16x16x32_bf16 v[12:15], v[68:71], a[104:107], v[12:15]
    ds_read_b64_tr_b16 v[98:99], v128 offset:25600
    s_waitcnt lgkmcnt(12)
    v_mfma_f32_16x16x32_bf16 v[16:19], v[72:75], a[40:43], v[16:19]
    ds_read_b64_tr_b16 v[100:101], v129 offset:24576
    v_mfma_f32_16x16x32_bf16 v[20:23], v[72:75], a[104:107], v[20:23]
    ds_read_b64_tr_b16 v[102:103], v129 offset:25600
    s_waitcnt lgkmcnt(12)
    v_mfma_f32_16x16x32_bf16 v[24:27], v[76:79], a[40:43], v[24:27]
    ds_read_b64_tr_b16 v[104:105], v130 offset:24576
    v_mfma_f32_16x16x32_bf16 v[28:31], v[76:79], a[104:107], v[28:31]
    ds_read_b64_tr_b16 v[106:107], v130 offset:25600
    s_waitcnt lgkmcnt(12)
    v_mfma_f32_16x16x32_bf16 v[32:35], v[80:83], a[40:43], v[32:35]
    ds_read_b64_tr_b16 v[108:109], v131 offset:24576
    v_mfma_f32_16x16x32_bf16 v[36:39], v[80:83], a[104:107], v[36:39]
    ds_read_b64_tr_b16 v[110:111], v131 offset:25600
    s_waitcnt lgkmcnt(12)
    v_mfma_f32_16x16x32_bf16 v[40:43], v[84:87], a[40:43], v[40:43]
    ds_read_b64_tr_b16 v[112:113], v132 offset:24576
    v_mfma_f32_16x16x32_bf16 v[44:47], v[84:87], a[104:107], v[44:47]
    ds_read_b64_tr_b16 v[114:115], v132 offset:25600
    s_waitcnt lgkmcnt(12)
    v_mfma_f32_16x16x32_bf16 v[48:51], v[88:91], a[40:43], v[48:51]
    ds_read_b64_tr_b16 v[116:117], v133 offset:24576
    v_mfma_f32_16x16x32_bf16 v[52:55], v[88:91], a[104:107], v[52:55]
    ds_read_b64_tr_b16 v[118:119], v133 offset:25600
    s_waitcnt lgkmcnt(12)
    v_mfma_f32_16x16x32_bf16 v[56:59], v[92:95], a[40:43], v[56:59]
    ds_read_b64_tr_b16 v[120:121], v134 offset:24576
    v_mfma_f32_16x16x32_bf16 v[60:63], v[92:95], a[104:107], v[60:63]
    ds_read_b64_tr_b16 v[122:123], v134 offset:25600
    s_waitcnt lgkmcnt(12)
    v_mfma_f32_16x16x32_bf16 v[0:3], v[96:99], a[44:47], v[0:3]
    ds_read_b64_tr_b16 v[124:125], v135 offset:24576
    v_mfma_f32_16x16x32_bf16 v[4:7], v[96:99], a[108:111], v[4:7]
    ds_read_b64_tr_b16 v[126:127], v135 offset:25600
    s_waitcnt lgkmcnt(12)
    v_mfma_f32_16x16x32_bf16 v[8:11], v[100:103], a[44:47], v[8:11]
    v_mfma_f32_16x16x32_bf16 v[12:15], v[100:103], a[108:111], v[12:15]
    s_waitcnt lgkmcnt(10)
    v_mfma_f32_16x16x32_bf16 v[16:19], v[104:107], a[44:47], v[16:19]
    v_mfma_f32_16x16x32_bf16 v[20:23], v[104:107], a[108:111], v[20:23]
    s_waitcnt lgkmcnt(8)
    v_mfma_f32_16x16x32_bf16 v[24:27], v[108:111], a[44:47], v[24:27]
    v_mfma_f32_16x16x32_bf16 v[28:31], v[108:111], a[108:111], v[28:31]
    s_waitcnt lgkmcnt(6)
    v_mfma_f32_16x16x32_bf16 v[32:35], v[112:115], a[44:47], v[32:35]
    v_mfma_f32_16x16x32_bf16 v[36:39], v[112:115], a[108:111], v[36:39]
    s_waitcnt lgkmcnt(4)
    v_mfma_f32_16x16x32_bf16 v[40:43], v[116:119], a[44:47], v[40:43]
    v_mfma_f32_16x16x32_bf16 v[44:47], v[116:119], a[108:111], v[44:47]
    s_waitcnt lgkmcnt(2)
    v_mfma_f32_16x16x32_bf16 v[48:51], v[120:123], a[44:47], v[48:51]
    v_mfma_f32_16x16x32_bf16 v[52:55], v[120:123], a[108:111], v[52:55]
    s_waitcnt lgkmcnt(0)
    v_mfma_f32_16x16x32_bf16 v[56:59], v[124:127], a[44:47], v[56:59]
    v_mfma_f32_16x16x32_bf16 v[60:63], v[124:127], a[108:111], v[60:63]
    s_waitcnt vmcnt(16)
    s_barrier
    ds_read_b64_tr_b16 v[64:65], v128 offset:32768
    ds_read_b64_tr_b16 v[66:67], v128 offset:33792
    ds_read_b64_tr_b16 v[68:69], v129 offset:32768
    ds_read_b64_tr_b16 v[70:71], v129 offset:33792
    ds_read_b64_tr_b16 v[72:73], v130 offset:32768
    ds_read_b64_tr_b16 v[74:75], v130 offset:33792
    ds_read_b64_tr_b16 v[76:77], v131 offset:32768
    ds_read_b64_tr_b16 v[78:79], v131 offset:33792
    ds_read_b64_tr_b16 v[80:81], v132 offset:32768
    ds_read_b64_tr_b16 v[82:83], v132 offset:33792
    ds_read_b64_tr_b16 v[84:85], v133 offset:32768
    ds_read_b64_tr_b16 v[86:87], v133 offset:33792
    ds_read_b64_tr_b16 v[88:89], v134 offset:32768
    ds_read_b64_tr_b16 v[90:91], v134 offset:33792
    s_waitcnt lgkmcnt(12)
    v_mfma_f32_16x16x32_bf16 v[0:3], v[64:67], a[48:51], v[0:3]
    ds_read_b64_tr_b16 v[92:93], v135 offset:32768
    v_mfma_f32_16x16x32_bf16 v[4:7], v[64:67], a[112:115], v[4:7]
    ds_read_b64_tr_b16 v[94:95], v135 offset:33792
    s_add_u32 s26, s24, 0x200000
    s_add_u32 m0, s29, 0x10000
    s_nop 0
    buffer_load_dwordx4 v136, s[16:19], s26 offen lds
    s_waitcnt lgkmcnt(12)
    v_mfma_f32_16x16x32_bf16 v[8:11], v[68:71], a[48:51], v[8:11]
    ds_read_b64_tr_b16 v[96:97], v128 offset:40960
    v_mfma_f32_16x16x32_bf16 v[12:15], v[68:71], a[112:115], v[12:15]
    ds_read_b64_tr_b16 v[98:99], v128 offset:41984
    s_add_u32 s26, s24, 0x220000
    s_add_u32 m0, s29, 0x11000
    s_nop 0
    buffer_load_dwordx4 v136, s[16:19], s26 offen lds
    s_waitcnt lgkmcnt(12)
    v_mfma_f32_16x16x32_bf16 v[16:19], v[72:75], a[48:51], v[16:19]
    ds_read_b64_tr_b16 v[100:101], v129 offset:40960
    v_mfma_f32_16x16x32_bf16 v[20:23], v[72:75], a[112:115], v[20:23]
    ds_read_b64_tr_b16 v[102:103], v129 offset:41984
    s_add_u32 s26, s24, 0x240000
    s_add_u32 m0, s29, 0x12000
    s_nop 0
    buffer_load_dwordx4 v136, s[16:19], s26 offen lds
    s_waitcnt lgkmcnt(12)
    v_mfma_f32_16x16x32_bf16 v[24:27], v[76:79], a[48:51], v[24:27]
    ds_read_b64_tr_b16 v[104:105], v130 offset:40960
    v_mfma_f32_16x16x32_bf16 v[28:31], v[76:79], a[112:115], v[28:31]
    ds_read_b64_tr_b16 v[106:107], v130 offset:41984
    s_add_u32 s26, s24, 0x260000
    s_add_u32 m0, s29, 0x13000
    s_nop 0
    buffer_load_dwordx4 v136, s[16:19], s26 offen lds
    s_waitcnt lgkmcnt(12)
    v_mfma_f32_16x16x32_bf16 v[32:35], v[80:83], a[48:51], v[32:35]
    ds_read_b64_tr_b16 v[108:109], v131 offset:40960
    v_mfma_f32_16x16x32_bf16 v[36:39], v[80:83], a[112:115], v[36:39]
    ds_read_b64_tr_b16 v[110:111], v131 offset:41984
    s_add_u32 s26, s24, 0x280000
    s_add_u32 m0, s29, 0x14000
    s_nop 0
    buffer_load_dwordx4 v136, s[16:19], s26 offen lds
    s_waitcnt lgkmcnt(12)
    v_mfma_f32_16x16x32_bf16 v[40:43], v[84:87], a[48:51], v[40:43]
    ds_read_b64_tr_b16 v[112:113], v132 offset:40960
    v_mfma_f32_16x16x32_bf16 v[44:47], v[84:87], a[112:115], v[44:47]
    ds_read_b64_tr_b16 v[114:115], v132 offset:41984
    s_add_u32 s26, s24, 0x2a0000
    s_add_u32 m0, s29, 0x15000
    s_nop 0
    buffer_load_dwordx4 v136, s[16:19], s26 offen lds
    s_waitcnt lgkmcnt(12)
    v_mfma_f32_16x16x32_bf16 v[48:51], v[88:91], a[48:51], v[48:51]
    ds_read_b64_tr_b16 v[116:117], v133 offset:40960
    v_mfma_f32_16x16x32_bf16 v[52:55], v[88:91], a[112:115], v[52:55]
    ds_read_b64_tr_b16 v[118:119], v133 offset:41984
    s_add_u32 s26, s24, 0x2c0000
    s_add_u32 m0, s29, 0x16000
    s_nop 0
    buffer_load_dwordx4 v136, s[16:19], s26 offen lds
    s_waitcnt lgkmcnt(12)
    v_mfma_f32_16x16x32_bf16 v[56:59], v[92:95], a[48:51], v[56:59]
    ds_read_b64_tr_b16 v[120:121], v134 offset:40960
    v_mfma_f32_16x16x32_bf16 v[60:63], v[92:95], a[112:115], v[60:63]
    ds_read_b64_tr_b16 v[122:123], v134 offset:41984
    s_add_u32 s26, s24, 0x2e0000
    s_add_u32 m0, s29, 0x17000
    s_nop 0
    buffer_load_dwordx4 v136, s[16:19], s26 offen lds
    s_waitcnt lgkmcnt(12)
    v_mfma_f32_16x16x32_bf16 v[0:3], v[96:99], a[52:55], v[0:3]
    ds_read_b64_tr_b16 v[124:125], v135 offset:40960
    v_mfma_f32_16x16x32_bf16 v[4:7], v[96:99], a[116:119], v[4:7]
    ds_read_b64_tr_b16 v[126:127], v135 offset:41984
    s_waitcnt lgkmcnt(12)
    v_mfma_f32_16x16x32_bf16 v[8:11], v[100:103], a[52:55], v[8:11]
    ds_read_b64_tr_b16 v[64:65], v128 offset:49152
    v_mfma_f32_16x16x32_bf16 v[12:15], v[100:103], a[116:119], v[12:15]
    ds_read_b64_tr_b16 v[66:67], v128 offset:50176
    s_waitcnt lgkmcnt(12)
    v_mfma_f32_16x16x32_bf16 v[16:19], v[104:107], a[52:55], v[16:19]
    ds_read_b64_tr_b16 v[68:69], v129 offset:49152
    v_mfma_f32_16x16x32_bf16 v[20:23], v[104:107], a[116:119], v[20:23]
    ds_read_b64_tr_b16 v[70:71], v129 offset:50176
    s_waitcnt lgkmcnt(12)
    v_mfma_f32_16x16x32_bf16 v[24:27], v[108:111], a[52:55], v[24:27]
    ds_read_b64_tr_b16 v[72:73], v130 offset:49152
    v_mfma_f32_16x16x32_bf16 v[28:31], v[108:111], a[116:119], v[28:31]
    ds_read_b64_tr_b16 v[74:75], v130 offset:50176
    s_waitcnt lgkmcnt(12)
    v_mfma_f32_16x16x32_bf16 v[32:35], v[112:115], a[52:55], v[32:35]
    ds_read_b64_tr_b16 v[76:77], v131 offset:49152
    v_mfma_f32_16x16x32_bf16 v[36:39], v[112:115], a[116:119], v[36:39]
    ds_read_b64_tr_b16 v[78:79], v131 offset:50176
    s_waitcnt lgkmcnt(12)
    v_mfma_f32_16x16x32_bf16 v[40:43], v[116:119], a[52:55], v[40:43]
    ds_read_b64_tr_b16 v[80:81], v132 offset:49152
    v_mfma_f32_16x16x32_bf16 v[44:47], v[116:119], a[116:119], v[44:47]
    ds_read_b64_tr_b16 v[82:83], v132 offset:50176
    s_waitcnt lgkmcnt(12)
    v_mfma_f32_16x16x32_bf16 v[48:51], v[120:123], a[52:55], v[48:51]
    ds_read_b64_tr_b16 v[84:85], v133 offset:49152
    v_mfma_f32_16x16x32_bf16 v[52:55], v[120:123], a[116:119], v[52:55]
    ds_read_b64_tr_b16 v[86:87], v133 offset:50176
    s_waitcnt lgkmcnt(12)
    v_mfma_f32_16x16x32_bf16 v[56:59], v[124:127], a[52:55], v[56:59]
    ds_read_b64_tr_b16 v[88:89], v134 offset:49152
    v_mfma_f32_16x16x32_bf16 v[60:63], v[124:127], a[116:119], v[60:63]
    ds_read_b64_tr_b16 v[90:91], v134 offset:50176
    s_waitcnt lgkmcnt(12)
    v_mfma_f32_16x16x32_bf16 v[0:3], v[64:67], a[56:59], v[0:3]
    ds_read_b64_tr_b16 v[92:93], v135 offset:49152
    v_mfma_f32_16x16x32_bf16 v[4:7], v[64:67], a[120:123], v[4:7]
    ds_read_b64_tr_b16 v[94:95], v135 offset:50176
    s_waitcnt lgkmcnt(12)
    v_mfma_f32_16x16x32_bf16 v[8:11], v[68:71], a[56:59], v[8:11]
    ds_read_b64_tr_b16 v[96:97], v128 offset:57344
    v_mfma_f32_16x16x32_bf16 v[12:15], v[68:71], a[120:123], v[12:15]
    ds_read_b64_tr_b16 v[98:99], v128 offset:58368
    s_waitcnt lgkmcnt(12)
    v_mfma_f32_16x16x32_bf16 v[16:19], v[72:75], a[56:59], v[16:19]
    ds_read_b64_tr_b16 v[100:101], v129 offset:57344
    v_mfma_f32_16x16x32_bf16 v[20:23], v[72:75], a[120:123], v[20:23]
    ds_read_b64_tr_b16 v[102:103], v129 offset:58368
    s_waitcnt lgkmcnt(12)
    v_mfma_f32_16x16x32_bf16 v[24:27], v[76:79], a[56:59], v[24:27]
    ds_read_b64_tr_b16 v[104:105], v130 offset:57344
    v_mfma_f32_16x16x32_bf16 v[28:31], v[76:79], a[120:123], v[28:31]
    ds_read_b64_tr_b16 v[106:107], v130 offset:58368
    s_waitcnt lgkmcnt(12)
    v_mfma_f32_16x16x32_bf16 v[32:35], v[80:83], a[56:59], v[32:35]
    ds_read_b64_tr_b16 v[108:109], v131 offset:57344
    v_mfma_f32_16x16x32_bf16 v[36:39], v[80:83], a[120:123], v[36:39]
    ds_read_b64_tr_b16 v[110:111], v131 offset:58368
    s_waitcnt lgkmcnt(12)
    v_mfma_f32_16x16x32_bf16 v[40:43], v[84:87], a[56:59], v[40:43]
    ds_read_b64_tr_b16 v[112:113], v132 offset:57344
    v_mfma_f32_16x16x32_bf16 v[44:47], v[84:87], a[120:123], v[44:47]
    ds_read_b64_tr_b16 v[114:115], v132 offset:58368
    s_waitcnt lgkmcnt(12)
    v_mfma_f32_16x16x32_bf16 v[48:51], v[88:91], a[56:59], v[48:51]
    ds_read_b64_tr_b16 v[116:117], v133 offset:57344
    v_mfma_f32_16x16x32_bf16 v[52:55], v[88:91], a[120:123], v[52:55]
    ds_read_b64_tr_b16 v[118:119], v133 offset:58368
    s_waitcnt lgkmcnt(12)
    v_mfma_f32_16x16x32_bf16 v[56:59], v[92:95], a[56:59], v[56:59]
    ds_read_b64_tr_b16 v[120:121], v134 offset:57344
    v_mfma_f32_16x16x32_bf16 v[60:63], v[92:95], a[120:123], v[60:63]
    ds_read_b64_tr_b16 v[122:123], v134 offset:58368
    s_waitcnt lgkmcnt(12)
    v_mfma_f32_16x16x32_bf16 v[0:3], v[96:99], a[60:63], v[0:3]
    ds_read_b64_tr_b16 v[124:125], v135 offset:57344
    v_mfma_f32_16x16x32_bf16 v[4:7], v[96:99], a[124:127], v[4:7]
    ds_read_b64_tr_b16 v[126:127], v135 offset:58368
    s_waitcnt lgkmcnt(12)
    v_mfma_f32_16x16x32_bf16 v[8:11], v[100:103], a[60:63], v[8:11]
    v_mfma_f32_16x16x32_bf16 v[12:15], v[100:103], a[124:127], v[12:15]
    s_waitcnt lgkmcnt(10)
    v_mfma_f32_16x16x32_bf16 v[16:19], v[104:107], a[60:63], v[16:19]
    v_mfma_f32_16x16x32_bf16 v[20:23], v[104:107], a[124:127], v[20:23]
    s_waitcnt lgkmcnt(8)
    v_mfma_f32_16x16x32_bf16 v[24:27], v[108:111], a[60:63], v[24:27]
    v_mfma_f32_16x16x32_bf16 v[28:31], v[108:111], a[124:127], v[28:31]
    s_waitcnt lgkmcnt(6)
    v_mfma_f32_16x16x32_bf16 v[32:35], v[112:115], a[60:63], v[32:35]
    v_mfma_f32_16x16x32_bf16 v[36:39], v[112:115], a[124:127], v[36:39]
    s_waitcnt lgkmcnt(4)
    v_mfma_f32_16x16x32_bf16 v[40:43], v[116:119], a[60:63], v[40:43]
    v_mfma_f32_16x16x32_bf16 v[44:47], v[116:119], a[124:127], v[44:47]
    s_waitcnt lgkmcnt(2)
    v_mfma_f32_16x16x32_bf16 v[48:51], v[120:123], a[60:63], v[48:51]
    v_mfma_f32_16x16x32_bf16 v[52:55], v[120:123], a[124:127], v[52:55]
    s_waitcnt lgkmcnt(0)
    v_mfma_f32_16x16x32_bf16 v[56:59], v[124:127], a[60:63], v[56:59]
    v_mfma_f32_16x16x32_bf16 v[60:63], v[124:127], a[124:127], v[60:63]
    v_xor_b32 v128, 0x10000, v128
    v_xor_b32 v129, 0x10000, v129
    v_xor_b32 v130, 0x10000, v130
    v_xor_b32 v131, 0x10000, v131
    v_xor_b32 v132, 0x10000, v132
    v_xor_b32 v133, 0x10000, v133
    v_xor_b32 v134, 0x10000, v134
    v_xor_b32 v135, 0x10000, v135
    v_cvt_pk_bf16_f32 v144, v0, v8
    v_cvt_pk_bf16_f32 v145, v1, v9
    v_cvt_pk_bf16_f32 v146, v2, v10
    v_cvt_pk_bf16_f32 v147, v3, v11
    buffer_store_dwordx4 v[144:147], v137, s[8:11], s25 offen sc1
    v_cvt_pk_bf16_f32 v148, v16, v24
    v_cvt_pk_bf16_f32 v149, v17, v25
    v_cvt_pk_bf16_f32 v150, v18, v26
    v_cvt_pk_bf16_f32 v151, v19, v27
    buffer_store_dwordx4 v[148:151], v137, s[8:11], s25 offen offset:1024 sc1
    v_cvt_pk_bf16_f32 v152, v32, v40
    v_cvt_pk_bf16_f32 v153, v33, v41
    v_cvt_pk_bf16_f32 v154, v34, v42
    v_cvt_pk_bf16_f32 v155, v35, v43
    buffer_store_dwordx4 v[152:155], v137, s[8:11], s25 offen offset:2048 sc1
    v_cvt_pk_bf16_f32 v156, v48, v56
    v_cvt_pk_bf16_f32 v157, v49, v57
    v_cvt_pk_bf16_f32 v158, v50, v58
    v_cvt_pk_bf16_f32 v159, v51, v59
    buffer_store_dwordx4 v[156:159], v137, s[8:11], s25 offen offset:3072 sc1
    v_cvt_pk_bf16_f32 v144, v4, v12
    v_cvt_pk_bf16_f32 v145, v5, v13
    v_cvt_pk_bf16_f32 v146, v6, v14
    v_cvt_pk_bf16_f32 v147, v7, v15
    s_add_u32 s25, s25, 4096
    buffer_store_dwordx4 v[144:147], v137, s[8:11], s25 offen sc1
    v_cvt_pk_bf16_f32 v148, v20, v28
    v_cvt_pk_bf16_f32 v149, v21, v29
    v_cvt_pk_bf16_f32 v150, v22, v30
    v_cvt_pk_bf16_f32 v151, v23, v31
    buffer_store_dwordx4 v[148:151], v137, s[8:11], s25 offen offset:1024 sc1
    v_cvt_pk_bf16_f32 v152, v36, v44
    v_cvt_pk_bf16_f32 v153, v37, v45
    v_cvt_pk_bf16_f32 v154, v38, v46
    v_cvt_pk_bf16_f32 v155, v39, v47
    buffer_store_dwordx4 v[152:155], v137, s[8:11], s25 offen offset:2048 sc1
    v_cvt_pk_bf16_f32 v156, v52, v60
    v_cvt_pk_bf16_f32 v157, v53, v61
    v_cvt_pk_bf16_f32 v158, v54, v62
    v_cvt_pk_bf16_f32 v159, v55, v63
    buffer_store_dwordx4 v[156:159], v137, s[8:11], s25 offen offset:3072 sc1
    s_branch L_p1_next
L_p1_v:
    s_waitcnt vmcnt(16)
    s_barrier
    ds_read_b64_tr_b16 v[64:65], v128
    ds_read_b64_tr_b16 v[66:67], v128 offset:1024
    ds_read_b64_tr_b16 v[68:69], v129
    ds_read_b64_tr_b16 v[70:71], v129 offset:1024
    ds_read_b64_tr_b16 v[72:73], v130
    ds_read_b64_tr_b16 v[74:75], v130 offset:1024
    ds_read_b64_tr_b16 v[76:77], v131
    ds_read_b64_tr_b16 v[78:79], v131 offset:1024
    ds_read_b64_tr_b16 v[80:81], v132
    ds_read_b64_tr_b16 v[82:83], v132 offset:1024
    ds_read_b64_tr_b16 v[84:85], v133
    ds_read_b64_tr_b16 v[86:87], v133 offset:1024
    ds_read_b64_tr_b16 v[88:89], v134
    ds_read_b64_tr_b16 v[90:91], v134 offset:1024
    s_waitcnt lgkmcnt(12)
    v_mfma_f32_16x16x32_bf16 v[0:3], a[0:3], v[64:67], 0
    ds_read_b64_tr_b16 v[92:93], v135
    v_mfma_f32_16x16x32_bf16 v[4:7], a[64:67], v[64:67], 0
    ds_read_b64_tr_b16 v[94:95], v135 offset:1024
    s_add_u32 s26, s24, 0x300000
    s_add_u32 m0, s29, 0x18000
    s_nop 0
    buffer_load_dwordx4 v136, s[16:19], s26 offen lds
    s_waitcnt lgkmcnt(12)
    v_mfma_f32_16x16x32_bf16 v[8:11], a[0:3], v[68:71], 0
    ds_read_b64_tr_b16 v[96:97], v128 offset:8192
    v_mfma_f32_16x16x32_bf16 v[12:15], a[64:67], v[68:71], 0
    ds_read_b64_tr_b16 v[98:99], v128 offset:9216
    s_add_u32 s26, s24, 0x320000
    s_add_u32 m0, s29, 0x19000
    s_nop 0
    buffer_load_dwordx4 v136, s[16:19], s26 offen lds
    s_waitcnt lgkmcnt(12)
    v_mfma_f32_16x16x32_bf16 v[16:19], a[0:3], v[72:75], 0
    ds_read_b64_tr_b16 v[100:101], v129 offset:8192
    v_mfma_f32_16x16x32_bf16 v[20:23], a[64:67], v[72:75], 0
    ds_read_b64_tr_b16 v[102:103], v129 offset:9216
    s_add_u32 s26, s24, 0x340000
    s_add_u32 m0, s29, 0x1a000
    s_nop 0
    buffer_load_dwordx4 v136, s[16:19], s26 offen lds
    s_waitcnt lgkmcnt(12)
    v_mfma_f32_16x16x32_bf16 v[24:27], a[0:3], v[76:79], 0
    ds_read_b64_tr_b16 v[104:105], v130 offset:8192
    v_mfma_f32_16x16x32_bf16 v[28:31], a[64:67], v[76:79], 0
    ds_read_b64_tr_b16 v[106:107], v130 offset:9216
    s_add_u32 s26, s24, 0x360000
    s_add_u32 m0, s29, 0x1b000
    s_nop 0
    buffer_load_dwordx4 v136, s[16:19], s26 offen lds
    s_waitcnt lgkmcnt(12)
    v_mfma_f32_16x16x32_bf16 v[32:35], a[0:3], v[80:83], 0
    ds_read_b64_tr_b16 v[108:109], v131 offset:8192
    v_mfma_f32_16x16x32_bf16 v[36:39], a[64:67], v[80:83], 0
    ds_read_b64_tr_b16 v[110:111], v131 offset:9216
    s_add_u32 s26, s24, 0x380000
    s_add_u32 m0, s29, 0x1c000
    s_nop 0
    buffer_load_dwordx4 v136, s[16:19], s26 offen lds
    s_waitcnt lgkmcnt(12)
    v_mfma_f32_16x16x32_bf16 v[40:43], a[0:3], v[84:87], 0
    ds_read_b64_tr_b16 v[112:113], v132 offset:8192
    v_mfma_f32_16x16x32_bf16 v[44:47], a[64:67], v[84:87], 0
    ds_read_b64_tr_b16 v[114:115], v132 offset:9216
    s_add_u32 s26, s24, 0x3a0000
    s_add_u32 m0, s29, 0x1d000
    s_nop 0
    buffer_load_dwordx4 v136, s[16:19], s26 offen lds
    s_waitcnt lgkmcnt(12)
    v_mfma_f32_16x16x32_bf16 v[48:51], a[0:3], v[88:91], 0
    ds_read_b64_tr_b16 v[116:117], v133 offset:8192
    v_mfma_f32_16x16x32_bf16 v[52:55], a[64:67], v[88:91], 0
    ds_read_b64_tr_b16 v[118:119], v133 offset:9216
    s_add_u32 s26, s24, 0x3c0000
    s_add_u32 m0, s29, 0x1e000
    s_nop 0
    buffer_load_dwordx4 v136, s[16:19], s26 offen lds
    s_waitcnt lgkmcnt(12)
    v_mfma_f32_16x16x32_bf16 v[56:59], a[0:3], v[92:95], 0
    ds_read_b64_tr_b16 v[120:121], v134 offset:8192
    v_mfma_f32_16x16x32_bf16 v[60:63], a[64:67], v[92:95], 0
    ds_read_b64_tr_b16 v[122:123], v134 offset:9216
    s_add_u32 s26, s24, 0x3e0000
    s_add_u32 m0, s29, 0x1f000
    s_nop 0
    buffer_load_dwordx4 v136, s[16:19], s26 offen lds
    s_waitcnt lgkmcnt(12)
    v_mfma_f32_16x16x32_bf16 v[0:3], a[4:7], v[96:99], v[0:3]
    ds_read_b64_tr_b16 v[124:125], v135 offset:8192
    v_mfma_f32_16x16x32_bf16 v[4:7], a[68:71], v[96:99], v[4:7]
    ds_read_b64_tr_b16 v[126:127], v135 offset:9216
    s_waitcnt lgkmcnt(12)
    v_mfma_f32_16x16x32_bf16 v[8:11], a[4:7], v[100:103], v[8:11]
    ds_read_b64_tr_b16 v[64:65], v128 offset:16384
    v_mfma_f32_16x16x32_bf16 v[12:15], a[68:71], v[100:103], v[12:15]
    ds_read_b64_tr_b16 v[66:67], v128 offset:17408
    s_waitcnt lgkmcnt(12)
    v_mfma_f32_16x16x32_bf16 v[16:19], a[4:7], v[104:107], v[16:19]
    ds_read_b64_tr_b16 v[68:69], v129 offset:16384
    v_mfma_f32_16x16x32_bf16 v[20:23], a[68:71], v[104:107], v[20:23]
    ds_read_b64_tr_b16 v[70:71], v129 offset:17408
    s_waitcnt lgkmcnt(12)
    v_mfma_f32_16x16x32_bf16 v[24:27], a[4:7], v[108:111], v[24:27]
    ds_read_b64_tr_b16 v[72:73], v130 offset:16384
    v_mfma_f32_16x16x32_bf16 v[28:31], a[68:71], v[108:111], v[28:31]
    ds_read_b64_tr_b16 v[74:75], v130 offset:17408
    s_waitcnt lgkmcnt(12)
    v_mfma_f32_16x16x32_bf16 v[32:35], a[4:7], v[112:115], v[32:35]
    ds_read_b64_tr_b16 v[76:77], v131 offset:16384
    v_mfma_f32_16x16x32_bf16 v[36:39], a[68:71], v[112:115], v[36:39]
    ds_read_b64_tr_b16 v[78:79], v131 offset:17408
    s_waitcnt lgkmcnt(12)
    v_mfma_f32_16x16x32_bf16 v[40:43], a[4:7], v[116:119], v[40:43]
    ds_read_b64_tr_b16 v[80:81], v132 offset:16384
    v_mfma_f32_16x16x32_bf16 v[44:47], a[68:71], v[116:119], v[44:47]
    ds_read_b64_tr_b16 v[82:83], v132 offset:17408
    s_waitcnt lgkmcnt(12)
    v_mfma_f32_16x16x32_bf16 v[48:51], a[4:7], v[120:123], v[48:51]
    ds_read_b64_tr_b16 v[84:85], v133 offset:16384
    v_mfma_f32_16x16x32_bf16 v[52:55], a[68:71], v[120:123], v[52:55]
    ds_read_b64_tr_b16 v[86:87], v133 offset:17408
    s_waitcnt lgkmcnt(12)
    v_mfma_f32_16x16x32_bf16 v[56:59], a[4:7], v[124:127], v[56:59]
    ds_read_b64_tr_b16 v[88:89], v134 offset:16384
    v_mfma_f32_16x16x32_bf16 v[60:63], a[68:71], v[124:127], v[60:63]
    ds_read_b64_tr_b16 v[90:91], v134 offset:17408
    s_waitcnt lgkmcnt(12)
    v_mfma_f32_16x16x32_bf16 v[0:3], a[8:11], v[64:67], v[0:3]
    ds_read_b64_tr_b16 v[92:93], v135 offset:16384
    v_mfma_f32_16x16x32_bf16 v[4:7], a[72:75], v[64:67], v[4:7]
    ds_read_b64_tr_b16 v[94:95], v135 offset:17408
    s_waitcnt lgkmcnt(12)
    v_mfma_f32_16x16x32_bf16 v[8:11], a[8:11], v[68:71], v[8:11]
    ds_read_b64_tr_b16 v[96:97], v128 offset:24576
    v_mfma_f32_16x16x32_bf16 v[12:15], a[72:75], v[68:71], v[12:15]
    ds_read_b64_tr_b16 v[98:99], v128 offset:25600
    s_waitcnt lgkmcnt(12)
    v_mfma_f32_16x16x32_bf16 v[16:19], a[8:11], v[72:75], v[16:19]
    ds_read_b64_tr_b16 v[100:101], v129 offset:24576
    v_mfma_f32_16x16x32_bf16 v[20:23], a[72:75], v[72:75], v[20:23]
    ds_read_b64_tr_b16 v[102:103], v129 offset:25600
    s_waitcnt lgkmcnt(12)
    v_mfma_f32_16x16x32_bf16 v[24:27], a[8:11], v[76:79], v[24:27]
    ds_read_b64_tr_b16 v[104:105], v130 offset:24576
    v_mfma_f32_16x16x32_bf16 v[28:31], a[72:75], v[76:79], v[28:31]
    ds_read_b64_tr_b16 v[106:107], v130 offset:25600
    s_waitcnt lgkmcnt(12)
    v_mfma_f32_16x16x32_bf16 v[32:35], a[8:11], v[80:83], v[32:35]
    ds_read_b64_tr_b16 v[108:109], v131 offset:24576
    v_mfma_f32_16x16x32_bf16 v[36:39], a[72:75], v[80:83], v[36:39]
    ds_read_b64_tr_b16 v[110:111], v131 offset:25600
    s_waitcnt lgkmcnt(12)
    v_mfma_f32_16x16x32_bf16 v[40:43], a[8:11], v[84:87], v[40:43]
    ds_read_b64_tr_b16 v[112:113], v132 offset:24576
    v_mfma_f32_16x16x32_bf16 v[44:47], a[72:75], v[84:87], v[44:47]
    ds_read_b64_tr_b16 v[114:115], v132 offset:25600
    s_waitcnt lgkmcnt(12)
    v_mfma_f32_16x16x32_bf16 v[48:51], a[8:11], v[88:91], v[48:51]
    ds_read_b64_tr_b16 v[116:117], v133 offset:24576
    v_mfma_f32_16x16x32_bf16 v[52:55], a[72:75], v[88:91], v[52:55]
    ds_read_b64_tr_b16 v[118:119], v133 offset:25600
    s_waitcnt lgkmcnt(12)
    v_mfma_f32_16x16x32_bf16 v[56:59], a[8:11], v[92:95], v[56:59]
    ds_read_b64_tr_b16 v[120:121], v134 offset:24576
    v_mfma_f32_16x16x32_bf16 v[60:63], a[72:75], v[92:95], v[60:63]
    ds_read_b64_tr_b16 v[122:123], v134 offset:25600
    s_waitcnt lgkmcnt(12)
    v_mfma_f32_16x16x32_bf16 v[0:3], a[12:15], v[96:99], v[0:3]
    ds_read_b64_tr_b16 v[124:125], v135 offset:24576
    v_mfma_f32_16x16x32_bf16 v[4:7], a[76:79], v[96:99], v[4:7]
    ds_read_b64_tr_b16 v[126:127], v135 offset:25600
    s_waitcnt lgkmcnt(12)
    v_mfma_f32_16x16x32_bf16 v[8:11], a[12:15], v[100:103], v[8:11]
    v_mfma_f32_16x16x32_bf16 v[12:15], a[76:79], v[100:103], v[12:15]
    s_waitcnt lgkmcnt(10)
    v_mfma_f32_16x16x32_bf16 v[16:19], a[12:15], v[104:107], v[16:19]
    v_mfma_f32_16x16x32_bf16 v[20:23], a[76:79], v[104:107], v[20:23]
    s_waitcnt lgkmcnt(8)
    v_mfma_f32_16x16x32_bf16 v[24:27], a[12:15], v[108:111], v[24:27]
    v_mfma_f32_16x16x32_bf16 v[28:31], a[76:79], v[108:111], v[28:31]
    s_waitcnt lgkmcnt(6)
    v_mfma_f32_16x16x32_bf16 v[32:35], a[12:15], v[112:115], v[32:35]
    v_mfma_f32_16x16x32_bf16 v[36:39], a[76:79], v[112:115], v[36:39]
    s_waitcnt lgkmcnt(4)
    v_mfma_f32_16x16x32_bf16 v[40:43], a[12:15], v[116:119], v[40:43]
    v_mfma_f32_16x16x32_bf16 v[44:47], a[76:79], v[116:119], v[44:47]
    s_waitcnt lgkmcnt(2)
    v_mfma_f32_16x16x32_bf16 v[48:51], a[12:15], v[120:123], v[48:51]
    v_mfma_f32_16x16x32_bf16 v[52:55], a[76:79], v[120:123], v[52:55]
    s_waitcnt lgkmcnt(0)
    v_mfma_f32_16x16x32_bf16 v[56:59], a[12:15], v[124:127], v[56:59]
    v_mfma_f32_16x16x32_bf16 v[60:63], a[76:79], v[124:127], v[60:63]
    s_waitcnt vmcnt(16)
    s_barrier
    ds_read_b64_tr_b16 v[64:65], v128 offset:32768
    ds_read_b64_tr_b16 v[66:67], v128 offset:33792
    ds_read_b64_tr_b16 v[68:69], v129 offset:32768
    ds_read_b64_tr_b16 v[70:71], v129 offset:33792
    ds_read_b64_tr_b16 v[72:73], v130 offset:32768
    ds_read_b64_tr_b16 v[74:75], v130 offset:33792
    ds_read_b64_tr_b16 v[76:77], v131 offset:32768
    ds_read_b64_tr_b16 v[78:79], v131 offset:33792
    ds_read_b64_tr_b16 v[80:81], v132 offset:32768
    ds_read_b64_tr_b16 v[82:83], v132 offset:33792
    ds_read_b64_tr_b16 v[84:85], v133 offset:32768
    ds_read_b64_tr_b16 v[86:87], v133 offset:33792
    ds_read_b64_tr_b16 v[88:89], v134 offset:32768
    ds_read_b64_tr_b16 v[90:91], v134 offset:33792
    s_add_u32 s39, s39, s37
    s_lshr_b32 s26, s39, 5
    s_cmp_eq_u32 s26, 0
    s_cselect_b64 s[16:17], s[30:31], s[34:35]
    s_cmp_eq_u32 s26, 1
    s_cselect_b64 s[16:17], s[32:33], s[16:17]
    s_and_b32 s17, s17, 0xffff
    s_cmp_lt_u32 s39, 96
    s_cselect_b32 s18, 0x400000, 0
    s_and_b32 s24, s39, 31
    s_lshl_b32 s24, s24, 8
    s_waitcnt lgkmcnt(12)
    v_mfma_f32_16x16x32_bf16 v[0:3], a[16:19], v[64:67], v[0:3]
    ds_read_b64_tr_b16 v[92:93], v135 offset:32768
    v_mfma_f32_16x16x32_bf16 v[4:7], a[80:83], v[64:67], v[4:7]
    ds_read_b64_tr_b16 v[94:95], v135 offset:33792
    s_add_u32 s26, s24, 0x0
    s_add_u32 m0, s29, 0x0
    s_nop 0
    buffer_load_dwordx4 v136, s[16:19], s26 offen lds
    s_waitcnt lgkmcnt(12)
    v_mfma_f32_16x16x32_bf16 v[8:11], a[16:19], v[68:71], v[8:11]
    ds_read_b64_tr_b16 v[96:97], v128 offset:40960
    v_mfma_f32_16x16x32_bf16 v[12:15], a[80:83], v[68:71], v[12:15]
    ds_read_b64_tr_b16 v[98:99], v128 offset:41984
    s_add_u32 s26, s24, 0x20000
    s_add_u32 m0, s29, 0x1000
    s_nop 0
    buffer_load_dwordx4 v136, s[16:19], s26 offen lds
    s_waitcnt lgkmcnt(12)
    v_mfma_f32_16x16x32_bf16 v[16:19], a[16:19], v[72:75], v[16:19]
    ds_read_b64_tr_b16 v[100:101], v129 offset:40960
    v_mfma_f32_16x16x32_bf16 v[20:23], a[80:83], v[72:75], v[20:23]
    ds_read_b64_tr_b16 v[102:103], v129 offset:41984
    s_add_u32 s26, s24, 0x40000
    s_add_u32 m0, s29, 0x2000
    s_nop 0
    buffer_load_dwordx4 v136, s[16:19], s26 offen lds
    s_waitcnt lgkmcnt(12)
    v_mfma_f32_16x16x32_bf16 v[24:27], a[16:19], v[76:79], v[24:27]
    ds_read_b64_tr_b16 v[104:105], v130 offset:40960
    v_mfma_f32_16x16x32_bf16 v[28:31], a[80:83], v[76:79], v[28:31]
    ds_read_b64_tr_b16 v[106:107], v130 offset:41984
    s_add_u32 s26, s24, 0x60000
    s_add_u32 m0, s29, 0x3000
    s_nop 0
    buffer_load_dwordx4 v136, s[16:19], s26 offen lds
    s_waitcnt lgkmcnt(12)
    v_mfma_f32_16x16x32_bf16 v[32:35], a[16:19], v[80:83], v[32:35]
    ds_read_b64_tr_b16 v[108:109], v131 offset:40960
    v_mfma_f32_16x16x32_bf16 v[36:39], a[80:83], v[80:83], v[36:39]
    ds_read_b64_tr_b16 v[110:111], v131 offset:41984
    s_add_u32 s26, s24, 0x80000
    s_add_u32 m0, s29, 0x4000
    s_nop 0
    buffer_load_dwordx4 v136, s[16:19], s26 offen lds
    s_waitcnt lgkmcnt(12)
    v_mfma_f32_16x16x32_bf16 v[40:43], a[16:19], v[84:87], v[40:43]
    ds_read_b64_tr_b16 v[112:113], v132 offset:40960
    v_mfma_f32_16x16x32_bf16 v[44:47], a[80:83], v[84:87], v[44:47]
    ds_read_b64_tr_b16 v[114:115], v132 offset:41984
    s_add_u32 s26, s24, 0xa0000
    s_add_u32 m0, s29, 0x5000
    s_nop 0
    buffer_load_dwordx4 v136, s[16:19], s26 offen lds
    s_waitcnt lgkmcnt(12)
    v_mfma_f32_16x16x32_bf16 v[48:51], a[16:19], v[88:91], v[48:51]
    ds_read_b64_tr_b16 v[116:117], v133 offset:40960
    v_mfma_f32_16x16x32_bf16 v[52:55], a[80:83], v[88:91], v[52:55]
    ds_read_b64_tr_b16 v[118:119], v133 offset:41984
    s_add_u32 s26, s24, 0xc0000
    s_add_u32 m0, s29, 0x6000
    s_nop 0
    buffer_load_dwordx4 v136, s[16:19], s26 offen lds
    s_waitcnt lgkmcnt(12)
    v_mfma_f32_16x16x32_bf16 v[56:59], a[16:19], v[92:95], v[56:59]
    ds_read_b64_tr_b16 v[120:121], v134 offset:40960
    v_mfma_f32_16x16x32_bf16 v[60:63], a[80:83], v[92:95], v[60:63]
    ds_read_b64_tr_b16 v[122:123], v134 offset:41984
    s_add_u32 s26, s24, 0xe0000
    s_add_u32 m0, s29, 0x7000
    s_nop 0
    buffer_load_dwordx4 v136, s[16:19], s26 offen lds
    s_waitcnt lgkmcnt(12)
    v_mfma_f32_16x16x32_bf16 v[0:3], a[20:23], v[96:99], v[0:3]
    ds_read_b64_tr_b16 v[124:125], v135 offset:40960
    v_mfma_f32_16x16x32_bf16 v[4:7], a[84:87], v[96:99], v[4:7]
    ds_read_b64_tr_b16 v[126:127], v135 offset:41984
    s_waitcnt lgkmcnt(12)
    v_mfma_f32_16x16x32_bf16 v[8:11], a[20:23], v[100:103], v[8:11]
    ds_read_b64_tr_b16 v[64:65], v128 offset:49152
    v_mfma_f32_16x16x32_bf16 v[12:15], a[84:87], v[100:103], v[12:15]
    ds_read_b64_tr_b16 v[66:67], v128 offset:50176
    s_waitcnt lgkmcnt(12)
    v_mfma_f32_16x16x32_bf16 v[16:19], a[20:23], v[104:107], v[16:19]
    ds_read_b64_tr_b16 v[68:69], v129 offset:49152
    v_mfma_f32_16x16x32_bf16 v[20:23], a[84:87], v[104:107], v[20:23]
    ds_read_b64_tr_b16 v[70:71], v129 offset:50176
    s_waitcnt lgkmcnt(12)
    v_mfma_f32_16x16x32_bf16 v[24:27], a[20:23], v[108:111], v[24:27]
    ds_read_b64_tr_b16 v[72:73], v130 offset:49152
    v_mfma_f32_16x16x32_bf16 v[28:31], a[84:87], v[108:111], v[28:31]
    ds_read_b64_tr_b16 v[74:75], v130 offset:50176
    s_waitcnt lgkmcnt(12)
    v_mfma_f32_16x16x32_bf16 v[32:35], a[20:23], v[112:115], v[32:35]
    ds_read_b64_tr_b16 v[76:77], v131 offset:49152
    v_mfma_f32_16x16x32_bf16 v[36:39], a[84:87], v[112:115], v[36:39]
    ds_read_b64_tr_b16 v[78:79], v131 offset:50176
    s_waitcnt lgkmcnt(12)
    v_mfma_f32_16x16x32_bf16 v[40:43], a[20:23], v[116:119], v[40:43]
    ds_read_b64_tr_b16 v[80:81], v132 offset:49152
    v_mfma_f32_16x16x32_bf16 v[44:47], a[84:87], v[116:119], v[44:47]
    ds_read_b64_tr_b16 v[82:83], v132 offset:50176
    s_waitcnt lgkmcnt(12)
    v_mfma_f32_16x16x32_bf16 v[48:51], a[20:23], v[120:123], v[48:51]
    ds_read_b64_tr_b16 v[84:85], v133 offset:49152
    v_mfma_f32_16x16x32_bf16 v[52:55], a[84:87], v[120:123], v[52:55]
    ds_read_b64_tr_b16 v[86:87], v133 offset:50176
    s_waitcnt lgkmcnt(12)
    v_mfma_f32_16x16x32_bf16 v[56:59], a[20:23], v[124:127], v[56:59]
    ds_read_b64_tr_b16 v[88:89], v134 offset:49152
    v_mfma_f32_16x16x32_bf16 v[60:63], a[84:87], v[124:127], v[60:63]
    ds_read_b64_tr_b16 v[90:91], v134 offset:50176
    s_waitcnt lgkmcnt(12)
    v_mfma_f32_16x16x32_bf16 v[0:3], a[24:27], v[64:67], v[0:3]
    ds_read_b64_tr_b16 v[92:93], v135 offset:49152
    v_mfma_f32_16x16x32_bf16 v[4:7], a[88:91], v[64:67], v[4:7]
    ds_read_b64_tr_b16 v[94:95], v135 offset:50176
    s_waitcnt lgkmcnt(12)
    v_mfma_f32_16x16x32_bf16 v[8:11], a[24:27], v[68:71], v[8:11]
    ds_read_b64_tr_b16 v[96:97], v128 offset:57344
    v_mfma_f32_16x16x32_bf16 v[12:15], a[88:91], v[68:71], v[12:15]
    ds_read_b64_tr_b16 v[98:99], v128 offset:58368
    s_waitcnt lgkmcnt(12)
    v_mfma_f32_16x16x32_bf16 v[16:19], a[24:27], v[72:75], v[16:19]
    ds_read_b64_tr_b16 v[100:101], v129 offset:57344
    v_mfma_f32_16x16x32_bf16 v[20:23], a[88:91], v[72:75], v[20:23]
    ds_read_b64_tr_b16 v[102:103], v129 offset:58368
    s_waitcnt lgkmcnt(12)
    v_mfma_f32_16x16x32_bf16 v[24:27], a[24:27], v[76:79], v[24:27]
    ds_read_b64_tr_b16 v[104:105], v130 offset:57344
    v_mfma_f32_16x16x32_bf16 v[28:31], a[88:91], v[76:79], v[28:31]
    ds_read_b64_tr_b16 v[106:107], v130 offset:58368
    s_waitcnt lgkmcnt(12)
    v_mfma_f32_16x16x32_bf16 v[32:35], a[24:27], v[80:83], v[32:35]
    ds_read_b64_tr_b16 v[108:109], v131 offset:57344
    v_mfma_f32_16x16x32_bf16 v[36:39], a[88:91], v[80:83], v[36:39]
    ds_read_b64_tr_b16 v[110:111], v131 offset:58368
    s_waitcnt lgkmcnt(12)
    v_mfma_f32_16x16x32_bf16 v[40:43], a[24:27], v[84:87], v[40:43]
    ds_read_b64_tr_b16 v[112:113], v132 offset:57344
    v_mfma_f32_16x16x32_bf16 v[44:47], a[88:91], v[84:87], v[44:47]
    ds_read_b64_tr_b16 v[114:115], v132 offset:58368
    s_waitcnt lgkmcnt(12)
    v_mfma_f32_16x16x32_bf16 v[48:51], a[24:27], v[88:91], v[48:51]
    ds_read_b64_tr_b16 v[116:117], v133 offset:57344
    v_mfma_f32_16x16x32_bf16 v[52:55], a[88:91], v[88:91], v[52:55]
    ds_read_b64_tr_b16 v[118:119], v133 offset:58368
    s_waitcnt lgkmcnt(12)
    v_mfma_f32_16x16x32_bf16 v[56:59], a[24:27], v[92:95], v[56:59]
    ds_read_b64_tr_b16 v[120:121], v134 offset:57344
    v_mfma_f32_16x16x32_bf16 v[60:63], a[88:91], v[92:95], v[60:63]
    ds_read_b64_tr_b16 v[122:123], v134 offset:58368
    s_waitcnt lgkmcnt(12)
    v_mfma_f32_16x16x32_bf16 v[0:3], a[28:31], v[96:99], v[0:3]
    ds_read_b64_tr_b16 v[124:125], v135 offset:57344
    v_mfma_f32_16x16x32_bf16 v[4:7], a[92:95], v[96:99], v[4:7]
    ds_read_b64_tr_b16 v[126:127], v135 offset:58368
    s_waitcnt lgkmcnt(12)
    v_mfma_f32_16x16x32_bf16 v[8:11], a[28:31], v[100:103], v[8:11]
    v_mfma_f32_16x16x32_bf16 v[12:15], a[92:95], v[100:103], v[12:15]
    s_waitcnt lgkmcnt(10)
    v_mfma_f32_16x16x32_bf16 v[16:19], a[28:31], v[104:107], v[16:19]
    v_mfma_f32_16x16x32_bf16 v[20:23], a[92:95], v[104:107], v[20:23]
    s_waitcnt lgkmcnt(8)
    v_mfma_f32_16x16x32_bf16 v[24:27], a[28:31], v[108:111], v[24:27]
    v_mfma_f32_16x16x32_bf16 v[28:31], a[92:95], v[108:111], v[28:31]
    s_waitcnt lgkmcnt(6)
    v_mfma_f32_16x16x32_bf16 v[32:35], a[28:31], v[112:115], v[32:35]
    v_mfma_f32_16x16x32_bf16 v[36:39], a[92:95], v[112:115], v[36:39]
    s_waitcnt lgkmcnt(4)
    v_mfma_f32_16x16x32_bf16 v[40:43], a[28:31], v[116:119], v[40:43]
    v_mfma_f32_16x16x32_bf16 v[44:47], a[92:95], v[116:119], v[44:47]
    s_waitcnt lgkmcnt(2)
    v_mfma_f32_16x16x32_bf16 v[48:51], a[28:31], v[120:123], v[48:51]
    v_mfma_f32_16x16x32_bf16 v[52:55], a[92:95], v[120:123], v[52:55]
    s_waitcnt lgkmcnt(0)
    v_mfma_f32_16x16x32_bf16 v[56:59], a[28:31], v[124:127], v[56:59]
    v_mfma_f32_16x16x32_bf16 v[60:63], a[92:95], v[124:127], v[60:63]
    v_xor_b32 v128, 0x10000, v128
    v_xor_b32 v129, 0x10000, v129
    v_xor_b32 v130, 0x10000, v130
    v_xor_b32 v131, 0x10000, v131
    v_xor_b32 v132, 0x10000, v132
    v_xor_b32 v133, 0x10000, v133
    v_xor_b32 v134, 0x10000, v134
    v_xor_b32 v135, 0x10000, v135
    s_waitcnt vmcnt(16)
    s_barrier
    ds_read_b64_tr_b16 v[64:65], v128
    ds_read_b64_tr_b16 v[66:67], v128 offset:1024
    ds_read_b64_tr_b16 v[68:69], v129
    ds_read_b64_tr_b16 v[70:71], v129 offset:1024
    ds_read_b64_tr_b16 v[72:73], v130
    ds_read_b64_tr_b16 v[74:75], v130 offset:1024
    ds_read_b64_tr_b16 v[76:77], v131
    ds_read_b64_tr_b16 v[78:79], v131 offset:1024
    ds_read_b64_tr_b16 v[80:81], v132
    ds_read_b64_tr_b16 v[82:83], v132 offset:1024
    ds_read_b64_tr_b16 v[84:85], v133
    ds_read_b64_tr_b16 v[86:87], v133 offset:1024
    ds_read_b64_tr_b16 v[88:89], v134
    ds_read_b64_tr_b16 v[90:91], v134 offset:1024
    s_cmp_eq_u32 s40, 0
    s_cbranch_scc1 L_nopf_92
    s_cmp_lg_u32 s87, 0
    s_cbranch_scc1 L_modeok_93
    s_mov_b32 s96, 0
L_mode_94:
    buffer_load_dwordx2 v[140:141], off, s[92:95], 0 offset:36 sc1
    s_waitcnt vmcnt(0)
    v_readfirstlane_b32 s87, v140
    v_readfirstlane_b32 s97, v141
    s_nop 0
    s_min_u32 s97, s97, s87
    s_cmp_lg_u32 s97, 0
    s_cbranch_scc1 L_moded_95
    s_sleep 4
    s_add_u32 s96, s96, 1
    s_cmp_lg_u32 s96, 0x100
    s_cbranch_scc1 L_modef_96
    v_mov_b32 v140, 2
    v_mov_b32 v141, 0
    s_mov_b64 exec, 1
    buffer_atomic_cmpswap v[140:141], off, s[92:95], 0 offset:36
    s_mov_b64 exec, -1
L_modef_96:
    s_cmp_lt_u32 s96, 0x10000
    s_cbranch_scc1 L_mode_94
L_moded_95:
    s_cmp_lg_u32 s87, 1
    s_cbranch_scc1 L_fallback
L_modeok_93:
    s_cmp_lg_u32 s100, 0
    s_cbranch_scc1 L_flag_97
    v_mov_b32 v138, 1
    s_mov_b64 exec, 1
    buffer_store_dword v138, off, s[8:11], s40 sc1
    s_mov_b64 exec, -1
L_flag_97:
    s_mov_b32 s40, 0
L_nopf_92:
    s_waitcnt lgkmcnt(12)
    v_mfma_f32_16x16x32_bf16 v[0:3], a[32:35], v[64:67], v[0:3]
    ds_read_b64_tr_b16 v[92:93], v135
    v_mfma_f32_16x16x32_bf16 v[4:7], a[96:99], v[64:67], v[4:7]
    ds_read_b64_tr_b16 v[94:95], v135 offset:1024
    s_add_u32 s26, s24, 0x100000
    s_add_u32 m0, s29, 0x8000
    s_nop 0
    buffer_load_dwordx4 v136, s[16:19], s26 offen lds
    s_waitcnt lgkmcnt(12)
    v_mfma_f32_16x16x32_bf16 v[8:11], a[32:35], v[68:71], v[8:11]
    ds_read_b64_tr_b16 v[96:97], v128 offset:8192
    v_mfma_f32_16x16x32_bf16 v[12:15], a[96:99], v[68:71], v[12:15]
    ds_read_b64_tr_b16 v[98:99], v128 offset:9216
    s_add_u32 s26, s24, 0x120000
    s_add_u32 m0, s29, 0x9000
    s_nop 0
    buffer_load_dwordx4 v136, s[16:19], s26 offen lds
    s_waitcnt lgkmcnt(12)
    v_mfma_f32_16x16x32_bf16 v[16:19], a[32:35], v[72:75], v[16:19]
    ds_read_b64_tr_b16 v[100:101], v129 offset:8192
    v_mfma_f32_16x16x32_bf16 v[20:23], a[96:99], v[72:75], v[20:23]
    ds_read_b64_tr_b16 v[102:103], v129 offset:9216
    s_add_u32 s26, s24, 0x140000
    s_add_u32 m0, s29, 0xa000
    s_nop 0
    buffer_load_dwordx4 v136, s[16:19], s26 offen lds
    s_waitcnt lgkmcnt(12)
    v_mfma_f32_16x16x32_bf16 v[24:27], a[32:35], v[76:79], v[24:27]
    ds_read_b64_tr_b16 v[104:105], v130 offset:8192
    v_mfma_f32_16x16x32_bf16 v[28:31], a[96:99], v[76:79], v[28:31]
    ds_read_b64_tr_b16 v[106:107], v130 offset:9216
    s_add_u32 s26, s24, 0x160000
    s_add_u32 m0, s29, 0xb000
    s_nop 0
    buffer_load_dwordx4 v136, s[16:19], s26 offen lds
    s_waitcnt lgkmcnt(12)
    v_mfma_f32_16x16x32_bf16 v[32:35], a[32:35], v[80:83], v[32:35]
    ds_read_b64_tr_b16 v[108:109], v131 offset:8192
    v_mfma_f32_16x16x32_bf16 v[36:39], a[96:99], v[80:83], v[36:39]
    ds_read_b64_tr_b16 v[110:111], v131 offset:9216
    s_add_u32 s26, s24, 0x180000
    s_add_u32 m0, s29, 0xc000
    s_nop 0
    buffer_load_dwordx4 v136, s[16:19], s26 offen lds
    s_waitcnt lgkmcnt(12)
    v_mfma_f32_16x16x32_bf16 v[40:43], a[32:35], v[84:87], v[40:43]
    ds_read_b64_tr_b16 v[112:113], v132 offset:8192
    v_mfma_f32_16x16x32_bf16 v[44:47], a[96:99], v[84:87], v[44:47]
    ds_read_b64_tr_b16 v[114:115], v132 offset:9216
    s_add_u32 s26, s24, 0x1a0000
    s_add_u32 m0, s29, 0xd000
    s_nop 0
    buffer_load_dwordx4 v136, s[16:19], s26 offen lds
    s_waitcnt lgkmcnt(12)
    v_mfma_f32_16x16x32_bf16 v[48:51], a[32:35], v[88:91], v[48:51]
    ds_read_b64_tr_b16 v[116:117], v133 offset:8192
    v_mfma_f32_16x16x32_bf16 v[52:55], a[96:99], v[88:91], v[52:55]
    ds_read_b64_tr_b16 v[118:119], v133 offset:9216
    s_add_u32 s26, s24, 0x1c0000
    s_add_u32 m0, s29, 0xe000
    s_nop 0
    buffer_load_dwordx4 v136, s[16:19], s26 offen lds
    s_waitcnt lgkmcnt(12)
    v_mfma_f32_16x16x32_bf16 v[56:59], a[32:35], v[92:95], v[56:59]
    ds_read_b64_tr_b16 v[120:121], v134 offset:8192
    v_mfma_f32_16x16x32_bf16 v[60:63], a[96:99], v[92:95], v[60:63]
    ds_read_b64_tr_b16 v[122:123], v134 offset:9216
    s_add_u32 s26, s24, 0x1e0000
    s_add_u32 m0, s29, 0xf000
    s_nop 0
    buffer_load_dwordx4 v136, s[16:19], s26 offen lds
    s_waitcnt lgkmcnt(12)
    v_mfma_f32_16x16x32_bf16 v[0:3], a[36:39], v[96:99], v[0:3]
    ds_read_b64_tr_b16 v[124:125], v135 offset:8192
    v_mfma_f32_16x16x32_bf16 v[4:7], a[100:103], v[96:99], v[4:7]
    ds_read_b64_tr_b16 v[126:127], v135 offset:9216
    s_waitcnt lgkmcnt(12)
    v_mfma_f32_16x16x32_bf16 v[8:11], a[36:39], v[100:103], v[8:11]
    ds_read_b64_tr_b16 v[64:65], v128 offset:16384
    v_mfma_f32_16x16x32_bf16 v[12:15], a[100:103], v[100:103], v[12:15]
    ds_read_b64_tr_b16 v[66:67], v128 offset:17408
    s_waitcnt lgkmcnt(12)
    v_mfma_f32_16x16x32_bf16 v[16:19], a[36:39], v[104:107], v[16:19]
    ds_read_b64_tr_b16 v[68:69], v129 offset:16384
    v_mfma_f32_16x16x32_bf16 v[20:23], a[100:103], v[104:107], v[20:23]
    ds_read_b64_tr_b16 v[70:71], v129 offset:17408
    s_waitcnt lgkmcnt(12)
    v_mfma_f32_16x16x32_bf16 v[24:27], a[36:39], v[108:111], v[24:27]
    ds_read_b64_tr_b16 v[72:73], v130 offset:16384
    v_mfma_f32_16x16x32_bf16 v[28:31], a[100:103], v[108:111], v[28:31]
    ds_read_b64_tr_b16 v[74:75], v130 offset:17408
    s_waitcnt lgkmcnt(12)
    v_mfma_f32_16x16x32_bf16 v[32:35], a[36:39], v[112:115], v[32:35]
    ds_read_b64_tr_b16 v[76:77], v131 offset:16384
    v_mfma_f32_16x16x32_bf16 v[36:39], a[100:103], v[112:115], v[36:39]
    ds_read_b64_tr_b16 v[78:79], v131 offset:17408
    s_waitcnt lgkmcnt(12)
    v_mfma_f32_16x16x32_bf16 v[40:43], a[36:39], v[116:119], v[40:43]
    ds_read_b64_tr_b16 v[80:81], v132 offset:16384
    v_mfma_f32_16x16x32_bf16 v[44:47], a[100:103], v[116:119], v[44:47]
    ds_read_b64_tr_b16 v[82:83], v132 offset:17408
    s_waitcnt lgkmcnt(12)
    v_mfma_f32_16x16x32_bf16 v[48:51], a[36:39], v[120:123], v[48:51]
    ds_read_b64_tr_b16 v[84:85], v133 offset:16384
    v_mfma_f32_16x16x32_bf16 v[52:55], a[100:103], v[120:123], v[52:55]
    ds_read_b64_tr_b16 v[86:87], v133 offset:17408
    s_waitcnt lgkmcnt(12)
    v_mfma_f32_16x16x32_bf16 v[56:59], a[36:39], v[124:127], v[56:59]
    ds_read_b64_tr_b16 v[88:89], v134 offset:16384
    v_mfma_f32_16x16x32_bf16 v[60:63], a[100:103], v[124:127], v[60:63]
    ds_read_b64_tr_b16 v[90:91], v134 offset:17408
    s_waitcnt lgkmcnt(12)
    v_mfma_f32_16x16x32_bf16 v[0:3], a[40:43], v[64:67], v[0:3]
    ds_read_b64_tr_b16 v[92:93], v135 offset:16384
    v_mfma_f32_16x16x32_bf16 v[4:7], a[104:107], v[64:67], v[4:7]
    ds_read_b64_tr_b16 v[94:95], v135 offset:17408
    s_waitcnt lgkmcnt(12)
    v_mfma_f32_16x16x32_bf16 v[8:11], a[40:43], v[68:71], v[8:11]
    ds_read_b64_tr_b16 v[96:97], v128 offset:24576
    v_mfma_f32_16x16x32_bf16 v[12:15], a[104:107], v[68:71], v[12:15]
    ds_read_b64_tr_b16 v[98:99], v128 offset:25600
    s_waitcnt lgkmcnt(12)
    v_mfma_f32_16x16x32_bf16 v[16:19], a[40:43], v[72:75], v[16:19]
    ds_read_b64_tr_b16 v[100:101], v129 offset:24576
    v_mfma_f32_16x16x32_bf16 v[20:23], a[104:107], v[72:75], v[20:23]
    ds_read_b64_tr_b16 v[102:103], v129 offset:25600
    s_waitcnt lgkmcnt(12)
    v_mfma_f32_16x16x32_bf16 v[24:27], a[40:43], v[76:79], v[24:27]
    ds_read_b64_tr_b16 v[104:105], v130 offset:24576
    v_mfma_f32_16x16x32_bf16 v[28:31], a[104:107], v[76:79], v[28:31]
    ds_read_b64_tr_b16 v[106:107], v130 offset:25600
    s_waitcnt lgkmcnt(12)
    v_mfma_f32_16x16x32_bf16 v[32:35], a[40:43], v[80:83], v[32:35]
    ds_read_b64_tr_b16 v[108:109], v131 offset:24576
    v_mfma_f32_16x16x32_bf16 v[36:39], a[104:107], v[80:83], v[36:39]
    ds_read_b64_tr_b16 v[110:111], v131 offset:25600
    s_waitcnt lgkmcnt(12)
    v_mfma_f32_16x16x32_bf16 v[40:43], a[40:43], v[84:87], v[40:43]
    ds_read_b64_tr_b16 v[112:113], v132 offset:24576
    v_mfma_f32_16x16x32_bf16 v[44:47], a[104:107], v[84:87], v[44:47]
    ds_read_b64_tr_b16 v[114:115], v132 offset:25600
    s_waitcnt lgkmcnt(12)
    v_mfma_f32_16x16x32_bf16 v[48:51], a[40:43], v[88:91], v[48:51]
    ds_read_b64_tr_b16 v[116:117], v133 offset:24576
    v_mfma_f32_16x16x32_bf16 v[52:55], a[104:107], v[88:91], v[52:55]
    ds_read_b64_tr_b16 v[118:119], v133 offset:25600
    s_waitcnt lgkmcnt(12)
    v_mfma_f32_16x16x32_bf16 v[56:59], a[40:43], v[92:95], v[56:59]
    ds_read_b64_tr_b16 v[120:121], v134 offset:24576
    v_mfma_f32_16x16x32_bf16 v[60:63], a[104:107], v[92:95], v[60:63]
    ds_read_b64_tr_b16 v[122:123], v134 offset:25600
    s_waitcnt lgkmcnt(12)
    v_mfma_f32_16x16x32_bf16 v[0:3], a[44:47], v[96:99], v[0:3]
    ds_read_b64_tr_b16 v[124:125], v135 offset:24576
    v_mfma_f32_16x16x32_bf16 v[4:7], a[108:111], v[96:99], v[4:7]
    ds_read_b64_tr_b16 v[126:127], v135 offset:25600
    s_waitcnt lgkmcnt(12)
    v_mfma_f32_16x16x32_bf16 v[8:11], a[44:47], v[100:103], v[8:11]
    v_mfma_f32_16x16x32_bf16 v[12:15], a[108:111], v[100:103], v[12:15]
    s_waitcnt lgkmcnt(10)
    v_mfma_f32_16x16x32_bf16 v[16:19], a[44:47], v[104:107], v[16:19]
    v_mfma_f32_16x16x32_bf16 v[20:23], a[108:111], v[104:107], v[20:23]
    s_waitcnt lgkmcnt(8)
    v_mfma_f32_16x16x32_bf16 v[24:27], a[44:47], v[108:111], v[24:27]
    v_mfma_f32_16x16x32_bf16 v[28:31], a[108:111], v[108:111], v[28:31]
    s_waitcnt lgkmcnt(6)
    v_mfma_f32_16x16x32_bf16 v[32:35], a[44:47], v[112:115], v[32:35]
    v_mfma_f32_16x16x32_bf16 v[36:39], a[108:111], v[112:115], v[36:39]
    s_waitcnt lgkmcnt(4)
    v_mfma_f32_16x16x32_bf16 v[40:43], a[44:47], v[116:119], v[40:43]
    v_mfma_f32_16x16x32_bf16 v[44:47], a[108:111], v[116:119], v[44:47]
    s_waitcnt lgkmcnt(2)
    v_mfma_f32_16x16x32_bf16 v[48:51], a[44:47], v[120:123], v[48:51]
    v_mfma_f32_16x16x32_bf16 v[52:55], a[108:111], v[120:123], v[52:55]
    s_waitcnt lgkmcnt(0)
    v_mfma_f32_16x16x32_bf16 v[56:59], a[44:47], v[124:127], v[56:59]
    v_mfma_f32_16x16x32_bf16 v[60:63], a[108:111], v[124:127], v[60:63]
    s_waitcnt vmcnt(16)
    s_barrier
    ds_read_b64_tr_b16 v[64:65], v128 offset:32768
    ds_read_b64_tr_b16 v[66:67], v128 offset:33792
    ds_read_b64_tr_b16 v[68:69], v129 offset:32768
    ds_read_b64_tr_b16 v[70:71], v129 offset:33792
    ds_read_b64_tr_b16 v[72:73], v130 offset:32768
    ds_read_b64_tr_b16 v[74:75], v130 offset:33792
    ds_read_b64_tr_b16 v[76:77], v131 offset:32768
    ds_read_b64_tr_b16 v[78:79], v131 offset:33792
    ds_read_b64_tr_b16 v[80:81], v132 offset:32768
    ds_read_b64_tr_b16 v[82:83], v132 offset:33792
    ds_read_b64_tr_b16 v[84:85], v133 offset:32768
    ds_read_b64_tr_b16 v[86:87], v133 offset:33792
    ds_read_b64_tr_b16 v[88:89], v134 offset:32768
    ds_read_b64_tr_b16 v[90:91], v134 offset:33792
    s_waitcnt lgkmcnt(12)
    v_mfma_f32_16x16x32_bf16 v[0:3], a[48:51], v[64:67], v[0:3]
    ds_read_b64_tr_b16 v[92:93], v135 offset:32768
    v_mfma_f32_16x16x32_bf16 v[4:7], a[112:115], v[64:67], v[4:7]
    ds_read_b64_tr_b16 v[94:95], v135 offset:33792
    s_add_u32 s26, s24, 0x200000
    s_add_u32 m0, s29, 0x10000
    s_nop 0
    buffer_load_dwordx4 v136, s[16:19], s26 offen lds
    s_waitcnt lgkmcnt(12)
    v_mfma_f32_16x16x32_bf16 v[8:11], a[48:51], v[68:71], v[8:11]
    ds_read_b64_tr_b16 v[96:97], v128 offset:40960
    v_mfma_f32_16x16x32_bf16 v[12:15], a[112:115], v[68:71], v[12:15]
    ds_read_b64_tr_b16 v[98:99], v128 offset:41984
    s_add_u32 s26, s24, 0x220000
    s_add_u32 m0, s29, 0x11000
    s_nop 0
    buffer_load_dwordx4 v136, s[16:19], s26 offen lds
    s_waitcnt lgkmcnt(12)
    v_mfma_f32_16x16x32_bf16 v[16:19], a[48:51], v[72:75], v[16:19]
    ds_read_b64_tr_b16 v[100:101], v129 offset:40960
    v_mfma_f32_16x16x32_bf16 v[20:23], a[112:115], v[72:75], v[20:23]
    ds_read_b64_tr_b16 v[102:103], v129 offset:41984
    s_add_u32 s26, s24, 0x240000
    s_add_u32 m0, s29, 0x12000
    s_nop 0
    buffer_load_dwordx4 v136, s[16:19], s26 offen lds
    s_waitcnt lgkmcnt(12)
    v_mfma_f32_16x16x32_bf16 v[24:27], a[48:51], v[76:79], v[24:27]
    ds_read_b64_tr_b16 v[104:105], v130 offset:40960
    v_mfma_f32_16x16x32_bf16 v[28:31], a[112:115], v[76:79], v[28:31]
    ds_read_b64_tr_b16 v[106:107], v130 offset:41984
    s_add_u32 s26, s24, 0x260000
    s_add_u32 m0, s29, 0x13000
    s_nop 0
    buffer_load_dwordx4 v136, s[16:19], s26 offen lds
    s_waitcnt lgkmcnt(12)
    v_mfma_f32_16x16x32_bf16 v[32:35], a[48:51], v[80:83], v[32:35]
    ds_read_b64_tr_b16 v[108:109], v131 offset:40960
    v_mfma_f32_16x16x32_bf16 v[36:39], a[112:115], v[80:83], v[36:39]
    ds_read_b64_tr_b16 v[110:111], v131 offset:41984
    s_add_u32 s26, s24, 0x280000
    s_add_u32 m0, s29, 0x14000
    s_nop 0
    buffer_load_dwordx4 v136, s[16:19], s26 offen lds
    s_waitcnt lgkmcnt(12)
    v_mfma_f32_16x16x32_bf16 v[40:43], a[48:51], v[84:87], v[40:43]
    ds_read_b64_tr_b16 v[112:113], v132 offset:40960
    v_mfma_f32_16x16x32_bf16 v[44:47], a[112:115], v[84:87], v[44:47]
    ds_read_b64_tr_b16 v[114:115], v132 offset:41984
    s_add_u32 s26, s24, 0x2a0000
    s_add_u32 m0, s29, 0x15000
    s_nop 0
    buffer_load_dwordx4 v136, s[16:19], s26 offen lds
    s_waitcnt lgkmcnt(12)
    v_mfma_f32_16x16x32_bf16 v[48:51], a[48:51], v[88:91], v[48:51]
    ds_read_b64_tr_b16 v[116:117], v133 offset:40960
    v_mfma_f32_16x16x32_bf16 v[52:55], a[112:115], v[88:91], v[52:55]
    ds_read_b64_tr_b16 v[118:119], v133 offset:41984
    s_add_u32 s26, s24, 0x2c0000
    s_add_u32 m0, s29, 0x16000
    s_nop 0
    buffer_load_dwordx4 v136, s[16:19], s26 offen lds
    s_waitcnt lgkmcnt(12)
    v_mfma_f32_16x16x32_bf16 v[56:59], a[48:51], v[92:95], v[56:59]
    ds_read_b64_tr_b16 v[120:121], v134 offset:40960
    v_mfma_f32_16x16x32_bf16 v[60:63], a[112:115], v[92:95], v[60:63]
    ds_read_b64_tr_b16 v[122:123], v134 offset:41984
    s_add_u32 s26, s24, 0x2e0000
    s_add_u32 m0, s29, 0x17000
    s_nop 0
    buffer_load_dwordx4 v136, s[16:19], s26 offen lds
    s_waitcnt lgkmcnt(12)
    v_mfma_f32_16x16x32_bf16 v[0:3], a[52:55], v[96:99], v[0:3]
    ds_read_b64_tr_b16 v[124:125], v135 offset:40960
    v_mfma_f32_16x16x32_bf16 v[4:7], a[116:119], v[96:99], v[4:7]
    ds_read_b64_tr_b16 v[126:127], v135 offset:41984
    s_waitcnt lgkmcnt(12)
    v_mfma_f32_16x16x32_bf16 v[8:11], a[52:55], v[100:103], v[8:11]
    ds_read_b64_tr_b16 v[64:65], v128 offset:49152
    v_mfma_f32_16x16x32_bf16 v[12:15], a[116:119], v[100:103], v[12:15]
    ds_read_b64_tr_b16 v[66:67], v128 offset:50176
    s_waitcnt lgkmcnt(12)
    v_mfma_f32_16x16x32_bf16 v[16:19], a[52:55], v[104:107], v[16:19]
    ds_read_b64_tr_b16 v[68:69], v129 offset:49152
    v_mfma_f32_16x16x32_bf16 v[20:23], a[116:119], v[104:107], v[20:23]
    ds_read_b64_tr_b16 v[70:71], v129 offset:50176
    s_waitcnt lgkmcnt(12)
    v_mfma_f32_16x16x32_bf16 v[24:27], a[52:55], v[108:111], v[24:27]
    ds_read_b64_tr_b16 v[72:73], v130 offset:49152
    v_mfma_f32_16x16x32_bf16 v[28:31], a[116:119], v[108:111], v[28:31]
    ds_read_b64_tr_b16 v[74:75], v130 offset:50176
    s_waitcnt lgkmcnt(12)
    v_mfma_f32_16x16x32_bf16 v[32:35], a[52:55], v[112:115], v[32:35]
    ds_read_b64_tr_b16 v[76:77], v131 offset:49152
    v_mfma_f32_16x16x32_bf16 v[36:39], a[116:119], v[112:115], v[36:39]
    ds_read_b64_tr_b16 v[78:79], v131 offset:50176
    s_waitcnt lgkmcnt(12)
    v_mfma_f32_16x16x32_bf16 v[40:43], a[52:55], v[116:119], v[40:43]
    ds_read_b64_tr_b16 v[80:81], v132 offset:49152
    v_mfma_f32_16x16x32_bf16 v[44:47], a[116:119], v[116:119], v[44:47]
    ds_read_b64_tr_b16 v[82:83], v132 offset:50176
    s_waitcnt lgkmcnt(12)
    v_mfma_f32_16x16x32_bf16 v[48:51], a[52:55], v[120:123], v[48:51]
    ds_read_b64_tr_b16 v[84:85], v133 offset:49152
    v_mfma_f32_16x16x32_bf16 v[52:55], a[116:119], v[120:123], v[52:55]
    ds_read_b64_tr_b16 v[86:87], v133 offset:50176
    s_waitcnt lgkmcnt(12)
    v_mfma_f32_16x16x32_bf16 v[56:59], a[52:55], v[124:127], v[56:59]
    ds_read_b64_tr_b16 v[88:89], v134 offset:49152
    v_mfma_f32_16x16x32_bf16 v[60:63], a[116:119], v[124:127], v[60:63]
    ds_read_b64_tr_b16 v[90:91], v134 offset:50176
    s_waitcnt lgkmcnt(12)
    v_mfma_f32_16x16x32_bf16 v[0:3], a[56:59], v[64:67], v[0:3]
    ds_read_b64_tr_b16 v[92:93], v135 offset:49152
    v_mfma_f32_16x16x32_bf16 v[4:7], a[120:123], v[64:67], v[4:7]
    ds_read_b64_tr_b16 v[94:95], v135 offset:50176
    s_waitcnt lgkmcnt(12)
    v_mfma_f32_16x16x32_bf16 v[8:11], a[56:59], v[68:71], v[8:11]
    ds_read_b64_tr_b16 v[96:97], v128 offset:57344
    v_mfma_f32_16x16x32_bf16 v[12:15], a[120:123], v[68:71], v[12:15]
    ds_read_b64_tr_b16 v[98:99], v128 offset:58368
    s_waitcnt lgkmcnt(12)
    v_mfma_f32_16x16x32_bf16 v[16:19], a[56:59], v[72:75], v[16:19]
    ds_read_b64_tr_b16 v[100:101], v129 offset:57344
    v_mfma_f32_16x16x32_bf16 v[20:23], a[120:123], v[72:75], v[20:23]
    ds_read_b64_tr_b16 v[102:103], v129 offset:58368
    s_waitcnt lgkmcnt(12)
    v_mfma_f32_16x16x32_bf16 v[24:27], a[56:59], v[76:79], v[24:27]
    ds_read_b64_tr_b16 v[104:105], v130 offset:57344
    v_mfma_f32_16x16x32_bf16 v[28:31], a[120:123], v[76:79], v[28:31]
    ds_read_b64_tr_b16 v[106:107], v130 offset:58368
    s_waitcnt lgkmcnt(12)
    v_mfma_f32_16x16x32_bf16 v[32:35], a[56:59], v[80:83], v[32:35]
    ds_read_b64_tr_b16 v[108:109], v131 offset:57344
    v_mfma_f32_16x16x32_bf16 v[36:39], a[120:123], v[80:83], v[36:39]
    ds_read_b64_tr_b16 v[110:111], v131 offset:58368
    s_waitcnt lgkmcnt(12)
    v_mfma_f32_16x16x32_bf16 v[40:43], a[56:59], v[84:87], v[40:43]
    ds_read_b64_tr_b16 v[112:113], v132 offset:57344
    v_mfma_f32_16x16x32_bf16 v[44:47], a[120:123], v[84:87], v[44:47]
    ds_read_b64_tr_b16 v[114:115], v132 offset:58368
    s_waitcnt lgkmcnt(12)
    v_mfma_f32_16x16x32_bf16 v[48:51], a[56:59], v[88:91], v[48:51]
    ds_read_b64_tr_b16 v[116:117], v133 offset:57344
    v_mfma_f32_16x16x32_bf16 v[52:55], a[120:123], v[88:91], v[52:55]
    ds_read_b64_tr_b16 v[118:119], v133 offset:58368
    s_waitcnt lgkmcnt(12)
    v_mfma_f32_16x16x32_bf16 v[56:59], a[56:59], v[92:95], v[56:59]
    ds_read_b64_tr_b16 v[120:121], v134 offset:57344
    v_mfma_f32_16x16x32_bf16 v[60:63], a[120:123], v[92:95], v[60:63]
    ds_read_b64_tr_b16 v[122:123], v134 offset:58368
    s_waitcnt lgkmcnt(12)
    v_mfma_f32_16x16x32_bf16 v[0:3], a[60:63], v[96:99], v[0:3]
    ds_read_b64_tr_b16 v[124:125], v135 offset:57344
    v_mfma_f32_16x16x32_bf16 v[4:7], a[124:127], v[96:99], v[4:7]
    ds_read_b64_tr_b16 v[126:127], v135 offset:58368
    s_waitcnt lgkmcnt(12)
    v_mfma_f32_16x16x32_bf16 v[8:11], a[60:63], v[100:103], v[8:11]
    v_mfma_f32_16x16x32_bf16 v[12:15], a[124:127], v[100:103], v[12:15]
    s_waitcnt lgkmcnt(10)
    v_mfma_f32_16x16x32_bf16 v[16:19], a[60:63], v[104:107], v[16:19]
    v_mfma_f32_16x16x32_bf16 v[20:23], a[124:127], v[104:107], v[20:23]
    s_waitcnt lgkmcnt(8)
    v_mfma_f32_16x16x32_bf16 v[24:27], a[60:63], v[108:111], v[24:27]
    v_mfma_f32_16x16x32_bf16 v[28:31], a[124:127], v[108:111], v[28:31]
    s_waitcnt lgkmcnt(6)
    v_mfma_f32_16x16x32_bf16 v[32:35], a[60:63], v[112:115], v[32:35]
    v_mfma_f32_16x16x32_bf16 v[36:39], a[124:127], v[112:115], v[36:39]
    s_waitcnt lgkmcnt(4)
    v_mfma_f32_16x16x32_bf16 v[40:43], a[60:63], v[116:119], v[40:43]
    v_mfma_f32_16x16x32_bf16 v[44:47], a[124:127], v[116:119], v[44:47]
    s_waitcnt lgkmcnt(2)
    v_mfma_f32_16x16x32_bf16 v[48:51], a[60:63], v[120:123], v[48:51]
    v_mfma_f32_16x16x32_bf16 v[52:55], a[124:127], v[120:123], v[52:55]
    s_waitcnt lgkmcnt(0)
    v_mfma_f32_16x16x32_bf16 v[56:59], a[60:63], v[124:127], v[56:59]
    v_mfma_f32_16x16x32_bf16 v[60:63], a[124:127], v[124:127], v[60:63]
    v_xor_b32 v128, 0x10000, v128
    v_xor_b32 v129, 0x10000, v129
    v_xor_b32 v130, 0x10000, v130
    v_xor_b32 v131, 0x10000, v131
    v_xor_b32 v132, 0x10000, v132
    v_xor_b32 v133, 0x10000, v133
    v_xor_b32 v134, 0x10000, v134
    v_xor_b32 v135, 0x10000, v135
    v_cvt_pk_bf16_f32 v144, v0, v1
    v_cvt_pk_bf16_f32 v145, v2, v3
    v_cvt_pk_bf16_f32 v146, v4, v5
    v_cvt_pk_bf16_f32 v147, v6, v7
    buffer_store_dwordx4 v[144:147], v137, s[8:11], s25 offen sc1
    v_cvt_pk_bf16_f32 v148, v8, v9
    v_cvt_pk_bf16_f32 v149, v10, v11
    v_cvt_pk_bf16_f32 v150, v12, v13
    v_cvt_pk_bf16_f32 v151, v14, v15
    buffer_store_dwordx4 v[148:151], v137, s[8:11], s25 offen offset:1024 sc1
    v_cvt_pk_bf16_f32 v152, v16, v17
    v_cvt_pk_bf16_f32 v153, v18, v19
    v_cvt_pk_bf16_f32 v154, v20, v21
    v_cvt_pk_bf16_f32 v155, v22, v23
    buffer_store_dwordx4 v[152:155], v137, s[8:11], s25 offen offset:2048 sc1
    v_cvt_pk_bf16_f32 v156, v24, v25
    v_cvt_pk_bf16_f32 v157, v26, v27
    v_cvt_pk_bf16_f32 v158, v28, v29
    v_cvt_pk_bf16_f32 v159, v30, v31
    buffer_store_dwordx4 v[156:159], v137, s[8:11], s25 offen offset:3072 sc1
    v_cvt_pk_bf16_f32 v144, v32, v33
    v_cvt_pk_bf16_f32 v145, v34, v35
    v_cvt_pk_bf16_f32 v146, v36, v37
    v_cvt_pk_bf16_f32 v147, v38, v39
    s_add_u32 s25, s25, 4096
    buffer_store_dwordx4 v[144:147], v137, s[8:11], s25 offen sc1
    v_cvt_pk_bf16_f32 v148, v40, v41
    v_cvt_pk_bf16_f32 v149, v42, v43
    v_cvt_pk_bf16_f32 v150, v44, v45
    v_cvt_pk_bf16_f32 v151, v46, v47
    buffer_store_dwordx4 v[148:151], v137, s[8:11], s25 offen offset:1024 sc1
    v_cvt_pk_bf16_f32 v152, v48, v49
    v_cvt_pk_bf16_f32 v153, v50, v51
    v_cvt_pk_bf16_f32 v154, v52, v53
    v_cvt_pk_bf16_f32 v155, v54, v55
    buffer_store_dwordx4 v[152:155], v137, s[8:11], s25 offen offset:2048 sc1
    v_cvt_pk_bf16_f32 v156, v56, v57
    v_cvt_pk_bf16_f32 v157, v58, v59
    v_cvt_pk_bf16_f32 v158, v60, v61
    v_cvt_pk_bf16_f32 v159, v62, v63
    buffer_store_dwordx4 v[156:159], v137, s[8:11], s25 offen offset:3072 sc1
L_p1_next:
    s_add_u32 s80, s80, 1
    s_lshl_b32 s40, s38, 4
    s_add_u32 s40, s40, s20
    s_lshl_b32 s40, s40, 2
    s_add_u32 s40, s40, 0x2000
    s_add_u32 s38, s38, s37
    s_branch L_p1_unit
L_p1_end:
    s_waitcnt vmcnt(0)
    s_barrier
    s_cmp_eq_u32 s40, 0
    s_cbranch_scc1 L_nopf_98
    s_cmp_lg_u32 s87, 0
    s_cbranch_scc1 L_modeok_99
    s_mov_b32 s96, 0
L_mode_100:
    buffer_load_dwordx2 v[140:141], off, s[92:95], 0 offset:36 sc1
    s_waitcnt vmcnt(0)
    v_readfirstlane_b32 s87, v140
    v_readfirstlane_b32 s97, v141
    s_nop 0
    s_min_u32 s97, s97, s87
    s_cmp_lg_u32 s97, 0
    s_cbranch_scc1 L_moded_101
    s_sleep 4
    s_add_u32 s96, s96, 1
    s_cmp_lg_u32 s96, 0x100
    s_cbranch_scc1 L_modef_102
    v_mov_b32 v140, 2
    v_mov_b32 v141, 0
    s_mov_b64 exec, 1
    buffer_atomic_cmpswap v[140:141], off, s[92:95], 0 offset:36
    s_mov_b64 exec, -1
L_modef_102:
    s_cmp_lt_u32 s96, 0x10000
    s_cbranch_scc1 L_mode_100
L_moded_101:
    s_cmp_lg_u32 s87, 1
    s_cbranch_scc1 L_fallback
L_modeok_99:
    s_cmp_lg_u32 s100, 0
    s_cbranch_scc1 L_flag_103
    v_mov_b32 v138, 1
    s_mov_b64 exec, 1
    buffer_store_dword v138, off, s[8:11], s40 sc1
    s_mov_b64 exec, -1
L_flag_103:
    s_mov_b32 s40, 0
L_nopf_98:
    s_cmp_lg_u32 s41, 0
    s_cbranch_scc1 L_p1done
    s_mov_b32 s41, 1
    s_and_b32 s20, s101, 15
    s_lshr_b32 s22, s101, 4
    s_mov_b32 s37, 14
    s_add_u32 s26, s22, 70
    s_add_u32 s27, s22, 56
    s_cmp_ge_u32 s27, 64
    s_cselect_b32 s26, s27, s26
    s_add_u32 s27, s22, 42
    s_add_u32 s28, s22, 28
    s_cmp_ge_u32 s28, 32
    s_cselect_b32 s27, s28, s27
    s_cmp_eq_u32 s20, 3
    s_cselect_b32 s22, s27, s22
    s_cmp_lt_u32 s20, 3
    s_cselect_b32 s22, s26, s22
    s_branch L_p1_pass
L_p1done:
    v_mbcnt_lo_u32_b32 v0, -1, 0
    v_mbcnt_hi_u32_b32 v0, -1, v0
    s_lshl_b32 s96, s100, 6
    v_add_u32 v0, s96, v0
    s_and_b32 s20, s101, 15
    s_lshr_b32 s22, s101, 4
    s_mov_b32 s23, 14
    s_load_dwordx2 s[12:13], s[0:1], 40
    s_waitcnt lgkmcnt(0)
    s_and_b32 s13, s13, 0xffff
    s_mov_b32 s14, 0x400000
    s_mov_b32 s15, 0x20000
    v_lshrrev_b32 v4, 6, v0
    s_nop 0
    v_readfirstlane_b32 s21, v4
    v_and_b32 v1, 63, v0
    v_lshrrev_b32 v2, 4, v1
    v_and_b32 v3, 15, v1
    v_lshrrev_b32 v6, 2, v3
    v_lshlrev_b32 v240, 4, v1
    v_lshlrev_b32 v241, 3, v1
    s_lshl_b32 s27, s21, 10
    s_lshl_b32 s24, s21, 5
    v_xor_b32 v4, s24, v240
    v_add_u32 v8, s27, v4
    v_xor_b32 v9, 128, v8
    v_lshl_add_u32 v4, v2, 2, v6
    v_and_b32 v5, 7, v4
    v_lshlrev_b32 v4, 10, v4
    v_lshl_add_u32 v4, v5, 5, v4
    v_and_b32 v5, 3, v3
    v_lshl_add_u32 v4, v5, 3, v4
    s_lshl_b32 s24, s21, 8
    v_add_u32 v10, s24, v4
    s_lshl_b32 s25, s20, 18
    s_add_u32 s24, s25, 0x0
    s_add_u32 m0, s27, 0x0
    s_nop 0
    buffer_load_dwordx4 v8, s[12:15], s24 offen lds
    s_add_u32 s24, s25, 0x1000
    s_add_u32 m0, s27, 0x1000
    s_nop 0
    buffer_load_dwordx4 v9, s[12:15], s24 offen lds
    s_add_u32 s24, s25, 0x2000
    s_add_u32 m0, s27, 0x2000
    s_nop 0
    buffer_load_dwordx4 v8, s[12:15], s24 offen lds
    s_add_u32 s24, s25, 0x3000
    s_add_u32 m0, s27, 0x3000
    s_nop 0
    buffer_load_dwordx4 v9, s[12:15], s24 offen lds
    s_add_u32 s24, s25, 0x4000
    s_add_u32 m0, s27, 0x4000
    s_nop 0
    buffer_load_dwordx4 v8, s[12:15], s24 offen lds
    s_add_u32 s24, s25, 0x5000
    s_add_u32 m0, s27, 0x5000
    s_nop 0
    buffer_load_dwordx4 v9, s[12:15], s24 offen lds
    s_add_u32 s24, s25, 0x6000
    s_add_u32 m0, s27, 0x6000
    s_nop 0
    buffer_load_dwordx4 v8, s[12:15], s24 offen lds
    s_add_u32 s24, s25, 0x7000
    s_add_u32 m0, s27, 0x7000
    s_nop 0
    buffer_load_dwordx4 v9, s[12:15], s24 offen lds
    s_add_u32 s24, s25, 0x8000
    s_add_u32 m0, s27, 0x8000
    s_nop 0
    buffer_load_dwordx4 v8, s[12:15], s24 offen lds
    s_add_u32 s24, s25, 0x9000
    s_add_u32 m0, s27, 0x9000
    s_nop 0
    buffer_load_dwordx4 v9, s[12:15], s24 offen lds
    s_add_u32 s24, s25, 0xa000
    s_add_u32 m0, s27, 0xa000
    s_nop 0
    buffer_load_dwordx4 v8, s[12:15], s24 offen lds
    s_add_u32 s24, s25, 0xb000
    s_add_u32 m0, s27, 0xb000
    s_nop 0
    buffer_load_dwordx4 v9, s[12:15], s24 offen lds
    s_add_u32 s24, s25, 0xc000
    s_add_u32 m0, s27, 0xc000
    s_nop 0
    buffer_load_dwordx4 v8, s[12:15], s24 offen lds
    s_add_u32 s24, s25, 0xd000
    s_add_u32 m0, s27, 0xd000
    s_nop 0
    buffer_load_dwordx4 v9, s[12:15], s24 offen lds
    s_add_u32 s24, s25, 0xe000
    s_add_u32 m0, s27, 0xe000
    s_nop 0
    buffer_load_dwordx4 v8, s[12:15], s24 offen lds
    s_add_u32 s24, s25, 0xf000
    s_add_u32 m0, s27, 0xf000
    s_nop 0
    buffer_load_dwordx4 v9, s[12:15], s24 offen lds
    s_add_u32 s24, s25, 0x10000
    s_add_u32 m0, s27, 0x10000
    s_nop 0
    buffer_load_dwordx4 v8, s[12:15], s24 offen lds
    s_add_u32 s24, s25, 0x11000
    s_add_u32 m0, s27, 0x11000
    s_nop 0
    buffer_load_dwordx4 v9, s[12:15], s24 offen lds
    s_add_u32 s24, s25, 0x12000
    s_add_u32 m0, s27, 0x12000
    s_nop 0
    buffer_load_dwordx4 v8, s[12:15], s24 offen lds
    s_add_u32 s24, s25, 0x13000
    s_add_u32 m0, s27, 0x13000
    s_nop 0
    buffer_load_dwordx4 v9, s[12:15], s24 offen lds
    s_add_u32 s24, s25, 0x14000
    s_add_u32 m0, s27, 0x14000
    s_nop 0
    buffer_load_dwordx4 v8, s[12:15], s24 offen lds
    s_add_u32 s24, s25, 0x15000
    s_add_u32 m0, s27, 0x15000
    s_nop 0
    buffer_load_dwordx4 v9, s[12:15], s24 offen lds
    s_add_u32 s24, s25, 0x16000
    s_add_u32 m0, s27, 0x16000
    s_nop 0
    buffer_load_dwordx4 v8, s[12:15], s24 offen lds
    s_add_u32 s24, s25, 0x17000
    s_add_u32 m0, s27, 0x17000
    s_nop 0
    buffer_load_dwordx4 v9, s[12:15], s24 offen lds
    s_add_u32 s24, s25, 0x18000
    s_add_u32 m0, s27, 0x18000
    s_nop 0
    buffer_load_dwordx4 v8, s[12:15], s24 offen lds
    s_add_u32 s24, s25, 0x19000
    s_add_u32 m0, s27, 0x19000
    s_nop 0
    buffer_load_dwordx4 v9, s[12:15], s24 offen lds
    s_add_u32 s24, s25, 0x1a000
    s_add_u32 m0, s27, 0x1a000
    s_nop 0
    buffer_load_dwordx4 v8, s[12:15], s24 offen lds
    s_add_u32 s24, s25, 0x1b000
    s_add_u32 m0, s27, 0x1b000
    s_nop 0
    buffer_load_dwordx4 v9, s[12:15], s24 offen lds
    s_add_u32 s24, s25, 0x1c000
    s_add_u32 m0, s27, 0x1c000
    s_nop 0
    buffer_load_dwordx4 v8, s[12:15], s24 offen lds
    s_add_u32 s24, s25, 0x1d000
    s_add_u32 m0, s27, 0x1d000
    s_nop 0
    buffer_load_dwordx4 v9, s[12:15], s24 offen lds
    s_add_u32 s24, s25, 0x1e000
    s_add_u32 m0, s27, 0x1e000
    s_nop 0
    buffer_load_dwordx4 v8, s[12:15], s24 offen lds
    s_add_u32 s24, s25, 0x1f000
    s_add_u32 m0, s27, 0x1f000
    s_nop 0
    buffer_load_dwordx4 v9, s[12:15], s24 offen lds
    s_waitcnt vmcnt(0)
    s_barrier
    v_xor_b32 v11, 0x0, v10
    ds_read_b64_tr_b16 a[0:1], v11
    ds_read_b64_tr_b16 a[2:3], v11 offset:16384
    ds_read_b64_tr_b16 a[32:33], v11 offset:32768
    ds_read_b64_tr_b16 a[34:35], v11 offset:49152
    v_xor_b32 v11, 0x20, v10
    ds_read_b64_tr_b16 a[4:5], v11
    ds_read_b64_tr_b16 a[6:7], v11 offset:16384
    ds_read_b64_tr_b16 a[36:37], v11 offset:32768
    ds_read_b64_tr_b16 a[38:39], v11 offset:49152
    s_waitcnt lgkmcnt(0)
    v_xor_b32 v11, 0x40, v10
    ds_read_b64_tr_b16 a[8:9], v11
    ds_read_b64_tr_b16 a[10:11], v11 offset:16384
    ds_read_b64_tr_b16 a[40:41], v11 offset:32768
    ds_read_b64_tr_b16 a[42:43], v11 offset:49152
    v_xor_b32 v11, 0x60, v10
    ds_read_b64_tr_b16 a[12:13], v11
    ds_read_b64_tr_b16 a[14:15], v11 offset:16384
    ds_read_b64_tr_b16 a[44:45], v11 offset:32768
    ds_read_b64_tr_b16 a[46:47], v11 offset:49152
    s_waitcnt lgkmcnt(0)
    v_xor_b32 v11, 0x80, v10
    ds_read_b64_tr_b16 a[16:17], v11
    ds_read_b64_tr_b16 a[18:19], v11 offset:16384
    ds_read_b64_tr_b16 a[48:49], v11 offset:32768
    ds_read_b64_tr_b16 a[50:51], v11 offset:49152
    v_xor_b32 v11, 0xa0, v10
    ds_read_b64_tr_b16 a[20:21], v11
    ds_read_b64_tr_b16 a[22:23], v11 offset:16384
    ds_read_b64_tr_b16 a[52:53], v11 offset:32768
    ds_read_b64_tr_b16 a[54:55], v11 offset:49152
    s_waitcnt lgkmcnt(0)
    v_xor_b32 v11, 0xc0, v10
    ds_read_b64_tr_b16 a[24:25], v11
    ds_read_b64_tr_b16 a[26:27], v11 offset:16384
    ds_read_b64_tr_b16 a[56:57], v11 offset:32768
    ds_read_b64_tr_b16 a[58:59], v11 offset:49152
    v_xor_b32 v11, 0xe0, v10
    ds_read_b64_tr_b16 a[28:29], v11
    ds_read_b64_tr_b16 a[30:31], v11 offset:16384
    ds_read_b64_tr_b16 a[60:61], v11 offset:32768
    ds_read_b64_tr_b16 a[62:63], v11 offset:49152
    s_waitcnt lgkmcnt(0)
    v_xor_b32 v11, 0x10000, v10
    ds_read_b64_tr_b16 a[64:65], v11
    ds_read_b64_tr_b16 a[66:67], v11 offset:16384
    ds_read_b64_tr_b16 a[96:97], v11 offset:32768
    ds_read_b64_tr_b16 a[98:99], v11 offset:49152
    v_xor_b32 v11, 0x10020, v10
    ds_read_b64_tr_b16 a[68:69], v11
    ds_read_b64_tr_b16 a[70:71], v11 offset:16384
    ds_read_b64_tr_b16 a[100:101], v11 offset:32768
    ds_read_b64_tr_b16 a[102:103], v11 offset:49152
    s_waitcnt lgkmcnt(0)
    v_xor_b32 v11, 0x10040, v10
    ds_read_b64_tr_b16 a[72:73], v11
    ds_read_b64_tr_b16 a[74:75], v11 offset:16384
    ds_read_b64_tr_b16 a[104:105], v11 offset:32768
    ds_read_b64_tr_b16 a[106:107], v11 offset:49152
    v_xor_b32 v11, 0x10060, v10
    ds_read_b64_tr_b16 a[76:77], v11
    ds_read_b64_tr_b16 a[78:79], v11 offset:16384
    ds_read_b64_tr_b16 a[108:109], v11 offset:32768
    ds_read_b64_tr_b16 a[110:111], v11 offset:49152
    s_waitcnt lgkmcnt(0)
    v_xor_b32 v11, 0x10080, v10
    ds_read_b64_tr_b16 a[80:81], v11
    ds_read_b64_tr_b16 a[82:83], v11 offset:16384
    ds_read_b64_tr_b16 a[112:113], v11 offset:32768
    ds_read_b64_tr_b16 a[114:115], v11 offset:49152
    v_xor_b32 v11, 0x100a0, v10
    ds_read_b64_tr_b16 a[84:85], v11
    ds_read_b64_tr_b16 a[86:87], v11 offset:16384
    ds_read_b64_tr_b16 a[116:117], v11 offset:32768
    ds_read_b64_tr_b16 a[118:119], v11 offset:49152
    s_waitcnt lgkmcnt(0)
    v_xor_b32 v11, 0x100c0, v10
    ds_read_b64_tr_b16 a[88:89], v11
    ds_read_b64_tr_b16 a[90:91], v11 offset:16384
    ds_read_b64_tr_b16 a[120:121], v11 offset:32768
    ds_read_b64_tr_b16 a[122:123], v11 offset:49152
    v_xor_b32 v11, 0x100e0, v10
    ds_read_b64_tr_b16 a[92:93], v11
    ds_read_b64_tr_b16 a[94:95], v11 offset:16384
    ds_read_b64_tr_b16 a[124:125], v11 offset:32768
    ds_read_b64_tr_b16 a[126:127], v11 offset:49152
    s_waitcnt lgkmcnt(0)
    s_barrier
    s_lshl_b32 s25, s20, 18
    s_add_u32 s24, s25, 0x20000
    s_add_u32 m0, s27, 0x0
    s_nop 0
    buffer_load_dwordx4 v8, s[12:15], s24 offen lds
    s_add_u32 s24, s25, 0x21000
    s_add_u32 m0, s27, 0x1000
    s_nop 0
    buffer_load_dwordx4 v9, s[12:15], s24 offen lds
    s_add_u32 s24, s25, 0x22000
    s_add_u32 m0, s27, 0x2000
    s_nop 0
    buffer_load_dwordx4 v8, s[12:15], s24 offen lds
    s_add_u32 s24, s25, 0x23000
    s_add_u32 m0, s27, 0x3000
    s_nop 0
    buffer_load_dwordx4 v9, s[12:15], s24 offen lds
    s_add_u32 s24, s25, 0x24000
    s_add_u32 m0, s27, 0x4000
    s_nop 0
    buffer_load_dwordx4 v8, s[12:15], s24 offen lds
    s_add_u32 s24, s25, 0x25000
    s_add_u32 m0, s27, 0x5000
    s_nop 0
    buffer_load_dwordx4 v9, s[12:15], s24 offen lds
    s_add_u32 s24, s25, 0x26000
    s_add_u32 m0, s27, 0x6000
    s_nop 0
    buffer_load_dwordx4 v8, s[12:15], s24 offen lds
    s_add_u32 s24, s25, 0x27000
    s_add_u32 m0, s27, 0x7000
    s_nop 0
    buffer_load_dwordx4 v9, s[12:15], s24 offen lds
    s_add_u32 s24, s25, 0x28000
    s_add_u32 m0, s27, 0x8000
    s_nop 0
    buffer_load_dwordx4 v8, s[12:15], s24 offen lds
    s_add_u32 s24, s25, 0x29000
    s_add_u32 m0, s27, 0x9000
    s_nop 0
    buffer_load_dwordx4 v9, s[12:15], s24 offen lds
    s_add_u32 s24, s25, 0x2a000
    s_add_u32 m0, s27, 0xa000
    s_nop 0
    buffer_load_dwordx4 v8, s[12:15], s24 offen lds
    s_add_u32 s24, s25, 0x2b000
    s_add_u32 m0, s27, 0xb000
    s_nop 0
    buffer_load_dwordx4 v9, s[12:15], s24 offen lds
    s_add_u32 s24, s25, 0x2c000
    s_add_u32 m0, s27, 0xc000
    s_nop 0
    buffer_load_dwordx4 v8, s[12:15], s24 offen lds
    s_add_u32 s24, s25, 0x2d000
    s_add_u32 m0, s27, 0xd000
    s_nop 0
    buffer_load_dwordx4 v9, s[12:15], s24 offen lds
    s_add_u32 s24, s25, 0x2e000
    s_add_u32 m0, s27, 0xe000
    s_nop 0
    buffer_load_dwordx4 v8, s[12:15], s24 offen lds
    s_add_u32 s24, s25, 0x2f000
    s_add_u32 m0, s27, 0xf000
    s_nop 0
    buffer_load_dwordx4 v9, s[12:15], s24 offen lds
    s_add_u32 s24, s25, 0x30000
    s_add_u32 m0, s27, 0x10000
    s_nop 0
    buffer_load_dwordx4 v8, s[12:15], s24 offen lds
    s_add_u32 s24, s25, 0x31000
    s_add_u32 m0, s27, 0x11000
    s_nop 0
    buffer_load_dwordx4 v9, s[12:15], s24 offen lds
    s_add_u32 s24, s25, 0x32000
    s_add_u32 m0, s27, 0x12000
    s_nop 0
    buffer_load_dwordx4 v8, s[12:15], s24 offen lds
    s_add_u32 s24, s25, 0x33000
    s_add_u32 m0, s27, 0x13000
    s_nop 0
    buffer_load_dwordx4 v9, s[12:15], s24 offen lds
    s_add_u32 s24, s25, 0x34000
    s_add_u32 m0, s27, 0x14000
    s_nop 0
    buffer_load_dwordx4 v8, s[12:15], s24 offen lds
    s_add_u32 s24, s25, 0x35000
    s_add_u32 m0, s27, 0x15000
    s_nop 0
    buffer_load_dwordx4 v9, s[12:15], s24 offen lds
    s_add_u32 s24, s25, 0x36000
    s_add_u32 m0, s27, 0x16000
    s_nop 0
    buffer_load_dwordx4 v8, s[12:15], s24 offen lds
    s_add_u32 s24, s25, 0x37000
    s_add_u32 m0, s27, 0x17000
    s_nop 0
    buffer_load_dwordx4 v9, s[12:15], s24 offen lds
    s_add_u32 s24, s25, 0x38000
    s_add_u32 m0, s27, 0x18000
    s_nop 0
    buffer_load_dwordx4 v8, s[12:15], s24 offen lds
    s_add_u32 s24, s25, 0x39000
    s_add_u32 m0, s27, 0x19000
    s_nop 0
    buffer_load_dwordx4 v9, s[12:15], s24 offen lds
    s_add_u32 s24, s25, 0x3a000
    s_add_u32 m0, s27, 0x1a000
    s_nop 0
    buffer_load_dwordx4 v8, s[12:15], s24 offen lds
    s_add_u32 s24, s25, 0x3b000
    s_add_u32 m0, s27, 0x1b000
    s_nop 0
    buffer_load_dwordx4 v9, s[12:15], s24 offen lds
    s_add_u32 s24, s25, 0x3c000
    s_add_u32 m0, s27, 0x1c000
    s_nop 0
    buffer_load_dwordx4 v8, s[12:15], s24 offen lds
    s_add_u32 s24, s25, 0x3d000
    s_add_u32 m0, s27, 0x1d000
    s_nop 0
    buffer_load_dwordx4 v9, s[12:15], s24 offen lds
    s_add_u32 s24, s25, 0x3e000
    s_add_u32 m0, s27, 0x1e000
    s_nop 0
    buffer_load_dwordx4 v8, s[12:15], s24 offen lds
    s_add_u32 s24, s25, 0x3f000
    s_add_u32 m0, s27, 0x1f000
    s_nop 0
    buffer_load_dwordx4 v9, s[12:15], s24 offen lds
    s_waitcnt vmcnt(0)
    s_barrier
    v_xor_b32 v11, 0x0, v10
    ds_read_b64_tr_b16 a[128:129], v11
    ds_read_b64_tr_b16 a[130:131], v11 offset:16384
    ds_read_b64_tr_b16 a[160:161], v11 offset:32768
    ds_read_b64_tr_b16 a[162:163], v11 offset:49152
    v_xor_b32 v11, 0x20, v10
    ds_read_b64_tr_b16 a[132:133], v11
    ds_read_b64_tr_b16 a[134:135], v11 offset:16384
    ds_read_b64_tr_b16 a[164:165], v11 offset:32768
    ds_read_b64_tr_b16 a[166:167], v11 offset:49152
    s_waitcnt lgkmcnt(0)
    v_xor_b32 v11, 0x40, v10
    ds_read_b64_tr_b16 a[136:137], v11
    ds_read_b64_tr_b16 a[138:139], v11 offset:16384
    ds_read_b64_tr_b16 a[168:169], v11 offset:32768
    ds_read_b64_tr_b16 a[170:171], v11 offset:49152
    v_xor_b32 v11, 0x60, v10
    ds_read_b64_tr_b16 a[140:141], v11
    ds_read_b64_tr_b16 a[142:143], v11 offset:16384
    ds_read_b64_tr_b16 a[172:173], v11 offset:32768
    ds_read_b64_tr_b16 a[174:175], v11 offset:49152
    s_waitcnt lgkmcnt(0)
    v_xor_b32 v11, 0x80, v10
    ds_read_b64_tr_b16 a[144:145], v11
    ds_read_b64_tr_b16 a[146:147], v11 offset:16384
    ds_read_b64_tr_b16 a[176:177], v11 offset:32768
    ds_read_b64_tr_b16 a[178:179], v11 offset:49152
    v_xor_b32 v11, 0xa0, v10
    ds_read_b64_tr_b16 a[148:149], v11
    ds_read_b64_tr_b16 a[150:151], v11 offset:16384
    ds_read_b64_tr_b16 a[180:181], v11 offset:32768
    ds_read_b64_tr_b16 a[182:183], v11 offset:49152
    s_waitcnt lgkmcnt(0)
    v_xor_b32 v11, 0xc0, v10
    ds_read_b64_tr_b16 a[152:153], v11
    ds_read_b64_tr_b16 a[154:155], v11 offset:16384
    ds_read_b64_tr_b16 a[184:185], v11 offset:32768
    ds_read_b64_tr_b16 a[186:187], v11 offset:49152
    v_xor_b32 v11, 0xe0, v10
    ds_read_b64_tr_b16 a[156:157], v11
    ds_read_b64_tr_b16 a[158:159], v11 offset:16384
    ds_read_b64_tr_b16 a[188:189], v11 offset:32768
    ds_read_b64_tr_b16 a[190:191], v11 offset:49152
    s_waitcnt lgkmcnt(0)
    v_xor_b32 v11, 0x10000, v10
    ds_read_b64_tr_b16 a[192:193], v11
    ds_read_b64_tr_b16 a[194:195], v11 offset:16384
    ds_read_b64_tr_b16 a[224:225], v11 offset:32768
    ds_read_b64_tr_b16 a[226:227], v11 offset:49152
    v_xor_b32 v11, 0x10020, v10
    ds_read_b64_tr_b16 a[196:197], v11
    ds_read_b64_tr_b16 a[198:199], v11 offset:16384
    ds_read_b64_tr_b16 a[228:229], v11 offset:32768
    ds_read_b64_tr_b16 a[230:231], v11 offset:49152
    s_waitcnt lgkmcnt(0)
    v_xor_b32 v11, 0x10040, v10
    ds_read_b64_tr_b16 a[200:201], v11
    ds_read_b64_tr_b16 a[202:203], v11 offset:16384
    ds_read_b64_tr_b16 a[232:233], v11 offset:32768
    ds_read_b64_tr_b16 a[234:235], v11 offset:49152
    v_xor_b32 v11, 0x10060, v10
    ds_read_b64_tr_b16 a[204:205], v11
    ds_read_b64_tr_b16 a[206:207], v11 offset:16384
    ds_read_b64_tr_b16 a[236:237], v11 offset:32768
    ds_read_b64_tr_b16 a[238:239], v11 offset:49152
    s_waitcnt lgkmcnt(0)
    v_xor_b32 v11, 0x10080, v10
    ds_read_b64_tr_b16 a[208:209], v11
    ds_read_b64_tr_b16 a[210:211], v11 offset:16384
    ds_read_b64_tr_b16 a[240:241], v11 offset:32768
    ds_read_b64_tr_b16 a[242:243], v11 offset:49152
    v_xor_b32 v11, 0x100a0, v10
    ds_read_b64_tr_b16 a[212:213], v11
    ds_read_b64_tr_b16 a[214:215], v11 offset:16384
    ds_read_b64_tr_b16 a[244:245], v11 offset:32768
    ds_read_b64_tr_b16 a[246:247], v11 offset:49152
    s_waitcnt lgkmcnt(0)
    v_xor_b32 v11, 0x100c0, v10
    ds_read_b64_tr_b16 a[216:217], v11
    ds_read_b64_tr_b16 a[218:219], v11 offset:16384
    ds_read_b64_tr_b16 a[248:249], v11 offset:32768
    ds_read_b64_tr_b16 a[250:251], v11 offset:49152
    v_xor_b32 v11, 0x100e0, v10
    ds_read_b64_tr_b16 a[220:221], v11
    ds_read_b64_tr_b16 a[222:223], v11 offset:16384
    ds_read_b64_tr_b16 a[252:253], v11 offset:32768
    ds_read_b64_tr_b16 a[254:255], v11 offset:49152
    s_waitcnt lgkmcnt(0)
    s_barrier
    s_and_b32 s24, s21, 1
    s_lshl_b32 s24, s24, 4
    v_add_u32 v4, s24, v3
    v_lshlrev_b32 v5, 2, v2
    v_sub_u32 v4, v4, v5
    v_cmp_le_i32 s[30:31], 0, v4
    v_cmp_le_i32 s[32:33], 1, v4
    v_cmp_le_i32 s[34:35], 2, v4
    v_cmp_le_i32 s[36:37], 3, v4
    v_cmp_le_i32 s[38:39], 16, v4
    v_cmp_le_i32 s[40:41], 17, v4
    v_cmp_le_i32 s[42:43], 18, v4
    v_cmp_le_i32 s[44:45], 19, v4
    s_mov_b32 s28, 0x3e0293ee
    s_mov_b32 s29, 0x3e0293ee
    s_mov_b32 s53, 0xff000000
    v_mov_b32 v136, 0x3f803f80
    v_mov_b32 v137, 0x3f803f80
    v_mov_b32 v138, 0x3f803f80
    v_mov_b32 v139, 0x3f803f80
    v_lshlrev_b32 v4, 10, v3
    v_lshl_add_u32 v4, v2, 4, v4
    s_lshl_b32 s24, s21, 8
    v_add_u32 v242, s24, v4
    s_lshl_b32 s24, s21, 12
    v_add_u32 v243, s24, v240
    v_mov_b32 v244, v240
    s_add_u32 s24, s24, 0x22000
    v_xor_b32 v7, v2, v6
    v_lshl_add_u32 v4, v2, 4, v7
    v_and_b32 v5, 3, v3
    v_lshl_add_u32 v4, v4, 2, v5
    v_lshl_add_u32 v253, v4, 2, s24
    v_lshl_add_u32 v4, v3, 2, v7
    v_lshl_add_u32 v254, v4, 4, s24
    s_load_dwordx2 s[12:13], s[0:1], 0
    s_waitcnt lgkmcnt(0)
    s_and_b32 s13, s13, 0xffff
    s_mov_b32 s14, 0x200000
    s_mov_b32 s15, 0x20000
    s_load_dwordx2 s[16:17], s[0:1], 96
    s_waitcnt lgkmcnt(0)
    s_and_b32 s17, s17, 0xffff
    s_mov_b32 s18, 0x200000
    s_mov_b32 s19, 0x20000
    s_load_dwordx2 s[56:57], s[0:1], 64
    s_waitcnt lgkmcnt(0)
    s_and_b32 s57, s57, 0xffff
    s_mov_b32 s58, 0x400
    s_mov_b32 s59, 0x20000
    v_and_b32 v100, 63, v0
    v_lshlrev_b32 v240, 4, v100
    v_lshrrev_b32 v101, 2, v100
    v_lshlrev_b32 v101, 6, v101
    v_and_b32 v102, 3, v100
    v_lshl_add_u32 v252, v102, 3, v101
    buffer_load_dwordx2 v[236:237], v252, s[56:59], 0 offen
    buffer_load_dwordx2 v[238:239], v252, s[56:59], 0 offen offset:32
    s_mov_b32 s65, 0x3f80
    s_mov_b32 s66, 0x3f800000
    s_waitcnt vmcnt(0)
    s_sub_u32 s67, s101, 128
    s_cmp_ge_u32 s67, 56
    s_cbranch_scc1 L_nostage_104
    v_lshrrev_b32 v2, 6, v0
    s_nop 0
    v_readfirstlane_b32 s68, v2
    v_and_b32 v1, 63, v0
    s_lshl_b32 s73, s68, 10
    v_lshrrev_b32 v2, 2, v1
    s_lshl_b32 s71, s68, 4
    v_add_u32 v2, s71, v2
    s_movk_i32 s71, 3584
    v_mul_lo_u32 v2, v2, s71
    v_and_b32 v3, 3, v1
    v_lshl_add_u32 v4, v3, 4, v2
    s_load_dwordx2 s[76:77], s[0:1], 72
    s_waitcnt lgkmcnt(0)
    s_and_b32 s77, s77, 0xffff
    s_mov_b32 s78, 0x1c0000
    s_mov_b32 s79, 0x20000
    s_lshl_b32 s71, s67, 6
    s_add_u32 s71, s71, 0x0
    s_add_u32 m0, s73, 0x8000
    s_nop 0
    buffer_load_dwordx4 v4, s[76:79], s71 offen lds
    s_lshl_b32 s71, s67, 6
    s_add_u32 s71, s71, 0x38000
    s_add_u32 m0, s73, 0x9000
    s_nop 0
    buffer_load_dwordx4 v4, s[76:79], s71 offen lds
    s_lshl_b32 s71, s67, 6
    s_add_u32 s71, s71, 0x70000
    s_add_u32 m0, s73, 0xa000
    s_nop 0
    buffer_load_dwordx4 v4, s[76:79], s71 offen lds
    s_lshl_b32 s71, s67, 6
    s_add_u32 s71, s71, 0xa8000
    s_add_u32 m0, s73, 0xb000
    s_nop 0
    buffer_load_dwordx4 v4, s[76:79], s71 offen lds
    s_lshl_b32 s71, s67, 6
    s_add_u32 s71, s71, 0xe0000
    s_add_u32 m0, s73, 0xc000
    s_nop 0
    buffer_load_dwordx4 v4, s[76:79], s71 offen lds
    s_lshl_b32 s71, s67, 6
    s_add_u32 s71, s71, 0x118000
    s_add_u32 m0, s73, 0xd000
    s_nop 0
    buffer_load_dwordx4 v4, s[76:79], s71 offen lds
    s_lshl_b32 s71, s67, 6
    s_add_u32 s71, s71, 0x150000
    s_add_u32 m0, s73, 0xe000
    s_nop 0
    buffer_load_dwordx4 v4, s[76:79], s71 offen lds
    s_lshl_b32 s71, s67, 6
    s_add_u32 s71, s71, 0x188000
    s_add_u32 m0, s73, 0xf000
    s_nop 0
    buffer_load_dwordx4 v4, s[76:79], s71 offen lds
    s_load_dwordx2 s[76:77], s[0:1], 80
    s_waitcnt lgkmcnt(0)
    s_and_b32 s77, s77, 0xffff
    s_mov_b32 s78, 0x1c0000
    s_mov_b32 s79, 0x20000
    s_lshl_b32 s71, s67, 6
    s_add_u32 s71, s71, 0x0
    s_add_u32 m0, s73, 0x10000
    s_nop 0
    buffer_load_dwordx4 v4, s[76:79], s71 offen lds
    s_lshl_b32 s71, s67, 6
    s_add_u32 s71, s71, 0x38000
    s_add_u32 m0, s73, 0x11000
    s_nop 0
    buffer_load_dwordx4 v4, s[76:79], s71 offen lds
    s_lshl_b32 s71, s67, 6
    s_add_u32 s71, s71, 0x70000
    s_add_u32 m0, s73, 0x12000
    s_nop 0
    buffer_load_dwordx4 v4, s[76:79], s71 offen lds
    s_lshl_b32 s71, s67, 6
    s_add_u32 s71, s71, 0xa8000
    s_add_u32 m0, s73, 0x13000
    s_nop 0
    buffer_load_dwordx4 v4, s[76:79], s71 offen lds
    s_lshl_b32 s71, s67, 6
    s_add_u32 s71, s71, 0xe0000
    s_add_u32 m0, s73, 0x14000
    s_nop 0
    buffer_load_dwordx4 v4, s[76:79], s71 offen lds
    s_lshl_b32 s71, s67, 6
    s_add_u32 s71, s71, 0x118000
    s_add_u32 m0, s73, 0x15000
    s_nop 0
    buffer_load_dwordx4 v4, s[76:79], s71 offen lds
    s_lshl_b32 s71, s67, 6
    s_add_u32 s71, s71, 0x150000
    s_add_u32 m0, s73, 0x16000
    s_nop 0
    buffer_load_dwordx4 v4, s[76:79], s71 offen lds
    s_lshl_b32 s71, s67, 6
    s_add_u32 s71, s71, 0x188000
    s_add_u32 m0, s73, 0x17000
    s_nop 0
    buffer_load_dwordx4 v4, s[76:79], s71 offen lds
    s_load_dwordx2 s[76:77], s[0:1], 88
    s_waitcnt lgkmcnt(0)
    s_and_b32 s77, s77, 0xffff
    s_mov_b32 s78, 0x1c0000
    s_mov_b32 s79, 0x20000
    v_lshlrev_b32 v5, 4, v1
    v_add_u32 v5, s73, v5
    s_lshl_b32 s71, s67, 15
    s_add_u32 s71, s71, 0
    s_add_u32 m0, s73, 0x18000
    s_nop 0
    buffer_load_dwordx4 v5, s[76:79], s71 offen lds
    s_lshl_b32 s71, s67, 15
    s_add_u32 s71, s71, 4096
    s_add_u32 m0, s73, 0x19000
    s_nop 0
    buffer_load_dwordx4 v5, s[76:79], s71 offen lds
    s_lshl_b32 s71, s67, 15
    s_add_u32 s71, s71, 8192
    s_add_u32 m0, s73, 0x1a000
    s_nop 0
    buffer_load_dwordx4 v5, s[76:79], s71 offen lds
    s_lshl_b32 s71, s67, 15
    s_add_u32 s71, s71, 12288
    s_add_u32 m0, s73, 0x1b000
    s_nop 0
    buffer_load_dwordx4 v5, s[76:79], s71 offen lds
    s_lshl_b32 s71, s67, 15
    s_add_u32 s71, s71, 16384
    s_add_u32 m0, s73, 0x1c000
    s_nop 0
    buffer_load_dwordx4 v5, s[76:79], s71 offen lds
    s_lshl_b32 s71, s67, 15
    s_add_u32 s71, s71, 20480
    s_add_u32 m0, s73, 0x1d000
    s_nop 0
    buffer_load_dwordx4 v5, s[76:79], s71 offen lds
    s_lshl_b32 s71, s67, 15
    s_add_u32 s71, s71, 24576
    s_add_u32 m0, s73, 0x1e000
    s_nop 0
    buffer_load_dwordx4 v5, s[76:79], s71 offen lds
    s_lshl_b32 s71, s67, 15
    s_add_u32 s71, s71, 28672
    s_add_u32 m0, s73, 0x1f000
    s_nop 0
    buffer_load_dwordx4 v5, s[76:79], s71 offen lds
L_nostage_104:
    v_lshrrev_b32 v246, 2, v240
    s_lshl_b32 s24, s20, 7
    s_add_u32 s24, s24, 0x2000
    s_cmp_lg_u32 s100, 0
    s_cbranch_scc1 L_polls_107
    s_mov_b32 exec_lo, 0xffffffff
    s_mov_b32 exec_hi, 0
    s_mov_b32 s96, 0
L_poll_105:
    buffer_load_dword v247, v246, s[8:11], s24 offen sc1
    s_waitcnt vmcnt(0)
    v_cmp_gt_u32 vcc, 1, v247
    s_cbranch_vccz L_polld_106
    s_sleep 32
    s_add_u32 s96, s96, 1
    s_cmp_lt_u32 s96, 0x10000
    s_cbranch_scc1 L_poll_105
L_polld_106:
    s_mov_b64 exec, -1
L_polls_107:
    s_barrier
    s_lshl_b32 s24, s20, 7
    s_add_u32 s24, s24, 0x2800
    s_cmp_lg_u32 s100, 0
    s_cbranch_scc1 L_polls_110
    s_mov_b32 exec_lo, 0xffffffff
    s_mov_b32 exec_hi, 0
    s_mov_b32 s96, 0
L_poll_108:
    buffer_load_dword v247, v246, s[8:11], s24 offen sc1
    s_waitcnt vmcnt(0)
    v_cmp_gt_u32 vcc, 1, v247
    s_cbranch_vccz L_polld_109
    s_sleep 32
    s_add_u32 s96, s96, 1
    s_cmp_lt_u32 s96, 0x10000
    s_cbranch_scc1 L_poll_108
L_polld_109:
    s_mov_b64 exec, -1
L_polls_110:
    s_barrier
    s_lshl_b32 s24, s20, 7
    s_add_u32 s24, s24, 0x3000
    s_cmp_lg_u32 s100, 0
    s_cbranch_scc1 L_polls_113
    s_mov_b32 exec_lo, 0xffffffff
    s_mov_b32 exec_hi, 0
    s_mov_b32 s96, 0
L_poll_111:
    buffer_load_dword v247, v246, s[8:11], s24 offen sc1
    s_waitcnt vmcnt(0)
    v_cmp_gt_u32 vcc, 1, v247
    s_cbranch_vccz L_polld_112
    s_sleep 32
    s_add_u32 s96, s96, 1
    s_cmp_lt_u32 s96, 0x10000
    s_cbranch_scc1 L_poll_111
L_polld_112:
    s_mov_b64 exec, -1
L_polls_113:
    s_barrier
    s_mov_b32 s80, 0
L_p2_seg:
    s_cmp_ge_u32 s22, 64
    s_cbranch_scc1 L_p2_end
    s_lshl_b32 s24, s22, 5
    s_lshl_b32 s25, s20, 1
    s_add_u32 s24, s24, s25
    s_lshr_b32 s25, s21, 1
    s_add_u32 s24, s24, s25
    s_lshl_b32 s25, s24, 13
    s_add_u32 s47, s25, 0x1000000
    s_add_u32 s54, s47, 4096
    s_add_u32 s48, s25, 0x2000000
    s_add_u32 s55, s48, 4096
    s_and_b32 s26, s21, 1
    s_lshl_b32 s26, s26, 12
    s_add_u32 s46, s25, s26
    s_add_u32 s46, s46, 0x3000000
    s_lshl_b32 s25, s24, 12
    s_add_u32 s49, s25, 0x240000
    s_lshl_b32 s24, s22, 4
    s_add_u32 s24, s24, s20
    s_lshl_b32 s24, s24, 15
    s_add_u32 s51, s24, 0x4000000
    buffer_load_dwordx4 v[0:3], v240, s[8:11], s46 offen
    buffer_load_dwordx4 v[4:7], v240, s[8:11], s46 offen offset:1024
    buffer_load_dwordx4 v[8:11], v240, s[8:11], s46 offen offset:2048
    buffer_load_dwordx4 v[12:15], v240, s[8:11], s46 offen offset:3072
    buffer_load_dwordx4 v[16:19], v240, s[8:11], s47 offen
    buffer_load_dwordx4 v[20:23], v240, s[8:11], s47 offen offset:1024
    buffer_load_dwordx4 v[24:27], v240, s[8:11], s47 offen offset:2048
    buffer_load_dwordx4 v[28:31], v240, s[8:11], s47 offen offset:3072
    buffer_load_dwordx4 v[32:35], v240, s[8:11], s54 offen
    buffer_load_dwordx4 v[36:39], v240, s[8:11], s54 offen offset:1024
    buffer_load_dwordx4 v[40:43], v240, s[8:11], s54 offen offset:2048
    buffer_load_dwordx4 v[44:47], v240, s[8:11], s54 offen offset:3072
    buffer_load_dwordx4 v[64:67], v240, s[8:11], s48 offen
    buffer_load_dwordx4 v[68:71], v240, s[8:11], s48 offen offset:1024
    buffer_load_dwordx4 v[72:75], v240, s[8:11], s48 offen offset:2048
    buffer_load_dwordx4 v[76:79], v240, s[8:11], s48 offen offset:3072
    buffer_load_dwordx4 v[80:83], v240, s[8:11], s55 offen
    buffer_load_dwordx4 v[84:87], v240, s[8:11], s55 offen offset:1024
    buffer_load_dwordx4 v[88:91], v240, s[8:11], s55 offen offset:2048
    buffer_load_dwordx4 v[92:95], v240, s[8:11], s55 offen offset:3072
    s_waitcnt vmcnt(8)
    v_mfma_f32_16x16x32_bf16 v[116:119], v[16:19], v[0:3], 0
    v_mfma_f32_16x16x32_bf16 v[116:119], v[20:23], v[4:7], v[116:119]
    v_mfma_f32_16x16x32_bf16 v[116:119], v[24:27], v[8:11], v[116:119]
    v_mfma_f32_16x16x32_bf16 v[116:119], v[28:31], v[12:15], v[116:119]
    v_mfma_f32_16x16x32_bf16 v[120:123], v[32:35], v[0:3], 0
    v_mfma_f32_16x16x32_bf16 v[120:123], v[36:39], v[4:7], v[120:123]
    v_mfma_f32_16x16x32_bf16 v[120:123], v[40:43], v[8:11], v[120:123]
    v_mfma_f32_16x16x32_bf16 v[120:123], v[44:47], v[12:15], v[120:123]
    v_mov_b32 v247, s53
    v_cndmask_b32 v116, v247, v116, s[30:31]
    v_cndmask_b32 v117, v247, v117, s[32:33]
    v_cndmask_b32 v118, v247, v118, s[34:35]
    v_cndmask_b32 v119, v247, v119, s[36:37]
    s_nop 2
    v_cndmask_b32 v120, v247, v120, s[38:39]
    v_cndmask_b32 v121, v247, v121, s[40:41]
    v_cndmask_b32 v122, v247, v122, s[42:43]
    v_cndmask_b32 v123, v247, v123, s[44:45]
    v_max3_f32 v251, v116, v117, v118
    v_max3_f32 v251, v251, v119, v120
    v_max3_f32 v251, v251, v121, v122
    v_lshrrev_b32 v246, 2, v240
    s_lshl_b32 s24, s20, 7
    s_add_u32 s24, s24, 0x1000
    s_add_u32 s25, s22, 1
    s_nop 1
    s_cmp_lg_u32 s100, 0
    s_cbranch_scc1 L_polls_116
    s_mov_b32 exec_lo, 0x11
    s_mov_b32 exec_hi, 0
    s_mov_b32 s96, 0
L_poll_114:
    buffer_load_dword v247, v246, s[8:11], s24 offen sc1
    s_waitcnt vmcnt(0)
    v_cmp_gt_u32 vcc, s25, v247
    s_cbranch_vccz L_polld_115
    v_readfirstlane_b32 s97, v247
    s_nop 0
    s_sub_u32 s97, s25, s97
    s_cmp_lt_i32 s97, 3
    s_cbranch_scc1 L_near_117
    s_sleep 40
    s_cmp_lt_i32 s97, 5
    s_cbranch_scc1 L_near_117
    s_sleep 100
L_near_117:
    s_sleep 8
    s_add_u32 s96, s96, 1
    s_cmp_lt_u32 s96, 0x10000
    s_cbranch_scc1 L_poll_114
L_polld_115:
    s_mov_b64 exec, -1
L_polls_116:
    s_barrier
    buffer_load_dwordx4 v[172:175], v240, s[8:11], s49 offen
    buffer_load_dwordx4 v[176:179], v240, s[8:11], s49 offen offset:1024
    buffer_load_dwordx4 v[180:183], v240, s[8:11], s49 offen offset:2048
    buffer_load_dwordx4 v[184:187], v240, s[8:11], s49 offen offset:3072
    s_waitcnt vmcnt(0)
    ds_write_b32 v253, v173
    ds_write_b32 v253, v175 offset:64
    ds_write_b32 v253, v177 offset:1024
    ds_write_b32 v253, v179 offset:1088
    ds_write_b32 v253, v181 offset:2048
    ds_write_b32 v253, v183 offset:2112
    ds_write_b32 v253, v185 offset:3072
    ds_write_b32 v253, v187 offset:3136
    ds_read_b128 v[48:51], v254
    ds_read_b128 v[52:55], v254 offset:1024
    ds_read_b128 v[56:59], v254 offset:2048
    ds_read_b128 v[60:63], v254 offset:3072
    s_waitcnt lgkmcnt(0)
    v_mfma_f32_16x16x32_bf16 v[112:115], v[48:51], v[0:3], 0
    v_mfma_f32_16x16x32_bf16 v[112:115], v[52:55], v[4:7], v[112:115]
    v_mfma_f32_16x16x32_bf16 v[112:115], v[56:59], v[8:11], v[112:115]
    v_mfma_f32_16x16x32_bf16 v[112:115], v[60:63], v[12:15], v[112:115]
    v_mov_b32 v246, v251
    s_nop 6
    v_max3_f32 v246, v246, v123, v112
    v_max_f32 v246, v246, v113
    v_mov_b32 v247, v246
    s_nop 1
    v_permlane32_swap_b32 v247, v246
    v_max_f32 v246, v247, v246
    v_mov_b32 v247, v246
    s_nop 1
    v_permlane16_swap_b32 v247, v246
    v_max_f32 v246, v247, v246
    v_mul_f32 v248, s28, v246
    v_pk_fma_f32 v[116:117], v[116:117], s[28:29], v[248:249] op_sel_hi:[1,1,0] neg_lo:[0,0,1] neg_hi:[0,0,1]
    v_pk_fma_f32 v[118:119], v[118:119], s[28:29], v[248:249] op_sel_hi:[1,1,0] neg_lo:[0,0,1] neg_hi:[0,0,1]
    v_pk_fma_f32 v[120:121], v[120:121], s[28:29], v[248:249] op_sel_hi:[1,1,0] neg_lo:[0,0,1] neg_hi:[0,0,1]
    v_pk_fma_f32 v[122:123], v[122:123], s[28:29], v[248:249] op_sel_hi:[1,1,0] neg_lo:[0,0,1] neg_hi:[0,0,1]
    v_pk_fma_f32 v[112:113], v[112:113], s[28:29], v[248:249] op_sel_hi:[1,1,0] neg_lo:[0,0,1] neg_hi:[0,0,1]
    v_exp_f32 v116, v116
    v_exp_f32 v117, v117
    v_exp_f32 v118, v118
    v_exp_f32 v119, v119
    v_exp_f32 v120, v120
    v_exp_f32 v121, v121
    v_exp_f32 v122, v122
    v_exp_f32 v123, v123
    v_exp_f32 v112, v112
    v_exp_f32 v113, v113
    v_cvt_pk_bf16_f32 v124, v116, v117
    v_cvt_pk_bf16_f32 v125, v118, v119
    v_cvt_pk_bf16_f32 v126, v120, v121
    v_cvt_pk_bf16_f32 v127, v122, v123
    v_cvt_pk_bf16_f32 v128, v112, v113
    v_mov_b32 v129, 0
    v_mfma_f32_16x16x32_bf16 v[132:135], v[136:139], v[124:127], 0
    v_mfma_f32_16x16x32_bf16 v[140:143], v[64:67], v[124:127], 0
    v_mfma_f32_16x16x32_bf16 v[144:147], v[68:71], v[124:127], 0
    v_mfma_f32_16x16x32_bf16 v[148:151], v[72:75], v[124:127], 0
    v_mfma_f32_16x16x32_bf16 v[152:155], v[76:79], v[124:127], 0
    v_mfma_f32_16x16x32_bf16 v[156:159], v[80:83], v[124:127], 0
    v_mfma_f32_16x16x32_bf16 v[160:163], v[84:87], v[124:127], 0
    v_mfma_f32_16x16x32_bf16 v[164:167], v[88:91], v[124:127], 0
    v_mfma_f32_16x16x32_bf16 v[168:171], v[92:95], v[124:127], 0
    v_mfma_f32_16x16x16_bf16 v[132:135], v[136:137], v[128:129], v[132:135]
    v_mfma_f32_16x16x16_bf16 v[140:143], v[172:173], v[128:129], v[140:143]
    v_mfma_f32_16x16x16_bf16 v[144:147], v[174:175], v[128:129], v[144:147]
    v_mfma_f32_16x16x16_bf16 v[148:151], v[176:177], v[128:129], v[148:151]
    v_mfma_f32_16x16x16_bf16 v[152:155], v[178:179], v[128:129], v[152:155]
    v_mfma_f32_16x16x16_bf16 v[156:159], v[180:181], v[128:129], v[156:159]
    v_mfma_f32_16x16x16_bf16 v[160:163], v[182:183], v[128:129], v[160:163]
    v_mfma_f32_16x16x16_bf16 v[164:167], v[184:185], v[128:129], v[164:167]
    v_mfma_f32_16x16x16_bf16 v[168:171], v[186:187], v[128:129], v[168:171]
    v_rcp_f32 v250, v132
    s_nop 0
    v_pk_mul_f32 v[140:141], v[140:141], v[250:251] op_sel_hi:[1,0]
    v_pk_mul_f32 v[142:143], v[142:143], v[250:251] op_sel_hi:[1,0]
    v_pk_mul_f32 v[144:145], v[144:145], v[250:251] op_sel_hi:[1,0]
    v_pk_mul_f32 v[146:147], v[146:147], v[250:251] op_sel_hi:[1,0]
    v_pk_mul_f32 v[148:149], v[148:149], v[250:251] op_sel_hi:[1,0]
    v_pk_mul_f32 v[150:151], v[150:151], v[250:251] op_sel_hi:[1,0]
    v_pk_mul_f32 v[152:153], v[152:153], v[250:251] op_sel_hi:[1,0]
    v_pk_mul_f32 v[154:155], v[154:155], v[250:251] op_sel_hi:[1,0]
    v_pk_mul_f32 v[156:157], v[156:157], v[250:251] op_sel_hi:[1,0]
    v_pk_mul_f32 v[158:159], v[158:159], v[250:251] op_sel_hi:[1,0]
    v_pk_mul_f32 v[160:161], v[160:161], v[250:251] op_sel_hi:[1,0]
    v_pk_mul_f32 v[162:163], v[162:163], v[250:251] op_sel_hi:[1,0]
    v_pk_mul_f32 v[164:165], v[164:165], v[250:251] op_sel_hi:[1,0]
    v_pk_mul_f32 v[166:167], v[166:167], v[250:251] op_sel_hi:[1,0]
    v_pk_mul_f32 v[168:169], v[168:169], v[250:251] op_sel_hi:[1,0]
    v_pk_mul_f32 v[170:171], v[170:171], v[250:251] op_sel_hi:[1,0]
    v_cvt_pk_bf16_f32 v140, v140, v141
    v_cvt_pk_bf16_f32 v141, v142, v143
    v_cvt_pk_bf16_f32 v142, v144, v145
    v_cvt_pk_bf16_f32 v143, v146, v147
    v_cvt_pk_bf16_f32 v144, v148, v149
    v_cvt_pk_bf16_f32 v145, v150, v151
    v_cvt_pk_bf16_f32 v146, v152, v153
    v_cvt_pk_bf16_f32 v147, v154, v155
    v_cvt_pk_bf16_f32 v148, v156, v157
    v_cvt_pk_bf16_f32 v149, v158, v159
    v_cvt_pk_bf16_f32 v150, v160, v161
    v_cvt_pk_bf16_f32 v151, v162, v163
    v_cvt_pk_bf16_f32 v152, v164, v165
    v_cvt_pk_bf16_f32 v153, v166, v167
    v_cvt_pk_bf16_f32 v154, v168, v169
    v_cvt_pk_bf16_f32 v155, v170, v171
    ds_write_b128 v243, v[140:143]
    ds_write_b128 v243, v[144:147] offset:1024
    ds_write_b128 v243, v[148:151] offset:2048
    ds_write_b128 v243, v[152:155] offset:3072
    s_waitcnt lgkmcnt(0)
    s_barrier
    ds_read_b128 v[0:3], v244
    ds_read_b128 v[4:7], v244 offset:1024
    ds_read_b128 v[8:11], v244 offset:2048
    ds_read_b128 v[12:15], v244 offset:3072
    ds_read_b128 v[16:19], v244 offset:4096
    ds_read_b128 v[20:23], v244 offset:5120
    ds_read_b128 v[24:27], v244 offset:6144
    ds_read_b128 v[28:31], v244 offset:7168
    s_waitcnt lgkmcnt(4)
    ds_read_b128 v[32:35], v244 offset:8192
    ds_read_b128 v[36:39], v244 offset:9216
    ds_read_b128 v[40:43], v244 offset:10240
    ds_read_b128 v[44:47], v244 offset:11264
    ds_read_b128 v[48:51], v244 offset:12288
    ds_read_b128 v[52:55], v244 offset:13312
    ds_read_b128 v[56:59], v244 offset:14336
    ds_read_b128 v[60:63], v244 offset:15360
    v_xor_b32 v243, 0x4000, v243
    v_xor_b32 v244, 0x4000, v244
    s_waitcnt lgkmcnt(0)
    v_mfma_f32_16x16x32_bf16 v[172:175], a[0:3], v[0:3], 0
    v_mfma_f32_16x16x32_bf16 v[176:179], a[4:7], v[0:3], 0
    v_mfma_f32_16x16x32_bf16 v[180:183], a[8:11], v[0:3], 0
    v_mfma_f32_16x16x32_bf16 v[184:187], a[12:15], v[0:3], 0
    v_mfma_f32_16x16x32_bf16 v[188:191], a[16:19], v[0:3], 0
    v_mfma_f32_16x16x32_bf16 v[192:195], a[20:23], v[0:3], 0
    v_mfma_f32_16x16x32_bf16 v[196:199], a[24:27], v[0:3], 0
    v_mfma_f32_16x16x32_bf16 v[200:203], a[28:31], v[0:3], 0
    v_mfma_f32_16x16x32_bf16 v[172:175], a[32:35], v[4:7], v[172:175]
    v_mfma_f32_16x16x32_bf16 v[176:179], a[36:39], v[4:7], v[176:179]
    v_mfma_f32_16x16x32_bf16 v[180:183], a[40:43], v[4:7], v[180:183]
    v_mfma_f32_16x16x32_bf16 v[184:187], a[44:47], v[4:7], v[184:187]
    v_mfma_f32_16x16x32_bf16 v[188:191], a[48:51], v[4:7], v[188:191]
    v_mfma_f32_16x16x32_bf16 v[192:195], a[52:55], v[4:7], v[192:195]
    v_mfma_f32_16x16x32_bf16 v[196:199], a[56:59], v[4:7], v[196:199]
    v_mfma_f32_16x16x32_bf16 v[200:203], a[60:63], v[4:7], v[200:203]
    v_mfma_f32_16x16x32_bf16 v[172:175], a[64:67], v[8:11], v[172:175]
    v_mfma_f32_16x16x32_bf16 v[176:179], a[68:71], v[8:11], v[176:179]
    v_mfma_f32_16x16x32_bf16 v[180:183], a[72:75], v[8:11], v[180:183]
    v_mfma_f32_16x16x32_bf16 v[184:187], a[76:79], v[8:11], v[184:187]
    v_mfma_f32_16x16x32_bf16 v[188:191], a[80:83], v[8:11], v[188:191]
    v_mfma_f32_16x16x32_bf16 v[192:195], a[84:87], v[8:11], v[192:195]
    v_mfma_f32_16x16x32_bf16 v[196:199], a[88:91], v[8:11], v[196:199]
    v_mfma_f32_16x16x32_bf16 v[200:203], a[92:95], v[8:11], v[200:203]
    v_mfma_f32_16x16x32_bf16 v[172:175], a[96:99], v[12:15], v[172:175]
    v_mfma_f32_16x16x32_bf16 v[176:179], a[100:103], v[12:15], v[176:179]
    v_mfma_f32_16x16x32_bf16 v[180:183], a[104:107], v[12:15], v[180:183]
    v_mfma_f32_16x16x32_bf16 v[184:187], a[108:111], v[12:15], v[184:187]
    v_mfma_f32_16x16x32_bf16 v[188:191], a[112:115], v[12:15], v[188:191]
    v_mfma_f32_16x16x32_bf16 v[192:195], a[116:119], v[12:15], v[192:195]
    v_mfma_f32_16x16x32_bf16 v[196:199], a[120:123], v[12:15], v[196:199]
    v_mfma_f32_16x16x32_bf16 v[200:203], a[124:127], v[12:15], v[200:203]
    v_mfma_f32_16x16x32_bf16 v[172:175], a[128:131], v[32:35], v[172:175]
    v_mfma_f32_16x16x32_bf16 v[176:179], a[132:135], v[32:35], v[176:179]
    v_mfma_f32_16x16x32_bf16 v[180:183], a[136:139], v[32:35], v[180:183]
    v_mfma_f32_16x16x32_bf16 v[184:187], a[140:143], v[32:35], v[184:187]
    v_mfma_f32_16x16x32_bf16 v[188:191], a[144:147], v[32:35], v[188:191]
    v_mfma_f32_16x16x32_bf16 v[192:195], a[148:151], v[32:35], v[192:195]
    v_mfma_f32_16x16x32_bf16 v[196:199], a[152:155], v[32:35], v[196:199]
    v_mfma_f32_16x16x32_bf16 v[200:203], a[156:159], v[32:35], v[200:203]
    v_mfma_f32_16x16x32_bf16 v[172:175], a[160:163], v[36:39], v[172:175]
    v_mfma_f32_16x16x32_bf16 v[176:179], a[164:167], v[36:39], v[176:179]
    v_mfma_f32_16x16x32_bf16 v[180:183], a[168:171], v[36:39], v[180:183]
    v_mfma_f32_16x16x32_bf16 v[184:187], a[172:175], v[36:39], v[184:187]
    v_mfma_f32_16x16x32_bf16 v[188:191], a[176:179], v[36:39], v[188:191]
    v_mfma_f32_16x16x32_bf16 v[192:195], a[180:183], v[36:39], v[192:195]
    v_mfma_f32_16x16x32_bf16 v[196:199], a[184:187], v[36:39], v[196:199]
    v_mfma_f32_16x16x32_bf16 v[200:203], a[188:191], v[36:39], v[200:203]
    v_mfma_f32_16x16x32_bf16 v[172:175], a[192:195], v[40:43], v[172:175]
    v_mfma_f32_16x16x32_bf16 v[176:179], a[196:199], v[40:43], v[176:179]
    v_mfma_f32_16x16x32_bf16 v[180:183], a[200:203], v[40:43], v[180:183]
    v_mfma_f32_16x16x32_bf16 v[184:187], a[204:207], v[40:43], v[184:187]
    v_mfma_f32_16x16x32_bf16 v[188:191], a[208:211], v[40:43], v[188:191]
    v_mfma_f32_16x16x32_bf16 v[192:195], a[212:215], v[40:43], v[192:195]
    v_mfma_f32_16x16x32_bf16 v[196:199], a[216:219], v[40:43], v[196:199]
    v_mfma_f32_16x16x32_bf16 v[200:203], a[220:223], v[40:43], v[200:203]
    v_mfma_f32_16x16x32_bf16 v[172:175], a[224:227], v[44:47], v[172:175]
    v_mfma_f32_16x16x32_bf16 v[176:179], a[228:231], v[44:47], v[176:179]
    v_mfma_f32_16x16x32_bf16 v[180:183], a[232:235], v[44:47], v[180:183]
    v_mfma_f32_16x16x32_bf16 v[184:187], a[236:239], v[44:47], v[184:187]
    v_mfma_f32_16x16x32_bf16 v[188:191], a[240:243], v[44:47], v[188:191]
    v_mfma_f32_16x16x32_bf16 v[192:195], a[244:247], v[44:47], v[192:195]
    v_mfma_f32_16x16x32_bf16 v[196:199], a[248:251], v[44:47], v[196:199]
    v_mfma_f32_16x16x32_bf16 v[200:203], a[252:255], v[44:47], v[200:203]
    v_mfma_f32_16x16x32_bf16 v[204:207], a[0:3], v[16:19], 0
    v_mfma_f32_16x16x32_bf16 v[208:211], a[4:7], v[16:19], 0
    v_mfma_f32_16x16x32_bf16 v[212:215], a[8:11], v[16:19], 0
    v_mfma_f32_16x16x32_bf16 v[216:219], a[12:15], v[16:19], 0
    v_mfma_f32_16x16x32_bf16 v[220:223], a[16:19], v[16:19], 0
    v_mfma_f32_16x16x32_bf16 v[224:227], a[20:23], v[16:19], 0
    v_mfma_f32_16x16x32_bf16 v[228:231], a[24:27], v[16:19], 0
    v_mfma_f32_16x16x32_bf16 v[232:235], a[28:31], v[16:19], 0
    v_cvt_pk_bf16_f32 v140, v172, v173
    v_cvt_pk_bf16_f32 v141, v174, v175
    v_cvt_pk_bf16_f32 v142, v176, v177
    v_cvt_pk_bf16_f32 v143, v178, v179
    s_add_u32 s24, s51, 0
    buffer_store_dwordx4 v[140:143], v242, s[8:11], s24 offen sc1
    v_mfma_f32_16x16x32_bf16 v[204:207], a[32:35], v[20:23], v[204:207]
    v_mfma_f32_16x16x32_bf16 v[208:211], a[36:39], v[20:23], v[208:211]
    v_mfma_f32_16x16x32_bf16 v[212:215], a[40:43], v[20:23], v[212:215]
    v_mfma_f32_16x16x32_bf16 v[216:219], a[44:47], v[20:23], v[216:219]
    v_mfma_f32_16x16x32_bf16 v[220:223], a[48:51], v[20:23], v[220:223]
    v_mfma_f32_16x16x32_bf16 v[224:227], a[52:55], v[20:23], v[224:227]
    v_mfma_f32_16x16x32_bf16 v[228:231], a[56:59], v[20:23], v[228:231]
    v_mfma_f32_16x16x32_bf16 v[232:235], a[60:63], v[20:23], v[232:235]
    v_cvt_pk_bf16_f32 v144, v180, v181
    v_cvt_pk_bf16_f32 v145, v182, v183
    v_cvt_pk_bf16_f32 v146, v184, v185
    v_cvt_pk_bf16_f32 v147, v186, v187
    buffer_store_dwordx4 v[144:147], v242, s[8:11], s24 offen offset:64 sc1
    v_mfma_f32_16x16x32_bf16 v[204:207], a[64:67], v[24:27], v[204:207]
    v_mfma_f32_16x16x32_bf16 v[208:211], a[68:71], v[24:27], v[208:211]
    v_mfma_f32_16x16x32_bf16 v[212:215], a[72:75], v[24:27], v[212:215]
    v_mfma_f32_16x16x32_bf16 v[216:219], a[76:79], v[24:27], v[216:219]
    v_mfma_f32_16x16x32_bf16 v[220:223], a[80:83], v[24:27], v[220:223]
    v_mfma_f32_16x16x32_bf16 v[224:227], a[84:87], v[24:27], v[224:227]
    v_mfma_f32_16x16x32_bf16 v[228:231], a[88:91], v[24:27], v[228:231]
    v_mfma_f32_16x16x32_bf16 v[232:235], a[92:95], v[24:27], v[232:235]
    v_cvt_pk_bf16_f32 v148, v188, v189
    v_cvt_pk_bf16_f32 v149, v190, v191
    v_cvt_pk_bf16_f32 v150, v192, v193
    v_cvt_pk_bf16_f32 v151, v194, v195
    buffer_store_dwordx4 v[148:151], v242, s[8:11], s24 offen offset:128 sc1
    v_mfma_f32_16x16x32_bf16 v[204:207], a[96:99], v[28:31], v[204:207]
    v_mfma_f32_16x16x32_bf16 v[208:211], a[100:103], v[28:31], v[208:211]
    v_mfma_f32_16x16x32_bf16 v[212:215], a[104:107], v[28:31], v[212:215]
    v_mfma_f32_16x16x32_bf16 v[216:219], a[108:111], v[28:31], v[216:219]
    v_mfma_f32_16x16x32_bf16 v[220:223], a[112:115], v[28:31], v[220:223]
    v_mfma_f32_16x16x32_bf16 v[224:227], a[116:119], v[28:31], v[224:227]
    v_mfma_f32_16x16x32_bf16 v[228:231], a[120:123], v[28:31], v[228:231]
    v_mfma_f32_16x16x32_bf16 v[232:235], a[124:127], v[28:31], v[232:235]
    v_cvt_pk_bf16_f32 v152, v196, v197
    v_cvt_pk_bf16_f32 v153, v198, v199
    v_cvt_pk_bf16_f32 v154, v200, v201
    v_cvt_pk_bf16_f32 v155, v202, v203
    buffer_store_dwordx4 v[152:155], v242, s[8:11], s24 offen offset:192 sc1
    v_mfma_f32_16x16x32_bf16 v[204:207], a[128:131], v[48:51], v[204:207]
    v_mfma_f32_16x16x32_bf16 v[208:211], a[132:135], v[48:51], v[208:211]
    v_mfma_f32_16x16x32_bf16 v[212:215], a[136:139], v[48:51], v[212:215]
    v_mfma_f32_16x16x32_bf16 v[216:219], a[140:143], v[48:51], v[216:219]
    v_mfma_f32_16x16x32_bf16 v[220:223], a[144:147], v[48:51], v[220:223]
    v_mfma_f32_16x16x32_bf16 v[224:227], a[148:151], v[48:51], v[224:227]
    v_mfma_f32_16x16x32_bf16 v[228:231], a[152:155], v[48:51], v[228:231]
    v_mfma_f32_16x16x32_bf16 v[232:235], a[156:159], v[48:51], v[232:235]
    v_mfma_f32_16x16x32_bf16 v[204:207], a[160:163], v[52:55], v[204:207]
    v_mfma_f32_16x16x32_bf16 v[208:211], a[164:167], v[52:55], v[208:211]
    v_mfma_f32_16x16x32_bf16 v[212:215], a[168:171], v[52:55], v[212:215]
    v_mfma_f32_16x16x32_bf16 v[216:219], a[172:175], v[52:55], v[216:219]
    v_mfma_f32_16x16x32_bf16 v[220:223], a[176:179], v[52:55], v[220:223]
    v_mfma_f32_16x16x32_bf16 v[224:227], a[180:183], v[52:55], v[224:227]
    v_mfma_f32_16x16x32_bf16 v[228:231], a[184:187], v[52:55], v[228:231]
    v_mfma_f32_16x16x32_bf16 v[232:235], a[188:191], v[52:55], v[232:235]
    v_mfma_f32_16x16x32_bf16 v[204:207], a[192:195], v[56:59], v[204:207]
    v_mfma_f32_16x16x32_bf16 v[208:211], a[196:199], v[56:59], v[208:211]
    v_mfma_f32_16x16x32_bf16 v[212:215], a[200:203], v[56:59], v[212:215]
    v_mfma_f32_16x16x32_bf16 v[216:219], a[204:207], v[56:59], v[216:219]
    v_mfma_f32_16x16x32_bf16 v[220:223], a[208:211], v[56:59], v[220:223]
    v_mfma_f32_16x16x32_bf16 v[224:227], a[212:215], v[56:59], v[224:227]
    v_mfma_f32_16x16x32_bf16 v[228:231], a[216:219], v[56:59], v[228:231]
    v_mfma_f32_16x16x32_bf16 v[232:235], a[220:223], v[56:59], v[232:235]
    v_mfma_f32_16x16x32_bf16 v[204:207], a[224:227], v[60:63], v[204:207]
    v_mfma_f32_16x16x32_bf16 v[208:211], a[228:231], v[60:63], v[208:211]
    v_mfma_f32_16x16x32_bf16 v[212:215], a[232:235], v[60:63], v[212:215]
    v_mfma_f32_16x16x32_bf16 v[216:219], a[236:239], v[60:63], v[216:219]
    v_mfma_f32_16x16x32_bf16 v[220:223], a[240:243], v[60:63], v[220:223]
    v_mfma_f32_16x16x32_bf16 v[224:227], a[244:247], v[60:63], v[224:227]
    v_mfma_f32_16x16x32_bf16 v[228:231], a[248:251], v[60:63], v[228:231]
    v_mfma_f32_16x16x32_bf16 v[232:235], a[252:255], v[60:63], v[232:235]
    v_cvt_pk_bf16_f32 v140, v204, v205
    v_cvt_pk_bf16_f32 v141, v206, v207
    v_cvt_pk_bf16_f32 v142, v208, v209
    v_cvt_pk_bf16_f32 v143, v210, v211
    s_add_u32 s24, s51, 16384
    buffer_store_dwordx4 v[140:143], v242, s[8:11], s24 offen sc1
    v_cvt_pk_bf16_f32 v144, v212, v213
    v_cvt_pk_bf16_f32 v145, v214, v215
    v_cvt_pk_bf16_f32 v146, v216, v217
    v_cvt_pk_bf16_f32 v147, v218, v219
    buffer_store_dwordx4 v[144:147], v242, s[8:11], s24 offen offset:64 sc1
    v_cvt_pk_bf16_f32 v148, v220, v221
    v_cvt_pk_bf16_f32 v149, v222, v223
    v_cvt_pk_bf16_f32 v150, v224, v225
    v_cvt_pk_bf16_f32 v151, v226, v227
    buffer_store_dwordx4 v[148:151], v242, s[8:11], s24 offen offset:128 sc1
    v_cvt_pk_bf16_f32 v152, v228, v229
    v_cvt_pk_bf16_f32 v153, v230, v231
    v_cvt_pk_bf16_f32 v154, v232, v233
    v_cvt_pk_bf16_f32 v155, v234, v235
    buffer_store_dwordx4 v[152:155], v242, s[8:11], s24 offen offset:192 sc1
    s_waitcnt vmcnt(0)
    s_barrier
    s_lshl_b32 s25, s22, 6
    s_add_u32 s25, s25, 0x4000
    s_lshl_b32 s24, s20, 2
    s_add_u32 s24, s24, s25
    s_cmp_lg_u32 s100, 0
    s_cbranch_scc1 L_flag_118
    v_mov_b32 v246, 1
    s_mov_b64 exec, 1
    buffer_store_dword v246, off, s[8:11], s24 sc1
    s_mov_b64 exec, -1
L_flag_118:
    v_lshrrev_b32 v246, 2, v240
    s_cmp_lg_u32 s100, 0
    s_cbranch_scc1 L_polls_121
    s_mov_b32 exec_lo, 0xffff
    s_mov_b32 exec_hi, 0
    s_mov_b32 s96, 0
L_poll_119:
    buffer_load_dword v247, v246, s[8:11], s25 offen sc1
    s_waitcnt vmcnt(0)
    v_cmp_gt_u32 vcc, 1, v247
    s_cbranch_vccz L_polld_120
    s_sleep 2
    s_add_u32 s96, s96, 1
    s_cmp_lt_u32 s96, 0x10000
    s_cbranch_scc1 L_poll_119
L_polld_120:
    s_mov_b64 exec, -1
L_polls_121:
    s_barrier
    s_cmp_ge_u32 s100, 2
    s_cbranch_scc1 L_nofin_122
    s_lshl_b32 s60, s22, 5
    s_lshl_b32 s24, s20, 1
    s_add_u32 s60, s60, s24
    s_add_u32 s60, s60, s100
    s_lshr_b32 s62, s60, 5
    s_lshl_b32 s62, s62, 19
    s_and_b32 s63, s60, 31
    s_lshl_b32 s63, s63, 10
    s_add_u32 s62, s62, s63
    s_add_u32 s62, s62, 0x4000000
    s_lshl_b32 s64, s60, 10
    buffer_load_dwordx2 v[64:65], v252, s[12:15], s64 offen
    buffer_load_dwordx2 v[66:67], v252, s[12:15], s64 offen offset:32
    buffer_load_dwordx4 v[0:3], v240, s[8:11], s62 offen
    s_add_u32 s62, s62, 32768
    buffer_load_dwordx4 v[4:7], v240, s[8:11], s62 offen
    s_add_u32 s62, s62, 32768
    buffer_load_dwordx4 v[8:11], v240, s[8:11], s62 offen
    s_add_u32 s62, s62, 32768
    buffer_load_dwordx4 v[12:15], v240, s[8:11], s62 offen
    s_add_u32 s62, s62, 32768
    buffer_load_dwordx4 v[16:19], v240, s[8:11], s62 offen
    s_add_u32 s62, s62, 32768
    buffer_load_dwordx4 v[20:23], v240, s[8:11], s62 offen
    s_add_u32 s62, s62, 32768
    buffer_load_dwordx4 v[24:27], v240, s[8:11], s62 offen
    s_add_u32 s62, s62, 32768
    buffer_load_dwordx4 v[28:31], v240, s[8:11], s62 offen
    s_add_u32 s62, s62, 32768
    buffer_load_dwordx4 v[32:35], v240, s[8:11], s62 offen
    s_add_u32 s62, s62, 32768
    buffer_load_dwordx4 v[36:39], v240, s[8:11], s62 offen
    s_add_u32 s62, s62, 32768
    buffer_load_dwordx4 v[40:43], v240, s[8:11], s62 offen
    s_add_u32 s62, s62, 32768
    buffer_load_dwordx4 v[44:47], v240, s[8:11], s62 offen
    s_add_u32 s62, s62, 32768
    buffer_load_dwordx4 v[48:51], v240, s[8:11], s62 offen
    s_add_u32 s62, s62, 32768
    buffer_load_dwordx4 v[52:55], v240, s[8:11], s62 offen
    s_add_u32 s62, s62, 32768
    buffer_load_dwordx4 v[56:59], v240, s[8:11], s62 offen
    s_add_u32 s62, s62, 32768
    buffer_load_dwordx4 v[60:63], v240, s[8:11], s62 offen
    v_mov_b32 v68, 0
    v_mov_b32 v69, 0
    v_mov_b32 v70, 0
    v_mov_b32 v71, 0
    v_mov_b32 v72, 0
    v_mov_b32 v73, 0
    v_mov_b32 v74, 0
    v_mov_b32 v75, 0
    s_waitcnt vmcnt(15)
    v_dot2_f32_bf16 v68, v0, s65, v68
    v_dot2_f32_bf16 v69, v0, s66, v69
    v_dot2_f32_bf16 v70, v1, s65, v70
    v_dot2_f32_bf16 v71, v1, s66, v71
    v_dot2_f32_bf16 v72, v2, s65, v72
    v_dot2_f32_bf16 v73, v2, s66, v73
    v_dot2_f32_bf16 v74, v3, s65, v74
    v_dot2_f32_bf16 v75, v3, s66, v75
    s_waitcnt vmcnt(14)
    v_dot2_f32_bf16 v68, v4, s65, v68
    v_dot2_f32_bf16 v69, v4, s66, v69
    v_dot2_f32_bf16 v70, v5, s65, v70
    v_dot2_f32_bf16 v71, v5, s66, v71
    v_dot2_f32_bf16 v72, v6, s65, v72
    v_dot2_f32_bf16 v73, v6, s66, v73
    v_dot2_f32_bf16 v74, v7, s65, v74
    v_dot2_f32_bf16 v75, v7, s66, v75
    s_waitcnt vmcnt(13)
    v_dot2_f32_bf16 v68, v8, s65, v68
    v_dot2_f32_bf16 v69, v8, s66, v69
    v_dot2_f32_bf16 v70, v9, s65, v70
    v_dot2_f32_bf16 v71, v9, s66, v71
    v_dot2_f32_bf16 v72, v10, s65, v72
    v_dot2_f32_bf16 v73, v10, s66, v73
    v_dot2_f32_bf16 v74, v11, s65, v74
    v_dot2_f32_bf16 v75, v11, s66, v75
    s_waitcnt vmcnt(12)
    v_dot2_f32_bf16 v68, v12, s65, v68
    v_dot2_f32_bf16 v69, v12, s66, v69
    v_dot2_f32_bf16 v70, v13, s65, v70
    v_dot2_f32_bf16 v71, v13, s66, v71
    v_dot2_f32_bf16 v72, v14, s65, v72
    v_dot2_f32_bf16 v73, v14, s66, v73
    v_dot2_f32_bf16 v74, v15, s65, v74
    v_dot2_f32_bf16 v75, v15, s66, v75
    s_waitcnt vmcnt(11)
    v_dot2_f32_bf16 v68, v16, s65, v68
    v_dot2_f32_bf16 v69, v16, s66, v69
    v_dot2_f32_bf16 v70, v17, s65, v70
    v_dot2_f32_bf16 v71, v17, s66, v71
    v_dot2_f32_bf16 v72, v18, s65, v72
    v_dot2_f32_bf16 v73, v18, s66, v73
    v_dot2_f32_bf16 v74, v19, s65, v74
    v_dot2_f32_bf16 v75, v19, s66, v75
    s_waitcnt vmcnt(10)
    v_dot2_f32_bf16 v68, v20, s65, v68
    v_dot2_f32_bf16 v69, v20, s66, v69
    v_dot2_f32_bf16 v70, v21, s65, v70
    v_dot2_f32_bf16 v71, v21, s66, v71
    v_dot2_f32_bf16 v72, v22, s65, v72
    v_dot2_f32_bf16 v73, v22, s66, v73
    v_dot2_f32_bf16 v74, v23, s65, v74
    v_dot2_f32_bf16 v75, v23, s66, v75
    s_waitcnt vmcnt(9)
    v_dot2_f32_bf16 v68, v24, s65, v68
    v_dot2_f32_bf16 v69, v24, s66, v69
    v_dot2_f32_bf16 v70, v25, s65, v70
    v_dot2_f32_bf16 v71, v25, s66, v71
    v_dot2_f32_bf16 v72, v26, s65, v72
    v_dot2_f32_bf16 v73, v26, s66, v73
    v_dot2_f32_bf16 v74, v27, s65, v74
    v_dot2_f32_bf16 v75, v27, s66, v75
    s_waitcnt vmcnt(8)
    v_dot2_f32_bf16 v68, v28, s65, v68
    v_dot2_f32_bf16 v69, v28, s66, v69
    v_dot2_f32_bf16 v70, v29, s65, v70
    v_dot2_f32_bf16 v71, v29, s66, v71
    v_dot2_f32_bf16 v72, v30, s65, v72
    v_dot2_f32_bf16 v73, v30, s66, v73
    v_dot2_f32_bf16 v74, v31, s65, v74
    v_dot2_f32_bf16 v75, v31, s66, v75
    s_waitcnt vmcnt(7)
    v_dot2_f32_bf16 v68, v32, s65, v68
    v_dot2_f32_bf16 v69, v32, s66, v69
    v_dot2_f32_bf16 v70, v33, s65, v70
    v_dot2_f32_bf16 v71, v33, s66, v71
    v_dot2_f32_bf16 v72, v34, s65, v72
    v_dot2_f32_bf16 v73, v34, s66, v73
    v_dot2_f32_bf16 v74, v35, s65, v74
    v_dot2_f32_bf16 v75, v35, s66, v75
    s_waitcnt vmcnt(6)
    v_dot2_f32_bf16 v68, v36, s65, v68
    v_dot2_f32_bf16 v69, v36, s66, v69
    v_dot2_f32_bf16 v70, v37, s65, v70
    v_dot2_f32_bf16 v71, v37, s66, v71
    v_dot2_f32_bf16 v72, v38, s65, v72
    v_dot2_f32_bf16 v73, v38, s66, v73
    v_dot2_f32_bf16 v74, v39, s65, v74
    v_dot2_f32_bf16 v75, v39, s66, v75
    s_waitcnt vmcnt(5)
    v_dot2_f32_bf16 v68, v40, s65, v68
    v_dot2_f32_bf16 v69, v40, s66, v69
    v_dot2_f32_bf16 v70, v41, s65, v70
    v_dot2_f32_bf16 v71, v41, s66, v71
    v_dot2_f32_bf16 v72, v42, s65, v72
    v_dot2_f32_bf16 v73, v42, s66, v73
    v_dot2_f32_bf16 v74, v43, s65, v74
    v_dot2_f32_bf16 v75, v43, s66, v75
    s_waitcnt vmcnt(4)
    v_dot2_f32_bf16 v68, v44, s65, v68
    v_dot2_f32_bf16 v69, v44, s66, v69
    v_dot2_f32_bf16 v70, v45, s65, v70
    v_dot2_f32_bf16 v71, v45, s66, v71
    v_dot2_f32_bf16 v72, v46, s65, v72
    v_dot2_f32_bf16 v73, v46, s66, v73
    v_dot2_f32_bf16 v74, v47, s65, v74
    v_dot2_f32_bf16 v75, v47, s66, v75
    s_waitcnt vmcnt(3)
    v_dot2_f32_bf16 v68, v48, s65, v68
    v_dot2_f32_bf16 v69, v48, s66, v69
    v_dot2_f32_bf16 v70, v49, s65, v70
    v_dot2_f32_bf16 v71, v49, s66, v71
    v_dot2_f32_bf16 v72, v50, s65, v72
    v_dot2_f32_bf16 v73, v50, s66, v73
    v_dot2_f32_bf16 v74, v51, s65, v74
    v_dot2_f32_bf16 v75, v51, s66, v75
    s_waitcnt vmcnt(2)
    v_dot2_f32_bf16 v68, v52, s65, v68
    v_dot2_f32_bf16 v69, v52, s66, v69
    v_dot2_f32_bf16 v70, v53, s65, v70
    v_dot2_f32_bf16 v71, v53, s66, v71
    v_dot2_f32_bf16 v72, v54, s65, v72
    v_dot2_f32_bf16 v73, v54, s66, v73
    v_dot2_f32_bf16 v74, v55, s65, v74
    v_dot2_f32_bf16 v75, v55, s66, v75
    s_waitcnt vmcnt(1)
    v_dot2_f32_bf16 v68, v56, s65, v68
    v_dot2_f32_bf16 v69, v56, s66, v69
    v_dot2_f32_bf16 v70, v57, s65, v70
    v_dot2_f32_bf16 v71, v57, s66, v71
    v_dot2_f32_bf16 v72, v58, s65, v72
    v_dot2_f32_bf16 v73, v58, s66, v73
    v_dot2_f32_bf16 v74, v59, s65, v74
    v_dot2_f32_bf16 v75, v59, s66, v75
    s_waitcnt vmcnt(0)
    v_dot2_f32_bf16 v68, v60, s65, v68
    v_dot2_f32_bf16 v69, v60, s66, v69
    v_dot2_f32_bf16 v70, v61, s65, v70
    v_dot2_f32_bf16 v71, v61, s66, v71
    v_dot2_f32_bf16 v72, v62, s65, v72
    v_dot2_f32_bf16 v73, v62, s66, v73
    v_dot2_f32_bf16 v74, v63, s65, v74
    v_dot2_f32_bf16 v75, v63, s66, v75
    v_cvt_pk_bf16_f32 v0, v68, v69
    v_cvt_pk_bf16_f32 v1, v70, v71
    v_cvt_pk_bf16_f32 v2, v72, v73
    v_cvt_pk_bf16_f32 v3, v74, v75
    v_lshlrev_b32 v68, 16, v0
    v_and_b32 v69, 0xffff0000, v0
    v_lshlrev_b32 v76, 16, v64
    v_and_b32 v77, 0xffff0000, v64
    v_lshlrev_b32 v70, 16, v1
    v_and_b32 v71, 0xffff0000, v1
    v_lshlrev_b32 v78, 16, v65
    v_and_b32 v79, 0xffff0000, v65
    v_lshlrev_b32 v72, 16, v2
    v_and_b32 v73, 0xffff0000, v2
    v_lshlrev_b32 v80, 16, v66
    v_and_b32 v81, 0xffff0000, v66
    v_lshlrev_b32 v74, 16, v3
    v_and_b32 v75, 0xffff0000, v3
    v_lshlrev_b32 v82, 16, v67
    v_and_b32 v83, 0xffff0000, v67
    v_pk_add_f32 v[68:69], v[68:69], v[76:77]
    v_pk_add_f32 v[70:71], v[70:71], v[78:79]
    v_pk_add_f32 v[72:73], v[72:73], v[80:81]
    v_pk_add_f32 v[74:75], v[74:75], v[82:83]
    v_cvt_pk_bf16_f32 v4, v68, v69
    v_cvt_pk_bf16_f32 v5, v70, v71
    v_cvt_pk_bf16_f32 v6, v72, v73
    v_cvt_pk_bf16_f32 v7, v74, v75
    v_lshlrev_b32 v68, 16, v4
    v_and_b32 v69, 0xffff0000, v4
    v_lshlrev_b32 v70, 16, v5
    v_and_b32 v71, 0xffff0000, v5
    v_lshlrev_b32 v72, 16, v6
    v_and_b32 v73, 0xffff0000, v6
    v_lshlrev_b32 v74, 16, v7
    v_and_b32 v75, 0xffff0000, v7
    s_add_u32 s62, s64, 0x6000000
    buffer_store_dwordx2 v[4:5], v252, s[8:11], s62 offen sc1
    buffer_store_dwordx2 v[6:7], v252, s[8:11], s62 offen offset:32 sc1
    v_add_f32 v84, v68, v69
    v_add_f32 v84, v84, v70
    v_add_f32 v84, v84, v71
    v_add_f32 v84, v84, v72
    v_add_f32 v84, v84, v73
    v_add_f32 v84, v84, v74
    v_add_f32 v84, v84, v75
    s_nop 1
    v_add_f32_dpp v84, v84, v84 row_ror:1 row_mask:0xf bank_mask:0xf
    s_nop 1
    v_add_f32_dpp v84, v84, v84 row_ror:2 row_mask:0xf bank_mask:0xf
    s_nop 1
    v_add_f32_dpp v84, v84, v84 row_ror:4 row_mask:0xf bank_mask:0xf
    s_nop 1
    v_add_f32_dpp v84, v84, v84 row_ror:8 row_mask:0xf bank_mask:0xf
    v_mov_b32 v85, v84
    s_nop 1
    v_permlane32_swap_b32 v85, v84
    v_add_f32 v84, v85, v84
    v_mov_b32 v85, v84
    s_nop 1
    v_permlane16_swap_b32 v85, v84
    v_add_f32 v84, v85, v84
    v_mul_f32 v84, 0x3b000000, v84
    v_cvt_pk_bf16_f32 v86, v84, v84
    v_and_b32 v86, 0xffff0000, v86
    v_sub_f32 v87, v84, v86
    v_sub_f32 v76, v68, v86
    v_sub_f32 v77, v69, v86
    v_sub_f32 v78, v70, v86
    v_sub_f32 v79, v71, v86
    v_sub_f32 v80, v72, v86
    v_sub_f32 v81, v73, v86
    v_sub_f32 v82, v74, v86
    v_sub_f32 v83, v75, v86
    v_mul_f32 v100, v76, v76
    v_fmac_f32 v100, v77, v77
    v_fmac_f32 v100, v78, v78
    v_fmac_f32 v100, v79, v79
    v_fmac_f32 v100, v80, v80
    v_fmac_f32 v100, v81, v81
    v_fmac_f32 v100, v82, v82
    v_fmac_f32 v100, v83, v83
    s_nop 1
    v_add_f32_dpp v100, v100, v100 row_ror:1 row_mask:0xf bank_mask:0xf
    s_nop 1
    v_add_f32_dpp v100, v100, v100 row_ror:2 row_mask:0xf bank_mask:0xf
    s_nop 1
    v_add_f32_dpp v100, v100, v100 row_ror:4 row_mask:0xf bank_mask:0xf
    s_nop 1
    v_add_f32_dpp v100, v100, v100 row_ror:8 row_mask:0xf bank_mask:0xf
    v_mov_b32 v85, v100
    s_nop 1
    v_permlane32_swap_b32 v85, v100
    v_add_f32 v100, v85, v100
    v_mov_b32 v85, v100
    s_nop 1
    v_permlane16_swap_b32 v85, v100
    v_add_f32 v100, v85, v100
    v_mul_f32 v85, v87, v87
    v_mul_f32 v100, 0x3b000000, v100
    v_sub_f32 v100, v100, v85
    v_max_f32 v100, 0, v100
    v_cvt_pk_bf16_f32 v100, v100, v100
    v_and_b32 v100, 0xffff0000, v100
    v_add_f32 v100, 0x3727c5ac, v100
    v_cvt_pk_bf16_f32 v100, v100, v100
    v_and_b32 v100, 0xffff0000, v100
    v_sqrt_f32 v100, v100
    s_nop 0
    v_cvt_pk_bf16_f32 v100, v100, v100
    v_and_b32 v100, 0xffff0000, v100
    v_rcp_f32 v100, v100
    v_cvt_pk_bf16_f32 v8, v76, v77
    v_cvt_pk_bf16_f32 v9, v78, v79
    v_cvt_pk_bf16_f32 v10, v80, v81
    v_cvt_pk_bf16_f32 v11, v82, v83
    v_lshlrev_b32 v76, 16, v8
    v_and_b32 v77, 0xffff0000, v8
    v_lshlrev_b32 v78, 16, v9
    v_and_b32 v79, 0xffff0000, v9
    v_lshlrev_b32 v80, 16, v10
    v_and_b32 v81, 0xffff0000, v10
    v_lshlrev_b32 v82, 16, v11
    v_and_b32 v83, 0xffff0000, v11
    v_mul_f32 v76, v100, v76
    v_mul_f32 v77, v100, v77
    v_mul_f32 v78, v100, v78
    v_mul_f32 v79, v100, v79
    v_mul_f32 v80, v100, v80
    v_mul_f32 v81, v100, v81
    v_mul_f32 v82, v100, v82
    v_mul_f32 v83, v100, v83
    v_cvt_pk_bf16_f32 v8, v76, v77
    v_cvt_pk_bf16_f32 v9, v78, v79
    v_cvt_pk_bf16_f32 v10, v80, v81
    v_cvt_pk_bf16_f32 v11, v82, v83
    v_lshlrev_b32 v76, 16, v8
    v_and_b32 v77, 0xffff0000, v8
    v_lshlrev_b32 v78, 16, v9
    v_and_b32 v79, 0xffff0000, v9
    v_lshlrev_b32 v80, 16, v10
    v_and_b32 v81, 0xffff0000, v10
    v_lshlrev_b32 v82, 16, v11
    v_and_b32 v83, 0xffff0000, v11
    s_add_u32 s62, s64, 0x6200000
    buffer_store_dwordx2 v[8:9], v252, s[8:11], s62 offen sc1
    buffer_store_dwordx2 v[10:11], v252, s[8:11], s62 offen offset:32 sc1
    v_pk_add_f32 v[68:69], v[68:69], v[76:77]
    v_pk_add_f32 v[70:71], v[70:71], v[78:79]
    v_pk_add_f32 v[72:73], v[72:73], v[80:81]
    v_pk_add_f32 v[74:75], v[74:75], v[82:83]
    v_cvt_pk_bf16_f32 v12, v68, v69
    v_cvt_pk_bf16_f32 v13, v70, v71
    v_cvt_pk_bf16_f32 v14, v72, v73
    v_cvt_pk_bf16_f32 v15, v74, v75
    buffer_store_dwordx2 v[12:13], v252, s[16:19], s64 offen sc1
    buffer_store_dwordx2 v[14:15], v252, s[16:19], s64 offen offset:32 sc1
    v_lshlrev_b32 v88, 16, v236
    v_and_b32 v89, 0xffff0000, v236
    v_lshlrev_b32 v90, 16, v237
    v_and_b32 v91, 0xffff0000, v237
    v_lshlrev_b32 v92, 16, v238
    v_and_b32 v93, 0xffff0000, v238
    v_lshlrev_b32 v94, 16, v239
    v_and_b32 v95, 0xffff0000, v239
    v_mul_f32 v84, v76, v88
    v_fmac_f32 v84, v77, v89
    v_fmac_f32 v84, v78, v90
    v_fmac_f32 v84, v79, v91
    v_fmac_f32 v84, v80, v92
    v_fmac_f32 v84, v81, v93
    v_fmac_f32 v84, v82, v94
    v_fmac_f32 v84, v83, v95
    s_nop 1
    v_add_f32_dpp v84, v84, v84 row_ror:1 row_mask:0xf bank_mask:0xf
    s_nop 1
    v_add_f32_dpp v84, v84, v84 row_ror:2 row_mask:0xf bank_mask:0xf
    s_nop 1
    v_add_f32_dpp v84, v84, v84 row_ror:4 row_mask:0xf bank_mask:0xf
    s_nop 1
    v_add_f32_dpp v84, v84, v84 row_ror:8 row_mask:0xf bank_mask:0xf
    v_mov_b32 v85, v84
    s_nop 1
    v_permlane32_swap_b32 v85, v84
    v_add_f32 v84, v85, v84
    v_mov_b32 v85, v84
    s_nop 1
    v_permlane16_swap_b32 v85, v84
    v_add_f32 v84, v85, v84
    v_cvt_pk_bf16_f32 v84, v84, v84
    v_and_b32 v84, 0xffff0000, v84
    v_ashrrev_i32 v85, 31, v84
    v_or_b32 v85, 0x80000000, v85
    v_xor_b32 v84, v84, v85
    v_and_b32 v84, 0xffff0000, v84
    s_sub_u32 s62, 0x87ff, s60
    v_or_b32 v84, s62, v84
    s_waitcnt vmcnt(0)
    s_lshl_b32 s62, s60, 2
    s_add_u32 s62, s62, 0x6000
    s_mov_b64 exec, 1
    buffer_store_dword v84, off, s[8:11], s62 sc1
    s_mov_b64 exec, -1
L_nofin_122:
    s_add_u32 s80, s80, 4
    s_add_u32 s22, s22, s23
    s_branch L_p2_seg
L_p2_end:
    s_cmp_ge_u32 s67, 56
    s_cbranch_scc1 L_exit
    s_mov_b32 s74, 0
    s_mov_b32 s75, 0
    v_mov_b32 v202, 0x7ffffff0
    v_mov_b32 v1, 0
    s_and_b32 s71, s101, 15
    s_lshl_b32 s71, s71, 7
    s_add_u32 s71, s71, 0x1000
    s_mov_b32 s72, 61
    s_cmp_lg_u32 s100, 0
    s_cbranch_scc1 L_polls_125
    s_mov_b32 exec_lo, 0x1
    s_mov_b32 exec_hi, 0
    s_mov_b32 s96, 0
L_poll_123:
    buffer_load_dword v2, v1, s[8:11], s71 offen sc1
    s_waitcnt vmcnt(0)
    v_cmp_gt_u32 vcc, s72, v2
    s_cbranch_vccz L_polld_124
    v_readfirstlane_b32 s97, v2
    s_nop 0
    s_sub_u32 s97, s72, s97
    s_cmp_lt_i32 s97, 3
    s_cbranch_scc1 L_near_126
    s_sleep 40
    s_cmp_lt_i32 s97, 5
    s_cbranch_scc1 L_near_126
    s_sleep 100
L_near_126:
    s_sleep 16
    s_add_u32 s96, s96, 1
    s_cmp_lt_u32 s96, 0x10000
    s_cbranch_scc1 L_poll_123
L_polld_124:
    s_mov_b64 exec, -1
L_polls_125:
    s_barrier
L_ffn_round:
    v_mbcnt_lo_u32_b32 v0, -1, 0
    v_mbcnt_hi_u32_b32 v0, -1, v0
    s_lshl_b32 s96, s100, 6
    v_add_u32 v0, s96, v0
    s_cmp_lg_u32 s75, 0
    s_cbranch_scc1 L_ffn_re
    v_lshlrev_b32 v30, 5, v0
    s_mov_b32 s69, 0x6000
    v_cmp_le_u32 vcc, 240, v0
    v_mov_b32 v29, s75
    v_add_u32 v29, -1, v29
    v_cndmask_b32 v19, 0, v29, vcc
    s_mov_b32 s70, 0
L_kpoll_127:
    buffer_load_dwordx4 v[20:23], v30, s[8:11], s69 offen sc1
    buffer_load_dwordx4 v[24:27], v30, s[8:11], s69 offen offset:16 sc1
    s_waitcnt vmcnt(0)
    v_min3_u32 v28, v20, v21, v22
    v_min3_u32 v28, v28, v23, v24
    v_min3_u32 v28, v28, v25, v26
    v_min_u32 v28, v28, v27
    v_or_b32 v28, v28, v19
    v_cmp_eq_u32 vcc, 0, v28
    s_cbranch_vccz L_kpolld_128
    s_sleep 6
    s_add_u32 s70, s70, 1
    s_cmp_lt_u32 s70, 0x10000
    s_cbranch_scc1 L_kpoll_127
L_kpolld_128:
    v_bfi_b32 v20, v19, 0, v20
    v_bfi_b32 v21, v19, 0, v21
    v_bfi_b32 v22, v19, 0, v22
    v_bfi_b32 v23, v19, 0, v23
    v_bfi_b32 v24, v19, 0, v24
    v_bfi_b32 v25, v19, 0, v25
    v_bfi_b32 v26, v19, 0, v26
    v_bfi_b32 v27, v19, 0, v27
    v_lshrrev_b32 v30, 6, v0
    v_lshlrev_b32 v30, 2, v30
    v_add_u32 v30, 0x20400, v30
    v_mov_b32 v31, 0x20400
    s_waitcnt vmcnt(0)
    v_max3_u32 v28, v20, v21, v22
    v_max3_u32 v28, v28, v23, v24
    v_max3_u32 v28, v28, v25, v26
    v_max_u32 v28, v28, v27
    s_nop 1
    v_max_u32_dpp v28, v28, v28 row_ror:1 row_mask:0xf bank_mask:0xf
    s_nop 1
    v_max_u32_dpp v28, v28, v28 row_ror:2 row_mask:0xf bank_mask:0xf
    s_nop 1
    v_max_u32_dpp v28, v28, v28 row_ror:4 row_mask:0xf bank_mask:0xf
    s_nop 1
    v_max_u32_dpp v28, v28, v28 row_ror:8 row_mask:0xf bank_mask:0xf
    v_mov_b32 v29, v28
    s_nop 1
    v_permlane32_swap_b32 v29, v28
    v_max_u32 v28, v29, v28
    v_mov_b32 v29, v28
    s_nop 1
    v_permlane16_swap_b32 v29, v28
    v_max_u32 v28, v29, v28
    ds_write_b32 v30, v28
    s_waitcnt lgkmcnt(0)
    s_barrier
    ds_read_b128 v[16:19], v31
    s_waitcnt lgkmcnt(0)
    v_max3_u32 v28, v16, v17, v18
    v_max_u32 v28, v28, v19
    s_nop 0
    v_readfirstlane_b32 s69, v28
    s_nop 1
    v_cmp_ne_u32 vcc, s69, v20
    s_nop 1
    v_cndmask_b32 v20, 0, v20, vcc
    v_cmp_ne_u32 vcc, s69, v21
    s_nop 1
    v_cndmask_b32 v21, 0, v21, vcc
    v_cmp_ne_u32 vcc, s69, v22
    s_nop 1
    v_cndmask_b32 v22, 0, v22, vcc
    v_cmp_ne_u32 vcc, s69, v23
    s_nop 1
    v_cndmask_b32 v23, 0, v23, vcc
    v_cmp_ne_u32 vcc, s69, v24
    s_nop 1
    v_cndmask_b32 v24, 0, v24, vcc
    v_cmp_ne_u32 vcc, s69, v25
    s_nop 1
    v_cndmask_b32 v25, 0, v25, vcc
    v_cmp_ne_u32 vcc, s69, v26
    s_nop 1
    v_cndmask_b32 v26, 0, v26, vcc
    v_cmp_ne_u32 vcc, s69, v27
    s_nop 1
    v_cndmask_b32 v27, 0, v27, vcc
    v_max3_u32 v28, v20, v21, v22
    v_max3_u32 v28, v28, v23, v24
    v_max3_u32 v28, v28, v25, v26
    v_max_u32 v28, v28, v27
    s_nop 1
    v_max_u32_dpp v28, v28, v28 row_ror:1 row_mask:0xf bank_mask:0xf
    s_nop 1
    v_max_u32_dpp v28, v28, v28 row_ror:2 row_mask:0xf bank_mask:0xf
    s_nop 1
    v_max_u32_dpp v28, v28, v28 row_ror:4 row_mask:0xf bank_mask:0xf
    s_nop 1
    v_max_u32_dpp v28, v28, v28 row_ror:8 row_mask:0xf bank_mask:0xf
    v_mov_b32 v29, v28
    s_nop 1
    v_permlane32_swap_b32 v29, v28
    v_max_u32 v28, v29, v28
    v_mov_b32 v29, v28
    s_nop 1
    v_permlane16_swap_b32 v29, v28
    v_max_u32 v28, v29, v28
    ds_write_b32 v30, v28 offset:16
    s_waitcnt lgkmcnt(0)
    s_barrier
    ds_read_b128 v[16:19], v31 offset:16
    s_waitcnt lgkmcnt(0)
    v_max3_u32 v28, v16, v17, v18
    v_max_u32 v28, v28, v19
    s_nop 0
    v_readfirstlane_b32 s70, v28
    s_barrier
    s_branch L_ffn_sel
L_ffn_re:
    v_and_b32 v24, 63, v0
    v_lshlrev_b32 v24, 3, v24
    s_mov_b32 s71, 0x7e00
    s_mov_b32 s72, 0
L_rsel_129:
    buffer_load_dwordx2 v[20:21], v24, s[8:11], s71 offen sc1
    s_waitcnt vmcnt(0)
    v_min_u32 v22, v20, v21
    v_cmp_eq_u32 vcc, 0, v22
    s_cbranch_vccz L_rseld_130
    s_sleep 3
    s_add_u32 s72, s72, 1
    s_cmp_lt_u32 s72, 0x10000
    s_cbranch_scc1 L_rsel_129
L_rseld_130:
    v_max_u32 v22, v20, v21
    v_cmp_lt_u32 vcc, s70, v22
    s_cbranch_vccz L_rsele_131
    v_max_u32_dpp v22, v22, v22 row_ror:1 row_mask:0xf bank_mask:0xf
    s_nop 1
    v_max_u32_dpp v22, v22, v22 row_ror:2 row_mask:0xf bank_mask:0xf
    s_nop 1
    v_max_u32_dpp v22, v22, v22 row_ror:4 row_mask:0xf bank_mask:0xf
    s_nop 1
    v_max_u32_dpp v22, v22, v22 row_ror:8 row_mask:0xf bank_mask:0xf
    v_mov_b32 v23, v22
    s_nop 1
    v_permlane32_swap_b32 v23, v22
    v_max_u32 v22, v23, v22
    v_mov_b32 v23, v22
    s_nop 1
    v_permlane16_swap_b32 v23, v22
    v_max_u32 v22, v23, v22
    s_nop 0
    v_readfirstlane_b32 s71, v22
    s_nop 1
    v_cmp_ne_u32 vcc, s71, v20
    s_nop 1
    v_cndmask_b32 v20, 0, v20, vcc
    v_cmp_ne_u32 vcc, s71, v21
    s_nop 1
    v_cndmask_b32 v21, 0, v21, vcc
    v_max_u32 v22, v20, v21
    s_nop 1
    v_max_u32_dpp v22, v22, v22 row_ror:1 row_mask:0xf bank_mask:0xf
    s_nop 1
    v_max_u32_dpp v22, v22, v22 row_ror:2 row_mask:0xf bank_mask:0xf
    s_nop 1
    v_max_u32_dpp v22, v22, v22 row_ror:4 row_mask:0xf bank_mask:0xf
    s_nop 1
    v_max_u32_dpp v22, v22, v22 row_ror:8 row_mask:0xf bank_mask:0xf
    v_mov_b32 v23, v22
    s_nop 1
    v_permlane32_swap_b32 v23, v22
    v_max_u32 v22, v23, v22
    v_mov_b32 v23, v22
    s_nop 1
    v_permlane16_swap_b32 v23, v22
    v_max_u32 v22, v23, v22
    s_nop 0
    v_readfirstlane_b32 s72, v22
    s_nop 0
    s_max_u32 s70, s70, s72
    s_min_u32 s72, s71, s69
    s_max_u32 s70, s70, s72
    s_max_u32 s69, s69, s71
L_rsele_131:
L_ffn_sel:
    s_and_b32 s71, s69, 2047
    s_lshl_b32 s71, s71, 11
    s_and_b32 s72, s70, 2047
    s_or_b32 s71, s71, s72
    s_add_u32 s71, s71, 1
    s_cmp_eq_u32 s71, s74
    s_cbranch_scc1 L_ffn_same
    s_mov_b32 s74, s71
    v_and_b32 v1, 63, v0
    v_lshrrev_b32 v2, 4, v1
    v_and_b32 v3, 15, v1
    v_lshrrev_b32 v6, 2, v3
    s_and_b32 s71, s69, 2047
    s_sub_u32 s71, 2047, s71
    s_and_b32 s72, s70, 2047
    s_sub_u32 s72, 2047, s72
    v_and_b32 v4, 1, v3
    v_cmp_eq_u32 vcc, 0, v4
    v_mov_b32 v4, s71
    v_mov_b32 v5, s72
    v_cndmask_b32 v4, v5, v4, vcc
    v_lshlrev_b32 v4, 10, v4
    v_lshl_add_u32 v4, v2, 4, v4
    s_mov_b32 s71, 0x6200000
    buffer_load_dwordx4 v[32:35], v4, s[8:11], s71 offen
    buffer_load_dwordx4 v[36:39], v4, s[8:11], s71 offen offset:64
    buffer_load_dwordx4 v[40:43], v4, s[8:11], s71 offen offset:128
    buffer_load_dwordx4 v[44:47], v4, s[8:11], s71 offen offset:192
    buffer_load_dwordx4 v[48:51], v4, s[8:11], s71 offen offset:256
    buffer_load_dwordx4 v[52:55], v4, s[8:11], s71 offen offset:320
    buffer_load_dwordx4 v[56:59], v4, s[8:11], s71 offen offset:384
    buffer_load_dwordx4 v[60:63], v4, s[8:11], s71 offen offset:448
    buffer_load_dwordx4 v[64:67], v4, s[8:11], s71 offen offset:512
    buffer_load_dwordx4 v[68:71], v4, s[8:11], s71 offen offset:576
    buffer_load_dwordx4 v[72:75], v4, s[8:11], s71 offen offset:640
    buffer_load_dwordx4 v[76:79], v4, s[8:11], s71 offen offset:704
    buffer_load_dwordx4 v[80:83], v4, s[8:11], s71 offen offset:768
    buffer_load_dwordx4 v[84:87], v4, s[8:11], s71 offen offset:832
    buffer_load_dwordx4 v[88:91], v4, s[8:11], s71 offen offset:896
    buffer_load_dwordx4 v[92:95], v4, s[8:11], s71 offen offset:960
    v_lshl_add_u32 v4, v2, 3, v6
    v_lshlrev_b32 v4, 6, v4
    v_and_b32 v5, 3, v3
    v_lshl_add_u32 v4, v5, 3, v4
    s_lshr_b32 s71, s68, 1
    s_lshl_b32 s71, s71, 15
    s_and_b32 s72, s68, 1
    s_lshl_b32 s72, s72, 5
    s_add_u32 s71, s71, s72
    s_add_u32 s71, s71, 0x8000
    v_add_u32 v7, s71, v4
    ds_read_b64_tr_b16 v[96:97], v7
    ds_read_b64_tr_b16 v[98:99], v7 offset:256
    ds_read_b64_tr_b16 v[100:101], v7 offset:2048
    ds_read_b64_tr_b16 v[102:103], v7 offset:2304
    ds_read_b64_tr_b16 v[104:105], v7 offset:4096
    ds_read_b64_tr_b16 v[106:107], v7 offset:4352
    ds_read_b64_tr_b16 v[108:109], v7 offset:6144
    ds_read_b64_tr_b16 v[110:111], v7 offset:6400
    s_waitcnt lgkmcnt(0)
    ds_read_b64_tr_b16 v[112:113], v7 offset:8192
    ds_read_b64_tr_b16 v[114:115], v7 offset:8448
    ds_read_b64_tr_b16 v[116:117], v7 offset:10240
    ds_read_b64_tr_b16 v[118:119], v7 offset:10496
    ds_read_b64_tr_b16 v[120:121], v7 offset:12288
    ds_read_b64_tr_b16 v[122:123], v7 offset:12544
    ds_read_b64_tr_b16 v[124:125], v7 offset:14336
    ds_read_b64_tr_b16 v[126:127], v7 offset:14592
    s_waitcnt lgkmcnt(0)
    ds_read_b64_tr_b16 v[128:129], v7 offset:16384
    ds_read_b64_tr_b16 v[130:131], v7 offset:16640
    ds_read_b64_tr_b16 v[132:133], v7 offset:18432
    ds_read_b64_tr_b16 v[134:135], v7 offset:18688
    ds_read_b64_tr_b16 v[136:137], v7 offset:20480
    ds_read_b64_tr_b16 v[138:139], v7 offset:20736
    ds_read_b64_tr_b16 v[140:141], v7 offset:22528
    ds_read_b64_tr_b16 v[142:143], v7 offset:22784
    s_waitcnt lgkmcnt(0)
    ds_read_b64_tr_b16 v[144:145], v7 offset:24576
    ds_read_b64_tr_b16 v[146:147], v7 offset:24832
    ds_read_b64_tr_b16 v[148:149], v7 offset:26624
    ds_read_b64_tr_b16 v[150:151], v7 offset:26880
    ds_read_b64_tr_b16 v[152:153], v7 offset:28672
    ds_read_b64_tr_b16 v[154:155], v7 offset:28928
    ds_read_b64_tr_b16 v[156:157], v7 offset:30720
    ds_read_b64_tr_b16 v[158:159], v7 offset:30976
    s_waitcnt lgkmcnt(0)
    s_waitcnt vmcnt(0)
    v_mfma_f32_16x16x32_bf16 v[8:11], v[32:35], v[96:99], 0
    v_mfma_f32_16x16x32_bf16 v[8:11], v[36:39], v[100:103], v[8:11]
    v_mfma_f32_16x16x32_bf16 v[8:11], v[40:43], v[104:107], v[8:11]
    v_mfma_f32_16x16x32_bf16 v[8:11], v[44:47], v[108:111], v[8:11]
    v_mfma_f32_16x16x32_bf16 v[8:11], v[48:51], v[112:115], v[8:11]
    v_mfma_f32_16x16x32_bf16 v[8:11], v[52:55], v[116:119], v[8:11]
    v_mfma_f32_16x16x32_bf16 v[8:11], v[56:59], v[120:123], v[8:11]
    v_mfma_f32_16x16x32_bf16 v[8:11], v[60:63], v[124:127], v[8:11]
    v_mfma_f32_16x16x32_bf16 v[8:11], v[64:67], v[128:131], v[8:11]
    v_mfma_f32_16x16x32_bf16 v[8:11], v[68:71], v[132:135], v[8:11]
    v_mfma_f32_16x16x32_bf16 v[8:11], v[72:75], v[136:139], v[8:11]
    v_mfma_f32_16x16x32_bf16 v[8:11], v[76:79], v[140:143], v[8:11]
    v_mfma_f32_16x16x32_bf16 v[8:11], v[80:83], v[144:147], v[8:11]
    v_mfma_f32_16x16x32_bf16 v[8:11], v[84:87], v[148:151], v[8:11]
    v_mfma_f32_16x16x32_bf16 v[8:11], v[88:91], v[152:155], v[8:11]
    v_mfma_f32_16x16x32_bf16 v[8:11], v[92:95], v[156:159], v[8:11]
    s_nop 7
    v_cvt_pk_bf16_f32 v8, v8, v8
    v_and_b32 v8, 0xffff0000, v8
    v_cvt_pk_bf16_f32 v9, v9, v9
    v_and_b32 v9, 0xffff0000, v9
    s_cmp_ge_u32 s68, 2
    s_cbranch_scc1 L_ffn_up_132
    v_mul_f32 v13, 0xbfb8aa3b, v8
    v_exp_f32 v13, v13
    s_nop 0
    v_add_f32 v13, 1.0, v13
    v_rcp_f32 v12, v13
    s_nop 0
    v_mul_f32 v8, v12, v8
    v_cvt_pk_bf16_f32 v8, v8, v8
    v_and_b32 v8, 0xffff0000, v8
    v_mul_f32 v13, 0xbfb8aa3b, v9
    v_exp_f32 v13, v13
    s_nop 0
    v_add_f32 v13, 1.0, v13
    v_rcp_f32 v12, v13
    s_nop 0
    v_mul_f32 v9, v12, v9
    v_cvt_pk_bf16_f32 v9, v9, v9
    v_and_b32 v9, 0xffff0000, v9
    s_nop 4
L_ffn_up_132:
    s_lshr_b32 s71, s68, 1
    s_lshl_b32 s71, s71, 8
    s_and_b32 s72, s68, 1
    s_lshl_b32 s72, s72, 6
    s_add_u32 s71, s71, s72
    s_add_u32 s71, s71, 0x20000
    v_lshlrev_b32 v4, 2, v3
    v_add_u32 v4, s71, v4
    ds_write_b32 v4, v8
    ds_write_b32 v4, v9 offset:128
    s_waitcnt lgkmcnt(0)
    s_barrier
    v_and_b32 v4, 1, v3
    v_lshlrev_b32 v4, 7, v4
    v_lshl_add_u32 v4, v2, 5, v4
    v_add_u32 v4, 0x20000, v4
    ds_read_b128 v[32:35], v4
    ds_read_b128 v[36:39], v4 offset:16
    ds_read_b128 v[40:43], v4 offset:256
    ds_read_b128 v[44:47], v4 offset:272
    v_lshl_add_u32 v5, v2, 3, v6
    v_lshlrev_b32 v5, 10, v5
    v_and_b32 v7, 3, v3
    v_lshl_add_u32 v5, v7, 3, v5
    s_lshl_b32 s71, s68, 8
    s_add_u32 s71, s71, 0x18000
    v_add_u32 v7, s71, v5
    s_waitcnt lgkmcnt(0)
    ds_read_b64_tr_b16 v[96:97], v7
    ds_read_b64_tr_b16 v[98:99], v7 offset:4096
    ds_read_b64_tr_b16 v[100:101], v7 offset:32
    ds_read_b64_tr_b16 v[102:103], v7 offset:4128
    ds_read_b64_tr_b16 v[104:105], v7 offset:64
    ds_read_b64_tr_b16 v[106:107], v7 offset:4160
    ds_read_b64_tr_b16 v[108:109], v7 offset:96
    ds_read_b64_tr_b16 v[110:111], v7 offset:4192
    s_waitcnt lgkmcnt(0)
    ds_read_b64_tr_b16 v[112:113], v7 offset:128
    ds_read_b64_tr_b16 v[114:115], v7 offset:4224
    ds_read_b64_tr_b16 v[116:117], v7 offset:160
    ds_read_b64_tr_b16 v[118:119], v7 offset:4256
    ds_read_b64_tr_b16 v[120:121], v7 offset:192
    ds_read_b64_tr_b16 v[122:123], v7 offset:4288
    ds_read_b64_tr_b16 v[124:125], v7 offset:224
    ds_read_b64_tr_b16 v[126:127], v7 offset:4320
    v_mul_f32 v32, v32, v40
    v_mul_f32 v33, v33, v41
    v_mul_f32 v34, v34, v42
    v_mul_f32 v35, v35, v43
    v_mul_f32 v36, v36, v44
    v_mul_f32 v37, v37, v45
    v_mul_f32 v38, v38, v46
    v_mul_f32 v39, v39, v47
    v_cvt_pk_bf16_f32 v48, v32, v33
    v_cvt_pk_bf16_f32 v49, v34, v35
    v_cvt_pk_bf16_f32 v50, v36, v37
    v_cvt_pk_bf16_f32 v51, v38, v39
    s_waitcnt lgkmcnt(0)
    s_nop 0
    v_mfma_f32_16x16x32_bf16 v[56:59], v[48:51], v[96:99], 0
    v_mfma_f32_16x16x32_bf16 v[60:63], v[48:51], v[100:103], 0
    v_mfma_f32_16x16x32_bf16 v[64:67], v[48:51], v[104:107], 0
    v_mfma_f32_16x16x32_bf16 v[68:71], v[48:51], v[108:111], 0
    v_mfma_f32_16x16x32_bf16 v[72:75], v[48:51], v[112:115], 0
    v_mfma_f32_16x16x32_bf16 v[76:79], v[48:51], v[116:119], 0
    v_mfma_f32_16x16x32_bf16 v[80:83], v[48:51], v[120:123], 0
    v_mfma_f32_16x16x32_bf16 v[84:87], v[48:51], v[124:127], 0
    v_cmp_eq_u32 vcc, 0, v2
    v_lshlrev_b32 v4, 11, v2
    v_lshl_add_u32 v4, v3, 2, v4
    s_lshl_b32 s71, s67, 12
    s_lshl_b32 s72, s68, 9
    s_add_u32 s71, s71, s72
    s_add_u32 s71, s71, 0x6410000
    v_cndmask_b32 v56, v57, v56, vcc
    v_cndmask_b32 v60, v61, v60, vcc
    v_cndmask_b32 v64, v65, v64, vcc
    v_cndmask_b32 v68, v69, v68, vcc
    v_cndmask_b32 v72, v73, v72, vcc
    v_cndmask_b32 v76, v77, v76, vcc
    v_cndmask_b32 v80, v81, v80, vcc
    v_cndmask_b32 v84, v85, v84, vcc
    s_mov_b32 exec_hi, 0
    buffer_store_dword v56, v4, s[8:11], s71 offen sc1
    buffer_store_dword v60, v4, s[8:11], s71 offen offset:64 sc1
    buffer_store_dword v64, v4, s[8:11], s71 offen offset:128 sc1
    buffer_store_dword v68, v4, s[8:11], s71 offen offset:192 sc1
    buffer_store_dword v72, v4, s[8:11], s71 offen offset:256 sc1
    buffer_store_dword v76, v4, s[8:11], s71 offen offset:320 sc1
    buffer_store_dword v80, v4, s[8:11], s71 offen offset:384 sc1
    buffer_store_dword v84, v4, s[8:11], s71 offen offset:448 sc1
    s_mov_b64 exec, -1
    s_waitcnt vmcnt(0)
    s_barrier
    s_lshl_b32 s71, s67, 2
    s_lshl_b32 s72, s75, 8
    s_add_u32 s71, s71, s72
    s_add_u32 s71, s71, 0x8000
    s_cmp_lg_u32 s100, 0
    s_cbranch_scc1 L_flag_133
    v_mov_b32 v2, s74
    s_mov_b64 exec, 1
    buffer_store_dword v2, off, s[8:11], s71 sc1
    s_mov_b64 exec, -1
L_flag_133:
    s_cmp_ge_u32 s67, 8
    s_cbranch_scc1 L_ffn_same
    s_load_dwordx2 s[16:17], s[0:1], 96
    s_waitcnt lgkmcnt(0)
    s_and_b32 s17, s17, 0xffff
    s_mov_b32 s18, 0x200000
    s_mov_b32 s19, 0x20000
    v_and_b32 v3, 63, v0
    s_cmp_lt_u32 s100, 2
    s_cselect_b32 s71, s69, s70
    v_mov_b32 v5, s71
    s_and_b32 s71, s71, 2047
    s_sub_u32 s71, 2047, s71
    s_lshl_b32 s71, s71, 10
    s_lshl_b32 s72, s67, 1
    s_and_b32 s96, s100, 1
    s_add_u32 s72, s72, s96
    s_lshl_b32 s96, s72, 6
    s_add_u32 s71, s71, s96
    v_and_b32 v4, 7, v3
    v_lshlrev_b32 v6, 3, v4
    v_add_u32 v6, s71, v6
    v_lshrrev_b32 v7, 3, v3
    v_lshlrev_b32 v7, 12, v7
    v_lshl_add_u32 v7, v4, 4, v7
    s_lshl_b32 s72, s72, 7
    s_lshr_b32 s96, s100, 1
    s_lshl_b32 s96, s96, 11
    s_add_u32 s72, s72, s96
    v_add_u32 v7, s72, v7
    s_mov_b32 s71, 0x6000000
    s_mov_b32 s72, 0x6200000
    buffer_load_dwordx2 v[8:9], v6, s[8:11], s71 offen sc1
    buffer_load_dwordx2 v[10:11], v6, s[8:11], s72 offen sc1
    v_and_b32 v5, 0xffff0000, v5
    v_ashrrev_i32 v4, 31, v5
    v_not_b32 v4, v4
    v_or_b32 v4, 0x80000000, v4
    v_xor_b32 v5, v5, v4
    v_and_b32 v5, 0xffff0000, v5
    v_mul_f32 v23, 0xbfb8aa3b, v5
    v_exp_f32 v23, v23
    s_nop 0
    v_add_f32 v23, 1.0, v23
    v_rcp_f32 v22, v23
    s_nop 0
    v_cvt_pk_bf16_f32 v22, v22, v22
    v_and_b32 v22, 0xffff0000, v22
    v_lshlrev_b32 v1, 2, v0
    s_lshl_b32 s71, s75, 8
    s_add_u32 s71, s71, 0x8000
    s_cmp_lg_u32 s100, 0
    s_cbranch_scc1 L_polls_136
    s_mov_b32 exec_hi, 0xffffff
    s_mov_b32 s96, 0
L_poll_134:
    buffer_load_dword v2, v1, s[8:11], s71 offen sc1
    s_waitcnt vmcnt(0)
    v_cmp_ne_u32 vcc, s74, v2
    s_cbranch_vccz L_polld_135
    s_sleep 2
    s_add_u32 s96, s96, 1
    s_cmp_lt_u32 s96, 0x10000
    s_cbranch_scc1 L_poll_134
L_polld_135:
    s_mov_b64 exec, -1
L_polls_136:
    s_barrier
    s_mov_b32 s71, 0x6410000
    buffer_load_dwordx4 v[32:35], v7, s[8:11], s71 offen sc1
    s_add_u32 s71, s71, 32768
    buffer_load_dwordx4 v[36:39], v7, s[8:11], s71 offen sc1
    s_add_u32 s71, s71, 32768
    buffer_load_dwordx4 v[40:43], v7, s[8:11], s71 offen sc1
    s_add_u32 s71, s71, 32768
    buffer_load_dwordx4 v[44:47], v7, s[8:11], s71 offen sc1
    s_add_u32 s71, s71, 32768
    buffer_load_dwordx4 v[48:51], v7, s[8:11], s71 offen sc1
    s_add_u32 s71, s71, 32768
    buffer_load_dwordx4 v[52:55], v7, s[8:11], s71 offen sc1
    s_add_u32 s71, s71, 32768
    buffer_load_dwordx4 v[56:59], v7, s[8:11], s71 offen sc1
    s_add_u32 s71, s71, 32768
    s_waitcnt vmcnt(7)
    v_lshlrev_b32 v12, 16, v8
    v_and_b32 v13, 0xffff0000, v8
    v_lshlrev_b32 v16, 16, v10
    v_and_b32 v17, 0xffff0000, v10
    v_lshlrev_b32 v14, 16, v9
    v_and_b32 v15, 0xffff0000, v9
    v_lshlrev_b32 v18, 16, v11
    v_and_b32 v19, 0xffff0000, v11
    s_waitcnt vmcnt(0)
    v_pk_add_f32 v[32:33], v[32:33], v[36:37]
    v_pk_add_f32 v[34:35], v[34:35], v[38:39]
    v_pk_add_f32 v[32:33], v[32:33], v[40:41]
    v_pk_add_f32 v[34:35], v[34:35], v[42:43]
    v_pk_add_f32 v[32:33], v[32:33], v[44:45]
    v_pk_add_f32 v[34:35], v[34:35], v[46:47]
    v_pk_add_f32 v[32:33], v[32:33], v[48:49]
    v_pk_add_f32 v[34:35], v[34:35], v[50:51]
    v_pk_add_f32 v[32:33], v[32:33], v[52:53]
    v_pk_add_f32 v[34:35], v[34:35], v[54:55]
    v_pk_add_f32 v[32:33], v[32:33], v[56:57]
    v_pk_add_f32 v[34:35], v[34:35], v[58:59]
    s_nop 0
    v_add_f32_dpp v32, v32, v32 row_ror:8 row_mask:0xf bank_mask:0xf
    v_add_f32_dpp v33, v33, v33 row_ror:8 row_mask:0xf bank_mask:0xf
    v_add_f32_dpp v34, v34, v34 row_ror:8 row_mask:0xf bank_mask:0xf
    v_add_f32_dpp v35, v35, v35 row_ror:8 row_mask:0xf bank_mask:0xf
    v_mov_b32 v24, v32
    s_nop 1
    v_permlane32_swap_b32 v24, v32
    v_add_f32 v32, v24, v32
    v_mov_b32 v24, v32
    s_nop 1
    v_permlane16_swap_b32 v24, v32
    v_add_f32 v32, v24, v32
    v_mov_b32 v24, v33
    s_nop 1
    v_permlane32_swap_b32 v24, v33
    v_add_f32 v33, v24, v33
    v_mov_b32 v24, v33
    s_nop 1
    v_permlane16_swap_b32 v24, v33
    v_add_f32 v33, v24, v33
    v_mov_b32 v24, v34
    s_nop 1
    v_permlane32_swap_b32 v24, v34
    v_add_f32 v34, v24, v34
    v_mov_b32 v24, v34
    s_nop 1
    v_permlane16_swap_b32 v24, v34
    v_add_f32 v34, v24, v34
    v_mov_b32 v24, v35
    s_nop 1
    v_permlane32_swap_b32 v24, v35
    v_add_f32 v35, v24, v35
    v_mov_b32 v24, v35
    s_nop 1
    v_permlane16_swap_b32 v24, v35
    v_add_f32 v35, v24, v35
    v_cvt_pk_bf16_f32 v32, v32, v32
    v_and_b32 v32, 0xffff0000, v32
    v_mul_f32 v32, v22, v32
    v_cvt_pk_bf16_f32 v32, v32, v32
    v_and_b32 v32, 0xffff0000, v32
    v_add_f32 v32, v16, v32
    v_cvt_pk_bf16_f32 v32, v32, v32
    v_and_b32 v32, 0xffff0000, v32
    v_add_f32 v32, v12, v32
    v_cvt_pk_bf16_f32 v33, v33, v33
    v_and_b32 v33, 0xffff0000, v33
    v_mul_f32 v33, v22, v33
    v_cvt_pk_bf16_f32 v33, v33, v33
    v_and_b32 v33, 0xffff0000, v33
    v_add_f32 v33, v17, v33
    v_cvt_pk_bf16_f32 v33, v33, v33
    v_and_b32 v33, 0xffff0000, v33
    v_add_f32 v33, v13, v33
    v_cvt_pk_bf16_f32 v34, v34, v34
    v_and_b32 v34, 0xffff0000, v34
    v_mul_f32 v34, v22, v34
    v_cvt_pk_bf16_f32 v34, v34, v34
    v_and_b32 v34, 0xffff0000, v34
    v_add_f32 v34, v18, v34
    v_cvt_pk_bf16_f32 v34, v34, v34
    v_and_b32 v34, 0xffff0000, v34
    v_add_f32 v34, v14, v34
    v_cvt_pk_bf16_f32 v35, v35, v35
    v_and_b32 v35, 0xffff0000, v35
    v_mul_f32 v35, v22, v35
    v_cvt_pk_bf16_f32 v35, v35, v35
    v_and_b32 v35, 0xffff0000, v35
    v_add_f32 v35, v19, v35
    v_cvt_pk_bf16_f32 v35, v35, v35
    v_and_b32 v35, 0xffff0000, v35
    v_add_f32 v35, v15, v35
    v_cvt_pk_bf16_f32 v200, v32, v33
    v_cvt_pk_bf16_f32 v201, v34, v35
    v_mov_b32 v202, v6
L_ffn_same:
    s_add_u32 s75, s75, 1
    s_cmp_lt_u32 s75, 2
    s_cbranch_scc1 L_ffn_round
    s_cmp_ge_u32 s67, 8
    s_cbranch_scc1 L_exit
    s_mov_b32 exec_lo, 0xff
    s_mov_b32 exec_hi, 0
    buffer_store_dwordx2 v[200:201], v202, s[16:19], 0 offen
    s_mov_b64 exec, -1
    s_waitcnt vmcnt(0)
L_exit:
    s_endpgm
.section .rodata,"a"
.p2align 6
.amdhsa_kernel sequential_preLN__memory_aug_recurrent_mem_tr__moe_arch_mod__prompt_kernel
  .amdhsa_next_free_vgpr 512
  .amdhsa_next_free_sgpr 102
  .amdhsa_accum_offset 256
  .amdhsa_group_segment_fixed_size 0
  .amdhsa_kernarg_size 120
  .amdhsa_user_sgpr_count 2
  .amdhsa_user_sgpr_kernarg_segment_ptr 1
  .amdhsa_system_sgpr_workgroup_id_x 1
  .amdhsa_float_denorm_mode_32 3
.end_amdhsa_kernel
```

```asm
; @launch grid=(256,1,1) block=(256,1,1) lds=163840
.amdgcn_target "amdgcn-amd-amdhsa--gfx950"
.text
.globl sequential_preLN__memory_aug_recurrent_mem_tr__moe_arch_mod__prompt_kernel
.p2align 8
.type sequential_preLN__memory_aug_recurrent_mem_tr__moe_arch_mod__prompt_kernel,@function
sequential_preLN__memory_aug_recurrent_mem_tr__moe_arch_mod__prompt_kernel:
    s_cmp_ge_u32 s2, 256
    s_cbranch_scc1 L_exit
    s_load_dwordx2 s[8:9], s[0:1], 112
    s_waitcnt lgkmcnt(0)
    s_and_b32 s9, s9, 0xffff
    s_mov_b32 s10, 0x10000000
    s_mov_b32 s11, 0x20000
    s_load_dwordx2 s[92:93], s[0:1], 104
    s_waitcnt lgkmcnt(0)
    s_and_b32 s93, s93, 0xffff
    s_mov_b32 s94, 0x100
    s_mov_b32 s95, 0x20000
    v_lshrrev_b32 v1, 6, v0
    s_nop 0
    v_readfirstlane_b32 s100, v1
    s_getreg_b32 s84, hwreg(HW_REG_XCC_ID)
    s_and_b32 s84, s84, 7
    s_lshl_b32 s97, s84, 4
    s_add_u32 s97, s97, 64
    s_cmp_lg_u32 s100, 0
    s_cbranch_scc1 L_at_1
    s_mov_b64 exec, 1
    v_mov_b32 v2, 1
    buffer_atomic_add v2, off, s[92:95], s97 sc0
    s_mov_b64 exec, -1
L_at_1:
    s_load_dwordx4 s[20:23], s[0:1], 16
    s_load_dwordx4 s[24:27], s[0:1], 32
    v_lshlrev_b32 v3, 6, v0
    s_lshl_b32 s28, s2, 14
    s_cmp_eq_u32 s84, 0
    s_cselect_b32 s14, 0, 0x400000
    s_mov_b32 s15, 0x20000
    s_waitcnt lgkmcnt(0)
    s_mov_b32 s12, s20
    s_and_b32 s13, s21, 0xffff
    buffer_load_dword v255, v3, s[12:15], s28 offen
    s_mov_b32 s12, s22
    s_and_b32 s13, s23, 0xffff
    buffer_load_dword v255, v3, s[12:15], s28 offen
    s_mov_b32 s12, s24
    s_and_b32 s13, s25, 0xffff
    buffer_load_dword v255, v3, s[12:15], s28 offen
    s_mov_b32 s12, s26
    s_and_b32 s13, s27, 0xffff
    buffer_load_dword v255, v3, s[12:15], s28 offen
    s_cmp_lg_u32 s100, 0
    s_cbranch_scc1 L_at2_2
    s_mov_b64 exec, 1
    v_mov_b32 v1, 0
    s_waitcnt vmcnt(4)
    ds_write_b32 v1, v2
    s_waitcnt lgkmcnt(0)
    s_mov_b64 exec, -1
L_at2_2:
    s_barrier
    v_mov_b32 v1, 0
    ds_read_b32 v2, v1
    s_waitcnt lgkmcnt(0)
    v_readfirstlane_b32 s85, v2
    s_mov_b32 s87, 0
    s_cmp_lg_u32 s2, 0
    s_cbranch_scc1 L_noz
    v_mov_b32 v4, 0
    v_mov_b32 v5, 0
    v_mov_b32 v6, 0
    v_mov_b32 v7, 0
    v_lshlrev_b32 v1, 4, v0
    s_mov_b32 s97, 0x0
    buffer_store_dwordx4 v[4:7], v1, s[8:11], s97 offen sc1
    s_mov_b32 s97, 0x1000
    buffer_store_dwordx4 v[4:7], v1, s[8:11], s97 offen sc1
    s_mov_b32 s97, 0x2000
    buffer_store_dwordx4 v[4:7], v1, s[8:11], s97 offen sc1
    s_mov_b32 s97, 0x3000
    buffer_store_dwordx4 v[4:7], v1, s[8:11], s97 offen sc1
    s_mov_b32 s97, 0x4000
    buffer_store_dwordx4 v[4:7], v1, s[8:11], s97 offen sc1
    s_mov_b32 s97, 0x5000
    buffer_store_dwordx4 v[4:7], v1, s[8:11], s97 offen sc1
    s_mov_b32 s97, 0x6000
    buffer_store_dwordx4 v[4:7], v1, s[8:11], s97 offen sc1
    s_mov_b32 s97, 0x7000
    buffer_store_dwordx4 v[4:7], v1, s[8:11], s97 offen sc1
    s_mov_b32 s97, 0x8000
    buffer_store_dwordx4 v[4:7], v1, s[8:11], s97 offen sc1
    s_waitcnt vmcnt(0)
    s_barrier
    s_cmp_lg_u32 s100, 0
    s_cbranch_scc1 L_flag_3
    v_mov_b32 v2, 1
    s_mov_b64 exec, 1
    buffer_store_dword v2, off, s[92:95], 40 sc1
    s_mov_b64 exec, -1
L_flag_3:
L_noz:
    s_cmp_lg_u32 s85, 31
    s_cbranch_scc1 L_nod
    s_cmp_lg_u32 s100, 0
    s_cbranch_scc1 L_nod
    s_mov_b64 exec, 1
    v_mov_b32 v2, 1
    buffer_atomic_add v2, off, s[92:95], 0 offset:32 sc0
    s_waitcnt vmcnt(0)
    v_readfirstlane_b32 s86, v2
    s_nop 0
    s_cmp_lg_u32 s86, 7
    s_cbranch_scc1 L_nod2
    v_mov_b32 v2, 1
    v_mov_b32 v3, 0
    buffer_atomic_cmpswap v[2:3], off, s[92:95], 0 offset:36
L_nod2:
    s_mov_b64 exec, -1
L_nod:
    s_cmp_ge_u32 s85, 32
    s_cbranch_scc1 L_odd
    s_cmp_lg_u32 s84, 0
    s_cbranch_scc1 L_other
    s_mov_b32 s20, s85
    s_mov_b32 s16, s92
    s_mov_b32 s17, s93
    s_mov_b32 s18, s94
    s_mov_b32 s19, s95
    s_mov_b32 s88, s20
    v_lshrrev_b32 v4, 6, v0
    s_nop 0
    v_readfirstlane_b32 s21, v4
    v_and_b32 v1, 63, v0
    v_lshrrev_b32 v2, 4, v1
    v_and_b32 v3, 15, v1
    v_lshrrev_b32 v6, 2, v3
    v_lshlrev_b32 v117, 4, v1
    s_lshl_b32 s51, s21, 10
    s_lshl_b32 s52, s21, 11
    s_load_dwordx8 s[60:67], s[0:1], 16
    s_mov_b32 s14, 0x400000
    s_mov_b32 s15, 0x20000
    s_lshl_b32 s41, s20, 8
    s_lshl_b32 s42, s20, 17
    s_lshr_b32 s43, s21, 1
    s_lshl_b32 s43, s43, 2
    v_or_b32 v5, s43, v2
    v_lshlrev_b32 v5, 1, v5
    v_xor_b32 v5, v5, v3
    v_lshrrev_b32 v14, 2, v5
    v_lshlrev_b32 v5, 4, v5
    s_lshl_b32 s43, s21, 4
    v_add_u32 v4, s43, v2
    v_lshl_add_u32 v8, v4, 13, v5
    s_waitcnt lgkmcnt(0)
    s_mov_b32 s12, s60
    s_and_b32 s13, s61, 0xffff
    v_xor_b32 v15, 1, v14
    v_lshl_add_u32 v15, v15, 15, v8
    s_add_u32 s43, s41, 0x0
    s_add_u32 m0, s51, 0x8000
    s_nop 0
    buffer_load_dwordx4 v15, s[12:15], s43 offen lds
    s_add_u32 s43, s41, 0x80000
    s_add_u32 m0, s51, 0x9000
    s_nop 0
    buffer_load_dwordx4 v15, s[12:15], s43 offen lds
    s_add_u32 s43, s41, 0x100000
    s_add_u32 m0, s51, 0xa000
    s_nop 0
    buffer_load_dwordx4 v15, s[12:15], s43 offen lds
    s_add_u32 s43, s41, 0x180000
    s_add_u32 m0, s51, 0xb000
    s_nop 0
    buffer_load_dwordx4 v15, s[12:15], s43 offen lds
    s_add_u32 s43, s41, 0x200000
    s_add_u32 m0, s51, 0xc000
    s_nop 0
    buffer_load_dwordx4 v15, s[12:15], s43 offen lds
    s_add_u32 s43, s41, 0x280000
    s_add_u32 m0, s51, 0xd000
    s_nop 0
    buffer_load_dwordx4 v15, s[12:15], s43 offen lds
    s_add_u32 s43, s41, 0x300000
    s_add_u32 m0, s51, 0xe000
    s_nop 0
    buffer_load_dwordx4 v15, s[12:15], s43 offen lds
    s_add_u32 s43, s41, 0x380000
    s_add_u32 m0, s51, 0xf000
    s_nop 0
    buffer_load_dwordx4 v15, s[12:15], s43 offen lds
    v_xor_b32 v15, 2, v14
    v_lshl_add_u32 v15, v15, 15, v8
    s_add_u32 s43, s41, 0x0
    s_add_u32 m0, s51, 0x10000
    s_nop 0
    buffer_load_dwordx4 v15, s[12:15], s43 offen lds
    s_add_u32 s43, s41, 0x80000
    s_add_u32 m0, s51, 0x11000
    s_nop 0
    buffer_load_dwordx4 v15, s[12:15], s43 offen lds
    s_add_u32 s43, s41, 0x100000
    s_add_u32 m0, s51, 0x12000
    s_nop 0
    buffer_load_dwordx4 v15, s[12:15], s43 offen lds
    s_add_u32 s43, s41, 0x180000
    s_add_u32 m0, s51, 0x13000
    s_nop 0
    buffer_load_dwordx4 v15, s[12:15], s43 offen lds
    s_add_u32 s43, s41, 0x200000
    s_add_u32 m0, s51, 0x14000
    s_nop 0
    buffer_load_dwordx4 v15, s[12:15], s43 offen lds
    s_add_u32 s43, s41, 0x280000
    s_add_u32 m0, s51, 0x15000
    s_nop 0
    buffer_load_dwordx4 v15, s[12:15], s43 offen lds
    s_add_u32 s43, s41, 0x300000
    s_add_u32 m0, s51, 0x16000
    s_nop 0
    buffer_load_dwordx4 v15, s[12:15], s43 offen lds
    s_add_u32 s43, s41, 0x380000
    s_add_u32 m0, s51, 0x17000
    s_nop 0
    buffer_load_dwordx4 v15, s[12:15], s43 offen lds
    v_xor_b32 v15, 3, v14
    v_lshl_add_u32 v15, v15, 15, v8
    s_add_u32 s43, s41, 0x0
    s_add_u32 m0, s51, 0x18000
    s_nop 0
    buffer_load_dwordx4 v15, s[12:15], s43 offen lds
    s_add_u32 s43, s41, 0x80000
    s_add_u32 m0, s51, 0x19000
    s_nop 0
    buffer_load_dwordx4 v15, s[12:15], s43 offen lds
    s_add_u32 s43, s41, 0x100000
    s_add_u32 m0, s51, 0x1a000
    s_nop 0
    buffer_load_dwordx4 v15, s[12:15], s43 offen lds
    s_add_u32 s43, s41, 0x180000
    s_add_u32 m0, s51, 0x1b000
    s_nop 0
    buffer_load_dwordx4 v15, s[12:15], s43 offen lds
    s_add_u32 s43, s41, 0x200000
    s_add_u32 m0, s51, 0x1c000
    s_nop 0
    buffer_load_dwordx4 v15, s[12:15], s43 offen lds
    s_add_u32 s43, s41, 0x280000
    s_add_u32 m0, s51, 0x1d000
    s_nop 0
    buffer_load_dwordx4 v15, s[12:15], s43 offen lds
    s_add_u32 s43, s41, 0x300000
    s_add_u32 m0, s51, 0x1e000
    s_nop 0
    buffer_load_dwordx4 v15, s[12:15], s43 offen lds
    s_add_u32 s43, s41, 0x380000
    s_add_u32 m0, s51, 0x1f000
    s_nop 0
    buffer_load_dwordx4 v15, s[12:15], s43 offen lds
    s_mov_b32 s12, s62
    s_and_b32 s13, s63, 0xffff
    v_xor_b32 v15, 1, v14
    v_lshl_add_u32 v15, v15, 15, v8
    s_add_u32 s43, s41, 0x0
    s_add_u32 m0, s51, 0x20000
    s_nop 0
    buffer_load_dwordx4 v15, s[12:15], s43 offen lds
    s_add_u32 s43, s41, 0x80000
    s_add_u32 m0, s51, 0x21000
    s_nop 0
    buffer_load_dwordx4 v15, s[12:15], s43 offen lds
    s_add_u32 s43, s41, 0x100000
    s_add_u32 m0, s51, 0x22000
    s_nop 0
    buffer_load_dwordx4 v15, s[12:15], s43 offen lds
    s_add_u32 s43, s41, 0x180000
    s_add_u32 m0, s51, 0x23000
    s_nop 0
    buffer_load_dwordx4 v15, s[12:15], s43 offen lds
    s_add_u32 s43, s41, 0x200000
    s_add_u32 m0, s51, 0x24000
    s_nop 0
    buffer_load_dwordx4 v15, s[12:15], s43 offen lds
    s_add_u32 s43, s41, 0x280000
    s_add_u32 m0, s51, 0x25000
    s_nop 0
    buffer_load_dwordx4 v15, s[12:15], s43 offen lds
    s_add_u32 s43, s41, 0x300000
    s_add_u32 m0, s51, 0x26000
    s_nop 0
    buffer_load_dwordx4 v15, s[12:15], s43 offen lds
    s_add_u32 s43, s41, 0x380000
    s_add_u32 m0, s51, 0x27000
    s_nop 0
    buffer_load_dwordx4 v15, s[12:15], s43 offen lds
    v_and_b32 v4, 2, v3
    v_cmp_ne_u32 vcc, 0, v4
    v_mov_b32 v4, 0x4444
    v_mov_b32 v5, 0xeeee
    v_cndmask_b32 v116, v4, v5, vcc
    v_lshrrev_b32 v5, 1, v2
    v_lshl_add_u32 v4, v6, 3, v5
    s_lshl_b32 s43, s21, 1
    v_add_u32 v4, s43, v4
    v_add_u32 v5, s20, v4
    v_and_b32 v5, 31, v5
    v_lshl_add_u32 v4, v4, 6, v5
    v_and_b32 v5, 1, v2
    v_lshl_add_u32 v4, v4, 1, v5
    v_and_b32 v5, 3, v3
    v_lshl_add_u32 v4, v4, 2, v5
    v_lshlrev_b32 v118, 4, v4
    v_and_b32 v4, 1, v2
    v_lshlrev_b32 v4, 2, v4
    v_and_b32 v7, 2, v2
    v_add_u32 v4, v4, v7
    v_and_b32 v7, 1, v6
    v_add_u32 v4, v4, v7
    v_lshl_add_u32 v4, v4, 2, v5
    v_lshlrev_b32 v4, 2, v4
    s_and_b32 s43, s21, 1
    s_lshl_b32 s43, s43, 12
    s_lshl_b32 s40, s20, 7
    s_add_u32 s43, s43, s40
    v_add_u32 v119, s43, v4
    v_sub_u32 v7, 0, v2
    v_and_b32 v7, 3, v7
    v_xor_b32 v7, v7, v6
    v_lshl_add_u32 v4, v2, 4, v7
    v_and_b32 v5, 3, v3
    v_lshl_add_u32 v4, v4, 2, v5
    s_add_u32 s43, s51, 16384
    v_lshl_add_u32 v120, v4, 2, s43
    v_sub_u32 v7, 0, v6
    v_and_b32 v7, 3, v7
    v_xor_b32 v7, v7, v2
    v_lshl_add_u32 v4, v3, 2, v7
    v_lshlrev_b32 v121, 4, v4
    v_and_b32 v5, 1, v3
    v_lshl_add_u32 v4, v6, 1, v5
    v_lshl_add_u32 v4, v2, 3, v4
    v_lshlrev_b32 v127, 4, v4
    v_and_or_b32 v122, v116, 8, v127
    s_lshl_b32 s43, s21, 13
    s_add_u32 s43, s43, 32768
    v_add_u32 v123, s43, v117
    v_add_u32 v124, 0x10000, v123
    s_mov_b32 s36, 0xcccccccc
    s_mov_b32 s37, 0xcccccccc
    s_mov_b32 s38, 0x00ff00ff
    s_mov_b32 s39, 0x00ff00ff
    s_mov_b32 s34, 0x3e0293ee
    s_mov_b32 s35, 0x49800000
    s_mov_b32 s50, 0x3f803f80
    v_and_b32 v5, 1, v2
    v_or_b32 v5, 0, v5
    v_xor_b32 v5, v5, v6
    v_lshlrev_b32 v5, 8, v5
    v_and_b32 v7, 3, v3
    v_lshl_add_u32 v7, v7, 4, v5
    s_lshl_b32 s43, s21, 2
    v_add_u32 v4, s43, v2
    v_lshl_add_u32 v10, v4, 10, v7
    v_and_b32 v5, 1, v2
    v_or_b32 v5, 2, v5
    v_xor_b32 v5, v5, v6
    v_lshlrev_b32 v5, 8, v5
    v_and_b32 v7, 3, v3
    v_lshl_add_u32 v7, v7, 4, v5
    s_lshl_b32 s43, s21, 2
    v_add_u32 v4, s43, v2
    v_lshl_add_u32 v9, v4, 10, v7
    v_and_b32 v5, 1, v2
    v_lshl_add_u32 v4, v5, 3, v6
    v_lshrrev_b32 v7, 1, v2
    v_lshl_add_u32 v4, v7, 5, v4
    v_lshlrev_b32 v4, 8, v4
    v_lshl_or_b32 v5, v5, 2, v6
    v_lshlrev_b32 v5, 5, v5
    s_lshl_b32 s43, s21, 6
    v_xor_b32 v5, s43, v5
    v_add_u32 v4, v4, v5
    v_and_b32 v5, 3, v3
    v_lshl_add_u32 v4, v5, 3, v4
    v_add_u32 v11, 32768, v4
    v_and_b32 v5, 1, v2
    v_lshlrev_b32 v4, 4, v5
    v_lshl_add_u32 v4, v7, 2, v4
    v_and_b32 v7, 1, v6
    v_add_u32 v4, v4, v7
    s_lshl_b32 s43, s21, 5
    v_add_u32 v4, s43, v4
    v_lshlrev_b32 v4, 8, v4
    v_lshl_or_b32 v5, v5, 1, v7
    v_xor_b32 v5, s21, v5
    v_lshl_add_u32 v4, v5, 6, v4
    v_lshrrev_b32 v5, 1, v6
    v_lshl_add_u32 v4, v5, 5, v4
    v_and_b32 v5, 3, v3
    v_lshl_add_u32 v4, v5, 3, v4
    v_add_u32 v12, 32768, v4
    v_mov_b32 v16, -1
    v_mov_b32 v17, -1
    v_mov_b32 v18, -1
    v_mov_b32 v19, -1
    s_lshl_b32 s43, s20, 13
    s_add_u32 s43, s43, 0x100000
    s_and_b32 s40, s21, 1
    s_lshl_b32 s40, s40, 12
    s_add_u32 s29, s43, s40
    s_add_u32 s43, s43, s52
    s_xor_b32 s40, s43, 0x40000
    buffer_store_dwordx4 v[16:19], v117, s[8:11], s43 offen
    buffer_store_dwordx4 v[16:19], v117, s[8:11], s43 offen offset:1024
    buffer_store_dwordx4 v[16:19], v117, s[8:11], s40 offen
    buffer_store_dwordx4 v[16:19], v117, s[8:11], s40 offen offset:1024
    s_mov_b32 s43, 0x12000
    buffer_store_dword v16, v119, s[8:11], s43 offen
    s_mov_b32 s43, 0x14000
    buffer_store_dword v16, v119, s[8:11], s43 offen
    s_mov_b32 s43, 0x16000
    buffer_store_dword v16, v119, s[8:11], s43 offen
    s_load_dwordx2 s[4:5], s[0:1], 8
    s_waitcnt lgkmcnt(0)
    s_and_b32 s5, s5, 0xffff
    s_mov_b32 s6, 8192
    s_mov_b32 s7, 0x20000
    v_and_b32 v20, 1, v2
    v_and_b32 v21, 1, v6
    v_lshl_add_u32 v20, v20, 1, v21
    v_lshlrev_b32 v20, 9, v20
    v_and_b32 v21, 3, v3
    v_lshl_add_u32 v20, v21, 4, v20
    v_and_b32 v21, 2, v2
    v_add_u32 v20, v20, v21
    s_and_b32 s43, s20, 1
    s_lshl_b32 s43, s43, 11
    s_bfe_u32 s40, s20, 0x20001
    s_lshl_b32 s40, s40, 7
    s_add_u32 s43, s43, s40
    s_and_b32 s40, s21, 1
    s_lshl_b32 s40, s40, 6
    s_add_u32 s43, s43, s40
    s_lshr_b32 s40, s20, 3
    s_lshl_b32 s40, s40, 2
    s_add_u32 s43, s43, s40
    v_add_u32 v20, s43, v20
    v_lshlrev_b32 v20, 1, v20
    buffer_load_dword v21, v20, s[4:7], 0 offen
    s_waitcnt vmcnt(32)
    s_barrier
    v_xor_b32 v13, 0, v11
    v_add_u32 v13, 0x0, v13
    ds_read_b64_tr_b16 a[0:1], v13
    ds_read_b64_tr_b16 a[2:3], v13 offset:1024
    ds_read_b64_tr_b16 a[4:5], v13 offset:16384
    ds_read_b64_tr_b16 a[6:7], v13 offset:17408
    ds_read_b64_tr_b16 a[16:17], v13 offset:4096
    ds_read_b64_tr_b16 a[18:19], v13 offset:5120
    ds_read_b64_tr_b16 a[20:21], v13 offset:20480
    ds_read_b64_tr_b16 a[22:23], v13 offset:21504
    s_waitcnt lgkmcnt(0)
    v_xor_b32 v13, 32, v11
    v_add_u32 v13, 0x0, v13
    ds_read_b64_tr_b16 a[8:9], v13
    ds_read_b64_tr_b16 a[10:11], v13 offset:1024
    ds_read_b64_tr_b16 a[12:13], v13 offset:16384
    ds_read_b64_tr_b16 a[14:15], v13 offset:17408
    ds_read_b64_tr_b16 a[24:25], v13 offset:4096
    ds_read_b64_tr_b16 a[26:27], v13 offset:5120
    ds_read_b64_tr_b16 a[28:29], v13 offset:20480
    ds_read_b64_tr_b16 a[30:31], v13 offset:21504
    s_waitcnt lgkmcnt(0)
    s_barrier
    v_xor_b32 v15, 2, v14
    v_lshl_add_u32 v15, v15, 15, v8
    s_add_u32 s43, s41, 0x0
    s_add_u32 m0, s51, 0x8000
    s_nop 0
    buffer_load_dwordx4 v15, s[12:15], s43 offen lds
    s_add_u32 s43, s41, 0x80000
    s_add_u32 m0, s51, 0x9000
    s_nop 0
    buffer_load_dwordx4 v15, s[12:15], s43 offen lds
    s_add_u32 s43, s41, 0x100000
    s_add_u32 m0, s51, 0xa000
    s_nop 0
    buffer_load_dwordx4 v15, s[12:15], s43 offen lds
    s_add_u32 s43, s41, 0x180000
    s_add_u32 m0, s51, 0xb000
    s_nop 0
    buffer_load_dwordx4 v15, s[12:15], s43 offen lds
    s_add_u32 s43, s41, 0x200000
    s_add_u32 m0, s51, 0xc000
    s_nop 0
    buffer_load_dwordx4 v15, s[12:15], s43 offen lds
    s_add_u32 s43, s41, 0x280000
    s_add_u32 m0, s51, 0xd000
    s_nop 0
    buffer_load_dwordx4 v15, s[12:15], s43 offen lds
    s_add_u32 s43, s41, 0x300000
    s_add_u32 m0, s51, 0xe000
    s_nop 0
    buffer_load_dwordx4 v15, s[12:15], s43 offen lds
    s_add_u32 s43, s41, 0x380000
    s_add_u32 m0, s51, 0xf000
    s_nop 0
    buffer_load_dwordx4 v15, s[12:15], s43 offen lds
    s_waitcnt vmcnt(32)
    s_barrier
    v_xor_b32 v13, 0, v11
    v_add_u32 v13, 0x8000, v13
    ds_read_b64_tr_b16 a[32:33], v13
    ds_read_b64_tr_b16 a[34:35], v13 offset:1024
    ds_read_b64_tr_b16 a[36:37], v13 offset:16384
    ds_read_b64_tr_b16 a[38:39], v13 offset:17408
    ds_read_b64_tr_b16 a[48:49], v13 offset:4096
    ds_read_b64_tr_b16 a[50:51], v13 offset:5120
    ds_read_b64_tr_b16 a[52:53], v13 offset:20480
    ds_read_b64_tr_b16 a[54:55], v13 offset:21504
    s_waitcnt lgkmcnt(0)
    v_xor_b32 v13, 32, v11
    v_add_u32 v13, 0x8000, v13
    ds_read_b64_tr_b16 a[40:41], v13
    ds_read_b64_tr_b16 a[42:43], v13 offset:1024
    ds_read_b64_tr_b16 a[44:45], v13 offset:16384
    ds_read_b64_tr_b16 a[46:47], v13 offset:17408
    ds_read_b64_tr_b16 a[56:57], v13 offset:4096
    ds_read_b64_tr_b16 a[58:59], v13 offset:5120
    ds_read_b64_tr_b16 a[60:61], v13 offset:20480
    ds_read_b64_tr_b16 a[62:63], v13 offset:21504
    s_waitcnt lgkmcnt(0)
    s_barrier
    v_xor_b32 v15, 3, v14
    v_lshl_add_u32 v15, v15, 15, v8
    s_add_u32 s43, s41, 0x0
    s_add_u32 m0, s51, 0x10000
    s_nop 0
    buffer_load_dwordx4 v15, s[12:15], s43 offen lds
    s_add_u32 s43, s41, 0x80000
    s_add_u32 m0, s51, 0x11000
    s_nop 0
    buffer_load_dwordx4 v15, s[12:15], s43 offen lds
    s_add_u32 s43, s41, 0x100000
    s_add_u32 m0, s51, 0x12000
    s_nop 0
    buffer_load_dwordx4 v15, s[12:15], s43 offen lds
    s_add_u32 s43, s41, 0x180000
    s_add_u32 m0, s51, 0x13000
    s_nop 0
    buffer_load_dwordx4 v15, s[12:15], s43 offen lds
    s_add_u32 s43, s41, 0x200000
    s_add_u32 m0, s51, 0x14000
    s_nop 0
    buffer_load_dwordx4 v15, s[12:15], s43 offen lds
    s_add_u32 s43, s41, 0x280000
    s_add_u32 m0, s51, 0x15000
    s_nop 0
    buffer_load_dwordx4 v15, s[12:15], s43 offen lds
    s_add_u32 s43, s41, 0x300000
    s_add_u32 m0, s51, 0x16000
    s_nop 0
    buffer_load_dwordx4 v15, s[12:15], s43 offen lds
    s_add_u32 s43, s41, 0x380000
    s_add_u32 m0, s51, 0x17000
    s_nop 0
    buffer_load_dwordx4 v15, s[12:15], s43 offen lds
    s_waitcnt vmcnt(32)
    s_barrier
    v_xor_b32 v13, 0, v11
    v_add_u32 v13, 0x10000, v13
    ds_read_b64_tr_b16 a[64:65], v13
    ds_read_b64_tr_b16 a[66:67], v13 offset:1024
    ds_read_b64_tr_b16 a[68:69], v13 offset:16384
    ds_read_b64_tr_b16 a[70:71], v13 offset:17408
    ds_read_b64_tr_b16 a[80:81], v13 offset:4096
    ds_read_b64_tr_b16 a[82:83], v13 offset:5120
    ds_read_b64_tr_b16 a[84:85], v13 offset:20480
    ds_read_b64_tr_b16 a[86:87], v13 offset:21504
    s_waitcnt lgkmcnt(0)
    v_xor_b32 v13, 32, v11
    v_add_u32 v13, 0x10000, v13
    ds_read_b64_tr_b16 a[72:73], v13
    ds_read_b64_tr_b16 a[74:75], v13 offset:1024
    ds_read_b64_tr_b16 a[76:77], v13 offset:16384
    ds_read_b64_tr_b16 a[78:79], v13 offset:17408
    ds_read_b64_tr_b16 a[88:89], v13 offset:4096
    ds_read_b64_tr_b16 a[90:91], v13 offset:5120
    ds_read_b64_tr_b16 a[92:93], v13 offset:20480
    ds_read_b64_tr_b16 a[94:95], v13 offset:21504
    s_waitcnt lgkmcnt(0)
    s_barrier
    s_mov_b32 s12, s64
    s_and_b32 s13, s65, 0xffff
    v_xor_b32 v15, 0, v14
    v_lshl_add_u32 v15, v15, 15, v8
    s_add_u32 s43, s41, 0x0
    s_add_u32 m0, s51, 0x18000
    s_nop 0
    buffer_load_dwordx4 v15, s[12:15], s43 offen lds
    s_add_u32 s43, s41, 0x80000
    s_add_u32 m0, s51, 0x19000
    s_nop 0
    buffer_load_dwordx4 v15, s[12:15], s43 offen lds
    s_add_u32 s43, s41, 0x100000
    s_add_u32 m0, s51, 0x1a000
    s_nop 0
    buffer_load_dwordx4 v15, s[12:15], s43 offen lds
    s_add_u32 s43, s41, 0x180000
    s_add_u32 m0, s51, 0x1b000
    s_nop 0
    buffer_load_dwordx4 v15, s[12:15], s43 offen lds
    s_add_u32 s43, s41, 0x200000
    s_add_u32 m0, s51, 0x1c000
    s_nop 0
    buffer_load_dwordx4 v15, s[12:15], s43 offen lds
    s_add_u32 s43, s41, 0x280000
    s_add_u32 m0, s51, 0x1d000
    s_nop 0
    buffer_load_dwordx4 v15, s[12:15], s43 offen lds
    s_add_u32 s43, s41, 0x300000
    s_add_u32 m0, s51, 0x1e000
    s_nop 0
    buffer_load_dwordx4 v15, s[12:15], s43 offen lds
    s_add_u32 s43, s41, 0x380000
    s_add_u32 m0, s51, 0x1f000
    s_nop 0
    buffer_load_dwordx4 v15, s[12:15], s43 offen lds
    s_waitcnt vmcnt(32)
    s_barrier
    v_xor_b32 v13, 0, v11
    v_add_u32 v13, 0x18000, v13
    ds_read_b64_tr_b16 a[96:97], v13
    ds_read_b64_tr_b16 a[98:99], v13 offset:1024
    ds_read_b64_tr_b16 a[100:101], v13 offset:16384
    ds_read_b64_tr_b16 a[102:103], v13 offset:17408
    ds_read_b64_tr_b16 a[112:113], v13 offset:4096
    ds_read_b64_tr_b16 a[114:115], v13 offset:5120
    ds_read_b64_tr_b16 a[116:117], v13 offset:20480
    ds_read_b64_tr_b16 a[118:119], v13 offset:21504
    s_waitcnt lgkmcnt(0)
    v_xor_b32 v13, 32, v11
    v_add_u32 v13, 0x18000, v13
    ds_read_b64_tr_b16 a[104:105], v13
    ds_read_b64_tr_b16 a[106:107], v13 offset:1024
    ds_read_b64_tr_b16 a[108:109], v13 offset:16384
    ds_read_b64_tr_b16 a[110:111], v13 offset:17408
    ds_read_b64_tr_b16 a[120:121], v13 offset:4096
    ds_read_b64_tr_b16 a[122:123], v13 offset:5120
    ds_read_b64_tr_b16 a[124:125], v13 offset:20480
    ds_read_b64_tr_b16 a[126:127], v13 offset:21504
    s_waitcnt lgkmcnt(0)
    s_barrier
    v_xor_b32 v15, 1, v14
    v_lshl_add_u32 v15, v15, 15, v8
    s_add_u32 s43, s41, 0x0
    s_add_u32 m0, s51, 0x20000
    s_nop 0
    buffer_load_dwordx4 v15, s[12:15], s43 offen lds
    s_add_u32 s43, s41, 0x80000
    s_add_u32 m0, s51, 0x21000
    s_nop 0
    buffer_load_dwordx4 v15, s[12:15], s43 offen lds
    s_add_u32 s43, s41, 0x100000
    s_add_u32 m0, s51, 0x22000
    s_nop 0
    buffer_load_dwordx4 v15, s[12:15], s43 offen lds
    s_add_u32 s43, s41, 0x180000
    s_add_u32 m0, s51, 0x23000
    s_nop 0
    buffer_load_dwordx4 v15, s[12:15], s43 offen lds
    s_add_u32 s43, s41, 0x200000
    s_add_u32 m0, s51, 0x24000
    s_nop 0
    buffer_load_dwordx4 v15, s[12:15], s43 offen lds
    s_add_u32 s43, s41, 0x280000
    s_add_u32 m0, s51, 0x25000
    s_nop 0
    buffer_load_dwordx4 v15, s[12:15], s43 offen lds
    s_add_u32 s43, s41, 0x300000
    s_add_u32 m0, s51, 0x26000
    s_nop 0
    buffer_load_dwordx4 v15, s[12:15], s43 offen lds
    s_add_u32 s43, s41, 0x380000
    s_add_u32 m0, s51, 0x27000
    s_nop 0
    buffer_load_dwordx4 v15, s[12:15], s43 offen lds
    s_waitcnt vmcnt(24)
    v_min_u32 v21, 0xfffffffe, v21
    s_mov_b32 s43, 0x10000
    s_mov_b64 exec, s[38:39]
    buffer_store_dword v21, v119, s[8:11], s43 offen
    s_mov_b64 exec, -1
    s_barrier
    v_xor_b32 v13, 0, v11
    v_add_u32 v13, 0x0, v13
    ds_read_b64_tr_b16 a[128:129], v13
    ds_read_b64_tr_b16 a[130:131], v13 offset:1024
    ds_read_b64_tr_b16 a[132:133], v13 offset:16384
    ds_read_b64_tr_b16 a[134:135], v13 offset:17408
    ds_read_b64_tr_b16 a[144:145], v13 offset:4096
    ds_read_b64_tr_b16 a[146:147], v13 offset:5120
    ds_read_b64_tr_b16 a[148:149], v13 offset:20480
    ds_read_b64_tr_b16 a[150:151], v13 offset:21504
    s_waitcnt lgkmcnt(0)
    v_xor_b32 v13, 32, v11
    v_add_u32 v13, 0x0, v13
    ds_read_b64_tr_b16 a[136:137], v13
    ds_read_b64_tr_b16 a[138:139], v13 offset:1024
    ds_read_b64_tr_b16 a[140:141], v13 offset:16384
    ds_read_b64_tr_b16 a[142:143], v13 offset:17408
    ds_read_b64_tr_b16 a[152:153], v13 offset:4096
    ds_read_b64_tr_b16 a[154:155], v13 offset:5120
    ds_read_b64_tr_b16 a[156:157], v13 offset:20480
    ds_read_b64_tr_b16 a[158:159], v13 offset:21504
    s_waitcnt lgkmcnt(0)
    s_barrier
    v_xor_b32 v15, 2, v14
    v_lshl_add_u32 v15, v15, 15, v8
    s_add_u32 s43, s41, 0x0
    s_add_u32 m0, s51, 0x8000
    s_nop 0
    buffer_load_dwordx4 v15, s[12:15], s43 offen lds
    s_add_u32 s43, s41, 0x80000
    s_add_u32 m0, s51, 0x9000
    s_nop 0
    buffer_load_dwordx4 v15, s[12:15], s43 offen lds
    s_add_u32 s43, s41, 0x100000
    s_add_u32 m0, s51, 0xa000
    s_nop 0
    buffer_load_dwordx4 v15, s[12:15], s43 offen lds
    s_add_u32 s43, s41, 0x180000
    s_add_u32 m0, s51, 0xb000
    s_nop 0
    buffer_load_dwordx4 v15, s[12:15], s43 offen lds
    s_add_u32 s43, s41, 0x200000
    s_add_u32 m0, s51, 0xc000
    s_nop 0
    buffer_load_dwordx4 v15, s[12:15], s43 offen lds
    s_add_u32 s43, s41, 0x280000
    s_add_u32 m0, s51, 0xd000
    s_nop 0
    buffer_load_dwordx4 v15, s[12:15], s43 offen lds
    s_add_u32 s43, s41, 0x300000
    s_add_u32 m0, s51, 0xe000
    s_nop 0
    buffer_load_dwordx4 v15, s[12:15], s43 offen lds
    s_add_u32 s43, s41, 0x380000
    s_add_u32 m0, s51, 0xf000
    s_nop 0
    buffer_load_dwordx4 v15, s[12:15], s43 offen lds
    s_waitcnt vmcnt(24)
    s_barrier
    v_xor_b32 v13, 0, v11
    v_add_u32 v13, 0x8000, v13
    ds_read_b64_tr_b16 a[160:161], v13
    ds_read_b64_tr_b16 a[162:163], v13 offset:1024
    ds_read_b64_tr_b16 a[164:165], v13 offset:16384
    ds_read_b64_tr_b16 a[166:167], v13 offset:17408
    ds_read_b64_tr_b16 a[176:177], v13 offset:4096
    ds_read_b64_tr_b16 a[178:179], v13 offset:5120
    ds_read_b64_tr_b16 a[180:181], v13 offset:20480
    ds_read_b64_tr_b16 a[182:183], v13 offset:21504
    s_waitcnt lgkmcnt(0)
    v_xor_b32 v13, 32, v11
    v_add_u32 v13, 0x8000, v13
    ds_read_b64_tr_b16 a[168:169], v13
    ds_read_b64_tr_b16 a[170:171], v13 offset:1024
    ds_read_b64_tr_b16 a[172:173], v13 offset:16384
    ds_read_b64_tr_b16 a[174:175], v13 offset:17408
    ds_read_b64_tr_b16 a[184:185], v13 offset:4096
    ds_read_b64_tr_b16 a[186:187], v13 offset:5120
    ds_read_b64_tr_b16 a[188:189], v13 offset:20480
    ds_read_b64_tr_b16 a[190:191], v13 offset:21504
    s_waitcnt lgkmcnt(0)
    s_barrier
    v_xor_b32 v15, 3, v14
    v_lshl_add_u32 v15, v15, 15, v8
    s_add_u32 s43, s41, 0x0
    s_add_u32 m0, s51, 0x10000
    s_nop 0
    buffer_load_dwordx4 v15, s[12:15], s43 offen lds
    s_add_u32 s43, s41, 0x80000
    s_add_u32 m0, s51, 0x11000
    s_nop 0
    buffer_load_dwordx4 v15, s[12:15], s43 offen lds
    s_add_u32 s43, s41, 0x100000
    s_add_u32 m0, s51, 0x12000
    s_nop 0
    buffer_load_dwordx4 v15, s[12:15], s43 offen lds
    s_add_u32 s43, s41, 0x180000
    s_add_u32 m0, s51, 0x13000
    s_nop 0
    buffer_load_dwordx4 v15, s[12:15], s43 offen lds
    s_add_u32 s43, s41, 0x200000
    s_add_u32 m0, s51, 0x14000
    s_nop 0
    buffer_load_dwordx4 v15, s[12:15], s43 offen lds
    s_add_u32 s43, s41, 0x280000
    s_add_u32 m0, s51, 0x15000
    s_nop 0
    buffer_load_dwordx4 v15, s[12:15], s43 offen lds
    s_add_u32 s43, s41, 0x300000
    s_add_u32 m0, s51, 0x16000
    s_nop 0
    buffer_load_dwordx4 v15, s[12:15], s43 offen lds
    s_add_u32 s43, s41, 0x380000
    s_add_u32 m0, s51, 0x17000
    s_nop 0
    buffer_load_dwordx4 v15, s[12:15], s43 offen lds
    s_waitcnt vmcnt(24)
    s_barrier
    v_xor_b32 v13, 0, v11
    v_add_u32 v13, 0x10000, v13
    ds_read_b64_tr_b16 a[192:193], v13
    ds_read_b64_tr_b16 a[194:195], v13 offset:1024
    ds_read_b64_tr_b16 a[196:197], v13 offset:16384
    ds_read_b64_tr_b16 a[198:199], v13 offset:17408
    ds_read_b64_tr_b16 a[208:209], v13 offset:4096
    ds_read_b64_tr_b16 a[210:211], v13 offset:5120
    ds_read_b64_tr_b16 a[212:213], v13 offset:20480
    ds_read_b64_tr_b16 a[214:215], v13 offset:21504
    s_waitcnt lgkmcnt(0)
    v_xor_b32 v13, 32, v11
    v_add_u32 v13, 0x10000, v13
    ds_read_b64_tr_b16 a[200:201], v13
    ds_read_b64_tr_b16 a[202:203], v13 offset:1024
    ds_read_b64_tr_b16 a[204:205], v13 offset:16384
    ds_read_b64_tr_b16 a[206:207], v13 offset:17408
    ds_read_b64_tr_b16 a[216:217], v13 offset:4096
    ds_read_b64_tr_b16 a[218:219], v13 offset:5120
    ds_read_b64_tr_b16 a[220:221], v13 offset:20480
    ds_read_b64_tr_b16 a[222:223], v13 offset:21504
    s_waitcnt lgkmcnt(0)
    s_barrier
    s_mov_b32 s12, s66
    s_and_b32 s13, s67, 0xffff
    s_add_u32 s43, s42, 0x0
    s_add_u32 m0, s51, 0x18000
    s_nop 0
    buffer_load_dwordx4 v10, s[12:15], s43 offen lds
    s_add_u32 s43, s42, 0x4000
    s_add_u32 m0, s51, 0x19000
    s_nop 0
    buffer_load_dwordx4 v9, s[12:15], s43 offen lds
    s_add_u32 s43, s42, 0x8000
    s_add_u32 m0, s51, 0x1a000
    s_nop 0
    buffer_load_dwordx4 v10, s[12:15], s43 offen lds
    s_add_u32 s43, s42, 0xc000
    s_add_u32 m0, s51, 0x1b000
    s_nop 0
    buffer_load_dwordx4 v9, s[12:15], s43 offen lds
    s_add_u32 s43, s42, 0x10000
    s_add_u32 m0, s51, 0x1c000
    s_nop 0
    buffer_load_dwordx4 v10, s[12:15], s43 offen lds
    s_add_u32 s43, s42, 0x14000
    s_add_u32 m0, s51, 0x1d000
    s_nop 0
    buffer_load_dwordx4 v9, s[12:15], s43 offen lds
    s_add_u32 s43, s42, 0x18000
    s_add_u32 m0, s51, 0x1e000
    s_nop 0
    buffer_load_dwordx4 v10, s[12:15], s43 offen lds
    s_add_u32 s43, s42, 0x1c000
    s_add_u32 m0, s51, 0x1f000
    s_nop 0
    buffer_load_dwordx4 v9, s[12:15], s43 offen lds
    s_waitcnt vmcnt(24)
    s_barrier
    v_xor_b32 v13, 0, v11
    v_add_u32 v13, 0x18000, v13
    ds_read_b64_tr_b16 a[224:225], v13
    ds_read_b64_tr_b16 a[226:227], v13 offset:1024
    ds_read_b64_tr_b16 a[228:229], v13 offset:16384
    ds_read_b64_tr_b16 a[230:231], v13 offset:17408
    ds_read_b64_tr_b16 a[240:241], v13 offset:4096
    ds_read_b64_tr_b16 a[242:243], v13 offset:5120
    ds_read_b64_tr_b16 a[244:245], v13 offset:20480
    ds_read_b64_tr_b16 a[246:247], v13 offset:21504
    s_waitcnt lgkmcnt(0)
    v_xor_b32 v13, 32, v11
    v_add_u32 v13, 0x18000, v13
    ds_read_b64_tr_b16 a[232:233], v13
    ds_read_b64_tr_b16 a[234:235], v13 offset:1024
    ds_read_b64_tr_b16 a[236:237], v13 offset:16384
    ds_read_b64_tr_b16 a[238:239], v13 offset:17408
    ds_read_b64_tr_b16 a[248:249], v13 offset:4096
    ds_read_b64_tr_b16 a[250:251], v13 offset:5120
    ds_read_b64_tr_b16 a[252:253], v13 offset:20480
    ds_read_b64_tr_b16 a[254:255], v13 offset:21504
    s_waitcnt lgkmcnt(0)
    s_barrier
    s_add_u32 s43, s42, 0x40
    s_add_u32 m0, s51, 0x20000
    s_nop 0
    buffer_load_dwordx4 v10, s[12:15], s43 offen lds
    s_add_u32 s43, s42, 0x4040
    s_add_u32 m0, s51, 0x21000
    s_nop 0
    buffer_load_dwordx4 v9, s[12:15], s43 offen lds
    s_add_u32 s43, s42, 0x8040
    s_add_u32 m0, s51, 0x22000
    s_nop 0
    buffer_load_dwordx4 v10, s[12:15], s43 offen lds
    s_add_u32 s43, s42, 0xc040
    s_add_u32 m0, s51, 0x23000
    s_nop 0
    buffer_load_dwordx4 v9, s[12:15], s43 offen lds
    s_add_u32 s43, s42, 0x10040
    s_add_u32 m0, s51, 0x24000
    s_nop 0
    buffer_load_dwordx4 v10, s[12:15], s43 offen lds
    s_add_u32 s43, s42, 0x14040
    s_add_u32 m0, s51, 0x25000
    s_nop 0
    buffer_load_dwordx4 v9, s[12:15], s43 offen lds
    s_add_u32 s43, s42, 0x18040
    s_add_u32 m0, s51, 0x26000
    s_nop 0
    buffer_load_dwordx4 v10, s[12:15], s43 offen lds
    s_add_u32 s43, s42, 0x1c040
    s_add_u32 m0, s51, 0x27000
    s_nop 0
    buffer_load_dwordx4 v9, s[12:15], s43 offen lds
    s_waitcnt vmcnt(24)
    s_barrier
    v_xor_b32 v13, 0, v11
    v_add_u32 v13, 0x0, v13
    ds_read_b64_tr_b16 v[128:129], v13
    ds_read_b64_tr_b16 v[130:131], v13 offset:1024
    ds_read_b64_tr_b16 v[132:133], v13 offset:16384
    ds_read_b64_tr_b16 v[134:135], v13 offset:17408
    ds_read_b64_tr_b16 v[144:145], v13 offset:4096
    ds_read_b64_tr_b16 v[146:147], v13 offset:5120
    ds_read_b64_tr_b16 v[148:149], v13 offset:20480
    ds_read_b64_tr_b16 v[150:151], v13 offset:21504
    s_waitcnt lgkmcnt(0)
    v_xor_b32 v13, 32, v11
    v_add_u32 v13, 0x0, v13
    ds_read_b64_tr_b16 v[136:137], v13
    ds_read_b64_tr_b16 v[138:139], v13 offset:1024
    ds_read_b64_tr_b16 v[140:141], v13 offset:16384
    ds_read_b64_tr_b16 v[142:143], v13 offset:17408
    ds_read_b64_tr_b16 v[152:153], v13 offset:4096
    ds_read_b64_tr_b16 v[154:155], v13 offset:5120
    ds_read_b64_tr_b16 v[156:157], v13 offset:20480
    ds_read_b64_tr_b16 v[158:159], v13 offset:21504
    s_waitcnt lgkmcnt(0)
    s_barrier
    s_mov_b32 s12, s60
    s_and_b32 s13, s61, 0xffff
    v_xor_b32 v15, 0, v14
    v_lshl_add_u32 v15, v15, 15, v8
    s_add_u32 s43, s41, 0x0
    s_add_u32 m0, s51, 0x8000
    s_nop 0
    buffer_load_dwordx4 v15, s[12:15], s43 offen lds
    s_add_u32 s43, s41, 0x80000
    s_add_u32 m0, s51, 0x9000
    s_nop 0
    buffer_load_dwordx4 v15, s[12:15], s43 offen lds
    s_add_u32 s43, s41, 0x100000
    s_add_u32 m0, s51, 0xa000
    s_nop 0
    buffer_load_dwordx4 v15, s[12:15], s43 offen lds
    s_add_u32 s43, s41, 0x180000
    s_add_u32 m0, s51, 0xb000
    s_nop 0
    buffer_load_dwordx4 v15, s[12:15], s43 offen lds
    s_add_u32 s43, s41, 0x200000
    s_add_u32 m0, s51, 0xc000
    s_nop 0
    buffer_load_dwordx4 v15, s[12:15], s43 offen lds
    s_add_u32 s43, s41, 0x280000
    s_add_u32 m0, s51, 0xd000
    s_nop 0
    buffer_load_dwordx4 v15, s[12:15], s43 offen lds
    s_add_u32 s43, s41, 0x300000
    s_add_u32 m0, s51, 0xe000
    s_nop 0
    buffer_load_dwordx4 v15, s[12:15], s43 offen lds
    s_add_u32 s43, s41, 0x380000
    s_add_u32 m0, s51, 0xf000
    s_nop 0
    buffer_load_dwordx4 v15, s[12:15], s43 offen lds
    s_waitcnt vmcnt(24)
    s_barrier
    s_cmp_lg_u32 s21, 0
    s_cbranch_scc1 L_arr_4
    v_mov_b32 v23, 1
    s_mov_b64 exec, 1
    buffer_atomic_add v23, off, s[16:19], 0 offset:4
    s_mov_b64 exec, -1
L_arr_4:
    v_xor_b32 v13, 0, v11
    v_add_u32 v13, 0x8000, v13
    ds_read_b64_tr_b16 v[160:161], v13
    ds_read_b64_tr_b16 v[162:163], v13 offset:1024
    ds_read_b64_tr_b16 v[164:165], v13 offset:16384
    ds_read_b64_tr_b16 v[166:167], v13 offset:17408
    ds_read_b64_tr_b16 v[176:177], v13 offset:4096
    ds_read_b64_tr_b16 v[178:179], v13 offset:5120
    ds_read_b64_tr_b16 v[180:181], v13 offset:20480
    ds_read_b64_tr_b16 v[182:183], v13 offset:21504
    s_waitcnt lgkmcnt(0)
    v_xor_b32 v13, 32, v11
    v_add_u32 v13, 0x8000, v13
    ds_read_b64_tr_b16 v[168:169], v13
    ds_read_b64_tr_b16 v[170:171], v13 offset:1024
    ds_read_b64_tr_b16 v[172:173], v13 offset:16384
    ds_read_b64_tr_b16 v[174:175], v13 offset:17408
    ds_read_b64_tr_b16 v[184:185], v13 offset:4096
    ds_read_b64_tr_b16 v[186:187], v13 offset:5120
    ds_read_b64_tr_b16 v[188:189], v13 offset:20480
    ds_read_b64_tr_b16 v[190:191], v13 offset:21504
    s_waitcnt lgkmcnt(0)
    s_barrier
    s_mov_b32 s12, s62
    s_and_b32 s13, s63, 0xffff
    v_xor_b32 v15, 0, v14
    v_lshl_add_u32 v15, v15, 15, v8
    s_add_u32 s43, s41, 0x0
    s_add_u32 m0, s51, 0x10000
    s_nop 0
    buffer_load_dwordx4 v15, s[12:15], s43 offen lds
    s_add_u32 s43, s41, 0x80000
    s_add_u32 m0, s51, 0x11000
    s_nop 0
    buffer_load_dwordx4 v15, s[12:15], s43 offen lds
    s_add_u32 s43, s41, 0x100000
    s_add_u32 m0, s51, 0x12000
    s_nop 0
    buffer_load_dwordx4 v15, s[12:15], s43 offen lds
    s_add_u32 s43, s41, 0x180000
    s_add_u32 m0, s51, 0x13000
    s_nop 0
    buffer_load_dwordx4 v15, s[12:15], s43 offen lds
    s_add_u32 s43, s41, 0x200000
    s_add_u32 m0, s51, 0x14000
    s_nop 0
    buffer_load_dwordx4 v15, s[12:15], s43 offen lds
    s_add_u32 s43, s41, 0x280000
    s_add_u32 m0, s51, 0x15000
    s_nop 0
    buffer_load_dwordx4 v15, s[12:15], s43 offen lds
    s_add_u32 s43, s41, 0x300000
    s_add_u32 m0, s51, 0x16000
    s_nop 0
    buffer_load_dwordx4 v15, s[12:15], s43 offen lds
    s_add_u32 s43, s41, 0x380000
    s_add_u32 m0, s51, 0x17000
    s_nop 0
    buffer_load_dwordx4 v15, s[12:15], s43 offen lds
    s_waitcnt vmcnt(24)
    s_barrier
    v_xor_b32 v13, 0x0, v12
    v_add_u32 v13, 0x10000, v13
    ds_read_b64_tr_b16 v[192:193], v13
    ds_read_b64_tr_b16 v[194:195], v13 offset:512
    ds_read_b64_tr_b16 v[196:197], v13 offset:2048
    ds_read_b64_tr_b16 v[198:199], v13 offset:2560
    v_xor_b32 v13, 0x2000, v12
    v_add_u32 v13, 0x10000, v13
    ds_read_b64_tr_b16 v[200:201], v13
    ds_read_b64_tr_b16 v[202:203], v13 offset:512
    ds_read_b64_tr_b16 v[204:205], v13 offset:2048
    ds_read_b64_tr_b16 v[206:207], v13 offset:2560
    s_waitcnt lgkmcnt(0)
    v_xor_b32 v13, 0x4000, v12
    v_add_u32 v13, 0x10000, v13
    ds_read_b64_tr_b16 v[208:209], v13
    ds_read_b64_tr_b16 v[210:211], v13 offset:512
    ds_read_b64_tr_b16 v[212:213], v13 offset:2048
    ds_read_b64_tr_b16 v[214:215], v13 offset:2560
    v_xor_b32 v13, 0x6000, v12
    v_add_u32 v13, 0x10000, v13
    ds_read_b64_tr_b16 v[216:217], v13
    ds_read_b64_tr_b16 v[218:219], v13 offset:512
    ds_read_b64_tr_b16 v[220:221], v13 offset:2048
    ds_read_b64_tr_b16 v[222:223], v13 offset:2560
    s_waitcnt lgkmcnt(0)
    s_barrier
    s_mov_b32 s12, s66
    s_and_b32 s13, s67, 0xffff
    s_add_u32 s43, s42, 0x80
    s_add_u32 m0, s51, 0x18000
    s_nop 0
    buffer_load_dwordx4 v10, s[12:15], s43 offen lds
    s_add_u32 s43, s42, 0x4080
    s_add_u32 m0, s51, 0x19000
    s_nop 0
    buffer_load_dwordx4 v9, s[12:15], s43 offen lds
    s_add_u32 s43, s42, 0x8080
    s_add_u32 m0, s51, 0x1a000
    s_nop 0
    buffer_load_dwordx4 v10, s[12:15], s43 offen lds
    s_add_u32 s43, s42, 0xc080
    s_add_u32 m0, s51, 0x1b000
    s_nop 0
    buffer_load_dwordx4 v9, s[12:15], s43 offen lds
    s_add_u32 s43, s42, 0x10080
    s_add_u32 m0, s51, 0x1c000
    s_nop 0
    buffer_load_dwordx4 v10, s[12:15], s43 offen lds
    s_add_u32 s43, s42, 0x14080
    s_add_u32 m0, s51, 0x1d000
    s_nop 0
    buffer_load_dwordx4 v9, s[12:15], s43 offen lds
    s_add_u32 s43, s42, 0x18080
    s_add_u32 m0, s51, 0x1e000
    s_nop 0
    buffer_load_dwordx4 v10, s[12:15], s43 offen lds
    s_add_u32 s43, s42, 0x1c080
    s_add_u32 m0, s51, 0x1f000
    s_nop 0
    buffer_load_dwordx4 v9, s[12:15], s43 offen lds
    s_waitcnt vmcnt(24)
    s_barrier
    v_xor_b32 v13, 0x0, v12
    v_add_u32 v13, 0x18000, v13
    ds_read_b64_tr_b16 v[224:225], v13
    ds_read_b64_tr_b16 v[226:227], v13 offset:512
    ds_read_b64_tr_b16 v[228:229], v13 offset:2048
    ds_read_b64_tr_b16 v[230:231], v13 offset:2560
    v_xor_b32 v13, 0x2000, v12
    v_add_u32 v13, 0x18000, v13
    ds_read_b64_tr_b16 v[232:233], v13
    ds_read_b64_tr_b16 v[234:235], v13 offset:512
    ds_read_b64_tr_b16 v[236:237], v13 offset:2048
    ds_read_b64_tr_b16 v[238:239], v13 offset:2560
    s_waitcnt lgkmcnt(0)
    v_xor_b32 v13, 0x4000, v12
    v_add_u32 v13, 0x18000, v13
    ds_read_b64_tr_b16 v[240:241], v13
    ds_read_b64_tr_b16 v[242:243], v13 offset:512
    ds_read_b64_tr_b16 v[244:245], v13 offset:2048
    ds_read_b64_tr_b16 v[246:247], v13 offset:2560
    v_xor_b32 v13, 0x6000, v12
    v_add_u32 v13, 0x18000, v13
    ds_read_b64_tr_b16 v[248:249], v13
    ds_read_b64_tr_b16 v[250:251], v13 offset:512
    ds_read_b64_tr_b16 v[252:253], v13 offset:2048
    ds_read_b64_tr_b16 v[254:255], v13 offset:2560
    s_waitcnt lgkmcnt(0)
    s_barrier
    s_lshl_b32 s43, s20, 13
    s_add_u32 s43, s43, 0x100000
    s_add_u32 s43, s43, s52
    s_xor_b32 s40, s43, 0x40000
    buffer_load_dwordx4 v[28:31], v117, s[8:11], s43 offen sc1
    buffer_load_dwordx4 v[28:31], v117, s[8:11], s43 offen offset:1024 sc1
    buffer_load_dwordx4 v[28:31], v117, s[8:11], s40 offen sc1
    buffer_load_dwordx4 v[28:31], v117, s[8:11], s40 offen offset:1024 sc1
    s_mov_b32 s43, 0x10000
    buffer_load_dword v28, v119, s[8:11], s43 offen sc1
    s_mov_b32 s43, 0x12000
    buffer_load_dword v28, v119, s[8:11], s43 offen sc1
    s_mov_b32 s43, 0x14000
    buffer_load_dword v28, v119, s[8:11], s43 offen sc1
    s_mov_b32 s43, 0x16000
    buffer_load_dword v28, v119, s[8:11], s43 offen sc1
    s_add_u32 s43, s42, 0xc0
    s_add_u32 m0, s51, 0x20000
    s_nop 0
    buffer_load_dwordx4 v10, s[12:15], s43 offen lds
    s_add_u32 s43, s42, 0x40c0
    s_add_u32 m0, s51, 0x21000
    s_nop 0
    buffer_load_dwordx4 v9, s[12:15], s43 offen lds
    s_add_u32 s43, s42, 0x80c0
    s_add_u32 m0, s51, 0x22000
    s_nop 0
    buffer_load_dwordx4 v10, s[12:15], s43 offen lds
    s_add_u32 s43, s42, 0xc0c0
    s_add_u32 m0, s51, 0x23000
    s_nop 0
    buffer_load_dwordx4 v9, s[12:15], s43 offen lds
    s_add_u32 s43, s42, 0x100c0
    s_add_u32 m0, s51, 0x24000
    s_nop 0
    buffer_load_dwordx4 v10, s[12:15], s43 offen lds
    s_add_u32 s43, s42, 0x140c0
    s_add_u32 m0, s51, 0x25000
    s_nop 0
    buffer_load_dwordx4 v9, s[12:15], s43 offen lds
    s_add_u32 s43, s42, 0x180c0
    s_add_u32 m0, s51, 0x26000
    s_nop 0
    buffer_load_dwordx4 v10, s[12:15], s43 offen lds
    s_add_u32 s43, s42, 0x1c0c0
    s_add_u32 m0, s51, 0x27000
    s_nop 0
    buffer_load_dwordx4 v9, s[12:15], s43 offen lds
    s_waitcnt vmcnt(32)
    s_barrier
    v_xor_b32 v13, 0, v11
    v_add_u32 v13, 0x0, v13
    ds_read_b64_tr_b16 v[32:33], v13
    ds_read_b64_tr_b16 v[34:35], v13 offset:1024
    ds_read_b64_tr_b16 v[36:37], v13 offset:16384
    ds_read_b64_tr_b16 v[38:39], v13 offset:17408
    ds_read_b64_tr_b16 v[48:49], v13 offset:4096
    ds_read_b64_tr_b16 v[50:51], v13 offset:5120
    ds_read_b64_tr_b16 v[52:53], v13 offset:20480
    ds_read_b64_tr_b16 v[54:55], v13 offset:21504
    s_waitcnt lgkmcnt(0)
    v_xor_b32 v13, 32, v11
    v_add_u32 v13, 0x0, v13
    ds_read_b64_tr_b16 v[40:41], v13
    ds_read_b64_tr_b16 v[42:43], v13 offset:1024
    ds_read_b64_tr_b16 v[44:45], v13 offset:16384
    ds_read_b64_tr_b16 v[46:47], v13 offset:17408
    ds_read_b64_tr_b16 v[56:57], v13 offset:4096
    ds_read_b64_tr_b16 v[58:59], v13 offset:5120
    ds_read_b64_tr_b16 v[60:61], v13 offset:20480
    ds_read_b64_tr_b16 v[62:63], v13 offset:21504
    s_waitcnt lgkmcnt(0)
    s_barrier
    ds_write_b128 v123, v[32:35]
    ds_write_b128 v123, v[36:39] offset:1024
    ds_write_b128 v123, v[40:43] offset:2048
    ds_write_b128 v123, v[44:47] offset:3072
    ds_write_b128 v123, v[48:51] offset:4096
    ds_write_b128 v123, v[52:55] offset:5120
    ds_write_b128 v123, v[56:59] offset:6144
    ds_write_b128 v123, v[60:63] offset:7168
    s_waitcnt vmcnt(24)
    s_barrier
    v_xor_b32 v13, 0, v11
    v_add_u32 v13, 0x8000, v13
    ds_read_b64_tr_b16 v[32:33], v13
    ds_read_b64_tr_b16 v[34:35], v13 offset:1024
    ds_read_b64_tr_b16 v[36:37], v13 offset:16384
    ds_read_b64_tr_b16 v[38:39], v13 offset:17408
    ds_read_b64_tr_b16 v[48:49], v13 offset:4096
    ds_read_b64_tr_b16 v[50:51], v13 offset:5120
    ds_read_b64_tr_b16 v[52:53], v13 offset:20480
    ds_read_b64_tr_b16 v[54:55], v13 offset:21504
    s_waitcnt lgkmcnt(0)
    v_xor_b32 v13, 32, v11
    v_add_u32 v13, 0x8000, v13
    ds_read_b64_tr_b16 v[40:41], v13
    ds_read_b64_tr_b16 v[42:43], v13 offset:1024
    ds_read_b64_tr_b16 v[44:45], v13 offset:16384
    ds_read_b64_tr_b16 v[46:47], v13 offset:17408
    ds_read_b64_tr_b16 v[56:57], v13 offset:4096
    ds_read_b64_tr_b16 v[58:59], v13 offset:5120
    ds_read_b64_tr_b16 v[60:61], v13 offset:20480
    ds_read_b64_tr_b16 v[62:63], v13 offset:21504
    s_waitcnt lgkmcnt(0)
    s_barrier
    ds_write_b128 v123, v[32:35] offset:32768
    ds_write_b128 v123, v[36:39] offset:33792
    ds_write_b128 v123, v[40:43] offset:34816
    ds_write_b128 v123, v[44:47] offset:35840
    ds_write_b128 v123, v[48:51] offset:36864
    ds_write_b128 v123, v[52:55] offset:37888
    ds_write_b128 v123, v[56:59] offset:38912
    ds_write_b128 v123, v[60:63] offset:39936
    s_waitcnt vmcnt(16)
    s_barrier
    v_xor_b32 v13, 0x0, v12
    v_add_u32 v13, 0x10000, v13
    ds_read_b64_tr_b16 v[32:33], v13
    ds_read_b64_tr_b16 v[34:35], v13 offset:512
    ds_read_b64_tr_b16 v[36:37], v13 offset:2048
    ds_read_b64_tr_b16 v[38:39], v13 offset:2560
    v_xor_b32 v13, 0x2000, v12
    v_add_u32 v13, 0x10000, v13
    ds_read_b64_tr_b16 v[40:41], v13
    ds_read_b64_tr_b16 v[42:43], v13 offset:512
    ds_read_b64_tr_b16 v[44:45], v13 offset:2048
    ds_read_b64_tr_b16 v[46:47], v13 offset:2560
    s_waitcnt lgkmcnt(0)
    v_xor_b32 v13, 0x4000, v12
    v_add_u32 v13, 0x10000, v13
    ds_read_b64_tr_b16 v[48:49], v13
    ds_read_b64_tr_b16 v[50:51], v13 offset:512
    ds_read_b64_tr_b16 v[52:53], v13 offset:2048
    ds_read_b64_tr_b16 v[54:55], v13 offset:2560
    v_xor_b32 v13, 0x6000, v12
    v_add_u32 v13, 0x10000, v13
    ds_read_b64_tr_b16 v[56:57], v13
    ds_read_b64_tr_b16 v[58:59], v13 offset:512
    ds_read_b64_tr_b16 v[60:61], v13 offset:2048
    ds_read_b64_tr_b16 v[62:63], v13 offset:2560
    s_waitcnt lgkmcnt(0)
    s_barrier
    ds_write_b128 v124, v[32:35]
    ds_write_b128 v124, v[36:39] offset:1024
    ds_write_b128 v124, v[40:43] offset:2048
    ds_write_b128 v124, v[44:47] offset:3072
    ds_write_b128 v124, v[48:51] offset:4096
    ds_write_b128 v124, v[52:55] offset:5120
    ds_write_b128 v124, v[56:59] offset:6144
    ds_write_b128 v124, v[60:63] offset:7168
    s_waitcnt vmcnt(0)
    v_min_u32 v21, 0xfffffffe, v21
    s_mov_b32 s43, 0x10000
    s_mov_b64 exec, s[38:39]
    buffer_store_dword v21, v119, s[8:11], s43 offen
    s_mov_b64 exec, -1
    v_mov_b32 v16, -1
    v_mov_b32 v17, -1
    v_mov_b32 v18, -1
    v_mov_b32 v19, -1
    s_lshl_b32 s43, s20, 13
    s_add_u32 s43, s43, 0x100000
    s_and_b32 s40, s21, 1
    s_lshl_b32 s40, s40, 12
    s_add_u32 s29, s43, s40
    s_add_u32 s43, s43, s52
    s_xor_b32 s40, s43, 0x40000
    buffer_store_dwordx4 v[16:19], v117, s[8:11], s40 offen
    buffer_store_dwordx4 v[16:19], v117, s[8:11], s40 offen offset:1024
    s_mov_b32 s43, 0x12000
    buffer_store_dword v16, v119, s[8:11], s43 offen
    s_mov_b32 s43, 0x14000
    buffer_store_dword v16, v119, s[8:11], s43 offen
    s_mov_b32 s43, 0x16000
    buffer_store_dword v16, v119, s[8:11], s43 offen
    s_barrier
    v_xor_b32 v13, 0x0, v12
    v_add_u32 v13, 0x18000, v13
    ds_read_b64_tr_b16 v[32:33], v13
    ds_read_b64_tr_b16 v[34:35], v13 offset:512
    ds_read_b64_tr_b16 v[36:37], v13 offset:2048
    ds_read_b64_tr_b16 v[38:39], v13 offset:2560
    v_xor_b32 v13, 0x2000, v12
    v_add_u32 v13, 0x18000, v13
    ds_read_b64_tr_b16 v[40:41], v13
    ds_read_b64_tr_b16 v[42:43], v13 offset:512
    ds_read_b64_tr_b16 v[44:45], v13 offset:2048
    ds_read_b64_tr_b16 v[46:47], v13 offset:2560
    s_waitcnt lgkmcnt(0)
    v_xor_b32 v13, 0x4000, v12
    v_add_u32 v13, 0x18000, v13
    ds_read_b64_tr_b16 v[48:49], v13
    ds_read_b64_tr_b16 v[50:51], v13 offset:512
    ds_read_b64_tr_b16 v[52:53], v13 offset:2048
    ds_read_b64_tr_b16 v[54:55], v13 offset:2560
    v_xor_b32 v13, 0x6000, v12
    v_add_u32 v13, 0x18000, v13
    ds_read_b64_tr_b16 v[56:57], v13
    ds_read_b64_tr_b16 v[58:59], v13 offset:512
    ds_read_b64_tr_b16 v[60:61], v13 offset:2048
    ds_read_b64_tr_b16 v[62:63], v13 offset:2560
    s_waitcnt lgkmcnt(0)
    s_barrier
    ds_write_b128 v124, v[32:35] offset:32768
    ds_write_b128 v124, v[36:39] offset:33792
    ds_write_b128 v124, v[40:43] offset:34816
    ds_write_b128 v124, v[44:47] offset:35840
    ds_write_b128 v124, v[48:51] offset:36864
    ds_write_b128 v124, v[52:55] offset:37888
    ds_write_b128 v124, v[56:59] offset:38912
    ds_write_b128 v124, v[60:63] offset:39936
    s_waitcnt lgkmcnt(0)
    s_mov_b32 s96, 0
L_mode_5:
    buffer_load_dwordx2 v[2:3], off, s[92:95], 0 offset:36 sc1
    s_waitcnt vmcnt(0)
    v_readfirstlane_b32 s87, v2
    v_readfirstlane_b32 s97, v3
    s_nop 0
    s_min_u32 s97, s97, s87
    s_cmp_lg_u32 s97, 0
    s_cbranch_scc1 L_moded_6
    s_sleep 4
    s_add_u32 s96, s96, 1
    s_cmp_lg_u32 s96, 0x100
    s_cbranch_scc1 L_modef_7
    v_mov_b32 v2, 2
    v_mov_b32 v3, 0
    s_mov_b64 exec, 1
    buffer_atomic_cmpswap v[2:3], off, s[92:95], 0 offset:36
    s_mov_b64 exec, -1
L_modef_7:
    s_cmp_lt_u32 s96, 0x10000
    s_cbranch_scc1 L_mode_5
L_moded_6:
    s_cmp_lg_u32 s87, 1
    s_cbranch_scc1 L_fallback
    v_lshrrev_b32 v1, 4, v117
    v_and_b32 v2, 15, v1
    v_lshrrev_b32 v1, 4, v1
    v_lshlrev_b32 v1, 11, v1
    v_lshl_add_u32 v1, v2, 2, v1
    s_lshl_b32 s43, s20, 6
    s_add_u32 s43, s43, 0x2000
    s_cmp_lg_u32 s100, 0
    s_cbranch_scc1 L_polls_10
    s_mov_b32 exec_lo, 0x10001
    s_mov_b32 exec_hi, 0
    s_mov_b32 s96, 0
L_poll_8:
    buffer_load_dword v2, v1, s[8:11], s43 offen sc1
    s_waitcnt vmcnt(0)
    v_cmp_gt_u32 vcc, 1, v2
    s_cbranch_vccz L_polld_9
    s_sleep 4
    s_add_u32 s96, s96, 1
    s_cmp_lt_u32 s96, 0x10000
    s_cbranch_scc1 L_poll_8
L_polld_9:
    s_mov_b64 exec, -1
L_polls_10:
    s_barrier
    s_mov_b32 s22, 0
    s_mov_b32 s33, 0
    s_xor_b32 s53, s29, 1024
    s_add_u32 s23, s51, 0x10000
    s_add_u32 s48, s23, 4096
    s_mov_b32 s24, 0x12000
    s_add_u32 s55, s24, 16384
    s_mov_b32 s25, 0x100000
    s_mov_b32 s26, 0x101000
    s_lshl_b32 s43, s20, 13
    v_mov_b32 v112, 0
    v_mov_b32 v113, 0
    v_mov_b32 v114, 0
    v_mov_b32 v115, 0
    s_add_u32 s43, s43, s52
    s_add_u32 s30, s43, 0x1000000
    s_add_u32 s31, s43, 0x2000000
    s_lshr_b32 s43, s43, 1
    s_add_u32 s32, s43, 0x220000
    s_add_u32 m0, s52, 8192
    s_nop 0
    buffer_load_dwordx4 v117, s[8:11], s30 offen lds
    buffer_load_dwordx4 v117, s[8:11], s30 offen offset:1024 lds
    s_add_u32 m0, s52, 0x6000
    s_nop 0
    buffer_load_dwordx4 v117, s[8:11], s31 offen lds
    buffer_load_dwordx4 v117, s[8:11], s31 offen offset:1024 lds
    s_add_u32 m0, s51, 4096
    ds_write_b128 v117, v[112:115] offset:22528
    ds_write_b128 v117, v[112:115] offset:23552
    s_cmp_lg_u32 s21, 0
    s_cselect_b32 s40, -1, 0
    v_mov_b32 v126, s40
    v_bfe_u32 v1, v117, 4, 1
    v_lshlrev_b32 v1, 4, v1
    s_movk_i32 s43, 0x3f80
    v_lshlrev_b32 v125, v1, s43
    v_bfe_u32 v1, v117, 5, 3
    v_cmp_eq_u32 s[68:69], 0, v1
    v_cmp_eq_u32 s[70:71], 1, v1
    v_cmp_eq_u32 s[72:73], 2, v1
    v_cmp_eq_u32 s[74:75], 3, v1
    v_lshrrev_b32 v1, 2, v117
    s_cmp_lt_u32 s21, 2
    s_cselect_b64 vcc, -1, 0
    v_cndmask_b32 v119, v119, v1, vcc
    v_mov_b32 v32, 0
    v_mov_b32 v33, 0
    v_mov_b32 v34, 0
    v_mov_b32 v35, 0
    v_mov_b32 v36, 0
    v_mov_b32 v37, 0
    v_mov_b32 v38, 0
    v_mov_b32 v39, 0
    v_mov_b32 v40, 0
    v_mov_b32 v41, 0
    v_mov_b32 v42, 0
    v_mov_b32 v43, 0
    v_mov_b32 v44, 0
    v_mov_b32 v45, 0
    v_mov_b32 v46, 0
    v_mov_b32 v47, 0
    v_mov_b32 v48, 0
    v_mov_b32 v49, 0
    v_mov_b32 v50, 0
    v_mov_b32 v51, 0
    v_mov_b32 v52, 0
    v_mov_b32 v53, 0
    v_mov_b32 v54, 0
    v_mov_b32 v55, 0
    s_add_u32 s30, s30, 0x40000
    s_add_u32 s31, s31, 0x40000
    s_mov_b32 s45, 0
    s_mov_b32 s46, 0
    s_mov_b32 s47, 0
    s_mov_b32 s76, 0
    s_and_b32 s43, s21, 1
    s_lshl_b32 s43, s43, 5
    s_add_u32 s43, s43, s20
    s_lshl_b32 s43, s43, 6
    s_add_u32 s28, s43, 0x2000
    s_mov_b32 s59, 0
    ds_read_b128 v[80:83], v123
    ds_read_b128 v[84:87], v123 offset:1024
    ds_read_b128 v[56:59], v123 offset:2048
    ds_read_b128 v[60:63], v123 offset:3072
    ds_read_b128 v[64:67], v123 offset:32768
    ds_read_b128 v[68:71], v123 offset:33792
    ds_read_b128 v[72:75], v123 offset:34816
    ds_read_b128 v[76:79], v123 offset:35840
    ds_read_b128 v[88:91], v123 offset:4096
    ds_read_b128 v[92:95], v123 offset:5120
    ds_read_b128 v[96:99], v123 offset:6144
    ds_read_b128 v[100:103], v123 offset:7168
    ds_read_b128 v[104:107], v123 offset:36864
    ds_read_b128 v[108:111], v123 offset:37888
    ds_read_b128 v[24:27], v123 offset:38912
    ds_read_b128 v[28:31], v123 offset:39936
    s_cmp_lg_u32 s21, 0
    s_cbranch_scc1 L_cb_skip_11
    v_mov_b32 v1, 4
    s_mov_b64 exec, 1
    s_mov_b32 s49, 0
L_cb_poll_12:
    buffer_load_dword v3, v1, s[16:19], 0 offen sc1
    s_waitcnt vmcnt(0)
    v_readfirstlane_b32 s43, v3
    s_nop 0
    s_cmp_ge_u32 s43, 32
    s_cbranch_scc1 L_cb_done_13
    s_sleep 2
    s_add_u32 s49, s49, 1
    s_cmp_lt_u32 s49, 0x40000
    s_cbranch_scc1 L_cb_poll_12
L_cb_done_13:
    s_mov_b64 exec, -1
L_cb_skip_11:
    s_mov_b32 s49, 0
    s_lshr_b32 s43, s20, 1
    s_lshl_b32 s43, s43, 7
    s_and_b32 s40, s20, 1
    s_lshl_b32 s40, s40, 4
    s_add_u32 s43, s43, s40
    s_add_u32 s44, s43, 0x1000
    s_cmp_eq_u32 s21, 0
    s_cselect_b32 s44, s44, 0x7ff00000
    s_waitcnt vmcnt(0) lgkmcnt(0)
    s_barrier
    buffer_load_dwordx4 v[0:3], v117, s[8:11], s23 offen sc1
    s_waitcnt vmcnt(0) lgkmcnt(0)
    s_cmp_eq_u32 s21, 1
    s_cbranch_scc1 L_chain_top1_f
    s_cmp_eq_u32 s21, 2
    s_cbranch_scc1 L_chain_top2_f
    s_cmp_eq_u32 s21, 3
    s_cbranch_scc1 L_chain_top3_f
.p2align 6
L_chain_top0_f:
    buffer_load_dwordx4 v[0:3], v117, s[8:11], s23 offen nt
    v_mov_b32 v15, 0
    v_mov_b32 v15, 0
    v_mov_b32 v15, 0
    v_mov_b32 v15, 0
    v_mov_b32 v15, 0
    v_mov_b32 v15, 0
    v_mov_b32 v15, 0
    v_mov_b32 v15, 0
    v_mov_b32 v15, 0
    v_mov_b32 v15, 0
    v_mov_b32 v15, 0
    v_mov_b32 v15, 0
    v_mov_b32 v15, 0
    v_mov_b32 v15, 0
    v_mov_b32 v15, 0
    v_mov_b32 v15, 0
    buffer_load_dwordx4 v[0:3], v117, s[8:11], s23 offen sc1
    v_mov_b32 v15, 0
    v_mov_b32 v15, 0
    v_mov_b32 v15, 0
    v_mov_b32 v15, 0
    v_mov_b32 v15, 0
    v_mov_b32 v15, 0
    v_mov_b32 v15, 0
    v_mov_b32 v15, 0
    v_mov_b32 v15, 0
    v_mov_b32 v15, 0
    v_mov_b32 v15, 0
    v_mov_b32 v15, 0
    v_mov_b32 v15, 0
    v_mov_b32 v15, 0
    v_mov_b32 v15, 0
    v_mov_b32 v15, 0
L_mret_14:
    buffer_load_dwordx4 v[0:3], v117, s[8:11], s23 offen sc1
    s_add_u32 s45, s45, 1
    s_cmp_lt_u32 s45, 0x10000
    s_cselect_b32 s56, -2, -1
    s_nop 3
    v_mov_b32 v32, 0
    v_mov_b32 v33, 0
    v_mov_b32 v34, 0
    v_mov_b32 v35, 0
    s_waitcnt vmcnt(2)
    v_max3_u32 v15, v0, v1, v2
    v_max_u32 v15, v15, v3
    v_cmp_lt_u32 vcc, s56, v15
    v_smfmac_f32_16x16x64_bf16 v[32:35], v[0:3], v[80:87], v116
    s_cbranch_vccnz L_mret_14
    ds_write_b128 v117, v[0:3]
    v_smfmac_f32_16x16x64_bf16 v[36:39], v[0:3], v[56:63], v116
    buffer_load_dwordx4 v[4:7], v117, s[8:11], s48 offen nt
    v_smfmac_f32_16x16x64_bf16 v[40:43], v[0:3], v[64:71], v116
    buffer_load_dwordx4 v117, s[8:11], s48 offen nt lds
    s_mov_b32 m0, 8192
    v_smfmac_f32_16x16x64_bf16 v[44:47], v[0:3], v[72:79], v116
    s_waitcnt lgkmcnt(0)
    s_barrier
    ds_read_b128 v[8:11], v117 offset:1024
    v_smfmac_f32_16x16x64_bf16 v[48:51], v[0:3], a[192:199], v116
    ds_read_b128 v[16:19], v117 offset:2048
    ds_read_b128 v[20:23], v117 offset:3072
    v_smfmac_f32_16x16x64_bf16 v[52:55], v[0:3], a[200:207], v116
    ds_read_b128 v[80:83], v117 offset:14336
    s_waitcnt lgkmcnt(3)
    v_smfmac_f32_16x16x64_bf16 v[32:35], v[8:11], a[0:7], v116
    ds_read_b128 v[84:87], v117 offset:15360
    v_smfmac_f32_16x16x64_bf16 v[36:39], v[8:11], a[8:15], v116
    buffer_store_dwordx4 v[112:115], v117, s[8:11], s32 offen sc1
    s_waitcnt lgkmcnt(3)
    v_smfmac_f32_16x16x64_bf16 v[32:35], v[16:19], a[32:39], v116
    ds_read_b128 v[56:59], v117 offset:8192
    v_smfmac_f32_16x16x64_bf16 v[36:39], v[16:19], a[40:47], v116
    ds_read_b128 v[60:63], v117 offset:9216
    s_waitcnt lgkmcnt(4)
    v_smfmac_f32_16x16x64_bf16 v[32:35], v[20:23], a[64:71], v116
    ds_read_b128 v[64:67], v117 offset:10240
    v_smfmac_f32_16x16x64_bf16 v[36:39], v[20:23], a[72:79], v116
    ds_read_b128 v[68:71], v117 offset:11264
    v_smfmac_f32_16x16x64_bf16 v[40:43], v[8:11], a[96:103], v116
    ds_read_b128 v[72:75], v117 offset:12288
    v_smfmac_f32_16x16x64_bf16 v[40:43], v[16:19], a[128:135], v116
    ds_read_b128 v[76:79], v117 offset:13312
    v_smfmac_f32_16x16x64_bf16 v[40:43], v[20:23], a[160:167], v116
    s_waitcnt vmcnt(2)
    v_max3_u32 v15, v4, v5, v6
    v_smfmac_f32_16x16x64_bf16 v[44:47], v[8:11], a[104:111], v116
    v_max_u32 v15, v15, v7
    v_smfmac_f32_16x16x64_bf16 v[44:47], v[16:19], a[136:143], v116
    s_waitcnt vmcnt(1) lgkmcnt(0)
    v_cmp_lt_u32 vcc, s56, v15
    v_smfmac_f32_16x16x64_bf16 v[44:47], v[20:23], a[168:175], v116
    s_cbranch_vccnz L_mret_15
L_mgo_16:
    v_smfmac_f32_16x16x64_bf16 v[44:47], v[4:7], v[24:31], v116
    s_barrier
    ds_read_b128 v[12:15], v117 offset:5120
    v_smfmac_f32_16x16x64_bf16 v[32:35], v[4:7], v[88:95], v116
    ds_read_b128 v[24:27], v117 offset:6144
    v_smfmac_f32_16x16x64_bf16 v[36:39], v[4:7], v[96:103], v116
    ds_read_b128 v[28:31], v117 offset:7168
    v_smfmac_f32_16x16x64_bf16 v[40:43], v[4:7], v[104:111], v116
    ds_read_b128 v[88:91], v117 offset:24576
    s_waitcnt lgkmcnt(3)
    v_smfmac_f32_16x16x64_bf16 v[32:35], v[12:15], a[16:23], v116
    ds_read_b128 v[92:95], v117 offset:25600
    s_waitcnt lgkmcnt(3)
    v_smfmac_f32_16x16x64_bf16 v[32:35], v[24:27], a[48:55], v116
    buffer_load_dwordx4 v117, s[8:11], s30 offen lds
    s_waitcnt lgkmcnt(2)
    v_smfmac_f32_16x16x64_bf16 v[32:35], v[28:31], a[80:87], v116
    ds_read_b128 v[96:99], v117 offset:23552
    v_smfmac_f32_16x16x64_bf16 v[36:39], v[12:15], a[24:31], v116
    ds_read_b128 v[100:103], v117 offset:23552
    v_smfmac_f32_16x16x64_bf16 v[36:39], v[24:27], a[56:63], v116
    buffer_load_dwordx4 v117, s[8:11], s30 offen offset:1024 lds
    s_add_u32 m0, s52, 0x6000
    v_add_f32 v32, v32, v34
    v_smfmac_f32_16x16x64_bf16 v[36:39], v[28:31], a[88:95], v116
    ds_read_b128 v[104:107], v117 offset:23552
    v_add_f32 v33, v33, v35
    v_smfmac_f32_16x16x64_bf16 v[40:43], v[12:15], a[112:119], v116
    ds_read_b128 v[108:111], v117 offset:23552
    v_mul_f32 v32, s34, v32
    v_smfmac_f32_16x16x64_bf16 v[40:43], v[24:27], a[144:151], v116
    buffer_load_dword v125, v119, s[8:11], s28 offen sc1
    v_mul_f32 v33, s34, v33
    v_smfmac_f32_16x16x64_bf16 v[40:43], v[28:31], a[176:183], v116
    ds_read_b128 v[0:3], v124
    v_add_f32 v36, v36, v38
    v_smfmac_f32_16x16x64_bf16 v[48:51], v[4:7], a[208:215], v116
    v_add_f32 v37, v37, v39
    v_smfmac_f32_16x16x64_bf16 v[52:55], v[4:7], a[216:223], v116
    s_waitcnt lgkmcnt(5)
    buffer_load_dwordx4 v117, s[8:11], s31 offen lds
    v_mul_f32 v36, s34, v36
    v_smfmac_f32_16x16x64_bf16 v[44:47], v[12:15], a[120:127], v116
    ds_read_b128 v[4:7], v124 offset:1024
    v_mul_f32 v37, s34, v37
    v_smfmac_f32_16x16x64_bf16 v[44:47], v[24:27], a[152:159], v116
    v_cvt_pk_bf16_f32 v34, v32, v36
    v_smfmac_f32_16x16x64_bf16 v[44:47], v[28:31], a[184:191], v116
    buffer_load_dwordx4 v117, s[8:11], s31 offen offset:1024 lds
    s_mov_b32 m0, 4096
    v_cvt_pk_bf16_f32 v35, v33, v37
    v_add_f32 v40, v40, v42
    v_smfmac_f32_16x16x64_bf16 v[48:51], v[8:11], a[224:231], v116
    ds_write2_b32 v120, v34, v35 offset0:32 offset1:48
    v_add_f32 v41, v41, v43
    v_smfmac_f32_16x16x64_bf16 v[52:55], v[8:11], a[232:239], v116
    v_add_f32 v44, v44, v46
    v_add_f32 v45, v45, v47
    v_cvt_pk_bf16_f32 v113, v40, v44
    v_cvt_pk_bf16_f32 v115, v41, v45
    v_smfmac_f32_16x16x64_bf16 v[48:51], v[12:15], a[240:247], v116
    ds_write2_b32 v120, v113, v115 offset0:0 offset1:16
    v_smfmac_f32_16x16x64_bf16 v[52:55], v[12:15], a[248:255], v116
    s_cmp_eq_u32 s22, 63
    s_cbranch_scc1 L_chain_last_f
    buffer_store_dword v126, off, s[8:11], s44 sc1
    v_smfmac_f32_16x16x64_bf16 v[48:51], v[16:19], v[128:135], v116
    v_smfmac_f32_16x16x64_bf16 v[48:51], v[20:23], v[160:167], v116
    v_smfmac_f32_16x16x64_bf16 v[48:51], v[24:27], v[144:151], v116
    s_waitcnt lgkmcnt(0)
    s_barrier
    v_smfmac_f32_16x16x64_bf16 v[48:51], v[28:31], v[176:183], v116
    ds_read_b128 v[32:35], v121 offset:16384
    ds_read_b128 v[36:39], v121 offset:17408
    v_smfmac_f32_16x16x64_bf16 v[52:55], v[16:19], v[136:143], v116
    ds_read_b128 v[40:43], v121 offset:18432
    ds_read_b128 v[44:47], v121 offset:19456
    v_smfmac_f32_16x16x64_bf16 v[52:55], v[20:23], v[168:175], v116
    ds_read_b128 v[8:11], v124 offset:32768
    v_add_f32 v48, v48, v50
    v_smfmac_f32_16x16x64_bf16 v[52:55], v[24:27], v[152:159], v116
    ds_read_b128 v[12:15], v124 offset:33792
    v_add_f32 v49, v49, v51
    v_smfmac_f32_16x16x64_bf16 v[52:55], v[28:31], v[184:191], v116
    s_waitcnt lgkmcnt(5)
    v_cvt_pk_bf16_f32 v112, v48, v49
    v_mfma_f32_16x16x32_bf16 v[56:59], v[56:59], v[32:35], 0
    s_waitcnt lgkmcnt(4)
    v_mov_b32 v48, s50
    v_mov_b32 v49, s50
    v_mfma_f32_16x16x32_bf16 v[56:59], v[60:63], v[36:39], v[56:59]
    ds_read_b128 v[16:19], v124 offset:2048
    s_waitcnt lgkmcnt(4)
    v_mov_b32 v50, s50
    v_mov_b32 v51, s50
    v_mfma_f32_16x16x32_bf16 v[56:59], v[64:67], v[40:43], v[56:59]
    ds_read_b128 v[20:23], v124 offset:3072
    s_waitcnt lgkmcnt(4)
    v_add_f32 v52, v52, v54
    v_mfma_f32_16x16x32_bf16 v[56:59], v[68:71], v[44:47], v[56:59]
    ds_read_b128 v[24:27], v124 offset:4096
    v_add_f32 v53, v53, v55
    v_mfma_f32_16x16x32_bf16 v[60:63], v[72:75], v[32:35], 0
    ds_read_b128 v[28:31], v124 offset:5120
    v_cvt_pk_bf16_f32 v114, v52, v53
    v_mov_b32 v53, 0
    v_mfma_f32_16x16x32_bf16 v[60:63], v[76:79], v[36:39], v[60:63]
    v_exp_f32 v56, v56
    v_mfma_f32_16x16x32_bf16 v[60:63], v[80:83], v[40:43], v[60:63]
    v_exp_f32 v57, v57
    v_mfma_f32_16x16x32_bf16 v[60:63], v[84:87], v[44:47], v[60:63]
    v_exp_f32 v58, v58
    v_mfma_f32_16x16x32_bf16 v[64:67], v[32:35], v[32:35], 0
    v_exp_f32 v59, v59
    v_cvt_pk_bf16_f32 v68, v56, v57
    v_mfma_f32_16x16x32_bf16 v[64:67], v[36:39], v[36:39], v[64:67]
    v_exp_f32 v60, v60
    v_cvt_pk_bf16_f32 v69, v58, v59
    v_mfma_f32_16x16x32_bf16 v[64:67], v[40:43], v[40:43], v[64:67]
    v_exp_f32 v61, v61
    v_mfma_f32_16x16x32_bf16 v[64:67], v[44:47], v[44:47], v[64:67]
    v_exp_f32 v62, v62
    v_exp_f32 v63, v63
    v_cvt_pk_bf16_f32 v70, v60, v61
    v_cvt_pk_bf16_f32 v71, v62, v63
    s_nop 1
    v_mfma_f32_16x16x32_bf16 v[72:75], v[88:91], v[68:71], 0
    s_nop 0
    v_exp_f32 v64, v64
    v_mfma_f32_16x16x32_bf16 v[76:79], v[92:95], v[68:71], 0
    v_exp_f32 v65, v65
    v_mfma_f32_16x16x32_bf16 v[80:83], v[48:51], v[68:71], 0
    v_cvt_pk_bf16_f32 v52, v64, v65
    s_nop 1
    v_mfma_f32_16x16x16_bf16 v[72:75], v[112:113], v[52:53], v[72:75]
    ds_read_b128 v[32:35], v124 offset:6144
    v_mfma_f32_16x16x16_bf16 v[76:79], v[114:115], v[52:53], v[76:79]
    ds_read_b128 v[36:39], v124 offset:7168
    v_mfma_f32_16x16x16_bf16 v[80:83], v[48:49], v[52:53], v[80:83]
L_norm_17:
    s_mov_b64 vcc, s[36:37]
    v_mov_b32 v122, v122
    v_mov_b32 v122, v122
    v_mov_b32 v122, v122
    v_cndmask_b32_dpp v76, v72, v76, vcc quad_perm:[2,3,2,3] row_mask:0xf bank_mask:0xf
    v_cndmask_b32_dpp v77, v73, v77, vcc quad_perm:[2,3,2,3] row_mask:0xf bank_mask:0xf
    v_cndmask_b32_dpp v78, v74, v78, vcc quad_perm:[2,3,2,3] row_mask:0xf bank_mask:0xf
    v_cndmask_b32_dpp v79, v75, v79, vcc quad_perm:[2,3,2,3] row_mask:0xf bank_mask:0xf
    v_rcp_f32_dpp v84, v80 quad_perm:[2,3,2,3] row_mask:0xf bank_mask:0xf
    s_nop 0
    v_pk_mul_f32 v[76:77], v[76:77], v[84:85] op_sel_hi:[1,0]
    v_pk_mul_f32 v[78:79], v[78:79], v[84:85] op_sel_hi:[1,0]
    v_cvt_pk_bf16_f32 v72, v76, v77
    v_cvt_pk_bf16_f32 v73, v78, v79
    ds_write_b64 v122, v[72:73] offset:20480
    v_max_f32_dpp v86, v80, v84 quad_perm:[2,3,2,3] row_mask:0xf bank_mask:0xf
    v_mov_b32_dpp v60, v72 quad_perm:[0,1,0,1] row_mask:0xf bank_mask:0xf
    v_mov_b32_dpp v61, v73 quad_perm:[0,1,0,1] row_mask:0xf bank_mask:0xf
    v_cmp_lt_f32 vcc, s35, v86
    v_mov_b32_dpp v62, v72 quad_perm:[2,3,2,3] row_mask:0xf bank_mask:0xf
    v_mov_b32_dpp v63, v73 quad_perm:[2,3,2,3] row_mask:0xf bank_mask:0xf
    s_nop 1
    v_smfmac_f32_16x16x64_bf16 v[96:99], v[60:63], v[192:199], v116
    s_cbranch_vccnz L_smax_18
    v_smfmac_f32_16x16x64_bf16 v[100:103], v[60:63], v[224:231], v116
    s_waitcnt lgkmcnt(0)
    s_barrier
    ds_read_b128 v[92:95], v127 offset:20992
    ds_read_b128 v[80:83], v127 offset:21504
    ds_read_b128 v[84:87], v127 offset:22016
    v_smfmac_f32_16x16x64_bf16 v[104:107], v[60:63], v[0:7], v116
    ds_read_b128 v[40:43], v124 offset:34816
    v_smfmac_f32_16x16x64_bf16 v[108:111], v[60:63], v[8:15], v116
    ds_read_b128 v[56:59], v124 offset:36864
    s_waitcnt lgkmcnt(4)
    v_smfmac_f32_16x16x64_bf16 v[96:99], v[92:95], v[200:207], v116
    s_waitcnt lgkmcnt(3)
    v_smfmac_f32_16x16x64_bf16 v[96:99], v[80:83], v[208:215], v116
    ds_read_b128 v[44:47], v124 offset:35840
    s_waitcnt lgkmcnt(3)
    v_smfmac_f32_16x16x64_bf16 v[96:99], v[84:87], v[216:223], v116
    ds_read_b128 v[68:71], v124 offset:39936
    v_smfmac_f32_16x16x64_bf16 v[100:103], v[92:95], v[232:239], v116
    ds_read_b128 v[64:67], v124 offset:38912
    v_smfmac_f32_16x16x64_bf16 v[100:103], v[80:83], v[240:247], v116
    ds_read_b128 v[60:63], v124 offset:37888
    v_cvt_pk_bf16_f32 v72, v96, v98
    v_smfmac_f32_16x16x64_bf16 v[100:103], v[84:87], v[248:255], v116
    v_and_or_b32 v72, v72, -2, s33
    v_smfmac_f32_16x16x64_bf16 v[104:107], v[92:95], v[16:23], v116
    v_cvt_pk_bf16_f32 v74, v97, v99
    v_smfmac_f32_16x16x64_bf16 v[104:107], v[80:83], v[24:31], v116
    v_cvt_pk_bf16_f32 v73, v100, v102
    v_cvt_pk_bf16_f32 v75, v101, v103
    v_smfmac_f32_16x16x64_bf16 v[104:107], v[84:87], v[32:39], v116
    buffer_store_dwordx4 v[72:75], v118, s[8:11], s25 offen
    s_waitcnt lgkmcnt(3)
    v_smfmac_f32_16x16x64_bf16 v[108:111], v[92:95], v[40:47], v116
    s_waitcnt lgkmcnt(0)
    v_smfmac_f32_16x16x64_bf16 v[108:111], v[80:83], v[56:63], v116
    v_cvt_pk_bf16_f32 v76, v104, v106
    v_smfmac_f32_16x16x64_bf16 v[108:111], v[84:87], v[64:71], v116
    v_and_or_b32 v76, v76, -2, s33
    v_cvt_pk_bf16_f32 v78, v105, v107
    v_mov_b32 v122, v122
    v_mov_b32 v122, v122
    v_mov_b32 v122, v122
    v_mov_b32 v122, v122
    v_mov_b32 v122, v122
    v_mov_b32 v122, v122
    v_cvt_pk_bf16_f32 v77, v108, v110
    v_cvt_pk_bf16_f32 v79, v109, v111
    buffer_store_dwordx4 v[76:79], v118, s[8:11], s26 offen
    s_add_u32 s30, s30, 0x40000
    s_add_u32 s31, s31, 0x40000
    s_add_u32 s32, s32, 0x20000
    s_add_u32 s23, s24, 0
    s_add_u32 s48, s23, 4096
    s_xor_b32 s25, s25, 0x40000
    s_xor_b32 s26, s26, 0x40000
    s_mov_b32 s35, 0x49800000
    v_mov_b32 v126, s22
    s_add_u32 s22, s22, 1
    v_mov_b32 v32, 0
    v_mov_b32 v33, 0
    v_mov_b32 v34, 0
    v_mov_b32 v35, 0
    v_mov_b32 v36, 0
    v_mov_b32 v37, 0
    v_mov_b32 v38, 0
    v_mov_b32 v39, 0
    v_mov_b32 v40, 0
    v_mov_b32 v41, 0
    v_mov_b32 v42, 0
    v_mov_b32 v43, 0
    v_mov_b32 v44, 0
    v_mov_b32 v45, 0
    v_mov_b32 v46, 0
    v_mov_b32 v47, 0
    v_mov_b32 v48, 0
    v_mov_b32 v49, 0
    v_mov_b32 v50, 0
    v_mov_b32 v51, 0
    v_mov_b32 v52, 0
    v_mov_b32 v53, 0
    v_mov_b32 v54, 0
    v_mov_b32 v55, 0
    ds_read_b128 v[80:83], v123
    ds_read_b128 v[84:87], v123 offset:1024
    ds_read_b128 v[56:59], v123 offset:2048
    ds_read_b128 v[60:63], v123 offset:3072
    ds_read_b128 v[64:67], v123 offset:32768
    ds_read_b128 v[68:71], v123 offset:33792
    ds_read_b128 v[72:75], v123 offset:34816
    ds_read_b128 v[76:79], v123 offset:35840
    ds_read_b128 v[88:91], v123 offset:4096
    ds_read_b128 v[92:95], v123 offset:5120
    ds_read_b128 v[96:99], v123 offset:6144
    ds_read_b128 v[100:103], v123 offset:7168
    ds_read_b128 v[104:107], v123 offset:36864
    ds_read_b128 v[108:111], v123 offset:37888
    ds_read_b128 v[24:27], v123 offset:38912
    ds_read_b128 v[28:31], v123 offset:39936
    s_add_u32 s24, s24, 8192
    s_bitset0_b32 s24, 15
    s_xor_b32 s55, s24, 16384
    s_xor_b32 s29, s29, 0x40000
    s_xor_b32 s53, s29, 1024
    s_bfe_u32 s33, s22, 0x10001
    s_add_u32 s40, s22, 5
    s_lshr_b32 s40, s40, 2
    s_min_u32 s40, s40, 16
    s_bfm_b32 s58, s40, 0
    s_waitcnt vmcnt(5)
    v_cmp_eq_u32 vcc, 0, v125
    s_nop 0
    s_and_b64 vcc, vcc, s[58:59]
    s_cbranch_scc1 L_kvw_19
L_kvb_20:
    v_mov_b32 v15, 0
    s_nop 2
    v_mov_b32 v15, 0
    s_nop 2
    v_mov_b32 v15, 0
    s_nop 2
    v_mov_b32 v15, 0
    s_nop 2
    v_mov_b32 v15, 0
    s_nop 2
    v_mov_b32 v15, 0
    s_nop 2
    v_mov_b32 v15, 0
    s_nop 2
    v_mov_b32 v15, 0
    s_nop 2
    v_mov_b32 v15, 0
    s_nop 2
    v_mov_b32 v15, 0
    s_nop 2
    v_mov_b32 v15, 0
    s_nop 2
    v_mov_b32 v15, 0
    s_nop 2
    v_mov_b32 v15, 0
    s_nop 2
    v_mov_b32 v15, 0
    s_nop 2
    v_mov_b32 v15, 0
    s_nop 2
    v_mov_b32 v15, 0
    s_nop 2
    v_mov_b32 v15, 0
    s_nop 2
    v_mov_b32 v15, 0
    s_nop 2
    v_mov_b32 v15, 0
    s_nop 2
    v_mov_b32 v15, 0
    s_nop 2
    v_mov_b32 v15, 0
    s_nop 2
    v_mov_b32 v15, 0
    s_nop 2
    v_mov_b32 v15, 0
    s_nop 2
    v_mov_b32 v15, 0
    s_nop 2
    v_mov_b32 v15, 0
    s_nop 2
    v_mov_b32 v15, 0
    s_nop 2
    v_mov_b32 v15, 0
    s_nop 2
    v_mov_b32 v15, 0
    s_nop 2
    v_mov_b32 v15, 0
    s_nop 2
    v_mov_b32 v15, 0
    s_nop 2
    v_mov_b32 v15, 0
    s_nop 2
    s_waitcnt lgkmcnt(0)
    s_branch L_chain_top0_f
.p2align 6
L_chain_top1_f:
    buffer_load_dwordx4 v[0:3], v117, s[8:11], s23 offen nt
    v_mov_b32 v15, 0
    v_mov_b32 v15, 0
    v_mov_b32 v15, 0
    v_mov_b32 v15, 0
    v_mov_b32 v15, 0
    v_mov_b32 v15, 0
    v_mov_b32 v15, 0
    v_mov_b32 v15, 0
    v_mov_b32 v15, 0
    v_mov_b32 v15, 0
    v_mov_b32 v15, 0
    v_mov_b32 v15, 0
    v_mov_b32 v15, 0
    v_mov_b32 v15, 0
    v_mov_b32 v15, 0
    v_mov_b32 v15, 0
    buffer_load_dwordx4 v[0:3], v117, s[8:11], s23 offen sc1
    v_mov_b32 v15, 0
    v_mov_b32 v15, 0
    v_mov_b32 v15, 0
    v_mov_b32 v15, 0
    v_mov_b32 v15, 0
    v_mov_b32 v15, 0
    v_mov_b32 v15, 0
    v_mov_b32 v15, 0
    v_mov_b32 v15, 0
    v_mov_b32 v15, 0
    v_mov_b32 v15, 0
    v_mov_b32 v15, 0
    v_mov_b32 v15, 0
    v_mov_b32 v15, 0
    v_mov_b32 v15, 0
    v_mov_b32 v15, 0
L_mret_21:
    buffer_load_dwordx4 v[0:3], v117, s[8:11], s23 offen sc1
    s_add_u32 s45, s45, 1
    s_cmp_lt_u32 s45, 0x10000
    s_cselect_b32 s56, -2, -1
    s_nop 3
    v_mov_b32 v32, 0
    v_mov_b32 v33, 0
    v_mov_b32 v34, 0
    v_mov_b32 v35, 0
    s_waitcnt vmcnt(2)
    v_max3_u32 v15, v0, v1, v2
    v_max_u32 v15, v15, v3
    v_cmp_lt_u32 vcc, s56, v15
    v_smfmac_f32_16x16x64_bf16 v[32:35], v[0:3], v[80:87], v116
    s_cbranch_vccnz L_mret_21
    ds_write_b128 v117, v[0:3] offset:1024
    v_smfmac_f32_16x16x64_bf16 v[36:39], v[0:3], v[56:63], v116
    buffer_load_dwordx4 v[4:7], v117, s[8:11], s48 offen nt
    v_smfmac_f32_16x16x64_bf16 v[40:43], v[0:3], v[64:71], v116
    buffer_load_dwordx4 v117, s[8:11], s48 offen nt lds
    s_mov_b32 m0, 10240
    v_smfmac_f32_16x16x64_bf16 v[44:47], v[0:3], v[72:79], v116
    s_waitcnt lgkmcnt(0)
    s_barrier
    ds_read_b128 v[8:11], v117
    v_smfmac_f32_16x16x64_bf16 v[48:51], v[0:3], a[192:199], v116
    ds_read_b128 v[16:19], v117 offset:3072
    ds_read_b128 v[20:23], v117 offset:2048
    v_smfmac_f32_16x16x64_bf16 v[52:55], v[0:3], a[200:207], v116
    ds_read_b128 v[80:83], v117 offset:14336
    s_waitcnt lgkmcnt(3)
    v_smfmac_f32_16x16x64_bf16 v[32:35], v[8:11], a[0:7], v116
    ds_read_b128 v[84:87], v117 offset:15360
    v_smfmac_f32_16x16x64_bf16 v[36:39], v[8:11], a[8:15], v116
    ds_read_b128 v[56:59], v117 offset:8192
    s_waitcnt lgkmcnt(4)
    v_smfmac_f32_16x16x64_bf16 v[32:35], v[16:19], a[32:39], v116
    ds_read_b128 v[60:63], v117 offset:9216
    v_smfmac_f32_16x16x64_bf16 v[36:39], v[16:19], a[40:47], v116
    buffer_store_dwordx4 v[112:115], v117, s[8:11], s32 offen sc1
    s_waitcnt lgkmcnt(4)
    v_smfmac_f32_16x16x64_bf16 v[32:35], v[20:23], a[64:71], v116
    ds_read_b128 v[64:67], v117 offset:10240
    v_smfmac_f32_16x16x64_bf16 v[36:39], v[20:23], a[72:79], v116
    ds_read_b128 v[68:71], v117 offset:11264
    v_smfmac_f32_16x16x64_bf16 v[40:43], v[8:11], a[96:103], v116
    ds_read_b128 v[72:75], v117 offset:12288
    v_smfmac_f32_16x16x64_bf16 v[40:43], v[16:19], a[128:135], v116
    ds_read_b128 v[76:79], v117 offset:13312
    v_smfmac_f32_16x16x64_bf16 v[40:43], v[20:23], a[160:167], v116
    s_waitcnt vmcnt(2)
    v_max3_u32 v15, v4, v5, v6
    v_smfmac_f32_16x16x64_bf16 v[44:47], v[8:11], a[104:111], v116
    v_max_u32 v15, v15, v7
    v_smfmac_f32_16x16x64_bf16 v[44:47], v[16:19], a[136:143], v116
    s_waitcnt vmcnt(1) lgkmcnt(0)
    v_cmp_lt_u32 vcc, s56, v15
    v_smfmac_f32_16x16x64_bf16 v[44:47], v[20:23], a[168:175], v116
    s_cbranch_vccnz L_mret_22
L_mgo_23:
    v_smfmac_f32_16x16x64_bf16 v[44:47], v[4:7], v[24:31], v116
    s_barrier
    ds_read_b128 v[12:15], v117 offset:4096
    v_smfmac_f32_16x16x64_bf16 v[32:35], v[4:7], v[88:95], v116
    ds_read_b128 v[24:27], v117 offset:7168
    v_smfmac_f32_16x16x64_bf16 v[36:39], v[4:7], v[96:103], v116
    ds_read_b128 v[28:31], v117 offset:6144
    v_smfmac_f32_16x16x64_bf16 v[40:43], v[4:7], v[104:111], v116
    ds_read_b128 v[88:91], v117 offset:26624
    s_waitcnt lgkmcnt(3)
    v_smfmac_f32_16x16x64_bf16 v[32:35], v[12:15], a[16:23], v116
    ds_read_b128 v[92:95], v117 offset:27648
    s_waitcnt lgkmcnt(3)
    v_smfmac_f32_16x16x64_bf16 v[32:35], v[24:27], a[48:55], v116
    buffer_load_dwordx4 v117, s[8:11], s30 offen lds
    s_waitcnt lgkmcnt(2)
    v_smfmac_f32_16x16x64_bf16 v[32:35], v[28:31], a[80:87], v116
    ds_read_b128 v[96:99], v117 offset:23552
    v_smfmac_f32_16x16x64_bf16 v[36:39], v[12:15], a[24:31], v116
    ds_read_b128 v[100:103], v117 offset:23552
    v_smfmac_f32_16x16x64_bf16 v[36:39], v[24:27], a[56:63], v116
    buffer_load_dwordx4 v117, s[8:11], s30 offen offset:1024 lds
    s_add_u32 m0, s52, 0x6000
    v_add_f32 v32, v32, v34
    v_smfmac_f32_16x16x64_bf16 v[36:39], v[28:31], a[88:95], v116
    ds_read_b128 v[104:107], v117 offset:23552
    v_add_f32 v33, v33, v35
    v_smfmac_f32_16x16x64_bf16 v[40:43], v[12:15], a[112:119], v116
    ds_read_b128 v[108:111], v117 offset:23552
    v_mul_f32 v32, s34, v32
    v_smfmac_f32_16x16x64_bf16 v[40:43], v[24:27], a[144:151], v116
    buffer_load_dword v125, v119, s[8:11], s28 offen sc1
    v_mul_f32 v33, s34, v33
    v_smfmac_f32_16x16x64_bf16 v[40:43], v[28:31], a[176:183], v116
    ds_read_b128 v[0:3], v124
    v_add_f32 v36, v36, v38
    v_smfmac_f32_16x16x64_bf16 v[48:51], v[4:7], a[208:215], v116
    v_add_f32 v37, v37, v39
    v_smfmac_f32_16x16x64_bf16 v[52:55], v[4:7], a[216:223], v116
    s_waitcnt lgkmcnt(5)
    buffer_load_dwordx4 v117, s[8:11], s31 offen lds
    v_mul_f32 v36, s34, v36
    v_smfmac_f32_16x16x64_bf16 v[44:47], v[12:15], a[120:127], v116
    ds_read_b128 v[4:7], v124 offset:1024
    v_mul_f32 v37, s34, v37
    v_smfmac_f32_16x16x64_bf16 v[44:47], v[24:27], a[152:159], v116
    v_cvt_pk_bf16_f32 v34, v32, v36
    v_smfmac_f32_16x16x64_bf16 v[44:47], v[28:31], a[184:191], v116
    buffer_load_dwordx4 v117, s[8:11], s31 offen offset:1024 lds
    s_mov_b32 m0, 5120
    v_cvt_pk_bf16_f32 v35, v33, v37
    v_add_f32 v40, v40, v42
    v_smfmac_f32_16x16x64_bf16 v[48:51], v[8:11], a[224:231], v116
    ds_write2_b32 v120, v34, v35 offset0:32 offset1:48
    v_add_f32 v41, v41, v43
    v_smfmac_f32_16x16x64_bf16 v[52:55], v[8:11], a[232:239], v116
    v_add_f32 v44, v44, v46
    v_add_f32 v45, v45, v47
    v_cvt_pk_bf16_f32 v113, v40, v44
    v_cvt_pk_bf16_f32 v115, v41, v45
    v_smfmac_f32_16x16x64_bf16 v[48:51], v[12:15], a[240:247], v116
    ds_write2_b32 v120, v113, v115 offset0:0 offset1:16
    v_smfmac_f32_16x16x64_bf16 v[52:55], v[12:15], a[248:255], v116
    s_cmp_eq_u32 s22, 63
    s_cbranch_scc1 L_chain_last_f
    v_smfmac_f32_16x16x64_bf16 v[48:51], v[16:19], v[128:135], v116
    v_smfmac_f32_16x16x64_bf16 v[48:51], v[20:23], v[160:167], v116
    v_smfmac_f32_16x16x64_bf16 v[48:51], v[24:27], v[144:151], v116
    s_waitcnt lgkmcnt(0)
    s_barrier
    v_smfmac_f32_16x16x64_bf16 v[48:51], v[28:31], v[176:183], v116
    ds_read_b128 v[32:35], v121 offset:16384
    ds_read_b128 v[36:39], v121 offset:17408
    v_smfmac_f32_16x16x64_bf16 v[52:55], v[16:19], v[136:143], v116
    ds_read_b128 v[40:43], v121 offset:18432
    ds_read_b128 v[44:47], v121 offset:19456
    v_smfmac_f32_16x16x64_bf16 v[52:55], v[20:23], v[168:175], v116
    ds_read_b128 v[8:11], v124 offset:32768
    v_add_f32 v48, v48, v50
    v_smfmac_f32_16x16x64_bf16 v[52:55], v[24:27], v[152:159], v116
    ds_read_b128 v[12:15], v124 offset:33792
    v_add_f32 v49, v49, v51
    v_smfmac_f32_16x16x64_bf16 v[52:55], v[28:31], v[184:191], v116
    s_waitcnt lgkmcnt(5)
    v_cvt_pk_bf16_f32 v112, v48, v49
    v_mfma_f32_16x16x32_bf16 v[56:59], v[56:59], v[32:35], 0
    s_waitcnt lgkmcnt(4)
    v_mov_b32 v48, s50
    v_mov_b32 v49, s50
    v_mfma_f32_16x16x32_bf16 v[56:59], v[60:63], v[36:39], v[56:59]
    ds_read_b128 v[16:19], v124 offset:2048
    s_waitcnt lgkmcnt(4)
    v_mov_b32 v50, s50
    v_mov_b32 v51, s50
    v_mfma_f32_16x16x32_bf16 v[56:59], v[64:67], v[40:43], v[56:59]
    ds_read_b128 v[20:23], v124 offset:3072
    s_waitcnt lgkmcnt(4)
    v_add_f32 v52, v52, v54
    v_mfma_f32_16x16x32_bf16 v[56:59], v[68:71], v[44:47], v[56:59]
    ds_read_b128 v[24:27], v124 offset:4096
    v_add_f32 v53, v53, v55
    v_mfma_f32_16x16x32_bf16 v[60:63], v[72:75], v[32:35], 0
    ds_read_b128 v[28:31], v124 offset:5120
    v_cvt_pk_bf16_f32 v114, v52, v53
    v_mov_b32 v53, 0
    v_mfma_f32_16x16x32_bf16 v[60:63], v[76:79], v[36:39], v[60:63]
    v_exp_f32 v56, v56
    v_mfma_f32_16x16x32_bf16 v[60:63], v[80:83], v[40:43], v[60:63]
    v_exp_f32 v57, v57
    v_mfma_f32_16x16x32_bf16 v[60:63], v[84:87], v[44:47], v[60:63]
    v_exp_f32 v58, v58
    v_mfma_f32_16x16x32_bf16 v[64:67], v[32:35], v[32:35], 0
    v_exp_f32 v59, v59
    v_cvt_pk_bf16_f32 v68, v56, v57
    v_mfma_f32_16x16x32_bf16 v[64:67], v[36:39], v[36:39], v[64:67]
    v_exp_f32 v60, v60
    v_cvt_pk_bf16_f32 v69, v58, v59
    v_mfma_f32_16x16x32_bf16 v[64:67], v[40:43], v[40:43], v[64:67]
    v_exp_f32 v61, v61
    v_mfma_f32_16x16x32_bf16 v[64:67], v[44:47], v[44:47], v[64:67]
    v_exp_f32 v62, v62
    v_exp_f32 v63, v63
    v_cvt_pk_bf16_f32 v70, v60, v61
    v_cvt_pk_bf16_f32 v71, v62, v63
    s_nop 1
    v_mfma_f32_16x16x32_bf16 v[72:75], v[88:91], v[68:71], 0
    s_nop 0
    v_exp_f32 v64, v64
    v_mfma_f32_16x16x32_bf16 v[76:79], v[92:95], v[68:71], 0
    v_exp_f32 v65, v65
    v_mfma_f32_16x16x32_bf16 v[80:83], v[48:51], v[68:71], 0
    v_cvt_pk_bf16_f32 v52, v64, v65
    s_nop 1
    v_mfma_f32_16x16x16_bf16 v[72:75], v[112:113], v[52:53], v[72:75]
    ds_read_b128 v[32:35], v124 offset:6144
    v_mfma_f32_16x16x16_bf16 v[76:79], v[114:115], v[52:53], v[76:79]
    ds_read_b128 v[36:39], v124 offset:7168
    v_mfma_f32_16x16x16_bf16 v[80:83], v[48:49], v[52:53], v[80:83]
L_norm_24:
    s_mov_b64 vcc, s[36:37]
    v_mov_b32 v122, v122
    v_mov_b32 v122, v122
    v_mov_b32 v122, v122
    v_cndmask_b32_dpp v76, v72, v76, vcc quad_perm:[2,3,2,3] row_mask:0xf bank_mask:0xf
    v_cndmask_b32_dpp v77, v73, v77, vcc quad_perm:[2,3,2,3] row_mask:0xf bank_mask:0xf
    v_cndmask_b32_dpp v78, v74, v78, vcc quad_perm:[2,3,2,3] row_mask:0xf bank_mask:0xf
    v_cndmask_b32_dpp v79, v75, v79, vcc quad_perm:[2,3,2,3] row_mask:0xf bank_mask:0xf
    v_rcp_f32_dpp v84, v80 quad_perm:[2,3,2,3] row_mask:0xf bank_mask:0xf
    s_nop 0
    v_pk_mul_f32 v[76:77], v[76:77], v[84:85] op_sel_hi:[1,0]
    v_pk_mul_f32 v[78:79], v[78:79], v[84:85] op_sel_hi:[1,0]
    v_cvt_pk_bf16_f32 v72, v76, v77
    v_cvt_pk_bf16_f32 v73, v78, v79
    ds_write_b64 v122, v[72:73] offset:20992
    v_max_f32_dpp v86, v80, v84 quad_perm:[2,3,2,3] row_mask:0xf bank_mask:0xf
    v_mov_b32_dpp v60, v72 quad_perm:[0,1,0,1] row_mask:0xf bank_mask:0xf
    v_mov_b32_dpp v61, v73 quad_perm:[0,1,0,1] row_mask:0xf bank_mask:0xf
    v_cmp_lt_f32 vcc, s35, v86
    v_mov_b32_dpp v62, v72 quad_perm:[2,3,2,3] row_mask:0xf bank_mask:0xf
    v_mov_b32_dpp v63, v73 quad_perm:[2,3,2,3] row_mask:0xf bank_mask:0xf
    s_nop 1
    v_smfmac_f32_16x16x64_bf16 v[96:99], v[60:63], v[192:199], v116
    s_cbranch_vccnz L_smax_25
    v_smfmac_f32_16x16x64_bf16 v[100:103], v[60:63], v[224:231], v116
    s_waitcnt lgkmcnt(0)
    s_barrier
    ds_read_b128 v[92:95], v127 offset:20480
    ds_read_b128 v[80:83], v127 offset:22016
    ds_read_b128 v[84:87], v127 offset:21504
    v_smfmac_f32_16x16x64_bf16 v[104:107], v[60:63], v[0:7], v116
    ds_read_b128 v[40:43], v124 offset:34816
    v_smfmac_f32_16x16x64_bf16 v[108:111], v[60:63], v[8:15], v116
    ds_read_b128 v[56:59], v124 offset:36864
    s_waitcnt lgkmcnt(4)
    v_smfmac_f32_16x16x64_bf16 v[96:99], v[92:95], v[200:207], v116
    s_waitcnt lgkmcnt(3)
    v_smfmac_f32_16x16x64_bf16 v[96:99], v[80:83], v[208:215], v116
    ds_read_b128 v[44:47], v124 offset:35840
    s_waitcnt lgkmcnt(3)
    v_smfmac_f32_16x16x64_bf16 v[96:99], v[84:87], v[216:223], v116
    ds_read_b128 v[68:71], v124 offset:39936
    v_smfmac_f32_16x16x64_bf16 v[100:103], v[92:95], v[232:239], v116
    ds_read_b128 v[64:67], v124 offset:38912
    v_smfmac_f32_16x16x64_bf16 v[100:103], v[80:83], v[240:247], v116
    ds_read_b128 v[60:63], v124 offset:37888
    v_cvt_pk_bf16_f32 v72, v96, v98
    v_smfmac_f32_16x16x64_bf16 v[100:103], v[84:87], v[248:255], v116
    v_and_or_b32 v72, v72, -2, s33
    v_smfmac_f32_16x16x64_bf16 v[104:107], v[92:95], v[16:23], v116
    v_cvt_pk_bf16_f32 v74, v97, v99
    v_smfmac_f32_16x16x64_bf16 v[104:107], v[80:83], v[24:31], v116
    v_cvt_pk_bf16_f32 v73, v100, v102
    v_cvt_pk_bf16_f32 v75, v101, v103
    v_smfmac_f32_16x16x64_bf16 v[104:107], v[84:87], v[32:39], v116
    buffer_store_dwordx4 v[72:75], v118, s[8:11], s25 offen
    s_waitcnt lgkmcnt(3)
    v_smfmac_f32_16x16x64_bf16 v[108:111], v[92:95], v[40:47], v116
    s_waitcnt lgkmcnt(0)
    v_smfmac_f32_16x16x64_bf16 v[108:111], v[80:83], v[56:63], v116
    v_cvt_pk_bf16_f32 v76, v104, v106
    v_smfmac_f32_16x16x64_bf16 v[108:111], v[84:87], v[64:71], v116
    v_and_or_b32 v76, v76, -2, s33
    v_cvt_pk_bf16_f32 v78, v105, v107
    v_mov_b32 v122, v122
    v_mov_b32 v122, v122
    v_mov_b32 v122, v122
    v_mov_b32 v122, v122
    v_mov_b32 v122, v122
    v_mov_b32 v122, v122
    v_cvt_pk_bf16_f32 v77, v108, v110
    v_cvt_pk_bf16_f32 v79, v109, v111
    buffer_store_dwordx4 v[76:79], v118, s[8:11], s26 offen
    s_add_u32 s30, s30, 0x40000
    s_add_u32 s31, s31, 0x40000
    s_add_u32 s32, s32, 0x20000
    s_add_u32 s23, s24, 1024
    s_add_u32 s48, s23, 4096
    s_xor_b32 s25, s25, 0x40000
    s_xor_b32 s26, s26, 0x40000
    s_mov_b32 s35, 0x49800000
    s_add_u32 s22, s22, 1
    v_mov_b32 v32, 0
    v_mov_b32 v33, 0
    v_mov_b32 v34, 0
    v_mov_b32 v35, 0
    v_mov_b32 v36, 0
    v_mov_b32 v37, 0
    v_mov_b32 v38, 0
    v_mov_b32 v39, 0
    v_mov_b32 v40, 0
    v_mov_b32 v41, 0
    v_mov_b32 v42, 0
    v_mov_b32 v43, 0
    v_mov_b32 v44, 0
    v_mov_b32 v45, 0
    v_mov_b32 v46, 0
    v_mov_b32 v47, 0
    v_mov_b32 v48, 0
    v_mov_b32 v49, 0
    v_mov_b32 v50, 0
    v_mov_b32 v51, 0
    v_mov_b32 v52, 0
    v_mov_b32 v53, 0
    v_mov_b32 v54, 0
    v_mov_b32 v55, 0
    ds_read_b128 v[80:83], v123
    ds_read_b128 v[84:87], v123 offset:1024
    ds_read_b128 v[56:59], v123 offset:2048
    ds_read_b128 v[60:63], v123 offset:3072
    ds_read_b128 v[64:67], v123 offset:32768
    ds_read_b128 v[68:71], v123 offset:33792
    ds_read_b128 v[72:75], v123 offset:34816
    ds_read_b128 v[76:79], v123 offset:35840
    ds_read_b128 v[88:91], v123 offset:4096
    ds_read_b128 v[92:95], v123 offset:5120
    ds_read_b128 v[96:99], v123 offset:6144
    ds_read_b128 v[100:103], v123 offset:7168
    ds_read_b128 v[104:107], v123 offset:36864
    ds_read_b128 v[108:111], v123 offset:37888
    ds_read_b128 v[24:27], v123 offset:38912
    ds_read_b128 v[28:31], v123 offset:39936
    s_add_u32 s24, s24, 8192
    s_bitset0_b32 s24, 15
    s_xor_b32 s55, s24, 16384
    s_xor_b32 s29, s29, 0x40000
    s_xor_b32 s53, s29, 1024
    s_bfe_u32 s33, s22, 0x10001
    s_add_u32 s40, s22, 5
    s_lshr_b32 s40, s40, 2
    s_min_u32 s40, s40, 16
    s_bfm_b32 s58, s40, 0
    s_waitcnt vmcnt(4)
    v_cmp_eq_u32 vcc, 0, v125
    s_nop 0
    s_and_b64 vcc, vcc, s[58:59]
    s_cbranch_scc1 L_kvw_26
L_kvb_27:
    v_mov_b32 v15, 0
    s_nop 2
    v_mov_b32 v15, 0
    s_nop 2
    v_mov_b32 v15, 0
    s_nop 2
    v_mov_b32 v15, 0
    s_nop 2
    v_mov_b32 v15, 0
    s_nop 2
    v_mov_b32 v15, 0
    s_nop 2
    v_mov_b32 v15, 0
    s_nop 2
    v_mov_b32 v15, 0
    s_nop 2
    v_mov_b32 v15, 0
    s_nop 2
    v_mov_b32 v15, 0
    s_nop 2
    v_mov_b32 v15, 0
    s_nop 2
    v_mov_b32 v15, 0
    s_nop 2
    v_mov_b32 v15, 0
    s_nop 2
    v_mov_b32 v15, 0
    s_nop 2
    v_mov_b32 v15, 0
    s_nop 2
    v_mov_b32 v15, 0
    s_nop 2
    v_mov_b32 v15, 0
    s_nop 2
    v_mov_b32 v15, 0
    s_nop 2
    v_mov_b32 v15, 0
    s_nop 2
    v_mov_b32 v15, 0
    s_nop 2
    v_mov_b32 v15, 0
    s_nop 2
    v_mov_b32 v15, 0
    s_nop 2
    v_mov_b32 v15, 0
    s_nop 2
    v_mov_b32 v15, 0
    s_nop 2
    v_mov_b32 v15, 0
    s_nop 2
    v_mov_b32 v15, 0
    s_nop 2
    v_mov_b32 v15, 0
    s_nop 2
    v_mov_b32 v15, 0
    s_nop 2
    v_mov_b32 v15, 0
    s_nop 2
    v_mov_b32 v15, 0
    s_nop 2
    v_mov_b32 v15, 0
    s_nop 2
    s_waitcnt lgkmcnt(0)
    s_branch L_chain_top1_f
.p2align 6
L_chain_top2_f:
    buffer_load_dwordx4 v[0:3], v117, s[8:11], s23 offen nt
    v_mov_b32 v48, 0
    v_mov_b32 v49, 0
    v_mov_b32 v50, 0
    v_mov_b32 v51, 0
    v_mov_b32 v52, 0
    v_mov_b32 v53, 0
    v_mov_b32 v15, 0
    v_mov_b32 v15, 0
    v_mov_b32 v15, 0
    v_mov_b32 v15, 0
    v_mov_b32 v15, 0
    v_mov_b32 v15, 0
    v_mov_b32 v15, 0
    v_mov_b32 v15, 0
    v_mov_b32 v15, 0
    v_mov_b32 v15, 0
    buffer_load_dwordx4 v[0:3], v117, s[8:11], s23 offen sc1
    v_mov_b32 v15, 0
    v_mov_b32 v15, 0
    v_mov_b32 v15, 0
    v_mov_b32 v15, 0
    v_mov_b32 v15, 0
    v_mov_b32 v15, 0
    v_mov_b32 v15, 0
    v_mov_b32 v15, 0
    v_mov_b32 v15, 0
    v_mov_b32 v15, 0
    v_mov_b32 v15, 0
    v_mov_b32 v15, 0
    v_mov_b32 v15, 0
    v_mov_b32 v15, 0
    v_mov_b32 v15, 0
    v_mov_b32 v15, 0
L_mret_28:
    buffer_load_dwordx4 v[0:3], v117, s[8:11], s23 offen sc1
    s_add_u32 s45, s45, 1
    s_cmp_lt_u32 s45, 0x10000
    s_cselect_b32 s56, -2, -1
    s_nop 3
    v_mov_b32 v32, 0
    v_mov_b32 v33, 0
    v_mov_b32 v34, 0
    v_mov_b32 v35, 0
    s_waitcnt vmcnt(2)
    v_max3_u32 v15, v0, v1, v2
    v_max_u32 v15, v15, v3
    v_cmp_lt_u32 vcc, s56, v15
    v_smfmac_f32_16x16x64_bf16 v[32:35], v[0:3], v[80:87], v116
    s_cbranch_vccnz L_mret_28
    ds_write_b128 v117, v[0:3] offset:2048
    v_smfmac_f32_16x16x64_bf16 v[36:39], v[0:3], v[56:63], v116
    buffer_load_dwordx4 v[4:7], v117, s[8:11], s48 offen nt
    v_smfmac_f32_16x16x64_bf16 v[40:43], v[0:3], v[64:71], v116
    buffer_load_dwordx4 v117, s[8:11], s48 offen nt lds
    s_mov_b32 m0, 12288
    v_smfmac_f32_16x16x64_bf16 v[44:47], v[0:3], v[72:79], v116
    s_waitcnt lgkmcnt(0)
    s_barrier
    ds_read_b128 v[8:11], v117 offset:3072
    v_smfmac_f32_16x16x64_bf16 v[48:51], v[0:3], a[192:199], v116
    ds_read_b128 v[16:19], v117
    ds_read_b128 v[20:23], v117 offset:1024
    v_smfmac_f32_16x16x64_bf16 v[52:55], v[0:3], a[200:207], v116
    ds_read_b128 v[80:83], v117 offset:14336
    s_waitcnt lgkmcnt(3)
    v_smfmac_f32_16x16x64_bf16 v[32:35], v[8:11], a[0:7], v116
    ds_read_b128 v[84:87], v117 offset:15360
    v_smfmac_f32_16x16x64_bf16 v[36:39], v[8:11], a[8:15], v116
    ds_read_b128 v[56:59], v117 offset:8192
    s_waitcnt lgkmcnt(4)
    v_smfmac_f32_16x16x64_bf16 v[32:35], v[16:19], a[32:39], v116
    ds_read_b128 v[60:63], v117 offset:9216
    v_smfmac_f32_16x16x64_bf16 v[36:39], v[16:19], a[40:47], v116
    ds_read_b128 v[64:67], v117 offset:10240
    s_waitcnt lgkmcnt(5)
    v_smfmac_f32_16x16x64_bf16 v[32:35], v[20:23], a[64:71], v116
    ds_read_b128 v[68:71], v117 offset:11264
    v_smfmac_f32_16x16x64_bf16 v[36:39], v[20:23], a[72:79], v116
    buffer_store_dwordx4 v[112:115], v117, s[8:11], s32 offen sc1
    v_smfmac_f32_16x16x64_bf16 v[40:43], v[8:11], a[96:103], v116
    ds_read_b128 v[72:75], v117 offset:12288
    v_smfmac_f32_16x16x64_bf16 v[40:43], v[16:19], a[128:135], v116
    ds_read_b128 v[76:79], v117 offset:13312
    v_smfmac_f32_16x16x64_bf16 v[40:43], v[20:23], a[160:167], v116
    s_waitcnt vmcnt(2)
    v_max3_u32 v15, v4, v5, v6
    v_smfmac_f32_16x16x64_bf16 v[44:47], v[8:11], a[104:111], v116
    v_max_u32 v15, v15, v7
    v_smfmac_f32_16x16x64_bf16 v[44:47], v[16:19], a[136:143], v116
    s_waitcnt vmcnt(1) lgkmcnt(0)
    v_cmp_lt_u32 vcc, s56, v15
    v_smfmac_f32_16x16x64_bf16 v[44:47], v[20:23], a[168:175], v116
    s_cbranch_vccnz L_mret_29
L_mgo_30:
    v_smfmac_f32_16x16x64_bf16 v[44:47], v[4:7], v[24:31], v116
    s_barrier
    ds_read_b128 v[12:15], v117 offset:7168
    v_smfmac_f32_16x16x64_bf16 v[32:35], v[4:7], v[88:95], v116
    ds_read_b128 v[24:27], v117 offset:4096
    v_smfmac_f32_16x16x64_bf16 v[36:39], v[4:7], v[96:103], v116
    ds_read_b128 v[28:31], v117 offset:5120
    v_smfmac_f32_16x16x64_bf16 v[40:43], v[4:7], v[104:111], v116
    ds_read_b128 v[88:91], v117 offset:28672
    s_waitcnt lgkmcnt(3)
    v_smfmac_f32_16x16x64_bf16 v[32:35], v[12:15], a[16:23], v116
    ds_read_b128 v[92:95], v117 offset:29696
    s_waitcnt lgkmcnt(3)
    v_smfmac_f32_16x16x64_bf16 v[32:35], v[24:27], a[48:55], v116
    buffer_load_dwordx4 v117, s[8:11], s30 offen lds
    s_waitcnt lgkmcnt(2)
    v_smfmac_f32_16x16x64_bf16 v[32:35], v[28:31], a[80:87], v116
    ds_read_b128 v[96:99], v117 offset:23552
    v_smfmac_f32_16x16x64_bf16 v[36:39], v[12:15], a[24:31], v116
    ds_read_b128 v[100:103], v117 offset:23552
    v_smfmac_f32_16x16x64_bf16 v[36:39], v[24:27], a[56:63], v116
    buffer_load_dwordx4 v117, s[8:11], s30 offen offset:1024 lds
    s_add_u32 m0, s52, 0x6000
    v_add_f32 v32, v32, v34
    v_smfmac_f32_16x16x64_bf16 v[36:39], v[28:31], a[88:95], v116
    ds_read_b128 v[104:107], v117 offset:23552
    v_add_f32 v33, v33, v35
    v_smfmac_f32_16x16x64_bf16 v[40:43], v[12:15], a[112:119], v116
    ds_read_b128 v[108:111], v117 offset:23552
    v_mul_f32 v32, s34, v32
    v_smfmac_f32_16x16x64_bf16 v[40:43], v[24:27], a[144:151], v116
    s_waitcnt lgkmcnt(4)
    buffer_load_dwordx4 v117, s[8:11], s31 offen lds
    v_mul_f32 v33, s34, v33
    v_smfmac_f32_16x16x64_bf16 v[40:43], v[28:31], a[176:183], v116
    ds_read_b128 v[0:3], v124
    v_add_f32 v36, v36, v38
    v_smfmac_f32_16x16x64_bf16 v[48:51], v[4:7], a[208:215], v116
    v_add_f32 v37, v37, v39
    v_smfmac_f32_16x16x64_bf16 v[52:55], v[4:7], a[216:223], v116
    buffer_load_dwordx4 v117, s[8:11], s31 offen offset:1024 lds
    s_mov_b32 m0, 6144
    v_mul_f32 v36, s34, v36
    v_smfmac_f32_16x16x64_bf16 v[44:47], v[12:15], a[120:127], v116
    ds_read_b128 v[4:7], v124 offset:1024
    v_mul_f32 v37, s34, v37
    v_smfmac_f32_16x16x64_bf16 v[44:47], v[24:27], a[152:159], v116
    v_cvt_pk_bf16_f32 v34, v32, v36
    v_smfmac_f32_16x16x64_bf16 v[44:47], v[28:31], a[184:191], v116
    v_cvt_pk_bf16_f32 v35, v33, v37
    v_add_f32 v40, v40, v42
    v_smfmac_f32_16x16x64_bf16 v[48:51], v[8:11], a[224:231], v116
    ds_write2_b32 v120, v34, v35 offset0:32 offset1:48
    v_add_f32 v41, v41, v43
    v_smfmac_f32_16x16x64_bf16 v[52:55], v[8:11], a[232:239], v116
    v_add_f32 v44, v44, v46
    v_add_f32 v45, v45, v47
    v_cvt_pk_bf16_f32 v113, v40, v44
    v_cvt_pk_bf16_f32 v115, v41, v45
    v_smfmac_f32_16x16x64_bf16 v[48:51], v[12:15], a[240:247], v116
    ds_write2_b32 v120, v113, v115 offset0:0 offset1:16
    v_smfmac_f32_16x16x64_bf16 v[52:55], v[12:15], a[248:255], v116
    s_cmp_eq_u32 s22, 63
    s_cbranch_scc1 L_chain_last_f
    v_smfmac_f32_16x16x64_bf16 v[48:51], v[16:19], v[128:135], v116
    buffer_store_dword v126, v119, s[8:11], s55 offen
    v_smfmac_f32_16x16x64_bf16 v[48:51], v[20:23], v[160:167], v116
    v_smfmac_f32_16x16x64_bf16 v[48:51], v[24:27], v[144:151], v116
    s_waitcnt lgkmcnt(0)
    s_barrier
    v_smfmac_f32_16x16x64_bf16 v[48:51], v[28:31], v[176:183], v116
    ds_read_b128 v[32:35], v121 offset:16384
    ds_read_b128 v[36:39], v121 offset:17408
    v_smfmac_f32_16x16x64_bf16 v[52:55], v[16:19], v[136:143], v116
    ds_read_b128 v[40:43], v121 offset:18432
    ds_read_b128 v[44:47], v121 offset:19456
    v_smfmac_f32_16x16x64_bf16 v[52:55], v[20:23], v[168:175], v116
    ds_read_b128 v[8:11], v124 offset:32768
    v_add_f32 v48, v48, v50
    v_smfmac_f32_16x16x64_bf16 v[52:55], v[24:27], v[152:159], v116
    ds_read_b128 v[12:15], v124 offset:33792
    v_add_f32 v49, v49, v51
    v_smfmac_f32_16x16x64_bf16 v[52:55], v[28:31], v[184:191], v116
    s_waitcnt lgkmcnt(5)
    v_cvt_pk_bf16_f32 v112, v48, v49
    v_mfma_f32_16x16x32_bf16 v[56:59], v[56:59], v[32:35], 0
    s_waitcnt lgkmcnt(4)
    v_mov_b32 v48, s50
    v_mov_b32 v49, s50
    v_mfma_f32_16x16x32_bf16 v[56:59], v[60:63], v[36:39], v[56:59]
    ds_read_b128 v[16:19], v124 offset:2048
    s_waitcnt lgkmcnt(4)
    v_mov_b32 v50, s50
    v_mov_b32 v51, s50
    v_mfma_f32_16x16x32_bf16 v[56:59], v[64:67], v[40:43], v[56:59]
    ds_read_b128 v[20:23], v124 offset:3072
    s_waitcnt lgkmcnt(4)
    v_add_f32 v52, v52, v54
    v_mfma_f32_16x16x32_bf16 v[56:59], v[68:71], v[44:47], v[56:59]
    ds_read_b128 v[24:27], v124 offset:4096
    v_add_f32 v53, v53, v55
    v_mfma_f32_16x16x32_bf16 v[60:63], v[72:75], v[32:35], 0
    ds_read_b128 v[28:31], v124 offset:5120
    v_cvt_pk_bf16_f32 v114, v52, v53
    v_mov_b32 v53, 0
    v_mfma_f32_16x16x32_bf16 v[60:63], v[76:79], v[36:39], v[60:63]
    v_exp_f32 v56, v56
    v_mfma_f32_16x16x32_bf16 v[60:63], v[80:83], v[40:43], v[60:63]
    v_exp_f32 v57, v57
    v_mfma_f32_16x16x32_bf16 v[60:63], v[84:87], v[44:47], v[60:63]
    v_exp_f32 v58, v58
    v_mfma_f32_16x16x32_bf16 v[64:67], v[32:35], v[32:35], 0
    v_exp_f32 v59, v59
    v_cvt_pk_bf16_f32 v68, v56, v57
    v_mfma_f32_16x16x32_bf16 v[64:67], v[36:39], v[36:39], v[64:67]
    v_exp_f32 v60, v60
    v_cvt_pk_bf16_f32 v69, v58, v59
    v_mfma_f32_16x16x32_bf16 v[64:67], v[40:43], v[40:43], v[64:67]
    v_exp_f32 v61, v61
    v_mfma_f32_16x16x32_bf16 v[64:67], v[44:47], v[44:47], v[64:67]
    v_exp_f32 v62, v62
    v_exp_f32 v63, v63
    v_cvt_pk_bf16_f32 v70, v60, v61
    v_cvt_pk_bf16_f32 v71, v62, v63
    s_nop 1
    v_mfma_f32_16x16x32_bf16 v[72:75], v[88:91], v[68:71], 0
    s_nop 0
    v_exp_f32 v64, v64
    v_mfma_f32_16x16x32_bf16 v[76:79], v[92:95], v[68:71], 0
    v_exp_f32 v65, v65
    v_mfma_f32_16x16x32_bf16 v[80:83], v[48:51], v[68:71], 0
    v_cvt_pk_bf16_f32 v52, v64, v65
    s_nop 1
    v_mfma_f32_16x16x16_bf16 v[72:75], v[112:113], v[52:53], v[72:75]
    ds_read_b128 v[32:35], v124 offset:6144
    v_mfma_f32_16x16x16_bf16 v[76:79], v[114:115], v[52:53], v[76:79]
    ds_read_b128 v[36:39], v124 offset:7168
    v_mfma_f32_16x16x16_bf16 v[80:83], v[48:49], v[52:53], v[80:83]
L_norm_31:
    s_mov_b64 vcc, s[36:37]
    v_mov_b32 v122, v122
    v_mov_b32 v122, v122
    v_mov_b32 v122, v122
    v_cndmask_b32_dpp v76, v72, v76, vcc quad_perm:[2,3,2,3] row_mask:0xf bank_mask:0xf
    v_cndmask_b32_dpp v77, v73, v77, vcc quad_perm:[2,3,2,3] row_mask:0xf bank_mask:0xf
    v_cndmask_b32_dpp v78, v74, v78, vcc quad_perm:[2,3,2,3] row_mask:0xf bank_mask:0xf
    v_cndmask_b32_dpp v79, v75, v79, vcc quad_perm:[2,3,2,3] row_mask:0xf bank_mask:0xf
    v_rcp_f32_dpp v84, v80 quad_perm:[2,3,2,3] row_mask:0xf bank_mask:0xf
    s_nop 0
    v_pk_mul_f32 v[76:77], v[76:77], v[84:85] op_sel_hi:[1,0]
    v_pk_mul_f32 v[78:79], v[78:79], v[84:85] op_sel_hi:[1,0]
    v_cvt_pk_bf16_f32 v72, v76, v77
    v_cvt_pk_bf16_f32 v73, v78, v79
    ds_write_b64 v122, v[72:73] offset:21504
    v_max_f32_dpp v86, v80, v84 quad_perm:[2,3,2,3] row_mask:0xf bank_mask:0xf
    v_mov_b32_dpp v60, v72 quad_perm:[0,1,0,1] row_mask:0xf bank_mask:0xf
    v_mov_b32_dpp v61, v73 quad_perm:[0,1,0,1] row_mask:0xf bank_mask:0xf
    v_cmp_lt_f32 vcc, s35, v86
    v_mov_b32_dpp v62, v72 quad_perm:[2,3,2,3] row_mask:0xf bank_mask:0xf
    v_mov_b32_dpp v63, v73 quad_perm:[2,3,2,3] row_mask:0xf bank_mask:0xf
    s_nop 1
    v_smfmac_f32_16x16x64_bf16 v[96:99], v[60:63], v[192:199], v116
    s_cbranch_vccnz L_smax_32
    v_smfmac_f32_16x16x64_bf16 v[100:103], v[60:63], v[224:231], v116
    s_waitcnt lgkmcnt(0)
    s_barrier
    ds_read_b128 v[92:95], v127 offset:22016
    ds_read_b128 v[80:83], v127 offset:20480
    ds_read_b128 v[84:87], v127 offset:20992
    v_smfmac_f32_16x16x64_bf16 v[104:107], v[60:63], v[0:7], v116
    ds_read_b128 v[40:43], v124 offset:34816
    v_smfmac_f32_16x16x64_bf16 v[108:111], v[60:63], v[8:15], v116
    ds_read_b128 v[56:59], v124 offset:36864
    s_waitcnt lgkmcnt(4)
    v_smfmac_f32_16x16x64_bf16 v[96:99], v[92:95], v[200:207], v116
    s_waitcnt lgkmcnt(3)
    v_smfmac_f32_16x16x64_bf16 v[96:99], v[80:83], v[208:215], v116
    ds_read_b128 v[44:47], v124 offset:35840
    s_waitcnt lgkmcnt(3)
    v_smfmac_f32_16x16x64_bf16 v[96:99], v[84:87], v[216:223], v116
    ds_read_b128 v[68:71], v124 offset:39936
    v_smfmac_f32_16x16x64_bf16 v[100:103], v[92:95], v[232:239], v116
    ds_read_b128 v[64:67], v124 offset:38912
    v_smfmac_f32_16x16x64_bf16 v[100:103], v[80:83], v[240:247], v116
    ds_read_b128 v[60:63], v124 offset:37888
    v_cvt_pk_bf16_f32 v72, v96, v98
    v_smfmac_f32_16x16x64_bf16 v[100:103], v[84:87], v[248:255], v116
    v_and_or_b32 v72, v72, -2, s33
    v_smfmac_f32_16x16x64_bf16 v[104:107], v[92:95], v[16:23], v116
    v_cvt_pk_bf16_f32 v74, v97, v99
    v_smfmac_f32_16x16x64_bf16 v[104:107], v[80:83], v[24:31], v116
    v_cvt_pk_bf16_f32 v73, v100, v102
    v_cvt_pk_bf16_f32 v75, v101, v103
    v_smfmac_f32_16x16x64_bf16 v[104:107], v[84:87], v[32:39], v116
    buffer_store_dwordx4 v[72:75], v118, s[8:11], s25 offen
    s_waitcnt lgkmcnt(3)
    v_smfmac_f32_16x16x64_bf16 v[108:111], v[92:95], v[40:47], v116
    s_waitcnt lgkmcnt(0)
    v_smfmac_f32_16x16x64_bf16 v[108:111], v[80:83], v[56:63], v116
    v_cvt_pk_bf16_f32 v76, v104, v106
    v_smfmac_f32_16x16x64_bf16 v[108:111], v[84:87], v[64:71], v116
    v_and_or_b32 v76, v76, -2, s33
    v_cvt_pk_bf16_f32 v78, v105, v107
    v_mov_b32 v122, v122
    v_mov_b32 v122, v122
    v_mov_b32 v122, v122
    v_mov_b32 v122, v122
    v_mov_b32 v122, v122
    v_mov_b32 v122, v122
    v_cvt_pk_bf16_f32 v77, v108, v110
    v_cvt_pk_bf16_f32 v79, v109, v111
    buffer_store_dwordx4 v[76:79], v118, s[8:11], s26 offen
    ds_read_b128 v[80:83], v123
    ds_read_b128 v[84:87], v123 offset:1024
    ds_read_b128 v[56:59], v123 offset:2048
    ds_read_b128 v[60:63], v123 offset:3072
    ds_read_b128 v[64:67], v123 offset:32768
    ds_read_b128 v[68:71], v123 offset:33792
    ds_read_b128 v[72:75], v123 offset:34816
    ds_read_b128 v[76:79], v123 offset:35840
    ds_read_b128 v[88:91], v123 offset:4096
    ds_read_b128 v[92:95], v123 offset:5120
    ds_read_b128 v[96:99], v123 offset:6144
    ds_read_b128 v[100:103], v123 offset:7168
    ds_read_b128 v[104:107], v123 offset:36864
    ds_read_b128 v[108:111], v123 offset:37888
    ds_read_b128 v[24:27], v123 offset:38912
    ds_read_b128 v[28:31], v123 offset:39936
    s_add_u32 s30, s30, 0x40000
    s_add_u32 s31, s31, 0x40000
    s_add_u32 s32, s32, 0x20000
    s_add_u32 s23, s24, 2048
    s_add_u32 s48, s23, 4096
    s_xor_b32 s25, s25, 0x40000
    s_xor_b32 s26, s26, 0x40000
    s_mov_b32 s35, 0x49800000
    s_add_u32 s22, s22, 1
    v_cndmask_b32 v12, 0, v125, s[68:69]
    v_cndmask_b32 v13, 0, v125, s[70:71]
    v_cndmask_b32 v14, 0, v125, s[72:73]
    v_cndmask_b32 v15, 0, v125, s[74:75]
    v_mov_b32 v32, 0
    v_mov_b32 v33, 0
    v_mov_b32 v34, 0
    v_mov_b32 v35, 0
    v_mov_b32 v36, 0
    v_mov_b32 v37, 0
    v_mov_b32 v38, 0
    v_mov_b32 v39, 0
    v_mov_b32 v40, 0
    v_mov_b32 v41, 0
    v_mov_b32 v42, 0
    v_mov_b32 v43, 0
    v_mov_b32 v44, 0
    v_mov_b32 v45, 0
    v_mov_b32 v46, 0
    v_mov_b32 v47, 0
    v_mov_b32 v54, 0
    v_mov_b32 v55, 0
    v_mov_b32 v52, 0
    v_mov_b32 v52, 0
    v_mov_b32 v52, 0
    v_mov_b32 v52, 0
    v_mov_b32 v52, 0
    v_mov_b32 v52, 0
    v_mov_b32 v52, 0
    v_mov_b32 v52, 0
    v_mov_b32 v52, 0
    v_mov_b32 v52, 0
    v_mov_b32 v52, 0
    v_mov_b32 v52, 0
    v_mov_b32 v52, 0
    buffer_load_dwordx4 v[4:7], v117, s[8:11], s29 offen nt
    buffer_load_dwordx4 v[8:11], v117, s[8:11], s53 offen nt
    buffer_load_dwordx4 v[16:19], v117, s[8:11], s29 offen offset:2048 nt
    buffer_load_dwordx4 v[20:23], v117, s[8:11], s53 offen offset:2048 nt
    v_mov_b32 v52, 0
    s_waitcnt vmcnt(3)
L_rl_33:
    v_mfma_f32_16x16x32_bf16 v[48:51], v[4:7], v[12:15], 0
    v_xor_b32 v52, s33, v4
    s_waitcnt vmcnt(2)
    v_mfma_f32_16x16x32_bf16 v[48:51], v[8:11], v[12:15], v[48:51]
    v_xor_b32 v53, s33, v8
    v_or_b32 v52, v52, v53
    s_waitcnt vmcnt(1)
    v_mfma_f32_16x16x32_bf16 v[48:51], v[16:19], v[12:15], v[48:51]
    v_xor_b32 v53, s33, v16
    v_or_b32 v52, v52, v53
    s_waitcnt vmcnt(0)
    v_mfma_f32_16x16x32_bf16 v[48:51], v[20:23], v[12:15], v[48:51]
    v_xor_b32 v53, s33, v20
    v_or_b32 v52, v52, v53
    v_and_b32 v52, 1, v52
    v_cmp_ne_u32 vcc, 0, v52
    s_cbranch_vccnz L_rslow_34
L_rgo_35:
    s_nop 2
    v_permlane32_swap_b32 v48, v50
    v_permlane32_swap_b32 v49, v51
    v_pk_add_f32 v[48:49], v[48:49], v[50:51]
    s_mov_b64 exec, s[38:39]
    v_cvt_pk_bf16_f32 v12, v48, v49
    v_min_u32 v12, 0xfffffffe, v12
    buffer_store_dword v12, v119, s[8:11], s24 offen
    s_mov_b64 exec, -1
    s_add_u32 s24, s24, 8192
    s_bitset0_b32 s24, 15
    s_xor_b32 s55, s24, 16384
    s_xor_b32 s29, s29, 0x40000
    s_xor_b32 s53, s29, 1024
    s_bfe_u32 s33, s22, 0x10001
    s_waitcnt lgkmcnt(0)
    s_branch L_chain_top2_f
.p2align 6
L_chain_top3_f:
    buffer_load_dwordx4 v[0:3], v117, s[8:11], s23 offen nt
    v_mov_b32 v48, 0
    v_mov_b32 v49, 0
    v_mov_b32 v50, 0
    v_mov_b32 v51, 0
    v_mov_b32 v52, 0
    v_mov_b32 v53, 0
    v_mov_b32 v15, 0
    v_mov_b32 v15, 0
    v_mov_b32 v15, 0
    v_mov_b32 v15, 0
    v_mov_b32 v15, 0
    v_mov_b32 v15, 0
    v_mov_b32 v15, 0
    v_mov_b32 v15, 0
    v_mov_b32 v15, 0
    v_mov_b32 v15, 0
    buffer_load_dwordx4 v[0:3], v117, s[8:11], s23 offen sc1
    v_mov_b32 v15, 0
    v_mov_b32 v15, 0
    v_mov_b32 v15, 0
    v_mov_b32 v15, 0
    v_mov_b32 v15, 0
    v_mov_b32 v15, 0
    v_mov_b32 v15, 0
    v_mov_b32 v15, 0
    v_mov_b32 v15, 0
    v_mov_b32 v15, 0
    v_mov_b32 v15, 0
    v_mov_b32 v15, 0
    v_mov_b32 v15, 0
    v_mov_b32 v15, 0
    v_mov_b32 v15, 0
    v_mov_b32 v15, 0
L_mret_36:
    buffer_load_dwordx4 v[0:3], v117, s[8:11], s23 offen sc1
    s_add_u32 s45, s45, 1
    s_cmp_lt_u32 s45, 0x10000
    s_cselect_b32 s56, -2, -1
    s_nop 3
    v_mov_b32 v32, 0
    v_mov_b32 v33, 0
    v_mov_b32 v34, 0
    v_mov_b32 v35, 0
    s_waitcnt vmcnt(2)
    v_max3_u32 v15, v0, v1, v2
    v_max_u32 v15, v15, v3
    v_cmp_lt_u32 vcc, s56, v15
    v_smfmac_f32_16x16x64_bf16 v[32:35], v[0:3], v[80:87], v116
    s_cbranch_vccnz L_mret_36
    ds_write_b128 v117, v[0:3] offset:3072
    v_smfmac_f32_16x16x64_bf16 v[36:39], v[0:3], v[56:63], v116
    buffer_load_dwordx4 v[4:7], v117, s[8:11], s48 offen nt
    v_smfmac_f32_16x16x64_bf16 v[40:43], v[0:3], v[64:71], v116
    buffer_load_dwordx4 v117, s[8:11], s48 offen nt lds
    s_mov_b32 m0, 14336
    v_smfmac_f32_16x16x64_bf16 v[44:47], v[0:3], v[72:79], v116
    s_waitcnt lgkmcnt(0)
    s_barrier
    ds_read_b128 v[8:11], v117 offset:2048
    v_smfmac_f32_16x16x64_bf16 v[48:51], v[0:3], a[192:199], v116
    ds_read_b128 v[16:19], v117 offset:1024
    ds_read_b128 v[20:23], v117
    v_smfmac_f32_16x16x64_bf16 v[52:55], v[0:3], a[200:207], v116
    ds_read_b128 v[80:83], v117 offset:14336
    s_waitcnt lgkmcnt(3)
    v_smfmac_f32_16x16x64_bf16 v[32:35], v[8:11], a[0:7], v116
    ds_read_b128 v[84:87], v117 offset:15360
    v_smfmac_f32_16x16x64_bf16 v[36:39], v[8:11], a[8:15], v116
    ds_read_b128 v[56:59], v117 offset:8192
    s_waitcnt lgkmcnt(4)
    v_smfmac_f32_16x16x64_bf16 v[32:35], v[16:19], a[32:39], v116
    ds_read_b128 v[60:63], v117 offset:9216
    v_smfmac_f32_16x16x64_bf16 v[36:39], v[16:19], a[40:47], v116
    ds_read_b128 v[64:67], v117 offset:10240
    s_waitcnt lgkmcnt(5)
    v_smfmac_f32_16x16x64_bf16 v[32:35], v[20:23], a[64:71], v116
    ds_read_b128 v[68:71], v117 offset:11264
    v_smfmac_f32_16x16x64_bf16 v[36:39], v[20:23], a[72:79], v116
    ds_read_b128 v[72:75], v117 offset:12288
    v_smfmac_f32_16x16x64_bf16 v[40:43], v[8:11], a[96:103], v116
    ds_read_b128 v[76:79], v117 offset:13312
    v_smfmac_f32_16x16x64_bf16 v[40:43], v[16:19], a[128:135], v116
    buffer_store_dwordx4 v[112:115], v117, s[8:11], s32 offen sc1
    v_smfmac_f32_16x16x64_bf16 v[40:43], v[20:23], a[160:167], v116
    s_waitcnt vmcnt(2)
    v_max3_u32 v15, v4, v5, v6
    v_smfmac_f32_16x16x64_bf16 v[44:47], v[8:11], a[104:111], v116
    v_max_u32 v15, v15, v7
    v_smfmac_f32_16x16x64_bf16 v[44:47], v[16:19], a[136:143], v116
    s_waitcnt vmcnt(1) lgkmcnt(0)
    v_cmp_lt_u32 vcc, s56, v15
    v_smfmac_f32_16x16x64_bf16 v[44:47], v[20:23], a[168:175], v116
    s_cbranch_vccnz L_mret_37
L_mgo_38:
    v_smfmac_f32_16x16x64_bf16 v[44:47], v[4:7], v[24:31], v116
    s_barrier
    ds_read_b128 v[12:15], v117 offset:6144
    v_smfmac_f32_16x16x64_bf16 v[32:35], v[4:7], v[88:95], v116
    ds_read_b128 v[24:27], v117 offset:5120
    v_smfmac_f32_16x16x64_bf16 v[36:39], v[4:7], v[96:103], v116
    ds_read_b128 v[28:31], v117 offset:4096
    v_smfmac_f32_16x16x64_bf16 v[40:43], v[4:7], v[104:111], v116
    ds_read_b128 v[88:91], v117 offset:30720
    s_waitcnt lgkmcnt(3)
    v_smfmac_f32_16x16x64_bf16 v[32:35], v[12:15], a[16:23], v116
    ds_read_b128 v[92:95], v117 offset:31744
    s_waitcnt lgkmcnt(3)
    v_smfmac_f32_16x16x64_bf16 v[32:35], v[24:27], a[48:55], v116
    ds_read_b128 v[96:99], v117 offset:23552
    s_waitcnt lgkmcnt(3)
    v_smfmac_f32_16x16x64_bf16 v[32:35], v[28:31], a[80:87], v116
    buffer_load_dwordx4 v117, s[8:11], s30 offen lds
    v_smfmac_f32_16x16x64_bf16 v[36:39], v[12:15], a[24:31], v116
    ds_read_b128 v[100:103], v117 offset:23552
    v_smfmac_f32_16x16x64_bf16 v[36:39], v[24:27], a[56:63], v116
    ds_read_b128 v[104:107], v117 offset:23552
    v_add_f32 v32, v32, v34
    v_smfmac_f32_16x16x64_bf16 v[36:39], v[28:31], a[88:95], v116
    buffer_load_dwordx4 v117, s[8:11], s30 offen offset:1024 lds
    s_add_u32 m0, s52, 0x6000
    v_add_f32 v33, v33, v35
    v_smfmac_f32_16x16x64_bf16 v[40:43], v[12:15], a[112:119], v116
    ds_read_b128 v[108:111], v117 offset:23552
    v_mul_f32 v32, s34, v32
    v_smfmac_f32_16x16x64_bf16 v[40:43], v[24:27], a[144:151], v116
    ds_read_b128 v[0:3], v124
    v_mul_f32 v33, s34, v33
    v_smfmac_f32_16x16x64_bf16 v[40:43], v[28:31], a[176:183], v116
    s_waitcnt lgkmcnt(5)
    buffer_load_dwordx4 v117, s[8:11], s31 offen lds
    v_add_f32 v36, v36, v38
    v_smfmac_f32_16x16x64_bf16 v[48:51], v[4:7], a[208:215], v116
    v_add_f32 v37, v37, v39
    v_smfmac_f32_16x16x64_bf16 v[52:55], v[4:7], a[216:223], v116
    ds_read_b128 v[4:7], v124 offset:1024
    v_mul_f32 v36, s34, v36
    v_smfmac_f32_16x16x64_bf16 v[44:47], v[12:15], a[120:127], v116
    buffer_load_dwordx4 v117, s[8:11], s31 offen offset:1024 lds
    s_mov_b32 m0, 7168
    v_mul_f32 v37, s34, v37
    v_smfmac_f32_16x16x64_bf16 v[44:47], v[24:27], a[152:159], v116
    v_cvt_pk_bf16_f32 v34, v32, v36
    v_smfmac_f32_16x16x64_bf16 v[44:47], v[28:31], a[184:191], v116
    v_cvt_pk_bf16_f32 v35, v33, v37
    v_add_f32 v40, v40, v42
    v_smfmac_f32_16x16x64_bf16 v[48:51], v[8:11], a[224:231], v116
    ds_write2_b32 v120, v34, v35 offset0:32 offset1:48
    v_add_f32 v41, v41, v43
    v_smfmac_f32_16x16x64_bf16 v[52:55], v[8:11], a[232:239], v116
    v_add_f32 v44, v44, v46
    v_add_f32 v45, v45, v47
    v_cvt_pk_bf16_f32 v113, v40, v44
    v_cvt_pk_bf16_f32 v115, v41, v45
    v_smfmac_f32_16x16x64_bf16 v[48:51], v[12:15], a[240:247], v116
    ds_write2_b32 v120, v113, v115 offset0:0 offset1:16
    v_smfmac_f32_16x16x64_bf16 v[52:55], v[12:15], a[248:255], v116
    s_cmp_eq_u32 s22, 63
    s_cbranch_scc1 L_chain_last_f
    v_smfmac_f32_16x16x64_bf16 v[48:51], v[16:19], v[128:135], v116
    v_smfmac_f32_16x16x64_bf16 v[48:51], v[20:23], v[160:167], v116
    buffer_store_dword v126, v119, s[8:11], s55 offen
    v_smfmac_f32_16x16x64_bf16 v[48:51], v[24:27], v[144:151], v116
    s_waitcnt lgkmcnt(0)
    s_barrier
    v_smfmac_f32_16x16x64_bf16 v[48:51], v[28:31], v[176:183], v116
    ds_read_b128 v[32:35], v121 offset:16384
    ds_read_b128 v[36:39], v121 offset:17408
    v_smfmac_f32_16x16x64_bf16 v[52:55], v[16:19], v[136:143], v116
    ds_read_b128 v[40:43], v121 offset:18432
    ds_read_b128 v[44:47], v121 offset:19456
    v_smfmac_f32_16x16x64_bf16 v[52:55], v[20:23], v[168:175], v116
    ds_read_b128 v[8:11], v124 offset:32768
    v_add_f32 v48, v48, v50
    v_smfmac_f32_16x16x64_bf16 v[52:55], v[24:27], v[152:159], v116
    ds_read_b128 v[12:15], v124 offset:33792
    v_add_f32 v49, v49, v51
    v_smfmac_f32_16x16x64_bf16 v[52:55], v[28:31], v[184:191], v116
    s_waitcnt lgkmcnt(5)
    v_cvt_pk_bf16_f32 v112, v48, v49
    v_mfma_f32_16x16x32_bf16 v[56:59], v[56:59], v[32:35], 0
    s_waitcnt lgkmcnt(4)
    v_mov_b32 v48, s50
    v_mov_b32 v49, s50
    v_mfma_f32_16x16x32_bf16 v[56:59], v[60:63], v[36:39], v[56:59]
    ds_read_b128 v[16:19], v124 offset:2048
    s_waitcnt lgkmcnt(4)
    v_mov_b32 v50, s50
    v_mov_b32 v51, s50
    v_mfma_f32_16x16x32_bf16 v[56:59], v[64:67], v[40:43], v[56:59]
    ds_read_b128 v[20:23], v124 offset:3072
    s_waitcnt lgkmcnt(4)
    v_add_f32 v52, v52, v54
    v_mfma_f32_16x16x32_bf16 v[56:59], v[68:71], v[44:47], v[56:59]
    ds_read_b128 v[24:27], v124 offset:4096
    v_add_f32 v53, v53, v55
    v_mfma_f32_16x16x32_bf16 v[60:63], v[72:75], v[32:35], 0
    ds_read_b128 v[28:31], v124 offset:5120
    v_cvt_pk_bf16_f32 v114, v52, v53
    v_mov_b32 v53, 0
    v_mfma_f32_16x16x32_bf16 v[60:63], v[76:79], v[36:39], v[60:63]
    v_exp_f32 v56, v56
    v_mfma_f32_16x16x32_bf16 v[60:63], v[80:83], v[40:43], v[60:63]
    v_exp_f32 v57, v57
    v_mfma_f32_16x16x32_bf16 v[60:63], v[84:87], v[44:47], v[60:63]
    v_exp_f32 v58, v58
    v_mfma_f32_16x16x32_bf16 v[64:67], v[32:35], v[32:35], 0
    v_exp_f32 v59, v59
    v_cvt_pk_bf16_f32 v68, v56, v57
    v_mfma_f32_16x16x32_bf16 v[64:67], v[36:39], v[36:39], v[64:67]
    v_exp_f32 v60, v60
    v_cvt_pk_bf16_f32 v69, v58, v59
    v_mfma_f32_16x16x32_bf16 v[64:67], v[40:43], v[40:43], v[64:67]
    v_exp_f32 v61, v61
    v_mfma_f32_16x16x32_bf16 v[64:67], v[44:47], v[44:47], v[64:67]
    v_exp_f32 v62, v62
    v_exp_f32 v63, v63
    v_cvt_pk_bf16_f32 v70, v60, v61
    v_cvt_pk_bf16_f32 v71, v62, v63
    s_nop 1
    v_mfma_f32_16x16x32_bf16 v[72:75], v[88:91], v[68:71], 0
    s_nop 0
    v_exp_f32 v64, v64
    v_mfma_f32_16x16x32_bf16 v[76:79], v[92:95], v[68:71], 0
    v_exp_f32 v65, v65
    v_mfma_f32_16x16x32_bf16 v[80:83], v[48:51], v[68:71], 0
    v_cvt_pk_bf16_f32 v52, v64, v65
    s_nop 1
    v_mfma_f32_16x16x16_bf16 v[72:75], v[112:113], v[52:53], v[72:75]
    ds_read_b128 v[32:35], v124 offset:6144
    v_mfma_f32_16x16x16_bf16 v[76:79], v[114:115], v[52:53], v[76:79]
    ds_read_b128 v[36:39], v124 offset:7168
    v_mfma_f32_16x16x16_bf16 v[80:83], v[48:49], v[52:53], v[80:83]
L_norm_39:
    s_mov_b64 vcc, s[36:37]
    v_mov_b32 v122, v122
    v_mov_b32 v122, v122
    v_mov_b32 v122, v122
    v_cndmask_b32_dpp v76, v72, v76, vcc quad_perm:[2,3,2,3] row_mask:0xf bank_mask:0xf
    v_cndmask_b32_dpp v77, v73, v77, vcc quad_perm:[2,3,2,3] row_mask:0xf bank_mask:0xf
    v_cndmask_b32_dpp v78, v74, v78, vcc quad_perm:[2,3,2,3] row_mask:0xf bank_mask:0xf
    v_cndmask_b32_dpp v79, v75, v79, vcc quad_perm:[2,3,2,3] row_mask:0xf bank_mask:0xf
    v_rcp_f32_dpp v84, v80 quad_perm:[2,3,2,3] row_mask:0xf bank_mask:0xf
    s_nop 0
    v_pk_mul_f32 v[76:77], v[76:77], v[84:85] op_sel_hi:[1,0]
    v_pk_mul_f32 v[78:79], v[78:79], v[84:85] op_sel_hi:[1,0]
    v_cvt_pk_bf16_f32 v72, v76, v77
    v_cvt_pk_bf16_f32 v73, v78, v79
    ds_write_b64 v122, v[72:73] offset:22016
    v_max_f32_dpp v86, v80, v84 quad_perm:[2,3,2,3] row_mask:0xf bank_mask:0xf
    v_mov_b32_dpp v60, v72 quad_perm:[0,1,0,1] row_mask:0xf bank_mask:0xf
    v_mov_b32_dpp v61, v73 quad_perm:[0,1,0,1] row_mask:0xf bank_mask:0xf
    v_cmp_lt_f32 vcc, s35, v86
    v_mov_b32_dpp v62, v72 quad_perm:[2,3,2,3] row_mask:0xf bank_mask:0xf
    v_mov_b32_dpp v63, v73 quad_perm:[2,3,2,3] row_mask:0xf bank_mask:0xf
    s_nop 1
    v_smfmac_f32_16x16x64_bf16 v[96:99], v[60:63], v[192:199], v116
    s_cbranch_vccnz L_smax_40
    v_smfmac_f32_16x16x64_bf16 v[100:103], v[60:63], v[224:231], v116
    s_waitcnt lgkmcnt(0)
    s_barrier
    ds_read_b128 v[92:95], v127 offset:21504
    ds_read_b128 v[80:83], v127 offset:20992
    ds_read_b128 v[84:87], v127 offset:20480
    v_smfmac_f32_16x16x64_bf16 v[104:107], v[60:63], v[0:7], v116
    ds_read_b128 v[40:43], v124 offset:34816
    v_smfmac_f32_16x16x64_bf16 v[108:111], v[60:63], v[8:15], v116
    ds_read_b128 v[56:59], v124 offset:36864
    s_waitcnt lgkmcnt(4)
    v_smfmac_f32_16x16x64_bf16 v[96:99], v[92:95], v[200:207], v116
    s_waitcnt lgkmcnt(3)
    v_smfmac_f32_16x16x64_bf16 v[96:99], v[80:83], v[208:215], v116
    ds_read_b128 v[44:47], v124 offset:35840
    s_waitcnt lgkmcnt(3)
    v_smfmac_f32_16x16x64_bf16 v[96:99], v[84:87], v[216:223], v116
    ds_read_b128 v[68:71], v124 offset:39936
    v_smfmac_f32_16x16x64_bf16 v[100:103], v[92:95], v[232:239], v116
    ds_read_b128 v[64:67], v124 offset:38912
    v_smfmac_f32_16x16x64_bf16 v[100:103], v[80:83], v[240:247], v116
    ds_read_b128 v[60:63], v124 offset:37888
    v_cvt_pk_bf16_f32 v72, v96, v98
    v_smfmac_f32_16x16x64_bf16 v[100:103], v[84:87], v[248:255], v116
    v_and_or_b32 v72, v72, -2, s33
    v_smfmac_f32_16x16x64_bf16 v[104:107], v[92:95], v[16:23], v116
    v_cvt_pk_bf16_f32 v74, v97, v99
    v_smfmac_f32_16x16x64_bf16 v[104:107], v[80:83], v[24:31], v116
    v_cvt_pk_bf16_f32 v73, v100, v102
    v_cvt_pk_bf16_f32 v75, v101, v103
    v_smfmac_f32_16x16x64_bf16 v[104:107], v[84:87], v[32:39], v116
    buffer_store_dwordx4 v[72:75], v118, s[8:11], s25 offen
    s_waitcnt lgkmcnt(3)
    v_smfmac_f32_16x16x64_bf16 v[108:111], v[92:95], v[40:47], v116
    s_waitcnt lgkmcnt(0)
    v_smfmac_f32_16x16x64_bf16 v[108:111], v[80:83], v[56:63], v116
    v_cvt_pk_bf16_f32 v76, v104, v106
    v_smfmac_f32_16x16x64_bf16 v[108:111], v[84:87], v[64:71], v116
    v_and_or_b32 v76, v76, -2, s33
    v_cvt_pk_bf16_f32 v78, v105, v107
    v_mov_b32 v122, v122
    v_mov_b32 v122, v122
    v_mov_b32 v122, v122
    v_mov_b32 v122, v122
    v_mov_b32 v122, v122
    v_mov_b32 v122, v122
    v_cvt_pk_bf16_f32 v77, v108, v110
    v_cvt_pk_bf16_f32 v79, v109, v111
    buffer_store_dwordx4 v[76:79], v118, s[8:11], s26 offen
    ds_read_b128 v[80:83], v123
    ds_read_b128 v[84:87], v123 offset:1024
    ds_read_b128 v[56:59], v123 offset:2048
    ds_read_b128 v[60:63], v123 offset:3072
    ds_read_b128 v[64:67], v123 offset:32768
    ds_read_b128 v[68:71], v123 offset:33792
    ds_read_b128 v[72:75], v123 offset:34816
    ds_read_b128 v[76:79], v123 offset:35840
    ds_read_b128 v[88:91], v123 offset:4096
    ds_read_b128 v[92:95], v123 offset:5120
    ds_read_b128 v[96:99], v123 offset:6144
    ds_read_b128 v[100:103], v123 offset:7168
    ds_read_b128 v[104:107], v123 offset:36864
    ds_read_b128 v[108:111], v123 offset:37888
    ds_read_b128 v[24:27], v123 offset:38912
    ds_read_b128 v[28:31], v123 offset:39936
    s_add_u32 s30, s30, 0x40000
    s_add_u32 s31, s31, 0x40000
    s_add_u32 s32, s32, 0x20000
    s_add_u32 s23, s24, 3072
    s_add_u32 s48, s23, 4096
    s_xor_b32 s25, s25, 0x40000
    s_xor_b32 s26, s26, 0x40000
    s_mov_b32 s35, 0x49800000
    s_add_u32 s22, s22, 1
    v_cndmask_b32 v12, 0, v125, s[68:69]
    v_cndmask_b32 v13, 0, v125, s[70:71]
    v_cndmask_b32 v14, 0, v125, s[72:73]
    v_cndmask_b32 v15, 0, v125, s[74:75]
    v_mov_b32 v32, 0
    v_mov_b32 v33, 0
    v_mov_b32 v34, 0
    v_mov_b32 v35, 0
    v_mov_b32 v36, 0
    v_mov_b32 v37, 0
    v_mov_b32 v38, 0
    v_mov_b32 v39, 0
    v_mov_b32 v40, 0
    v_mov_b32 v41, 0
    v_mov_b32 v42, 0
    v_mov_b32 v43, 0
    v_mov_b32 v44, 0
    v_mov_b32 v45, 0
    v_mov_b32 v46, 0
    v_mov_b32 v47, 0
    v_mov_b32 v54, 0
    v_mov_b32 v55, 0
    v_mov_b32 v52, 0
    v_mov_b32 v52, 0
    v_mov_b32 v52, 0
    v_mov_b32 v52, 0
    v_mov_b32 v52, 0
    v_mov_b32 v52, 0
    v_mov_b32 v52, 0
    v_mov_b32 v52, 0
    v_mov_b32 v52, 0
    v_mov_b32 v52, 0
    v_mov_b32 v52, 0
    v_mov_b32 v52, 0
    v_mov_b32 v52, 0
    v_mov_b32 v52, 0
    v_mov_b32 v52, 0
    v_mov_b32 v52, 0
    v_mov_b32 v52, 0
    v_mov_b32 v52, 0
    v_mov_b32 v52, 0
    v_mov_b32 v52, 0
    v_mov_b32 v52, 0
    v_mov_b32 v52, 0
    v_mov_b32 v52, 0
    v_mov_b32 v52, 0
    v_mov_b32 v52, 0
    v_mov_b32 v52, 0
    v_mov_b32 v52, 0
    v_mov_b32 v52, 0
    v_mov_b32 v52, 0
    v_mov_b32 v52, 0
    v_mov_b32 v52, 0
    v_mov_b32 v52, 0
    v_mov_b32 v52, 0
    v_mov_b32 v52, 0
    v_mov_b32 v52, 0
    v_mov_b32 v52, 0
    v_mov_b32 v52, 0
    v_mov_b32 v52, 0
    v_mov_b32 v52, 0
    v_mov_b32 v52, 0
    v_mov_b32 v52, 0
    v_mov_b32 v52, 0
    v_mov_b32 v52, 0
    buffer_load_dwordx4 v[4:7], v117, s[8:11], s29 offen nt
    buffer_load_dwordx4 v[8:11], v117, s[8:11], s53 offen nt
    buffer_load_dwordx4 v[16:19], v117, s[8:11], s29 offen offset:2048 nt
    buffer_load_dwordx4 v[20:23], v117, s[8:11], s53 offen offset:2048 nt
    v_mov_b32 v52, 0
    s_waitcnt vmcnt(3)
L_rl_41:
    v_mfma_f32_16x16x32_bf16 v[48:51], v[4:7], v[12:15], 0
    v_xor_b32 v52, s33, v4
    s_waitcnt vmcnt(2)
    v_mfma_f32_16x16x32_bf16 v[48:51], v[8:11], v[12:15], v[48:51]
    v_xor_b32 v53, s33, v8
    v_or_b32 v52, v52, v53
    s_waitcnt vmcnt(1)
    v_mfma_f32_16x16x32_bf16 v[48:51], v[16:19], v[12:15], v[48:51]
    v_xor_b32 v53, s33, v16
    v_or_b32 v52, v52, v53
    s_waitcnt vmcnt(0)
    v_mfma_f32_16x16x32_bf16 v[48:51], v[20:23], v[12:15], v[48:51]
    v_xor_b32 v53, s33, v20
    v_or_b32 v52, v52, v53
    v_and_b32 v52, 1, v52
    v_cmp_ne_u32 vcc, 0, v52
    s_cbranch_vccnz L_rslow_42
L_rgo_43:
    s_nop 2
    v_permlane32_swap_b32 v48, v50
    v_permlane32_swap_b32 v49, v51
    v_pk_add_f32 v[48:49], v[48:49], v[50:51]
    s_mov_b64 exec, s[38:39]
    v_cvt_pk_bf16_f32 v12, v48, v49
    v_min_u32 v12, 0xfffffffe, v12
    buffer_store_dword v12, v119, s[8:11], s24 offen
    s_mov_b64 exec, -1
    s_add_u32 s24, s24, 8192
    s_bitset0_b32 s24, 15
    s_xor_b32 s55, s24, 16384
    s_xor_b32 s29, s29, 0x40000
    s_xor_b32 s53, s29, 1024
    s_bfe_u32 s33, s22, 0x10001
    s_waitcnt lgkmcnt(0)
    s_branch L_chain_top3_f
L_chain_last_f:
    s_nop 1
    v_smfmac_f32_16x16x64_bf16 v[48:51], v[16:19], v[128:135], v116
    v_smfmac_f32_16x16x64_bf16 v[48:51], v[20:23], v[160:167], v116
    v_smfmac_f32_16x16x64_bf16 v[48:51], v[24:27], v[144:151], v116
    v_smfmac_f32_16x16x64_bf16 v[48:51], v[28:31], v[176:183], v116
    v_smfmac_f32_16x16x64_bf16 v[52:55], v[16:19], v[136:143], v116
    v_smfmac_f32_16x16x64_bf16 v[52:55], v[20:23], v[168:175], v116
    v_smfmac_f32_16x16x64_bf16 v[52:55], v[24:27], v[152:159], v116
    v_smfmac_f32_16x16x64_bf16 v[52:55], v[28:31], v[184:191], v116
    v_add_f32 v48, v48, v50
    v_add_f32 v49, v49, v51
    v_cvt_pk_bf16_f32 v112, v48, v49
    s_nop 4
    v_add_f32 v52, v52, v54
    v_add_f32 v53, v53, v55
    v_cvt_pk_bf16_f32 v114, v52, v53
    s_add_u32 s32, s32, 0x20000
    buffer_store_dwordx4 v[112:115], v117, s[8:11], s32 offen sc1
    v_mov_b32 v94, 64
    s_waitcnt vmcnt(0) lgkmcnt(0)
    s_barrier
    s_mov_b64 exec, 1
    buffer_store_dword v94, off, s[8:11], s44 sc1
    s_mov_b64 exec, -1
    s_endpgm
L_mret_15:
    s_mov_b32 s43, m0
    s_mov_b32 m0, 4096
    buffer_load_dwordx4 v[4:7], v117, s[8:11], s48 offen sc1
    buffer_load_dwordx4 v117, s[8:11], s48 offen sc1 lds
    s_mov_b32 m0, 8192
    s_mov_b32 m0, s43
    s_waitcnt vmcnt(0)
    v_max3_u32 v15, v4, v5, v6
    v_max_u32 v15, v15, v7
    v_cmp_lt_u32 vcc, s56, v15
    s_add_u32 s47, s47, 1
    s_add_u32 s49, s49, 1
    s_cmp_ge_u32 s49, 0x10000
    s_cbranch_scc1 L_mgo_16
    s_cbranch_vccnz L_mret_15
    s_branch L_mgo_16
L_smax_18:
    s_add_u32 s47, s47, 1
    s_mov_b32 s35, 0x7f800000
    s_waitcnt lgkmcnt(0)
    s_sub_u32 s43, s30, 0x40000
    s_add_u32 s40, s43, 4096
    s_nop 7
    buffer_load_dwordx4 v[56:59], v117, s[8:11], s43 offen
    buffer_load_dwordx4 v[60:63], v117, s[8:11], s43 offen offset:1024
    buffer_load_dwordx4 v[64:67], v117, s[8:11], s43 offen offset:2048
    buffer_load_dwordx4 v[68:71], v117, s[8:11], s43 offen offset:3072
    buffer_load_dwordx4 v[72:75], v117, s[8:11], s40 offen
    buffer_load_dwordx4 v[76:79], v117, s[8:11], s40 offen offset:1024
    buffer_load_dwordx4 v[80:83], v117, s[8:11], s40 offen offset:2048
    buffer_load_dwordx4 v[84:87], v117, s[8:11], s40 offen offset:3072
    ds_read_b128 v[32:35], v121 offset:16384
    ds_read_b128 v[36:39], v121 offset:17408
    ds_read_b128 v[40:43], v121 offset:18432
    ds_read_b128 v[44:47], v121 offset:19456
    v_mov_b32 v96, 0
    v_mov_b32 v97, 0
    v_mov_b32 v98, 0
    v_mov_b32 v99, 0
    v_mov_b32 v100, 0
    v_mov_b32 v101, 0
    v_mov_b32 v102, 0
    v_mov_b32 v103, 0
    v_mov_b32 v104, 0
    v_mov_b32 v105, 0
    v_mov_b32 v106, 0
    v_mov_b32 v107, 0
    v_mov_b32 v108, 0
    v_mov_b32 v109, 0
    v_mov_b32 v110, 0
    v_mov_b32 v111, 0
    s_waitcnt vmcnt(0) lgkmcnt(0)
    v_mfma_f32_16x16x32_bf16 v[56:59], v[56:59], v[32:35], 0
    v_mfma_f32_16x16x32_bf16 v[56:59], v[60:63], v[36:39], v[56:59]
    v_mfma_f32_16x16x32_bf16 v[56:59], v[64:67], v[40:43], v[56:59]
    v_mfma_f32_16x16x32_bf16 v[56:59], v[68:71], v[44:47], v[56:59]
    v_mfma_f32_16x16x32_bf16 v[60:63], v[72:75], v[32:35], 0
    v_mfma_f32_16x16x32_bf16 v[60:63], v[76:79], v[36:39], v[60:63]
    v_mfma_f32_16x16x32_bf16 v[60:63], v[80:83], v[40:43], v[60:63]
    v_mfma_f32_16x16x32_bf16 v[60:63], v[84:87], v[44:47], v[60:63]
    v_mfma_f32_16x16x32_bf16 v[64:67], v[32:35], v[32:35], 0
    v_mfma_f32_16x16x32_bf16 v[64:67], v[36:39], v[36:39], v[64:67]
    v_mfma_f32_16x16x32_bf16 v[64:67], v[40:43], v[40:43], v[64:67]
    v_mfma_f32_16x16x32_bf16 v[64:67], v[44:47], v[44:47], v[64:67]
    v_max3_f32 v84, v56, v57, v58
    v_max3_f32 v84, v84, v59, v60
    v_max3_f32 v84, v84, v61, v62
    s_nop 4
    v_max3_f32 v84, v84, v63, v64
    v_max_f32 v84, v84, v65
    v_mov_b32 v85, v84
    s_nop 1
    v_permlane32_swap_b32 v85, v84
    v_max_f32 v84, v85, v84
    v_mov_b32 v85, v84
    s_nop 1
    v_permlane16_swap_b32 v85, v84
    v_max_f32 v84, v85, v84
    v_sub_f32 v56, v56, v84
    v_sub_f32 v57, v57, v84
    v_sub_f32 v58, v58, v84
    v_sub_f32 v59, v59, v84
    v_sub_f32 v60, v60, v84
    v_sub_f32 v61, v61, v84
    v_sub_f32 v62, v62, v84
    v_sub_f32 v63, v63, v84
    v_sub_f32 v64, v64, v84
    v_sub_f32 v65, v65, v84
    v_exp_f32 v56, v56
    v_exp_f32 v57, v57
    v_exp_f32 v58, v58
    v_exp_f32 v59, v59
    v_exp_f32 v60, v60
    v_exp_f32 v61, v61
    v_exp_f32 v62, v62
    v_exp_f32 v63, v63
    v_exp_f32 v64, v64
    v_exp_f32 v65, v65
    v_cvt_pk_bf16_f32 v68, v56, v57
    v_cvt_pk_bf16_f32 v69, v58, v59
    v_cvt_pk_bf16_f32 v70, v60, v61
    v_cvt_pk_bf16_f32 v71, v62, v63
    v_cvt_pk_bf16_f32 v52, v64, v65
    s_nop 0
    v_mfma_f32_16x16x32_bf16 v[72:75], v[88:91], v[68:71], 0
    v_mfma_f32_16x16x32_bf16 v[76:79], v[92:95], v[68:71], 0
    v_mfma_f32_16x16x32_bf16 v[80:83], v[48:51], v[68:71], 0
    v_mfma_f32_16x16x16_bf16 v[72:75], v[112:113], v[52:53], v[72:75]
    v_mfma_f32_16x16x16_bf16 v[76:79], v[114:115], v[52:53], v[76:79]
    v_mfma_f32_16x16x16_bf16 v[80:83], v[48:49], v[52:53], v[80:83]
    ds_read_b128 v[32:35], v124 offset:6144
    ds_read_b128 v[36:39], v124 offset:7168
    ds_read_b128 v[40:43], v124 offset:34816
    ds_read_b128 v[44:47], v124 offset:35840
    ds_read_b128 v[56:59], v124 offset:36864
    ds_read_b128 v[64:67], v124 offset:38912
    ds_read_b128 v[68:71], v124 offset:39936
    s_waitcnt lgkmcnt(0)
    s_branch L_norm_17
L_kvw_19:
    s_add_u32 s47, s47, 1
    s_add_u32 s49, s49, 1
    s_cmp_ge_u32 s49, 0x10000
    s_cbranch_scc1 L_kvb_20
    s_sleep 4
    buffer_load_dword v125, v119, s[8:11], s28 offen sc1
    s_waitcnt vmcnt(0)
    v_cmp_eq_u32 vcc, 0, v125
    s_nop 0
    s_and_b64 vcc, vcc, s[58:59]
    s_cbranch_scc1 L_kvw_19
    s_branch L_kvb_20
L_mret_22:
    s_mov_b32 s43, m0
    s_mov_b32 m0, 5120
    buffer_load_dwordx4 v[4:7], v117, s[8:11], s48 offen sc1
    buffer_load_dwordx4 v117, s[8:11], s48 offen sc1 lds
    s_mov_b32 m0, 10240
    s_mov_b32 m0, s43
    s_waitcnt vmcnt(0)
    v_max3_u32 v15, v4, v5, v6
    v_max_u32 v15, v15, v7
    v_cmp_lt_u32 vcc, s56, v15
    s_add_u32 s47, s47, 1
    s_add_u32 s49, s49, 1
    s_cmp_ge_u32 s49, 0x10000
    s_cbranch_scc1 L_mgo_23
    s_cbranch_vccnz L_mret_22
    s_branch L_mgo_23
L_smax_25:
    s_add_u32 s47, s47, 1
    s_mov_b32 s35, 0x7f800000
    s_waitcnt lgkmcnt(0)
    s_sub_u32 s43, s30, 0x40800
    s_add_u32 s40, s43, 4096
    s_nop 7
    buffer_load_dwordx4 v[56:59], v117, s[8:11], s43 offen
    buffer_load_dwordx4 v[60:63], v117, s[8:11], s43 offen offset:1024
    buffer_load_dwordx4 v[64:67], v117, s[8:11], s43 offen offset:2048
    buffer_load_dwordx4 v[68:71], v117, s[8:11], s43 offen offset:3072
    buffer_load_dwordx4 v[72:75], v117, s[8:11], s40 offen
    buffer_load_dwordx4 v[76:79], v117, s[8:11], s40 offen offset:1024
    buffer_load_dwordx4 v[80:83], v117, s[8:11], s40 offen offset:2048
    buffer_load_dwordx4 v[84:87], v117, s[8:11], s40 offen offset:3072
    ds_read_b128 v[32:35], v121 offset:16384
    ds_read_b128 v[36:39], v121 offset:17408
    ds_read_b128 v[40:43], v121 offset:18432
    ds_read_b128 v[44:47], v121 offset:19456
    v_mov_b32 v96, 0
    v_mov_b32 v97, 0
    v_mov_b32 v98, 0
    v_mov_b32 v99, 0
    v_mov_b32 v100, 0
    v_mov_b32 v101, 0
    v_mov_b32 v102, 0
    v_mov_b32 v103, 0
    v_mov_b32 v104, 0
    v_mov_b32 v105, 0
    v_mov_b32 v106, 0
    v_mov_b32 v107, 0
    v_mov_b32 v108, 0
    v_mov_b32 v109, 0
    v_mov_b32 v110, 0
    v_mov_b32 v111, 0
    s_waitcnt vmcnt(0) lgkmcnt(0)
    v_mfma_f32_16x16x32_bf16 v[56:59], v[56:59], v[32:35], 0
    v_mfma_f32_16x16x32_bf16 v[56:59], v[60:63], v[36:39], v[56:59]
    v_mfma_f32_16x16x32_bf16 v[56:59], v[64:67], v[40:43], v[56:59]
    v_mfma_f32_16x16x32_bf16 v[56:59], v[68:71], v[44:47], v[56:59]
    v_mfma_f32_16x16x32_bf16 v[60:63], v[72:75], v[32:35], 0
    v_mfma_f32_16x16x32_bf16 v[60:63], v[76:79], v[36:39], v[60:63]
    v_mfma_f32_16x16x32_bf16 v[60:63], v[80:83], v[40:43], v[60:63]
    v_mfma_f32_16x16x32_bf16 v[60:63], v[84:87], v[44:47], v[60:63]
    v_mfma_f32_16x16x32_bf16 v[64:67], v[32:35], v[32:35], 0
    v_mfma_f32_16x16x32_bf16 v[64:67], v[36:39], v[36:39], v[64:67]
    v_mfma_f32_16x16x32_bf16 v[64:67], v[40:43], v[40:43], v[64:67]
    v_mfma_f32_16x16x32_bf16 v[64:67], v[44:47], v[44:47], v[64:67]
    v_max3_f32 v84, v56, v57, v58
    v_max3_f32 v84, v84, v59, v60
    v_max3_f32 v84, v84, v61, v62
    s_nop 4
    v_max3_f32 v84, v84, v63, v64
    v_max_f32 v84, v84, v65
    v_mov_b32 v85, v84
    s_nop 1
    v_permlane32_swap_b32 v85, v84
    v_max_f32 v84, v85, v84
    v_mov_b32 v85, v84
    s_nop 1
    v_permlane16_swap_b32 v85, v84
    v_max_f32 v84, v85, v84
    v_sub_f32 v56, v56, v84
    v_sub_f32 v57, v57, v84
    v_sub_f32 v58, v58, v84
    v_sub_f32 v59, v59, v84
    v_sub_f32 v60, v60, v84
    v_sub_f32 v61, v61, v84
    v_sub_f32 v62, v62, v84
    v_sub_f32 v63, v63, v84
    v_sub_f32 v64, v64, v84
    v_sub_f32 v65, v65, v84
    v_exp_f32 v56, v56
    v_exp_f32 v57, v57
    v_exp_f32 v58, v58
    v_exp_f32 v59, v59
    v_exp_f32 v60, v60
    v_exp_f32 v61, v61
    v_exp_f32 v62, v62
    v_exp_f32 v63, v63
    v_exp_f32 v64, v64
    v_exp_f32 v65, v65
    v_cvt_pk_bf16_f32 v68, v56, v57
    v_cvt_pk_bf16_f32 v69, v58, v59
    v_cvt_pk_bf16_f32 v70, v60, v61
    v_cvt_pk_bf16_f32 v71, v62, v63
    v_cvt_pk_bf16_f32 v52, v64, v65
    s_nop 0
    v_mfma_f32_16x16x32_bf16 v[72:75], v[88:91], v[68:71], 0
    v_mfma_f32_16x16x32_bf16 v[76:79], v[92:95], v[68:71], 0
    v_mfma_f32_16x16x32_bf16 v[80:83], v[48:51], v[68:71], 0
    v_mfma_f32_16x16x16_bf16 v[72:75], v[112:113], v[52:53], v[72:75]
    v_mfma_f32_16x16x16_bf16 v[76:79], v[114:115], v[52:53], v[76:79]
    v_mfma_f32_16x16x16_bf16 v[80:83], v[48:49], v[52:53], v[80:83]
    ds_read_b128 v[32:35], v124 offset:6144
    ds_read_b128 v[36:39], v124 offset:7168
    ds_read_b128 v[40:43], v124 offset:34816
    ds_read_b128 v[44:47], v124 offset:35840
    ds_read_b128 v[56:59], v124 offset:36864
    ds_read_b128 v[64:67], v124 offset:38912
    ds_read_b128 v[68:71], v124 offset:39936
    s_waitcnt lgkmcnt(0)
    s_branch L_norm_24
L_kvw_26:
    s_add_u32 s47, s47, 1
    s_add_u32 s49, s49, 1
    s_cmp_ge_u32 s49, 0x10000
    s_cbranch_scc1 L_kvb_27
    s_sleep 4
    buffer_load_dword v125, v119, s[8:11], s28 offen sc1
    s_waitcnt vmcnt(0)
    v_cmp_eq_u32 vcc, 0, v125
    s_nop 0
    s_and_b64 vcc, vcc, s[58:59]
    s_cbranch_scc1 L_kvw_26
    s_branch L_kvb_27
L_mret_29:
    s_mov_b32 s43, m0
    s_mov_b32 m0, 6144
    buffer_load_dwordx4 v[4:7], v117, s[8:11], s48 offen sc1
    buffer_load_dwordx4 v117, s[8:11], s48 offen sc1 lds
    s_mov_b32 m0, 12288
    s_mov_b32 m0, s43
    s_waitcnt vmcnt(0)
    v_max3_u32 v15, v4, v5, v6
    v_max_u32 v15, v15, v7
    v_cmp_lt_u32 vcc, s56, v15
    s_add_u32 s47, s47, 1
    s_add_u32 s49, s49, 1
    s_cmp_ge_u32 s49, 0x10000
    s_cbranch_scc1 L_mgo_30
    s_cbranch_vccnz L_mret_29
    s_branch L_mgo_30
L_smax_32:
    s_add_u32 s47, s47, 1
    s_mov_b32 s35, 0x7f800000
    s_waitcnt lgkmcnt(0)
    s_sub_u32 s43, s30, 0x41000
    s_add_u32 s40, s43, 4096
    s_nop 7
    buffer_load_dwordx4 v[56:59], v117, s[8:11], s43 offen
    buffer_load_dwordx4 v[60:63], v117, s[8:11], s43 offen offset:1024
    buffer_load_dwordx4 v[64:67], v117, s[8:11], s43 offen offset:2048
    buffer_load_dwordx4 v[68:71], v117, s[8:11], s43 offen offset:3072
    buffer_load_dwordx4 v[72:75], v117, s[8:11], s40 offen
    buffer_load_dwordx4 v[76:79], v117, s[8:11], s40 offen offset:1024
    buffer_load_dwordx4 v[80:83], v117, s[8:11], s40 offen offset:2048
    buffer_load_dwordx4 v[84:87], v117, s[8:11], s40 offen offset:3072
    ds_read_b128 v[32:35], v121 offset:16384
    ds_read_b128 v[36:39], v121 offset:17408
    ds_read_b128 v[40:43], v121 offset:18432
    ds_read_b128 v[44:47], v121 offset:19456
    v_mov_b32 v96, 0
    v_mov_b32 v97, 0
    v_mov_b32 v98, 0
    v_mov_b32 v99, 0
    v_mov_b32 v100, 0
    v_mov_b32 v101, 0
    v_mov_b32 v102, 0
    v_mov_b32 v103, 0
    v_mov_b32 v104, 0
    v_mov_b32 v105, 0
    v_mov_b32 v106, 0
    v_mov_b32 v107, 0
    v_mov_b32 v108, 0
    v_mov_b32 v109, 0
    v_mov_b32 v110, 0
    v_mov_b32 v111, 0
    s_waitcnt vmcnt(0) lgkmcnt(0)
    v_mfma_f32_16x16x32_bf16 v[56:59], v[56:59], v[32:35], 0
    v_mfma_f32_16x16x32_bf16 v[56:59], v[60:63], v[36:39], v[56:59]
    v_mfma_f32_16x16x32_bf16 v[56:59], v[64:67], v[40:43], v[56:59]
    v_mfma_f32_16x16x32_bf16 v[56:59], v[68:71], v[44:47], v[56:59]
    v_mfma_f32_16x16x32_bf16 v[60:63], v[72:75], v[32:35], 0
    v_mfma_f32_16x16x32_bf16 v[60:63], v[76:79], v[36:39], v[60:63]
    v_mfma_f32_16x16x32_bf16 v[60:63], v[80:83], v[40:43], v[60:63]
    v_mfma_f32_16x16x32_bf16 v[60:63], v[84:87], v[44:47], v[60:63]
    v_mfma_f32_16x16x32_bf16 v[64:67], v[32:35], v[32:35], 0
    v_mfma_f32_16x16x32_bf16 v[64:67], v[36:39], v[36:39], v[64:67]
    v_mfma_f32_16x16x32_bf16 v[64:67], v[40:43], v[40:43], v[64:67]
    v_mfma_f32_16x16x32_bf16 v[64:67], v[44:47], v[44:47], v[64:67]
    v_max3_f32 v84, v56, v57, v58
    v_max3_f32 v84, v84, v59, v60
    v_max3_f32 v84, v84, v61, v62
    s_nop 4
    v_max3_f32 v84, v84, v63, v64
    v_max_f32 v84, v84, v65
    v_mov_b32 v85, v84
    s_nop 1
    v_permlane32_swap_b32 v85, v84
    v_max_f32 v84, v85, v84
    v_mov_b32 v85, v84
    s_nop 1
    v_permlane16_swap_b32 v85, v84
    v_max_f32 v84, v85, v84
    v_sub_f32 v56, v56, v84
    v_sub_f32 v57, v57, v84
    v_sub_f32 v58, v58, v84
    v_sub_f32 v59, v59, v84
    v_sub_f32 v60, v60, v84
    v_sub_f32 v61, v61, v84
    v_sub_f32 v62, v62, v84
    v_sub_f32 v63, v63, v84
    v_sub_f32 v64, v64, v84
    v_sub_f32 v65, v65, v84
    v_exp_f32 v56, v56
    v_exp_f32 v57, v57
    v_exp_f32 v58, v58
    v_exp_f32 v59, v59
    v_exp_f32 v60, v60
    v_exp_f32 v61, v61
    v_exp_f32 v62, v62
    v_exp_f32 v63, v63
    v_exp_f32 v64, v64
    v_exp_f32 v65, v65
    v_cvt_pk_bf16_f32 v68, v56, v57
    v_cvt_pk_bf16_f32 v69, v58, v59
    v_cvt_pk_bf16_f32 v70, v60, v61
    v_cvt_pk_bf16_f32 v71, v62, v63
    v_cvt_pk_bf16_f32 v52, v64, v65
    s_nop 0
    v_mfma_f32_16x16x32_bf16 v[72:75], v[88:91], v[68:71], 0
    v_mfma_f32_16x16x32_bf16 v[76:79], v[92:95], v[68:71], 0
    v_mfma_f32_16x16x32_bf16 v[80:83], v[48:51], v[68:71], 0
    v_mfma_f32_16x16x16_bf16 v[72:75], v[112:113], v[52:53], v[72:75]
    v_mfma_f32_16x16x16_bf16 v[76:79], v[114:115], v[52:53], v[76:79]
    v_mfma_f32_16x16x16_bf16 v[80:83], v[48:49], v[52:53], v[80:83]
    ds_read_b128 v[32:35], v124 offset:6144
    ds_read_b128 v[36:39], v124 offset:7168
    ds_read_b128 v[40:43], v124 offset:34816
    ds_read_b128 v[44:47], v124 offset:35840
    ds_read_b128 v[56:59], v124 offset:36864
    ds_read_b128 v[64:67], v124 offset:38912
    ds_read_b128 v[68:71], v124 offset:39936
    s_waitcnt lgkmcnt(0)
    s_branch L_norm_31
L_rslow_34:
    buffer_load_dwordx4 v[4:7], v117, s[8:11], s29 offen sc1
    buffer_load_dwordx4 v[8:11], v117, s[8:11], s53 offen sc1
    buffer_load_dwordx4 v[16:19], v117, s[8:11], s29 offen offset:2048 sc1
    buffer_load_dwordx4 v[20:23], v117, s[8:11], s53 offen offset:2048 sc1
    s_add_u32 s46, s46, 1
    s_add_u32 s49, s49, 1
    s_cmp_ge_u32 s49, 0x10000
    s_cbranch_scc1 L_rgo_35
    s_waitcnt vmcnt(0)
    s_branch L_rl_33
L_mret_37:
    s_mov_b32 s43, m0
    s_mov_b32 m0, 7168
    buffer_load_dwordx4 v[4:7], v117, s[8:11], s48 offen sc1
    buffer_load_dwordx4 v117, s[8:11], s48 offen sc1 lds
    s_mov_b32 m0, 14336
    s_mov_b32 m0, s43
    s_waitcnt vmcnt(0)
    v_max3_u32 v15, v4, v5, v6
    v_max_u32 v15, v15, v7
    v_cmp_lt_u32 vcc, s56, v15
    s_add_u32 s47, s47, 1
    s_add_u32 s49, s49, 1
    s_cmp_ge_u32 s49, 0x10000
    s_cbranch_scc1 L_mgo_38
    s_cbranch_vccnz L_mret_37
    s_branch L_mgo_38
L_smax_40:
    s_add_u32 s47, s47, 1
    s_mov_b32 s35, 0x7f800000
    s_waitcnt lgkmcnt(0)
    s_sub_u32 s43, s30, 0x41800
    s_add_u32 s40, s43, 4096
    s_nop 7
    buffer_load_dwordx4 v[56:59], v117, s[8:11], s43 offen
    buffer_load_dwordx4 v[60:63], v117, s[8:11], s43 offen offset:1024
    buffer_load_dwordx4 v[64:67], v117, s[8:11], s43 offen offset:2048
    buffer_load_dwordx4 v[68:71], v117, s[8:11], s43 offen offset:3072
    buffer_load_dwordx4 v[72:75], v117, s[8:11], s40 offen
    buffer_load_dwordx4 v[76:79], v117, s[8:11], s40 offen offset:1024
    buffer_load_dwordx4 v[80:83], v117, s[8:11], s40 offen offset:2048
    buffer_load_dwordx4 v[84:87], v117, s[8:11], s40 offen offset:3072
    ds_read_b128 v[32:35], v121 offset:16384
    ds_read_b128 v[36:39], v121 offset:17408
    ds_read_b128 v[40:43], v121 offset:18432
    ds_read_b128 v[44:47], v121 offset:19456
    v_mov_b32 v96, 0
    v_mov_b32 v97, 0
    v_mov_b32 v98, 0
    v_mov_b32 v99, 0
    v_mov_b32 v100, 0
    v_mov_b32 v101, 0
    v_mov_b32 v102, 0
    v_mov_b32 v103, 0
    v_mov_b32 v104, 0
    v_mov_b32 v105, 0
    v_mov_b32 v106, 0
    v_mov_b32 v107, 0
    v_mov_b32 v108, 0
    v_mov_b32 v109, 0
    v_mov_b32 v110, 0
    v_mov_b32 v111, 0
    s_waitcnt vmcnt(0) lgkmcnt(0)
    v_mfma_f32_16x16x32_bf16 v[56:59], v[56:59], v[32:35], 0
    v_mfma_f32_16x16x32_bf16 v[56:59], v[60:63], v[36:39], v[56:59]
    v_mfma_f32_16x16x32_bf16 v[56:59], v[64:67], v[40:43], v[56:59]
    v_mfma_f32_16x16x32_bf16 v[56:59], v[68:71], v[44:47], v[56:59]
    v_mfma_f32_16x16x32_bf16 v[60:63], v[72:75], v[32:35], 0
    v_mfma_f32_16x16x32_bf16 v[60:63], v[76:79], v[36:39], v[60:63]
    v_mfma_f32_16x16x32_bf16 v[60:63], v[80:83], v[40:43], v[60:63]
    v_mfma_f32_16x16x32_bf16 v[60:63], v[84:87], v[44:47], v[60:63]
    v_mfma_f32_16x16x32_bf16 v[64:67], v[32:35], v[32:35], 0
    v_mfma_f32_16x16x32_bf16 v[64:67], v[36:39], v[36:39], v[64:67]
    v_mfma_f32_16x16x32_bf16 v[64:67], v[40:43], v[40:43], v[64:67]
    v_mfma_f32_16x16x32_bf16 v[64:67], v[44:47], v[44:47], v[64:67]
    v_max3_f32 v84, v56, v57, v58
    v_max3_f32 v84, v84, v59, v60
    v_max3_f32 v84, v84, v61, v62
    s_nop 4
    v_max3_f32 v84, v84, v63, v64
    v_max_f32 v84, v84, v65
    v_mov_b32 v85, v84
    s_nop 1
    v_permlane32_swap_b32 v85, v84
    v_max_f32 v84, v85, v84
    v_mov_b32 v85, v84
    s_nop 1
    v_permlane16_swap_b32 v85, v84
    v_max_f32 v84, v85, v84
    v_sub_f32 v56, v56, v84
    v_sub_f32 v57, v57, v84
    v_sub_f32 v58, v58, v84
    v_sub_f32 v59, v59, v84
    v_sub_f32 v60, v60, v84
    v_sub_f32 v61, v61, v84
    v_sub_f32 v62, v62, v84
    v_sub_f32 v63, v63, v84
    v_sub_f32 v64, v64, v84
    v_sub_f32 v65, v65, v84
    v_exp_f32 v56, v56
    v_exp_f32 v57, v57
    v_exp_f32 v58, v58
    v_exp_f32 v59, v59
    v_exp_f32 v60, v60
    v_exp_f32 v61, v61
    v_exp_f32 v62, v62
    v_exp_f32 v63, v63
    v_exp_f32 v64, v64
    v_exp_f32 v65, v65
    v_cvt_pk_bf16_f32 v68, v56, v57
    v_cvt_pk_bf16_f32 v69, v58, v59
    v_cvt_pk_bf16_f32 v70, v60, v61
    v_cvt_pk_bf16_f32 v71, v62, v63
    v_cvt_pk_bf16_f32 v52, v64, v65
    s_nop 0
    v_mfma_f32_16x16x32_bf16 v[72:75], v[88:91], v[68:71], 0
    v_mfma_f32_16x16x32_bf16 v[76:79], v[92:95], v[68:71], 0
    v_mfma_f32_16x16x32_bf16 v[80:83], v[48:51], v[68:71], 0
    v_mfma_f32_16x16x16_bf16 v[72:75], v[112:113], v[52:53], v[72:75]
    v_mfma_f32_16x16x16_bf16 v[76:79], v[114:115], v[52:53], v[76:79]
    v_mfma_f32_16x16x16_bf16 v[80:83], v[48:49], v[52:53], v[80:83]
    ds_read_b128 v[32:35], v124 offset:6144
    ds_read_b128 v[36:39], v124 offset:7168
    ds_read_b128 v[40:43], v124 offset:34816
    ds_read_b128 v[44:47], v124 offset:35840
    ds_read_b128 v[56:59], v124 offset:36864
    ds_read_b128 v[64:67], v124 offset:38912
    ds_read_b128 v[68:71], v124 offset:39936
    s_waitcnt lgkmcnt(0)
    s_branch L_norm_39
L_rslow_42:
    buffer_load_dwordx4 v[4:7], v117, s[8:11], s29 offen sc1
    buffer_load_dwordx4 v[8:11], v117, s[8:11], s53 offen sc1
    buffer_load_dwordx4 v[16:19], v117, s[8:11], s29 offen offset:2048 sc1
    buffer_load_dwordx4 v[20:23], v117, s[8:11], s53 offen offset:2048 sc1
    s_add_u32 s46, s46, 1
    s_add_u32 s49, s49, 1
    s_cmp_ge_u32 s49, 0x10000
    s_cbranch_scc1 L_rgo_43
    s_waitcnt vmcnt(0)
    s_branch L_rl_41
L_other:
    s_sub_u32 s101, s84, 1
    s_lshl_b32 s101, s101, 5
    s_add_u32 s101, s101, s85
    s_branch L_bulk
L_odd:
    s_mov_b32 s96, 0
L_mode_44:
    buffer_load_dwordx2 v[2:3], off, s[92:95], 0 offset:36 sc1
    s_waitcnt vmcnt(0)
    v_readfirstlane_b32 s87, v2
    v_readfirstlane_b32 s97, v3
    s_nop 0
    s_min_u32 s97, s97, s87
    s_cmp_lg_u32 s97, 0
    s_cbranch_scc1 L_moded_45
    s_sleep 4
    s_add_u32 s96, s96, 1
    s_cmp_lg_u32 s96, 0x100
    s_cbranch_scc1 L_modef_46
    v_mov_b32 v2, 2
    v_mov_b32 v3, 0
    s_mov_b64 exec, 1
    buffer_atomic_cmpswap v[2:3], off, s[92:95], 0 offset:36
    s_mov_b64 exec, -1
L_modef_46:
    s_cmp_lt_u32 s96, 0x10000
    s_cbranch_scc1 L_mode_44
L_moded_45:
    s_cmp_eq_u32 s87, 1
    s_cbranch_scc1 L_exit
L_fallback:
    s_waitcnt vmcnt(0) lgkmcnt(0)
    s_barrier
    v_mbcnt_lo_u32_b32 v0, -1, 0
    v_mbcnt_hi_u32_b32 v0, -1, v0
    s_lshl_b32 s96, s100, 6
    v_add_u32 v0, s96, v0
    s_mov_b32 s97, 44
    s_cmp_lg_u32 s100, 0
    s_cbranch_scc1 L_at_47
    s_mov_b64 exec, 1
    v_mov_b32 v2, 1
    buffer_atomic_add v2, off, s[92:95], s97 sc0
    s_mov_b64 exec, -1
L_at_47:
    s_cmp_lg_u32 s100, 0
    s_cbranch_scc1 L_at2_48
    s_mov_b64 exec, 1
    v_mov_b32 v1, 8
    s_waitcnt vmcnt(0)
    ds_write_b32 v1, v2
    s_waitcnt lgkmcnt(0)
    s_mov_b64 exec, -1
L_at2_48:
    s_barrier
    v_mov_b32 v1, 8
    ds_read_b32 v2, v1
    s_waitcnt lgkmcnt(0)
    v_readfirstlane_b32 s85, v2
    s_barrier
    s_sub_u32 s101, s85, 32
    s_cmp_ge_u32 s85, 32
    s_cbranch_scc1 L_bulk
    s_mov_b32 s20, s85
    s_mov_b32 s16, s92
    s_mov_b32 s17, s93
    s_mov_b32 s18, s94
    s_mov_b32 s19, s95
    s_mov_b32 s88, s20
    v_lshrrev_b32 v4, 6, v0
    s_nop 0
    v_readfirstlane_b32 s21, v4
    v_and_b32 v1, 63, v0
    v_lshrrev_b32 v2, 4, v1
    v_and_b32 v3, 15, v1
    v_lshrrev_b32 v6, 2, v3
    v_lshlrev_b32 v117, 4, v1
    s_lshl_b32 s51, s21, 10
    s_lshl_b32 s52, s21, 11
    s_load_dwordx8 s[60:67], s[0:1], 16
    s_mov_b32 s14, 0x400000
    s_mov_b32 s15, 0x20000
    s_lshl_b32 s41, s20, 8
    s_lshl_b32 s42, s20, 17
    s_lshr_b32 s43, s21, 1
    s_lshl_b32 s43, s43, 2
    v_or_b32 v5, s43, v2
    v_lshlrev_b32 v5, 1, v5
    v_xor_b32 v5, v5, v3
    v_lshrrev_b32 v14, 2, v5
    v_lshlrev_b32 v5, 4, v5
    s_lshl_b32 s43, s21, 4
    v_add_u32 v4, s43, v2
    v_lshl_add_u32 v8, v4, 13, v5
    s_waitcnt lgkmcnt(0)
    s_mov_b32 s12, s60
    s_and_b32 s13, s61, 0xffff
    v_xor_b32 v15, 1, v14
    v_lshl_add_u32 v15, v15, 15, v8
    s_add_u32 s43, s41, 0x0
    s_add_u32 m0, s51, 0x8000
    s_nop 0
    buffer_load_dwordx4 v15, s[12:15], s43 offen lds
    s_add_u32 s43, s41, 0x80000
    s_add_u32 m0, s51, 0x9000
    s_nop 0
    buffer_load_dwordx4 v15, s[12:15], s43 offen lds
    s_add_u32 s43, s41, 0x100000
    s_add_u32 m0, s51, 0xa000
    s_nop 0
    buffer_load_dwordx4 v15, s[12:15], s43 offen lds
    s_add_u32 s43, s41, 0x180000
    s_add_u32 m0, s51, 0xb000
    s_nop 0
    buffer_load_dwordx4 v15, s[12:15], s43 offen lds
    s_add_u32 s43, s41, 0x200000
    s_add_u32 m0, s51, 0xc000
    s_nop 0
    buffer_load_dwordx4 v15, s[12:15], s43 offen lds
    s_add_u32 s43, s41, 0x280000
    s_add_u32 m0, s51, 0xd000
    s_nop 0
    buffer_load_dwordx4 v15, s[12:15], s43 offen lds
    s_add_u32 s43, s41, 0x300000
    s_add_u32 m0, s51, 0xe000
    s_nop 0
    buffer_load_dwordx4 v15, s[12:15], s43 offen lds
    s_add_u32 s43, s41, 0x380000
    s_add_u32 m0, s51, 0xf000
    s_nop 0
    buffer_load_dwordx4 v15, s[12:15], s43 offen lds
    v_xor_b32 v15, 2, v14
    v_lshl_add_u32 v15, v15, 15, v8
    s_add_u32 s43, s41, 0x0
    s_add_u32 m0, s51, 0x10000
    s_nop 0
    buffer_load_dwordx4 v15, s[12:15], s43 offen lds
    s_add_u32 s43, s41, 0x80000
    s_add_u32 m0, s51, 0x11000
    s_nop 0
    buffer_load_dwordx4 v15, s[12:15], s43 offen lds
    s_add_u32 s43, s41, 0x100000
    s_add_u32 m0, s51, 0x12000
    s_nop 0
    buffer_load_dwordx4 v15, s[12:15], s43 offen lds
    s_add_u32 s43, s41, 0x180000
    s_add_u32 m0, s51, 0x13000
    s_nop 0
    buffer_load_dwordx4 v15, s[12:15], s43 offen lds
    s_add_u32 s43, s41, 0x200000
    s_add_u32 m0, s51, 0x14000
    s_nop 0
    buffer_load_dwordx4 v15, s[12:15], s43 offen lds
    s_add_u32 s43, s41, 0x280000
    s_add_u32 m0, s51, 0x15000
    s_nop 0
    buffer_load_dwordx4 v15, s[12:15], s43 offen lds
    s_add_u32 s43, s41, 0x300000
    s_add_u32 m0, s51, 0x16000
    s_nop 0
    buffer_load_dwordx4 v15, s[12:15], s43 offen lds
    s_add_u32 s43, s41, 0x380000
    s_add_u32 m0, s51, 0x17000
    s_nop 0
    buffer_load_dwordx4 v15, s[12:15], s43 offen lds
    v_xor_b32 v15, 3, v14
    v_lshl_add_u32 v15, v15, 15, v8
    s_add_u32 s43, s41, 0x0
    s_add_u32 m0, s51, 0x18000
    s_nop 0
    buffer_load_dwordx4 v15, s[12:15], s43 offen lds
    s_add_u32 s43, s41, 0x80000
    s_add_u32 m0, s51, 0x19000
    s_nop 0
    buffer_load_dwordx4 v15, s[12:15], s43 offen lds
    s_add_u32 s43, s41, 0x100000
    s_add_u32 m0, s51, 0x1a000
    s_nop 0
    buffer_load_dwordx4 v15, s[12:15], s43 offen lds
    s_add_u32 s43, s41, 0x180000
    s_add_u32 m0, s51, 0x1b000
    s_nop 0
    buffer_load_dwordx4 v15, s[12:15], s43 offen lds
    s_add_u32 s43, s41, 0x200000
    s_add_u32 m0, s51, 0x1c000
    s_nop 0
    buffer_load_dwordx4 v15, s[12:15], s43 offen lds
    s_add_u32 s43, s41, 0x280000
    s_add_u32 m0, s51, 0x1d000
    s_nop 0
    buffer_load_dwordx4 v15, s[12:15], s43 offen lds
    s_add_u32 s43, s41, 0x300000
    s_add_u32 m0, s51, 0x1e000
    s_nop 0
    buffer_load_dwordx4 v15, s[12:15], s43 offen lds
    s_add_u32 s43, s41, 0x380000
    s_add_u32 m0, s51, 0x1f000
    s_nop 0
    buffer_load_dwordx4 v15, s[12:15], s43 offen lds
    s_mov_b32 s12, s62
    s_and_b32 s13, s63, 0xffff
    v_xor_b32 v15, 1, v14
    v_lshl_add_u32 v15, v15, 15, v8
    s_add_u32 s43, s41, 0x0
    s_add_u32 m0, s51, 0x20000
    s_nop 0
    buffer_load_dwordx4 v15, s[12:15], s43 offen lds
    s_add_u32 s43, s41, 0x80000
    s_add_u32 m0, s51, 0x21000
    s_nop 0
    buffer_load_dwordx4 v15, s[12:15], s43 offen lds
    s_add_u32 s43, s41, 0x100000
    s_add_u32 m0, s51, 0x22000
    s_nop 0
    buffer_load_dwordx4 v15, s[12:15], s43 offen lds
    s_add_u32 s43, s41, 0x180000
    s_add_u32 m0, s51, 0x23000
    s_nop 0
    buffer_load_dwordx4 v15, s[12:15], s43 offen lds
    s_add_u32 s43, s41, 0x200000
    s_add_u32 m0, s51, 0x24000
    s_nop 0
    buffer_load_dwordx4 v15, s[12:15], s43 offen lds
    s_add_u32 s43, s41, 0x280000
    s_add_u32 m0, s51, 0x25000
    s_nop 0
    buffer_load_dwordx4 v15, s[12:15], s43 offen lds
    s_add_u32 s43, s41, 0x300000
    s_add_u32 m0, s51, 0x26000
    s_nop 0
    buffer_load_dwordx4 v15, s[12:15], s43 offen lds
    s_add_u32 s43, s41, 0x380000
    s_add_u32 m0, s51, 0x27000
    s_nop 0
    buffer_load_dwordx4 v15, s[12:15], s43 offen lds
    v_and_b32 v4, 2, v3
    v_cmp_ne_u32 vcc, 0, v4
    v_mov_b32 v4, 0x4444
    v_mov_b32 v5, 0xeeee
    v_cndmask_b32 v116, v4, v5, vcc
    v_lshrrev_b32 v5, 1, v2
    v_lshl_add_u32 v4, v6, 3, v5
    s_lshl_b32 s43, s21, 1
    v_add_u32 v4, s43, v4
    v_add_u32 v5, s20, v4
    v_and_b32 v5, 31, v5
    v_lshl_add_u32 v4, v4, 6, v5
    v_and_b32 v5, 1, v2
    v_lshl_add_u32 v4, v4, 1, v5
    v_and_b32 v5, 3, v3
    v_lshl_add_u32 v4, v4, 2, v5
    v_lshlrev_b32 v118, 4, v4
    v_and_b32 v4, 1, v2
    v_lshlrev_b32 v4, 2, v4
    v_and_b32 v7, 2, v2
    v_add_u32 v4, v4, v7
    v_and_b32 v7, 1, v6
    v_add_u32 v4, v4, v7
    v_lshl_add_u32 v4, v4, 2, v5
    v_lshlrev_b32 v4, 2, v4
    s_and_b32 s43, s21, 1
    s_lshl_b32 s43, s43, 12
    s_lshl_b32 s40, s20, 7
    s_add_u32 s43, s43, s40
    v_add_u32 v119, s43, v4
    v_sub_u32 v7, 0, v2
    v_and_b32 v7, 3, v7
    v_xor_b32 v7, v7, v6
    v_lshl_add_u32 v4, v2, 4, v7
    v_and_b32 v5, 3, v3
    v_lshl_add_u32 v4, v4, 2, v5
    s_add_u32 s43, s51, 16384
    v_lshl_add_u32 v120, v4, 2, s43
    v_sub_u32 v7, 0, v6
    v_and_b32 v7, 3, v7
    v_xor_b32 v7, v7, v2
    v_lshl_add_u32 v4, v3, 2, v7
    v_lshlrev_b32 v121, 4, v4
    v_and_b32 v5, 1, v3
    v_lshl_add_u32 v4, v6, 1, v5
    v_lshl_add_u32 v4, v2, 3, v4
    v_lshlrev_b32 v127, 4, v4
    v_and_or_b32 v122, v116, 8, v127
    s_lshl_b32 s43, s21, 13
    s_add_u32 s43, s43, 32768
    v_add_u32 v123, s43, v117
    v_add_u32 v124, 0x10000, v123
    s_mov_b32 s36, 0xcccccccc
    s_mov_b32 s37, 0xcccccccc
    s_mov_b32 s38, 0x00ff00ff
    s_mov_b32 s39, 0x00ff00ff
    s_mov_b32 s34, 0x3e0293ee
    s_mov_b32 s35, 0x49800000
    s_mov_b32 s50, 0x3f803f80
    v_and_b32 v5, 1, v2
    v_or_b32 v5, 0, v5
    v_xor_b32 v5, v5, v6
    v_lshlrev_b32 v5, 8, v5
    v_and_b32 v7, 3, v3
    v_lshl_add_u32 v7, v7, 4, v5
    s_lshl_b32 s43, s21, 2
    v_add_u32 v4, s43, v2
    v_lshl_add_u32 v10, v4, 10, v7
    v_and_b32 v5, 1, v2
    v_or_b32 v5, 2, v5
    v_xor_b32 v5, v5, v6
    v_lshlrev_b32 v5, 8, v5
    v_and_b32 v7, 3, v3
    v_lshl_add_u32 v7, v7, 4, v5
    s_lshl_b32 s43, s21, 2
    v_add_u32 v4, s43, v2
    v_lshl_add_u32 v9, v4, 10, v7
    v_and_b32 v5, 1, v2
    v_lshl_add_u32 v4, v5, 3, v6
    v_lshrrev_b32 v7, 1, v2
    v_lshl_add_u32 v4, v7, 5, v4
    v_lshlrev_b32 v4, 8, v4
    v_lshl_or_b32 v5, v5, 2, v6
    v_lshlrev_b32 v5, 5, v5
    s_lshl_b32 s43, s21, 6
    v_xor_b32 v5, s43, v5
    v_add_u32 v4, v4, v5
    v_and_b32 v5, 3, v3
    v_lshl_add_u32 v4, v5, 3, v4
    v_add_u32 v11, 32768, v4
    v_and_b32 v5, 1, v2
    v_lshlrev_b32 v4, 4, v5
    v_lshl_add_u32 v4, v7, 2, v4
    v_and_b32 v7, 1, v6
    v_add_u32 v4, v4, v7
    s_lshl_b32 s43, s21, 5
    v_add_u32 v4, s43, v4
    v_lshlrev_b32 v4, 8, v4
    v_lshl_or_b32 v5, v5, 1, v7
    v_xor_b32 v5, s21, v5
    v_lshl_add_u32 v4, v5, 6, v4
    v_lshrrev_b32 v5, 1, v6
    v_lshl_add_u32 v4, v5, 5, v4
    v_and_b32 v5, 3, v3
    v_lshl_add_u32 v4, v5, 3, v4
    v_add_u32 v12, 32768, v4
    v_mov_b32 v16, -1
    v_mov_b32 v17, -1
    v_mov_b32 v18, -1
    v_mov_b32 v19, -1
    s_lshl_b32 s43, s20, 13
    s_add_u32 s43, s43, 0x7100000
    s_and_b32 s40, s21, 1
    s_lshl_b32 s40, s40, 12
    s_add_u32 s29, s43, s40
    s_add_u32 s43, s43, s52
    s_xor_b32 s40, s43, 0x40000
    buffer_store_dwordx4 v[16:19], v117, s[8:11], s43 offen sc1
    buffer_store_dwordx4 v[16:19], v117, s[8:11], s43 offen offset:1024 sc1
    buffer_store_dwordx4 v[16:19], v117, s[8:11], s40 offen sc1
    buffer_store_dwordx4 v[16:19], v117, s[8:11], s40 offen offset:1024 sc1
    s_mov_b32 s43, 0x7012000
    buffer_store_dword v16, v119, s[8:11], s43 offen sc1
    s_mov_b32 s43, 0x7014000
    buffer_store_dword v16, v119, s[8:11], s43 offen sc1
    s_mov_b32 s43, 0x7016000
    buffer_store_dword v16, v119, s[8:11], s43 offen sc1
    s_load_dwordx2 s[4:5], s[0:1], 8
    s_waitcnt lgkmcnt(0)
    s_and_b32 s5, s5, 0xffff
    s_mov_b32 s6, 8192
    s_mov_b32 s7, 0x20000
    v_and_b32 v20, 1, v2
    v_and_b32 v21, 1, v6
    v_lshl_add_u32 v20, v20, 1, v21
    v_lshlrev_b32 v20, 9, v20
    v_and_b32 v21, 3, v3
    v_lshl_add_u32 v20, v21, 4, v20
    v_and_b32 v21, 2, v2
    v_add_u32 v20, v20, v21
    s_and_b32 s43, s20, 1
    s_lshl_b32 s43, s43, 11
    s_bfe_u32 s40, s20, 0x20001
    s_lshl_b32 s40, s40, 7
    s_add_u32 s43, s43, s40
    s_and_b32 s40, s21, 1
    s_lshl_b32 s40, s40, 6
    s_add_u32 s43, s43, s40
    s_lshr_b32 s40, s20, 3
    s_lshl_b32 s40, s40, 2
    s_add_u32 s43, s43, s40
    v_add_u32 v20, s43, v20
    v_lshlrev_b32 v20, 1, v20
    buffer_load_dword v21, v20, s[4:7], 0 offen
    s_waitcnt vmcnt(32)
    s_barrier
    v_xor_b32 v13, 0, v11
    v_add_u32 v13, 0x0, v13
    ds_read_b64_tr_b16 a[0:1], v13
    ds_read_b64_tr_b16 a[2:3], v13 offset:1024
    ds_read_b64_tr_b16 a[4:5], v13 offset:16384
    ds_read_b64_tr_b16 a[6:7], v13 offset:17408
    ds_read_b64_tr_b16 a[16:17], v13 offset:4096
    ds_read_b64_tr_b16 a[18:19], v13 offset:5120
    ds_read_b64_tr_b16 a[20:21], v13 offset:20480
    ds_read_b64_tr_b16 a[22:23], v13 offset:21504
    s_waitcnt lgkmcnt(0)
    v_xor_b32 v13, 32, v11
    v_add_u32 v13, 0x0, v13
    ds_read_b64_tr_b16 a[8:9], v13
    ds_read_b64_tr_b16 a[10:11], v13 offset:1024
    ds_read_b64_tr_b16 a[12:13], v13 offset:16384
    ds_read_b64_tr_b16 a[14:15], v13 offset:17408
    ds_read_b64_tr_b16 a[24:25], v13 offset:4096
    ds_read_b64_tr_b16 a[26:27], v13 offset:5120
    ds_read_b64_tr_b16 a[28:29], v13 offset:20480
    ds_read_b64_tr_b16 a[30:31], v13 offset:21504
    s_waitcnt lgkmcnt(0)
    s_barrier
    v_xor_b32 v15, 2, v14
    v_lshl_add_u32 v15, v15, 15, v8
    s_add_u32 s43, s41, 0x0
    s_add_u32 m0, s51, 0x8000
    s_nop 0
    buffer_load_dwordx4 v15, s[12:15], s43 offen lds
    s_add_u32 s43, s41, 0x80000
    s_add_u32 m0, s51, 0x9000
    s_nop 0
    buffer_load_dwordx4 v15, s[12:15], s43 offen lds
    s_add_u32 s43, s41, 0x100000
    s_add_u32 m0, s51, 0xa000
    s_nop 0
    buffer_load_dwordx4 v15, s[12:15], s43 offen lds
    s_add_u32 s43, s41, 0x180000
    s_add_u32 m0, s51, 0xb000
    s_nop 0
    buffer_load_dwordx4 v15, s[12:15], s43 offen lds
    s_add_u32 s43, s41, 0x200000
    s_add_u32 m0, s51, 0xc000
    s_nop 0
    buffer_load_dwordx4 v15, s[12:15], s43 offen lds
    s_add_u32 s43, s41, 0x280000
    s_add_u32 m0, s51, 0xd000
    s_nop 0
    buffer_load_dwordx4 v15, s[12:15], s43 offen lds
    s_add_u32 s43, s41, 0x300000
    s_add_u32 m0, s51, 0xe000
    s_nop 0
    buffer_load_dwordx4 v15, s[12:15], s43 offen lds
    s_add_u32 s43, s41, 0x380000
    s_add_u32 m0, s51, 0xf000
    s_nop 0
    buffer_load_dwordx4 v15, s[12:15], s43 offen lds
    s_waitcnt vmcnt(32)
    s_barrier
    v_xor_b32 v13, 0, v11
    v_add_u32 v13, 0x8000, v13
    ds_read_b64_tr_b16 a[32:33], v13
    ds_read_b64_tr_b16 a[34:35], v13 offset:1024
    ds_read_b64_tr_b16 a[36:37], v13 offset:16384
    ds_read_b64_tr_b16 a[38:39], v13 offset:17408
    ds_read_b64_tr_b16 a[48:49], v13 offset:4096
    ds_read_b64_tr_b16 a[50:51], v13 offset:5120
    ds_read_b64_tr_b16 a[52:53], v13 offset:20480
    ds_read_b64_tr_b16 a[54:55], v13 offset:21504
    s_waitcnt lgkmcnt(0)
    v_xor_b32 v13, 32, v11
    v_add_u32 v13, 0x8000, v13
    ds_read_b64_tr_b16 a[40:41], v13
    ds_read_b64_tr_b16 a[42:43], v13 offset:1024
    ds_read_b64_tr_b16 a[44:45], v13 offset:16384
    ds_read_b64_tr_b16 a[46:47], v13 offset:17408
    ds_read_b64_tr_b16 a[56:57], v13 offset:4096
    ds_read_b64_tr_b16 a[58:59], v13 offset:5120
    ds_read_b64_tr_b16 a[60:61], v13 offset:20480
    ds_read_b64_tr_b16 a[62:63], v13 offset:21504
    s_waitcnt lgkmcnt(0)
    s_barrier
    v_xor_b32 v15, 3, v14
    v_lshl_add_u32 v15, v15, 15, v8
    s_add_u32 s43, s41, 0x0
    s_add_u32 m0, s51, 0x10000
    s_nop 0
    buffer_load_dwordx4 v15, s[12:15], s43 offen lds
    s_add_u32 s43, s41, 0x80000
    s_add_u32 m0, s51, 0x11000
    s_nop 0
    buffer_load_dwordx4 v15, s[12:15], s43 offen lds
    s_add_u32 s43, s41, 0x100000
    s_add_u32 m0, s51, 0x12000
    s_nop 0
    buffer_load_dwordx4 v15, s[12:15], s43 offen lds
    s_add_u32 s43, s41, 0x180000
    s_add_u32 m0, s51, 0x13000
    s_nop 0
    buffer_load_dwordx4 v15, s[12:15], s43 offen lds
    s_add_u32 s43, s41, 0x200000
    s_add_u32 m0, s51, 0x14000
    s_nop 0
    buffer_load_dwordx4 v15, s[12:15], s43 offen lds
    s_add_u32 s43, s41, 0x280000
    s_add_u32 m0, s51, 0x15000
    s_nop 0
    buffer_load_dwordx4 v15, s[12:15], s43 offen lds
    s_add_u32 s43, s41, 0x300000
    s_add_u32 m0, s51, 0x16000
    s_nop 0
    buffer_load_dwordx4 v15, s[12:15], s43 offen lds
    s_add_u32 s43, s41, 0x380000
    s_add_u32 m0, s51, 0x17000
    s_nop 0
    buffer_load_dwordx4 v15, s[12:15], s43 offen lds
    s_waitcnt vmcnt(32)
    s_barrier
    v_xor_b32 v13, 0, v11
    v_add_u32 v13, 0x10000, v13
    ds_read_b64_tr_b16 a[64:65], v13
    ds_read_b64_tr_b16 a[66:67], v13 offset:1024
    ds_read_b64_tr_b16 a[68:69], v13 offset:16384
    ds_read_b64_tr_b16 a[70:71], v13 offset:17408
    ds_read_b64_tr_b16 a[80:81], v13 offset:4096
    ds_read_b64_tr_b16 a[82:83], v13 offset:5120
    ds_read_b64_tr_b16 a[84:85], v13 offset:20480
    ds_read_b64_tr_b16 a[86:87], v13 offset:21504
    s_waitcnt lgkmcnt(0)
    v_xor_b32 v13, 32, v11
    v_add_u32 v13, 0x10000, v13
    ds_read_b64_tr_b16 a[72:73], v13
    ds_read_b64_tr_b16 a[74:75], v13 offset:1024
    ds_read_b64_tr_b16 a[76:77], v13 offset:16384
    ds_read_b64_tr_b16 a[78:79], v13 offset:17408
    ds_read_b64_tr_b16 a[88:89], v13 offset:4096
    ds_read_b64_tr_b16 a[90:91], v13 offset:5120
    ds_read_b64_tr_b16 a[92:93], v13 offset:20480
    ds_read_b64_tr_b16 a[94:95], v13 offset:21504
    s_waitcnt lgkmcnt(0)
    s_barrier
    s_mov_b32 s12, s64
    s_and_b32 s13, s65, 0xffff
    v_xor_b32 v15, 0, v14
    v_lshl_add_u32 v15, v15, 15, v8
    s_add_u32 s43, s41, 0x0
    s_add_u32 m0, s51, 0x18000
    s_nop 0
    buffer_load_dwordx4 v15, s[12:15], s43 offen lds
    s_add_u32 s43, s41, 0x80000
    s_add_u32 m0, s51, 0x19000
    s_nop 0
    buffer_load_dwordx4 v15, s[12:15], s43 offen lds
    s_add_u32 s43, s41, 0x100000
    s_add_u32 m0, s51, 0x1a000
    s_nop 0
    buffer_load_dwordx4 v15, s[12:15], s43 offen lds
    s_add_u32 s43, s41, 0x180000
    s_add_u32 m0, s51, 0x1b000
    s_nop 0
    buffer_load_dwordx4 v15, s[12:15], s43 offen lds
    s_add_u32 s43, s41, 0x200000
    s_add_u32 m0, s51, 0x1c000
    s_nop 0
    buffer_load_dwordx4 v15, s[12:15], s43 offen lds
    s_add_u32 s43, s41, 0x280000
    s_add_u32 m0, s51, 0x1d000
    s_nop 0
    buffer_load_dwordx4 v15, s[12:15], s43 offen lds
    s_add_u32 s43, s41, 0x300000
    s_add_u32 m0, s51, 0x1e000
    s_nop 0
    buffer_load_dwordx4 v15, s[12:15], s43 offen lds
    s_add_u32 s43, s41, 0x380000
    s_add_u32 m0, s51, 0x1f000
    s_nop 0
    buffer_load_dwordx4 v15, s[12:15], s43 offen lds
    s_waitcnt vmcnt(32)
    s_barrier
    v_xor_b32 v13, 0, v11
    v_add_u32 v13, 0x18000, v13
    ds_read_b64_tr_b16 a[96:97], v13
    ds_read_b64_tr_b16 a[98:99], v13 offset:1024
    ds_read_b64_tr_b16 a[100:101], v13 offset:16384
    ds_read_b64_tr_b16 a[102:103], v13 offset:17408
    ds_read_b64_tr_b16 a[112:113], v13 offset:4096
    ds_read_b64_tr_b16 a[114:115], v13 offset:5120
    ds_read_b64_tr_b16 a[116:117], v13 offset:20480
    ds_read_b64_tr_b16 a[118:119], v13 offset:21504
    s_waitcnt lgkmcnt(0)
    v_xor_b32 v13, 32, v11
    v_add_u32 v13, 0x18000, v13
    ds_read_b64_tr_b16 a[104:105], v13
    ds_read_b64_tr_b16 a[106:107], v13 offset:1024
    ds_read_b64_tr_b16 a[108:109], v13 offset:16384
    ds_read_b64_tr_b16 a[110:111], v13 offset:17408
    ds_read_b64_tr_b16 a[120:121], v13 offset:4096
    ds_read_b64_tr_b16 a[122:123], v13 offset:5120
    ds_read_b64_tr_b16 a[124:125], v13 offset:20480
    ds_read_b64_tr_b16 a[126:127], v13 offset:21504
    s_waitcnt lgkmcnt(0)
    s_barrier
    v_xor_b32 v15, 1, v14
    v_lshl_add_u32 v15, v15, 15, v8
    s_add_u32 s43, s41, 0x0
    s_add_u32 m0, s51, 0x20000
    s_nop 0
    buffer_load_dwordx4 v15, s[12:15], s43 offen lds
    s_add_u32 s43, s41, 0x80000
    s_add_u32 m0, s51, 0x21000
    s_nop 0
    buffer_load_dwordx4 v15, s[12:15], s43 offen lds
    s_add_u32 s43, s41, 0x100000
    s_add_u32 m0, s51, 0x22000
    s_nop 0
    buffer_load_dwordx4 v15, s[12:15], s43 offen lds
    s_add_u32 s43, s41, 0x180000
    s_add_u32 m0, s51, 0x23000
    s_nop 0
    buffer_load_dwordx4 v15, s[12:15], s43 offen lds
    s_add_u32 s43, s41, 0x200000
    s_add_u32 m0, s51, 0x24000
    s_nop 0
    buffer_load_dwordx4 v15, s[12:15], s43 offen lds
    s_add_u32 s43, s41, 0x280000
    s_add_u32 m0, s51, 0x25000
    s_nop 0
    buffer_load_dwordx4 v15, s[12:15], s43 offen lds
    s_add_u32 s43, s41, 0x300000
    s_add_u32 m0, s51, 0x26000
    s_nop 0
    buffer_load_dwordx4 v15, s[12:15], s43 offen lds
    s_add_u32 s43, s41, 0x380000
    s_add_u32 m0, s51, 0x27000
    s_nop 0
    buffer_load_dwordx4 v15, s[12:15], s43 offen lds
    s_waitcnt vmcnt(24)
    v_min_u32 v21, 0xfffffffe, v21
    s_mov_b32 s43, 0x7010000
    s_mov_b64 exec, s[38:39]
    buffer_store_dword v21, v119, s[8:11], s43 offen sc1
    s_mov_b64 exec, -1
    s_barrier
    v_xor_b32 v13, 0, v11
    v_add_u32 v13, 0x0, v13
    ds_read_b64_tr_b16 a[128:129], v13
    ds_read_b64_tr_b16 a[130:131], v13 offset:1024
    ds_read_b64_tr_b16 a[132:133], v13 offset:16384
    ds_read_b64_tr_b16 a[134:135], v13 offset:17408
    ds_read_b64_tr_b16 a[144:145], v13 offset:4096
    ds_read_b64_tr_b16 a[146:147], v13 offset:5120
    ds_read_b64_tr_b16 a[148:149], v13 offset:20480
    ds_read_b64_tr_b16 a[150:151], v13 offset:21504
    s_waitcnt lgkmcnt(0)
    v_xor_b32 v13, 32, v11
    v_add_u32 v13, 0x0, v13
    ds_read_b64_tr_b16 a[136:137], v13
    ds_read_b64_tr_b16 a[138:139], v13 offset:1024
    ds_read_b64_tr_b16 a[140:141], v13 offset:16384
    ds_read_b64_tr_b16 a[142:143], v13 offset:17408
    ds_read_b64_tr_b16 a[152:153], v13 offset:4096
    ds_read_b64_tr_b16 a[154:155], v13 offset:5120
    ds_read_b64_tr_b16 a[156:157], v13 offset:20480
    ds_read_b64_tr_b16 a[158:159], v13 offset:21504
    s_waitcnt lgkmcnt(0)
    s_barrier
    v_xor_b32 v15, 2, v14
    v_lshl_add_u32 v15, v15, 15, v8
    s_add_u32 s43, s41, 0x0
    s_add_u32 m0, s51, 0x8000
    s_nop 0
    buffer_load_dwordx4 v15, s[12:15], s43 offen lds
    s_add_u32 s43, s41, 0x80000
    s_add_u32 m0, s51, 0x9000
    s_nop 0
    buffer_load_dwordx4 v15, s[12:15], s43 offen lds
    s_add_u32 s43, s41, 0x100000
    s_add_u32 m0, s51, 0xa000
    s_nop 0
    buffer_load_dwordx4 v15, s[12:15], s43 offen lds
    s_add_u32 s43, s41, 0x180000
    s_add_u32 m0, s51, 0xb000
    s_nop 0
    buffer_load_dwordx4 v15, s[12:15], s43 offen lds
    s_add_u32 s43, s41, 0x200000
    s_add_u32 m0, s51, 0xc000
    s_nop 0
    buffer_load_dwordx4 v15, s[12:15], s43 offen lds
    s_add_u32 s43, s41, 0x280000
    s_add_u32 m0, s51, 0xd000
    s_nop 0
    buffer_load_dwordx4 v15, s[12:15], s43 offen lds
    s_add_u32 s43, s41, 0x300000
    s_add_u32 m0, s51, 0xe000
    s_nop 0
    buffer_load_dwordx4 v15, s[12:15], s43 offen lds
    s_add_u32 s43, s41, 0x380000
    s_add_u32 m0, s51, 0xf000
    s_nop 0
    buffer_load_dwordx4 v15, s[12:15], s43 offen lds
    s_waitcnt vmcnt(24)
    s_barrier
    v_xor_b32 v13, 0, v11
    v_add_u32 v13, 0x8000, v13
    ds_read_b64_tr_b16 a[160:161], v13
    ds_read_b64_tr_b16 a[162:163], v13 offset:1024
    ds_read_b64_tr_b16 a[164:165], v13 offset:16384
    ds_read_b64_tr_b16 a[166:167], v13 offset:17408
    ds_read_b64_tr_b16 a[176:177], v13 offset:4096
    ds_read_b64_tr_b16 a[178:179], v13 offset:5120
    ds_read_b64_tr_b16 a[180:181], v13 offset:20480
    ds_read_b64_tr_b16 a[182:183], v13 offset:21504
    s_waitcnt lgkmcnt(0)
    v_xor_b32 v13, 32, v11
    v_add_u32 v13, 0x8000, v13
    ds_read_b64_tr_b16 a[168:169], v13
    ds_read_b64_tr_b16 a[170:171], v13 offset:1024
    ds_read_b64_tr_b16 a[172:173], v13 offset:16384
    ds_read_b64_tr_b16 a[174:175], v13 offset:17408
    ds_read_b64_tr_b16 a[184:185], v13 offset:4096
    ds_read_b64_tr_b16 a[186:187], v13 offset:5120
    ds_read_b64_tr_b16 a[188:189], v13 offset:20480
    ds_read_b64_tr_b16 a[190:191], v13 offset:21504
    s_waitcnt lgkmcnt(0)
    s_barrier
    v_xor_b32 v15, 3, v14
    v_lshl_add_u32 v15, v15, 15, v8
    s_add_u32 s43, s41, 0x0
    s_add_u32 m0, s51, 0x10000
    s_nop 0
    buffer_load_dwordx4 v15, s[12:15], s43 offen lds
    s_add_u32 s43, s41, 0x80000
    s_add_u32 m0, s51, 0x11000
    s_nop 0
    buffer_load_dwordx4 v15, s[12:15], s43 offen lds
    s_add_u32 s43, s41, 0x100000
    s_add_u32 m0, s51, 0x12000
    s_nop 0
    buffer_load_dwordx4 v15, s[12:15], s43 offen lds
    s_add_u32 s43, s41, 0x180000
    s_add_u32 m0, s51, 0x13000
    s_nop 0
    buffer_load_dwordx4 v15, s[12:15], s43 offen lds
    s_add_u32 s43, s41, 0x200000
    s_add_u32 m0, s51, 0x14000
    s_nop 0
    buffer_load_dwordx4 v15, s[12:15], s43 offen lds
    s_add_u32 s43, s41, 0x280000
    s_add_u32 m0, s51, 0x15000
    s_nop 0
    buffer_load_dwordx4 v15, s[12:15], s43 offen lds
    s_add_u32 s43, s41, 0x300000
    s_add_u32 m0, s51, 0x16000
    s_nop 0
    buffer_load_dwordx4 v15, s[12:15], s43 offen lds
    s_add_u32 s43, s41, 0x380000
    s_add_u32 m0, s51, 0x17000
    s_nop 0
    buffer_load_dwordx4 v15, s[12:15], s43 offen lds
    s_waitcnt vmcnt(24)
    s_barrier
    v_xor_b32 v13, 0, v11
    v_add_u32 v13, 0x10000, v13
    ds_read_b64_tr_b16 a[192:193], v13
    ds_read_b64_tr_b16 a[194:195], v13 offset:1024
    ds_read_b64_tr_b16 a[196:197], v13 offset:16384
    ds_read_b64_tr_b16 a[198:199], v13 offset:17408
    ds_read_b64_tr_b16 a[208:209], v13 offset:4096
    ds_read_b64_tr_b16 a[210:211], v13 offset:5120
    ds_read_b64_tr_b16 a[212:213], v13 offset:20480
    ds_read_b64_tr_b16 a[214:215], v13 offset:21504
    s_waitcnt lgkmcnt(0)
    v_xor_b32 v13, 32, v11
    v_add_u32 v13, 0x10000, v13
    ds_read_b64_tr_b16 a[200:201], v13
    ds_read_b64_tr_b16 a[202:203], v13 offset:1024
    ds_read_b64_tr_b16 a[204:205], v13 offset:16384
    ds_read_b64_tr_b16 a[206:207], v13 offset:17408
    ds_read_b64_tr_b16 a[216:217], v13 offset:4096
    ds_read_b64_tr_b16 a[218:219], v13 offset:5120
    ds_read_b64_tr_b16 a[220:221], v13 offset:20480
    ds_read_b64_tr_b16 a[222:223], v13 offset:21504
    s_waitcnt lgkmcnt(0)
    s_barrier
    s_mov_b32 s12, s66
    s_and_b32 s13, s67, 0xffff
    s_add_u32 s43, s42, 0x0
    s_add_u32 m0, s51, 0x18000
    s_nop 0
    buffer_load_dwordx4 v10, s[12:15], s43 offen lds
    s_add_u32 s43, s42, 0x4000
    s_add_u32 m0, s51, 0x19000
    s_nop 0
    buffer_load_dwordx4 v9, s[12:15], s43 offen lds
    s_add_u32 s43, s42, 0x8000
    s_add_u32 m0, s51, 0x1a000
    s_nop 0
    buffer_load_dwordx4 v10, s[12:15], s43 offen lds
    s_add_u32 s43, s42, 0xc000
    s_add_u32 m0, s51, 0x1b000
    s_nop 0
    buffer_load_dwordx4 v9, s[12:15], s43 offen lds
    s_add_u32 s43, s42, 0x10000
    s_add_u32 m0, s51, 0x1c000
    s_nop 0
    buffer_load_dwordx4 v10, s[12:15], s43 offen lds
    s_add_u32 s43, s42, 0x14000
    s_add_u32 m0, s51, 0x1d000
    s_nop 0
    buffer_load_dwordx4 v9, s[12:15], s43 offen lds
    s_add_u32 s43, s42, 0x18000
    s_add_u32 m0, s51, 0x1e000
    s_nop 0
    buffer_load_dwordx4 v10, s[12:15], s43 offen lds
    s_add_u32 s43, s42, 0x1c000
    s_add_u32 m0, s51, 0x1f000
    s_nop 0
    buffer_load_dwordx4 v9, s[12:15], s43 offen lds
    s_waitcnt vmcnt(24)
    s_barrier
    v_xor_b32 v13, 0, v11
    v_add_u32 v13, 0x18000, v13
    ds_read_b64_tr_b16 a[224:225], v13
    ds_read_b64_tr_b16 a[226:227], v13 offset:1024
    ds_read_b64_tr_b16 a[228:229], v13 offset:16384
    ds_read_b64_tr_b16 a[230:231], v13 offset:17408
    ds_read_b64_tr_b16 a[240:241], v13 offset:4096
    ds_read_b64_tr_b16 a[242:243], v13 offset:5120
    ds_read_b64_tr_b16 a[244:245], v13 offset:20480
    ds_read_b64_tr_b16 a[246:247], v13 offset:21504
    s_waitcnt lgkmcnt(0)
    v_xor_b32 v13, 32, v11
    v_add_u32 v13, 0x18000, v13
    ds_read_b64_tr_b16 a[232:233], v13
    ds_read_b64_tr_b16 a[234:235], v13 offset:1024
    ds_read_b64_tr_b16 a[236:237], v13 offset:16384
    ds_read_b64_tr_b16 a[238:239], v13 offset:17408
    ds_read_b64_tr_b16 a[248:249], v13 offset:4096
    ds_read_b64_tr_b16 a[250:251], v13 offset:5120
    ds_read_b64_tr_b16 a[252:253], v13 offset:20480
    ds_read_b64_tr_b16 a[254:255], v13 offset:21504
    s_waitcnt lgkmcnt(0)
    s_barrier
    s_add_u32 s43, s42, 0x40
    s_add_u32 m0, s51, 0x20000
    s_nop 0
    buffer_load_dwordx4 v10, s[12:15], s43 offen lds
    s_add_u32 s43, s42, 0x4040
    s_add_u32 m0, s51, 0x21000
    s_nop 0
    buffer_load_dwordx4 v9, s[12:15], s43 offen lds
    s_add_u32 s43, s42, 0x8040
    s_add_u32 m0, s51, 0x22000
    s_nop 0
    buffer_load_dwordx4 v10, s[12:15], s43 offen lds
    s_add_u32 s43, s42, 0xc040
    s_add_u32 m0, s51, 0x23000
    s_nop 0
    buffer_load_dwordx4 v9, s[12:15], s43 offen lds
    s_add_u32 s43, s42, 0x10040
    s_add_u32 m0, s51, 0x24000
    s_nop 0
    buffer_load_dwordx4 v10, s[12:15], s43 offen lds
    s_add_u32 s43, s42, 0x14040
    s_add_u32 m0, s51, 0x25000
    s_nop 0
    buffer_load_dwordx4 v9, s[12:15], s43 offen lds
    s_add_u32 s43, s42, 0x18040
    s_add_u32 m0, s51, 0x26000
    s_nop 0
    buffer_load_dwordx4 v10, s[12:15], s43 offen lds
    s_add_u32 s43, s42, 0x1c040
    s_add_u32 m0, s51, 0x27000
    s_nop 0
    buffer_load_dwordx4 v9, s[12:15], s43 offen lds
    s_waitcnt vmcnt(24)
    s_barrier
    v_xor_b32 v13, 0, v11
    v_add_u32 v13, 0x0, v13
    ds_read_b64_tr_b16 v[128:129], v13
    ds_read_b64_tr_b16 v[130:131], v13 offset:1024
    ds_read_b64_tr_b16 v[132:133], v13 offset:16384
    ds_read_b64_tr_b16 v[134:135], v13 offset:17408
    ds_read_b64_tr_b16 v[144:145], v13 offset:4096
    ds_read_b64_tr_b16 v[146:147], v13 offset:5120
    ds_read_b64_tr_b16 v[148:149], v13 offset:20480
    ds_read_b64_tr_b16 v[150:151], v13 offset:21504
    s_waitcnt lgkmcnt(0)
    v_xor_b32 v13, 32, v11
    v_add_u32 v13, 0x0, v13
    ds_read_b64_tr_b16 v[136:137], v13
    ds_read_b64_tr_b16 v[138:139], v13 offset:1024
    ds_read_b64_tr_b16 v[140:141], v13 offset:16384
    ds_read_b64_tr_b16 v[142:143], v13 offset:17408
    ds_read_b64_tr_b16 v[152:153], v13 offset:4096
    ds_read_b64_tr_b16 v[154:155], v13 offset:5120
    ds_read_b64_tr_b16 v[156:157], v13 offset:20480
    ds_read_b64_tr_b16 v[158:159], v13 offset:21504
    s_waitcnt lgkmcnt(0)
    s_barrier
    s_mov_b32 s12, s60
    s_and_b32 s13, s61, 0xffff
    v_xor_b32 v15, 0, v14
    v_lshl_add_u32 v15, v15, 15, v8
    s_add_u32 s43, s41, 0x0
    s_add_u32 m0, s51, 0x8000
    s_nop 0
    buffer_load_dwordx4 v15, s[12:15], s43 offen lds
    s_add_u32 s43, s41, 0x80000
    s_add_u32 m0, s51, 0x9000
    s_nop 0
    buffer_load_dwordx4 v15, s[12:15], s43 offen lds
    s_add_u32 s43, s41, 0x100000
    s_add_u32 m0, s51, 0xa000
    s_nop 0
    buffer_load_dwordx4 v15, s[12:15], s43 offen lds
    s_add_u32 s43, s41, 0x180000
    s_add_u32 m0, s51, 0xb000
    s_nop 0
    buffer_load_dwordx4 v15, s[12:15], s43 offen lds
    s_add_u32 s43, s41, 0x200000
    s_add_u32 m0, s51, 0xc000
    s_nop 0
    buffer_load_dwordx4 v15, s[12:15], s43 offen lds
    s_add_u32 s43, s41, 0x280000
    s_add_u32 m0, s51, 0xd000
    s_nop 0
    buffer_load_dwordx4 v15, s[12:15], s43 offen lds
    s_add_u32 s43, s41, 0x300000
    s_add_u32 m0, s51, 0xe000
    s_nop 0
    buffer_load_dwordx4 v15, s[12:15], s43 offen lds
    s_add_u32 s43, s41, 0x380000
    s_add_u32 m0, s51, 0xf000
    s_nop 0
    buffer_load_dwordx4 v15, s[12:15], s43 offen lds
    s_waitcnt vmcnt(24)
    s_barrier
    s_cmp_lg_u32 s21, 0
    s_cbranch_scc1 L_arr_49
    v_mov_b32 v23, 1
    s_mov_b64 exec, 1
    buffer_atomic_add v23, off, s[16:19], 0 offset:8
    s_mov_b64 exec, -1
L_arr_49:
    v_xor_b32 v13, 0, v11
    v_add_u32 v13, 0x8000, v13
    ds_read_b64_tr_b16 v[160:161], v13
    ds_read_b64_tr_b16 v[162:163], v13 offset:1024
    ds_read_b64_tr_b16 v[164:165], v13 offset:16384
    ds_read_b64_tr_b16 v[166:167], v13 offset:17408
    ds_read_b64_tr_b16 v[176:177], v13 offset:4096
    ds_read_b64_tr_b16 v[178:179], v13 offset:5120
    ds_read_b64_tr_b16 v[180:181], v13 offset:20480
    ds_read_b64_tr_b16 v[182:183], v13 offset:21504
    s_waitcnt lgkmcnt(0)
    v_xor_b32 v13, 32, v11
    v_add_u32 v13, 0x8000, v13
    ds_read_b64_tr_b16 v[168:169], v13
    ds_read_b64_tr_b16 v[170:171], v13 offset:1024
    ds_read_b64_tr_b16 v[172:173], v13 offset:16384
    ds_read_b64_tr_b16 v[174:175], v13 offset:17408
    ds_read_b64_tr_b16 v[184:185], v13 offset:4096
    ds_read_b64_tr_b16 v[186:187], v13 offset:5120
    ds_read_b64_tr_b16 v[188:189], v13 offset:20480
    ds_read_b64_tr_b16 v[190:191], v13 offset:21504
    s_waitcnt lgkmcnt(0)
    s_barrier
    s_mov_b32 s12, s62
    s_and_b32 s13, s63, 0xffff
    v_xor_b32 v15, 0, v14
    v_lshl_add_u32 v15, v15, 15, v8
    s_add_u32 s43, s41, 0x0
    s_add_u32 m0, s51, 0x10000
    s_nop 0
    buffer_load_dwordx4 v15, s[12:15], s43 offen lds
    s_add_u32 s43, s41, 0x80000
    s_add_u32 m0, s51, 0x11000
    s_nop 0
    buffer_load_dwordx4 v15, s[12:15], s43 offen lds
    s_add_u32 s43, s41, 0x100000
    s_add_u32 m0, s51, 0x12000
    s_nop 0
    buffer_load_dwordx4 v15, s[12:15], s43 offen lds
    s_add_u32 s43, s41, 0x180000
    s_add_u32 m0, s51, 0x13000
    s_nop 0
    buffer_load_dwordx4 v15, s[12:15], s43 offen lds
    s_add_u32 s43, s41, 0x200000
    s_add_u32 m0, s51, 0x14000
    s_nop 0
    buffer_load_dwordx4 v15, s[12:15], s43 offen lds
    s_add_u32 s43, s41, 0x280000
    s_add_u32 m0, s51, 0x15000
    s_nop 0
    buffer_load_dwordx4 v15, s[12:15], s43 offen lds
    s_add_u32 s43, s41, 0x300000
    s_add_u32 m0, s51, 0x16000
    s_nop 0
    buffer_load_dwordx4 v15, s[12:15], s43 offen lds
    s_add_u32 s43, s41, 0x380000
    s_add_u32 m0, s51, 0x17000
    s_nop 0
    buffer_load_dwordx4 v15, s[12:15], s43 offen lds
    s_waitcnt vmcnt(24)
    s_barrier
    v_xor_b32 v13, 0x0, v12
    v_add_u32 v13, 0x10000, v13
    ds_read_b64_tr_b16 v[192:193], v13
    ds_read_b64_tr_b16 v[194:195], v13 offset:512
    ds_read_b64_tr_b16 v[196:197], v13 offset:2048
    ds_read_b64_tr_b16 v[198:199], v13 offset:2560
    v_xor_b32 v13, 0x2000, v12
    v_add_u32 v13, 0x10000, v13
    ds_read_b64_tr_b16 v[200:201], v13
    ds_read_b64_tr_b16 v[202:203], v13 offset:512
    ds_read_b64_tr_b16 v[204:205], v13 offset:2048
    ds_read_b64_tr_b16 v[206:207], v13 offset:2560
    s_waitcnt lgkmcnt(0)
    v_xor_b32 v13, 0x4000, v12
    v_add_u32 v13, 0x10000, v13
    ds_read_b64_tr_b16 v[208:209], v13
    ds_read_b64_tr_b16 v[210:211], v13 offset:512
    ds_read_b64_tr_b16 v[212:213], v13 offset:2048
    ds_read_b64_tr_b16 v[214:215], v13 offset:2560
    v_xor_b32 v13, 0x6000, v12
    v_add_u32 v13, 0x10000, v13
    ds_read_b64_tr_b16 v[216:217], v13
    ds_read_b64_tr_b16 v[218:219], v13 offset:512
    ds_read_b64_tr_b16 v[220:221], v13 offset:2048
    ds_read_b64_tr_b16 v[222:223], v13 offset:2560
    s_waitcnt lgkmcnt(0)
    s_barrier
    s_mov_b32 s12, s66
    s_and_b32 s13, s67, 0xffff
    s_add_u32 s43, s42, 0x80
    s_add_u32 m0, s51, 0x18000
    s_nop 0
    buffer_load_dwordx4 v10, s[12:15], s43 offen lds
    s_add_u32 s43, s42, 0x4080
    s_add_u32 m0, s51, 0x19000
    s_nop 0
    buffer_load_dwordx4 v9, s[12:15], s43 offen lds
    s_add_u32 s43, s42, 0x8080
    s_add_u32 m0, s51, 0x1a000
    s_nop 0
    buffer_load_dwordx4 v10, s[12:15], s43 offen lds
    s_add_u32 s43, s42, 0xc080
    s_add_u32 m0, s51, 0x1b000
    s_nop 0
    buffer_load_dwordx4 v9, s[12:15], s43 offen lds
    s_add_u32 s43, s42, 0x10080
    s_add_u32 m0, s51, 0x1c000
    s_nop 0
    buffer_load_dwordx4 v10, s[12:15], s43 offen lds
    s_add_u32 s43, s42, 0x14080
    s_add_u32 m0, s51, 0x1d000
    s_nop 0
    buffer_load_dwordx4 v9, s[12:15], s43 offen lds
    s_add_u32 s43, s42, 0x18080
    s_add_u32 m0, s51, 0x1e000
    s_nop 0
    buffer_load_dwordx4 v10, s[12:15], s43 offen lds
    s_add_u32 s43, s42, 0x1c080
    s_add_u32 m0, s51, 0x1f000
    s_nop 0
    buffer_load_dwordx4 v9, s[12:15], s43 offen lds
    s_waitcnt vmcnt(24)
    s_barrier
    v_xor_b32 v13, 0x0, v12
    v_add_u32 v13, 0x18000, v13
    ds_read_b64_tr_b16 v[224:225], v13
    ds_read_b64_tr_b16 v[226:227], v13 offset:512
    ds_read_b64_tr_b16 v[228:229], v13 offset:2048
    ds_read_b64_tr_b16 v[230:231], v13 offset:2560
    v_xor_b32 v13, 0x2000, v12
    v_add_u32 v13, 0x18000, v13
    ds_read_b64_tr_b16 v[232:233], v13
    ds_read_b64_tr_b16 v[234:235], v13 offset:512
    ds_read_b64_tr_b16 v[236:237], v13 offset:2048
    ds_read_b64_tr_b16 v[238:239], v13 offset:2560
    s_waitcnt lgkmcnt(0)
    v_xor_b32 v13, 0x4000, v12
    v_add_u32 v13, 0x18000, v13
    ds_read_b64_tr_b16 v[240:241], v13
    ds_read_b64_tr_b16 v[242:243], v13 offset:512
    ds_read_b64_tr_b16 v[244:245], v13 offset:2048
    ds_read_b64_tr_b16 v[246:247], v13 offset:2560
    v_xor_b32 v13, 0x6000, v12
    v_add_u32 v13, 0x18000, v13
    ds_read_b64_tr_b16 v[248:249], v13
    ds_read_b64_tr_b16 v[250:251], v13 offset:512
    ds_read_b64_tr_b16 v[252:253], v13 offset:2048
    ds_read_b64_tr_b16 v[254:255], v13 offset:2560
    s_waitcnt lgkmcnt(0)
    s_barrier
    s_add_u32 s43, s42, 0xc0
    s_add_u32 m0, s51, 0x20000
    s_nop 0
    buffer_load_dwordx4 v10, s[12:15], s43 offen lds
    s_add_u32 s43, s42, 0x40c0
    s_add_u32 m0, s51, 0x21000
    s_nop 0
    buffer_load_dwordx4 v9, s[12:15], s43 offen lds
    s_add_u32 s43, s42, 0x80c0
    s_add_u32 m0, s51, 0x22000
    s_nop 0
    buffer_load_dwordx4 v10, s[12:15], s43 offen lds
    s_add_u32 s43, s42, 0xc0c0
    s_add_u32 m0, s51, 0x23000
    s_nop 0
    buffer_load_dwordx4 v9, s[12:15], s43 offen lds
    s_add_u32 s43, s42, 0x100c0
    s_add_u32 m0, s51, 0x24000
    s_nop 0
    buffer_load_dwordx4 v10, s[12:15], s43 offen lds
    s_add_u32 s43, s42, 0x140c0
    s_add_u32 m0, s51, 0x25000
    s_nop 0
    buffer_load_dwordx4 v9, s[12:15], s43 offen lds
    s_add_u32 s43, s42, 0x180c0
    s_add_u32 m0, s51, 0x26000
    s_nop 0
    buffer_load_dwordx4 v10, s[12:15], s43 offen lds
    s_add_u32 s43, s42, 0x1c0c0
    s_add_u32 m0, s51, 0x27000
    s_nop 0
    buffer_load_dwordx4 v9, s[12:15], s43 offen lds
    s_waitcnt vmcnt(24)
    s_barrier
    v_xor_b32 v13, 0, v11
    v_add_u32 v13, 0x0, v13
    ds_read_b64_tr_b16 v[32:33], v13
    ds_read_b64_tr_b16 v[34:35], v13 offset:1024
    ds_read_b64_tr_b16 v[36:37], v13 offset:16384
    ds_read_b64_tr_b16 v[38:39], v13 offset:17408
    ds_read_b64_tr_b16 v[48:49], v13 offset:4096
    ds_read_b64_tr_b16 v[50:51], v13 offset:5120
    ds_read_b64_tr_b16 v[52:53], v13 offset:20480
    ds_read_b64_tr_b16 v[54:55], v13 offset:21504
    s_waitcnt lgkmcnt(0)
    v_xor_b32 v13, 32, v11
    v_add_u32 v13, 0x0, v13
    ds_read_b64_tr_b16 v[40:41], v13
    ds_read_b64_tr_b16 v[42:43], v13 offset:1024
    ds_read_b64_tr_b16 v[44:45], v13 offset:16384
    ds_read_b64_tr_b16 v[46:47], v13 offset:17408
    ds_read_b64_tr_b16 v[56:57], v13 offset:4096
    ds_read_b64_tr_b16 v[58:59], v13 offset:5120
    ds_read_b64_tr_b16 v[60:61], v13 offset:20480
    ds_read_b64_tr_b16 v[62:63], v13 offset:21504
    s_waitcnt lgkmcnt(0)
    s_barrier
    ds_write_b128 v123, v[32:35]
    ds_write_b128 v123, v[36:39] offset:1024
    ds_write_b128 v123, v[40:43] offset:2048
    ds_write_b128 v123, v[44:47] offset:3072
    ds_write_b128 v123, v[48:51] offset:4096
    ds_write_b128 v123, v[52:55] offset:5120
    ds_write_b128 v123, v[56:59] offset:6144
    ds_write_b128 v123, v[60:63] offset:7168
    s_waitcnt vmcnt(16)
    s_barrier
    v_xor_b32 v13, 0, v11
    v_add_u32 v13, 0x8000, v13
    ds_read_b64_tr_b16 v[32:33], v13
    ds_read_b64_tr_b16 v[34:35], v13 offset:1024
    ds_read_b64_tr_b16 v[36:37], v13 offset:16384
    ds_read_b64_tr_b16 v[38:39], v13 offset:17408
    ds_read_b64_tr_b16 v[48:49], v13 offset:4096
    ds_read_b64_tr_b16 v[50:51], v13 offset:5120
    ds_read_b64_tr_b16 v[52:53], v13 offset:20480
    ds_read_b64_tr_b16 v[54:55], v13 offset:21504
    s_waitcnt lgkmcnt(0)
    v_xor_b32 v13, 32, v11
    v_add_u32 v13, 0x8000, v13
    ds_read_b64_tr_b16 v[40:41], v13
    ds_read_b64_tr_b16 v[42:43], v13 offset:1024
    ds_read_b64_tr_b16 v[44:45], v13 offset:16384
    ds_read_b64_tr_b16 v[46:47], v13 offset:17408
    ds_read_b64_tr_b16 v[56:57], v13 offset:4096
    ds_read_b64_tr_b16 v[58:59], v13 offset:5120
    ds_read_b64_tr_b16 v[60:61], v13 offset:20480
    ds_read_b64_tr_b16 v[62:63], v13 offset:21504
    s_waitcnt lgkmcnt(0)
    s_barrier
    ds_write_b128 v123, v[32:35] offset:32768
    ds_write_b128 v123, v[36:39] offset:33792
    ds_write_b128 v123, v[40:43] offset:34816
    ds_write_b128 v123, v[44:47] offset:35840
    ds_write_b128 v123, v[48:51] offset:36864
    ds_write_b128 v123, v[52:55] offset:37888
    ds_write_b128 v123, v[56:59] offset:38912
    ds_write_b128 v123, v[60:63] offset:39936
    s_waitcnt vmcnt(8)
    s_barrier
    v_xor_b32 v13, 0x0, v12
    v_add_u32 v13, 0x10000, v13
    ds_read_b64_tr_b16 v[32:33], v13
    ds_read_b64_tr_b16 v[34:35], v13 offset:512
    ds_read_b64_tr_b16 v[36:37], v13 offset:2048
    ds_read_b64_tr_b16 v[38:39], v13 offset:2560
    v_xor_b32 v13, 0x2000, v12
    v_add_u32 v13, 0x10000, v13
    ds_read_b64_tr_b16 v[40:41], v13
    ds_read_b64_tr_b16 v[42:43], v13 offset:512
    ds_read_b64_tr_b16 v[44:45], v13 offset:2048
    ds_read_b64_tr_b16 v[46:47], v13 offset:2560
    s_waitcnt lgkmcnt(0)
    v_xor_b32 v13, 0x4000, v12
    v_add_u32 v13, 0x10000, v13
    ds_read_b64_tr_b16 v[48:49], v13
    ds_read_b64_tr_b16 v[50:51], v13 offset:512
    ds_read_b64_tr_b16 v[52:53], v13 offset:2048
    ds_read_b64_tr_b16 v[54:55], v13 offset:2560
    v_xor_b32 v13, 0x6000, v12
    v_add_u32 v13, 0x10000, v13
    ds_read_b64_tr_b16 v[56:57], v13
    ds_read_b64_tr_b16 v[58:59], v13 offset:512
    ds_read_b64_tr_b16 v[60:61], v13 offset:2048
    ds_read_b64_tr_b16 v[62:63], v13 offset:2560
    s_waitcnt lgkmcnt(0)
    s_barrier
    ds_write_b128 v124, v[32:35]
    ds_write_b128 v124, v[36:39] offset:1024
    ds_write_b128 v124, v[40:43] offset:2048
    ds_write_b128 v124, v[44:47] offset:3072
    ds_write_b128 v124, v[48:51] offset:4096
    ds_write_b128 v124, v[52:55] offset:5120
    ds_write_b128 v124, v[56:59] offset:6144
    ds_write_b128 v124, v[60:63] offset:7168
    s_waitcnt vmcnt(0)
    s_barrier
    v_xor_b32 v13, 0x0, v12
    v_add_u32 v13, 0x18000, v13
    ds_read_b64_tr_b16 v[32:33], v13
    ds_read_b64_tr_b16 v[34:35], v13 offset:512
    ds_read_b64_tr_b16 v[36:37], v13 offset:2048
    ds_read_b64_tr_b16 v[38:39], v13 offset:2560
    v_xor_b32 v13, 0x2000, v12
    v_add_u32 v13, 0x18000, v13
    ds_read_b64_tr_b16 v[40:41], v13
    ds_read_b64_tr_b16 v[42:43], v13 offset:512
    ds_read_b64_tr_b16 v[44:45], v13 offset:2048
    ds_read_b64_tr_b16 v[46:47], v13 offset:2560
    s_waitcnt lgkmcnt(0)
    v_xor_b32 v13, 0x4000, v12
    v_add_u32 v13, 0x18000, v13
    ds_read_b64_tr_b16 v[48:49], v13
    ds_read_b64_tr_b16 v[50:51], v13 offset:512
    ds_read_b64_tr_b16 v[52:53], v13 offset:2048
    ds_read_b64_tr_b16 v[54:55], v13 offset:2560
    v_xor_b32 v13, 0x6000, v12
    v_add_u32 v13, 0x18000, v13
    ds_read_b64_tr_b16 v[56:57], v13
    ds_read_b64_tr_b16 v[58:59], v13 offset:512
    ds_read_b64_tr_b16 v[60:61], v13 offset:2048
    ds_read_b64_tr_b16 v[62:63], v13 offset:2560
    s_waitcnt lgkmcnt(0)
    s_barrier
    ds_write_b128 v124, v[32:35] offset:32768
    ds_write_b128 v124, v[36:39] offset:33792
    ds_write_b128 v124, v[40:43] offset:34816
    ds_write_b128 v124, v[44:47] offset:35840
    ds_write_b128 v124, v[48:51] offset:36864
    ds_write_b128 v124, v[52:55] offset:37888
    ds_write_b128 v124, v[56:59] offset:38912
    ds_write_b128 v124, v[60:63] offset:39936
    s_waitcnt lgkmcnt(0)
    v_lshrrev_b32 v1, 4, v117
    v_and_b32 v2, 15, v1
    v_lshrrev_b32 v1, 4, v1
    v_lshlrev_b32 v1, 11, v1
    v_lshl_add_u32 v1, v2, 2, v1
    s_lshl_b32 s43, s20, 6
    s_add_u32 s43, s43, 0x2000
    s_cmp_lg_u32 s100, 0
    s_cbranch_scc1 L_polls_52
    s_mov_b32 exec_lo, 0x10001
    s_mov_b32 exec_hi, 0
    s_mov_b32 s96, 0
L_poll_50:
    buffer_load_dword v2, v1, s[8:11], s43 offen sc1
    s_waitcnt vmcnt(0)
    v_cmp_gt_u32 vcc, 1, v2
    s_cbranch_vccz L_polld_51
    s_sleep 4
    s_add_u32 s96, s96, 1
    s_cmp_lt_u32 s96, 0x10000
    s_cbranch_scc1 L_poll_50
L_polld_51:
    s_mov_b64 exec, -1
L_polls_52:
    s_barrier
    s_mov_b32 s22, 0
    s_mov_b32 s33, 0
    s_xor_b32 s53, s29, 1024
    s_add_u32 s23, s51, 0x7010000
    s_add_u32 s48, s23, 4096
    s_mov_b32 s24, 0x7012000
    s_add_u32 s55, s24, 16384
    s_mov_b32 s25, 0x7100000
    s_mov_b32 s26, 0x7101000
    s_lshl_b32 s43, s20, 13
    v_mov_b32 v112, 0
    v_mov_b32 v113, 0
    v_mov_b32 v114, 0
    v_mov_b32 v115, 0
    s_add_u32 s43, s43, s52
    s_add_u32 s30, s43, 0x1000000
    s_add_u32 s31, s43, 0x2000000
    s_lshr_b32 s43, s43, 1
    s_add_u32 s32, s43, 0x220000
    s_add_u32 m0, s52, 8192
    s_nop 0
    buffer_load_dwordx4 v117, s[8:11], s30 offen lds
    buffer_load_dwordx4 v117, s[8:11], s30 offen offset:1024 lds
    s_add_u32 m0, s52, 0x6000
    s_nop 0
    buffer_load_dwordx4 v117, s[8:11], s31 offen lds
    buffer_load_dwordx4 v117, s[8:11], s31 offen offset:1024 lds
    s_add_u32 m0, s51, 4096
    ds_write_b128 v117, v[112:115] offset:22528
    ds_write_b128 v117, v[112:115] offset:23552
    s_cmp_lg_u32 s21, 0
    s_cselect_b32 s40, -1, 0
    v_mov_b32 v126, s40
    v_bfe_u32 v1, v117, 4, 1
    v_lshlrev_b32 v1, 4, v1
    s_movk_i32 s43, 0x3f80
    v_lshlrev_b32 v125, v1, s43
    v_bfe_u32 v1, v117, 5, 3
    v_cmp_eq_u32 s[68:69], 0, v1
    v_cmp_eq_u32 s[70:71], 1, v1
    v_cmp_eq_u32 s[72:73], 2, v1
    v_cmp_eq_u32 s[74:75], 3, v1
    v_lshrrev_b32 v1, 2, v117
    s_cmp_lt_u32 s21, 2
    s_cselect_b64 vcc, -1, 0
    v_cndmask_b32 v119, v119, v1, vcc
    v_mov_b32 v32, 0
    v_mov_b32 v33, 0
    v_mov_b32 v34, 0
    v_mov_b32 v35, 0
    v_mov_b32 v36, 0
    v_mov_b32 v37, 0
    v_mov_b32 v38, 0
    v_mov_b32 v39, 0
    v_mov_b32 v40, 0
    v_mov_b32 v41, 0
    v_mov_b32 v42, 0
    v_mov_b32 v43, 0
    v_mov_b32 v44, 0
    v_mov_b32 v45, 0
    v_mov_b32 v46, 0
    v_mov_b32 v47, 0
    v_mov_b32 v48, 0
    v_mov_b32 v49, 0
    v_mov_b32 v50, 0
    v_mov_b32 v51, 0
    v_mov_b32 v52, 0
    v_mov_b32 v53, 0
    v_mov_b32 v54, 0
    v_mov_b32 v55, 0
    s_add_u32 s30, s30, 0x40000
    s_add_u32 s31, s31, 0x40000
    s_mov_b32 s45, 0
    s_mov_b32 s46, 0
    s_mov_b32 s47, 0
    s_mov_b32 s76, 0
    s_and_b32 s43, s21, 1
    s_lshl_b32 s43, s43, 5
    s_add_u32 s43, s43, s20
    s_lshl_b32 s43, s43, 6
    s_add_u32 s28, s43, 0x2000
    s_mov_b32 s59, 0
    ds_read_b128 v[80:83], v123
    ds_read_b128 v[84:87], v123 offset:1024
    ds_read_b128 v[56:59], v123 offset:2048
    ds_read_b128 v[60:63], v123 offset:3072
    ds_read_b128 v[64:67], v123 offset:32768
    ds_read_b128 v[68:71], v123 offset:33792
    ds_read_b128 v[72:75], v123 offset:34816
    ds_read_b128 v[76:79], v123 offset:35840
    ds_read_b128 v[88:91], v123 offset:4096
    ds_read_b128 v[92:95], v123 offset:5120
    ds_read_b128 v[96:99], v123 offset:6144
    ds_read_b128 v[100:103], v123 offset:7168
    ds_read_b128 v[104:107], v123 offset:36864
    ds_read_b128 v[108:111], v123 offset:37888
    ds_read_b128 v[24:27], v123 offset:38912
    ds_read_b128 v[28:31], v123 offset:39936
    s_cmp_lg_u32 s21, 0
    s_cbranch_scc1 L_cb_skip_53
    v_mov_b32 v1, 8
    s_mov_b64 exec, 1
    s_mov_b32 s49, 0
L_cb_poll_54:
    buffer_load_dword v3, v1, s[16:19], 0 offen sc1
    s_waitcnt vmcnt(0)
    v_readfirstlane_b32 s43, v3
    s_nop 0
    s_cmp_ge_u32 s43, 32
    s_cbranch_scc1 L_cb_done_55
    s_sleep 2
    s_add_u32 s49, s49, 1
    s_cmp_lt_u32 s49, 0x40000
    s_cbranch_scc1 L_cb_poll_54
L_cb_done_55:
    s_mov_b64 exec, -1
L_cb_skip_53:
    s_mov_b32 s49, 0
    s_lshr_b32 s43, s20, 1
    s_lshl_b32 s43, s43, 7
    s_and_b32 s40, s20, 1
    s_lshl_b32 s40, s40, 4
    s_add_u32 s43, s43, s40
    s_add_u32 s44, s43, 0x1000
    s_cmp_eq_u32 s21, 0
    s_cselect_b32 s44, s44, 0x7ff00000
    s_waitcnt vmcnt(0) lgkmcnt(0)
    s_barrier
    buffer_load_dwordx4 v[0:3], v117, s[8:11], s23 offen sc1
    s_waitcnt vmcnt(0) lgkmcnt(0)
    s_cmp_eq_u32 s21, 1
    s_cbranch_scc1 L_chain_top1_s
    s_cmp_eq_u32 s21, 2
    s_cbranch_scc1 L_chain_top2_s
    s_cmp_eq_u32 s21, 3
    s_cbranch_scc1 L_chain_top3_s
.p2align 6
L_chain_top0_s:
    buffer_load_dwordx4 v[0:3], v117, s[8:11], s23 offen sc1
    v_mov_b32 v15, 0
    v_mov_b32 v15, 0
    v_mov_b32 v15, 0
    v_mov_b32 v15, 0
    v_mov_b32 v15, 0
    v_mov_b32 v15, 0
    v_mov_b32 v15, 0
    v_mov_b32 v15, 0
    v_mov_b32 v15, 0
    v_mov_b32 v15, 0
    v_mov_b32 v15, 0
    v_mov_b32 v15, 0
    v_mov_b32 v15, 0
    v_mov_b32 v15, 0
    v_mov_b32 v15, 0
    v_mov_b32 v15, 0
    buffer_load_dwordx4 v[0:3], v117, s[8:11], s23 offen sc1
    v_mov_b32 v15, 0
    v_mov_b32 v15, 0
    v_mov_b32 v15, 0
    v_mov_b32 v15, 0
    v_mov_b32 v15, 0
    v_mov_b32 v15, 0
    v_mov_b32 v15, 0
    v_mov_b32 v15, 0
    v_mov_b32 v15, 0
    v_mov_b32 v15, 0
    v_mov_b32 v15, 0
    v_mov_b32 v15, 0
    v_mov_b32 v15, 0
    v_mov_b32 v15, 0
    v_mov_b32 v15, 0
    v_mov_b32 v15, 0
L_mret_56:
    buffer_load_dwordx4 v[0:3], v117, s[8:11], s23 offen sc1
    s_add_u32 s45, s45, 1
    s_cmp_lt_u32 s45, 0x10000
    s_cselect_b32 s56, -2, -1
    s_nop 3
    v_mov_b32 v32, 0
    v_mov_b32 v33, 0
    v_mov_b32 v34, 0
    v_mov_b32 v35, 0
    s_waitcnt vmcnt(2)
    v_max3_u32 v15, v0, v1, v2
    v_max_u32 v15, v15, v3
    v_cmp_lt_u32 vcc, s56, v15
    v_smfmac_f32_16x16x64_bf16 v[32:35], v[0:3], v[80:87], v116
    s_cbranch_vccnz L_mret_56
    ds_write_b128 v117, v[0:3]
    v_smfmac_f32_16x16x64_bf16 v[36:39], v[0:3], v[56:63], v116
    buffer_load_dwordx4 v[4:7], v117, s[8:11], s48 offen sc1
    v_smfmac_f32_16x16x64_bf16 v[40:43], v[0:3], v[64:71], v116
    buffer_load_dwordx4 v117, s[8:11], s48 offen sc1 lds
    s_mov_b32 m0, 8192
    v_smfmac_f32_16x16x64_bf16 v[44:47], v[0:3], v[72:79], v116
    s_waitcnt lgkmcnt(0)
    s_barrier
    ds_read_b128 v[8:11], v117 offset:1024
    v_smfmac_f32_16x16x64_bf16 v[48:51], v[0:3], a[192:199], v116
    ds_read_b128 v[16:19], v117 offset:2048
    ds_read_b128 v[20:23], v117 offset:3072
    v_smfmac_f32_16x16x64_bf16 v[52:55], v[0:3], a[200:207], v116
    ds_read_b128 v[80:83], v117 offset:14336
    s_waitcnt lgkmcnt(3)
    v_smfmac_f32_16x16x64_bf16 v[32:35], v[8:11], a[0:7], v116
    ds_read_b128 v[84:87], v117 offset:15360
    v_smfmac_f32_16x16x64_bf16 v[36:39], v[8:11], a[8:15], v116
    buffer_store_dwordx4 v[112:115], v117, s[8:11], s32 offen sc1
    s_waitcnt lgkmcnt(3)
    v_smfmac_f32_16x16x64_bf16 v[32:35], v[16:19], a[32:39], v116
    ds_read_b128 v[56:59], v117 offset:8192
    v_smfmac_f32_16x16x64_bf16 v[36:39], v[16:19], a[40:47], v116
    ds_read_b128 v[60:63], v117 offset:9216
    s_waitcnt lgkmcnt(4)
    v_smfmac_f32_16x16x64_bf16 v[32:35], v[20:23], a[64:71], v116
    ds_read_b128 v[64:67], v117 offset:10240
    v_smfmac_f32_16x16x64_bf16 v[36:39], v[20:23], a[72:79], v116
    ds_read_b128 v[68:71], v117 offset:11264
    v_smfmac_f32_16x16x64_bf16 v[40:43], v[8:11], a[96:103], v116
    ds_read_b128 v[72:75], v117 offset:12288
    v_smfmac_f32_16x16x64_bf16 v[40:43], v[16:19], a[128:135], v116
    ds_read_b128 v[76:79], v117 offset:13312
    v_smfmac_f32_16x16x64_bf16 v[40:43], v[20:23], a[160:167], v116
    s_waitcnt vmcnt(2)
    v_max3_u32 v15, v4, v5, v6
    v_smfmac_f32_16x16x64_bf16 v[44:47], v[8:11], a[104:111], v116
    v_max_u32 v15, v15, v7
    v_smfmac_f32_16x16x64_bf16 v[44:47], v[16:19], a[136:143], v116
    s_waitcnt vmcnt(1) lgkmcnt(0)
    v_cmp_lt_u32 vcc, s56, v15
    v_smfmac_f32_16x16x64_bf16 v[44:47], v[20:23], a[168:175], v116
    s_cbranch_vccnz L_mret_57
L_mgo_58:
    v_smfmac_f32_16x16x64_bf16 v[44:47], v[4:7], v[24:31], v116
    s_barrier
    ds_read_b128 v[12:15], v117 offset:5120
    v_smfmac_f32_16x16x64_bf16 v[32:35], v[4:7], v[88:95], v116
    ds_read_b128 v[24:27], v117 offset:6144
    v_smfmac_f32_16x16x64_bf16 v[36:39], v[4:7], v[96:103], v116
    ds_read_b128 v[28:31], v117 offset:7168
    v_smfmac_f32_16x16x64_bf16 v[40:43], v[4:7], v[104:111], v116
    ds_read_b128 v[88:91], v117 offset:24576
    s_waitcnt lgkmcnt(3)
    v_smfmac_f32_16x16x64_bf16 v[32:35], v[12:15], a[16:23], v116
    ds_read_b128 v[92:95], v117 offset:25600
    s_waitcnt lgkmcnt(3)
    v_smfmac_f32_16x16x64_bf16 v[32:35], v[24:27], a[48:55], v116
    buffer_load_dwordx4 v117, s[8:11], s30 offen lds
    s_waitcnt lgkmcnt(2)
    v_smfmac_f32_16x16x64_bf16 v[32:35], v[28:31], a[80:87], v116
    ds_read_b128 v[96:99], v117 offset:23552
    v_smfmac_f32_16x16x64_bf16 v[36:39], v[12:15], a[24:31], v116
    ds_read_b128 v[100:103], v117 offset:23552
    v_smfmac_f32_16x16x64_bf16 v[36:39], v[24:27], a[56:63], v116
    buffer_load_dwordx4 v117, s[8:11], s30 offen offset:1024 lds
    s_add_u32 m0, s52, 0x6000
    v_add_f32 v32, v32, v34
    v_smfmac_f32_16x16x64_bf16 v[36:39], v[28:31], a[88:95], v116
    ds_read_b128 v[104:107], v117 offset:23552
    v_add_f32 v33, v33, v35
    v_smfmac_f32_16x16x64_bf16 v[40:43], v[12:15], a[112:119], v116
    ds_read_b128 v[108:111], v117 offset:23552
    v_mul_f32 v32, s34, v32
    v_smfmac_f32_16x16x64_bf16 v[40:43], v[24:27], a[144:151], v116
    buffer_load_dword v125, v119, s[8:11], s28 offen sc1
    v_mul_f32 v33, s34, v33
    v_smfmac_f32_16x16x64_bf16 v[40:43], v[28:31], a[176:183], v116
    ds_read_b128 v[0:3], v124
    v_add_f32 v36, v36, v38
    v_smfmac_f32_16x16x64_bf16 v[48:51], v[4:7], a[208:215], v116
    v_add_f32 v37, v37, v39
    v_smfmac_f32_16x16x64_bf16 v[52:55], v[4:7], a[216:223], v116
    s_waitcnt lgkmcnt(5)
    buffer_load_dwordx4 v117, s[8:11], s31 offen lds
    v_mul_f32 v36, s34, v36
    v_smfmac_f32_16x16x64_bf16 v[44:47], v[12:15], a[120:127], v116
    ds_read_b128 v[4:7], v124 offset:1024
    v_mul_f32 v37, s34, v37
    v_smfmac_f32_16x16x64_bf16 v[44:47], v[24:27], a[152:159], v116
    v_cvt_pk_bf16_f32 v34, v32, v36
    v_smfmac_f32_16x16x64_bf16 v[44:47], v[28:31], a[184:191], v116
    buffer_load_dwordx4 v117, s[8:11], s31 offen offset:1024 lds
    s_mov_b32 m0, 4096
    v_cvt_pk_bf16_f32 v35, v33, v37
    v_add_f32 v40, v40, v42
    v_smfmac_f32_16x16x64_bf16 v[48:51], v[8:11], a[224:231], v116
    ds_write2_b32 v120, v34, v35 offset0:32 offset1:48
    v_add_f32 v41, v41, v43
    v_smfmac_f32_16x16x64_bf16 v[52:55], v[8:11], a[232:239], v116
    v_add_f32 v44, v44, v46
    v_add_f32 v45, v45, v47
    v_cvt_pk_bf16_f32 v113, v40, v44
    v_cvt_pk_bf16_f32 v115, v41, v45
    v_smfmac_f32_16x16x64_bf16 v[48:51], v[12:15], a[240:247], v116
    ds_write2_b32 v120, v113, v115 offset0:0 offset1:16
    v_smfmac_f32_16x16x64_bf16 v[52:55], v[12:15], a[248:255], v116
    s_cmp_eq_u32 s22, 63
    s_cbranch_scc1 L_chain_last_s
    buffer_store_dword v126, off, s[8:11], s44 sc1
    v_smfmac_f32_16x16x64_bf16 v[48:51], v[16:19], v[128:135], v116
    v_smfmac_f32_16x16x64_bf16 v[48:51], v[20:23], v[160:167], v116
    v_smfmac_f32_16x16x64_bf16 v[48:51], v[24:27], v[144:151], v116
    s_waitcnt lgkmcnt(0)
    s_barrier
    v_smfmac_f32_16x16x64_bf16 v[48:51], v[28:31], v[176:183], v116
    ds_read_b128 v[32:35], v121 offset:16384
    ds_read_b128 v[36:39], v121 offset:17408
    v_smfmac_f32_16x16x64_bf16 v[52:55], v[16:19], v[136:143], v116
    ds_read_b128 v[40:43], v121 offset:18432
    ds_read_b128 v[44:47], v121 offset:19456
    v_smfmac_f32_16x16x64_bf16 v[52:55], v[20:23], v[168:175], v116
    ds_read_b128 v[8:11], v124 offset:32768
    v_add_f32 v48, v48, v50
    v_smfmac_f32_16x16x64_bf16 v[52:55], v[24:27], v[152:159], v116
    ds_read_b128 v[12:15], v124 offset:33792
    v_add_f32 v49, v49, v51
    v_smfmac_f32_16x16x64_bf16 v[52:55], v[28:31], v[184:191], v116
    s_waitcnt lgkmcnt(5)
    v_cvt_pk_bf16_f32 v112, v48, v49
    v_mfma_f32_16x16x32_bf16 v[56:59], v[56:59], v[32:35], 0
    s_waitcnt lgkmcnt(4)
    v_mov_b32 v48, s50
    v_mov_b32 v49, s50
    v_mfma_f32_16x16x32_bf16 v[56:59], v[60:63], v[36:39], v[56:59]
    ds_read_b128 v[16:19], v124 offset:2048
    s_waitcnt lgkmcnt(4)
    v_mov_b32 v50, s50
    v_mov_b32 v51, s50
    v_mfma_f32_16x16x32_bf16 v[56:59], v[64:67], v[40:43], v[56:59]
    ds_read_b128 v[20:23], v124 offset:3072
    s_waitcnt lgkmcnt(4)
    v_add_f32 v52, v52, v54
    v_mfma_f32_16x16x32_bf16 v[56:59], v[68:71], v[44:47], v[56:59]
    ds_read_b128 v[24:27], v124 offset:4096
    v_add_f32 v53, v53, v55
    v_mfma_f32_16x16x32_bf16 v[60:63], v[72:75], v[32:35], 0
    ds_read_b128 v[28:31], v124 offset:5120
    v_cvt_pk_bf16_f32 v114, v52, v53
    v_mov_b32 v53, 0
    v_mfma_f32_16x16x32_bf16 v[60:63], v[76:79], v[36:39], v[60:63]
    v_exp_f32 v56, v56
    v_mfma_f32_16x16x32_bf16 v[60:63], v[80:83], v[40:43], v[60:63]
    v_exp_f32 v57, v57
    v_mfma_f32_16x16x32_bf16 v[60:63], v[84:87], v[44:47], v[60:63]
    v_exp_f32 v58, v58
    v_mfma_f32_16x16x32_bf16 v[64:67], v[32:35], v[32:35], 0
    v_exp_f32 v59, v59
    v_cvt_pk_bf16_f32 v68, v56, v57
    v_mfma_f32_16x16x32_bf16 v[64:67], v[36:39], v[36:39], v[64:67]
    v_exp_f32 v60, v60
    v_cvt_pk_bf16_f32 v69, v58, v59
    v_mfma_f32_16x16x32_bf16 v[64:67], v[40:43], v[40:43], v[64:67]
    v_exp_f32 v61, v61
    v_mfma_f32_16x16x32_bf16 v[64:67], v[44:47], v[44:47], v[64:67]
    v_exp_f32 v62, v62
    v_exp_f32 v63, v63
    v_cvt_pk_bf16_f32 v70, v60, v61
    v_cvt_pk_bf16_f32 v71, v62, v63
    s_nop 1
    v_mfma_f32_16x16x32_bf16 v[72:75], v[88:91], v[68:71], 0
    s_nop 0
    v_exp_f32 v64, v64
    v_mfma_f32_16x16x32_bf16 v[76:79], v[92:95], v[68:71], 0
    v_exp_f32 v65, v65
    v_mfma_f32_16x16x32_bf16 v[80:83], v[48:51], v[68:71], 0
    v_cvt_pk_bf16_f32 v52, v64, v65
    s_nop 1
    v_mfma_f32_16x16x16_bf16 v[72:75], v[112:113], v[52:53], v[72:75]
    ds_read_b128 v[32:35], v124 offset:6144
    v_mfma_f32_16x16x16_bf16 v[76:79], v[114:115], v[52:53], v[76:79]
    ds_read_b128 v[36:39], v124 offset:7168
    v_mfma_f32_16x16x16_bf16 v[80:83], v[48:49], v[52:53], v[80:83]
L_norm_59:
    s_mov_b64 vcc, s[36:37]
    v_mov_b32 v122, v122
    v_mov_b32 v122, v122
    v_mov_b32 v122, v122
    v_cndmask_b32_dpp v76, v72, v76, vcc quad_perm:[2,3,2,3] row_mask:0xf bank_mask:0xf
    v_cndmask_b32_dpp v77, v73, v77, vcc quad_perm:[2,3,2,3] row_mask:0xf bank_mask:0xf
    v_cndmask_b32_dpp v78, v74, v78, vcc quad_perm:[2,3,2,3] row_mask:0xf bank_mask:0xf
    v_cndmask_b32_dpp v79, v75, v79, vcc quad_perm:[2,3,2,3] row_mask:0xf bank_mask:0xf
    v_rcp_f32_dpp v84, v80 quad_perm:[2,3,2,3] row_mask:0xf bank_mask:0xf
    s_nop 0
    v_pk_mul_f32 v[76:77], v[76:77], v[84:85] op_sel_hi:[1,0]
    v_pk_mul_f32 v[78:79], v[78:79], v[84:85] op_sel_hi:[1,0]
    v_cvt_pk_bf16_f32 v72, v76, v77
    v_cvt_pk_bf16_f32 v73, v78, v79
    ds_write_b64 v122, v[72:73] offset:20480
    v_max_f32_dpp v86, v80, v84 quad_perm:[2,3,2,3] row_mask:0xf bank_mask:0xf
    v_mov_b32_dpp v60, v72 quad_perm:[0,1,0,1] row_mask:0xf bank_mask:0xf
    v_mov_b32_dpp v61, v73 quad_perm:[0,1,0,1] row_mask:0xf bank_mask:0xf
    v_cmp_lt_f32 vcc, s35, v86
    v_mov_b32_dpp v62, v72 quad_perm:[2,3,2,3] row_mask:0xf bank_mask:0xf
    v_mov_b32_dpp v63, v73 quad_perm:[2,3,2,3] row_mask:0xf bank_mask:0xf
    s_nop 1
    v_smfmac_f32_16x16x64_bf16 v[96:99], v[60:63], v[192:199], v116
    s_cbranch_vccnz L_smax_60
    v_smfmac_f32_16x16x64_bf16 v[100:103], v[60:63], v[224:231], v116
    s_waitcnt lgkmcnt(0)
    s_barrier
    ds_read_b128 v[92:95], v127 offset:20992
    ds_read_b128 v[80:83], v127 offset:21504
    ds_read_b128 v[84:87], v127 offset:22016
    v_smfmac_f32_16x16x64_bf16 v[104:107], v[60:63], v[0:7], v116
    ds_read_b128 v[40:43], v124 offset:34816
    v_smfmac_f32_16x16x64_bf16 v[108:111], v[60:63], v[8:15], v116
    ds_read_b128 v[56:59], v124 offset:36864
    s_waitcnt lgkmcnt(4)
    v_smfmac_f32_16x16x64_bf16 v[96:99], v[92:95], v[200:207], v116
    s_waitcnt lgkmcnt(3)
    v_smfmac_f32_16x16x64_bf16 v[96:99], v[80:83], v[208:215], v116
    ds_read_b128 v[44:47], v124 offset:35840
    s_waitcnt lgkmcnt(3)
    v_smfmac_f32_16x16x64_bf16 v[96:99], v[84:87], v[216:223], v116
    ds_read_b128 v[68:71], v124 offset:39936
    v_smfmac_f32_16x16x64_bf16 v[100:103], v[92:95], v[232:239], v116
    ds_read_b128 v[64:67], v124 offset:38912
    v_smfmac_f32_16x16x64_bf16 v[100:103], v[80:83], v[240:247], v116
    ds_read_b128 v[60:63], v124 offset:37888
    v_cvt_pk_bf16_f32 v72, v96, v98
    v_smfmac_f32_16x16x64_bf16 v[100:103], v[84:87], v[248:255], v116
    v_and_or_b32 v72, v72, -2, s33
    v_smfmac_f32_16x16x64_bf16 v[104:107], v[92:95], v[16:23], v116
    v_cvt_pk_bf16_f32 v74, v97, v99
    v_smfmac_f32_16x16x64_bf16 v[104:107], v[80:83], v[24:31], v116
    v_cvt_pk_bf16_f32 v73, v100, v102
    v_cvt_pk_bf16_f32 v75, v101, v103
    v_smfmac_f32_16x16x64_bf16 v[104:107], v[84:87], v[32:39], v116
    buffer_store_dwordx4 v[72:75], v118, s[8:11], s25 offen sc1
    s_waitcnt lgkmcnt(3)
    v_smfmac_f32_16x16x64_bf16 v[108:111], v[92:95], v[40:47], v116
    s_waitcnt lgkmcnt(0)
    v_smfmac_f32_16x16x64_bf16 v[108:111], v[80:83], v[56:63], v116
    v_cvt_pk_bf16_f32 v76, v104, v106
    v_smfmac_f32_16x16x64_bf16 v[108:111], v[84:87], v[64:71], v116
    v_and_or_b32 v76, v76, -2, s33
    v_cvt_pk_bf16_f32 v78, v105, v107
    v_mov_b32 v122, v122
    v_mov_b32 v122, v122
    v_mov_b32 v122, v122
    v_mov_b32 v122, v122
    v_mov_b32 v122, v122
    v_mov_b32 v122, v122
    v_cvt_pk_bf16_f32 v77, v108, v110
    v_cvt_pk_bf16_f32 v79, v109, v111
    buffer_store_dwordx4 v[76:79], v118, s[8:11], s26 offen sc1
    s_add_u32 s30, s30, 0x40000
    s_add_u32 s31, s31, 0x40000
    s_add_u32 s32, s32, 0x20000
    s_add_u32 s23, s24, 0
    s_add_u32 s48, s23, 4096
    s_xor_b32 s25, s25, 0x40000
    s_xor_b32 s26, s26, 0x40000
    s_mov_b32 s35, 0x49800000
    v_mov_b32 v126, s22
    s_add_u32 s22, s22, 1
    v_mov_b32 v32, 0
    v_mov_b32 v33, 0
    v_mov_b32 v34, 0
    v_mov_b32 v35, 0
    v_mov_b32 v36, 0
    v_mov_b32 v37, 0
    v_mov_b32 v38, 0
    v_mov_b32 v39, 0
    v_mov_b32 v40, 0
    v_mov_b32 v41, 0
    v_mov_b32 v42, 0
    v_mov_b32 v43, 0
    v_mov_b32 v44, 0
    v_mov_b32 v45, 0
    v_mov_b32 v46, 0
    v_mov_b32 v47, 0
    v_mov_b32 v48, 0
    v_mov_b32 v49, 0
    v_mov_b32 v50, 0
    v_mov_b32 v51, 0
    v_mov_b32 v52, 0
    v_mov_b32 v53, 0
    v_mov_b32 v54, 0
    v_mov_b32 v55, 0
    ds_read_b128 v[80:83], v123
    ds_read_b128 v[84:87], v123 offset:1024
    ds_read_b128 v[56:59], v123 offset:2048
    ds_read_b128 v[60:63], v123 offset:3072
    ds_read_b128 v[64:67], v123 offset:32768
    ds_read_b128 v[68:71], v123 offset:33792
    ds_read_b128 v[72:75], v123 offset:34816
    ds_read_b128 v[76:79], v123 offset:35840
    ds_read_b128 v[88:91], v123 offset:4096
    ds_read_b128 v[92:95], v123 offset:5120
    ds_read_b128 v[96:99], v123 offset:6144
    ds_read_b128 v[100:103], v123 offset:7168
    ds_read_b128 v[104:107], v123 offset:36864
    ds_read_b128 v[108:111], v123 offset:37888
    ds_read_b128 v[24:27], v123 offset:38912
    ds_read_b128 v[28:31], v123 offset:39936
    s_add_u32 s24, s24, 8192
    s_bitset0_b32 s24, 15
    s_xor_b32 s55, s24, 16384
    s_xor_b32 s29, s29, 0x40000
    s_xor_b32 s53, s29, 1024
    s_bfe_u32 s33, s22, 0x10001
    s_add_u32 s40, s22, 5
    s_lshr_b32 s40, s40, 2
    s_min_u32 s40, s40, 16
    s_bfm_b32 s58, s40, 0
    s_waitcnt vmcnt(5)
    v_cmp_eq_u32 vcc, 0, v125
    s_nop 0
    s_and_b64 vcc, vcc, s[58:59]
    s_cbranch_scc1 L_kvw_61
L_kvb_62:
    v_mov_b32 v15, 0
    s_nop 2
    v_mov_b32 v15, 0
    s_nop 2
    v_mov_b32 v15, 0
    s_nop 2
    v_mov_b32 v15, 0
    s_nop 2
    v_mov_b32 v15, 0
    s_nop 2
    v_mov_b32 v15, 0
    s_nop 2
    v_mov_b32 v15, 0
    s_nop 2
    v_mov_b32 v15, 0
    s_nop 2
    v_mov_b32 v15, 0
    s_nop 2
    v_mov_b32 v15, 0
    s_nop 2
    v_mov_b32 v15, 0
    s_nop 2
    v_mov_b32 v15, 0
    s_nop 2
    v_mov_b32 v15, 0
    s_nop 2
    v_mov_b32 v15, 0
    s_nop 2
    v_mov_b32 v15, 0
    s_nop 2
    v_mov_b32 v15, 0
    s_nop 2
    v_mov_b32 v15, 0
    s_nop 2
    v_mov_b32 v15, 0
    s_nop 2
    v_mov_b32 v15, 0
    s_nop 2
    v_mov_b32 v15, 0
    s_nop 2
    v_mov_b32 v15, 0
    s_nop 2
    v_mov_b32 v15, 0
    s_nop 2
    v_mov_b32 v15, 0
    s_nop 2
    v_mov_b32 v15, 0
    s_nop 2
    v_mov_b32 v15, 0
    s_nop 2
    v_mov_b32 v15, 0
    s_nop 2
    v_mov_b32 v15, 0
    s_nop 2
    v_mov_b32 v15, 0
    s_nop 2
    v_mov_b32 v15, 0
    s_nop 2
    v_mov_b32 v15, 0
    s_nop 2
    v_mov_b32 v15, 0
    s_nop 2
    s_waitcnt lgkmcnt(0)
    s_branch L_chain_top0_s
.p2align 6
L_chain_top1_s:
    buffer_load_dwordx4 v[0:3], v117, s[8:11], s23 offen sc1
    v_mov_b32 v15, 0
    v_mov_b32 v15, 0
    v_mov_b32 v15, 0
    v_mov_b32 v15, 0
    v_mov_b32 v15, 0
    v_mov_b32 v15, 0
    v_mov_b32 v15, 0
    v_mov_b32 v15, 0
    v_mov_b32 v15, 0
    v_mov_b32 v15, 0
    v_mov_b32 v15, 0
    v_mov_b32 v15, 0
    v_mov_b32 v15, 0
    v_mov_b32 v15, 0
    v_mov_b32 v15, 0
    v_mov_b32 v15, 0
    buffer_load_dwordx4 v[0:3], v117, s[8:11], s23 offen sc1
    v_mov_b32 v15, 0
    v_mov_b32 v15, 0
    v_mov_b32 v15, 0
    v_mov_b32 v15, 0
    v_mov_b32 v15, 0
    v_mov_b32 v15, 0
    v_mov_b32 v15, 0
    v_mov_b32 v15, 0
    v_mov_b32 v15, 0
    v_mov_b32 v15, 0
    v_mov_b32 v15, 0
    v_mov_b32 v15, 0
    v_mov_b32 v15, 0
    v_mov_b32 v15, 0
    v_mov_b32 v15, 0
    v_mov_b32 v15, 0
L_mret_63:
    buffer_load_dwordx4 v[0:3], v117, s[8:11], s23 offen sc1
    s_add_u32 s45, s45, 1
    s_cmp_lt_u32 s45, 0x10000
    s_cselect_b32 s56, -2, -1
    s_nop 3
    v_mov_b32 v32, 0
    v_mov_b32 v33, 0
    v_mov_b32 v34, 0
    v_mov_b32 v35, 0
    s_waitcnt vmcnt(2)
    v_max3_u32 v15, v0, v1, v2
    v_max_u32 v15, v15, v3
    v_cmp_lt_u32 vcc, s56, v15
    v_smfmac_f32_16x16x64_bf16 v[32:35], v[0:3], v[80:87], v116
    s_cbranch_vccnz L_mret_63
    ds_write_b128 v117, v[0:3] offset:1024
    v_smfmac_f32_16x16x64_bf16 v[36:39], v[0:3], v[56:63], v116
    buffer_load_dwordx4 v[4:7], v117, s[8:11], s48 offen sc1
    v_smfmac_f32_16x16x64_bf16 v[40:43], v[0:3], v[64:71], v116
    buffer_load_dwordx4 v117, s[8:11], s48 offen sc1 lds
    s_mov_b32 m0, 10240
    v_smfmac_f32_16x16x64_bf16 v[44:47], v[0:3], v[72:79], v116
    s_waitcnt lgkmcnt(0)
    s_barrier
    ds_read_b128 v[8:11], v117
    v_smfmac_f32_16x16x64_bf16 v[48:51], v[0:3], a[192:199], v116
    ds_read_b128 v[16:19], v117 offset:3072
    ds_read_b128 v[20:23], v117 offset:2048
    v_smfmac_f32_16x16x64_bf16 v[52:55], v[0:3], a[200:207], v116
    ds_read_b128 v[80:83], v117 offset:14336
    s_waitcnt lgkmcnt(3)
    v_smfmac_f32_16x16x64_bf16 v[32:35], v[8:11], a[0:7], v116
    ds_read_b128 v[84:87], v117 offset:15360
    v_smfmac_f32_16x16x64_bf16 v[36:39], v[8:11], a[8:15], v116
    ds_read_b128 v[56:59], v117 offset:8192
    s_waitcnt lgkmcnt(4)
    v_smfmac_f32_16x16x64_bf16 v[32:35], v[16:19], a[32:39], v116
    ds_read_b128 v[60:63], v117 offset:9216
    v_smfmac_f32_16x16x64_bf16 v[36:39], v[16:19], a[40:47], v116
    buffer_store_dwordx4 v[112:115], v117, s[8:11], s32 offen sc1
    s_waitcnt lgkmcnt(4)
    v_smfmac_f32_16x16x64_bf16 v[32:35], v[20:23], a[64:71], v116
    ds_read_b128 v[64:67], v117 offset:10240
    v_smfmac_f32_16x16x64_bf16 v[36:39], v[20:23], a[72:79], v116
    ds_read_b128 v[68:71], v117 offset:11264
    v_smfmac_f32_16x16x64_bf16 v[40:43], v[8:11], a[96:103], v116
    ds_read_b128 v[72:75], v117 offset:12288
    v_smfmac_f32_16x16x64_bf16 v[40:43], v[16:19], a[128:135], v116
    ds_read_b128 v[76:79], v117 offset:13312
    v_smfmac_f32_16x16x64_bf16 v[40:43], v[20:23], a[160:167], v116
    s_waitcnt vmcnt(2)
    v_max3_u32 v15, v4, v5, v6
    v_smfmac_f32_16x16x64_bf16 v[44:47], v[8:11], a[104:111], v116
    v_max_u32 v15, v15, v7
    v_smfmac_f32_16x16x64_bf16 v[44:47], v[16:19], a[136:143], v116
    s_waitcnt vmcnt(1) lgkmcnt(0)
    v_cmp_lt_u32 vcc, s56, v15
    v_smfmac_f32_16x16x64_bf16 v[44:47], v[20:23], a[168:175], v116
    s_cbranch_vccnz L_mret_64
L_mgo_65:
    v_smfmac_f32_16x16x64_bf16 v[44:47], v[4:7], v[24:31], v116
    s_barrier
    ds_read_b128 v[12:15], v117 offset:4096
    v_smfmac_f32_16x16x64_bf16 v[32:35], v[4:7], v[88:95], v116
    ds_read_b128 v[24:27], v117 offset:7168
    v_smfmac_f32_16x16x64_bf16 v[36:39], v[4:7], v[96:103], v116
    ds_read_b128 v[28:31], v117 offset:6144
    v_smfmac_f32_16x16x64_bf16 v[40:43], v[4:7], v[104:111], v116
    ds_read_b128 v[88:91], v117 offset:26624
    s_waitcnt lgkmcnt(3)
    v_smfmac_f32_16x16x64_bf16 v[32:35], v[12:15], a[16:23], v116
    ds_read_b128 v[92:95], v117 offset:27648
    s_waitcnt lgkmcnt(3)
    v_smfmac_f32_16x16x64_bf16 v[32:35], v[24:27], a[48:55], v116
    buffer_load_dwordx4 v117, s[8:11], s30 offen lds
    s_waitcnt lgkmcnt(2)
    v_smfmac_f32_16x16x64_bf16 v[32:35], v[28:31], a[80:87], v116
    ds_read_b128 v[96:99], v117 offset:23552
    v_smfmac_f32_16x16x64_bf16 v[36:39], v[12:15], a[24:31], v116
    ds_read_b128 v[100:103], v117 offset:23552
    v_smfmac_f32_16x16x64_bf16 v[36:39], v[24:27], a[56:63], v116
    buffer_load_dwordx4 v117, s[8:11], s30 offen offset:1024 lds
    s_add_u32 m0, s52, 0x6000
    v_add_f32 v32, v32, v34
    v_smfmac_f32_16x16x64_bf16 v[36:39], v[28:31], a[88:95], v116
    ds_read_b128 v[104:107], v117 offset:23552
    v_add_f32 v33, v33, v35
    v_smfmac_f32_16x16x64_bf16 v[40:43], v[12:15], a[112:119], v116
    ds_read_b128 v[108:111], v117 offset:23552
    v_mul_f32 v32, s34, v32
    v_smfmac_f32_16x16x64_bf16 v[40:43], v[24:27], a[144:151], v116
    buffer_load_dword v125, v119, s[8:11], s28 offen sc1
    v_mul_f32 v33, s34, v33
    v_smfmac_f32_16x16x64_bf16 v[40:43], v[28:31], a[176:183], v116
    ds_read_b128 v[0:3], v124
    v_add_f32 v36, v36, v38
    v_smfmac_f32_16x16x64_bf16 v[48:51], v[4:7], a[208:215], v116
    v_add_f32 v37, v37, v39
    v_smfmac_f32_16x16x64_bf16 v[52:55], v[4:7], a[216:223], v116
    s_waitcnt lgkmcnt(5)
    buffer_load_dwordx4 v117, s[8:11], s31 offen lds
    v_mul_f32 v36, s34, v36
    v_smfmac_f32_16x16x64_bf16 v[44:47], v[12:15], a[120:127], v116
    ds_read_b128 v[4:7], v124 offset:1024
    v_mul_f32 v37, s34, v37
    v_smfmac_f32_16x16x64_bf16 v[44:47], v[24:27], a[152:159], v116
    v_cvt_pk_bf16_f32 v34, v32, v36
    v_smfmac_f32_16x16x64_bf16 v[44:47], v[28:31], a[184:191], v116
    buffer_load_dwordx4 v117, s[8:11], s31 offen offset:1024 lds
    s_mov_b32 m0, 5120
    v_cvt_pk_bf16_f32 v35, v33, v37
    v_add_f32 v40, v40, v42
    v_smfmac_f32_16x16x64_bf16 v[48:51], v[8:11], a[224:231], v116
    ds_write2_b32 v120, v34, v35 offset0:32 offset1:48
    v_add_f32 v41, v41, v43
    v_smfmac_f32_16x16x64_bf16 v[52:55], v[8:11], a[232:239], v116
    v_add_f32 v44, v44, v46
    v_add_f32 v45, v45, v47
    v_cvt_pk_bf16_f32 v113, v40, v44
    v_cvt_pk_bf16_f32 v115, v41, v45
    v_smfmac_f32_16x16x64_bf16 v[48:51], v[12:15], a[240:247], v116
    ds_write2_b32 v120, v113, v115 offset0:0 offset1:16
    v_smfmac_f32_16x16x64_bf16 v[52:55], v[12:15], a[248:255], v116
    s_cmp_eq_u32 s22, 63
    s_cbranch_scc1 L_chain_last_s
    v_smfmac_f32_16x16x64_bf16 v[48:51], v[16:19], v[128:135], v116
    v_smfmac_f32_16x16x64_bf16 v[48:51], v[20:23], v[160:167], v116
    v_smfmac_f32_16x16x64_bf16 v[48:51], v[24:27], v[144:151], v116
    s_waitcnt lgkmcnt(0)
    s_barrier
    v_smfmac_f32_16x16x64_bf16 v[48:51], v[28:31], v[176:183], v116
    ds_read_b128 v[32:35], v121 offset:16384
    ds_read_b128 v[36:39], v121 offset:17408
    v_smfmac_f32_16x16x64_bf16 v[52:55], v[16:19], v[136:143], v116
    ds_read_b128 v[40:43], v121 offset:18432
    ds_read_b128 v[44:47], v121 offset:19456
    v_smfmac_f32_16x16x64_bf16 v[52:55], v[20:23], v[168:175], v116
    ds_read_b128 v[8:11], v124 offset:32768
    v_add_f32 v48, v48, v50
    v_smfmac_f32_16x16x64_bf16 v[52:55], v[24:27], v[152:159], v116
    ds_read_b128 v[12:15], v124 offset:33792
    v_add_f32 v49, v49, v51
    v_smfmac_f32_16x16x64_bf16 v[52:55], v[28:31], v[184:191], v116
    s_waitcnt lgkmcnt(5)
    v_cvt_pk_bf16_f32 v112, v48, v49
    v_mfma_f32_16x16x32_bf16 v[56:59], v[56:59], v[32:35], 0
    s_waitcnt lgkmcnt(4)
    v_mov_b32 v48, s50
    v_mov_b32 v49, s50
    v_mfma_f32_16x16x32_bf16 v[56:59], v[60:63], v[36:39], v[56:59]
    ds_read_b128 v[16:19], v124 offset:2048
    s_waitcnt lgkmcnt(4)
    v_mov_b32 v50, s50
    v_mov_b32 v51, s50
    v_mfma_f32_16x16x32_bf16 v[56:59], v[64:67], v[40:43], v[56:59]
    ds_read_b128 v[20:23], v124 offset:3072
    s_waitcnt lgkmcnt(4)
    v_add_f32 v52, v52, v54
    v_mfma_f32_16x16x32_bf16 v[56:59], v[68:71], v[44:47], v[56:59]
    ds_read_b128 v[24:27], v124 offset:4096
    v_add_f32 v53, v53, v55
    v_mfma_f32_16x16x32_bf16 v[60:63], v[72:75], v[32:35], 0
    ds_read_b128 v[28:31], v124 offset:5120
    v_cvt_pk_bf16_f32 v114, v52, v53
    v_mov_b32 v53, 0
    v_mfma_f32_16x16x32_bf16 v[60:63], v[76:79], v[36:39], v[60:63]
    v_exp_f32 v56, v56
    v_mfma_f32_16x16x32_bf16 v[60:63], v[80:83], v[40:43], v[60:63]
    v_exp_f32 v57, v57
    v_mfma_f32_16x16x32_bf16 v[60:63], v[84:87], v[44:47], v[60:63]
    v_exp_f32 v58, v58
    v_mfma_f32_16x16x32_bf16 v[64:67], v[32:35], v[32:35], 0
    v_exp_f32 v59, v59
    v_cvt_pk_bf16_f32 v68, v56, v57
    v_mfma_f32_16x16x32_bf16 v[64:67], v[36:39], v[36:39], v[64:67]
    v_exp_f32 v60, v60
    v_cvt_pk_bf16_f32 v69, v58, v59
    v_mfma_f32_16x16x32_bf16 v[64:67], v[40:43], v[40:43], v[64:67]
    v_exp_f32 v61, v61
    v_mfma_f32_16x16x32_bf16 v[64:67], v[44:47], v[44:47], v[64:67]
    v_exp_f32 v62, v62
    v_exp_f32 v63, v63
    v_cvt_pk_bf16_f32 v70, v60, v61
    v_cvt_pk_bf16_f32 v71, v62, v63
    s_nop 1
    v_mfma_f32_16x16x32_bf16 v[72:75], v[88:91], v[68:71], 0
    s_nop 0
    v_exp_f32 v64, v64
    v_mfma_f32_16x16x32_bf16 v[76:79], v[92:95], v[68:71], 0
    v_exp_f32 v65, v65
    v_mfma_f32_16x16x32_bf16 v[80:83], v[48:51], v[68:71], 0
    v_cvt_pk_bf16_f32 v52, v64, v65
    s_nop 1
    v_mfma_f32_16x16x16_bf16 v[72:75], v[112:113], v[52:53], v[72:75]
    ds_read_b128 v[32:35], v124 offset:6144
    v_mfma_f32_16x16x16_bf16 v[76:79], v[114:115], v[52:53], v[76:79]
    ds_read_b128 v[36:39], v124 offset:7168
    v_mfma_f32_16x16x16_bf16 v[80:83], v[48:49], v[52:53], v[80:83]
L_norm_66:
    s_mov_b64 vcc, s[36:37]
    v_mov_b32 v122, v122
    v_mov_b32 v122, v122
    v_mov_b32 v122, v122
    v_cndmask_b32_dpp v76, v72, v76, vcc quad_perm:[2,3,2,3] row_mask:0xf bank_mask:0xf
    v_cndmask_b32_dpp v77, v73, v77, vcc quad_perm:[2,3,2,3] row_mask:0xf bank_mask:0xf
    v_cndmask_b32_dpp v78, v74, v78, vcc quad_perm:[2,3,2,3] row_mask:0xf bank_mask:0xf
    v_cndmask_b32_dpp v79, v75, v79, vcc quad_perm:[2,3,2,3] row_mask:0xf bank_mask:0xf
    v_rcp_f32_dpp v84, v80 quad_perm:[2,3,2,3] row_mask:0xf bank_mask:0xf
    s_nop 0
    v_pk_mul_f32 v[76:77], v[76:77], v[84:85] op_sel_hi:[1,0]
    v_pk_mul_f32 v[78:79], v[78:79], v[84:85] op_sel_hi:[1,0]
    v_cvt_pk_bf16_f32 v72, v76, v77
    v_cvt_pk_bf16_f32 v73, v78, v79
    ds_write_b64 v122, v[72:73] offset:20992
    v_max_f32_dpp v86, v80, v84 quad_perm:[2,3,2,3] row_mask:0xf bank_mask:0xf
    v_mov_b32_dpp v60, v72 quad_perm:[0,1,0,1] row_mask:0xf bank_mask:0xf
    v_mov_b32_dpp v61, v73 quad_perm:[0,1,0,1] row_mask:0xf bank_mask:0xf
    v_cmp_lt_f32 vcc, s35, v86
    v_mov_b32_dpp v62, v72 quad_perm:[2,3,2,3] row_mask:0xf bank_mask:0xf
    v_mov_b32_dpp v63, v73 quad_perm:[2,3,2,3] row_mask:0xf bank_mask:0xf
    s_nop 1
    v_smfmac_f32_16x16x64_bf16 v[96:99], v[60:63], v[192:199], v116
    s_cbranch_vccnz L_smax_67
    v_smfmac_f32_16x16x64_bf16 v[100:103], v[60:63], v[224:231], v116
    s_waitcnt lgkmcnt(0)
    s_barrier
    ds_read_b128 v[92:95], v127 offset:20480
    ds_read_b128 v[80:83], v127 offset:22016
    ds_read_b128 v[84:87], v127 offset:21504
    v_smfmac_f32_16x16x64_bf16 v[104:107], v[60:63], v[0:7], v116
    ds_read_b128 v[40:43], v124 offset:34816
    v_smfmac_f32_16x16x64_bf16 v[108:111], v[60:63], v[8:15], v116
    ds_read_b128 v[56:59], v124 offset:36864
    s_waitcnt lgkmcnt(4)
    v_smfmac_f32_16x16x64_bf16 v[96:99], v[92:95], v[200:207], v116
    s_waitcnt lgkmcnt(3)
    v_smfmac_f32_16x16x64_bf16 v[96:99], v[80:83], v[208:215], v116
    ds_read_b128 v[44:47], v124 offset:35840
    s_waitcnt lgkmcnt(3)
    v_smfmac_f32_16x16x64_bf16 v[96:99], v[84:87], v[216:223], v116
    ds_read_b128 v[68:71], v124 offset:39936
    v_smfmac_f32_16x16x64_bf16 v[100:103], v[92:95], v[232:239], v116
    ds_read_b128 v[64:67], v124 offset:38912
    v_smfmac_f32_16x16x64_bf16 v[100:103], v[80:83], v[240:247], v116
    ds_read_b128 v[60:63], v124 offset:37888
    v_cvt_pk_bf16_f32 v72, v96, v98
    v_smfmac_f32_16x16x64_bf16 v[100:103], v[84:87], v[248:255], v116
    v_and_or_b32 v72, v72, -2, s33
    v_smfmac_f32_16x16x64_bf16 v[104:107], v[92:95], v[16:23], v116
    v_cvt_pk_bf16_f32 v74, v97, v99
    v_smfmac_f32_16x16x64_bf16 v[104:107], v[80:83], v[24:31], v116
    v_cvt_pk_bf16_f32 v73, v100, v102
    v_cvt_pk_bf16_f32 v75, v101, v103
    v_smfmac_f32_16x16x64_bf16 v[104:107], v[84:87], v[32:39], v116
    buffer_store_dwordx4 v[72:75], v118, s[8:11], s25 offen sc1
    s_waitcnt lgkmcnt(3)
    v_smfmac_f32_16x16x64_bf16 v[108:111], v[92:95], v[40:47], v116
    s_waitcnt lgkmcnt(0)
    v_smfmac_f32_16x16x64_bf16 v[108:111], v[80:83], v[56:63], v116
    v_cvt_pk_bf16_f32 v76, v104, v106
    v_smfmac_f32_16x16x64_bf16 v[108:111], v[84:87], v[64:71], v116
    v_and_or_b32 v76, v76, -2, s33
    v_cvt_pk_bf16_f32 v78, v105, v107
    v_mov_b32 v122, v122
    v_mov_b32 v122, v122
    v_mov_b32 v122, v122
    v_mov_b32 v122, v122
    v_mov_b32 v122, v122
    v_mov_b32 v122, v122
    v_cvt_pk_bf16_f32 v77, v108, v110
    v_cvt_pk_bf16_f32 v79, v109, v111
    buffer_store_dwordx4 v[76:79], v118, s[8:11], s26 offen sc1
    s_add_u32 s30, s30, 0x40000
    s_add_u32 s31, s31, 0x40000
    s_add_u32 s32, s32, 0x20000
    s_add_u32 s23, s24, 1024
    s_add_u32 s48, s23, 4096
    s_xor_b32 s25, s25, 0x40000
    s_xor_b32 s26, s26, 0x40000
    s_mov_b32 s35, 0x49800000
    s_add_u32 s22, s22, 1
    v_mov_b32 v32, 0
    v_mov_b32 v33, 0
    v_mov_b32 v34, 0
    v_mov_b32 v35, 0
    v_mov_b32 v36, 0
    v_mov_b32 v37, 0
    v_mov_b32 v38, 0
    v_mov_b32 v39, 0
    v_mov_b32 v40, 0
    v_mov_b32 v41, 0
    v_mov_b32 v42, 0
    v_mov_b32 v43, 0
    v_mov_b32 v44, 0
    v_mov_b32 v45, 0
    v_mov_b32 v46, 0
    v_mov_b32 v47, 0
    v_mov_b32 v48, 0
    v_mov_b32 v49, 0
    v_mov_b32 v50, 0
    v_mov_b32 v51, 0
    v_mov_b32 v52, 0
    v_mov_b32 v53, 0
    v_mov_b32 v54, 0
    v_mov_b32 v55, 0
    ds_read_b128 v[80:83], v123
    ds_read_b128 v[84:87], v123 offset:1024
    ds_read_b128 v[56:59], v123 offset:2048
    ds_read_b128 v[60:63], v123 offset:3072
    ds_read_b128 v[64:67], v123 offset:32768
    ds_read_b128 v[68:71], v123 offset:33792
    ds_read_b128 v[72:75], v123 offset:34816
    ds_read_b128 v[76:79], v123 offset:35840
    ds_read_b128 v[88:91], v123 offset:4096
    ds_read_b128 v[92:95], v123 offset:5120
    ds_read_b128 v[96:99], v123 offset:6144
    ds_read_b128 v[100:103], v123 offset:7168
    ds_read_b128 v[104:107], v123 offset:36864
    ds_read_b128 v[108:111], v123 offset:37888
    ds_read_b128 v[24:27], v123 offset:38912
    ds_read_b128 v[28:31], v123 offset:39936
    s_add_u32 s24, s24, 8192
    s_bitset0_b32 s24, 15
    s_xor_b32 s55, s24, 16384
    s_xor_b32 s29, s29, 0x40000
    s_xor_b32 s53, s29, 1024
    s_bfe_u32 s33, s22, 0x10001
    s_add_u32 s40, s22, 5
    s_lshr_b32 s40, s40, 2
    s_min_u32 s40, s40, 16
    s_bfm_b32 s58, s40, 0
    s_waitcnt vmcnt(4)
    v_cmp_eq_u32 vcc, 0, v125
    s_nop 0
    s_and_b64 vcc, vcc, s[58:59]
    s_cbranch_scc1 L_kvw_68
L_kvb_69:
    v_mov_b32 v15, 0
    s_nop 2
    v_mov_b32 v15, 0
    s_nop 2
    v_mov_b32 v15, 0
    s_nop 2
    v_mov_b32 v15, 0
    s_nop 2
    v_mov_b32 v15, 0
    s_nop 2
    v_mov_b32 v15, 0
    s_nop 2
    v_mov_b32 v15, 0
    s_nop 2
    v_mov_b32 v15, 0
    s_nop 2
    v_mov_b32 v15, 0
    s_nop 2
    v_mov_b32 v15, 0
    s_nop 2
    v_mov_b32 v15, 0
    s_nop 2
    v_mov_b32 v15, 0
    s_nop 2
    v_mov_b32 v15, 0
    s_nop 2
    v_mov_b32 v15, 0
    s_nop 2
    v_mov_b32 v15, 0
    s_nop 2
    v_mov_b32 v15, 0
    s_nop 2
    v_mov_b32 v15, 0
    s_nop 2
    v_mov_b32 v15, 0
    s_nop 2
    v_mov_b32 v15, 0
    s_nop 2
    v_mov_b32 v15, 0
    s_nop 2
    v_mov_b32 v15, 0
    s_nop 2
    v_mov_b32 v15, 0
    s_nop 2
    v_mov_b32 v15, 0
    s_nop 2
    v_mov_b32 v15, 0
    s_nop 2
    v_mov_b32 v15, 0
    s_nop 2
    v_mov_b32 v15, 0
    s_nop 2
    v_mov_b32 v15, 0
    s_nop 2
    v_mov_b32 v15, 0
    s_nop 2
    v_mov_b32 v15, 0
    s_nop 2
    v_mov_b32 v15, 0
    s_nop 2
    v_mov_b32 v15, 0
    s_nop 2
    s_waitcnt lgkmcnt(0)
    s_branch L_chain_top1_s
.p2align 6
L_chain_top2_s:
    buffer_load_dwordx4 v[0:3], v117, s[8:11], s23 offen sc1
    v_mov_b32 v48, 0
    v_mov_b32 v49, 0
    v_mov_b32 v50, 0
    v_mov_b32 v51, 0
    v_mov_b32 v52, 0
    v_mov_b32 v53, 0
    v_mov_b32 v15, 0
    v_mov_b32 v15, 0
    v_mov_b32 v15, 0
    v_mov_b32 v15, 0
    v_mov_b32 v15, 0
    v_mov_b32 v15, 0
    v_mov_b32 v15, 0
    v_mov_b32 v15, 0
    v_mov_b32 v15, 0
    v_mov_b32 v15, 0
    buffer_load_dwordx4 v[0:3], v117, s[8:11], s23 offen sc1
    v_mov_b32 v15, 0
    v_mov_b32 v15, 0
    v_mov_b32 v15, 0
    v_mov_b32 v15, 0
    v_mov_b32 v15, 0
    v_mov_b32 v15, 0
    v_mov_b32 v15, 0
    v_mov_b32 v15, 0
    v_mov_b32 v15, 0
    v_mov_b32 v15, 0
    v_mov_b32 v15, 0
    v_mov_b32 v15, 0
    v_mov_b32 v15, 0
    v_mov_b32 v15, 0
    v_mov_b32 v15, 0
    v_mov_b32 v15, 0
L_mret_70:
    buffer_load_dwordx4 v[0:3], v117, s[8:11], s23 offen sc1
    s_add_u32 s45, s45, 1
    s_cmp_lt_u32 s45, 0x10000
    s_cselect_b32 s56, -2, -1
    s_nop 3
    v_mov_b32 v32, 0
    v_mov_b32 v33, 0
    v_mov_b32 v34, 0
    v_mov_b32 v35, 0
    s_waitcnt vmcnt(2)
    v_max3_u32 v15, v0, v1, v2
    v_max_u32 v15, v15, v3
    v_cmp_lt_u32 vcc, s56, v15
    v_smfmac_f32_16x16x64_bf16 v[32:35], v[0:3], v[80:87], v116
    s_cbranch_vccnz L_mret_70
    ds_write_b128 v117, v[0:3] offset:2048
    v_smfmac_f32_16x16x64_bf16 v[36:39], v[0:3], v[56:63], v116
    buffer_load_dwordx4 v[4:7], v117, s[8:11], s48 offen sc1
    v_smfmac_f32_16x16x64_bf16 v[40:43], v[0:3], v[64:71], v116
    buffer_load_dwordx4 v117, s[8:11], s48 offen sc1 lds
    s_mov_b32 m0, 12288
    v_smfmac_f32_16x16x64_bf16 v[44:47], v[0:3], v[72:79], v116
    s_waitcnt lgkmcnt(0)
    s_barrier
    ds_read_b128 v[8:11], v117 offset:3072
    v_smfmac_f32_16x16x64_bf16 v[48:51], v[0:3], a[192:199], v116
    ds_read_b128 v[16:19], v117
    ds_read_b128 v[20:23], v117 offset:1024
    v_smfmac_f32_16x16x64_bf16 v[52:55], v[0:3], a[200:207], v116
    ds_read_b128 v[80:83], v117 offset:14336
    s_waitcnt lgkmcnt(3)
    v_smfmac_f32_16x16x64_bf16 v[32:35], v[8:11], a[0:7], v116
    ds_read_b128 v[84:87], v117 offset:15360
    v_smfmac_f32_16x16x64_bf16 v[36:39], v[8:11], a[8:15], v116
    ds_read_b128 v[56:59], v117 offset:8192
    s_waitcnt lgkmcnt(4)
    v_smfmac_f32_16x16x64_bf16 v[32:35], v[16:19], a[32:39], v116
    ds_read_b128 v[60:63], v117 offset:9216
    v_smfmac_f32_16x16x64_bf16 v[36:39], v[16:19], a[40:47], v116
    ds_read_b128 v[64:67], v117 offset:10240
    s_waitcnt lgkmcnt(5)
    v_smfmac_f32_16x16x64_bf16 v[32:35], v[20:23], a[64:71], v116
    ds_read_b128 v[68:71], v117 offset:11264
    v_smfmac_f32_16x16x64_bf16 v[36:39], v[20:23], a[72:79], v116
    buffer_store_dwordx4 v[112:115], v117, s[8:11], s32 offen sc1
    v_smfmac_f32_16x16x64_bf16 v[40:43], v[8:11], a[96:103], v116
    ds_read_b128 v[72:75], v117 offset:12288
    v_smfmac_f32_16x16x64_bf16 v[40:43], v[16:19], a[128:135], v116
    ds_read_b128 v[76:79], v117 offset:13312
    v_smfmac_f32_16x16x64_bf16 v[40:43], v[20:23], a[160:167], v116
    s_waitcnt vmcnt(2)
    v_max3_u32 v15, v4, v5, v6
    v_smfmac_f32_16x16x64_bf16 v[44:47], v[8:11], a[104:111], v116
    v_max_u32 v15, v15, v7
    v_smfmac_f32_16x16x64_bf16 v[44:47], v[16:19], a[136:143], v116
    s_waitcnt vmcnt(1) lgkmcnt(0)
    v_cmp_lt_u32 vcc, s56, v15
    v_smfmac_f32_16x16x64_bf16 v[44:47], v[20:23], a[168:175], v116
    s_cbranch_vccnz L_mret_71
L_mgo_72:
    v_smfmac_f32_16x16x64_bf16 v[44:47], v[4:7], v[24:31], v116
    s_barrier
    ds_read_b128 v[12:15], v117 offset:7168
    v_smfmac_f32_16x16x64_bf16 v[32:35], v[4:7], v[88:95], v116
    ds_read_b128 v[24:27], v117 offset:4096
    v_smfmac_f32_16x16x64_bf16 v[36:39], v[4:7], v[96:103], v116
    ds_read_b128 v[28:31], v117 offset:5120
    v_smfmac_f32_16x16x64_bf16 v[40:43], v[4:7], v[104:111], v116
    ds_read_b128 v[88:91], v117 offset:28672
    s_waitcnt lgkmcnt(3)
    v_smfmac_f32_16x16x64_bf16 v[32:35], v[12:15], a[16:23], v116
    ds_read_b128 v[92:95], v117 offset:29696
    s_waitcnt lgkmcnt(3)
    v_smfmac_f32_16x16x64_bf16 v[32:35], v[24:27], a[48:55], v116
    buffer_load_dwordx4 v117, s[8:11], s30 offen lds
    s_waitcnt lgkmcnt(2)
    v_smfmac_f32_16x16x64_bf16 v[32:35], v[28:31], a[80:87], v116
    ds_read_b128 v[96:99], v117 offset:23552
    v_smfmac_f32_16x16x64_bf16 v[36:39], v[12:15], a[24:31], v116
    ds_read_b128 v[100:103], v117 offset:23552
    v_smfmac_f32_16x16x64_bf16 v[36:39], v[24:27], a[56:63], v116
    buffer_load_dwordx4 v117, s[8:11], s30 offen offset:1024 lds
    s_add_u32 m0, s52, 0x6000
    v_add_f32 v32, v32, v34
    v_smfmac_f32_16x16x64_bf16 v[36:39], v[28:31], a[88:95], v116
    ds_read_b128 v[104:107], v117 offset:23552
    v_add_f32 v33, v33, v35
    v_smfmac_f32_16x16x64_bf16 v[40:43], v[12:15], a[112:119], v116
    ds_read_b128 v[108:111], v117 offset:23552
    v_mul_f32 v32, s34, v32
    v_smfmac_f32_16x16x64_bf16 v[40:43], v[24:27], a[144:151], v116
    s_waitcnt lgkmcnt(4)
    buffer_load_dwordx4 v117, s[8:11], s31 offen lds
    v_mul_f32 v33, s34, v33
    v_smfmac_f32_16x16x64_bf16 v[40:43], v[28:31], a[176:183], v116
    ds_read_b128 v[0:3], v124
    v_add_f32 v36, v36, v38
    v_smfmac_f32_16x16x64_bf16 v[48:51], v[4:7], a[208:215], v116
    v_add_f32 v37, v37, v39
    v_smfmac_f32_16x16x64_bf16 v[52:55], v[4:7], a[216:223], v116
    buffer_load_dwordx4 v117, s[8:11], s31 offen offset:1024 lds
    s_mov_b32 m0, 6144
    v_mul_f32 v36, s34, v36
    v_smfmac_f32_16x16x64_bf16 v[44:47], v[12:15], a[120:127], v116
    ds_read_b128 v[4:7], v124 offset:1024
    v_mul_f32 v37, s34, v37
    v_smfmac_f32_16x16x64_bf16 v[44:47], v[24:27], a[152:159], v116
    v_cvt_pk_bf16_f32 v34, v32, v36
    v_smfmac_f32_16x16x64_bf16 v[44:47], v[28:31], a[184:191], v116
    v_cvt_pk_bf16_f32 v35, v33, v37
    v_add_f32 v40, v40, v42
    v_smfmac_f32_16x16x64_bf16 v[48:51], v[8:11], a[224:231], v116
    ds_write2_b32 v120, v34, v35 offset0:32 offset1:48
    v_add_f32 v41, v41, v43
    v_smfmac_f32_16x16x64_bf16 v[52:55], v[8:11], a[232:239], v116
    v_add_f32 v44, v44, v46
    v_add_f32 v45, v45, v47
    v_cvt_pk_bf16_f32 v113, v40, v44
    v_cvt_pk_bf16_f32 v115, v41, v45
    v_smfmac_f32_16x16x64_bf16 v[48:51], v[12:15], a[240:247], v116
    ds_write2_b32 v120, v113, v115 offset0:0 offset1:16
    v_smfmac_f32_16x16x64_bf16 v[52:55], v[12:15], a[248:255], v116
    s_cmp_eq_u32 s22, 63
    s_cbranch_scc1 L_chain_last_s
    v_smfmac_f32_16x16x64_bf16 v[48:51], v[16:19], v[128:135], v116
    buffer_store_dword v126, v119, s[8:11], s55 offen sc1
    v_smfmac_f32_16x16x64_bf16 v[48:51], v[20:23], v[160:167], v116
    v_smfmac_f32_16x16x64_bf16 v[48:51], v[24:27], v[144:151], v116
    s_waitcnt lgkmcnt(0)
    s_barrier
    v_smfmac_f32_16x16x64_bf16 v[48:51], v[28:31], v[176:183], v116
    ds_read_b128 v[32:35], v121 offset:16384
    ds_read_b128 v[36:39], v121 offset:17408
    v_smfmac_f32_16x16x64_bf16 v[52:55], v[16:19], v[136:143], v116
    ds_read_b128 v[40:43], v121 offset:18432
    ds_read_b128 v[44:47], v121 offset:19456
    v_smfmac_f32_16x16x64_bf16 v[52:55], v[20:23], v[168:175], v116
    ds_read_b128 v[8:11], v124 offset:32768
    v_add_f32 v48, v48, v50
    v_smfmac_f32_16x16x64_bf16 v[52:55], v[24:27], v[152:159], v116
    ds_read_b128 v[12:15], v124 offset:33792
    v_add_f32 v49, v49, v51
    v_smfmac_f32_16x16x64_bf16 v[52:55], v[28:31], v[184:191], v116
    s_waitcnt lgkmcnt(5)
    v_cvt_pk_bf16_f32 v112, v48, v49
    v_mfma_f32_16x16x32_bf16 v[56:59], v[56:59], v[32:35], 0
    s_waitcnt lgkmcnt(4)
    v_mov_b32 v48, s50
    v_mov_b32 v49, s50
    v_mfma_f32_16x16x32_bf16 v[56:59], v[60:63], v[36:39], v[56:59]
    ds_read_b128 v[16:19], v124 offset:2048
    s_waitcnt lgkmcnt(4)
    v_mov_b32 v50, s50
    v_mov_b32 v51, s50
    v_mfma_f32_16x16x32_bf16 v[56:59], v[64:67], v[40:43], v[56:59]
    ds_read_b128 v[20:23], v124 offset:3072
    s_waitcnt lgkmcnt(4)
    v_add_f32 v52, v52, v54
    v_mfma_f32_16x16x32_bf16 v[56:59], v[68:71], v[44:47], v[56:59]
    ds_read_b128 v[24:27], v124 offset:4096
    v_add_f32 v53, v53, v55
    v_mfma_f32_16x16x32_bf16 v[60:63], v[72:75], v[32:35], 0
    ds_read_b128 v[28:31], v124 offset:5120
    v_cvt_pk_bf16_f32 v114, v52, v53
    v_mov_b32 v53, 0
    v_mfma_f32_16x16x32_bf16 v[60:63], v[76:79], v[36:39], v[60:63]
    v_exp_f32 v56, v56
    v_mfma_f32_16x16x32_bf16 v[60:63], v[80:83], v[40:43], v[60:63]
    v_exp_f32 v57, v57
    v_mfma_f32_16x16x32_bf16 v[60:63], v[84:87], v[44:47], v[60:63]
    v_exp_f32 v58, v58
    v_mfma_f32_16x16x32_bf16 v[64:67], v[32:35], v[32:35], 0
    v_exp_f32 v59, v59
    v_cvt_pk_bf16_f32 v68, v56, v57
    v_mfma_f32_16x16x32_bf16 v[64:67], v[36:39], v[36:39], v[64:67]
    v_exp_f32 v60, v60
    v_cvt_pk_bf16_f32 v69, v58, v59
    v_mfma_f32_16x16x32_bf16 v[64:67], v[40:43], v[40:43], v[64:67]
    v_exp_f32 v61, v61
    v_mfma_f32_16x16x32_bf16 v[64:67], v[44:47], v[44:47], v[64:67]
    v_exp_f32 v62, v62
    v_exp_f32 v63, v63
    v_cvt_pk_bf16_f32 v70, v60, v61
    v_cvt_pk_bf16_f32 v71, v62, v63
    s_nop 1
    v_mfma_f32_16x16x32_bf16 v[72:75], v[88:91], v[68:71], 0
    s_nop 0
    v_exp_f32 v64, v64
    v_mfma_f32_16x16x32_bf16 v[76:79], v[92:95], v[68:71], 0
    v_exp_f32 v65, v65
    v_mfma_f32_16x16x32_bf16 v[80:83], v[48:51], v[68:71], 0
    v_cvt_pk_bf16_f32 v52, v64, v65
    s_nop 1
    v_mfma_f32_16x16x16_bf16 v[72:75], v[112:113], v[52:53], v[72:75]
    ds_read_b128 v[32:35], v124 offset:6144
    v_mfma_f32_16x16x16_bf16 v[76:79], v[114:115], v[52:53], v[76:79]
    ds_read_b128 v[36:39], v124 offset:7168
    v_mfma_f32_16x16x16_bf16 v[80:83], v[48:49], v[52:53], v[80:83]
L_norm_73:
    s_mov_b64 vcc, s[36:37]
    v_mov_b32 v122, v122
    v_mov_b32 v122, v122
    v_mov_b32 v122, v122
    v_cndmask_b32_dpp v76, v72, v76, vcc quad_perm:[2,3,2,3] row_mask:0xf bank_mask:0xf
    v_cndmask_b32_dpp v77, v73, v77, vcc quad_perm:[2,3,2,3] row_mask:0xf bank_mask:0xf
    v_cndmask_b32_dpp v78, v74, v78, vcc quad_perm:[2,3,2,3] row_mask:0xf bank_mask:0xf
    v_cndmask_b32_dpp v79, v75, v79, vcc quad_perm:[2,3,2,3] row_mask:0xf bank_mask:0xf
    v_rcp_f32_dpp v84, v80 quad_perm:[2,3,2,3] row_mask:0xf bank_mask:0xf
    s_nop 0
    v_pk_mul_f32 v[76:77], v[76:77], v[84:85] op_sel_hi:[1,0]
    v_pk_mul_f32 v[78:79], v[78:79], v[84:85] op_sel_hi:[1,0]
    v_cvt_pk_bf16_f32 v72, v76, v77
    v_cvt_pk_bf16_f32 v73, v78, v79
    ds_write_b64 v122, v[72:73] offset:21504
    v_max_f32_dpp v86, v80, v84 quad_perm:[2,3,2,3] row_mask:0xf bank_mask:0xf
    v_mov_b32_dpp v60, v72 quad_perm:[0,1,0,1] row_mask:0xf bank_mask:0xf
    v_mov_b32_dpp v61, v73 quad_perm:[0,1,0,1] row_mask:0xf bank_mask:0xf
    v_cmp_lt_f32 vcc, s35, v86
    v_mov_b32_dpp v62, v72 quad_perm:[2,3,2,3] row_mask:0xf bank_mask:0xf
    v_mov_b32_dpp v63, v73 quad_perm:[2,3,2,3] row_mask:0xf bank_mask:0xf
    s_nop 1
    v_smfmac_f32_16x16x64_bf16 v[96:99], v[60:63], v[192:199], v116
    s_cbranch_vccnz L_smax_74
    v_smfmac_f32_16x16x64_bf16 v[100:103], v[60:63], v[224:231], v116
    s_waitcnt lgkmcnt(0)
    s_barrier
    ds_read_b128 v[92:95], v127 offset:22016
    ds_read_b128 v[80:83], v127 offset:20480
    ds_read_b128 v[84:87], v127 offset:20992
    v_smfmac_f32_16x16x64_bf16 v[104:107], v[60:63], v[0:7], v116
    ds_read_b128 v[40:43], v124 offset:34816
    v_smfmac_f32_16x16x64_bf16 v[108:111], v[60:63], v[8:15], v116
    ds_read_b128 v[56:59], v124 offset:36864
    s_waitcnt lgkmcnt(4)
    v_smfmac_f32_16x16x64_bf16 v[96:99], v[92:95], v[200:207], v116
    s_waitcnt lgkmcnt(3)
    v_smfmac_f32_16x16x64_bf16 v[96:99], v[80:83], v[208:215], v116
    ds_read_b128 v[44:47], v124 offset:35840
    s_waitcnt lgkmcnt(3)
    v_smfmac_f32_16x16x64_bf16 v[96:99], v[84:87], v[216:223], v116
    ds_read_b128 v[68:71], v124 offset:39936
    v_smfmac_f32_16x16x64_bf16 v[100:103], v[92:95], v[232:239], v116
    ds_read_b128 v[64:67], v124 offset:38912
    v_smfmac_f32_16x16x64_bf16 v[100:103], v[80:83], v[240:247], v116
    ds_read_b128 v[60:63], v124 offset:37888
    v_cvt_pk_bf16_f32 v72, v96, v98
    v_smfmac_f32_16x16x64_bf16 v[100:103], v[84:87], v[248:255], v116
    v_and_or_b32 v72, v72, -2, s33
    v_smfmac_f32_16x16x64_bf16 v[104:107], v[92:95], v[16:23], v116
    v_cvt_pk_bf16_f32 v74, v97, v99
    v_smfmac_f32_16x16x64_bf16 v[104:107], v[80:83], v[24:31], v116
    v_cvt_pk_bf16_f32 v73, v100, v102
    v_cvt_pk_bf16_f32 v75, v101, v103
    v_smfmac_f32_16x16x64_bf16 v[104:107], v[84:87], v[32:39], v116
    buffer_store_dwordx4 v[72:75], v118, s[8:11], s25 offen sc1
    s_waitcnt lgkmcnt(3)
    v_smfmac_f32_16x16x64_bf16 v[108:111], v[92:95], v[40:47], v116
    s_waitcnt lgkmcnt(0)
    v_smfmac_f32_16x16x64_bf16 v[108:111], v[80:83], v[56:63], v116
    v_cvt_pk_bf16_f32 v76, v104, v106
    v_smfmac_f32_16x16x64_bf16 v[108:111], v[84:87], v[64:71], v116
    v_and_or_b32 v76, v76, -2, s33
    v_cvt_pk_bf16_f32 v78, v105, v107
    v_mov_b32 v122, v122
    v_mov_b32 v122, v122
    v_mov_b32 v122, v122
    v_mov_b32 v122, v122
    v_mov_b32 v122, v122
    v_mov_b32 v122, v122
    v_cvt_pk_bf16_f32 v77, v108, v110
    v_cvt_pk_bf16_f32 v79, v109, v111
    buffer_store_dwordx4 v[76:79], v118, s[8:11], s26 offen sc1
    ds_read_b128 v[80:83], v123
    ds_read_b128 v[84:87], v123 offset:1024
    ds_read_b128 v[56:59], v123 offset:2048
    ds_read_b128 v[60:63], v123 offset:3072
    ds_read_b128 v[64:67], v123 offset:32768
    ds_read_b128 v[68:71], v123 offset:33792
    ds_read_b128 v[72:75], v123 offset:34816
    ds_read_b128 v[76:79], v123 offset:35840
    ds_read_b128 v[88:91], v123 offset:4096
    ds_read_b128 v[92:95], v123 offset:5120
    ds_read_b128 v[96:99], v123 offset:6144
    ds_read_b128 v[100:103], v123 offset:7168
    ds_read_b128 v[104:107], v123 offset:36864
    ds_read_b128 v[108:111], v123 offset:37888
    ds_read_b128 v[24:27], v123 offset:38912
    ds_read_b128 v[28:31], v123 offset:39936
    s_add_u32 s30, s30, 0x40000
    s_add_u32 s31, s31, 0x40000
    s_add_u32 s32, s32, 0x20000
    s_add_u32 s23, s24, 2048
    s_add_u32 s48, s23, 4096
    s_xor_b32 s25, s25, 0x40000
    s_xor_b32 s26, s26, 0x40000
    s_mov_b32 s35, 0x49800000
    s_add_u32 s22, s22, 1
    v_cndmask_b32 v12, 0, v125, s[68:69]
    v_cndmask_b32 v13, 0, v125, s[70:71]
    v_cndmask_b32 v14, 0, v125, s[72:73]
    v_cndmask_b32 v15, 0, v125, s[74:75]
    v_mov_b32 v32, 0
    v_mov_b32 v33, 0
    v_mov_b32 v34, 0
    v_mov_b32 v35, 0
    v_mov_b32 v36, 0
    v_mov_b32 v37, 0
    v_mov_b32 v38, 0
    v_mov_b32 v39, 0
    v_mov_b32 v40, 0
    v_mov_b32 v41, 0
    v_mov_b32 v42, 0
    v_mov_b32 v43, 0
    v_mov_b32 v44, 0
    v_mov_b32 v45, 0
    v_mov_b32 v46, 0
    v_mov_b32 v47, 0
    v_mov_b32 v54, 0
    v_mov_b32 v55, 0
    v_mov_b32 v52, 0
    v_mov_b32 v52, 0
    v_mov_b32 v52, 0
    v_mov_b32 v52, 0
    v_mov_b32 v52, 0
    v_mov_b32 v52, 0
    v_mov_b32 v52, 0
    v_mov_b32 v52, 0
    v_mov_b32 v52, 0
    v_mov_b32 v52, 0
    v_mov_b32 v52, 0
    v_mov_b32 v52, 0
    v_mov_b32 v52, 0
    buffer_load_dwordx4 v[4:7], v117, s[8:11], s29 offen sc1
    buffer_load_dwordx4 v[8:11], v117, s[8:11], s53 offen sc1
    buffer_load_dwordx4 v[16:19], v117, s[8:11], s29 offen offset:2048 sc1
    buffer_load_dwordx4 v[20:23], v117, s[8:11], s53 offen offset:2048 sc1
    v_mov_b32 v52, 0
    s_waitcnt vmcnt(3)
L_rl_75:
    v_mfma_f32_16x16x32_bf16 v[48:51], v[4:7], v[12:15], 0
    v_xor_b32 v52, s33, v4
    s_waitcnt vmcnt(2)
    v_mfma_f32_16x16x32_bf16 v[48:51], v[8:11], v[12:15], v[48:51]
    v_xor_b32 v53, s33, v8
    v_or_b32 v52, v52, v53
    s_waitcnt vmcnt(1)
    v_mfma_f32_16x16x32_bf16 v[48:51], v[16:19], v[12:15], v[48:51]
    v_xor_b32 v53, s33, v16
    v_or_b32 v52, v52, v53
    s_waitcnt vmcnt(0)
    v_mfma_f32_16x16x32_bf16 v[48:51], v[20:23], v[12:15], v[48:51]
    v_xor_b32 v53, s33, v20
    v_or_b32 v52, v52, v53
    v_and_b32 v52, 1, v52
    v_cmp_ne_u32 vcc, 0, v52
    s_cbranch_vccnz L_rslow_76
L_rgo_77:
    s_nop 2
    v_permlane32_swap_b32 v48, v50
    v_permlane32_swap_b32 v49, v51
    v_pk_add_f32 v[48:49], v[48:49], v[50:51]
    s_mov_b64 exec, s[38:39]
    v_cvt_pk_bf16_f32 v12, v48, v49
    v_min_u32 v12, 0xfffffffe, v12
    buffer_store_dword v12, v119, s[8:11], s24 offen sc1
    s_mov_b64 exec, -1
    s_add_u32 s24, s24, 8192
    s_bitset0_b32 s24, 15
    s_xor_b32 s55, s24, 16384
    s_xor_b32 s29, s29, 0x40000
    s_xor_b32 s53, s29, 1024
    s_bfe_u32 s33, s22, 0x10001
    s_waitcnt lgkmcnt(0)
    s_branch L_chain_top2_s
.p2align 6
L_chain_top3_s:
    buffer_load_dwordx4 v[0:3], v117, s[8:11], s23 offen sc1
    v_mov_b32 v48, 0
    v_mov_b32 v49, 0
    v_mov_b32 v50, 0
    v_mov_b32 v51, 0
    v_mov_b32 v52, 0
    v_mov_b32 v53, 0
    v_mov_b32 v15, 0
    v_mov_b32 v15, 0
    v_mov_b32 v15, 0
    v_mov_b32 v15, 0
    v_mov_b32 v15, 0
    v_mov_b32 v15, 0
    v_mov_b32 v15, 0
    v_mov_b32 v15, 0
    v_mov_b32 v15, 0
    v_mov_b32 v15, 0
    buffer_load_dwordx4 v[0:3], v117, s[8:11], s23 offen sc1
    v_mov_b32 v15, 0
    v_mov_b32 v15, 0
    v_mov_b32 v15, 0
    v_mov_b32 v15, 0
    v_mov_b32 v15, 0
    v_mov_b32 v15, 0
    v_mov_b32 v15, 0
    v_mov_b32 v15, 0
    v_mov_b32 v15, 0
    v_mov_b32 v15, 0
    v_mov_b32 v15, 0
    v_mov_b32 v15, 0
    v_mov_b32 v15, 0
    v_mov_b32 v15, 0
    v_mov_b32 v15, 0
    v_mov_b32 v15, 0
L_mret_78:
    buffer_load_dwordx4 v[0:3], v117, s[8:11], s23 offen sc1
    s_add_u32 s45, s45, 1
    s_cmp_lt_u32 s45, 0x10000
    s_cselect_b32 s56, -2, -1
    s_nop 3
    v_mov_b32 v32, 0
    v_mov_b32 v33, 0
    v_mov_b32 v34, 0
    v_mov_b32 v35, 0
    s_waitcnt vmcnt(2)
    v_max3_u32 v15, v0, v1, v2
    v_max_u32 v15, v15, v3
    v_cmp_lt_u32 vcc, s56, v15
    v_smfmac_f32_16x16x64_bf16 v[32:35], v[0:3], v[80:87], v116
    s_cbranch_vccnz L_mret_78
    ds_write_b128 v117, v[0:3] offset:3072
    v_smfmac_f32_16x16x64_bf16 v[36:39], v[0:3], v[56:63], v116
    buffer_load_dwordx4 v[4:7], v117, s[8:11], s48 offen sc1
    v_smfmac_f32_16x16x64_bf16 v[40:43], v[0:3], v[64:71], v116
    buffer_load_dwordx4 v117, s[8:11], s48 offen sc1 lds
    s_mov_b32 m0, 14336
    v_smfmac_f32_16x16x64_bf16 v[44:47], v[0:3], v[72:79], v116
    s_waitcnt lgkmcnt(0)
    s_barrier
    ds_read_b128 v[8:11], v117 offset:2048
    v_smfmac_f32_16x16x64_bf16 v[48:51], v[0:3], a[192:199], v116
    ds_read_b128 v[16:19], v117 offset:1024
    ds_read_b128 v[20:23], v117
    v_smfmac_f32_16x16x64_bf16 v[52:55], v[0:3], a[200:207], v116
    ds_read_b128 v[80:83], v117 offset:14336
    s_waitcnt lgkmcnt(3)
    v_smfmac_f32_16x16x64_bf16 v[32:35], v[8:11], a[0:7], v116
    ds_read_b128 v[84:87], v117 offset:15360
    v_smfmac_f32_16x16x64_bf16 v[36:39], v[8:11], a[8:15], v116
    ds_read_b128 v[56:59], v117 offset:8192
    s_waitcnt lgkmcnt(4)
    v_smfmac_f32_16x16x64_bf16 v[32:35], v[16:19], a[32:39], v116
    ds_read_b128 v[60:63], v117 offset:9216
    v_smfmac_f32_16x16x64_bf16 v[36:39], v[16:19], a[40:47], v116
    ds_read_b128 v[64:67], v117 offset:10240
    s_waitcnt lgkmcnt(5)
    v_smfmac_f32_16x16x64_bf16 v[32:35], v[20:23], a[64:71], v116
    ds_read_b128 v[68:71], v117 offset:11264
    v_smfmac_f32_16x16x64_bf16 v[36:39], v[20:23], a[72:79], v116
    ds_read_b128 v[72:75], v117 offset:12288
    v_smfmac_f32_16x16x64_bf16 v[40:43], v[8:11], a[96:103], v116
    ds_read_b128 v[76:79], v117 offset:13312
    v_smfmac_f32_16x16x64_bf16 v[40:43], v[16:19], a[128:135], v116
    buffer_store_dwordx4 v[112:115], v117, s[8:11], s32 offen sc1
    v_smfmac_f32_16x16x64_bf16 v[40:43], v[20:23], a[160:167], v116
    s_waitcnt vmcnt(2)
    v_max3_u32 v15, v4, v5, v6
    v_smfmac_f32_16x16x64_bf16 v[44:47], v[8:11], a[104:111], v116
    v_max_u32 v15, v15, v7
    v_smfmac_f32_16x16x64_bf16 v[44:47], v[16:19], a[136:143], v116
    s_waitcnt vmcnt(1) lgkmcnt(0)
    v_cmp_lt_u32 vcc, s56, v15
    v_smfmac_f32_16x16x64_bf16 v[44:47], v[20:23], a[168:175], v116
    s_cbranch_vccnz L_mret_79
L_mgo_80:
    v_smfmac_f32_16x16x64_bf16 v[44:47], v[4:7], v[24:31], v116
    s_barrier
    ds_read_b128 v[12:15], v117 offset:6144
    v_smfmac_f32_16x16x64_bf16 v[32:35], v[4:7], v[88:95], v116
    ds_read_b128 v[24:27], v117 offset:5120
    v_smfmac_f32_16x16x64_bf16 v[36:39], v[4:7], v[96:103], v116
    ds_read_b128 v[28:31], v117 offset:4096
    v_smfmac_f32_16x16x64_bf16 v[40:43], v[4:7], v[104:111], v116
    ds_read_b128 v[88:91], v117 offset:30720
    s_waitcnt lgkmcnt(3)
    v_smfmac_f32_16x16x64_bf16 v[32:35], v[12:15], a[16:23], v116
    ds_read_b128 v[92:95], v117 offset:31744
    s_waitcnt lgkmcnt(3)
    v_smfmac_f32_16x16x64_bf16 v[32:35], v[24:27], a[48:55], v116
    ds_read_b128 v[96:99], v117 offset:23552
    s_waitcnt lgkmcnt(3)
    v_smfmac_f32_16x16x64_bf16 v[32:35], v[28:31], a[80:87], v116
    buffer_load_dwordx4 v117, s[8:11], s30 offen lds
    v_smfmac_f32_16x16x64_bf16 v[36:39], v[12:15], a[24:31], v116
    ds_read_b128 v[100:103], v117 offset:23552
    v_smfmac_f32_16x16x64_bf16 v[36:39], v[24:27], a[56:63], v116
    ds_read_b128 v[104:107], v117 offset:23552
    v_add_f32 v32, v32, v34
    v_smfmac_f32_16x16x64_bf16 v[36:39], v[28:31], a[88:95], v116
    buffer_load_dwordx4 v117, s[8:11], s30 offen offset:1024 lds
    s_add_u32 m0, s52, 0x6000
    v_add_f32 v33, v33, v35
    v_smfmac_f32_16x16x64_bf16 v[40:43], v[12:15], a[112:119], v116
    ds_read_b128 v[108:111], v117 offset:23552
    v_mul_f32 v32, s34, v32
    v_smfmac_f32_16x16x64_bf16 v[40:43], v[24:27], a[144:151], v116
    ds_read_b128 v[0:3], v124
    v_mul_f32 v33, s34, v33
    v_smfmac_f32_16x16x64_bf16 v[40:43], v[28:31], a[176:183], v116
    s_waitcnt lgkmcnt(5)
    buffer_load_dwordx4 v117, s[8:11], s31 offen lds
    v_add_f32 v36, v36, v38
    v_smfmac_f32_16x16x64_bf16 v[48:51], v[4:7], a[208:215], v116
    v_add_f32 v37, v37, v39
    v_smfmac_f32_16x16x64_bf16 v[52:55], v[4:7], a[216:223], v116
    ds_read_b128 v[4:7], v124 offset:1024
    v_mul_f32 v36, s34, v36
    v_smfmac_f32_16x16x64_bf16 v[44:47], v[12:15], a[120:127], v116
    buffer_load_dwordx4 v117, s[8:11], s31 offen offset:1024 lds
    s_mov_b32 m0, 7168
    v_mul_f32 v37, s34, v37
    v_smfmac_f32_16x16x64_bf16 v[44:47], v[24:27], a[152:159], v116
    v_cvt_pk_bf16_f32 v34, v32, v36
    v_smfmac_f32_16x16x64_bf16 v[44:47], v[28:31], a[184:191], v116
    v_cvt_pk_bf16_f32 v35, v33, v37
    v_add_f32 v40, v40, v42
    v_smfmac_f32_16x16x64_bf16 v[48:51], v[8:11], a[224:231], v116
    ds_write2_b32 v120, v34, v35 offset0:32 offset1:48
    v_add_f32 v41, v41, v43
    v_smfmac_f32_16x16x64_bf16 v[52:55], v[8:11], a[232:239], v116
    v_add_f32 v44, v44, v46
    v_add_f32 v45, v45, v47
    v_cvt_pk_bf16_f32 v113, v40, v44
    v_cvt_pk_bf16_f32 v115, v41, v45
    v_smfmac_f32_16x16x64_bf16 v[48:51], v[12:15], a[240:247], v116
    ds_write2_b32 v120, v113, v115 offset0:0 offset1:16
    v_smfmac_f32_16x16x64_bf16 v[52:55], v[12:15], a[248:255], v116
    s_cmp_eq_u32 s22, 63
    s_cbranch_scc1 L_chain_last_s
    v_smfmac_f32_16x16x64_bf16 v[48:51], v[16:19], v[128:135], v116
    v_smfmac_f32_16x16x64_bf16 v[48:51], v[20:23], v[160:167], v116
    buffer_store_dword v126, v119, s[8:11], s55 offen sc1
    v_smfmac_f32_16x16x64_bf16 v[48:51], v[24:27], v[144:151], v116
    s_waitcnt lgkmcnt(0)
    s_barrier
    v_smfmac_f32_16x16x64_bf16 v[48:51], v[28:31], v[176:183], v116
    ds_read_b128 v[32:35], v121 offset:16384
    ds_read_b128 v[36:39], v121 offset:17408
    v_smfmac_f32_16x16x64_bf16 v[52:55], v[16:19], v[136:143], v116
    ds_read_b128 v[40:43], v121 offset:18432
    ds_read_b128 v[44:47], v121 offset:19456
    v_smfmac_f32_16x16x64_bf16 v[52:55], v[20:23], v[168:175], v116
    ds_read_b128 v[8:11], v124 offset:32768
    v_add_f32 v48, v48, v50
    v_smfmac_f32_16x16x64_bf16 v[52:55], v[24:27], v[152:159], v116
    ds_read_b128 v[12:15], v124 offset:33792
    v_add_f32 v49, v49, v51
    v_smfmac_f32_16x16x64_bf16 v[52:55], v[28:31], v[184:191], v116
    s_waitcnt lgkmcnt(5)
    v_cvt_pk_bf16_f32 v112, v48, v49
    v_mfma_f32_16x16x32_bf16 v[56:59], v[56:59], v[32:35], 0
    s_waitcnt lgkmcnt(4)
    v_mov_b32 v48, s50
    v_mov_b32 v49, s50
    v_mfma_f32_16x16x32_bf16 v[56:59], v[60:63], v[36:39], v[56:59]
    ds_read_b128 v[16:19], v124 offset:2048
    s_waitcnt lgkmcnt(4)
    v_mov_b32 v50, s50
    v_mov_b32 v51, s50
    v_mfma_f32_16x16x32_bf16 v[56:59], v[64:67], v[40:43], v[56:59]
    ds_read_b128 v[20:23], v124 offset:3072
    s_waitcnt lgkmcnt(4)
    v_add_f32 v52, v52, v54
    v_mfma_f32_16x16x32_bf16 v[56:59], v[68:71], v[44:47], v[56:59]
    ds_read_b128 v[24:27], v124 offset:4096
    v_add_f32 v53, v53, v55
    v_mfma_f32_16x16x32_bf16 v[60:63], v[72:75], v[32:35], 0
    ds_read_b128 v[28:31], v124 offset:5120
    v_cvt_pk_bf16_f32 v114, v52, v53
    v_mov_b32 v53, 0
    v_mfma_f32_16x16x32_bf16 v[60:63], v[76:79], v[36:39], v[60:63]
    v_exp_f32 v56, v56
    v_mfma_f32_16x16x32_bf16 v[60:63], v[80:83], v[40:43], v[60:63]
    v_exp_f32 v57, v57
    v_mfma_f32_16x16x32_bf16 v[60:63], v[84:87], v[44:47], v[60:63]
    v_exp_f32 v58, v58
    v_mfma_f32_16x16x32_bf16 v[64:67], v[32:35], v[32:35], 0
    v_exp_f32 v59, v59
    v_cvt_pk_bf16_f32 v68, v56, v57
    v_mfma_f32_16x16x32_bf16 v[64:67], v[36:39], v[36:39], v[64:67]
    v_exp_f32 v60, v60
    v_cvt_pk_bf16_f32 v69, v58, v59
    v_mfma_f32_16x16x32_bf16 v[64:67], v[40:43], v[40:43], v[64:67]
    v_exp_f32 v61, v61
    v_mfma_f32_16x16x32_bf16 v[64:67], v[44:47], v[44:47], v[64:67]
    v_exp_f32 v62, v62
    v_exp_f32 v63, v63
    v_cvt_pk_bf16_f32 v70, v60, v61
    v_cvt_pk_bf16_f32 v71, v62, v63
    s_nop 1
    v_mfma_f32_16x16x32_bf16 v[72:75], v[88:91], v[68:71], 0
    s_nop 0
    v_exp_f32 v64, v64
    v_mfma_f32_16x16x32_bf16 v[76:79], v[92:95], v[68:71], 0
    v_exp_f32 v65, v65
    v_mfma_f32_16x16x32_bf16 v[80:83], v[48:51], v[68:71], 0
    v_cvt_pk_bf16_f32 v52, v64, v65
    s_nop 1
    v_mfma_f32_16x16x16_bf16 v[72:75], v[112:113], v[52:53], v[72:75]
    ds_read_b128 v[32:35], v124 offset:6144
    v_mfma_f32_16x16x16_bf16 v[76:79], v[114:115], v[52:53], v[76:79]
    ds_read_b128 v[36:39], v124 offset:7168
    v_mfma_f32_16x16x16_bf16 v[80:83], v[48:49], v[52:53], v[80:83]
L_norm_81:
    s_mov_b64 vcc, s[36:37]
    v_mov_b32 v122, v122
    v_mov_b32 v122, v122
    v_mov_b32 v122, v122
    v_cndmask_b32_dpp v76, v72, v76, vcc quad_perm:[2,3,2,3] row_mask:0xf bank_mask:0xf
    v_cndmask_b32_dpp v77, v73, v77, vcc quad_perm:[2,3,2,3] row_mask:0xf bank_mask:0xf
    v_cndmask_b32_dpp v78, v74, v78, vcc quad_perm:[2,3,2,3] row_mask:0xf bank_mask:0xf
    v_cndmask_b32_dpp v79, v75, v79, vcc quad_perm:[2,3,2,3] row_mask:0xf bank_mask:0xf
    v_rcp_f32_dpp v84, v80 quad_perm:[2,3,2,3] row_mask:0xf bank_mask:0xf
    s_nop 0
    v_pk_mul_f32 v[76:77], v[76:77], v[84:85] op_sel_hi:[1,0]
    v_pk_mul_f32 v[78:79], v[78:79], v[84:85] op_sel_hi:[1,0]
    v_cvt_pk_bf16_f32 v72, v76, v77
    v_cvt_pk_bf16_f32 v73, v78, v79
    ds_write_b64 v122, v[72:73] offset:22016
    v_max_f32_dpp v86, v80, v84 quad_perm:[2,3,2,3] row_mask:0xf bank_mask:0xf
    v_mov_b32_dpp v60, v72 quad_perm:[0,1,0,1] row_mask:0xf bank_mask:0xf
    v_mov_b32_dpp v61, v73 quad_perm:[0,1,0,1] row_mask:0xf bank_mask:0xf
    v_cmp_lt_f32 vcc, s35, v86
    v_mov_b32_dpp v62, v72 quad_perm:[2,3,2,3] row_mask:0xf bank_mask:0xf
    v_mov_b32_dpp v63, v73 quad_perm:[2,3,2,3] row_mask:0xf bank_mask:0xf
    s_nop 1
    v_smfmac_f32_16x16x64_bf16 v[96:99], v[60:63], v[192:199], v116
    s_cbranch_vccnz L_smax_82
    v_smfmac_f32_16x16x64_bf16 v[100:103], v[60:63], v[224:231], v116
    s_waitcnt lgkmcnt(0)
    s_barrier
    ds_read_b128 v[92:95], v127 offset:21504
    ds_read_b128 v[80:83], v127 offset:20992
    ds_read_b128 v[84:87], v127 offset:20480
    v_smfmac_f32_16x16x64_bf16 v[104:107], v[60:63], v[0:7], v116
    ds_read_b128 v[40:43], v124 offset:34816
    v_smfmac_f32_16x16x64_bf16 v[108:111], v[60:63], v[8:15], v116
    ds_read_b128 v[56:59], v124 offset:36864
    s_waitcnt lgkmcnt(4)
    v_smfmac_f32_16x16x64_bf16 v[96:99], v[92:95], v[200:207], v116
    s_waitcnt lgkmcnt(3)
    v_smfmac_f32_16x16x64_bf16 v[96:99], v[80:83], v[208:215], v116
    ds_read_b128 v[44:47], v124 offset:35840
    s_waitcnt lgkmcnt(3)
    v_smfmac_f32_16x16x64_bf16 v[96:99], v[84:87], v[216:223], v116
    ds_read_b128 v[68:71], v124 offset:39936
    v_smfmac_f32_16x16x64_bf16 v[100:103], v[92:95], v[232:239], v116
    ds_read_b128 v[64:67], v124 offset:38912
    v_smfmac_f32_16x16x64_bf16 v[100:103], v[80:83], v[240:247], v116
    ds_read_b128 v[60:63], v124 offset:37888
    v_cvt_pk_bf16_f32 v72, v96, v98
    v_smfmac_f32_16x16x64_bf16 v[100:103], v[84:87], v[248:255], v116
    v_and_or_b32 v72, v72, -2, s33
    v_smfmac_f32_16x16x64_bf16 v[104:107], v[92:95], v[16:23], v116
    v_cvt_pk_bf16_f32 v74, v97, v99
    v_smfmac_f32_16x16x64_bf16 v[104:107], v[80:83], v[24:31], v116
    v_cvt_pk_bf16_f32 v73, v100, v102
    v_cvt_pk_bf16_f32 v75, v101, v103
    v_smfmac_f32_16x16x64_bf16 v[104:107], v[84:87], v[32:39], v116
    buffer_store_dwordx4 v[72:75], v118, s[8:11], s25 offen sc1
    s_waitcnt lgkmcnt(3)
    v_smfmac_f32_16x16x64_bf16 v[108:111], v[92:95], v[40:47], v116
    s_waitcnt lgkmcnt(0)
    v_smfmac_f32_16x16x64_bf16 v[108:111], v[80:83], v[56:63], v116
    v_cvt_pk_bf16_f32 v76, v104, v106
    v_smfmac_f32_16x16x64_bf16 v[108:111], v[84:87], v[64:71], v116
    v_and_or_b32 v76, v76, -2, s33
    v_cvt_pk_bf16_f32 v78, v105, v107
    v_mov_b32 v122, v122
    v_mov_b32 v122, v122
    v_mov_b32 v122, v122
    v_mov_b32 v122, v122
    v_mov_b32 v122, v122
    v_mov_b32 v122, v122
    v_cvt_pk_bf16_f32 v77, v108, v110
    v_cvt_pk_bf16_f32 v79, v109, v111
    buffer_store_dwordx4 v[76:79], v118, s[8:11], s26 offen sc1
    ds_read_b128 v[80:83], v123
    ds_read_b128 v[84:87], v123 offset:1024
    ds_read_b128 v[56:59], v123 offset:2048
    ds_read_b128 v[60:63], v123 offset:3072
    ds_read_b128 v[64:67], v123 offset:32768
    ds_read_b128 v[68:71], v123 offset:33792
    ds_read_b128 v[72:75], v123 offset:34816
    ds_read_b128 v[76:79], v123 offset:35840
    ds_read_b128 v[88:91], v123 offset:4096
    ds_read_b128 v[92:95], v123 offset:5120
    ds_read_b128 v[96:99], v123 offset:6144
    ds_read_b128 v[100:103], v123 offset:7168
    ds_read_b128 v[104:107], v123 offset:36864
    ds_read_b128 v[108:111], v123 offset:37888
    ds_read_b128 v[24:27], v123 offset:38912
    ds_read_b128 v[28:31], v123 offset:39936
    s_add_u32 s30, s30, 0x40000
    s_add_u32 s31, s31, 0x40000
    s_add_u32 s32, s32, 0x20000
    s_add_u32 s23, s24, 3072
    s_add_u32 s48, s23, 4096
    s_xor_b32 s25, s25, 0x40000
    s_xor_b32 s26, s26, 0x40000
    s_mov_b32 s35, 0x49800000
    s_add_u32 s22, s22, 1
    v_cndmask_b32 v12, 0, v125, s[68:69]
    v_cndmask_b32 v13, 0, v125, s[70:71]
    v_cndmask_b32 v14, 0, v125, s[72:73]
    v_cndmask_b32 v15, 0, v125, s[74:75]
    v_mov_b32 v32, 0
    v_mov_b32 v33, 0
    v_mov_b32 v34, 0
    v_mov_b32 v35, 0
    v_mov_b32 v36, 0
    v_mov_b32 v37, 0
    v_mov_b32 v38, 0
    v_mov_b32 v39, 0
    v_mov_b32 v40, 0
    v_mov_b32 v41, 0
    v_mov_b32 v42, 0
    v_mov_b32 v43, 0
    v_mov_b32 v44, 0
    v_mov_b32 v45, 0
    v_mov_b32 v46, 0
    v_mov_b32 v47, 0
    v_mov_b32 v54, 0
    v_mov_b32 v55, 0
    v_mov_b32 v52, 0
    v_mov_b32 v52, 0
    v_mov_b32 v52, 0
    v_mov_b32 v52, 0
    v_mov_b32 v52, 0
    v_mov_b32 v52, 0
    v_mov_b32 v52, 0
    v_mov_b32 v52, 0
    v_mov_b32 v52, 0
    v_mov_b32 v52, 0
    v_mov_b32 v52, 0
    v_mov_b32 v52, 0
    v_mov_b32 v52, 0
    v_mov_b32 v52, 0
    v_mov_b32 v52, 0
    v_mov_b32 v52, 0
    v_mov_b32 v52, 0
    v_mov_b32 v52, 0
    v_mov_b32 v52, 0
    v_mov_b32 v52, 0
    v_mov_b32 v52, 0
    v_mov_b32 v52, 0
    v_mov_b32 v52, 0
    v_mov_b32 v52, 0
    v_mov_b32 v52, 0
    v_mov_b32 v52, 0
    v_mov_b32 v52, 0
    v_mov_b32 v52, 0
    v_mov_b32 v52, 0
    v_mov_b32 v52, 0
    v_mov_b32 v52, 0
    v_mov_b32 v52, 0
    v_mov_b32 v52, 0
    v_mov_b32 v52, 0
    v_mov_b32 v52, 0
    v_mov_b32 v52, 0
    v_mov_b32 v52, 0
    v_mov_b32 v52, 0
    v_mov_b32 v52, 0
    v_mov_b32 v52, 0
    v_mov_b32 v52, 0
    v_mov_b32 v52, 0
    v_mov_b32 v52, 0
    buffer_load_dwordx4 v[4:7], v117, s[8:11], s29 offen sc1
    buffer_load_dwordx4 v[8:11], v117, s[8:11], s53 offen sc1
    buffer_load_dwordx4 v[16:19], v117, s[8:11], s29 offen offset:2048 sc1
    buffer_load_dwordx4 v[20:23], v117, s[8:11], s53 offen offset:2048 sc1
    v_mov_b32 v52, 0
    s_waitcnt vmcnt(3)
L_rl_83:
    v_mfma_f32_16x16x32_bf16 v[48:51], v[4:7], v[12:15], 0
    v_xor_b32 v52, s33, v4
    s_waitcnt vmcnt(2)
    v_mfma_f32_16x16x32_bf16 v[48:51], v[8:11], v[12:15], v[48:51]
    v_xor_b32 v53, s33, v8
    v_or_b32 v52, v52, v53
    s_waitcnt vmcnt(1)
    v_mfma_f32_16x16x32_bf16 v[48:51], v[16:19], v[12:15], v[48:51]
    v_xor_b32 v53, s33, v16
    v_or_b32 v52, v52, v53
    s_waitcnt vmcnt(0)
    v_mfma_f32_16x16x32_bf16 v[48:51], v[20:23], v[12:15], v[48:51]
    v_xor_b32 v53, s33, v20
    v_or_b32 v52, v52, v53
    v_and_b32 v52, 1, v52
    v_cmp_ne_u32 vcc, 0, v52
    s_cbranch_vccnz L_rslow_84
L_rgo_85:
    s_nop 2
    v_permlane32_swap_b32 v48, v50
    v_permlane32_swap_b32 v49, v51
    v_pk_add_f32 v[48:49], v[48:49], v[50:51]
    s_mov_b64 exec, s[38:39]
    v_cvt_pk_bf16_f32 v12, v48, v49
    v_min_u32 v12, 0xfffffffe, v12
    buffer_store_dword v12, v119, s[8:11], s24 offen sc1
    s_mov_b64 exec, -1
    s_add_u32 s24, s24, 8192
    s_bitset0_b32 s24, 15
    s_xor_b32 s55, s24, 16384
    s_xor_b32 s29, s29, 0x40000
    s_xor_b32 s53, s29, 1024
    s_bfe_u32 s33, s22, 0x10001
    s_waitcnt lgkmcnt(0)
    s_branch L_chain_top3_s
L_chain_last_s:
    s_nop 1
    v_smfmac_f32_16x16x64_bf16 v[48:51], v[16:19], v[128:135], v116
    v_smfmac_f32_16x16x64_bf16 v[48:51], v[20:23], v[160:167], v116
    v_smfmac_f32_16x16x64_bf16 v[48:51], v[24:27], v[144:151], v116
    v_smfmac_f32_16x16x64_bf16 v[48:51], v[28:31], v[176:183], v116
    v_smfmac_f32_16x16x64_bf16 v[52:55], v[16:19], v[136:143], v116
    v_smfmac_f32_16x16x64_bf16 v[52:55], v[20:23], v[168:175], v116
    v_smfmac_f32_16x16x64_bf16 v[52:55], v[24:27], v[152:159], v116
    v_smfmac_f32_16x16x64_bf16 v[52:55], v[28:31], v[184:191], v116
    v_add_f32 v48, v48, v50
    v_add_f32 v49, v49, v51
    v_cvt_pk_bf16_f32 v112, v48, v49
    s_nop 4
    v_add_f32 v52, v52, v54
    v_add_f32 v53, v53, v55
    v_cvt_pk_bf16_f32 v114, v52, v53
    s_add_u32 s32, s32, 0x20000
    buffer_store_dwordx4 v[112:115], v117, s[8:11], s32 offen sc1
    v_mov_b32 v94, 64
    s_waitcnt vmcnt(0) lgkmcnt(0)
    s_barrier
    s_mov_b64 exec, 1
    buffer_store_dword v94, off, s[8:11], s44 sc1
    s_mov_b64 exec, -1
    s_endpgm
L_mret_57:
    s_mov_b32 s43, m0
    s_mov_b32 m0, 4096
    buffer_load_dwordx4 v[4:7], v117, s[8:11], s48 offen sc1
    buffer_load_dwordx4 v117, s[8:11], s48 offen sc1 lds
    s_mov_b32 m0, 8192
    s_mov_b32 m0, s43
    s_waitcnt vmcnt(0)
    v_max3_u32 v15, v4, v5, v6
    v_max_u32 v15, v15, v7
    v_cmp_lt_u32 vcc, s56, v15
    s_add_u32 s47, s47, 1
    s_add_u32 s49, s49, 1
    s_cmp_ge_u32 s49, 0x10000
    s_cbranch_scc1 L_mgo_58
    s_cbranch_vccnz L_mret_57
    s_branch L_mgo_58
L_smax_60:
    s_add_u32 s47, s47, 1
    s_mov_b32 s35, 0x7f800000
    s_waitcnt lgkmcnt(0)
    s_sub_u32 s43, s30, 0x40000
    s_add_u32 s40, s43, 4096
    s_nop 7
    buffer_load_dwordx4 v[56:59], v117, s[8:11], s43 offen
    buffer_load_dwordx4 v[60:63], v117, s[8:11], s43 offen offset:1024
    buffer_load_dwordx4 v[64:67], v117, s[8:11], s43 offen offset:2048
    buffer_load_dwordx4 v[68:71], v117, s[8:11], s43 offen offset:3072
    buffer_load_dwordx4 v[72:75], v117, s[8:11], s40 offen
    buffer_load_dwordx4 v[76:79], v117, s[8:11], s40 offen offset:1024
    buffer_load_dwordx4 v[80:83], v117, s[8:11], s40 offen offset:2048
    buffer_load_dwordx4 v[84:87], v117, s[8:11], s40 offen offset:3072
    ds_read_b128 v[32:35], v121 offset:16384
    ds_read_b128 v[36:39], v121 offset:17408
    ds_read_b128 v[40:43], v121 offset:18432
    ds_read_b128 v[44:47], v121 offset:19456
    v_mov_b32 v96, 0
    v_mov_b32 v97, 0
    v_mov_b32 v98, 0
    v_mov_b32 v99, 0
    v_mov_b32 v100, 0
    v_mov_b32 v101, 0
    v_mov_b32 v102, 0
    v_mov_b32 v103, 0
    v_mov_b32 v104, 0
    v_mov_b32 v105, 0
    v_mov_b32 v106, 0
    v_mov_b32 v107, 0
    v_mov_b32 v108, 0
    v_mov_b32 v109, 0
    v_mov_b32 v110, 0
    v_mov_b32 v111, 0
    s_waitcnt vmcnt(0) lgkmcnt(0)
    v_mfma_f32_16x16x32_bf16 v[56:59], v[56:59], v[32:35], 0
    v_mfma_f32_16x16x32_bf16 v[56:59], v[60:63], v[36:39], v[56:59]
    v_mfma_f32_16x16x32_bf16 v[56:59], v[64:67], v[40:43], v[56:59]
    v_mfma_f32_16x16x32_bf16 v[56:59], v[68:71], v[44:47], v[56:59]
    v_mfma_f32_16x16x32_bf16 v[60:63], v[72:75], v[32:35], 0
    v_mfma_f32_16x16x32_bf16 v[60:63], v[76:79], v[36:39], v[60:63]
    v_mfma_f32_16x16x32_bf16 v[60:63], v[80:83], v[40:43], v[60:63]
    v_mfma_f32_16x16x32_bf16 v[60:63], v[84:87], v[44:47], v[60:63]
    v_mfma_f32_16x16x32_bf16 v[64:67], v[32:35], v[32:35], 0
    v_mfma_f32_16x16x32_bf16 v[64:67], v[36:39], v[36:39], v[64:67]
    v_mfma_f32_16x16x32_bf16 v[64:67], v[40:43], v[40:43], v[64:67]
    v_mfma_f32_16x16x32_bf16 v[64:67], v[44:47], v[44:47], v[64:67]
    v_max3_f32 v84, v56, v57, v58
    v_max3_f32 v84, v84, v59, v60
    v_max3_f32 v84, v84, v61, v62
    s_nop 4
    v_max3_f32 v84, v84, v63, v64
    v_max_f32 v84, v84, v65
    v_mov_b32 v85, v84
    s_nop 1
    v_permlane32_swap_b32 v85, v84
    v_max_f32 v84, v85, v84
    v_mov_b32 v85, v84
    s_nop 1
    v_permlane16_swap_b32 v85, v84
    v_max_f32 v84, v85, v84
    v_sub_f32 v56, v56, v84
    v_sub_f32 v57, v57, v84
    v_sub_f32 v58, v58, v84
    v_sub_f32 v59, v59, v84
    v_sub_f32 v60, v60, v84
    v_sub_f32 v61, v61, v84
    v_sub_f32 v62, v62, v84
    v_sub_f32 v63, v63, v84
    v_sub_f32 v64, v64, v84
    v_sub_f32 v65, v65, v84
    v_exp_f32 v56, v56
    v_exp_f32 v57, v57
    v_exp_f32 v58, v58
    v_exp_f32 v59, v59
    v_exp_f32 v60, v60
    v_exp_f32 v61, v61
    v_exp_f32 v62, v62
    v_exp_f32 v63, v63
    v_exp_f32 v64, v64
    v_exp_f32 v65, v65
    v_cvt_pk_bf16_f32 v68, v56, v57
    v_cvt_pk_bf16_f32 v69, v58, v59
    v_cvt_pk_bf16_f32 v70, v60, v61
    v_cvt_pk_bf16_f32 v71, v62, v63
    v_cvt_pk_bf16_f32 v52, v64, v65
    s_nop 0
    v_mfma_f32_16x16x32_bf16 v[72:75], v[88:91], v[68:71], 0
    v_mfma_f32_16x16x32_bf16 v[76:79], v[92:95], v[68:71], 0
    v_mfma_f32_16x16x32_bf16 v[80:83], v[48:51], v[68:71], 0
    v_mfma_f32_16x16x16_bf16 v[72:75], v[112:113], v[52:53], v[72:75]
    v_mfma_f32_16x16x16_bf16 v[76:79], v[114:115], v[52:53], v[76:79]
    v_mfma_f32_16x16x16_bf16 v[80:83], v[48:49], v[52:53], v[80:83]
    ds_read_b128 v[32:35], v124 offset:6144
    ds_read_b128 v[36:39], v124 offset:7168
    ds_read_b128 v[40:43], v124 offset:34816
    ds_read_b128 v[44:47], v124 offset:35840
    ds_read_b128 v[56:59], v124 offset:36864
    ds_read_b128 v[64:67], v124 offset:38912
    ds_read_b128 v[68:71], v124 offset:39936
    s_waitcnt lgkmcnt(0)
    s_branch L_norm_59
L_kvw_61:
    s_add_u32 s47, s47, 1
    s_add_u32 s49, s49, 1
    s_cmp_ge_u32 s49, 0x10000
    s_cbranch_scc1 L_kvb_62
    s_sleep 4
    buffer_load_dword v125, v119, s[8:11], s28 offen sc1
    s_waitcnt vmcnt(0)
    v_cmp_eq_u32 vcc, 0, v125
    s_nop 0
    s_and_b64 vcc, vcc, s[58:59]
    s_cbranch_scc1 L_kvw_61
    s_branch L_kvb_62
L_mret_64:
    s_mov_b32 s43, m0
    s_mov_b32 m0, 5120
    buffer_load_dwordx4 v[4:7], v117, s[8:11], s48 offen sc1
    buffer_load_dwordx4 v117, s[8:11], s48 offen sc1 lds
    s_mov_b32 m0, 10240
    s_mov_b32 m0, s43
    s_waitcnt vmcnt(0)
    v_max3_u32 v15, v4, v5, v6
    v_max_u32 v15, v15, v7
    v_cmp_lt_u32 vcc, s56, v15
    s_add_u32 s47, s47, 1
    s_add_u32 s49, s49, 1
    s_cmp_ge_u32 s49, 0x10000
    s_cbranch_scc1 L_mgo_65
    s_cbranch_vccnz L_mret_64
    s_branch L_mgo_65
L_smax_67:
    s_add_u32 s47, s47, 1
    s_mov_b32 s35, 0x7f800000
    s_waitcnt lgkmcnt(0)
    s_sub_u32 s43, s30, 0x40800
    s_add_u32 s40, s43, 4096
    s_nop 7
    buffer_load_dwordx4 v[56:59], v117, s[8:11], s43 offen
    buffer_load_dwordx4 v[60:63], v117, s[8:11], s43 offen offset:1024
    buffer_load_dwordx4 v[64:67], v117, s[8:11], s43 offen offset:2048
    buffer_load_dwordx4 v[68:71], v117, s[8:11], s43 offen offset:3072
    buffer_load_dwordx4 v[72:75], v117, s[8:11], s40 offen
    buffer_load_dwordx4 v[76:79], v117, s[8:11], s40 offen offset:1024
    buffer_load_dwordx4 v[80:83], v117, s[8:11], s40 offen offset:2048
    buffer_load_dwordx4 v[84:87], v117, s[8:11], s40 offen offset:3072
    ds_read_b128 v[32:35], v121 offset:16384
    ds_read_b128 v[36:39], v121 offset:17408
    ds_read_b128 v[40:43], v121 offset:18432
    ds_read_b128 v[44:47], v121 offset:19456
    v_mov_b32 v96, 0
    v_mov_b32 v97, 0
    v_mov_b32 v98, 0
    v_mov_b32 v99, 0
    v_mov_b32 v100, 0
    v_mov_b32 v101, 0
    v_mov_b32 v102, 0
    v_mov_b32 v103, 0
    v_mov_b32 v104, 0
    v_mov_b32 v105, 0
    v_mov_b32 v106, 0
    v_mov_b32 v107, 0
    v_mov_b32 v108, 0
    v_mov_b32 v109, 0
    v_mov_b32 v110, 0
    v_mov_b32 v111, 0
    s_waitcnt vmcnt(0) lgkmcnt(0)
    v_mfma_f32_16x16x32_bf16 v[56:59], v[56:59], v[32:35], 0
    v_mfma_f32_16x16x32_bf16 v[56:59], v[60:63], v[36:39], v[56:59]
    v_mfma_f32_16x16x32_bf16 v[56:59], v[64:67], v[40:43], v[56:59]
    v_mfma_f32_16x16x32_bf16 v[56:59], v[68:71], v[44:47], v[56:59]
    v_mfma_f32_16x16x32_bf16 v[60:63], v[72:75], v[32:35], 0
    v_mfma_f32_16x16x32_bf16 v[60:63], v[76:79], v[36:39], v[60:63]
    v_mfma_f32_16x16x32_bf16 v[60:63], v[80:83], v[40:43], v[60:63]
    v_mfma_f32_16x16x32_bf16 v[60:63], v[84:87], v[44:47], v[60:63]
    v_mfma_f32_16x16x32_bf16 v[64:67], v[32:35], v[32:35], 0
    v_mfma_f32_16x16x32_bf16 v[64:67], v[36:39], v[36:39], v[64:67]
    v_mfma_f32_16x16x32_bf16 v[64:67], v[40:43], v[40:43], v[64:67]
    v_mfma_f32_16x16x32_bf16 v[64:67], v[44:47], v[44:47], v[64:67]
    v_max3_f32 v84, v56, v57, v58
    v_max3_f32 v84, v84, v59, v60
    v_max3_f32 v84, v84, v61, v62
    s_nop 4
    v_max3_f32 v84, v84, v63, v64
    v_max_f32 v84, v84, v65
    v_mov_b32 v85, v84
    s_nop 1
    v_permlane32_swap_b32 v85, v84
    v_max_f32 v84, v85, v84
    v_mov_b32 v85, v84
    s_nop 1
    v_permlane16_swap_b32 v85, v84
    v_max_f32 v84, v85, v84
    v_sub_f32 v56, v56, v84
    v_sub_f32 v57, v57, v84
    v_sub_f32 v58, v58, v84
    v_sub_f32 v59, v59, v84
    v_sub_f32 v60, v60, v84
    v_sub_f32 v61, v61, v84
    v_sub_f32 v62, v62, v84
    v_sub_f32 v63, v63, v84
    v_sub_f32 v64, v64, v84
    v_sub_f32 v65, v65, v84
    v_exp_f32 v56, v56
    v_exp_f32 v57, v57
    v_exp_f32 v58, v58
    v_exp_f32 v59, v59
    v_exp_f32 v60, v60
    v_exp_f32 v61, v61
    v_exp_f32 v62, v62
    v_exp_f32 v63, v63
    v_exp_f32 v64, v64
    v_exp_f32 v65, v65
    v_cvt_pk_bf16_f32 v68, v56, v57
    v_cvt_pk_bf16_f32 v69, v58, v59
    v_cvt_pk_bf16_f32 v70, v60, v61
    v_cvt_pk_bf16_f32 v71, v62, v63
    v_cvt_pk_bf16_f32 v52, v64, v65
    s_nop 0
    v_mfma_f32_16x16x32_bf16 v[72:75], v[88:91], v[68:71], 0
    v_mfma_f32_16x16x32_bf16 v[76:79], v[92:95], v[68:71], 0
    v_mfma_f32_16x16x32_bf16 v[80:83], v[48:51], v[68:71], 0
    v_mfma_f32_16x16x16_bf16 v[72:75], v[112:113], v[52:53], v[72:75]
    v_mfma_f32_16x16x16_bf16 v[76:79], v[114:115], v[52:53], v[76:79]
    v_mfma_f32_16x16x16_bf16 v[80:83], v[48:49], v[52:53], v[80:83]
    ds_read_b128 v[32:35], v124 offset:6144
    ds_read_b128 v[36:39], v124 offset:7168
    ds_read_b128 v[40:43], v124 offset:34816
    ds_read_b128 v[44:47], v124 offset:35840
    ds_read_b128 v[56:59], v124 offset:36864
    ds_read_b128 v[64:67], v124 offset:38912
    ds_read_b128 v[68:71], v124 offset:39936
    s_waitcnt lgkmcnt(0)
    s_branch L_norm_66
L_kvw_68:
    s_add_u32 s47, s47, 1
    s_add_u32 s49, s49, 1
    s_cmp_ge_u32 s49, 0x10000
    s_cbranch_scc1 L_kvb_69
    s_sleep 4
    buffer_load_dword v125, v119, s[8:11], s28 offen sc1
    s_waitcnt vmcnt(0)
    v_cmp_eq_u32 vcc, 0, v125
    s_nop 0
    s_and_b64 vcc, vcc, s[58:59]
    s_cbranch_scc1 L_kvw_68
    s_branch L_kvb_69
L_mret_71:
    s_mov_b32 s43, m0
    s_mov_b32 m0, 6144
    buffer_load_dwordx4 v[4:7], v117, s[8:11], s48 offen sc1
    buffer_load_dwordx4 v117, s[8:11], s48 offen sc1 lds
    s_mov_b32 m0, 12288
    s_mov_b32 m0, s43
    s_waitcnt vmcnt(0)
    v_max3_u32 v15, v4, v5, v6
    v_max_u32 v15, v15, v7
    v_cmp_lt_u32 vcc, s56, v15
    s_add_u32 s47, s47, 1
    s_add_u32 s49, s49, 1
    s_cmp_ge_u32 s49, 0x10000
    s_cbranch_scc1 L_mgo_72
    s_cbranch_vccnz L_mret_71
    s_branch L_mgo_72
L_smax_74:
    s_add_u32 s47, s47, 1
    s_mov_b32 s35, 0x7f800000
    s_waitcnt lgkmcnt(0)
    s_sub_u32 s43, s30, 0x41000
    s_add_u32 s40, s43, 4096
    s_nop 7
    buffer_load_dwordx4 v[56:59], v117, s[8:11], s43 offen
    buffer_load_dwordx4 v[60:63], v117, s[8:11], s43 offen offset:1024
    buffer_load_dwordx4 v[64:67], v117, s[8:11], s43 offen offset:2048
    buffer_load_dwordx4 v[68:71], v117, s[8:11], s43 offen offset:3072
    buffer_load_dwordx4 v[72:75], v117, s[8:11], s40 offen
    buffer_load_dwordx4 v[76:79], v117, s[8:11], s40 offen offset:1024
    buffer_load_dwordx4 v[80:83], v117, s[8:11], s40 offen offset:2048
    buffer_load_dwordx4 v[84:87], v117, s[8:11], s40 offen offset:3072
    ds_read_b128 v[32:35], v121 offset:16384
    ds_read_b128 v[36:39], v121 offset:17408
    ds_read_b128 v[40:43], v121 offset:18432
    ds_read_b128 v[44:47], v121 offset:19456
    v_mov_b32 v96, 0
    v_mov_b32 v97, 0
    v_mov_b32 v98, 0
    v_mov_b32 v99, 0
    v_mov_b32 v100, 0
    v_mov_b32 v101, 0
    v_mov_b32 v102, 0
    v_mov_b32 v103, 0
    v_mov_b32 v104, 0
    v_mov_b32 v105, 0
    v_mov_b32 v106, 0
    v_mov_b32 v107, 0
    v_mov_b32 v108, 0
    v_mov_b32 v109, 0
    v_mov_b32 v110, 0
    v_mov_b32 v111, 0
    s_waitcnt vmcnt(0) lgkmcnt(0)
    v_mfma_f32_16x16x32_bf16 v[56:59], v[56:59], v[32:35], 0
    v_mfma_f32_16x16x32_bf16 v[56:59], v[60:63], v[36:39], v[56:59]
    v_mfma_f32_16x16x32_bf16 v[56:59], v[64:67], v[40:43], v[56:59]
    v_mfma_f32_16x16x32_bf16 v[56:59], v[68:71], v[44:47], v[56:59]
    v_mfma_f32_16x16x32_bf16 v[60:63], v[72:75], v[32:35], 0
    v_mfma_f32_16x16x32_bf16 v[60:63], v[76:79], v[36:39], v[60:63]
    v_mfma_f32_16x16x32_bf16 v[60:63], v[80:83], v[40:43], v[60:63]
    v_mfma_f32_16x16x32_bf16 v[60:63], v[84:87], v[44:47], v[60:63]
    v_mfma_f32_16x16x32_bf16 v[64:67], v[32:35], v[32:35], 0
    v_mfma_f32_16x16x32_bf16 v[64:67], v[36:39], v[36:39], v[64:67]
    v_mfma_f32_16x16x32_bf16 v[64:67], v[40:43], v[40:43], v[64:67]
    v_mfma_f32_16x16x32_bf16 v[64:67], v[44:47], v[44:47], v[64:67]
    v_max3_f32 v84, v56, v57, v58
    v_max3_f32 v84, v84, v59, v60
    v_max3_f32 v84, v84, v61, v62
    s_nop 4
    v_max3_f32 v84, v84, v63, v64
    v_max_f32 v84, v84, v65
    v_mov_b32 v85, v84
    s_nop 1
    v_permlane32_swap_b32 v85, v84
    v_max_f32 v84, v85, v84
    v_mov_b32 v85, v84
    s_nop 1
    v_permlane16_swap_b32 v85, v84
    v_max_f32 v84, v85, v84
    v_sub_f32 v56, v56, v84
    v_sub_f32 v57, v57, v84
    v_sub_f32 v58, v58, v84
    v_sub_f32 v59, v59, v84
    v_sub_f32 v60, v60, v84
    v_sub_f32 v61, v61, v84
    v_sub_f32 v62, v62, v84
    v_sub_f32 v63, v63, v84
    v_sub_f32 v64, v64, v84
    v_sub_f32 v65, v65, v84
    v_exp_f32 v56, v56
    v_exp_f32 v57, v57
    v_exp_f32 v58, v58
    v_exp_f32 v59, v59
    v_exp_f32 v60, v60
    v_exp_f32 v61, v61
    v_exp_f32 v62, v62
    v_exp_f32 v63, v63
    v_exp_f32 v64, v64
    v_exp_f32 v65, v65
    v_cvt_pk_bf16_f32 v68, v56, v57
    v_cvt_pk_bf16_f32 v69, v58, v59
    v_cvt_pk_bf16_f32 v70, v60, v61
    v_cvt_pk_bf16_f32 v71, v62, v63
    v_cvt_pk_bf16_f32 v52, v64, v65
    s_nop 0
    v_mfma_f32_16x16x32_bf16 v[72:75], v[88:91], v[68:71], 0
    v_mfma_f32_16x16x32_bf16 v[76:79], v[92:95], v[68:71], 0
    v_mfma_f32_16x16x32_bf16 v[80:83], v[48:51], v[68:71], 0
    v_mfma_f32_16x16x16_bf16 v[72:75], v[112:113], v[52:53], v[72:75]
    v_mfma_f32_16x16x16_bf16 v[76:79], v[114:115], v[52:53], v[76:79]
    v_mfma_f32_16x16x16_bf16 v[80:83], v[48:49], v[52:53], v[80:83]
    ds_read_b128 v[32:35], v124 offset:6144
    ds_read_b128 v[36:39], v124 offset:7168
    ds_read_b128 v[40:43], v124 offset:34816
    ds_read_b128 v[44:47], v124 offset:35840
    ds_read_b128 v[56:59], v124 offset:36864
    ds_read_b128 v[64:67], v124 offset:38912
    ds_read_b128 v[68:71], v124 offset:39936
    s_waitcnt lgkmcnt(0)
    s_branch L_norm_73
L_rslow_76:
    buffer_load_dwordx4 v[4:7], v117, s[8:11], s29 offen sc1
    buffer_load_dwordx4 v[8:11], v117, s[8:11], s53 offen sc1
    buffer_load_dwordx4 v[16:19], v117, s[8:11], s29 offen offset:2048 sc1
    buffer_load_dwordx4 v[20:23], v117, s[8:11], s53 offen offset:2048 sc1
    s_add_u32 s46, s46, 1
    s_add_u32 s49, s49, 1
    s_cmp_ge_u32 s49, 0x10000
    s_cbranch_scc1 L_rgo_77
    s_waitcnt vmcnt(0)
    s_branch L_rl_75
L_mret_79:
    s_mov_b32 s43, m0
    s_mov_b32 m0, 7168
    buffer_load_dwordx4 v[4:7], v117, s[8:11], s48 offen sc1
    buffer_load_dwordx4 v117, s[8:11], s48 offen sc1 lds
    s_mov_b32 m0, 14336
    s_mov_b32 m0, s43
    s_waitcnt vmcnt(0)
    v_max3_u32 v15, v4, v5, v6
    v_max_u32 v15, v15, v7
    v_cmp_lt_u32 vcc, s56, v15
    s_add_u32 s47, s47, 1
    s_add_u32 s49, s49, 1
    s_cmp_ge_u32 s49, 0x10000
    s_cbranch_scc1 L_mgo_80
    s_cbranch_vccnz L_mret_79
    s_branch L_mgo_80
L_smax_82:
    s_add_u32 s47, s47, 1
    s_mov_b32 s35, 0x7f800000
    s_waitcnt lgkmcnt(0)
    s_sub_u32 s43, s30, 0x41800
    s_add_u32 s40, s43, 4096
    s_nop 7
    buffer_load_dwordx4 v[56:59], v117, s[8:11], s43 offen
    buffer_load_dwordx4 v[60:63], v117, s[8:11], s43 offen offset:1024
    buffer_load_dwordx4 v[64:67], v117, s[8:11], s43 offen offset:2048
    buffer_load_dwordx4 v[68:71], v117, s[8:11], s43 offen offset:3072
    buffer_load_dwordx4 v[72:75], v117, s[8:11], s40 offen
    buffer_load_dwordx4 v[76:79], v117, s[8:11], s40 offen offset:1024
    buffer_load_dwordx4 v[80:83], v117, s[8:11], s40 offen offset:2048
    buffer_load_dwordx4 v[84:87], v117, s[8:11], s40 offen offset:3072
    ds_read_b128 v[32:35], v121 offset:16384
    ds_read_b128 v[36:39], v121 offset:17408
    ds_read_b128 v[40:43], v121 offset:18432
    ds_read_b128 v[44:47], v121 offset:19456
    v_mov_b32 v96, 0
    v_mov_b32 v97, 0
    v_mov_b32 v98, 0
    v_mov_b32 v99, 0
    v_mov_b32 v100, 0
    v_mov_b32 v101, 0
    v_mov_b32 v102, 0
    v_mov_b32 v103, 0
    v_mov_b32 v104, 0
    v_mov_b32 v105, 0
    v_mov_b32 v106, 0
    v_mov_b32 v107, 0
    v_mov_b32 v108, 0
    v_mov_b32 v109, 0
    v_mov_b32 v110, 0
    v_mov_b32 v111, 0
    s_waitcnt vmcnt(0) lgkmcnt(0)
    v_mfma_f32_16x16x32_bf16 v[56:59], v[56:59], v[32:35], 0
    v_mfma_f32_16x16x32_bf16 v[56:59], v[60:63], v[36:39], v[56:59]
    v_mfma_f32_16x16x32_bf16 v[56:59], v[64:67], v[40:43], v[56:59]
    v_mfma_f32_16x16x32_bf16 v[56:59], v[68:71], v[44:47], v[56:59]
    v_mfma_f32_16x16x32_bf16 v[60:63], v[72:75], v[32:35], 0
    v_mfma_f32_16x16x32_bf16 v[60:63], v[76:79], v[36:39], v[60:63]
    v_mfma_f32_16x16x32_bf16 v[60:63], v[80:83], v[40:43], v[60:63]
    v_mfma_f32_16x16x32_bf16 v[60:63], v[84:87], v[44:47], v[60:63]
    v_mfma_f32_16x16x32_bf16 v[64:67], v[32:35], v[32:35], 0
    v_mfma_f32_16x16x32_bf16 v[64:67], v[36:39], v[36:39], v[64:67]
    v_mfma_f32_16x16x32_bf16 v[64:67], v[40:43], v[40:43], v[64:67]
    v_mfma_f32_16x16x32_bf16 v[64:67], v[44:47], v[44:47], v[64:67]
    v_max3_f32 v84, v56, v57, v58
    v_max3_f32 v84, v84, v59, v60
    v_max3_f32 v84, v84, v61, v62
    s_nop 4
    v_max3_f32 v84, v84, v63, v64
    v_max_f32 v84, v84, v65
    v_mov_b32 v85, v84
    s_nop 1
    v_permlane32_swap_b32 v85, v84
    v_max_f32 v84, v85, v84
    v_mov_b32 v85, v84
    s_nop 1
    v_permlane16_swap_b32 v85, v84
    v_max_f32 v84, v85, v84
    v_sub_f32 v56, v56, v84
    v_sub_f32 v57, v57, v84
    v_sub_f32 v58, v58, v84
    v_sub_f32 v59, v59, v84
    v_sub_f32 v60, v60, v84
    v_sub_f32 v61, v61, v84
    v_sub_f32 v62, v62, v84
    v_sub_f32 v63, v63, v84
    v_sub_f32 v64, v64, v84
    v_sub_f32 v65, v65, v84
    v_exp_f32 v56, v56
    v_exp_f32 v57, v57
    v_exp_f32 v58, v58
    v_exp_f32 v59, v59
    v_exp_f32 v60, v60
    v_exp_f32 v61, v61
    v_exp_f32 v62, v62
    v_exp_f32 v63, v63
    v_exp_f32 v64, v64
    v_exp_f32 v65, v65
    v_cvt_pk_bf16_f32 v68, v56, v57
    v_cvt_pk_bf16_f32 v69, v58, v59
    v_cvt_pk_bf16_f32 v70, v60, v61
    v_cvt_pk_bf16_f32 v71, v62, v63
    v_cvt_pk_bf16_f32 v52, v64, v65
    s_nop 0
    v_mfma_f32_16x16x32_bf16 v[72:75], v[88:91], v[68:71], 0
    v_mfma_f32_16x16x32_bf16 v[76:79], v[92:95], v[68:71], 0
    v_mfma_f32_16x16x32_bf16 v[80:83], v[48:51], v[68:71], 0
    v_mfma_f32_16x16x16_bf16 v[72:75], v[112:113], v[52:53], v[72:75]
    v_mfma_f32_16x16x16_bf16 v[76:79], v[114:115], v[52:53], v[76:79]
    v_mfma_f32_16x16x16_bf16 v[80:83], v[48:49], v[52:53], v[80:83]
    ds_read_b128 v[32:35], v124 offset:6144
    ds_read_b128 v[36:39], v124 offset:7168
    ds_read_b128 v[40:43], v124 offset:34816
    ds_read_b128 v[44:47], v124 offset:35840
    ds_read_b128 v[56:59], v124 offset:36864
    ds_read_b128 v[64:67], v124 offset:38912
    ds_read_b128 v[68:71], v124 offset:39936
    s_waitcnt lgkmcnt(0)
    s_branch L_norm_81
L_rslow_84:
    buffer_load_dwordx4 v[4:7], v117, s[8:11], s29 offen sc1
    buffer_load_dwordx4 v[8:11], v117, s[8:11], s53 offen sc1
    buffer_load_dwordx4 v[16:19], v117, s[8:11], s29 offen offset:2048 sc1
    buffer_load_dwordx4 v[20:23], v117, s[8:11], s53 offen offset:2048 sc1
    s_add_u32 s46, s46, 1
    s_add_u32 s49, s49, 1
    s_cmp_ge_u32 s49, 0x10000
    s_cbranch_scc1 L_rgo_85
    s_waitcnt vmcnt(0)
    s_branch L_rl_83
L_bulk:
    s_add_u32 s88, s101, 32
    s_mov_b32 s41, 0
    s_lshr_b32 s20, s101, 6
    s_and_b32 s22, s101, 63
    s_movk_i32 s37, 1000
L_p1go:
    s_mov_b32 s40, 0
    s_mov_b32 s80, 0
    s_mov_b32 s23, 0
L_p1_pass:
    v_mbcnt_lo_u32_b32 v0, -1, 0
    v_mbcnt_hi_u32_b32 v0, -1, v0
    s_lshl_b32 s96, s100, 6
    v_add_u32 v0, s96, v0
    s_load_dwordx2 s[34:35], s[0:1], 16
    s_load_dwordx2 s[30:31], s[0:1], 24
    s_load_dwordx2 s[32:33], s[0:1], 32
    s_load_dwordx2 s[42:43], s[0:1], 40
    s_load_dwordx2 s[12:13], s[0:1], 0
    s_waitcnt lgkmcnt(0)
    s_and_b32 s13, s13, 0xffff
    s_mov_b32 s14, 0x200000
    s_mov_b32 s15, 0x20000
    v_lshrrev_b32 v147, 6, v0
    s_nop 0
    v_readfirstlane_b32 s21, v147
    v_and_b32 v144, 63, v0
    v_lshrrev_b32 v145, 4, v144
    v_and_b32 v146, 15, v144
    v_lshrrev_b32 v149, 2, v146
    v_lshlrev_b32 v137, 4, v144
    s_lshl_b32 s29, s21, 10
    s_lshl_b32 s26, s20, 7
    s_lshl_b32 s27, s21, 5
    s_add_u32 s26, s26, s27
    v_add_u32 v147, s26, v146
    v_lshlrev_b32 v147, 10, v147
    v_lshl_add_u32 v139, v145, 4, v147
    s_mov_b32 s26, 0x0
    buffer_load_dwordx4 v[0:3], v139, s[12:15], s26 offen
    buffer_load_dwordx4 v[4:7], v139, s[12:15], s26 offen offset:64
    buffer_load_dwordx4 v[8:11], v139, s[12:15], s26 offen offset:128
    buffer_load_dwordx4 v[12:15], v139, s[12:15], s26 offen offset:192
    buffer_load_dwordx4 v[16:19], v139, s[12:15], s26 offen offset:256
    buffer_load_dwordx4 v[20:23], v139, s[12:15], s26 offen offset:320
    buffer_load_dwordx4 v[24:27], v139, s[12:15], s26 offen offset:384
    buffer_load_dwordx4 v[28:31], v139, s[12:15], s26 offen offset:448
    buffer_load_dwordx4 v[32:35], v139, s[12:15], s26 offen offset:512
    buffer_load_dwordx4 v[36:39], v139, s[12:15], s26 offen offset:576
    buffer_load_dwordx4 v[40:43], v139, s[12:15], s26 offen offset:640
    buffer_load_dwordx4 v[44:47], v139, s[12:15], s26 offen offset:704
    buffer_load_dwordx4 v[48:51], v139, s[12:15], s26 offen offset:768
    buffer_load_dwordx4 v[52:55], v139, s[12:15], s26 offen offset:832
    buffer_load_dwordx4 v[56:59], v139, s[12:15], s26 offen offset:896
    buffer_load_dwordx4 v[60:63], v139, s[12:15], s26 offen offset:960
    s_mov_b32 s26, 0x4000
    buffer_load_dwordx4 v[64:67], v139, s[12:15], s26 offen
    buffer_load_dwordx4 v[68:71], v139, s[12:15], s26 offen offset:64
    buffer_load_dwordx4 v[72:75], v139, s[12:15], s26 offen offset:128
    buffer_load_dwordx4 v[76:79], v139, s[12:15], s26 offen offset:192
    buffer_load_dwordx4 v[80:83], v139, s[12:15], s26 offen offset:256
    buffer_load_dwordx4 v[84:87], v139, s[12:15], s26 offen offset:320
    buffer_load_dwordx4 v[88:91], v139, s[12:15], s26 offen offset:384
    buffer_load_dwordx4 v[92:95], v139, s[12:15], s26 offen offset:448
    buffer_load_dwordx4 v[96:99], v139, s[12:15], s26 offen offset:512
    buffer_load_dwordx4 v[100:103], v139, s[12:15], s26 offen offset:576
    buffer_load_dwordx4 v[104:107], v139, s[12:15], s26 offen offset:640
    buffer_load_dwordx4 v[108:111], v139, s[12:15], s26 offen offset:704
    buffer_load_dwordx4 v[112:115], v139, s[12:15], s26 offen offset:768
    buffer_load_dwordx4 v[116:119], v139, s[12:15], s26 offen offset:832
    buffer_load_dwordx4 v[120:123], v139, s[12:15], s26 offen offset:896
    buffer_load_dwordx4 v[124:127], v139, s[12:15], s26 offen offset:960
    s_lshr_b32 s26, s21, 1
    s_lshl_b32 s26, s26, 2
    v_or_b32 v148, s26, v145
    v_lshlrev_b32 v148, 1, v148
    v_xor_b32 v148, v148, v146
    v_lshlrev_b32 v148, 4, v148
    s_lshl_b32 s26, s21, 2
    v_add_u32 v147, s26, v145
    v_lshl_add_u32 v136, v147, 13, v148
    v_lshl_add_u32 v147, v145, 3, v149
    v_lshlrev_b32 v147, 8, v147
    v_and_b32 v148, 1, v145
    v_lshl_or_b32 v148, v148, 2, v149
    v_lshl_add_u32 v147, v148, 5, v147
    v_and_b32 v148, 3, v146
    v_lshl_add_u32 v128, v148, 3, v147
    v_xor_b32 v129, 32, v128
    v_xor_b32 v130, 64, v128
    v_xor_b32 v131, 96, v128
    v_xor_b32 v132, 128, v128
    v_xor_b32 v133, 160, v128
    v_xor_b32 v134, 192, v128
    v_xor_b32 v135, 224, v128
    s_mov_b32 s19, 0x20000
    s_mov_b32 s38, s22
    s_mov_b32 s39, s22
    v_mov_b32 v158, 0x3f803f80
    s_waitcnt vmcnt(16)
    v_pk_mov_b32 v[150:151], 0, 0
    v_pk_mov_b32 v[152:153], 0, 0
    v_dot2_f32_bf16 v150, v0, v158, v150
    v_dot2_f32_bf16 v152, v0, v0, v152
    v_dot2_f32_bf16 v151, v1, v158, v151
    v_dot2_f32_bf16 v153, v1, v1, v153
    v_dot2_f32_bf16 v150, v2, v158, v150
    v_dot2_f32_bf16 v152, v2, v2, v152
    v_dot2_f32_bf16 v151, v3, v158, v151
    v_dot2_f32_bf16 v153, v3, v3, v153
    v_dot2_f32_bf16 v150, v4, v158, v150
    v_dot2_f32_bf16 v152, v4, v4, v152
    v_dot2_f32_bf16 v151, v5, v158, v151
    v_dot2_f32_bf16 v153, v5, v5, v153
    v_dot2_f32_bf16 v150, v6, v158, v150
    v_dot2_f32_bf16 v152, v6, v6, v152
    v_dot2_f32_bf16 v151, v7, v158, v151
    v_dot2_f32_bf16 v153, v7, v7, v153
    v_dot2_f32_bf16 v150, v8, v158, v150
    v_dot2_f32_bf16 v152, v8, v8, v152
    v_dot2_f32_bf16 v151, v9, v158, v151
    v_dot2_f32_bf16 v153, v9, v9, v153
    v_dot2_f32_bf16 v150, v10, v158, v150
    v_dot2_f32_bf16 v152, v10, v10, v152
    v_dot2_f32_bf16 v151, v11, v158, v151
    v_dot2_f32_bf16 v153, v11, v11, v153
    v_dot2_f32_bf16 v150, v12, v158, v150
    v_dot2_f32_bf16 v152, v12, v12, v152
    v_dot2_f32_bf16 v151, v13, v158, v151
    v_dot2_f32_bf16 v153, v13, v13, v153
    v_dot2_f32_bf16 v150, v14, v158, v150
    v_dot2_f32_bf16 v152, v14, v14, v152
    v_dot2_f32_bf16 v151, v15, v158, v151
    v_dot2_f32_bf16 v153, v15, v15, v153
    v_dot2_f32_bf16 v150, v16, v158, v150
    v_dot2_f32_bf16 v152, v16, v16, v152
    v_dot2_f32_bf16 v151, v17, v158, v151
    v_dot2_f32_bf16 v153, v17, v17, v153
    v_dot2_f32_bf16 v150, v18, v158, v150
    v_dot2_f32_bf16 v152, v18, v18, v152
    v_dot2_f32_bf16 v151, v19, v158, v151
    v_dot2_f32_bf16 v153, v19, v19, v153
    v_dot2_f32_bf16 v150, v20, v158, v150
    v_dot2_f32_bf16 v152, v20, v20, v152
    v_dot2_f32_bf16 v151, v21, v158, v151
    v_dot2_f32_bf16 v153, v21, v21, v153
    v_dot2_f32_bf16 v150, v22, v158, v150
    v_dot2_f32_bf16 v152, v22, v22, v152
    v_dot2_f32_bf16 v151, v23, v158, v151
    v_dot2_f32_bf16 v153, v23, v23, v153
    v_dot2_f32_bf16 v150, v24, v158, v150
    v_dot2_f32_bf16 v152, v24, v24, v152
    v_dot2_f32_bf16 v151, v25, v158, v151
    v_dot2_f32_bf16 v153, v25, v25, v153
    v_dot2_f32_bf16 v150, v26, v158, v150
    v_dot2_f32_bf16 v152, v26, v26, v152
    v_dot2_f32_bf16 v151, v27, v158, v151
    v_dot2_f32_bf16 v153, v27, v27, v153
    v_dot2_f32_bf16 v150, v28, v158, v150
    v_dot2_f32_bf16 v152, v28, v28, v152
    v_dot2_f32_bf16 v151, v29, v158, v151
    v_dot2_f32_bf16 v153, v29, v29, v153
    v_dot2_f32_bf16 v150, v30, v158, v150
    v_dot2_f32_bf16 v152, v30, v30, v152
    v_dot2_f32_bf16 v151, v31, v158, v151
    v_dot2_f32_bf16 v153, v31, v31, v153
    v_dot2_f32_bf16 v150, v32, v158, v150
    v_dot2_f32_bf16 v152, v32, v32, v152
    v_dot2_f32_bf16 v151, v33, v158, v151
    v_dot2_f32_bf16 v153, v33, v33, v153
    v_dot2_f32_bf16 v150, v34, v158, v150
    v_dot2_f32_bf16 v152, v34, v34, v152
    v_dot2_f32_bf16 v151, v35, v158, v151
    v_dot2_f32_bf16 v153, v35, v35, v153
    v_dot2_f32_bf16 v150, v36, v158, v150
    v_dot2_f32_bf16 v152, v36, v36, v152
    v_dot2_f32_bf16 v151, v37, v158, v151
    v_dot2_f32_bf16 v153, v37, v37, v153
    v_dot2_f32_bf16 v150, v38, v158, v150
    v_dot2_f32_bf16 v152, v38, v38, v152
    v_dot2_f32_bf16 v151, v39, v158, v151
    v_dot2_f32_bf16 v153, v39, v39, v153
    v_dot2_f32_bf16 v150, v40, v158, v150
    v_dot2_f32_bf16 v152, v40, v40, v152
    v_dot2_f32_bf16 v151, v41, v158, v151
    v_dot2_f32_bf16 v153, v41, v41, v153
    v_dot2_f32_bf16 v150, v42, v158, v150
    v_dot2_f32_bf16 v152, v42, v42, v152
    v_dot2_f32_bf16 v151, v43, v158, v151
    v_dot2_f32_bf16 v153, v43, v43, v153
    v_dot2_f32_bf16 v150, v44, v158, v150
    v_dot2_f32_bf16 v152, v44, v44, v152
    v_dot2_f32_bf16 v151, v45, v158, v151
    v_dot2_f32_bf16 v153, v45, v45, v153
    v_dot2_f32_bf16 v150, v46, v158, v150
    v_dot2_f32_bf16 v152, v46, v46, v152
    v_dot2_f32_bf16 v151, v47, v158, v151
    v_dot2_f32_bf16 v153, v47, v47, v153
    v_dot2_f32_bf16 v150, v48, v158, v150
    v_dot2_f32_bf16 v152, v48, v48, v152
    v_dot2_f32_bf16 v151, v49, v158, v151
    v_dot2_f32_bf16 v153, v49, v49, v153
    v_dot2_f32_bf16 v150, v50, v158, v150
    v_dot2_f32_bf16 v152, v50, v50, v152
    v_dot2_f32_bf16 v151, v51, v158, v151
    v_dot2_f32_bf16 v153, v51, v51, v153
    v_dot2_f32_bf16 v150, v52, v158, v150
    v_dot2_f32_bf16 v152, v52, v52, v152
    v_dot2_f32_bf16 v151, v53, v158, v151
    v_dot2_f32_bf16 v153, v53, v53, v153
    v_dot2_f32_bf16 v150, v54, v158, v150
    v_dot2_f32_bf16 v152, v54, v54, v152
    v_dot2_f32_bf16 v151, v55, v158, v151
    v_dot2_f32_bf16 v153, v55, v55, v153
    v_dot2_f32_bf16 v150, v56, v158, v150
    v_dot2_f32_bf16 v152, v56, v56, v152
    v_dot2_f32_bf16 v151, v57, v158, v151
    v_dot2_f32_bf16 v153, v57, v57, v153
    v_dot2_f32_bf16 v150, v58, v158, v150
    v_dot2_f32_bf16 v152, v58, v58, v152
    v_dot2_f32_bf16 v151, v59, v158, v151
    v_dot2_f32_bf16 v153, v59, v59, v153
    v_dot2_f32_bf16 v150, v60, v158, v150
    v_dot2_f32_bf16 v152, v60, v60, v152
    v_dot2_f32_bf16 v151, v61, v158, v151
    v_dot2_f32_bf16 v153, v61, v61, v153
    v_dot2_f32_bf16 v150, v62, v158, v150
    v_dot2_f32_bf16 v152, v62, v62, v152
    v_dot2_f32_bf16 v151, v63, v158, v151
    v_dot2_f32_bf16 v153, v63, v63, v153
    s_nop 1
    v_add_f32 v150, v150, v151
    v_add_f32 v152, v152, v153
    v_mov_b32 v157, v150
    s_nop 1
    v_permlane32_swap_b32 v157, v150
    v_add_f32 v150, v157, v150
    v_mov_b32 v157, v150
    s_nop 1
    v_permlane16_swap_b32 v157, v150
    v_add_f32 v150, v157, v150
    v_mov_b32 v157, v152
    s_nop 1
    v_permlane32_swap_b32 v157, v152
    v_add_f32 v152, v157, v152
    v_mov_b32 v157, v152
    s_nop 1
    v_permlane16_swap_b32 v157, v152
    v_add_f32 v152, v157, v152
    v_mul_f32 v150, 0x3b000000, v150
    v_cvt_pk_bf16_f32 v154, v150, v150
    v_and_b32 v154, 0xffff0000, v154
    v_sub_f32 v156, v150, v154
    v_mul_f32 v157, v150, v150
    v_mul_f32 v152, 0x3b000000, v152
    v_sub_f32 v152, v152, v157
    v_max_f32 v152, 0, v152
    v_cvt_pk_bf16_f32 v152, v152, v152
    v_and_b32 v152, 0xffff0000, v152
    v_add_f32 v152, 0x3727c5ac, v152
    v_cvt_pk_bf16_f32 v152, v152, v152
    v_and_b32 v152, 0xffff0000, v152
    v_sqrt_f32 v152, v152
    s_nop 0
    v_cvt_pk_bf16_f32 v152, v152, v152
    v_and_b32 v152, 0xffff0000, v152
    v_rcp_f32 v152, v152
    v_lshlrev_b32 v160, 16, v0
    v_and_b32 v161, 0xffff0000, v0
    v_lshlrev_b32 v162, 16, v1
    v_and_b32 v163, 0xffff0000, v1
    v_lshlrev_b32 v164, 16, v2
    v_and_b32 v165, 0xffff0000, v2
    v_lshlrev_b32 v166, 16, v3
    v_and_b32 v167, 0xffff0000, v3
    v_lshlrev_b32 v168, 16, v4
    v_and_b32 v169, 0xffff0000, v4
    v_lshlrev_b32 v170, 16, v5
    v_and_b32 v171, 0xffff0000, v5
    v_lshlrev_b32 v172, 16, v6
    v_and_b32 v173, 0xffff0000, v6
    v_lshlrev_b32 v174, 16, v7
    v_and_b32 v175, 0xffff0000, v7
    v_pk_add_f32 v[160:161], v[160:161], v[154:155] op_sel_hi:[1,0] neg_lo:[0,1] neg_hi:[0,1]
    v_pk_add_f32 v[162:163], v[162:163], v[154:155] op_sel_hi:[1,0] neg_lo:[0,1] neg_hi:[0,1]
    v_pk_add_f32 v[164:165], v[164:165], v[154:155] op_sel_hi:[1,0] neg_lo:[0,1] neg_hi:[0,1]
    v_pk_add_f32 v[166:167], v[166:167], v[154:155] op_sel_hi:[1,0] neg_lo:[0,1] neg_hi:[0,1]
    v_pk_add_f32 v[168:169], v[168:169], v[154:155] op_sel_hi:[1,0] neg_lo:[0,1] neg_hi:[0,1]
    v_pk_add_f32 v[170:171], v[170:171], v[154:155] op_sel_hi:[1,0] neg_lo:[0,1] neg_hi:[0,1]
    v_pk_add_f32 v[172:173], v[172:173], v[154:155] op_sel_hi:[1,0] neg_lo:[0,1] neg_hi:[0,1]
    v_pk_add_f32 v[174:175], v[174:175], v[154:155] op_sel_hi:[1,0] neg_lo:[0,1] neg_hi:[0,1]
    v_cvt_pk_bf16_f32 v0, v160, v161
    v_cvt_pk_bf16_f32 v1, v162, v163
    v_cvt_pk_bf16_f32 v2, v164, v165
    v_cvt_pk_bf16_f32 v3, v166, v167
    v_cvt_pk_bf16_f32 v4, v168, v169
    v_cvt_pk_bf16_f32 v5, v170, v171
    v_cvt_pk_bf16_f32 v6, v172, v173
    v_cvt_pk_bf16_f32 v7, v174, v175
    v_lshlrev_b32 v160, 16, v0
    v_and_b32 v161, 0xffff0000, v0
    v_lshlrev_b32 v162, 16, v1
    v_and_b32 v163, 0xffff0000, v1
    v_lshlrev_b32 v164, 16, v2
    v_and_b32 v165, 0xffff0000, v2
    v_lshlrev_b32 v166, 16, v3
    v_and_b32 v167, 0xffff0000, v3
    v_lshlrev_b32 v168, 16, v4
    v_and_b32 v169, 0xffff0000, v4
    v_lshlrev_b32 v170, 16, v5
    v_and_b32 v171, 0xffff0000, v5
    v_lshlrev_b32 v172, 16, v6
    v_and_b32 v173, 0xffff0000, v6
    v_lshlrev_b32 v174, 16, v7
    v_and_b32 v175, 0xffff0000, v7
    v_pk_mul_f32 v[160:161], v[160:161], v[152:153] op_sel_hi:[1,0]
    v_pk_mul_f32 v[162:163], v[162:163], v[152:153] op_sel_hi:[1,0]
    v_pk_mul_f32 v[164:165], v[164:165], v[152:153] op_sel_hi:[1,0]
    v_pk_mul_f32 v[166:167], v[166:167], v[152:153] op_sel_hi:[1,0]
    v_pk_mul_f32 v[168:169], v[168:169], v[152:153] op_sel_hi:[1,0]
    v_pk_mul_f32 v[170:171], v[170:171], v[152:153] op_sel_hi:[1,0]
    v_pk_mul_f32 v[172:173], v[172:173], v[152:153] op_sel_hi:[1,0]
    v_pk_mul_f32 v[174:175], v[174:175], v[152:153] op_sel_hi:[1,0]
    v_cvt_pk_bf16_f32 v160, v160, v161
    v_cvt_pk_bf16_f32 v162, v162, v163
    v_cvt_pk_bf16_f32 v164, v164, v165
    v_cvt_pk_bf16_f32 v166, v166, v167
    v_cvt_pk_bf16_f32 v168, v168, v169
    v_cvt_pk_bf16_f32 v170, v170, v171
    v_cvt_pk_bf16_f32 v172, v172, v173
    v_cvt_pk_bf16_f32 v174, v174, v175
    v_accvgpr_write_b32 a0, v160
    v_accvgpr_write_b32 a1, v162
    v_accvgpr_write_b32 a2, v164
    v_accvgpr_write_b32 a3, v166
    v_accvgpr_write_b32 a4, v168
    v_accvgpr_write_b32 a5, v170
    v_accvgpr_write_b32 a6, v172
    v_accvgpr_write_b32 a7, v174
    v_lshlrev_b32 v160, 16, v8
    v_and_b32 v161, 0xffff0000, v8
    v_lshlrev_b32 v162, 16, v9
    v_and_b32 v163, 0xffff0000, v9
    v_lshlrev_b32 v164, 16, v10
    v_and_b32 v165, 0xffff0000, v10
    v_lshlrev_b32 v166, 16, v11
    v_and_b32 v167, 0xffff0000, v11
    v_lshlrev_b32 v168, 16, v12
    v_and_b32 v169, 0xffff0000, v12
    v_lshlrev_b32 v170, 16, v13
    v_and_b32 v171, 0xffff0000, v13
    v_lshlrev_b32 v172, 16, v14
    v_and_b32 v173, 0xffff0000, v14
    v_lshlrev_b32 v174, 16, v15
    v_and_b32 v175, 0xffff0000, v15
    v_pk_add_f32 v[160:161], v[160:161], v[154:155] op_sel_hi:[1,0] neg_lo:[0,1] neg_hi:[0,1]
    v_pk_add_f32 v[162:163], v[162:163], v[154:155] op_sel_hi:[1,0] neg_lo:[0,1] neg_hi:[0,1]
    v_pk_add_f32 v[164:165], v[164:165], v[154:155] op_sel_hi:[1,0] neg_lo:[0,1] neg_hi:[0,1]
    v_pk_add_f32 v[166:167], v[166:167], v[154:155] op_sel_hi:[1,0] neg_lo:[0,1] neg_hi:[0,1]
    v_pk_add_f32 v[168:169], v[168:169], v[154:155] op_sel_hi:[1,0] neg_lo:[0,1] neg_hi:[0,1]
    v_pk_add_f32 v[170:171], v[170:171], v[154:155] op_sel_hi:[1,0] neg_lo:[0,1] neg_hi:[0,1]
    v_pk_add_f32 v[172:173], v[172:173], v[154:155] op_sel_hi:[1,0] neg_lo:[0,1] neg_hi:[0,1]
    v_pk_add_f32 v[174:175], v[174:175], v[154:155] op_sel_hi:[1,0] neg_lo:[0,1] neg_hi:[0,1]
    v_cvt_pk_bf16_f32 v8, v160, v161
    v_cvt_pk_bf16_f32 v9, v162, v163
    v_cvt_pk_bf16_f32 v10, v164, v165
    v_cvt_pk_bf16_f32 v11, v166, v167
    v_cvt_pk_bf16_f32 v12, v168, v169
    v_cvt_pk_bf16_f32 v13, v170, v171
    v_cvt_pk_bf16_f32 v14, v172, v173
    v_cvt_pk_bf16_f32 v15, v174, v175
    v_lshlrev_b32 v160, 16, v8
    v_and_b32 v161, 0xffff0000, v8
    v_lshlrev_b32 v162, 16, v9
    v_and_b32 v163, 0xffff0000, v9
    v_lshlrev_b32 v164, 16, v10
    v_and_b32 v165, 0xffff0000, v10
    v_lshlrev_b32 v166, 16, v11
    v_and_b32 v167, 0xffff0000, v11
    v_lshlrev_b32 v168, 16, v12
    v_and_b32 v169, 0xffff0000, v12
    v_lshlrev_b32 v170, 16, v13
    v_and_b32 v171, 0xffff0000, v13
    v_lshlrev_b32 v172, 16, v14
    v_and_b32 v173, 0xffff0000, v14
    v_lshlrev_b32 v174, 16, v15
    v_and_b32 v175, 0xffff0000, v15
    v_pk_mul_f32 v[160:161], v[160:161], v[152:153] op_sel_hi:[1,0]
    v_pk_mul_f32 v[162:163], v[162:163], v[152:153] op_sel_hi:[1,0]
    v_pk_mul_f32 v[164:165], v[164:165], v[152:153] op_sel_hi:[1,0]
    v_pk_mul_f32 v[166:167], v[166:167], v[152:153] op_sel_hi:[1,0]
    v_pk_mul_f32 v[168:169], v[168:169], v[152:153] op_sel_hi:[1,0]
    v_pk_mul_f32 v[170:171], v[170:171], v[152:153] op_sel_hi:[1,0]
    v_pk_mul_f32 v[172:173], v[172:173], v[152:153] op_sel_hi:[1,0]
    v_pk_mul_f32 v[174:175], v[174:175], v[152:153] op_sel_hi:[1,0]
    v_cvt_pk_bf16_f32 v160, v160, v161
    v_cvt_pk_bf16_f32 v162, v162, v163
    v_cvt_pk_bf16_f32 v164, v164, v165
    v_cvt_pk_bf16_f32 v166, v166, v167
    v_cvt_pk_bf16_f32 v168, v168, v169
    v_cvt_pk_bf16_f32 v170, v170, v171
    v_cvt_pk_bf16_f32 v172, v172, v173
    v_cvt_pk_bf16_f32 v174, v174, v175
    v_accvgpr_write_b32 a8, v160
    v_accvgpr_write_b32 a9, v162
    v_accvgpr_write_b32 a10, v164
    v_accvgpr_write_b32 a11, v166
    v_accvgpr_write_b32 a12, v168
    v_accvgpr_write_b32 a13, v170
    v_accvgpr_write_b32 a14, v172
    v_accvgpr_write_b32 a15, v174
    v_lshlrev_b32 v160, 16, v16
    v_and_b32 v161, 0xffff0000, v16
    v_lshlrev_b32 v162, 16, v17
    v_and_b32 v163, 0xffff0000, v17
    v_lshlrev_b32 v164, 16, v18
    v_and_b32 v165, 0xffff0000, v18
    v_lshlrev_b32 v166, 16, v19
    v_and_b32 v167, 0xffff0000, v19
    v_lshlrev_b32 v168, 16, v20
    v_and_b32 v169, 0xffff0000, v20
    v_lshlrev_b32 v170, 16, v21
    v_and_b32 v171, 0xffff0000, v21
    v_lshlrev_b32 v172, 16, v22
    v_and_b32 v173, 0xffff0000, v22
    v_lshlrev_b32 v174, 16, v23
    v_and_b32 v175, 0xffff0000, v23
    v_pk_add_f32 v[160:161], v[160:161], v[154:155] op_sel_hi:[1,0] neg_lo:[0,1] neg_hi:[0,1]
    v_pk_add_f32 v[162:163], v[162:163], v[154:155] op_sel_hi:[1,0] neg_lo:[0,1] neg_hi:[0,1]
    v_pk_add_f32 v[164:165], v[164:165], v[154:155] op_sel_hi:[1,0] neg_lo:[0,1] neg_hi:[0,1]
    v_pk_add_f32 v[166:167], v[166:167], v[154:155] op_sel_hi:[1,0] neg_lo:[0,1] neg_hi:[0,1]
    v_pk_add_f32 v[168:169], v[168:169], v[154:155] op_sel_hi:[1,0] neg_lo:[0,1] neg_hi:[0,1]
    v_pk_add_f32 v[170:171], v[170:171], v[154:155] op_sel_hi:[1,0] neg_lo:[0,1] neg_hi:[0,1]
    v_pk_add_f32 v[172:173], v[172:173], v[154:155] op_sel_hi:[1,0] neg_lo:[0,1] neg_hi:[0,1]
    v_pk_add_f32 v[174:175], v[174:175], v[154:155] op_sel_hi:[1,0] neg_lo:[0,1] neg_hi:[0,1]
    v_cvt_pk_bf16_f32 v16, v160, v161
    v_cvt_pk_bf16_f32 v17, v162, v163
    v_cvt_pk_bf16_f32 v18, v164, v165
    v_cvt_pk_bf16_f32 v19, v166, v167
    v_cvt_pk_bf16_f32 v20, v168, v169
    v_cvt_pk_bf16_f32 v21, v170, v171
    v_cvt_pk_bf16_f32 v22, v172, v173
    v_cvt_pk_bf16_f32 v23, v174, v175
    v_lshlrev_b32 v160, 16, v16
    v_and_b32 v161, 0xffff0000, v16
    v_lshlrev_b32 v162, 16, v17
    v_and_b32 v163, 0xffff0000, v17
    v_lshlrev_b32 v164, 16, v18
    v_and_b32 v165, 0xffff0000, v18
    v_lshlrev_b32 v166, 16, v19
    v_and_b32 v167, 0xffff0000, v19
    v_lshlrev_b32 v168, 16, v20
    v_and_b32 v169, 0xffff0000, v20
    v_lshlrev_b32 v170, 16, v21
    v_and_b32 v171, 0xffff0000, v21
    v_lshlrev_b32 v172, 16, v22
    v_and_b32 v173, 0xffff0000, v22
    v_lshlrev_b32 v174, 16, v23
    v_and_b32 v175, 0xffff0000, v23
    v_pk_mul_f32 v[160:161], v[160:161], v[152:153] op_sel_hi:[1,0]
    v_pk_mul_f32 v[162:163], v[162:163], v[152:153] op_sel_hi:[1,0]
    v_pk_mul_f32 v[164:165], v[164:165], v[152:153] op_sel_hi:[1,0]
    v_pk_mul_f32 v[166:167], v[166:167], v[152:153] op_sel_hi:[1,0]
    v_pk_mul_f32 v[168:169], v[168:169], v[152:153] op_sel_hi:[1,0]
    v_pk_mul_f32 v[170:171], v[170:171], v[152:153] op_sel_hi:[1,0]
    v_pk_mul_f32 v[172:173], v[172:173], v[152:153] op_sel_hi:[1,0]
    v_pk_mul_f32 v[174:175], v[174:175], v[152:153] op_sel_hi:[1,0]
    v_cvt_pk_bf16_f32 v160, v160, v161
    v_cvt_pk_bf16_f32 v162, v162, v163
    v_cvt_pk_bf16_f32 v164, v164, v165
    v_cvt_pk_bf16_f32 v166, v166, v167
    v_cvt_pk_bf16_f32 v168, v168, v169
    v_cvt_pk_bf16_f32 v170, v170, v171
    v_cvt_pk_bf16_f32 v172, v172, v173
    v_cvt_pk_bf16_f32 v174, v174, v175
    v_accvgpr_write_b32 a16, v160
    v_accvgpr_write_b32 a17, v162
    v_accvgpr_write_b32 a18, v164
    v_accvgpr_write_b32 a19, v166
    v_accvgpr_write_b32 a20, v168
    v_accvgpr_write_b32 a21, v170
    v_accvgpr_write_b32 a22, v172
    v_accvgpr_write_b32 a23, v174
    v_lshlrev_b32 v160, 16, v24
    v_and_b32 v161, 0xffff0000, v24
    v_lshlrev_b32 v162, 16, v25
    v_and_b32 v163, 0xffff0000, v25
    v_lshlrev_b32 v164, 16, v26
    v_and_b32 v165, 0xffff0000, v26
    v_lshlrev_b32 v166, 16, v27
    v_and_b32 v167, 0xffff0000, v27
    v_lshlrev_b32 v168, 16, v28
    v_and_b32 v169, 0xffff0000, v28
    v_lshlrev_b32 v170, 16, v29
    v_and_b32 v171, 0xffff0000, v29
    v_lshlrev_b32 v172, 16, v30
    v_and_b32 v173, 0xffff0000, v30
    v_lshlrev_b32 v174, 16, v31
    v_and_b32 v175, 0xffff0000, v31
    v_pk_add_f32 v[160:161], v[160:161], v[154:155] op_sel_hi:[1,0] neg_lo:[0,1] neg_hi:[0,1]
    v_pk_add_f32 v[162:163], v[162:163], v[154:155] op_sel_hi:[1,0] neg_lo:[0,1] neg_hi:[0,1]
    v_pk_add_f32 v[164:165], v[164:165], v[154:155] op_sel_hi:[1,0] neg_lo:[0,1] neg_hi:[0,1]
    v_pk_add_f32 v[166:167], v[166:167], v[154:155] op_sel_hi:[1,0] neg_lo:[0,1] neg_hi:[0,1]
    v_pk_add_f32 v[168:169], v[168:169], v[154:155] op_sel_hi:[1,0] neg_lo:[0,1] neg_hi:[0,1]
    v_pk_add_f32 v[170:171], v[170:171], v[154:155] op_sel_hi:[1,0] neg_lo:[0,1] neg_hi:[0,1]
    v_pk_add_f32 v[172:173], v[172:173], v[154:155] op_sel_hi:[1,0] neg_lo:[0,1] neg_hi:[0,1]
    v_pk_add_f32 v[174:175], v[174:175], v[154:155] op_sel_hi:[1,0] neg_lo:[0,1] neg_hi:[0,1]
    v_cvt_pk_bf16_f32 v24, v160, v161
    v_cvt_pk_bf16_f32 v25, v162, v163
    v_cvt_pk_bf16_f32 v26, v164, v165
    v_cvt_pk_bf16_f32 v27, v166, v167
    v_cvt_pk_bf16_f32 v28, v168, v169
    v_cvt_pk_bf16_f32 v29, v170, v171
    v_cvt_pk_bf16_f32 v30, v172, v173
    v_cvt_pk_bf16_f32 v31, v174, v175
    v_lshlrev_b32 v160, 16, v24
    v_and_b32 v161, 0xffff0000, v24
    v_lshlrev_b32 v162, 16, v25
    v_and_b32 v163, 0xffff0000, v25
    v_lshlrev_b32 v164, 16, v26
    v_and_b32 v165, 0xffff0000, v26
    v_lshlrev_b32 v166, 16, v27
    v_and_b32 v167, 0xffff0000, v27
    v_lshlrev_b32 v168, 16, v28
    v_and_b32 v169, 0xffff0000, v28
    v_lshlrev_b32 v170, 16, v29
    v_and_b32 v171, 0xffff0000, v29
    v_lshlrev_b32 v172, 16, v30
    v_and_b32 v173, 0xffff0000, v30
    v_lshlrev_b32 v174, 16, v31
    v_and_b32 v175, 0xffff0000, v31
    v_pk_mul_f32 v[160:161], v[160:161], v[152:153] op_sel_hi:[1,0]
    v_pk_mul_f32 v[162:163], v[162:163], v[152:153] op_sel_hi:[1,0]
    v_pk_mul_f32 v[164:165], v[164:165], v[152:153] op_sel_hi:[1,0]
    v_pk_mul_f32 v[166:167], v[166:167], v[152:153] op_sel_hi:[1,0]
    v_pk_mul_f32 v[168:169], v[168:169], v[152:153] op_sel_hi:[1,0]
    v_pk_mul_f32 v[170:171], v[170:171], v[152:153] op_sel_hi:[1,0]
    v_pk_mul_f32 v[172:173], v[172:173], v[152:153] op_sel_hi:[1,0]
    v_pk_mul_f32 v[174:175], v[174:175], v[152:153] op_sel_hi:[1,0]
    v_cvt_pk_bf16_f32 v160, v160, v161
    v_cvt_pk_bf16_f32 v162, v162, v163
    v_cvt_pk_bf16_f32 v164, v164, v165
    v_cvt_pk_bf16_f32 v166, v166, v167
    v_cvt_pk_bf16_f32 v168, v168, v169
    v_cvt_pk_bf16_f32 v170, v170, v171
    v_cvt_pk_bf16_f32 v172, v172, v173
    v_cvt_pk_bf16_f32 v174, v174, v175
    v_accvgpr_write_b32 a24, v160
    v_accvgpr_write_b32 a25, v162
    v_accvgpr_write_b32 a26, v164
    v_accvgpr_write_b32 a27, v166
    v_accvgpr_write_b32 a28, v168
    v_accvgpr_write_b32 a29, v170
    v_accvgpr_write_b32 a30, v172
    v_accvgpr_write_b32 a31, v174
    v_lshlrev_b32 v160, 16, v32
    v_and_b32 v161, 0xffff0000, v32
    v_lshlrev_b32 v162, 16, v33
    v_and_b32 v163, 0xffff0000, v33
    v_lshlrev_b32 v164, 16, v34
    v_and_b32 v165, 0xffff0000, v34
    v_lshlrev_b32 v166, 16, v35
    v_and_b32 v167, 0xffff0000, v35
    v_lshlrev_b32 v168, 16, v36
    v_and_b32 v169, 0xffff0000, v36
    v_lshlrev_b32 v170, 16, v37
    v_and_b32 v171, 0xffff0000, v37
    v_lshlrev_b32 v172, 16, v38
    v_and_b32 v173, 0xffff0000, v38
    v_lshlrev_b32 v174, 16, v39
    v_and_b32 v175, 0xffff0000, v39
    v_pk_add_f32 v[160:161], v[160:161], v[154:155] op_sel_hi:[1,0] neg_lo:[0,1] neg_hi:[0,1]
    v_pk_add_f32 v[162:163], v[162:163], v[154:155] op_sel_hi:[1,0] neg_lo:[0,1] neg_hi:[0,1]
    v_pk_add_f32 v[164:165], v[164:165], v[154:155] op_sel_hi:[1,0] neg_lo:[0,1] neg_hi:[0,1]
    v_pk_add_f32 v[166:167], v[166:167], v[154:155] op_sel_hi:[1,0] neg_lo:[0,1] neg_hi:[0,1]
    v_pk_add_f32 v[168:169], v[168:169], v[154:155] op_sel_hi:[1,0] neg_lo:[0,1] neg_hi:[0,1]
    v_pk_add_f32 v[170:171], v[170:171], v[154:155] op_sel_hi:[1,0] neg_lo:[0,1] neg_hi:[0,1]
    v_pk_add_f32 v[172:173], v[172:173], v[154:155] op_sel_hi:[1,0] neg_lo:[0,1] neg_hi:[0,1]
    v_pk_add_f32 v[174:175], v[174:175], v[154:155] op_sel_hi:[1,0] neg_lo:[0,1] neg_hi:[0,1]
    v_cvt_pk_bf16_f32 v32, v160, v161
    v_cvt_pk_bf16_f32 v33, v162, v163
    v_cvt_pk_bf16_f32 v34, v164, v165
    v_cvt_pk_bf16_f32 v35, v166, v167
    v_cvt_pk_bf16_f32 v36, v168, v169
    v_cvt_pk_bf16_f32 v37, v170, v171
    v_cvt_pk_bf16_f32 v38, v172, v173
    v_cvt_pk_bf16_f32 v39, v174, v175
    v_lshlrev_b32 v160, 16, v32
    v_and_b32 v161, 0xffff0000, v32
    v_lshlrev_b32 v162, 16, v33
    v_and_b32 v163, 0xffff0000, v33
    v_lshlrev_b32 v164, 16, v34
    v_and_b32 v165, 0xffff0000, v34
    v_lshlrev_b32 v166, 16, v35
    v_and_b32 v167, 0xffff0000, v35
    v_lshlrev_b32 v168, 16, v36
    v_and_b32 v169, 0xffff0000, v36
    v_lshlrev_b32 v170, 16, v37
    v_and_b32 v171, 0xffff0000, v37
    v_lshlrev_b32 v172, 16, v38
    v_and_b32 v173, 0xffff0000, v38
    v_lshlrev_b32 v174, 16, v39
    v_and_b32 v175, 0xffff0000, v39
    v_pk_mul_f32 v[160:161], v[160:161], v[152:153] op_sel_hi:[1,0]
    v_pk_mul_f32 v[162:163], v[162:163], v[152:153] op_sel_hi:[1,0]
    v_pk_mul_f32 v[164:165], v[164:165], v[152:153] op_sel_hi:[1,0]
    v_pk_mul_f32 v[166:167], v[166:167], v[152:153] op_sel_hi:[1,0]
    v_pk_mul_f32 v[168:169], v[168:169], v[152:153] op_sel_hi:[1,0]
    v_pk_mul_f32 v[170:171], v[170:171], v[152:153] op_sel_hi:[1,0]
    v_pk_mul_f32 v[172:173], v[172:173], v[152:153] op_sel_hi:[1,0]
    v_pk_mul_f32 v[174:175], v[174:175], v[152:153] op_sel_hi:[1,0]
    v_cvt_pk_bf16_f32 v160, v160, v161
    v_cvt_pk_bf16_f32 v162, v162, v163
    v_cvt_pk_bf16_f32 v164, v164, v165
    v_cvt_pk_bf16_f32 v166, v166, v167
    v_cvt_pk_bf16_f32 v168, v168, v169
    v_cvt_pk_bf16_f32 v170, v170, v171
    v_cvt_pk_bf16_f32 v172, v172, v173
    v_cvt_pk_bf16_f32 v174, v174, v175
    v_accvgpr_write_b32 a32, v160
    v_accvgpr_write_b32 a33, v162
    v_accvgpr_write_b32 a34, v164
    v_accvgpr_write_b32 a35, v166
    v_accvgpr_write_b32 a36, v168
    v_accvgpr_write_b32 a37, v170
    v_accvgpr_write_b32 a38, v172
    v_accvgpr_write_b32 a39, v174
    v_lshlrev_b32 v160, 16, v40
    v_and_b32 v161, 0xffff0000, v40
    v_lshlrev_b32 v162, 16, v41
    v_and_b32 v163, 0xffff0000, v41
    v_lshlrev_b32 v164, 16, v42
    v_and_b32 v165, 0xffff0000, v42
    v_lshlrev_b32 v166, 16, v43
    v_and_b32 v167, 0xffff0000, v43
    v_lshlrev_b32 v168, 16, v44
    v_and_b32 v169, 0xffff0000, v44
    v_lshlrev_b32 v170, 16, v45
    v_and_b32 v171, 0xffff0000, v45
    v_lshlrev_b32 v172, 16, v46
    v_and_b32 v173, 0xffff0000, v46
    v_lshlrev_b32 v174, 16, v47
    v_and_b32 v175, 0xffff0000, v47
    v_pk_add_f32 v[160:161], v[160:161], v[154:155] op_sel_hi:[1,0] neg_lo:[0,1] neg_hi:[0,1]
    v_pk_add_f32 v[162:163], v[162:163], v[154:155] op_sel_hi:[1,0] neg_lo:[0,1] neg_hi:[0,1]
    v_pk_add_f32 v[164:165], v[164:165], v[154:155] op_sel_hi:[1,0] neg_lo:[0,1] neg_hi:[0,1]
    v_pk_add_f32 v[166:167], v[166:167], v[154:155] op_sel_hi:[1,0] neg_lo:[0,1] neg_hi:[0,1]
    v_pk_add_f32 v[168:169], v[168:169], v[154:155] op_sel_hi:[1,0] neg_lo:[0,1] neg_hi:[0,1]
    v_pk_add_f32 v[170:171], v[170:171], v[154:155] op_sel_hi:[1,0] neg_lo:[0,1] neg_hi:[0,1]
    v_pk_add_f32 v[172:173], v[172:173], v[154:155] op_sel_hi:[1,0] neg_lo:[0,1] neg_hi:[0,1]
    v_pk_add_f32 v[174:175], v[174:175], v[154:155] op_sel_hi:[1,0] neg_lo:[0,1] neg_hi:[0,1]
    v_cvt_pk_bf16_f32 v40, v160, v161
    v_cvt_pk_bf16_f32 v41, v162, v163
    v_cvt_pk_bf16_f32 v42, v164, v165
    v_cvt_pk_bf16_f32 v43, v166, v167
    v_cvt_pk_bf16_f32 v44, v168, v169
    v_cvt_pk_bf16_f32 v45, v170, v171
    v_cvt_pk_bf16_f32 v46, v172, v173
    v_cvt_pk_bf16_f32 v47, v174, v175
    v_lshlrev_b32 v160, 16, v40
    v_and_b32 v161, 0xffff0000, v40
    v_lshlrev_b32 v162, 16, v41
    v_and_b32 v163, 0xffff0000, v41
    v_lshlrev_b32 v164, 16, v42
    v_and_b32 v165, 0xffff0000, v42
    v_lshlrev_b32 v166, 16, v43
    v_and_b32 v167, 0xffff0000, v43
    v_lshlrev_b32 v168, 16, v44
    v_and_b32 v169, 0xffff0000, v44
    v_lshlrev_b32 v170, 16, v45
    v_and_b32 v171, 0xffff0000, v45
    v_lshlrev_b32 v172, 16, v46
    v_and_b32 v173, 0xffff0000, v46
    v_lshlrev_b32 v174, 16, v47
    v_and_b32 v175, 0xffff0000, v47
    v_pk_mul_f32 v[160:161], v[160:161], v[152:153] op_sel_hi:[1,0]
    v_pk_mul_f32 v[162:163], v[162:163], v[152:153] op_sel_hi:[1,0]
    v_pk_mul_f32 v[164:165], v[164:165], v[152:153] op_sel_hi:[1,0]
    v_pk_mul_f32 v[166:167], v[166:167], v[152:153] op_sel_hi:[1,0]
    v_pk_mul_f32 v[168:169], v[168:169], v[152:153] op_sel_hi:[1,0]
    v_pk_mul_f32 v[170:171], v[170:171], v[152:153] op_sel_hi:[1,0]
    v_pk_mul_f32 v[172:173], v[172:173], v[152:153] op_sel_hi:[1,0]
    v_pk_mul_f32 v[174:175], v[174:175], v[152:153] op_sel_hi:[1,0]
    v_cvt_pk_bf16_f32 v160, v160, v161
    v_cvt_pk_bf16_f32 v162, v162, v163
    v_cvt_pk_bf16_f32 v164, v164, v165
    v_cvt_pk_bf16_f32 v166, v166, v167
    v_cvt_pk_bf16_f32 v168, v168, v169
    v_cvt_pk_bf16_f32 v170, v170, v171
    v_cvt_pk_bf16_f32 v172, v172, v173
    v_cvt_pk_bf16_f32 v174, v174, v175
    v_accvgpr_write_b32 a40, v160
    v_accvgpr_write_b32 a41, v162
    v_accvgpr_write_b32 a42, v164
    v_accvgpr_write_b32 a43, v166
    v_accvgpr_write_b32 a44, v168
    v_accvgpr_write_b32 a45, v170
    v_accvgpr_write_b32 a46, v172
    v_accvgpr_write_b32 a47, v174
    v_lshlrev_b32 v160, 16, v48
    v_and_b32 v161, 0xffff0000, v48
    v_lshlrev_b32 v162, 16, v49
    v_and_b32 v163, 0xffff0000, v49
    v_lshlrev_b32 v164, 16, v50
    v_and_b32 v165, 0xffff0000, v50
    v_lshlrev_b32 v166, 16, v51
    v_and_b32 v167, 0xffff0000, v51
    v_lshlrev_b32 v168, 16, v52
    v_and_b32 v169, 0xffff0000, v52
    v_lshlrev_b32 v170, 16, v53
    v_and_b32 v171, 0xffff0000, v53
    v_lshlrev_b32 v172, 16, v54
    v_and_b32 v173, 0xffff0000, v54
    v_lshlrev_b32 v174, 16, v55
    v_and_b32 v175, 0xffff0000, v55
    v_pk_add_f32 v[160:161], v[160:161], v[154:155] op_sel_hi:[1,0] neg_lo:[0,1] neg_hi:[0,1]
    v_pk_add_f32 v[162:163], v[162:163], v[154:155] op_sel_hi:[1,0] neg_lo:[0,1] neg_hi:[0,1]
    v_pk_add_f32 v[164:165], v[164:165], v[154:155] op_sel_hi:[1,0] neg_lo:[0,1] neg_hi:[0,1]
    v_pk_add_f32 v[166:167], v[166:167], v[154:155] op_sel_hi:[1,0] neg_lo:[0,1] neg_hi:[0,1]
    v_pk_add_f32 v[168:169], v[168:169], v[154:155] op_sel_hi:[1,0] neg_lo:[0,1] neg_hi:[0,1]
    v_pk_add_f32 v[170:171], v[170:171], v[154:155] op_sel_hi:[1,0] neg_lo:[0,1] neg_hi:[0,1]
    v_pk_add_f32 v[172:173], v[172:173], v[154:155] op_sel_hi:[1,0] neg_lo:[0,1] neg_hi:[0,1]
    v_pk_add_f32 v[174:175], v[174:175], v[154:155] op_sel_hi:[1,0] neg_lo:[0,1] neg_hi:[0,1]
    v_cvt_pk_bf16_f32 v48, v160, v161
    v_cvt_pk_bf16_f32 v49, v162, v163
    v_cvt_pk_bf16_f32 v50, v164, v165
    v_cvt_pk_bf16_f32 v51, v166, v167
    v_cvt_pk_bf16_f32 v52, v168, v169
    v_cvt_pk_bf16_f32 v53, v170, v171
    v_cvt_pk_bf16_f32 v54, v172, v173
    v_cvt_pk_bf16_f32 v55, v174, v175
    v_lshlrev_b32 v160, 16, v48
    v_and_b32 v161, 0xffff0000, v48
    v_lshlrev_b32 v162, 16, v49
    v_and_b32 v163, 0xffff0000, v49
    v_lshlrev_b32 v164, 16, v50
    v_and_b32 v165, 0xffff0000, v50
    v_lshlrev_b32 v166, 16, v51
    v_and_b32 v167, 0xffff0000, v51
    v_lshlrev_b32 v168, 16, v52
    v_and_b32 v169, 0xffff0000, v52
    v_lshlrev_b32 v170, 16, v53
    v_and_b32 v171, 0xffff0000, v53
    v_lshlrev_b32 v172, 16, v54
    v_and_b32 v173, 0xffff0000, v54
    v_lshlrev_b32 v174, 16, v55
    v_and_b32 v175, 0xffff0000, v55
    v_pk_mul_f32 v[160:161], v[160:161], v[152:153] op_sel_hi:[1,0]
    v_pk_mul_f32 v[162:163], v[162:163], v[152:153] op_sel_hi:[1,0]
    v_pk_mul_f32 v[164:165], v[164:165], v[152:153] op_sel_hi:[1,0]
    v_pk_mul_f32 v[166:167], v[166:167], v[152:153] op_sel_hi:[1,0]
    v_pk_mul_f32 v[168:169], v[168:169], v[152:153] op_sel_hi:[1,0]
    v_pk_mul_f32 v[170:171], v[170:171], v[152:153] op_sel_hi:[1,0]
    v_pk_mul_f32 v[172:173], v[172:173], v[152:153] op_sel_hi:[1,0]
    v_pk_mul_f32 v[174:175], v[174:175], v[152:153] op_sel_hi:[1,0]
    v_cvt_pk_bf16_f32 v160, v160, v161
    v_cvt_pk_bf16_f32 v162, v162, v163
    v_cvt_pk_bf16_f32 v164, v164, v165
    v_cvt_pk_bf16_f32 v166, v166, v167
    v_cvt_pk_bf16_f32 v168, v168, v169
    v_cvt_pk_bf16_f32 v170, v170, v171
    v_cvt_pk_bf16_f32 v172, v172, v173
    v_cvt_pk_bf16_f32 v174, v174, v175
    v_accvgpr_write_b32 a48, v160
    v_accvgpr_write_b32 a49, v162
    v_accvgpr_write_b32 a50, v164
    v_accvgpr_write_b32 a51, v166
    v_accvgpr_write_b32 a52, v168
    v_accvgpr_write_b32 a53, v170
    v_accvgpr_write_b32 a54, v172
    v_accvgpr_write_b32 a55, v174
    v_lshlrev_b32 v160, 16, v56
    v_and_b32 v161, 0xffff0000, v56
    v_lshlrev_b32 v162, 16, v57
    v_and_b32 v163, 0xffff0000, v57
    v_lshlrev_b32 v164, 16, v58
    v_and_b32 v165, 0xffff0000, v58
    v_lshlrev_b32 v166, 16, v59
    v_and_b32 v167, 0xffff0000, v59
    v_lshlrev_b32 v168, 16, v60
    v_and_b32 v169, 0xffff0000, v60
    v_lshlrev_b32 v170, 16, v61
    v_and_b32 v171, 0xffff0000, v61
    v_lshlrev_b32 v172, 16, v62
    v_and_b32 v173, 0xffff0000, v62
    v_lshlrev_b32 v174, 16, v63
    v_and_b32 v175, 0xffff0000, v63
    v_pk_add_f32 v[160:161], v[160:161], v[154:155] op_sel_hi:[1,0] neg_lo:[0,1] neg_hi:[0,1]
    v_pk_add_f32 v[162:163], v[162:163], v[154:155] op_sel_hi:[1,0] neg_lo:[0,1] neg_hi:[0,1]
    v_pk_add_f32 v[164:165], v[164:165], v[154:155] op_sel_hi:[1,0] neg_lo:[0,1] neg_hi:[0,1]
    v_pk_add_f32 v[166:167], v[166:167], v[154:155] op_sel_hi:[1,0] neg_lo:[0,1] neg_hi:[0,1]
    v_pk_add_f32 v[168:169], v[168:169], v[154:155] op_sel_hi:[1,0] neg_lo:[0,1] neg_hi:[0,1]
    v_pk_add_f32 v[170:171], v[170:171], v[154:155] op_sel_hi:[1,0] neg_lo:[0,1] neg_hi:[0,1]
    v_pk_add_f32 v[172:173], v[172:173], v[154:155] op_sel_hi:[1,0] neg_lo:[0,1] neg_hi:[0,1]
    v_pk_add_f32 v[174:175], v[174:175], v[154:155] op_sel_hi:[1,0] neg_lo:[0,1] neg_hi:[0,1]
    v_cvt_pk_bf16_f32 v56, v160, v161
    v_cvt_pk_bf16_f32 v57, v162, v163
    v_cvt_pk_bf16_f32 v58, v164, v165
    v_cvt_pk_bf16_f32 v59, v166, v167
    v_cvt_pk_bf16_f32 v60, v168, v169
    v_cvt_pk_bf16_f32 v61, v170, v171
    v_cvt_pk_bf16_f32 v62, v172, v173
    v_cvt_pk_bf16_f32 v63, v174, v175
    v_lshlrev_b32 v160, 16, v56
    v_and_b32 v161, 0xffff0000, v56
    v_lshlrev_b32 v162, 16, v57
    v_and_b32 v163, 0xffff0000, v57
    v_lshlrev_b32 v164, 16, v58
    v_and_b32 v165, 0xffff0000, v58
    v_lshlrev_b32 v166, 16, v59
    v_and_b32 v167, 0xffff0000, v59
    v_lshlrev_b32 v168, 16, v60
    v_and_b32 v169, 0xffff0000, v60
    v_lshlrev_b32 v170, 16, v61
    v_and_b32 v171, 0xffff0000, v61
    v_lshlrev_b32 v172, 16, v62
    v_and_b32 v173, 0xffff0000, v62
    v_lshlrev_b32 v174, 16, v63
    v_and_b32 v175, 0xffff0000, v63
    v_pk_mul_f32 v[160:161], v[160:161], v[152:153] op_sel_hi:[1,0]
    v_pk_mul_f32 v[162:163], v[162:163], v[152:153] op_sel_hi:[1,0]
    v_pk_mul_f32 v[164:165], v[164:165], v[152:153] op_sel_hi:[1,0]
    v_pk_mul_f32 v[166:167], v[166:167], v[152:153] op_sel_hi:[1,0]
    v_pk_mul_f32 v[168:169], v[168:169], v[152:153] op_sel_hi:[1,0]
    v_pk_mul_f32 v[170:171], v[170:171], v[152:153] op_sel_hi:[1,0]
    v_pk_mul_f32 v[172:173], v[172:173], v[152:153] op_sel_hi:[1,0]
    v_pk_mul_f32 v[174:175], v[174:175], v[152:153] op_sel_hi:[1,0]
    v_cvt_pk_bf16_f32 v160, v160, v161
    v_cvt_pk_bf16_f32 v162, v162, v163
    v_cvt_pk_bf16_f32 v164, v164, v165
    v_cvt_pk_bf16_f32 v166, v166, v167
    v_cvt_pk_bf16_f32 v168, v168, v169
    v_cvt_pk_bf16_f32 v170, v170, v171
    v_cvt_pk_bf16_f32 v172, v172, v173
    v_cvt_pk_bf16_f32 v174, v174, v175
    v_accvgpr_write_b32 a56, v160
    v_accvgpr_write_b32 a57, v162
    v_accvgpr_write_b32 a58, v164
    v_accvgpr_write_b32 a59, v166
    v_accvgpr_write_b32 a60, v168
    v_accvgpr_write_b32 a61, v170
    v_accvgpr_write_b32 a62, v172
    v_accvgpr_write_b32 a63, v174
    s_waitcnt vmcnt(0)
    s_lshr_b32 s26, s39, 5
    s_cmp_eq_u32 s26, 0
    s_cselect_b64 s[16:17], s[30:31], s[34:35]
    s_cmp_eq_u32 s26, 1
    s_cselect_b64 s[16:17], s[32:33], s[16:17]
    s_and_b32 s17, s17, 0xffff
    s_cmp_lt_u32 s39, 96
    s_cselect_b32 s18, 0x400000, 0
    s_and_b32 s24, s39, 31
    s_lshl_b32 s24, s24, 8
    s_add_u32 s26, s24, 0x0
    s_add_u32 m0, s29, 0x0
    s_nop 0
    buffer_load_dwordx4 v136, s[16:19], s26 offen lds
    s_add_u32 s26, s24, 0x20000
    s_add_u32 m0, s29, 0x1000
    s_nop 0
    buffer_load_dwordx4 v136, s[16:19], s26 offen lds
    s_add_u32 s26, s24, 0x40000
    s_add_u32 m0, s29, 0x2000
    s_nop 0
    buffer_load_dwordx4 v136, s[16:19], s26 offen lds
    s_add_u32 s26, s24, 0x60000
    s_add_u32 m0, s29, 0x3000
    s_nop 0
    buffer_load_dwordx4 v136, s[16:19], s26 offen lds
    s_add_u32 s26, s24, 0x80000
    s_add_u32 m0, s29, 0x4000
    s_nop 0
    buffer_load_dwordx4 v136, s[16:19], s26 offen lds
    s_add_u32 s26, s24, 0xa0000
    s_add_u32 m0, s29, 0x5000
    s_nop 0
    buffer_load_dwordx4 v136, s[16:19], s26 offen lds
    s_add_u32 s26, s24, 0xc0000
    s_add_u32 m0, s29, 0x6000
    s_nop 0
    buffer_load_dwordx4 v136, s[16:19], s26 offen lds
    s_add_u32 s26, s24, 0xe0000
    s_add_u32 m0, s29, 0x7000
    s_nop 0
    buffer_load_dwordx4 v136, s[16:19], s26 offen lds
    s_add_u32 s26, s24, 0x100000
    s_add_u32 m0, s29, 0x8000
    s_nop 0
    buffer_load_dwordx4 v136, s[16:19], s26 offen lds
    s_add_u32 s26, s24, 0x120000
    s_add_u32 m0, s29, 0x9000
    s_nop 0
    buffer_load_dwordx4 v136, s[16:19], s26 offen lds
    s_add_u32 s26, s24, 0x140000
    s_add_u32 m0, s29, 0xa000
    s_nop 0
    buffer_load_dwordx4 v136, s[16:19], s26 offen lds
    s_add_u32 s26, s24, 0x160000
    s_add_u32 m0, s29, 0xb000
    s_nop 0
    buffer_load_dwordx4 v136, s[16:19], s26 offen lds
    s_add_u32 s26, s24, 0x180000
    s_add_u32 m0, s29, 0xc000
    s_nop 0
    buffer_load_dwordx4 v136, s[16:19], s26 offen lds
    s_add_u32 s26, s24, 0x1a0000
    s_add_u32 m0, s29, 0xd000
    s_nop 0
    buffer_load_dwordx4 v136, s[16:19], s26 offen lds
    s_add_u32 s26, s24, 0x1c0000
    s_add_u32 m0, s29, 0xe000
    s_nop 0
    buffer_load_dwordx4 v136, s[16:19], s26 offen lds
    s_add_u32 s26, s24, 0x1e0000
    s_add_u32 m0, s29, 0xf000
    s_nop 0
    buffer_load_dwordx4 v136, s[16:19], s26 offen lds
    s_add_u32 s26, s24, 0x200000
    s_add_u32 m0, s29, 0x10000
    s_nop 0
    buffer_load_dwordx4 v136, s[16:19], s26 offen lds
    s_add_u32 s26, s24, 0x220000
    s_add_u32 m0, s29, 0x11000
    s_nop 0
    buffer_load_dwordx4 v136, s[16:19], s26 offen lds
    s_add_u32 s26, s24, 0x240000
    s_add_u32 m0, s29, 0x12000
    s_nop 0
    buffer_load_dwordx4 v136, s[16:19], s26 offen lds
    s_add_u32 s26, s24, 0x260000
    s_add_u32 m0, s29, 0x13000
    s_nop 0
    buffer_load_dwordx4 v136, s[16:19], s26 offen lds
    s_add_u32 s26, s24, 0x280000
    s_add_u32 m0, s29, 0x14000
    s_nop 0
    buffer_load_dwordx4 v136, s[16:19], s26 offen lds
    s_add_u32 s26, s24, 0x2a0000
    s_add_u32 m0, s29, 0x15000
    s_nop 0
    buffer_load_dwordx4 v136, s[16:19], s26 offen lds
    s_add_u32 s26, s24, 0x2c0000
    s_add_u32 m0, s29, 0x16000
    s_nop 0
    buffer_load_dwordx4 v136, s[16:19], s26 offen lds
    s_add_u32 s26, s24, 0x2e0000
    s_add_u32 m0, s29, 0x17000
    s_nop 0
    buffer_load_dwordx4 v136, s[16:19], s26 offen lds
    v_pk_mov_b32 v[150:151], 0, 0
    v_pk_mov_b32 v[152:153], 0, 0
    v_dot2_f32_bf16 v150, v64, v158, v150
    v_dot2_f32_bf16 v152, v64, v64, v152
    v_dot2_f32_bf16 v151, v65, v158, v151
    v_dot2_f32_bf16 v153, v65, v65, v153
    v_dot2_f32_bf16 v150, v66, v158, v150
    v_dot2_f32_bf16 v152, v66, v66, v152
    v_dot2_f32_bf16 v151, v67, v158, v151
    v_dot2_f32_bf16 v153, v67, v67, v153
    v_dot2_f32_bf16 v150, v68, v158, v150
    v_dot2_f32_bf16 v152, v68, v68, v152
    v_dot2_f32_bf16 v151, v69, v158, v151
    v_dot2_f32_bf16 v153, v69, v69, v153
    v_dot2_f32_bf16 v150, v70, v158, v150
    v_dot2_f32_bf16 v152, v70, v70, v152
    v_dot2_f32_bf16 v151, v71, v158, v151
    v_dot2_f32_bf16 v153, v71, v71, v153
    v_dot2_f32_bf16 v150, v72, v158, v150
    v_dot2_f32_bf16 v152, v72, v72, v152
    v_dot2_f32_bf16 v151, v73, v158, v151
    v_dot2_f32_bf16 v153, v73, v73, v153
    v_dot2_f32_bf16 v150, v74, v158, v150
    v_dot2_f32_bf16 v152, v74, v74, v152
    v_dot2_f32_bf16 v151, v75, v158, v151
    v_dot2_f32_bf16 v153, v75, v75, v153
    v_dot2_f32_bf16 v150, v76, v158, v150
    v_dot2_f32_bf16 v152, v76, v76, v152
    v_dot2_f32_bf16 v151, v77, v158, v151
    v_dot2_f32_bf16 v153, v77, v77, v153
    v_dot2_f32_bf16 v150, v78, v158, v150
    v_dot2_f32_bf16 v152, v78, v78, v152
    v_dot2_f32_bf16 v151, v79, v158, v151
    v_dot2_f32_bf16 v153, v79, v79, v153
    v_dot2_f32_bf16 v150, v80, v158, v150
    v_dot2_f32_bf16 v152, v80, v80, v152
    v_dot2_f32_bf16 v151, v81, v158, v151
    v_dot2_f32_bf16 v153, v81, v81, v153
    v_dot2_f32_bf16 v150, v82, v158, v150
    v_dot2_f32_bf16 v152, v82, v82, v152
    v_dot2_f32_bf16 v151, v83, v158, v151
    v_dot2_f32_bf16 v153, v83, v83, v153
    v_dot2_f32_bf16 v150, v84, v158, v150
    v_dot2_f32_bf16 v152, v84, v84, v152
    v_dot2_f32_bf16 v151, v85, v158, v151
    v_dot2_f32_bf16 v153, v85, v85, v153
    v_dot2_f32_bf16 v150, v86, v158, v150
    v_dot2_f32_bf16 v152, v86, v86, v152
    v_dot2_f32_bf16 v151, v87, v158, v151
    v_dot2_f32_bf16 v153, v87, v87, v153
    v_dot2_f32_bf16 v150, v88, v158, v150
    v_dot2_f32_bf16 v152, v88, v88, v152
    v_dot2_f32_bf16 v151, v89, v158, v151
    v_dot2_f32_bf16 v153, v89, v89, v153
    v_dot2_f32_bf16 v150, v90, v158, v150
    v_dot2_f32_bf16 v152, v90, v90, v152
    v_dot2_f32_bf16 v151, v91, v158, v151
    v_dot2_f32_bf16 v153, v91, v91, v153
    v_dot2_f32_bf16 v150, v92, v158, v150
    v_dot2_f32_bf16 v152, v92, v92, v152
    v_dot2_f32_bf16 v151, v93, v158, v151
    v_dot2_f32_bf16 v153, v93, v93, v153
    v_dot2_f32_bf16 v150, v94, v158, v150
    v_dot2_f32_bf16 v152, v94, v94, v152
    v_dot2_f32_bf16 v151, v95, v158, v151
    v_dot2_f32_bf16 v153, v95, v95, v153
    v_dot2_f32_bf16 v150, v96, v158, v150
    v_dot2_f32_bf16 v152, v96, v96, v152
    v_dot2_f32_bf16 v151, v97, v158, v151
    v_dot2_f32_bf16 v153, v97, v97, v153
    v_dot2_f32_bf16 v150, v98, v158, v150
    v_dot2_f32_bf16 v152, v98, v98, v152
    v_dot2_f32_bf16 v151, v99, v158, v151
    v_dot2_f32_bf16 v153, v99, v99, v153
    v_dot2_f32_bf16 v150, v100, v158, v150
    v_dot2_f32_bf16 v152, v100, v100, v152
    v_dot2_f32_bf16 v151, v101, v158, v151
    v_dot2_f32_bf16 v153, v101, v101, v153
    v_dot2_f32_bf16 v150, v102, v158, v150
    v_dot2_f32_bf16 v152, v102, v102, v152
    v_dot2_f32_bf16 v151, v103, v158, v151
    v_dot2_f32_bf16 v153, v103, v103, v153
    v_dot2_f32_bf16 v150, v104, v158, v150
    v_dot2_f32_bf16 v152, v104, v104, v152
    v_dot2_f32_bf16 v151, v105, v158, v151
    v_dot2_f32_bf16 v153, v105, v105, v153
    v_dot2_f32_bf16 v150, v106, v158, v150
    v_dot2_f32_bf16 v152, v106, v106, v152
    v_dot2_f32_bf16 v151, v107, v158, v151
    v_dot2_f32_bf16 v153, v107, v107, v153
    v_dot2_f32_bf16 v150, v108, v158, v150
    v_dot2_f32_bf16 v152, v108, v108, v152
    v_dot2_f32_bf16 v151, v109, v158, v151
    v_dot2_f32_bf16 v153, v109, v109, v153
    v_dot2_f32_bf16 v150, v110, v158, v150
    v_dot2_f32_bf16 v152, v110, v110, v152
    v_dot2_f32_bf16 v151, v111, v158, v151
    v_dot2_f32_bf16 v153, v111, v111, v153
    v_dot2_f32_bf16 v150, v112, v158, v150
    v_dot2_f32_bf16 v152, v112, v112, v152
    v_dot2_f32_bf16 v151, v113, v158, v151
    v_dot2_f32_bf16 v153, v113, v113, v153
    v_dot2_f32_bf16 v150, v114, v158, v150
    v_dot2_f32_bf16 v152, v114, v114, v152
    v_dot2_f32_bf16 v151, v115, v158, v151
    v_dot2_f32_bf16 v153, v115, v115, v153
    v_dot2_f32_bf16 v150, v116, v158, v150
    v_dot2_f32_bf16 v152, v116, v116, v152
    v_dot2_f32_bf16 v151, v117, v158, v151
    v_dot2_f32_bf16 v153, v117, v117, v153
    v_dot2_f32_bf16 v150, v118, v158, v150
    v_dot2_f32_bf16 v152, v118, v118, v152
    v_dot2_f32_bf16 v151, v119, v158, v151
    v_dot2_f32_bf16 v153, v119, v119, v153
    v_dot2_f32_bf16 v150, v120, v158, v150
    v_dot2_f32_bf16 v152, v120, v120, v152
    v_dot2_f32_bf16 v151, v121, v158, v151
    v_dot2_f32_bf16 v153, v121, v121, v153
    v_dot2_f32_bf16 v150, v122, v158, v150
    v_dot2_f32_bf16 v152, v122, v122, v152
    v_dot2_f32_bf16 v151, v123, v158, v151
    v_dot2_f32_bf16 v153, v123, v123, v153
    v_dot2_f32_bf16 v150, v124, v158, v150
    v_dot2_f32_bf16 v152, v124, v124, v152
    v_dot2_f32_bf16 v151, v125, v158, v151
    v_dot2_f32_bf16 v153, v125, v125, v153
    v_dot2_f32_bf16 v150, v126, v158, v150
    v_dot2_f32_bf16 v152, v126, v126, v152
    v_dot2_f32_bf16 v151, v127, v158, v151
    v_dot2_f32_bf16 v153, v127, v127, v153
    s_nop 1
    v_add_f32 v150, v150, v151
    v_add_f32 v152, v152, v153
    v_mov_b32 v157, v150
    s_nop 1
    v_permlane32_swap_b32 v157, v150
    v_add_f32 v150, v157, v150
    v_mov_b32 v157, v150
    s_nop 1
    v_permlane16_swap_b32 v157, v150
    v_add_f32 v150, v157, v150
    v_mov_b32 v157, v152
    s_nop 1
    v_permlane32_swap_b32 v157, v152
    v_add_f32 v152, v157, v152
    v_mov_b32 v157, v152
    s_nop 1
    v_permlane16_swap_b32 v157, v152
    v_add_f32 v152, v157, v152
    v_mul_f32 v150, 0x3b000000, v150
    v_cvt_pk_bf16_f32 v154, v150, v150
    v_and_b32 v154, 0xffff0000, v154
    v_sub_f32 v156, v150, v154
    v_mul_f32 v157, v150, v150
    v_mul_f32 v152, 0x3b000000, v152
    v_sub_f32 v152, v152, v157
    v_max_f32 v152, 0, v152
    v_cvt_pk_bf16_f32 v152, v152, v152
    v_and_b32 v152, 0xffff0000, v152
    v_add_f32 v152, 0x3727c5ac, v152
    v_cvt_pk_bf16_f32 v152, v152, v152
    v_and_b32 v152, 0xffff0000, v152
    v_sqrt_f32 v152, v152
    s_nop 0
    v_cvt_pk_bf16_f32 v152, v152, v152
    v_and_b32 v152, 0xffff0000, v152
    v_rcp_f32 v152, v152
    v_lshlrev_b32 v160, 16, v64
    v_and_b32 v161, 0xffff0000, v64
    v_lshlrev_b32 v162, 16, v65
    v_and_b32 v163, 0xffff0000, v65
    v_lshlrev_b32 v164, 16, v66
    v_and_b32 v165, 0xffff0000, v66
    v_lshlrev_b32 v166, 16, v67
    v_and_b32 v167, 0xffff0000, v67
    v_lshlrev_b32 v168, 16, v68
    v_and_b32 v169, 0xffff0000, v68
    v_lshlrev_b32 v170, 16, v69
    v_and_b32 v171, 0xffff0000, v69
    v_lshlrev_b32 v172, 16, v70
    v_and_b32 v173, 0xffff0000, v70
    v_lshlrev_b32 v174, 16, v71
    v_and_b32 v175, 0xffff0000, v71
    v_pk_add_f32 v[160:161], v[160:161], v[154:155] op_sel_hi:[1,0] neg_lo:[0,1] neg_hi:[0,1]
    v_pk_add_f32 v[162:163], v[162:163], v[154:155] op_sel_hi:[1,0] neg_lo:[0,1] neg_hi:[0,1]
    v_pk_add_f32 v[164:165], v[164:165], v[154:155] op_sel_hi:[1,0] neg_lo:[0,1] neg_hi:[0,1]
    v_pk_add_f32 v[166:167], v[166:167], v[154:155] op_sel_hi:[1,0] neg_lo:[0,1] neg_hi:[0,1]
    v_pk_add_f32 v[168:169], v[168:169], v[154:155] op_sel_hi:[1,0] neg_lo:[0,1] neg_hi:[0,1]
    v_pk_add_f32 v[170:171], v[170:171], v[154:155] op_sel_hi:[1,0] neg_lo:[0,1] neg_hi:[0,1]
    v_pk_add_f32 v[172:173], v[172:173], v[154:155] op_sel_hi:[1,0] neg_lo:[0,1] neg_hi:[0,1]
    v_pk_add_f32 v[174:175], v[174:175], v[154:155] op_sel_hi:[1,0] neg_lo:[0,1] neg_hi:[0,1]
    v_cvt_pk_bf16_f32 v64, v160, v161
    v_cvt_pk_bf16_f32 v65, v162, v163
    v_cvt_pk_bf16_f32 v66, v164, v165
    v_cvt_pk_bf16_f32 v67, v166, v167
    v_cvt_pk_bf16_f32 v68, v168, v169
    v_cvt_pk_bf16_f32 v69, v170, v171
    v_cvt_pk_bf16_f32 v70, v172, v173
    v_cvt_pk_bf16_f32 v71, v174, v175
    v_lshlrev_b32 v160, 16, v64
    v_and_b32 v161, 0xffff0000, v64
    v_lshlrev_b32 v162, 16, v65
    v_and_b32 v163, 0xffff0000, v65
    v_lshlrev_b32 v164, 16, v66
    v_and_b32 v165, 0xffff0000, v66
    v_lshlrev_b32 v166, 16, v67
    v_and_b32 v167, 0xffff0000, v67
    v_lshlrev_b32 v168, 16, v68
    v_and_b32 v169, 0xffff0000, v68
    v_lshlrev_b32 v170, 16, v69
    v_and_b32 v171, 0xffff0000, v69
    v_lshlrev_b32 v172, 16, v70
    v_and_b32 v173, 0xffff0000, v70
    v_lshlrev_b32 v174, 16, v71
    v_and_b32 v175, 0xffff0000, v71
    v_pk_mul_f32 v[160:161], v[160:161], v[152:153] op_sel_hi:[1,0]
    v_pk_mul_f32 v[162:163], v[162:163], v[152:153] op_sel_hi:[1,0]
    v_pk_mul_f32 v[164:165], v[164:165], v[152:153] op_sel_hi:[1,0]
    v_pk_mul_f32 v[166:167], v[166:167], v[152:153] op_sel_hi:[1,0]
    v_pk_mul_f32 v[168:169], v[168:169], v[152:153] op_sel_hi:[1,0]
    v_pk_mul_f32 v[170:171], v[170:171], v[152:153] op_sel_hi:[1,0]
    v_pk_mul_f32 v[172:173], v[172:173], v[152:153] op_sel_hi:[1,0]
    v_pk_mul_f32 v[174:175], v[174:175], v[152:153] op_sel_hi:[1,0]
    v_cvt_pk_bf16_f32 v160, v160, v161
    v_cvt_pk_bf16_f32 v162, v162, v163
    v_cvt_pk_bf16_f32 v164, v164, v165
    v_cvt_pk_bf16_f32 v166, v166, v167
    v_cvt_pk_bf16_f32 v168, v168, v169
    v_cvt_pk_bf16_f32 v170, v170, v171
    v_cvt_pk_bf16_f32 v172, v172, v173
    v_cvt_pk_bf16_f32 v174, v174, v175
    v_accvgpr_write_b32 a64, v160
    v_accvgpr_write_b32 a65, v162
    v_accvgpr_write_b32 a66, v164
    v_accvgpr_write_b32 a67, v166
    v_accvgpr_write_b32 a68, v168
    v_accvgpr_write_b32 a69, v170
    v_accvgpr_write_b32 a70, v172
    v_accvgpr_write_b32 a71, v174
    v_lshlrev_b32 v160, 16, v72
    v_and_b32 v161, 0xffff0000, v72
    v_lshlrev_b32 v162, 16, v73
    v_and_b32 v163, 0xffff0000, v73
    v_lshlrev_b32 v164, 16, v74
    v_and_b32 v165, 0xffff0000, v74
    v_lshlrev_b32 v166, 16, v75
    v_and_b32 v167, 0xffff0000, v75
    v_lshlrev_b32 v168, 16, v76
    v_and_b32 v169, 0xffff0000, v76
    v_lshlrev_b32 v170, 16, v77
    v_and_b32 v171, 0xffff0000, v77
    v_lshlrev_b32 v172, 16, v78
    v_and_b32 v173, 0xffff0000, v78
    v_lshlrev_b32 v174, 16, v79
    v_and_b32 v175, 0xffff0000, v79
    v_pk_add_f32 v[160:161], v[160:161], v[154:155] op_sel_hi:[1,0] neg_lo:[0,1] neg_hi:[0,1]
    v_pk_add_f32 v[162:163], v[162:163], v[154:155] op_sel_hi:[1,0] neg_lo:[0,1] neg_hi:[0,1]
    v_pk_add_f32 v[164:165], v[164:165], v[154:155] op_sel_hi:[1,0] neg_lo:[0,1] neg_hi:[0,1]
    v_pk_add_f32 v[166:167], v[166:167], v[154:155] op_sel_hi:[1,0] neg_lo:[0,1] neg_hi:[0,1]
    v_pk_add_f32 v[168:169], v[168:169], v[154:155] op_sel_hi:[1,0] neg_lo:[0,1] neg_hi:[0,1]
    v_pk_add_f32 v[170:171], v[170:171], v[154:155] op_sel_hi:[1,0] neg_lo:[0,1] neg_hi:[0,1]
    v_pk_add_f32 v[172:173], v[172:173], v[154:155] op_sel_hi:[1,0] neg_lo:[0,1] neg_hi:[0,1]
    v_pk_add_f32 v[174:175], v[174:175], v[154:155] op_sel_hi:[1,0] neg_lo:[0,1] neg_hi:[0,1]
    v_cvt_pk_bf16_f32 v72, v160, v161
    v_cvt_pk_bf16_f32 v73, v162, v163
    v_cvt_pk_bf16_f32 v74, v164, v165
    v_cvt_pk_bf16_f32 v75, v166, v167
    v_cvt_pk_bf16_f32 v76, v168, v169
    v_cvt_pk_bf16_f32 v77, v170, v171
    v_cvt_pk_bf16_f32 v78, v172, v173
    v_cvt_pk_bf16_f32 v79, v174, v175
    v_lshlrev_b32 v160, 16, v72
    v_and_b32 v161, 0xffff0000, v72
    v_lshlrev_b32 v162, 16, v73
    v_and_b32 v163, 0xffff0000, v73
    v_lshlrev_b32 v164, 16, v74
    v_and_b32 v165, 0xffff0000, v74
    v_lshlrev_b32 v166, 16, v75
    v_and_b32 v167, 0xffff0000, v75
    v_lshlrev_b32 v168, 16, v76
    v_and_b32 v169, 0xffff0000, v76
    v_lshlrev_b32 v170, 16, v77
    v_and_b32 v171, 0xffff0000, v77
    v_lshlrev_b32 v172, 16, v78
    v_and_b32 v173, 0xffff0000, v78
    v_lshlrev_b32 v174, 16, v79
    v_and_b32 v175, 0xffff0000, v79
    v_pk_mul_f32 v[160:161], v[160:161], v[152:153] op_sel_hi:[1,0]
    v_pk_mul_f32 v[162:163], v[162:163], v[152:153] op_sel_hi:[1,0]
    v_pk_mul_f32 v[164:165], v[164:165], v[152:153] op_sel_hi:[1,0]
    v_pk_mul_f32 v[166:167], v[166:167], v[152:153] op_sel_hi:[1,0]
    v_pk_mul_f32 v[168:169], v[168:169], v[152:153] op_sel_hi:[1,0]
    v_pk_mul_f32 v[170:171], v[170:171], v[152:153] op_sel_hi:[1,0]
    v_pk_mul_f32 v[172:173], v[172:173], v[152:153] op_sel_hi:[1,0]
    v_pk_mul_f32 v[174:175], v[174:175], v[152:153] op_sel_hi:[1,0]
    v_cvt_pk_bf16_f32 v160, v160, v161
    v_cvt_pk_bf16_f32 v162, v162, v163
    v_cvt_pk_bf16_f32 v164, v164, v165
    v_cvt_pk_bf16_f32 v166, v166, v167
    v_cvt_pk_bf16_f32 v168, v168, v169
    v_cvt_pk_bf16_f32 v170, v170, v171
    v_cvt_pk_bf16_f32 v172, v172, v173
    v_cvt_pk_bf16_f32 v174, v174, v175
    v_accvgpr_write_b32 a72, v160
    v_accvgpr_write_b32 a73, v162
    v_accvgpr_write_b32 a74, v164
    v_accvgpr_write_b32 a75, v166
    v_accvgpr_write_b32 a76, v168
    v_accvgpr_write_b32 a77, v170
    v_accvgpr_write_b32 a78, v172
    v_accvgpr_write_b32 a79, v174
    v_lshlrev_b32 v160, 16, v80
    v_and_b32 v161, 0xffff0000, v80
    v_lshlrev_b32 v162, 16, v81
    v_and_b32 v163, 0xffff0000, v81
    v_lshlrev_b32 v164, 16, v82
    v_and_b32 v165, 0xffff0000, v82
    v_lshlrev_b32 v166, 16, v83
    v_and_b32 v167, 0xffff0000, v83
    v_lshlrev_b32 v168, 16, v84
    v_and_b32 v169, 0xffff0000, v84
    v_lshlrev_b32 v170, 16, v85
    v_and_b32 v171, 0xffff0000, v85
    v_lshlrev_b32 v172, 16, v86
    v_and_b32 v173, 0xffff0000, v86
    v_lshlrev_b32 v174, 16, v87
    v_and_b32 v175, 0xffff0000, v87
    v_pk_add_f32 v[160:161], v[160:161], v[154:155] op_sel_hi:[1,0] neg_lo:[0,1] neg_hi:[0,1]
    v_pk_add_f32 v[162:163], v[162:163], v[154:155] op_sel_hi:[1,0] neg_lo:[0,1] neg_hi:[0,1]
    v_pk_add_f32 v[164:165], v[164:165], v[154:155] op_sel_hi:[1,0] neg_lo:[0,1] neg_hi:[0,1]
    v_pk_add_f32 v[166:167], v[166:167], v[154:155] op_sel_hi:[1,0] neg_lo:[0,1] neg_hi:[0,1]
    v_pk_add_f32 v[168:169], v[168:169], v[154:155] op_sel_hi:[1,0] neg_lo:[0,1] neg_hi:[0,1]
    v_pk_add_f32 v[170:171], v[170:171], v[154:155] op_sel_hi:[1,0] neg_lo:[0,1] neg_hi:[0,1]
    v_pk_add_f32 v[172:173], v[172:173], v[154:155] op_sel_hi:[1,0] neg_lo:[0,1] neg_hi:[0,1]
    v_pk_add_f32 v[174:175], v[174:175], v[154:155] op_sel_hi:[1,0] neg_lo:[0,1] neg_hi:[0,1]
    v_cvt_pk_bf16_f32 v80, v160, v161
    v_cvt_pk_bf16_f32 v81, v162, v163
    v_cvt_pk_bf16_f32 v82, v164, v165
    v_cvt_pk_bf16_f32 v83, v166, v167
    v_cvt_pk_bf16_f32 v84, v168, v169
    v_cvt_pk_bf16_f32 v85, v170, v171
    v_cvt_pk_bf16_f32 v86, v172, v173
    v_cvt_pk_bf16_f32 v87, v174, v175
    v_lshlrev_b32 v160, 16, v80
    v_and_b32 v161, 0xffff0000, v80
    v_lshlrev_b32 v162, 16, v81
    v_and_b32 v163, 0xffff0000, v81
    v_lshlrev_b32 v164, 16, v82
    v_and_b32 v165, 0xffff0000, v82
    v_lshlrev_b32 v166, 16, v83
    v_and_b32 v167, 0xffff0000, v83
    v_lshlrev_b32 v168, 16, v84
    v_and_b32 v169, 0xffff0000, v84
    v_lshlrev_b32 v170, 16, v85
    v_and_b32 v171, 0xffff0000, v85
    v_lshlrev_b32 v172, 16, v86
    v_and_b32 v173, 0xffff0000, v86
    v_lshlrev_b32 v174, 16, v87
    v_and_b32 v175, 0xffff0000, v87
    v_pk_mul_f32 v[160:161], v[160:161], v[152:153] op_sel_hi:[1,0]
    v_pk_mul_f32 v[162:163], v[162:163], v[152:153] op_sel_hi:[1,0]
    v_pk_mul_f32 v[164:165], v[164:165], v[152:153] op_sel_hi:[1,0]
    v_pk_mul_f32 v[166:167], v[166:167], v[152:153] op_sel_hi:[1,0]
    v_pk_mul_f32 v[168:169], v[168:169], v[152:153] op_sel_hi:[1,0]
    v_pk_mul_f32 v[170:171], v[170:171], v[152:153] op_sel_hi:[1,0]
    v_pk_mul_f32 v[172:173], v[172:173], v[152:153] op_sel_hi:[1,0]
    v_pk_mul_f32 v[174:175], v[174:175], v[152:153] op_sel_hi:[1,0]
    v_cvt_pk_bf16_f32 v160, v160, v161
    v_cvt_pk_bf16_f32 v162, v162, v163
    v_cvt_pk_bf16_f32 v164, v164, v165
    v_cvt_pk_bf16_f32 v166, v166, v167
    v_cvt_pk_bf16_f32 v168, v168, v169
    v_cvt_pk_bf16_f32 v170, v170, v171
    v_cvt_pk_bf16_f32 v172, v172, v173
    v_cvt_pk_bf16_f32 v174, v174, v175
    v_accvgpr_write_b32 a80, v160
    v_accvgpr_write_b32 a81, v162
    v_accvgpr_write_b32 a82, v164
    v_accvgpr_write_b32 a83, v166
    v_accvgpr_write_b32 a84, v168
    v_accvgpr_write_b32 a85, v170
    v_accvgpr_write_b32 a86, v172
    v_accvgpr_write_b32 a87, v174
    v_lshlrev_b32 v160, 16, v88
    v_and_b32 v161, 0xffff0000, v88
    v_lshlrev_b32 v162, 16, v89
    v_and_b32 v163, 0xffff0000, v89
    v_lshlrev_b32 v164, 16, v90
    v_and_b32 v165, 0xffff0000, v90
    v_lshlrev_b32 v166, 16, v91
    v_and_b32 v167, 0xffff0000, v91
    v_lshlrev_b32 v168, 16, v92
    v_and_b32 v169, 0xffff0000, v92
    v_lshlrev_b32 v170, 16, v93
    v_and_b32 v171, 0xffff0000, v93
    v_lshlrev_b32 v172, 16, v94
    v_and_b32 v173, 0xffff0000, v94
    v_lshlrev_b32 v174, 16, v95
    v_and_b32 v175, 0xffff0000, v95
    v_pk_add_f32 v[160:161], v[160:161], v[154:155] op_sel_hi:[1,0] neg_lo:[0,1] neg_hi:[0,1]
    v_pk_add_f32 v[162:163], v[162:163], v[154:155] op_sel_hi:[1,0] neg_lo:[0,1] neg_hi:[0,1]
    v_pk_add_f32 v[164:165], v[164:165], v[154:155] op_sel_hi:[1,0] neg_lo:[0,1] neg_hi:[0,1]
    v_pk_add_f32 v[166:167], v[166:167], v[154:155] op_sel_hi:[1,0] neg_lo:[0,1] neg_hi:[0,1]
    v_pk_add_f32 v[168:169], v[168:169], v[154:155] op_sel_hi:[1,0] neg_lo:[0,1] neg_hi:[0,1]
    v_pk_add_f32 v[170:171], v[170:171], v[154:155] op_sel_hi:[1,0] neg_lo:[0,1] neg_hi:[0,1]
    v_pk_add_f32 v[172:173], v[172:173], v[154:155] op_sel_hi:[1,0] neg_lo:[0,1] neg_hi:[0,1]
    v_pk_add_f32 v[174:175], v[174:175], v[154:155] op_sel_hi:[1,0] neg_lo:[0,1] neg_hi:[0,1]
    v_cvt_pk_bf16_f32 v88, v160, v161
    v_cvt_pk_bf16_f32 v89, v162, v163
    v_cvt_pk_bf16_f32 v90, v164, v165
    v_cvt_pk_bf16_f32 v91, v166, v167
    v_cvt_pk_bf16_f32 v92, v168, v169
    v_cvt_pk_bf16_f32 v93, v170, v171
    v_cvt_pk_bf16_f32 v94, v172, v173
    v_cvt_pk_bf16_f32 v95, v174, v175
    v_lshlrev_b32 v160, 16, v88
    v_and_b32 v161, 0xffff0000, v88
    v_lshlrev_b32 v162, 16, v89
    v_and_b32 v163, 0xffff0000, v89
    v_lshlrev_b32 v164, 16, v90
    v_and_b32 v165, 0xffff0000, v90
    v_lshlrev_b32 v166, 16, v91
    v_and_b32 v167, 0xffff0000, v91
    v_lshlrev_b32 v168, 16, v92
    v_and_b32 v169, 0xffff0000, v92
    v_lshlrev_b32 v170, 16, v93
    v_and_b32 v171, 0xffff0000, v93
    v_lshlrev_b32 v172, 16, v94
    v_and_b32 v173, 0xffff0000, v94
    v_lshlrev_b32 v174, 16, v95
    v_and_b32 v175, 0xffff0000, v95
    v_pk_mul_f32 v[160:161], v[160:161], v[152:153] op_sel_hi:[1,0]
    v_pk_mul_f32 v[162:163], v[162:163], v[152:153] op_sel_hi:[1,0]
    v_pk_mul_f32 v[164:165], v[164:165], v[152:153] op_sel_hi:[1,0]
    v_pk_mul_f32 v[166:167], v[166:167], v[152:153] op_sel_hi:[1,0]
    v_pk_mul_f32 v[168:169], v[168:169], v[152:153] op_sel_hi:[1,0]
    v_pk_mul_f32 v[170:171], v[170:171], v[152:153] op_sel_hi:[1,0]
    v_pk_mul_f32 v[172:173], v[172:173], v[152:153] op_sel_hi:[1,0]
    v_pk_mul_f32 v[174:175], v[174:175], v[152:153] op_sel_hi:[1,0]
    v_cvt_pk_bf16_f32 v160, v160, v161
    v_cvt_pk_bf16_f32 v162, v162, v163
    v_cvt_pk_bf16_f32 v164, v164, v165
    v_cvt_pk_bf16_f32 v166, v166, v167
    v_cvt_pk_bf16_f32 v168, v168, v169
    v_cvt_pk_bf16_f32 v170, v170, v171
    v_cvt_pk_bf16_f32 v172, v172, v173
    v_cvt_pk_bf16_f32 v174, v174, v175
    v_accvgpr_write_b32 a88, v160
    v_accvgpr_write_b32 a89, v162
    v_accvgpr_write_b32 a90, v164
    v_accvgpr_write_b32 a91, v166
    v_accvgpr_write_b32 a92, v168
    v_accvgpr_write_b32 a93, v170
    v_accvgpr_write_b32 a94, v172
    v_accvgpr_write_b32 a95, v174
    v_lshlrev_b32 v160, 16, v96
    v_and_b32 v161, 0xffff0000, v96
    v_lshlrev_b32 v162, 16, v97
    v_and_b32 v163, 0xffff0000, v97
    v_lshlrev_b32 v164, 16, v98
    v_and_b32 v165, 0xffff0000, v98
    v_lshlrev_b32 v166, 16, v99
    v_and_b32 v167, 0xffff0000, v99
    v_lshlrev_b32 v168, 16, v100
    v_and_b32 v169, 0xffff0000, v100
    v_lshlrev_b32 v170, 16, v101
    v_and_b32 v171, 0xffff0000, v101
    v_lshlrev_b32 v172, 16, v102
    v_and_b32 v173, 0xffff0000, v102
    v_lshlrev_b32 v174, 16, v103
    v_and_b32 v175, 0xffff0000, v103
    v_pk_add_f32 v[160:161], v[160:161], v[154:155] op_sel_hi:[1,0] neg_lo:[0,1] neg_hi:[0,1]
    v_pk_add_f32 v[162:163], v[162:163], v[154:155] op_sel_hi:[1,0] neg_lo:[0,1] neg_hi:[0,1]
    v_pk_add_f32 v[164:165], v[164:165], v[154:155] op_sel_hi:[1,0] neg_lo:[0,1] neg_hi:[0,1]
    v_pk_add_f32 v[166:167], v[166:167], v[154:155] op_sel_hi:[1,0] neg_lo:[0,1] neg_hi:[0,1]
    v_pk_add_f32 v[168:169], v[168:169], v[154:155] op_sel_hi:[1,0] neg_lo:[0,1] neg_hi:[0,1]
    v_pk_add_f32 v[170:171], v[170:171], v[154:155] op_sel_hi:[1,0] neg_lo:[0,1] neg_hi:[0,1]
    v_pk_add_f32 v[172:173], v[172:173], v[154:155] op_sel_hi:[1,0] neg_lo:[0,1] neg_hi:[0,1]
    v_pk_add_f32 v[174:175], v[174:175], v[154:155] op_sel_hi:[1,0] neg_lo:[0,1] neg_hi:[0,1]
    v_cvt_pk_bf16_f32 v96, v160, v161
    v_cvt_pk_bf16_f32 v97, v162, v163
    v_cvt_pk_bf16_f32 v98, v164, v165
    v_cvt_pk_bf16_f32 v99, v166, v167
    v_cvt_pk_bf16_f32 v100, v168, v169
    v_cvt_pk_bf16_f32 v101, v170, v171
    v_cvt_pk_bf16_f32 v102, v172, v173
    v_cvt_pk_bf16_f32 v103, v174, v175
    v_lshlrev_b32 v160, 16, v96
    v_and_b32 v161, 0xffff0000, v96
    v_lshlrev_b32 v162, 16, v97
    v_and_b32 v163, 0xffff0000, v97
    v_lshlrev_b32 v164, 16, v98
    v_and_b32 v165, 0xffff0000, v98
    v_lshlrev_b32 v166, 16, v99
    v_and_b32 v167, 0xffff0000, v99
    v_lshlrev_b32 v168, 16, v100
    v_and_b32 v169, 0xffff0000, v100
    v_lshlrev_b32 v170, 16, v101
    v_and_b32 v171, 0xffff0000, v101
    v_lshlrev_b32 v172, 16, v102
    v_and_b32 v173, 0xffff0000, v102
    v_lshlrev_b32 v174, 16, v103
    v_and_b32 v175, 0xffff0000, v103
    v_pk_mul_f32 v[160:161], v[160:161], v[152:153] op_sel_hi:[1,0]
    v_pk_mul_f32 v[162:163], v[162:163], v[152:153] op_sel_hi:[1,0]
    v_pk_mul_f32 v[164:165], v[164:165], v[152:153] op_sel_hi:[1,0]
    v_pk_mul_f32 v[166:167], v[166:167], v[152:153] op_sel_hi:[1,0]
    v_pk_mul_f32 v[168:169], v[168:169], v[152:153] op_sel_hi:[1,0]
    v_pk_mul_f32 v[170:171], v[170:171], v[152:153] op_sel_hi:[1,0]
    v_pk_mul_f32 v[172:173], v[172:173], v[152:153] op_sel_hi:[1,0]
    v_pk_mul_f32 v[174:175], v[174:175], v[152:153] op_sel_hi:[1,0]
    v_cvt_pk_bf16_f32 v160, v160, v161
    v_cvt_pk_bf16_f32 v162, v162, v163
    v_cvt_pk_bf16_f32 v164, v164, v165
    v_cvt_pk_bf16_f32 v166, v166, v167
    v_cvt_pk_bf16_f32 v168, v168, v169
    v_cvt_pk_bf16_f32 v170, v170, v171
    v_cvt_pk_bf16_f32 v172, v172, v173
    v_cvt_pk_bf16_f32 v174, v174, v175
    v_accvgpr_write_b32 a96, v160
    v_accvgpr_write_b32 a97, v162
    v_accvgpr_write_b32 a98, v164
    v_accvgpr_write_b32 a99, v166
    v_accvgpr_write_b32 a100, v168
    v_accvgpr_write_b32 a101, v170
    v_accvgpr_write_b32 a102, v172
    v_accvgpr_write_b32 a103, v174
    v_lshlrev_b32 v160, 16, v104
    v_and_b32 v161, 0xffff0000, v104
    v_lshlrev_b32 v162, 16, v105
    v_and_b32 v163, 0xffff0000, v105
    v_lshlrev_b32 v164, 16, v106
    v_and_b32 v165, 0xffff0000, v106
    v_lshlrev_b32 v166, 16, v107
    v_and_b32 v167, 0xffff0000, v107
    v_lshlrev_b32 v168, 16, v108
    v_and_b32 v169, 0xffff0000, v108
    v_lshlrev_b32 v170, 16, v109
    v_and_b32 v171, 0xffff0000, v109
    v_lshlrev_b32 v172, 16, v110
    v_and_b32 v173, 0xffff0000, v110
    v_lshlrev_b32 v174, 16, v111
    v_and_b32 v175, 0xffff0000, v111
    v_pk_add_f32 v[160:161], v[160:161], v[154:155] op_sel_hi:[1,0] neg_lo:[0,1] neg_hi:[0,1]
    v_pk_add_f32 v[162:163], v[162:163], v[154:155] op_sel_hi:[1,0] neg_lo:[0,1] neg_hi:[0,1]
    v_pk_add_f32 v[164:165], v[164:165], v[154:155] op_sel_hi:[1,0] neg_lo:[0,1] neg_hi:[0,1]
    v_pk_add_f32 v[166:167], v[166:167], v[154:155] op_sel_hi:[1,0] neg_lo:[0,1] neg_hi:[0,1]
    v_pk_add_f32 v[168:169], v[168:169], v[154:155] op_sel_hi:[1,0] neg_lo:[0,1] neg_hi:[0,1]
    v_pk_add_f32 v[170:171], v[170:171], v[154:155] op_sel_hi:[1,0] neg_lo:[0,1] neg_hi:[0,1]
    v_pk_add_f32 v[172:173], v[172:173], v[154:155] op_sel_hi:[1,0] neg_lo:[0,1] neg_hi:[0,1]
    v_pk_add_f32 v[174:175], v[174:175], v[154:155] op_sel_hi:[1,0] neg_lo:[0,1] neg_hi:[0,1]
    v_cvt_pk_bf16_f32 v104, v160, v161
    v_cvt_pk_bf16_f32 v105, v162, v163
    v_cvt_pk_bf16_f32 v106, v164, v165
    v_cvt_pk_bf16_f32 v107, v166, v167
    v_cvt_pk_bf16_f32 v108, v168, v169
    v_cvt_pk_bf16_f32 v109, v170, v171
    v_cvt_pk_bf16_f32 v110, v172, v173
    v_cvt_pk_bf16_f32 v111, v174, v175
    v_lshlrev_b32 v160, 16, v104
    v_and_b32 v161, 0xffff0000, v104
    v_lshlrev_b32 v162, 16, v105
    v_and_b32 v163, 0xffff0000, v105
    v_lshlrev_b32 v164, 16, v106
    v_and_b32 v165, 0xffff0000, v106
    v_lshlrev_b32 v166, 16, v107
    v_and_b32 v167, 0xffff0000, v107
    v_lshlrev_b32 v168, 16, v108
    v_and_b32 v169, 0xffff0000, v108
    v_lshlrev_b32 v170, 16, v109
    v_and_b32 v171, 0xffff0000, v109
    v_lshlrev_b32 v172, 16, v110
    v_and_b32 v173, 0xffff0000, v110
    v_lshlrev_b32 v174, 16, v111
    v_and_b32 v175, 0xffff0000, v111
    v_pk_mul_f32 v[160:161], v[160:161], v[152:153] op_sel_hi:[1,0]
    v_pk_mul_f32 v[162:163], v[162:163], v[152:153] op_sel_hi:[1,0]
    v_pk_mul_f32 v[164:165], v[164:165], v[152:153] op_sel_hi:[1,0]
    v_pk_mul_f32 v[166:167], v[166:167], v[152:153] op_sel_hi:[1,0]
    v_pk_mul_f32 v[168:169], v[168:169], v[152:153] op_sel_hi:[1,0]
    v_pk_mul_f32 v[170:171], v[170:171], v[152:153] op_sel_hi:[1,0]
    v_pk_mul_f32 v[172:173], v[172:173], v[152:153] op_sel_hi:[1,0]
    v_pk_mul_f32 v[174:175], v[174:175], v[152:153] op_sel_hi:[1,0]
    v_cvt_pk_bf16_f32 v160, v160, v161
    v_cvt_pk_bf16_f32 v162, v162, v163
    v_cvt_pk_bf16_f32 v164, v164, v165
    v_cvt_pk_bf16_f32 v166, v166, v167
    v_cvt_pk_bf16_f32 v168, v168, v169
    v_cvt_pk_bf16_f32 v170, v170, v171
    v_cvt_pk_bf16_f32 v172, v172, v173
    v_cvt_pk_bf16_f32 v174, v174, v175
    v_accvgpr_write_b32 a104, v160
    v_accvgpr_write_b32 a105, v162
    v_accvgpr_write_b32 a106, v164
    v_accvgpr_write_b32 a107, v166
    v_accvgpr_write_b32 a108, v168
    v_accvgpr_write_b32 a109, v170
    v_accvgpr_write_b32 a110, v172
    v_accvgpr_write_b32 a111, v174
    v_lshlrev_b32 v160, 16, v112
    v_and_b32 v161, 0xffff0000, v112
    v_lshlrev_b32 v162, 16, v113
    v_and_b32 v163, 0xffff0000, v113
    v_lshlrev_b32 v164, 16, v114
    v_and_b32 v165, 0xffff0000, v114
    v_lshlrev_b32 v166, 16, v115
    v_and_b32 v167, 0xffff0000, v115
    v_lshlrev_b32 v168, 16, v116
    v_and_b32 v169, 0xffff0000, v116
    v_lshlrev_b32 v170, 16, v117
    v_and_b32 v171, 0xffff0000, v117
    v_lshlrev_b32 v172, 16, v118
    v_and_b32 v173, 0xffff0000, v118
    v_lshlrev_b32 v174, 16, v119
    v_and_b32 v175, 0xffff0000, v119
    v_pk_add_f32 v[160:161], v[160:161], v[154:155] op_sel_hi:[1,0] neg_lo:[0,1] neg_hi:[0,1]
    v_pk_add_f32 v[162:163], v[162:163], v[154:155] op_sel_hi:[1,0] neg_lo:[0,1] neg_hi:[0,1]
    v_pk_add_f32 v[164:165], v[164:165], v[154:155] op_sel_hi:[1,0] neg_lo:[0,1] neg_hi:[0,1]
    v_pk_add_f32 v[166:167], v[166:167], v[154:155] op_sel_hi:[1,0] neg_lo:[0,1] neg_hi:[0,1]
    v_pk_add_f32 v[168:169], v[168:169], v[154:155] op_sel_hi:[1,0] neg_lo:[0,1] neg_hi:[0,1]
    v_pk_add_f32 v[170:171], v[170:171], v[154:155] op_sel_hi:[1,0] neg_lo:[0,1] neg_hi:[0,1]
    v_pk_add_f32 v[172:173], v[172:173], v[154:155] op_sel_hi:[1,0] neg_lo:[0,1] neg_hi:[0,1]
    v_pk_add_f32 v[174:175], v[174:175], v[154:155] op_sel_hi:[1,0] neg_lo:[0,1] neg_hi:[0,1]
    v_cvt_pk_bf16_f32 v112, v160, v161
    v_cvt_pk_bf16_f32 v113, v162, v163
    v_cvt_pk_bf16_f32 v114, v164, v165
    v_cvt_pk_bf16_f32 v115, v166, v167
    v_cvt_pk_bf16_f32 v116, v168, v169
    v_cvt_pk_bf16_f32 v117, v170, v171
    v_cvt_pk_bf16_f32 v118, v172, v173
    v_cvt_pk_bf16_f32 v119, v174, v175
    v_lshlrev_b32 v160, 16, v112
    v_and_b32 v161, 0xffff0000, v112
    v_lshlrev_b32 v162, 16, v113
    v_and_b32 v163, 0xffff0000, v113
    v_lshlrev_b32 v164, 16, v114
    v_and_b32 v165, 0xffff0000, v114
    v_lshlrev_b32 v166, 16, v115
    v_and_b32 v167, 0xffff0000, v115
    v_lshlrev_b32 v168, 16, v116
    v_and_b32 v169, 0xffff0000, v116
    v_lshlrev_b32 v170, 16, v117
    v_and_b32 v171, 0xffff0000, v117
    v_lshlrev_b32 v172, 16, v118
    v_and_b32 v173, 0xffff0000, v118
    v_lshlrev_b32 v174, 16, v119
    v_and_b32 v175, 0xffff0000, v119
    v_pk_mul_f32 v[160:161], v[160:161], v[152:153] op_sel_hi:[1,0]
    v_pk_mul_f32 v[162:163], v[162:163], v[152:153] op_sel_hi:[1,0]
    v_pk_mul_f32 v[164:165], v[164:165], v[152:153] op_sel_hi:[1,0]
    v_pk_mul_f32 v[166:167], v[166:167], v[152:153] op_sel_hi:[1,0]
    v_pk_mul_f32 v[168:169], v[168:169], v[152:153] op_sel_hi:[1,0]
    v_pk_mul_f32 v[170:171], v[170:171], v[152:153] op_sel_hi:[1,0]
    v_pk_mul_f32 v[172:173], v[172:173], v[152:153] op_sel_hi:[1,0]
    v_pk_mul_f32 v[174:175], v[174:175], v[152:153] op_sel_hi:[1,0]
    v_cvt_pk_bf16_f32 v160, v160, v161
    v_cvt_pk_bf16_f32 v162, v162, v163
    v_cvt_pk_bf16_f32 v164, v164, v165
    v_cvt_pk_bf16_f32 v166, v166, v167
    v_cvt_pk_bf16_f32 v168, v168, v169
    v_cvt_pk_bf16_f32 v170, v170, v171
    v_cvt_pk_bf16_f32 v172, v172, v173
    v_cvt_pk_bf16_f32 v174, v174, v175
    v_accvgpr_write_b32 a112, v160
    v_accvgpr_write_b32 a113, v162
    v_accvgpr_write_b32 a114, v164
    v_accvgpr_write_b32 a115, v166
    v_accvgpr_write_b32 a116, v168
    v_accvgpr_write_b32 a117, v170
    v_accvgpr_write_b32 a118, v172
    v_accvgpr_write_b32 a119, v174
    v_lshlrev_b32 v160, 16, v120
    v_and_b32 v161, 0xffff0000, v120
    v_lshlrev_b32 v162, 16, v121
    v_and_b32 v163, 0xffff0000, v121
    v_lshlrev_b32 v164, 16, v122
    v_and_b32 v165, 0xffff0000, v122
    v_lshlrev_b32 v166, 16, v123
    v_and_b32 v167, 0xffff0000, v123
    v_lshlrev_b32 v168, 16, v124
    v_and_b32 v169, 0xffff0000, v124
    v_lshlrev_b32 v170, 16, v125
    v_and_b32 v171, 0xffff0000, v125
    v_lshlrev_b32 v172, 16, v126
    v_and_b32 v173, 0xffff0000, v126
    v_lshlrev_b32 v174, 16, v127
    v_and_b32 v175, 0xffff0000, v127
    v_pk_add_f32 v[160:161], v[160:161], v[154:155] op_sel_hi:[1,0] neg_lo:[0,1] neg_hi:[0,1]
    v_pk_add_f32 v[162:163], v[162:163], v[154:155] op_sel_hi:[1,0] neg_lo:[0,1] neg_hi:[0,1]
    v_pk_add_f32 v[164:165], v[164:165], v[154:155] op_sel_hi:[1,0] neg_lo:[0,1] neg_hi:[0,1]
    v_pk_add_f32 v[166:167], v[166:167], v[154:155] op_sel_hi:[1,0] neg_lo:[0,1] neg_hi:[0,1]
    v_pk_add_f32 v[168:169], v[168:169], v[154:155] op_sel_hi:[1,0] neg_lo:[0,1] neg_hi:[0,1]
    v_pk_add_f32 v[170:171], v[170:171], v[154:155] op_sel_hi:[1,0] neg_lo:[0,1] neg_hi:[0,1]
    v_pk_add_f32 v[172:173], v[172:173], v[154:155] op_sel_hi:[1,0] neg_lo:[0,1] neg_hi:[0,1]
    v_pk_add_f32 v[174:175], v[174:175], v[154:155] op_sel_hi:[1,0] neg_lo:[0,1] neg_hi:[0,1]
    v_cvt_pk_bf16_f32 v120, v160, v161
    v_cvt_pk_bf16_f32 v121, v162, v163
    v_cvt_pk_bf16_f32 v122, v164, v165
    v_cvt_pk_bf16_f32 v123, v166, v167
    v_cvt_pk_bf16_f32 v124, v168, v169
    v_cvt_pk_bf16_f32 v125, v170, v171
    v_cvt_pk_bf16_f32 v126, v172, v173
    v_cvt_pk_bf16_f32 v127, v174, v175
    v_lshlrev_b32 v160, 16, v120
    v_and_b32 v161, 0xffff0000, v120
    v_lshlrev_b32 v162, 16, v121
    v_and_b32 v163, 0xffff0000, v121
    v_lshlrev_b32 v164, 16, v122
    v_and_b32 v165, 0xffff0000, v122
    v_lshlrev_b32 v166, 16, v123
    v_and_b32 v167, 0xffff0000, v123
    v_lshlrev_b32 v168, 16, v124
    v_and_b32 v169, 0xffff0000, v124
    v_lshlrev_b32 v170, 16, v125
    v_and_b32 v171, 0xffff0000, v125
    v_lshlrev_b32 v172, 16, v126
    v_and_b32 v173, 0xffff0000, v126
    v_lshlrev_b32 v174, 16, v127
    v_and_b32 v175, 0xffff0000, v127
    v_pk_mul_f32 v[160:161], v[160:161], v[152:153] op_sel_hi:[1,0]
    v_pk_mul_f32 v[162:163], v[162:163], v[152:153] op_sel_hi:[1,0]
    v_pk_mul_f32 v[164:165], v[164:165], v[152:153] op_sel_hi:[1,0]
    v_pk_mul_f32 v[166:167], v[166:167], v[152:153] op_sel_hi:[1,0]
    v_pk_mul_f32 v[168:169], v[168:169], v[152:153] op_sel_hi:[1,0]
    v_pk_mul_f32 v[170:171], v[170:171], v[152:153] op_sel_hi:[1,0]
    v_pk_mul_f32 v[172:173], v[172:173], v[152:153] op_sel_hi:[1,0]
    v_pk_mul_f32 v[174:175], v[174:175], v[152:153] op_sel_hi:[1,0]
    v_cvt_pk_bf16_f32 v160, v160, v161
    v_cvt_pk_bf16_f32 v162, v162, v163
    v_cvt_pk_bf16_f32 v164, v164, v165
    v_cvt_pk_bf16_f32 v166, v166, v167
    v_cvt_pk_bf16_f32 v168, v168, v169
    v_cvt_pk_bf16_f32 v170, v170, v171
    v_cvt_pk_bf16_f32 v172, v172, v173
    v_cvt_pk_bf16_f32 v174, v174, v175
    v_accvgpr_write_b32 a120, v160
    v_accvgpr_write_b32 a121, v162
    v_accvgpr_write_b32 a122, v164
    v_accvgpr_write_b32 a123, v166
    v_accvgpr_write_b32 a124, v168
    v_accvgpr_write_b32 a125, v170
    v_accvgpr_write_b32 a126, v172
    v_accvgpr_write_b32 a127, v174
    s_nop 4
L_p1_unit:
    s_cmp_ge_u32 s38, 96
    s_cbranch_scc1 L_p1_end
    s_lshr_b32 s26, s38, 5
    s_add_u32 s27, s26, 1
    s_lshl_b32 s25, s27, 24
    s_lshl_b32 s27, s20, 2
    s_add_u32 s27, s27, s21
    s_lshl_b32 s27, s27, 5
    s_and_b32 s28, s38, 31
    s_add_u32 s27, s27, s28
    s_lshl_b32 s27, s27, 13
    s_add_u32 s25, s25, s27
    s_lshr_b32 s26, s38, 5
    s_cmp_eq_u32 s26, 1
    s_cbranch_scc1 L_p1_v
    s_waitcnt vmcnt(16)
    s_barrier
    ds_read_b64_tr_b16 v[64:65], v128
    ds_read_b64_tr_b16 v[66:67], v128 offset:1024
    ds_read_b64_tr_b16 v[68:69], v129
    ds_read_b64_tr_b16 v[70:71], v129 offset:1024
    ds_read_b64_tr_b16 v[72:73], v130
    ds_read_b64_tr_b16 v[74:75], v130 offset:1024
    ds_read_b64_tr_b16 v[76:77], v131
    ds_read_b64_tr_b16 v[78:79], v131 offset:1024
    ds_read_b64_tr_b16 v[80:81], v132
    ds_read_b64_tr_b16 v[82:83], v132 offset:1024
    ds_read_b64_tr_b16 v[84:85], v133
    ds_read_b64_tr_b16 v[86:87], v133 offset:1024
    ds_read_b64_tr_b16 v[88:89], v134
    ds_read_b64_tr_b16 v[90:91], v134 offset:1024
    s_waitcnt lgkmcnt(12)
    v_mfma_f32_16x16x32_bf16 v[0:3], v[64:67], a[0:3], 0
    ds_read_b64_tr_b16 v[92:93], v135
    v_mfma_f32_16x16x32_bf16 v[4:7], v[64:67], a[64:67], 0
    ds_read_b64_tr_b16 v[94:95], v135 offset:1024
    s_add_u32 s26, s24, 0x300000
    s_add_u32 m0, s29, 0x18000
    s_nop 0
    buffer_load_dwordx4 v136, s[16:19], s26 offen lds
    s_waitcnt lgkmcnt(12)
    v_mfma_f32_16x16x32_bf16 v[8:11], v[68:71], a[0:3], 0
    ds_read_b64_tr_b16 v[96:97], v128 offset:8192
    v_mfma_f32_16x16x32_bf16 v[12:15], v[68:71], a[64:67], 0
    ds_read_b64_tr_b16 v[98:99], v128 offset:9216
    s_add_u32 s26, s24, 0x320000
    s_add_u32 m0, s29, 0x19000
    s_nop 0
    buffer_load_dwordx4 v136, s[16:19], s26 offen lds
    s_waitcnt lgkmcnt(12)
    v_mfma_f32_16x16x32_bf16 v[16:19], v[72:75], a[0:3], 0
    ds_read_b64_tr_b16 v[100:101], v129 offset:8192
    v_mfma_f32_16x16x32_bf16 v[20:23], v[72:75], a[64:67], 0
    ds_read_b64_tr_b16 v[102:103], v129 offset:9216
    s_add_u32 s26, s24, 0x340000
    s_add_u32 m0, s29, 0x1a000
    s_nop 0
    buffer_load_dwordx4 v136, s[16:19], s26 offen lds
    s_waitcnt lgkmcnt(12)
    v_mfma_f32_16x16x32_bf16 v[24:27], v[76:79], a[0:3], 0
    ds_read_b64_tr_b16 v[104:105], v130 offset:8192
    v_mfma_f32_16x16x32_bf16 v[28:31], v[76:79], a[64:67], 0
    ds_read_b64_tr_b16 v[106:107], v130 offset:9216
    s_add_u32 s26, s24, 0x360000
    s_add_u32 m0, s29, 0x1b000
    s_nop 0
    buffer_load_dwordx4 v136, s[16:19], s26 offen lds
    s_waitcnt lgkmcnt(12)
    v_mfma_f32_16x16x32_bf16 v[32:35], v[80:83], a[0:3], 0
    ds_read_b64_tr_b16 v[108:109], v131 offset:8192
    v_mfma_f32_16x16x32_bf16 v[36:39], v[80:83], a[64:67], 0
    ds_read_b64_tr_b16 v[110:111], v131 offset:9216
    s_add_u32 s26, s24, 0x380000
    s_add_u32 m0, s29, 0x1c000
    s_nop 0
    buffer_load_dwordx4 v136, s[16:19], s26 offen lds
    s_waitcnt lgkmcnt(12)
    v_mfma_f32_16x16x32_bf16 v[40:43], v[84:87], a[0:3], 0
    ds_read_b64_tr_b16 v[112:113], v132 offset:8192
    v_mfma_f32_16x16x32_bf16 v[44:47], v[84:87], a[64:67], 0
    ds_read_b64_tr_b16 v[114:115], v132 offset:9216
    s_add_u32 s26, s24, 0x3a0000
    s_add_u32 m0, s29, 0x1d000
    s_nop 0
    buffer_load_dwordx4 v136, s[16:19], s26 offen lds
    s_waitcnt lgkmcnt(12)
    v_mfma_f32_16x16x32_bf16 v[48:51], v[88:91], a[0:3], 0
    ds_read_b64_tr_b16 v[116:117], v133 offset:8192
    v_mfma_f32_16x16x32_bf16 v[52:55], v[88:91], a[64:67], 0
    ds_read_b64_tr_b16 v[118:119], v133 offset:9216
    s_add_u32 s26, s24, 0x3c0000
    s_add_u32 m0, s29, 0x1e000
    s_nop 0
    buffer_load_dwordx4 v136, s[16:19], s26 offen lds
    s_waitcnt lgkmcnt(12)
    v_mfma_f32_16x16x32_bf16 v[56:59], v[92:95], a[0:3], 0
    ds_read_b64_tr_b16 v[120:121], v134 offset:8192
    v_mfma_f32_16x16x32_bf16 v[60:63], v[92:95], a[64:67], 0
    ds_read_b64_tr_b16 v[122:123], v134 offset:9216
    s_add_u32 s26, s24, 0x3e0000
    s_add_u32 m0, s29, 0x1f000
    s_nop 0
    buffer_load_dwordx4 v136, s[16:19], s26 offen lds
    s_waitcnt lgkmcnt(12)
    v_mfma_f32_16x16x32_bf16 v[0:3], v[96:99], a[4:7], v[0:3]
    ds_read_b64_tr_b16 v[124:125], v135 offset:8192
    v_mfma_f32_16x16x32_bf16 v[4:7], v[96:99], a[68:71], v[4:7]
    ds_read_b64_tr_b16 v[126:127], v135 offset:9216
    s_waitcnt lgkmcnt(12)
    v_mfma_f32_16x16x32_bf16 v[8:11], v[100:103], a[4:7], v[8:11]
    ds_read_b64_tr_b16 v[64:65], v128 offset:16384
    v_mfma_f32_16x16x32_bf16 v[12:15], v[100:103], a[68:71], v[12:15]
    ds_read_b64_tr_b16 v[66:67], v128 offset:17408
    s_waitcnt lgkmcnt(12)
    v_mfma_f32_16x16x32_bf16 v[16:19], v[104:107], a[4:7], v[16:19]
    ds_read_b64_tr_b16 v[68:69], v129 offset:16384
    v_mfma_f32_16x16x32_bf16 v[20:23], v[104:107], a[68:71], v[20:23]
    ds_read_b64_tr_b16 v[70:71], v129 offset:17408
    s_waitcnt lgkmcnt(12)
    v_mfma_f32_16x16x32_bf16 v[24:27], v[108:111], a[4:7], v[24:27]
    ds_read_b64_tr_b16 v[72:73], v130 offset:16384
    v_mfma_f32_16x16x32_bf16 v[28:31], v[108:111], a[68:71], v[28:31]
    ds_read_b64_tr_b16 v[74:75], v130 offset:17408
    s_waitcnt lgkmcnt(12)
    v_mfma_f32_16x16x32_bf16 v[32:35], v[112:115], a[4:7], v[32:35]
    ds_read_b64_tr_b16 v[76:77], v131 offset:16384
    v_mfma_f32_16x16x32_bf16 v[36:39], v[112:115], a[68:71], v[36:39]
    ds_read_b64_tr_b16 v[78:79], v131 offset:17408
    s_waitcnt lgkmcnt(12)
    v_mfma_f32_16x16x32_bf16 v[40:43], v[116:119], a[4:7], v[40:43]
    ds_read_b64_tr_b16 v[80:81], v132 offset:16384
    v_mfma_f32_16x16x32_bf16 v[44:47], v[116:119], a[68:71], v[44:47]
    ds_read_b64_tr_b16 v[82:83], v132 offset:17408
    s_waitcnt lgkmcnt(12)
    v_mfma_f32_16x16x32_bf16 v[48:51], v[120:123], a[4:7], v[48:51]
    ds_read_b64_tr_b16 v[84:85], v133 offset:16384
    v_mfma_f32_16x16x32_bf16 v[52:55], v[120:123], a[68:71], v[52:55]
    ds_read_b64_tr_b16 v[86:87], v133 offset:17408
    s_waitcnt lgkmcnt(12)
    v_mfma_f32_16x16x32_bf16 v[56:59], v[124:127], a[4:7], v[56:59]
    ds_read_b64_tr_b16 v[88:89], v134 offset:16384
    v_mfma_f32_16x16x32_bf16 v[60:63], v[124:127], a[68:71], v[60:63]
    ds_read_b64_tr_b16 v[90:91], v134 offset:17408
    s_waitcnt lgkmcnt(12)
    v_mfma_f32_16x16x32_bf16 v[0:3], v[64:67], a[8:11], v[0:3]
    ds_read_b64_tr_b16 v[92:93], v135 offset:16384
    v_mfma_f32_16x16x32_bf16 v[4:7], v[64:67], a[72:75], v[4:7]
    ds_read_b64_tr_b16 v[94:95], v135 offset:17408
    s_waitcnt lgkmcnt(12)
    v_mfma_f32_16x16x32_bf16 v[8:11], v[68:71], a[8:11], v[8:11]
    ds_read_b64_tr_b16 v[96:97], v128 offset:24576
    v_mfma_f32_16x16x32_bf16 v[12:15], v[68:71], a[72:75], v[12:15]
    ds_read_b64_tr_b16 v[98:99], v128 offset:25600
    s_waitcnt lgkmcnt(12)
    v_mfma_f32_16x16x32_bf16 v[16:19], v[72:75], a[8:11], v[16:19]
    ds_read_b64_tr_b16 v[100:101], v129 offset:24576
    v_mfma_f32_16x16x32_bf16 v[20:23], v[72:75], a[72:75], v[20:23]
    ds_read_b64_tr_b16 v[102:103], v129 offset:25600
    s_waitcnt lgkmcnt(12)
    v_mfma_f32_16x16x32_bf16 v[24:27], v[76:79], a[8:11], v[24:27]
    ds_read_b64_tr_b16 v[104:105], v130 offset:24576
    v_mfma_f32_16x16x32_bf16 v[28:31], v[76:79], a[72:75], v[28:31]
    ds_read_b64_tr_b16 v[106:107], v130 offset:25600
    s_waitcnt lgkmcnt(12)
    v_mfma_f32_16x16x32_bf16 v[32:35], v[80:83], a[8:11], v[32:35]
    ds_read_b64_tr_b16 v[108:109], v131 offset:24576
    v_mfma_f32_16x16x32_bf16 v[36:39], v[80:83], a[72:75], v[36:39]
    ds_read_b64_tr_b16 v[110:111], v131 offset:25600
    s_waitcnt lgkmcnt(12)
    v_mfma_f32_16x16x32_bf16 v[40:43], v[84:87], a[8:11], v[40:43]
    ds_read_b64_tr_b16 v[112:113], v132 offset:24576
    v_mfma_f32_16x16x32_bf16 v[44:47], v[84:87], a[72:75], v[44:47]
    ds_read_b64_tr_b16 v[114:115], v132 offset:25600
    s_waitcnt lgkmcnt(12)
    v_mfma_f32_16x16x32_bf16 v[48:51], v[88:91], a[8:11], v[48:51]
    ds_read_b64_tr_b16 v[116:117], v133 offset:24576
    v_mfma_f32_16x16x32_bf16 v[52:55], v[88:91], a[72:75], v[52:55]
    ds_read_b64_tr_b16 v[118:119], v133 offset:25600
    s_waitcnt lgkmcnt(12)
    v_mfma_f32_16x16x32_bf16 v[56:59], v[92:95], a[8:11], v[56:59]
    ds_read_b64_tr_b16 v[120:121], v134 offset:24576
    v_mfma_f32_16x16x32_bf16 v[60:63], v[92:95], a[72:75], v[60:63]
    ds_read_b64_tr_b16 v[122:123], v134 offset:25600
    s_waitcnt lgkmcnt(12)
    v_mfma_f32_16x16x32_bf16 v[0:3], v[96:99], a[12:15], v[0:3]
    ds_read_b64_tr_b16 v[124:125], v135 offset:24576
    v_mfma_f32_16x16x32_bf16 v[4:7], v[96:99], a[76:79], v[4:7]
    ds_read_b64_tr_b16 v[126:127], v135 offset:25600
    s_waitcnt lgkmcnt(12)
    v_mfma_f32_16x16x32_bf16 v[8:11], v[100:103], a[12:15], v[8:11]
    v_mfma_f32_16x16x32_bf16 v[12:15], v[100:103], a[76:79], v[12:15]
    s_waitcnt lgkmcnt(10)
    v_mfma_f32_16x16x32_bf16 v[16:19], v[104:107], a[12:15], v[16:19]
    v_mfma_f32_16x16x32_bf16 v[20:23], v[104:107], a[76:79], v[20:23]
    s_waitcnt lgkmcnt(8)
    v_mfma_f32_16x16x32_bf16 v[24:27], v[108:111], a[12:15], v[24:27]
    v_mfma_f32_16x16x32_bf16 v[28:31], v[108:111], a[76:79], v[28:31]
    s_waitcnt lgkmcnt(6)
    v_mfma_f32_16x16x32_bf16 v[32:35], v[112:115], a[12:15], v[32:35]
    v_mfma_f32_16x16x32_bf16 v[36:39], v[112:115], a[76:79], v[36:39]
    s_waitcnt lgkmcnt(4)
    v_mfma_f32_16x16x32_bf16 v[40:43], v[116:119], a[12:15], v[40:43]
    v_mfma_f32_16x16x32_bf16 v[44:47], v[116:119], a[76:79], v[44:47]
    s_waitcnt lgkmcnt(2)
    v_mfma_f32_16x16x32_bf16 v[48:51], v[120:123], a[12:15], v[48:51]
    v_mfma_f32_16x16x32_bf16 v[52:55], v[120:123], a[76:79], v[52:55]
    s_waitcnt lgkmcnt(0)
    v_mfma_f32_16x16x32_bf16 v[56:59], v[124:127], a[12:15], v[56:59]
    v_mfma_f32_16x16x32_bf16 v[60:63], v[124:127], a[76:79], v[60:63]
    s_waitcnt vmcnt(16)
    s_barrier
    ds_read_b64_tr_b16 v[64:65], v128 offset:32768
    ds_read_b64_tr_b16 v[66:67], v128 offset:33792
    ds_read_b64_tr_b16 v[68:69], v129 offset:32768
    ds_read_b64_tr_b16 v[70:71], v129 offset:33792
    ds_read_b64_tr_b16 v[72:73], v130 offset:32768
    ds_read_b64_tr_b16 v[74:75], v130 offset:33792
    ds_read_b64_tr_b16 v[76:77], v131 offset:32768
    ds_read_b64_tr_b16 v[78:79], v131 offset:33792
    ds_read_b64_tr_b16 v[80:81], v132 offset:32768
    ds_read_b64_tr_b16 v[82:83], v132 offset:33792
    ds_read_b64_tr_b16 v[84:85], v133 offset:32768
    ds_read_b64_tr_b16 v[86:87], v133 offset:33792
    ds_read_b64_tr_b16 v[88:89], v134 offset:32768
    ds_read_b64_tr_b16 v[90:91], v134 offset:33792
    s_add_u32 s39, s39, s37
    s_lshr_b32 s26, s39, 5
    s_cmp_eq_u32 s26, 0
    s_cselect_b64 s[16:17], s[30:31], s[34:35]
    s_cmp_eq_u32 s26, 1
    s_cselect_b64 s[16:17], s[32:33], s[16:17]
    s_and_b32 s17, s17, 0xffff
    s_cmp_lt_u32 s39, 96
    s_cselect_b32 s18, 0x400000, 0
    s_and_b32 s24, s39, 31
    s_lshl_b32 s24, s24, 8
    s_waitcnt lgkmcnt(12)
    v_mfma_f32_16x16x32_bf16 v[0:3], v[64:67], a[16:19], v[0:3]
    ds_read_b64_tr_b16 v[92:93], v135 offset:32768
    v_mfma_f32_16x16x32_bf16 v[4:7], v[64:67], a[80:83], v[4:7]
    ds_read_b64_tr_b16 v[94:95], v135 offset:33792
    s_add_u32 s26, s24, 0x0
    s_add_u32 m0, s29, 0x0
    s_nop 0
    buffer_load_dwordx4 v136, s[16:19], s26 offen lds
    s_waitcnt lgkmcnt(12)
    v_mfma_f32_16x16x32_bf16 v[8:11], v[68:71], a[16:19], v[8:11]
    ds_read_b64_tr_b16 v[96:97], v128 offset:40960
    v_mfma_f32_16x16x32_bf16 v[12:15], v[68:71], a[80:83], v[12:15]
    ds_read_b64_tr_b16 v[98:99], v128 offset:41984
    s_add_u32 s26, s24, 0x20000
    s_add_u32 m0, s29, 0x1000
    s_nop 0
    buffer_load_dwordx4 v136, s[16:19], s26 offen lds
    s_waitcnt lgkmcnt(12)
    v_mfma_f32_16x16x32_bf16 v[16:19], v[72:75], a[16:19], v[16:19]
    ds_read_b64_tr_b16 v[100:101], v129 offset:40960
    v_mfma_f32_16x16x32_bf16 v[20:23], v[72:75], a[80:83], v[20:23]
    ds_read_b64_tr_b16 v[102:103], v129 offset:41984
    s_add_u32 s26, s24, 0x40000
    s_add_u32 m0, s29, 0x2000
    s_nop 0
    buffer_load_dwordx4 v136, s[16:19], s26 offen lds
    s_waitcnt lgkmcnt(12)
    v_mfma_f32_16x16x32_bf16 v[24:27], v[76:79], a[16:19], v[24:27]
    ds_read_b64_tr_b16 v[104:105], v130 offset:40960
    v_mfma_f32_16x16x32_bf16 v[28:31], v[76:79], a[80:83], v[28:31]
    ds_read_b64_tr_b16 v[106:107], v130 offset:41984
    s_add_u32 s26, s24, 0x60000
    s_add_u32 m0, s29, 0x3000
    s_nop 0
    buffer_load_dwordx4 v136, s[16:19], s26 offen lds
    s_waitcnt lgkmcnt(12)
    v_mfma_f32_16x16x32_bf16 v[32:35], v[80:83], a[16:19], v[32:35]
    ds_read_b64_tr_b16 v[108:109], v131 offset:40960
    v_mfma_f32_16x16x32_bf16 v[36:39], v[80:83], a[80:83], v[36:39]
    ds_read_b64_tr_b16 v[110:111], v131 offset:41984
    s_add_u32 s26, s24, 0x80000
    s_add_u32 m0, s29, 0x4000
    s_nop 0
    buffer_load_dwordx4 v136, s[16:19], s26 offen lds
    s_waitcnt lgkmcnt(12)
    v_mfma_f32_16x16x32_bf16 v[40:43], v[84:87], a[16:19], v[40:43]
    ds_read_b64_tr_b16 v[112:113], v132 offset:40960
    v_mfma_f32_16x16x32_bf16 v[44:47], v[84:87], a[80:83], v[44:47]
    ds_read_b64_tr_b16 v[114:115], v132 offset:41984
    s_add_u32 s26, s24, 0xa0000
    s_add_u32 m0, s29, 0x5000
    s_nop 0
    buffer_load_dwordx4 v136, s[16:19], s26 offen lds
    s_waitcnt lgkmcnt(12)
    v_mfma_f32_16x16x32_bf16 v[48:51], v[88:91], a[16:19], v[48:51]
    ds_read_b64_tr_b16 v[116:117], v133 offset:40960
    v_mfma_f32_16x16x32_bf16 v[52:55], v[88:91], a[80:83], v[52:55]
    ds_read_b64_tr_b16 v[118:119], v133 offset:41984
    s_add_u32 s26, s24, 0xc0000
    s_add_u32 m0, s29, 0x6000
    s_nop 0
    buffer_load_dwordx4 v136, s[16:19], s26 offen lds
    s_waitcnt lgkmcnt(12)
    v_mfma_f32_16x16x32_bf16 v[56:59], v[92:95], a[16:19], v[56:59]
    ds_read_b64_tr_b16 v[120:121], v134 offset:40960
    v_mfma_f32_16x16x32_bf16 v[60:63], v[92:95], a[80:83], v[60:63]
    ds_read_b64_tr_b16 v[122:123], v134 offset:41984
    s_add_u32 s26, s24, 0xe0000
    s_add_u32 m0, s29, 0x7000
    s_nop 0
    buffer_load_dwordx4 v136, s[16:19], s26 offen lds
    s_waitcnt lgkmcnt(12)
    v_mfma_f32_16x16x32_bf16 v[0:3], v[96:99], a[20:23], v[0:3]
    ds_read_b64_tr_b16 v[124:125], v135 offset:40960
    v_mfma_f32_16x16x32_bf16 v[4:7], v[96:99], a[84:87], v[4:7]
    ds_read_b64_tr_b16 v[126:127], v135 offset:41984
    s_waitcnt lgkmcnt(12)
    v_mfma_f32_16x16x32_bf16 v[8:11], v[100:103], a[20:23], v[8:11]
    ds_read_b64_tr_b16 v[64:65], v128 offset:49152
    v_mfma_f32_16x16x32_bf16 v[12:15], v[100:103], a[84:87], v[12:15]
    ds_read_b64_tr_b16 v[66:67], v128 offset:50176
    s_waitcnt lgkmcnt(12)
    v_mfma_f32_16x16x32_bf16 v[16:19], v[104:107], a[20:23], v[16:19]
    ds_read_b64_tr_b16 v[68:69], v129 offset:49152
    v_mfma_f32_16x16x32_bf16 v[20:23], v[104:107], a[84:87], v[20:23]
    ds_read_b64_tr_b16 v[70:71], v129 offset:50176
    s_waitcnt lgkmcnt(12)
    v_mfma_f32_16x16x32_bf16 v[24:27], v[108:111], a[20:23], v[24:27]
    ds_read_b64_tr_b16 v[72:73], v130 offset:49152
    v_mfma_f32_16x16x32_bf16 v[28:31], v[108:111], a[84:87], v[28:31]
    ds_read_b64_tr_b16 v[74:75], v130 offset:50176
    s_waitcnt lgkmcnt(12)
    v_mfma_f32_16x16x32_bf16 v[32:35], v[112:115], a[20:23], v[32:35]
    ds_read_b64_tr_b16 v[76:77], v131 offset:49152
    v_mfma_f32_16x16x32_bf16 v[36:39], v[112:115], a[84:87], v[36:39]
    ds_read_b64_tr_b16 v[78:79], v131 offset:50176
    s_waitcnt lgkmcnt(12)
    v_mfma_f32_16x16x32_bf16 v[40:43], v[116:119], a[20:23], v[40:43]
    ds_read_b64_tr_b16 v[80:81], v132 offset:49152
    v_mfma_f32_16x16x32_bf16 v[44:47], v[116:119], a[84:87], v[44:47]
    ds_read_b64_tr_b16 v[82:83], v132 offset:50176
    s_waitcnt lgkmcnt(12)
    v_mfma_f32_16x16x32_bf16 v[48:51], v[120:123], a[20:23], v[48:51]
    ds_read_b64_tr_b16 v[84:85], v133 offset:49152
    v_mfma_f32_16x16x32_bf16 v[52:55], v[120:123], a[84:87], v[52:55]
    ds_read_b64_tr_b16 v[86:87], v133 offset:50176
    s_waitcnt lgkmcnt(12)
    v_mfma_f32_16x16x32_bf16 v[56:59], v[124:127], a[20:23], v[56:59]
    ds_read_b64_tr_b16 v[88:89], v134 offset:49152
    v_mfma_f32_16x16x32_bf16 v[60:63], v[124:127], a[84:87], v[60:63]
    ds_read_b64_tr_b16 v[90:91], v134 offset:50176
    s_waitcnt lgkmcnt(12)
    v_mfma_f32_16x16x32_bf16 v[0:3], v[64:67], a[24:27], v[0:3]
    ds_read_b64_tr_b16 v[92:93], v135 offset:49152
    v_mfma_f32_16x16x32_bf16 v[4:7], v[64:67], a[88:91], v[4:7]
    ds_read_b64_tr_b16 v[94:95], v135 offset:50176
    s_waitcnt lgkmcnt(12)
    v_mfma_f32_16x16x32_bf16 v[8:11], v[68:71], a[24:27], v[8:11]
    ds_read_b64_tr_b16 v[96:97], v128 offset:57344
    v_mfma_f32_16x16x32_bf16 v[12:15], v[68:71], a[88:91], v[12:15]
    ds_read_b64_tr_b16 v[98:99], v128 offset:58368
    s_waitcnt lgkmcnt(12)
    v_mfma_f32_16x16x32_bf16 v[16:19], v[72:75], a[24:27], v[16:19]
    ds_read_b64_tr_b16 v[100:101], v129 offset:57344
    v_mfma_f32_16x16x32_bf16 v[20:23], v[72:75], a[88:91], v[20:23]
    ds_read_b64_tr_b16 v[102:103], v129 offset:58368
    s_waitcnt lgkmcnt(12)
    v_mfma_f32_16x16x32_bf16 v[24:27], v[76:79], a[24:27], v[24:27]
    ds_read_b64_tr_b16 v[104:105], v130 offset:57344
    v_mfma_f32_16x16x32_bf16 v[28:31], v[76:79], a[88:91], v[28:31]
    ds_read_b64_tr_b16 v[106:107], v130 offset:58368
    s_waitcnt lgkmcnt(12)
    v_mfma_f32_16x16x32_bf16 v[32:35], v[80:83], a[24:27], v[32:35]
    ds_read_b64_tr_b16 v[108:109], v131 offset:57344
    v_mfma_f32_16x16x32_bf16 v[36:39], v[80:83], a[88:91], v[36:39]
    ds_read_b64_tr_b16 v[110:111], v131 offset:58368
    s_waitcnt lgkmcnt(12)
    v_mfma_f32_16x16x32_bf16 v[40:43], v[84:87], a[24:27], v[40:43]
    ds_read_b64_tr_b16 v[112:113], v132 offset:57344
    v_mfma_f32_16x16x32_bf16 v[44:47], v[84:87], a[88:91], v[44:47]
    ds_read_b64_tr_b16 v[114:115], v132 offset:58368
    s_waitcnt lgkmcnt(12)
    v_mfma_f32_16x16x32_bf16 v[48:51], v[88:91], a[24:27], v[48:51]
    ds_read_b64_tr_b16 v[116:117], v133 offset:57344
    v_mfma_f32_16x16x32_bf16 v[52:55], v[88:91], a[88:91], v[52:55]
    ds_read_b64_tr_b16 v[118:119], v133 offset:58368
    s_waitcnt lgkmcnt(12)
    v_mfma_f32_16x16x32_bf16 v[56:59], v[92:95], a[24:27], v[56:59]
    ds_read_b64_tr_b16 v[120:121], v134 offset:57344
    v_mfma_f32_16x16x32_bf16 v[60:63], v[92:95], a[88:91], v[60:63]
    ds_read_b64_tr_b16 v[122:123], v134 offset:58368
    s_waitcnt lgkmcnt(12)
    v_mfma_f32_16x16x32_bf16 v[0:3], v[96:99], a[28:31], v[0:3]
    ds_read_b64_tr_b16 v[124:125], v135 offset:57344
    v_mfma_f32_16x16x32_bf16 v[4:7], v[96:99], a[92:95], v[4:7]
    ds_read_b64_tr_b16 v[126:127], v135 offset:58368
    s_waitcnt lgkmcnt(12)
    v_mfma_f32_16x16x32_bf16 v[8:11], v[100:103], a[28:31], v[8:11]
    v_mfma_f32_16x16x32_bf16 v[12:15], v[100:103], a[92:95], v[12:15]
    s_waitcnt lgkmcnt(10)
    v_mfma_f32_16x16x32_bf16 v[16:19], v[104:107], a[28:31], v[16:19]
    v_mfma_f32_16x16x32_bf16 v[20:23], v[104:107], a[92:95], v[20:23]
    s_waitcnt lgkmcnt(8)
    v_mfma_f32_16x16x32_bf16 v[24:27], v[108:111], a[28:31], v[24:27]
    v_mfma_f32_16x16x32_bf16 v[28:31], v[108:111], a[92:95], v[28:31]
    s_waitcnt lgkmcnt(6)
    v_mfma_f32_16x16x32_bf16 v[32:35], v[112:115], a[28:31], v[32:35]
    v_mfma_f32_16x16x32_bf16 v[36:39], v[112:115], a[92:95], v[36:39]
    s_waitcnt lgkmcnt(4)
    v_mfma_f32_16x16x32_bf16 v[40:43], v[116:119], a[28:31], v[40:43]
    v_mfma_f32_16x16x32_bf16 v[44:47], v[116:119], a[92:95], v[44:47]
    s_waitcnt lgkmcnt(2)
    v_mfma_f32_16x16x32_bf16 v[48:51], v[120:123], a[28:31], v[48:51]
    v_mfma_f32_16x16x32_bf16 v[52:55], v[120:123], a[92:95], v[52:55]
    s_waitcnt lgkmcnt(0)
    v_mfma_f32_16x16x32_bf16 v[56:59], v[124:127], a[28:31], v[56:59]
    v_mfma_f32_16x16x32_bf16 v[60:63], v[124:127], a[92:95], v[60:63]
    v_xor_b32 v128, 0x10000, v128
    v_xor_b32 v129, 0x10000, v129
    v_xor_b32 v130, 0x10000, v130
    v_xor_b32 v131, 0x10000, v131
    v_xor_b32 v132, 0x10000, v132
    v_xor_b32 v133, 0x10000, v133
    v_xor_b32 v134, 0x10000, v134
    v_xor_b32 v135, 0x10000, v135
    s_waitcnt vmcnt(16)
    s_barrier
    ds_read_b64_tr_b16 v[64:65], v128
    ds_read_b64_tr_b16 v[66:67], v128 offset:1024
    ds_read_b64_tr_b16 v[68:69], v129
    ds_read_b64_tr_b16 v[70:71], v129 offset:1024
    ds_read_b64_tr_b16 v[72:73], v130
    ds_read_b64_tr_b16 v[74:75], v130 offset:1024
    ds_read_b64_tr_b16 v[76:77], v131
    ds_read_b64_tr_b16 v[78:79], v131 offset:1024
    ds_read_b64_tr_b16 v[80:81], v132
    ds_read_b64_tr_b16 v[82:83], v132 offset:1024
    ds_read_b64_tr_b16 v[84:85], v133
    ds_read_b64_tr_b16 v[86:87], v133 offset:1024
    ds_read_b64_tr_b16 v[88:89], v134
    ds_read_b64_tr_b16 v[90:91], v134 offset:1024
    s_cmp_eq_u32 s40, 0
    s_cbranch_scc1 L_nopf_86
    s_cmp_lg_u32 s87, 0
    s_cbranch_scc1 L_modeok_87
    s_mov_b32 s96, 0
L_mode_88:
    buffer_load_dwordx2 v[140:141], off, s[92:95], 0 offset:36 sc1
    s_waitcnt vmcnt(0)
    v_readfirstlane_b32 s87, v140
    v_readfirstlane_b32 s97, v141
    s_nop 0
    s_min_u32 s97, s97, s87
    s_cmp_lg_u32 s97, 0
    s_cbranch_scc1 L_moded_89
    s_sleep 4
    s_add_u32 s96, s96, 1
    s_cmp_lg_u32 s96, 0x100
    s_cbranch_scc1 L_modef_90
    v_mov_b32 v140, 2
    v_mov_b32 v141, 0
    s_mov_b64 exec, 1
    buffer_atomic_cmpswap v[140:141], off, s[92:95], 0 offset:36
    s_mov_b64 exec, -1
L_modef_90:
    s_cmp_lt_u32 s96, 0x10000
    s_cbranch_scc1 L_mode_88
L_moded_89:
    s_cmp_lg_u32 s87, 1
    s_cbranch_scc1 L_fallback
L_modeok_87:
    s_cmp_lg_u32 s100, 0
    s_cbranch_scc1 L_flag_91
    v_mov_b32 v138, 1
    s_mov_b64 exec, 1
    buffer_store_dword v138, off, s[8:11], s40 sc1
    s_mov_b64 exec, -1
L_flag_91:
    s_mov_b32 s40, 0
L_nopf_86:
    s_waitcnt lgkmcnt(12)
    v_mfma_f32_16x16x32_bf16 v[0:3], v[64:67], a[32:35], v[0:3]
    ds_read_b64_tr_b16 v[92:93], v135
    v_mfma_f32_16x16x32_bf16 v[4:7], v[64:67], a[96:99], v[4:7]
    ds_read_b64_tr_b16 v[94:95], v135 offset:1024
    s_add_u32 s26, s24, 0x100000
    s_add_u32 m0, s29, 0x8000
    s_nop 0
    buffer_load_dwordx4 v136, s[16:19], s26 offen lds
    s_waitcnt lgkmcnt(12)
    v_mfma_f32_16x16x32_bf16 v[8:11], v[68:71], a[32:35], v[8:11]
    ds_read_b64_tr_b16 v[96:97], v128 offset:8192
    v_mfma_f32_16x16x32_bf16 v[12:15], v[68:71], a[96:99], v[12:15]
    ds_read_b64_tr_b16 v[98:99], v128 offset:9216
    s_add_u32 s26, s24, 0x120000
    s_add_u32 m0, s29, 0x9000
    s_nop 0
    buffer_load_dwordx4 v136, s[16:19], s26 offen lds
    s_waitcnt lgkmcnt(12)
    v_mfma_f32_16x16x32_bf16 v[16:19], v[72:75], a[32:35], v[16:19]
    ds_read_b64_tr_b16 v[100:101], v129 offset:8192
    v_mfma_f32_16x16x32_bf16 v[20:23], v[72:75], a[96:99], v[20:23]
    ds_read_b64_tr_b16 v[102:103], v129 offset:9216
    s_add_u32 s26, s24, 0x140000
    s_add_u32 m0, s29, 0xa000
    s_nop 0
    buffer_load_dwordx4 v136, s[16:19], s26 offen lds
    s_waitcnt lgkmcnt(12)
    v_mfma_f32_16x16x32_bf16 v[24:27], v[76:79], a[32:35], v[24:27]
    ds_read_b64_tr_b16 v[104:105], v130 offset:8192
    v_mfma_f32_16x16x32_bf16 v[28:31], v[76:79], a[96:99], v[28:31]
    ds_read_b64_tr_b16 v[106:107], v130 offset:9216
    s_add_u32 s26, s24, 0x160000
    s_add_u32 m0, s29, 0xb000
    s_nop 0
    buffer_load_dwordx4 v136, s[16:19], s26 offen lds
    s_waitcnt lgkmcnt(12)
    v_mfma_f32_16x16x32_bf16 v[32:35], v[80:83], a[32:35], v[32:35]
    ds_read_b64_tr_b16 v[108:109], v131 offset:8192
    v_mfma_f32_16x16x32_bf16 v[36:39], v[80:83], a[96:99], v[36:39]
    ds_read_b64_tr_b16 v[110:111], v131 offset:9216
    s_add_u32 s26, s24, 0x180000
    s_add_u32 m0, s29, 0xc000
    s_nop 0
    buffer_load_dwordx4 v136, s[16:19], s26 offen lds
    s_waitcnt lgkmcnt(12)
    v_mfma_f32_16x16x32_bf16 v[40:43], v[84:87], a[32:35], v[40:43]
    ds_read_b64_tr_b16 v[112:113], v132 offset:8192
    v_mfma_f32_16x16x32_bf16 v[44:47], v[84:87], a[96:99], v[44:47]
    ds_read_b64_tr_b16 v[114:115], v132 offset:9216
    s_add_u32 s26, s24, 0x1a0000
    s_add_u32 m0, s29, 0xd000
    s_nop 0
    buffer_load_dwordx4 v136, s[16:19], s26 offen lds
    s_waitcnt lgkmcnt(12)
    v_mfma_f32_16x16x32_bf16 v[48:51], v[88:91], a[32:35], v[48:51]
    ds_read_b64_tr_b16 v[116:117], v133 offset:8192
    v_mfma_f32_16x16x32_bf16 v[52:55], v[88:91], a[96:99], v[52:55]
    ds_read_b64_tr_b16 v[118:119], v133 offset:9216
    s_add_u32 s26, s24, 0x1c0000
    s_add_u32 m0, s29, 0xe000
    s_nop 0
    buffer_load_dwordx4 v136, s[16:19], s26 offen lds
    s_waitcnt lgkmcnt(12)
    v_mfma_f32_16x16x32_bf16 v[56:59], v[92:95], a[32:35], v[56:59]
    ds_read_b64_tr_b16 v[120:121], v134 offset:8192
    v_mfma_f32_16x16x32_bf16 v[60:63], v[92:95], a[96:99], v[60:63]
    ds_read_b64_tr_b16 v[122:123], v134 offset:9216
    s_add_u32 s26, s24, 0x1e0000
    s_add_u32 m0, s29, 0xf000
    s_nop 0
    buffer_load_dwordx4 v136, s[16:19], s26 offen lds
    s_waitcnt lgkmcnt(12)
    v_mfma_f32_16x16x32_bf16 v[0:3], v[96:99], a[36:39], v[0:3]
    ds_read_b64_tr_b16 v[124:125], v135 offset:8192
    v_mfma_f32_16x16x32_bf16 v[4:7], v[96:99], a[100:103], v[4:7]
    ds_read_b64_tr_b16 v[126:127], v135 offset:9216
    s_waitcnt lgkmcnt(12)
    v_mfma_f32_16x16x32_bf16 v[8:11], v[100:103], a[36:39], v[8:11]
    ds_read_b64_tr_b16 v[64:65], v128 offset:16384
    v_mfma_f32_16x16x32_bf16 v[12:15], v[100:103], a[100:103], v[12:15]
    ds_read_b64_tr_b16 v[66:67], v128 offset:17408
    s_waitcnt lgkmcnt(12)
    v_mfma_f32_16x16x32_bf16 v[16:19], v[104:107], a[36:39], v[16:19]
    ds_read_b64_tr_b16 v[68:69], v129 offset:16384
    v_mfma_f32_16x16x32_bf16 v[20:23], v[104:107], a[100:103], v[20:23]
    ds_read_b64_tr_b16 v[70:71], v129 offset:17408
    s_waitcnt lgkmcnt(12)
    v_mfma_f32_16x16x32_bf16 v[24:27], v[108:111], a[36:39], v[24:27]
    ds_read_b64_tr_b16 v[72:73], v130 offset:16384
    v_mfma_f32_16x16x32_bf16 v[28:31], v[108:111], a[100:103], v[28:31]
    ds_read_b64_tr_b16 v[74:75], v130 offset:17408
    s_waitcnt lgkmcnt(12)
    v_mfma_f32_16x16x32_bf16 v[32:35], v[112:115], a[36:39], v[32:35]
    ds_read_b64_tr_b16 v[76:77], v131 offset:16384
    v_mfma_f32_16x16x32_bf16 v[36:39], v[112:115], a[100:103], v[36:39]
    ds_read_b64_tr_b16 v[78:79], v131 offset:17408
    s_waitcnt lgkmcnt(12)
    v_mfma_f32_16x16x32_bf16 v[40:43], v[116:119], a[36:39], v[40:43]
    ds_read_b64_tr_b16 v[80:81], v132 offset:16384
    v_mfma_f32_16x16x32_bf16 v[44:47], v[116:119], a[100:103], v[44:47]
    ds_read_b64_tr_b16 v[82:83], v132 offset:17408
    s_waitcnt lgkmcnt(12)
    v_mfma_f32_16x16x32_bf16 v[48:51], v[120:123], a[36:39], v[48:51]
    ds_read_b64_tr_b16 v[84:85], v133 offset:16384
    v_mfma_f32_16x16x32_bf16 v[52:55], v[120:123], a[100:103], v[52:55]
    ds_read_b64_tr_b16 v[86:87], v133 offset:17408
    s_waitcnt lgkmcnt(12)
    v_mfma_f32_16x16x32_bf16 v[56:59], v[124:127], a[36:39], v[56:59]
    ds_read_b64_tr_b16 v[88:89], v134 offset:16384
    v_mfma_f32_16x16x32_bf16 v[60:63], v[124:127], a[100:103], v[60:63]
    ds_read_b64_tr_b16 v[90:91], v134 offset:17408
    s_waitcnt lgkmcnt(12)
    v_mfma_f32_16x16x32_bf16 v[0:3], v[64:67], a[40:43], v[0:3]
    ds_read_b64_tr_b16 v[92:93], v135 offset:16384
    v_mfma_f32_16x16x32_bf16 v[4:7], v[64:67], a[104:107], v[4:7]
    ds_read_b64_tr_b16 v[94:95], v135 offset:17408
    s_waitcnt lgkmcnt(12)
    v_mfma_f32_16x16x32_bf16 v[8:11], v[68:71], a[40:43], v[8:11]
    ds_read_b64_tr_b16 v[96:97], v128 offset:24576
    v_mfma_f32_16x16x32_bf16 v[12:15], v[68:71], a[104:107], v[12:15]
    ds_read_b64_tr_b16 v[98:99], v128 offset:25600
    s_waitcnt lgkmcnt(12)
    v_mfma_f32_16x16x32_bf16 v[16:19], v[72:75], a[40:43], v[16:19]
    ds_read_b64_tr_b16 v[100:101], v129 offset:24576
    v_mfma_f32_16x16x32_bf16 v[20:23], v[72:75], a[104:107], v[20:23]
    ds_read_b64_tr_b16 v[102:103], v129 offset:25600
    s_waitcnt lgkmcnt(12)
    v_mfma_f32_16x16x32_bf16 v[24:27], v[76:79], a[40:43], v[24:27]
    ds_read_b64_tr_b16 v[104:105], v130 offset:24576
    v_mfma_f32_16x16x32_bf16 v[28:31], v[76:79], a[104:107], v[28:31]
    ds_read_b64_tr_b16 v[106:107], v130 offset:25600
    s_waitcnt lgkmcnt(12)
    v_mfma_f32_16x16x32_bf16 v[32:35], v[80:83], a[40:43], v[32:35]
    ds_read_b64_tr_b16 v[108:109], v131 offset:24576
    v_mfma_f32_16x16x32_bf16 v[36:39], v[80:83], a[104:107], v[36:39]
    ds_read_b64_tr_b16 v[110:111], v131 offset:25600
    s_waitcnt lgkmcnt(12)
    v_mfma_f32_16x16x32_bf16 v[40:43], v[84:87], a[40:43], v[40:43]
    ds_read_b64_tr_b16 v[112:113], v132 offset:24576
    v_mfma_f32_16x16x32_bf16 v[44:47], v[84:87], a[104:107], v[44:47]
    ds_read_b64_tr_b16 v[114:115], v132 offset:25600
    s_waitcnt lgkmcnt(12)
    v_mfma_f32_16x16x32_bf16 v[48:51], v[88:91], a[40:43], v[48:51]
    ds_read_b64_tr_b16 v[116:117], v133 offset:24576
    v_mfma_f32_16x16x32_bf16 v[52:55], v[88:91], a[104:107], v[52:55]
    ds_read_b64_tr_b16 v[118:119], v133 offset:25600
    s_waitcnt lgkmcnt(12)
    v_mfma_f32_16x16x32_bf16 v[56:59], v[92:95], a[40:43], v[56:59]
    ds_read_b64_tr_b16 v[120:121], v134 offset:24576
    v_mfma_f32_16x16x32_bf16 v[60:63], v[92:95], a[104:107], v[60:63]
    ds_read_b64_tr_b16 v[122:123], v134 offset:25600
    s_waitcnt lgkmcnt(12)
    v_mfma_f32_16x16x32_bf16 v[0:3], v[96:99], a[44:47], v[0:3]
    ds_read_b64_tr_b16 v[124:125], v135 offset:24576
    v_mfma_f32_16x16x32_bf16 v[4:7], v[96:99], a[108:111], v[4:7]
    ds_read_b64_tr_b16 v[126:127], v135 offset:25600
    s_waitcnt lgkmcnt(12)
    v_mfma_f32_16x16x32_bf16 v[8:11], v[100:103], a[44:47], v[8:11]
    v_mfma_f32_16x16x32_bf16 v[12:15], v[100:103], a[108:111], v[12:15]
    s_waitcnt lgkmcnt(10)
    v_mfma_f32_16x16x32_bf16 v[16:19], v[104:107], a[44:47], v[16:19]
    v_mfma_f32_16x16x32_bf16 v[20:23], v[104:107], a[108:111], v[20:23]
    s_waitcnt lgkmcnt(8)
    v_mfma_f32_16x16x32_bf16 v[24:27], v[108:111], a[44:47], v[24:27]
    v_mfma_f32_16x16x32_bf16 v[28:31], v[108:111], a[108:111], v[28:31]
    s_waitcnt lgkmcnt(6)
    v_mfma_f32_16x16x32_bf16 v[32:35], v[112:115], a[44:47], v[32:35]
    v_mfma_f32_16x16x32_bf16 v[36:39], v[112:115], a[108:111], v[36:39]
    s_waitcnt lgkmcnt(4)
    v_mfma_f32_16x16x32_bf16 v[40:43], v[116:119], a[44:47], v[40:43]
    v_mfma_f32_16x16x32_bf16 v[44:47], v[116:119], a[108:111], v[44:47]
    s_waitcnt lgkmcnt(2)
    v_mfma_f32_16x16x32_bf16 v[48:51], v[120:123], a[44:47], v[48:51]
    v_mfma_f32_16x16x32_bf16 v[52:55], v[120:123], a[108:111], v[52:55]
    s_waitcnt lgkmcnt(0)
    v_mfma_f32_16x16x32_bf16 v[56:59], v[124:127], a[44:47], v[56:59]
    v_mfma_f32_16x16x32_bf16 v[60:63], v[124:127], a[108:111], v[60:63]
    s_waitcnt vmcnt(16)
    s_barrier
    ds_read_b64_tr_b16 v[64:65], v128 offset:32768
    ds_read_b64_tr_b16 v[66:67], v128 offset:33792
    ds_read_b64_tr_b16 v[68:69], v129 offset:32768
    ds_read_b64_tr_b16 v[70:71], v129 offset:33792
    ds_read_b64_tr_b16 v[72:73], v130 offset:32768
    ds_read_b64_tr_b16 v[74:75], v130 offset:33792
    ds_read_b64_tr_b16 v[76:77], v131 offset:32768
    ds_read_b64_tr_b16 v[78:79], v131 offset:33792
    ds_read_b64_tr_b16 v[80:81], v132 offset:32768
    ds_read_b64_tr_b16 v[82:83], v132 offset:33792
    ds_read_b64_tr_b16 v[84:85], v133 offset:32768
    ds_read_b64_tr_b16 v[86:87], v133 offset:33792
    ds_read_b64_tr_b16 v[88:89], v134 offset:32768
    ds_read_b64_tr_b16 v[90:91], v134 offset:33792
    s_waitcnt lgkmcnt(12)
    v_mfma_f32_16x16x32_bf16 v[0:3], v[64:67], a[48:51], v[0:3]
    ds_read_b64_tr_b16 v[92:93], v135 offset:32768
    v_mfma_f32_16x16x32_bf16 v[4:7], v[64:67], a[112:115], v[4:7]
    ds_read_b64_tr_b16 v[94:95], v135 offset:33792
    s_add_u32 s26, s24, 0x200000
    s_add_u32 m0, s29, 0x10000
    s_nop 0
    buffer_load_dwordx4 v136, s[16:19], s26 offen lds
    s_waitcnt lgkmcnt(12)
    v_mfma_f32_16x16x32_bf16 v[8:11], v[68:71], a[48:51], v[8:11]
    ds_read_b64_tr_b16 v[96:97], v128 offset:40960
    v_mfma_f32_16x16x32_bf16 v[12:15], v[68:71], a[112:115], v[12:15]
    ds_read_b64_tr_b16 v[98:99], v128 offset:41984
    s_add_u32 s26, s24, 0x220000
    s_add_u32 m0, s29, 0x11000
    s_nop 0
    buffer_load_dwordx4 v136, s[16:19], s26 offen lds
    s_waitcnt lgkmcnt(12)
    v_mfma_f32_16x16x32_bf16 v[16:19], v[72:75], a[48:51], v[16:19]
    ds_read_b64_tr_b16 v[100:101], v129 offset:40960
    v_mfma_f32_16x16x32_bf16 v[20:23], v[72:75], a[112:115], v[20:23]
    ds_read_b64_tr_b16 v[102:103], v129 offset:41984
    s_add_u32 s26, s24, 0x240000
    s_add_u32 m0, s29, 0x12000
    s_nop 0
    buffer_load_dwordx4 v136, s[16:19], s26 offen lds
    s_waitcnt lgkmcnt(12)
    v_mfma_f32_16x16x32_bf16 v[24:27], v[76:79], a[48:51], v[24:27]
    ds_read_b64_tr_b16 v[104:105], v130 offset:40960
    v_mfma_f32_16x16x32_bf16 v[28:31], v[76:79], a[112:115], v[28:31]
    ds_read_b64_tr_b16 v[106:107], v130 offset:41984
    s_add_u32 s26, s24, 0x260000
    s_add_u32 m0, s29, 0x13000
    s_nop 0
    buffer_load_dwordx4 v136, s[16:19], s26 offen lds
    s_waitcnt lgkmcnt(12)
    v_mfma_f32_16x16x32_bf16 v[32:35], v[80:83], a[48:51], v[32:35]
    ds_read_b64_tr_b16 v[108:109], v131 offset:40960
    v_mfma_f32_16x16x32_bf16 v[36:39], v[80:83], a[112:115], v[36:39]
    ds_read_b64_tr_b16 v[110:111], v131 offset:41984
    s_add_u32 s26, s24, 0x280000
    s_add_u32 m0, s29, 0x14000
    s_nop 0
    buffer_load_dwordx4 v136, s[16:19], s26 offen lds
    s_waitcnt lgkmcnt(12)
    v_mfma_f32_16x16x32_bf16 v[40:43], v[84:87], a[48:51], v[40:43]
    ds_read_b64_tr_b16 v[112:113], v132 offset:40960
    v_mfma_f32_16x16x32_bf16 v[44:47], v[84:87], a[112:115], v[44:47]
    ds_read_b64_tr_b16 v[114:115], v132 offset:41984
    s_add_u32 s26, s24, 0x2a0000
    s_add_u32 m0, s29, 0x15000
    s_nop 0
    buffer_load_dwordx4 v136, s[16:19], s26 offen lds
    s_waitcnt lgkmcnt(12)
    v_mfma_f32_16x16x32_bf16 v[48:51], v[88:91], a[48:51], v[48:51]
    ds_read_b64_tr_b16 v[116:117], v133 offset:40960
    v_mfma_f32_16x16x32_bf16 v[52:55], v[88:91], a[112:115], v[52:55]
    ds_read_b64_tr_b16 v[118:119], v133 offset:41984
    s_add_u32 s26, s24, 0x2c0000
    s_add_u32 m0, s29, 0x16000
    s_nop 0
    buffer_load_dwordx4 v136, s[16:19], s26 offen lds
    s_waitcnt lgkmcnt(12)
    v_mfma_f32_16x16x32_bf16 v[56:59], v[92:95], a[48:51], v[56:59]
    ds_read_b64_tr_b16 v[120:121], v134 offset:40960
    v_mfma_f32_16x16x32_bf16 v[60:63], v[92:95], a[112:115], v[60:63]
    ds_read_b64_tr_b16 v[122:123], v134 offset:41984
    s_add_u32 s26, s24, 0x2e0000
    s_add_u32 m0, s29, 0x17000
    s_nop 0
    buffer_load_dwordx4 v136, s[16:19], s26 offen lds
    s_waitcnt lgkmcnt(12)
    v_mfma_f32_16x16x32_bf16 v[0:3], v[96:99], a[52:55], v[0:3]
    ds_read_b64_tr_b16 v[124:125], v135 offset:40960
    v_mfma_f32_16x16x32_bf16 v[4:7], v[96:99], a[116:119], v[4:7]
    ds_read_b64_tr_b16 v[126:127], v135 offset:41984
    s_waitcnt lgkmcnt(12)
    v_mfma_f32_16x16x32_bf16 v[8:11], v[100:103], a[52:55], v[8:11]
    ds_read_b64_tr_b16 v[64:65], v128 offset:49152
    v_mfma_f32_16x16x32_bf16 v[12:15], v[100:103], a[116:119], v[12:15]
    ds_read_b64_tr_b16 v[66:67], v128 offset:50176
    s_waitcnt lgkmcnt(12)
    v_mfma_f32_16x16x32_bf16 v[16:19], v[104:107], a[52:55], v[16:19]
    ds_read_b64_tr_b16 v[68:69], v129 offset:49152
    v_mfma_f32_16x16x32_bf16 v[20:23], v[104:107], a[116:119], v[20:23]
    ds_read_b64_tr_b16 v[70:71], v129 offset:50176
    s_waitcnt lgkmcnt(12)
    v_mfma_f32_16x16x32_bf16 v[24:27], v[108:111], a[52:55], v[24:27]
    ds_read_b64_tr_b16 v[72:73], v130 offset:49152
    v_mfma_f32_16x16x32_bf16 v[28:31], v[108:111], a[116:119], v[28:31]
    ds_read_b64_tr_b16 v[74:75], v130 offset:50176
    s_waitcnt lgkmcnt(12)
    v_mfma_f32_16x16x32_bf16 v[32:35], v[112:115], a[52:55], v[32:35]
    ds_read_b64_tr_b16 v[76:77], v131 offset:49152
    v_mfma_f32_16x16x32_bf16 v[36:39], v[112:115], a[116:119], v[36:39]
    ds_read_b64_tr_b16 v[78:79], v131 offset:50176
    s_waitcnt lgkmcnt(12)
    v_mfma_f32_16x16x32_bf16 v[40:43], v[116:119], a[52:55], v[40:43]
    ds_read_b64_tr_b16 v[80:81], v132 offset:49152
    v_mfma_f32_16x16x32_bf16 v[44:47], v[116:119], a[116:119], v[44:47]
    ds_read_b64_tr_b16 v[82:83], v132 offset:50176
    s_waitcnt lgkmcnt(12)
    v_mfma_f32_16x16x32_bf16 v[48:51], v[120:123], a[52:55], v[48:51]
    ds_read_b64_tr_b16 v[84:85], v133 offset:49152
    v_mfma_f32_16x16x32_bf16 v[52:55], v[120:123], a[116:119], v[52:55]
    ds_read_b64_tr_b16 v[86:87], v133 offset:50176
    s_waitcnt lgkmcnt(12)
    v_mfma_f32_16x16x32_bf16 v[56:59], v[124:127], a[52:55], v[56:59]
    ds_read_b64_tr_b16 v[88:89], v134 offset:49152
    v_mfma_f32_16x16x32_bf16 v[60:63], v[124:127], a[116:119], v[60:63]
    ds_read_b64_tr_b16 v[90:91], v134 offset:50176
    s_waitcnt lgkmcnt(12)
    v_mfma_f32_16x16x32_bf16 v[0:3], v[64:67], a[56:59], v[0:3]
    ds_read_b64_tr_b16 v[92:93], v135 offset:49152
    v_mfma_f32_16x16x32_bf16 v[4:7], v[64:67], a[120:123], v[4:7]
    ds_read_b64_tr_b16 v[94:95], v135 offset:50176
    s_waitcnt lgkmcnt(12)
    v_mfma_f32_16x16x32_bf16 v[8:11], v[68:71], a[56:59], v[8:11]
    ds_read_b64_tr_b16 v[96:97], v128 offset:57344
    v_mfma_f32_16x16x32_bf16 v[12:15], v[68:71], a[120:123], v[12:15]
    ds_read_b64_tr_b16 v[98:99], v128 offset:58368
    s_waitcnt lgkmcnt(12)
    v_mfma_f32_16x16x32_bf16 v[16:19], v[72:75], a[56:59], v[16:19]
    ds_read_b64_tr_b16 v[100:101], v129 offset:57344
    v_mfma_f32_16x16x32_bf16 v[20:23], v[72:75], a[120:123], v[20:23]
    ds_read_b64_tr_b16 v[102:103], v129 offset:58368
    s_waitcnt lgkmcnt(12)
    v_mfma_f32_16x16x32_bf16 v[24:27], v[76:79], a[56:59], v[24:27]
    ds_read_b64_tr_b16 v[104:105], v130 offset:57344
    v_mfma_f32_16x16x32_bf16 v[28:31], v[76:79], a[120:123], v[28:31]
    ds_read_b64_tr_b16 v[106:107], v130 offset:58368
    s_waitcnt lgkmcnt(12)
    v_mfma_f32_16x16x32_bf16 v[32:35], v[80:83], a[56:59], v[32:35]
    ds_read_b64_tr_b16 v[108:109], v131 offset:57344
    v_mfma_f32_16x16x32_bf16 v[36:39], v[80:83], a[120:123], v[36:39]
    ds_read_b64_tr_b16 v[110:111], v131 offset:58368
    s_waitcnt lgkmcnt(12)
    v_mfma_f32_16x16x32_bf16 v[40:43], v[84:87], a[56:59], v[40:43]
    ds_read_b64_tr_b16 v[112:113], v132 offset:57344
    v_mfma_f32_16x16x32_bf16 v[44:47], v[84:87], a[120:123], v[44:47]
    ds_read_b64_tr_b16 v[114:115], v132 offset:58368
    s_waitcnt lgkmcnt(12)
    v_mfma_f32_16x16x32_bf16 v[48:51], v[88:91], a[56:59], v[48:51]
    ds_read_b64_tr_b16 v[116:117], v133 offset:57344
    v_mfma_f32_16x16x32_bf16 v[52:55], v[88:91], a[120:123], v[52:55]
    ds_read_b64_tr_b16 v[118:119], v133 offset:58368
    s_waitcnt lgkmcnt(12)
    v_mfma_f32_16x16x32_bf16 v[56:59], v[92:95], a[56:59], v[56:59]
    ds_read_b64_tr_b16 v[120:121], v134 offset:57344
    v_mfma_f32_16x16x32_bf16 v[60:63], v[92:95], a[120:123], v[60:63]
    ds_read_b64_tr_b16 v[122:123], v134 offset:58368
    s_waitcnt lgkmcnt(12)
    v_mfma_f32_16x16x32_bf16 v[0:3], v[96:99], a[60:63], v[0:3]
    ds_read_b64_tr_b16 v[124:125], v135 offset:57344
    v_mfma_f32_16x16x32_bf16 v[4:7], v[96:99], a[124:127], v[4:7]
    ds_read_b64_tr_b16 v[126:127], v135 offset:58368
    s_waitcnt lgkmcnt(12)
    v_mfma_f32_16x16x32_bf16 v[8:11], v[100:103], a[60:63], v[8:11]
    v_mfma_f32_16x16x32_bf16 v[12:15], v[100:103], a[124:127], v[12:15]
    s_waitcnt lgkmcnt(10)
    v_mfma_f32_16x16x32_bf16 v[16:19], v[104:107], a[60:63], v[16:19]
    v_mfma_f32_16x16x32_bf16 v[20:23], v[104:107], a[124:127], v[20:23]
    s_waitcnt lgkmcnt(8)
    v_mfma_f32_16x16x32_bf16 v[24:27], v[108:111], a[60:63], v[24:27]
    v_mfma_f32_16x16x32_bf16 v[28:31], v[108:111], a[124:127], v[28:31]
    s_waitcnt lgkmcnt(6)
    v_mfma_f32_16x16x32_bf16 v[32:35], v[112:115], a[60:63], v[32:35]
    v_mfma_f32_16x16x32_bf16 v[36:39], v[112:115], a[124:127], v[36:39]
    s_waitcnt lgkmcnt(4)
    v_mfma_f32_16x16x32_bf16 v[40:43], v[116:119], a[60:63], v[40:43]
    v_mfma_f32_16x16x32_bf16 v[44:47], v[116:119], a[124:127], v[44:47]
    s_waitcnt lgkmcnt(2)
    v_mfma_f32_16x16x32_bf16 v[48:51], v[120:123], a[60:63], v[48:51]
    v_mfma_f32_16x16x32_bf16 v[52:55], v[120:123], a[124:127], v[52:55]
    s_waitcnt lgkmcnt(0)
    v_mfma_f32_16x16x32_bf16 v[56:59], v[124:127], a[60:63], v[56:59]
    v_mfma_f32_16x16x32_bf16 v[60:63], v[124:127], a[124:127], v[60:63]
    v_xor_b32 v128, 0x10000, v128
    v_xor_b32 v129, 0x10000, v129
    v_xor_b32 v130, 0x10000, v130
    v_xor_b32 v131, 0x10000, v131
    v_xor_b32 v132, 0x10000, v132
    v_xor_b32 v133, 0x10000, v133
    v_xor_b32 v134, 0x10000, v134
    v_xor_b32 v135, 0x10000, v135
    v_cvt_pk_bf16_f32 v144, v0, v8
    v_cvt_pk_bf16_f32 v145, v1, v9
    v_cvt_pk_bf16_f32 v146, v2, v10
    v_cvt_pk_bf16_f32 v147, v3, v11
    buffer_store_dwordx4 v[144:147], v137, s[8:11], s25 offen sc1
    v_cvt_pk_bf16_f32 v148, v16, v24
    v_cvt_pk_bf16_f32 v149, v17, v25
    v_cvt_pk_bf16_f32 v150, v18, v26
    v_cvt_pk_bf16_f32 v151, v19, v27
    buffer_store_dwordx4 v[148:151], v137, s[8:11], s25 offen offset:1024 sc1
    v_cvt_pk_bf16_f32 v152, v32, v40
    v_cvt_pk_bf16_f32 v153, v33, v41
    v_cvt_pk_bf16_f32 v154, v34, v42
    v_cvt_pk_bf16_f32 v155, v35, v43
    buffer_store_dwordx4 v[152:155], v137, s[8:11], s25 offen offset:2048 sc1
    v_cvt_pk_bf16_f32 v156, v48, v56
    v_cvt_pk_bf16_f32 v157, v49, v57
    v_cvt_pk_bf16_f32 v158, v50, v58
    v_cvt_pk_bf16_f32 v159, v51, v59
    buffer_store_dwordx4 v[156:159], v137, s[8:11], s25 offen offset:3072 sc1
    v_cvt_pk_bf16_f32 v144, v4, v12
    v_cvt_pk_bf16_f32 v145, v5, v13
    v_cvt_pk_bf16_f32 v146, v6, v14
    v_cvt_pk_bf16_f32 v147, v7, v15
    s_add_u32 s25, s25, 4096
    buffer_store_dwordx4 v[144:147], v137, s[8:11], s25 offen sc1
    v_cvt_pk_bf16_f32 v148, v20, v28
    v_cvt_pk_bf16_f32 v149, v21, v29
    v_cvt_pk_bf16_f32 v150, v22, v30
    v_cvt_pk_bf16_f32 v151, v23, v31
    buffer_store_dwordx4 v[148:151], v137, s[8:11], s25 offen offset:1024 sc1
    v_cvt_pk_bf16_f32 v152, v36, v44
    v_cvt_pk_bf16_f32 v153, v37, v45
    v_cvt_pk_bf16_f32 v154, v38, v46
    v_cvt_pk_bf16_f32 v155, v39, v47
    buffer_store_dwordx4 v[152:155], v137, s[8:11], s25 offen offset:2048 sc1
    v_cvt_pk_bf16_f32 v156, v52, v60
    v_cvt_pk_bf16_f32 v157, v53, v61
    v_cvt_pk_bf16_f32 v158, v54, v62
    v_cvt_pk_bf16_f32 v159, v55, v63
    buffer_store_dwordx4 v[156:159], v137, s[8:11], s25 offen offset:3072 sc1
    s_branch L_p1_next
L_p1_v:
    s_waitcnt vmcnt(16)
    s_barrier
    ds_read_b64_tr_b16 v[64:65], v128
    ds_read_b64_tr_b16 v[66:67], v128 offset:1024
    ds_read_b64_tr_b16 v[68:69], v129
    ds_read_b64_tr_b16 v[70:71], v129 offset:1024
    ds_read_b64_tr_b16 v[72:73], v130
    ds_read_b64_tr_b16 v[74:75], v130 offset:1024
    ds_read_b64_tr_b16 v[76:77], v131
    ds_read_b64_tr_b16 v[78:79], v131 offset:1024
    ds_read_b64_tr_b16 v[80:81], v132
    ds_read_b64_tr_b16 v[82:83], v132 offset:1024
    ds_read_b64_tr_b16 v[84:85], v133
    ds_read_b64_tr_b16 v[86:87], v133 offset:1024
    ds_read_b64_tr_b16 v[88:89], v134
    ds_read_b64_tr_b16 v[90:91], v134 offset:1024
    s_waitcnt lgkmcnt(12)
    v_mfma_f32_16x16x32_bf16 v[0:3], a[0:3], v[64:67], 0
    ds_read_b64_tr_b16 v[92:93], v135
    v_mfma_f32_16x16x32_bf16 v[4:7], a[64:67], v[64:67], 0
    ds_read_b64_tr_b16 v[94:95], v135 offset:1024
    s_add_u32 s26, s24, 0x300000
    s_add_u32 m0, s29, 0x18000
    s_nop 0
    buffer_load_dwordx4 v136, s[16:19], s26 offen lds
    s_waitcnt lgkmcnt(12)
    v_mfma_f32_16x16x32_bf16 v[8:11], a[0:3], v[68:71], 0
    ds_read_b64_tr_b16 v[96:97], v128 offset:8192
    v_mfma_f32_16x16x32_bf16 v[12:15], a[64:67], v[68:71], 0
    ds_read_b64_tr_b16 v[98:99], v128 offset:9216
    s_add_u32 s26, s24, 0x320000
    s_add_u32 m0, s29, 0x19000
    s_nop 0
    buffer_load_dwordx4 v136, s[16:19], s26 offen lds
    s_waitcnt lgkmcnt(12)
    v_mfma_f32_16x16x32_bf16 v[16:19], a[0:3], v[72:75], 0
    ds_read_b64_tr_b16 v[100:101], v129 offset:8192
    v_mfma_f32_16x16x32_bf16 v[20:23], a[64:67], v[72:75], 0
    ds_read_b64_tr_b16 v[102:103], v129 offset:9216
    s_add_u32 s26, s24, 0x340000
    s_add_u32 m0, s29, 0x1a000
    s_nop 0
    buffer_load_dwordx4 v136, s[16:19], s26 offen lds
    s_waitcnt lgkmcnt(12)
    v_mfma_f32_16x16x32_bf16 v[24:27], a[0:3], v[76:79], 0
    ds_read_b64_tr_b16 v[104:105], v130 offset:8192
    v_mfma_f32_16x16x32_bf16 v[28:31], a[64:67], v[76:79], 0
    ds_read_b64_tr_b16 v[106:107], v130 offset:9216
    s_add_u32 s26, s24, 0x360000
    s_add_u32 m0, s29, 0x1b000
    s_nop 0
    buffer_load_dwordx4 v136, s[16:19], s26 offen lds
    s_waitcnt lgkmcnt(12)
    v_mfma_f32_16x16x32_bf16 v[32:35], a[0:3], v[80:83], 0
    ds_read_b64_tr_b16 v[108:109], v131 offset:8192
    v_mfma_f32_16x16x32_bf16 v[36:39], a[64:67], v[80:83], 0
    ds_read_b64_tr_b16 v[110:111], v131 offset:9216
    s_add_u32 s26, s24, 0x380000
    s_add_u32 m0, s29, 0x1c000
    s_nop 0
    buffer_load_dwordx4 v136, s[16:19], s26 offen lds
    s_waitcnt lgkmcnt(12)
    v_mfma_f32_16x16x32_bf16 v[40:43], a[0:3], v[84:87], 0
    ds_read_b64_tr_b16 v[112:113], v132 offset:8192
    v_mfma_f32_16x16x32_bf16 v[44:47], a[64:67], v[84:87], 0
    ds_read_b64_tr_b16 v[114:115], v132 offset:9216
    s_add_u32 s26, s24, 0x3a0000
    s_add_u32 m0, s29, 0x1d000
    s_nop 0
    buffer_load_dwordx4 v136, s[16:19], s26 offen lds
    s_waitcnt lgkmcnt(12)
    v_mfma_f32_16x16x32_bf16 v[48:51], a[0:3], v[88:91], 0
    ds_read_b64_tr_b16 v[116:117], v133 offset:8192
    v_mfma_f32_16x16x32_bf16 v[52:55], a[64:67], v[88:91], 0
    ds_read_b64_tr_b16 v[118:119], v133 offset:9216
    s_add_u32 s26, s24, 0x3c0000
    s_add_u32 m0, s29, 0x1e000
    s_nop 0
    buffer_load_dwordx4 v136, s[16:19], s26 offen lds
    s_waitcnt lgkmcnt(12)
    v_mfma_f32_16x16x32_bf16 v[56:59], a[0:3], v[92:95], 0
    ds_read_b64_tr_b16 v[120:121], v134 offset:8192
    v_mfma_f32_16x16x32_bf16 v[60:63], a[64:67], v[92:95], 0
    ds_read_b64_tr_b16 v[122:123], v134 offset:9216
    s_add_u32 s26, s24, 0x3e0000
    s_add_u32 m0, s29, 0x1f000
    s_nop 0
    buffer_load_dwordx4 v136, s[16:19], s26 offen lds
    s_waitcnt lgkmcnt(12)
    v_mfma_f32_16x16x32_bf16 v[0:3], a[4:7], v[96:99], v[0:3]
    ds_read_b64_tr_b16 v[124:125], v135 offset:8192
    v_mfma_f32_16x16x32_bf16 v[4:7], a[68:71], v[96:99], v[4:7]
    ds_read_b64_tr_b16 v[126:127], v135 offset:9216
    s_waitcnt lgkmcnt(12)
    v_mfma_f32_16x16x32_bf16 v[8:11], a[4:7], v[100:103], v[8:11]
    ds_read_b64_tr_b16 v[64:65], v128 offset:16384
    v_mfma_f32_16x16x32_bf16 v[12:15], a[68:71], v[100:103], v[12:15]
    ds_read_b64_tr_b16 v[66:67], v128 offset:17408
    s_waitcnt lgkmcnt(12)
    v_mfma_f32_16x16x32_bf16 v[16:19], a[4:7], v[104:107], v[16:19]
    ds_read_b64_tr_b16 v[68:69], v129 offset:16384
    v_mfma_f32_16x16x32_bf16 v[20:23], a[68:71], v[104:107], v[20:23]
    ds_read_b64_tr_b16 v[70:71], v129 offset:17408
    s_waitcnt lgkmcnt(12)
    v_mfma_f32_16x16x32_bf16 v[24:27], a[4:7], v[108:111], v[24:27]
    ds_read_b64_tr_b16 v[72:73], v130 offset:16384
    v_mfma_f32_16x16x32_bf16 v[28:31], a[68:71], v[108:111], v[28:31]
    ds_read_b64_tr_b16 v[74:75], v130 offset:17408
    s_waitcnt lgkmcnt(12)
    v_mfma_f32_16x16x32_bf16 v[32:35], a[4:7], v[112:115], v[32:35]
    ds_read_b64_tr_b16 v[76:77], v131 offset:16384
    v_mfma_f32_16x16x32_bf16 v[36:39], a[68:71], v[112:115], v[36:39]
    ds_read_b64_tr_b16 v[78:79], v131 offset:17408
    s_waitcnt lgkmcnt(12)
    v_mfma_f32_16x16x32_bf16 v[40:43], a[4:7], v[116:119], v[40:43]
    ds_read_b64_tr_b16 v[80:81], v132 offset:16384
    v_mfma_f32_16x16x32_bf16 v[44:47], a[68:71], v[116:119], v[44:47]
    ds_read_b64_tr_b16 v[82:83], v132 offset:17408
    s_waitcnt lgkmcnt(12)
    v_mfma_f32_16x16x32_bf16 v[48:51], a[4:7], v[120:123], v[48:51]
    ds_read_b64_tr_b16 v[84:85], v133 offset:16384
    v_mfma_f32_16x16x32_bf16 v[52:55], a[68:71], v[120:123], v[52:55]
    ds_read_b64_tr_b16 v[86:87], v133 offset:17408
    s_waitcnt lgkmcnt(12)
    v_mfma_f32_16x16x32_bf16 v[56:59], a[4:7], v[124:127], v[56:59]
    ds_read_b64_tr_b16 v[88:89], v134 offset:16384
    v_mfma_f32_16x16x32_bf16 v[60:63], a[68:71], v[124:127], v[60:63]
    ds_read_b64_tr_b16 v[90:91], v134 offset:17408
    s_waitcnt lgkmcnt(12)
    v_mfma_f32_16x16x32_bf16 v[0:3], a[8:11], v[64:67], v[0:3]
    ds_read_b64_tr_b16 v[92:93], v135 offset:16384
    v_mfma_f32_16x16x32_bf16 v[4:7], a[72:75], v[64:67], v[4:7]
    ds_read_b64_tr_b16 v[94:95], v135 offset:17408
    s_waitcnt lgkmcnt(12)
    v_mfma_f32_16x16x32_bf16 v[8:11], a[8:11], v[68:71], v[8:11]
    ds_read_b64_tr_b16 v[96:97], v128 offset:24576
    v_mfma_f32_16x16x32_bf16 v[12:15], a[72:75], v[68:71], v[12:15]
    ds_read_b64_tr_b16 v[98:99], v128 offset:25600
    s_waitcnt lgkmcnt(12)
    v_mfma_f32_16x16x32_bf16 v[16:19], a[8:11], v[72:75], v[16:19]
    ds_read_b64_tr_b16 v[100:101], v129 offset:24576
    v_mfma_f32_16x16x32_bf16 v[20:23], a[72:75], v[72:75], v[20:23]
    ds_read_b64_tr_b16 v[102:103], v129 offset:25600
    s_waitcnt lgkmcnt(12)
    v_mfma_f32_16x16x32_bf16 v[24:27], a[8:11], v[76:79], v[24:27]
    ds_read_b64_tr_b16 v[104:105], v130 offset:24576
    v_mfma_f32_16x16x32_bf16 v[28:31], a[72:75], v[76:79], v[28:31]
    ds_read_b64_tr_b16 v[106:107], v130 offset:25600
    s_waitcnt lgkmcnt(12)
    v_mfma_f32_16x16x32_bf16 v[32:35], a[8:11], v[80:83], v[32:35]
    ds_read_b64_tr_b16 v[108:109], v131 offset:24576
    v_mfma_f32_16x16x32_bf16 v[36:39], a[72:75], v[80:83], v[36:39]
    ds_read_b64_tr_b16 v[110:111], v131 offset:25600
    s_waitcnt lgkmcnt(12)
    v_mfma_f32_16x16x32_bf16 v[40:43], a[8:11], v[84:87], v[40:43]
    ds_read_b64_tr_b16 v[112:113], v132 offset:24576
    v_mfma_f32_16x16x32_bf16 v[44:47], a[72:75], v[84:87], v[44:47]
    ds_read_b64_tr_b16 v[114:115], v132 offset:25600
    s_waitcnt lgkmcnt(12)
    v_mfma_f32_16x16x32_bf16 v[48:51], a[8:11], v[88:91], v[48:51]
    ds_read_b64_tr_b16 v[116:117], v133 offset:24576
    v_mfma_f32_16x16x32_bf16 v[52:55], a[72:75], v[88:91], v[52:55]
    ds_read_b64_tr_b16 v[118:119], v133 offset:25600
    s_waitcnt lgkmcnt(12)
    v_mfma_f32_16x16x32_bf16 v[56:59], a[8:11], v[92:95], v[56:59]
    ds_read_b64_tr_b16 v[120:121], v134 offset:24576
    v_mfma_f32_16x16x32_bf16 v[60:63], a[72:75], v[92:95], v[60:63]
    ds_read_b64_tr_b16 v[122:123], v134 offset:25600
    s_waitcnt lgkmcnt(12)
    v_mfma_f32_16x16x32_bf16 v[0:3], a[12:15], v[96:99], v[0:3]
    ds_read_b64_tr_b16 v[124:125], v135 offset:24576
    v_mfma_f32_16x16x32_bf16 v[4:7], a[76:79], v[96:99], v[4:7]
    ds_read_b64_tr_b16 v[126:127], v135 offset:25600
    s_waitcnt lgkmcnt(12)
    v_mfma_f32_16x16x32_bf16 v[8:11], a[12:15], v[100:103], v[8:11]
    v_mfma_f32_16x16x32_bf16 v[12:15], a[76:79], v[100:103], v[12:15]
    s_waitcnt lgkmcnt(10)
    v_mfma_f32_16x16x32_bf16 v[16:19], a[12:15], v[104:107], v[16:19]
    v_mfma_f32_16x16x32_bf16 v[20:23], a[76:79], v[104:107], v[20:23]
    s_waitcnt lgkmcnt(8)
    v_mfma_f32_16x16x32_bf16 v[24:27], a[12:15], v[108:111], v[24:27]
    v_mfma_f32_16x16x32_bf16 v[28:31], a[76:79], v[108:111], v[28:31]
    s_waitcnt lgkmcnt(6)
    v_mfma_f32_16x16x32_bf16 v[32:35], a[12:15], v[112:115], v[32:35]
    v_mfma_f32_16x16x32_bf16 v[36:39], a[76:79], v[112:115], v[36:39]
    s_waitcnt lgkmcnt(4)
    v_mfma_f32_16x16x32_bf16 v[40:43], a[12:15], v[116:119], v[40:43]
    v_mfma_f32_16x16x32_bf16 v[44:47], a[76:79], v[116:119], v[44:47]
    s_waitcnt lgkmcnt(2)
    v_mfma_f32_16x16x32_bf16 v[48:51], a[12:15], v[120:123], v[48:51]
    v_mfma_f32_16x16x32_bf16 v[52:55], a[76:79], v[120:123], v[52:55]
    s_waitcnt lgkmcnt(0)
    v_mfma_f32_16x16x32_bf16 v[56:59], a[12:15], v[124:127], v[56:59]
    v_mfma_f32_16x16x32_bf16 v[60:63], a[76:79], v[124:127], v[60:63]
    s_waitcnt vmcnt(16)
    s_barrier
    ds_read_b64_tr_b16 v[64:65], v128 offset:32768
    ds_read_b64_tr_b16 v[66:67], v128 offset:33792
    ds_read_b64_tr_b16 v[68:69], v129 offset:32768
    ds_read_b64_tr_b16 v[70:71], v129 offset:33792
    ds_read_b64_tr_b16 v[72:73], v130 offset:32768
    ds_read_b64_tr_b16 v[74:75], v130 offset:33792
    ds_read_b64_tr_b16 v[76:77], v131 offset:32768
    ds_read_b64_tr_b16 v[78:79], v131 offset:33792
    ds_read_b64_tr_b16 v[80:81], v132 offset:32768
    ds_read_b64_tr_b16 v[82:83], v132 offset:33792
    ds_read_b64_tr_b16 v[84:85], v133 offset:32768
    ds_read_b64_tr_b16 v[86:87], v133 offset:33792
    ds_read_b64_tr_b16 v[88:89], v134 offset:32768
    ds_read_b64_tr_b16 v[90:91], v134 offset:33792
    s_add_u32 s39, s39, s37
    s_lshr_b32 s26, s39, 5
    s_cmp_eq_u32 s26, 0
    s_cselect_b64 s[16:17], s[30:31], s[34:35]
    s_cmp_eq_u32 s26, 1
    s_cselect_b64 s[16:17], s[32:33], s[16:17]
    s_and_b32 s17, s17, 0xffff
    s_cmp_lt_u32 s39, 96
    s_cselect_b32 s18, 0x400000, 0
    s_and_b32 s24, s39, 31
    s_lshl_b32 s24, s24, 8
    s_waitcnt lgkmcnt(12)
    v_mfma_f32_16x16x32_bf16 v[0:3], a[16:19], v[64:67], v[0:3]
    ds_read_b64_tr_b16 v[92:93], v135 offset:32768
    v_mfma_f32_16x16x32_bf16 v[4:7], a[80:83], v[64:67], v[4:7]
    ds_read_b64_tr_b16 v[94:95], v135 offset:33792
    s_add_u32 s26, s24, 0x0
    s_add_u32 m0, s29, 0x0
    s_nop 0
    buffer_load_dwordx4 v136, s[16:19], s26 offen lds
    s_waitcnt lgkmcnt(12)
    v_mfma_f32_16x16x32_bf16 v[8:11], a[16:19], v[68:71], v[8:11]
    ds_read_b64_tr_b16 v[96:97], v128 offset:40960
    v_mfma_f32_16x16x32_bf16 v[12:15], a[80:83], v[68:71], v[12:15]
    ds_read_b64_tr_b16 v[98:99], v128 offset:41984
    s_add_u32 s26, s24, 0x20000
    s_add_u32 m0, s29, 0x1000
    s_nop 0
    buffer_load_dwordx4 v136, s[16:19], s26 offen lds
    s_waitcnt lgkmcnt(12)
    v_mfma_f32_16x16x32_bf16 v[16:19], a[16:19], v[72:75], v[16:19]
    ds_read_b64_tr_b16 v[100:101], v129 offset:40960
    v_mfma_f32_16x16x32_bf16 v[20:23], a[80:83], v[72:75], v[20:23]
    ds_read_b64_tr_b16 v[102:103], v129 offset:41984
    s_add_u32 s26, s24, 0x40000
    s_add_u32 m0, s29, 0x2000
    s_nop 0
    buffer_load_dwordx4 v136, s[16:19], s26 offen lds
    s_waitcnt lgkmcnt(12)
    v_mfma_f32_16x16x32_bf16 v[24:27], a[16:19], v[76:79], v[24:27]
    ds_read_b64_tr_b16 v[104:105], v130 offset:40960
    v_mfma_f32_16x16x32_bf16 v[28:31], a[80:83], v[76:79], v[28:31]
    ds_read_b64_tr_b16 v[106:107], v130 offset:41984
    s_add_u32 s26, s24, 0x60000
    s_add_u32 m0, s29, 0x3000
    s_nop 0
    buffer_load_dwordx4 v136, s[16:19], s26 offen lds
    s_waitcnt lgkmcnt(12)
    v_mfma_f32_16x16x32_bf16 v[32:35], a[16:19], v[80:83], v[32:35]
    ds_read_b64_tr_b16 v[108:109], v131 offset:40960
    v_mfma_f32_16x16x32_bf16 v[36:39], a[80:83], v[80:83], v[36:39]
    ds_read_b64_tr_b16 v[110:111], v131 offset:41984
    s_add_u32 s26, s24, 0x80000
    s_add_u32 m0, s29, 0x4000
    s_nop 0
    buffer_load_dwordx4 v136, s[16:19], s26 offen lds
    s_waitcnt lgkmcnt(12)
    v_mfma_f32_16x16x32_bf16 v[40:43], a[16:19], v[84:87], v[40:43]
    ds_read_b64_tr_b16 v[112:113], v132 offset:40960
    v_mfma_f32_16x16x32_bf16 v[44:47], a[80:83], v[84:87], v[44:47]
    ds_read_b64_tr_b16 v[114:115], v132 offset:41984
    s_add_u32 s26, s24, 0xa0000
    s_add_u32 m0, s29, 0x5000
    s_nop 0
    buffer_load_dwordx4 v136, s[16:19], s26 offen lds
    s_waitcnt lgkmcnt(12)
    v_mfma_f32_16x16x32_bf16 v[48:51], a[16:19], v[88:91], v[48:51]
    ds_read_b64_tr_b16 v[116:117], v133 offset:40960
    v_mfma_f32_16x16x32_bf16 v[52:55], a[80:83], v[88:91], v[52:55]
    ds_read_b64_tr_b16 v[118:119], v133 offset:41984
    s_add_u32 s26, s24, 0xc0000
    s_add_u32 m0, s29, 0x6000
    s_nop 0
    buffer_load_dwordx4 v136, s[16:19], s26 offen lds
    s_waitcnt lgkmcnt(12)
    v_mfma_f32_16x16x32_bf16 v[56:59], a[16:19], v[92:95], v[56:59]
    ds_read_b64_tr_b16 v[120:121], v134 offset:40960
    v_mfma_f32_16x16x32_bf16 v[60:63], a[80:83], v[92:95], v[60:63]
    ds_read_b64_tr_b16 v[122:123], v134 offset:41984
    s_add_u32 s26, s24, 0xe0000
    s_add_u32 m0, s29, 0x7000
    s_nop 0
    buffer_load_dwordx4 v136, s[16:19], s26 offen lds
    s_waitcnt lgkmcnt(12)
    v_mfma_f32_16x16x32_bf16 v[0:3], a[20:23], v[96:99], v[0:3]
    ds_read_b64_tr_b16 v[124:125], v135 offset:40960
    v_mfma_f32_16x16x32_bf16 v[4:7], a[84:87], v[96:99], v[4:7]
    ds_read_b64_tr_b16 v[126:127], v135 offset:41984
    s_waitcnt lgkmcnt(12)
    v_mfma_f32_16x16x32_bf16 v[8:11], a[20:23], v[100:103], v[8:11]
    ds_read_b64_tr_b16 v[64:65], v128 offset:49152
    v_mfma_f32_16x16x32_bf16 v[12:15], a[84:87], v[100:103], v[12:15]
    ds_read_b64_tr_b16 v[66:67], v128 offset:50176
    s_waitcnt lgkmcnt(12)
    v_mfma_f32_16x16x32_bf16 v[16:19], a[20:23], v[104:107], v[16:19]
    ds_read_b64_tr_b16 v[68:69], v129 offset:49152
    v_mfma_f32_16x16x32_bf16 v[20:23], a[84:87], v[104:107], v[20:23]
    ds_read_b64_tr_b16 v[70:71], v129 offset:50176
    s_waitcnt lgkmcnt(12)
    v_mfma_f32_16x16x32_bf16 v[24:27], a[20:23], v[108:111], v[24:27]
    ds_read_b64_tr_b16 v[72:73], v130 offset:49152
    v_mfma_f32_16x16x32_bf16 v[28:31], a[84:87], v[108:111], v[28:31]
    ds_read_b64_tr_b16 v[74:75], v130 offset:50176
    s_waitcnt lgkmcnt(12)
    v_mfma_f32_16x16x32_bf16 v[32:35], a[20:23], v[112:115], v[32:35]
    ds_read_b64_tr_b16 v[76:77], v131 offset:49152
    v_mfma_f32_16x16x32_bf16 v[36:39], a[84:87], v[112:115], v[36:39]
    ds_read_b64_tr_b16 v[78:79], v131 offset:50176
    s_waitcnt lgkmcnt(12)
    v_mfma_f32_16x16x32_bf16 v[40:43], a[20:23], v[116:119], v[40:43]
    ds_read_b64_tr_b16 v[80:81], v132 offset:49152
    v_mfma_f32_16x16x32_bf16 v[44:47], a[84:87], v[116:119], v[44:47]
    ds_read_b64_tr_b16 v[82:83], v132 offset:50176
    s_waitcnt lgkmcnt(12)
    v_mfma_f32_16x16x32_bf16 v[48:51], a[20:23], v[120:123], v[48:51]
    ds_read_b64_tr_b16 v[84:85], v133 offset:49152
    v_mfma_f32_16x16x32_bf16 v[52:55], a[84:87], v[120:123], v[52:55]
    ds_read_b64_tr_b16 v[86:87], v133 offset:50176
    s_waitcnt lgkmcnt(12)
    v_mfma_f32_16x16x32_bf16 v[56:59], a[20:23], v[124:127], v[56:59]
    ds_read_b64_tr_b16 v[88:89], v134 offset:49152
    v_mfma_f32_16x16x32_bf16 v[60:63], a[84:87], v[124:127], v[60:63]
    ds_read_b64_tr_b16 v[90:91], v134 offset:50176
    s_waitcnt lgkmcnt(12)
    v_mfma_f32_16x16x32_bf16 v[0:3], a[24:27], v[64:67], v[0:3]
    ds_read_b64_tr_b16 v[92:93], v135 offset:49152
    v_mfma_f32_16x16x32_bf16 v[4:7], a[88:91], v[64:67], v[4:7]
    ds_read_b64_tr_b16 v[94:95], v135 offset:50176
    s_waitcnt lgkmcnt(12)
    v_mfma_f32_16x16x32_bf16 v[8:11], a[24:27], v[68:71], v[8:11]
    ds_read_b64_tr_b16 v[96:97], v128 offset:57344
    v_mfma_f32_16x16x32_bf16 v[12:15], a[88:91], v[68:71], v[12:15]
    ds_read_b64_tr_b16 v[98:99], v128 offset:58368
    s_waitcnt lgkmcnt(12)
    v_mfma_f32_16x16x32_bf16 v[16:19], a[24:27], v[72:75], v[16:19]
    ds_read_b64_tr_b16 v[100:101], v129 offset:57344
    v_mfma_f32_16x16x32_bf16 v[20:23], a[88:91], v[72:75], v[20:23]
    ds_read_b64_tr_b16 v[102:103], v129 offset:58368
    s_waitcnt lgkmcnt(12)
    v_mfma_f32_16x16x32_bf16 v[24:27], a[24:27], v[76:79], v[24:27]
    ds_read_b64_tr_b16 v[104:105], v130 offset:57344
    v_mfma_f32_16x16x32_bf16 v[28:31], a[88:91], v[76:79], v[28:31]
    ds_read_b64_tr_b16 v[106:107], v130 offset:58368
    s_waitcnt lgkmcnt(12)
    v_mfma_f32_16x16x32_bf16 v[32:35], a[24:27], v[80:83], v[32:35]
    ds_read_b64_tr_b16 v[108:109], v131 offset:57344
    v_mfma_f32_16x16x32_bf16 v[36:39], a[88:91], v[80:83], v[36:39]
    ds_read_b64_tr_b16 v[110:111], v131 offset:58368
    s_waitcnt lgkmcnt(12)
    v_mfma_f32_16x16x32_bf16 v[40:43], a[24:27], v[84:87], v[40:43]
    ds_read_b64_tr_b16 v[112:113], v132 offset:57344
    v_mfma_f32_16x16x32_bf16 v[44:47], a[88:91], v[84:87], v[44:47]
    ds_read_b64_tr_b16 v[114:115], v132 offset:58368
    s_waitcnt lgkmcnt(12)
    v_mfma_f32_16x16x32_bf16 v[48:51], a[24:27], v[88:91], v[48:51]
    ds_read_b64_tr_b16 v[116:117], v133 offset:57344
    v_mfma_f32_16x16x32_bf16 v[52:55], a[88:91], v[88:91], v[52:55]
    ds_read_b64_tr_b16 v[118:119], v133 offset:58368
    s_waitcnt lgkmcnt(12)
    v_mfma_f32_16x16x32_bf16 v[56:59], a[24:27], v[92:95], v[56:59]
    ds_read_b64_tr_b16 v[120:121], v134 offset:57344
    v_mfma_f32_16x16x32_bf16 v[60:63], a[88:91], v[92:95], v[60:63]
    ds_read_b64_tr_b16 v[122:123], v134 offset:58368
    s_waitcnt lgkmcnt(12)
    v_mfma_f32_16x16x32_bf16 v[0:3], a[28:31], v[96:99], v[0:3]
    ds_read_b64_tr_b16 v[124:125], v135 offset:57344
    v_mfma_f32_16x16x32_bf16 v[4:7], a[92:95], v[96:99], v[4:7]
    ds_read_b64_tr_b16 v[126:127], v135 offset:58368
    s_waitcnt lgkmcnt(12)
    v_mfma_f32_16x16x32_bf16 v[8:11], a[28:31], v[100:103], v[8:11]
    v_mfma_f32_16x16x32_bf16 v[12:15], a[92:95], v[100:103], v[12:15]
    s_waitcnt lgkmcnt(10)
    v_mfma_f32_16x16x32_bf16 v[16:19], a[28:31], v[104:107], v[16:19]
    v_mfma_f32_16x16x32_bf16 v[20:23], a[92:95], v[104:107], v[20:23]
    s_waitcnt lgkmcnt(8)
    v_mfma_f32_16x16x32_bf16 v[24:27], a[28:31], v[108:111], v[24:27]
    v_mfma_f32_16x16x32_bf16 v[28:31], a[92:95], v[108:111], v[28:31]
    s_waitcnt lgkmcnt(6)
    v_mfma_f32_16x16x32_bf16 v[32:35], a[28:31], v[112:115], v[32:35]
    v_mfma_f32_16x16x32_bf16 v[36:39], a[92:95], v[112:115], v[36:39]
    s_waitcnt lgkmcnt(4)
    v_mfma_f32_16x16x32_bf16 v[40:43], a[28:31], v[116:119], v[40:43]
    v_mfma_f32_16x16x32_bf16 v[44:47], a[92:95], v[116:119], v[44:47]
    s_waitcnt lgkmcnt(2)
    v_mfma_f32_16x16x32_bf16 v[48:51], a[28:31], v[120:123], v[48:51]
    v_mfma_f32_16x16x32_bf16 v[52:55], a[92:95], v[120:123], v[52:55]
    s_waitcnt lgkmcnt(0)
    v_mfma_f32_16x16x32_bf16 v[56:59], a[28:31], v[124:127], v[56:59]
    v_mfma_f32_16x16x32_bf16 v[60:63], a[92:95], v[124:127], v[60:63]
    v_xor_b32 v128, 0x10000, v128
    v_xor_b32 v129, 0x10000, v129
    v_xor_b32 v130, 0x10000, v130
    v_xor_b32 v131, 0x10000, v131
    v_xor_b32 v132, 0x10000, v132
    v_xor_b32 v133, 0x10000, v133
    v_xor_b32 v134, 0x10000, v134
    v_xor_b32 v135, 0x10000, v135
    s_waitcnt vmcnt(16)
    s_barrier
    ds_read_b64_tr_b16 v[64:65], v128
    ds_read_b64_tr_b16 v[66:67], v128 offset:1024
    ds_read_b64_tr_b16 v[68:69], v129
    ds_read_b64_tr_b16 v[70:71], v129 offset:1024
    ds_read_b64_tr_b16 v[72:73], v130
    ds_read_b64_tr_b16 v[74:75], v130 offset:1024
    ds_read_b64_tr_b16 v[76:77], v131
    ds_read_b64_tr_b16 v[78:79], v131 offset:1024
    ds_read_b64_tr_b16 v[80:81], v132
    ds_read_b64_tr_b16 v[82:83], v132 offset:1024
    ds_read_b64_tr_b16 v[84:85], v133
    ds_read_b64_tr_b16 v[86:87], v133 offset:1024
    ds_read_b64_tr_b16 v[88:89], v134
    ds_read_b64_tr_b16 v[90:91], v134 offset:1024
    s_cmp_eq_u32 s40, 0
    s_cbranch_scc1 L_nopf_92
    s_cmp_lg_u32 s87, 0
    s_cbranch_scc1 L_modeok_93
    s_mov_b32 s96, 0
L_mode_94:
    buffer_load_dwordx2 v[140:141], off, s[92:95], 0 offset:36 sc1
    s_waitcnt vmcnt(0)
    v_readfirstlane_b32 s87, v140
    v_readfirstlane_b32 s97, v141
    s_nop 0
    s_min_u32 s97, s97, s87
    s_cmp_lg_u32 s97, 0
    s_cbranch_scc1 L_moded_95
    s_sleep 4
    s_add_u32 s96, s96, 1
    s_cmp_lg_u32 s96, 0x100
    s_cbranch_scc1 L_modef_96
    v_mov_b32 v140, 2
    v_mov_b32 v141, 0
    s_mov_b64 exec, 1
    buffer_atomic_cmpswap v[140:141], off, s[92:95], 0 offset:36
    s_mov_b64 exec, -1
L_modef_96:
    s_cmp_lt_u32 s96, 0x10000
    s_cbranch_scc1 L_mode_94
L_moded_95:
    s_cmp_lg_u32 s87, 1
    s_cbranch_scc1 L_fallback
L_modeok_93:
    s_cmp_lg_u32 s100, 0
    s_cbranch_scc1 L_flag_97
    v_mov_b32 v138, 1
    s_mov_b64 exec, 1
    buffer_store_dword v138, off, s[8:11], s40 sc1
    s_mov_b64 exec, -1
L_flag_97:
    s_mov_b32 s40, 0
L_nopf_92:
    s_waitcnt lgkmcnt(12)
    v_mfma_f32_16x16x32_bf16 v[0:3], a[32:35], v[64:67], v[0:3]
    ds_read_b64_tr_b16 v[92:93], v135
    v_mfma_f32_16x16x32_bf16 v[4:7], a[96:99], v[64:67], v[4:7]
    ds_read_b64_tr_b16 v[94:95], v135 offset:1024
    s_add_u32 s26, s24, 0x100000
    s_add_u32 m0, s29, 0x8000
    s_nop 0
    buffer_load_dwordx4 v136, s[16:19], s26 offen lds
    s_waitcnt lgkmcnt(12)
    v_mfma_f32_16x16x32_bf16 v[8:11], a[32:35], v[68:71], v[8:11]
    ds_read_b64_tr_b16 v[96:97], v128 offset:8192
    v_mfma_f32_16x16x32_bf16 v[12:15], a[96:99], v[68:71], v[12:15]
    ds_read_b64_tr_b16 v[98:99], v128 offset:9216
    s_add_u32 s26, s24, 0x120000
    s_add_u32 m0, s29, 0x9000
    s_nop 0
    buffer_load_dwordx4 v136, s[16:19], s26 offen lds
    s_waitcnt lgkmcnt(12)
    v_mfma_f32_16x16x32_bf16 v[16:19], a[32:35], v[72:75], v[16:19]
    ds_read_b64_tr_b16 v[100:101], v129 offset:8192
    v_mfma_f32_16x16x32_bf16 v[20:23], a[96:99], v[72:75], v[20:23]
    ds_read_b64_tr_b16 v[102:103], v129 offset:9216
    s_add_u32 s26, s24, 0x140000
    s_add_u32 m0, s29, 0xa000
    s_nop 0
    buffer_load_dwordx4 v136, s[16:19], s26 offen lds
    s_waitcnt lgkmcnt(12)
    v_mfma_f32_16x16x32_bf16 v[24:27], a[32:35], v[76:79], v[24:27]
    ds_read_b64_tr_b16 v[104:105], v130 offset:8192
    v_mfma_f32_16x16x32_bf16 v[28:31], a[96:99], v[76:79], v[28:31]
    ds_read_b64_tr_b16 v[106:107], v130 offset:9216
    s_add_u32 s26, s24, 0x160000
    s_add_u32 m0, s29, 0xb000
    s_nop 0
    buffer_load_dwordx4 v136, s[16:19], s26 offen lds
    s_waitcnt lgkmcnt(12)
    v_mfma_f32_16x16x32_bf16 v[32:35], a[32:35], v[80:83], v[32:35]
    ds_read_b64_tr_b16 v[108:109], v131 offset:8192
    v_mfma_f32_16x16x32_bf16 v[36:39], a[96:99], v[80:83], v[36:39]
    ds_read_b64_tr_b16 v[110:111], v131 offset:9216
    s_add_u32 s26, s24, 0x180000
    s_add_u32 m0, s29, 0xc000
    s_nop 0
    buffer_load_dwordx4 v136, s[16:19], s26 offen lds
    s_waitcnt lgkmcnt(12)
    v_mfma_f32_16x16x32_bf16 v[40:43], a[32:35], v[84:87], v[40:43]
    ds_read_b64_tr_b16 v[112:113], v132 offset:8192
    v_mfma_f32_16x16x32_bf16 v[44:47], a[96:99], v[84:87], v[44:47]
    ds_read_b64_tr_b16 v[114:115], v132 offset:9216
    s_add_u32 s26, s24, 0x1a0000
    s_add_u32 m0, s29, 0xd000
    s_nop 0
    buffer_load_dwordx4 v136, s[16:19], s26 offen lds
    s_waitcnt lgkmcnt(12)
    v_mfma_f32_16x16x32_bf16 v[48:51], a[32:35], v[88:91], v[48:51]
    ds_read_b64_tr_b16 v[116:117], v133 offset:8192
    v_mfma_f32_16x16x32_bf16 v[52:55], a[96:99], v[88:91], v[52:55]
    ds_read_b64_tr_b16 v[118:119], v133 offset:9216
    s_add_u32 s26, s24, 0x1c0000
    s_add_u32 m0, s29, 0xe000
    s_nop 0
    buffer_load_dwordx4 v136, s[16:19], s26 offen lds
    s_waitcnt lgkmcnt(12)
    v_mfma_f32_16x16x32_bf16 v[56:59], a[32:35], v[92:95], v[56:59]
    ds_read_b64_tr_b16 v[120:121], v134 offset:8192
    v_mfma_f32_16x16x32_bf16 v[60:63], a[96:99], v[92:95], v[60:63]
    ds_read_b64_tr_b16 v[122:123], v134 offset:9216
    s_add_u32 s26, s24, 0x1e0000
    s_add_u32 m0, s29, 0xf000
    s_nop 0
    buffer_load_dwordx4 v136, s[16:19], s26 offen lds
    s_waitcnt lgkmcnt(12)
    v_mfma_f32_16x16x32_bf16 v[0:3], a[36:39], v[96:99], v[0:3]
    ds_read_b64_tr_b16 v[124:125], v135 offset:8192
    v_mfma_f32_16x16x32_bf16 v[4:7], a[100:103], v[96:99], v[4:7]
    ds_read_b64_tr_b16 v[126:127], v135 offset:9216
    s_waitcnt lgkmcnt(12)
    v_mfma_f32_16x16x32_bf16 v[8:11], a[36:39], v[100:103], v[8:11]
    ds_read_b64_tr_b16 v[64:65], v128 offset:16384
    v_mfma_f32_16x16x32_bf16 v[12:15], a[100:103], v[100:103], v[12:15]
    ds_read_b64_tr_b16 v[66:67], v128 offset:17408
    s_waitcnt lgkmcnt(12)
    v_mfma_f32_16x16x32_bf16 v[16:19], a[36:39], v[104:107], v[16:19]
    ds_read_b64_tr_b16 v[68:69], v129 offset:16384
    v_mfma_f32_16x16x32_bf16 v[20:23], a[100:103], v[104:107], v[20:23]
    ds_read_b64_tr_b16 v[70:71], v129 offset:17408
    s_waitcnt lgkmcnt(12)
    v_mfma_f32_16x16x32_bf16 v[24:27], a[36:39], v[108:111], v[24:27]
    ds_read_b64_tr_b16 v[72:73], v130 offset:16384
    v_mfma_f32_16x16x32_bf16 v[28:31], a[100:103], v[108:111], v[28:31]
    ds_read_b64_tr_b16 v[74:75], v130 offset:17408
    s_waitcnt lgkmcnt(12)
    v_mfma_f32_16x16x32_bf16 v[32:35], a[36:39], v[112:115], v[32:35]
    ds_read_b64_tr_b16 v[76:77], v131 offset:16384
    v_mfma_f32_16x16x32_bf16 v[36:39], a[100:103], v[112:115], v[36:39]
    ds_read_b64_tr_b16 v[78:79], v131 offset:17408
    s_waitcnt lgkmcnt(12)
    v_mfma_f32_16x16x32_bf16 v[40:43], a[36:39], v[116:119], v[40:43]
    ds_read_b64_tr_b16 v[80:81], v132 offset:16384
    v_mfma_f32_16x16x32_bf16 v[44:47], a[100:103], v[116:119], v[44:47]
    ds_read_b64_tr_b16 v[82:83], v132 offset:17408
    s_waitcnt lgkmcnt(12)
    v_mfma_f32_16x16x32_bf16 v[48:51], a[36:39], v[120:123], v[48:51]
    ds_read_b64_tr_b16 v[84:85], v133 offset:16384
    v_mfma_f32_16x16x32_bf16 v[52:55], a[100:103], v[120:123], v[52:55]
    ds_read_b64_tr_b16 v[86:87], v133 offset:17408
    s_waitcnt lgkmcnt(12)
    v_mfma_f32_16x16x32_bf16 v[56:59], a[36:39], v[124:127], v[56:59]
    ds_read_b64_tr_b16 v[88:89], v134 offset:16384
    v_mfma_f32_16x16x32_bf16 v[60:63], a[100:103], v[124:127], v[60:63]
    ds_read_b64_tr_b16 v[90:91], v134 offset:17408
    s_waitcnt lgkmcnt(12)
    v_mfma_f32_16x16x32_bf16 v[0:3], a[40:43], v[64:67], v[0:3]
    ds_read_b64_tr_b16 v[92:93], v135 offset:16384
    v_mfma_f32_16x16x32_bf16 v[4:7], a[104:107], v[64:67], v[4:7]
    ds_read_b64_tr_b16 v[94:95], v135 offset:17408
    s_waitcnt lgkmcnt(12)
    v_mfma_f32_16x16x32_bf16 v[8:11], a[40:43], v[68:71], v[8:11]
    ds_read_b64_tr_b16 v[96:97], v128 offset:24576
    v_mfma_f32_16x16x32_bf16 v[12:15], a[104:107], v[68:71], v[12:15]
    ds_read_b64_tr_b16 v[98:99], v128 offset:25600
    s_waitcnt lgkmcnt(12)
    v_mfma_f32_16x16x32_bf16 v[16:19], a[40:43], v[72:75], v[16:19]
    ds_read_b64_tr_b16 v[100:101], v129 offset:24576
    v_mfma_f32_16x16x32_bf16 v[20:23], a[104:107], v[72:75], v[20:23]
    ds_read_b64_tr_b16 v[102:103], v129 offset:25600
    s_waitcnt lgkmcnt(12)
    v_mfma_f32_16x16x32_bf16 v[24:27], a[40:43], v[76:79], v[24:27]
    ds_read_b64_tr_b16 v[104:105], v130 offset:24576
    v_mfma_f32_16x16x32_bf16 v[28:31], a[104:107], v[76:79], v[28:31]
    ds_read_b64_tr_b16 v[106:107], v130 offset:25600
    s_waitcnt lgkmcnt(12)
    v_mfma_f32_16x16x32_bf16 v[32:35], a[40:43], v[80:83], v[32:35]
    ds_read_b64_tr_b16 v[108:109], v131 offset:24576
    v_mfma_f32_16x16x32_bf16 v[36:39], a[104:107], v[80:83], v[36:39]
    ds_read_b64_tr_b16 v[110:111], v131 offset:25600
    s_waitcnt lgkmcnt(12)
    v_mfma_f32_16x16x32_bf16 v[40:43], a[40:43], v[84:87], v[40:43]
    ds_read_b64_tr_b16 v[112:113], v132 offset:24576
    v_mfma_f32_16x16x32_bf16 v[44:47], a[104:107], v[84:87], v[44:47]
    ds_read_b64_tr_b16 v[114:115], v132 offset:25600
    s_waitcnt lgkmcnt(12)
    v_mfma_f32_16x16x32_bf16 v[48:51], a[40:43], v[88:91], v[48:51]
    ds_read_b64_tr_b16 v[116:117], v133 offset:24576
    v_mfma_f32_16x16x32_bf16 v[52:55], a[104:107], v[88:91], v[52:55]
    ds_read_b64_tr_b16 v[118:119], v133 offset:25600
    s_waitcnt lgkmcnt(12)
    v_mfma_f32_16x16x32_bf16 v[56:59], a[40:43], v[92:95], v[56:59]
    ds_read_b64_tr_b16 v[120:121], v134 offset:24576
    v_mfma_f32_16x16x32_bf16 v[60:63], a[104:107], v[92:95], v[60:63]
    ds_read_b64_tr_b16 v[122:123], v134 offset:25600
    s_waitcnt lgkmcnt(12)
    v_mfma_f32_16x16x32_bf16 v[0:3], a[44:47], v[96:99], v[0:3]
    ds_read_b64_tr_b16 v[124:125], v135 offset:24576
    v_mfma_f32_16x16x32_bf16 v[4:7], a[108:111], v[96:99], v[4:7]
    ds_read_b64_tr_b16 v[126:127], v135 offset:25600
    s_waitcnt lgkmcnt(12)
    v_mfma_f32_16x16x32_bf16 v[8:11], a[44:47], v[100:103], v[8:11]
    v_mfma_f32_16x16x32_bf16 v[12:15], a[108:111], v[100:103], v[12:15]
    s_waitcnt lgkmcnt(10)
    v_mfma_f32_16x16x32_bf16 v[16:19], a[44:47], v[104:107], v[16:19]
    v_mfma_f32_16x16x32_bf16 v[20:23], a[108:111], v[104:107], v[20:23]
    s_waitcnt lgkmcnt(8)
    v_mfma_f32_16x16x32_bf16 v[24:27], a[44:47], v[108:111], v[24:27]
    v_mfma_f32_16x16x32_bf16 v[28:31], a[108:111], v[108:111], v[28:31]
    s_waitcnt lgkmcnt(6)
    v_mfma_f32_16x16x32_bf16 v[32:35], a[44:47], v[112:115], v[32:35]
    v_mfma_f32_16x16x32_bf16 v[36:39], a[108:111], v[112:115], v[36:39]
    s_waitcnt lgkmcnt(4)
    v_mfma_f32_16x16x32_bf16 v[40:43], a[44:47], v[116:119], v[40:43]
    v_mfma_f32_16x16x32_bf16 v[44:47], a[108:111], v[116:119], v[44:47]
    s_waitcnt lgkmcnt(2)
    v_mfma_f32_16x16x32_bf16 v[48:51], a[44:47], v[120:123], v[48:51]
    v_mfma_f32_16x16x32_bf16 v[52:55], a[108:111], v[120:123], v[52:55]
    s_waitcnt lgkmcnt(0)
    v_mfma_f32_16x16x32_bf16 v[56:59], a[44:47], v[124:127], v[56:59]
    v_mfma_f32_16x16x32_bf16 v[60:63], a[108:111], v[124:127], v[60:63]
    s_waitcnt vmcnt(16)
    s_barrier
    ds_read_b64_tr_b16 v[64:65], v128 offset:32768
    ds_read_b64_tr_b16 v[66:67], v128 offset:33792
    ds_read_b64_tr_b16 v[68:69], v129 offset:32768
    ds_read_b64_tr_b16 v[70:71], v129 offset:33792
    ds_read_b64_tr_b16 v[72:73], v130 offset:32768
    ds_read_b64_tr_b16 v[74:75], v130 offset:33792
    ds_read_b64_tr_b16 v[76:77], v131 offset:32768
    ds_read_b64_tr_b16 v[78:79], v131 offset:33792
    ds_read_b64_tr_b16 v[80:81], v132 offset:32768
    ds_read_b64_tr_b16 v[82:83], v132 offset:33792
    ds_read_b64_tr_b16 v[84:85], v133 offset:32768
    ds_read_b64_tr_b16 v[86:87], v133 offset:33792
    ds_read_b64_tr_b16 v[88:89], v134 offset:32768
    ds_read_b64_tr_b16 v[90:91], v134 offset:33792
    s_waitcnt lgkmcnt(12)
    v_mfma_f32_16x16x32_bf16 v[0:3], a[48:51], v[64:67], v[0:3]
    ds_read_b64_tr_b16 v[92:93], v135 offset:32768
    v_mfma_f32_16x16x32_bf16 v[4:7], a[112:115], v[64:67], v[4:7]
    ds_read_b64_tr_b16 v[94:95], v135 offset:33792
    s_add_u32 s26, s24, 0x200000
    s_add_u32 m0, s29, 0x10000
    s_nop 0
    buffer_load_dwordx4 v136, s[16:19], s26 offen lds
    s_waitcnt lgkmcnt(12)
    v_mfma_f32_16x16x32_bf16 v[8:11], a[48:51], v[68:71], v[8:11]
    ds_read_b64_tr_b16 v[96:97], v128 offset:40960
    v_mfma_f32_16x16x32_bf16 v[12:15], a[112:115], v[68:71], v[12:15]
    ds_read_b64_tr_b16 v[98:99], v128 offset:41984
    s_add_u32 s26, s24, 0x220000
    s_add_u32 m0, s29, 0x11000
    s_nop 0
    buffer_load_dwordx4 v136, s[16:19], s26 offen lds
    s_waitcnt lgkmcnt(12)
    v_mfma_f32_16x16x32_bf16 v[16:19], a[48:51], v[72:75], v[16:19]
    ds_read_b64_tr_b16 v[100:101], v129 offset:40960
    v_mfma_f32_16x16x32_bf16 v[20:23], a[112:115], v[72:75], v[20:23]
    ds_read_b64_tr_b16 v[102:103], v129 offset:41984
    s_add_u32 s26, s24, 0x240000
    s_add_u32 m0, s29, 0x12000
    s_nop 0
    buffer_load_dwordx4 v136, s[16:19], s26 offen lds
    s_waitcnt lgkmcnt(12)
    v_mfma_f32_16x16x32_bf16 v[24:27], a[48:51], v[76:79], v[24:27]
    ds_read_b64_tr_b16 v[104:105], v130 offset:40960
    v_mfma_f32_16x16x32_bf16 v[28:31], a[112:115], v[76:79], v[28:31]
    ds_read_b64_tr_b16 v[106:107], v130 offset:41984
    s_add_u32 s26, s24, 0x260000
    s_add_u32 m0, s29, 0x13000
    s_nop 0
    buffer_load_dwordx4 v136, s[16:19], s26 offen lds
    s_waitcnt lgkmcnt(12)
    v_mfma_f32_16x16x32_bf16 v[32:35], a[48:51], v[80:83], v[32:35]
    ds_read_b64_tr_b16 v[108:109], v131 offset:40960
    v_mfma_f32_16x16x32_bf16 v[36:39], a[112:115], v[80:83], v[36:39]
    ds_read_b64_tr_b16 v[110:111], v131 offset:41984
    s_add_u32 s26, s24, 0x280000
    s_add_u32 m0, s29, 0x14000
    s_nop 0
    buffer_load_dwordx4 v136, s[16:19], s26 offen lds
    s_waitcnt lgkmcnt(12)
    v_mfma_f32_16x16x32_bf16 v[40:43], a[48:51], v[84:87], v[40:43]
    ds_read_b64_tr_b16 v[112:113], v132 offset:40960
    v_mfma_f32_16x16x32_bf16 v[44:47], a[112:115], v[84:87], v[44:47]
    ds_read_b64_tr_b16 v[114:115], v132 offset:41984
    s_add_u32 s26, s24, 0x2a0000
    s_add_u32 m0, s29, 0x15000
    s_nop 0
    buffer_load_dwordx4 v136, s[16:19], s26 offen lds
    s_waitcnt lgkmcnt(12)
    v_mfma_f32_16x16x32_bf16 v[48:51], a[48:51], v[88:91], v[48:51]
    ds_read_b64_tr_b16 v[116:117], v133 offset:40960
    v_mfma_f32_16x16x32_bf16 v[52:55], a[112:115], v[88:91], v[52:55]
    ds_read_b64_tr_b16 v[118:119], v133 offset:41984
    s_add_u32 s26, s24, 0x2c0000
    s_add_u32 m0, s29, 0x16000
    s_nop 0
    buffer_load_dwordx4 v136, s[16:19], s26 offen lds
    s_waitcnt lgkmcnt(12)
    v_mfma_f32_16x16x32_bf16 v[56:59], a[48:51], v[92:95], v[56:59]
    ds_read_b64_tr_b16 v[120:121], v134 offset:40960
    v_mfma_f32_16x16x32_bf16 v[60:63], a[112:115], v[92:95], v[60:63]
    ds_read_b64_tr_b16 v[122:123], v134 offset:41984
    s_add_u32 s26, s24, 0x2e0000
    s_add_u32 m0, s29, 0x17000
    s_nop 0
    buffer_load_dwordx4 v136, s[16:19], s26 offen lds
    s_waitcnt lgkmcnt(12)
    v_mfma_f32_16x16x32_bf16 v[0:3], a[52:55], v[96:99], v[0:3]
    ds_read_b64_tr_b16 v[124:125], v135 offset:40960
    v_mfma_f32_16x16x32_bf16 v[4:7], a[116:119], v[96:99], v[4:7]
    ds_read_b64_tr_b16 v[126:127], v135 offset:41984
    s_waitcnt lgkmcnt(12)
    v_mfma_f32_16x16x32_bf16 v[8:11], a[52:55], v[100:103], v[8:11]
    ds_read_b64_tr_b16 v[64:65], v128 offset:49152
    v_mfma_f32_16x16x32_bf16 v[12:15], a[116:119], v[100:103], v[12:15]
    ds_read_b64_tr_b16 v[66:67], v128 offset:50176
    s_waitcnt lgkmcnt(12)
    v_mfma_f32_16x16x32_bf16 v[16:19], a[52:55], v[104:107], v[16:19]
    ds_read_b64_tr_b16 v[68:69], v129 offset:49152
    v_mfma_f32_16x16x32_bf16 v[20:23], a[116:119], v[104:107], v[20:23]
    ds_read_b64_tr_b16 v[70:71], v129 offset:50176
    s_waitcnt lgkmcnt(12)
    v_mfma_f32_16x16x32_bf16 v[24:27], a[52:55], v[108:111], v[24:27]
    ds_read_b64_tr_b16 v[72:73], v130 offset:49152
    v_mfma_f32_16x16x32_bf16 v[28:31], a[116:119], v[108:111], v[28:31]
    ds_read_b64_tr_b16 v[74:75], v130 offset:50176
    s_waitcnt lgkmcnt(12)
    v_mfma_f32_16x16x32_bf16 v[32:35], a[52:55], v[112:115], v[32:35]
    ds_read_b64_tr_b16 v[76:77], v131 offset:49152
    v_mfma_f32_16x16x32_bf16 v[36:39], a[116:119], v[112:115], v[36:39]
    ds_read_b64_tr_b16 v[78:79], v131 offset:50176
    s_waitcnt lgkmcnt(12)
    v_mfma_f32_16x16x32_bf16 v[40:43], a[52:55], v[116:119], v[40:43]
    ds_read_b64_tr_b16 v[80:81], v132 offset:49152
    v_mfma_f32_16x16x32_bf16 v[44:47], a[116:119], v[116:119], v[44:47]
    ds_read_b64_tr_b16 v[82:83], v132 offset:50176
    s_waitcnt lgkmcnt(12)
    v_mfma_f32_16x16x32_bf16 v[48:51], a[52:55], v[120:123], v[48:51]
    ds_read_b64_tr_b16 v[84:85], v133 offset:49152
    v_mfma_f32_16x16x32_bf16 v[52:55], a[116:119], v[120:123], v[52:55]
    ds_read_b64_tr_b16 v[86:87], v133 offset:50176
    s_waitcnt lgkmcnt(12)
    v_mfma_f32_16x16x32_bf16 v[56:59], a[52:55], v[124:127], v[56:59]
    ds_read_b64_tr_b16 v[88:89], v134 offset:49152
    v_mfma_f32_16x16x32_bf16 v[60:63], a[116:119], v[124:127], v[60:63]
    ds_read_b64_tr_b16 v[90:91], v134 offset:50176
    s_waitcnt lgkmcnt(12)
    v_mfma_f32_16x16x32_bf16 v[0:3], a[56:59], v[64:67], v[0:3]
    ds_read_b64_tr_b16 v[92:93], v135 offset:49152
    v_mfma_f32_16x16x32_bf16 v[4:7], a[120:123], v[64:67], v[4:7]
    ds_read_b64_tr_b16 v[94:95], v135 offset:50176
    s_waitcnt lgkmcnt(12)
    v_mfma_f32_16x16x32_bf16 v[8:11], a[56:59], v[68:71], v[8:11]
    ds_read_b64_tr_b16 v[96:97], v128 offset:57344
    v_mfma_f32_16x16x32_bf16 v[12:15], a[120:123], v[68:71], v[12:15]
    ds_read_b64_tr_b16 v[98:99], v128 offset:58368
    s_waitcnt lgkmcnt(12)
    v_mfma_f32_16x16x32_bf16 v[16:19], a[56:59], v[72:75], v[16:19]
    ds_read_b64_tr_b16 v[100:101], v129 offset:57344
    v_mfma_f32_16x16x32_bf16 v[20:23], a[120:123], v[72:75], v[20:23]
    ds_read_b64_tr_b16 v[102:103], v129 offset:58368
    s_waitcnt lgkmcnt(12)
    v_mfma_f32_16x16x32_bf16 v[24:27], a[56:59], v[76:79], v[24:27]
    ds_read_b64_tr_b16 v[104:105], v130 offset:57344
    v_mfma_f32_16x16x32_bf16 v[28:31], a[120:123], v[76:79], v[28:31]
    ds_read_b64_tr_b16 v[106:107], v130 offset:58368
    s_waitcnt lgkmcnt(12)
    v_mfma_f32_16x16x32_bf16 v[32:35], a[56:59], v[80:83], v[32:35]
    ds_read_b64_tr_b16 v[108:109], v131 offset:57344
    v_mfma_f32_16x16x32_bf16 v[36:39], a[120:123], v[80:83], v[36:39]
    ds_read_b64_tr_b16 v[110:111], v131 offset:58368
    s_waitcnt lgkmcnt(12)
    v_mfma_f32_16x16x32_bf16 v[40:43], a[56:59], v[84:87], v[40:43]
    ds_read_b64_tr_b16 v[112:113], v132 offset:57344
    v_mfma_f32_16x16x32_bf16 v[44:47], a[120:123], v[84:87], v[44:47]
    ds_read_b64_tr_b16 v[114:115], v132 offset:58368
    s_waitcnt lgkmcnt(12)
    v_mfma_f32_16x16x32_bf16 v[48:51], a[56:59], v[88:91], v[48:51]
    ds_read_b64_tr_b16 v[116:117], v133 offset:57344
    v_mfma_f32_16x16x32_bf16 v[52:55], a[120:123], v[88:91], v[52:55]
    ds_read_b64_tr_b16 v[118:119], v133 offset:58368
    s_waitcnt lgkmcnt(12)
    v_mfma_f32_16x16x32_bf16 v[56:59], a[56:59], v[92:95], v[56:59]
    ds_read_b64_tr_b16 v[120:121], v134 offset:57344
    v_mfma_f32_16x16x32_bf16 v[60:63], a[120:123], v[92:95], v[60:63]
    ds_read_b64_tr_b16 v[122:123], v134 offset:58368
    s_waitcnt lgkmcnt(12)
    v_mfma_f32_16x16x32_bf16 v[0:3], a[60:63], v[96:99], v[0:3]
    ds_read_b64_tr_b16 v[124:125], v135 offset:57344
    v_mfma_f32_16x16x32_bf16 v[4:7], a[124:127], v[96:99], v[4:7]
    ds_read_b64_tr_b16 v[126:127], v135 offset:58368
    s_waitcnt lgkmcnt(12)
    v_mfma_f32_16x16x32_bf16 v[8:11], a[60:63], v[100:103], v[8:11]
    v_mfma_f32_16x16x32_bf16 v[12:15], a[124:127], v[100:103], v[12:15]
    s_waitcnt lgkmcnt(10)
    v_mfma_f32_16x16x32_bf16 v[16:19], a[60:63], v[104:107], v[16:19]
    v_mfma_f32_16x16x32_bf16 v[20:23], a[124:127], v[104:107], v[20:23]
    s_waitcnt lgkmcnt(8)
    v_mfma_f32_16x16x32_bf16 v[24:27], a[60:63], v[108:111], v[24:27]
    v_mfma_f32_16x16x32_bf16 v[28:31], a[124:127], v[108:111], v[28:31]
    s_waitcnt lgkmcnt(6)
    v_mfma_f32_16x16x32_bf16 v[32:35], a[60:63], v[112:115], v[32:35]
    v_mfma_f32_16x16x32_bf16 v[36:39], a[124:127], v[112:115], v[36:39]
    s_waitcnt lgkmcnt(4)
    v_mfma_f32_16x16x32_bf16 v[40:43], a[60:63], v[116:119], v[40:43]
    v_mfma_f32_16x16x32_bf16 v[44:47], a[124:127], v[116:119], v[44:47]
    s_waitcnt lgkmcnt(2)
    v_mfma_f32_16x16x32_bf16 v[48:51], a[60:63], v[120:123], v[48:51]
    v_mfma_f32_16x16x32_bf16 v[52:55], a[124:127], v[120:123], v[52:55]
    s_waitcnt lgkmcnt(0)
    v_mfma_f32_16x16x32_bf16 v[56:59], a[60:63], v[124:127], v[56:59]
    v_mfma_f32_16x16x32_bf16 v[60:63], a[124:127], v[124:127], v[60:63]
    v_xor_b32 v128, 0x10000, v128
    v_xor_b32 v129, 0x10000, v129
    v_xor_b32 v130, 0x10000, v130
    v_xor_b32 v131, 0x10000, v131
    v_xor_b32 v132, 0x10000, v132
    v_xor_b32 v133, 0x10000, v133
    v_xor_b32 v134, 0x10000, v134
    v_xor_b32 v135, 0x10000, v135
    v_cvt_pk_bf16_f32 v144, v0, v1
    v_cvt_pk_bf16_f32 v145, v2, v3
    v_cvt_pk_bf16_f32 v146, v4, v5
    v_cvt_pk_bf16_f32 v147, v6, v7
    buffer_store_dwordx4 v[144:147], v137, s[8:11], s25 offen sc1
    v_cvt_pk_bf16_f32 v148, v8, v9
    v_cvt_pk_bf16_f32 v149, v10, v11
    v_cvt_pk_bf16_f32 v150, v12, v13
    v_cvt_pk_bf16_f32 v151, v14, v15
    buffer_store_dwordx4 v[148:151], v137, s[8:11], s25 offen offset:1024 sc1
    v_cvt_pk_bf16_f32 v152, v16, v17
    v_cvt_pk_bf16_f32 v153, v18, v19
    v_cvt_pk_bf16_f32 v154, v20, v21
    v_cvt_pk_bf16_f32 v155, v22, v23
    buffer_store_dwordx4 v[152:155], v137, s[8:11], s25 offen offset:2048 sc1
    v_cvt_pk_bf16_f32 v156, v24, v25
    v_cvt_pk_bf16_f32 v157, v26, v27
    v_cvt_pk_bf16_f32 v158, v28, v29
    v_cvt_pk_bf16_f32 v159, v30, v31
    buffer_store_dwordx4 v[156:159], v137, s[8:11], s25 offen offset:3072 sc1
    v_cvt_pk_bf16_f32 v144, v32, v33
    v_cvt_pk_bf16_f32 v145, v34, v35
    v_cvt_pk_bf16_f32 v146, v36, v37
    v_cvt_pk_bf16_f32 v147, v38, v39
    s_add_u32 s25, s25, 4096
    buffer_store_dwordx4 v[144:147], v137, s[8:11], s25 offen sc1
    v_cvt_pk_bf16_f32 v148, v40, v41
    v_cvt_pk_bf16_f32 v149, v42, v43
    v_cvt_pk_bf16_f32 v150, v44, v45
    v_cvt_pk_bf16_f32 v151, v46, v47
    buffer_store_dwordx4 v[148:151], v137, s[8:11], s25 offen offset:1024 sc1
    v_cvt_pk_bf16_f32 v152, v48, v49
    v_cvt_pk_bf16_f32 v153, v50, v51
    v_cvt_pk_bf16_f32 v154, v52, v53
    v_cvt_pk_bf16_f32 v155, v54, v55
    buffer_store_dwordx4 v[152:155], v137, s[8:11], s25 offen offset:2048 sc1
    v_cvt_pk_bf16_f32 v156, v56, v57
    v_cvt_pk_bf16_f32 v157, v58, v59
    v_cvt_pk_bf16_f32 v158, v60, v61
    v_cvt_pk_bf16_f32 v159, v62, v63
    buffer_store_dwordx4 v[156:159], v137, s[8:11], s25 offen offset:3072 sc1
L_p1_next:
    s_add_u32 s80, s80, 1
    s_lshl_b32 s40, s38, 4
    s_add_u32 s40, s40, s20
    s_lshl_b32 s40, s40, 2
    s_add_u32 s40, s40, 0x2000
    s_add_u32 s38, s38, s37
    s_branch L_p1_unit
L_p1_end:
    s_waitcnt vmcnt(0)
    s_barrier
    s_cmp_eq_u32 s40, 0
    s_cbranch_scc1 L_nopf_98
    s_cmp_lg_u32 s87, 0
    s_cbranch_scc1 L_modeok_99
    s_mov_b32 s96, 0
L_mode_100:
    buffer_load_dwordx2 v[140:141], off, s[92:95], 0 offset:36 sc1
    s_waitcnt vmcnt(0)
    v_readfirstlane_b32 s87, v140
    v_readfirstlane_b32 s97, v141
    s_nop 0
    s_min_u32 s97, s97, s87
    s_cmp_lg_u32 s97, 0
    s_cbranch_scc1 L_moded_101
    s_sleep 4
    s_add_u32 s96, s96, 1
    s_cmp_lg_u32 s96, 0x100
    s_cbranch_scc1 L_modef_102
    v_mov_b32 v140, 2
    v_mov_b32 v141, 0
    s_mov_b64 exec, 1
    buffer_atomic_cmpswap v[140:141], off, s[92:95], 0 offset:36
    s_mov_b64 exec, -1
L_modef_102:
    s_cmp_lt_u32 s96, 0x10000
    s_cbranch_scc1 L_mode_100
L_moded_101:
    s_cmp_lg_u32 s87, 1
    s_cbranch_scc1 L_fallback
L_modeok_99:
    s_cmp_lg_u32 s100, 0
    s_cbranch_scc1 L_flag_103
    v_mov_b32 v138, 1
    s_mov_b64 exec, 1
    buffer_store_dword v138, off, s[8:11], s40 sc1
    s_mov_b64 exec, -1
L_flag_103:
    s_mov_b32 s40, 0
L_nopf_98:
    s_cmp_lg_u32 s41, 0
    s_cbranch_scc1 L_p1done
    s_mov_b32 s41, 1
    s_and_b32 s20, s101, 15
    s_lshr_b32 s22, s101, 4
    s_mov_b32 s37, 14
    s_add_u32 s26, s22, 70
    s_add_u32 s27, s22, 56
    s_cmp_ge_u32 s27, 64
    s_cselect_b32 s26, s27, s26
    s_add_u32 s27, s22, 42
    s_add_u32 s28, s22, 28
    s_cmp_ge_u32 s28, 32
    s_cselect_b32 s27, s28, s27
    s_cmp_eq_u32 s20, 3
    s_cselect_b32 s22, s27, s22
    s_cmp_lt_u32 s20, 3
    s_cselect_b32 s22, s26, s22
    s_branch L_p1_pass
L_p1done:
    v_mbcnt_lo_u32_b32 v0, -1, 0
    v_mbcnt_hi_u32_b32 v0, -1, v0
    s_lshl_b32 s96, s100, 6
    v_add_u32 v0, s96, v0
    s_and_b32 s20, s101, 15
    s_lshr_b32 s22, s101, 4
    s_mov_b32 s23, 14
    s_load_dwordx2 s[12:13], s[0:1], 40
    s_waitcnt lgkmcnt(0)
    s_and_b32 s13, s13, 0xffff
    s_mov_b32 s14, 0x400000
    s_mov_b32 s15, 0x20000
    v_lshrrev_b32 v4, 6, v0
    s_nop 0
    v_readfirstlane_b32 s21, v4
    v_and_b32 v1, 63, v0
    v_lshrrev_b32 v2, 4, v1
    v_and_b32 v3, 15, v1
    v_lshrrev_b32 v6, 2, v3
    v_lshlrev_b32 v240, 4, v1
    v_lshlrev_b32 v241, 3, v1
    s_lshl_b32 s27, s21, 10
    s_lshl_b32 s24, s21, 5
    v_xor_b32 v4, s24, v240
    v_add_u32 v8, s27, v4
    v_xor_b32 v9, 128, v8
    v_lshl_add_u32 v4, v2, 2, v6
    v_and_b32 v5, 7, v4
    v_lshlrev_b32 v4, 10, v4
    v_lshl_add_u32 v4, v5, 5, v4
    v_and_b32 v5, 3, v3
    v_lshl_add_u32 v4, v5, 3, v4
    s_lshl_b32 s24, s21, 8
    v_add_u32 v10, s24, v4
    s_lshl_b32 s25, s20, 18
    s_add_u32 s24, s25, 0x0
    s_add_u32 m0, s27, 0x0
    s_nop 0
    buffer_load_dwordx4 v8, s[12:15], s24 offen lds
    s_add_u32 s24, s25, 0x1000
    s_add_u32 m0, s27, 0x1000
    s_nop 0
    buffer_load_dwordx4 v9, s[12:15], s24 offen lds
    s_add_u32 s24, s25, 0x2000
    s_add_u32 m0, s27, 0x2000
    s_nop 0
    buffer_load_dwordx4 v8, s[12:15], s24 offen lds
    s_add_u32 s24, s25, 0x3000
    s_add_u32 m0, s27, 0x3000
    s_nop 0
    buffer_load_dwordx4 v9, s[12:15], s24 offen lds
    s_add_u32 s24, s25, 0x4000
    s_add_u32 m0, s27, 0x4000
    s_nop 0
    buffer_load_dwordx4 v8, s[12:15], s24 offen lds
    s_add_u32 s24, s25, 0x5000
    s_add_u32 m0, s27, 0x5000
    s_nop 0
    buffer_load_dwordx4 v9, s[12:15], s24 offen lds
    s_add_u32 s24, s25, 0x6000
    s_add_u32 m0, s27, 0x6000
    s_nop 0
    buffer_load_dwordx4 v8, s[12:15], s24 offen lds
    s_add_u32 s24, s25, 0x7000
    s_add_u32 m0, s27, 0x7000
    s_nop 0
    buffer_load_dwordx4 v9, s[12:15], s24 offen lds
    s_add_u32 s24, s25, 0x8000
    s_add_u32 m0, s27, 0x8000
    s_nop 0
    buffer_load_dwordx4 v8, s[12:15], s24 offen lds
    s_add_u32 s24, s25, 0x9000
    s_add_u32 m0, s27, 0x9000
    s_nop 0
    buffer_load_dwordx4 v9, s[12:15], s24 offen lds
    s_add_u32 s24, s25, 0xa000
    s_add_u32 m0, s27, 0xa000
    s_nop 0
    buffer_load_dwordx4 v8, s[12:15], s24 offen lds
    s_add_u32 s24, s25, 0xb000
    s_add_u32 m0, s27, 0xb000
    s_nop 0
    buffer_load_dwordx4 v9, s[12:15], s24 offen lds
    s_add_u32 s24, s25, 0xc000
    s_add_u32 m0, s27, 0xc000
    s_nop 0
    buffer_load_dwordx4 v8, s[12:15], s24 offen lds
    s_add_u32 s24, s25, 0xd000
    s_add_u32 m0, s27, 0xd000
    s_nop 0
    buffer_load_dwordx4 v9, s[12:15], s24 offen lds
    s_add_u32 s24, s25, 0xe000
    s_add_u32 m0, s27, 0xe000
    s_nop 0
    buffer_load_dwordx4 v8, s[12:15], s24 offen lds
    s_add_u32 s24, s25, 0xf000
    s_add_u32 m0, s27, 0xf000
    s_nop 0
    buffer_load_dwordx4 v9, s[12:15], s24 offen lds
    s_add_u32 s24, s25, 0x10000
    s_add_u32 m0, s27, 0x10000
    s_nop 0
    buffer_load_dwordx4 v8, s[12:15], s24 offen lds
    s_add_u32 s24, s25, 0x11000
    s_add_u32 m0, s27, 0x11000
    s_nop 0
    buffer_load_dwordx4 v9, s[12:15], s24 offen lds
    s_add_u32 s24, s25, 0x12000
    s_add_u32 m0, s27, 0x12000
    s_nop 0
    buffer_load_dwordx4 v8, s[12:15], s24 offen lds
    s_add_u32 s24, s25, 0x13000
    s_add_u32 m0, s27, 0x13000
    s_nop 0
    buffer_load_dwordx4 v9, s[12:15], s24 offen lds
    s_add_u32 s24, s25, 0x14000
    s_add_u32 m0, s27, 0x14000
    s_nop 0
    buffer_load_dwordx4 v8, s[12:15], s24 offen lds
    s_add_u32 s24, s25, 0x15000
    s_add_u32 m0, s27, 0x15000
    s_nop 0
    buffer_load_dwordx4 v9, s[12:15], s24 offen lds
    s_add_u32 s24, s25, 0x16000
    s_add_u32 m0, s27, 0x16000
    s_nop 0
    buffer_load_dwordx4 v8, s[12:15], s24 offen lds
    s_add_u32 s24, s25, 0x17000
    s_add_u32 m0, s27, 0x17000
    s_nop 0
    buffer_load_dwordx4 v9, s[12:15], s24 offen lds
    s_add_u32 s24, s25, 0x18000
    s_add_u32 m0, s27, 0x18000
    s_nop 0
    buffer_load_dwordx4 v8, s[12:15], s24 offen lds
    s_add_u32 s24, s25, 0x19000
    s_add_u32 m0, s27, 0x19000
    s_nop 0
    buffer_load_dwordx4 v9, s[12:15], s24 offen lds
    s_add_u32 s24, s25, 0x1a000
    s_add_u32 m0, s27, 0x1a000
    s_nop 0
    buffer_load_dwordx4 v8, s[12:15], s24 offen lds
    s_add_u32 s24, s25, 0x1b000
    s_add_u32 m0, s27, 0x1b000
    s_nop 0
    buffer_load_dwordx4 v9, s[12:15], s24 offen lds
    s_add_u32 s24, s25, 0x1c000
    s_add_u32 m0, s27, 0x1c000
    s_nop 0
    buffer_load_dwordx4 v8, s[12:15], s24 offen lds
    s_add_u32 s24, s25, 0x1d000
    s_add_u32 m0, s27, 0x1d000
    s_nop 0
    buffer_load_dwordx4 v9, s[12:15], s24 offen lds
    s_add_u32 s24, s25, 0x1e000
    s_add_u32 m0, s27, 0x1e000
    s_nop 0
    buffer_load_dwordx4 v8, s[12:15], s24 offen lds
    s_add_u32 s24, s25, 0x1f000
    s_add_u32 m0, s27, 0x1f000
    s_nop 0
    buffer_load_dwordx4 v9, s[12:15], s24 offen lds
    s_waitcnt vmcnt(0)
    s_barrier
    v_xor_b32 v11, 0x0, v10
    ds_read_b64_tr_b16 a[0:1], v11
    ds_read_b64_tr_b16 a[2:3], v11 offset:16384
    ds_read_b64_tr_b16 a[32:33], v11 offset:32768
    ds_read_b64_tr_b16 a[34:35], v11 offset:49152
    v_xor_b32 v11, 0x20, v10
    ds_read_b64_tr_b16 a[4:5], v11
    ds_read_b64_tr_b16 a[6:7], v11 offset:16384
    ds_read_b64_tr_b16 a[36:37], v11 offset:32768
    ds_read_b64_tr_b16 a[38:39], v11 offset:49152
    s_waitcnt lgkmcnt(0)
    v_xor_b32 v11, 0x40, v10
    ds_read_b64_tr_b16 a[8:9], v11
    ds_read_b64_tr_b16 a[10:11], v11 offset:16384
    ds_read_b64_tr_b16 a[40:41], v11 offset:32768
    ds_read_b64_tr_b16 a[42:43], v11 offset:49152
    v_xor_b32 v11, 0x60, v10
    ds_read_b64_tr_b16 a[12:13], v11
    ds_read_b64_tr_b16 a[14:15], v11 offset:16384
    ds_read_b64_tr_b16 a[44:45], v11 offset:32768
    ds_read_b64_tr_b16 a[46:47], v11 offset:49152
    s_waitcnt lgkmcnt(0)
    v_xor_b32 v11, 0x80, v10
    ds_read_b64_tr_b16 a[16:17], v11
    ds_read_b64_tr_b16 a[18:19], v11 offset:16384
    ds_read_b64_tr_b16 a[48:49], v11 offset:32768
    ds_read_b64_tr_b16 a[50:51], v11 offset:49152
    v_xor_b32 v11, 0xa0, v10
    ds_read_b64_tr_b16 a[20:21], v11
    ds_read_b64_tr_b16 a[22:23], v11 offset:16384
    ds_read_b64_tr_b16 a[52:53], v11 offset:32768
    ds_read_b64_tr_b16 a[54:55], v11 offset:49152
    s_waitcnt lgkmcnt(0)
    v_xor_b32 v11, 0xc0, v10
    ds_read_b64_tr_b16 a[24:25], v11
    ds_read_b64_tr_b16 a[26:27], v11 offset:16384
    ds_read_b64_tr_b16 a[56:57], v11 offset:32768
    ds_read_b64_tr_b16 a[58:59], v11 offset:49152
    v_xor_b32 v11, 0xe0, v10
    ds_read_b64_tr_b16 a[28:29], v11
    ds_read_b64_tr_b16 a[30:31], v11 offset:16384
    ds_read_b64_tr_b16 a[60:61], v11 offset:32768
    ds_read_b64_tr_b16 a[62:63], v11 offset:49152
    s_waitcnt lgkmcnt(0)
    v_xor_b32 v11, 0x10000, v10
    ds_read_b64_tr_b16 a[64:65], v11
    ds_read_b64_tr_b16 a[66:67], v11 offset:16384
    ds_read_b64_tr_b16 a[96:97], v11 offset:32768
    ds_read_b64_tr_b16 a[98:99], v11 offset:49152
    v_xor_b32 v11, 0x10020, v10
    ds_read_b64_tr_b16 a[68:69], v11
    ds_read_b64_tr_b16 a[70:71], v11 offset:16384
    ds_read_b64_tr_b16 a[100:101], v11 offset:32768
    ds_read_b64_tr_b16 a[102:103], v11 offset:49152
    s_waitcnt lgkmcnt(0)
    v_xor_b32 v11, 0x10040, v10
    ds_read_b64_tr_b16 a[72:73], v11
    ds_read_b64_tr_b16 a[74:75], v11 offset:16384
    ds_read_b64_tr_b16 a[104:105], v11 offset:32768
    ds_read_b64_tr_b16 a[106:107], v11 offset:49152
    v_xor_b32 v11, 0x10060, v10
    ds_read_b64_tr_b16 a[76:77], v11
    ds_read_b64_tr_b16 a[78:79], v11 offset:16384
    ds_read_b64_tr_b16 a[108:109], v11 offset:32768
    ds_read_b64_tr_b16 a[110:111], v11 offset:49152
    s_waitcnt lgkmcnt(0)
    v_xor_b32 v11, 0x10080, v10
    ds_read_b64_tr_b16 a[80:81], v11
    ds_read_b64_tr_b16 a[82:83], v11 offset:16384
    ds_read_b64_tr_b16 a[112:113], v11 offset:32768
    ds_read_b64_tr_b16 a[114:115], v11 offset:49152
    v_xor_b32 v11, 0x100a0, v10
    ds_read_b64_tr_b16 a[84:85], v11
    ds_read_b64_tr_b16 a[86:87], v11 offset:16384
    ds_read_b64_tr_b16 a[116:117], v11 offset:32768
    ds_read_b64_tr_b16 a[118:119], v11 offset:49152
    s_waitcnt lgkmcnt(0)
    v_xor_b32 v11, 0x100c0, v10
    ds_read_b64_tr_b16 a[88:89], v11
    ds_read_b64_tr_b16 a[90:91], v11 offset:16384
    ds_read_b64_tr_b16 a[120:121], v11 offset:32768
    ds_read_b64_tr_b16 a[122:123], v11 offset:49152
    v_xor_b32 v11, 0x100e0, v10
    ds_read_b64_tr_b16 a[92:93], v11
    ds_read_b64_tr_b16 a[94:95], v11 offset:16384
    ds_read_b64_tr_b16 a[124:125], v11 offset:32768
    ds_read_b64_tr_b16 a[126:127], v11 offset:49152
    s_waitcnt lgkmcnt(0)
    s_barrier
    s_lshl_b32 s25, s20, 18
    s_add_u32 s24, s25, 0x20000
    s_add_u32 m0, s27, 0x0
    s_nop 0
    buffer_load_dwordx4 v8, s[12:15], s24 offen lds
    s_add_u32 s24, s25, 0x21000
    s_add_u32 m0, s27, 0x1000
    s_nop 0
    buffer_load_dwordx4 v9, s[12:15], s24 offen lds
    s_add_u32 s24, s25, 0x22000
    s_add_u32 m0, s27, 0x2000
    s_nop 0
    buffer_load_dwordx4 v8, s[12:15], s24 offen lds
    s_add_u32 s24, s25, 0x23000
    s_add_u32 m0, s27, 0x3000
    s_nop 0
    buffer_load_dwordx4 v9, s[12:15], s24 offen lds
    s_add_u32 s24, s25, 0x24000
    s_add_u32 m0, s27, 0x4000
    s_nop 0
    buffer_load_dwordx4 v8, s[12:15], s24 offen lds
    s_add_u32 s24, s25, 0x25000
    s_add_u32 m0, s27, 0x5000
    s_nop 0
    buffer_load_dwordx4 v9, s[12:15], s24 offen lds
    s_add_u32 s24, s25, 0x26000
    s_add_u32 m0, s27, 0x6000
    s_nop 0
    buffer_load_dwordx4 v8, s[12:15], s24 offen lds
    s_add_u32 s24, s25, 0x27000
    s_add_u32 m0, s27, 0x7000
    s_nop 0
    buffer_load_dwordx4 v9, s[12:15], s24 offen lds
    s_add_u32 s24, s25, 0x28000
    s_add_u32 m0, s27, 0x8000
    s_nop 0
    buffer_load_dwordx4 v8, s[12:15], s24 offen lds
    s_add_u32 s24, s25, 0x29000
    s_add_u32 m0, s27, 0x9000
    s_nop 0
    buffer_load_dwordx4 v9, s[12:15], s24 offen lds
    s_add_u32 s24, s25, 0x2a000
    s_add_u32 m0, s27, 0xa000
    s_nop 0
    buffer_load_dwordx4 v8, s[12:15], s24 offen lds
    s_add_u32 s24, s25, 0x2b000
    s_add_u32 m0, s27, 0xb000
    s_nop 0
    buffer_load_dwordx4 v9, s[12:15], s24 offen lds
    s_add_u32 s24, s25, 0x2c000
    s_add_u32 m0, s27, 0xc000
    s_nop 0
    buffer_load_dwordx4 v8, s[12:15], s24 offen lds
    s_add_u32 s24, s25, 0x2d000
    s_add_u32 m0, s27, 0xd000
    s_nop 0
    buffer_load_dwordx4 v9, s[12:15], s24 offen lds
    s_add_u32 s24, s25, 0x2e000
    s_add_u32 m0, s27, 0xe000
    s_nop 0
    buffer_load_dwordx4 v8, s[12:15], s24 offen lds
    s_add_u32 s24, s25, 0x2f000
    s_add_u32 m0, s27, 0xf000
    s_nop 0
    buffer_load_dwordx4 v9, s[12:15], s24 offen lds
    s_add_u32 s24, s25, 0x30000
    s_add_u32 m0, s27, 0x10000
    s_nop 0
    buffer_load_dwordx4 v8, s[12:15], s24 offen lds
    s_add_u32 s24, s25, 0x31000
    s_add_u32 m0, s27, 0x11000
    s_nop 0
    buffer_load_dwordx4 v9, s[12:15], s24 offen lds
    s_add_u32 s24, s25, 0x32000
    s_add_u32 m0, s27, 0x12000
    s_nop 0
    buffer_load_dwordx4 v8, s[12:15], s24 offen lds
    s_add_u32 s24, s25, 0x33000
    s_add_u32 m0, s27, 0x13000
    s_nop 0
    buffer_load_dwordx4 v9, s[12:15], s24 offen lds
    s_add_u32 s24, s25, 0x34000
    s_add_u32 m0, s27, 0x14000
    s_nop 0
    buffer_load_dwordx4 v8, s[12:15], s24 offen lds
    s_add_u32 s24, s25, 0x35000
    s_add_u32 m0, s27, 0x15000
    s_nop 0
    buffer_load_dwordx4 v9, s[12:15], s24 offen lds
    s_add_u32 s24, s25, 0x36000
    s_add_u32 m0, s27, 0x16000
    s_nop 0
    buffer_load_dwordx4 v8, s[12:15], s24 offen lds
    s_add_u32 s24, s25, 0x37000
    s_add_u32 m0, s27, 0x17000
    s_nop 0
    buffer_load_dwordx4 v9, s[12:15], s24 offen lds
    s_add_u32 s24, s25, 0x38000
    s_add_u32 m0, s27, 0x18000
    s_nop 0
    buffer_load_dwordx4 v8, s[12:15], s24 offen lds
    s_add_u32 s24, s25, 0x39000
    s_add_u32 m0, s27, 0x19000
    s_nop 0
    buffer_load_dwordx4 v9, s[12:15], s24 offen lds
    s_add_u32 s24, s25, 0x3a000
    s_add_u32 m0, s27, 0x1a000
    s_nop 0
    buffer_load_dwordx4 v8, s[12:15], s24 offen lds
    s_add_u32 s24, s25, 0x3b000
    s_add_u32 m0, s27, 0x1b000
    s_nop 0
    buffer_load_dwordx4 v9, s[12:15], s24 offen lds
    s_add_u32 s24, s25, 0x3c000
    s_add_u32 m0, s27, 0x1c000
    s_nop 0
    buffer_load_dwordx4 v8, s[12:15], s24 offen lds
    s_add_u32 s24, s25, 0x3d000
    s_add_u32 m0, s27, 0x1d000
    s_nop 0
    buffer_load_dwordx4 v9, s[12:15], s24 offen lds
    s_add_u32 s24, s25, 0x3e000
    s_add_u32 m0, s27, 0x1e000
    s_nop 0
    buffer_load_dwordx4 v8, s[12:15], s24 offen lds
    s_add_u32 s24, s25, 0x3f000
    s_add_u32 m0, s27, 0x1f000
    s_nop 0
    buffer_load_dwordx4 v9, s[12:15], s24 offen lds
    s_waitcnt vmcnt(0)
    s_barrier
    v_xor_b32 v11, 0x0, v10
    ds_read_b64_tr_b16 a[128:129], v11
    ds_read_b64_tr_b16 a[130:131], v11 offset:16384
    ds_read_b64_tr_b16 a[160:161], v11 offset:32768
    ds_read_b64_tr_b16 a[162:163], v11 offset:49152
    v_xor_b32 v11, 0x20, v10
    ds_read_b64_tr_b16 a[132:133], v11
    ds_read_b64_tr_b16 a[134:135], v11 offset:16384
    ds_read_b64_tr_b16 a[164:165], v11 offset:32768
    ds_read_b64_tr_b16 a[166:167], v11 offset:49152
    s_waitcnt lgkmcnt(0)
    v_xor_b32 v11, 0x40, v10
    ds_read_b64_tr_b16 a[136:137], v11
    ds_read_b64_tr_b16 a[138:139], v11 offset:16384
    ds_read_b64_tr_b16 a[168:169], v11 offset:32768
    ds_read_b64_tr_b16 a[170:171], v11 offset:49152
    v_xor_b32 v11, 0x60, v10
    ds_read_b64_tr_b16 a[140:141], v11
    ds_read_b64_tr_b16 a[142:143], v11 offset:16384
    ds_read_b64_tr_b16 a[172:173], v11 offset:32768
    ds_read_b64_tr_b16 a[174:175], v11 offset:49152
    s_waitcnt lgkmcnt(0)
    v_xor_b32 v11, 0x80, v10
    ds_read_b64_tr_b16 a[144:145], v11
    ds_read_b64_tr_b16 a[146:147], v11 offset:16384
    ds_read_b64_tr_b16 a[176:177], v11 offset:32768
    ds_read_b64_tr_b16 a[178:179], v11 offset:49152
    v_xor_b32 v11, 0xa0, v10
    ds_read_b64_tr_b16 a[148:149], v11
    ds_read_b64_tr_b16 a[150:151], v11 offset:16384
    ds_read_b64_tr_b16 a[180:181], v11 offset:32768
    ds_read_b64_tr_b16 a[182:183], v11 offset:49152
    s_waitcnt lgkmcnt(0)
    v_xor_b32 v11, 0xc0, v10
    ds_read_b64_tr_b16 a[152:153], v11
    ds_read_b64_tr_b16 a[154:155], v11 offset:16384
    ds_read_b64_tr_b16 a[184:185], v11 offset:32768
    ds_read_b64_tr_b16 a[186:187], v11 offset:49152
    v_xor_b32 v11, 0xe0, v10
    ds_read_b64_tr_b16 a[156:157], v11
    ds_read_b64_tr_b16 a[158:159], v11 offset:16384
    ds_read_b64_tr_b16 a[188:189], v11 offset:32768
    ds_read_b64_tr_b16 a[190:191], v11 offset:49152
    s_waitcnt lgkmcnt(0)
    v_xor_b32 v11, 0x10000, v10
    ds_read_b64_tr_b16 a[192:193], v11
    ds_read_b64_tr_b16 a[194:195], v11 offset:16384
    ds_read_b64_tr_b16 a[224:225], v11 offset:32768
    ds_read_b64_tr_b16 a[226:227], v11 offset:49152
    v_xor_b32 v11, 0x10020, v10
    ds_read_b64_tr_b16 a[196:197], v11
    ds_read_b64_tr_b16 a[198:199], v11 offset:16384
    ds_read_b64_tr_b16 a[228:229], v11 offset:32768
    ds_read_b64_tr_b16 a[230:231], v11 offset:49152
    s_waitcnt lgkmcnt(0)
    v_xor_b32 v11, 0x10040, v10
    ds_read_b64_tr_b16 a[200:201], v11
    ds_read_b64_tr_b16 a[202:203], v11 offset:16384
    ds_read_b64_tr_b16 a[232:233], v11 offset:32768
    ds_read_b64_tr_b16 a[234:235], v11 offset:49152
    v_xor_b32 v11, 0x10060, v10
    ds_read_b64_tr_b16 a[204:205], v11
    ds_read_b64_tr_b16 a[206:207], v11 offset:16384
    ds_read_b64_tr_b16 a[236:237], v11 offset:32768
    ds_read_b64_tr_b16 a[238:239], v11 offset:49152
    s_waitcnt lgkmcnt(0)
    v_xor_b32 v11, 0x10080, v10
    ds_read_b64_tr_b16 a[208:209], v11
    ds_read_b64_tr_b16 a[210:211], v11 offset:16384
    ds_read_b64_tr_b16 a[240:241], v11 offset:32768
    ds_read_b64_tr_b16 a[242:243], v11 offset:49152
    v_xor_b32 v11, 0x100a0, v10
    ds_read_b64_tr_b16 a[212:213], v11
    ds_read_b64_tr_b16 a[214:215], v11 offset:16384
    ds_read_b64_tr_b16 a[244:245], v11 offset:32768
    ds_read_b64_tr_b16 a[246:247], v11 offset:49152
    s_waitcnt lgkmcnt(0)
    v_xor_b32 v11, 0x100c0, v10
    ds_read_b64_tr_b16 a[216:217], v11
    ds_read_b64_tr_b16 a[218:219], v11 offset:16384
    ds_read_b64_tr_b16 a[248:249], v11 offset:32768
    ds_read_b64_tr_b16 a[250:251], v11 offset:49152
    v_xor_b32 v11, 0x100e0, v10
    ds_read_b64_tr_b16 a[220:221], v11
    ds_read_b64_tr_b16 a[222:223], v11 offset:16384
    ds_read_b64_tr_b16 a[252:253], v11 offset:32768
    ds_read_b64_tr_b16 a[254:255], v11 offset:49152
    s_waitcnt lgkmcnt(0)
    s_barrier
    s_and_b32 s24, s21, 1
    s_lshl_b32 s24, s24, 4
    v_add_u32 v4, s24, v3
    v_lshlrev_b32 v5, 2, v2
    v_sub_u32 v4, v4, v5
    v_cmp_le_i32 s[30:31], 0, v4
    v_cmp_le_i32 s[32:33], 1, v4
    v_cmp_le_i32 s[34:35], 2, v4
    v_cmp_le_i32 s[36:37], 3, v4
    v_cmp_le_i32 s[38:39], 16, v4
    v_cmp_le_i32 s[40:41], 17, v4
    v_cmp_le_i32 s[42:43], 18, v4
    v_cmp_le_i32 s[44:45], 19, v4
    s_mov_b32 s28, 0x3e0293ee
    s_mov_b32 s29, 0x3e0293ee
    s_mov_b32 s53, 0xff000000
    v_mov_b32 v136, 0x3f803f80
    v_mov_b32 v137, 0x3f803f80
    v_mov_b32 v138, 0x3f803f80
    v_mov_b32 v139, 0x3f803f80
    v_lshlrev_b32 v4, 10, v3
    v_lshl_add_u32 v4, v2, 4, v4
    s_lshl_b32 s24, s21, 8
    v_add_u32 v242, s24, v4
    s_lshl_b32 s24, s21, 12
    v_add_u32 v243, s24, v240
    v_mov_b32 v244, v240
    s_add_u32 s24, s24, 0x22000
    v_xor_b32 v7, v2, v6
    v_lshl_add_u32 v4, v2, 4, v7
    v_and_b32 v5, 3, v3
    v_lshl_add_u32 v4, v4, 2, v5
    v_lshl_add_u32 v253, v4, 2, s24
    v_lshl_add_u32 v4, v3, 2, v7
    v_lshl_add_u32 v254, v4, 4, s24
    s_load_dwordx2 s[12:13], s[0:1], 0
    s_waitcnt lgkmcnt(0)
    s_and_b32 s13, s13, 0xffff
    s_mov_b32 s14, 0x200000
    s_mov_b32 s15, 0x20000
    s_load_dwordx2 s[16:17], s[0:1], 96
    s_waitcnt lgkmcnt(0)
    s_and_b32 s17, s17, 0xffff
    s_mov_b32 s18, 0x200000
    s_mov_b32 s19, 0x20000
    s_load_dwordx2 s[56:57], s[0:1], 64
    s_waitcnt lgkmcnt(0)
    s_and_b32 s57, s57, 0xffff
    s_mov_b32 s58, 0x400
    s_mov_b32 s59, 0x20000
    v_and_b32 v100, 63, v0
    v_lshlrev_b32 v240, 4, v100
    v_lshrrev_b32 v101, 2, v100
    v_lshlrev_b32 v101, 6, v101
    v_and_b32 v102, 3, v100
    v_lshl_add_u32 v252, v102, 3, v101
    buffer_load_dwordx2 v[236:237], v252, s[56:59], 0 offen
    buffer_load_dwordx2 v[238:239], v252, s[56:59], 0 offen offset:32
    s_mov_b32 s65, 0x3f80
    s_mov_b32 s66, 0x3f800000
    s_waitcnt vmcnt(0)
    s_sub_u32 s67, s101, 128
    s_cmp_ge_u32 s67, 56
    s_cbranch_scc1 L_nostage_104
    v_lshrrev_b32 v2, 6, v0
    s_nop 0
    v_readfirstlane_b32 s68, v2
    v_and_b32 v1, 63, v0
    s_lshl_b32 s73, s68, 10
    v_lshrrev_b32 v2, 2, v1
    s_lshl_b32 s71, s68, 4
    v_add_u32 v2, s71, v2
    s_movk_i32 s71, 3584
    v_mul_lo_u32 v2, v2, s71
    v_and_b32 v3, 3, v1
    v_lshl_add_u32 v4, v3, 4, v2
    s_load_dwordx2 s[76:77], s[0:1], 72
    s_waitcnt lgkmcnt(0)
    s_and_b32 s77, s77, 0xffff
    s_mov_b32 s78, 0x1c0000
    s_mov_b32 s79, 0x20000
    s_lshl_b32 s71, s67, 6
    s_add_u32 s71, s71, 0x0
    s_add_u32 m0, s73, 0x8000
    s_nop 0
    buffer_load_dwordx4 v4, s[76:79], s71 offen lds
    s_lshl_b32 s71, s67, 6
    s_add_u32 s71, s71, 0x38000
    s_add_u32 m0, s73, 0x9000
    s_nop 0
    buffer_load_dwordx4 v4, s[76:79], s71 offen lds
    s_lshl_b32 s71, s67, 6
    s_add_u32 s71, s71, 0x70000
    s_add_u32 m0, s73, 0xa000
    s_nop 0
    buffer_load_dwordx4 v4, s[76:79], s71 offen lds
    s_lshl_b32 s71, s67, 6
    s_add_u32 s71, s71, 0xa8000
    s_add_u32 m0, s73, 0xb000
    s_nop 0
    buffer_load_dwordx4 v4, s[76:79], s71 offen lds
    s_lshl_b32 s71, s67, 6
    s_add_u32 s71, s71, 0xe0000
    s_add_u32 m0, s73, 0xc000
    s_nop 0
    buffer_load_dwordx4 v4, s[76:79], s71 offen lds
    s_lshl_b32 s71, s67, 6
    s_add_u32 s71, s71, 0x118000
    s_add_u32 m0, s73, 0xd000
    s_nop 0
    buffer_load_dwordx4 v4, s[76:79], s71 offen lds
    s_lshl_b32 s71, s67, 6
    s_add_u32 s71, s71, 0x150000
    s_add_u32 m0, s73, 0xe000
    s_nop 0
    buffer_load_dwordx4 v4, s[76:79], s71 offen lds
    s_lshl_b32 s71, s67, 6
    s_add_u32 s71, s71, 0x188000
    s_add_u32 m0, s73, 0xf000
    s_nop 0
    buffer_load_dwordx4 v4, s[76:79], s71 offen lds
    s_load_dwordx2 s[76:77], s[0:1], 80
    s_waitcnt lgkmcnt(0)
    s_and_b32 s77, s77, 0xffff
    s_mov_b32 s78, 0x1c0000
    s_mov_b32 s79, 0x20000
    s_lshl_b32 s71, s67, 6
    s_add_u32 s71, s71, 0x0
    s_add_u32 m0, s73, 0x10000
    s_nop 0
    buffer_load_dwordx4 v4, s[76:79], s71 offen lds
    s_lshl_b32 s71, s67, 6
    s_add_u32 s71, s71, 0x38000
    s_add_u32 m0, s73, 0x11000
    s_nop 0
    buffer_load_dwordx4 v4, s[76:79], s71 offen lds
    s_lshl_b32 s71, s67, 6
    s_add_u32 s71, s71, 0x70000
    s_add_u32 m0, s73, 0x12000
    s_nop 0
    buffer_load_dwordx4 v4, s[76:79], s71 offen lds
    s_lshl_b32 s71, s67, 6
    s_add_u32 s71, s71, 0xa8000
    s_add_u32 m0, s73, 0x13000
    s_nop 0
    buffer_load_dwordx4 v4, s[76:79], s71 offen lds
    s_lshl_b32 s71, s67, 6
    s_add_u32 s71, s71, 0xe0000
    s_add_u32 m0, s73, 0x14000
    s_nop 0
    buffer_load_dwordx4 v4, s[76:79], s71 offen lds
    s_lshl_b32 s71, s67, 6
    s_add_u32 s71, s71, 0x118000
    s_add_u32 m0, s73, 0x15000
    s_nop 0
    buffer_load_dwordx4 v4, s[76:79], s71 offen lds
    s_lshl_b32 s71, s67, 6
    s_add_u32 s71, s71, 0x150000
    s_add_u32 m0, s73, 0x16000
    s_nop 0
    buffer_load_dwordx4 v4, s[76:79], s71 offen lds
    s_lshl_b32 s71, s67, 6
    s_add_u32 s71, s71, 0x188000
    s_add_u32 m0, s73, 0x17000
    s_nop 0
    buffer_load_dwordx4 v4, s[76:79], s71 offen lds
    s_load_dwordx2 s[76:77], s[0:1], 88
    s_waitcnt lgkmcnt(0)
    s_and_b32 s77, s77, 0xffff
    s_mov_b32 s78, 0x1c0000
    s_mov_b32 s79, 0x20000
    v_lshlrev_b32 v5, 4, v1
    v_add_u32 v5, s73, v5
    s_lshl_b32 s71, s67, 15
    s_add_u32 s71, s71, 0
    s_add_u32 m0, s73, 0x18000
    s_nop 0
    buffer_load_dwordx4 v5, s[76:79], s71 offen lds
    s_lshl_b32 s71, s67, 15
    s_add_u32 s71, s71, 4096
    s_add_u32 m0, s73, 0x19000
    s_nop 0
    buffer_load_dwordx4 v5, s[76:79], s71 offen lds
    s_lshl_b32 s71, s67, 15
    s_add_u32 s71, s71, 8192
    s_add_u32 m0, s73, 0x1a000
    s_nop 0
    buffer_load_dwordx4 v5, s[76:79], s71 offen lds
    s_lshl_b32 s71, s67, 15
    s_add_u32 s71, s71, 12288
    s_add_u32 m0, s73, 0x1b000
    s_nop 0
    buffer_load_dwordx4 v5, s[76:79], s71 offen lds
    s_lshl_b32 s71, s67, 15
    s_add_u32 s71, s71, 16384
    s_add_u32 m0, s73, 0x1c000
    s_nop 0
    buffer_load_dwordx4 v5, s[76:79], s71 offen lds
    s_lshl_b32 s71, s67, 15
    s_add_u32 s71, s71, 20480
    s_add_u32 m0, s73, 0x1d000
    s_nop 0
    buffer_load_dwordx4 v5, s[76:79], s71 offen lds
    s_lshl_b32 s71, s67, 15
    s_add_u32 s71, s71, 24576
    s_add_u32 m0, s73, 0x1e000
    s_nop 0
    buffer_load_dwordx4 v5, s[76:79], s71 offen lds
    s_lshl_b32 s71, s67, 15
    s_add_u32 s71, s71, 28672
    s_add_u32 m0, s73, 0x1f000
    s_nop 0
    buffer_load_dwordx4 v5, s[76:79], s71 offen lds
L_nostage_104:
    v_lshrrev_b32 v246, 2, v240
    s_lshl_b32 s24, s20, 7
    s_add_u32 s24, s24, 0x2000
    s_cmp_lg_u32 s100, 0
    s_cbranch_scc1 L_polls_107
    s_mov_b32 exec_lo, 0xffffffff
    s_mov_b32 exec_hi, 0
    s_mov_b32 s96, 0
L_poll_105:
    buffer_load_dword v247, v246, s[8:11], s24 offen sc1
    s_waitcnt vmcnt(0)
    v_cmp_gt_u32 vcc, 1, v247
    s_cbranch_vccz L_polld_106
    s_sleep 32
    s_add_u32 s96, s96, 1
    s_cmp_lt_u32 s96, 0x10000
    s_cbranch_scc1 L_poll_105
L_polld_106:
    s_mov_b64 exec, -1
L_polls_107:
    s_barrier
    s_lshl_b32 s24, s20, 7
    s_add_u32 s24, s24, 0x2800
    s_cmp_lg_u32 s100, 0
    s_cbranch_scc1 L_polls_110
    s_mov_b32 exec_lo, 0xffffffff
    s_mov_b32 exec_hi, 0
    s_mov_b32 s96, 0
L_poll_108:
    buffer_load_dword v247, v246, s[8:11], s24 offen sc1
    s_waitcnt vmcnt(0)
    v_cmp_gt_u32 vcc, 1, v247
    s_cbranch_vccz L_polld_109
    s_sleep 32
    s_add_u32 s96, s96, 1
    s_cmp_lt_u32 s96, 0x10000
    s_cbranch_scc1 L_poll_108
L_polld_109:
    s_mov_b64 exec, -1
L_polls_110:
    s_barrier
    s_lshl_b32 s24, s20, 7
    s_add_u32 s24, s24, 0x3000
    s_cmp_lg_u32 s100, 0
    s_cbranch_scc1 L_polls_113
    s_mov_b32 exec_lo, 0xffffffff
    s_mov_b32 exec_hi, 0
    s_mov_b32 s96, 0
L_poll_111:
    buffer_load_dword v247, v246, s[8:11], s24 offen sc1
    s_waitcnt vmcnt(0)
    v_cmp_gt_u32 vcc, 1, v247
    s_cbranch_vccz L_polld_112
    s_sleep 32
    s_add_u32 s96, s96, 1
    s_cmp_lt_u32 s96, 0x10000
    s_cbranch_scc1 L_poll_111
L_polld_112:
    s_mov_b64 exec, -1
L_polls_113:
    s_barrier
    s_mov_b32 s80, 0
L_p2_seg:
    s_cmp_ge_u32 s22, 64
    s_cbranch_scc1 L_p2_end
    v_lshrrev_b32 v246, 2, v240
    s_lshl_b32 s24, s20, 7
    s_add_u32 s24, s24, 0x1000
    s_mul_i32 s25, s22, 10
    s_lshr_b32 s25, s25, 4
    s_add_u32 s25, s25, 17
    s_cmp_lg_u32 s100, 0
    s_cbranch_scc1 L_polls_116
    s_mov_b32 exec_lo, 0x1
    s_mov_b32 exec_hi, 0
    s_mov_b32 s96, 0
L_poll_114:
    buffer_load_dword v247, v246, s[8:11], s24 offen sc1
    s_waitcnt vmcnt(0)
    v_cmp_gt_u32 vcc, s25, v247
    s_cbranch_vccz L_polld_115
    v_readfirstlane_b32 s97, v247
    s_nop 0
    s_sub_u32 s97, s25, s97
    s_cmp_lt_i32 s97, 3
    s_cbranch_scc1 L_near_117
    s_sleep 40
    s_cmp_lt_i32 s97, 5
    s_cbranch_scc1 L_near_117
    s_sleep 100
L_near_117:
    s_sleep 8
    s_add_u32 s96, s96, 1
    s_cmp_lt_u32 s96, 0x10000
    s_cbranch_scc1 L_poll_114
L_polld_115:
    s_mov_b64 exec, -1
L_polls_116:
    s_barrier
    s_lshl_b32 s24, s22, 5
    s_lshl_b32 s25, s20, 1
    s_add_u32 s24, s24, s25
    s_lshr_b32 s25, s21, 1
    s_add_u32 s24, s24, s25
    s_lshl_b32 s25, s24, 13
    s_add_u32 s47, s25, 0x1000000
    s_add_u32 s54, s47, 4096
    s_add_u32 s48, s25, 0x2000000
    s_add_u32 s55, s48, 4096
    s_and_b32 s26, s21, 1
    s_lshl_b32 s26, s26, 12
    s_add_u32 s46, s25, s26
    s_add_u32 s46, s46, 0x3000000
    s_lshl_b32 s25, s24, 12
    s_add_u32 s49, s25, 0x240000
    s_lshl_b32 s24, s22, 4
    s_add_u32 s24, s24, s20
    s_lshl_b32 s24, s24, 15
    s_add_u32 s51, s24, 0x4000000
    buffer_load_dwordx4 v[0:3], v240, s[8:11], s46 offen
    buffer_load_dwordx4 v[4:7], v240, s[8:11], s46 offen offset:1024
    buffer_load_dwordx4 v[8:11], v240, s[8:11], s46 offen offset:2048
    buffer_load_dwordx4 v[12:15], v240, s[8:11], s46 offen offset:3072
    buffer_load_dwordx4 v[16:19], v240, s[8:11], s47 offen
    buffer_load_dwordx4 v[20:23], v240, s[8:11], s47 offen offset:1024
    buffer_load_dwordx4 v[24:27], v240, s[8:11], s47 offen offset:2048
    buffer_load_dwordx4 v[28:31], v240, s[8:11], s47 offen offset:3072
    buffer_load_dwordx4 v[32:35], v240, s[8:11], s54 offen
    buffer_load_dwordx4 v[36:39], v240, s[8:11], s54 offen offset:1024
    buffer_load_dwordx4 v[40:43], v240, s[8:11], s54 offen offset:2048
    buffer_load_dwordx4 v[44:47], v240, s[8:11], s54 offen offset:3072
    buffer_load_dwordx4 v[64:67], v240, s[8:11], s48 offen
    buffer_load_dwordx4 v[68:71], v240, s[8:11], s48 offen offset:1024
    buffer_load_dwordx4 v[72:75], v240, s[8:11], s48 offen offset:2048
    buffer_load_dwordx4 v[76:79], v240, s[8:11], s48 offen offset:3072
    buffer_load_dwordx4 v[80:83], v240, s[8:11], s55 offen
    buffer_load_dwordx4 v[84:87], v240, s[8:11], s55 offen offset:1024
    buffer_load_dwordx4 v[88:91], v240, s[8:11], s55 offen offset:2048
    buffer_load_dwordx4 v[92:95], v240, s[8:11], s55 offen offset:3072
    s_waitcnt vmcnt(8)
    v_mfma_f32_16x16x32_bf16 v[116:119], v[16:19], v[0:3], 0
    v_mfma_f32_16x16x32_bf16 v[116:119], v[20:23], v[4:7], v[116:119]
    v_mfma_f32_16x16x32_bf16 v[116:119], v[24:27], v[8:11], v[116:119]
    v_mfma_f32_16x16x32_bf16 v[116:119], v[28:31], v[12:15], v[116:119]
    v_mfma_f32_16x16x32_bf16 v[120:123], v[32:35], v[0:3], 0
    v_mfma_f32_16x16x32_bf16 v[120:123], v[36:39], v[4:7], v[120:123]
    v_mfma_f32_16x16x32_bf16 v[120:123], v[40:43], v[8:11], v[120:123]
    v_mfma_f32_16x16x32_bf16 v[120:123], v[44:47], v[12:15], v[120:123]
    v_mov_b32 v247, s53
    v_cndmask_b32 v116, v247, v116, s[30:31]
    v_cndmask_b32 v117, v247, v117, s[32:33]
    v_cndmask_b32 v118, v247, v118, s[34:35]
    v_cndmask_b32 v119, v247, v119, s[36:37]
    s_nop 2
    v_cndmask_b32 v120, v247, v120, s[38:39]
    v_cndmask_b32 v121, v247, v121, s[40:41]
    v_cndmask_b32 v122, v247, v122, s[42:43]
    v_cndmask_b32 v123, v247, v123, s[44:45]
    v_max3_f32 v251, v116, v117, v118
    v_max3_f32 v251, v251, v119, v120
    v_max3_f32 v251, v251, v121, v122
    v_lshrrev_b32 v246, 2, v240
    s_lshl_b32 s24, s20, 7
    s_add_u32 s24, s24, 0x1000
    s_add_u32 s25, s22, 1
    s_nop 1
    s_cmp_lg_u32 s100, 0
    s_cbranch_scc1 L_polls_120
    s_mov_b32 exec_lo, 0x11
    s_mov_b32 exec_hi, 0
    s_mov_b32 s96, 0
L_poll_118:
    buffer_load_dword v247, v246, s[8:11], s24 offen sc1
    s_waitcnt vmcnt(0)
    v_cmp_gt_u32 vcc, s25, v247
    s_cbranch_vccz L_polld_119
    v_readfirstlane_b32 s97, v247
    s_nop 0
    s_sub_u32 s97, s25, s97
    s_cmp_lt_i32 s97, 3
    s_cbranch_scc1 L_near_121
    s_sleep 40
    s_cmp_lt_i32 s97, 5
    s_cbranch_scc1 L_near_121
    s_sleep 100
L_near_121:
    s_sleep 8
    s_add_u32 s96, s96, 1
    s_cmp_lt_u32 s96, 0x10000
    s_cbranch_scc1 L_poll_118
L_polld_119:
    s_mov_b64 exec, -1
L_polls_120:
    s_barrier
    buffer_load_dwordx4 v[172:175], v240, s[8:11], s49 offen
    buffer_load_dwordx4 v[176:179], v240, s[8:11], s49 offen offset:1024
    buffer_load_dwordx4 v[180:183], v240, s[8:11], s49 offen offset:2048
    buffer_load_dwordx4 v[184:187], v240, s[8:11], s49 offen offset:3072
    s_waitcnt vmcnt(0)
    ds_write_b32 v253, v173
    ds_write_b32 v253, v175 offset:64
    ds_write_b32 v253, v177 offset:1024
    ds_write_b32 v253, v179 offset:1088
    ds_write_b32 v253, v181 offset:2048
    ds_write_b32 v253, v183 offset:2112
    ds_write_b32 v253, v185 offset:3072
    ds_write_b32 v253, v187 offset:3136
    ds_read_b128 v[48:51], v254
    ds_read_b128 v[52:55], v254 offset:1024
    ds_read_b128 v[56:59], v254 offset:2048
    ds_read_b128 v[60:63], v254 offset:3072
    s_waitcnt lgkmcnt(0)
    v_mfma_f32_16x16x32_bf16 v[112:115], v[48:51], v[0:3], 0
    v_mfma_f32_16x16x32_bf16 v[112:115], v[52:55], v[4:7], v[112:115]
    v_mfma_f32_16x16x32_bf16 v[112:115], v[56:59], v[8:11], v[112:115]
    v_mfma_f32_16x16x32_bf16 v[112:115], v[60:63], v[12:15], v[112:115]
    v_mov_b32 v246, v251
    s_nop 6
    v_max3_f32 v246, v246, v123, v112
    v_max_f32 v246, v246, v113
    v_mov_b32 v247, v246
    s_nop 1
    v_permlane32_swap_b32 v247, v246
    v_max_f32 v246, v247, v246
    v_mov_b32 v247, v246
    s_nop 1
    v_permlane16_swap_b32 v247, v246
    v_max_f32 v246, v247, v246
    v_mul_f32 v248, s28, v246
    v_pk_fma_f32 v[116:117], v[116:117], s[28:29], v[248:249] op_sel_hi:[1,1,0] neg_lo:[0,0,1] neg_hi:[0,0,1]
    v_pk_fma_f32 v[118:119], v[118:119], s[28:29], v[248:249] op_sel_hi:[1,1,0] neg_lo:[0,0,1] neg_hi:[0,0,1]
    v_pk_fma_f32 v[120:121], v[120:121], s[28:29], v[248:249] op_sel_hi:[1,1,0] neg_lo:[0,0,1] neg_hi:[0,0,1]
    v_pk_fma_f32 v[122:123], v[122:123], s[28:29], v[248:249] op_sel_hi:[1,1,0] neg_lo:[0,0,1] neg_hi:[0,0,1]
    v_pk_fma_f32 v[112:113], v[112:113], s[28:29], v[248:249] op_sel_hi:[1,1,0] neg_lo:[0,0,1] neg_hi:[0,0,1]
    v_exp_f32 v116, v116
    v_exp_f32 v117, v117
    v_exp_f32 v118, v118
    v_exp_f32 v119, v119
    v_exp_f32 v120, v120
    v_exp_f32 v121, v121
    v_exp_f32 v122, v122
    v_exp_f32 v123, v123
    v_exp_f32 v112, v112
    v_exp_f32 v113, v113
    v_cvt_pk_bf16_f32 v124, v116, v117
    v_cvt_pk_bf16_f32 v125, v118, v119
    v_cvt_pk_bf16_f32 v126, v120, v121
    v_cvt_pk_bf16_f32 v127, v122, v123
    v_cvt_pk_bf16_f32 v128, v112, v113
    v_mov_b32 v129, 0
    v_mfma_f32_16x16x32_bf16 v[132:135], v[136:139], v[124:127], 0
    v_mfma_f32_16x16x32_bf16 v[140:143], v[64:67], v[124:127], 0
    v_mfma_f32_16x16x32_bf16 v[144:147], v[68:71], v[124:127], 0
    v_mfma_f32_16x16x32_bf16 v[148:151], v[72:75], v[124:127], 0
    v_mfma_f32_16x16x32_bf16 v[152:155], v[76:79], v[124:127], 0
    v_mfma_f32_16x16x32_bf16 v[156:159], v[80:83], v[124:127], 0
    v_mfma_f32_16x16x32_bf16 v[160:163], v[84:87], v[124:127], 0
    v_mfma_f32_16x16x32_bf16 v[164:167], v[88:91], v[124:127], 0
    v_mfma_f32_16x16x32_bf16 v[168:171], v[92:95], v[124:127], 0
    v_mfma_f32_16x16x16_bf16 v[132:135], v[136:137], v[128:129], v[132:135]
    v_mfma_f32_16x16x16_bf16 v[140:143], v[172:173], v[128:129], v[140:143]
    v_mfma_f32_16x16x16_bf16 v[144:147], v[174:175], v[128:129], v[144:147]
    v_mfma_f32_16x16x16_bf16 v[148:151], v[176:177], v[128:129], v[148:151]
    v_mfma_f32_16x16x16_bf16 v[152:155], v[178:179], v[128:129], v[152:155]
    v_mfma_f32_16x16x16_bf16 v[156:159], v[180:181], v[128:129], v[156:159]
    v_mfma_f32_16x16x16_bf16 v[160:163], v[182:183], v[128:129], v[160:163]
    v_mfma_f32_16x16x16_bf16 v[164:167], v[184:185], v[128:129], v[164:167]
    v_mfma_f32_16x16x16_bf16 v[168:171], v[186:187], v[128:129], v[168:171]
    v_rcp_f32 v250, v132
    s_nop 0
    v_pk_mul_f32 v[140:141], v[140:141], v[250:251] op_sel_hi:[1,0]
    v_pk_mul_f32 v[142:143], v[142:143], v[250:251] op_sel_hi:[1,0]
    v_pk_mul_f32 v[144:145], v[144:145], v[250:251] op_sel_hi:[1,0]
    v_pk_mul_f32 v[146:147], v[146:147], v[250:251] op_sel_hi:[1,0]
    v_pk_mul_f32 v[148:149], v[148:149], v[250:251] op_sel_hi:[1,0]
    v_pk_mul_f32 v[150:151], v[150:151], v[250:251] op_sel_hi:[1,0]
    v_pk_mul_f32 v[152:153], v[152:153], v[250:251] op_sel_hi:[1,0]
    v_pk_mul_f32 v[154:155], v[154:155], v[250:251] op_sel_hi:[1,0]
    v_pk_mul_f32 v[156:157], v[156:157], v[250:251] op_sel_hi:[1,0]
    v_pk_mul_f32 v[158:159], v[158:159], v[250:251] op_sel_hi:[1,0]
    v_pk_mul_f32 v[160:161], v[160:161], v[250:251] op_sel_hi:[1,0]
    v_pk_mul_f32 v[162:163], v[162:163], v[250:251] op_sel_hi:[1,0]
    v_pk_mul_f32 v[164:165], v[164:165], v[250:251] op_sel_hi:[1,0]
    v_pk_mul_f32 v[166:167], v[166:167], v[250:251] op_sel_hi:[1,0]
    v_pk_mul_f32 v[168:169], v[168:169], v[250:251] op_sel_hi:[1,0]
    v_pk_mul_f32 v[170:171], v[170:171], v[250:251] op_sel_hi:[1,0]
    v_cvt_pk_bf16_f32 v140, v140, v141
    v_cvt_pk_bf16_f32 v141, v142, v143
    v_cvt_pk_bf16_f32 v142, v144, v145
    v_cvt_pk_bf16_f32 v143, v146, v147
    v_cvt_pk_bf16_f32 v144, v148, v149
    v_cvt_pk_bf16_f32 v145, v150, v151
    v_cvt_pk_bf16_f32 v146, v152, v153
    v_cvt_pk_bf16_f32 v147, v154, v155
    v_cvt_pk_bf16_f32 v148, v156, v157
    v_cvt_pk_bf16_f32 v149, v158, v159
    v_cvt_pk_bf16_f32 v150, v160, v161
    v_cvt_pk_bf16_f32 v151, v162, v163
    v_cvt_pk_bf16_f32 v152, v164, v165
    v_cvt_pk_bf16_f32 v153, v166, v167
    v_cvt_pk_bf16_f32 v154, v168, v169
    v_cvt_pk_bf16_f32 v155, v170, v171
    ds_write_b128 v243, v[140:143]
    ds_write_b128 v243, v[144:147] offset:1024
    ds_write_b128 v243, v[148:151] offset:2048
    ds_write_b128 v243, v[152:155] offset:3072
    s_waitcnt lgkmcnt(0)
    s_barrier
    ds_read_b128 v[0:3], v244
    ds_read_b128 v[4:7], v244 offset:1024
    ds_read_b128 v[8:11], v244 offset:2048
    ds_read_b128 v[12:15], v244 offset:3072
    ds_read_b128 v[16:19], v244 offset:4096
    ds_read_b128 v[20:23], v244 offset:5120
    ds_read_b128 v[24:27], v244 offset:6144
    ds_read_b128 v[28:31], v244 offset:7168
    s_waitcnt lgkmcnt(4)
    ds_read_b128 v[32:35], v244 offset:8192
    ds_read_b128 v[36:39], v244 offset:9216
    ds_read_b128 v[40:43], v244 offset:10240
    ds_read_b128 v[44:47], v244 offset:11264
    ds_read_b128 v[48:51], v244 offset:12288
    ds_read_b128 v[52:55], v244 offset:13312
    ds_read_b128 v[56:59], v244 offset:14336
    ds_read_b128 v[60:63], v244 offset:15360
    v_xor_b32 v243, 0x4000, v243
    v_xor_b32 v244, 0x4000, v244
    s_waitcnt lgkmcnt(0)
    v_mfma_f32_16x16x32_bf16 v[172:175], a[0:3], v[0:3], 0
    v_mfma_f32_16x16x32_bf16 v[176:179], a[4:7], v[0:3], 0
    v_mfma_f32_16x16x32_bf16 v[180:183], a[8:11], v[0:3], 0
    v_mfma_f32_16x16x32_bf16 v[184:187], a[12:15], v[0:3], 0
    v_mfma_f32_16x16x32_bf16 v[188:191], a[16:19], v[0:3], 0
    v_mfma_f32_16x16x32_bf16 v[192:195], a[20:23], v[0:3], 0
    v_mfma_f32_16x16x32_bf16 v[196:199], a[24:27], v[0:3], 0
    v_mfma_f32_16x16x32_bf16 v[200:203], a[28:31], v[0:3], 0
    v_mfma_f32_16x16x32_bf16 v[172:175], a[32:35], v[4:7], v[172:175]
    v_mfma_f32_16x16x32_bf16 v[176:179], a[36:39], v[4:7], v[176:179]
    v_mfma_f32_16x16x32_bf16 v[180:183], a[40:43], v[4:7], v[180:183]
    v_mfma_f32_16x16x32_bf16 v[184:187], a[44:47], v[4:7], v[184:187]
    v_mfma_f32_16x16x32_bf16 v[188:191], a[48:51], v[4:7], v[188:191]
    v_mfma_f32_16x16x32_bf16 v[192:195], a[52:55], v[4:7], v[192:195]
    v_mfma_f32_16x16x32_bf16 v[196:199], a[56:59], v[4:7], v[196:199]
    v_mfma_f32_16x16x32_bf16 v[200:203], a[60:63], v[4:7], v[200:203]
    v_mfma_f32_16x16x32_bf16 v[172:175], a[64:67], v[8:11], v[172:175]
    v_mfma_f32_16x16x32_bf16 v[176:179], a[68:71], v[8:11], v[176:179]
    v_mfma_f32_16x16x32_bf16 v[180:183], a[72:75], v[8:11], v[180:183]
    v_mfma_f32_16x16x32_bf16 v[184:187], a[76:79], v[8:11], v[184:187]
    v_mfma_f32_16x16x32_bf16 v[188:191], a[80:83], v[8:11], v[188:191]
    v_mfma_f32_16x16x32_bf16 v[192:195], a[84:87], v[8:11], v[192:195]
    v_mfma_f32_16x16x32_bf16 v[196:199], a[88:91], v[8:11], v[196:199]
    v_mfma_f32_16x16x32_bf16 v[200:203], a[92:95], v[8:11], v[200:203]
    v_mfma_f32_16x16x32_bf16 v[172:175], a[96:99], v[12:15], v[172:175]
    v_mfma_f32_16x16x32_bf16 v[176:179], a[100:103], v[12:15], v[176:179]
    v_mfma_f32_16x16x32_bf16 v[180:183], a[104:107], v[12:15], v[180:183]
    v_mfma_f32_16x16x32_bf16 v[184:187], a[108:111], v[12:15], v[184:187]
    v_mfma_f32_16x16x32_bf16 v[188:191], a[112:115], v[12:15], v[188:191]
    v_mfma_f32_16x16x32_bf16 v[192:195], a[116:119], v[12:15], v[192:195]
    v_mfma_f32_16x16x32_bf16 v[196:199], a[120:123], v[12:15], v[196:199]
    v_mfma_f32_16x16x32_bf16 v[200:203], a[124:127], v[12:15], v[200:203]
    v_mfma_f32_16x16x32_bf16 v[172:175], a[128:131], v[32:35], v[172:175]
    v_mfma_f32_16x16x32_bf16 v[176:179], a[132:135], v[32:35], v[176:179]
    v_mfma_f32_16x16x32_bf16 v[180:183], a[136:139], v[32:35], v[180:183]
    v_mfma_f32_16x16x32_bf16 v[184:187], a[140:143], v[32:35], v[184:187]
    v_mfma_f32_16x16x32_bf16 v[188:191], a[144:147], v[32:35], v[188:191]
    v_mfma_f32_16x16x32_bf16 v[192:195], a[148:151], v[32:35], v[192:195]
    v_mfma_f32_16x16x32_bf16 v[196:199], a[152:155], v[32:35], v[196:199]
    v_mfma_f32_16x16x32_bf16 v[200:203], a[156:159], v[32:35], v[200:203]
    v_mfma_f32_16x16x32_bf16 v[172:175], a[160:163], v[36:39], v[172:175]
    v_mfma_f32_16x16x32_bf16 v[176:179], a[164:167], v[36:39], v[176:179]
    v_mfma_f32_16x16x32_bf16 v[180:183], a[168:171], v[36:39], v[180:183]
    v_mfma_f32_16x16x32_bf16 v[184:187], a[172:175], v[36:39], v[184:187]
    v_mfma_f32_16x16x32_bf16 v[188:191], a[176:179], v[36:39], v[188:191]
    v_mfma_f32_16x16x32_bf16 v[192:195], a[180:183], v[36:39], v[192:195]
    v_mfma_f32_16x16x32_bf16 v[196:199], a[184:187], v[36:39], v[196:199]
    v_mfma_f32_16x16x32_bf16 v[200:203], a[188:191], v[36:39], v[200:203]
    v_mfma_f32_16x16x32_bf16 v[172:175], a[192:195], v[40:43], v[172:175]
    v_mfma_f32_16x16x32_bf16 v[176:179], a[196:199], v[40:43], v[176:179]
    v_mfma_f32_16x16x32_bf16 v[180:183], a[200:203], v[40:43], v[180:183]
    v_mfma_f32_16x16x32_bf16 v[184:187], a[204:207], v[40:43], v[184:187]
    v_mfma_f32_16x16x32_bf16 v[188:191], a[208:211], v[40:43], v[188:191]
    v_mfma_f32_16x16x32_bf16 v[192:195], a[212:215], v[40:43], v[192:195]
    v_mfma_f32_16x16x32_bf16 v[196:199], a[216:219], v[40:43], v[196:199]
    v_mfma_f32_16x16x32_bf16 v[200:203], a[220:223], v[40:43], v[200:203]
    v_mfma_f32_16x16x32_bf16 v[172:175], a[224:227], v[44:47], v[172:175]
    v_mfma_f32_16x16x32_bf16 v[176:179], a[228:231], v[44:47], v[176:179]
    v_mfma_f32_16x16x32_bf16 v[180:183], a[232:235], v[44:47], v[180:183]
    v_mfma_f32_16x16x32_bf16 v[184:187], a[236:239], v[44:47], v[184:187]
    v_mfma_f32_16x16x32_bf16 v[188:191], a[240:243], v[44:47], v[188:191]
    v_mfma_f32_16x16x32_bf16 v[192:195], a[244:247], v[44:47], v[192:195]
    v_mfma_f32_16x16x32_bf16 v[196:199], a[248:251], v[44:47], v[196:199]
    v_mfma_f32_16x16x32_bf16 v[200:203], a[252:255], v[44:47], v[200:203]
    v_mfma_f32_16x16x32_bf16 v[204:207], a[0:3], v[16:19], 0
    v_mfma_f32_16x16x32_bf16 v[208:211], a[4:7], v[16:19], 0
    v_mfma_f32_16x16x32_bf16 v[212:215], a[8:11], v[16:19], 0
    v_mfma_f32_16x16x32_bf16 v[216:219], a[12:15], v[16:19], 0
    v_mfma_f32_16x16x32_bf16 v[220:223], a[16:19], v[16:19], 0
    v_mfma_f32_16x16x32_bf16 v[224:227], a[20:23], v[16:19], 0
    v_mfma_f32_16x16x32_bf16 v[228:231], a[24:27], v[16:19], 0
    v_mfma_f32_16x16x32_bf16 v[232:235], a[28:31], v[16:19], 0
    v_cvt_pk_bf16_f32 v140, v172, v173
    v_cvt_pk_bf16_f32 v141, v174, v175
    v_cvt_pk_bf16_f32 v142, v176, v177
    v_cvt_pk_bf16_f32 v143, v178, v179
    s_add_u32 s24, s51, 0
    buffer_store_dwordx4 v[140:143], v242, s[8:11], s24 offen sc1
    v_mfma_f32_16x16x32_bf16 v[204:207], a[32:35], v[20:23], v[204:207]
    v_mfma_f32_16x16x32_bf16 v[208:211], a[36:39], v[20:23], v[208:211]
    v_mfma_f32_16x16x32_bf16 v[212:215], a[40:43], v[20:23], v[212:215]
    v_mfma_f32_16x16x32_bf16 v[216:219], a[44:47], v[20:23], v[216:219]
    v_mfma_f32_16x16x32_bf16 v[220:223], a[48:51], v[20:23], v[220:223]
    v_mfma_f32_16x16x32_bf16 v[224:227], a[52:55], v[20:23], v[224:227]
    v_mfma_f32_16x16x32_bf16 v[228:231], a[56:59], v[20:23], v[228:231]
    v_mfma_f32_16x16x32_bf16 v[232:235], a[60:63], v[20:23], v[232:235]
    v_cvt_pk_bf16_f32 v144, v180, v181
    v_cvt_pk_bf16_f32 v145, v182, v183
    v_cvt_pk_bf16_f32 v146, v184, v185
    v_cvt_pk_bf16_f32 v147, v186, v187
    buffer_store_dwordx4 v[144:147], v242, s[8:11], s24 offen offset:64 sc1
    v_mfma_f32_16x16x32_bf16 v[204:207], a[64:67], v[24:27], v[204:207]
    v_mfma_f32_16x16x32_bf16 v[208:211], a[68:71], v[24:27], v[208:211]
    v_mfma_f32_16x16x32_bf16 v[212:215], a[72:75], v[24:27], v[212:215]
    v_mfma_f32_16x16x32_bf16 v[216:219], a[76:79], v[24:27], v[216:219]
    v_mfma_f32_16x16x32_bf16 v[220:223], a[80:83], v[24:27], v[220:223]
    v_mfma_f32_16x16x32_bf16 v[224:227], a[84:87], v[24:27], v[224:227]
    v_mfma_f32_16x16x32_bf16 v[228:231], a[88:91], v[24:27], v[228:231]
    v_mfma_f32_16x16x32_bf16 v[232:235], a[92:95], v[24:27], v[232:235]
    v_cvt_pk_bf16_f32 v148, v188, v189
    v_cvt_pk_bf16_f32 v149, v190, v191
    v_cvt_pk_bf16_f32 v150, v192, v193
    v_cvt_pk_bf16_f32 v151, v194, v195
    buffer_store_dwordx4 v[148:151], v242, s[8:11], s24 offen offset:128 sc1
    v_mfma_f32_16x16x32_bf16 v[204:207], a[96:99], v[28:31], v[204:207]
    v_mfma_f32_16x16x32_bf16 v[208:211], a[100:103], v[28:31], v[208:211]
    v_mfma_f32_16x16x32_bf16 v[212:215], a[104:107], v[28:31], v[212:215]
    v_mfma_f32_16x16x32_bf16 v[216:219], a[108:111], v[28:31], v[216:219]
    v_mfma_f32_16x16x32_bf16 v[220:223], a[112:115], v[28:31], v[220:223]
    v_mfma_f32_16x16x32_bf16 v[224:227], a[116:119], v[28:31], v[224:227]
    v_mfma_f32_16x16x32_bf16 v[228:231], a[120:123], v[28:31], v[228:231]
    v_mfma_f32_16x16x32_bf16 v[232:235], a[124:127], v[28:31], v[232:235]
    v_cvt_pk_bf16_f32 v152, v196, v197
    v_cvt_pk_bf16_f32 v153, v198, v199
    v_cvt_pk_bf16_f32 v154, v200, v201
    v_cvt_pk_bf16_f32 v155, v202, v203
    buffer_store_dwordx4 v[152:155], v242, s[8:11], s24 offen offset:192 sc1
    v_mfma_f32_16x16x32_bf16 v[204:207], a[128:131], v[48:51], v[204:207]
    v_mfma_f32_16x16x32_bf16 v[208:211], a[132:135], v[48:51], v[208:211]
    v_mfma_f32_16x16x32_bf16 v[212:215], a[136:139], v[48:51], v[212:215]
    v_mfma_f32_16x16x32_bf16 v[216:219], a[140:143], v[48:51], v[216:219]
    v_mfma_f32_16x16x32_bf16 v[220:223], a[144:147], v[48:51], v[220:223]
    v_mfma_f32_16x16x32_bf16 v[224:227], a[148:151], v[48:51], v[224:227]
    v_mfma_f32_16x16x32_bf16 v[228:231], a[152:155], v[48:51], v[228:231]
    v_mfma_f32_16x16x32_bf16 v[232:235], a[156:159], v[48:51], v[232:235]
    v_mfma_f32_16x16x32_bf16 v[204:207], a[160:163], v[52:55], v[204:207]
    v_mfma_f32_16x16x32_bf16 v[208:211], a[164:167], v[52:55], v[208:211]
    v_mfma_f32_16x16x32_bf16 v[212:215], a[168:171], v[52:55], v[212:215]
    v_mfma_f32_16x16x32_bf16 v[216:219], a[172:175], v[52:55], v[216:219]
    v_mfma_f32_16x16x32_bf16 v[220:223], a[176:179], v[52:55], v[220:223]
    v_mfma_f32_16x16x32_bf16 v[224:227], a[180:183], v[52:55], v[224:227]
    v_mfma_f32_16x16x32_bf16 v[228:231], a[184:187], v[52:55], v[228:231]
    v_mfma_f32_16x16x32_bf16 v[232:235], a[188:191], v[52:55], v[232:235]
    v_mfma_f32_16x16x32_bf16 v[204:207], a[192:195], v[56:59], v[204:207]
    v_mfma_f32_16x16x32_bf16 v[208:211], a[196:199], v[56:59], v[208:211]
    v_mfma_f32_16x16x32_bf16 v[212:215], a[200:203], v[56:59], v[212:215]
    v_mfma_f32_16x16x32_bf16 v[216:219], a[204:207], v[56:59], v[216:219]
    v_mfma_f32_16x16x32_bf16 v[220:223], a[208:211], v[56:59], v[220:223]
    v_mfma_f32_16x16x32_bf16 v[224:227], a[212:215], v[56:59], v[224:227]
    v_mfma_f32_16x16x32_bf16 v[228:231], a[216:219], v[56:59], v[228:231]
    v_mfma_f32_16x16x32_bf16 v[232:235], a[220:223], v[56:59], v[232:235]
    v_mfma_f32_16x16x32_bf16 v[204:207], a[224:227], v[60:63], v[204:207]
    v_mfma_f32_16x16x32_bf16 v[208:211], a[228:231], v[60:63], v[208:211]
    v_mfma_f32_16x16x32_bf16 v[212:215], a[232:235], v[60:63], v[212:215]
    v_mfma_f32_16x16x32_bf16 v[216:219], a[236:239], v[60:63], v[216:219]
    v_mfma_f32_16x16x32_bf16 v[220:223], a[240:243], v[60:63], v[220:223]
    v_mfma_f32_16x16x32_bf16 v[224:227], a[244:247], v[60:63], v[224:227]
    v_mfma_f32_16x16x32_bf16 v[228:231], a[248:251], v[60:63], v[228:231]
    v_mfma_f32_16x16x32_bf16 v[232:235], a[252:255], v[60:63], v[232:235]
    v_cvt_pk_bf16_f32 v140, v204, v205
    v_cvt_pk_bf16_f32 v141, v206, v207
    v_cvt_pk_bf16_f32 v142, v208, v209
    v_cvt_pk_bf16_f32 v143, v210, v211
    s_add_u32 s24, s51, 16384
    buffer_store_dwordx4 v[140:143], v242, s[8:11], s24 offen sc1
    v_cvt_pk_bf16_f32 v144, v212, v213
    v_cvt_pk_bf16_f32 v145, v214, v215
    v_cvt_pk_bf16_f32 v146, v216, v217
    v_cvt_pk_bf16_f32 v147, v218, v219
    buffer_store_dwordx4 v[144:147], v242, s[8:11], s24 offen offset:64 sc1
    v_cvt_pk_bf16_f32 v148, v220, v221
    v_cvt_pk_bf16_f32 v149, v222, v223
    v_cvt_pk_bf16_f32 v150, v224, v225
    v_cvt_pk_bf16_f32 v151, v226, v227
    buffer_store_dwordx4 v[148:151], v242, s[8:11], s24 offen offset:128 sc1
    v_cvt_pk_bf16_f32 v152, v228, v229
    v_cvt_pk_bf16_f32 v153, v230, v231
    v_cvt_pk_bf16_f32 v154, v232, v233
    v_cvt_pk_bf16_f32 v155, v234, v235
    buffer_store_dwordx4 v[152:155], v242, s[8:11], s24 offen offset:192 sc1
    s_waitcnt vmcnt(0)
    s_barrier
    s_lshl_b32 s25, s22, 6
    s_add_u32 s25, s25, 0x4000
    s_lshl_b32 s24, s20, 2
    s_add_u32 s24, s24, s25
    s_cmp_lg_u32 s100, 0
    s_cbranch_scc1 L_flag_122
    v_mov_b32 v246, 1
    s_mov_b64 exec, 1
    buffer_store_dword v246, off, s[8:11], s24 sc1
    s_mov_b64 exec, -1
L_flag_122:
    v_lshrrev_b32 v246, 2, v240
    s_cmp_lg_u32 s100, 0
    s_cbranch_scc1 L_polls_125
    s_mov_b32 exec_lo, 0xffff
    s_mov_b32 exec_hi, 0
    s_mov_b32 s96, 0
L_poll_123:
    buffer_load_dword v247, v246, s[8:11], s25 offen sc1
    s_waitcnt vmcnt(0)
    v_cmp_gt_u32 vcc, 1, v247
    s_cbranch_vccz L_polld_124
    s_sleep 2
    s_add_u32 s96, s96, 1
    s_cmp_lt_u32 s96, 0x10000
    s_cbranch_scc1 L_poll_123
L_polld_124:
    s_mov_b64 exec, -1
L_polls_125:
    s_barrier
    s_cmp_ge_u32 s100, 2
    s_cbranch_scc1 L_nofin_126
    s_lshl_b32 s60, s22, 5
    s_lshl_b32 s24, s20, 1
    s_add_u32 s60, s60, s24
    s_add_u32 s60, s60, s100
    s_lshr_b32 s62, s60, 5
    s_lshl_b32 s62, s62, 19
    s_and_b32 s63, s60, 31
    s_lshl_b32 s63, s63, 10
    s_add_u32 s62, s62, s63
    s_add_u32 s62, s62, 0x4000000
    s_lshl_b32 s64, s60, 10
    buffer_load_dwordx2 v[64:65], v252, s[12:15], s64 offen
    buffer_load_dwordx2 v[66:67], v252, s[12:15], s64 offen offset:32
    buffer_load_dwordx4 v[0:3], v240, s[8:11], s62 offen
    s_add_u32 s62, s62, 32768
    buffer_load_dwordx4 v[4:7], v240, s[8:11], s62 offen
    s_add_u32 s62, s62, 32768
    buffer_load_dwordx4 v[8:11], v240, s[8:11], s62 offen
    s_add_u32 s62, s62, 32768
    buffer_load_dwordx4 v[12:15], v240, s[8:11], s62 offen
    s_add_u32 s62, s62, 32768
    buffer_load_dwordx4 v[16:19], v240, s[8:11], s62 offen
    s_add_u32 s62, s62, 32768
    buffer_load_dwordx4 v[20:23], v240, s[8:11], s62 offen
    s_add_u32 s62, s62, 32768
    buffer_load_dwordx4 v[24:27], v240, s[8:11], s62 offen
    s_add_u32 s62, s62, 32768
    buffer_load_dwordx4 v[28:31], v240, s[8:11], s62 offen
    s_add_u32 s62, s62, 32768
    buffer_load_dwordx4 v[32:35], v240, s[8:11], s62 offen
    s_add_u32 s62, s62, 32768
    buffer_load_dwordx4 v[36:39], v240, s[8:11], s62 offen
    s_add_u32 s62, s62, 32768
    buffer_load_dwordx4 v[40:43], v240, s[8:11], s62 offen
    s_add_u32 s62, s62, 32768
    buffer_load_dwordx4 v[44:47], v240, s[8:11], s62 offen
    s_add_u32 s62, s62, 32768
    buffer_load_dwordx4 v[48:51], v240, s[8:11], s62 offen
    s_add_u32 s62, s62, 32768
    buffer_load_dwordx4 v[52:55], v240, s[8:11], s62 offen
    s_add_u32 s62, s62, 32768
    buffer_load_dwordx4 v[56:59], v240, s[8:11], s62 offen
    s_add_u32 s62, s62, 32768
    buffer_load_dwordx4 v[60:63], v240, s[8:11], s62 offen
    v_mov_b32 v68, 0
    v_mov_b32 v69, 0
    v_mov_b32 v70, 0
    v_mov_b32 v71, 0
    v_mov_b32 v72, 0
    v_mov_b32 v73, 0
    v_mov_b32 v74, 0
    v_mov_b32 v75, 0
    s_waitcnt vmcnt(15)
    v_dot2_f32_bf16 v68, v0, s65, v68
    v_dot2_f32_bf16 v69, v0, s66, v69
    v_dot2_f32_bf16 v70, v1, s65, v70
    v_dot2_f32_bf16 v71, v1, s66, v71
    v_dot2_f32_bf16 v72, v2, s65, v72
    v_dot2_f32_bf16 v73, v2, s66, v73
    v_dot2_f32_bf16 v74, v3, s65, v74
    v_dot2_f32_bf16 v75, v3, s66, v75
    s_waitcnt vmcnt(14)
    v_dot2_f32_bf16 v68, v4, s65, v68
    v_dot2_f32_bf16 v69, v4, s66, v69
    v_dot2_f32_bf16 v70, v5, s65, v70
    v_dot2_f32_bf16 v71, v5, s66, v71
    v_dot2_f32_bf16 v72, v6, s65, v72
    v_dot2_f32_bf16 v73, v6, s66, v73
    v_dot2_f32_bf16 v74, v7, s65, v74
    v_dot2_f32_bf16 v75, v7, s66, v75
    s_waitcnt vmcnt(13)
    v_dot2_f32_bf16 v68, v8, s65, v68
    v_dot2_f32_bf16 v69, v8, s66, v69
    v_dot2_f32_bf16 v70, v9, s65, v70
    v_dot2_f32_bf16 v71, v9, s66, v71
    v_dot2_f32_bf16 v72, v10, s65, v72
    v_dot2_f32_bf16 v73, v10, s66, v73
    v_dot2_f32_bf16 v74, v11, s65, v74
    v_dot2_f32_bf16 v75, v11, s66, v75
    s_waitcnt vmcnt(12)
    v_dot2_f32_bf16 v68, v12, s65, v68
    v_dot2_f32_bf16 v69, v12, s66, v69
    v_dot2_f32_bf16 v70, v13, s65, v70
    v_dot2_f32_bf16 v71, v13, s66, v71
    v_dot2_f32_bf16 v72, v14, s65, v72
    v_dot2_f32_bf16 v73, v14, s66, v73
    v_dot2_f32_bf16 v74, v15, s65, v74
    v_dot2_f32_bf16 v75, v15, s66, v75
    s_waitcnt vmcnt(11)
    v_dot2_f32_bf16 v68, v16, s65, v68
    v_dot2_f32_bf16 v69, v16, s66, v69
    v_dot2_f32_bf16 v70, v17, s65, v70
    v_dot2_f32_bf16 v71, v17, s66, v71
    v_dot2_f32_bf16 v72, v18, s65, v72
    v_dot2_f32_bf16 v73, v18, s66, v73
    v_dot2_f32_bf16 v74, v19, s65, v74
    v_dot2_f32_bf16 v75, v19, s66, v75
    s_waitcnt vmcnt(10)
    v_dot2_f32_bf16 v68, v20, s65, v68
    v_dot2_f32_bf16 v69, v20, s66, v69
    v_dot2_f32_bf16 v70, v21, s65, v70
    v_dot2_f32_bf16 v71, v21, s66, v71
    v_dot2_f32_bf16 v72, v22, s65, v72
    v_dot2_f32_bf16 v73, v22, s66, v73
    v_dot2_f32_bf16 v74, v23, s65, v74
    v_dot2_f32_bf16 v75, v23, s66, v75
    s_waitcnt vmcnt(9)
    v_dot2_f32_bf16 v68, v24, s65, v68
    v_dot2_f32_bf16 v69, v24, s66, v69
    v_dot2_f32_bf16 v70, v25, s65, v70
    v_dot2_f32_bf16 v71, v25, s66, v71
    v_dot2_f32_bf16 v72, v26, s65, v72
    v_dot2_f32_bf16 v73, v26, s66, v73
    v_dot2_f32_bf16 v74, v27, s65, v74
    v_dot2_f32_bf16 v75, v27, s66, v75
    s_waitcnt vmcnt(8)
    v_dot2_f32_bf16 v68, v28, s65, v68
    v_dot2_f32_bf16 v69, v28, s66, v69
    v_dot2_f32_bf16 v70, v29, s65, v70
    v_dot2_f32_bf16 v71, v29, s66, v71
    v_dot2_f32_bf16 v72, v30, s65, v72
    v_dot2_f32_bf16 v73, v30, s66, v73
    v_dot2_f32_bf16 v74, v31, s65, v74
    v_dot2_f32_bf16 v75, v31, s66, v75
    s_waitcnt vmcnt(7)
    v_dot2_f32_bf16 v68, v32, s65, v68
    v_dot2_f32_bf16 v69, v32, s66, v69
    v_dot2_f32_bf16 v70, v33, s65, v70
    v_dot2_f32_bf16 v71, v33, s66, v71
    v_dot2_f32_bf16 v72, v34, s65, v72
    v_dot2_f32_bf16 v73, v34, s66, v73
    v_dot2_f32_bf16 v74, v35, s65, v74
    v_dot2_f32_bf16 v75, v35, s66, v75
    s_waitcnt vmcnt(6)
    v_dot2_f32_bf16 v68, v36, s65, v68
    v_dot2_f32_bf16 v69, v36, s66, v69
    v_dot2_f32_bf16 v70, v37, s65, v70
    v_dot2_f32_bf16 v71, v37, s66, v71
    v_dot2_f32_bf16 v72, v38, s65, v72
    v_dot2_f32_bf16 v73, v38, s66, v73
    v_dot2_f32_bf16 v74, v39, s65, v74
    v_dot2_f32_bf16 v75, v39, s66, v75
    s_waitcnt vmcnt(5)
    v_dot2_f32_bf16 v68, v40, s65, v68
    v_dot2_f32_bf16 v69, v40, s66, v69
    v_dot2_f32_bf16 v70, v41, s65, v70
    v_dot2_f32_bf16 v71, v41, s66, v71
    v_dot2_f32_bf16 v72, v42, s65, v72
    v_dot2_f32_bf16 v73, v42, s66, v73
    v_dot2_f32_bf16 v74, v43, s65, v74
    v_dot2_f32_bf16 v75, v43, s66, v75
    s_waitcnt vmcnt(4)
    v_dot2_f32_bf16 v68, v44, s65, v68
    v_dot2_f32_bf16 v69, v44, s66, v69
    v_dot2_f32_bf16 v70, v45, s65, v70
    v_dot2_f32_bf16 v71, v45, s66, v71
    v_dot2_f32_bf16 v72, v46, s65, v72
    v_dot2_f32_bf16 v73, v46, s66, v73
    v_dot2_f32_bf16 v74, v47, s65, v74
    v_dot2_f32_bf16 v75, v47, s66, v75
    s_waitcnt vmcnt(3)
    v_dot2_f32_bf16 v68, v48, s65, v68
    v_dot2_f32_bf16 v69, v48, s66, v69
    v_dot2_f32_bf16 v70, v49, s65, v70
    v_dot2_f32_bf16 v71, v49, s66, v71
    v_dot2_f32_bf16 v72, v50, s65, v72
    v_dot2_f32_bf16 v73, v50, s66, v73
    v_dot2_f32_bf16 v74, v51, s65, v74
    v_dot2_f32_bf16 v75, v51, s66, v75
    s_waitcnt vmcnt(2)
    v_dot2_f32_bf16 v68, v52, s65, v68
    v_dot2_f32_bf16 v69, v52, s66, v69
    v_dot2_f32_bf16 v70, v53, s65, v70
    v_dot2_f32_bf16 v71, v53, s66, v71
    v_dot2_f32_bf16 v72, v54, s65, v72
    v_dot2_f32_bf16 v73, v54, s66, v73
    v_dot2_f32_bf16 v74, v55, s65, v74
    v_dot2_f32_bf16 v75, v55, s66, v75
    s_waitcnt vmcnt(1)
    v_dot2_f32_bf16 v68, v56, s65, v68
    v_dot2_f32_bf16 v69, v56, s66, v69
    v_dot2_f32_bf16 v70, v57, s65, v70
    v_dot2_f32_bf16 v71, v57, s66, v71
    v_dot2_f32_bf16 v72, v58, s65, v72
    v_dot2_f32_bf16 v73, v58, s66, v73
    v_dot2_f32_bf16 v74, v59, s65, v74
    v_dot2_f32_bf16 v75, v59, s66, v75
    s_waitcnt vmcnt(0)
    v_dot2_f32_bf16 v68, v60, s65, v68
    v_dot2_f32_bf16 v69, v60, s66, v69
    v_dot2_f32_bf16 v70, v61, s65, v70
    v_dot2_f32_bf16 v71, v61, s66, v71
    v_dot2_f32_bf16 v72, v62, s65, v72
    v_dot2_f32_bf16 v73, v62, s66, v73
    v_dot2_f32_bf16 v74, v63, s65, v74
    v_dot2_f32_bf16 v75, v63, s66, v75
    v_cvt_pk_bf16_f32 v0, v68, v69
    v_cvt_pk_bf16_f32 v1, v70, v71
    v_cvt_pk_bf16_f32 v2, v72, v73
    v_cvt_pk_bf16_f32 v3, v74, v75
    v_lshlrev_b32 v68, 16, v0
    v_and_b32 v69, 0xffff0000, v0
    v_lshlrev_b32 v76, 16, v64
    v_and_b32 v77, 0xffff0000, v64
    v_lshlrev_b32 v70, 16, v1
    v_and_b32 v71, 0xffff0000, v1
    v_lshlrev_b32 v78, 16, v65
    v_and_b32 v79, 0xffff0000, v65
    v_lshlrev_b32 v72, 16, v2
    v_and_b32 v73, 0xffff0000, v2
    v_lshlrev_b32 v80, 16, v66
    v_and_b32 v81, 0xffff0000, v66
    v_lshlrev_b32 v74, 16, v3
    v_and_b32 v75, 0xffff0000, v3
    v_lshlrev_b32 v82, 16, v67
    v_and_b32 v83, 0xffff0000, v67
    v_pk_add_f32 v[68:69], v[68:69], v[76:77]
    v_pk_add_f32 v[70:71], v[70:71], v[78:79]
    v_pk_add_f32 v[72:73], v[72:73], v[80:81]
    v_pk_add_f32 v[74:75], v[74:75], v[82:83]
    v_cvt_pk_bf16_f32 v4, v68, v69
    v_cvt_pk_bf16_f32 v5, v70, v71
    v_cvt_pk_bf16_f32 v6, v72, v73
    v_cvt_pk_bf16_f32 v7, v74, v75
    v_lshlrev_b32 v68, 16, v4
    v_and_b32 v69, 0xffff0000, v4
    v_lshlrev_b32 v70, 16, v5
    v_and_b32 v71, 0xffff0000, v5
    v_lshlrev_b32 v72, 16, v6
    v_and_b32 v73, 0xffff0000, v6
    v_lshlrev_b32 v74, 16, v7
    v_and_b32 v75, 0xffff0000, v7
    s_add_u32 s62, s64, 0x6000000
    buffer_store_dwordx2 v[4:5], v252, s[8:11], s62 offen sc1
    buffer_store_dwordx2 v[6:7], v252, s[8:11], s62 offen offset:32 sc1
    v_add_f32 v84, v68, v69
    v_add_f32 v84, v84, v70
    v_add_f32 v84, v84, v71
    v_add_f32 v84, v84, v72
    v_add_f32 v84, v84, v73
    v_add_f32 v84, v84, v74
    v_add_f32 v84, v84, v75
    s_nop 1
    v_add_f32_dpp v84, v84, v84 row_ror:1 row_mask:0xf bank_mask:0xf
    s_nop 1
    v_add_f32_dpp v84, v84, v84 row_ror:2 row_mask:0xf bank_mask:0xf
    s_nop 1
    v_add_f32_dpp v84, v84, v84 row_ror:4 row_mask:0xf bank_mask:0xf
    s_nop 1
    v_add_f32_dpp v84, v84, v84 row_ror:8 row_mask:0xf bank_mask:0xf
    v_mov_b32 v85, v84
    s_nop 1
    v_permlane32_swap_b32 v85, v84
    v_add_f32 v84, v85, v84
    v_mov_b32 v85, v84
    s_nop 1
    v_permlane16_swap_b32 v85, v84
    v_add_f32 v84, v85, v84
    v_mul_f32 v84, 0x3b000000, v84
    v_cvt_pk_bf16_f32 v86, v84, v84
    v_and_b32 v86, 0xffff0000, v86
    v_sub_f32 v87, v84, v86
    v_sub_f32 v76, v68, v86
    v_sub_f32 v77, v69, v86
    v_sub_f32 v78, v70, v86
    v_sub_f32 v79, v71, v86
    v_sub_f32 v80, v72, v86
    v_sub_f32 v81, v73, v86
    v_sub_f32 v82, v74, v86
    v_sub_f32 v83, v75, v86
    v_mul_f32 v100, v76, v76
    v_fmac_f32 v100, v77, v77
    v_fmac_f32 v100, v78, v78
    v_fmac_f32 v100, v79, v79
    v_fmac_f32 v100, v80, v80
    v_fmac_f32 v100, v81, v81
    v_fmac_f32 v100, v82, v82
    v_fmac_f32 v100, v83, v83
    s_nop 1
    v_add_f32_dpp v100, v100, v100 row_ror:1 row_mask:0xf bank_mask:0xf
    s_nop 1
    v_add_f32_dpp v100, v100, v100 row_ror:2 row_mask:0xf bank_mask:0xf
    s_nop 1
    v_add_f32_dpp v100, v100, v100 row_ror:4 row_mask:0xf bank_mask:0xf
    s_nop 1
    v_add_f32_dpp v100, v100, v100 row_ror:8 row_mask:0xf bank_mask:0xf
    v_mov_b32 v85, v100
    s_nop 1
    v_permlane32_swap_b32 v85, v100
    v_add_f32 v100, v85, v100
    v_mov_b32 v85, v100
    s_nop 1
    v_permlane16_swap_b32 v85, v100
    v_add_f32 v100, v85, v100
    v_mul_f32 v85, v87, v87
    v_mul_f32 v100, 0x3b000000, v100
    v_sub_f32 v100, v100, v85
    v_max_f32 v100, 0, v100
    v_cvt_pk_bf16_f32 v100, v100, v100
    v_and_b32 v100, 0xffff0000, v100
    v_add_f32 v100, 0x3727c5ac, v100
    v_cvt_pk_bf16_f32 v100, v100, v100
    v_and_b32 v100, 0xffff0000, v100
    v_sqrt_f32 v100, v100
    s_nop 0
    v_cvt_pk_bf16_f32 v100, v100, v100
    v_and_b32 v100, 0xffff0000, v100
    v_rcp_f32 v100, v100
    v_cvt_pk_bf16_f32 v8, v76, v77
    v_cvt_pk_bf16_f32 v9, v78, v79
    v_cvt_pk_bf16_f32 v10, v80, v81
    v_cvt_pk_bf16_f32 v11, v82, v83
    v_lshlrev_b32 v76, 16, v8
    v_and_b32 v77, 0xffff0000, v8
    v_lshlrev_b32 v78, 16, v9
    v_and_b32 v79, 0xffff0000, v9
    v_lshlrev_b32 v80, 16, v10
    v_and_b32 v81, 0xffff0000, v10
    v_lshlrev_b32 v82, 16, v11
    v_and_b32 v83, 0xffff0000, v11
    v_mul_f32 v76, v100, v76
    v_mul_f32 v77, v100, v77
    v_mul_f32 v78, v100, v78
    v_mul_f32 v79, v100, v79
    v_mul_f32 v80, v100, v80
    v_mul_f32 v81, v100, v81
    v_mul_f32 v82, v100, v82
    v_mul_f32 v83, v100, v83
    v_cvt_pk_bf16_f32 v8, v76, v77
    v_cvt_pk_bf16_f32 v9, v78, v79
    v_cvt_pk_bf16_f32 v10, v80, v81
    v_cvt_pk_bf16_f32 v11, v82, v83
    v_lshlrev_b32 v76, 16, v8
    v_and_b32 v77, 0xffff0000, v8
    v_lshlrev_b32 v78, 16, v9
    v_and_b32 v79, 0xffff0000, v9
    v_lshlrev_b32 v80, 16, v10
    v_and_b32 v81, 0xffff0000, v10
    v_lshlrev_b32 v82, 16, v11
    v_and_b32 v83, 0xffff0000, v11
    s_add_u32 s62, s64, 0x6200000
    buffer_store_dwordx2 v[8:9], v252, s[8:11], s62 offen sc1
    buffer_store_dwordx2 v[10:11], v252, s[8:11], s62 offen offset:32 sc1
    v_pk_add_f32 v[68:69], v[68:69], v[76:77]
    v_pk_add_f32 v[70:71], v[70:71], v[78:79]
    v_pk_add_f32 v[72:73], v[72:73], v[80:81]
    v_pk_add_f32 v[74:75], v[74:75], v[82:83]
    v_cvt_pk_bf16_f32 v12, v68, v69
    v_cvt_pk_bf16_f32 v13, v70, v71
    v_cvt_pk_bf16_f32 v14, v72, v73
    v_cvt_pk_bf16_f32 v15, v74, v75
    buffer_store_dwordx2 v[12:13], v252, s[16:19], s64 offen sc1
    buffer_store_dwordx2 v[14:15], v252, s[16:19], s64 offen offset:32 sc1
    v_lshlrev_b32 v88, 16, v236
    v_and_b32 v89, 0xffff0000, v236
    v_lshlrev_b32 v90, 16, v237
    v_and_b32 v91, 0xffff0000, v237
    v_lshlrev_b32 v92, 16, v238
    v_and_b32 v93, 0xffff0000, v238
    v_lshlrev_b32 v94, 16, v239
    v_and_b32 v95, 0xffff0000, v239
    v_mul_f32 v84, v76, v88
    v_fmac_f32 v84, v77, v89
    v_fmac_f32 v84, v78, v90
    v_fmac_f32 v84, v79, v91
    v_fmac_f32 v84, v80, v92
    v_fmac_f32 v84, v81, v93
    v_fmac_f32 v84, v82, v94
    v_fmac_f32 v84, v83, v95
    s_nop 1
    v_add_f32_dpp v84, v84, v84 row_ror:1 row_mask:0xf bank_mask:0xf
    s_nop 1
    v_add_f32_dpp v84, v84, v84 row_ror:2 row_mask:0xf bank_mask:0xf
    s_nop 1
    v_add_f32_dpp v84, v84, v84 row_ror:4 row_mask:0xf bank_mask:0xf
    s_nop 1
    v_add_f32_dpp v84, v84, v84 row_ror:8 row_mask:0xf bank_mask:0xf
    v_mov_b32 v85, v84
    s_nop 1
    v_permlane32_swap_b32 v85, v84
    v_add_f32 v84, v85, v84
    v_mov_b32 v85, v84
    s_nop 1
    v_permlane16_swap_b32 v85, v84
    v_add_f32 v84, v85, v84
    v_cvt_pk_bf16_f32 v84, v84, v84
    v_and_b32 v84, 0xffff0000, v84
    v_ashrrev_i32 v85, 31, v84
    v_or_b32 v85, 0x80000000, v85
    v_xor_b32 v84, v84, v85
    v_and_b32 v84, 0xffff0000, v84
    s_sub_u32 s62, 0x87ff, s60
    v_or_b32 v84, s62, v84
    s_waitcnt vmcnt(0)
    s_lshl_b32 s62, s60, 2
    s_add_u32 s62, s62, 0x6000
    s_mov_b64 exec, 1
    buffer_store_dword v84, off, s[8:11], s62 sc1
    s_mov_b64 exec, -1
L_nofin_126:
    s_add_u32 s80, s80, 4
    s_add_u32 s22, s22, s23
    s_branch L_p2_seg
L_p2_end:
    s_cmp_ge_u32 s67, 56
    s_cbranch_scc1 L_exit
    s_mov_b32 s74, 0
    s_mov_b32 s75, 0
    v_mov_b32 v202, 0x7ffffff0
    v_mov_b32 v1, 0
    s_and_b32 s71, s101, 15
    s_lshl_b32 s71, s71, 7
    s_add_u32 s71, s71, 0x1000
    s_mov_b32 s72, 61
    s_cmp_lg_u32 s100, 0
    s_cbranch_scc1 L_polls_129
    s_mov_b32 exec_lo, 0x1
    s_mov_b32 exec_hi, 0
    s_mov_b32 s96, 0
L_poll_127:
    buffer_load_dword v2, v1, s[8:11], s71 offen sc1
    s_waitcnt vmcnt(0)
    v_cmp_gt_u32 vcc, s72, v2
    s_cbranch_vccz L_polld_128
    v_readfirstlane_b32 s97, v2
    s_nop 0
    s_sub_u32 s97, s72, s97
    s_cmp_lt_i32 s97, 3
    s_cbranch_scc1 L_near_130
    s_sleep 40
    s_cmp_lt_i32 s97, 5
    s_cbranch_scc1 L_near_130
    s_sleep 100
L_near_130:
    s_sleep 16
    s_add_u32 s96, s96, 1
    s_cmp_lt_u32 s96, 0x10000
    s_cbranch_scc1 L_poll_127
L_polld_128:
    s_mov_b64 exec, -1
L_polls_129:
    s_barrier
L_ffn_round:
    v_mbcnt_lo_u32_b32 v0, -1, 0
    v_mbcnt_hi_u32_b32 v0, -1, v0
    s_lshl_b32 s96, s100, 6
    v_add_u32 v0, s96, v0
    s_cmp_lg_u32 s75, 0
    s_cbranch_scc1 L_ffn_re
    v_lshlrev_b32 v30, 5, v0
    s_mov_b32 s69, 0x6000
    v_cmp_le_u32 vcc, 240, v0
    v_mov_b32 v29, s75
    v_add_u32 v29, -1, v29
    v_cndmask_b32 v19, 0, v29, vcc
    s_mov_b32 s70, 0
L_kpoll_131:
    buffer_load_dwordx4 v[20:23], v30, s[8:11], s69 offen sc1
    buffer_load_dwordx4 v[24:27], v30, s[8:11], s69 offen offset:16 sc1
    s_waitcnt vmcnt(0)
    v_min3_u32 v28, v20, v21, v22
    v_min3_u32 v28, v28, v23, v24
    v_min3_u32 v28, v28, v25, v26
    v_min_u32 v28, v28, v27
    v_or_b32 v28, v28, v19
    v_cmp_eq_u32 vcc, 0, v28
    s_cbranch_vccz L_kpolld_132
    s_sleep 6
    s_add_u32 s70, s70, 1
    s_cmp_lt_u32 s70, 0x10000
    s_cbranch_scc1 L_kpoll_131
L_kpolld_132:
    v_bfi_b32 v20, v19, 0, v20
    v_bfi_b32 v21, v19, 0, v21
    v_bfi_b32 v22, v19, 0, v22
    v_bfi_b32 v23, v19, 0, v23
    v_bfi_b32 v24, v19, 0, v24
    v_bfi_b32 v25, v19, 0, v25
    v_bfi_b32 v26, v19, 0, v26
    v_bfi_b32 v27, v19, 0, v27
    v_lshrrev_b32 v30, 6, v0
    v_lshlrev_b32 v30, 2, v30
    v_add_u32 v30, 0x20400, v30
    v_mov_b32 v31, 0x20400
    s_waitcnt vmcnt(0)
    v_max3_u32 v28, v20, v21, v22
    v_max3_u32 v28, v28, v23, v24
    v_max3_u32 v28, v28, v25, v26
    v_max_u32 v28, v28, v27
    s_nop 1
    v_max_u32_dpp v28, v28, v28 row_ror:1 row_mask:0xf bank_mask:0xf
    s_nop 1
    v_max_u32_dpp v28, v28, v28 row_ror:2 row_mask:0xf bank_mask:0xf
    s_nop 1
    v_max_u32_dpp v28, v28, v28 row_ror:4 row_mask:0xf bank_mask:0xf
    s_nop 1
    v_max_u32_dpp v28, v28, v28 row_ror:8 row_mask:0xf bank_mask:0xf
    v_mov_b32 v29, v28
    s_nop 1
    v_permlane32_swap_b32 v29, v28
    v_max_u32 v28, v29, v28
    v_mov_b32 v29, v28
    s_nop 1
    v_permlane16_swap_b32 v29, v28
    v_max_u32 v28, v29, v28
    ds_write_b32 v30, v28
    s_waitcnt lgkmcnt(0)
    s_barrier
    ds_read_b128 v[16:19], v31
    s_waitcnt lgkmcnt(0)
    v_max3_u32 v28, v16, v17, v18
    v_max_u32 v28, v28, v19
    s_nop 0
    v_readfirstlane_b32 s69, v28
    s_nop 1
    v_cmp_ne_u32 vcc, s69, v20
    s_nop 1
    v_cndmask_b32 v20, 0, v20, vcc
    v_cmp_ne_u32 vcc, s69, v21
    s_nop 1
    v_cndmask_b32 v21, 0, v21, vcc
    v_cmp_ne_u32 vcc, s69, v22
    s_nop 1
    v_cndmask_b32 v22, 0, v22, vcc
    v_cmp_ne_u32 vcc, s69, v23
    s_nop 1
    v_cndmask_b32 v23, 0, v23, vcc
    v_cmp_ne_u32 vcc, s69, v24
    s_nop 1
    v_cndmask_b32 v24, 0, v24, vcc
    v_cmp_ne_u32 vcc, s69, v25
    s_nop 1
    v_cndmask_b32 v25, 0, v25, vcc
    v_cmp_ne_u32 vcc, s69, v26
    s_nop 1
    v_cndmask_b32 v26, 0, v26, vcc
    v_cmp_ne_u32 vcc, s69, v27
    s_nop 1
    v_cndmask_b32 v27, 0, v27, vcc
    v_max3_u32 v28, v20, v21, v22
    v_max3_u32 v28, v28, v23, v24
    v_max3_u32 v28, v28, v25, v26
    v_max_u32 v28, v28, v27
    s_nop 1
    v_max_u32_dpp v28, v28, v28 row_ror:1 row_mask:0xf bank_mask:0xf
    s_nop 1
    v_max_u32_dpp v28, v28, v28 row_ror:2 row_mask:0xf bank_mask:0xf
    s_nop 1
    v_max_u32_dpp v28, v28, v28 row_ror:4 row_mask:0xf bank_mask:0xf
    s_nop 1
    v_max_u32_dpp v28, v28, v28 row_ror:8 row_mask:0xf bank_mask:0xf
    v_mov_b32 v29, v28
    s_nop 1
    v_permlane32_swap_b32 v29, v28
    v_max_u32 v28, v29, v28
    v_mov_b32 v29, v28
    s_nop 1
    v_permlane16_swap_b32 v29, v28
    v_max_u32 v28, v29, v28
    ds_write_b32 v30, v28 offset:16
    s_waitcnt lgkmcnt(0)
    s_barrier
    ds_read_b128 v[16:19], v31 offset:16
    s_waitcnt lgkmcnt(0)
    v_max3_u32 v28, v16, v17, v18
    v_max_u32 v28, v28, v19
    s_nop 0
    v_readfirstlane_b32 s70, v28
    s_barrier
    s_branch L_ffn_sel
L_ffn_re:
    v_and_b32 v24, 63, v0
    v_lshlrev_b32 v24, 3, v24
    s_mov_b32 s71, 0x7e00
    s_mov_b32 s72, 0
L_rsel_133:
    buffer_load_dwordx2 v[20:21], v24, s[8:11], s71 offen sc1
    s_waitcnt vmcnt(0)
    v_min_u32 v22, v20, v21
    v_cmp_eq_u32 vcc, 0, v22
    s_cbranch_vccz L_rseld_134
    s_sleep 3
    s_add_u32 s72, s72, 1
    s_cmp_lt_u32 s72, 0x10000
    s_cbranch_scc1 L_rsel_133
L_rseld_134:
    v_max_u32 v22, v20, v21
    v_cmp_lt_u32 vcc, s70, v22
    s_cbranch_vccz L_rsele_135
    v_max_u32_dpp v22, v22, v22 row_ror:1 row_mask:0xf bank_mask:0xf
    s_nop 1
    v_max_u32_dpp v22, v22, v22 row_ror:2 row_mask:0xf bank_mask:0xf
    s_nop 1
    v_max_u32_dpp v22, v22, v22 row_ror:4 row_mask:0xf bank_mask:0xf
    s_nop 1
    v_max_u32_dpp v22, v22, v22 row_ror:8 row_mask:0xf bank_mask:0xf
    v_mov_b32 v23, v22
    s_nop 1
    v_permlane32_swap_b32 v23, v22
    v_max_u32 v22, v23, v22
    v_mov_b32 v23, v22
    s_nop 1
    v_permlane16_swap_b32 v23, v22
    v_max_u32 v22, v23, v22
    s_nop 0
    v_readfirstlane_b32 s71, v22
    s_nop 1
    v_cmp_ne_u32 vcc, s71, v20
    s_nop 1
    v_cndmask_b32 v20, 0, v20, vcc
    v_cmp_ne_u32 vcc, s71, v21
    s_nop 1
    v_cndmask_b32 v21, 0, v21, vcc
    v_max_u32 v22, v20, v21
    s_nop 1
    v_max_u32_dpp v22, v22, v22 row_ror:1 row_mask:0xf bank_mask:0xf
    s_nop 1
    v_max_u32_dpp v22, v22, v22 row_ror:2 row_mask:0xf bank_mask:0xf
    s_nop 1
    v_max_u32_dpp v22, v22, v22 row_ror:4 row_mask:0xf bank_mask:0xf
    s_nop 1
    v_max_u32_dpp v22, v22, v22 row_ror:8 row_mask:0xf bank_mask:0xf
    v_mov_b32 v23, v22
    s_nop 1
    v_permlane32_swap_b32 v23, v22
    v_max_u32 v22, v23, v22
    v_mov_b32 v23, v22
    s_nop 1
    v_permlane16_swap_b32 v23, v22
    v_max_u32 v22, v23, v22
    s_nop 0
    v_readfirstlane_b32 s72, v22
    s_nop 0
    s_max_u32 s70, s70, s72
    s_min_u32 s72, s71, s69
    s_max_u32 s70, s70, s72
    s_max_u32 s69, s69, s71
L_rsele_135:
L_ffn_sel:
    s_and_b32 s71, s69, 2047
    s_lshl_b32 s71, s71, 11
    s_and_b32 s72, s70, 2047
    s_or_b32 s71, s71, s72
    s_add_u32 s71, s71, 1
    s_cmp_eq_u32 s71, s74
    s_cbranch_scc1 L_ffn_same
    s_mov_b32 s74, s71
    v_and_b32 v1, 63, v0
    v_lshrrev_b32 v2, 4, v1
    v_and_b32 v3, 15, v1
    v_lshrrev_b32 v6, 2, v3
    s_and_b32 s71, s69, 2047
    s_sub_u32 s71, 2047, s71
    s_and_b32 s72, s70, 2047
    s_sub_u32 s72, 2047, s72
    v_and_b32 v4, 1, v3
    v_cmp_eq_u32 vcc, 0, v4
    v_mov_b32 v4, s71
    v_mov_b32 v5, s72
    v_cndmask_b32 v4, v5, v4, vcc
    v_lshlrev_b32 v4, 10, v4
    v_lshl_add_u32 v4, v2, 4, v4
    s_mov_b32 s71, 0x6200000
    buffer_load_dwordx4 v[32:35], v4, s[8:11], s71 offen
    buffer_load_dwordx4 v[36:39], v4, s[8:11], s71 offen offset:64
    buffer_load_dwordx4 v[40:43], v4, s[8:11], s71 offen offset:128
    buffer_load_dwordx4 v[44:47], v4, s[8:11], s71 offen offset:192
    buffer_load_dwordx4 v[48:51], v4, s[8:11], s71 offen offset:256
    buffer_load_dwordx4 v[52:55], v4, s[8:11], s71 offen offset:320
    buffer_load_dwordx4 v[56:59], v4, s[8:11], s71 offen offset:384
    buffer_load_dwordx4 v[60:63], v4, s[8:11], s71 offen offset:448
    buffer_load_dwordx4 v[64:67], v4, s[8:11], s71 offen offset:512
    buffer_load_dwordx4 v[68:71], v4, s[8:11], s71 offen offset:576
    buffer_load_dwordx4 v[72:75], v4, s[8:11], s71 offen offset:640
    buffer_load_dwordx4 v[76:79], v4, s[8:11], s71 offen offset:704
    buffer_load_dwordx4 v[80:83], v4, s[8:11], s71 offen offset:768
    buffer_load_dwordx4 v[84:87], v4, s[8:11], s71 offen offset:832
    buffer_load_dwordx4 v[88:91], v4, s[8:11], s71 offen offset:896
    buffer_load_dwordx4 v[92:95], v4, s[8:11], s71 offen offset:960
    v_lshl_add_u32 v4, v2, 3, v6
    v_lshlrev_b32 v4, 6, v4
    v_and_b32 v5, 3, v3
    v_lshl_add_u32 v4, v5, 3, v4
    s_lshr_b32 s71, s68, 1
    s_lshl_b32 s71, s71, 15
    s_and_b32 s72, s68, 1
    s_lshl_b32 s72, s72, 5
    s_add_u32 s71, s71, s72
    s_add_u32 s71, s71, 0x8000
    v_add_u32 v7, s71, v4
    ds_read_b64_tr_b16 v[96:97], v7
    ds_read_b64_tr_b16 v[98:99], v7 offset:256
    ds_read_b64_tr_b16 v[100:101], v7 offset:2048
    ds_read_b64_tr_b16 v[102:103], v7 offset:2304
    ds_read_b64_tr_b16 v[104:105], v7 offset:4096
    ds_read_b64_tr_b16 v[106:107], v7 offset:4352
    ds_read_b64_tr_b16 v[108:109], v7 offset:6144
    ds_read_b64_tr_b16 v[110:111], v7 offset:6400
    s_waitcnt lgkmcnt(0)
    ds_read_b64_tr_b16 v[112:113], v7 offset:8192
    ds_read_b64_tr_b16 v[114:115], v7 offset:8448
    ds_read_b64_tr_b16 v[116:117], v7 offset:10240
    ds_read_b64_tr_b16 v[118:119], v7 offset:10496
    ds_read_b64_tr_b16 v[120:121], v7 offset:12288
    ds_read_b64_tr_b16 v[122:123], v7 offset:12544
    ds_read_b64_tr_b16 v[124:125], v7 offset:14336
    ds_read_b64_tr_b16 v[126:127], v7 offset:14592
    s_waitcnt lgkmcnt(0)
    ds_read_b64_tr_b16 v[128:129], v7 offset:16384
    ds_read_b64_tr_b16 v[130:131], v7 offset:16640
    ds_read_b64_tr_b16 v[132:133], v7 offset:18432
    ds_read_b64_tr_b16 v[134:135], v7 offset:18688
    ds_read_b64_tr_b16 v[136:137], v7 offset:20480
    ds_read_b64_tr_b16 v[138:139], v7 offset:20736
    ds_read_b64_tr_b16 v[140:141], v7 offset:22528
    ds_read_b64_tr_b16 v[142:143], v7 offset:22784
    s_waitcnt lgkmcnt(0)
    ds_read_b64_tr_b16 v[144:145], v7 offset:24576
    ds_read_b64_tr_b16 v[146:147], v7 offset:24832
    ds_read_b64_tr_b16 v[148:149], v7 offset:26624
    ds_read_b64_tr_b16 v[150:151], v7 offset:26880
    ds_read_b64_tr_b16 v[152:153], v7 offset:28672
    ds_read_b64_tr_b16 v[154:155], v7 offset:28928
    ds_read_b64_tr_b16 v[156:157], v7 offset:30720
    ds_read_b64_tr_b16 v[158:159], v7 offset:30976
    s_waitcnt lgkmcnt(0)
    s_waitcnt vmcnt(0)
    v_mfma_f32_16x16x32_bf16 v[8:11], v[32:35], v[96:99], 0
    v_mfma_f32_16x16x32_bf16 v[8:11], v[36:39], v[100:103], v[8:11]
    v_mfma_f32_16x16x32_bf16 v[8:11], v[40:43], v[104:107], v[8:11]
    v_mfma_f32_16x16x32_bf16 v[8:11], v[44:47], v[108:111], v[8:11]
    v_mfma_f32_16x16x32_bf16 v[8:11], v[48:51], v[112:115], v[8:11]
    v_mfma_f32_16x16x32_bf16 v[8:11], v[52:55], v[116:119], v[8:11]
    v_mfma_f32_16x16x32_bf16 v[8:11], v[56:59], v[120:123], v[8:11]
    v_mfma_f32_16x16x32_bf16 v[8:11], v[60:63], v[124:127], v[8:11]
    v_mfma_f32_16x16x32_bf16 v[8:11], v[64:67], v[128:131], v[8:11]
    v_mfma_f32_16x16x32_bf16 v[8:11], v[68:71], v[132:135], v[8:11]
    v_mfma_f32_16x16x32_bf16 v[8:11], v[72:75], v[136:139], v[8:11]
    v_mfma_f32_16x16x32_bf16 v[8:11], v[76:79], v[140:143], v[8:11]
    v_mfma_f32_16x16x32_bf16 v[8:11], v[80:83], v[144:147], v[8:11]
    v_mfma_f32_16x16x32_bf16 v[8:11], v[84:87], v[148:151], v[8:11]
    v_mfma_f32_16x16x32_bf16 v[8:11], v[88:91], v[152:155], v[8:11]
    v_mfma_f32_16x16x32_bf16 v[8:11], v[92:95], v[156:159], v[8:11]
    s_nop 7
    v_cvt_pk_bf16_f32 v8, v8, v8
    v_and_b32 v8, 0xffff0000, v8
    v_cvt_pk_bf16_f32 v9, v9, v9
    v_and_b32 v9, 0xffff0000, v9
    s_cmp_ge_u32 s68, 2
    s_cbranch_scc1 L_ffn_up_136
    v_mul_f32 v13, 0xbfb8aa3b, v8
    v_exp_f32 v13, v13
    s_nop 0
    v_add_f32 v13, 1.0, v13
    v_rcp_f32 v12, v13
    s_nop 0
    v_mul_f32 v8, v12, v8
    v_cvt_pk_bf16_f32 v8, v8, v8
    v_and_b32 v8, 0xffff0000, v8
    v_mul_f32 v13, 0xbfb8aa3b, v9
    v_exp_f32 v13, v13
    s_nop 0
    v_add_f32 v13, 1.0, v13
    v_rcp_f32 v12, v13
    s_nop 0
    v_mul_f32 v9, v12, v9
    v_cvt_pk_bf16_f32 v9, v9, v9
    v_and_b32 v9, 0xffff0000, v9
    s_nop 4
L_ffn_up_136:
    s_lshr_b32 s71, s68, 1
    s_lshl_b32 s71, s71, 8
    s_and_b32 s72, s68, 1
    s_lshl_b32 s72, s72, 6
    s_add_u32 s71, s71, s72
    s_add_u32 s71, s71, 0x20000
    v_lshlrev_b32 v4, 2, v3
    v_add_u32 v4, s71, v4
    ds_write_b32 v4, v8
    ds_write_b32 v4, v9 offset:128
    s_waitcnt lgkmcnt(0)
    s_barrier
    v_and_b32 v4, 1, v3
    v_lshlrev_b32 v4, 7, v4
    v_lshl_add_u32 v4, v2, 5, v4
    v_add_u32 v4, 0x20000, v4
    ds_read_b128 v[32:35], v4
    ds_read_b128 v[36:39], v4 offset:16
    ds_read_b128 v[40:43], v4 offset:256
    ds_read_b128 v[44:47], v4 offset:272
    v_lshl_add_u32 v5, v2, 3, v6
    v_lshlrev_b32 v5, 10, v5
    v_and_b32 v7, 3, v3
    v_lshl_add_u32 v5, v7, 3, v5
    s_lshl_b32 s71, s68, 8
    s_add_u32 s71, s71, 0x18000
    v_add_u32 v7, s71, v5
    s_waitcnt lgkmcnt(0)
    ds_read_b64_tr_b16 v[96:97], v7
    ds_read_b64_tr_b16 v[98:99], v7 offset:4096
    ds_read_b64_tr_b16 v[100:101], v7 offset:32
    ds_read_b64_tr_b16 v[102:103], v7 offset:4128
    ds_read_b64_tr_b16 v[104:105], v7 offset:64
    ds_read_b64_tr_b16 v[106:107], v7 offset:4160
    ds_read_b64_tr_b16 v[108:109], v7 offset:96
    ds_read_b64_tr_b16 v[110:111], v7 offset:4192
    s_waitcnt lgkmcnt(0)
    ds_read_b64_tr_b16 v[112:113], v7 offset:128
    ds_read_b64_tr_b16 v[114:115], v7 offset:4224
    ds_read_b64_tr_b16 v[116:117], v7 offset:160
    ds_read_b64_tr_b16 v[118:119], v7 offset:4256
    ds_read_b64_tr_b16 v[120:121], v7 offset:192
    ds_read_b64_tr_b16 v[122:123], v7 offset:4288
    ds_read_b64_tr_b16 v[124:125], v7 offset:224
    ds_read_b64_tr_b16 v[126:127], v7 offset:4320
    v_mul_f32 v32, v32, v40
    v_mul_f32 v33, v33, v41
    v_mul_f32 v34, v34, v42
    v_mul_f32 v35, v35, v43
    v_mul_f32 v36, v36, v44
    v_mul_f32 v37, v37, v45
    v_mul_f32 v38, v38, v46
    v_mul_f32 v39, v39, v47
    v_cvt_pk_bf16_f32 v48, v32, v33
    v_cvt_pk_bf16_f32 v49, v34, v35
    v_cvt_pk_bf16_f32 v50, v36, v37
    v_cvt_pk_bf16_f32 v51, v38, v39
    s_waitcnt lgkmcnt(0)
    s_nop 0
    v_mfma_f32_16x16x32_bf16 v[56:59], v[48:51], v[96:99], 0
    v_mfma_f32_16x16x32_bf16 v[60:63], v[48:51], v[100:103], 0
    v_mfma_f32_16x16x32_bf16 v[64:67], v[48:51], v[104:107], 0
    v_mfma_f32_16x16x32_bf16 v[68:71], v[48:51], v[108:111], 0
    v_mfma_f32_16x16x32_bf16 v[72:75], v[48:51], v[112:115], 0
    v_mfma_f32_16x16x32_bf16 v[76:79], v[48:51], v[116:119], 0
    v_mfma_f32_16x16x32_bf16 v[80:83], v[48:51], v[120:123], 0
    v_mfma_f32_16x16x32_bf16 v[84:87], v[48:51], v[124:127], 0
    v_cmp_eq_u32 vcc, 0, v2
    v_lshlrev_b32 v4, 11, v2
    v_lshl_add_u32 v4, v3, 2, v4
    s_lshl_b32 s71, s67, 12
    s_lshl_b32 s72, s68, 9
    s_add_u32 s71, s71, s72
    s_add_u32 s71, s71, 0x6410000
    v_cndmask_b32 v56, v57, v56, vcc
    v_cndmask_b32 v60, v61, v60, vcc
    v_cndmask_b32 v64, v65, v64, vcc
    v_cndmask_b32 v68, v69, v68, vcc
    v_cndmask_b32 v72, v73, v72, vcc
    v_cndmask_b32 v76, v77, v76, vcc
    v_cndmask_b32 v80, v81, v80, vcc
    v_cndmask_b32 v84, v85, v84, vcc
    s_mov_b32 exec_hi, 0
    buffer_store_dword v56, v4, s[8:11], s71 offen sc1
    buffer_store_dword v60, v4, s[8:11], s71 offen offset:64 sc1
    buffer_store_dword v64, v4, s[8:11], s71 offen offset:128 sc1
    buffer_store_dword v68, v4, s[8:11], s71 offen offset:192 sc1
    buffer_store_dword v72, v4, s[8:11], s71 offen offset:256 sc1
    buffer_store_dword v76, v4, s[8:11], s71 offen offset:320 sc1
    buffer_store_dword v80, v4, s[8:11], s71 offen offset:384 sc1
    buffer_store_dword v84, v4, s[8:11], s71 offen offset:448 sc1
    s_mov_b64 exec, -1
    s_waitcnt vmcnt(0)
    s_barrier
    s_lshl_b32 s71, s67, 2
    s_lshl_b32 s72, s75, 8
    s_add_u32 s71, s71, s72
    s_add_u32 s71, s71, 0x8000
    s_cmp_lg_u32 s100, 0
    s_cbranch_scc1 L_flag_137
    v_mov_b32 v2, s74
    s_mov_b64 exec, 1
    buffer_store_dword v2, off, s[8:11], s71 sc1
    s_mov_b64 exec, -1
L_flag_137:
    s_cmp_ge_u32 s67, 8
    s_cbranch_scc1 L_ffn_same
    s_load_dwordx2 s[16:17], s[0:1], 96
    s_waitcnt lgkmcnt(0)
    s_and_b32 s17, s17, 0xffff
    s_mov_b32 s18, 0x200000
    s_mov_b32 s19, 0x20000
    v_and_b32 v3, 63, v0
    s_cmp_lt_u32 s100, 2
    s_cselect_b32 s71, s69, s70
    v_mov_b32 v5, s71
    s_and_b32 s71, s71, 2047
    s_sub_u32 s71, 2047, s71
    s_lshl_b32 s71, s71, 10
    s_lshl_b32 s72, s67, 1
    s_and_b32 s96, s100, 1
    s_add_u32 s72, s72, s96
    s_lshl_b32 s96, s72, 6
    s_add_u32 s71, s71, s96
    v_and_b32 v4, 7, v3
    v_lshlrev_b32 v6, 3, v4
    v_add_u32 v6, s71, v6
    v_lshrrev_b32 v7, 3, v3
    v_lshlrev_b32 v7, 12, v7
    v_lshl_add_u32 v7, v4, 4, v7
    s_lshl_b32 s72, s72, 7
    s_lshr_b32 s96, s100, 1
    s_lshl_b32 s96, s96, 11
    s_add_u32 s72, s72, s96
    v_add_u32 v7, s72, v7
    s_mov_b32 s71, 0x6000000
    s_mov_b32 s72, 0x6200000
    buffer_load_dwordx2 v[8:9], v6, s[8:11], s71 offen sc1
    buffer_load_dwordx2 v[10:11], v6, s[8:11], s72 offen sc1
    v_and_b32 v5, 0xffff0000, v5
    v_ashrrev_i32 v4, 31, v5
    v_not_b32 v4, v4
    v_or_b32 v4, 0x80000000, v4
    v_xor_b32 v5, v5, v4
    v_and_b32 v5, 0xffff0000, v5
    v_mul_f32 v23, 0xbfb8aa3b, v5
    v_exp_f32 v23, v23
    s_nop 0
    v_add_f32 v23, 1.0, v23
    v_rcp_f32 v22, v23
    s_nop 0
    v_cvt_pk_bf16_f32 v22, v22, v22
    v_and_b32 v22, 0xffff0000, v22
    v_lshlrev_b32 v1, 2, v0
    s_lshl_b32 s71, s75, 8
    s_add_u32 s71, s71, 0x8000
    s_cmp_lg_u32 s100, 0
    s_cbranch_scc1 L_polls_140
    s_mov_b32 exec_hi, 0xffffff
    s_mov_b32 s96, 0
L_poll_138:
    buffer_load_dword v2, v1, s[8:11], s71 offen sc1
    s_waitcnt vmcnt(0)
    v_cmp_ne_u32 vcc, s74, v2
    s_cbranch_vccz L_polld_139
    s_sleep 2
    s_add_u32 s96, s96, 1
    s_cmp_lt_u32 s96, 0x10000
    s_cbranch_scc1 L_poll_138
L_polld_139:
    s_mov_b64 exec, -1
L_polls_140:
    s_barrier
    s_mov_b32 s71, 0x6410000
    buffer_load_dwordx4 v[32:35], v7, s[8:11], s71 offen sc1
    s_add_u32 s71, s71, 32768
    buffer_load_dwordx4 v[36:39], v7, s[8:11], s71 offen sc1
    s_add_u32 s71, s71, 32768
    buffer_load_dwordx4 v[40:43], v7, s[8:11], s71 offen sc1
    s_add_u32 s71, s71, 32768
    buffer_load_dwordx4 v[44:47], v7, s[8:11], s71 offen sc1
    s_add_u32 s71, s71, 32768
    buffer_load_dwordx4 v[48:51], v7, s[8:11], s71 offen sc1
    s_add_u32 s71, s71, 32768
    buffer_load_dwordx4 v[52:55], v7, s[8:11], s71 offen sc1
    s_add_u32 s71, s71, 32768
    buffer_load_dwordx4 v[56:59], v7, s[8:11], s71 offen sc1
    s_add_u32 s71, s71, 32768
    s_waitcnt vmcnt(7)
    v_lshlrev_b32 v12, 16, v8
    v_and_b32 v13, 0xffff0000, v8
    v_lshlrev_b32 v16, 16, v10
    v_and_b32 v17, 0xffff0000, v10
    v_lshlrev_b32 v14, 16, v9
    v_and_b32 v15, 0xffff0000, v9
    v_lshlrev_b32 v18, 16, v11
    v_and_b32 v19, 0xffff0000, v11
    s_waitcnt vmcnt(0)
    v_pk_add_f32 v[32:33], v[32:33], v[36:37]
    v_pk_add_f32 v[34:35], v[34:35], v[38:39]
    v_pk_add_f32 v[32:33], v[32:33], v[40:41]
    v_pk_add_f32 v[34:35], v[34:35], v[42:43]
    v_pk_add_f32 v[32:33], v[32:33], v[44:45]
    v_pk_add_f32 v[34:35], v[34:35], v[46:47]
    v_pk_add_f32 v[32:33], v[32:33], v[48:49]
    v_pk_add_f32 v[34:35], v[34:35], v[50:51]
    v_pk_add_f32 v[32:33], v[32:33], v[52:53]
    v_pk_add_f32 v[34:35], v[34:35], v[54:55]
    v_pk_add_f32 v[32:33], v[32:33], v[56:57]
    v_pk_add_f32 v[34:35], v[34:35], v[58:59]
    s_nop 0
    v_add_f32_dpp v32, v32, v32 row_ror:8 row_mask:0xf bank_mask:0xf
    v_add_f32_dpp v33, v33, v33 row_ror:8 row_mask:0xf bank_mask:0xf
    v_add_f32_dpp v34, v34, v34 row_ror:8 row_mask:0xf bank_mask:0xf
    v_add_f32_dpp v35, v35, v35 row_ror:8 row_mask:0xf bank_mask:0xf
    v_mov_b32 v24, v32
    s_nop 1
    v_permlane32_swap_b32 v24, v32
    v_add_f32 v32, v24, v32
    v_mov_b32 v24, v32
    s_nop 1
    v_permlane16_swap_b32 v24, v32
    v_add_f32 v32, v24, v32
    v_mov_b32 v24, v33
    s_nop 1
    v_permlane32_swap_b32 v24, v33
    v_add_f32 v33, v24, v33
    v_mov_b32 v24, v33
    s_nop 1
    v_permlane16_swap_b32 v24, v33
    v_add_f32 v33, v24, v33
    v_mov_b32 v24, v34
    s_nop 1
    v_permlane32_swap_b32 v24, v34
    v_add_f32 v34, v24, v34
    v_mov_b32 v24, v34
    s_nop 1
    v_permlane16_swap_b32 v24, v34
    v_add_f32 v34, v24, v34
    v_mov_b32 v24, v35
    s_nop 1
    v_permlane32_swap_b32 v24, v35
    v_add_f32 v35, v24, v35
    v_mov_b32 v24, v35
    s_nop 1
    v_permlane16_swap_b32 v24, v35
    v_add_f32 v35, v24, v35
    v_cvt_pk_bf16_f32 v32, v32, v32
    v_and_b32 v32, 0xffff0000, v32
    v_mul_f32 v32, v22, v32
    v_cvt_pk_bf16_f32 v32, v32, v32
    v_and_b32 v32, 0xffff0000, v32
    v_add_f32 v32, v16, v32
    v_cvt_pk_bf16_f32 v32, v32, v32
    v_and_b32 v32, 0xffff0000, v32
    v_add_f32 v32, v12, v32
    v_cvt_pk_bf16_f32 v33, v33, v33
    v_and_b32 v33, 0xffff0000, v33
    v_mul_f32 v33, v22, v33
    v_cvt_pk_bf16_f32 v33, v33, v33
    v_and_b32 v33, 0xffff0000, v33
    v_add_f32 v33, v17, v33
    v_cvt_pk_bf16_f32 v33, v33, v33
    v_and_b32 v33, 0xffff0000, v33
    v_add_f32 v33, v13, v33
    v_cvt_pk_bf16_f32 v34, v34, v34
    v_and_b32 v34, 0xffff0000, v34
    v_mul_f32 v34, v22, v34
    v_cvt_pk_bf16_f32 v34, v34, v34
    v_and_b32 v34, 0xffff0000, v34
    v_add_f32 v34, v18, v34
    v_cvt_pk_bf16_f32 v34, v34, v34
    v_and_b32 v34, 0xffff0000, v34
    v_add_f32 v34, v14, v34
    v_cvt_pk_bf16_f32 v35, v35, v35
    v_and_b32 v35, 0xffff0000, v35
    v_mul_f32 v35, v22, v35
    v_cvt_pk_bf16_f32 v35, v35, v35
    v_and_b32 v35, 0xffff0000, v35
    v_add_f32 v35, v19, v35
    v_cvt_pk_bf16_f32 v35, v35, v35
    v_and_b32 v35, 0xffff0000, v35
    v_add_f32 v35, v15, v35
    v_cvt_pk_bf16_f32 v200, v32, v33
    v_cvt_pk_bf16_f32 v201, v34, v35
    v_mov_b32 v202, v6
L_ffn_same:
    s_add_u32 s75, s75, 1
    s_cmp_lt_u32 s75, 2
    s_cbranch_scc1 L_ffn_round
    s_cmp_ge_u32 s67, 8
    s_cbranch_scc1 L_exit
    s_mov_b32 exec_lo, 0xff
    s_mov_b32 exec_hi, 0
    buffer_store_dwordx2 v[200:201], v202, s[16:19], 0 offen
    s_mov_b64 exec, -1
    s_waitcnt vmcnt(0)
L_exit:
    s_endpgm
.section .rodata,"a"
.p2align 6
.amdhsa_kernel sequential_preLN__memory_aug_recurrent_mem_tr__moe_arch_mod__prompt_kernel
  .amdhsa_next_free_vgpr 512
  .amdhsa_next_free_sgpr 102
  .amdhsa_accum_offset 256
  .amdhsa_group_segment_fixed_size 0
  .amdhsa_kernarg_size 120
  .amdhsa_user_sgpr_count 2
  .amdhsa_user_sgpr_kernarg_segment_ptr 1
  .amdhsa_system_sgpr_workgroup_id_x 1
  .amdhsa_float_denorm_mode_32 3
.end_amdhsa_kernel
```

```asm
; @launch grid=(256,1,1) block=(256,1,1) lds=163840
.amdgcn_target "amdgcn-amd-amdhsa--gfx950"
.text
.globl sequential_preLN__memory_aug_recurrent_mem_tr__moe_arch_mod__prompt_kernel
.p2align 8
.type sequential_preLN__memory_aug_recurrent_mem_tr__moe_arch_mod__prompt_kernel,@function
sequential_preLN__memory_aug_recurrent_mem_tr__moe_arch_mod__prompt_kernel:
    s_cmp_ge_u32 s2, 256
    s_cbranch_scc1 L_exit
    s_load_dwordx2 s[8:9], s[0:1], 112
    s_waitcnt lgkmcnt(0)
    s_and_b32 s9, s9, 0xffff
    s_mov_b32 s10, 0x10000000
    s_mov_b32 s11, 0x20000
    s_load_dwordx2 s[92:93], s[0:1], 104
    s_waitcnt lgkmcnt(0)
    s_and_b32 s93, s93, 0xffff
    s_mov_b32 s94, 0x100
    s_mov_b32 s95, 0x20000
    v_lshrrev_b32 v1, 6, v0
    s_nop 0
    v_readfirstlane_b32 s100, v1
    s_getreg_b32 s84, hwreg(HW_REG_XCC_ID)
    s_and_b32 s84, s84, 7
    s_lshl_b32 s97, s84, 4
    s_add_u32 s97, s97, 64
    s_cmp_lg_u32 s100, 0
    s_cbranch_scc1 L_at_1
    s_mov_b64 exec, 1
    v_mov_b32 v2, 1
    buffer_atomic_add v2, off, s[92:95], s97 sc0
    s_mov_b64 exec, -1
L_at_1:
    s_load_dwordx4 s[20:23], s[0:1], 16
    s_load_dwordx4 s[24:27], s[0:1], 32
    v_lshlrev_b32 v3, 6, v0
    s_lshl_b32 s28, s2, 14
    s_cmp_eq_u32 s84, 0
    s_cselect_b32 s14, 0, 0x400000
    s_mov_b32 s15, 0x20000
    s_waitcnt lgkmcnt(0)
    s_mov_b32 s12, s20
    s_and_b32 s13, s21, 0xffff
    buffer_load_dword v255, v3, s[12:15], s28 offen
    s_mov_b32 s12, s22
    s_and_b32 s13, s23, 0xffff
    buffer_load_dword v255, v3, s[12:15], s28 offen
    s_mov_b32 s12, s24
    s_and_b32 s13, s25, 0xffff
    buffer_load_dword v255, v3, s[12:15], s28 offen
    s_mov_b32 s12, s26
    s_and_b32 s13, s27, 0xffff
    buffer_load_dword v255, v3, s[12:15], s28 offen
    s_cmp_lg_u32 s100, 0
    s_cbranch_scc1 L_at2_2
    s_mov_b64 exec, 1
    v_mov_b32 v1, 0
    s_waitcnt vmcnt(4)
    ds_write_b32 v1, v2
    s_waitcnt lgkmcnt(0)
    s_mov_b64 exec, -1
L_at2_2:
    s_barrier
    v_mov_b32 v1, 0
    ds_read_b32 v2, v1
    s_waitcnt lgkmcnt(0)
    v_readfirstlane_b32 s85, v2
    s_mov_b32 s87, 0
    s_cmp_lg_u32 s2, 0
    s_cbranch_scc1 L_noz
    v_mov_b32 v4, 0
    v_mov_b32 v5, 0
    v_mov_b32 v6, 0
    v_mov_b32 v7, 0
    v_lshlrev_b32 v1, 4, v0
    s_mov_b32 s97, 0x0
    buffer_store_dwordx4 v[4:7], v1, s[8:11], s97 offen sc1
    s_mov_b32 s97, 0x1000
    buffer_store_dwordx4 v[4:7], v1, s[8:11], s97 offen sc1
    s_mov_b32 s97, 0x2000
    buffer_store_dwordx4 v[4:7], v1, s[8:11], s97 offen sc1
    s_mov_b32 s97, 0x3000
    buffer_store_dwordx4 v[4:7], v1, s[8:11], s97 offen sc1
    s_mov_b32 s97, 0x4000
    buffer_store_dwordx4 v[4:7], v1, s[8:11], s97 offen sc1
    s_mov_b32 s97, 0x5000
    buffer_store_dwordx4 v[4:7], v1, s[8:11], s97 offen sc1
    s_mov_b32 s97, 0x6000
    buffer_store_dwordx4 v[4:7], v1, s[8:11], s97 offen sc1
    s_mov_b32 s97, 0x7000
    buffer_store_dwordx4 v[4:7], v1, s[8:11], s97 offen sc1
    s_mov_b32 s97, 0x8000
    buffer_store_dwordx4 v[4:7], v1, s[8:11], s97 offen sc1
    s_waitcnt vmcnt(0)
    s_barrier
    s_cmp_lg_u32 s100, 0
    s_cbranch_scc1 L_flag_3
    v_mov_b32 v2, 1
    s_mov_b64 exec, 1
    buffer_store_dword v2, off, s[92:95], 40 sc1
    s_mov_b64 exec, -1
L_flag_3:
L_noz:
    s_cmp_lg_u32 s85, 31
    s_cbranch_scc1 L_nod
    s_cmp_lg_u32 s100, 0
    s_cbranch_scc1 L_nod
    s_mov_b64 exec, 1
    v_mov_b32 v2, 1
    buffer_atomic_add v2, off, s[92:95], 0 offset:32 sc0
    s_waitcnt vmcnt(0)
    v_readfirstlane_b32 s86, v2
    s_nop 0
    s_cmp_lg_u32 s86, 7
    s_cbranch_scc1 L_nod2
    v_mov_b32 v2, 1
    v_mov_b32 v3, 0
    buffer_atomic_cmpswap v[2:3], off, s[92:95], 0 offset:36
L_nod2:
    s_mov_b64 exec, -1
L_nod:
    s_cmp_ge_u32 s85, 32
    s_cbranch_scc1 L_odd
    s_cmp_lg_u32 s84, 0
    s_cbranch_scc1 L_other
    s_mov_b32 s20, s85
    s_mov_b32 s16, s92
    s_mov_b32 s17, s93
    s_mov_b32 s18, s94
    s_mov_b32 s19, s95
    s_mov_b32 s88, s20
    v_lshrrev_b32 v4, 6, v0
    s_nop 0
    v_readfirstlane_b32 s21, v4
    v_and_b32 v1, 63, v0
    v_lshrrev_b32 v2, 4, v1
    v_and_b32 v3, 15, v1
    v_lshrrev_b32 v6, 2, v3
    v_lshlrev_b32 v117, 4, v1
    s_lshl_b32 s51, s21, 10
    s_lshl_b32 s52, s21, 11
    s_load_dwordx8 s[60:67], s[0:1], 16
    s_mov_b32 s14, 0x400000
    s_mov_b32 s15, 0x20000
    s_lshl_b32 s41, s20, 8
    s_lshl_b32 s42, s20, 17
    s_lshr_b32 s43, s21, 1
    s_lshl_b32 s43, s43, 2
    v_or_b32 v5, s43, v2
    v_lshlrev_b32 v5, 1, v5
    v_xor_b32 v5, v5, v3
    v_lshrrev_b32 v14, 2, v5
    v_lshlrev_b32 v5, 4, v5
    s_lshl_b32 s43, s21, 4
    v_add_u32 v4, s43, v2
    v_lshl_add_u32 v8, v4, 13, v5
    s_waitcnt lgkmcnt(0)
    s_mov_b32 s12, s60
    s_and_b32 s13, s61, 0xffff
    v_xor_b32 v15, 2, v14
    v_lshl_add_u32 v15, v15, 15, v8
    s_add_u32 s43, s41, 0x0
    s_add_u32 m0, s51, 0x8000
    s_nop 0
    buffer_load_dwordx4 v15, s[12:15], s43 offen lds
    s_add_u32 s43, s41, 0x80000
    s_add_u32 m0, s51, 0x9000
    s_nop 0
    buffer_load_dwordx4 v15, s[12:15], s43 offen lds
    s_add_u32 s43, s41, 0x100000
    s_add_u32 m0, s51, 0xa000
    s_nop 0
    buffer_load_dwordx4 v15, s[12:15], s43 offen lds
    s_add_u32 s43, s41, 0x180000
    s_add_u32 m0, s51, 0xb000
    s_nop 0
    buffer_load_dwordx4 v15, s[12:15], s43 offen lds
    s_add_u32 s43, s41, 0x200000
    s_add_u32 m0, s51, 0xc000
    s_nop 0
    buffer_load_dwordx4 v15, s[12:15], s43 offen lds
    s_add_u32 s43, s41, 0x280000
    s_add_u32 m0, s51, 0xd000
    s_nop 0
    buffer_load_dwordx4 v15, s[12:15], s43 offen lds
    s_add_u32 s43, s41, 0x300000
    s_add_u32 m0, s51, 0xe000
    s_nop 0
    buffer_load_dwordx4 v15, s[12:15], s43 offen lds
    s_add_u32 s43, s41, 0x380000
    s_add_u32 m0, s51, 0xf000
    s_nop 0
    buffer_load_dwordx4 v15, s[12:15], s43 offen lds
    v_xor_b32 v15, 3, v14
    v_lshl_add_u32 v15, v15, 15, v8
    s_add_u32 s43, s41, 0x0
    s_add_u32 m0, s51, 0x10000
    s_nop 0
    buffer_load_dwordx4 v15, s[12:15], s43 offen lds
    s_add_u32 s43, s41, 0x80000
    s_add_u32 m0, s51, 0x11000
    s_nop 0
    buffer_load_dwordx4 v15, s[12:15], s43 offen lds
    s_add_u32 s43, s41, 0x100000
    s_add_u32 m0, s51, 0x12000
    s_nop 0
    buffer_load_dwordx4 v15, s[12:15], s43 offen lds
    s_add_u32 s43, s41, 0x180000
    s_add_u32 m0, s51, 0x13000
    s_nop 0
    buffer_load_dwordx4 v15, s[12:15], s43 offen lds
    s_add_u32 s43, s41, 0x200000
    s_add_u32 m0, s51, 0x14000
    s_nop 0
    buffer_load_dwordx4 v15, s[12:15], s43 offen lds
    s_add_u32 s43, s41, 0x280000
    s_add_u32 m0, s51, 0x15000
    s_nop 0
    buffer_load_dwordx4 v15, s[12:15], s43 offen lds
    s_add_u32 s43, s41, 0x300000
    s_add_u32 m0, s51, 0x16000
    s_nop 0
    buffer_load_dwordx4 v15, s[12:15], s43 offen lds
    s_add_u32 s43, s41, 0x380000
    s_add_u32 m0, s51, 0x17000
    s_nop 0
    buffer_load_dwordx4 v15, s[12:15], s43 offen lds
    s_mov_b32 s12, s62
    s_and_b32 s13, s63, 0xffff
    v_xor_b32 v15, 2, v14
    v_lshl_add_u32 v15, v15, 15, v8
    s_add_u32 s43, s41, 0x0
    s_add_u32 m0, s51, 0x18000
    s_nop 0
    buffer_load_dwordx4 v15, s[12:15], s43 offen lds
    s_add_u32 s43, s41, 0x80000
    s_add_u32 m0, s51, 0x19000
    s_nop 0
    buffer_load_dwordx4 v15, s[12:15], s43 offen lds
    s_add_u32 s43, s41, 0x100000
    s_add_u32 m0, s51, 0x1a000
    s_nop 0
    buffer_load_dwordx4 v15, s[12:15], s43 offen lds
    s_add_u32 s43, s41, 0x180000
    s_add_u32 m0, s51, 0x1b000
    s_nop 0
    buffer_load_dwordx4 v15, s[12:15], s43 offen lds
    s_add_u32 s43, s41, 0x200000
    s_add_u32 m0, s51, 0x1c000
    s_nop 0
    buffer_load_dwordx4 v15, s[12:15], s43 offen lds
    s_add_u32 s43, s41, 0x280000
    s_add_u32 m0, s51, 0x1d000
    s_nop 0
    buffer_load_dwordx4 v15, s[12:15], s43 offen lds
    s_add_u32 s43, s41, 0x300000
    s_add_u32 m0, s51, 0x1e000
    s_nop 0
    buffer_load_dwordx4 v15, s[12:15], s43 offen lds
    s_add_u32 s43, s41, 0x380000
    s_add_u32 m0, s51, 0x1f000
    s_nop 0
    buffer_load_dwordx4 v15, s[12:15], s43 offen lds
    v_xor_b32 v15, 3, v14
    v_lshl_add_u32 v15, v15, 15, v8
    s_add_u32 s43, s41, 0x0
    s_add_u32 m0, s51, 0x20000
    s_nop 0
    buffer_load_dwordx4 v15, s[12:15], s43 offen lds
    s_add_u32 s43, s41, 0x80000
    s_add_u32 m0, s51, 0x21000
    s_nop 0
    buffer_load_dwordx4 v15, s[12:15], s43 offen lds
    s_add_u32 s43, s41, 0x100000
    s_add_u32 m0, s51, 0x22000
    s_nop 0
    buffer_load_dwordx4 v15, s[12:15], s43 offen lds
    s_add_u32 s43, s41, 0x180000
    s_add_u32 m0, s51, 0x23000
    s_nop 0
    buffer_load_dwordx4 v15, s[12:15], s43 offen lds
    s_add_u32 s43, s41, 0x200000
    s_add_u32 m0, s51, 0x24000
    s_nop 0
    buffer_load_dwordx4 v15, s[12:15], s43 offen lds
    s_add_u32 s43, s41, 0x280000
    s_add_u32 m0, s51, 0x25000
    s_nop 0
    buffer_load_dwordx4 v15, s[12:15], s43 offen lds
    s_add_u32 s43, s41, 0x300000
    s_add_u32 m0, s51, 0x26000
    s_nop 0
    buffer_load_dwordx4 v15, s[12:15], s43 offen lds
    s_add_u32 s43, s41, 0x380000
    s_add_u32 m0, s51, 0x27000
    s_nop 0
    buffer_load_dwordx4 v15, s[12:15], s43 offen lds
    v_and_b32 v4, 2, v3
    v_cmp_ne_u32 vcc, 0, v4
    v_mov_b32 v4, 0x4444
    v_mov_b32 v5, 0xeeee
    v_cndmask_b32 v116, v4, v5, vcc
    v_lshrrev_b32 v5, 1, v2
    v_lshl_add_u32 v4, v6, 3, v5
    s_lshl_b32 s43, s21, 1
    v_add_u32 v4, s43, v4
    v_add_u32 v5, s20, v4
    v_and_b32 v5, 31, v5
    v_lshl_add_u32 v4, v4, 6, v5
    v_and_b32 v5, 1, v2
    v_lshl_add_u32 v4, v4, 1, v5
    v_and_b32 v5, 3, v3
    v_lshl_add_u32 v4, v4, 2, v5
    v_lshlrev_b32 v118, 4, v4
    v_and_b32 v4, 1, v2
    v_lshlrev_b32 v4, 2, v4
    v_and_b32 v7, 2, v2
    v_add_u32 v4, v4, v7
    v_and_b32 v7, 1, v6
    v_add_u32 v4, v4, v7
    v_lshl_add_u32 v4, v4, 2, v5
    v_lshlrev_b32 v4, 2, v4
    s_and_b32 s43, s21, 1
    s_lshl_b32 s43, s43, 12
    s_lshl_b32 s40, s20, 7
    s_add_u32 s43, s43, s40
    v_add_u32 v119, s43, v4
    v_sub_u32 v7, 0, v2
    v_and_b32 v7, 3, v7
    v_xor_b32 v7, v7, v6
    v_lshl_add_u32 v4, v2, 4, v7
    v_and_b32 v5, 3, v3
    v_lshl_add_u32 v4, v4, 2, v5
    s_add_u32 s43, s51, 16384
    v_lshl_add_u32 v120, v4, 2, s43
    v_sub_u32 v7, 0, v6
    v_and_b32 v7, 3, v7
    v_xor_b32 v7, v7, v2
    v_lshl_add_u32 v4, v3, 2, v7
    v_lshlrev_b32 v121, 4, v4
    v_and_b32 v5, 1, v3
    v_lshl_add_u32 v4, v6, 1, v5
    v_lshl_add_u32 v4, v2, 3, v4
    v_lshlrev_b32 v127, 4, v4
    v_and_or_b32 v122, v116, 8, v127
    s_lshl_b32 s43, s21, 13
    s_add_u32 s43, s43, 32768
    v_add_u32 v123, s43, v117
    v_add_u32 v124, 0x10000, v123
    s_mov_b32 s36, 0xcccccccc
    s_mov_b32 s37, 0xcccccccc
    s_mov_b32 s38, 0x00ff00ff
    s_mov_b32 s39, 0x00ff00ff
    s_mov_b32 s34, 0x3e0293ee
    s_mov_b32 s35, 0x49800000
    s_mov_b32 s50, 0x3f803f80
    v_and_b32 v5, 1, v2
    v_or_b32 v5, 0, v5
    v_xor_b32 v5, v5, v6
    v_lshlrev_b32 v5, 8, v5
    v_and_b32 v7, 3, v3
    v_lshl_add_u32 v7, v7, 4, v5
    s_lshl_b32 s43, s21, 2
    v_add_u32 v4, s43, v2
    v_lshl_add_u32 v10, v4, 10, v7
    v_and_b32 v5, 1, v2
    v_or_b32 v5, 2, v5
    v_xor_b32 v5, v5, v6
    v_lshlrev_b32 v5, 8, v5
    v_and_b32 v7, 3, v3
    v_lshl_add_u32 v7, v7, 4, v5
    s_lshl_b32 s43, s21, 2
    v_add_u32 v4, s43, v2
    v_lshl_add_u32 v9, v4, 10, v7
    v_and_b32 v5, 1, v2
    v_lshl_add_u32 v4, v5, 3, v6
    v_lshrrev_b32 v7, 1, v2
    v_lshl_add_u32 v4, v7, 5, v4
    v_lshlrev_b32 v4, 8, v4
    v_lshl_or_b32 v5, v5, 2, v6
    v_lshlrev_b32 v5, 5, v5
    s_lshl_b32 s43, s21, 6
    v_xor_b32 v5, s43, v5
    v_add_u32 v4, v4, v5
    v_and_b32 v5, 3, v3
    v_lshl_add_u32 v4, v5, 3, v4
    v_add_u32 v11, 32768, v4
    v_and_b32 v5, 1, v2
    v_lshlrev_b32 v4, 4, v5
    v_lshl_add_u32 v4, v7, 2, v4
    v_and_b32 v7, 1, v6
    v_add_u32 v4, v4, v7
    s_lshl_b32 s43, s21, 5
    v_add_u32 v4, s43, v4
    v_lshlrev_b32 v4, 8, v4
    v_lshl_or_b32 v5, v5, 1, v7
    v_xor_b32 v5, s21, v5
    v_lshl_add_u32 v4, v5, 6, v4
    v_lshrrev_b32 v5, 1, v6
    v_lshl_add_u32 v4, v5, 5, v4
    v_and_b32 v5, 3, v3
    v_lshl_add_u32 v4, v5, 3, v4
    v_add_u32 v12, 32768, v4
    v_mov_b32 v16, -1
    v_mov_b32 v17, -1
    v_mov_b32 v18, -1
    v_mov_b32 v19, -1
    s_lshl_b32 s43, s20, 13
    s_add_u32 s43, s43, 0x100000
    s_and_b32 s40, s21, 1
    s_lshl_b32 s40, s40, 12
    s_add_u32 s29, s43, s40
    s_add_u32 s43, s43, s52
    s_xor_b32 s40, s43, 0x40000
    buffer_store_dwordx4 v[16:19], v117, s[8:11], s43 offen
    buffer_store_dwordx4 v[16:19], v117, s[8:11], s43 offen offset:1024
    buffer_store_dwordx4 v[16:19], v117, s[8:11], s40 offen
    buffer_store_dwordx4 v[16:19], v117, s[8:11], s40 offen offset:1024
    s_mov_b32 s43, 0x12000
    buffer_store_dword v16, v119, s[8:11], s43 offen
    s_mov_b32 s43, 0x14000
    buffer_store_dword v16, v119, s[8:11], s43 offen
    s_mov_b32 s43, 0x16000
    buffer_store_dword v16, v119, s[8:11], s43 offen
    s_load_dwordx2 s[4:5], s[0:1], 8
    s_waitcnt lgkmcnt(0)
    s_and_b32 s5, s5, 0xffff
    s_mov_b32 s6, 8192
    s_mov_b32 s7, 0x20000
    v_and_b32 v20, 1, v2
    v_and_b32 v21, 1, v6
    v_lshl_add_u32 v20, v20, 1, v21
    v_lshlrev_b32 v20, 9, v20
    v_and_b32 v21, 3, v3
    v_lshl_add_u32 v20, v21, 4, v20
    v_and_b32 v21, 2, v2
    v_add_u32 v20, v20, v21
    s_and_b32 s43, s20, 1
    s_lshl_b32 s43, s43, 11
    s_bfe_u32 s40, s20, 0x20001
    s_lshl_b32 s40, s40, 7
    s_add_u32 s43, s43, s40
    s_and_b32 s40, s21, 1
    s_lshl_b32 s40, s40, 6
    s_add_u32 s43, s43, s40
    s_lshr_b32 s40, s20, 3
    s_lshl_b32 s40, s40, 2
    s_add_u32 s43, s43, s40
    v_add_u32 v20, s43, v20
    v_lshlrev_b32 v20, 1, v20
    buffer_load_dword v21, v20, s[4:7], 0 offen
    s_waitcnt vmcnt(32)
    s_barrier
    v_xor_b32 v13, 0, v11
    v_add_u32 v13, 0x0, v13
    ds_read_b64_tr_b16 a[32:33], v13
    ds_read_b64_tr_b16 a[34:35], v13 offset:1024
    ds_read_b64_tr_b16 a[36:37], v13 offset:16384
    ds_read_b64_tr_b16 a[38:39], v13 offset:17408
    ds_read_b64_tr_b16 a[48:49], v13 offset:4096
    ds_read_b64_tr_b16 a[50:51], v13 offset:5120
    ds_read_b64_tr_b16 a[52:53], v13 offset:20480
    ds_read_b64_tr_b16 a[54:55], v13 offset:21504
    s_waitcnt lgkmcnt(0)
    v_xor_b32 v13, 32, v11
    v_add_u32 v13, 0x0, v13
    ds_read_b64_tr_b16 a[40:41], v13
    ds_read_b64_tr_b16 a[42:43], v13 offset:1024
    ds_read_b64_tr_b16 a[44:45], v13 offset:16384
    ds_read_b64_tr_b16 a[46:47], v13 offset:17408
    ds_read_b64_tr_b16 a[56:57], v13 offset:4096
    ds_read_b64_tr_b16 a[58:59], v13 offset:5120
    ds_read_b64_tr_b16 a[60:61], v13 offset:20480
    ds_read_b64_tr_b16 a[62:63], v13 offset:21504
    s_waitcnt lgkmcnt(0)
    s_barrier
    s_mov_b32 s12, s64
    s_and_b32 s13, s65, 0xffff
    v_xor_b32 v15, 0, v14
    v_lshl_add_u32 v15, v15, 15, v8
    s_add_u32 s43, s41, 0x0
    s_add_u32 m0, s51, 0x8000
    s_nop 0
    buffer_load_dwordx4 v15, s[12:15], s43 offen lds
    s_add_u32 s43, s41, 0x80000
    s_add_u32 m0, s51, 0x9000
    s_nop 0
    buffer_load_dwordx4 v15, s[12:15], s43 offen lds
    s_add_u32 s43, s41, 0x100000
    s_add_u32 m0, s51, 0xa000
    s_nop 0
    buffer_load_dwordx4 v15, s[12:15], s43 offen lds
    s_add_u32 s43, s41, 0x180000
    s_add_u32 m0, s51, 0xb000
    s_nop 0
    buffer_load_dwordx4 v15, s[12:15], s43 offen lds
    s_add_u32 s43, s41, 0x200000
    s_add_u32 m0, s51, 0xc000
    s_nop 0
    buffer_load_dwordx4 v15, s[12:15], s43 offen lds
    s_add_u32 s43, s41, 0x280000
    s_add_u32 m0, s51, 0xd000
    s_nop 0
    buffer_load_dwordx4 v15, s[12:15], s43 offen lds
    s_add_u32 s43, s41, 0x300000
    s_add_u32 m0, s51, 0xe000
    s_nop 0
    buffer_load_dwordx4 v15, s[12:15], s43 offen lds
    s_add_u32 s43, s41, 0x380000
    s_add_u32 m0, s51, 0xf000
    s_nop 0
    buffer_load_dwordx4 v15, s[12:15], s43 offen lds
    s_waitcnt vmcnt(32)
    s_barrier
    v_xor_b32 v13, 0, v11
    v_add_u32 v13, 0x8000, v13
    ds_read_b64_tr_b16 a[64:65], v13
    ds_read_b64_tr_b16 a[66:67], v13 offset:1024
    ds_read_b64_tr_b16 a[68:69], v13 offset:16384
    ds_read_b64_tr_b16 a[70:71], v13 offset:17408
    ds_read_b64_tr_b16 a[80:81], v13 offset:4096
    ds_read_b64_tr_b16 a[82:83], v13 offset:5120
    ds_read_b64_tr_b16 a[84:85], v13 offset:20480
    ds_read_b64_tr_b16 a[86:87], v13 offset:21504
    s_waitcnt lgkmcnt(0)
    v_xor_b32 v13, 32, v11
    v_add_u32 v13, 0x8000, v13
    ds_read_b64_tr_b16 a[72:73], v13
    ds_read_b64_tr_b16 a[74:75], v13 offset:1024
    ds_read_b64_tr_b16 a[76:77], v13 offset:16384
    ds_read_b64_tr_b16 a[78:79], v13 offset:17408
    ds_read_b64_tr_b16 a[88:89], v13 offset:4096
    ds_read_b64_tr_b16 a[90:91], v13 offset:5120
    ds_read_b64_tr_b16 a[92:93], v13 offset:20480
    ds_read_b64_tr_b16 a[94:95], v13 offset:21504
    s_waitcnt lgkmcnt(0)
    s_barrier
    v_xor_b32 v15, 1, v14
    v_lshl_add_u32 v15, v15, 15, v8
    s_add_u32 s43, s41, 0x0
    s_add_u32 m0, s51, 0x10000
    s_nop 0
    buffer_load_dwordx4 v15, s[12:15], s43 offen lds
    s_add_u32 s43, s41, 0x80000
    s_add_u32 m0, s51, 0x11000
    s_nop 0
    buffer_load_dwordx4 v15, s[12:15], s43 offen lds
    s_add_u32 s43, s41, 0x100000
    s_add_u32 m0, s51, 0x12000
    s_nop 0
    buffer_load_dwordx4 v15, s[12:15], s43 offen lds
    s_add_u32 s43, s41, 0x180000
    s_add_u32 m0, s51, 0x13000
    s_nop 0
    buffer_load_dwordx4 v15, s[12:15], s43 offen lds
    s_add_u32 s43, s41, 0x200000
    s_add_u32 m0, s51, 0x14000
    s_nop 0
    buffer_load_dwordx4 v15, s[12:15], s43 offen lds
    s_add_u32 s43, s41, 0x280000
    s_add_u32 m0, s51, 0x15000
    s_nop 0
    buffer_load_dwordx4 v15, s[12:15], s43 offen lds
    s_add_u32 s43, s41, 0x300000
    s_add_u32 m0, s51, 0x16000
    s_nop 0
    buffer_load_dwordx4 v15, s[12:15], s43 offen lds
    s_add_u32 s43, s41, 0x380000
    s_add_u32 m0, s51, 0x17000
    s_nop 0
    buffer_load_dwordx4 v15, s[12:15], s43 offen lds
    s_waitcnt vmcnt(32)
    s_barrier
    v_xor_b32 v13, 0, v11
    v_add_u32 v13, 0x10000, v13
    ds_read_b64_tr_b16 a[128:129], v13
    ds_read_b64_tr_b16 a[130:131], v13 offset:1024
    ds_read_b64_tr_b16 a[132:133], v13 offset:16384
    ds_read_b64_tr_b16 a[134:135], v13 offset:17408
    ds_read_b64_tr_b16 a[144:145], v13 offset:4096
    ds_read_b64_tr_b16 a[146:147], v13 offset:5120
    ds_read_b64_tr_b16 a[148:149], v13 offset:20480
    ds_read_b64_tr_b16 a[150:151], v13 offset:21504
    s_waitcnt lgkmcnt(0)
    v_xor_b32 v13, 32, v11
    v_add_u32 v13, 0x10000, v13
    ds_read_b64_tr_b16 a[136:137], v13
    ds_read_b64_tr_b16 a[138:139], v13 offset:1024
    ds_read_b64_tr_b16 a[140:141], v13 offset:16384
    ds_read_b64_tr_b16 a[142:143], v13 offset:17408
    ds_read_b64_tr_b16 a[152:153], v13 offset:4096
    ds_read_b64_tr_b16 a[154:155], v13 offset:5120
    ds_read_b64_tr_b16 a[156:157], v13 offset:20480
    ds_read_b64_tr_b16 a[158:159], v13 offset:21504
    s_waitcnt lgkmcnt(0)
    s_barrier
    v_xor_b32 v15, 2, v14
    v_lshl_add_u32 v15, v15, 15, v8
    s_add_u32 s43, s41, 0x0
    s_add_u32 m0, s51, 0x18000
    s_nop 0
    buffer_load_dwordx4 v15, s[12:15], s43 offen lds
    s_add_u32 s43, s41, 0x80000
    s_add_u32 m0, s51, 0x19000
    s_nop 0
    buffer_load_dwordx4 v15, s[12:15], s43 offen lds
    s_add_u32 s43, s41, 0x100000
    s_add_u32 m0, s51, 0x1a000
    s_nop 0
    buffer_load_dwordx4 v15, s[12:15], s43 offen lds
    s_add_u32 s43, s41, 0x180000
    s_add_u32 m0, s51, 0x1b000
    s_nop 0
    buffer_load_dwordx4 v15, s[12:15], s43 offen lds
    s_add_u32 s43, s41, 0x200000
    s_add_u32 m0, s51, 0x1c000
    s_nop 0
    buffer_load_dwordx4 v15, s[12:15], s43 offen lds
    s_add_u32 s43, s41, 0x280000
    s_add_u32 m0, s51, 0x1d000
    s_nop 0
    buffer_load_dwordx4 v15, s[12:15], s43 offen lds
    s_add_u32 s43, s41, 0x300000
    s_add_u32 m0, s51, 0x1e000
    s_nop 0
    buffer_load_dwordx4 v15, s[12:15], s43 offen lds
    s_add_u32 s43, s41, 0x380000
    s_add_u32 m0, s51, 0x1f000
    s_nop 0
    buffer_load_dwordx4 v15, s[12:15], s43 offen lds
    s_waitcnt vmcnt(32)
    s_barrier
    v_xor_b32 v13, 0, v11
    v_add_u32 v13, 0x18000, v13
    ds_read_b64_tr_b16 a[160:161], v13
    ds_read_b64_tr_b16 a[162:163], v13 offset:1024
    ds_read_b64_tr_b16 a[164:165], v13 offset:16384
    ds_read_b64_tr_b16 a[166:167], v13 offset:17408
    ds_read_b64_tr_b16 a[176:177], v13 offset:4096
    ds_read_b64_tr_b16 a[178:179], v13 offset:5120
    ds_read_b64_tr_b16 a[180:181], v13 offset:20480
    ds_read_b64_tr_b16 a[182:183], v13 offset:21504
    s_waitcnt lgkmcnt(0)
    v_xor_b32 v13, 32, v11
    v_add_u32 v13, 0x18000, v13
    ds_read_b64_tr_b16 a[168:169], v13
    ds_read_b64_tr_b16 a[170:171], v13 offset:1024
    ds_read_b64_tr_b16 a[172:173], v13 offset:16384
    ds_read_b64_tr_b16 a[174:175], v13 offset:17408
    ds_read_b64_tr_b16 a[184:185], v13 offset:4096
    ds_read_b64_tr_b16 a[186:187], v13 offset:5120
    ds_read_b64_tr_b16 a[188:189], v13 offset:20480
    ds_read_b64_tr_b16 a[190:191], v13 offset:21504
    s_waitcnt lgkmcnt(0)
    s_barrier
    v_xor_b32 v15, 3, v14
    v_lshl_add_u32 v15, v15, 15, v8
    s_add_u32 s43, s41, 0x0
    s_add_u32 m0, s51, 0x20000
    s_nop 0
    buffer_load_dwordx4 v15, s[12:15], s43 offen lds
    s_add_u32 s43, s41, 0x80000
    s_add_u32 m0, s51, 0x21000
    s_nop 0
    buffer_load_dwordx4 v15, s[12:15], s43 offen lds
    s_add_u32 s43, s41, 0x100000
    s_add_u32 m0, s51, 0x22000
    s_nop 0
    buffer_load_dwordx4 v15, s[12:15], s43 offen lds
    s_add_u32 s43, s41, 0x180000
    s_add_u32 m0, s51, 0x23000
    s_nop 0
    buffer_load_dwordx4 v15, s[12:15], s43 offen lds
    s_add_u32 s43, s41, 0x200000
    s_add_u32 m0, s51, 0x24000
    s_nop 0
    buffer_load_dwordx4 v15, s[12:15], s43 offen lds
    s_add_u32 s43, s41, 0x280000
    s_add_u32 m0, s51, 0x25000
    s_nop 0
    buffer_load_dwordx4 v15, s[12:15], s43 offen lds
    s_add_u32 s43, s41, 0x300000
    s_add_u32 m0, s51, 0x26000
    s_nop 0
    buffer_load_dwordx4 v15, s[12:15], s43 offen lds
    s_add_u32 s43, s41, 0x380000
    s_add_u32 m0, s51, 0x27000
    s_nop 0
    buffer_load_dwordx4 v15, s[12:15], s43 offen lds
    s_waitcnt vmcnt(24)
    v_min_u32 v21, 0xfffffffe, v21
    s_mov_b32 s43, 0x10000
    s_mov_b64 exec, s[38:39]
    buffer_store_dword v21, v119, s[8:11], s43 offen
    s_mov_b64 exec, -1
    s_barrier
    v_xor_b32 v13, 0, v11
    v_add_u32 v13, 0x0, v13
    ds_read_b64_tr_b16 a[192:193], v13
    ds_read_b64_tr_b16 a[194:195], v13 offset:1024
    ds_read_b64_tr_b16 a[196:197], v13 offset:16384
    ds_read_b64_tr_b16 a[198:199], v13 offset:17408
    ds_read_b64_tr_b16 a[208:209], v13 offset:4096
    ds_read_b64_tr_b16 a[210:211], v13 offset:5120
    ds_read_b64_tr_b16 a[212:213], v13 offset:20480
    ds_read_b64_tr_b16 a[214:215], v13 offset:21504
    s_waitcnt lgkmcnt(0)
    v_xor_b32 v13, 32, v11
    v_add_u32 v13, 0x0, v13
    ds_read_b64_tr_b16 a[200:201], v13
    ds_read_b64_tr_b16 a[202:203], v13 offset:1024
    ds_read_b64_tr_b16 a[204:205], v13 offset:16384
    ds_read_b64_tr_b16 a[206:207], v13 offset:17408
    ds_read_b64_tr_b16 a[216:217], v13 offset:4096
    ds_read_b64_tr_b16 a[218:219], v13 offset:5120
    ds_read_b64_tr_b16 a[220:221], v13 offset:20480
    ds_read_b64_tr_b16 a[222:223], v13 offset:21504
    s_waitcnt lgkmcnt(0)
    s_barrier
    s_mov_b32 s12, s66
    s_and_b32 s13, s67, 0xffff
    s_add_u32 s43, s42, 0x0
    s_add_u32 m0, s51, 0x8000
    s_nop 0
    buffer_load_dwordx4 v10, s[12:15], s43 offen lds
    s_add_u32 s43, s42, 0x4000
    s_add_u32 m0, s51, 0x9000
    s_nop 0
    buffer_load_dwordx4 v9, s[12:15], s43 offen lds
    s_add_u32 s43, s42, 0x8000
    s_add_u32 m0, s51, 0xa000
    s_nop 0
    buffer_load_dwordx4 v10, s[12:15], s43 offen lds
    s_add_u32 s43, s42, 0xc000
    s_add_u32 m0, s51, 0xb000
    s_nop 0
    buffer_load_dwordx4 v9, s[12:15], s43 offen lds
    s_add_u32 s43, s42, 0x10000
    s_add_u32 m0, s51, 0xc000
    s_nop 0
    buffer_load_dwordx4 v10, s[12:15], s43 offen lds
    s_add_u32 s43, s42, 0x14000
    s_add_u32 m0, s51, 0xd000
    s_nop 0
    buffer_load_dwordx4 v9, s[12:15], s43 offen lds
    s_add_u32 s43, s42, 0x18000
    s_add_u32 m0, s51, 0xe000
    s_nop 0
    buffer_load_dwordx4 v10, s[12:15], s43 offen lds
    s_add_u32 s43, s42, 0x1c000
    s_add_u32 m0, s51, 0xf000
    s_nop 0
    buffer_load_dwordx4 v9, s[12:15], s43 offen lds
    s_waitcnt vmcnt(24)
    s_barrier
    v_xor_b32 v13, 0, v11
    v_add_u32 v13, 0x8000, v13
    ds_read_b64_tr_b16 a[224:225], v13
    ds_read_b64_tr_b16 a[226:227], v13 offset:1024
    ds_read_b64_tr_b16 a[228:229], v13 offset:16384
    ds_read_b64_tr_b16 a[230:231], v13 offset:17408
    ds_read_b64_tr_b16 a[240:241], v13 offset:4096
    ds_read_b64_tr_b16 a[242:243], v13 offset:5120
    ds_read_b64_tr_b16 a[244:245], v13 offset:20480
    ds_read_b64_tr_b16 a[246:247], v13 offset:21504
    s_waitcnt lgkmcnt(0)
    v_xor_b32 v13, 32, v11
    v_add_u32 v13, 0x8000, v13
    ds_read_b64_tr_b16 a[232:233], v13
    ds_read_b64_tr_b16 a[234:235], v13 offset:1024
    ds_read_b64_tr_b16 a[236:237], v13 offset:16384
    ds_read_b64_tr_b16 a[238:239], v13 offset:17408
    ds_read_b64_tr_b16 a[248:249], v13 offset:4096
    ds_read_b64_tr_b16 a[250:251], v13 offset:5120
    ds_read_b64_tr_b16 a[252:253], v13 offset:20480
    ds_read_b64_tr_b16 a[254:255], v13 offset:21504
    s_waitcnt lgkmcnt(0)
    s_barrier
    s_add_u32 s43, s42, 0x40
    s_add_u32 m0, s51, 0x10000
    s_nop 0
    buffer_load_dwordx4 v10, s[12:15], s43 offen lds
    s_add_u32 s43, s42, 0x4040
    s_add_u32 m0, s51, 0x11000
    s_nop 0
    buffer_load_dwordx4 v9, s[12:15], s43 offen lds
    s_add_u32 s43, s42, 0x8040
    s_add_u32 m0, s51, 0x12000
    s_nop 0
    buffer_load_dwordx4 v10, s[12:15], s43 offen lds
    s_add_u32 s43, s42, 0xc040
    s_add_u32 m0, s51, 0x13000
    s_nop 0
    buffer_load_dwordx4 v9, s[12:15], s43 offen lds
    s_add_u32 s43, s42, 0x10040
    s_add_u32 m0, s51, 0x14000
    s_nop 0
    buffer_load_dwordx4 v10, s[12:15], s43 offen lds
    s_add_u32 s43, s42, 0x14040
    s_add_u32 m0, s51, 0x15000
    s_nop 0
    buffer_load_dwordx4 v9, s[12:15], s43 offen lds
    s_add_u32 s43, s42, 0x18040
    s_add_u32 m0, s51, 0x16000
    s_nop 0
    buffer_load_dwordx4 v10, s[12:15], s43 offen lds
    s_add_u32 s43, s42, 0x1c040
    s_add_u32 m0, s51, 0x17000
    s_nop 0
    buffer_load_dwordx4 v9, s[12:15], s43 offen lds
    s_waitcnt vmcnt(24)
    s_barrier
    v_xor_b32 v13, 0, v11
    v_add_u32 v13, 0x10000, v13
    ds_read_b64_tr_b16 v[128:129], v13
    ds_read_b64_tr_b16 v[130:131], v13 offset:1024
    ds_read_b64_tr_b16 v[132:133], v13 offset:16384
    ds_read_b64_tr_b16 v[134:135], v13 offset:17408
    ds_read_b64_tr_b16 v[144:145], v13 offset:4096
    ds_read_b64_tr_b16 v[146:147], v13 offset:5120
    ds_read_b64_tr_b16 v[148:149], v13 offset:20480
    ds_read_b64_tr_b16 v[150:151], v13 offset:21504
    s_waitcnt lgkmcnt(0)
    v_xor_b32 v13, 32, v11
    v_add_u32 v13, 0x10000, v13
    ds_read_b64_tr_b16 v[136:137], v13
    ds_read_b64_tr_b16 v[138:139], v13 offset:1024
    ds_read_b64_tr_b16 v[140:141], v13 offset:16384
    ds_read_b64_tr_b16 v[142:143], v13 offset:17408
    ds_read_b64_tr_b16 v[152:153], v13 offset:4096
    ds_read_b64_tr_b16 v[154:155], v13 offset:5120
    ds_read_b64_tr_b16 v[156:157], v13 offset:20480
    ds_read_b64_tr_b16 v[158:159], v13 offset:21504
    s_waitcnt lgkmcnt(0)
    s_barrier
    s_mov_b32 s12, s62
    s_and_b32 s13, s63, 0xffff
    v_xor_b32 v15, 1, v14
    v_lshl_add_u32 v15, v15, 15, v8
    s_add_u32 s43, s41, 0x0
    s_add_u32 m0, s51, 0x18000
    s_nop 0
    buffer_load_dwordx4 v15, s[12:15], s43 offen lds
    s_add_u32 s43, s41, 0x80000
    s_add_u32 m0, s51, 0x19000
    s_nop 0
    buffer_load_dwordx4 v15, s[12:15], s43 offen lds
    s_add_u32 s43, s41, 0x100000
    s_add_u32 m0, s51, 0x1a000
    s_nop 0
    buffer_load_dwordx4 v15, s[12:15], s43 offen lds
    s_add_u32 s43, s41, 0x180000
    s_add_u32 m0, s51, 0x1b000
    s_nop 0
    buffer_load_dwordx4 v15, s[12:15], s43 offen lds
    s_add_u32 s43, s41, 0x200000
    s_add_u32 m0, s51, 0x1c000
    s_nop 0
    buffer_load_dwordx4 v15, s[12:15], s43 offen lds
    s_add_u32 s43, s41, 0x280000
    s_add_u32 m0, s51, 0x1d000
    s_nop 0
    buffer_load_dwordx4 v15, s[12:15], s43 offen lds
    s_add_u32 s43, s41, 0x300000
    s_add_u32 m0, s51, 0x1e000
    s_nop 0
    buffer_load_dwordx4 v15, s[12:15], s43 offen lds
    s_add_u32 s43, s41, 0x380000
    s_add_u32 m0, s51, 0x1f000
    s_nop 0
    buffer_load_dwordx4 v15, s[12:15], s43 offen lds
    s_waitcnt vmcnt(24)
    s_barrier
    v_xor_b32 v13, 0, v11
    v_add_u32 v13, 0x18000, v13
    ds_read_b64_tr_b16 v[160:161], v13
    ds_read_b64_tr_b16 v[162:163], v13 offset:1024
    ds_read_b64_tr_b16 v[164:165], v13 offset:16384
    ds_read_b64_tr_b16 v[166:167], v13 offset:17408
    ds_read_b64_tr_b16 v[176:177], v13 offset:4096
    ds_read_b64_tr_b16 v[178:179], v13 offset:5120
    ds_read_b64_tr_b16 v[180:181], v13 offset:20480
    ds_read_b64_tr_b16 v[182:183], v13 offset:21504
    s_waitcnt lgkmcnt(0)
    v_xor_b32 v13, 32, v11
    v_add_u32 v13, 0x18000, v13
    ds_read_b64_tr_b16 v[168:169], v13
    ds_read_b64_tr_b16 v[170:171], v13 offset:1024
    ds_read_b64_tr_b16 v[172:173], v13 offset:16384
    ds_read_b64_tr_b16 v[174:175], v13 offset:17408
    ds_read_b64_tr_b16 v[184:185], v13 offset:4096
    ds_read_b64_tr_b16 v[186:187], v13 offset:5120
    ds_read_b64_tr_b16 v[188:189], v13 offset:20480
    ds_read_b64_tr_b16 v[190:191], v13 offset:21504
    s_waitcnt lgkmcnt(0)
    s_barrier
    s_mov_b32 s12, s60
    s_and_b32 s13, s61, 0xffff
    v_xor_b32 v15, 1, v14
    v_lshl_add_u32 v15, v15, 15, v8
    s_add_u32 s43, s41, 0x0
    s_add_u32 m0, s51, 0x20000
    s_nop 0
    buffer_load_dwordx4 v15, s[12:15], s43 offen lds
    s_add_u32 s43, s41, 0x80000
    s_add_u32 m0, s51, 0x21000
    s_nop 0
    buffer_load_dwordx4 v15, s[12:15], s43 offen lds
    s_add_u32 s43, s41, 0x100000
    s_add_u32 m0, s51, 0x22000
    s_nop 0
    buffer_load_dwordx4 v15, s[12:15], s43 offen lds
    s_add_u32 s43, s41, 0x180000
    s_add_u32 m0, s51, 0x23000
    s_nop 0
    buffer_load_dwordx4 v15, s[12:15], s43 offen lds
    s_add_u32 s43, s41, 0x200000
    s_add_u32 m0, s51, 0x24000
    s_nop 0
    buffer_load_dwordx4 v15, s[12:15], s43 offen lds
    s_add_u32 s43, s41, 0x280000
    s_add_u32 m0, s51, 0x25000
    s_nop 0
    buffer_load_dwordx4 v15, s[12:15], s43 offen lds
    s_add_u32 s43, s41, 0x300000
    s_add_u32 m0, s51, 0x26000
    s_nop 0
    buffer_load_dwordx4 v15, s[12:15], s43 offen lds
    s_add_u32 s43, s41, 0x380000
    s_add_u32 m0, s51, 0x27000
    s_nop 0
    buffer_load_dwordx4 v15, s[12:15], s43 offen lds
    s_waitcnt vmcnt(24)
    s_barrier
    v_xor_b32 v13, 0x0, v12
    v_add_u32 v13, 0x0, v13
    ds_read_b64_tr_b16 v[192:193], v13
    ds_read_b64_tr_b16 v[194:195], v13 offset:512
    ds_read_b64_tr_b16 v[196:197], v13 offset:2048
    ds_read_b64_tr_b16 v[198:199], v13 offset:2560
    v_xor_b32 v13, 0x2000, v12
    v_add_u32 v13, 0x0, v13
    ds_read_b64_tr_b16 v[200:201], v13
    ds_read_b64_tr_b16 v[202:203], v13 offset:512
    ds_read_b64_tr_b16 v[204:205], v13 offset:2048
    ds_read_b64_tr_b16 v[206:207], v13 offset:2560
    s_waitcnt lgkmcnt(0)
    v_xor_b32 v13, 0x4000, v12
    v_add_u32 v13, 0x0, v13
    ds_read_b64_tr_b16 v[208:209], v13
    ds_read_b64_tr_b16 v[210:211], v13 offset:512
    ds_read_b64_tr_b16 v[212:213], v13 offset:2048
    ds_read_b64_tr_b16 v[214:215], v13 offset:2560
    v_xor_b32 v13, 0x6000, v12
    v_add_u32 v13, 0x0, v13
    ds_read_b64_tr_b16 v[216:217], v13
    ds_read_b64_tr_b16 v[218:219], v13 offset:512
    ds_read_b64_tr_b16 v[220:221], v13 offset:2048
    ds_read_b64_tr_b16 v[222:223], v13 offset:2560
    s_waitcnt lgkmcnt(0)
    s_barrier
    v_xor_b32 v15, 0, v14
    v_lshl_add_u32 v15, v15, 15, v8
    s_add_u32 s43, s41, 0x0
    s_add_u32 m0, s51, 0x8000
    s_nop 0
    buffer_load_dwordx4 v15, s[12:15], s43 offen lds
    s_add_u32 s43, s41, 0x80000
    s_add_u32 m0, s51, 0x9000
    s_nop 0
    buffer_load_dwordx4 v15, s[12:15], s43 offen lds
    s_add_u32 s43, s41, 0x100000
    s_add_u32 m0, s51, 0xa000
    s_nop 0
    buffer_load_dwordx4 v15, s[12:15], s43 offen lds
    s_add_u32 s43, s41, 0x180000
    s_add_u32 m0, s51, 0xb000
    s_nop 0
    buffer_load_dwordx4 v15, s[12:15], s43 offen lds
    s_add_u32 s43, s41, 0x200000
    s_add_u32 m0, s51, 0xc000
    s_nop 0
    buffer_load_dwordx4 v15, s[12:15], s43 offen lds
    s_add_u32 s43, s41, 0x280000
    s_add_u32 m0, s51, 0xd000
    s_nop 0
    buffer_load_dwordx4 v15, s[12:15], s43 offen lds
    s_add_u32 s43, s41, 0x300000
    s_add_u32 m0, s51, 0xe000
    s_nop 0
    buffer_load_dwordx4 v15, s[12:15], s43 offen lds
    s_add_u32 s43, s41, 0x380000
    s_add_u32 m0, s51, 0xf000
    s_nop 0
    buffer_load_dwordx4 v15, s[12:15], s43 offen lds
    s_waitcnt vmcnt(24)
    s_barrier
    s_cmp_lg_u32 s21, 0
    s_cbranch_scc1 L_arr_4
    v_mov_b32 v23, 1
    s_mov_b64 exec, 1
    buffer_atomic_add v23, off, s[16:19], 0 offset:4
    s_mov_b64 exec, -1
L_arr_4:
    v_xor_b32 v13, 0x0, v12
    v_add_u32 v13, 0x8000, v13
    ds_read_b64_tr_b16 v[224:225], v13
    ds_read_b64_tr_b16 v[226:227], v13 offset:512
    ds_read_b64_tr_b16 v[228:229], v13 offset:2048
    ds_read_b64_tr_b16 v[230:231], v13 offset:2560
    v_xor_b32 v13, 0x2000, v12
    v_add_u32 v13, 0x8000, v13
    ds_read_b64_tr_b16 v[232:233], v13
    ds_read_b64_tr_b16 v[234:235], v13 offset:512
    ds_read_b64_tr_b16 v[236:237], v13 offset:2048
    ds_read_b64_tr_b16 v[238:239], v13 offset:2560
    s_waitcnt lgkmcnt(0)
    v_xor_b32 v13, 0x4000, v12
    v_add_u32 v13, 0x8000, v13
    ds_read_b64_tr_b16 v[240:241], v13
    ds_read_b64_tr_b16 v[242:243], v13 offset:512
    ds_read_b64_tr_b16 v[244:245], v13 offset:2048
    ds_read_b64_tr_b16 v[246:247], v13 offset:2560
    v_xor_b32 v13, 0x6000, v12
    v_add_u32 v13, 0x8000, v13
    ds_read_b64_tr_b16 v[248:249], v13
    ds_read_b64_tr_b16 v[250:251], v13 offset:512
    ds_read_b64_tr_b16 v[252:253], v13 offset:2048
    ds_read_b64_tr_b16 v[254:255], v13 offset:2560
    s_waitcnt lgkmcnt(0)
    s_barrier
    s_mov_b32 s12, s62
    s_and_b32 s13, s63, 0xffff
    v_xor_b32 v15, 0, v14
    v_lshl_add_u32 v15, v15, 15, v8
    s_add_u32 s43, s41, 0x0
    s_add_u32 m0, s51, 0x10000
    s_nop 0
    buffer_load_dwordx4 v15, s[12:15], s43 offen lds
    s_add_u32 s43, s41, 0x80000
    s_add_u32 m0, s51, 0x11000
    s_nop 0
    buffer_load_dwordx4 v15, s[12:15], s43 offen lds
    s_add_u32 s43, s41, 0x100000
    s_add_u32 m0, s51, 0x12000
    s_nop 0
    buffer_load_dwordx4 v15, s[12:15], s43 offen lds
    s_add_u32 s43, s41, 0x180000
    s_add_u32 m0, s51, 0x13000
    s_nop 0
    buffer_load_dwordx4 v15, s[12:15], s43 offen lds
    s_add_u32 s43, s41, 0x200000
    s_add_u32 m0, s51, 0x14000
    s_nop 0
    buffer_load_dwordx4 v15, s[12:15], s43 offen lds
    s_add_u32 s43, s41, 0x280000
    s_add_u32 m0, s51, 0x15000
    s_nop 0
    buffer_load_dwordx4 v15, s[12:15], s43 offen lds
    s_add_u32 s43, s41, 0x300000
    s_add_u32 m0, s51, 0x16000
    s_nop 0
    buffer_load_dwordx4 v15, s[12:15], s43 offen lds
    s_add_u32 s43, s41, 0x380000
    s_add_u32 m0, s51, 0x17000
    s_nop 0
    buffer_load_dwordx4 v15, s[12:15], s43 offen lds
    s_waitcnt vmcnt(24)
    s_barrier
    v_xor_b32 v13, 0, v11
    v_add_u32 v13, 0x10000, v13
    ds_read_b64_tr_b16 a[96:97], v13
    ds_read_b64_tr_b16 a[98:99], v13 offset:1024
    ds_read_b64_tr_b16 a[100:101], v13 offset:16384
    ds_read_b64_tr_b16 a[102:103], v13 offset:17408
    ds_read_b64_tr_b16 a[112:113], v13 offset:4096
    ds_read_b64_tr_b16 a[114:115], v13 offset:5120
    ds_read_b64_tr_b16 a[116:117], v13 offset:20480
    ds_read_b64_tr_b16 a[118:119], v13 offset:21504
    s_waitcnt lgkmcnt(0)
    v_xor_b32 v13, 32, v11
    v_add_u32 v13, 0x10000, v13
    ds_read_b64_tr_b16 a[104:105], v13
    ds_read_b64_tr_b16 a[106:107], v13 offset:1024
    ds_read_b64_tr_b16 a[108:109], v13 offset:16384
    ds_read_b64_tr_b16 a[110:111], v13 offset:17408
    ds_read_b64_tr_b16 a[120:121], v13 offset:4096
    ds_read_b64_tr_b16 a[122:123], v13 offset:5120
    ds_read_b64_tr_b16 a[124:125], v13 offset:20480
    ds_read_b64_tr_b16 a[126:127], v13 offset:21504
    s_waitcnt lgkmcnt(0)
    s_barrier
    s_mov_b32 s12, s66
    s_and_b32 s13, s67, 0xffff
    s_add_u32 s43, s42, 0x80
    s_add_u32 m0, s51, 0x18000
    s_nop 0
    buffer_load_dwordx4 v10, s[12:15], s43 offen lds
    s_add_u32 s43, s42, 0x4080
    s_add_u32 m0, s51, 0x19000
    s_nop 0
    buffer_load_dwordx4 v9, s[12:15], s43 offen lds
    s_add_u32 s43, s42, 0x8080
    s_add_u32 m0, s51, 0x1a000
    s_nop 0
    buffer_load_dwordx4 v10, s[12:15], s43 offen lds
    s_add_u32 s43, s42, 0xc080
    s_add_u32 m0, s51, 0x1b000
    s_nop 0
    buffer_load_dwordx4 v9, s[12:15], s43 offen lds
    s_add_u32 s43, s42, 0x10080
    s_add_u32 m0, s51, 0x1c000
    s_nop 0
    buffer_load_dwordx4 v10, s[12:15], s43 offen lds
    s_add_u32 s43, s42, 0x14080
    s_add_u32 m0, s51, 0x1d000
    s_nop 0
    buffer_load_dwordx4 v9, s[12:15], s43 offen lds
    s_add_u32 s43, s42, 0x18080
    s_add_u32 m0, s51, 0x1e000
    s_nop 0
    buffer_load_dwordx4 v10, s[12:15], s43 offen lds
    s_add_u32 s43, s42, 0x1c080
    s_add_u32 m0, s51, 0x1f000
    s_nop 0
    buffer_load_dwordx4 v9, s[12:15], s43 offen lds
    s_waitcnt vmcnt(24)
    s_barrier
    v_xor_b32 v13, 0, v11
    v_add_u32 v13, 0x18000, v13
    ds_read_b64_tr_b16 a[0:1], v13
    ds_read_b64_tr_b16 a[2:3], v13 offset:1024
    ds_read_b64_tr_b16 a[4:5], v13 offset:16384
    ds_read_b64_tr_b16 a[6:7], v13 offset:17408
    ds_read_b64_tr_b16 a[16:17], v13 offset:4096
    ds_read_b64_tr_b16 a[18:19], v13 offset:5120
    ds_read_b64_tr_b16 a[20:21], v13 offset:20480
    ds_read_b64_tr_b16 a[22:23], v13 offset:21504
    s_waitcnt lgkmcnt(0)
    v_xor_b32 v13, 32, v11
    v_add_u32 v13, 0x18000, v13
    ds_read_b64_tr_b16 a[8:9], v13
    ds_read_b64_tr_b16 a[10:11], v13 offset:1024
    ds_read_b64_tr_b16 a[12:13], v13 offset:16384
    ds_read_b64_tr_b16 a[14:15], v13 offset:17408
    ds_read_b64_tr_b16 a[24:25], v13 offset:4096
    ds_read_b64_tr_b16 a[26:27], v13 offset:5120
    ds_read_b64_tr_b16 a[28:29], v13 offset:20480
    ds_read_b64_tr_b16 a[30:31], v13 offset:21504
    s_waitcnt lgkmcnt(0)
    s_barrier
    s_lshl_b32 s43, s20, 13
    s_add_u32 s43, s43, 0x100000
    s_add_u32 s43, s43, s52
    s_xor_b32 s40, s43, 0x40000
    buffer_load_dwordx4 v[28:31], v117, s[8:11], s43 offen sc1
    buffer_load_dwordx4 v[28:31], v117, s[8:11], s43 offen offset:1024 sc1
    buffer_load_dwordx4 v[28:31], v117, s[8:11], s40 offen sc1
    buffer_load_dwordx4 v[28:31], v117, s[8:11], s40 offen offset:1024 sc1
    s_mov_b32 s43, 0x10000
    buffer_load_dword v28, v119, s[8:11], s43 offen sc1
    s_mov_b32 s43, 0x12000
    buffer_load_dword v28, v119, s[8:11], s43 offen sc1
    s_mov_b32 s43, 0x14000
    buffer_load_dword v28, v119, s[8:11], s43 offen sc1
    s_mov_b32 s43, 0x16000
    buffer_load_dword v28, v119, s[8:11], s43 offen sc1
    s_add_u32 s43, s42, 0xc0
    s_add_u32 m0, s51, 0x20000
    s_nop 0
    buffer_load_dwordx4 v10, s[12:15], s43 offen lds
    s_add_u32 s43, s42, 0x40c0
    s_add_u32 m0, s51, 0x21000
    s_nop 0
    buffer_load_dwordx4 v9, s[12:15], s43 offen lds
    s_add_u32 s43, s42, 0x80c0
    s_add_u32 m0, s51, 0x22000
    s_nop 0
    buffer_load_dwordx4 v10, s[12:15], s43 offen lds
    s_add_u32 s43, s42, 0xc0c0
    s_add_u32 m0, s51, 0x23000
    s_nop 0
    buffer_load_dwordx4 v9, s[12:15], s43 offen lds
    s_add_u32 s43, s42, 0x100c0
    s_add_u32 m0, s51, 0x24000
    s_nop 0
    buffer_load_dwordx4 v10, s[12:15], s43 offen lds
    s_add_u32 s43, s42, 0x140c0
    s_add_u32 m0, s51, 0x25000
    s_nop 0
    buffer_load_dwordx4 v9, s[12:15], s43 offen lds
    s_add_u32 s43, s42, 0x180c0
    s_add_u32 m0, s51, 0x26000
    s_nop 0
    buffer_load_dwordx4 v10, s[12:15], s43 offen lds
    s_add_u32 s43, s42, 0x1c0c0
    s_add_u32 m0, s51, 0x27000
    s_nop 0
    buffer_load_dwordx4 v9, s[12:15], s43 offen lds
    s_waitcnt vmcnt(32)
    s_barrier
    v_xor_b32 v13, 0, v11
    v_add_u32 v13, 0x0, v13
    ds_read_b64_tr_b16 v[32:33], v13
    ds_read_b64_tr_b16 v[34:35], v13 offset:1024
    ds_read_b64_tr_b16 v[36:37], v13 offset:16384
    ds_read_b64_tr_b16 v[38:39], v13 offset:17408
    ds_read_b64_tr_b16 v[48:49], v13 offset:4096
    ds_read_b64_tr_b16 v[50:51], v13 offset:5120
    ds_read_b64_tr_b16 v[52:53], v13 offset:20480
    ds_read_b64_tr_b16 v[54:55], v13 offset:21504
    s_waitcnt lgkmcnt(0)
    v_xor_b32 v13, 32, v11
    v_add_u32 v13, 0x0, v13
    ds_read_b64_tr_b16 v[40:41], v13
    ds_read_b64_tr_b16 v[42:43], v13 offset:1024
    ds_read_b64_tr_b16 v[44:45], v13 offset:16384
    ds_read_b64_tr_b16 v[46:47], v13 offset:17408
    ds_read_b64_tr_b16 v[56:57], v13 offset:4096
    ds_read_b64_tr_b16 v[58:59], v13 offset:5120
    ds_read_b64_tr_b16 v[60:61], v13 offset:20480
    ds_read_b64_tr_b16 v[62:63], v13 offset:21504
    s_waitcnt lgkmcnt(0)
    s_barrier
    ds_write_b128 v123, v[32:35]
    ds_write_b128 v123, v[36:39] offset:1024
    ds_write_b128 v123, v[40:43] offset:2048
    ds_write_b128 v123, v[44:47] offset:3072
    ds_write_b128 v123, v[48:51] offset:4096
    ds_write_b128 v123, v[52:55] offset:5120
    ds_write_b128 v123, v[56:59] offset:6144
    ds_write_b128 v123, v[60:63] offset:7168
    s_waitcnt vmcnt(24)
    s_barrier
    v_xor_b32 v13, 0, v11
    v_add_u32 v13, 0x8000, v13
    ds_read_b64_tr_b16 v[32:33], v13
    ds_read_b64_tr_b16 v[34:35], v13 offset:1024
    ds_read_b64_tr_b16 v[36:37], v13 offset:16384
    ds_read_b64_tr_b16 v[38:39], v13 offset:17408
    ds_read_b64_tr_b16 v[48:49], v13 offset:4096
    ds_read_b64_tr_b16 v[50:51], v13 offset:5120
    ds_read_b64_tr_b16 v[52:53], v13 offset:20480
    ds_read_b64_tr_b16 v[54:55], v13 offset:21504
    s_waitcnt lgkmcnt(0)
    v_xor_b32 v13, 32, v11
    v_add_u32 v13, 0x8000, v13
    ds_read_b64_tr_b16 v[40:41], v13
    ds_read_b64_tr_b16 v[42:43], v13 offset:1024
    ds_read_b64_tr_b16 v[44:45], v13 offset:16384
    ds_read_b64_tr_b16 v[46:47], v13 offset:17408
    ds_read_b64_tr_b16 v[56:57], v13 offset:4096
    ds_read_b64_tr_b16 v[58:59], v13 offset:5120
    ds_read_b64_tr_b16 v[60:61], v13 offset:20480
    ds_read_b64_tr_b16 v[62:63], v13 offset:21504
    s_waitcnt lgkmcnt(0)
    s_barrier
    ds_write_b128 v123, v[32:35] offset:32768
    ds_write_b128 v123, v[36:39] offset:33792
    ds_write_b128 v123, v[40:43] offset:34816
    ds_write_b128 v123, v[44:47] offset:35840
    ds_write_b128 v123, v[48:51] offset:36864
    ds_write_b128 v123, v[52:55] offset:37888
    ds_write_b128 v123, v[56:59] offset:38912
    ds_write_b128 v123, v[60:63] offset:39936
    s_waitcnt vmcnt(16)
    s_barrier
    v_xor_b32 v13, 0x0, v12
    v_add_u32 v13, 0x10000, v13
    ds_read_b64_tr_b16 v[32:33], v13
    ds_read_b64_tr_b16 v[34:35], v13 offset:512
    ds_read_b64_tr_b16 v[36:37], v13 offset:2048
    ds_read_b64_tr_b16 v[38:39], v13 offset:2560
    v_xor_b32 v13, 0x2000, v12
    v_add_u32 v13, 0x10000, v13
    ds_read_b64_tr_b16 v[40:41], v13
    ds_read_b64_tr_b16 v[42:43], v13 offset:512
    ds_read_b64_tr_b16 v[44:45], v13 offset:2048
    ds_read_b64_tr_b16 v[46:47], v13 offset:2560
    s_waitcnt lgkmcnt(0)
    v_xor_b32 v13, 0x4000, v12
    v_add_u32 v13, 0x10000, v13
    ds_read_b64_tr_b16 v[48:49], v13
    ds_read_b64_tr_b16 v[50:51], v13 offset:512
    ds_read_b64_tr_b16 v[52:53], v13 offset:2048
    ds_read_b64_tr_b16 v[54:55], v13 offset:2560
    v_xor_b32 v13, 0x6000, v12
    v_add_u32 v13, 0x10000, v13
    ds_read_b64_tr_b16 v[56:57], v13
    ds_read_b64_tr_b16 v[58:59], v13 offset:512
    ds_read_b64_tr_b16 v[60:61], v13 offset:2048
    ds_read_b64_tr_b16 v[62:63], v13 offset:2560
    s_waitcnt lgkmcnt(0)
    s_barrier
    ds_write_b128 v124, v[32:35]
    ds_write_b128 v124, v[36:39] offset:1024
    ds_write_b128 v124, v[40:43] offset:2048
    ds_write_b128 v124, v[44:47] offset:3072
    ds_write_b128 v124, v[48:51] offset:4096
    ds_write_b128 v124, v[52:55] offset:5120
    ds_write_b128 v124, v[56:59] offset:6144
    ds_write_b128 v124, v[60:63] offset:7168
    s_waitcnt vmcnt(0)
    v_min_u32 v21, 0xfffffffe, v21
    s_mov_b32 s43, 0x10000
    s_mov_b64 exec, s[38:39]
    buffer_store_dword v21, v119, s[8:11], s43 offen
    s_mov_b64 exec, -1
    v_mov_b32 v16, -1
    v_mov_b32 v17, -1
    v_mov_b32 v18, -1
    v_mov_b32 v19, -1
    s_lshl_b32 s43, s20, 13
    s_add_u32 s43, s43, 0x100000
    s_and_b32 s40, s21, 1
    s_lshl_b32 s40, s40, 12
    s_add_u32 s29, s43, s40
    s_add_u32 s43, s43, s52
    s_xor_b32 s40, s43, 0x40000
    buffer_store_dwordx4 v[16:19], v117, s[8:11], s40 offen
    buffer_store_dwordx4 v[16:19], v117, s[8:11], s40 offen offset:1024
    s_mov_b32 s43, 0x12000
    buffer_store_dword v16, v119, s[8:11], s43 offen
    s_mov_b32 s43, 0x14000
    buffer_store_dword v16, v119, s[8:11], s43 offen
    s_mov_b32 s43, 0x16000
    buffer_store_dword v16, v119, s[8:11], s43 offen
    s_barrier
    v_xor_b32 v13, 0x0, v12
    v_add_u32 v13, 0x18000, v13
    ds_read_b64_tr_b16 v[32:33], v13
    ds_read_b64_tr_b16 v[34:35], v13 offset:512
    ds_read_b64_tr_b16 v[36:37], v13 offset:2048
    ds_read_b64_tr_b16 v[38:39], v13 offset:2560
    v_xor_b32 v13, 0x2000, v12
    v_add_u32 v13, 0x18000, v13
    ds_read_b64_tr_b16 v[40:41], v13
    ds_read_b64_tr_b16 v[42:43], v13 offset:512
    ds_read_b64_tr_b16 v[44:45], v13 offset:2048
    ds_read_b64_tr_b16 v[46:47], v13 offset:2560
    s_waitcnt lgkmcnt(0)
    v_xor_b32 v13, 0x4000, v12
    v_add_u32 v13, 0x18000, v13
    ds_read_b64_tr_b16 v[48:49], v13
    ds_read_b64_tr_b16 v[50:51], v13 offset:512
    ds_read_b64_tr_b16 v[52:53], v13 offset:2048
    ds_read_b64_tr_b16 v[54:55], v13 offset:2560
    v_xor_b32 v13, 0x6000, v12
    v_add_u32 v13, 0x18000, v13
    ds_read_b64_tr_b16 v[56:57], v13
    ds_read_b64_tr_b16 v[58:59], v13 offset:512
    ds_read_b64_tr_b16 v[60:61], v13 offset:2048
    ds_read_b64_tr_b16 v[62:63], v13 offset:2560
    s_waitcnt lgkmcnt(0)
    s_barrier
    ds_write_b128 v124, v[32:35] offset:32768
    ds_write_b128 v124, v[36:39] offset:33792
    ds_write_b128 v124, v[40:43] offset:34816
    ds_write_b128 v124, v[44:47] offset:35840
    ds_write_b128 v124, v[48:51] offset:36864
    ds_write_b128 v124, v[52:55] offset:37888
    ds_write_b128 v124, v[56:59] offset:38912
    ds_write_b128 v124, v[60:63] offset:39936
    s_waitcnt lgkmcnt(0)
    s_mov_b32 s96, 0
L_mode_5:
    buffer_load_dwordx2 v[2:3], off, s[92:95], 0 offset:36 sc1
    s_waitcnt vmcnt(0)
    v_readfirstlane_b32 s87, v2
    v_readfirstlane_b32 s97, v3
    s_nop 0
    s_min_u32 s97, s97, s87
    s_cmp_lg_u32 s97, 0
    s_cbranch_scc1 L_moded_6
    s_sleep 4
    s_add_u32 s96, s96, 1
    s_cmp_lg_u32 s96, 0x100
    s_cbranch_scc1 L_modef_7
    v_mov_b32 v2, 2
    v_mov_b32 v3, 0
    s_mov_b64 exec, 1
    buffer_atomic_cmpswap v[2:3], off, s[92:95], 0 offset:36
    s_mov_b64 exec, -1
L_modef_7:
    s_cmp_lt_u32 s96, 0x10000
    s_cbranch_scc1 L_mode_5
L_moded_6:
    s_cmp_lg_u32 s87, 1
    s_cbranch_scc1 L_fallback
    v_lshrrev_b32 v1, 4, v117
    v_and_b32 v2, 15, v1
    v_lshrrev_b32 v1, 4, v1
    v_lshlrev_b32 v1, 11, v1
    v_lshl_add_u32 v1, v2, 2, v1
    s_lshl_b32 s43, s20, 6
    s_add_u32 s43, s43, 0x2000
    s_cmp_lg_u32 s100, 0
    s_cbranch_scc1 L_polls_10
    s_mov_b32 exec_lo, 0x10001
    s_mov_b32 exec_hi, 0
    s_mov_b32 s96, 0
L_poll_8:
    buffer_load_dword v2, v1, s[8:11], s43 offen sc1
    s_waitcnt vmcnt(0)
    v_cmp_gt_u32 vcc, 1, v2
    s_cbranch_vccz L_polld_9
    s_sleep 4
    s_add_u32 s96, s96, 1
    s_cmp_lt_u32 s96, 0x10000
    s_cbranch_scc1 L_poll_8
L_polld_9:
    s_mov_b64 exec, -1
L_polls_10:
    s_barrier
    s_mov_b32 s22, 0
    s_mov_b32 s33, 0
    s_xor_b32 s53, s29, 1024
    s_add_u32 s23, s51, 0x10000
    s_add_u32 s48, s23, 4096
    s_mov_b32 s24, 0x12000
    s_add_u32 s55, s24, 16384
    s_mov_b32 s25, 0x100000
    s_mov_b32 s26, 0x101000
    s_lshl_b32 s43, s20, 13
    v_mov_b32 v112, 0
    v_mov_b32 v113, 0
    v_mov_b32 v114, 0
    v_mov_b32 v115, 0
    s_add_u32 s43, s43, s52
    s_add_u32 s30, s43, 0x1000000
    s_add_u32 s31, s43, 0x2000000
    s_lshr_b32 s43, s43, 1
    s_add_u32 s32, s43, 0x220000
    s_add_u32 m0, s52, 8192
    s_nop 0
    buffer_load_dwordx4 v117, s[8:11], s30 offen lds
    buffer_load_dwordx4 v117, s[8:11], s30 offen offset:1024 lds
    s_add_u32 m0, s52, 0x6000
    s_nop 0
    buffer_load_dwordx4 v117, s[8:11], s31 offen lds
    buffer_load_dwordx4 v117, s[8:11], s31 offen offset:1024 lds
    s_add_u32 m0, s51, 4096
    ds_write_b128 v117, v[112:115] offset:22528
    ds_write_b128 v117, v[112:115] offset:23552
    s_cmp_lg_u32 s21, 0
    s_cselect_b32 s40, -1, 0
    v_mov_b32 v126, s40
    v_bfe_u32 v1, v117, 4, 1
    v_lshlrev_b32 v1, 4, v1
    s_movk_i32 s43, 0x3f80
    v_lshlrev_b32 v125, v1, s43
    v_bfe_u32 v1, v117, 5, 3
    v_cmp_eq_u32 s[68:69], 0, v1
    v_cmp_eq_u32 s[70:71], 1, v1
    v_cmp_eq_u32 s[72:73], 2, v1
    v_cmp_eq_u32 s[74:75], 3, v1
    v_lshrrev_b32 v1, 2, v117
    s_cmp_lt_u32 s21, 2
    s_cselect_b64 vcc, -1, 0
    v_cndmask_b32 v119, v119, v1, vcc
    v_mov_b32 v32, 0
    v_mov_b32 v33, 0
    v_mov_b32 v34, 0
    v_mov_b32 v35, 0
    v_mov_b32 v36, 0
    v_mov_b32 v37, 0
    v_mov_b32 v38, 0
    v_mov_b32 v39, 0
    v_mov_b32 v40, 0
    v_mov_b32 v41, 0
    v_mov_b32 v42, 0
    v_mov_b32 v43, 0
    v_mov_b32 v44, 0
    v_mov_b32 v45, 0
    v_mov_b32 v46, 0
    v_mov_b32 v47, 0
    v_mov_b32 v48, 0
    v_mov_b32 v49, 0
    v_mov_b32 v50, 0
    v_mov_b32 v51, 0
    v_mov_b32 v52, 0
    v_mov_b32 v53, 0
    v_mov_b32 v54, 0
    v_mov_b32 v55, 0
    s_add_u32 s30, s30, 0x40000
    s_add_u32 s31, s31, 0x40000
    s_mov_b32 s45, 0
    s_mov_b32 s46, 0
    s_mov_b32 s47, 0
    s_mov_b32 s76, 0
    s_and_b32 s43, s21, 1
    s_lshl_b32 s43, s43, 5
    s_add_u32 s43, s43, s20
    s_lshl_b32 s43, s43, 6
    s_add_u32 s28, s43, 0x2000
    s_mov_b32 s59, 0
    ds_read_b128 v[80:83], v123
    ds_read_b128 v[84:87], v123 offset:1024
    ds_read_b128 v[56:59], v123 offset:2048
    ds_read_b128 v[60:63], v123 offset:3072
    ds_read_b128 v[64:67], v123 offset:32768
    ds_read_b128 v[68:71], v123 offset:33792
    ds_read_b128 v[72:75], v123 offset:34816
    ds_read_b128 v[76:79], v123 offset:35840
    ds_read_b128 v[88:91], v123 offset:4096
    ds_read_b128 v[92:95], v123 offset:5120
    ds_read_b128 v[96:99], v123 offset:6144
    ds_read_b128 v[100:103], v123 offset:7168
    ds_read_b128 v[104:107], v123 offset:36864
    ds_read_b128 v[108:111], v123 offset:37888
    ds_read_b128 v[24:27], v123 offset:38912
    ds_read_b128 v[28:31], v123 offset:39936
    s_cmp_lg_u32 s21, 0
    s_cbranch_scc1 L_cb_skip_11
    v_mov_b32 v1, 4
    s_mov_b64 exec, 1
    s_mov_b32 s49, 0
L_cb_poll_12:
    buffer_load_dword v3, v1, s[16:19], 0 offen sc1
    s_waitcnt vmcnt(0)
    v_readfirstlane_b32 s43, v3
    s_nop 0
    s_cmp_ge_u32 s43, 32
    s_cbranch_scc1 L_cb_done_13
    s_sleep 2
    s_add_u32 s49, s49, 1
    s_cmp_lt_u32 s49, 0x40000
    s_cbranch_scc1 L_cb_poll_12
L_cb_done_13:
    s_mov_b64 exec, -1
L_cb_skip_11:
    s_mov_b32 s49, 0
    s_lshr_b32 s43, s20, 1
    s_lshl_b32 s43, s43, 7
    s_and_b32 s40, s20, 1
    s_lshl_b32 s40, s40, 4
    s_add_u32 s43, s43, s40
    s_add_u32 s44, s43, 0x1000
    s_cmp_eq_u32 s21, 0
    s_cselect_b32 s44, s44, 0x7ff00000
    s_waitcnt vmcnt(0) lgkmcnt(0)
    s_barrier
    buffer_load_dwordx4 v[0:3], v117, s[8:11], s23 offen sc1
    s_waitcnt vmcnt(0) lgkmcnt(0)
    s_cmp_eq_u32 s21, 1
    s_cbranch_scc1 L_chain_top1_f
    s_cmp_eq_u32 s21, 2
    s_cbranch_scc1 L_chain_top2_f
    s_cmp_eq_u32 s21, 3
    s_cbranch_scc1 L_chain_top3_f
.p2align 6
L_chain_top0_f:
    buffer_load_dwordx4 v[0:3], v117, s[8:11], s23 offen nt
    v_mov_b32 v15, 0
    v_mov_b32 v15, 0
    v_mov_b32 v15, 0
    v_mov_b32 v15, 0
    v_mov_b32 v15, 0
    v_mov_b32 v15, 0
    v_mov_b32 v15, 0
    v_mov_b32 v15, 0
    v_mov_b32 v15, 0
    v_mov_b32 v15, 0
    v_mov_b32 v15, 0
    v_mov_b32 v15, 0
    v_mov_b32 v15, 0
    v_mov_b32 v15, 0
    v_mov_b32 v15, 0
    v_mov_b32 v15, 0
    buffer_load_dwordx4 v[0:3], v117, s[8:11], s23 offen sc1
    v_mov_b32 v15, 0
    v_mov_b32 v15, 0
    v_mov_b32 v15, 0
    v_mov_b32 v15, 0
    v_mov_b32 v15, 0
    v_mov_b32 v15, 0
    v_mov_b32 v15, 0
    v_mov_b32 v15, 0
    v_mov_b32 v15, 0
    v_mov_b32 v15, 0
    v_mov_b32 v15, 0
    v_mov_b32 v15, 0
    v_mov_b32 v15, 0
    v_mov_b32 v15, 0
    v_mov_b32 v15, 0
    v_mov_b32 v15, 0
L_mret_14:
    buffer_load_dwordx4 v[0:3], v117, s[8:11], s23 offen sc1
    s_add_u32 s45, s45, 1
    s_cmp_lt_u32 s45, 0x10000
    s_cselect_b32 s56, -2, -1
    s_nop 3
    v_mov_b32 v32, 0
    v_mov_b32 v33, 0
    v_mov_b32 v34, 0
    v_mov_b32 v35, 0
    s_waitcnt vmcnt(2)
    v_max3_u32 v15, v0, v1, v2
    v_max_u32 v15, v15, v3
    v_cmp_lt_u32 vcc, s56, v15
    v_smfmac_f32_16x16x64_bf16 v[32:35], v[0:3], v[80:87], v116
    s_cbranch_vccnz L_mret_14
    ds_write_b128 v117, v[0:3]
    v_smfmac_f32_16x16x64_bf16 v[36:39], v[0:3], v[56:63], v116
    buffer_load_dwordx4 v[4:7], v117, s[8:11], s48 offen nt
    v_smfmac_f32_16x16x64_bf16 v[40:43], v[0:3], v[64:71], v116
    buffer_load_dwordx4 v117, s[8:11], s48 offen nt lds
    s_mov_b32 m0, 8192
    v_smfmac_f32_16x16x64_bf16 v[44:47], v[0:3], v[72:79], v116
    s_waitcnt lgkmcnt(0)
    s_barrier
    ds_read_b128 v[8:11], v117 offset:1024
    v_smfmac_f32_16x16x64_bf16 v[48:51], v[0:3], a[192:199], v116
    ds_read_b128 v[16:19], v117 offset:2048
    ds_read_b128 v[20:23], v117 offset:3072
    v_smfmac_f32_16x16x64_bf16 v[52:55], v[0:3], a[200:207], v116
    ds_read_b128 v[80:83], v117 offset:14336
    s_waitcnt lgkmcnt(3)
    v_smfmac_f32_16x16x64_bf16 v[32:35], v[8:11], a[0:7], v116
    ds_read_b128 v[84:87], v117 offset:15360
    v_smfmac_f32_16x16x64_bf16 v[36:39], v[8:11], a[8:15], v116
    buffer_store_dwordx4 v[112:115], v117, s[8:11], s32 offen sc1
    s_waitcnt lgkmcnt(3)
    v_smfmac_f32_16x16x64_bf16 v[32:35], v[16:19], a[32:39], v116
    ds_read_b128 v[56:59], v117 offset:8192
    v_smfmac_f32_16x16x64_bf16 v[36:39], v[16:19], a[40:47], v116
    ds_read_b128 v[60:63], v117 offset:9216
    s_waitcnt lgkmcnt(4)
    v_smfmac_f32_16x16x64_bf16 v[32:35], v[20:23], a[64:71], v116
    ds_read_b128 v[64:67], v117 offset:10240
    v_smfmac_f32_16x16x64_bf16 v[36:39], v[20:23], a[72:79], v116
    ds_read_b128 v[68:71], v117 offset:11264
    v_smfmac_f32_16x16x64_bf16 v[40:43], v[8:11], a[96:103], v116
    ds_read_b128 v[72:75], v117 offset:12288
    v_smfmac_f32_16x16x64_bf16 v[40:43], v[16:19], a[128:135], v116
    ds_read_b128 v[76:79], v117 offset:13312
    v_smfmac_f32_16x16x64_bf16 v[40:43], v[20:23], a[160:167], v116
    s_waitcnt vmcnt(2)
    v_max3_u32 v15, v4, v5, v6
    v_smfmac_f32_16x16x64_bf16 v[44:47], v[8:11], a[104:111], v116
    v_max_u32 v15, v15, v7
    v_smfmac_f32_16x16x64_bf16 v[44:47], v[16:19], a[136:143], v116
    s_waitcnt vmcnt(1) lgkmcnt(0)
    v_cmp_lt_u32 vcc, s56, v15
    v_smfmac_f32_16x16x64_bf16 v[44:47], v[20:23], a[168:175], v116
    s_cbranch_vccnz L_mret_15
L_mgo_16:
    v_smfmac_f32_16x16x64_bf16 v[44:47], v[4:7], v[24:31], v116
    s_barrier
    ds_read_b128 v[12:15], v117 offset:5120
    v_smfmac_f32_16x16x64_bf16 v[32:35], v[4:7], v[88:95], v116
    ds_read_b128 v[24:27], v117 offset:6144
    v_smfmac_f32_16x16x64_bf16 v[36:39], v[4:7], v[96:103], v116
    ds_read_b128 v[28:31], v117 offset:7168
    v_smfmac_f32_16x16x64_bf16 v[40:43], v[4:7], v[104:111], v116
    ds_read_b128 v[88:91], v117 offset:24576
    s_waitcnt lgkmcnt(3)
    v_smfmac_f32_16x16x64_bf16 v[32:35], v[12:15], a[16:23], v116
    ds_read_b128 v[92:95], v117 offset:25600
    s_waitcnt lgkmcnt(3)
    v_smfmac_f32_16x16x64_bf16 v[32:35], v[24:27], a[48:55], v116
    buffer_load_dwordx4 v117, s[8:11], s30 offen lds
    s_waitcnt lgkmcnt(2)
    v_smfmac_f32_16x16x64_bf16 v[32:35], v[28:31], a[80:87], v116
    ds_read_b128 v[96:99], v117 offset:23552
    v_smfmac_f32_16x16x64_bf16 v[36:39], v[12:15], a[24:31], v116
    ds_read_b128 v[100:103], v117 offset:23552
    v_smfmac_f32_16x16x64_bf16 v[36:39], v[24:27], a[56:63], v116
    buffer_load_dwordx4 v117, s[8:11], s30 offen offset:1024 lds
    s_add_u32 m0, s52, 0x6000
    v_add_f32 v32, v32, v34
    v_smfmac_f32_16x16x64_bf16 v[36:39], v[28:31], a[88:95], v116
    ds_read_b128 v[104:107], v117 offset:23552
    v_add_f32 v33, v33, v35
    v_smfmac_f32_16x16x64_bf16 v[40:43], v[12:15], a[112:119], v116
    ds_read_b128 v[108:111], v117 offset:23552
    v_mul_f32 v32, s34, v32
    v_smfmac_f32_16x16x64_bf16 v[40:43], v[24:27], a[144:151], v116
    buffer_load_dword v125, v119, s[8:11], s28 offen sc1
    v_mul_f32 v33, s34, v33
    v_smfmac_f32_16x16x64_bf16 v[40:43], v[28:31], a[176:183], v116
    ds_read_b128 v[0:3], v124
    v_add_f32 v36, v36, v38
    v_smfmac_f32_16x16x64_bf16 v[48:51], v[4:7], a[208:215], v116
    v_add_f32 v37, v37, v39
    v_smfmac_f32_16x16x64_bf16 v[52:55], v[4:7], a[216:223], v116
    s_waitcnt lgkmcnt(5)
    buffer_load_dwordx4 v117, s[8:11], s31 offen lds
    v_mul_f32 v36, s34, v36
    v_smfmac_f32_16x16x64_bf16 v[44:47], v[12:15], a[120:127], v116
    ds_read_b128 v[4:7], v124 offset:1024
    v_mul_f32 v37, s34, v37
    v_smfmac_f32_16x16x64_bf16 v[44:47], v[24:27], a[152:159], v116
    v_cvt_pk_bf16_f32 v34, v32, v36
    v_smfmac_f32_16x16x64_bf16 v[44:47], v[28:31], a[184:191], v116
    buffer_load_dwordx4 v117, s[8:11], s31 offen offset:1024 lds
    s_mov_b32 m0, 4096
    v_cvt_pk_bf16_f32 v35, v33, v37
    v_add_f32 v40, v40, v42
    v_smfmac_f32_16x16x64_bf16 v[48:51], v[8:11], a[224:231], v116
    ds_write2_b32 v120, v34, v35 offset0:32 offset1:48
    v_add_f32 v41, v41, v43
    v_smfmac_f32_16x16x64_bf16 v[52:55], v[8:11], a[232:239], v116
    v_add_f32 v44, v44, v46
    v_add_f32 v45, v45, v47
    v_cvt_pk_bf16_f32 v113, v40, v44
    v_cvt_pk_bf16_f32 v115, v41, v45
    v_smfmac_f32_16x16x64_bf16 v[48:51], v[12:15], a[240:247], v116
    ds_write2_b32 v120, v113, v115 offset0:0 offset1:16
    v_smfmac_f32_16x16x64_bf16 v[52:55], v[12:15], a[248:255], v116
    s_cmp_eq_u32 s22, 63
    s_cbranch_scc1 L_chain_last_f
    buffer_store_dword v126, off, s[8:11], s44 sc1
    v_smfmac_f32_16x16x64_bf16 v[48:51], v[16:19], v[128:135], v116
    v_smfmac_f32_16x16x64_bf16 v[48:51], v[20:23], v[160:167], v116
    v_smfmac_f32_16x16x64_bf16 v[48:51], v[24:27], v[144:151], v116
    s_waitcnt lgkmcnt(0)
    s_barrier
    v_smfmac_f32_16x16x64_bf16 v[48:51], v[28:31], v[176:183], v116
    ds_read_b128 v[32:35], v121 offset:16384
    ds_read_b128 v[36:39], v121 offset:17408
    v_smfmac_f32_16x16x64_bf16 v[52:55], v[16:19], v[136:143], v116
    ds_read_b128 v[40:43], v121 offset:18432
    ds_read_b128 v[44:47], v121 offset:19456
    v_smfmac_f32_16x16x64_bf16 v[52:55], v[20:23], v[168:175], v116
    ds_read_b128 v[8:11], v124 offset:32768
    v_add_f32 v48, v48, v50
    v_smfmac_f32_16x16x64_bf16 v[52:55], v[24:27], v[152:159], v116
    ds_read_b128 v[12:15], v124 offset:33792
    v_add_f32 v49, v49, v51
    v_smfmac_f32_16x16x64_bf16 v[52:55], v[28:31], v[184:191], v116
    s_waitcnt lgkmcnt(5)
    v_cvt_pk_bf16_f32 v112, v48, v49
    v_mfma_f32_16x16x32_bf16 v[56:59], v[56:59], v[32:35], 0
    s_waitcnt lgkmcnt(4)
    v_mov_b32 v48, s50
    v_mov_b32 v49, s50
    v_mfma_f32_16x16x32_bf16 v[56:59], v[60:63], v[36:39], v[56:59]
    ds_read_b128 v[16:19], v124 offset:2048
    s_waitcnt lgkmcnt(4)
    v_mov_b32 v50, s50
    v_mov_b32 v51, s50
    v_mfma_f32_16x16x32_bf16 v[56:59], v[64:67], v[40:43], v[56:59]
    ds_read_b128 v[20:23], v124 offset:3072
    s_waitcnt lgkmcnt(4)
    v_add_f32 v52, v52, v54
    v_mfma_f32_16x16x32_bf16 v[56:59], v[68:71], v[44:47], v[56:59]
    ds_read_b128 v[24:27], v124 offset:4096
    v_add_f32 v53, v53, v55
    v_mfma_f32_16x16x32_bf16 v[60:63], v[72:75], v[32:35], 0
    ds_read_b128 v[28:31], v124 offset:5120
    v_cvt_pk_bf16_f32 v114, v52, v53
    v_mov_b32 v53, 0
    v_mfma_f32_16x16x32_bf16 v[60:63], v[76:79], v[36:39], v[60:63]
    v_exp_f32 v56, v56
    v_mfma_f32_16x16x32_bf16 v[60:63], v[80:83], v[40:43], v[60:63]
    v_exp_f32 v57, v57
    v_mfma_f32_16x16x32_bf16 v[60:63], v[84:87], v[44:47], v[60:63]
    v_exp_f32 v58, v58
    v_mfma_f32_16x16x32_bf16 v[64:67], v[32:35], v[32:35], 0
    v_exp_f32 v59, v59
    v_cvt_pk_bf16_f32 v68, v56, v57
    v_mfma_f32_16x16x32_bf16 v[64:67], v[36:39], v[36:39], v[64:67]
    v_exp_f32 v60, v60
    v_cvt_pk_bf16_f32 v69, v58, v59
    v_mfma_f32_16x16x32_bf16 v[64:67], v[40:43], v[40:43], v[64:67]
    v_exp_f32 v61, v61
    v_mfma_f32_16x16x32_bf16 v[64:67], v[44:47], v[44:47], v[64:67]
    v_exp_f32 v62, v62
    v_exp_f32 v63, v63
    v_cvt_pk_bf16_f32 v70, v60, v61
    v_cvt_pk_bf16_f32 v71, v62, v63
    s_nop 1
    v_mfma_f32_16x16x32_bf16 v[72:75], v[88:91], v[68:71], 0
    s_nop 0
    v_exp_f32 v64, v64
    v_mfma_f32_16x16x32_bf16 v[76:79], v[92:95], v[68:71], 0
    v_exp_f32 v65, v65
    v_mfma_f32_16x16x32_bf16 v[80:83], v[48:51], v[68:71], 0
    v_cvt_pk_bf16_f32 v52, v64, v65
    s_nop 1
    v_mfma_f32_16x16x16_bf16 v[72:75], v[112:113], v[52:53], v[72:75]
    ds_read_b128 v[32:35], v124 offset:6144
    v_mfma_f32_16x16x16_bf16 v[76:79], v[114:115], v[52:53], v[76:79]
    ds_read_b128 v[36:39], v124 offset:7168
    v_mfma_f32_16x16x16_bf16 v[80:83], v[48:49], v[52:53], v[80:83]
L_norm_17:
    s_mov_b64 vcc, s[36:37]
    v_mov_b32 v122, v122
    v_mov_b32 v122, v122
    v_mov_b32 v122, v122
    v_cndmask_b32_dpp v76, v72, v76, vcc quad_perm:[2,3,2,3] row_mask:0xf bank_mask:0xf
    v_cndmask_b32_dpp v77, v73, v77, vcc quad_perm:[2,3,2,3] row_mask:0xf bank_mask:0xf
    v_cndmask_b32_dpp v78, v74, v78, vcc quad_perm:[2,3,2,3] row_mask:0xf bank_mask:0xf
    v_cndmask_b32_dpp v79, v75, v79, vcc quad_perm:[2,3,2,3] row_mask:0xf bank_mask:0xf
    v_rcp_f32_dpp v84, v80 quad_perm:[2,3,2,3] row_mask:0xf bank_mask:0xf
    s_nop 0
    v_pk_mul_f32 v[76:77], v[76:77], v[84:85] op_sel_hi:[1,0]
    v_pk_mul_f32 v[78:79], v[78:79], v[84:85] op_sel_hi:[1,0]
    v_cvt_pk_bf16_f32 v72, v76, v77
    v_cvt_pk_bf16_f32 v73, v78, v79
    ds_write_b64 v122, v[72:73] offset:20480
    v_max_f32_dpp v86, v80, v84 quad_perm:[2,3,2,3] row_mask:0xf bank_mask:0xf
    v_mov_b32_dpp v60, v72 quad_perm:[0,1,0,1] row_mask:0xf bank_mask:0xf
    v_mov_b32_dpp v61, v73 quad_perm:[0,1,0,1] row_mask:0xf bank_mask:0xf
    v_cmp_lt_f32 vcc, s35, v86
    v_mov_b32_dpp v62, v72 quad_perm:[2,3,2,3] row_mask:0xf bank_mask:0xf
    v_mov_b32_dpp v63, v73 quad_perm:[2,3,2,3] row_mask:0xf bank_mask:0xf
    s_nop 1
    v_smfmac_f32_16x16x64_bf16 v[96:99], v[60:63], v[192:199], v116
    s_cbranch_vccnz L_smax_18
    v_smfmac_f32_16x16x64_bf16 v[100:103], v[60:63], v[224:231], v116
    s_waitcnt lgkmcnt(0)
    s_barrier
    ds_read_b128 v[92:95], v127 offset:20992
    ds_read_b128 v[80:83], v127 offset:21504
    ds_read_b128 v[84:87], v127 offset:22016
    v_smfmac_f32_16x16x64_bf16 v[104:107], v[60:63], v[0:7], v116
    ds_read_b128 v[40:43], v124 offset:34816
    v_smfmac_f32_16x16x64_bf16 v[108:111], v[60:63], v[8:15], v116
    ds_read_b128 v[56:59], v124 offset:36864
    s_waitcnt lgkmcnt(4)
    v_smfmac_f32_16x16x64_bf16 v[96:99], v[92:95], v[200:207], v116
    s_waitcnt lgkmcnt(3)
    v_smfmac_f32_16x16x64_bf16 v[96:99], v[80:83], v[208:215], v116
    ds_read_b128 v[44:47], v124 offset:35840
    s_waitcnt lgkmcnt(3)
    v_smfmac_f32_16x16x64_bf16 v[96:99], v[84:87], v[216:223], v116
    ds_read_b128 v[68:71], v124 offset:39936
    v_smfmac_f32_16x16x64_bf16 v[100:103], v[92:95], v[232:239], v116
    ds_read_b128 v[64:67], v124 offset:38912
    v_smfmac_f32_16x16x64_bf16 v[100:103], v[80:83], v[240:247], v116
    ds_read_b128 v[60:63], v124 offset:37888
    v_cvt_pk_bf16_f32 v72, v96, v98
    v_smfmac_f32_16x16x64_bf16 v[100:103], v[84:87], v[248:255], v116
    v_and_or_b32 v72, v72, -2, s33
    v_smfmac_f32_16x16x64_bf16 v[104:107], v[92:95], v[16:23], v116
    v_cvt_pk_bf16_f32 v74, v97, v99
    v_smfmac_f32_16x16x64_bf16 v[104:107], v[80:83], v[24:31], v116
    v_cvt_pk_bf16_f32 v73, v100, v102
    v_cvt_pk_bf16_f32 v75, v101, v103
    v_smfmac_f32_16x16x64_bf16 v[104:107], v[84:87], v[32:39], v116
    buffer_store_dwordx4 v[72:75], v118, s[8:11], s25 offen
    s_waitcnt lgkmcnt(3)
    v_smfmac_f32_16x16x64_bf16 v[108:111], v[92:95], v[40:47], v116
    s_waitcnt lgkmcnt(0)
    v_smfmac_f32_16x16x64_bf16 v[108:111], v[80:83], v[56:63], v116
    v_cvt_pk_bf16_f32 v76, v104, v106
    v_smfmac_f32_16x16x64_bf16 v[108:111], v[84:87], v[64:71], v116
    v_and_or_b32 v76, v76, -2, s33
    v_cvt_pk_bf16_f32 v78, v105, v107
    v_mov_b32 v122, v122
    v_mov_b32 v122, v122
    v_mov_b32 v122, v122
    v_mov_b32 v122, v122
    v_mov_b32 v122, v122
    v_mov_b32 v122, v122
    v_cvt_pk_bf16_f32 v77, v108, v110
    v_cvt_pk_bf16_f32 v79, v109, v111
    buffer_store_dwordx4 v[76:79], v118, s[8:11], s26 offen
    s_add_u32 s30, s30, 0x40000
    s_add_u32 s31, s31, 0x40000
    s_add_u32 s32, s32, 0x20000
    s_add_u32 s23, s24, 0
    s_add_u32 s48, s23, 4096
    s_xor_b32 s25, s25, 0x40000
    s_xor_b32 s26, s26, 0x40000
    s_mov_b32 s35, 0x49800000
    v_mov_b32 v126, s22
    s_add_u32 s22, s22, 1
    v_mov_b32 v32, 0
    v_mov_b32 v33, 0
    v_mov_b32 v34, 0
    v_mov_b32 v35, 0
    v_mov_b32 v36, 0
    v_mov_b32 v37, 0
    v_mov_b32 v38, 0
    v_mov_b32 v39, 0
    v_mov_b32 v40, 0
    v_mov_b32 v41, 0
    v_mov_b32 v42, 0
    v_mov_b32 v43, 0
    v_mov_b32 v44, 0
    v_mov_b32 v45, 0
    v_mov_b32 v46, 0
    v_mov_b32 v47, 0
    v_mov_b32 v48, 0
    v_mov_b32 v49, 0
    v_mov_b32 v50, 0
    v_mov_b32 v51, 0
    v_mov_b32 v52, 0
    v_mov_b32 v53, 0
    v_mov_b32 v54, 0
    v_mov_b32 v55, 0
    ds_read_b128 v[80:83], v123
    ds_read_b128 v[84:87], v123 offset:1024
    ds_read_b128 v[56:59], v123 offset:2048
    ds_read_b128 v[60:63], v123 offset:3072
    ds_read_b128 v[64:67], v123 offset:32768
    ds_read_b128 v[68:71], v123 offset:33792
    ds_read_b128 v[72:75], v123 offset:34816
    ds_read_b128 v[76:79], v123 offset:35840
    ds_read_b128 v[88:91], v123 offset:4096
    ds_read_b128 v[92:95], v123 offset:5120
    ds_read_b128 v[96:99], v123 offset:6144
    ds_read_b128 v[100:103], v123 offset:7168
    ds_read_b128 v[104:107], v123 offset:36864
    ds_read_b128 v[108:111], v123 offset:37888
    ds_read_b128 v[24:27], v123 offset:38912
    ds_read_b128 v[28:31], v123 offset:39936
    s_add_u32 s24, s24, 8192
    s_bitset0_b32 s24, 15
    s_xor_b32 s55, s24, 16384
    s_xor_b32 s29, s29, 0x40000
    s_xor_b32 s53, s29, 1024
    s_bfe_u32 s33, s22, 0x10001
    s_add_u32 s40, s22, 5
    s_lshr_b32 s40, s40, 2
    s_min_u32 s40, s40, 16
    s_bfm_b32 s58, s40, 0
    s_waitcnt vmcnt(5)
    v_cmp_eq_u32 vcc, 0, v125
    s_nop 0
    s_and_b64 vcc, vcc, s[58:59]
    s_cbranch_scc1 L_kvw_19
L_kvb_20:
    v_mov_b32 v15, 0
    s_nop 2
    v_mov_b32 v15, 0
    s_nop 2
    v_mov_b32 v15, 0
    s_nop 2
    v_mov_b32 v15, 0
    s_nop 2
    v_mov_b32 v15, 0
    s_nop 2
    v_mov_b32 v15, 0
    s_nop 2
    v_mov_b32 v15, 0
    s_nop 2
    v_mov_b32 v15, 0
    s_nop 2
    v_mov_b32 v15, 0
    s_nop 2
    v_mov_b32 v15, 0
    s_nop 2
    v_mov_b32 v15, 0
    s_nop 2
    v_mov_b32 v15, 0
    s_nop 2
    v_mov_b32 v15, 0
    s_nop 2
    v_mov_b32 v15, 0
    s_nop 2
    v_mov_b32 v15, 0
    s_nop 2
    v_mov_b32 v15, 0
    s_nop 2
    v_mov_b32 v15, 0
    s_nop 2
    v_mov_b32 v15, 0
    s_nop 2
    v_mov_b32 v15, 0
    s_nop 2
    v_mov_b32 v15, 0
    s_nop 2
    v_mov_b32 v15, 0
    s_nop 2
    v_mov_b32 v15, 0
    s_nop 2
    v_mov_b32 v15, 0
    s_nop 2
    v_mov_b32 v15, 0
    s_nop 2
    v_mov_b32 v15, 0
    s_nop 2
    v_mov_b32 v15, 0
    s_nop 2
    v_mov_b32 v15, 0
    s_nop 2
    v_mov_b32 v15, 0
    s_nop 2
    v_mov_b32 v15, 0
    s_nop 2
    v_mov_b32 v15, 0
    s_nop 2
    v_mov_b32 v15, 0
    s_nop 2
    s_waitcnt lgkmcnt(0)
    s_branch L_chain_top0_f
.p2align 6
L_chain_top1_f:
    buffer_load_dwordx4 v[0:3], v117, s[8:11], s23 offen nt
    v_mov_b32 v15, 0
    v_mov_b32 v15, 0
    v_mov_b32 v15, 0
    v_mov_b32 v15, 0
    v_mov_b32 v15, 0
    v_mov_b32 v15, 0
    v_mov_b32 v15, 0
    v_mov_b32 v15, 0
    v_mov_b32 v15, 0
    v_mov_b32 v15, 0
    v_mov_b32 v15, 0
    v_mov_b32 v15, 0
    v_mov_b32 v15, 0
    v_mov_b32 v15, 0
    v_mov_b32 v15, 0
    v_mov_b32 v15, 0
    buffer_load_dwordx4 v[0:3], v117, s[8:11], s23 offen sc1
    v_mov_b32 v15, 0
    v_mov_b32 v15, 0
    v_mov_b32 v15, 0
    v_mov_b32 v15, 0
    v_mov_b32 v15, 0
    v_mov_b32 v15, 0
    v_mov_b32 v15, 0
    v_mov_b32 v15, 0
    v_mov_b32 v15, 0
    v_mov_b32 v15, 0
    v_mov_b32 v15, 0
    v_mov_b32 v15, 0
    v_mov_b32 v15, 0
    v_mov_b32 v15, 0
    v_mov_b32 v15, 0
    v_mov_b32 v15, 0
L_mret_21:
    buffer_load_dwordx4 v[0:3], v117, s[8:11], s23 offen sc1
    s_add_u32 s45, s45, 1
    s_cmp_lt_u32 s45, 0x10000
    s_cselect_b32 s56, -2, -1
    s_nop 3
    v_mov_b32 v32, 0
    v_mov_b32 v33, 0
    v_mov_b32 v34, 0
    v_mov_b32 v35, 0
    s_waitcnt vmcnt(2)
    v_max3_u32 v15, v0, v1, v2
    v_max_u32 v15, v15, v3
    v_cmp_lt_u32 vcc, s56, v15
    v_smfmac_f32_16x16x64_bf16 v[32:35], v[0:3], v[80:87], v116
    s_cbranch_vccnz L_mret_21
    ds_write_b128 v117, v[0:3] offset:1024
    v_smfmac_f32_16x16x64_bf16 v[36:39], v[0:3], v[56:63], v116
    buffer_load_dwordx4 v[4:7], v117, s[8:11], s48 offen nt
    v_smfmac_f32_16x16x64_bf16 v[40:43], v[0:3], v[64:71], v116
    buffer_load_dwordx4 v117, s[8:11], s48 offen nt lds
    s_mov_b32 m0, 10240
    v_smfmac_f32_16x16x64_bf16 v[44:47], v[0:3], v[72:79], v116
    s_waitcnt lgkmcnt(0)
    s_barrier
    ds_read_b128 v[8:11], v117
    v_smfmac_f32_16x16x64_bf16 v[48:51], v[0:3], a[192:199], v116
    ds_read_b128 v[16:19], v117 offset:3072
    ds_read_b128 v[20:23], v117 offset:2048
    v_smfmac_f32_16x16x64_bf16 v[52:55], v[0:3], a[200:207], v116
    ds_read_b128 v[80:83], v117 offset:14336
    s_waitcnt lgkmcnt(3)
    v_smfmac_f32_16x16x64_bf16 v[32:35], v[8:11], a[0:7], v116
    ds_read_b128 v[84:87], v117 offset:15360
    v_smfmac_f32_16x16x64_bf16 v[36:39], v[8:11], a[8:15], v116
    ds_read_b128 v[56:59], v117 offset:8192
    s_waitcnt lgkmcnt(4)
    v_smfmac_f32_16x16x64_bf16 v[32:35], v[16:19], a[32:39], v116
    ds_read_b128 v[60:63], v117 offset:9216
    v_smfmac_f32_16x16x64_bf16 v[36:39], v[16:19], a[40:47], v116
    buffer_store_dwordx4 v[112:115], v117, s[8:11], s32 offen sc1
    s_waitcnt lgkmcnt(4)
    v_smfmac_f32_16x16x64_bf16 v[32:35], v[20:23], a[64:71], v116
    ds_read_b128 v[64:67], v117 offset:10240
    v_smfmac_f32_16x16x64_bf16 v[36:39], v[20:23], a[72:79], v116
    ds_read_b128 v[68:71], v117 offset:11264
    v_smfmac_f32_16x16x64_bf16 v[40:43], v[8:11], a[96:103], v116
    ds_read_b128 v[72:75], v117 offset:12288
    v_smfmac_f32_16x16x64_bf16 v[40:43], v[16:19], a[128:135], v116
    ds_read_b128 v[76:79], v117 offset:13312
    v_smfmac_f32_16x16x64_bf16 v[40:43], v[20:23], a[160:167], v116
    s_waitcnt vmcnt(2)
    v_max3_u32 v15, v4, v5, v6
    v_smfmac_f32_16x16x64_bf16 v[44:47], v[8:11], a[104:111], v116
    v_max_u32 v15, v15, v7
    v_smfmac_f32_16x16x64_bf16 v[44:47], v[16:19], a[136:143], v116
    s_waitcnt vmcnt(1) lgkmcnt(0)
    v_cmp_lt_u32 vcc, s56, v15
    v_smfmac_f32_16x16x64_bf16 v[44:47], v[20:23], a[168:175], v116
    s_cbranch_vccnz L_mret_22
L_mgo_23:
    v_smfmac_f32_16x16x64_bf16 v[44:47], v[4:7], v[24:31], v116
    s_barrier
    ds_read_b128 v[12:15], v117 offset:4096
    v_smfmac_f32_16x16x64_bf16 v[32:35], v[4:7], v[88:95], v116
    ds_read_b128 v[24:27], v117 offset:7168
    v_smfmac_f32_16x16x64_bf16 v[36:39], v[4:7], v[96:103], v116
    ds_read_b128 v[28:31], v117 offset:6144
    v_smfmac_f32_16x16x64_bf16 v[40:43], v[4:7], v[104:111], v116
    ds_read_b128 v[88:91], v117 offset:26624
    s_waitcnt lgkmcnt(3)
    v_smfmac_f32_16x16x64_bf16 v[32:35], v[12:15], a[16:23], v116
    ds_read_b128 v[92:95], v117 offset:27648
    s_waitcnt lgkmcnt(3)
    v_smfmac_f32_16x16x64_bf16 v[32:35], v[24:27], a[48:55], v116
    buffer_load_dwordx4 v117, s[8:11], s30 offen lds
    s_waitcnt lgkmcnt(2)
    v_smfmac_f32_16x16x64_bf16 v[32:35], v[28:31], a[80:87], v116
    ds_read_b128 v[96:99], v117 offset:23552
    v_smfmac_f32_16x16x64_bf16 v[36:39], v[12:15], a[24:31], v116
    ds_read_b128 v[100:103], v117 offset:23552
    v_smfmac_f32_16x16x64_bf16 v[36:39], v[24:27], a[56:63], v116
    buffer_load_dwordx4 v117, s[8:11], s30 offen offset:1024 lds
    s_add_u32 m0, s52, 0x6000
    v_add_f32 v32, v32, v34
    v_smfmac_f32_16x16x64_bf16 v[36:39], v[28:31], a[88:95], v116
    ds_read_b128 v[104:107], v117 offset:23552
    v_add_f32 v33, v33, v35
    v_smfmac_f32_16x16x64_bf16 v[40:43], v[12:15], a[112:119], v116
    ds_read_b128 v[108:111], v117 offset:23552
    v_mul_f32 v32, s34, v32
    v_smfmac_f32_16x16x64_bf16 v[40:43], v[24:27], a[144:151], v116
    buffer_load_dword v125, v119, s[8:11], s28 offen sc1
    v_mul_f32 v33, s34, v33
    v_smfmac_f32_16x16x64_bf16 v[40:43], v[28:31], a[176:183], v116
    ds_read_b128 v[0:3], v124
    v_add_f32 v36, v36, v38
    v_smfmac_f32_16x16x64_bf16 v[48:51], v[4:7], a[208:215], v116
    v_add_f32 v37, v37, v39
    v_smfmac_f32_16x16x64_bf16 v[52:55], v[4:7], a[216:223], v116
    s_waitcnt lgkmcnt(5)
    buffer_load_dwordx4 v117, s[8:11], s31 offen lds
    v_mul_f32 v36, s34, v36
    v_smfmac_f32_16x16x64_bf16 v[44:47], v[12:15], a[120:127], v116
    ds_read_b128 v[4:7], v124 offset:1024
    v_mul_f32 v37, s34, v37
    v_smfmac_f32_16x16x64_bf16 v[44:47], v[24:27], a[152:159], v116
    v_cvt_pk_bf16_f32 v34, v32, v36
    v_smfmac_f32_16x16x64_bf16 v[44:47], v[28:31], a[184:191], v116
    buffer_load_dwordx4 v117, s[8:11], s31 offen offset:1024 lds
    s_mov_b32 m0, 5120
    v_cvt_pk_bf16_f32 v35, v33, v37
    v_add_f32 v40, v40, v42
    v_smfmac_f32_16x16x64_bf16 v[48:51], v[8:11], a[224:231], v116
    ds_write2_b32 v120, v34, v35 offset0:32 offset1:48
    v_add_f32 v41, v41, v43
    v_smfmac_f32_16x16x64_bf16 v[52:55], v[8:11], a[232:239], v116
    v_add_f32 v44, v44, v46
    v_add_f32 v45, v45, v47
    v_cvt_pk_bf16_f32 v113, v40, v44
    v_cvt_pk_bf16_f32 v115, v41, v45
    v_smfmac_f32_16x16x64_bf16 v[48:51], v[12:15], a[240:247], v116
    ds_write2_b32 v120, v113, v115 offset0:0 offset1:16
    v_smfmac_f32_16x16x64_bf16 v[52:55], v[12:15], a[248:255], v116
    s_cmp_eq_u32 s22, 63
    s_cbranch_scc1 L_chain_last_f
    v_smfmac_f32_16x16x64_bf16 v[48:51], v[16:19], v[128:135], v116
    v_smfmac_f32_16x16x64_bf16 v[48:51], v[20:23], v[160:167], v116
    v_smfmac_f32_16x16x64_bf16 v[48:51], v[24:27], v[144:151], v116
    s_waitcnt lgkmcnt(0)
    s_barrier
    v_smfmac_f32_16x16x64_bf16 v[48:51], v[28:31], v[176:183], v116
    ds_read_b128 v[32:35], v121 offset:16384
    ds_read_b128 v[36:39], v121 offset:17408
    v_smfmac_f32_16x16x64_bf16 v[52:55], v[16:19], v[136:143], v116
    ds_read_b128 v[40:43], v121 offset:18432
    ds_read_b128 v[44:47], v121 offset:19456
    v_smfmac_f32_16x16x64_bf16 v[52:55], v[20:23], v[168:175], v116
    ds_read_b128 v[8:11], v124 offset:32768
    v_add_f32 v48, v48, v50
    v_smfmac_f32_16x16x64_bf16 v[52:55], v[24:27], v[152:159], v116
    ds_read_b128 v[12:15], v124 offset:33792
    v_add_f32 v49, v49, v51
    v_smfmac_f32_16x16x64_bf16 v[52:55], v[28:31], v[184:191], v116
    s_waitcnt lgkmcnt(5)
    v_cvt_pk_bf16_f32 v112, v48, v49
    v_mfma_f32_16x16x32_bf16 v[56:59], v[56:59], v[32:35], 0
    s_waitcnt lgkmcnt(4)
    v_mov_b32 v48, s50
    v_mov_b32 v49, s50
    v_mfma_f32_16x16x32_bf16 v[56:59], v[60:63], v[36:39], v[56:59]
    ds_read_b128 v[16:19], v124 offset:2048
    s_waitcnt lgkmcnt(4)
    v_mov_b32 v50, s50
    v_mov_b32 v51, s50
    v_mfma_f32_16x16x32_bf16 v[56:59], v[64:67], v[40:43], v[56:59]
    ds_read_b128 v[20:23], v124 offset:3072
    s_waitcnt lgkmcnt(4)
    v_add_f32 v52, v52, v54
    v_mfma_f32_16x16x32_bf16 v[56:59], v[68:71], v[44:47], v[56:59]
    ds_read_b128 v[24:27], v124 offset:4096
    v_add_f32 v53, v53, v55
    v_mfma_f32_16x16x32_bf16 v[60:63], v[72:75], v[32:35], 0
    ds_read_b128 v[28:31], v124 offset:5120
    v_cvt_pk_bf16_f32 v114, v52, v53
    v_mov_b32 v53, 0
    v_mfma_f32_16x16x32_bf16 v[60:63], v[76:79], v[36:39], v[60:63]
    v_exp_f32 v56, v56
    v_mfma_f32_16x16x32_bf16 v[60:63], v[80:83], v[40:43], v[60:63]
    v_exp_f32 v57, v57
    v_mfma_f32_16x16x32_bf16 v[60:63], v[84:87], v[44:47], v[60:63]
    v_exp_f32 v58, v58
    v_mfma_f32_16x16x32_bf16 v[64:67], v[32:35], v[32:35], 0
    v_exp_f32 v59, v59
    v_cvt_pk_bf16_f32 v68, v56, v57
    v_mfma_f32_16x16x32_bf16 v[64:67], v[36:39], v[36:39], v[64:67]
    v_exp_f32 v60, v60
    v_cvt_pk_bf16_f32 v69, v58, v59
    v_mfma_f32_16x16x32_bf16 v[64:67], v[40:43], v[40:43], v[64:67]
    v_exp_f32 v61, v61
    v_mfma_f32_16x16x32_bf16 v[64:67], v[44:47], v[44:47], v[64:67]
    v_exp_f32 v62, v62
    v_exp_f32 v63, v63
    v_cvt_pk_bf16_f32 v70, v60, v61
    v_cvt_pk_bf16_f32 v71, v62, v63
    s_nop 1
    v_mfma_f32_16x16x32_bf16 v[72:75], v[88:91], v[68:71], 0
    s_nop 0
    v_exp_f32 v64, v64
    v_mfma_f32_16x16x32_bf16 v[76:79], v[92:95], v[68:71], 0
    v_exp_f32 v65, v65
    v_mfma_f32_16x16x32_bf16 v[80:83], v[48:51], v[68:71], 0
    v_cvt_pk_bf16_f32 v52, v64, v65
    s_nop 1
    v_mfma_f32_16x16x16_bf16 v[72:75], v[112:113], v[52:53], v[72:75]
    ds_read_b128 v[32:35], v124 offset:6144
    v_mfma_f32_16x16x16_bf16 v[76:79], v[114:115], v[52:53], v[76:79]
    ds_read_b128 v[36:39], v124 offset:7168
    v_mfma_f32_16x16x16_bf16 v[80:83], v[48:49], v[52:53], v[80:83]
L_norm_24:
    s_mov_b64 vcc, s[36:37]
    v_mov_b32 v122, v122
    v_mov_b32 v122, v122
    v_mov_b32 v122, v122
    v_cndmask_b32_dpp v76, v72, v76, vcc quad_perm:[2,3,2,3] row_mask:0xf bank_mask:0xf
    v_cndmask_b32_dpp v77, v73, v77, vcc quad_perm:[2,3,2,3] row_mask:0xf bank_mask:0xf
    v_cndmask_b32_dpp v78, v74, v78, vcc quad_perm:[2,3,2,3] row_mask:0xf bank_mask:0xf
    v_cndmask_b32_dpp v79, v75, v79, vcc quad_perm:[2,3,2,3] row_mask:0xf bank_mask:0xf
    v_rcp_f32_dpp v84, v80 quad_perm:[2,3,2,3] row_mask:0xf bank_mask:0xf
    s_nop 0
    v_pk_mul_f32 v[76:77], v[76:77], v[84:85] op_sel_hi:[1,0]
    v_pk_mul_f32 v[78:79], v[78:79], v[84:85] op_sel_hi:[1,0]
    v_cvt_pk_bf16_f32 v72, v76, v77
    v_cvt_pk_bf16_f32 v73, v78, v79
    ds_write_b64 v122, v[72:73] offset:20992
    v_max_f32_dpp v86, v80, v84 quad_perm:[2,3,2,3] row_mask:0xf bank_mask:0xf
    v_mov_b32_dpp v60, v72 quad_perm:[0,1,0,1] row_mask:0xf bank_mask:0xf
    v_mov_b32_dpp v61, v73 quad_perm:[0,1,0,1] row_mask:0xf bank_mask:0xf
    v_cmp_lt_f32 vcc, s35, v86
    v_mov_b32_dpp v62, v72 quad_perm:[2,3,2,3] row_mask:0xf bank_mask:0xf
    v_mov_b32_dpp v63, v73 quad_perm:[2,3,2,3] row_mask:0xf bank_mask:0xf
    s_nop 1
    v_smfmac_f32_16x16x64_bf16 v[96:99], v[60:63], v[192:199], v116
    s_cbranch_vccnz L_smax_25
    v_smfmac_f32_16x16x64_bf16 v[100:103], v[60:63], v[224:231], v116
    s_waitcnt lgkmcnt(0)
    s_barrier
    ds_read_b128 v[92:95], v127 offset:20480
    ds_read_b128 v[80:83], v127 offset:22016
    ds_read_b128 v[84:87], v127 offset:21504
    v_smfmac_f32_16x16x64_bf16 v[104:107], v[60:63], v[0:7], v116
    ds_read_b128 v[40:43], v124 offset:34816
    v_smfmac_f32_16x16x64_bf16 v[108:111], v[60:63], v[8:15], v116
    ds_read_b128 v[56:59], v124 offset:36864
    s_waitcnt lgkmcnt(4)
    v_smfmac_f32_16x16x64_bf16 v[96:99], v[92:95], v[200:207], v116
    s_waitcnt lgkmcnt(3)
    v_smfmac_f32_16x16x64_bf16 v[96:99], v[80:83], v[208:215], v116
    ds_read_b128 v[44:47], v124 offset:35840
    s_waitcnt lgkmcnt(3)
    v_smfmac_f32_16x16x64_bf16 v[96:99], v[84:87], v[216:223], v116
    ds_read_b128 v[68:71], v124 offset:39936
    v_smfmac_f32_16x16x64_bf16 v[100:103], v[92:95], v[232:239], v116
    ds_read_b128 v[64:67], v124 offset:38912
    v_smfmac_f32_16x16x64_bf16 v[100:103], v[80:83], v[240:247], v116
    ds_read_b128 v[60:63], v124 offset:37888
    v_cvt_pk_bf16_f32 v72, v96, v98
    v_smfmac_f32_16x16x64_bf16 v[100:103], v[84:87], v[248:255], v116
    v_and_or_b32 v72, v72, -2, s33
    v_smfmac_f32_16x16x64_bf16 v[104:107], v[92:95], v[16:23], v116
    v_cvt_pk_bf16_f32 v74, v97, v99
    v_smfmac_f32_16x16x64_bf16 v[104:107], v[80:83], v[24:31], v116
    v_cvt_pk_bf16_f32 v73, v100, v102
    v_cvt_pk_bf16_f32 v75, v101, v103
    v_smfmac_f32_16x16x64_bf16 v[104:107], v[84:87], v[32:39], v116
    buffer_store_dwordx4 v[72:75], v118, s[8:11], s25 offen
    s_waitcnt lgkmcnt(3)
    v_smfmac_f32_16x16x64_bf16 v[108:111], v[92:95], v[40:47], v116
    s_waitcnt lgkmcnt(0)
    v_smfmac_f32_16x16x64_bf16 v[108:111], v[80:83], v[56:63], v116
    v_cvt_pk_bf16_f32 v76, v104, v106
    v_smfmac_f32_16x16x64_bf16 v[108:111], v[84:87], v[64:71], v116
    v_and_or_b32 v76, v76, -2, s33
    v_cvt_pk_bf16_f32 v78, v105, v107
    v_mov_b32 v122, v122
    v_mov_b32 v122, v122
    v_mov_b32 v122, v122
    v_mov_b32 v122, v122
    v_mov_b32 v122, v122
    v_mov_b32 v122, v122
    v_cvt_pk_bf16_f32 v77, v108, v110
    v_cvt_pk_bf16_f32 v79, v109, v111
    buffer_store_dwordx4 v[76:79], v118, s[8:11], s26 offen
    s_add_u32 s30, s30, 0x40000
    s_add_u32 s31, s31, 0x40000
    s_add_u32 s32, s32, 0x20000
    s_add_u32 s23, s24, 1024
    s_add_u32 s48, s23, 4096
    s_xor_b32 s25, s25, 0x40000
    s_xor_b32 s26, s26, 0x40000
    s_mov_b32 s35, 0x49800000
    s_add_u32 s22, s22, 1
    v_mov_b32 v32, 0
    v_mov_b32 v33, 0
    v_mov_b32 v34, 0
    v_mov_b32 v35, 0
    v_mov_b32 v36, 0
    v_mov_b32 v37, 0
    v_mov_b32 v38, 0
    v_mov_b32 v39, 0
    v_mov_b32 v40, 0
    v_mov_b32 v41, 0
    v_mov_b32 v42, 0
    v_mov_b32 v43, 0
    v_mov_b32 v44, 0
    v_mov_b32 v45, 0
    v_mov_b32 v46, 0
    v_mov_b32 v47, 0
    v_mov_b32 v48, 0
    v_mov_b32 v49, 0
    v_mov_b32 v50, 0
    v_mov_b32 v51, 0
    v_mov_b32 v52, 0
    v_mov_b32 v53, 0
    v_mov_b32 v54, 0
    v_mov_b32 v55, 0
    ds_read_b128 v[80:83], v123
    ds_read_b128 v[84:87], v123 offset:1024
    ds_read_b128 v[56:59], v123 offset:2048
    ds_read_b128 v[60:63], v123 offset:3072
    ds_read_b128 v[64:67], v123 offset:32768
    ds_read_b128 v[68:71], v123 offset:33792
    ds_read_b128 v[72:75], v123 offset:34816
    ds_read_b128 v[76:79], v123 offset:35840
    ds_read_b128 v[88:91], v123 offset:4096
    ds_read_b128 v[92:95], v123 offset:5120
    ds_read_b128 v[96:99], v123 offset:6144
    ds_read_b128 v[100:103], v123 offset:7168
    ds_read_b128 v[104:107], v123 offset:36864
    ds_read_b128 v[108:111], v123 offset:37888
    ds_read_b128 v[24:27], v123 offset:38912
    ds_read_b128 v[28:31], v123 offset:39936
    s_add_u32 s24, s24, 8192
    s_bitset0_b32 s24, 15
    s_xor_b32 s55, s24, 16384
    s_xor_b32 s29, s29, 0x40000
    s_xor_b32 s53, s29, 1024
    s_bfe_u32 s33, s22, 0x10001
    s_add_u32 s40, s22, 5
    s_lshr_b32 s40, s40, 2
    s_min_u32 s40, s40, 16
    s_bfm_b32 s58, s40, 0
    s_waitcnt vmcnt(4)
    v_cmp_eq_u32 vcc, 0, v125
    s_nop 0
    s_and_b64 vcc, vcc, s[58:59]
    s_cbranch_scc1 L_kvw_26
L_kvb_27:
    v_mov_b32 v15, 0
    s_nop 2
    v_mov_b32 v15, 0
    s_nop 2
    v_mov_b32 v15, 0
    s_nop 2
    v_mov_b32 v15, 0
    s_nop 2
    v_mov_b32 v15, 0
    s_nop 2
    v_mov_b32 v15, 0
    s_nop 2
    v_mov_b32 v15, 0
    s_nop 2
    v_mov_b32 v15, 0
    s_nop 2
    v_mov_b32 v15, 0
    s_nop 2
    v_mov_b32 v15, 0
    s_nop 2
    v_mov_b32 v15, 0
    s_nop 2
    v_mov_b32 v15, 0
    s_nop 2
    v_mov_b32 v15, 0
    s_nop 2
    v_mov_b32 v15, 0
    s_nop 2
    v_mov_b32 v15, 0
    s_nop 2
    v_mov_b32 v15, 0
    s_nop 2
    v_mov_b32 v15, 0
    s_nop 2
    v_mov_b32 v15, 0
    s_nop 2
    v_mov_b32 v15, 0
    s_nop 2
    v_mov_b32 v15, 0
    s_nop 2
    v_mov_b32 v15, 0
    s_nop 2
    v_mov_b32 v15, 0
    s_nop 2
    v_mov_b32 v15, 0
    s_nop 2
    v_mov_b32 v15, 0
    s_nop 2
    v_mov_b32 v15, 0
    s_nop 2
    v_mov_b32 v15, 0
    s_nop 2
    v_mov_b32 v15, 0
    s_nop 2
    v_mov_b32 v15, 0
    s_nop 2
    v_mov_b32 v15, 0
    s_nop 2
    v_mov_b32 v15, 0
    s_nop 2
    v_mov_b32 v15, 0
    s_nop 2
    s_waitcnt lgkmcnt(0)
    s_branch L_chain_top1_f
.p2align 6
L_chain_top2_f:
    buffer_load_dwordx4 v[0:3], v117, s[8:11], s23 offen nt
    v_mov_b32 v48, 0
    v_mov_b32 v49, 0
    v_mov_b32 v50, 0
    v_mov_b32 v51, 0
    v_mov_b32 v52, 0
    v_mov_b32 v53, 0
    v_mov_b32 v15, 0
    v_mov_b32 v15, 0
    v_mov_b32 v15, 0
    v_mov_b32 v15, 0
    v_mov_b32 v15, 0
    v_mov_b32 v15, 0
    v_mov_b32 v15, 0
    v_mov_b32 v15, 0
    v_mov_b32 v15, 0
    v_mov_b32 v15, 0
    buffer_load_dwordx4 v[0:3], v117, s[8:11], s23 offen sc1
    s_waitcnt vmcnt(3)
    v_mov_b32 v36, 0
    v_mov_b32 v37, 0
    v_mov_b32 v38, 0
    v_mov_b32 v39, 0
    v_mov_b32 v40, 0
    v_mov_b32 v41, 0
    v_mov_b32 v42, 0
    v_mov_b32 v43, 0
    v_mov_b32 v44, 0
    v_mov_b32 v45, 0
    v_mov_b32 v46, 0
    v_mov_b32 v47, 0
    v_mov_b32 v15, 0
    v_mov_b32 v15, 0
    v_mov_b32 v15, 0
    v_mov_b32 v15, 0
L_mret_28:
    buffer_load_dwordx4 v[0:3], v117, s[8:11], s23 offen sc1
    s_add_u32 s45, s45, 1
    s_cmp_lt_u32 s45, 0x10000
    s_cselect_b32 s56, -2, -1
    s_nop 3
    v_mov_b32 v32, 0
    v_mov_b32 v33, 0
    v_mov_b32 v34, 0
    v_mov_b32 v35, 0
    s_waitcnt vmcnt(2)
    v_max3_u32 v15, v0, v1, v2
    v_max_u32 v15, v15, v3
    v_cmp_lt_u32 vcc, s56, v15
    v_smfmac_f32_16x16x64_bf16 v[32:35], v[0:3], v[80:87], v116
    s_cbranch_vccnz L_mret_28
    ds_write_b128 v117, v[0:3] offset:2048
    v_smfmac_f32_16x16x64_bf16 v[36:39], v[0:3], v[56:63], v116
    buffer_load_dwordx4 v[4:7], v117, s[8:11], s48 offen nt
    v_smfmac_f32_16x16x64_bf16 v[40:43], v[0:3], v[64:71], v116
    buffer_load_dwordx4 v117, s[8:11], s48 offen nt lds
    s_mov_b32 m0, 12288
    v_smfmac_f32_16x16x64_bf16 v[44:47], v[0:3], v[72:79], v116
    s_waitcnt lgkmcnt(0)
    s_barrier
    ds_read_b128 v[8:11], v117 offset:3072
    v_smfmac_f32_16x16x64_bf16 v[48:51], v[0:3], a[192:199], v116
    ds_read_b128 v[16:19], v117
    ds_read_b128 v[20:23], v117 offset:1024
    v_smfmac_f32_16x16x64_bf16 v[52:55], v[0:3], a[200:207], v116
    ds_read_b128 v[80:83], v117 offset:14336
    s_waitcnt lgkmcnt(3)
    v_smfmac_f32_16x16x64_bf16 v[32:35], v[8:11], a[0:7], v116
    ds_read_b128 v[84:87], v117 offset:15360
    v_smfmac_f32_16x16x64_bf16 v[36:39], v[8:11], a[8:15], v116
    ds_read_b128 v[56:59], v117 offset:8192
    s_waitcnt lgkmcnt(4)
    v_smfmac_f32_16x16x64_bf16 v[32:35], v[16:19], a[32:39], v116
    ds_read_b128 v[60:63], v117 offset:9216
    v_smfmac_f32_16x16x64_bf16 v[36:39], v[16:19], a[40:47], v116
    ds_read_b128 v[64:67], v117 offset:10240
    s_waitcnt lgkmcnt(5)
    v_smfmac_f32_16x16x64_bf16 v[32:35], v[20:23], a[64:71], v116
    ds_read_b128 v[68:71], v117 offset:11264
    v_smfmac_f32_16x16x64_bf16 v[36:39], v[20:23], a[72:79], v116
    buffer_store_dwordx4 v[112:115], v117, s[8:11], s32 offen sc1
    v_smfmac_f32_16x16x64_bf16 v[40:43], v[8:11], a[96:103], v116
    ds_read_b128 v[72:75], v117 offset:12288
    v_smfmac_f32_16x16x64_bf16 v[40:43], v[16:19], a[128:135], v116
    ds_read_b128 v[76:79], v117 offset:13312
    v_smfmac_f32_16x16x64_bf16 v[40:43], v[20:23], a[160:167], v116
    s_waitcnt vmcnt(2)
    v_max3_u32 v15, v4, v5, v6
    v_smfmac_f32_16x16x64_bf16 v[44:47], v[8:11], a[104:111], v116
    v_max_u32 v15, v15, v7
    v_smfmac_f32_16x16x64_bf16 v[44:47], v[16:19], a[136:143], v116
    s_waitcnt vmcnt(1) lgkmcnt(0)
    v_cmp_lt_u32 vcc, s56, v15
    v_smfmac_f32_16x16x64_bf16 v[44:47], v[20:23], a[168:175], v116
    s_cbranch_vccnz L_mret_29
L_mgo_30:
    v_smfmac_f32_16x16x64_bf16 v[44:47], v[4:7], v[24:31], v116
    s_barrier
    ds_read_b128 v[12:15], v117 offset:7168
    v_smfmac_f32_16x16x64_bf16 v[32:35], v[4:7], v[88:95], v116
    ds_read_b128 v[24:27], v117 offset:4096
    v_smfmac_f32_16x16x64_bf16 v[36:39], v[4:7], v[96:103], v116
    ds_read_b128 v[28:31], v117 offset:5120
    v_smfmac_f32_16x16x64_bf16 v[40:43], v[4:7], v[104:111], v116
    ds_read_b128 v[88:91], v117 offset:28672
    s_waitcnt lgkmcnt(3)
    v_smfmac_f32_16x16x64_bf16 v[32:35], v[12:15], a[16:23], v116
    ds_read_b128 v[92:95], v117 offset:29696
    s_waitcnt lgkmcnt(3)
    v_smfmac_f32_16x16x64_bf16 v[32:35], v[24:27], a[48:55], v116
    buffer_load_dwordx4 v117, s[8:11], s30 offen lds
    s_waitcnt lgkmcnt(2)
    v_smfmac_f32_16x16x64_bf16 v[32:35], v[28:31], a[80:87], v116
    ds_read_b128 v[96:99], v117 offset:23552
    v_smfmac_f32_16x16x64_bf16 v[36:39], v[12:15], a[24:31], v116
    ds_read_b128 v[100:103], v117 offset:23552
    v_smfmac_f32_16x16x64_bf16 v[36:39], v[24:27], a[56:63], v116
    buffer_load_dwordx4 v117, s[8:11], s30 offen offset:1024 lds
    s_add_u32 m0, s52, 0x6000
    v_add_f32 v32, v32, v34
    v_smfmac_f32_16x16x64_bf16 v[36:39], v[28:31], a[88:95], v116
    ds_read_b128 v[104:107], v117 offset:23552
    v_add_f32 v33, v33, v35
    v_smfmac_f32_16x16x64_bf16 v[40:43], v[12:15], a[112:119], v116
    ds_read_b128 v[108:111], v117 offset:23552
    v_mul_f32 v32, s34, v32
    v_smfmac_f32_16x16x64_bf16 v[40:43], v[24:27], a[144:151], v116
    s_waitcnt lgkmcnt(4)
    buffer_load_dwordx4 v117, s[8:11], s31 offen lds
    v_mul_f32 v33, s34, v33
    v_smfmac_f32_16x16x64_bf16 v[40:43], v[28:31], a[176:183], v116
    ds_read_b128 v[0:3], v124
    v_add_f32 v36, v36, v38
    v_smfmac_f32_16x16x64_bf16 v[48:51], v[4:7], a[208:215], v116
    v_add_f32 v37, v37, v39
    v_smfmac_f32_16x16x64_bf16 v[52:55], v[4:7], a[216:223], v116
    buffer_load_dwordx4 v117, s[8:11], s31 offen offset:1024 lds
    s_mov_b32 m0, 6144
    v_mul_f32 v36, s34, v36
    v_smfmac_f32_16x16x64_bf16 v[44:47], v[12:15], a[120:127], v116
    ds_read_b128 v[4:7], v124 offset:1024
    v_mul_f32 v37, s34, v37
    v_smfmac_f32_16x16x64_bf16 v[44:47], v[24:27], a[152:159], v116
    v_cvt_pk_bf16_f32 v34, v32, v36
    v_smfmac_f32_16x16x64_bf16 v[44:47], v[28:31], a[184:191], v116
    v_cvt_pk_bf16_f32 v35, v33, v37
    v_add_f32 v40, v40, v42
    v_smfmac_f32_16x16x64_bf16 v[48:51], v[8:11], a[224:231], v116
    ds_write2_b32 v120, v34, v35 offset0:32 offset1:48
    v_add_f32 v41, v41, v43
    v_smfmac_f32_16x16x64_bf16 v[52:55], v[8:11], a[232:239], v116
    v_add_f32 v44, v44, v46
    v_add_f32 v45, v45, v47
    v_cvt_pk_bf16_f32 v113, v40, v44
    v_cvt_pk_bf16_f32 v115, v41, v45
    v_smfmac_f32_16x16x64_bf16 v[48:51], v[12:15], a[240:247], v116
    ds_write2_b32 v120, v113, v115 offset0:0 offset1:16
    v_smfmac_f32_16x16x64_bf16 v[52:55], v[12:15], a[248:255], v116
    s_cmp_eq_u32 s22, 63
    s_cbranch_scc1 L_chain_last_f
    v_smfmac_f32_16x16x64_bf16 v[48:51], v[16:19], v[128:135], v116
    buffer_store_dword v126, v119, s[8:11], s55 offen
    v_smfmac_f32_16x16x64_bf16 v[48:51], v[20:23], v[160:167], v116
    v_smfmac_f32_16x16x64_bf16 v[48:51], v[24:27], v[144:151], v116
    s_waitcnt lgkmcnt(0)
    s_barrier
    v_smfmac_f32_16x16x64_bf16 v[48:51], v[28:31], v[176:183], v116
    ds_read_b128 v[32:35], v121 offset:16384
    ds_read_b128 v[36:39], v121 offset:17408
    v_smfmac_f32_16x16x64_bf16 v[52:55], v[16:19], v[136:143], v116
    ds_read_b128 v[40:43], v121 offset:18432
    ds_read_b128 v[44:47], v121 offset:19456
    v_smfmac_f32_16x16x64_bf16 v[52:55], v[20:23], v[168:175], v116
    ds_read_b128 v[8:11], v124 offset:32768
    v_add_f32 v48, v48, v50
    v_smfmac_f32_16x16x64_bf16 v[52:55], v[24:27], v[152:159], v116
    ds_read_b128 v[12:15], v124 offset:33792
    v_add_f32 v49, v49, v51
    v_smfmac_f32_16x16x64_bf16 v[52:55], v[28:31], v[184:191], v116
    s_waitcnt lgkmcnt(5)
    v_cvt_pk_bf16_f32 v112, v48, v49
    v_mfma_f32_16x16x32_bf16 v[56:59], v[56:59], v[32:35], 0
    s_waitcnt lgkmcnt(4)
    v_mov_b32 v48, s50
    v_mov_b32 v49, s50
    v_mfma_f32_16x16x32_bf16 v[56:59], v[60:63], v[36:39], v[56:59]
    ds_read_b128 v[16:19], v124 offset:2048
    s_waitcnt lgkmcnt(4)
    v_mov_b32 v50, s50
    v_mov_b32 v51, s50
    v_mfma_f32_16x16x32_bf16 v[56:59], v[64:67], v[40:43], v[56:59]
    ds_read_b128 v[20:23], v124 offset:3072
    s_waitcnt lgkmcnt(4)
    v_add_f32 v52, v52, v54
    v_mfma_f32_16x16x32_bf16 v[56:59], v[68:71], v[44:47], v[56:59]
    ds_read_b128 v[24:27], v124 offset:4096
    v_add_f32 v53, v53, v55
    v_mfma_f32_16x16x32_bf16 v[60:63], v[72:75], v[32:35], 0
    ds_read_b128 v[28:31], v124 offset:5120
    v_cvt_pk_bf16_f32 v114, v52, v53
    v_mov_b32 v53, 0
    v_mfma_f32_16x16x32_bf16 v[60:63], v[76:79], v[36:39], v[60:63]
    v_exp_f32 v56, v56
    v_mfma_f32_16x16x32_bf16 v[60:63], v[80:83], v[40:43], v[60:63]
    v_exp_f32 v57, v57
    v_mfma_f32_16x16x32_bf16 v[60:63], v[84:87], v[44:47], v[60:63]
    v_exp_f32 v58, v58
    v_mfma_f32_16x16x32_bf16 v[64:67], v[32:35], v[32:35], 0
    v_exp_f32 v59, v59
    v_cvt_pk_bf16_f32 v68, v56, v57
    v_mfma_f32_16x16x32_bf16 v[64:67], v[36:39], v[36:39], v[64:67]
    v_exp_f32 v60, v60
    v_cvt_pk_bf16_f32 v69, v58, v59
    v_mfma_f32_16x16x32_bf16 v[64:67], v[40:43], v[40:43], v[64:67]
    v_exp_f32 v61, v61
    v_mfma_f32_16x16x32_bf16 v[64:67], v[44:47], v[44:47], v[64:67]
    v_exp_f32 v62, v62
    v_exp_f32 v63, v63
    v_cvt_pk_bf16_f32 v70, v60, v61
    v_cvt_pk_bf16_f32 v71, v62, v63
    s_nop 1
    v_mfma_f32_16x16x32_bf16 v[72:75], v[88:91], v[68:71], 0
    s_nop 0
    v_exp_f32 v64, v64
    v_mfma_f32_16x16x32_bf16 v[76:79], v[92:95], v[68:71], 0
    v_exp_f32 v65, v65
    v_mfma_f32_16x16x32_bf16 v[80:83], v[48:51], v[68:71], 0
    v_cvt_pk_bf16_f32 v52, v64, v65
    s_nop 1
    v_mfma_f32_16x16x16_bf16 v[72:75], v[112:113], v[52:53], v[72:75]
    ds_read_b128 v[32:35], v124 offset:6144
    v_mfma_f32_16x16x16_bf16 v[76:79], v[114:115], v[52:53], v[76:79]
    ds_read_b128 v[36:39], v124 offset:7168
    v_mfma_f32_16x16x16_bf16 v[80:83], v[48:49], v[52:53], v[80:83]
L_norm_31:
    s_mov_b64 vcc, s[36:37]
    v_mov_b32 v122, v122
    v_mov_b32 v122, v122
    v_mov_b32 v122, v122
    v_cndmask_b32_dpp v76, v72, v76, vcc quad_perm:[2,3,2,3] row_mask:0xf bank_mask:0xf
    v_cndmask_b32_dpp v77, v73, v77, vcc quad_perm:[2,3,2,3] row_mask:0xf bank_mask:0xf
    v_cndmask_b32_dpp v78, v74, v78, vcc quad_perm:[2,3,2,3] row_mask:0xf bank_mask:0xf
    v_cndmask_b32_dpp v79, v75, v79, vcc quad_perm:[2,3,2,3] row_mask:0xf bank_mask:0xf
    v_rcp_f32_dpp v84, v80 quad_perm:[2,3,2,3] row_mask:0xf bank_mask:0xf
    s_nop 0
    v_pk_mul_f32 v[76:77], v[76:77], v[84:85] op_sel_hi:[1,0]
    v_pk_mul_f32 v[78:79], v[78:79], v[84:85] op_sel_hi:[1,0]
    v_cvt_pk_bf16_f32 v72, v76, v77
    v_cvt_pk_bf16_f32 v73, v78, v79
    ds_write_b64 v122, v[72:73] offset:21504
    v_max_f32_dpp v86, v80, v84 quad_perm:[2,3,2,3] row_mask:0xf bank_mask:0xf
    v_mov_b32_dpp v60, v72 quad_perm:[0,1,0,1] row_mask:0xf bank_mask:0xf
    v_mov_b32_dpp v61, v73 quad_perm:[0,1,0,1] row_mask:0xf bank_mask:0xf
    v_cmp_lt_f32 vcc, s35, v86
    v_mov_b32_dpp v62, v72 quad_perm:[2,3,2,3] row_mask:0xf bank_mask:0xf
    v_mov_b32_dpp v63, v73 quad_perm:[2,3,2,3] row_mask:0xf bank_mask:0xf
    s_nop 1
    v_smfmac_f32_16x16x64_bf16 v[96:99], v[60:63], v[192:199], v116
    s_cbranch_vccnz L_smax_32
    v_smfmac_f32_16x16x64_bf16 v[100:103], v[60:63], v[224:231], v116
    s_waitcnt lgkmcnt(0)
    s_barrier
    ds_read_b128 v[92:95], v127 offset:22016
    ds_read_b128 v[80:83], v127 offset:20480
    ds_read_b128 v[84:87], v127 offset:20992
    v_smfmac_f32_16x16x64_bf16 v[104:107], v[60:63], v[0:7], v116
    ds_read_b128 v[40:43], v124 offset:34816
    v_smfmac_f32_16x16x64_bf16 v[108:111], v[60:63], v[8:15], v116
    ds_read_b128 v[56:59], v124 offset:36864
    s_waitcnt lgkmcnt(4)
    v_smfmac_f32_16x16x64_bf16 v[96:99], v[92:95], v[200:207], v116
    s_waitcnt lgkmcnt(3)
    v_smfmac_f32_16x16x64_bf16 v[96:99], v[80:83], v[208:215], v116
    ds_read_b128 v[44:47], v124 offset:35840
    s_waitcnt lgkmcnt(3)
    v_smfmac_f32_16x16x64_bf16 v[96:99], v[84:87], v[216:223], v116
    ds_read_b128 v[68:71], v124 offset:39936
    v_smfmac_f32_16x16x64_bf16 v[100:103], v[92:95], v[232:239], v116
    ds_read_b128 v[64:67], v124 offset:38912
    v_smfmac_f32_16x16x64_bf16 v[100:103], v[80:83], v[240:247], v116
    ds_read_b128 v[60:63], v124 offset:37888
    v_cvt_pk_bf16_f32 v72, v96, v98
    v_smfmac_f32_16x16x64_bf16 v[100:103], v[84:87], v[248:255], v116
    v_and_or_b32 v72, v72, -2, s33
    v_smfmac_f32_16x16x64_bf16 v[104:107], v[92:95], v[16:23], v116
    v_cvt_pk_bf16_f32 v74, v97, v99
    v_smfmac_f32_16x16x64_bf16 v[104:107], v[80:83], v[24:31], v116
    v_cvt_pk_bf16_f32 v73, v100, v102
    v_cvt_pk_bf16_f32 v75, v101, v103
    v_smfmac_f32_16x16x64_bf16 v[104:107], v[84:87], v[32:39], v116
    buffer_store_dwordx4 v[72:75], v118, s[8:11], s25 offen
    s_waitcnt lgkmcnt(3)
    v_smfmac_f32_16x16x64_bf16 v[108:111], v[92:95], v[40:47], v116
    s_waitcnt lgkmcnt(0)
    v_smfmac_f32_16x16x64_bf16 v[108:111], v[80:83], v[56:63], v116
    v_cvt_pk_bf16_f32 v76, v104, v106
    v_smfmac_f32_16x16x64_bf16 v[108:111], v[84:87], v[64:71], v116
    v_and_or_b32 v76, v76, -2, s33
    v_cvt_pk_bf16_f32 v78, v105, v107
    v_mov_b32 v122, v122
    v_mov_b32 v122, v122
    v_mov_b32 v122, v122
    v_mov_b32 v122, v122
    v_mov_b32 v122, v122
    v_mov_b32 v122, v122
    v_cvt_pk_bf16_f32 v77, v108, v110
    v_cvt_pk_bf16_f32 v79, v109, v111
    buffer_store_dwordx4 v[76:79], v118, s[8:11], s26 offen
    ds_read_b128 v[80:83], v123
    ds_read_b128 v[84:87], v123 offset:1024
    ds_read_b128 v[56:59], v123 offset:2048
    ds_read_b128 v[60:63], v123 offset:3072
    ds_read_b128 v[64:67], v123 offset:32768
    ds_read_b128 v[68:71], v123 offset:33792
    ds_read_b128 v[72:75], v123 offset:34816
    ds_read_b128 v[76:79], v123 offset:35840
    ds_read_b128 v[88:91], v123 offset:4096
    ds_read_b128 v[92:95], v123 offset:5120
    ds_read_b128 v[96:99], v123 offset:6144
    ds_read_b128 v[100:103], v123 offset:7168
    ds_read_b128 v[104:107], v123 offset:36864
    ds_read_b128 v[108:111], v123 offset:37888
    ds_read_b128 v[24:27], v123 offset:38912
    ds_read_b128 v[28:31], v123 offset:39936
    s_add_u32 s30, s30, 0x40000
    s_add_u32 s31, s31, 0x40000
    s_add_u32 s32, s32, 0x20000
    s_add_u32 s23, s24, 2048
    s_add_u32 s48, s23, 4096
    s_xor_b32 s25, s25, 0x40000
    s_xor_b32 s26, s26, 0x40000
    s_mov_b32 s35, 0x49800000
    s_add_u32 s22, s22, 1
    v_cndmask_b32 v12, 0, v125, s[68:69]
    v_cndmask_b32 v13, 0, v125, s[70:71]
    v_cndmask_b32 v14, 0, v125, s[72:73]
    v_cndmask_b32 v15, 0, v125, s[74:75]
    v_mov_b32 v54, 0
    v_mov_b32 v55, 0
    v_mov_b32 v52, 0
    v_mov_b32 v52, 0
    v_mov_b32 v52, 0
    v_mov_b32 v52, 0
    v_mov_b32 v52, 0
    v_mov_b32 v52, 0
    v_mov_b32 v52, 0
    v_mov_b32 v52, 0
    v_mov_b32 v52, 0
    v_mov_b32 v52, 0
    v_mov_b32 v52, 0
    v_mov_b32 v52, 0
    v_mov_b32 v52, 0
    v_mov_b32 v52, 0
    v_mov_b32 v52, 0
    v_mov_b32 v52, 0
    v_mov_b32 v52, 0
    v_mov_b32 v52, 0
    v_mov_b32 v52, 0
    buffer_load_dwordx4 v[4:7], v117, s[8:11], s29 offen nt
    buffer_load_dwordx4 v[8:11], v117, s[8:11], s53 offen nt
    buffer_load_dwordx4 v[16:19], v117, s[8:11], s29 offen offset:2048 nt
    buffer_load_dwordx4 v[20:23], v117, s[8:11], s53 offen offset:2048 nt
    v_mov_b32 v52, 0
    v_mov_b32 v52, 0
    v_mov_b32 v52, 0
    v_mov_b32 v52, 0
    v_mov_b32 v52, 0
    v_mov_b32 v52, 0
    v_mov_b32 v52, 0
    v_mov_b32 v52, 0
    v_mov_b32 v52, 0
    v_mov_b32 v52, 0
    v_mov_b32 v52, 0
    v_mov_b32 v52, 0
    v_mov_b32 v52, 0
    v_mov_b32 v52, 0
    v_mov_b32 v52, 0
    v_mov_b32 v52, 0
    v_mov_b32 v52, 0
    v_mov_b32 v52, 0
    v_mov_b32 v52, 0
    v_mov_b32 v52, 0
    v_mov_b32 v52, 0
    v_mov_b32 v52, 0
    v_mov_b32 v52, 0
    v_mov_b32 v52, 0
    v_mov_b32 v52, 0
    v_mov_b32 v52, 0
    v_mov_b32 v52, 0
    v_mov_b32 v52, 0
    v_mov_b32 v52, 0
    v_mov_b32 v52, 0
    v_mov_b32 v52, 0
    v_mov_b32 v52, 0
    v_mov_b32 v52, 0
    v_mov_b32 v52, 0
    v_mov_b32 v52, 0
    v_mov_b32 v52, 0
    v_mov_b32 v52, 0
    v_mov_b32 v52, 0
    v_mov_b32 v52, 0
    v_mov_b32 v52, 0
    buffer_load_dwordx4 v[32:35], v117, s[8:11], s29 offen sc1
    buffer_load_dwordx4 v[36:39], v117, s[8:11], s53 offen sc1
    buffer_load_dwordx4 v[40:43], v117, s[8:11], s29 offen offset:2048 sc1
    buffer_load_dwordx4 v[44:47], v117, s[8:11], s53 offen offset:2048 sc1
    v_mov_b32 v52, 0
L_rl_33:
    s_waitcnt vmcnt(7)
    v_mfma_f32_16x16x32_bf16 v[48:51], v[4:7], v[12:15], 0
    v_xor_b32 v52, s33, v4
    s_waitcnt vmcnt(6)
    v_mfma_f32_16x16x32_bf16 v[48:51], v[8:11], v[12:15], v[48:51]
    v_xor_b32 v53, s33, v8
    v_or_b32 v52, v52, v53
    s_waitcnt vmcnt(5)
    v_mfma_f32_16x16x32_bf16 v[48:51], v[16:19], v[12:15], v[48:51]
    v_xor_b32 v53, s33, v16
    v_or_b32 v52, v52, v53
    s_waitcnt vmcnt(4)
    v_mfma_f32_16x16x32_bf16 v[48:51], v[20:23], v[12:15], v[48:51]
    v_xor_b32 v53, s33, v20
    v_or_b32 v52, v52, v53
    v_and_b32 v52, 1, v52
    v_cmp_ne_u32 vcc, 0, v52
    s_cbranch_vccnz L_rslow_34
L_rgo_35:
    s_nop 2
    v_permlane32_swap_b32 v48, v50
    v_permlane32_swap_b32 v49, v51
    v_pk_add_f32 v[48:49], v[48:49], v[50:51]
    s_mov_b64 exec, s[38:39]
    v_cvt_pk_bf16_f32 v12, v48, v49
    v_min_u32 v12, 0xfffffffe, v12
    buffer_store_dword v12, v119, s[8:11], s24 offen
    s_mov_b64 exec, -1
    s_add_u32 s24, s24, 8192
    s_bitset0_b32 s24, 15
    s_xor_b32 s55, s24, 16384
    s_xor_b32 s29, s29, 0x40000
    s_xor_b32 s53, s29, 1024
    s_bfe_u32 s33, s22, 0x10001
    s_waitcnt lgkmcnt(0)
    s_branch L_chain_top2_f
.p2align 6
L_chain_top3_f:
    buffer_load_dwordx4 v[0:3], v117, s[8:11], s23 offen nt
    v_mov_b32 v48, 0
    v_mov_b32 v49, 0
    v_mov_b32 v50, 0
    v_mov_b32 v51, 0
    v_mov_b32 v52, 0
    v_mov_b32 v53, 0
    v_mov_b32 v15, 0
    v_mov_b32 v15, 0
    v_mov_b32 v15, 0
    v_mov_b32 v15, 0
    v_mov_b32 v15, 0
    v_mov_b32 v15, 0
    v_mov_b32 v15, 0
    v_mov_b32 v15, 0
    v_mov_b32 v15, 0
    v_mov_b32 v15, 0
    buffer_load_dwordx4 v[0:3], v117, s[8:11], s23 offen sc1
    s_waitcnt vmcnt(3)
    v_mov_b32 v36, 0
    v_mov_b32 v37, 0
    v_mov_b32 v38, 0
    v_mov_b32 v39, 0
    v_mov_b32 v40, 0
    v_mov_b32 v41, 0
    v_mov_b32 v42, 0
    v_mov_b32 v43, 0
    v_mov_b32 v44, 0
    v_mov_b32 v45, 0
    v_mov_b32 v46, 0
    v_mov_b32 v47, 0
    v_mov_b32 v15, 0
    v_mov_b32 v15, 0
    v_mov_b32 v15, 0
    v_mov_b32 v15, 0
L_mret_36:
    buffer_load_dwordx4 v[0:3], v117, s[8:11], s23 offen sc1
    s_add_u32 s45, s45, 1
    s_cmp_lt_u32 s45, 0x10000
    s_cselect_b32 s56, -2, -1
    s_nop 3
    v_mov_b32 v32, 0
    v_mov_b32 v33, 0
    v_mov_b32 v34, 0
    v_mov_b32 v35, 0
    s_waitcnt vmcnt(2)
    v_max3_u32 v15, v0, v1, v2
    v_max_u32 v15, v15, v3
    v_cmp_lt_u32 vcc, s56, v15
    v_smfmac_f32_16x16x64_bf16 v[32:35], v[0:3], v[80:87], v116
    s_cbranch_vccnz L_mret_36
    ds_write_b128 v117, v[0:3] offset:3072
    v_smfmac_f32_16x16x64_bf16 v[36:39], v[0:3], v[56:63], v116
    buffer_load_dwordx4 v[4:7], v117, s[8:11], s48 offen nt
    v_smfmac_f32_16x16x64_bf16 v[40:43], v[0:3], v[64:71], v116
    buffer_load_dwordx4 v117, s[8:11], s48 offen nt lds
    s_mov_b32 m0, 14336
    v_smfmac_f32_16x16x64_bf16 v[44:47], v[0:3], v[72:79], v116
    s_waitcnt lgkmcnt(0)
    s_barrier
    ds_read_b128 v[8:11], v117 offset:2048
    v_smfmac_f32_16x16x64_bf16 v[48:51], v[0:3], a[192:199], v116
    ds_read_b128 v[16:19], v117 offset:1024
    ds_read_b128 v[20:23], v117
    v_smfmac_f32_16x16x64_bf16 v[52:55], v[0:3], a[200:207], v116
    ds_read_b128 v[80:83], v117 offset:14336
    s_waitcnt lgkmcnt(3)
    v_smfmac_f32_16x16x64_bf16 v[32:35], v[8:11], a[0:7], v116
    ds_read_b128 v[84:87], v117 offset:15360
    v_smfmac_f32_16x16x64_bf16 v[36:39], v[8:11], a[8:15], v116
    ds_read_b128 v[56:59], v117 offset:8192
    s_waitcnt lgkmcnt(4)
    v_smfmac_f32_16x16x64_bf16 v[32:35], v[16:19], a[32:39], v116
    ds_read_b128 v[60:63], v117 offset:9216
    v_smfmac_f32_16x16x64_bf16 v[36:39], v[16:19], a[40:47], v116
    ds_read_b128 v[64:67], v117 offset:10240
    s_waitcnt lgkmcnt(5)
    v_smfmac_f32_16x16x64_bf16 v[32:35], v[20:23], a[64:71], v116
    ds_read_b128 v[68:71], v117 offset:11264
    v_smfmac_f32_16x16x64_bf16 v[36:39], v[20:23], a[72:79], v116
    ds_read_b128 v[72:75], v117 offset:12288
    v_smfmac_f32_16x16x64_bf16 v[40:43], v[8:11], a[96:103], v116
    ds_read_b128 v[76:79], v117 offset:13312
    v_smfmac_f32_16x16x64_bf16 v[40:43], v[16:19], a[128:135], v116
    buffer_store_dwordx4 v[112:115], v117, s[8:11], s32 offen sc1
    v_smfmac_f32_16x16x64_bf16 v[40:43], v[20:23], a[160:167], v116
    s_waitcnt vmcnt(2)
    v_max3_u32 v15, v4, v5, v6
    v_smfmac_f32_16x16x64_bf16 v[44:47], v[8:11], a[104:111], v116
    v_max_u32 v15, v15, v7
    v_smfmac_f32_16x16x64_bf16 v[44:47], v[16:19], a[136:143], v116
    s_waitcnt vmcnt(1) lgkmcnt(0)
    v_cmp_lt_u32 vcc, s56, v15
    v_smfmac_f32_16x16x64_bf16 v[44:47], v[20:23], a[168:175], v116
    s_cbranch_vccnz L_mret_37
L_mgo_38:
    v_smfmac_f32_16x16x64_bf16 v[44:47], v[4:7], v[24:31], v116
    s_barrier
    ds_read_b128 v[12:15], v117 offset:6144
    v_smfmac_f32_16x16x64_bf16 v[32:35], v[4:7], v[88:95], v116
    ds_read_b128 v[24:27], v117 offset:5120
    v_smfmac_f32_16x16x64_bf16 v[36:39], v[4:7], v[96:103], v116
    ds_read_b128 v[28:31], v117 offset:4096
    v_smfmac_f32_16x16x64_bf16 v[40:43], v[4:7], v[104:111], v116
    ds_read_b128 v[88:91], v117 offset:30720
    s_waitcnt lgkmcnt(3)
    v_smfmac_f32_16x16x64_bf16 v[32:35], v[12:15], a[16:23], v116
    ds_read_b128 v[92:95], v117 offset:31744
    s_waitcnt lgkmcnt(3)
    v_smfmac_f32_16x16x64_bf16 v[32:35], v[24:27], a[48:55], v116
    ds_read_b128 v[96:99], v117 offset:23552
    s_waitcnt lgkmcnt(3)
    v_smfmac_f32_16x16x64_bf16 v[32:35], v[28:31], a[80:87], v116
    buffer_load_dwordx4 v117, s[8:11], s30 offen lds
    v_smfmac_f32_16x16x64_bf16 v[36:39], v[12:15], a[24:31], v116
    ds_read_b128 v[100:103], v117 offset:23552
    v_smfmac_f32_16x16x64_bf16 v[36:39], v[24:27], a[56:63], v116
    ds_read_b128 v[104:107], v117 offset:23552
    v_add_f32 v32, v32, v34
    v_smfmac_f32_16x16x64_bf16 v[36:39], v[28:31], a[88:95], v116
    buffer_load_dwordx4 v117, s[8:11], s30 offen offset:1024 lds
    s_add_u32 m0, s52, 0x6000
    v_add_f32 v33, v33, v35
    v_smfmac_f32_16x16x64_bf16 v[40:43], v[12:15], a[112:119], v116
    ds_read_b128 v[108:111], v117 offset:23552
    v_mul_f32 v32, s34, v32
    v_smfmac_f32_16x16x64_bf16 v[40:43], v[24:27], a[144:151], v116
    ds_read_b128 v[0:3], v124
    v_mul_f32 v33, s34, v33
    v_smfmac_f32_16x16x64_bf16 v[40:43], v[28:31], a[176:183], v116
    s_waitcnt lgkmcnt(5)
    buffer_load_dwordx4 v117, s[8:11], s31 offen lds
    v_add_f32 v36, v36, v38
    v_smfmac_f32_16x16x64_bf16 v[48:51], v[4:7], a[208:215], v116
    v_add_f32 v37, v37, v39
    v_smfmac_f32_16x16x64_bf16 v[52:55], v[4:7], a[216:223], v116
    ds_read_b128 v[4:7], v124 offset:1024
    v_mul_f32 v36, s34, v36
    v_smfmac_f32_16x16x64_bf16 v[44:47], v[12:15], a[120:127], v116
    buffer_load_dwordx4 v117, s[8:11], s31 offen offset:1024 lds
    s_mov_b32 m0, 7168
    v_mul_f32 v37, s34, v37
    v_smfmac_f32_16x16x64_bf16 v[44:47], v[24:27], a[152:159], v116
    v_cvt_pk_bf16_f32 v34, v32, v36
    v_smfmac_f32_16x16x64_bf16 v[44:47], v[28:31], a[184:191], v116
    v_cvt_pk_bf16_f32 v35, v33, v37
    v_add_f32 v40, v40, v42
    v_smfmac_f32_16x16x64_bf16 v[48:51], v[8:11], a[224:231], v116
    ds_write2_b32 v120, v34, v35 offset0:32 offset1:48
    v_add_f32 v41, v41, v43
    v_smfmac_f32_16x16x64_bf16 v[52:55], v[8:11], a[232:239], v116
    v_add_f32 v44, v44, v46
    v_add_f32 v45, v45, v47
    v_cvt_pk_bf16_f32 v113, v40, v44
    v_cvt_pk_bf16_f32 v115, v41, v45
    v_smfmac_f32_16x16x64_bf16 v[48:51], v[12:15], a[240:247], v116
    ds_write2_b32 v120, v113, v115 offset0:0 offset1:16
    v_smfmac_f32_16x16x64_bf16 v[52:55], v[12:15], a[248:255], v116
    s_cmp_eq_u32 s22, 63
    s_cbranch_scc1 L_chain_last_f
    v_smfmac_f32_16x16x64_bf16 v[48:51], v[16:19], v[128:135], v116
    v_smfmac_f32_16x16x64_bf16 v[48:51], v[20:23], v[160:167], v116
    buffer_store_dword v126, v119, s[8:11], s55 offen
    v_smfmac_f32_16x16x64_bf16 v[48:51], v[24:27], v[144:151], v116
    s_waitcnt lgkmcnt(0)
    s_barrier
    v_smfmac_f32_16x16x64_bf16 v[48:51], v[28:31], v[176:183], v116
    ds_read_b128 v[32:35], v121 offset:16384
    ds_read_b128 v[36:39], v121 offset:17408
    v_smfmac_f32_16x16x64_bf16 v[52:55], v[16:19], v[136:143], v116
    ds_read_b128 v[40:43], v121 offset:18432
    ds_read_b128 v[44:47], v121 offset:19456
    v_smfmac_f32_16x16x64_bf16 v[52:55], v[20:23], v[168:175], v116
    ds_read_b128 v[8:11], v124 offset:32768
    v_add_f32 v48, v48, v50
    v_smfmac_f32_16x16x64_bf16 v[52:55], v[24:27], v[152:159], v116
    ds_read_b128 v[12:15], v124 offset:33792
    v_add_f32 v49, v49, v51
    v_smfmac_f32_16x16x64_bf16 v[52:55], v[28:31], v[184:191], v116
    s_waitcnt lgkmcnt(5)
    v_cvt_pk_bf16_f32 v112, v48, v49
    v_mfma_f32_16x16x32_bf16 v[56:59], v[56:59], v[32:35], 0
    s_waitcnt lgkmcnt(4)
    v_mov_b32 v48, s50
    v_mov_b32 v49, s50
    v_mfma_f32_16x16x32_bf16 v[56:59], v[60:63], v[36:39], v[56:59]
    ds_read_b128 v[16:19], v124 offset:2048
    s_waitcnt lgkmcnt(4)
    v_mov_b32 v50, s50
    v_mov_b32 v51, s50
    v_mfma_f32_16x16x32_bf16 v[56:59], v[64:67], v[40:43], v[56:59]
    ds_read_b128 v[20:23], v124 offset:3072
    s_waitcnt lgkmcnt(4)
    v_add_f32 v52, v52, v54
    v_mfma_f32_16x16x32_bf16 v[56:59], v[68:71], v[44:47], v[56:59]
    ds_read_b128 v[24:27], v124 offset:4096
    v_add_f32 v53, v53, v55
    v_mfma_f32_16x16x32_bf16 v[60:63], v[72:75], v[32:35], 0
    ds_read_b128 v[28:31], v124 offset:5120
    v_cvt_pk_bf16_f32 v114, v52, v53
    v_mov_b32 v53, 0
    v_mfma_f32_16x16x32_bf16 v[60:63], v[76:79], v[36:39], v[60:63]
    v_exp_f32 v56, v56
    v_mfma_f32_16x16x32_bf16 v[60:63], v[80:83], v[40:43], v[60:63]
    v_exp_f32 v57, v57
    v_mfma_f32_16x16x32_bf16 v[60:63], v[84:87], v[44:47], v[60:63]
    v_exp_f32 v58, v58
    v_mfma_f32_16x16x32_bf16 v[64:67], v[32:35], v[32:35], 0
    v_exp_f32 v59, v59
    v_cvt_pk_bf16_f32 v68, v56, v57
    v_mfma_f32_16x16x32_bf16 v[64:67], v[36:39], v[36:39], v[64:67]
    v_exp_f32 v60, v60
    v_cvt_pk_bf16_f32 v69, v58, v59
    v_mfma_f32_16x16x32_bf16 v[64:67], v[40:43], v[40:43], v[64:67]
    v_exp_f32 v61, v61
    v_mfma_f32_16x16x32_bf16 v[64:67], v[44:47], v[44:47], v[64:67]
    v_exp_f32 v62, v62
    v_exp_f32 v63, v63
    v_cvt_pk_bf16_f32 v70, v60, v61
    v_cvt_pk_bf16_f32 v71, v62, v63
    s_nop 1
    v_mfma_f32_16x16x32_bf16 v[72:75], v[88:91], v[68:71], 0
    s_nop 0
    v_exp_f32 v64, v64
    v_mfma_f32_16x16x32_bf16 v[76:79], v[92:95], v[68:71], 0
    v_exp_f32 v65, v65
    v_mfma_f32_16x16x32_bf16 v[80:83], v[48:51], v[68:71], 0
    v_cvt_pk_bf16_f32 v52, v64, v65
    s_nop 1
    v_mfma_f32_16x16x16_bf16 v[72:75], v[112:113], v[52:53], v[72:75]
    ds_read_b128 v[32:35], v124 offset:6144
    v_mfma_f32_16x16x16_bf16 v[76:79], v[114:115], v[52:53], v[76:79]
    ds_read_b128 v[36:39], v124 offset:7168
    v_mfma_f32_16x16x16_bf16 v[80:83], v[48:49], v[52:53], v[80:83]
L_norm_39:
    s_mov_b64 vcc, s[36:37]
    v_mov_b32 v122, v122
    v_mov_b32 v122, v122
    v_mov_b32 v122, v122
    v_cndmask_b32_dpp v76, v72, v76, vcc quad_perm:[2,3,2,3] row_mask:0xf bank_mask:0xf
    v_cndmask_b32_dpp v77, v73, v77, vcc quad_perm:[2,3,2,3] row_mask:0xf bank_mask:0xf
    v_cndmask_b32_dpp v78, v74, v78, vcc quad_perm:[2,3,2,3] row_mask:0xf bank_mask:0xf
    v_cndmask_b32_dpp v79, v75, v79, vcc quad_perm:[2,3,2,3] row_mask:0xf bank_mask:0xf
    v_rcp_f32_dpp v84, v80 quad_perm:[2,3,2,3] row_mask:0xf bank_mask:0xf
    s_nop 0
    v_pk_mul_f32 v[76:77], v[76:77], v[84:85] op_sel_hi:[1,0]
    v_pk_mul_f32 v[78:79], v[78:79], v[84:85] op_sel_hi:[1,0]
    v_cvt_pk_bf16_f32 v72, v76, v77
    v_cvt_pk_bf16_f32 v73, v78, v79
    ds_write_b64 v122, v[72:73] offset:22016
    v_max_f32_dpp v86, v80, v84 quad_perm:[2,3,2,3] row_mask:0xf bank_mask:0xf
    v_mov_b32_dpp v60, v72 quad_perm:[0,1,0,1] row_mask:0xf bank_mask:0xf
    v_mov_b32_dpp v61, v73 quad_perm:[0,1,0,1] row_mask:0xf bank_mask:0xf
    v_cmp_lt_f32 vcc, s35, v86
    v_mov_b32_dpp v62, v72 quad_perm:[2,3,2,3] row_mask:0xf bank_mask:0xf
    v_mov_b32_dpp v63, v73 quad_perm:[2,3,2,3] row_mask:0xf bank_mask:0xf
    s_nop 1
    v_smfmac_f32_16x16x64_bf16 v[96:99], v[60:63], v[192:199], v116
    s_cbranch_vccnz L_smax_40
    v_smfmac_f32_16x16x64_bf16 v[100:103], v[60:63], v[224:231], v116
    s_waitcnt lgkmcnt(0)
    s_barrier
    ds_read_b128 v[92:95], v127 offset:21504
    ds_read_b128 v[80:83], v127 offset:20992
    ds_read_b128 v[84:87], v127 offset:20480
    v_smfmac_f32_16x16x64_bf16 v[104:107], v[60:63], v[0:7], v116
    ds_read_b128 v[40:43], v124 offset:34816
    v_smfmac_f32_16x16x64_bf16 v[108:111], v[60:63], v[8:15], v116
    ds_read_b128 v[56:59], v124 offset:36864
    s_waitcnt lgkmcnt(4)
    v_smfmac_f32_16x16x64_bf16 v[96:99], v[92:95], v[200:207], v116
    s_waitcnt lgkmcnt(3)
    v_smfmac_f32_16x16x64_bf16 v[96:99], v[80:83], v[208:215], v116
    ds_read_b128 v[44:47], v124 offset:35840
    s_waitcnt lgkmcnt(3)
    v_smfmac_f32_16x16x64_bf16 v[96:99], v[84:87], v[216:223], v116
    ds_read_b128 v[68:71], v124 offset:39936
    v_smfmac_f32_16x16x64_bf16 v[100:103], v[92:95], v[232:239], v116
    ds_read_b128 v[64:67], v124 offset:38912
    v_smfmac_f32_16x16x64_bf16 v[100:103], v[80:83], v[240:247], v116
    ds_read_b128 v[60:63], v124 offset:37888
    v_cvt_pk_bf16_f32 v72, v96, v98
    v_smfmac_f32_16x16x64_bf16 v[100:103], v[84:87], v[248:255], v116
    v_and_or_b32 v72, v72, -2, s33
    v_smfmac_f32_16x16x64_bf16 v[104:107], v[92:95], v[16:23], v116
    v_cvt_pk_bf16_f32 v74, v97, v99
    v_smfmac_f32_16x16x64_bf16 v[104:107], v[80:83], v[24:31], v116
    v_cvt_pk_bf16_f32 v73, v100, v102
    v_cvt_pk_bf16_f32 v75, v101, v103
    v_smfmac_f32_16x16x64_bf16 v[104:107], v[84:87], v[32:39], v116
    buffer_store_dwordx4 v[72:75], v118, s[8:11], s25 offen
    s_waitcnt lgkmcnt(3)
    v_smfmac_f32_16x16x64_bf16 v[108:111], v[92:95], v[40:47], v116
    s_waitcnt lgkmcnt(0)
    v_smfmac_f32_16x16x64_bf16 v[108:111], v[80:83], v[56:63], v116
    v_cvt_pk_bf16_f32 v76, v104, v106
    v_smfmac_f32_16x16x64_bf16 v[108:111], v[84:87], v[64:71], v116
    v_and_or_b32 v76, v76, -2, s33
    v_cvt_pk_bf16_f32 v78, v105, v107
    v_mov_b32 v122, v122
    v_mov_b32 v122, v122
    v_mov_b32 v122, v122
    v_mov_b32 v122, v122
    v_mov_b32 v122, v122
    v_mov_b32 v122, v122
    v_cvt_pk_bf16_f32 v77, v108, v110
    v_cvt_pk_bf16_f32 v79, v109, v111
    buffer_store_dwordx4 v[76:79], v118, s[8:11], s26 offen
    ds_read_b128 v[80:83], v123
    ds_read_b128 v[84:87], v123 offset:1024
    ds_read_b128 v[56:59], v123 offset:2048
    ds_read_b128 v[60:63], v123 offset:3072
    ds_read_b128 v[64:67], v123 offset:32768
    ds_read_b128 v[68:71], v123 offset:33792
    ds_read_b128 v[72:75], v123 offset:34816
    ds_read_b128 v[76:79], v123 offset:35840
    ds_read_b128 v[88:91], v123 offset:4096
    ds_read_b128 v[92:95], v123 offset:5120
    ds_read_b128 v[96:99], v123 offset:6144
    ds_read_b128 v[100:103], v123 offset:7168
    ds_read_b128 v[104:107], v123 offset:36864
    ds_read_b128 v[108:111], v123 offset:37888
    ds_read_b128 v[24:27], v123 offset:38912
    ds_read_b128 v[28:31], v123 offset:39936
    s_add_u32 s30, s30, 0x40000
    s_add_u32 s31, s31, 0x40000
    s_add_u32 s32, s32, 0x20000
    s_add_u32 s23, s24, 3072
    s_add_u32 s48, s23, 4096
    s_xor_b32 s25, s25, 0x40000
    s_xor_b32 s26, s26, 0x40000
    s_mov_b32 s35, 0x49800000
    s_add_u32 s22, s22, 1
    v_cndmask_b32 v12, 0, v125, s[68:69]
    v_cndmask_b32 v13, 0, v125, s[70:71]
    v_cndmask_b32 v14, 0, v125, s[72:73]
    v_cndmask_b32 v15, 0, v125, s[74:75]
    v_mov_b32 v54, 0
    v_mov_b32 v55, 0
    v_mov_b32 v52, 0
    v_mov_b32 v52, 0
    v_mov_b32 v52, 0
    v_mov_b32 v52, 0
    v_mov_b32 v52, 0
    v_mov_b32 v52, 0
    v_mov_b32 v52, 0
    v_mov_b32 v52, 0
    v_mov_b32 v52, 0
    v_mov_b32 v52, 0
    v_mov_b32 v52, 0
    v_mov_b32 v52, 0
    v_mov_b32 v52, 0
    v_mov_b32 v52, 0
    v_mov_b32 v52, 0
    v_mov_b32 v52, 0
    v_mov_b32 v52, 0
    v_mov_b32 v52, 0
    v_mov_b32 v52, 0
    v_mov_b32 v52, 0
    v_mov_b32 v52, 0
    v_mov_b32 v52, 0
    v_mov_b32 v52, 0
    v_mov_b32 v52, 0
    v_mov_b32 v52, 0
    v_mov_b32 v52, 0
    v_mov_b32 v52, 0
    v_mov_b32 v52, 0
    v_mov_b32 v52, 0
    v_mov_b32 v52, 0
    v_mov_b32 v52, 0
    v_mov_b32 v52, 0
    v_mov_b32 v52, 0
    v_mov_b32 v52, 0
    v_mov_b32 v52, 0
    v_mov_b32 v52, 0
    v_mov_b32 v52, 0
    v_mov_b32 v52, 0
    v_mov_b32 v52, 0
    v_mov_b32 v52, 0
    v_mov_b32 v52, 0
    v_mov_b32 v52, 0
    v_mov_b32 v52, 0
    v_mov_b32 v52, 0
    v_mov_b32 v52, 0
    v_mov_b32 v52, 0
    v_mov_b32 v52, 0
    v_mov_b32 v52, 0
    v_mov_b32 v52, 0
    buffer_load_dwordx4 v[4:7], v117, s[8:11], s29 offen nt
    buffer_load_dwordx4 v[8:11], v117, s[8:11], s53 offen nt
    buffer_load_dwordx4 v[16:19], v117, s[8:11], s29 offen offset:2048 nt
    buffer_load_dwordx4 v[20:23], v117, s[8:11], s53 offen offset:2048 nt
    v_mov_b32 v52, 0
    v_mov_b32 v52, 0
    v_mov_b32 v52, 0
    v_mov_b32 v52, 0
    v_mov_b32 v52, 0
    v_mov_b32 v52, 0
    v_mov_b32 v52, 0
    v_mov_b32 v52, 0
    v_mov_b32 v52, 0
    v_mov_b32 v52, 0
    v_mov_b32 v52, 0
    v_mov_b32 v52, 0
    v_mov_b32 v52, 0
    v_mov_b32 v52, 0
    v_mov_b32 v52, 0
    v_mov_b32 v52, 0
    v_mov_b32 v52, 0
    v_mov_b32 v52, 0
    v_mov_b32 v52, 0
    v_mov_b32 v52, 0
    v_mov_b32 v52, 0
    v_mov_b32 v52, 0
    v_mov_b32 v52, 0
    v_mov_b32 v52, 0
    v_mov_b32 v52, 0
    v_mov_b32 v52, 0
    v_mov_b32 v52, 0
    v_mov_b32 v52, 0
    v_mov_b32 v52, 0
    v_mov_b32 v52, 0
    buffer_load_dwordx4 v[32:35], v117, s[8:11], s29 offen sc1
    buffer_load_dwordx4 v[36:39], v117, s[8:11], s53 offen sc1
    buffer_load_dwordx4 v[40:43], v117, s[8:11], s29 offen offset:2048 sc1
    buffer_load_dwordx4 v[44:47], v117, s[8:11], s53 offen offset:2048 sc1
    v_mov_b32 v52, 0
L_rl_41:
    s_waitcnt vmcnt(7)
    v_mfma_f32_16x16x32_bf16 v[48:51], v[4:7], v[12:15], 0
    v_xor_b32 v52, s33, v4
    s_waitcnt vmcnt(6)
    v_mfma_f32_16x16x32_bf16 v[48:51], v[8:11], v[12:15], v[48:51]
    v_xor_b32 v53, s33, v8
    v_or_b32 v52, v52, v53
    s_waitcnt vmcnt(5)
    v_mfma_f32_16x16x32_bf16 v[48:51], v[16:19], v[12:15], v[48:51]
    v_xor_b32 v53, s33, v16
    v_or_b32 v52, v52, v53
    s_waitcnt vmcnt(4)
    v_mfma_f32_16x16x32_bf16 v[48:51], v[20:23], v[12:15], v[48:51]
    v_xor_b32 v53, s33, v20
    v_or_b32 v52, v52, v53
    v_and_b32 v52, 1, v52
    v_cmp_ne_u32 vcc, 0, v52
    s_cbranch_vccnz L_rslow_42
L_rgo_43:
    s_nop 2
    v_permlane32_swap_b32 v48, v50
    v_permlane32_swap_b32 v49, v51
    v_pk_add_f32 v[48:49], v[48:49], v[50:51]
    s_mov_b64 exec, s[38:39]
    v_cvt_pk_bf16_f32 v12, v48, v49
    v_min_u32 v12, 0xfffffffe, v12
    buffer_store_dword v12, v119, s[8:11], s24 offen
    s_mov_b64 exec, -1
    s_add_u32 s24, s24, 8192
    s_bitset0_b32 s24, 15
    s_xor_b32 s55, s24, 16384
    s_xor_b32 s29, s29, 0x40000
    s_xor_b32 s53, s29, 1024
    s_bfe_u32 s33, s22, 0x10001
    s_waitcnt lgkmcnt(0)
    s_branch L_chain_top3_f
L_chain_last_f:
    s_nop 1
    v_smfmac_f32_16x16x64_bf16 v[48:51], v[16:19], v[128:135], v116
    v_smfmac_f32_16x16x64_bf16 v[48:51], v[20:23], v[160:167], v116
    v_smfmac_f32_16x16x64_bf16 v[48:51], v[24:27], v[144:151], v116
    v_smfmac_f32_16x16x64_bf16 v[48:51], v[28:31], v[176:183], v116
    v_smfmac_f32_16x16x64_bf16 v[52:55], v[16:19], v[136:143], v116
    v_smfmac_f32_16x16x64_bf16 v[52:55], v[20:23], v[168:175], v116
    v_smfmac_f32_16x16x64_bf16 v[52:55], v[24:27], v[152:159], v116
    v_smfmac_f32_16x16x64_bf16 v[52:55], v[28:31], v[184:191], v116
    v_add_f32 v48, v48, v50
    v_add_f32 v49, v49, v51
    v_cvt_pk_bf16_f32 v112, v48, v49
    s_nop 4
    v_add_f32 v52, v52, v54
    v_add_f32 v53, v53, v55
    v_cvt_pk_bf16_f32 v114, v52, v53
    s_add_u32 s32, s32, 0x20000
    buffer_store_dwordx4 v[112:115], v117, s[8:11], s32 offen sc1
    v_mov_b32 v94, 64
    s_waitcnt vmcnt(0) lgkmcnt(0)
    s_barrier
    s_mov_b64 exec, 1
    buffer_store_dword v94, off, s[8:11], s44 sc1
    s_mov_b64 exec, -1
    s_endpgm
L_mret_15:
    s_mov_b32 s43, m0
    s_mov_b32 m0, 4096
    buffer_load_dwordx4 v[4:7], v117, s[8:11], s48 offen sc1
    buffer_load_dwordx4 v117, s[8:11], s48 offen sc1 lds
    s_mov_b32 m0, 8192
    s_mov_b32 m0, s43
    s_waitcnt vmcnt(0)
    v_max3_u32 v15, v4, v5, v6
    v_max_u32 v15, v15, v7
    v_cmp_lt_u32 vcc, s56, v15
    s_add_u32 s47, s47, 1
    s_add_u32 s49, s49, 1
    s_cmp_ge_u32 s49, 0x10000
    s_cbranch_scc1 L_mgo_16
    s_cbranch_vccnz L_mret_15
    s_branch L_mgo_16
L_smax_18:
    s_add_u32 s47, s47, 1
    s_mov_b32 s35, 0x7f800000
    s_waitcnt lgkmcnt(0)
    s_sub_u32 s43, s30, 0x40000
    s_add_u32 s40, s43, 4096
    s_nop 7
    buffer_load_dwordx4 v[56:59], v117, s[8:11], s43 offen
    buffer_load_dwordx4 v[60:63], v117, s[8:11], s43 offen offset:1024
    buffer_load_dwordx4 v[64:67], v117, s[8:11], s43 offen offset:2048
    buffer_load_dwordx4 v[68:71], v117, s[8:11], s43 offen offset:3072
    buffer_load_dwordx4 v[72:75], v117, s[8:11], s40 offen
    buffer_load_dwordx4 v[76:79], v117, s[8:11], s40 offen offset:1024
    buffer_load_dwordx4 v[80:83], v117, s[8:11], s40 offen offset:2048
    buffer_load_dwordx4 v[84:87], v117, s[8:11], s40 offen offset:3072
    ds_read_b128 v[32:35], v121 offset:16384
    ds_read_b128 v[36:39], v121 offset:17408
    ds_read_b128 v[40:43], v121 offset:18432
    ds_read_b128 v[44:47], v121 offset:19456
    v_mov_b32 v96, 0
    v_mov_b32 v97, 0
    v_mov_b32 v98, 0
    v_mov_b32 v99, 0
    v_mov_b32 v100, 0
    v_mov_b32 v101, 0
    v_mov_b32 v102, 0
    v_mov_b32 v103, 0
    v_mov_b32 v104, 0
    v_mov_b32 v105, 0
    v_mov_b32 v106, 0
    v_mov_b32 v107, 0
    v_mov_b32 v108, 0
    v_mov_b32 v109, 0
    v_mov_b32 v110, 0
    v_mov_b32 v111, 0
    s_waitcnt vmcnt(0) lgkmcnt(0)
    v_mfma_f32_16x16x32_bf16 v[56:59], v[56:59], v[32:35], 0
    v_mfma_f32_16x16x32_bf16 v[56:59], v[60:63], v[36:39], v[56:59]
    v_mfma_f32_16x16x32_bf16 v[56:59], v[64:67], v[40:43], v[56:59]
    v_mfma_f32_16x16x32_bf16 v[56:59], v[68:71], v[44:47], v[56:59]
    v_mfma_f32_16x16x32_bf16 v[60:63], v[72:75], v[32:35], 0
    v_mfma_f32_16x16x32_bf16 v[60:63], v[76:79], v[36:39], v[60:63]
    v_mfma_f32_16x16x32_bf16 v[60:63], v[80:83], v[40:43], v[60:63]
    v_mfma_f32_16x16x32_bf16 v[60:63], v[84:87], v[44:47], v[60:63]
    v_mfma_f32_16x16x32_bf16 v[64:67], v[32:35], v[32:35], 0
    v_mfma_f32_16x16x32_bf16 v[64:67], v[36:39], v[36:39], v[64:67]
    v_mfma_f32_16x16x32_bf16 v[64:67], v[40:43], v[40:43], v[64:67]
    v_mfma_f32_16x16x32_bf16 v[64:67], v[44:47], v[44:47], v[64:67]
    v_max3_f32 v84, v56, v57, v58
    v_max3_f32 v84, v84, v59, v60
    v_max3_f32 v84, v84, v61, v62
    s_nop 4
    v_max3_f32 v84, v84, v63, v64
    v_max_f32 v84, v84, v65
    v_mov_b32 v85, v84
    s_nop 1
    v_permlane32_swap_b32 v85, v84
    v_max_f32 v84, v85, v84
    v_mov_b32 v85, v84
    s_nop 1
    v_permlane16_swap_b32 v85, v84
    v_max_f32 v84, v85, v84
    v_sub_f32 v56, v56, v84
    v_sub_f32 v57, v57, v84
    v_sub_f32 v58, v58, v84
    v_sub_f32 v59, v59, v84
    v_sub_f32 v60, v60, v84
    v_sub_f32 v61, v61, v84
    v_sub_f32 v62, v62, v84
    v_sub_f32 v63, v63, v84
    v_sub_f32 v64, v64, v84
    v_sub_f32 v65, v65, v84
    v_exp_f32 v56, v56
    v_exp_f32 v57, v57
    v_exp_f32 v58, v58
    v_exp_f32 v59, v59
    v_exp_f32 v60, v60
    v_exp_f32 v61, v61
    v_exp_f32 v62, v62
    v_exp_f32 v63, v63
    v_exp_f32 v64, v64
    v_exp_f32 v65, v65
    v_cvt_pk_bf16_f32 v68, v56, v57
    v_cvt_pk_bf16_f32 v69, v58, v59
    v_cvt_pk_bf16_f32 v70, v60, v61
    v_cvt_pk_bf16_f32 v71, v62, v63
    v_cvt_pk_bf16_f32 v52, v64, v65
    s_nop 0
    v_mfma_f32_16x16x32_bf16 v[72:75], v[88:91], v[68:71], 0
    v_mfma_f32_16x16x32_bf16 v[76:79], v[92:95], v[68:71], 0
    v_mfma_f32_16x16x32_bf16 v[80:83], v[48:51], v[68:71], 0
    v_mfma_f32_16x16x16_bf16 v[72:75], v[112:113], v[52:53], v[72:75]
    v_mfma_f32_16x16x16_bf16 v[76:79], v[114:115], v[52:53], v[76:79]
    v_mfma_f32_16x16x16_bf16 v[80:83], v[48:49], v[52:53], v[80:83]
    ds_read_b128 v[32:35], v124 offset:6144
    ds_read_b128 v[36:39], v124 offset:7168
    ds_read_b128 v[40:43], v124 offset:34816
    ds_read_b128 v[44:47], v124 offset:35840
    ds_read_b128 v[56:59], v124 offset:36864
    ds_read_b128 v[64:67], v124 offset:38912
    ds_read_b128 v[68:71], v124 offset:39936
    s_waitcnt lgkmcnt(0)
    s_branch L_norm_17
L_kvw_19:
    s_add_u32 s47, s47, 1
    s_add_u32 s49, s49, 1
    s_cmp_ge_u32 s49, 0x10000
    s_cbranch_scc1 L_kvb_20
    s_sleep 4
    buffer_load_dword v125, v119, s[8:11], s28 offen sc1
    s_waitcnt vmcnt(0)
    v_cmp_eq_u32 vcc, 0, v125
    s_nop 0
    s_and_b64 vcc, vcc, s[58:59]
    s_cbranch_scc1 L_kvw_19
    s_branch L_kvb_20
L_mret_22:
    s_mov_b32 s43, m0
    s_mov_b32 m0, 5120
    buffer_load_dwordx4 v[4:7], v117, s[8:11], s48 offen sc1
    buffer_load_dwordx4 v117, s[8:11], s48 offen sc1 lds
    s_mov_b32 m0, 10240
    s_mov_b32 m0, s43
    s_waitcnt vmcnt(0)
    v_max3_u32 v15, v4, v5, v6
    v_max_u32 v15, v15, v7
    v_cmp_lt_u32 vcc, s56, v15
    s_add_u32 s47, s47, 1
    s_add_u32 s49, s49, 1
    s_cmp_ge_u32 s49, 0x10000
    s_cbranch_scc1 L_mgo_23
    s_cbranch_vccnz L_mret_22
    s_branch L_mgo_23
L_smax_25:
    s_add_u32 s47, s47, 1
    s_mov_b32 s35, 0x7f800000
    s_waitcnt lgkmcnt(0)
    s_sub_u32 s43, s30, 0x40800
    s_add_u32 s40, s43, 4096
    s_nop 7
    buffer_load_dwordx4 v[56:59], v117, s[8:11], s43 offen
    buffer_load_dwordx4 v[60:63], v117, s[8:11], s43 offen offset:1024
    buffer_load_dwordx4 v[64:67], v117, s[8:11], s43 offen offset:2048
    buffer_load_dwordx4 v[68:71], v117, s[8:11], s43 offen offset:3072
    buffer_load_dwordx4 v[72:75], v117, s[8:11], s40 offen
    buffer_load_dwordx4 v[76:79], v117, s[8:11], s40 offen offset:1024
    buffer_load_dwordx4 v[80:83], v117, s[8:11], s40 offen offset:2048
    buffer_load_dwordx4 v[84:87], v117, s[8:11], s40 offen offset:3072
    ds_read_b128 v[32:35], v121 offset:16384
    ds_read_b128 v[36:39], v121 offset:17408
    ds_read_b128 v[40:43], v121 offset:18432
    ds_read_b128 v[44:47], v121 offset:19456
    v_mov_b32 v96, 0
    v_mov_b32 v97, 0
    v_mov_b32 v98, 0
    v_mov_b32 v99, 0
    v_mov_b32 v100, 0
    v_mov_b32 v101, 0
    v_mov_b32 v102, 0
    v_mov_b32 v103, 0
    v_mov_b32 v104, 0
    v_mov_b32 v105, 0
    v_mov_b32 v106, 0
    v_mov_b32 v107, 0
    v_mov_b32 v108, 0
    v_mov_b32 v109, 0
    v_mov_b32 v110, 0
    v_mov_b32 v111, 0
    s_waitcnt vmcnt(0) lgkmcnt(0)
    v_mfma_f32_16x16x32_bf16 v[56:59], v[56:59], v[32:35], 0
    v_mfma_f32_16x16x32_bf16 v[56:59], v[60:63], v[36:39], v[56:59]
    v_mfma_f32_16x16x32_bf16 v[56:59], v[64:67], v[40:43], v[56:59]
    v_mfma_f32_16x16x32_bf16 v[56:59], v[68:71], v[44:47], v[56:59]
    v_mfma_f32_16x16x32_bf16 v[60:63], v[72:75], v[32:35], 0
    v_mfma_f32_16x16x32_bf16 v[60:63], v[76:79], v[36:39], v[60:63]
    v_mfma_f32_16x16x32_bf16 v[60:63], v[80:83], v[40:43], v[60:63]
    v_mfma_f32_16x16x32_bf16 v[60:63], v[84:87], v[44:47], v[60:63]
    v_mfma_f32_16x16x32_bf16 v[64:67], v[32:35], v[32:35], 0
    v_mfma_f32_16x16x32_bf16 v[64:67], v[36:39], v[36:39], v[64:67]
    v_mfma_f32_16x16x32_bf16 v[64:67], v[40:43], v[40:43], v[64:67]
    v_mfma_f32_16x16x32_bf16 v[64:67], v[44:47], v[44:47], v[64:67]
    v_max3_f32 v84, v56, v57, v58
    v_max3_f32 v84, v84, v59, v60
    v_max3_f32 v84, v84, v61, v62
    s_nop 4
    v_max3_f32 v84, v84, v63, v64
    v_max_f32 v84, v84, v65
    v_mov_b32 v85, v84
    s_nop 1
    v_permlane32_swap_b32 v85, v84
    v_max_f32 v84, v85, v84
    v_mov_b32 v85, v84
    s_nop 1
    v_permlane16_swap_b32 v85, v84
    v_max_f32 v84, v85, v84
    v_sub_f32 v56, v56, v84
    v_sub_f32 v57, v57, v84
    v_sub_f32 v58, v58, v84
    v_sub_f32 v59, v59, v84
    v_sub_f32 v60, v60, v84
    v_sub_f32 v61, v61, v84
    v_sub_f32 v62, v62, v84
    v_sub_f32 v63, v63, v84
    v_sub_f32 v64, v64, v84
    v_sub_f32 v65, v65, v84
    v_exp_f32 v56, v56
    v_exp_f32 v57, v57
    v_exp_f32 v58, v58
    v_exp_f32 v59, v59
    v_exp_f32 v60, v60
    v_exp_f32 v61, v61
    v_exp_f32 v62, v62
    v_exp_f32 v63, v63
    v_exp_f32 v64, v64
    v_exp_f32 v65, v65
    v_cvt_pk_bf16_f32 v68, v56, v57
    v_cvt_pk_bf16_f32 v69, v58, v59
    v_cvt_pk_bf16_f32 v70, v60, v61
    v_cvt_pk_bf16_f32 v71, v62, v63
    v_cvt_pk_bf16_f32 v52, v64, v65
    s_nop 0
    v_mfma_f32_16x16x32_bf16 v[72:75], v[88:91], v[68:71], 0
    v_mfma_f32_16x16x32_bf16 v[76:79], v[92:95], v[68:71], 0
    v_mfma_f32_16x16x32_bf16 v[80:83], v[48:51], v[68:71], 0
    v_mfma_f32_16x16x16_bf16 v[72:75], v[112:113], v[52:53], v[72:75]
    v_mfma_f32_16x16x16_bf16 v[76:79], v[114:115], v[52:53], v[76:79]
    v_mfma_f32_16x16x16_bf16 v[80:83], v[48:49], v[52:53], v[80:83]
    ds_read_b128 v[32:35], v124 offset:6144
    ds_read_b128 v[36:39], v124 offset:7168
    ds_read_b128 v[40:43], v124 offset:34816
    ds_read_b128 v[44:47], v124 offset:35840
    ds_read_b128 v[56:59], v124 offset:36864
    ds_read_b128 v[64:67], v124 offset:38912
    ds_read_b128 v[68:71], v124 offset:39936
    s_waitcnt lgkmcnt(0)
    s_branch L_norm_24
L_kvw_26:
    s_add_u32 s47, s47, 1
    s_add_u32 s49, s49, 1
    s_cmp_ge_u32 s49, 0x10000
    s_cbranch_scc1 L_kvb_27
    s_sleep 4
    buffer_load_dword v125, v119, s[8:11], s28 offen sc1
    s_waitcnt vmcnt(0)
    v_cmp_eq_u32 vcc, 0, v125
    s_nop 0
    s_and_b64 vcc, vcc, s[58:59]
    s_cbranch_scc1 L_kvw_26
    s_branch L_kvb_27
L_mret_29:
    s_mov_b32 s43, m0
    s_mov_b32 m0, 6144
    buffer_load_dwordx4 v[4:7], v117, s[8:11], s48 offen sc1
    buffer_load_dwordx4 v117, s[8:11], s48 offen sc1 lds
    s_mov_b32 m0, 12288
    s_mov_b32 m0, s43
    s_waitcnt vmcnt(0)
    v_max3_u32 v15, v4, v5, v6
    v_max_u32 v15, v15, v7
    v_cmp_lt_u32 vcc, s56, v15
    s_add_u32 s47, s47, 1
    s_add_u32 s49, s49, 1
    s_cmp_ge_u32 s49, 0x10000
    s_cbranch_scc1 L_mgo_30
    s_cbranch_vccnz L_mret_29
    s_branch L_mgo_30
L_smax_32:
    s_add_u32 s47, s47, 1
    s_mov_b32 s35, 0x7f800000
    s_waitcnt lgkmcnt(0)
    s_sub_u32 s43, s30, 0x41000
    s_add_u32 s40, s43, 4096
    s_nop 7
    buffer_load_dwordx4 v[56:59], v117, s[8:11], s43 offen
    buffer_load_dwordx4 v[60:63], v117, s[8:11], s43 offen offset:1024
    buffer_load_dwordx4 v[64:67], v117, s[8:11], s43 offen offset:2048
    buffer_load_dwordx4 v[68:71], v117, s[8:11], s43 offen offset:3072
    buffer_load_dwordx4 v[72:75], v117, s[8:11], s40 offen
    buffer_load_dwordx4 v[76:79], v117, s[8:11], s40 offen offset:1024
    buffer_load_dwordx4 v[80:83], v117, s[8:11], s40 offen offset:2048
    buffer_load_dwordx4 v[84:87], v117, s[8:11], s40 offen offset:3072
    ds_read_b128 v[32:35], v121 offset:16384
    ds_read_b128 v[36:39], v121 offset:17408
    ds_read_b128 v[40:43], v121 offset:18432
    ds_read_b128 v[44:47], v121 offset:19456
    v_mov_b32 v96, 0
    v_mov_b32 v97, 0
    v_mov_b32 v98, 0
    v_mov_b32 v99, 0
    v_mov_b32 v100, 0
    v_mov_b32 v101, 0
    v_mov_b32 v102, 0
    v_mov_b32 v103, 0
    v_mov_b32 v104, 0
    v_mov_b32 v105, 0
    v_mov_b32 v106, 0
    v_mov_b32 v107, 0
    v_mov_b32 v108, 0
    v_mov_b32 v109, 0
    v_mov_b32 v110, 0
    v_mov_b32 v111, 0
    s_waitcnt vmcnt(0) lgkmcnt(0)
    v_mfma_f32_16x16x32_bf16 v[56:59], v[56:59], v[32:35], 0
    v_mfma_f32_16x16x32_bf16 v[56:59], v[60:63], v[36:39], v[56:59]
    v_mfma_f32_16x16x32_bf16 v[56:59], v[64:67], v[40:43], v[56:59]
    v_mfma_f32_16x16x32_bf16 v[56:59], v[68:71], v[44:47], v[56:59]
    v_mfma_f32_16x16x32_bf16 v[60:63], v[72:75], v[32:35], 0
    v_mfma_f32_16x16x32_bf16 v[60:63], v[76:79], v[36:39], v[60:63]
    v_mfma_f32_16x16x32_bf16 v[60:63], v[80:83], v[40:43], v[60:63]
    v_mfma_f32_16x16x32_bf16 v[60:63], v[84:87], v[44:47], v[60:63]
    v_mfma_f32_16x16x32_bf16 v[64:67], v[32:35], v[32:35], 0
    v_mfma_f32_16x16x32_bf16 v[64:67], v[36:39], v[36:39], v[64:67]
    v_mfma_f32_16x16x32_bf16 v[64:67], v[40:43], v[40:43], v[64:67]
    v_mfma_f32_16x16x32_bf16 v[64:67], v[44:47], v[44:47], v[64:67]
    v_max3_f32 v84, v56, v57, v58
    v_max3_f32 v84, v84, v59, v60
    v_max3_f32 v84, v84, v61, v62
    s_nop 4
    v_max3_f32 v84, v84, v63, v64
    v_max_f32 v84, v84, v65
    v_mov_b32 v85, v84
    s_nop 1
    v_permlane32_swap_b32 v85, v84
    v_max_f32 v84, v85, v84
    v_mov_b32 v85, v84
    s_nop 1
    v_permlane16_swap_b32 v85, v84
    v_max_f32 v84, v85, v84
    v_sub_f32 v56, v56, v84
    v_sub_f32 v57, v57, v84
    v_sub_f32 v58, v58, v84
    v_sub_f32 v59, v59, v84
    v_sub_f32 v60, v60, v84
    v_sub_f32 v61, v61, v84
    v_sub_f32 v62, v62, v84
    v_sub_f32 v63, v63, v84
    v_sub_f32 v64, v64, v84
    v_sub_f32 v65, v65, v84
    v_exp_f32 v56, v56
    v_exp_f32 v57, v57
    v_exp_f32 v58, v58
    v_exp_f32 v59, v59
    v_exp_f32 v60, v60
    v_exp_f32 v61, v61
    v_exp_f32 v62, v62
    v_exp_f32 v63, v63
    v_exp_f32 v64, v64
    v_exp_f32 v65, v65
    v_cvt_pk_bf16_f32 v68, v56, v57
    v_cvt_pk_bf16_f32 v69, v58, v59
    v_cvt_pk_bf16_f32 v70, v60, v61
    v_cvt_pk_bf16_f32 v71, v62, v63
    v_cvt_pk_bf16_f32 v52, v64, v65
    s_nop 0
    v_mfma_f32_16x16x32_bf16 v[72:75], v[88:91], v[68:71], 0
    v_mfma_f32_16x16x32_bf16 v[76:79], v[92:95], v[68:71], 0
    v_mfma_f32_16x16x32_bf16 v[80:83], v[48:51], v[68:71], 0
    v_mfma_f32_16x16x16_bf16 v[72:75], v[112:113], v[52:53], v[72:75]
    v_mfma_f32_16x16x16_bf16 v[76:79], v[114:115], v[52:53], v[76:79]
    v_mfma_f32_16x16x16_bf16 v[80:83], v[48:49], v[52:53], v[80:83]
    ds_read_b128 v[32:35], v124 offset:6144
    ds_read_b128 v[36:39], v124 offset:7168
    ds_read_b128 v[40:43], v124 offset:34816
    ds_read_b128 v[44:47], v124 offset:35840
    ds_read_b128 v[56:59], v124 offset:36864
    ds_read_b128 v[64:67], v124 offset:38912
    ds_read_b128 v[68:71], v124 offset:39936
    s_waitcnt lgkmcnt(0)
    s_branch L_norm_31
L_rslow_34:
    buffer_load_dwordx4 v[4:7], v117, s[8:11], s29 offen sc1
    buffer_load_dwordx4 v[8:11], v117, s[8:11], s53 offen sc1
    buffer_load_dwordx4 v[16:19], v117, s[8:11], s29 offen offset:2048 sc1
    buffer_load_dwordx4 v[20:23], v117, s[8:11], s53 offen offset:2048 sc1
    s_add_u32 s46, s46, 1
    s_add_u32 s49, s49, 1
    s_cmp_ge_u32 s49, 0x10000
    s_cbranch_scc1 L_rgo_35
    s_waitcnt vmcnt(7)
    v_mfma_f32_16x16x32_bf16 v[48:51], v[32:35], v[12:15], 0
    v_xor_b32 v52, s33, v32
    s_waitcnt vmcnt(6)
    v_mfma_f32_16x16x32_bf16 v[48:51], v[36:39], v[12:15], v[48:51]
    v_xor_b32 v53, s33, v36
    v_or_b32 v52, v52, v53
    s_waitcnt vmcnt(5)
    v_mfma_f32_16x16x32_bf16 v[48:51], v[40:43], v[12:15], v[48:51]
    v_xor_b32 v53, s33, v40
    v_or_b32 v52, v52, v53
    s_waitcnt vmcnt(4)
    v_mfma_f32_16x16x32_bf16 v[48:51], v[44:47], v[12:15], v[48:51]
    v_xor_b32 v53, s33, v44
    v_or_b32 v52, v52, v53
    v_and_b32 v52, 1, v52
    v_cmp_ne_u32 vcc, 0, v52
    s_cbranch_vccz L_rgo_35
    buffer_load_dwordx4 v[32:35], v117, s[8:11], s29 offen sc1
    buffer_load_dwordx4 v[36:39], v117, s[8:11], s53 offen sc1
    buffer_load_dwordx4 v[40:43], v117, s[8:11], s29 offen offset:2048 sc1
    buffer_load_dwordx4 v[44:47], v117, s[8:11], s53 offen offset:2048 sc1
    s_add_u32 s46, s46, 1
    s_branch L_rl_33
L_mret_37:
    s_mov_b32 s43, m0
    s_mov_b32 m0, 7168
    buffer_load_dwordx4 v[4:7], v117, s[8:11], s48 offen sc1
    buffer_load_dwordx4 v117, s[8:11], s48 offen sc1 lds
    s_mov_b32 m0, 14336
    s_mov_b32 m0, s43
    s_waitcnt vmcnt(0)
    v_max3_u32 v15, v4, v5, v6
    v_max_u32 v15, v15, v7
    v_cmp_lt_u32 vcc, s56, v15
    s_add_u32 s47, s47, 1
    s_add_u32 s49, s49, 1
    s_cmp_ge_u32 s49, 0x10000
    s_cbranch_scc1 L_mgo_38
    s_cbranch_vccnz L_mret_37
    s_branch L_mgo_38
L_smax_40:
    s_add_u32 s47, s47, 1
    s_mov_b32 s35, 0x7f800000
    s_waitcnt lgkmcnt(0)
    s_sub_u32 s43, s30, 0x41800
    s_add_u32 s40, s43, 4096
    s_nop 7
    buffer_load_dwordx4 v[56:59], v117, s[8:11], s43 offen
    buffer_load_dwordx4 v[60:63], v117, s[8:11], s43 offen offset:1024
    buffer_load_dwordx4 v[64:67], v117, s[8:11], s43 offen offset:2048
    buffer_load_dwordx4 v[68:71], v117, s[8:11], s43 offen offset:3072
    buffer_load_dwordx4 v[72:75], v117, s[8:11], s40 offen
    buffer_load_dwordx4 v[76:79], v117, s[8:11], s40 offen offset:1024
    buffer_load_dwordx4 v[80:83], v117, s[8:11], s40 offen offset:2048
    buffer_load_dwordx4 v[84:87], v117, s[8:11], s40 offen offset:3072
    ds_read_b128 v[32:35], v121 offset:16384
    ds_read_b128 v[36:39], v121 offset:17408
    ds_read_b128 v[40:43], v121 offset:18432
    ds_read_b128 v[44:47], v121 offset:19456
    v_mov_b32 v96, 0
    v_mov_b32 v97, 0
    v_mov_b32 v98, 0
    v_mov_b32 v99, 0
    v_mov_b32 v100, 0
    v_mov_b32 v101, 0
    v_mov_b32 v102, 0
    v_mov_b32 v103, 0
    v_mov_b32 v104, 0
    v_mov_b32 v105, 0
    v_mov_b32 v106, 0
    v_mov_b32 v107, 0
    v_mov_b32 v108, 0
    v_mov_b32 v109, 0
    v_mov_b32 v110, 0
    v_mov_b32 v111, 0
    s_waitcnt vmcnt(0) lgkmcnt(0)
    v_mfma_f32_16x16x32_bf16 v[56:59], v[56:59], v[32:35], 0
    v_mfma_f32_16x16x32_bf16 v[56:59], v[60:63], v[36:39], v[56:59]
    v_mfma_f32_16x16x32_bf16 v[56:59], v[64:67], v[40:43], v[56:59]
    v_mfma_f32_16x16x32_bf16 v[56:59], v[68:71], v[44:47], v[56:59]
    v_mfma_f32_16x16x32_bf16 v[60:63], v[72:75], v[32:35], 0
    v_mfma_f32_16x16x32_bf16 v[60:63], v[76:79], v[36:39], v[60:63]
    v_mfma_f32_16x16x32_bf16 v[60:63], v[80:83], v[40:43], v[60:63]
    v_mfma_f32_16x16x32_bf16 v[60:63], v[84:87], v[44:47], v[60:63]
    v_mfma_f32_16x16x32_bf16 v[64:67], v[32:35], v[32:35], 0
    v_mfma_f32_16x16x32_bf16 v[64:67], v[36:39], v[36:39], v[64:67]
    v_mfma_f32_16x16x32_bf16 v[64:67], v[40:43], v[40:43], v[64:67]
    v_mfma_f32_16x16x32_bf16 v[64:67], v[44:47], v[44:47], v[64:67]
    v_max3_f32 v84, v56, v57, v58
    v_max3_f32 v84, v84, v59, v60
    v_max3_f32 v84, v84, v61, v62
    s_nop 4
    v_max3_f32 v84, v84, v63, v64
    v_max_f32 v84, v84, v65
    v_mov_b32 v85, v84
    s_nop 1
    v_permlane32_swap_b32 v85, v84
    v_max_f32 v84, v85, v84
    v_mov_b32 v85, v84
    s_nop 1
    v_permlane16_swap_b32 v85, v84
    v_max_f32 v84, v85, v84
    v_sub_f32 v56, v56, v84
    v_sub_f32 v57, v57, v84
    v_sub_f32 v58, v58, v84
    v_sub_f32 v59, v59, v84
    v_sub_f32 v60, v60, v84
    v_sub_f32 v61, v61, v84
    v_sub_f32 v62, v62, v84
    v_sub_f32 v63, v63, v84
    v_sub_f32 v64, v64, v84
    v_sub_f32 v65, v65, v84
    v_exp_f32 v56, v56
    v_exp_f32 v57, v57
    v_exp_f32 v58, v58
    v_exp_f32 v59, v59
    v_exp_f32 v60, v60
    v_exp_f32 v61, v61
    v_exp_f32 v62, v62
    v_exp_f32 v63, v63
    v_exp_f32 v64, v64
    v_exp_f32 v65, v65
    v_cvt_pk_bf16_f32 v68, v56, v57
    v_cvt_pk_bf16_f32 v69, v58, v59
    v_cvt_pk_bf16_f32 v70, v60, v61
    v_cvt_pk_bf16_f32 v71, v62, v63
    v_cvt_pk_bf16_f32 v52, v64, v65
    s_nop 0
    v_mfma_f32_16x16x32_bf16 v[72:75], v[88:91], v[68:71], 0
    v_mfma_f32_16x16x32_bf16 v[76:79], v[92:95], v[68:71], 0
    v_mfma_f32_16x16x32_bf16 v[80:83], v[48:51], v[68:71], 0
    v_mfma_f32_16x16x16_bf16 v[72:75], v[112:113], v[52:53], v[72:75]
    v_mfma_f32_16x16x16_bf16 v[76:79], v[114:115], v[52:53], v[76:79]
    v_mfma_f32_16x16x16_bf16 v[80:83], v[48:49], v[52:53], v[80:83]
    ds_read_b128 v[32:35], v124 offset:6144
    ds_read_b128 v[36:39], v124 offset:7168
    ds_read_b128 v[40:43], v124 offset:34816
    ds_read_b128 v[44:47], v124 offset:35840
    ds_read_b128 v[56:59], v124 offset:36864
    ds_read_b128 v[64:67], v124 offset:38912
    ds_read_b128 v[68:71], v124 offset:39936
    s_waitcnt lgkmcnt(0)
    s_branch L_norm_39
L_rslow_42:
    buffer_load_dwordx4 v[4:7], v117, s[8:11], s29 offen sc1
    buffer_load_dwordx4 v[8:11], v117, s[8:11], s53 offen sc1
    buffer_load_dwordx4 v[16:19], v117, s[8:11], s29 offen offset:2048 sc1
    buffer_load_dwordx4 v[20:23], v117, s[8:11], s53 offen offset:2048 sc1
    s_add_u32 s46, s46, 1
    s_add_u32 s49, s49, 1
    s_cmp_ge_u32 s49, 0x10000
    s_cbranch_scc1 L_rgo_43
    s_waitcnt vmcnt(7)
    v_mfma_f32_16x16x32_bf16 v[48:51], v[32:35], v[12:15], 0
    v_xor_b32 v52, s33, v32
    s_waitcnt vmcnt(6)
    v_mfma_f32_16x16x32_bf16 v[48:51], v[36:39], v[12:15], v[48:51]
    v_xor_b32 v53, s33, v36
    v_or_b32 v52, v52, v53
    s_waitcnt vmcnt(5)
    v_mfma_f32_16x16x32_bf16 v[48:51], v[40:43], v[12:15], v[48:51]
    v_xor_b32 v53, s33, v40
    v_or_b32 v52, v52, v53
    s_waitcnt vmcnt(4)
    v_mfma_f32_16x16x32_bf16 v[48:51], v[44:47], v[12:15], v[48:51]
    v_xor_b32 v53, s33, v44
    v_or_b32 v52, v52, v53
    v_and_b32 v52, 1, v52
    v_cmp_ne_u32 vcc, 0, v52
    s_cbranch_vccz L_rgo_43
    buffer_load_dwordx4 v[32:35], v117, s[8:11], s29 offen sc1
    buffer_load_dwordx4 v[36:39], v117, s[8:11], s53 offen sc1
    buffer_load_dwordx4 v[40:43], v117, s[8:11], s29 offen offset:2048 sc1
    buffer_load_dwordx4 v[44:47], v117, s[8:11], s53 offen offset:2048 sc1
    s_add_u32 s46, s46, 1
    s_branch L_rl_41
L_other:
    s_sub_u32 s101, s84, 1
    s_lshl_b32 s101, s101, 5
    s_add_u32 s101, s101, s85
    s_branch L_bulk
L_odd:
    s_mov_b32 s96, 0
L_mode_44:
    buffer_load_dwordx2 v[2:3], off, s[92:95], 0 offset:36 sc1
    s_waitcnt vmcnt(0)
    v_readfirstlane_b32 s87, v2
    v_readfirstlane_b32 s97, v3
    s_nop 0
    s_min_u32 s97, s97, s87
    s_cmp_lg_u32 s97, 0
    s_cbranch_scc1 L_moded_45
    s_sleep 4
    s_add_u32 s96, s96, 1
    s_cmp_lg_u32 s96, 0x100
    s_cbranch_scc1 L_modef_46
    v_mov_b32 v2, 2
    v_mov_b32 v3, 0
    s_mov_b64 exec, 1
    buffer_atomic_cmpswap v[2:3], off, s[92:95], 0 offset:36
    s_mov_b64 exec, -1
L_modef_46:
    s_cmp_lt_u32 s96, 0x10000
    s_cbranch_scc1 L_mode_44
L_moded_45:
    s_cmp_eq_u32 s87, 1
    s_cbranch_scc1 L_exit
L_fallback:
    s_waitcnt vmcnt(0) lgkmcnt(0)
    s_barrier
    v_mbcnt_lo_u32_b32 v0, -1, 0
    v_mbcnt_hi_u32_b32 v0, -1, v0
    s_lshl_b32 s96, s100, 6
    v_add_u32 v0, s96, v0
    s_mov_b32 s97, 44
    s_cmp_lg_u32 s100, 0
    s_cbranch_scc1 L_at_47
    s_mov_b64 exec, 1
    v_mov_b32 v2, 1
    buffer_atomic_add v2, off, s[92:95], s97 sc0
    s_mov_b64 exec, -1
L_at_47:
    s_cmp_lg_u32 s100, 0
    s_cbranch_scc1 L_at2_48
    s_mov_b64 exec, 1
    v_mov_b32 v1, 8
    s_waitcnt vmcnt(0)
    ds_write_b32 v1, v2
    s_waitcnt lgkmcnt(0)
    s_mov_b64 exec, -1
L_at2_48:
    s_barrier
    v_mov_b32 v1, 8
    ds_read_b32 v2, v1
    s_waitcnt lgkmcnt(0)
    v_readfirstlane_b32 s85, v2
    s_barrier
    s_sub_u32 s101, s85, 32
    s_cmp_ge_u32 s85, 32
    s_cbranch_scc1 L_bulk
    s_mov_b32 s20, s85
    s_mov_b32 s16, s92
    s_mov_b32 s17, s93
    s_mov_b32 s18, s94
    s_mov_b32 s19, s95
    s_mov_b32 s88, s20
    v_lshrrev_b32 v4, 6, v0
    s_nop 0
    v_readfirstlane_b32 s21, v4
    v_and_b32 v1, 63, v0
    v_lshrrev_b32 v2, 4, v1
    v_and_b32 v3, 15, v1
    v_lshrrev_b32 v6, 2, v3
    v_lshlrev_b32 v117, 4, v1
    s_lshl_b32 s51, s21, 10
    s_lshl_b32 s52, s21, 11
    s_load_dwordx8 s[60:67], s[0:1], 16
    s_mov_b32 s14, 0x400000
    s_mov_b32 s15, 0x20000
    s_lshl_b32 s41, s20, 8
    s_lshl_b32 s42, s20, 17
    s_lshr_b32 s43, s21, 1
    s_lshl_b32 s43, s43, 2
    v_or_b32 v5, s43, v2
    v_lshlrev_b32 v5, 1, v5
    v_xor_b32 v5, v5, v3
    v_lshrrev_b32 v14, 2, v5
    v_lshlrev_b32 v5, 4, v5
    s_lshl_b32 s43, s21, 4
    v_add_u32 v4, s43, v2
    v_lshl_add_u32 v8, v4, 13, v5
    s_waitcnt lgkmcnt(0)
    s_mov_b32 s12, s60
    s_and_b32 s13, s61, 0xffff
    v_xor_b32 v15, 2, v14
    v_lshl_add_u32 v15, v15, 15, v8
    s_add_u32 s43, s41, 0x0
    s_add_u32 m0, s51, 0x8000
    s_nop 0
    buffer_load_dwordx4 v15, s[12:15], s43 offen lds
    s_add_u32 s43, s41, 0x80000
    s_add_u32 m0, s51, 0x9000
    s_nop 0
    buffer_load_dwordx4 v15, s[12:15], s43 offen lds
    s_add_u32 s43, s41, 0x100000
    s_add_u32 m0, s51, 0xa000
    s_nop 0
    buffer_load_dwordx4 v15, s[12:15], s43 offen lds
    s_add_u32 s43, s41, 0x180000
    s_add_u32 m0, s51, 0xb000
    s_nop 0
    buffer_load_dwordx4 v15, s[12:15], s43 offen lds
    s_add_u32 s43, s41, 0x200000
    s_add_u32 m0, s51, 0xc000
    s_nop 0
    buffer_load_dwordx4 v15, s[12:15], s43 offen lds
    s_add_u32 s43, s41, 0x280000
    s_add_u32 m0, s51, 0xd000
    s_nop 0
    buffer_load_dwordx4 v15, s[12:15], s43 offen lds
    s_add_u32 s43, s41, 0x300000
    s_add_u32 m0, s51, 0xe000
    s_nop 0
    buffer_load_dwordx4 v15, s[12:15], s43 offen lds
    s_add_u32 s43, s41, 0x380000
    s_add_u32 m0, s51, 0xf000
    s_nop 0
    buffer_load_dwordx4 v15, s[12:15], s43 offen lds
    v_xor_b32 v15, 3, v14
    v_lshl_add_u32 v15, v15, 15, v8
    s_add_u32 s43, s41, 0x0
    s_add_u32 m0, s51, 0x10000
    s_nop 0
    buffer_load_dwordx4 v15, s[12:15], s43 offen lds
    s_add_u32 s43, s41, 0x80000
    s_add_u32 m0, s51, 0x11000
    s_nop 0
    buffer_load_dwordx4 v15, s[12:15], s43 offen lds
    s_add_u32 s43, s41, 0x100000
    s_add_u32 m0, s51, 0x12000
    s_nop 0
    buffer_load_dwordx4 v15, s[12:15], s43 offen lds
    s_add_u32 s43, s41, 0x180000
    s_add_u32 m0, s51, 0x13000
    s_nop 0
    buffer_load_dwordx4 v15, s[12:15], s43 offen lds
    s_add_u32 s43, s41, 0x200000
    s_add_u32 m0, s51, 0x14000
    s_nop 0
    buffer_load_dwordx4 v15, s[12:15], s43 offen lds
    s_add_u32 s43, s41, 0x280000
    s_add_u32 m0, s51, 0x15000
    s_nop 0
    buffer_load_dwordx4 v15, s[12:15], s43 offen lds
    s_add_u32 s43, s41, 0x300000
    s_add_u32 m0, s51, 0x16000
    s_nop 0
    buffer_load_dwordx4 v15, s[12:15], s43 offen lds
    s_add_u32 s43, s41, 0x380000
    s_add_u32 m0, s51, 0x17000
    s_nop 0
    buffer_load_dwordx4 v15, s[12:15], s43 offen lds
    s_mov_b32 s12, s62
    s_and_b32 s13, s63, 0xffff
    v_xor_b32 v15, 2, v14
    v_lshl_add_u32 v15, v15, 15, v8
    s_add_u32 s43, s41, 0x0
    s_add_u32 m0, s51, 0x18000
    s_nop 0
    buffer_load_dwordx4 v15, s[12:15], s43 offen lds
    s_add_u32 s43, s41, 0x80000
    s_add_u32 m0, s51, 0x19000
    s_nop 0
    buffer_load_dwordx4 v15, s[12:15], s43 offen lds
    s_add_u32 s43, s41, 0x100000
    s_add_u32 m0, s51, 0x1a000
    s_nop 0
    buffer_load_dwordx4 v15, s[12:15], s43 offen lds
    s_add_u32 s43, s41, 0x180000
    s_add_u32 m0, s51, 0x1b000
    s_nop 0
    buffer_load_dwordx4 v15, s[12:15], s43 offen lds
    s_add_u32 s43, s41, 0x200000
    s_add_u32 m0, s51, 0x1c000
    s_nop 0
    buffer_load_dwordx4 v15, s[12:15], s43 offen lds
    s_add_u32 s43, s41, 0x280000
    s_add_u32 m0, s51, 0x1d000
    s_nop 0
    buffer_load_dwordx4 v15, s[12:15], s43 offen lds
    s_add_u32 s43, s41, 0x300000
    s_add_u32 m0, s51, 0x1e000
    s_nop 0
    buffer_load_dwordx4 v15, s[12:15], s43 offen lds
    s_add_u32 s43, s41, 0x380000
    s_add_u32 m0, s51, 0x1f000
    s_nop 0
    buffer_load_dwordx4 v15, s[12:15], s43 offen lds
    v_xor_b32 v15, 3, v14
    v_lshl_add_u32 v15, v15, 15, v8
    s_add_u32 s43, s41, 0x0
    s_add_u32 m0, s51, 0x20000
    s_nop 0
    buffer_load_dwordx4 v15, s[12:15], s43 offen lds
    s_add_u32 s43, s41, 0x80000
    s_add_u32 m0, s51, 0x21000
    s_nop 0
    buffer_load_dwordx4 v15, s[12:15], s43 offen lds
    s_add_u32 s43, s41, 0x100000
    s_add_u32 m0, s51, 0x22000
    s_nop 0
    buffer_load_dwordx4 v15, s[12:15], s43 offen lds
    s_add_u32 s43, s41, 0x180000
    s_add_u32 m0, s51, 0x23000
    s_nop 0
    buffer_load_dwordx4 v15, s[12:15], s43 offen lds
    s_add_u32 s43, s41, 0x200000
    s_add_u32 m0, s51, 0x24000
    s_nop 0
    buffer_load_dwordx4 v15, s[12:15], s43 offen lds
    s_add_u32 s43, s41, 0x280000
    s_add_u32 m0, s51, 0x25000
    s_nop 0
    buffer_load_dwordx4 v15, s[12:15], s43 offen lds
    s_add_u32 s43, s41, 0x300000
    s_add_u32 m0, s51, 0x26000
    s_nop 0
    buffer_load_dwordx4 v15, s[12:15], s43 offen lds
    s_add_u32 s43, s41, 0x380000
    s_add_u32 m0, s51, 0x27000
    s_nop 0
    buffer_load_dwordx4 v15, s[12:15], s43 offen lds
    v_and_b32 v4, 2, v3
    v_cmp_ne_u32 vcc, 0, v4
    v_mov_b32 v4, 0x4444
    v_mov_b32 v5, 0xeeee
    v_cndmask_b32 v116, v4, v5, vcc
    v_lshrrev_b32 v5, 1, v2
    v_lshl_add_u32 v4, v6, 3, v5
    s_lshl_b32 s43, s21, 1
    v_add_u32 v4, s43, v4
    v_add_u32 v5, s20, v4
    v_and_b32 v5, 31, v5
    v_lshl_add_u32 v4, v4, 6, v5
    v_and_b32 v5, 1, v2
    v_lshl_add_u32 v4, v4, 1, v5
    v_and_b32 v5, 3, v3
    v_lshl_add_u32 v4, v4, 2, v5
    v_lshlrev_b32 v118, 4, v4
    v_and_b32 v4, 1, v2
    v_lshlrev_b32 v4, 2, v4
    v_and_b32 v7, 2, v2
    v_add_u32 v4, v4, v7
    v_and_b32 v7, 1, v6
    v_add_u32 v4, v4, v7
    v_lshl_add_u32 v4, v4, 2, v5
    v_lshlrev_b32 v4, 2, v4
    s_and_b32 s43, s21, 1
    s_lshl_b32 s43, s43, 12
    s_lshl_b32 s40, s20, 7
    s_add_u32 s43, s43, s40
    v_add_u32 v119, s43, v4
    v_sub_u32 v7, 0, v2
    v_and_b32 v7, 3, v7
    v_xor_b32 v7, v7, v6
    v_lshl_add_u32 v4, v2, 4, v7
    v_and_b32 v5, 3, v3
    v_lshl_add_u32 v4, v4, 2, v5
    s_add_u32 s43, s51, 16384
    v_lshl_add_u32 v120, v4, 2, s43
    v_sub_u32 v7, 0, v6
    v_and_b32 v7, 3, v7
    v_xor_b32 v7, v7, v2
    v_lshl_add_u32 v4, v3, 2, v7
    v_lshlrev_b32 v121, 4, v4
    v_and_b32 v5, 1, v3
    v_lshl_add_u32 v4, v6, 1, v5
    v_lshl_add_u32 v4, v2, 3, v4
    v_lshlrev_b32 v127, 4, v4
    v_and_or_b32 v122, v116, 8, v127
    s_lshl_b32 s43, s21, 13
    s_add_u32 s43, s43, 32768
    v_add_u32 v123, s43, v117
    v_add_u32 v124, 0x10000, v123
    s_mov_b32 s36, 0xcccccccc
    s_mov_b32 s37, 0xcccccccc
    s_mov_b32 s38, 0x00ff00ff
    s_mov_b32 s39, 0x00ff00ff
    s_mov_b32 s34, 0x3e0293ee
    s_mov_b32 s35, 0x49800000
    s_mov_b32 s50, 0x3f803f80
    v_and_b32 v5, 1, v2
    v_or_b32 v5, 0, v5
    v_xor_b32 v5, v5, v6
    v_lshlrev_b32 v5, 8, v5
    v_and_b32 v7, 3, v3
    v_lshl_add_u32 v7, v7, 4, v5
    s_lshl_b32 s43, s21, 2
    v_add_u32 v4, s43, v2
    v_lshl_add_u32 v10, v4, 10, v7
    v_and_b32 v5, 1, v2
    v_or_b32 v5, 2, v5
    v_xor_b32 v5, v5, v6
    v_lshlrev_b32 v5, 8, v5
    v_and_b32 v7, 3, v3
    v_lshl_add_u32 v7, v7, 4, v5
    s_lshl_b32 s43, s21, 2
    v_add_u32 v4, s43, v2
    v_lshl_add_u32 v9, v4, 10, v7
    v_and_b32 v5, 1, v2
    v_lshl_add_u32 v4, v5, 3, v6
    v_lshrrev_b32 v7, 1, v2
    v_lshl_add_u32 v4, v7, 5, v4
    v_lshlrev_b32 v4, 8, v4
    v_lshl_or_b32 v5, v5, 2, v6
    v_lshlrev_b32 v5, 5, v5
    s_lshl_b32 s43, s21, 6
    v_xor_b32 v5, s43, v5
    v_add_u32 v4, v4, v5
    v_and_b32 v5, 3, v3
    v_lshl_add_u32 v4, v5, 3, v4
    v_add_u32 v11, 32768, v4
    v_and_b32 v5, 1, v2
    v_lshlrev_b32 v4, 4, v5
    v_lshl_add_u32 v4, v7, 2, v4
    v_and_b32 v7, 1, v6
    v_add_u32 v4, v4, v7
    s_lshl_b32 s43, s21, 5
    v_add_u32 v4, s43, v4
    v_lshlrev_b32 v4, 8, v4
    v_lshl_or_b32 v5, v5, 1, v7
    v_xor_b32 v5, s21, v5
    v_lshl_add_u32 v4, v5, 6, v4
    v_lshrrev_b32 v5, 1, v6
    v_lshl_add_u32 v4, v5, 5, v4
    v_and_b32 v5, 3, v3
    v_lshl_add_u32 v4, v5, 3, v4
    v_add_u32 v12, 32768, v4
    v_mov_b32 v16, -1
    v_mov_b32 v17, -1
    v_mov_b32 v18, -1
    v_mov_b32 v19, -1
    s_lshl_b32 s43, s20, 13
    s_add_u32 s43, s43, 0x7100000
    s_and_b32 s40, s21, 1
    s_lshl_b32 s40, s40, 12
    s_add_u32 s29, s43, s40
    s_add_u32 s43, s43, s52
    s_xor_b32 s40, s43, 0x40000
    buffer_store_dwordx4 v[16:19], v117, s[8:11], s43 offen sc1
    buffer_store_dwordx4 v[16:19], v117, s[8:11], s43 offen offset:1024 sc1
    buffer_store_dwordx4 v[16:19], v117, s[8:11], s40 offen sc1
    buffer_store_dwordx4 v[16:19], v117, s[8:11], s40 offen offset:1024 sc1
    s_mov_b32 s43, 0x7012000
    buffer_store_dword v16, v119, s[8:11], s43 offen sc1
    s_mov_b32 s43, 0x7014000
    buffer_store_dword v16, v119, s[8:11], s43 offen sc1
    s_mov_b32 s43, 0x7016000
    buffer_store_dword v16, v119, s[8:11], s43 offen sc1
    s_load_dwordx2 s[4:5], s[0:1], 8
    s_waitcnt lgkmcnt(0)
    s_and_b32 s5, s5, 0xffff
    s_mov_b32 s6, 8192
    s_mov_b32 s7, 0x20000
    v_and_b32 v20, 1, v2
    v_and_b32 v21, 1, v6
    v_lshl_add_u32 v20, v20, 1, v21
    v_lshlrev_b32 v20, 9, v20
    v_and_b32 v21, 3, v3
    v_lshl_add_u32 v20, v21, 4, v20
    v_and_b32 v21, 2, v2
    v_add_u32 v20, v20, v21
    s_and_b32 s43, s20, 1
    s_lshl_b32 s43, s43, 11
    s_bfe_u32 s40, s20, 0x20001
    s_lshl_b32 s40, s40, 7
    s_add_u32 s43, s43, s40
    s_and_b32 s40, s21, 1
    s_lshl_b32 s40, s40, 6
    s_add_u32 s43, s43, s40
    s_lshr_b32 s40, s20, 3
    s_lshl_b32 s40, s40, 2
    s_add_u32 s43, s43, s40
    v_add_u32 v20, s43, v20
    v_lshlrev_b32 v20, 1, v20
    buffer_load_dword v21, v20, s[4:7], 0 offen
    s_waitcnt vmcnt(32)
    s_barrier
    v_xor_b32 v13, 0, v11
    v_add_u32 v13, 0x0, v13
    ds_read_b64_tr_b16 a[32:33], v13
    ds_read_b64_tr_b16 a[34:35], v13 offset:1024
    ds_read_b64_tr_b16 a[36:37], v13 offset:16384
    ds_read_b64_tr_b16 a[38:39], v13 offset:17408
    ds_read_b64_tr_b16 a[48:49], v13 offset:4096
    ds_read_b64_tr_b16 a[50:51], v13 offset:5120
    ds_read_b64_tr_b16 a[52:53], v13 offset:20480
    ds_read_b64_tr_b16 a[54:55], v13 offset:21504
    s_waitcnt lgkmcnt(0)
    v_xor_b32 v13, 32, v11
    v_add_u32 v13, 0x0, v13
    ds_read_b64_tr_b16 a[40:41], v13
    ds_read_b64_tr_b16 a[42:43], v13 offset:1024
    ds_read_b64_tr_b16 a[44:45], v13 offset:16384
    ds_read_b64_tr_b16 a[46:47], v13 offset:17408
    ds_read_b64_tr_b16 a[56:57], v13 offset:4096
    ds_read_b64_tr_b16 a[58:59], v13 offset:5120
    ds_read_b64_tr_b16 a[60:61], v13 offset:20480
    ds_read_b64_tr_b16 a[62:63], v13 offset:21504
    s_waitcnt lgkmcnt(0)
    s_barrier
    s_mov_b32 s12, s64
    s_and_b32 s13, s65, 0xffff
    v_xor_b32 v15, 0, v14
    v_lshl_add_u32 v15, v15, 15, v8
    s_add_u32 s43, s41, 0x0
    s_add_u32 m0, s51, 0x8000
    s_nop 0
    buffer_load_dwordx4 v15, s[12:15], s43 offen lds
    s_add_u32 s43, s41, 0x80000
    s_add_u32 m0, s51, 0x9000
    s_nop 0
    buffer_load_dwordx4 v15, s[12:15], s43 offen lds
    s_add_u32 s43, s41, 0x100000
    s_add_u32 m0, s51, 0xa000
    s_nop 0
    buffer_load_dwordx4 v15, s[12:15], s43 offen lds
    s_add_u32 s43, s41, 0x180000
    s_add_u32 m0, s51, 0xb000
    s_nop 0
    buffer_load_dwordx4 v15, s[12:15], s43 offen lds
    s_add_u32 s43, s41, 0x200000
    s_add_u32 m0, s51, 0xc000
    s_nop 0
    buffer_load_dwordx4 v15, s[12:15], s43 offen lds
    s_add_u32 s43, s41, 0x280000
    s_add_u32 m0, s51, 0xd000
    s_nop 0
    buffer_load_dwordx4 v15, s[12:15], s43 offen lds
    s_add_u32 s43, s41, 0x300000
    s_add_u32 m0, s51, 0xe000
    s_nop 0
    buffer_load_dwordx4 v15, s[12:15], s43 offen lds
    s_add_u32 s43, s41, 0x380000
    s_add_u32 m0, s51, 0xf000
    s_nop 0
    buffer_load_dwordx4 v15, s[12:15], s43 offen lds
    s_waitcnt vmcnt(32)
    s_barrier
    v_xor_b32 v13, 0, v11
    v_add_u32 v13, 0x8000, v13
    ds_read_b64_tr_b16 a[64:65], v13
    ds_read_b64_tr_b16 a[66:67], v13 offset:1024
    ds_read_b64_tr_b16 a[68:69], v13 offset:16384
    ds_read_b64_tr_b16 a[70:71], v13 offset:17408
    ds_read_b64_tr_b16 a[80:81], v13 offset:4096
    ds_read_b64_tr_b16 a[82:83], v13 offset:5120
    ds_read_b64_tr_b16 a[84:85], v13 offset:20480
    ds_read_b64_tr_b16 a[86:87], v13 offset:21504
    s_waitcnt lgkmcnt(0)
    v_xor_b32 v13, 32, v11
    v_add_u32 v13, 0x8000, v13
    ds_read_b64_tr_b16 a[72:73], v13
    ds_read_b64_tr_b16 a[74:75], v13 offset:1024
    ds_read_b64_tr_b16 a[76:77], v13 offset:16384
    ds_read_b64_tr_b16 a[78:79], v13 offset:17408
    ds_read_b64_tr_b16 a[88:89], v13 offset:4096
    ds_read_b64_tr_b16 a[90:91], v13 offset:5120
    ds_read_b64_tr_b16 a[92:93], v13 offset:20480
    ds_read_b64_tr_b16 a[94:95], v13 offset:21504
    s_waitcnt lgkmcnt(0)
    s_barrier
    v_xor_b32 v15, 1, v14
    v_lshl_add_u32 v15, v15, 15, v8
    s_add_u32 s43, s41, 0x0
    s_add_u32 m0, s51, 0x10000
    s_nop 0
    buffer_load_dwordx4 v15, s[12:15], s43 offen lds
    s_add_u32 s43, s41, 0x80000
    s_add_u32 m0, s51, 0x11000
    s_nop 0
    buffer_load_dwordx4 v15, s[12:15], s43 offen lds
    s_add_u32 s43, s41, 0x100000
    s_add_u32 m0, s51, 0x12000
    s_nop 0
    buffer_load_dwordx4 v15, s[12:15], s43 offen lds
    s_add_u32 s43, s41, 0x180000
    s_add_u32 m0, s51, 0x13000
    s_nop 0
    buffer_load_dwordx4 v15, s[12:15], s43 offen lds
    s_add_u32 s43, s41, 0x200000
    s_add_u32 m0, s51, 0x14000
    s_nop 0
    buffer_load_dwordx4 v15, s[12:15], s43 offen lds
    s_add_u32 s43, s41, 0x280000
    s_add_u32 m0, s51, 0x15000
    s_nop 0
    buffer_load_dwordx4 v15, s[12:15], s43 offen lds
    s_add_u32 s43, s41, 0x300000
    s_add_u32 m0, s51, 0x16000
    s_nop 0
    buffer_load_dwordx4 v15, s[12:15], s43 offen lds
    s_add_u32 s43, s41, 0x380000
    s_add_u32 m0, s51, 0x17000
    s_nop 0
    buffer_load_dwordx4 v15, s[12:15], s43 offen lds
    s_waitcnt vmcnt(32)
    s_barrier
    v_xor_b32 v13, 0, v11
    v_add_u32 v13, 0x10000, v13
    ds_read_b64_tr_b16 a[128:129], v13
    ds_read_b64_tr_b16 a[130:131], v13 offset:1024
    ds_read_b64_tr_b16 a[132:133], v13 offset:16384
    ds_read_b64_tr_b16 a[134:135], v13 offset:17408
    ds_read_b64_tr_b16 a[144:145], v13 offset:4096
    ds_read_b64_tr_b16 a[146:147], v13 offset:5120
    ds_read_b64_tr_b16 a[148:149], v13 offset:20480
    ds_read_b64_tr_b16 a[150:151], v13 offset:21504
    s_waitcnt lgkmcnt(0)
    v_xor_b32 v13, 32, v11
    v_add_u32 v13, 0x10000, v13
    ds_read_b64_tr_b16 a[136:137], v13
    ds_read_b64_tr_b16 a[138:139], v13 offset:1024
    ds_read_b64_tr_b16 a[140:141], v13 offset:16384
    ds_read_b64_tr_b16 a[142:143], v13 offset:17408
    ds_read_b64_tr_b16 a[152:153], v13 offset:4096
    ds_read_b64_tr_b16 a[154:155], v13 offset:5120
    ds_read_b64_tr_b16 a[156:157], v13 offset:20480
    ds_read_b64_tr_b16 a[158:159], v13 offset:21504
    s_waitcnt lgkmcnt(0)
    s_barrier
    v_xor_b32 v15, 2, v14
    v_lshl_add_u32 v15, v15, 15, v8
    s_add_u32 s43, s41, 0x0
    s_add_u32 m0, s51, 0x18000
    s_nop 0
    buffer_load_dwordx4 v15, s[12:15], s43 offen lds
    s_add_u32 s43, s41, 0x80000
    s_add_u32 m0, s51, 0x19000
    s_nop 0
    buffer_load_dwordx4 v15, s[12:15], s43 offen lds
    s_add_u32 s43, s41, 0x100000
    s_add_u32 m0, s51, 0x1a000
    s_nop 0
    buffer_load_dwordx4 v15, s[12:15], s43 offen lds
    s_add_u32 s43, s41, 0x180000
    s_add_u32 m0, s51, 0x1b000
    s_nop 0
    buffer_load_dwordx4 v15, s[12:15], s43 offen lds
    s_add_u32 s43, s41, 0x200000
    s_add_u32 m0, s51, 0x1c000
    s_nop 0
    buffer_load_dwordx4 v15, s[12:15], s43 offen lds
    s_add_u32 s43, s41, 0x280000
    s_add_u32 m0, s51, 0x1d000
    s_nop 0
    buffer_load_dwordx4 v15, s[12:15], s43 offen lds
    s_add_u32 s43, s41, 0x300000
    s_add_u32 m0, s51, 0x1e000
    s_nop 0
    buffer_load_dwordx4 v15, s[12:15], s43 offen lds
    s_add_u32 s43, s41, 0x380000
    s_add_u32 m0, s51, 0x1f000
    s_nop 0
    buffer_load_dwordx4 v15, s[12:15], s43 offen lds
    s_waitcnt vmcnt(32)
    s_barrier
    v_xor_b32 v13, 0, v11
    v_add_u32 v13, 0x18000, v13
    ds_read_b64_tr_b16 a[160:161], v13
    ds_read_b64_tr_b16 a[162:163], v13 offset:1024
    ds_read_b64_tr_b16 a[164:165], v13 offset:16384
    ds_read_b64_tr_b16 a[166:167], v13 offset:17408
    ds_read_b64_tr_b16 a[176:177], v13 offset:4096
    ds_read_b64_tr_b16 a[178:179], v13 offset:5120
    ds_read_b64_tr_b16 a[180:181], v13 offset:20480
    ds_read_b64_tr_b16 a[182:183], v13 offset:21504
    s_waitcnt lgkmcnt(0)
    v_xor_b32 v13, 32, v11
    v_add_u32 v13, 0x18000, v13
    ds_read_b64_tr_b16 a[168:169], v13
    ds_read_b64_tr_b16 a[170:171], v13 offset:1024
    ds_read_b64_tr_b16 a[172:173], v13 offset:16384
    ds_read_b64_tr_b16 a[174:175], v13 offset:17408
    ds_read_b64_tr_b16 a[184:185], v13 offset:4096
    ds_read_b64_tr_b16 a[186:187], v13 offset:5120
    ds_read_b64_tr_b16 a[188:189], v13 offset:20480
    ds_read_b64_tr_b16 a[190:191], v13 offset:21504
    s_waitcnt lgkmcnt(0)
    s_barrier
    v_xor_b32 v15, 3, v14
    v_lshl_add_u32 v15, v15, 15, v8
    s_add_u32 s43, s41, 0x0
    s_add_u32 m0, s51, 0x20000
    s_nop 0
    buffer_load_dwordx4 v15, s[12:15], s43 offen lds
    s_add_u32 s43, s41, 0x80000
    s_add_u32 m0, s51, 0x21000
    s_nop 0
    buffer_load_dwordx4 v15, s[12:15], s43 offen lds
    s_add_u32 s43, s41, 0x100000
    s_add_u32 m0, s51, 0x22000
    s_nop 0
    buffer_load_dwordx4 v15, s[12:15], s43 offen lds
    s_add_u32 s43, s41, 0x180000
    s_add_u32 m0, s51, 0x23000
    s_nop 0
    buffer_load_dwordx4 v15, s[12:15], s43 offen lds
    s_add_u32 s43, s41, 0x200000
    s_add_u32 m0, s51, 0x24000
    s_nop 0
    buffer_load_dwordx4 v15, s[12:15], s43 offen lds
    s_add_u32 s43, s41, 0x280000
    s_add_u32 m0, s51, 0x25000
    s_nop 0
    buffer_load_dwordx4 v15, s[12:15], s43 offen lds
    s_add_u32 s43, s41, 0x300000
    s_add_u32 m0, s51, 0x26000
    s_nop 0
    buffer_load_dwordx4 v15, s[12:15], s43 offen lds
    s_add_u32 s43, s41, 0x380000
    s_add_u32 m0, s51, 0x27000
    s_nop 0
    buffer_load_dwordx4 v15, s[12:15], s43 offen lds
    s_waitcnt vmcnt(24)
    v_min_u32 v21, 0xfffffffe, v21
    s_mov_b32 s43, 0x7010000
    s_mov_b64 exec, s[38:39]
    buffer_store_dword v21, v119, s[8:11], s43 offen sc1
    s_mov_b64 exec, -1
    s_barrier
    v_xor_b32 v13, 0, v11
    v_add_u32 v13, 0x0, v13
    ds_read_b64_tr_b16 a[192:193], v13
    ds_read_b64_tr_b16 a[194:195], v13 offset:1024
    ds_read_b64_tr_b16 a[196:197], v13 offset:16384
    ds_read_b64_tr_b16 a[198:199], v13 offset:17408
    ds_read_b64_tr_b16 a[208:209], v13 offset:4096
    ds_read_b64_tr_b16 a[210:211], v13 offset:5120
    ds_read_b64_tr_b16 a[212:213], v13 offset:20480
    ds_read_b64_tr_b16 a[214:215], v13 offset:21504
    s_waitcnt lgkmcnt(0)
    v_xor_b32 v13, 32, v11
    v_add_u32 v13, 0x0, v13
    ds_read_b64_tr_b16 a[200:201], v13
    ds_read_b64_tr_b16 a[202:203], v13 offset:1024
    ds_read_b64_tr_b16 a[204:205], v13 offset:16384
    ds_read_b64_tr_b16 a[206:207], v13 offset:17408
    ds_read_b64_tr_b16 a[216:217], v13 offset:4096
    ds_read_b64_tr_b16 a[218:219], v13 offset:5120
    ds_read_b64_tr_b16 a[220:221], v13 offset:20480
    ds_read_b64_tr_b16 a[222:223], v13 offset:21504
    s_waitcnt lgkmcnt(0)
    s_barrier
    s_mov_b32 s12, s66
    s_and_b32 s13, s67, 0xffff
    s_add_u32 s43, s42, 0x0
    s_add_u32 m0, s51, 0x8000
    s_nop 0
    buffer_load_dwordx4 v10, s[12:15], s43 offen lds
    s_add_u32 s43, s42, 0x4000
    s_add_u32 m0, s51, 0x9000
    s_nop 0
    buffer_load_dwordx4 v9, s[12:15], s43 offen lds
    s_add_u32 s43, s42, 0x8000
    s_add_u32 m0, s51, 0xa000
    s_nop 0
    buffer_load_dwordx4 v10, s[12:15], s43 offen lds
    s_add_u32 s43, s42, 0xc000
    s_add_u32 m0, s51, 0xb000
    s_nop 0
    buffer_load_dwordx4 v9, s[12:15], s43 offen lds
    s_add_u32 s43, s42, 0x10000
    s_add_u32 m0, s51, 0xc000
    s_nop 0
    buffer_load_dwordx4 v10, s[12:15], s43 offen lds
    s_add_u32 s43, s42, 0x14000
    s_add_u32 m0, s51, 0xd000
    s_nop 0
    buffer_load_dwordx4 v9, s[12:15], s43 offen lds
    s_add_u32 s43, s42, 0x18000
    s_add_u32 m0, s51, 0xe000
    s_nop 0
    buffer_load_dwordx4 v10, s[12:15], s43 offen lds
    s_add_u32 s43, s42, 0x1c000
    s_add_u32 m0, s51, 0xf000
    s_nop 0
    buffer_load_dwordx4 v9, s[12:15], s43 offen lds
    s_waitcnt vmcnt(24)
    s_barrier
    v_xor_b32 v13, 0, v11
    v_add_u32 v13, 0x8000, v13
    ds_read_b64_tr_b16 a[224:225], v13
    ds_read_b64_tr_b16 a[226:227], v13 offset:1024
    ds_read_b64_tr_b16 a[228:229], v13 offset:16384
    ds_read_b64_tr_b16 a[230:231], v13 offset:17408
    ds_read_b64_tr_b16 a[240:241], v13 offset:4096
    ds_read_b64_tr_b16 a[242:243], v13 offset:5120
    ds_read_b64_tr_b16 a[244:245], v13 offset:20480
    ds_read_b64_tr_b16 a[246:247], v13 offset:21504
    s_waitcnt lgkmcnt(0)
    v_xor_b32 v13, 32, v11
    v_add_u32 v13, 0x8000, v13
    ds_read_b64_tr_b16 a[232:233], v13
    ds_read_b64_tr_b16 a[234:235], v13 offset:1024
    ds_read_b64_tr_b16 a[236:237], v13 offset:16384
    ds_read_b64_tr_b16 a[238:239], v13 offset:17408
    ds_read_b64_tr_b16 a[248:249], v13 offset:4096
    ds_read_b64_tr_b16 a[250:251], v13 offset:5120
    ds_read_b64_tr_b16 a[252:253], v13 offset:20480
    ds_read_b64_tr_b16 a[254:255], v13 offset:21504
    s_waitcnt lgkmcnt(0)
    s_barrier
    s_add_u32 s43, s42, 0x40
    s_add_u32 m0, s51, 0x10000
    s_nop 0
    buffer_load_dwordx4 v10, s[12:15], s43 offen lds
    s_add_u32 s43, s42, 0x4040
    s_add_u32 m0, s51, 0x11000
    s_nop 0
    buffer_load_dwordx4 v9, s[12:15], s43 offen lds
    s_add_u32 s43, s42, 0x8040
    s_add_u32 m0, s51, 0x12000
    s_nop 0
    buffer_load_dwordx4 v10, s[12:15], s43 offen lds
    s_add_u32 s43, s42, 0xc040
    s_add_u32 m0, s51, 0x13000
    s_nop 0
    buffer_load_dwordx4 v9, s[12:15], s43 offen lds
    s_add_u32 s43, s42, 0x10040
    s_add_u32 m0, s51, 0x14000
    s_nop 0
    buffer_load_dwordx4 v10, s[12:15], s43 offen lds
    s_add_u32 s43, s42, 0x14040
    s_add_u32 m0, s51, 0x15000
    s_nop 0
    buffer_load_dwordx4 v9, s[12:15], s43 offen lds
    s_add_u32 s43, s42, 0x18040
    s_add_u32 m0, s51, 0x16000
    s_nop 0
    buffer_load_dwordx4 v10, s[12:15], s43 offen lds
    s_add_u32 s43, s42, 0x1c040
    s_add_u32 m0, s51, 0x17000
    s_nop 0
    buffer_load_dwordx4 v9, s[12:15], s43 offen lds
    s_waitcnt vmcnt(24)
    s_barrier
    v_xor_b32 v13, 0, v11
    v_add_u32 v13, 0x10000, v13
    ds_read_b64_tr_b16 v[128:129], v13
    ds_read_b64_tr_b16 v[130:131], v13 offset:1024
    ds_read_b64_tr_b16 v[132:133], v13 offset:16384
    ds_read_b64_tr_b16 v[134:135], v13 offset:17408
    ds_read_b64_tr_b16 v[144:145], v13 offset:4096
    ds_read_b64_tr_b16 v[146:147], v13 offset:5120
    ds_read_b64_tr_b16 v[148:149], v13 offset:20480
    ds_read_b64_tr_b16 v[150:151], v13 offset:21504
    s_waitcnt lgkmcnt(0)
    v_xor_b32 v13, 32, v11
    v_add_u32 v13, 0x10000, v13
    ds_read_b64_tr_b16 v[136:137], v13
    ds_read_b64_tr_b16 v[138:139], v13 offset:1024
    ds_read_b64_tr_b16 v[140:141], v13 offset:16384
    ds_read_b64_tr_b16 v[142:143], v13 offset:17408
    ds_read_b64_tr_b16 v[152:153], v13 offset:4096
    ds_read_b64_tr_b16 v[154:155], v13 offset:5120
    ds_read_b64_tr_b16 v[156:157], v13 offset:20480
    ds_read_b64_tr_b16 v[158:159], v13 offset:21504
    s_waitcnt lgkmcnt(0)
    s_barrier
    s_mov_b32 s12, s62
    s_and_b32 s13, s63, 0xffff
    v_xor_b32 v15, 1, v14
    v_lshl_add_u32 v15, v15, 15, v8
    s_add_u32 s43, s41, 0x0
    s_add_u32 m0, s51, 0x18000
    s_nop 0
    buffer_load_dwordx4 v15, s[12:15], s43 offen lds
    s_add_u32 s43, s41, 0x80000
    s_add_u32 m0, s51, 0x19000
    s_nop 0
    buffer_load_dwordx4 v15, s[12:15], s43 offen lds
    s_add_u32 s43, s41, 0x100000
    s_add_u32 m0, s51, 0x1a000
    s_nop 0
    buffer_load_dwordx4 v15, s[12:15], s43 offen lds
    s_add_u32 s43, s41, 0x180000
    s_add_u32 m0, s51, 0x1b000
    s_nop 0
    buffer_load_dwordx4 v15, s[12:15], s43 offen lds
    s_add_u32 s43, s41, 0x200000
    s_add_u32 m0, s51, 0x1c000
    s_nop 0
    buffer_load_dwordx4 v15, s[12:15], s43 offen lds
    s_add_u32 s43, s41, 0x280000
    s_add_u32 m0, s51, 0x1d000
    s_nop 0
    buffer_load_dwordx4 v15, s[12:15], s43 offen lds
    s_add_u32 s43, s41, 0x300000
    s_add_u32 m0, s51, 0x1e000
    s_nop 0
    buffer_load_dwordx4 v15, s[12:15], s43 offen lds
    s_add_u32 s43, s41, 0x380000
    s_add_u32 m0, s51, 0x1f000
    s_nop 0
    buffer_load_dwordx4 v15, s[12:15], s43 offen lds
    s_waitcnt vmcnt(24)
    s_barrier
    v_xor_b32 v13, 0, v11
    v_add_u32 v13, 0x18000, v13
    ds_read_b64_tr_b16 v[160:161], v13
    ds_read_b64_tr_b16 v[162:163], v13 offset:1024
    ds_read_b64_tr_b16 v[164:165], v13 offset:16384
    ds_read_b64_tr_b16 v[166:167], v13 offset:17408
    ds_read_b64_tr_b16 v[176:177], v13 offset:4096
    ds_read_b64_tr_b16 v[178:179], v13 offset:5120
    ds_read_b64_tr_b16 v[180:181], v13 offset:20480
    ds_read_b64_tr_b16 v[182:183], v13 offset:21504
    s_waitcnt lgkmcnt(0)
    v_xor_b32 v13, 32, v11
    v_add_u32 v13, 0x18000, v13
    ds_read_b64_tr_b16 v[168:169], v13
    ds_read_b64_tr_b16 v[170:171], v13 offset:1024
    ds_read_b64_tr_b16 v[172:173], v13 offset:16384
    ds_read_b64_tr_b16 v[174:175], v13 offset:17408
    ds_read_b64_tr_b16 v[184:185], v13 offset:4096
    ds_read_b64_tr_b16 v[186:187], v13 offset:5120
    ds_read_b64_tr_b16 v[188:189], v13 offset:20480
    ds_read_b64_tr_b16 v[190:191], v13 offset:21504
    s_waitcnt lgkmcnt(0)
    s_barrier
    s_mov_b32 s12, s60
    s_and_b32 s13, s61, 0xffff
    v_xor_b32 v15, 1, v14
    v_lshl_add_u32 v15, v15, 15, v8
    s_add_u32 s43, s41, 0x0
    s_add_u32 m0, s51, 0x20000
    s_nop 0
    buffer_load_dwordx4 v15, s[12:15], s43 offen lds
    s_add_u32 s43, s41, 0x80000
    s_add_u32 m0, s51, 0x21000
    s_nop 0
    buffer_load_dwordx4 v15, s[12:15], s43 offen lds
    s_add_u32 s43, s41, 0x100000
    s_add_u32 m0, s51, 0x22000
    s_nop 0
    buffer_load_dwordx4 v15, s[12:15], s43 offen lds
    s_add_u32 s43, s41, 0x180000
    s_add_u32 m0, s51, 0x23000
    s_nop 0
    buffer_load_dwordx4 v15, s[12:15], s43 offen lds
    s_add_u32 s43, s41, 0x200000
    s_add_u32 m0, s51, 0x24000
    s_nop 0
    buffer_load_dwordx4 v15, s[12:15], s43 offen lds
    s_add_u32 s43, s41, 0x280000
    s_add_u32 m0, s51, 0x25000
    s_nop 0
    buffer_load_dwordx4 v15, s[12:15], s43 offen lds
    s_add_u32 s43, s41, 0x300000
    s_add_u32 m0, s51, 0x26000
    s_nop 0
    buffer_load_dwordx4 v15, s[12:15], s43 offen lds
    s_add_u32 s43, s41, 0x380000
    s_add_u32 m0, s51, 0x27000
    s_nop 0
    buffer_load_dwordx4 v15, s[12:15], s43 offen lds
    s_waitcnt vmcnt(24)
    s_barrier
    v_xor_b32 v13, 0x0, v12
    v_add_u32 v13, 0x0, v13
    ds_read_b64_tr_b16 v[192:193], v13
    ds_read_b64_tr_b16 v[194:195], v13 offset:512
    ds_read_b64_tr_b16 v[196:197], v13 offset:2048
    ds_read_b64_tr_b16 v[198:199], v13 offset:2560
    v_xor_b32 v13, 0x2000, v12
    v_add_u32 v13, 0x0, v13
    ds_read_b64_tr_b16 v[200:201], v13
    ds_read_b64_tr_b16 v[202:203], v13 offset:512
    ds_read_b64_tr_b16 v[204:205], v13 offset:2048
    ds_read_b64_tr_b16 v[206:207], v13 offset:2560
    s_waitcnt lgkmcnt(0)
    v_xor_b32 v13, 0x4000, v12
    v_add_u32 v13, 0x0, v13
    ds_read_b64_tr_b16 v[208:209], v13
    ds_read_b64_tr_b16 v[210:211], v13 offset:512
    ds_read_b64_tr_b16 v[212:213], v13 offset:2048
    ds_read_b64_tr_b16 v[214:215], v13 offset:2560
    v_xor_b32 v13, 0x6000, v12
    v_add_u32 v13, 0x0, v13
    ds_read_b64_tr_b16 v[216:217], v13
    ds_read_b64_tr_b16 v[218:219], v13 offset:512
    ds_read_b64_tr_b16 v[220:221], v13 offset:2048
    ds_read_b64_tr_b16 v[222:223], v13 offset:2560
    s_waitcnt lgkmcnt(0)
    s_barrier
    v_xor_b32 v15, 0, v14
    v_lshl_add_u32 v15, v15, 15, v8
    s_add_u32 s43, s41, 0x0
    s_add_u32 m0, s51, 0x8000
    s_nop 0
    buffer_load_dwordx4 v15, s[12:15], s43 offen lds
    s_add_u32 s43, s41, 0x80000
    s_add_u32 m0, s51, 0x9000
    s_nop 0
    buffer_load_dwordx4 v15, s[12:15], s43 offen lds
    s_add_u32 s43, s41, 0x100000
    s_add_u32 m0, s51, 0xa000
    s_nop 0
    buffer_load_dwordx4 v15, s[12:15], s43 offen lds
    s_add_u32 s43, s41, 0x180000
    s_add_u32 m0, s51, 0xb000
    s_nop 0
    buffer_load_dwordx4 v15, s[12:15], s43 offen lds
    s_add_u32 s43, s41, 0x200000
    s_add_u32 m0, s51, 0xc000
    s_nop 0
    buffer_load_dwordx4 v15, s[12:15], s43 offen lds
    s_add_u32 s43, s41, 0x280000
    s_add_u32 m0, s51, 0xd000
    s_nop 0
    buffer_load_dwordx4 v15, s[12:15], s43 offen lds
    s_add_u32 s43, s41, 0x300000
    s_add_u32 m0, s51, 0xe000
    s_nop 0
    buffer_load_dwordx4 v15, s[12:15], s43 offen lds
    s_add_u32 s43, s41, 0x380000
    s_add_u32 m0, s51, 0xf000
    s_nop 0
    buffer_load_dwordx4 v15, s[12:15], s43 offen lds
    s_waitcnt vmcnt(24)
    s_barrier
    s_cmp_lg_u32 s21, 0
    s_cbranch_scc1 L_arr_49
    v_mov_b32 v23, 1
    s_mov_b64 exec, 1
    buffer_atomic_add v23, off, s[16:19], 0 offset:8
    s_mov_b64 exec, -1
L_arr_49:
    v_xor_b32 v13, 0x0, v12
    v_add_u32 v13, 0x8000, v13
    ds_read_b64_tr_b16 v[224:225], v13
    ds_read_b64_tr_b16 v[226:227], v13 offset:512
    ds_read_b64_tr_b16 v[228:229], v13 offset:2048
    ds_read_b64_tr_b16 v[230:231], v13 offset:2560
    v_xor_b32 v13, 0x2000, v12
    v_add_u32 v13, 0x8000, v13
    ds_read_b64_tr_b16 v[232:233], v13
    ds_read_b64_tr_b16 v[234:235], v13 offset:512
    ds_read_b64_tr_b16 v[236:237], v13 offset:2048
    ds_read_b64_tr_b16 v[238:239], v13 offset:2560
    s_waitcnt lgkmcnt(0)
    v_xor_b32 v13, 0x4000, v12
    v_add_u32 v13, 0x8000, v13
    ds_read_b64_tr_b16 v[240:241], v13
    ds_read_b64_tr_b16 v[242:243], v13 offset:512
    ds_read_b64_tr_b16 v[244:245], v13 offset:2048
    ds_read_b64_tr_b16 v[246:247], v13 offset:2560
    v_xor_b32 v13, 0x6000, v12
    v_add_u32 v13, 0x8000, v13
    ds_read_b64_tr_b16 v[248:249], v13
    ds_read_b64_tr_b16 v[250:251], v13 offset:512
    ds_read_b64_tr_b16 v[252:253], v13 offset:2048
    ds_read_b64_tr_b16 v[254:255], v13 offset:2560
    s_waitcnt lgkmcnt(0)
    s_barrier
    s_mov_b32 s12, s62
    s_and_b32 s13, s63, 0xffff
    v_xor_b32 v15, 0, v14
    v_lshl_add_u32 v15, v15, 15, v8
    s_add_u32 s43, s41, 0x0
    s_add_u32 m0, s51, 0x10000
    s_nop 0
    buffer_load_dwordx4 v15, s[12:15], s43 offen lds
    s_add_u32 s43, s41, 0x80000
    s_add_u32 m0, s51, 0x11000
    s_nop 0
    buffer_load_dwordx4 v15, s[12:15], s43 offen lds
    s_add_u32 s43, s41, 0x100000
    s_add_u32 m0, s51, 0x12000
    s_nop 0
    buffer_load_dwordx4 v15, s[12:15], s43 offen lds
    s_add_u32 s43, s41, 0x180000
    s_add_u32 m0, s51, 0x13000
    s_nop 0
    buffer_load_dwordx4 v15, s[12:15], s43 offen lds
    s_add_u32 s43, s41, 0x200000
    s_add_u32 m0, s51, 0x14000
    s_nop 0
    buffer_load_dwordx4 v15, s[12:15], s43 offen lds
    s_add_u32 s43, s41, 0x280000
    s_add_u32 m0, s51, 0x15000
    s_nop 0
    buffer_load_dwordx4 v15, s[12:15], s43 offen lds
    s_add_u32 s43, s41, 0x300000
    s_add_u32 m0, s51, 0x16000
    s_nop 0
    buffer_load_dwordx4 v15, s[12:15], s43 offen lds
    s_add_u32 s43, s41, 0x380000
    s_add_u32 m0, s51, 0x17000
    s_nop 0
    buffer_load_dwordx4 v15, s[12:15], s43 offen lds
    s_waitcnt vmcnt(24)
    s_barrier
    v_xor_b32 v13, 0, v11
    v_add_u32 v13, 0x10000, v13
    ds_read_b64_tr_b16 a[96:97], v13
    ds_read_b64_tr_b16 a[98:99], v13 offset:1024
    ds_read_b64_tr_b16 a[100:101], v13 offset:16384
    ds_read_b64_tr_b16 a[102:103], v13 offset:17408
    ds_read_b64_tr_b16 a[112:113], v13 offset:4096
    ds_read_b64_tr_b16 a[114:115], v13 offset:5120
    ds_read_b64_tr_b16 a[116:117], v13 offset:20480
    ds_read_b64_tr_b16 a[118:119], v13 offset:21504
    s_waitcnt lgkmcnt(0)
    v_xor_b32 v13, 32, v11
    v_add_u32 v13, 0x10000, v13
    ds_read_b64_tr_b16 a[104:105], v13
    ds_read_b64_tr_b16 a[106:107], v13 offset:1024
    ds_read_b64_tr_b16 a[108:109], v13 offset:16384
    ds_read_b64_tr_b16 a[110:111], v13 offset:17408
    ds_read_b64_tr_b16 a[120:121], v13 offset:4096
    ds_read_b64_tr_b16 a[122:123], v13 offset:5120
    ds_read_b64_tr_b16 a[124:125], v13 offset:20480
    ds_read_b64_tr_b16 a[126:127], v13 offset:21504
    s_waitcnt lgkmcnt(0)
    s_barrier
    s_mov_b32 s12, s66
    s_and_b32 s13, s67, 0xffff
    s_add_u32 s43, s42, 0x80
    s_add_u32 m0, s51, 0x18000
    s_nop 0
    buffer_load_dwordx4 v10, s[12:15], s43 offen lds
    s_add_u32 s43, s42, 0x4080
    s_add_u32 m0, s51, 0x19000
    s_nop 0
    buffer_load_dwordx4 v9, s[12:15], s43 offen lds
    s_add_u32 s43, s42, 0x8080
    s_add_u32 m0, s51, 0x1a000
    s_nop 0
    buffer_load_dwordx4 v10, s[12:15], s43 offen lds
    s_add_u32 s43, s42, 0xc080
    s_add_u32 m0, s51, 0x1b000
    s_nop 0
    buffer_load_dwordx4 v9, s[12:15], s43 offen lds
    s_add_u32 s43, s42, 0x10080
    s_add_u32 m0, s51, 0x1c000
    s_nop 0
    buffer_load_dwordx4 v10, s[12:15], s43 offen lds
    s_add_u32 s43, s42, 0x14080
    s_add_u32 m0, s51, 0x1d000
    s_nop 0
    buffer_load_dwordx4 v9, s[12:15], s43 offen lds
    s_add_u32 s43, s42, 0x18080
    s_add_u32 m0, s51, 0x1e000
    s_nop 0
    buffer_load_dwordx4 v10, s[12:15], s43 offen lds
    s_add_u32 s43, s42, 0x1c080
    s_add_u32 m0, s51, 0x1f000
    s_nop 0
    buffer_load_dwordx4 v9, s[12:15], s43 offen lds
    s_waitcnt vmcnt(24)
    s_barrier
    v_xor_b32 v13, 0, v11
    v_add_u32 v13, 0x18000, v13
    ds_read_b64_tr_b16 a[0:1], v13
    ds_read_b64_tr_b16 a[2:3], v13 offset:1024
    ds_read_b64_tr_b16 a[4:5], v13 offset:16384
    ds_read_b64_tr_b16 a[6:7], v13 offset:17408
    ds_read_b64_tr_b16 a[16:17], v13 offset:4096
    ds_read_b64_tr_b16 a[18:19], v13 offset:5120
    ds_read_b64_tr_b16 a[20:21], v13 offset:20480
    ds_read_b64_tr_b16 a[22:23], v13 offset:21504
    s_waitcnt lgkmcnt(0)
    v_xor_b32 v13, 32, v11
    v_add_u32 v13, 0x18000, v13
    ds_read_b64_tr_b16 a[8:9], v13
    ds_read_b64_tr_b16 a[10:11], v13 offset:1024
    ds_read_b64_tr_b16 a[12:13], v13 offset:16384
    ds_read_b64_tr_b16 a[14:15], v13 offset:17408
    ds_read_b64_tr_b16 a[24:25], v13 offset:4096
    ds_read_b64_tr_b16 a[26:27], v13 offset:5120
    ds_read_b64_tr_b16 a[28:29], v13 offset:20480
    ds_read_b64_tr_b16 a[30:31], v13 offset:21504
    s_waitcnt lgkmcnt(0)
    s_barrier
    s_add_u32 s43, s42, 0xc0
    s_add_u32 m0, s51, 0x20000
    s_nop 0
    buffer_load_dwordx4 v10, s[12:15], s43 offen lds
    s_add_u32 s43, s42, 0x40c0
    s_add_u32 m0, s51, 0x21000
    s_nop 0
    buffer_load_dwordx4 v9, s[12:15], s43 offen lds
    s_add_u32 s43, s42, 0x80c0
    s_add_u32 m0, s51, 0x22000
    s_nop 0
    buffer_load_dwordx4 v10, s[12:15], s43 offen lds
    s_add_u32 s43, s42, 0xc0c0
    s_add_u32 m0, s51, 0x23000
    s_nop 0
    buffer_load_dwordx4 v9, s[12:15], s43 offen lds
    s_add_u32 s43, s42, 0x100c0
    s_add_u32 m0, s51, 0x24000
    s_nop 0
    buffer_load_dwordx4 v10, s[12:15], s43 offen lds
    s_add_u32 s43, s42, 0x140c0
    s_add_u32 m0, s51, 0x25000
    s_nop 0
    buffer_load_dwordx4 v9, s[12:15], s43 offen lds
    s_add_u32 s43, s42, 0x180c0
    s_add_u32 m0, s51, 0x26000
    s_nop 0
    buffer_load_dwordx4 v10, s[12:15], s43 offen lds
    s_add_u32 s43, s42, 0x1c0c0
    s_add_u32 m0, s51, 0x27000
    s_nop 0
    buffer_load_dwordx4 v9, s[12:15], s43 offen lds
    s_waitcnt vmcnt(24)
    s_barrier
    v_xor_b32 v13, 0, v11
    v_add_u32 v13, 0x0, v13
    ds_read_b64_tr_b16 v[32:33], v13
    ds_read_b64_tr_b16 v[34:35], v13 offset:1024
    ds_read_b64_tr_b16 v[36:37], v13 offset:16384
    ds_read_b64_tr_b16 v[38:39], v13 offset:17408
    ds_read_b64_tr_b16 v[48:49], v13 offset:4096
    ds_read_b64_tr_b16 v[50:51], v13 offset:5120
    ds_read_b64_tr_b16 v[52:53], v13 offset:20480
    ds_read_b64_tr_b16 v[54:55], v13 offset:21504
    s_waitcnt lgkmcnt(0)
    v_xor_b32 v13, 32, v11
    v_add_u32 v13, 0x0, v13
    ds_read_b64_tr_b16 v[40:41], v13
    ds_read_b64_tr_b16 v[42:43], v13 offset:1024
    ds_read_b64_tr_b16 v[44:45], v13 offset:16384
    ds_read_b64_tr_b16 v[46:47], v13 offset:17408
    ds_read_b64_tr_b16 v[56:57], v13 offset:4096
    ds_read_b64_tr_b16 v[58:59], v13 offset:5120
    ds_read_b64_tr_b16 v[60:61], v13 offset:20480
    ds_read_b64_tr_b16 v[62:63], v13 offset:21504
    s_waitcnt lgkmcnt(0)
    s_barrier
    ds_write_b128 v123, v[32:35]
    ds_write_b128 v123, v[36:39] offset:1024
    ds_write_b128 v123, v[40:43] offset:2048
    ds_write_b128 v123, v[44:47] offset:3072
    ds_write_b128 v123, v[48:51] offset:4096
    ds_write_b128 v123, v[52:55] offset:5120
    ds_write_b128 v123, v[56:59] offset:6144
    ds_write_b128 v123, v[60:63] offset:7168
    s_waitcnt vmcnt(16)
    s_barrier
    v_xor_b32 v13, 0, v11
    v_add_u32 v13, 0x8000, v13
    ds_read_b64_tr_b16 v[32:33], v13
    ds_read_b64_tr_b16 v[34:35], v13 offset:1024
    ds_read_b64_tr_b16 v[36:37], v13 offset:16384
    ds_read_b64_tr_b16 v[38:39], v13 offset:17408
    ds_read_b64_tr_b16 v[48:49], v13 offset:4096
    ds_read_b64_tr_b16 v[50:51], v13 offset:5120
    ds_read_b64_tr_b16 v[52:53], v13 offset:20480
    ds_read_b64_tr_b16 v[54:55], v13 offset:21504
    s_waitcnt lgkmcnt(0)
    v_xor_b32 v13, 32, v11
    v_add_u32 v13, 0x8000, v13
    ds_read_b64_tr_b16 v[40:41], v13
    ds_read_b64_tr_b16 v[42:43], v13 offset:1024
    ds_read_b64_tr_b16 v[44:45], v13 offset:16384
    ds_read_b64_tr_b16 v[46:47], v13 offset:17408
    ds_read_b64_tr_b16 v[56:57], v13 offset:4096
    ds_read_b64_tr_b16 v[58:59], v13 offset:5120
    ds_read_b64_tr_b16 v[60:61], v13 offset:20480
    ds_read_b64_tr_b16 v[62:63], v13 offset:21504
    s_waitcnt lgkmcnt(0)
    s_barrier
    ds_write_b128 v123, v[32:35] offset:32768
    ds_write_b128 v123, v[36:39] offset:33792
    ds_write_b128 v123, v[40:43] offset:34816
    ds_write_b128 v123, v[44:47] offset:35840
    ds_write_b128 v123, v[48:51] offset:36864
    ds_write_b128 v123, v[52:55] offset:37888
    ds_write_b128 v123, v[56:59] offset:38912
    ds_write_b128 v123, v[60:63] offset:39936
    s_waitcnt vmcnt(8)
    s_barrier
    v_xor_b32 v13, 0x0, v12
    v_add_u32 v13, 0x10000, v13
    ds_read_b64_tr_b16 v[32:33], v13
    ds_read_b64_tr_b16 v[34:35], v13 offset:512
    ds_read_b64_tr_b16 v[36:37], v13 offset:2048
    ds_read_b64_tr_b16 v[38:39], v13 offset:2560
    v_xor_b32 v13, 0x2000, v12
    v_add_u32 v13, 0x10000, v13
    ds_read_b64_tr_b16 v[40:41], v13
    ds_read_b64_tr_b16 v[42:43], v13 offset:512
    ds_read_b64_tr_b16 v[44:45], v13 offset:2048
    ds_read_b64_tr_b16 v[46:47], v13 offset:2560
    s_waitcnt lgkmcnt(0)
    v_xor_b32 v13, 0x4000, v12
    v_add_u32 v13, 0x10000, v13
    ds_read_b64_tr_b16 v[48:49], v13
    ds_read_b64_tr_b16 v[50:51], v13 offset:512
    ds_read_b64_tr_b16 v[52:53], v13 offset:2048
    ds_read_b64_tr_b16 v[54:55], v13 offset:2560
    v_xor_b32 v13, 0x6000, v12
    v_add_u32 v13, 0x10000, v13
    ds_read_b64_tr_b16 v[56:57], v13
    ds_read_b64_tr_b16 v[58:59], v13 offset:512
    ds_read_b64_tr_b16 v[60:61], v13 offset:2048
    ds_read_b64_tr_b16 v[62:63], v13 offset:2560
    s_waitcnt lgkmcnt(0)
    s_barrier
    ds_write_b128 v124, v[32:35]
    ds_write_b128 v124, v[36:39] offset:1024
    ds_write_b128 v124, v[40:43] offset:2048
    ds_write_b128 v124, v[44:47] offset:3072
    ds_write_b128 v124, v[48:51] offset:4096
    ds_write_b128 v124, v[52:55] offset:5120
    ds_write_b128 v124, v[56:59] offset:6144
    ds_write_b128 v124, v[60:63] offset:7168
    s_waitcnt vmcnt(0)
    s_barrier
    v_xor_b32 v13, 0x0, v12
    v_add_u32 v13, 0x18000, v13
    ds_read_b64_tr_b16 v[32:33], v13
    ds_read_b64_tr_b16 v[34:35], v13 offset:512
    ds_read_b64_tr_b16 v[36:37], v13 offset:2048
    ds_read_b64_tr_b16 v[38:39], v13 offset:2560
    v_xor_b32 v13, 0x2000, v12
    v_add_u32 v13, 0x18000, v13
    ds_read_b64_tr_b16 v[40:41], v13
    ds_read_b64_tr_b16 v[42:43], v13 offset:512
    ds_read_b64_tr_b16 v[44:45], v13 offset:2048
    ds_read_b64_tr_b16 v[46:47], v13 offset:2560
    s_waitcnt lgkmcnt(0)
    v_xor_b32 v13, 0x4000, v12
    v_add_u32 v13, 0x18000, v13
    ds_read_b64_tr_b16 v[48:49], v13
    ds_read_b64_tr_b16 v[50:51], v13 offset:512
    ds_read_b64_tr_b16 v[52:53], v13 offset:2048
    ds_read_b64_tr_b16 v[54:55], v13 offset:2560
    v_xor_b32 v13, 0x6000, v12
    v_add_u32 v13, 0x18000, v13
    ds_read_b64_tr_b16 v[56:57], v13
    ds_read_b64_tr_b16 v[58:59], v13 offset:512
    ds_read_b64_tr_b16 v[60:61], v13 offset:2048
    ds_read_b64_tr_b16 v[62:63], v13 offset:2560
    s_waitcnt lgkmcnt(0)
    s_barrier
    ds_write_b128 v124, v[32:35] offset:32768
    ds_write_b128 v124, v[36:39] offset:33792
    ds_write_b128 v124, v[40:43] offset:34816
    ds_write_b128 v124, v[44:47] offset:35840
    ds_write_b128 v124, v[48:51] offset:36864
    ds_write_b128 v124, v[52:55] offset:37888
    ds_write_b128 v124, v[56:59] offset:38912
    ds_write_b128 v124, v[60:63] offset:39936
    s_waitcnt lgkmcnt(0)
    v_lshrrev_b32 v1, 4, v117
    v_and_b32 v2, 15, v1
    v_lshrrev_b32 v1, 4, v1
    v_lshlrev_b32 v1, 11, v1
    v_lshl_add_u32 v1, v2, 2, v1
    s_lshl_b32 s43, s20, 6
    s_add_u32 s43, s43, 0x2000
    s_cmp_lg_u32 s100, 0
    s_cbranch_scc1 L_polls_52
    s_mov_b32 exec_lo, 0x10001
    s_mov_b32 exec_hi, 0
    s_mov_b32 s96, 0
L_poll_50:
    buffer_load_dword v2, v1, s[8:11], s43 offen sc1
    s_waitcnt vmcnt(0)
    v_cmp_gt_u32 vcc, 1, v2
    s_cbranch_vccz L_polld_51
    s_sleep 4
    s_add_u32 s96, s96, 1
    s_cmp_lt_u32 s96, 0x10000
    s_cbranch_scc1 L_poll_50
L_polld_51:
    s_mov_b64 exec, -1
L_polls_52:
    s_barrier
    s_mov_b32 s22, 0
    s_mov_b32 s33, 0
    s_xor_b32 s53, s29, 1024
    s_add_u32 s23, s51, 0x7010000
    s_add_u32 s48, s23, 4096
    s_mov_b32 s24, 0x7012000
    s_add_u32 s55, s24, 16384
    s_mov_b32 s25, 0x7100000
    s_mov_b32 s26, 0x7101000
    s_lshl_b32 s43, s20, 13
    v_mov_b32 v112, 0
    v_mov_b32 v113, 0
    v_mov_b32 v114, 0
    v_mov_b32 v115, 0
    s_add_u32 s43, s43, s52
    s_add_u32 s30, s43, 0x1000000
    s_add_u32 s31, s43, 0x2000000
    s_lshr_b32 s43, s43, 1
    s_add_u32 s32, s43, 0x220000
    s_add_u32 m0, s52, 8192
    s_nop 0
    buffer_load_dwordx4 v117, s[8:11], s30 offen lds
    buffer_load_dwordx4 v117, s[8:11], s30 offen offset:1024 lds
    s_add_u32 m0, s52, 0x6000
    s_nop 0
    buffer_load_dwordx4 v117, s[8:11], s31 offen lds
    buffer_load_dwordx4 v117, s[8:11], s31 offen offset:1024 lds
    s_add_u32 m0, s51, 4096
    ds_write_b128 v117, v[112:115] offset:22528
    ds_write_b128 v117, v[112:115] offset:23552
    s_cmp_lg_u32 s21, 0
    s_cselect_b32 s40, -1, 0
    v_mov_b32 v126, s40
    v_bfe_u32 v1, v117, 4, 1
    v_lshlrev_b32 v1, 4, v1
    s_movk_i32 s43, 0x3f80
    v_lshlrev_b32 v125, v1, s43
    v_bfe_u32 v1, v117, 5, 3
    v_cmp_eq_u32 s[68:69], 0, v1
    v_cmp_eq_u32 s[70:71], 1, v1
    v_cmp_eq_u32 s[72:73], 2, v1
    v_cmp_eq_u32 s[74:75], 3, v1
    v_lshrrev_b32 v1, 2, v117
    s_cmp_lt_u32 s21, 2
    s_cselect_b64 vcc, -1, 0
    v_cndmask_b32 v119, v119, v1, vcc
    v_mov_b32 v32, 0
    v_mov_b32 v33, 0
    v_mov_b32 v34, 0
    v_mov_b32 v35, 0
    v_mov_b32 v36, 0
    v_mov_b32 v37, 0
    v_mov_b32 v38, 0
    v_mov_b32 v39, 0
    v_mov_b32 v40, 0
    v_mov_b32 v41, 0
    v_mov_b32 v42, 0
    v_mov_b32 v43, 0
    v_mov_b32 v44, 0
    v_mov_b32 v45, 0
    v_mov_b32 v46, 0
    v_mov_b32 v47, 0
    v_mov_b32 v48, 0
    v_mov_b32 v49, 0
    v_mov_b32 v50, 0
    v_mov_b32 v51, 0
    v_mov_b32 v52, 0
    v_mov_b32 v53, 0
    v_mov_b32 v54, 0
    v_mov_b32 v55, 0
    s_add_u32 s30, s30, 0x40000
    s_add_u32 s31, s31, 0x40000
    s_mov_b32 s45, 0
    s_mov_b32 s46, 0
    s_mov_b32 s47, 0
    s_mov_b32 s76, 0
    s_and_b32 s43, s21, 1
    s_lshl_b32 s43, s43, 5
    s_add_u32 s43, s43, s20
    s_lshl_b32 s43, s43, 6
    s_add_u32 s28, s43, 0x2000
    s_mov_b32 s59, 0
    ds_read_b128 v[80:83], v123
    ds_read_b128 v[84:87], v123 offset:1024
    ds_read_b128 v[56:59], v123 offset:2048
    ds_read_b128 v[60:63], v123 offset:3072
    ds_read_b128 v[64:67], v123 offset:32768
    ds_read_b128 v[68:71], v123 offset:33792
    ds_read_b128 v[72:75], v123 offset:34816
    ds_read_b128 v[76:79], v123 offset:35840
    ds_read_b128 v[88:91], v123 offset:4096
    ds_read_b128 v[92:95], v123 offset:5120
    ds_read_b128 v[96:99], v123 offset:6144
    ds_read_b128 v[100:103], v123 offset:7168
    ds_read_b128 v[104:107], v123 offset:36864
    ds_read_b128 v[108:111], v123 offset:37888
    ds_read_b128 v[24:27], v123 offset:38912
    ds_read_b128 v[28:31], v123 offset:39936
    s_cmp_lg_u32 s21, 0
    s_cbranch_scc1 L_cb_skip_53
    v_mov_b32 v1, 8
    s_mov_b64 exec, 1
    s_mov_b32 s49, 0
L_cb_poll_54:
    buffer_load_dword v3, v1, s[16:19], 0 offen sc1
    s_waitcnt vmcnt(0)
    v_readfirstlane_b32 s43, v3
    s_nop 0
    s_cmp_ge_u32 s43, 32
    s_cbranch_scc1 L_cb_done_55
    s_sleep 2
    s_add_u32 s49, s49, 1
    s_cmp_lt_u32 s49, 0x40000
    s_cbranch_scc1 L_cb_poll_54
L_cb_done_55:
    s_mov_b64 exec, -1
L_cb_skip_53:
    s_mov_b32 s49, 0
    s_lshr_b32 s43, s20, 1
    s_lshl_b32 s43, s43, 7
    s_and_b32 s40, s20, 1
    s_lshl_b32 s40, s40, 4
    s_add_u32 s43, s43, s40
    s_add_u32 s44, s43, 0x1000
    s_cmp_eq_u32 s21, 0
    s_cselect_b32 s44, s44, 0x7ff00000
    s_waitcnt vmcnt(0) lgkmcnt(0)
    s_barrier
    buffer_load_dwordx4 v[0:3], v117, s[8:11], s23 offen sc1
    s_waitcnt vmcnt(0) lgkmcnt(0)
    s_cmp_eq_u32 s21, 1
    s_cbranch_scc1 L_chain_top1_s
    s_cmp_eq_u32 s21, 2
    s_cbranch_scc1 L_chain_top2_s
    s_cmp_eq_u32 s21, 3
    s_cbranch_scc1 L_chain_top3_s
.p2align 6
L_chain_top0_s:
    buffer_load_dwordx4 v[0:3], v117, s[8:11], s23 offen sc1
    v_mov_b32 v15, 0
    v_mov_b32 v15, 0
    v_mov_b32 v15, 0
    v_mov_b32 v15, 0
    v_mov_b32 v15, 0
    v_mov_b32 v15, 0
    v_mov_b32 v15, 0
    v_mov_b32 v15, 0
    v_mov_b32 v15, 0
    v_mov_b32 v15, 0
    v_mov_b32 v15, 0
    v_mov_b32 v15, 0
    v_mov_b32 v15, 0
    v_mov_b32 v15, 0
    v_mov_b32 v15, 0
    v_mov_b32 v15, 0
    buffer_load_dwordx4 v[0:3], v117, s[8:11], s23 offen sc1
    v_mov_b32 v15, 0
    v_mov_b32 v15, 0
    v_mov_b32 v15, 0
    v_mov_b32 v15, 0
    v_mov_b32 v15, 0
    v_mov_b32 v15, 0
    v_mov_b32 v15, 0
    v_mov_b32 v15, 0
    v_mov_b32 v15, 0
    v_mov_b32 v15, 0
    v_mov_b32 v15, 0
    v_mov_b32 v15, 0
    v_mov_b32 v15, 0
    v_mov_b32 v15, 0
    v_mov_b32 v15, 0
    v_mov_b32 v15, 0
L_mret_56:
    buffer_load_dwordx4 v[0:3], v117, s[8:11], s23 offen sc1
    s_add_u32 s45, s45, 1
    s_cmp_lt_u32 s45, 0x10000
    s_cselect_b32 s56, -2, -1
    s_nop 3
    v_mov_b32 v32, 0
    v_mov_b32 v33, 0
    v_mov_b32 v34, 0
    v_mov_b32 v35, 0
    s_waitcnt vmcnt(2)
    v_max3_u32 v15, v0, v1, v2
    v_max_u32 v15, v15, v3
    v_cmp_lt_u32 vcc, s56, v15
    v_smfmac_f32_16x16x64_bf16 v[32:35], v[0:3], v[80:87], v116
    s_cbranch_vccnz L_mret_56
    ds_write_b128 v117, v[0:3]
    v_smfmac_f32_16x16x64_bf16 v[36:39], v[0:3], v[56:63], v116
    buffer_load_dwordx4 v[4:7], v117, s[8:11], s48 offen sc1
    v_smfmac_f32_16x16x64_bf16 v[40:43], v[0:3], v[64:71], v116
    buffer_load_dwordx4 v117, s[8:11], s48 offen sc1 lds
    s_mov_b32 m0, 8192
    v_smfmac_f32_16x16x64_bf16 v[44:47], v[0:3], v[72:79], v116
    s_waitcnt lgkmcnt(0)
    s_barrier
    ds_read_b128 v[8:11], v117 offset:1024
    v_smfmac_f32_16x16x64_bf16 v[48:51], v[0:3], a[192:199], v116
    ds_read_b128 v[16:19], v117 offset:2048
    ds_read_b128 v[20:23], v117 offset:3072
    v_smfmac_f32_16x16x64_bf16 v[52:55], v[0:3], a[200:207], v116
    ds_read_b128 v[80:83], v117 offset:14336
    s_waitcnt lgkmcnt(3)
    v_smfmac_f32_16x16x64_bf16 v[32:35], v[8:11], a[0:7], v116
    ds_read_b128 v[84:87], v117 offset:15360
    v_smfmac_f32_16x16x64_bf16 v[36:39], v[8:11], a[8:15], v116
    buffer_store_dwordx4 v[112:115], v117, s[8:11], s32 offen sc1
    s_waitcnt lgkmcnt(3)
    v_smfmac_f32_16x16x64_bf16 v[32:35], v[16:19], a[32:39], v116
    ds_read_b128 v[56:59], v117 offset:8192
    v_smfmac_f32_16x16x64_bf16 v[36:39], v[16:19], a[40:47], v116
    ds_read_b128 v[60:63], v117 offset:9216
    s_waitcnt lgkmcnt(4)
    v_smfmac_f32_16x16x64_bf16 v[32:35], v[20:23], a[64:71], v116
    ds_read_b128 v[64:67], v117 offset:10240
    v_smfmac_f32_16x16x64_bf16 v[36:39], v[20:23], a[72:79], v116
    ds_read_b128 v[68:71], v117 offset:11264
    v_smfmac_f32_16x16x64_bf16 v[40:43], v[8:11], a[96:103], v116
    ds_read_b128 v[72:75], v117 offset:12288
    v_smfmac_f32_16x16x64_bf16 v[40:43], v[16:19], a[128:135], v116
    ds_read_b128 v[76:79], v117 offset:13312
    v_smfmac_f32_16x16x64_bf16 v[40:43], v[20:23], a[160:167], v116
    s_waitcnt vmcnt(2)
    v_max3_u32 v15, v4, v5, v6
    v_smfmac_f32_16x16x64_bf16 v[44:47], v[8:11], a[104:111], v116
    v_max_u32 v15, v15, v7
    v_smfmac_f32_16x16x64_bf16 v[44:47], v[16:19], a[136:143], v116
    s_waitcnt vmcnt(1) lgkmcnt(0)
    v_cmp_lt_u32 vcc, s56, v15
    v_smfmac_f32_16x16x64_bf16 v[44:47], v[20:23], a[168:175], v116
    s_cbranch_vccnz L_mret_57
L_mgo_58:
    v_smfmac_f32_16x16x64_bf16 v[44:47], v[4:7], v[24:31], v116
    s_barrier
    ds_read_b128 v[12:15], v117 offset:5120
    v_smfmac_f32_16x16x64_bf16 v[32:35], v[4:7], v[88:95], v116
    ds_read_b128 v[24:27], v117 offset:6144
    v_smfmac_f32_16x16x64_bf16 v[36:39], v[4:7], v[96:103], v116
    ds_read_b128 v[28:31], v117 offset:7168
    v_smfmac_f32_16x16x64_bf16 v[40:43], v[4:7], v[104:111], v116
    ds_read_b128 v[88:91], v117 offset:24576
    s_waitcnt lgkmcnt(3)
    v_smfmac_f32_16x16x64_bf16 v[32:35], v[12:15], a[16:23], v116
    ds_read_b128 v[92:95], v117 offset:25600
    s_waitcnt lgkmcnt(3)
    v_smfmac_f32_16x16x64_bf16 v[32:35], v[24:27], a[48:55], v116
    buffer_load_dwordx4 v117, s[8:11], s30 offen lds
    s_waitcnt lgkmcnt(2)
    v_smfmac_f32_16x16x64_bf16 v[32:35], v[28:31], a[80:87], v116
    ds_read_b128 v[96:99], v117 offset:23552
    v_smfmac_f32_16x16x64_bf16 v[36:39], v[12:15], a[24:31], v116
    ds_read_b128 v[100:103], v117 offset:23552
    v_smfmac_f32_16x16x64_bf16 v[36:39], v[24:27], a[56:63], v116
    buffer_load_dwordx4 v117, s[8:11], s30 offen offset:1024 lds
    s_add_u32 m0, s52, 0x6000
    v_add_f32 v32, v32, v34
    v_smfmac_f32_16x16x64_bf16 v[36:39], v[28:31], a[88:95], v116
    ds_read_b128 v[104:107], v117 offset:23552
    v_add_f32 v33, v33, v35
    v_smfmac_f32_16x16x64_bf16 v[40:43], v[12:15], a[112:119], v116
    ds_read_b128 v[108:111], v117 offset:23552
    v_mul_f32 v32, s34, v32
    v_smfmac_f32_16x16x64_bf16 v[40:43], v[24:27], a[144:151], v116
    buffer_load_dword v125, v119, s[8:11], s28 offen sc1
    v_mul_f32 v33, s34, v33
    v_smfmac_f32_16x16x64_bf16 v[40:43], v[28:31], a[176:183], v116
    ds_read_b128 v[0:3], v124
    v_add_f32 v36, v36, v38
    v_smfmac_f32_16x16x64_bf16 v[48:51], v[4:7], a[208:215], v116
    v_add_f32 v37, v37, v39
    v_smfmac_f32_16x16x64_bf16 v[52:55], v[4:7], a[216:223], v116
    s_waitcnt lgkmcnt(5)
    buffer_load_dwordx4 v117, s[8:11], s31 offen lds
    v_mul_f32 v36, s34, v36
    v_smfmac_f32_16x16x64_bf16 v[44:47], v[12:15], a[120:127], v116
    ds_read_b128 v[4:7], v124 offset:1024
    v_mul_f32 v37, s34, v37
    v_smfmac_f32_16x16x64_bf16 v[44:47], v[24:27], a[152:159], v116
    v_cvt_pk_bf16_f32 v34, v32, v36
    v_smfmac_f32_16x16x64_bf16 v[44:47], v[28:31], a[184:191], v116
    buffer_load_dwordx4 v117, s[8:11], s31 offen offset:1024 lds
    s_mov_b32 m0, 4096
    v_cvt_pk_bf16_f32 v35, v33, v37
    v_add_f32 v40, v40, v42
    v_smfmac_f32_16x16x64_bf16 v[48:51], v[8:11], a[224:231], v116
    ds_write2_b32 v120, v34, v35 offset0:32 offset1:48
    v_add_f32 v41, v41, v43
    v_smfmac_f32_16x16x64_bf16 v[52:55], v[8:11], a[232:239], v116
    v_add_f32 v44, v44, v46
    v_add_f32 v45, v45, v47
    v_cvt_pk_bf16_f32 v113, v40, v44
    v_cvt_pk_bf16_f32 v115, v41, v45
    v_smfmac_f32_16x16x64_bf16 v[48:51], v[12:15], a[240:247], v116
    ds_write2_b32 v120, v113, v115 offset0:0 offset1:16
    v_smfmac_f32_16x16x64_bf16 v[52:55], v[12:15], a[248:255], v116
    s_cmp_eq_u32 s22, 63
    s_cbranch_scc1 L_chain_last_s
    buffer_store_dword v126, off, s[8:11], s44 sc1
    v_smfmac_f32_16x16x64_bf16 v[48:51], v[16:19], v[128:135], v116
    v_smfmac_f32_16x16x64_bf16 v[48:51], v[20:23], v[160:167], v116
    v_smfmac_f32_16x16x64_bf16 v[48:51], v[24:27], v[144:151], v116
    s_waitcnt lgkmcnt(0)
    s_barrier
    v_smfmac_f32_16x16x64_bf16 v[48:51], v[28:31], v[176:183], v116
    ds_read_b128 v[32:35], v121 offset:16384
    ds_read_b128 v[36:39], v121 offset:17408
    v_smfmac_f32_16x16x64_bf16 v[52:55], v[16:19], v[136:143], v116
    ds_read_b128 v[40:43], v121 offset:18432
    ds_read_b128 v[44:47], v121 offset:19456
    v_smfmac_f32_16x16x64_bf16 v[52:55], v[20:23], v[168:175], v116
    ds_read_b128 v[8:11], v124 offset:32768
    v_add_f32 v48, v48, v50
    v_smfmac_f32_16x16x64_bf16 v[52:55], v[24:27], v[152:159], v116
    ds_read_b128 v[12:15], v124 offset:33792
    v_add_f32 v49, v49, v51
    v_smfmac_f32_16x16x64_bf16 v[52:55], v[28:31], v[184:191], v116
    s_waitcnt lgkmcnt(5)
    v_cvt_pk_bf16_f32 v112, v48, v49
    v_mfma_f32_16x16x32_bf16 v[56:59], v[56:59], v[32:35], 0
    s_waitcnt lgkmcnt(4)
    v_mov_b32 v48, s50
    v_mov_b32 v49, s50
    v_mfma_f32_16x16x32_bf16 v[56:59], v[60:63], v[36:39], v[56:59]
    ds_read_b128 v[16:19], v124 offset:2048
    s_waitcnt lgkmcnt(4)
    v_mov_b32 v50, s50
    v_mov_b32 v51, s50
    v_mfma_f32_16x16x32_bf16 v[56:59], v[64:67], v[40:43], v[56:59]
    ds_read_b128 v[20:23], v124 offset:3072
    s_waitcnt lgkmcnt(4)
    v_add_f32 v52, v52, v54
    v_mfma_f32_16x16x32_bf16 v[56:59], v[68:71], v[44:47], v[56:59]
    ds_read_b128 v[24:27], v124 offset:4096
    v_add_f32 v53, v53, v55
    v_mfma_f32_16x16x32_bf16 v[60:63], v[72:75], v[32:35], 0
    ds_read_b128 v[28:31], v124 offset:5120
    v_cvt_pk_bf16_f32 v114, v52, v53
    v_mov_b32 v53, 0
    v_mfma_f32_16x16x32_bf16 v[60:63], v[76:79], v[36:39], v[60:63]
    v_exp_f32 v56, v56
    v_mfma_f32_16x16x32_bf16 v[60:63], v[80:83], v[40:43], v[60:63]
    v_exp_f32 v57, v57
    v_mfma_f32_16x16x32_bf16 v[60:63], v[84:87], v[44:47], v[60:63]
    v_exp_f32 v58, v58
    v_mfma_f32_16x16x32_bf16 v[64:67], v[32:35], v[32:35], 0
    v_exp_f32 v59, v59
    v_cvt_pk_bf16_f32 v68, v56, v57
    v_mfma_f32_16x16x32_bf16 v[64:67], v[36:39], v[36:39], v[64:67]
    v_exp_f32 v60, v60
    v_cvt_pk_bf16_f32 v69, v58, v59
    v_mfma_f32_16x16x32_bf16 v[64:67], v[40:43], v[40:43], v[64:67]
    v_exp_f32 v61, v61
    v_mfma_f32_16x16x32_bf16 v[64:67], v[44:47], v[44:47], v[64:67]
    v_exp_f32 v62, v62
    v_exp_f32 v63, v63
    v_cvt_pk_bf16_f32 v70, v60, v61
    v_cvt_pk_bf16_f32 v71, v62, v63
    s_nop 1
    v_mfma_f32_16x16x32_bf16 v[72:75], v[88:91], v[68:71], 0
    s_nop 0
    v_exp_f32 v64, v64
    v_mfma_f32_16x16x32_bf16 v[76:79], v[92:95], v[68:71], 0
    v_exp_f32 v65, v65
    v_mfma_f32_16x16x32_bf16 v[80:83], v[48:51], v[68:71], 0
    v_cvt_pk_bf16_f32 v52, v64, v65
    s_nop 1
    v_mfma_f32_16x16x16_bf16 v[72:75], v[112:113], v[52:53], v[72:75]
    ds_read_b128 v[32:35], v124 offset:6144
    v_mfma_f32_16x16x16_bf16 v[76:79], v[114:115], v[52:53], v[76:79]
    ds_read_b128 v[36:39], v124 offset:7168
    v_mfma_f32_16x16x16_bf16 v[80:83], v[48:49], v[52:53], v[80:83]
L_norm_59:
    s_mov_b64 vcc, s[36:37]
    v_mov_b32 v122, v122
    v_mov_b32 v122, v122
    v_mov_b32 v122, v122
    v_cndmask_b32_dpp v76, v72, v76, vcc quad_perm:[2,3,2,3] row_mask:0xf bank_mask:0xf
    v_cndmask_b32_dpp v77, v73, v77, vcc quad_perm:[2,3,2,3] row_mask:0xf bank_mask:0xf
    v_cndmask_b32_dpp v78, v74, v78, vcc quad_perm:[2,3,2,3] row_mask:0xf bank_mask:0xf
    v_cndmask_b32_dpp v79, v75, v79, vcc quad_perm:[2,3,2,3] row_mask:0xf bank_mask:0xf
    v_rcp_f32_dpp v84, v80 quad_perm:[2,3,2,3] row_mask:0xf bank_mask:0xf
    s_nop 0
    v_pk_mul_f32 v[76:77], v[76:77], v[84:85] op_sel_hi:[1,0]
    v_pk_mul_f32 v[78:79], v[78:79], v[84:85] op_sel_hi:[1,0]
    v_cvt_pk_bf16_f32 v72, v76, v77
    v_cvt_pk_bf16_f32 v73, v78, v79
    ds_write_b64 v122, v[72:73] offset:20480
    v_max_f32_dpp v86, v80, v84 quad_perm:[2,3,2,3] row_mask:0xf bank_mask:0xf
    v_mov_b32_dpp v60, v72 quad_perm:[0,1,0,1] row_mask:0xf bank_mask:0xf
    v_mov_b32_dpp v61, v73 quad_perm:[0,1,0,1] row_mask:0xf bank_mask:0xf
    v_cmp_lt_f32 vcc, s35, v86
    v_mov_b32_dpp v62, v72 quad_perm:[2,3,2,3] row_mask:0xf bank_mask:0xf
    v_mov_b32_dpp v63, v73 quad_perm:[2,3,2,3] row_mask:0xf bank_mask:0xf
    s_nop 1
    v_smfmac_f32_16x16x64_bf16 v[96:99], v[60:63], v[192:199], v116
    s_cbranch_vccnz L_smax_60
    v_smfmac_f32_16x16x64_bf16 v[100:103], v[60:63], v[224:231], v116
    s_waitcnt lgkmcnt(0)
    s_barrier
    ds_read_b128 v[92:95], v127 offset:20992
    ds_read_b128 v[80:83], v127 offset:21504
    ds_read_b128 v[84:87], v127 offset:22016
    v_smfmac_f32_16x16x64_bf16 v[104:107], v[60:63], v[0:7], v116
    ds_read_b128 v[40:43], v124 offset:34816
    v_smfmac_f32_16x16x64_bf16 v[108:111], v[60:63], v[8:15], v116
    ds_read_b128 v[56:59], v124 offset:36864
    s_waitcnt lgkmcnt(4)
    v_smfmac_f32_16x16x64_bf16 v[96:99], v[92:95], v[200:207], v116
    s_waitcnt lgkmcnt(3)
    v_smfmac_f32_16x16x64_bf16 v[96:99], v[80:83], v[208:215], v116
    ds_read_b128 v[44:47], v124 offset:35840
    s_waitcnt lgkmcnt(3)
    v_smfmac_f32_16x16x64_bf16 v[96:99], v[84:87], v[216:223], v116
    ds_read_b128 v[68:71], v124 offset:39936
    v_smfmac_f32_16x16x64_bf16 v[100:103], v[92:95], v[232:239], v116
    ds_read_b128 v[64:67], v124 offset:38912
    v_smfmac_f32_16x16x64_bf16 v[100:103], v[80:83], v[240:247], v116
    ds_read_b128 v[60:63], v124 offset:37888
    v_cvt_pk_bf16_f32 v72, v96, v98
    v_smfmac_f32_16x16x64_bf16 v[100:103], v[84:87], v[248:255], v116
    v_and_or_b32 v72, v72, -2, s33
    v_smfmac_f32_16x16x64_bf16 v[104:107], v[92:95], v[16:23], v116
    v_cvt_pk_bf16_f32 v74, v97, v99
    v_smfmac_f32_16x16x64_bf16 v[104:107], v[80:83], v[24:31], v116
    v_cvt_pk_bf16_f32 v73, v100, v102
    v_cvt_pk_bf16_f32 v75, v101, v103
    v_smfmac_f32_16x16x64_bf16 v[104:107], v[84:87], v[32:39], v116
    buffer_store_dwordx4 v[72:75], v118, s[8:11], s25 offen sc1
    s_waitcnt lgkmcnt(3)
    v_smfmac_f32_16x16x64_bf16 v[108:111], v[92:95], v[40:47], v116
    s_waitcnt lgkmcnt(0)
    v_smfmac_f32_16x16x64_bf16 v[108:111], v[80:83], v[56:63], v116
    v_cvt_pk_bf16_f32 v76, v104, v106
    v_smfmac_f32_16x16x64_bf16 v[108:111], v[84:87], v[64:71], v116
    v_and_or_b32 v76, v76, -2, s33
    v_cvt_pk_bf16_f32 v78, v105, v107
    v_mov_b32 v122, v122
    v_mov_b32 v122, v122
    v_mov_b32 v122, v122
    v_mov_b32 v122, v122
    v_mov_b32 v122, v122
    v_mov_b32 v122, v122
    v_cvt_pk_bf16_f32 v77, v108, v110
    v_cvt_pk_bf16_f32 v79, v109, v111
    buffer_store_dwordx4 v[76:79], v118, s[8:11], s26 offen sc1
    s_add_u32 s30, s30, 0x40000
    s_add_u32 s31, s31, 0x40000
    s_add_u32 s32, s32, 0x20000
    s_add_u32 s23, s24, 0
    s_add_u32 s48, s23, 4096
    s_xor_b32 s25, s25, 0x40000
    s_xor_b32 s26, s26, 0x40000
    s_mov_b32 s35, 0x49800000
    v_mov_b32 v126, s22
    s_add_u32 s22, s22, 1
    v_mov_b32 v32, 0
    v_mov_b32 v33, 0
    v_mov_b32 v34, 0
    v_mov_b32 v35, 0
    v_mov_b32 v36, 0
    v_mov_b32 v37, 0
    v_mov_b32 v38, 0
    v_mov_b32 v39, 0
    v_mov_b32 v40, 0
    v_mov_b32 v41, 0
    v_mov_b32 v42, 0
    v_mov_b32 v43, 0
    v_mov_b32 v44, 0
    v_mov_b32 v45, 0
    v_mov_b32 v46, 0
    v_mov_b32 v47, 0
    v_mov_b32 v48, 0
    v_mov_b32 v49, 0
    v_mov_b32 v50, 0
    v_mov_b32 v51, 0
    v_mov_b32 v52, 0
    v_mov_b32 v53, 0
    v_mov_b32 v54, 0
    v_mov_b32 v55, 0
    ds_read_b128 v[80:83], v123
    ds_read_b128 v[84:87], v123 offset:1024
    ds_read_b128 v[56:59], v123 offset:2048
    ds_read_b128 v[60:63], v123 offset:3072
    ds_read_b128 v[64:67], v123 offset:32768
    ds_read_b128 v[68:71], v123 offset:33792
    ds_read_b128 v[72:75], v123 offset:34816
    ds_read_b128 v[76:79], v123 offset:35840
    ds_read_b128 v[88:91], v123 offset:4096
    ds_read_b128 v[92:95], v123 offset:5120
    ds_read_b128 v[96:99], v123 offset:6144
    ds_read_b128 v[100:103], v123 offset:7168
    ds_read_b128 v[104:107], v123 offset:36864
    ds_read_b128 v[108:111], v123 offset:37888
    ds_read_b128 v[24:27], v123 offset:38912
    ds_read_b128 v[28:31], v123 offset:39936
    s_add_u32 s24, s24, 8192
    s_bitset0_b32 s24, 15
    s_xor_b32 s55, s24, 16384
    s_xor_b32 s29, s29, 0x40000
    s_xor_b32 s53, s29, 1024
    s_bfe_u32 s33, s22, 0x10001
    s_add_u32 s40, s22, 5
    s_lshr_b32 s40, s40, 2
    s_min_u32 s40, s40, 16
    s_bfm_b32 s58, s40, 0
    s_waitcnt vmcnt(5)
    v_cmp_eq_u32 vcc, 0, v125
    s_nop 0
    s_and_b64 vcc, vcc, s[58:59]
    s_cbranch_scc1 L_kvw_61
L_kvb_62:
    v_mov_b32 v15, 0
    s_nop 2
    v_mov_b32 v15, 0
    s_nop 2
    v_mov_b32 v15, 0
    s_nop 2
    v_mov_b32 v15, 0
    s_nop 2
    v_mov_b32 v15, 0
    s_nop 2
    v_mov_b32 v15, 0
    s_nop 2
    v_mov_b32 v15, 0
    s_nop 2
    v_mov_b32 v15, 0
    s_nop 2
    v_mov_b32 v15, 0
    s_nop 2
    v_mov_b32 v15, 0
    s_nop 2
    v_mov_b32 v15, 0
    s_nop 2
    v_mov_b32 v15, 0
    s_nop 2
    v_mov_b32 v15, 0
    s_nop 2
    v_mov_b32 v15, 0
    s_nop 2
    v_mov_b32 v15, 0
    s_nop 2
    v_mov_b32 v15, 0
    s_nop 2
    v_mov_b32 v15, 0
    s_nop 2
    v_mov_b32 v15, 0
    s_nop 2
    v_mov_b32 v15, 0
    s_nop 2
    v_mov_b32 v15, 0
    s_nop 2
    v_mov_b32 v15, 0
    s_nop 2
    v_mov_b32 v15, 0
    s_nop 2
    v_mov_b32 v15, 0
    s_nop 2
    v_mov_b32 v15, 0
    s_nop 2
    v_mov_b32 v15, 0
    s_nop 2
    v_mov_b32 v15, 0
    s_nop 2
    v_mov_b32 v15, 0
    s_nop 2
    v_mov_b32 v15, 0
    s_nop 2
    v_mov_b32 v15, 0
    s_nop 2
    v_mov_b32 v15, 0
    s_nop 2
    v_mov_b32 v15, 0
    s_nop 2
    s_waitcnt lgkmcnt(0)
    s_branch L_chain_top0_s
.p2align 6
L_chain_top1_s:
    buffer_load_dwordx4 v[0:3], v117, s[8:11], s23 offen sc1
    v_mov_b32 v15, 0
    v_mov_b32 v15, 0
    v_mov_b32 v15, 0
    v_mov_b32 v15, 0
    v_mov_b32 v15, 0
    v_mov_b32 v15, 0
    v_mov_b32 v15, 0
    v_mov_b32 v15, 0
    v_mov_b32 v15, 0
    v_mov_b32 v15, 0
    v_mov_b32 v15, 0
    v_mov_b32 v15, 0
    v_mov_b32 v15, 0
    v_mov_b32 v15, 0
    v_mov_b32 v15, 0
    v_mov_b32 v15, 0
    buffer_load_dwordx4 v[0:3], v117, s[8:11], s23 offen sc1
    v_mov_b32 v15, 0
    v_mov_b32 v15, 0
    v_mov_b32 v15, 0
    v_mov_b32 v15, 0
    v_mov_b32 v15, 0
    v_mov_b32 v15, 0
    v_mov_b32 v15, 0
    v_mov_b32 v15, 0
    v_mov_b32 v15, 0
    v_mov_b32 v15, 0
    v_mov_b32 v15, 0
    v_mov_b32 v15, 0
    v_mov_b32 v15, 0
    v_mov_b32 v15, 0
    v_mov_b32 v15, 0
    v_mov_b32 v15, 0
L_mret_63:
    buffer_load_dwordx4 v[0:3], v117, s[8:11], s23 offen sc1
    s_add_u32 s45, s45, 1
    s_cmp_lt_u32 s45, 0x10000
    s_cselect_b32 s56, -2, -1
    s_nop 3
    v_mov_b32 v32, 0
    v_mov_b32 v33, 0
    v_mov_b32 v34, 0
    v_mov_b32 v35, 0
    s_waitcnt vmcnt(2)
    v_max3_u32 v15, v0, v1, v2
    v_max_u32 v15, v15, v3
    v_cmp_lt_u32 vcc, s56, v15
    v_smfmac_f32_16x16x64_bf16 v[32:35], v[0:3], v[80:87], v116
    s_cbranch_vccnz L_mret_63
    ds_write_b128 v117, v[0:3] offset:1024
    v_smfmac_f32_16x16x64_bf16 v[36:39], v[0:3], v[56:63], v116
    buffer_load_dwordx4 v[4:7], v117, s[8:11], s48 offen sc1
    v_smfmac_f32_16x16x64_bf16 v[40:43], v[0:3], v[64:71], v116
    buffer_load_dwordx4 v117, s[8:11], s48 offen sc1 lds
    s_mov_b32 m0, 10240
    v_smfmac_f32_16x16x64_bf16 v[44:47], v[0:3], v[72:79], v116
    s_waitcnt lgkmcnt(0)
    s_barrier
    ds_read_b128 v[8:11], v117
    v_smfmac_f32_16x16x64_bf16 v[48:51], v[0:3], a[192:199], v116
    ds_read_b128 v[16:19], v117 offset:3072
    ds_read_b128 v[20:23], v117 offset:2048
    v_smfmac_f32_16x16x64_bf16 v[52:55], v[0:3], a[200:207], v116
    ds_read_b128 v[80:83], v117 offset:14336
    s_waitcnt lgkmcnt(3)
    v_smfmac_f32_16x16x64_bf16 v[32:35], v[8:11], a[0:7], v116
    ds_read_b128 v[84:87], v117 offset:15360
    v_smfmac_f32_16x16x64_bf16 v[36:39], v[8:11], a[8:15], v116
    ds_read_b128 v[56:59], v117 offset:8192
    s_waitcnt lgkmcnt(4)
    v_smfmac_f32_16x16x64_bf16 v[32:35], v[16:19], a[32:39], v116
    ds_read_b128 v[60:63], v117 offset:9216
    v_smfmac_f32_16x16x64_bf16 v[36:39], v[16:19], a[40:47], v116
    buffer_store_dwordx4 v[112:115], v117, s[8:11], s32 offen sc1
    s_waitcnt lgkmcnt(4)
    v_smfmac_f32_16x16x64_bf16 v[32:35], v[20:23], a[64:71], v116
    ds_read_b128 v[64:67], v117 offset:10240
    v_smfmac_f32_16x16x64_bf16 v[36:39], v[20:23], a[72:79], v116
    ds_read_b128 v[68:71], v117 offset:11264
    v_smfmac_f32_16x16x64_bf16 v[40:43], v[8:11], a[96:103], v116
    ds_read_b128 v[72:75], v117 offset:12288
    v_smfmac_f32_16x16x64_bf16 v[40:43], v[16:19], a[128:135], v116
    ds_read_b128 v[76:79], v117 offset:13312
    v_smfmac_f32_16x16x64_bf16 v[40:43], v[20:23], a[160:167], v116
    s_waitcnt vmcnt(2)
    v_max3_u32 v15, v4, v5, v6
    v_smfmac_f32_16x16x64_bf16 v[44:47], v[8:11], a[104:111], v116
    v_max_u32 v15, v15, v7
    v_smfmac_f32_16x16x64_bf16 v[44:47], v[16:19], a[136:143], v116
    s_waitcnt vmcnt(1) lgkmcnt(0)
    v_cmp_lt_u32 vcc, s56, v15
    v_smfmac_f32_16x16x64_bf16 v[44:47], v[20:23], a[168:175], v116
    s_cbranch_vccnz L_mret_64
L_mgo_65:
    v_smfmac_f32_16x16x64_bf16 v[44:47], v[4:7], v[24:31], v116
    s_barrier
    ds_read_b128 v[12:15], v117 offset:4096
    v_smfmac_f32_16x16x64_bf16 v[32:35], v[4:7], v[88:95], v116
    ds_read_b128 v[24:27], v117 offset:7168
    v_smfmac_f32_16x16x64_bf16 v[36:39], v[4:7], v[96:103], v116
    ds_read_b128 v[28:31], v117 offset:6144
    v_smfmac_f32_16x16x64_bf16 v[40:43], v[4:7], v[104:111], v116
    ds_read_b128 v[88:91], v117 offset:26624
    s_waitcnt lgkmcnt(3)
    v_smfmac_f32_16x16x64_bf16 v[32:35], v[12:15], a[16:23], v116
    ds_read_b128 v[92:95], v117 offset:27648
    s_waitcnt lgkmcnt(3)
    v_smfmac_f32_16x16x64_bf16 v[32:35], v[24:27], a[48:55], v116
    buffer_load_dwordx4 v117, s[8:11], s30 offen lds
    s_waitcnt lgkmcnt(2)
    v_smfmac_f32_16x16x64_bf16 v[32:35], v[28:31], a[80:87], v116
    ds_read_b128 v[96:99], v117 offset:23552
    v_smfmac_f32_16x16x64_bf16 v[36:39], v[12:15], a[24:31], v116
    ds_read_b128 v[100:103], v117 offset:23552
    v_smfmac_f32_16x16x64_bf16 v[36:39], v[24:27], a[56:63], v116
    buffer_load_dwordx4 v117, s[8:11], s30 offen offset:1024 lds
    s_add_u32 m0, s52, 0x6000
    v_add_f32 v32, v32, v34
    v_smfmac_f32_16x16x64_bf16 v[36:39], v[28:31], a[88:95], v116
    ds_read_b128 v[104:107], v117 offset:23552
    v_add_f32 v33, v33, v35
    v_smfmac_f32_16x16x64_bf16 v[40:43], v[12:15], a[112:119], v116
    ds_read_b128 v[108:111], v117 offset:23552
    v_mul_f32 v32, s34, v32
    v_smfmac_f32_16x16x64_bf16 v[40:43], v[24:27], a[144:151], v116
    buffer_load_dword v125, v119, s[8:11], s28 offen sc1
    v_mul_f32 v33, s34, v33
    v_smfmac_f32_16x16x64_bf16 v[40:43], v[28:31], a[176:183], v116
    ds_read_b128 v[0:3], v124
    v_add_f32 v36, v36, v38
    v_smfmac_f32_16x16x64_bf16 v[48:51], v[4:7], a[208:215], v116
    v_add_f32 v37, v37, v39
    v_smfmac_f32_16x16x64_bf16 v[52:55], v[4:7], a[216:223], v116
    s_waitcnt lgkmcnt(5)
    buffer_load_dwordx4 v117, s[8:11], s31 offen lds
    v_mul_f32 v36, s34, v36
    v_smfmac_f32_16x16x64_bf16 v[44:47], v[12:15], a[120:127], v116
    ds_read_b128 v[4:7], v124 offset:1024
    v_mul_f32 v37, s34, v37
    v_smfmac_f32_16x16x64_bf16 v[44:47], v[24:27], a[152:159], v116
    v_cvt_pk_bf16_f32 v34, v32, v36
    v_smfmac_f32_16x16x64_bf16 v[44:47], v[28:31], a[184:191], v116
    buffer_load_dwordx4 v117, s[8:11], s31 offen offset:1024 lds
    s_mov_b32 m0, 5120
    v_cvt_pk_bf16_f32 v35, v33, v37
    v_add_f32 v40, v40, v42
    v_smfmac_f32_16x16x64_bf16 v[48:51], v[8:11], a[224:231], v116
    ds_write2_b32 v120, v34, v35 offset0:32 offset1:48
    v_add_f32 v41, v41, v43
    v_smfmac_f32_16x16x64_bf16 v[52:55], v[8:11], a[232:239], v116
    v_add_f32 v44, v44, v46
    v_add_f32 v45, v45, v47
    v_cvt_pk_bf16_f32 v113, v40, v44
    v_cvt_pk_bf16_f32 v115, v41, v45
    v_smfmac_f32_16x16x64_bf16 v[48:51], v[12:15], a[240:247], v116
    ds_write2_b32 v120, v113, v115 offset0:0 offset1:16
    v_smfmac_f32_16x16x64_bf16 v[52:55], v[12:15], a[248:255], v116
    s_cmp_eq_u32 s22, 63
    s_cbranch_scc1 L_chain_last_s
    v_smfmac_f32_16x16x64_bf16 v[48:51], v[16:19], v[128:135], v116
    v_smfmac_f32_16x16x64_bf16 v[48:51], v[20:23], v[160:167], v116
    v_smfmac_f32_16x16x64_bf16 v[48:51], v[24:27], v[144:151], v116
    s_waitcnt lgkmcnt(0)
    s_barrier
    v_smfmac_f32_16x16x64_bf16 v[48:51], v[28:31], v[176:183], v116
    ds_read_b128 v[32:35], v121 offset:16384
    ds_read_b128 v[36:39], v121 offset:17408
    v_smfmac_f32_16x16x64_bf16 v[52:55], v[16:19], v[136:143], v116
    ds_read_b128 v[40:43], v121 offset:18432
    ds_read_b128 v[44:47], v121 offset:19456
    v_smfmac_f32_16x16x64_bf16 v[52:55], v[20:23], v[168:175], v116
    ds_read_b128 v[8:11], v124 offset:32768
    v_add_f32 v48, v48, v50
    v_smfmac_f32_16x16x64_bf16 v[52:55], v[24:27], v[152:159], v116
    ds_read_b128 v[12:15], v124 offset:33792
    v_add_f32 v49, v49, v51
    v_smfmac_f32_16x16x64_bf16 v[52:55], v[28:31], v[184:191], v116
    s_waitcnt lgkmcnt(5)
    v_cvt_pk_bf16_f32 v112, v48, v49
    v_mfma_f32_16x16x32_bf16 v[56:59], v[56:59], v[32:35], 0
    s_waitcnt lgkmcnt(4)
    v_mov_b32 v48, s50
    v_mov_b32 v49, s50
    v_mfma_f32_16x16x32_bf16 v[56:59], v[60:63], v[36:39], v[56:59]
    ds_read_b128 v[16:19], v124 offset:2048
    s_waitcnt lgkmcnt(4)
    v_mov_b32 v50, s50
    v_mov_b32 v51, s50
    v_mfma_f32_16x16x32_bf16 v[56:59], v[64:67], v[40:43], v[56:59]
    ds_read_b128 v[20:23], v124 offset:3072
    s_waitcnt lgkmcnt(4)
    v_add_f32 v52, v52, v54
    v_mfma_f32_16x16x32_bf16 v[56:59], v[68:71], v[44:47], v[56:59]
    ds_read_b128 v[24:27], v124 offset:4096
    v_add_f32 v53, v53, v55
    v_mfma_f32_16x16x32_bf16 v[60:63], v[72:75], v[32:35], 0
    ds_read_b128 v[28:31], v124 offset:5120
    v_cvt_pk_bf16_f32 v114, v52, v53
    v_mov_b32 v53, 0
    v_mfma_f32_16x16x32_bf16 v[60:63], v[76:79], v[36:39], v[60:63]
    v_exp_f32 v56, v56
    v_mfma_f32_16x16x32_bf16 v[60:63], v[80:83], v[40:43], v[60:63]
    v_exp_f32 v57, v57
    v_mfma_f32_16x16x32_bf16 v[60:63], v[84:87], v[44:47], v[60:63]
    v_exp_f32 v58, v58
    v_mfma_f32_16x16x32_bf16 v[64:67], v[32:35], v[32:35], 0
    v_exp_f32 v59, v59
    v_cvt_pk_bf16_f32 v68, v56, v57
    v_mfma_f32_16x16x32_bf16 v[64:67], v[36:39], v[36:39], v[64:67]
    v_exp_f32 v60, v60
    v_cvt_pk_bf16_f32 v69, v58, v59
    v_mfma_f32_16x16x32_bf16 v[64:67], v[40:43], v[40:43], v[64:67]
    v_exp_f32 v61, v61
    v_mfma_f32_16x16x32_bf16 v[64:67], v[44:47], v[44:47], v[64:67]
    v_exp_f32 v62, v62
    v_exp_f32 v63, v63
    v_cvt_pk_bf16_f32 v70, v60, v61
    v_cvt_pk_bf16_f32 v71, v62, v63
    s_nop 1
    v_mfma_f32_16x16x32_bf16 v[72:75], v[88:91], v[68:71], 0
    s_nop 0
    v_exp_f32 v64, v64
    v_mfma_f32_16x16x32_bf16 v[76:79], v[92:95], v[68:71], 0
    v_exp_f32 v65, v65
    v_mfma_f32_16x16x32_bf16 v[80:83], v[48:51], v[68:71], 0
    v_cvt_pk_bf16_f32 v52, v64, v65
    s_nop 1
    v_mfma_f32_16x16x16_bf16 v[72:75], v[112:113], v[52:53], v[72:75]
    ds_read_b128 v[32:35], v124 offset:6144
    v_mfma_f32_16x16x16_bf16 v[76:79], v[114:115], v[52:53], v[76:79]
    ds_read_b128 v[36:39], v124 offset:7168
    v_mfma_f32_16x16x16_bf16 v[80:83], v[48:49], v[52:53], v[80:83]
L_norm_66:
    s_mov_b64 vcc, s[36:37]
    v_mov_b32 v122, v122
    v_mov_b32 v122, v122
    v_mov_b32 v122, v122
    v_cndmask_b32_dpp v76, v72, v76, vcc quad_perm:[2,3,2,3] row_mask:0xf bank_mask:0xf
    v_cndmask_b32_dpp v77, v73, v77, vcc quad_perm:[2,3,2,3] row_mask:0xf bank_mask:0xf
    v_cndmask_b32_dpp v78, v74, v78, vcc quad_perm:[2,3,2,3] row_mask:0xf bank_mask:0xf
    v_cndmask_b32_dpp v79, v75, v79, vcc quad_perm:[2,3,2,3] row_mask:0xf bank_mask:0xf
    v_rcp_f32_dpp v84, v80 quad_perm:[2,3,2,3] row_mask:0xf bank_mask:0xf
    s_nop 0
    v_pk_mul_f32 v[76:77], v[76:77], v[84:85] op_sel_hi:[1,0]
    v_pk_mul_f32 v[78:79], v[78:79], v[84:85] op_sel_hi:[1,0]
    v_cvt_pk_bf16_f32 v72, v76, v77
    v_cvt_pk_bf16_f32 v73, v78, v79
    ds_write_b64 v122, v[72:73] offset:20992
    v_max_f32_dpp v86, v80, v84 quad_perm:[2,3,2,3] row_mask:0xf bank_mask:0xf
    v_mov_b32_dpp v60, v72 quad_perm:[0,1,0,1] row_mask:0xf bank_mask:0xf
    v_mov_b32_dpp v61, v73 quad_perm:[0,1,0,1] row_mask:0xf bank_mask:0xf
    v_cmp_lt_f32 vcc, s35, v86
    v_mov_b32_dpp v62, v72 quad_perm:[2,3,2,3] row_mask:0xf bank_mask:0xf
    v_mov_b32_dpp v63, v73 quad_perm:[2,3,2,3] row_mask:0xf bank_mask:0xf
    s_nop 1
    v_smfmac_f32_16x16x64_bf16 v[96:99], v[60:63], v[192:199], v116
    s_cbranch_vccnz L_smax_67
    v_smfmac_f32_16x16x64_bf16 v[100:103], v[60:63], v[224:231], v116
    s_waitcnt lgkmcnt(0)
    s_barrier
    ds_read_b128 v[92:95], v127 offset:20480
    ds_read_b128 v[80:83], v127 offset:22016
    ds_read_b128 v[84:87], v127 offset:21504
    v_smfmac_f32_16x16x64_bf16 v[104:107], v[60:63], v[0:7], v116
    ds_read_b128 v[40:43], v124 offset:34816
    v_smfmac_f32_16x16x64_bf16 v[108:111], v[60:63], v[8:15], v116
    ds_read_b128 v[56:59], v124 offset:36864
    s_waitcnt lgkmcnt(4)
    v_smfmac_f32_16x16x64_bf16 v[96:99], v[92:95], v[200:207], v116
    s_waitcnt lgkmcnt(3)
    v_smfmac_f32_16x16x64_bf16 v[96:99], v[80:83], v[208:215], v116
    ds_read_b128 v[44:47], v124 offset:35840
    s_waitcnt lgkmcnt(3)
    v_smfmac_f32_16x16x64_bf16 v[96:99], v[84:87], v[216:223], v116
    ds_read_b128 v[68:71], v124 offset:39936
    v_smfmac_f32_16x16x64_bf16 v[100:103], v[92:95], v[232:239], v116
    ds_read_b128 v[64:67], v124 offset:38912
    v_smfmac_f32_16x16x64_bf16 v[100:103], v[80:83], v[240:247], v116
    ds_read_b128 v[60:63], v124 offset:37888
    v_cvt_pk_bf16_f32 v72, v96, v98
    v_smfmac_f32_16x16x64_bf16 v[100:103], v[84:87], v[248:255], v116
    v_and_or_b32 v72, v72, -2, s33
    v_smfmac_f32_16x16x64_bf16 v[104:107], v[92:95], v[16:23], v116
    v_cvt_pk_bf16_f32 v74, v97, v99
    v_smfmac_f32_16x16x64_bf16 v[104:107], v[80:83], v[24:31], v116
    v_cvt_pk_bf16_f32 v73, v100, v102
    v_cvt_pk_bf16_f32 v75, v101, v103
    v_smfmac_f32_16x16x64_bf16 v[104:107], v[84:87], v[32:39], v116
    buffer_store_dwordx4 v[72:75], v118, s[8:11], s25 offen sc1
    s_waitcnt lgkmcnt(3)
    v_smfmac_f32_16x16x64_bf16 v[108:111], v[92:95], v[40:47], v116
    s_waitcnt lgkmcnt(0)
    v_smfmac_f32_16x16x64_bf16 v[108:111], v[80:83], v[56:63], v116
    v_cvt_pk_bf16_f32 v76, v104, v106
    v_smfmac_f32_16x16x64_bf16 v[108:111], v[84:87], v[64:71], v116
    v_and_or_b32 v76, v76, -2, s33
    v_cvt_pk_bf16_f32 v78, v105, v107
    v_mov_b32 v122, v122
    v_mov_b32 v122, v122
    v_mov_b32 v122, v122
    v_mov_b32 v122, v122
    v_mov_b32 v122, v122
    v_mov_b32 v122, v122
    v_cvt_pk_bf16_f32 v77, v108, v110
    v_cvt_pk_bf16_f32 v79, v109, v111
    buffer_store_dwordx4 v[76:79], v118, s[8:11], s26 offen sc1
    s_add_u32 s30, s30, 0x40000
    s_add_u32 s31, s31, 0x40000
    s_add_u32 s32, s32, 0x20000
    s_add_u32 s23, s24, 1024
    s_add_u32 s48, s23, 4096
    s_xor_b32 s25, s25, 0x40000
    s_xor_b32 s26, s26, 0x40000
    s_mov_b32 s35, 0x49800000
    s_add_u32 s22, s22, 1
    v_mov_b32 v32, 0
    v_mov_b32 v33, 0
    v_mov_b32 v34, 0
    v_mov_b32 v35, 0
    v_mov_b32 v36, 0
    v_mov_b32 v37, 0
    v_mov_b32 v38, 0
    v_mov_b32 v39, 0
    v_mov_b32 v40, 0
    v_mov_b32 v41, 0
    v_mov_b32 v42, 0
    v_mov_b32 v43, 0
    v_mov_b32 v44, 0
    v_mov_b32 v45, 0
    v_mov_b32 v46, 0
    v_mov_b32 v47, 0
    v_mov_b32 v48, 0
    v_mov_b32 v49, 0
    v_mov_b32 v50, 0
    v_mov_b32 v51, 0
    v_mov_b32 v52, 0
    v_mov_b32 v53, 0
    v_mov_b32 v54, 0
    v_mov_b32 v55, 0
    ds_read_b128 v[80:83], v123
    ds_read_b128 v[84:87], v123 offset:1024
    ds_read_b128 v[56:59], v123 offset:2048
    ds_read_b128 v[60:63], v123 offset:3072
    ds_read_b128 v[64:67], v123 offset:32768
    ds_read_b128 v[68:71], v123 offset:33792
    ds_read_b128 v[72:75], v123 offset:34816
    ds_read_b128 v[76:79], v123 offset:35840
    ds_read_b128 v[88:91], v123 offset:4096
    ds_read_b128 v[92:95], v123 offset:5120
    ds_read_b128 v[96:99], v123 offset:6144
    ds_read_b128 v[100:103], v123 offset:7168
    ds_read_b128 v[104:107], v123 offset:36864
    ds_read_b128 v[108:111], v123 offset:37888
    ds_read_b128 v[24:27], v123 offset:38912
    ds_read_b128 v[28:31], v123 offset:39936
    s_add_u32 s24, s24, 8192
    s_bitset0_b32 s24, 15
    s_xor_b32 s55, s24, 16384
    s_xor_b32 s29, s29, 0x40000
    s_xor_b32 s53, s29, 1024
    s_bfe_u32 s33, s22, 0x10001
    s_add_u32 s40, s22, 5
    s_lshr_b32 s40, s40, 2
    s_min_u32 s40, s40, 16
    s_bfm_b32 s58, s40, 0
    s_waitcnt vmcnt(4)
    v_cmp_eq_u32 vcc, 0, v125
    s_nop 0
    s_and_b64 vcc, vcc, s[58:59]
    s_cbranch_scc1 L_kvw_68
L_kvb_69:
    v_mov_b32 v15, 0
    s_nop 2
    v_mov_b32 v15, 0
    s_nop 2
    v_mov_b32 v15, 0
    s_nop 2
    v_mov_b32 v15, 0
    s_nop 2
    v_mov_b32 v15, 0
    s_nop 2
    v_mov_b32 v15, 0
    s_nop 2
    v_mov_b32 v15, 0
    s_nop 2
    v_mov_b32 v15, 0
    s_nop 2
    v_mov_b32 v15, 0
    s_nop 2
    v_mov_b32 v15, 0
    s_nop 2
    v_mov_b32 v15, 0
    s_nop 2
    v_mov_b32 v15, 0
    s_nop 2
    v_mov_b32 v15, 0
    s_nop 2
    v_mov_b32 v15, 0
    s_nop 2
    v_mov_b32 v15, 0
    s_nop 2
    v_mov_b32 v15, 0
    s_nop 2
    v_mov_b32 v15, 0
    s_nop 2
    v_mov_b32 v15, 0
    s_nop 2
    v_mov_b32 v15, 0
    s_nop 2
    v_mov_b32 v15, 0
    s_nop 2
    v_mov_b32 v15, 0
    s_nop 2
    v_mov_b32 v15, 0
    s_nop 2
    v_mov_b32 v15, 0
    s_nop 2
    v_mov_b32 v15, 0
    s_nop 2
    v_mov_b32 v15, 0
    s_nop 2
    v_mov_b32 v15, 0
    s_nop 2
    v_mov_b32 v15, 0
    s_nop 2
    v_mov_b32 v15, 0
    s_nop 2
    v_mov_b32 v15, 0
    s_nop 2
    v_mov_b32 v15, 0
    s_nop 2
    v_mov_b32 v15, 0
    s_nop 2
    s_waitcnt lgkmcnt(0)
    s_branch L_chain_top1_s
.p2align 6
L_chain_top2_s:
    buffer_load_dwordx4 v[0:3], v117, s[8:11], s23 offen sc1
    v_mov_b32 v48, 0
    v_mov_b32 v49, 0
    v_mov_b32 v50, 0
    v_mov_b32 v51, 0
    v_mov_b32 v52, 0
    v_mov_b32 v53, 0
    v_mov_b32 v15, 0
    v_mov_b32 v15, 0
    v_mov_b32 v15, 0
    v_mov_b32 v15, 0
    v_mov_b32 v15, 0
    v_mov_b32 v15, 0
    v_mov_b32 v15, 0
    v_mov_b32 v15, 0
    v_mov_b32 v15, 0
    v_mov_b32 v15, 0
    buffer_load_dwordx4 v[0:3], v117, s[8:11], s23 offen sc1
    s_waitcnt vmcnt(3)
    v_mov_b32 v36, 0
    v_mov_b32 v37, 0
    v_mov_b32 v38, 0
    v_mov_b32 v39, 0
    v_mov_b32 v40, 0
    v_mov_b32 v41, 0
    v_mov_b32 v42, 0
    v_mov_b32 v43, 0
    v_mov_b32 v44, 0
    v_mov_b32 v45, 0
    v_mov_b32 v46, 0
    v_mov_b32 v47, 0
    v_mov_b32 v15, 0
    v_mov_b32 v15, 0
    v_mov_b32 v15, 0
    v_mov_b32 v15, 0
L_mret_70:
    buffer_load_dwordx4 v[0:3], v117, s[8:11], s23 offen sc1
    s_add_u32 s45, s45, 1
    s_cmp_lt_u32 s45, 0x10000
    s_cselect_b32 s56, -2, -1
    s_nop 3
    v_mov_b32 v32, 0
    v_mov_b32 v33, 0
    v_mov_b32 v34, 0
    v_mov_b32 v35, 0
    s_waitcnt vmcnt(2)
    v_max3_u32 v15, v0, v1, v2
    v_max_u32 v15, v15, v3
    v_cmp_lt_u32 vcc, s56, v15
    v_smfmac_f32_16x16x64_bf16 v[32:35], v[0:3], v[80:87], v116
    s_cbranch_vccnz L_mret_70
    ds_write_b128 v117, v[0:3] offset:2048
    v_smfmac_f32_16x16x64_bf16 v[36:39], v[0:3], v[56:63], v116
    buffer_load_dwordx4 v[4:7], v117, s[8:11], s48 offen sc1
    v_smfmac_f32_16x16x64_bf16 v[40:43], v[0:3], v[64:71], v116
    buffer_load_dwordx4 v117, s[8:11], s48 offen sc1 lds
    s_mov_b32 m0, 12288
    v_smfmac_f32_16x16x64_bf16 v[44:47], v[0:3], v[72:79], v116
    s_waitcnt lgkmcnt(0)
    s_barrier
    ds_read_b128 v[8:11], v117 offset:3072
    v_smfmac_f32_16x16x64_bf16 v[48:51], v[0:3], a[192:199], v116
    ds_read_b128 v[16:19], v117
    ds_read_b128 v[20:23], v117 offset:1024
    v_smfmac_f32_16x16x64_bf16 v[52:55], v[0:3], a[200:207], v116
    ds_read_b128 v[80:83], v117 offset:14336
    s_waitcnt lgkmcnt(3)
    v_smfmac_f32_16x16x64_bf16 v[32:35], v[8:11], a[0:7], v116
    ds_read_b128 v[84:87], v117 offset:15360
    v_smfmac_f32_16x16x64_bf16 v[36:39], v[8:11], a[8:15], v116
    ds_read_b128 v[56:59], v117 offset:8192
    s_waitcnt lgkmcnt(4)
    v_smfmac_f32_16x16x64_bf16 v[32:35], v[16:19], a[32:39], v116
    ds_read_b128 v[60:63], v117 offset:9216
    v_smfmac_f32_16x16x64_bf16 v[36:39], v[16:19], a[40:47], v116
    ds_read_b128 v[64:67], v117 offset:10240
    s_waitcnt lgkmcnt(5)
    v_smfmac_f32_16x16x64_bf16 v[32:35], v[20:23], a[64:71], v116
    ds_read_b128 v[68:71], v117 offset:11264
    v_smfmac_f32_16x16x64_bf16 v[36:39], v[20:23], a[72:79], v116
    buffer_store_dwordx4 v[112:115], v117, s[8:11], s32 offen sc1
    v_smfmac_f32_16x16x64_bf16 v[40:43], v[8:11], a[96:103], v116
    ds_read_b128 v[72:75], v117 offset:12288
    v_smfmac_f32_16x16x64_bf16 v[40:43], v[16:19], a[128:135], v116
    ds_read_b128 v[76:79], v117 offset:13312
    v_smfmac_f32_16x16x64_bf16 v[40:43], v[20:23], a[160:167], v116
    s_waitcnt vmcnt(2)
    v_max3_u32 v15, v4, v5, v6
    v_smfmac_f32_16x16x64_bf16 v[44:47], v[8:11], a[104:111], v116
    v_max_u32 v15, v15, v7
    v_smfmac_f32_16x16x64_bf16 v[44:47], v[16:19], a[136:143], v116
    s_waitcnt vmcnt(1) lgkmcnt(0)
    v_cmp_lt_u32 vcc, s56, v15
    v_smfmac_f32_16x16x64_bf16 v[44:47], v[20:23], a[168:175], v116
    s_cbranch_vccnz L_mret_71
L_mgo_72:
    v_smfmac_f32_16x16x64_bf16 v[44:47], v[4:7], v[24:31], v116
    s_barrier
    ds_read_b128 v[12:15], v117 offset:7168
    v_smfmac_f32_16x16x64_bf16 v[32:35], v[4:7], v[88:95], v116
    ds_read_b128 v[24:27], v117 offset:4096
    v_smfmac_f32_16x16x64_bf16 v[36:39], v[4:7], v[96:103], v116
    ds_read_b128 v[28:31], v117 offset:5120
    v_smfmac_f32_16x16x64_bf16 v[40:43], v[4:7], v[104:111], v116
    ds_read_b128 v[88:91], v117 offset:28672
    s_waitcnt lgkmcnt(3)
    v_smfmac_f32_16x16x64_bf16 v[32:35], v[12:15], a[16:23], v116
    ds_read_b128 v[92:95], v117 offset:29696
    s_waitcnt lgkmcnt(3)
    v_smfmac_f32_16x16x64_bf16 v[32:35], v[24:27], a[48:55], v116
    buffer_load_dwordx4 v117, s[8:11], s30 offen lds
    s_waitcnt lgkmcnt(2)
    v_smfmac_f32_16x16x64_bf16 v[32:35], v[28:31], a[80:87], v116
    ds_read_b128 v[96:99], v117 offset:23552
    v_smfmac_f32_16x16x64_bf16 v[36:39], v[12:15], a[24:31], v116
    ds_read_b128 v[100:103], v117 offset:23552
    v_smfmac_f32_16x16x64_bf16 v[36:39], v[24:27], a[56:63], v116
    buffer_load_dwordx4 v117, s[8:11], s30 offen offset:1024 lds
    s_add_u32 m0, s52, 0x6000
    v_add_f32 v32, v32, v34
    v_smfmac_f32_16x16x64_bf16 v[36:39], v[28:31], a[88:95], v116
    ds_read_b128 v[104:107], v117 offset:23552
    v_add_f32 v33, v33, v35
    v_smfmac_f32_16x16x64_bf16 v[40:43], v[12:15], a[112:119], v116
    ds_read_b128 v[108:111], v117 offset:23552
    v_mul_f32 v32, s34, v32
    v_smfmac_f32_16x16x64_bf16 v[40:43], v[24:27], a[144:151], v116
    s_waitcnt lgkmcnt(4)
    buffer_load_dwordx4 v117, s[8:11], s31 offen lds
    v_mul_f32 v33, s34, v33
    v_smfmac_f32_16x16x64_bf16 v[40:43], v[28:31], a[176:183], v116
    ds_read_b128 v[0:3], v124
    v_add_f32 v36, v36, v38
    v_smfmac_f32_16x16x64_bf16 v[48:51], v[4:7], a[208:215], v116
    v_add_f32 v37, v37, v39
    v_smfmac_f32_16x16x64_bf16 v[52:55], v[4:7], a[216:223], v116
    buffer_load_dwordx4 v117, s[8:11], s31 offen offset:1024 lds
    s_mov_b32 m0, 6144
    v_mul_f32 v36, s34, v36
    v_smfmac_f32_16x16x64_bf16 v[44:47], v[12:15], a[120:127], v116
    ds_read_b128 v[4:7], v124 offset:1024
    v_mul_f32 v37, s34, v37
    v_smfmac_f32_16x16x64_bf16 v[44:47], v[24:27], a[152:159], v116
    v_cvt_pk_bf16_f32 v34, v32, v36
    v_smfmac_f32_16x16x64_bf16 v[44:47], v[28:31], a[184:191], v116
    v_cvt_pk_bf16_f32 v35, v33, v37
    v_add_f32 v40, v40, v42
    v_smfmac_f32_16x16x64_bf16 v[48:51], v[8:11], a[224:231], v116
    ds_write2_b32 v120, v34, v35 offset0:32 offset1:48
    v_add_f32 v41, v41, v43
    v_smfmac_f32_16x16x64_bf16 v[52:55], v[8:11], a[232:239], v116
    v_add_f32 v44, v44, v46
    v_add_f32 v45, v45, v47
    v_cvt_pk_bf16_f32 v113, v40, v44
    v_cvt_pk_bf16_f32 v115, v41, v45
    v_smfmac_f32_16x16x64_bf16 v[48:51], v[12:15], a[240:247], v116
    ds_write2_b32 v120, v113, v115 offset0:0 offset1:16
    v_smfmac_f32_16x16x64_bf16 v[52:55], v[12:15], a[248:255], v116
    s_cmp_eq_u32 s22, 63
    s_cbranch_scc1 L_chain_last_s
    v_smfmac_f32_16x16x64_bf16 v[48:51], v[16:19], v[128:135], v116
    buffer_store_dword v126, v119, s[8:11], s55 offen sc1
    v_smfmac_f32_16x16x64_bf16 v[48:51], v[20:23], v[160:167], v116
    v_smfmac_f32_16x16x64_bf16 v[48:51], v[24:27], v[144:151], v116
    s_waitcnt lgkmcnt(0)
    s_barrier
    v_smfmac_f32_16x16x64_bf16 v[48:51], v[28:31], v[176:183], v116
    ds_read_b128 v[32:35], v121 offset:16384
    ds_read_b128 v[36:39], v121 offset:17408
    v_smfmac_f32_16x16x64_bf16 v[52:55], v[16:19], v[136:143], v116
    ds_read_b128 v[40:43], v121 offset:18432
    ds_read_b128 v[44:47], v121 offset:19456
    v_smfmac_f32_16x16x64_bf16 v[52:55], v[20:23], v[168:175], v116
    ds_read_b128 v[8:11], v124 offset:32768
    v_add_f32 v48, v48, v50
    v_smfmac_f32_16x16x64_bf16 v[52:55], v[24:27], v[152:159], v116
    ds_read_b128 v[12:15], v124 offset:33792
    v_add_f32 v49, v49, v51
    v_smfmac_f32_16x16x64_bf16 v[52:55], v[28:31], v[184:191], v116
    s_waitcnt lgkmcnt(5)
    v_cvt_pk_bf16_f32 v112, v48, v49
    v_mfma_f32_16x16x32_bf16 v[56:59], v[56:59], v[32:35], 0
    s_waitcnt lgkmcnt(4)
    v_mov_b32 v48, s50
    v_mov_b32 v49, s50
    v_mfma_f32_16x16x32_bf16 v[56:59], v[60:63], v[36:39], v[56:59]
    ds_read_b128 v[16:19], v124 offset:2048
    s_waitcnt lgkmcnt(4)
    v_mov_b32 v50, s50
    v_mov_b32 v51, s50
    v_mfma_f32_16x16x32_bf16 v[56:59], v[64:67], v[40:43], v[56:59]
    ds_read_b128 v[20:23], v124 offset:3072
    s_waitcnt lgkmcnt(4)
    v_add_f32 v52, v52, v54
    v_mfma_f32_16x16x32_bf16 v[56:59], v[68:71], v[44:47], v[56:59]
    ds_read_b128 v[24:27], v124 offset:4096
    v_add_f32 v53, v53, v55
    v_mfma_f32_16x16x32_bf16 v[60:63], v[72:75], v[32:35], 0
    ds_read_b128 v[28:31], v124 offset:5120
    v_cvt_pk_bf16_f32 v114, v52, v53
    v_mov_b32 v53, 0
    v_mfma_f32_16x16x32_bf16 v[60:63], v[76:79], v[36:39], v[60:63]
    v_exp_f32 v56, v56
    v_mfma_f32_16x16x32_bf16 v[60:63], v[80:83], v[40:43], v[60:63]
    v_exp_f32 v57, v57
    v_mfma_f32_16x16x32_bf16 v[60:63], v[84:87], v[44:47], v[60:63]
    v_exp_f32 v58, v58
    v_mfma_f32_16x16x32_bf16 v[64:67], v[32:35], v[32:35], 0
    v_exp_f32 v59, v59
    v_cvt_pk_bf16_f32 v68, v56, v57
    v_mfma_f32_16x16x32_bf16 v[64:67], v[36:39], v[36:39], v[64:67]
    v_exp_f32 v60, v60
    v_cvt_pk_bf16_f32 v69, v58, v59
    v_mfma_f32_16x16x32_bf16 v[64:67], v[40:43], v[40:43], v[64:67]
    v_exp_f32 v61, v61
    v_mfma_f32_16x16x32_bf16 v[64:67], v[44:47], v[44:47], v[64:67]
    v_exp_f32 v62, v62
    v_exp_f32 v63, v63
    v_cvt_pk_bf16_f32 v70, v60, v61
    v_cvt_pk_bf16_f32 v71, v62, v63
    s_nop 1
    v_mfma_f32_16x16x32_bf16 v[72:75], v[88:91], v[68:71], 0
    s_nop 0
    v_exp_f32 v64, v64
    v_mfma_f32_16x16x32_bf16 v[76:79], v[92:95], v[68:71], 0
    v_exp_f32 v65, v65
    v_mfma_f32_16x16x32_bf16 v[80:83], v[48:51], v[68:71], 0
    v_cvt_pk_bf16_f32 v52, v64, v65
    s_nop 1
    v_mfma_f32_16x16x16_bf16 v[72:75], v[112:113], v[52:53], v[72:75]
    ds_read_b128 v[32:35], v124 offset:6144
    v_mfma_f32_16x16x16_bf16 v[76:79], v[114:115], v[52:53], v[76:79]
    ds_read_b128 v[36:39], v124 offset:7168
    v_mfma_f32_16x16x16_bf16 v[80:83], v[48:49], v[52:53], v[80:83]
L_norm_73:
    s_mov_b64 vcc, s[36:37]
    v_mov_b32 v122, v122
    v_mov_b32 v122, v122
    v_mov_b32 v122, v122
    v_cndmask_b32_dpp v76, v72, v76, vcc quad_perm:[2,3,2,3] row_mask:0xf bank_mask:0xf
    v_cndmask_b32_dpp v77, v73, v77, vcc quad_perm:[2,3,2,3] row_mask:0xf bank_mask:0xf
    v_cndmask_b32_dpp v78, v74, v78, vcc quad_perm:[2,3,2,3] row_mask:0xf bank_mask:0xf
    v_cndmask_b32_dpp v79, v75, v79, vcc quad_perm:[2,3,2,3] row_mask:0xf bank_mask:0xf
    v_rcp_f32_dpp v84, v80 quad_perm:[2,3,2,3] row_mask:0xf bank_mask:0xf
    s_nop 0
    v_pk_mul_f32 v[76:77], v[76:77], v[84:85] op_sel_hi:[1,0]
    v_pk_mul_f32 v[78:79], v[78:79], v[84:85] op_sel_hi:[1,0]
    v_cvt_pk_bf16_f32 v72, v76, v77
    v_cvt_pk_bf16_f32 v73, v78, v79
    ds_write_b64 v122, v[72:73] offset:21504
    v_max_f32_dpp v86, v80, v84 quad_perm:[2,3,2,3] row_mask:0xf bank_mask:0xf
    v_mov_b32_dpp v60, v72 quad_perm:[0,1,0,1] row_mask:0xf bank_mask:0xf
    v_mov_b32_dpp v61, v73 quad_perm:[0,1,0,1] row_mask:0xf bank_mask:0xf
    v_cmp_lt_f32 vcc, s35, v86
    v_mov_b32_dpp v62, v72 quad_perm:[2,3,2,3] row_mask:0xf bank_mask:0xf
    v_mov_b32_dpp v63, v73 quad_perm:[2,3,2,3] row_mask:0xf bank_mask:0xf
    s_nop 1
    v_smfmac_f32_16x16x64_bf16 v[96:99], v[60:63], v[192:199], v116
    s_cbranch_vccnz L_smax_74
    v_smfmac_f32_16x16x64_bf16 v[100:103], v[60:63], v[224:231], v116
    s_waitcnt lgkmcnt(0)
    s_barrier
    ds_read_b128 v[92:95], v127 offset:22016
    ds_read_b128 v[80:83], v127 offset:20480
    ds_read_b128 v[84:87], v127 offset:20992
    v_smfmac_f32_16x16x64_bf16 v[104:107], v[60:63], v[0:7], v116
    ds_read_b128 v[40:43], v124 offset:34816
    v_smfmac_f32_16x16x64_bf16 v[108:111], v[60:63], v[8:15], v116
    ds_read_b128 v[56:59], v124 offset:36864
    s_waitcnt lgkmcnt(4)
    v_smfmac_f32_16x16x64_bf16 v[96:99], v[92:95], v[200:207], v116
    s_waitcnt lgkmcnt(3)
    v_smfmac_f32_16x16x64_bf16 v[96:99], v[80:83], v[208:215], v116
    ds_read_b128 v[44:47], v124 offset:35840
    s_waitcnt lgkmcnt(3)
    v_smfmac_f32_16x16x64_bf16 v[96:99], v[84:87], v[216:223], v116
    ds_read_b128 v[68:71], v124 offset:39936
    v_smfmac_f32_16x16x64_bf16 v[100:103], v[92:95], v[232:239], v116
    ds_read_b128 v[64:67], v124 offset:38912
    v_smfmac_f32_16x16x64_bf16 v[100:103], v[80:83], v[240:247], v116
    ds_read_b128 v[60:63], v124 offset:37888
    v_cvt_pk_bf16_f32 v72, v96, v98
    v_smfmac_f32_16x16x64_bf16 v[100:103], v[84:87], v[248:255], v116
    v_and_or_b32 v72, v72, -2, s33
    v_smfmac_f32_16x16x64_bf16 v[104:107], v[92:95], v[16:23], v116
    v_cvt_pk_bf16_f32 v74, v97, v99
    v_smfmac_f32_16x16x64_bf16 v[104:107], v[80:83], v[24:31], v116
    v_cvt_pk_bf16_f32 v73, v100, v102
    v_cvt_pk_bf16_f32 v75, v101, v103
    v_smfmac_f32_16x16x64_bf16 v[104:107], v[84:87], v[32:39], v116
    buffer_store_dwordx4 v[72:75], v118, s[8:11], s25 offen sc1
    s_waitcnt lgkmcnt(3)
    v_smfmac_f32_16x16x64_bf16 v[108:111], v[92:95], v[40:47], v116
    s_waitcnt lgkmcnt(0)
    v_smfmac_f32_16x16x64_bf16 v[108:111], v[80:83], v[56:63], v116
    v_cvt_pk_bf16_f32 v76, v104, v106
    v_smfmac_f32_16x16x64_bf16 v[108:111], v[84:87], v[64:71], v116
    v_and_or_b32 v76, v76, -2, s33
    v_cvt_pk_bf16_f32 v78, v105, v107
    v_mov_b32 v122, v122
    v_mov_b32 v122, v122
    v_mov_b32 v122, v122
    v_mov_b32 v122, v122
    v_mov_b32 v122, v122
    v_mov_b32 v122, v122
    v_cvt_pk_bf16_f32 v77, v108, v110
    v_cvt_pk_bf16_f32 v79, v109, v111
    buffer_store_dwordx4 v[76:79], v118, s[8:11], s26 offen sc1
    ds_read_b128 v[80:83], v123
    ds_read_b128 v[84:87], v123 offset:1024
    ds_read_b128 v[56:59], v123 offset:2048
    ds_read_b128 v[60:63], v123 offset:3072
    ds_read_b128 v[64:67], v123 offset:32768
    ds_read_b128 v[68:71], v123 offset:33792
    ds_read_b128 v[72:75], v123 offset:34816
    ds_read_b128 v[76:79], v123 offset:35840
    ds_read_b128 v[88:91], v123 offset:4096
    ds_read_b128 v[92:95], v123 offset:5120
    ds_read_b128 v[96:99], v123 offset:6144
    ds_read_b128 v[100:103], v123 offset:7168
    ds_read_b128 v[104:107], v123 offset:36864
    ds_read_b128 v[108:111], v123 offset:37888
    ds_read_b128 v[24:27], v123 offset:38912
    ds_read_b128 v[28:31], v123 offset:39936
    s_add_u32 s30, s30, 0x40000
    s_add_u32 s31, s31, 0x40000
    s_add_u32 s32, s32, 0x20000
    s_add_u32 s23, s24, 2048
    s_add_u32 s48, s23, 4096
    s_xor_b32 s25, s25, 0x40000
    s_xor_b32 s26, s26, 0x40000
    s_mov_b32 s35, 0x49800000
    s_add_u32 s22, s22, 1
    v_cndmask_b32 v12, 0, v125, s[68:69]
    v_cndmask_b32 v13, 0, v125, s[70:71]
    v_cndmask_b32 v14, 0, v125, s[72:73]
    v_cndmask_b32 v15, 0, v125, s[74:75]
    v_mov_b32 v54, 0
    v_mov_b32 v55, 0
    v_mov_b32 v52, 0
    v_mov_b32 v52, 0
    v_mov_b32 v52, 0
    v_mov_b32 v52, 0
    v_mov_b32 v52, 0
    v_mov_b32 v52, 0
    v_mov_b32 v52, 0
    v_mov_b32 v52, 0
    v_mov_b32 v52, 0
    v_mov_b32 v52, 0
    v_mov_b32 v52, 0
    v_mov_b32 v52, 0
    v_mov_b32 v52, 0
    v_mov_b32 v52, 0
    v_mov_b32 v52, 0
    v_mov_b32 v52, 0
    v_mov_b32 v52, 0
    v_mov_b32 v52, 0
    v_mov_b32 v52, 0
    buffer_load_dwordx4 v[4:7], v117, s[8:11], s29 offen sc1
    buffer_load_dwordx4 v[8:11], v117, s[8:11], s53 offen sc1
    buffer_load_dwordx4 v[16:19], v117, s[8:11], s29 offen offset:2048 sc1
    buffer_load_dwordx4 v[20:23], v117, s[8:11], s53 offen offset:2048 sc1
    v_mov_b32 v52, 0
    v_mov_b32 v52, 0
    v_mov_b32 v52, 0
    v_mov_b32 v52, 0
    v_mov_b32 v52, 0
    v_mov_b32 v52, 0
    v_mov_b32 v52, 0
    v_mov_b32 v52, 0
    v_mov_b32 v52, 0
    v_mov_b32 v52, 0
    v_mov_b32 v52, 0
    v_mov_b32 v52, 0
    v_mov_b32 v52, 0
    v_mov_b32 v52, 0
    v_mov_b32 v52, 0
    v_mov_b32 v52, 0
    v_mov_b32 v52, 0
    v_mov_b32 v52, 0
    v_mov_b32 v52, 0
    v_mov_b32 v52, 0
    v_mov_b32 v52, 0
    v_mov_b32 v52, 0
    v_mov_b32 v52, 0
    v_mov_b32 v52, 0
    v_mov_b32 v52, 0
    v_mov_b32 v52, 0
    v_mov_b32 v52, 0
    v_mov_b32 v52, 0
    v_mov_b32 v52, 0
    v_mov_b32 v52, 0
    v_mov_b32 v52, 0
    v_mov_b32 v52, 0
    v_mov_b32 v52, 0
    v_mov_b32 v52, 0
    v_mov_b32 v52, 0
    v_mov_b32 v52, 0
    v_mov_b32 v52, 0
    v_mov_b32 v52, 0
    v_mov_b32 v52, 0
    v_mov_b32 v52, 0
    buffer_load_dwordx4 v[32:35], v117, s[8:11], s29 offen sc1
    buffer_load_dwordx4 v[36:39], v117, s[8:11], s53 offen sc1
    buffer_load_dwordx4 v[40:43], v117, s[8:11], s29 offen offset:2048 sc1
    buffer_load_dwordx4 v[44:47], v117, s[8:11], s53 offen offset:2048 sc1
    v_mov_b32 v52, 0
L_rl_75:
    s_waitcnt vmcnt(7)
    v_mfma_f32_16x16x32_bf16 v[48:51], v[4:7], v[12:15], 0
    v_xor_b32 v52, s33, v4
    s_waitcnt vmcnt(6)
    v_mfma_f32_16x16x32_bf16 v[48:51], v[8:11], v[12:15], v[48:51]
    v_xor_b32 v53, s33, v8
    v_or_b32 v52, v52, v53
    s_waitcnt vmcnt(5)
    v_mfma_f32_16x16x32_bf16 v[48:51], v[16:19], v[12:15], v[48:51]
    v_xor_b32 v53, s33, v16
    v_or_b32 v52, v52, v53
    s_waitcnt vmcnt(4)
    v_mfma_f32_16x16x32_bf16 v[48:51], v[20:23], v[12:15], v[48:51]
    v_xor_b32 v53, s33, v20
    v_or_b32 v52, v52, v53
    v_and_b32 v52, 1, v52
    v_cmp_ne_u32 vcc, 0, v52
    s_cbranch_vccnz L_rslow_76
L_rgo_77:
    s_nop 2
    v_permlane32_swap_b32 v48, v50
    v_permlane32_swap_b32 v49, v51
    v_pk_add_f32 v[48:49], v[48:49], v[50:51]
    s_mov_b64 exec, s[38:39]
    v_cvt_pk_bf16_f32 v12, v48, v49
    v_min_u32 v12, 0xfffffffe, v12
    buffer_store_dword v12, v119, s[8:11], s24 offen sc1
    s_mov_b64 exec, -1
    s_add_u32 s24, s24, 8192
    s_bitset0_b32 s24, 15
    s_xor_b32 s55, s24, 16384
    s_xor_b32 s29, s29, 0x40000
    s_xor_b32 s53, s29, 1024
    s_bfe_u32 s33, s22, 0x10001
    s_waitcnt lgkmcnt(0)
    s_branch L_chain_top2_s
.p2align 6
L_chain_top3_s:
    buffer_load_dwordx4 v[0:3], v117, s[8:11], s23 offen sc1
    v_mov_b32 v48, 0
    v_mov_b32 v49, 0
    v_mov_b32 v50, 0
    v_mov_b32 v51, 0
    v_mov_b32 v52, 0
    v_mov_b32 v53, 0
    v_mov_b32 v15, 0
    v_mov_b32 v15, 0
    v_mov_b32 v15, 0
    v_mov_b32 v15, 0
    v_mov_b32 v15, 0
    v_mov_b32 v15, 0
    v_mov_b32 v15, 0
    v_mov_b32 v15, 0
    v_mov_b32 v15, 0
    v_mov_b32 v15, 0
    buffer_load_dwordx4 v[0:3], v117, s[8:11], s23 offen sc1
    s_waitcnt vmcnt(3)
    v_mov_b32 v36, 0
    v_mov_b32 v37, 0
    v_mov_b32 v38, 0
    v_mov_b32 v39, 0
    v_mov_b32 v40, 0
    v_mov_b32 v41, 0
    v_mov_b32 v42, 0
    v_mov_b32 v43, 0
    v_mov_b32 v44, 0
    v_mov_b32 v45, 0
    v_mov_b32 v46, 0
    v_mov_b32 v47, 0
    v_mov_b32 v15, 0
    v_mov_b32 v15, 0
    v_mov_b32 v15, 0
    v_mov_b32 v15, 0
L_mret_78:
    buffer_load_dwordx4 v[0:3], v117, s[8:11], s23 offen sc1
    s_add_u32 s45, s45, 1
    s_cmp_lt_u32 s45, 0x10000
    s_cselect_b32 s56, -2, -1
    s_nop 3
    v_mov_b32 v32, 0
    v_mov_b32 v33, 0
    v_mov_b32 v34, 0
    v_mov_b32 v35, 0
    s_waitcnt vmcnt(2)
    v_max3_u32 v15, v0, v1, v2
    v_max_u32 v15, v15, v3
    v_cmp_lt_u32 vcc, s56, v15
    v_smfmac_f32_16x16x64_bf16 v[32:35], v[0:3], v[80:87], v116
    s_cbranch_vccnz L_mret_78
    ds_write_b128 v117, v[0:3] offset:3072
    v_smfmac_f32_16x16x64_bf16 v[36:39], v[0:3], v[56:63], v116
    buffer_load_dwordx4 v[4:7], v117, s[8:11], s48 offen sc1
    v_smfmac_f32_16x16x64_bf16 v[40:43], v[0:3], v[64:71], v116
    buffer_load_dwordx4 v117, s[8:11], s48 offen sc1 lds
    s_mov_b32 m0, 14336
    v_smfmac_f32_16x16x64_bf16 v[44:47], v[0:3], v[72:79], v116
    s_waitcnt lgkmcnt(0)
    s_barrier
    ds_read_b128 v[8:11], v117 offset:2048
    v_smfmac_f32_16x16x64_bf16 v[48:51], v[0:3], a[192:199], v116
    ds_read_b128 v[16:19], v117 offset:1024
    ds_read_b128 v[20:23], v117
    v_smfmac_f32_16x16x64_bf16 v[52:55], v[0:3], a[200:207], v116
    ds_read_b128 v[80:83], v117 offset:14336
    s_waitcnt lgkmcnt(3)
    v_smfmac_f32_16x16x64_bf16 v[32:35], v[8:11], a[0:7], v116
    ds_read_b128 v[84:87], v117 offset:15360
    v_smfmac_f32_16x16x64_bf16 v[36:39], v[8:11], a[8:15], v116
    ds_read_b128 v[56:59], v117 offset:8192
    s_waitcnt lgkmcnt(4)
    v_smfmac_f32_16x16x64_bf16 v[32:35], v[16:19], a[32:39], v116
    ds_read_b128 v[60:63], v117 offset:9216
    v_smfmac_f32_16x16x64_bf16 v[36:39], v[16:19], a[40:47], v116
    ds_read_b128 v[64:67], v117 offset:10240
    s_waitcnt lgkmcnt(5)
    v_smfmac_f32_16x16x64_bf16 v[32:35], v[20:23], a[64:71], v116
    ds_read_b128 v[68:71], v117 offset:11264
    v_smfmac_f32_16x16x64_bf16 v[36:39], v[20:23], a[72:79], v116
    ds_read_b128 v[72:75], v117 offset:12288
    v_smfmac_f32_16x16x64_bf16 v[40:43], v[8:11], a[96:103], v116
    ds_read_b128 v[76:79], v117 offset:13312
    v_smfmac_f32_16x16x64_bf16 v[40:43], v[16:19], a[128:135], v116
    buffer_store_dwordx4 v[112:115], v117, s[8:11], s32 offen sc1
    v_smfmac_f32_16x16x64_bf16 v[40:43], v[20:23], a[160:167], v116
    s_waitcnt vmcnt(2)
    v_max3_u32 v15, v4, v5, v6
    v_smfmac_f32_16x16x64_bf16 v[44:47], v[8:11], a[104:111], v116
    v_max_u32 v15, v15, v7
    v_smfmac_f32_16x16x64_bf16 v[44:47], v[16:19], a[136:143], v116
    s_waitcnt vmcnt(1) lgkmcnt(0)
    v_cmp_lt_u32 vcc, s56, v15
    v_smfmac_f32_16x16x64_bf16 v[44:47], v[20:23], a[168:175], v116
    s_cbranch_vccnz L_mret_79
L_mgo_80:
    v_smfmac_f32_16x16x64_bf16 v[44:47], v[4:7], v[24:31], v116
    s_barrier
    ds_read_b128 v[12:15], v117 offset:6144
    v_smfmac_f32_16x16x64_bf16 v[32:35], v[4:7], v[88:95], v116
    ds_read_b128 v[24:27], v117 offset:5120
    v_smfmac_f32_16x16x64_bf16 v[36:39], v[4:7], v[96:103], v116
    ds_read_b128 v[28:31], v117 offset:4096
    v_smfmac_f32_16x16x64_bf16 v[40:43], v[4:7], v[104:111], v116
    ds_read_b128 v[88:91], v117 offset:30720
    s_waitcnt lgkmcnt(3)
    v_smfmac_f32_16x16x64_bf16 v[32:35], v[12:15], a[16:23], v116
    ds_read_b128 v[92:95], v117 offset:31744
    s_waitcnt lgkmcnt(3)
    v_smfmac_f32_16x16x64_bf16 v[32:35], v[24:27], a[48:55], v116
    ds_read_b128 v[96:99], v117 offset:23552
    s_waitcnt lgkmcnt(3)
    v_smfmac_f32_16x16x64_bf16 v[32:35], v[28:31], a[80:87], v116
    buffer_load_dwordx4 v117, s[8:11], s30 offen lds
    v_smfmac_f32_16x16x64_bf16 v[36:39], v[12:15], a[24:31], v116
    ds_read_b128 v[100:103], v117 offset:23552
    v_smfmac_f32_16x16x64_bf16 v[36:39], v[24:27], a[56:63], v116
    ds_read_b128 v[104:107], v117 offset:23552
    v_add_f32 v32, v32, v34
    v_smfmac_f32_16x16x64_bf16 v[36:39], v[28:31], a[88:95], v116
    buffer_load_dwordx4 v117, s[8:11], s30 offen offset:1024 lds
    s_add_u32 m0, s52, 0x6000
    v_add_f32 v33, v33, v35
    v_smfmac_f32_16x16x64_bf16 v[40:43], v[12:15], a[112:119], v116
    ds_read_b128 v[108:111], v117 offset:23552
    v_mul_f32 v32, s34, v32
    v_smfmac_f32_16x16x64_bf16 v[40:43], v[24:27], a[144:151], v116
    ds_read_b128 v[0:3], v124
    v_mul_f32 v33, s34, v33
    v_smfmac_f32_16x16x64_bf16 v[40:43], v[28:31], a[176:183], v116
    s_waitcnt lgkmcnt(5)
    buffer_load_dwordx4 v117, s[8:11], s31 offen lds
    v_add_f32 v36, v36, v38
    v_smfmac_f32_16x16x64_bf16 v[48:51], v[4:7], a[208:215], v116
    v_add_f32 v37, v37, v39
    v_smfmac_f32_16x16x64_bf16 v[52:55], v[4:7], a[216:223], v116
    ds_read_b128 v[4:7], v124 offset:1024
    v_mul_f32 v36, s34, v36
    v_smfmac_f32_16x16x64_bf16 v[44:47], v[12:15], a[120:127], v116
    buffer_load_dwordx4 v117, s[8:11], s31 offen offset:1024 lds
    s_mov_b32 m0, 7168
    v_mul_f32 v37, s34, v37
    v_smfmac_f32_16x16x64_bf16 v[44:47], v[24:27], a[152:159], v116
    v_cvt_pk_bf16_f32 v34, v32, v36
    v_smfmac_f32_16x16x64_bf16 v[44:47], v[28:31], a[184:191], v116
    v_cvt_pk_bf16_f32 v35, v33, v37
    v_add_f32 v40, v40, v42
    v_smfmac_f32_16x16x64_bf16 v[48:51], v[8:11], a[224:231], v116
    ds_write2_b32 v120, v34, v35 offset0:32 offset1:48
    v_add_f32 v41, v41, v43
    v_smfmac_f32_16x16x64_bf16 v[52:55], v[8:11], a[232:239], v116
    v_add_f32 v44, v44, v46
    v_add_f32 v45, v45, v47
    v_cvt_pk_bf16_f32 v113, v40, v44
    v_cvt_pk_bf16_f32 v115, v41, v45
    v_smfmac_f32_16x16x64_bf16 v[48:51], v[12:15], a[240:247], v116
    ds_write2_b32 v120, v113, v115 offset0:0 offset1:16
    v_smfmac_f32_16x16x64_bf16 v[52:55], v[12:15], a[248:255], v116
    s_cmp_eq_u32 s22, 63
    s_cbranch_scc1 L_chain_last_s
    v_smfmac_f32_16x16x64_bf16 v[48:51], v[16:19], v[128:135], v116
    v_smfmac_f32_16x16x64_bf16 v[48:51], v[20:23], v[160:167], v116
    buffer_store_dword v126, v119, s[8:11], s55 offen sc1
    v_smfmac_f32_16x16x64_bf16 v[48:51], v[24:27], v[144:151], v116
    s_waitcnt lgkmcnt(0)
    s_barrier
    v_smfmac_f32_16x16x64_bf16 v[48:51], v[28:31], v[176:183], v116
    ds_read_b128 v[32:35], v121 offset:16384
    ds_read_b128 v[36:39], v121 offset:17408
    v_smfmac_f32_16x16x64_bf16 v[52:55], v[16:19], v[136:143], v116
    ds_read_b128 v[40:43], v121 offset:18432
    ds_read_b128 v[44:47], v121 offset:19456
    v_smfmac_f32_16x16x64_bf16 v[52:55], v[20:23], v[168:175], v116
    ds_read_b128 v[8:11], v124 offset:32768
    v_add_f32 v48, v48, v50
    v_smfmac_f32_16x16x64_bf16 v[52:55], v[24:27], v[152:159], v116
    ds_read_b128 v[12:15], v124 offset:33792
    v_add_f32 v49, v49, v51
    v_smfmac_f32_16x16x64_bf16 v[52:55], v[28:31], v[184:191], v116
    s_waitcnt lgkmcnt(5)
    v_cvt_pk_bf16_f32 v112, v48, v49
    v_mfma_f32_16x16x32_bf16 v[56:59], v[56:59], v[32:35], 0
    s_waitcnt lgkmcnt(4)
    v_mov_b32 v48, s50
    v_mov_b32 v49, s50
    v_mfma_f32_16x16x32_bf16 v[56:59], v[60:63], v[36:39], v[56:59]
    ds_read_b128 v[16:19], v124 offset:2048
    s_waitcnt lgkmcnt(4)
    v_mov_b32 v50, s50
    v_mov_b32 v51, s50
    v_mfma_f32_16x16x32_bf16 v[56:59], v[64:67], v[40:43], v[56:59]
    ds_read_b128 v[20:23], v124 offset:3072
    s_waitcnt lgkmcnt(4)
    v_add_f32 v52, v52, v54
    v_mfma_f32_16x16x32_bf16 v[56:59], v[68:71], v[44:47], v[56:59]
    ds_read_b128 v[24:27], v124 offset:4096
    v_add_f32 v53, v53, v55
    v_mfma_f32_16x16x32_bf16 v[60:63], v[72:75], v[32:35], 0
    ds_read_b128 v[28:31], v124 offset:5120
    v_cvt_pk_bf16_f32 v114, v52, v53
    v_mov_b32 v53, 0
    v_mfma_f32_16x16x32_bf16 v[60:63], v[76:79], v[36:39], v[60:63]
    v_exp_f32 v56, v56
    v_mfma_f32_16x16x32_bf16 v[60:63], v[80:83], v[40:43], v[60:63]
    v_exp_f32 v57, v57
    v_mfma_f32_16x16x32_bf16 v[60:63], v[84:87], v[44:47], v[60:63]
    v_exp_f32 v58, v58
    v_mfma_f32_16x16x32_bf16 v[64:67], v[32:35], v[32:35], 0
    v_exp_f32 v59, v59
    v_cvt_pk_bf16_f32 v68, v56, v57
    v_mfma_f32_16x16x32_bf16 v[64:67], v[36:39], v[36:39], v[64:67]
    v_exp_f32 v60, v60
    v_cvt_pk_bf16_f32 v69, v58, v59
    v_mfma_f32_16x16x32_bf16 v[64:67], v[40:43], v[40:43], v[64:67]
    v_exp_f32 v61, v61
    v_mfma_f32_16x16x32_bf16 v[64:67], v[44:47], v[44:47], v[64:67]
    v_exp_f32 v62, v62
    v_exp_f32 v63, v63
    v_cvt_pk_bf16_f32 v70, v60, v61
    v_cvt_pk_bf16_f32 v71, v62, v63
    s_nop 1
    v_mfma_f32_16x16x32_bf16 v[72:75], v[88:91], v[68:71], 0
    s_nop 0
    v_exp_f32 v64, v64
    v_mfma_f32_16x16x32_bf16 v[76:79], v[92:95], v[68:71], 0
    v_exp_f32 v65, v65
    v_mfma_f32_16x16x32_bf16 v[80:83], v[48:51], v[68:71], 0
    v_cvt_pk_bf16_f32 v52, v64, v65
    s_nop 1
    v_mfma_f32_16x16x16_bf16 v[72:75], v[112:113], v[52:53], v[72:75]
    ds_read_b128 v[32:35], v124 offset:6144
    v_mfma_f32_16x16x16_bf16 v[76:79], v[114:115], v[52:53], v[76:79]
    ds_read_b128 v[36:39], v124 offset:7168
    v_mfma_f32_16x16x16_bf16 v[80:83], v[48:49], v[52:53], v[80:83]
L_norm_81:
    s_mov_b64 vcc, s[36:37]
    v_mov_b32 v122, v122
    v_mov_b32 v122, v122
    v_mov_b32 v122, v122
    v_cndmask_b32_dpp v76, v72, v76, vcc quad_perm:[2,3,2,3] row_mask:0xf bank_mask:0xf
    v_cndmask_b32_dpp v77, v73, v77, vcc quad_perm:[2,3,2,3] row_mask:0xf bank_mask:0xf
    v_cndmask_b32_dpp v78, v74, v78, vcc quad_perm:[2,3,2,3] row_mask:0xf bank_mask:0xf
    v_cndmask_b32_dpp v79, v75, v79, vcc quad_perm:[2,3,2,3] row_mask:0xf bank_mask:0xf
    v_rcp_f32_dpp v84, v80 quad_perm:[2,3,2,3] row_mask:0xf bank_mask:0xf
    s_nop 0
    v_pk_mul_f32 v[76:77], v[76:77], v[84:85] op_sel_hi:[1,0]
    v_pk_mul_f32 v[78:79], v[78:79], v[84:85] op_sel_hi:[1,0]
    v_cvt_pk_bf16_f32 v72, v76, v77
    v_cvt_pk_bf16_f32 v73, v78, v79
    ds_write_b64 v122, v[72:73] offset:22016
    v_max_f32_dpp v86, v80, v84 quad_perm:[2,3,2,3] row_mask:0xf bank_mask:0xf
    v_mov_b32_dpp v60, v72 quad_perm:[0,1,0,1] row_mask:0xf bank_mask:0xf
    v_mov_b32_dpp v61, v73 quad_perm:[0,1,0,1] row_mask:0xf bank_mask:0xf
    v_cmp_lt_f32 vcc, s35, v86
    v_mov_b32_dpp v62, v72 quad_perm:[2,3,2,3] row_mask:0xf bank_mask:0xf
    v_mov_b32_dpp v63, v73 quad_perm:[2,3,2,3] row_mask:0xf bank_mask:0xf
    s_nop 1
    v_smfmac_f32_16x16x64_bf16 v[96:99], v[60:63], v[192:199], v116
    s_cbranch_vccnz L_smax_82
    v_smfmac_f32_16x16x64_bf16 v[100:103], v[60:63], v[224:231], v116
    s_waitcnt lgkmcnt(0)
    s_barrier
    ds_read_b128 v[92:95], v127 offset:21504
    ds_read_b128 v[80:83], v127 offset:20992
    ds_read_b128 v[84:87], v127 offset:20480
    v_smfmac_f32_16x16x64_bf16 v[104:107], v[60:63], v[0:7], v116
    ds_read_b128 v[40:43], v124 offset:34816
    v_smfmac_f32_16x16x64_bf16 v[108:111], v[60:63], v[8:15], v116
    ds_read_b128 v[56:59], v124 offset:36864
    s_waitcnt lgkmcnt(4)
    v_smfmac_f32_16x16x64_bf16 v[96:99], v[92:95], v[200:207], v116
    s_waitcnt lgkmcnt(3)
    v_smfmac_f32_16x16x64_bf16 v[96:99], v[80:83], v[208:215], v116
    ds_read_b128 v[44:47], v124 offset:35840
    s_waitcnt lgkmcnt(3)
    v_smfmac_f32_16x16x64_bf16 v[96:99], v[84:87], v[216:223], v116
    ds_read_b128 v[68:71], v124 offset:39936
    v_smfmac_f32_16x16x64_bf16 v[100:103], v[92:95], v[232:239], v116
    ds_read_b128 v[64:67], v124 offset:38912
    v_smfmac_f32_16x16x64_bf16 v[100:103], v[80:83], v[240:247], v116
    ds_read_b128 v[60:63], v124 offset:37888
    v_cvt_pk_bf16_f32 v72, v96, v98
    v_smfmac_f32_16x16x64_bf16 v[100:103], v[84:87], v[248:255], v116
    v_and_or_b32 v72, v72, -2, s33
    v_smfmac_f32_16x16x64_bf16 v[104:107], v[92:95], v[16:23], v116
    v_cvt_pk_bf16_f32 v74, v97, v99
    v_smfmac_f32_16x16x64_bf16 v[104:107], v[80:83], v[24:31], v116
    v_cvt_pk_bf16_f32 v73, v100, v102
    v_cvt_pk_bf16_f32 v75, v101, v103
    v_smfmac_f32_16x16x64_bf16 v[104:107], v[84:87], v[32:39], v116
    buffer_store_dwordx4 v[72:75], v118, s[8:11], s25 offen sc1
    s_waitcnt lgkmcnt(3)
    v_smfmac_f32_16x16x64_bf16 v[108:111], v[92:95], v[40:47], v116
    s_waitcnt lgkmcnt(0)
    v_smfmac_f32_16x16x64_bf16 v[108:111], v[80:83], v[56:63], v116
    v_cvt_pk_bf16_f32 v76, v104, v106
    v_smfmac_f32_16x16x64_bf16 v[108:111], v[84:87], v[64:71], v116
    v_and_or_b32 v76, v76, -2, s33
    v_cvt_pk_bf16_f32 v78, v105, v107
    v_mov_b32 v122, v122
    v_mov_b32 v122, v122
    v_mov_b32 v122, v122
    v_mov_b32 v122, v122
    v_mov_b32 v122, v122
    v_mov_b32 v122, v122
    v_cvt_pk_bf16_f32 v77, v108, v110
    v_cvt_pk_bf16_f32 v79, v109, v111
    buffer_store_dwordx4 v[76:79], v118, s[8:11], s26 offen sc1
    ds_read_b128 v[80:83], v123
    ds_read_b128 v[84:87], v123 offset:1024
    ds_read_b128 v[56:59], v123 offset:2048
    ds_read_b128 v[60:63], v123 offset:3072
    ds_read_b128 v[64:67], v123 offset:32768
    ds_read_b128 v[68:71], v123 offset:33792
    ds_read_b128 v[72:75], v123 offset:34816
    ds_read_b128 v[76:79], v123 offset:35840
    ds_read_b128 v[88:91], v123 offset:4096
    ds_read_b128 v[92:95], v123 offset:5120
    ds_read_b128 v[96:99], v123 offset:6144
    ds_read_b128 v[100:103], v123 offset:7168
    ds_read_b128 v[104:107], v123 offset:36864
    ds_read_b128 v[108:111], v123 offset:37888
    ds_read_b128 v[24:27], v123 offset:38912
    ds_read_b128 v[28:31], v123 offset:39936
    s_add_u32 s30, s30, 0x40000
    s_add_u32 s31, s31, 0x40000
    s_add_u32 s32, s32, 0x20000
    s_add_u32 s23, s24, 3072
    s_add_u32 s48, s23, 4096
    s_xor_b32 s25, s25, 0x40000
    s_xor_b32 s26, s26, 0x40000
    s_mov_b32 s35, 0x49800000
    s_add_u32 s22, s22, 1
    v_cndmask_b32 v12, 0, v125, s[68:69]
    v_cndmask_b32 v13, 0, v125, s[70:71]
    v_cndmask_b32 v14, 0, v125, s[72:73]
    v_cndmask_b32 v15, 0, v125, s[74:75]
    v_mov_b32 v54, 0
    v_mov_b32 v55, 0
    v_mov_b32 v52, 0
    v_mov_b32 v52, 0
    v_mov_b32 v52, 0
    v_mov_b32 v52, 0
    v_mov_b32 v52, 0
    v_mov_b32 v52, 0
    v_mov_b32 v52, 0
    v_mov_b32 v52, 0
    v_mov_b32 v52, 0
    v_mov_b32 v52, 0
    v_mov_b32 v52, 0
    v_mov_b32 v52, 0
    v_mov_b32 v52, 0
    v_mov_b32 v52, 0
    v_mov_b32 v52, 0
    v_mov_b32 v52, 0
    v_mov_b32 v52, 0
    v_mov_b32 v52, 0
    v_mov_b32 v52, 0
    v_mov_b32 v52, 0
    v_mov_b32 v52, 0
    v_mov_b32 v52, 0
    v_mov_b32 v52, 0
    v_mov_b32 v52, 0
    v_mov_b32 v52, 0
    v_mov_b32 v52, 0
    v_mov_b32 v52, 0
    v_mov_b32 v52, 0
    v_mov_b32 v52, 0
    v_mov_b32 v52, 0
    v_mov_b32 v52, 0
    v_mov_b32 v52, 0
    v_mov_b32 v52, 0
    v_mov_b32 v52, 0
    v_mov_b32 v52, 0
    v_mov_b32 v52, 0
    v_mov_b32 v52, 0
    v_mov_b32 v52, 0
    v_mov_b32 v52, 0
    v_mov_b32 v52, 0
    v_mov_b32 v52, 0
    v_mov_b32 v52, 0
    v_mov_b32 v52, 0
    v_mov_b32 v52, 0
    v_mov_b32 v52, 0
    v_mov_b32 v52, 0
    v_mov_b32 v52, 0
    v_mov_b32 v52, 0
    v_mov_b32 v52, 0
    buffer_load_dwordx4 v[4:7], v117, s[8:11], s29 offen sc1
    buffer_load_dwordx4 v[8:11], v117, s[8:11], s53 offen sc1
    buffer_load_dwordx4 v[16:19], v117, s[8:11], s29 offen offset:2048 sc1
    buffer_load_dwordx4 v[20:23], v117, s[8:11], s53 offen offset:2048 sc1
    v_mov_b32 v52, 0
    v_mov_b32 v52, 0
    v_mov_b32 v52, 0
    v_mov_b32 v52, 0
    v_mov_b32 v52, 0
    v_mov_b32 v52, 0
    v_mov_b32 v52, 0
    v_mov_b32 v52, 0
    v_mov_b32 v52, 0
    v_mov_b32 v52, 0
    v_mov_b32 v52, 0
    v_mov_b32 v52, 0
    v_mov_b32 v52, 0
    v_mov_b32 v52, 0
    v_mov_b32 v52, 0
    v_mov_b32 v52, 0
    v_mov_b32 v52, 0
    v_mov_b32 v52, 0
    v_mov_b32 v52, 0
    v_mov_b32 v52, 0
    v_mov_b32 v52, 0
    v_mov_b32 v52, 0
    v_mov_b32 v52, 0
    v_mov_b32 v52, 0
    v_mov_b32 v52, 0
    v_mov_b32 v52, 0
    v_mov_b32 v52, 0
    v_mov_b32 v52, 0
    v_mov_b32 v52, 0
    v_mov_b32 v52, 0
    buffer_load_dwordx4 v[32:35], v117, s[8:11], s29 offen sc1
    buffer_load_dwordx4 v[36:39], v117, s[8:11], s53 offen sc1
    buffer_load_dwordx4 v[40:43], v117, s[8:11], s29 offen offset:2048 sc1
    buffer_load_dwordx4 v[44:47], v117, s[8:11], s53 offen offset:2048 sc1
    v_mov_b32 v52, 0
L_rl_83:
    s_waitcnt vmcnt(7)
    v_mfma_f32_16x16x32_bf16 v[48:51], v[4:7], v[12:15], 0
    v_xor_b32 v52, s33, v4
    s_waitcnt vmcnt(6)
    v_mfma_f32_16x16x32_bf16 v[48:51], v[8:11], v[12:15], v[48:51]
    v_xor_b32 v53, s33, v8
    v_or_b32 v52, v52, v53
    s_waitcnt vmcnt(5)
    v_mfma_f32_16x16x32_bf16 v[48:51], v[16:19], v[12:15], v[48:51]
    v_xor_b32 v53, s33, v16
    v_or_b32 v52, v52, v53
    s_waitcnt vmcnt(4)
    v_mfma_f32_16x16x32_bf16 v[48:51], v[20:23], v[12:15], v[48:51]
    v_xor_b32 v53, s33, v20
    v_or_b32 v52, v52, v53
    v_and_b32 v52, 1, v52
    v_cmp_ne_u32 vcc, 0, v52
    s_cbranch_vccnz L_rslow_84
L_rgo_85:
    s_nop 2
    v_permlane32_swap_b32 v48, v50
    v_permlane32_swap_b32 v49, v51
    v_pk_add_f32 v[48:49], v[48:49], v[50:51]
    s_mov_b64 exec, s[38:39]
    v_cvt_pk_bf16_f32 v12, v48, v49
    v_min_u32 v12, 0xfffffffe, v12
    buffer_store_dword v12, v119, s[8:11], s24 offen sc1
    s_mov_b64 exec, -1
    s_add_u32 s24, s24, 8192
    s_bitset0_b32 s24, 15
    s_xor_b32 s55, s24, 16384
    s_xor_b32 s29, s29, 0x40000
    s_xor_b32 s53, s29, 1024
    s_bfe_u32 s33, s22, 0x10001
    s_waitcnt lgkmcnt(0)
    s_branch L_chain_top3_s
L_chain_last_s:
    s_nop 1
    v_smfmac_f32_16x16x64_bf16 v[48:51], v[16:19], v[128:135], v116
    v_smfmac_f32_16x16x64_bf16 v[48:51], v[20:23], v[160:167], v116
    v_smfmac_f32_16x16x64_bf16 v[48:51], v[24:27], v[144:151], v116
    v_smfmac_f32_16x16x64_bf16 v[48:51], v[28:31], v[176:183], v116
    v_smfmac_f32_16x16x64_bf16 v[52:55], v[16:19], v[136:143], v116
    v_smfmac_f32_16x16x64_bf16 v[52:55], v[20:23], v[168:175], v116
    v_smfmac_f32_16x16x64_bf16 v[52:55], v[24:27], v[152:159], v116
    v_smfmac_f32_16x16x64_bf16 v[52:55], v[28:31], v[184:191], v116
    v_add_f32 v48, v48, v50
    v_add_f32 v49, v49, v51
    v_cvt_pk_bf16_f32 v112, v48, v49
    s_nop 4
    v_add_f32 v52, v52, v54
    v_add_f32 v53, v53, v55
    v_cvt_pk_bf16_f32 v114, v52, v53
    s_add_u32 s32, s32, 0x20000
    buffer_store_dwordx4 v[112:115], v117, s[8:11], s32 offen sc1
    v_mov_b32 v94, 64
    s_waitcnt vmcnt(0) lgkmcnt(0)
    s_barrier
    s_mov_b64 exec, 1
    buffer_store_dword v94, off, s[8:11], s44 sc1
    s_mov_b64 exec, -1
    s_endpgm
L_mret_57:
    s_mov_b32 s43, m0
    s_mov_b32 m0, 4096
    buffer_load_dwordx4 v[4:7], v117, s[8:11], s48 offen sc1
    buffer_load_dwordx4 v117, s[8:11], s48 offen sc1 lds
    s_mov_b32 m0, 8192
    s_mov_b32 m0, s43
    s_waitcnt vmcnt(0)
    v_max3_u32 v15, v4, v5, v6
    v_max_u32 v15, v15, v7
    v_cmp_lt_u32 vcc, s56, v15
    s_add_u32 s47, s47, 1
    s_add_u32 s49, s49, 1
    s_cmp_ge_u32 s49, 0x10000
    s_cbranch_scc1 L_mgo_58
    s_cbranch_vccnz L_mret_57
    s_branch L_mgo_58
L_smax_60:
    s_add_u32 s47, s47, 1
    s_mov_b32 s35, 0x7f800000
    s_waitcnt lgkmcnt(0)
    s_sub_u32 s43, s30, 0x40000
    s_add_u32 s40, s43, 4096
    s_nop 7
    buffer_load_dwordx4 v[56:59], v117, s[8:11], s43 offen
    buffer_load_dwordx4 v[60:63], v117, s[8:11], s43 offen offset:1024
    buffer_load_dwordx4 v[64:67], v117, s[8:11], s43 offen offset:2048
    buffer_load_dwordx4 v[68:71], v117, s[8:11], s43 offen offset:3072
    buffer_load_dwordx4 v[72:75], v117, s[8:11], s40 offen
    buffer_load_dwordx4 v[76:79], v117, s[8:11], s40 offen offset:1024
    buffer_load_dwordx4 v[80:83], v117, s[8:11], s40 offen offset:2048
    buffer_load_dwordx4 v[84:87], v117, s[8:11], s40 offen offset:3072
    ds_read_b128 v[32:35], v121 offset:16384
    ds_read_b128 v[36:39], v121 offset:17408
    ds_read_b128 v[40:43], v121 offset:18432
    ds_read_b128 v[44:47], v121 offset:19456
    v_mov_b32 v96, 0
    v_mov_b32 v97, 0
    v_mov_b32 v98, 0
    v_mov_b32 v99, 0
    v_mov_b32 v100, 0
    v_mov_b32 v101, 0
    v_mov_b32 v102, 0
    v_mov_b32 v103, 0
    v_mov_b32 v104, 0
    v_mov_b32 v105, 0
    v_mov_b32 v106, 0
    v_mov_b32 v107, 0
    v_mov_b32 v108, 0
    v_mov_b32 v109, 0
    v_mov_b32 v110, 0
    v_mov_b32 v111, 0
    s_waitcnt vmcnt(0) lgkmcnt(0)
    v_mfma_f32_16x16x32_bf16 v[56:59], v[56:59], v[32:35], 0
    v_mfma_f32_16x16x32_bf16 v[56:59], v[60:63], v[36:39], v[56:59]
    v_mfma_f32_16x16x32_bf16 v[56:59], v[64:67], v[40:43], v[56:59]
    v_mfma_f32_16x16x32_bf16 v[56:59], v[68:71], v[44:47], v[56:59]
    v_mfma_f32_16x16x32_bf16 v[60:63], v[72:75], v[32:35], 0
    v_mfma_f32_16x16x32_bf16 v[60:63], v[76:79], v[36:39], v[60:63]
    v_mfma_f32_16x16x32_bf16 v[60:63], v[80:83], v[40:43], v[60:63]
    v_mfma_f32_16x16x32_bf16 v[60:63], v[84:87], v[44:47], v[60:63]
    v_mfma_f32_16x16x32_bf16 v[64:67], v[32:35], v[32:35], 0
    v_mfma_f32_16x16x32_bf16 v[64:67], v[36:39], v[36:39], v[64:67]
    v_mfma_f32_16x16x32_bf16 v[64:67], v[40:43], v[40:43], v[64:67]
    v_mfma_f32_16x16x32_bf16 v[64:67], v[44:47], v[44:47], v[64:67]
    v_max3_f32 v84, v56, v57, v58
    v_max3_f32 v84, v84, v59, v60
    v_max3_f32 v84, v84, v61, v62
    s_nop 4
    v_max3_f32 v84, v84, v63, v64
    v_max_f32 v84, v84, v65
    v_mov_b32 v85, v84
    s_nop 1
    v_permlane32_swap_b32 v85, v84
    v_max_f32 v84, v85, v84
    v_mov_b32 v85, v84
    s_nop 1
    v_permlane16_swap_b32 v85, v84
    v_max_f32 v84, v85, v84
    v_sub_f32 v56, v56, v84
    v_sub_f32 v57, v57, v84
    v_sub_f32 v58, v58, v84
    v_sub_f32 v59, v59, v84
    v_sub_f32 v60, v60, v84
    v_sub_f32 v61, v61, v84
    v_sub_f32 v62, v62, v84
    v_sub_f32 v63, v63, v84
    v_sub_f32 v64, v64, v84
    v_sub_f32 v65, v65, v84
    v_exp_f32 v56, v56
    v_exp_f32 v57, v57
    v_exp_f32 v58, v58
    v_exp_f32 v59, v59
    v_exp_f32 v60, v60
    v_exp_f32 v61, v61
    v_exp_f32 v62, v62
    v_exp_f32 v63, v63
    v_exp_f32 v64, v64
    v_exp_f32 v65, v65
    v_cvt_pk_bf16_f32 v68, v56, v57
    v_cvt_pk_bf16_f32 v69, v58, v59
    v_cvt_pk_bf16_f32 v70, v60, v61
    v_cvt_pk_bf16_f32 v71, v62, v63
    v_cvt_pk_bf16_f32 v52, v64, v65
    s_nop 0
    v_mfma_f32_16x16x32_bf16 v[72:75], v[88:91], v[68:71], 0
    v_mfma_f32_16x16x32_bf16 v[76:79], v[92:95], v[68:71], 0
    v_mfma_f32_16x16x32_bf16 v[80:83], v[48:51], v[68:71], 0
    v_mfma_f32_16x16x16_bf16 v[72:75], v[112:113], v[52:53], v[72:75]
    v_mfma_f32_16x16x16_bf16 v[76:79], v[114:115], v[52:53], v[76:79]
    v_mfma_f32_16x16x16_bf16 v[80:83], v[48:49], v[52:53], v[80:83]
    ds_read_b128 v[32:35], v124 offset:6144
    ds_read_b128 v[36:39], v124 offset:7168
    ds_read_b128 v[40:43], v124 offset:34816
    ds_read_b128 v[44:47], v124 offset:35840
    ds_read_b128 v[56:59], v124 offset:36864
    ds_read_b128 v[64:67], v124 offset:38912
    ds_read_b128 v[68:71], v124 offset:39936
    s_waitcnt lgkmcnt(0)
    s_branch L_norm_59
L_kvw_61:
    s_add_u32 s47, s47, 1
    s_add_u32 s49, s49, 1
    s_cmp_ge_u32 s49, 0x10000
    s_cbranch_scc1 L_kvb_62
    s_sleep 4
    buffer_load_dword v125, v119, s[8:11], s28 offen sc1
    s_waitcnt vmcnt(0)
    v_cmp_eq_u32 vcc, 0, v125
    s_nop 0
    s_and_b64 vcc, vcc, s[58:59]
    s_cbranch_scc1 L_kvw_61
    s_branch L_kvb_62
L_mret_64:
    s_mov_b32 s43, m0
    s_mov_b32 m0, 5120
    buffer_load_dwordx4 v[4:7], v117, s[8:11], s48 offen sc1
    buffer_load_dwordx4 v117, s[8:11], s48 offen sc1 lds
    s_mov_b32 m0, 10240
    s_mov_b32 m0, s43
    s_waitcnt vmcnt(0)
    v_max3_u32 v15, v4, v5, v6
    v_max_u32 v15, v15, v7
    v_cmp_lt_u32 vcc, s56, v15
    s_add_u32 s47, s47, 1
    s_add_u32 s49, s49, 1
    s_cmp_ge_u32 s49, 0x10000
    s_cbranch_scc1 L_mgo_65
    s_cbranch_vccnz L_mret_64
    s_branch L_mgo_65
L_smax_67:
    s_add_u32 s47, s47, 1
    s_mov_b32 s35, 0x7f800000
    s_waitcnt lgkmcnt(0)
    s_sub_u32 s43, s30, 0x40800
    s_add_u32 s40, s43, 4096
    s_nop 7
    buffer_load_dwordx4 v[56:59], v117, s[8:11], s43 offen
    buffer_load_dwordx4 v[60:63], v117, s[8:11], s43 offen offset:1024
    buffer_load_dwordx4 v[64:67], v117, s[8:11], s43 offen offset:2048
    buffer_load_dwordx4 v[68:71], v117, s[8:11], s43 offen offset:3072
    buffer_load_dwordx4 v[72:75], v117, s[8:11], s40 offen
    buffer_load_dwordx4 v[76:79], v117, s[8:11], s40 offen offset:1024
    buffer_load_dwordx4 v[80:83], v117, s[8:11], s40 offen offset:2048
    buffer_load_dwordx4 v[84:87], v117, s[8:11], s40 offen offset:3072
    ds_read_b128 v[32:35], v121 offset:16384
    ds_read_b128 v[36:39], v121 offset:17408
    ds_read_b128 v[40:43], v121 offset:18432
    ds_read_b128 v[44:47], v121 offset:19456
    v_mov_b32 v96, 0
    v_mov_b32 v97, 0
    v_mov_b32 v98, 0
    v_mov_b32 v99, 0
    v_mov_b32 v100, 0
    v_mov_b32 v101, 0
    v_mov_b32 v102, 0
    v_mov_b32 v103, 0
    v_mov_b32 v104, 0
    v_mov_b32 v105, 0
    v_mov_b32 v106, 0
    v_mov_b32 v107, 0
    v_mov_b32 v108, 0
    v_mov_b32 v109, 0
    v_mov_b32 v110, 0
    v_mov_b32 v111, 0
    s_waitcnt vmcnt(0) lgkmcnt(0)
    v_mfma_f32_16x16x32_bf16 v[56:59], v[56:59], v[32:35], 0
    v_mfma_f32_16x16x32_bf16 v[56:59], v[60:63], v[36:39], v[56:59]
    v_mfma_f32_16x16x32_bf16 v[56:59], v[64:67], v[40:43], v[56:59]
    v_mfma_f32_16x16x32_bf16 v[56:59], v[68:71], v[44:47], v[56:59]
    v_mfma_f32_16x16x32_bf16 v[60:63], v[72:75], v[32:35], 0
    v_mfma_f32_16x16x32_bf16 v[60:63], v[76:79], v[36:39], v[60:63]
    v_mfma_f32_16x16x32_bf16 v[60:63], v[80:83], v[40:43], v[60:63]
    v_mfma_f32_16x16x32_bf16 v[60:63], v[84:87], v[44:47], v[60:63]
    v_mfma_f32_16x16x32_bf16 v[64:67], v[32:35], v[32:35], 0
    v_mfma_f32_16x16x32_bf16 v[64:67], v[36:39], v[36:39], v[64:67]
    v_mfma_f32_16x16x32_bf16 v[64:67], v[40:43], v[40:43], v[64:67]
    v_mfma_f32_16x16x32_bf16 v[64:67], v[44:47], v[44:47], v[64:67]
    v_max3_f32 v84, v56, v57, v58
    v_max3_f32 v84, v84, v59, v60
    v_max3_f32 v84, v84, v61, v62
    s_nop 4
    v_max3_f32 v84, v84, v63, v64
    v_max_f32 v84, v84, v65
    v_mov_b32 v85, v84
    s_nop 1
    v_permlane32_swap_b32 v85, v84
    v_max_f32 v84, v85, v84
    v_mov_b32 v85, v84
    s_nop 1
    v_permlane16_swap_b32 v85, v84
    v_max_f32 v84, v85, v84
    v_sub_f32 v56, v56, v84
    v_sub_f32 v57, v57, v84
    v_sub_f32 v58, v58, v84
    v_sub_f32 v59, v59, v84
    v_sub_f32 v60, v60, v84
    v_sub_f32 v61, v61, v84
    v_sub_f32 v62, v62, v84
    v_sub_f32 v63, v63, v84
    v_sub_f32 v64, v64, v84
    v_sub_f32 v65, v65, v84
    v_exp_f32 v56, v56
    v_exp_f32 v57, v57
    v_exp_f32 v58, v58
    v_exp_f32 v59, v59
    v_exp_f32 v60, v60
    v_exp_f32 v61, v61
    v_exp_f32 v62, v62
    v_exp_f32 v63, v63
    v_exp_f32 v64, v64
    v_exp_f32 v65, v65
    v_cvt_pk_bf16_f32 v68, v56, v57
    v_cvt_pk_bf16_f32 v69, v58, v59
    v_cvt_pk_bf16_f32 v70, v60, v61
    v_cvt_pk_bf16_f32 v71, v62, v63
    v_cvt_pk_bf16_f32 v52, v64, v65
    s_nop 0
    v_mfma_f32_16x16x32_bf16 v[72:75], v[88:91], v[68:71], 0
    v_mfma_f32_16x16x32_bf16 v[76:79], v[92:95], v[68:71], 0
    v_mfma_f32_16x16x32_bf16 v[80:83], v[48:51], v[68:71], 0
    v_mfma_f32_16x16x16_bf16 v[72:75], v[112:113], v[52:53], v[72:75]
    v_mfma_f32_16x16x16_bf16 v[76:79], v[114:115], v[52:53], v[76:79]
    v_mfma_f32_16x16x16_bf16 v[80:83], v[48:49], v[52:53], v[80:83]
    ds_read_b128 v[32:35], v124 offset:6144
    ds_read_b128 v[36:39], v124 offset:7168
    ds_read_b128 v[40:43], v124 offset:34816
    ds_read_b128 v[44:47], v124 offset:35840
    ds_read_b128 v[56:59], v124 offset:36864
    ds_read_b128 v[64:67], v124 offset:38912
    ds_read_b128 v[68:71], v124 offset:39936
    s_waitcnt lgkmcnt(0)
    s_branch L_norm_66
L_kvw_68:
    s_add_u32 s47, s47, 1
    s_add_u32 s49, s49, 1
    s_cmp_ge_u32 s49, 0x10000
    s_cbranch_scc1 L_kvb_69
    s_sleep 4
    buffer_load_dword v125, v119, s[8:11], s28 offen sc1
    s_waitcnt vmcnt(0)
    v_cmp_eq_u32 vcc, 0, v125
    s_nop 0
    s_and_b64 vcc, vcc, s[58:59]
    s_cbranch_scc1 L_kvw_68
    s_branch L_kvb_69
L_mret_71:
    s_mov_b32 s43, m0
    s_mov_b32 m0, 6144
    buffer_load_dwordx4 v[4:7], v117, s[8:11], s48 offen sc1
    buffer_load_dwordx4 v117, s[8:11], s48 offen sc1 lds
    s_mov_b32 m0, 12288
    s_mov_b32 m0, s43
    s_waitcnt vmcnt(0)
    v_max3_u32 v15, v4, v5, v6
    v_max_u32 v15, v15, v7
    v_cmp_lt_u32 vcc, s56, v15
    s_add_u32 s47, s47, 1
    s_add_u32 s49, s49, 1
    s_cmp_ge_u32 s49, 0x10000
    s_cbranch_scc1 L_mgo_72
    s_cbranch_vccnz L_mret_71
    s_branch L_mgo_72
L_smax_74:
    s_add_u32 s47, s47, 1
    s_mov_b32 s35, 0x7f800000
    s_waitcnt lgkmcnt(0)
    s_sub_u32 s43, s30, 0x41000
    s_add_u32 s40, s43, 4096
    s_nop 7
    buffer_load_dwordx4 v[56:59], v117, s[8:11], s43 offen
    buffer_load_dwordx4 v[60:63], v117, s[8:11], s43 offen offset:1024
    buffer_load_dwordx4 v[64:67], v117, s[8:11], s43 offen offset:2048
    buffer_load_dwordx4 v[68:71], v117, s[8:11], s43 offen offset:3072
    buffer_load_dwordx4 v[72:75], v117, s[8:11], s40 offen
    buffer_load_dwordx4 v[76:79], v117, s[8:11], s40 offen offset:1024
    buffer_load_dwordx4 v[80:83], v117, s[8:11], s40 offen offset:2048
    buffer_load_dwordx4 v[84:87], v117, s[8:11], s40 offen offset:3072
    ds_read_b128 v[32:35], v121 offset:16384
    ds_read_b128 v[36:39], v121 offset:17408
    ds_read_b128 v[40:43], v121 offset:18432
    ds_read_b128 v[44:47], v121 offset:19456
    v_mov_b32 v96, 0
    v_mov_b32 v97, 0
    v_mov_b32 v98, 0
    v_mov_b32 v99, 0
    v_mov_b32 v100, 0
    v_mov_b32 v101, 0
    v_mov_b32 v102, 0
    v_mov_b32 v103, 0
    v_mov_b32 v104, 0
    v_mov_b32 v105, 0
    v_mov_b32 v106, 0
    v_mov_b32 v107, 0
    v_mov_b32 v108, 0
    v_mov_b32 v109, 0
    v_mov_b32 v110, 0
    v_mov_b32 v111, 0
    s_waitcnt vmcnt(0) lgkmcnt(0)
    v_mfma_f32_16x16x32_bf16 v[56:59], v[56:59], v[32:35], 0
    v_mfma_f32_16x16x32_bf16 v[56:59], v[60:63], v[36:39], v[56:59]
    v_mfma_f32_16x16x32_bf16 v[56:59], v[64:67], v[40:43], v[56:59]
    v_mfma_f32_16x16x32_bf16 v[56:59], v[68:71], v[44:47], v[56:59]
    v_mfma_f32_16x16x32_bf16 v[60:63], v[72:75], v[32:35], 0
    v_mfma_f32_16x16x32_bf16 v[60:63], v[76:79], v[36:39], v[60:63]
    v_mfma_f32_16x16x32_bf16 v[60:63], v[80:83], v[40:43], v[60:63]
    v_mfma_f32_16x16x32_bf16 v[60:63], v[84:87], v[44:47], v[60:63]
    v_mfma_f32_16x16x32_bf16 v[64:67], v[32:35], v[32:35], 0
    v_mfma_f32_16x16x32_bf16 v[64:67], v[36:39], v[36:39], v[64:67]
    v_mfma_f32_16x16x32_bf16 v[64:67], v[40:43], v[40:43], v[64:67]
    v_mfma_f32_16x16x32_bf16 v[64:67], v[44:47], v[44:47], v[64:67]
    v_max3_f32 v84, v56, v57, v58
    v_max3_f32 v84, v84, v59, v60
    v_max3_f32 v84, v84, v61, v62
    s_nop 4
    v_max3_f32 v84, v84, v63, v64
    v_max_f32 v84, v84, v65
    v_mov_b32 v85, v84
    s_nop 1
    v_permlane32_swap_b32 v85, v84
    v_max_f32 v84, v85, v84
    v_mov_b32 v85, v84
    s_nop 1
    v_permlane16_swap_b32 v85, v84
    v_max_f32 v84, v85, v84
    v_sub_f32 v56, v56, v84
    v_sub_f32 v57, v57, v84
    v_sub_f32 v58, v58, v84
    v_sub_f32 v59, v59, v84
    v_sub_f32 v60, v60, v84
    v_sub_f32 v61, v61, v84
    v_sub_f32 v62, v62, v84
    v_sub_f32 v63, v63, v84
    v_sub_f32 v64, v64, v84
    v_sub_f32 v65, v65, v84
    v_exp_f32 v56, v56
    v_exp_f32 v57, v57
    v_exp_f32 v58, v58
    v_exp_f32 v59, v59
    v_exp_f32 v60, v60
    v_exp_f32 v61, v61
    v_exp_f32 v62, v62
    v_exp_f32 v63, v63
    v_exp_f32 v64, v64
    v_exp_f32 v65, v65
    v_cvt_pk_bf16_f32 v68, v56, v57
    v_cvt_pk_bf16_f32 v69, v58, v59
    v_cvt_pk_bf16_f32 v70, v60, v61
    v_cvt_pk_bf16_f32 v71, v62, v63
    v_cvt_pk_bf16_f32 v52, v64, v65
    s_nop 0
    v_mfma_f32_16x16x32_bf16 v[72:75], v[88:91], v[68:71], 0
    v_mfma_f32_16x16x32_bf16 v[76:79], v[92:95], v[68:71], 0
    v_mfma_f32_16x16x32_bf16 v[80:83], v[48:51], v[68:71], 0
    v_mfma_f32_16x16x16_bf16 v[72:75], v[112:113], v[52:53], v[72:75]
    v_mfma_f32_16x16x16_bf16 v[76:79], v[114:115], v[52:53], v[76:79]
    v_mfma_f32_16x16x16_bf16 v[80:83], v[48:49], v[52:53], v[80:83]
    ds_read_b128 v[32:35], v124 offset:6144
    ds_read_b128 v[36:39], v124 offset:7168
    ds_read_b128 v[40:43], v124 offset:34816
    ds_read_b128 v[44:47], v124 offset:35840
    ds_read_b128 v[56:59], v124 offset:36864
    ds_read_b128 v[64:67], v124 offset:38912
    ds_read_b128 v[68:71], v124 offset:39936
    s_waitcnt lgkmcnt(0)
    s_branch L_norm_73
L_rslow_76:
    buffer_load_dwordx4 v[4:7], v117, s[8:11], s29 offen sc1
    buffer_load_dwordx4 v[8:11], v117, s[8:11], s53 offen sc1
    buffer_load_dwordx4 v[16:19], v117, s[8:11], s29 offen offset:2048 sc1
    buffer_load_dwordx4 v[20:23], v117, s[8:11], s53 offen offset:2048 sc1
    s_add_u32 s46, s46, 1
    s_add_u32 s49, s49, 1
    s_cmp_ge_u32 s49, 0x10000
    s_cbranch_scc1 L_rgo_77
    s_waitcnt vmcnt(7)
    v_mfma_f32_16x16x32_bf16 v[48:51], v[32:35], v[12:15], 0
    v_xor_b32 v52, s33, v32
    s_waitcnt vmcnt(6)
    v_mfma_f32_16x16x32_bf16 v[48:51], v[36:39], v[12:15], v[48:51]
    v_xor_b32 v53, s33, v36
    v_or_b32 v52, v52, v53
    s_waitcnt vmcnt(5)
    v_mfma_f32_16x16x32_bf16 v[48:51], v[40:43], v[12:15], v[48:51]
    v_xor_b32 v53, s33, v40
    v_or_b32 v52, v52, v53
    s_waitcnt vmcnt(4)
    v_mfma_f32_16x16x32_bf16 v[48:51], v[44:47], v[12:15], v[48:51]
    v_xor_b32 v53, s33, v44
    v_or_b32 v52, v52, v53
    v_and_b32 v52, 1, v52
    v_cmp_ne_u32 vcc, 0, v52
    s_cbranch_vccz L_rgo_77
    buffer_load_dwordx4 v[32:35], v117, s[8:11], s29 offen sc1
    buffer_load_dwordx4 v[36:39], v117, s[8:11], s53 offen sc1
    buffer_load_dwordx4 v[40:43], v117, s[8:11], s29 offen offset:2048 sc1
    buffer_load_dwordx4 v[44:47], v117, s[8:11], s53 offen offset:2048 sc1
    s_add_u32 s46, s46, 1
    s_branch L_rl_75
L_mret_79:
    s_mov_b32 s43, m0
    s_mov_b32 m0, 7168
    buffer_load_dwordx4 v[4:7], v117, s[8:11], s48 offen sc1
    buffer_load_dwordx4 v117, s[8:11], s48 offen sc1 lds
    s_mov_b32 m0, 14336
    s_mov_b32 m0, s43
    s_waitcnt vmcnt(0)
    v_max3_u32 v15, v4, v5, v6
    v_max_u32 v15, v15, v7
    v_cmp_lt_u32 vcc, s56, v15
    s_add_u32 s47, s47, 1
    s_add_u32 s49, s49, 1
    s_cmp_ge_u32 s49, 0x10000
    s_cbranch_scc1 L_mgo_80
    s_cbranch_vccnz L_mret_79
    s_branch L_mgo_80
L_smax_82:
    s_add_u32 s47, s47, 1
    s_mov_b32 s35, 0x7f800000
    s_waitcnt lgkmcnt(0)
    s_sub_u32 s43, s30, 0x41800
    s_add_u32 s40, s43, 4096
    s_nop 7
    buffer_load_dwordx4 v[56:59], v117, s[8:11], s43 offen
    buffer_load_dwordx4 v[60:63], v117, s[8:11], s43 offen offset:1024
    buffer_load_dwordx4 v[64:67], v117, s[8:11], s43 offen offset:2048
    buffer_load_dwordx4 v[68:71], v117, s[8:11], s43 offen offset:3072
    buffer_load_dwordx4 v[72:75], v117, s[8:11], s40 offen
    buffer_load_dwordx4 v[76:79], v117, s[8:11], s40 offen offset:1024
    buffer_load_dwordx4 v[80:83], v117, s[8:11], s40 offen offset:2048
    buffer_load_dwordx4 v[84:87], v117, s[8:11], s40 offen offset:3072
    ds_read_b128 v[32:35], v121 offset:16384
    ds_read_b128 v[36:39], v121 offset:17408
    ds_read_b128 v[40:43], v121 offset:18432
    ds_read_b128 v[44:47], v121 offset:19456
    v_mov_b32 v96, 0
    v_mov_b32 v97, 0
    v_mov_b32 v98, 0
    v_mov_b32 v99, 0
    v_mov_b32 v100, 0
    v_mov_b32 v101, 0
    v_mov_b32 v102, 0
    v_mov_b32 v103, 0
    v_mov_b32 v104, 0
    v_mov_b32 v105, 0
    v_mov_b32 v106, 0
    v_mov_b32 v107, 0
    v_mov_b32 v108, 0
    v_mov_b32 v109, 0
    v_mov_b32 v110, 0
    v_mov_b32 v111, 0
    s_waitcnt vmcnt(0) lgkmcnt(0)
    v_mfma_f32_16x16x32_bf16 v[56:59], v[56:59], v[32:35], 0
    v_mfma_f32_16x16x32_bf16 v[56:59], v[60:63], v[36:39], v[56:59]
    v_mfma_f32_16x16x32_bf16 v[56:59], v[64:67], v[40:43], v[56:59]
    v_mfma_f32_16x16x32_bf16 v[56:59], v[68:71], v[44:47], v[56:59]
    v_mfma_f32_16x16x32_bf16 v[60:63], v[72:75], v[32:35], 0
    v_mfma_f32_16x16x32_bf16 v[60:63], v[76:79], v[36:39], v[60:63]
    v_mfma_f32_16x16x32_bf16 v[60:63], v[80:83], v[40:43], v[60:63]
    v_mfma_f32_16x16x32_bf16 v[60:63], v[84:87], v[44:47], v[60:63]
    v_mfma_f32_16x16x32_bf16 v[64:67], v[32:35], v[32:35], 0
    v_mfma_f32_16x16x32_bf16 v[64:67], v[36:39], v[36:39], v[64:67]
    v_mfma_f32_16x16x32_bf16 v[64:67], v[40:43], v[40:43], v[64:67]
    v_mfma_f32_16x16x32_bf16 v[64:67], v[44:47], v[44:47], v[64:67]
    v_max3_f32 v84, v56, v57, v58
    v_max3_f32 v84, v84, v59, v60
    v_max3_f32 v84, v84, v61, v62
    s_nop 4
    v_max3_f32 v84, v84, v63, v64
    v_max_f32 v84, v84, v65
    v_mov_b32 v85, v84
    s_nop 1
    v_permlane32_swap_b32 v85, v84
    v_max_f32 v84, v85, v84
    v_mov_b32 v85, v84
    s_nop 1
    v_permlane16_swap_b32 v85, v84
    v_max_f32 v84, v85, v84
    v_sub_f32 v56, v56, v84
    v_sub_f32 v57, v57, v84
    v_sub_f32 v58, v58, v84
    v_sub_f32 v59, v59, v84
    v_sub_f32 v60, v60, v84
    v_sub_f32 v61, v61, v84
    v_sub_f32 v62, v62, v84
    v_sub_f32 v63, v63, v84
    v_sub_f32 v64, v64, v84
    v_sub_f32 v65, v65, v84
    v_exp_f32 v56, v56
    v_exp_f32 v57, v57
    v_exp_f32 v58, v58
    v_exp_f32 v59, v59
    v_exp_f32 v60, v60
    v_exp_f32 v61, v61
    v_exp_f32 v62, v62
    v_exp_f32 v63, v63
    v_exp_f32 v64, v64
    v_exp_f32 v65, v65
    v_cvt_pk_bf16_f32 v68, v56, v57
    v_cvt_pk_bf16_f32 v69, v58, v59
    v_cvt_pk_bf16_f32 v70, v60, v61
    v_cvt_pk_bf16_f32 v71, v62, v63
    v_cvt_pk_bf16_f32 v52, v64, v65
    s_nop 0
    v_mfma_f32_16x16x32_bf16 v[72:75], v[88:91], v[68:71], 0
    v_mfma_f32_16x16x32_bf16 v[76:79], v[92:95], v[68:71], 0
    v_mfma_f32_16x16x32_bf16 v[80:83], v[48:51], v[68:71], 0
    v_mfma_f32_16x16x16_bf16 v[72:75], v[112:113], v[52:53], v[72:75]
    v_mfma_f32_16x16x16_bf16 v[76:79], v[114:115], v[52:53], v[76:79]
    v_mfma_f32_16x16x16_bf16 v[80:83], v[48:49], v[52:53], v[80:83]
    ds_read_b128 v[32:35], v124 offset:6144
    ds_read_b128 v[36:39], v124 offset:7168
    ds_read_b128 v[40:43], v124 offset:34816
    ds_read_b128 v[44:47], v124 offset:35840
    ds_read_b128 v[56:59], v124 offset:36864
    ds_read_b128 v[64:67], v124 offset:38912
    ds_read_b128 v[68:71], v124 offset:39936
    s_waitcnt lgkmcnt(0)
    s_branch L_norm_81
L_rslow_84:
    buffer_load_dwordx4 v[4:7], v117, s[8:11], s29 offen sc1
    buffer_load_dwordx4 v[8:11], v117, s[8:11], s53 offen sc1
    buffer_load_dwordx4 v[16:19], v117, s[8:11], s29 offen offset:2048 sc1
    buffer_load_dwordx4 v[20:23], v117, s[8:11], s53 offen offset:2048 sc1
    s_add_u32 s46, s46, 1
    s_add_u32 s49, s49, 1
    s_cmp_ge_u32 s49, 0x10000
    s_cbranch_scc1 L_rgo_85
    s_waitcnt vmcnt(7)
    v_mfma_f32_16x16x32_bf16 v[48:51], v[32:35], v[12:15], 0
    v_xor_b32 v52, s33, v32
    s_waitcnt vmcnt(6)
    v_mfma_f32_16x16x32_bf16 v[48:51], v[36:39], v[12:15], v[48:51]
    v_xor_b32 v53, s33, v36
    v_or_b32 v52, v52, v53
    s_waitcnt vmcnt(5)
    v_mfma_f32_16x16x32_bf16 v[48:51], v[40:43], v[12:15], v[48:51]
    v_xor_b32 v53, s33, v40
    v_or_b32 v52, v52, v53
    s_waitcnt vmcnt(4)
    v_mfma_f32_16x16x32_bf16 v[48:51], v[44:47], v[12:15], v[48:51]
    v_xor_b32 v53, s33, v44
    v_or_b32 v52, v52, v53
    v_and_b32 v52, 1, v52
    v_cmp_ne_u32 vcc, 0, v52
    s_cbranch_vccz L_rgo_85
    buffer_load_dwordx4 v[32:35], v117, s[8:11], s29 offen sc1
    buffer_load_dwordx4 v[36:39], v117, s[8:11], s53 offen sc1
    buffer_load_dwordx4 v[40:43], v117, s[8:11], s29 offen offset:2048 sc1
    buffer_load_dwordx4 v[44:47], v117, s[8:11], s53 offen offset:2048 sc1
    s_add_u32 s46, s46, 1
    s_branch L_rl_83
L_bulk:
    s_add_u32 s88, s101, 32
    s_mov_b32 s41, 0
    s_lshr_b32 s20, s101, 6
    s_and_b32 s22, s101, 63
    s_movk_i32 s37, 1000
L_p1go:
    s_mov_b32 s40, 0
    s_mov_b32 s80, 0
    s_mov_b32 s23, 0
L_p1_pass:
    v_mbcnt_lo_u32_b32 v0, -1, 0
    v_mbcnt_hi_u32_b32 v0, -1, v0
    s_lshl_b32 s96, s100, 6
    v_add_u32 v0, s96, v0
    s_load_dwordx2 s[34:35], s[0:1], 16
    s_load_dwordx2 s[30:31], s[0:1], 24
    s_load_dwordx2 s[32:33], s[0:1], 32
    s_load_dwordx2 s[42:43], s[0:1], 40
    s_load_dwordx2 s[12:13], s[0:1], 0
    s_waitcnt lgkmcnt(0)
    s_and_b32 s13, s13, 0xffff
    s_mov_b32 s14, 0x200000
    s_mov_b32 s15, 0x20000
    v_lshrrev_b32 v147, 6, v0
    s_nop 0
    v_readfirstlane_b32 s21, v147
    v_and_b32 v144, 63, v0
    v_lshrrev_b32 v145, 4, v144
    v_and_b32 v146, 15, v144
    v_lshrrev_b32 v149, 2, v146
    v_lshlrev_b32 v137, 4, v144
    s_lshl_b32 s29, s21, 10
    s_lshl_b32 s26, s20, 7
    s_lshl_b32 s27, s21, 5
    s_add_u32 s26, s26, s27
    v_add_u32 v147, s26, v146
    v_lshlrev_b32 v147, 10, v147
    v_lshl_add_u32 v139, v145, 4, v147
    s_mov_b32 s26, 0x0
    buffer_load_dwordx4 v[0:3], v139, s[12:15], s26 offen
    buffer_load_dwordx4 v[4:7], v139, s[12:15], s26 offen offset:64
    buffer_load_dwordx4 v[8:11], v139, s[12:15], s26 offen offset:128
    buffer_load_dwordx4 v[12:15], v139, s[12:15], s26 offen offset:192
    buffer_load_dwordx4 v[16:19], v139, s[12:15], s26 offen offset:256
    buffer_load_dwordx4 v[20:23], v139, s[12:15], s26 offen offset:320
    buffer_load_dwordx4 v[24:27], v139, s[12:15], s26 offen offset:384
    buffer_load_dwordx4 v[28:31], v139, s[12:15], s26 offen offset:448
    buffer_load_dwordx4 v[32:35], v139, s[12:15], s26 offen offset:512
    buffer_load_dwordx4 v[36:39], v139, s[12:15], s26 offen offset:576
    buffer_load_dwordx4 v[40:43], v139, s[12:15], s26 offen offset:640
    buffer_load_dwordx4 v[44:47], v139, s[12:15], s26 offen offset:704
    buffer_load_dwordx4 v[48:51], v139, s[12:15], s26 offen offset:768
    buffer_load_dwordx4 v[52:55], v139, s[12:15], s26 offen offset:832
    buffer_load_dwordx4 v[56:59], v139, s[12:15], s26 offen offset:896
    buffer_load_dwordx4 v[60:63], v139, s[12:15], s26 offen offset:960
    s_mov_b32 s26, 0x4000
    buffer_load_dwordx4 v[64:67], v139, s[12:15], s26 offen
    buffer_load_dwordx4 v[68:71], v139, s[12:15], s26 offen offset:64
    buffer_load_dwordx4 v[72:75], v139, s[12:15], s26 offen offset:128
    buffer_load_dwordx4 v[76:79], v139, s[12:15], s26 offen offset:192
    buffer_load_dwordx4 v[80:83], v139, s[12:15], s26 offen offset:256
    buffer_load_dwordx4 v[84:87], v139, s[12:15], s26 offen offset:320
    buffer_load_dwordx4 v[88:91], v139, s[12:15], s26 offen offset:384
    buffer_load_dwordx4 v[92:95], v139, s[12:15], s26 offen offset:448
    buffer_load_dwordx4 v[96:99], v139, s[12:15], s26 offen offset:512
    buffer_load_dwordx4 v[100:103], v139, s[12:15], s26 offen offset:576
    buffer_load_dwordx4 v[104:107], v139, s[12:15], s26 offen offset:640
    buffer_load_dwordx4 v[108:111], v139, s[12:15], s26 offen offset:704
    buffer_load_dwordx4 v[112:115], v139, s[12:15], s26 offen offset:768
    buffer_load_dwordx4 v[116:119], v139, s[12:15], s26 offen offset:832
    buffer_load_dwordx4 v[120:123], v139, s[12:15], s26 offen offset:896
    buffer_load_dwordx4 v[124:127], v139, s[12:15], s26 offen offset:960
    s_lshr_b32 s26, s21, 1
    s_lshl_b32 s26, s26, 2
    v_or_b32 v148, s26, v145
    v_lshlrev_b32 v148, 1, v148
    v_xor_b32 v148, v148, v146
    v_lshlrev_b32 v148, 4, v148
    s_lshl_b32 s26, s21, 2
    v_add_u32 v147, s26, v145
    v_lshl_add_u32 v136, v147, 13, v148
    v_lshl_add_u32 v147, v145, 3, v149
    v_lshlrev_b32 v147, 8, v147
    v_and_b32 v148, 1, v145
    v_lshl_or_b32 v148, v148, 2, v149
    v_lshl_add_u32 v147, v148, 5, v147
    v_and_b32 v148, 3, v146
    v_lshl_add_u32 v128, v148, 3, v147
    v_xor_b32 v129, 32, v128
    v_xor_b32 v130, 64, v128
    v_xor_b32 v131, 96, v128
    v_xor_b32 v132, 128, v128
    v_xor_b32 v133, 160, v128
    v_xor_b32 v134, 192, v128
    v_xor_b32 v135, 224, v128
    s_mov_b32 s19, 0x20000
    s_mov_b32 s38, s22
    s_mov_b32 s39, s22
    v_mov_b32 v158, 0x3f803f80
    s_waitcnt vmcnt(16)
    v_pk_mov_b32 v[150:151], 0, 0
    v_pk_mov_b32 v[152:153], 0, 0
    v_dot2_f32_bf16 v150, v0, v158, v150
    v_dot2_f32_bf16 v152, v0, v0, v152
    v_dot2_f32_bf16 v151, v1, v158, v151
    v_dot2_f32_bf16 v153, v1, v1, v153
    v_dot2_f32_bf16 v150, v2, v158, v150
    v_dot2_f32_bf16 v152, v2, v2, v152
    v_dot2_f32_bf16 v151, v3, v158, v151
    v_dot2_f32_bf16 v153, v3, v3, v153
    v_dot2_f32_bf16 v150, v4, v158, v150
    v_dot2_f32_bf16 v152, v4, v4, v152
    v_dot2_f32_bf16 v151, v5, v158, v151
    v_dot2_f32_bf16 v153, v5, v5, v153
    v_dot2_f32_bf16 v150, v6, v158, v150
    v_dot2_f32_bf16 v152, v6, v6, v152
    v_dot2_f32_bf16 v151, v7, v158, v151
    v_dot2_f32_bf16 v153, v7, v7, v153
    v_dot2_f32_bf16 v150, v8, v158, v150
    v_dot2_f32_bf16 v152, v8, v8, v152
    v_dot2_f32_bf16 v151, v9, v158, v151
    v_dot2_f32_bf16 v153, v9, v9, v153
    v_dot2_f32_bf16 v150, v10, v158, v150
    v_dot2_f32_bf16 v152, v10, v10, v152
    v_dot2_f32_bf16 v151, v11, v158, v151
    v_dot2_f32_bf16 v153, v11, v11, v153
    v_dot2_f32_bf16 v150, v12, v158, v150
    v_dot2_f32_bf16 v152, v12, v12, v152
    v_dot2_f32_bf16 v151, v13, v158, v151
    v_dot2_f32_bf16 v153, v13, v13, v153
    v_dot2_f32_bf16 v150, v14, v158, v150
    v_dot2_f32_bf16 v152, v14, v14, v152
    v_dot2_f32_bf16 v151, v15, v158, v151
    v_dot2_f32_bf16 v153, v15, v15, v153
    v_dot2_f32_bf16 v150, v16, v158, v150
    v_dot2_f32_bf16 v152, v16, v16, v152
    v_dot2_f32_bf16 v151, v17, v158, v151
    v_dot2_f32_bf16 v153, v17, v17, v153
    v_dot2_f32_bf16 v150, v18, v158, v150
    v_dot2_f32_bf16 v152, v18, v18, v152
    v_dot2_f32_bf16 v151, v19, v158, v151
    v_dot2_f32_bf16 v153, v19, v19, v153
    v_dot2_f32_bf16 v150, v20, v158, v150
    v_dot2_f32_bf16 v152, v20, v20, v152
    v_dot2_f32_bf16 v151, v21, v158, v151
    v_dot2_f32_bf16 v153, v21, v21, v153
    v_dot2_f32_bf16 v150, v22, v158, v150
    v_dot2_f32_bf16 v152, v22, v22, v152
    v_dot2_f32_bf16 v151, v23, v158, v151
    v_dot2_f32_bf16 v153, v23, v23, v153
    v_dot2_f32_bf16 v150, v24, v158, v150
    v_dot2_f32_bf16 v152, v24, v24, v152
    v_dot2_f32_bf16 v151, v25, v158, v151
    v_dot2_f32_bf16 v153, v25, v25, v153
    v_dot2_f32_bf16 v150, v26, v158, v150
    v_dot2_f32_bf16 v152, v26, v26, v152
    v_dot2_f32_bf16 v151, v27, v158, v151
    v_dot2_f32_bf16 v153, v27, v27, v153
    v_dot2_f32_bf16 v150, v28, v158, v150
    v_dot2_f32_bf16 v152, v28, v28, v152
    v_dot2_f32_bf16 v151, v29, v158, v151
    v_dot2_f32_bf16 v153, v29, v29, v153
    v_dot2_f32_bf16 v150, v30, v158, v150
    v_dot2_f32_bf16 v152, v30, v30, v152
    v_dot2_f32_bf16 v151, v31, v158, v151
    v_dot2_f32_bf16 v153, v31, v31, v153
    v_dot2_f32_bf16 v150, v32, v158, v150
    v_dot2_f32_bf16 v152, v32, v32, v152
    v_dot2_f32_bf16 v151, v33, v158, v151
    v_dot2_f32_bf16 v153, v33, v33, v153
    v_dot2_f32_bf16 v150, v34, v158, v150
    v_dot2_f32_bf16 v152, v34, v34, v152
    v_dot2_f32_bf16 v151, v35, v158, v151
    v_dot2_f32_bf16 v153, v35, v35, v153
    v_dot2_f32_bf16 v150, v36, v158, v150
    v_dot2_f32_bf16 v152, v36, v36, v152
    v_dot2_f32_bf16 v151, v37, v158, v151
    v_dot2_f32_bf16 v153, v37, v37, v153
    v_dot2_f32_bf16 v150, v38, v158, v150
    v_dot2_f32_bf16 v152, v38, v38, v152
    v_dot2_f32_bf16 v151, v39, v158, v151
    v_dot2_f32_bf16 v153, v39, v39, v153
    v_dot2_f32_bf16 v150, v40, v158, v150
    v_dot2_f32_bf16 v152, v40, v40, v152
    v_dot2_f32_bf16 v151, v41, v158, v151
    v_dot2_f32_bf16 v153, v41, v41, v153
    v_dot2_f32_bf16 v150, v42, v158, v150
    v_dot2_f32_bf16 v152, v42, v42, v152
    v_dot2_f32_bf16 v151, v43, v158, v151
    v_dot2_f32_bf16 v153, v43, v43, v153
    v_dot2_f32_bf16 v150, v44, v158, v150
    v_dot2_f32_bf16 v152, v44, v44, v152
    v_dot2_f32_bf16 v151, v45, v158, v151
    v_dot2_f32_bf16 v153, v45, v45, v153
    v_dot2_f32_bf16 v150, v46, v158, v150
    v_dot2_f32_bf16 v152, v46, v46, v152
    v_dot2_f32_bf16 v151, v47, v158, v151
    v_dot2_f32_bf16 v153, v47, v47, v153
    v_dot2_f32_bf16 v150, v48, v158, v150
    v_dot2_f32_bf16 v152, v48, v48, v152
    v_dot2_f32_bf16 v151, v49, v158, v151
    v_dot2_f32_bf16 v153, v49, v49, v153
    v_dot2_f32_bf16 v150, v50, v158, v150
    v_dot2_f32_bf16 v152, v50, v50, v152
    v_dot2_f32_bf16 v151, v51, v158, v151
    v_dot2_f32_bf16 v153, v51, v51, v153
    v_dot2_f32_bf16 v150, v52, v158, v150
    v_dot2_f32_bf16 v152, v52, v52, v152
    v_dot2_f32_bf16 v151, v53, v158, v151
    v_dot2_f32_bf16 v153, v53, v53, v153
    v_dot2_f32_bf16 v150, v54, v158, v150
    v_dot2_f32_bf16 v152, v54, v54, v152
    v_dot2_f32_bf16 v151, v55, v158, v151
    v_dot2_f32_bf16 v153, v55, v55, v153
    v_dot2_f32_bf16 v150, v56, v158, v150
    v_dot2_f32_bf16 v152, v56, v56, v152
    v_dot2_f32_bf16 v151, v57, v158, v151
    v_dot2_f32_bf16 v153, v57, v57, v153
    v_dot2_f32_bf16 v150, v58, v158, v150
    v_dot2_f32_bf16 v152, v58, v58, v152
    v_dot2_f32_bf16 v151, v59, v158, v151
    v_dot2_f32_bf16 v153, v59, v59, v153
    v_dot2_f32_bf16 v150, v60, v158, v150
    v_dot2_f32_bf16 v152, v60, v60, v152
    v_dot2_f32_bf16 v151, v61, v158, v151
    v_dot2_f32_bf16 v153, v61, v61, v153
    v_dot2_f32_bf16 v150, v62, v158, v150
    v_dot2_f32_bf16 v152, v62, v62, v152
    v_dot2_f32_bf16 v151, v63, v158, v151
    v_dot2_f32_bf16 v153, v63, v63, v153
    s_nop 1
    v_add_f32 v150, v150, v151
    v_add_f32 v152, v152, v153
    v_mov_b32 v157, v150
    s_nop 1
    v_permlane32_swap_b32 v157, v150
    v_add_f32 v150, v157, v150
    v_mov_b32 v157, v150
    s_nop 1
    v_permlane16_swap_b32 v157, v150
    v_add_f32 v150, v157, v150
    v_mov_b32 v157, v152
    s_nop 1
    v_permlane32_swap_b32 v157, v152
    v_add_f32 v152, v157, v152
    v_mov_b32 v157, v152
    s_nop 1
    v_permlane16_swap_b32 v157, v152
    v_add_f32 v152, v157, v152
    v_mul_f32 v150, 0x3b000000, v150
    v_cvt_pk_bf16_f32 v154, v150, v150
    v_and_b32 v154, 0xffff0000, v154
    v_sub_f32 v156, v150, v154
    v_mul_f32 v157, v150, v150
    v_mul_f32 v152, 0x3b000000, v152
    v_sub_f32 v152, v152, v157
    v_max_f32 v152, 0, v152
    v_cvt_pk_bf16_f32 v152, v152, v152
    v_and_b32 v152, 0xffff0000, v152
    v_add_f32 v152, 0x3727c5ac, v152
    v_cvt_pk_bf16_f32 v152, v152, v152
    v_and_b32 v152, 0xffff0000, v152
    v_sqrt_f32 v152, v152
    s_nop 0
    v_cvt_pk_bf16_f32 v152, v152, v152
    v_and_b32 v152, 0xffff0000, v152
    v_rcp_f32 v152, v152
    v_lshlrev_b32 v160, 16, v0
    v_and_b32 v161, 0xffff0000, v0
    v_lshlrev_b32 v162, 16, v1
    v_and_b32 v163, 0xffff0000, v1
    v_lshlrev_b32 v164, 16, v2
    v_and_b32 v165, 0xffff0000, v2
    v_lshlrev_b32 v166, 16, v3
    v_and_b32 v167, 0xffff0000, v3
    v_lshlrev_b32 v168, 16, v4
    v_and_b32 v169, 0xffff0000, v4
    v_lshlrev_b32 v170, 16, v5
    v_and_b32 v171, 0xffff0000, v5
    v_lshlrev_b32 v172, 16, v6
    v_and_b32 v173, 0xffff0000, v6
    v_lshlrev_b32 v174, 16, v7
    v_and_b32 v175, 0xffff0000, v7
    v_pk_add_f32 v[160:161], v[160:161], v[154:155] op_sel_hi:[1,0] neg_lo:[0,1] neg_hi:[0,1]
    v_pk_add_f32 v[162:163], v[162:163], v[154:155] op_sel_hi:[1,0] neg_lo:[0,1] neg_hi:[0,1]
    v_pk_add_f32 v[164:165], v[164:165], v[154:155] op_sel_hi:[1,0] neg_lo:[0,1] neg_hi:[0,1]
    v_pk_add_f32 v[166:167], v[166:167], v[154:155] op_sel_hi:[1,0] neg_lo:[0,1] neg_hi:[0,1]
    v_pk_add_f32 v[168:169], v[168:169], v[154:155] op_sel_hi:[1,0] neg_lo:[0,1] neg_hi:[0,1]
    v_pk_add_f32 v[170:171], v[170:171], v[154:155] op_sel_hi:[1,0] neg_lo:[0,1] neg_hi:[0,1]
    v_pk_add_f32 v[172:173], v[172:173], v[154:155] op_sel_hi:[1,0] neg_lo:[0,1] neg_hi:[0,1]
    v_pk_add_f32 v[174:175], v[174:175], v[154:155] op_sel_hi:[1,0] neg_lo:[0,1] neg_hi:[0,1]
    v_cvt_pk_bf16_f32 v0, v160, v161
    v_cvt_pk_bf16_f32 v1, v162, v163
    v_cvt_pk_bf16_f32 v2, v164, v165
    v_cvt_pk_bf16_f32 v3, v166, v167
    v_cvt_pk_bf16_f32 v4, v168, v169
    v_cvt_pk_bf16_f32 v5, v170, v171
    v_cvt_pk_bf16_f32 v6, v172, v173
    v_cvt_pk_bf16_f32 v7, v174, v175
    v_lshlrev_b32 v160, 16, v0
    v_and_b32 v161, 0xffff0000, v0
    v_lshlrev_b32 v162, 16, v1
    v_and_b32 v163, 0xffff0000, v1
    v_lshlrev_b32 v164, 16, v2
    v_and_b32 v165, 0xffff0000, v2
    v_lshlrev_b32 v166, 16, v3
    v_and_b32 v167, 0xffff0000, v3
    v_lshlrev_b32 v168, 16, v4
    v_and_b32 v169, 0xffff0000, v4
    v_lshlrev_b32 v170, 16, v5
    v_and_b32 v171, 0xffff0000, v5
    v_lshlrev_b32 v172, 16, v6
    v_and_b32 v173, 0xffff0000, v6
    v_lshlrev_b32 v174, 16, v7
    v_and_b32 v175, 0xffff0000, v7
    v_pk_mul_f32 v[160:161], v[160:161], v[152:153] op_sel_hi:[1,0]
    v_pk_mul_f32 v[162:163], v[162:163], v[152:153] op_sel_hi:[1,0]
    v_pk_mul_f32 v[164:165], v[164:165], v[152:153] op_sel_hi:[1,0]
    v_pk_mul_f32 v[166:167], v[166:167], v[152:153] op_sel_hi:[1,0]
    v_pk_mul_f32 v[168:169], v[168:169], v[152:153] op_sel_hi:[1,0]
    v_pk_mul_f32 v[170:171], v[170:171], v[152:153] op_sel_hi:[1,0]
    v_pk_mul_f32 v[172:173], v[172:173], v[152:153] op_sel_hi:[1,0]
    v_pk_mul_f32 v[174:175], v[174:175], v[152:153] op_sel_hi:[1,0]
    v_cvt_pk_bf16_f32 v160, v160, v161
    v_cvt_pk_bf16_f32 v162, v162, v163
    v_cvt_pk_bf16_f32 v164, v164, v165
    v_cvt_pk_bf16_f32 v166, v166, v167
    v_cvt_pk_bf16_f32 v168, v168, v169
    v_cvt_pk_bf16_f32 v170, v170, v171
    v_cvt_pk_bf16_f32 v172, v172, v173
    v_cvt_pk_bf16_f32 v174, v174, v175
    v_accvgpr_write_b32 a0, v160
    v_accvgpr_write_b32 a1, v162
    v_accvgpr_write_b32 a2, v164
    v_accvgpr_write_b32 a3, v166
    v_accvgpr_write_b32 a4, v168
    v_accvgpr_write_b32 a5, v170
    v_accvgpr_write_b32 a6, v172
    v_accvgpr_write_b32 a7, v174
    v_lshlrev_b32 v160, 16, v8
    v_and_b32 v161, 0xffff0000, v8
    v_lshlrev_b32 v162, 16, v9
    v_and_b32 v163, 0xffff0000, v9
    v_lshlrev_b32 v164, 16, v10
    v_and_b32 v165, 0xffff0000, v10
    v_lshlrev_b32 v166, 16, v11
    v_and_b32 v167, 0xffff0000, v11
    v_lshlrev_b32 v168, 16, v12
    v_and_b32 v169, 0xffff0000, v12
    v_lshlrev_b32 v170, 16, v13
    v_and_b32 v171, 0xffff0000, v13
    v_lshlrev_b32 v172, 16, v14
    v_and_b32 v173, 0xffff0000, v14
    v_lshlrev_b32 v174, 16, v15
    v_and_b32 v175, 0xffff0000, v15
    v_pk_add_f32 v[160:161], v[160:161], v[154:155] op_sel_hi:[1,0] neg_lo:[0,1] neg_hi:[0,1]
    v_pk_add_f32 v[162:163], v[162:163], v[154:155] op_sel_hi:[1,0] neg_lo:[0,1] neg_hi:[0,1]
    v_pk_add_f32 v[164:165], v[164:165], v[154:155] op_sel_hi:[1,0] neg_lo:[0,1] neg_hi:[0,1]
    v_pk_add_f32 v[166:167], v[166:167], v[154:155] op_sel_hi:[1,0] neg_lo:[0,1] neg_hi:[0,1]
    v_pk_add_f32 v[168:169], v[168:169], v[154:155] op_sel_hi:[1,0] neg_lo:[0,1] neg_hi:[0,1]
    v_pk_add_f32 v[170:171], v[170:171], v[154:155] op_sel_hi:[1,0] neg_lo:[0,1] neg_hi:[0,1]
    v_pk_add_f32 v[172:173], v[172:173], v[154:155] op_sel_hi:[1,0] neg_lo:[0,1] neg_hi:[0,1]
    v_pk_add_f32 v[174:175], v[174:175], v[154:155] op_sel_hi:[1,0] neg_lo:[0,1] neg_hi:[0,1]
    v_cvt_pk_bf16_f32 v8, v160, v161
    v_cvt_pk_bf16_f32 v9, v162, v163
    v_cvt_pk_bf16_f32 v10, v164, v165
    v_cvt_pk_bf16_f32 v11, v166, v167
    v_cvt_pk_bf16_f32 v12, v168, v169
    v_cvt_pk_bf16_f32 v13, v170, v171
    v_cvt_pk_bf16_f32 v14, v172, v173
    v_cvt_pk_bf16_f32 v15, v174, v175
    v_lshlrev_b32 v160, 16, v8
    v_and_b32 v161, 0xffff0000, v8
    v_lshlrev_b32 v162, 16, v9
    v_and_b32 v163, 0xffff0000, v9
    v_lshlrev_b32 v164, 16, v10
    v_and_b32 v165, 0xffff0000, v10
    v_lshlrev_b32 v166, 16, v11
    v_and_b32 v167, 0xffff0000, v11
    v_lshlrev_b32 v168, 16, v12
    v_and_b32 v169, 0xffff0000, v12
    v_lshlrev_b32 v170, 16, v13
    v_and_b32 v171, 0xffff0000, v13
    v_lshlrev_b32 v172, 16, v14
    v_and_b32 v173, 0xffff0000, v14
    v_lshlrev_b32 v174, 16, v15
    v_and_b32 v175, 0xffff0000, v15
    v_pk_mul_f32 v[160:161], v[160:161], v[152:153] op_sel_hi:[1,0]
    v_pk_mul_f32 v[162:163], v[162:163], v[152:153] op_sel_hi:[1,0]
    v_pk_mul_f32 v[164:165], v[164:165], v[152:153] op_sel_hi:[1,0]
    v_pk_mul_f32 v[166:167], v[166:167], v[152:153] op_sel_hi:[1,0]
    v_pk_mul_f32 v[168:169], v[168:169], v[152:153] op_sel_hi:[1,0]
    v_pk_mul_f32 v[170:171], v[170:171], v[152:153] op_sel_hi:[1,0]
    v_pk_mul_f32 v[172:173], v[172:173], v[152:153] op_sel_hi:[1,0]
    v_pk_mul_f32 v[174:175], v[174:175], v[152:153] op_sel_hi:[1,0]
    v_cvt_pk_bf16_f32 v160, v160, v161
    v_cvt_pk_bf16_f32 v162, v162, v163
    v_cvt_pk_bf16_f32 v164, v164, v165
    v_cvt_pk_bf16_f32 v166, v166, v167
    v_cvt_pk_bf16_f32 v168, v168, v169
    v_cvt_pk_bf16_f32 v170, v170, v171
    v_cvt_pk_bf16_f32 v172, v172, v173
    v_cvt_pk_bf16_f32 v174, v174, v175
    v_accvgpr_write_b32 a8, v160
    v_accvgpr_write_b32 a9, v162
    v_accvgpr_write_b32 a10, v164
    v_accvgpr_write_b32 a11, v166
    v_accvgpr_write_b32 a12, v168
    v_accvgpr_write_b32 a13, v170
    v_accvgpr_write_b32 a14, v172
    v_accvgpr_write_b32 a15, v174
    v_lshlrev_b32 v160, 16, v16
    v_and_b32 v161, 0xffff0000, v16
    v_lshlrev_b32 v162, 16, v17
    v_and_b32 v163, 0xffff0000, v17
    v_lshlrev_b32 v164, 16, v18
    v_and_b32 v165, 0xffff0000, v18
    v_lshlrev_b32 v166, 16, v19
    v_and_b32 v167, 0xffff0000, v19
    v_lshlrev_b32 v168, 16, v20
    v_and_b32 v169, 0xffff0000, v20
    v_lshlrev_b32 v170, 16, v21
    v_and_b32 v171, 0xffff0000, v21
    v_lshlrev_b32 v172, 16, v22
    v_and_b32 v173, 0xffff0000, v22
    v_lshlrev_b32 v174, 16, v23
    v_and_b32 v175, 0xffff0000, v23
    v_pk_add_f32 v[160:161], v[160:161], v[154:155] op_sel_hi:[1,0] neg_lo:[0,1] neg_hi:[0,1]
    v_pk_add_f32 v[162:163], v[162:163], v[154:155] op_sel_hi:[1,0] neg_lo:[0,1] neg_hi:[0,1]
    v_pk_add_f32 v[164:165], v[164:165], v[154:155] op_sel_hi:[1,0] neg_lo:[0,1] neg_hi:[0,1]
    v_pk_add_f32 v[166:167], v[166:167], v[154:155] op_sel_hi:[1,0] neg_lo:[0,1] neg_hi:[0,1]
    v_pk_add_f32 v[168:169], v[168:169], v[154:155] op_sel_hi:[1,0] neg_lo:[0,1] neg_hi:[0,1]
    v_pk_add_f32 v[170:171], v[170:171], v[154:155] op_sel_hi:[1,0] neg_lo:[0,1] neg_hi:[0,1]
    v_pk_add_f32 v[172:173], v[172:173], v[154:155] op_sel_hi:[1,0] neg_lo:[0,1] neg_hi:[0,1]
    v_pk_add_f32 v[174:175], v[174:175], v[154:155] op_sel_hi:[1,0] neg_lo:[0,1] neg_hi:[0,1]
    v_cvt_pk_bf16_f32 v16, v160, v161
    v_cvt_pk_bf16_f32 v17, v162, v163
    v_cvt_pk_bf16_f32 v18, v164, v165
    v_cvt_pk_bf16_f32 v19, v166, v167
    v_cvt_pk_bf16_f32 v20, v168, v169
    v_cvt_pk_bf16_f32 v21, v170, v171
    v_cvt_pk_bf16_f32 v22, v172, v173
    v_cvt_pk_bf16_f32 v23, v174, v175
    v_lshlrev_b32 v160, 16, v16
    v_and_b32 v161, 0xffff0000, v16
    v_lshlrev_b32 v162, 16, v17
    v_and_b32 v163, 0xffff0000, v17
    v_lshlrev_b32 v164, 16, v18
    v_and_b32 v165, 0xffff0000, v18
    v_lshlrev_b32 v166, 16, v19
    v_and_b32 v167, 0xffff0000, v19
    v_lshlrev_b32 v168, 16, v20
    v_and_b32 v169, 0xffff0000, v20
    v_lshlrev_b32 v170, 16, v21
    v_and_b32 v171, 0xffff0000, v21
    v_lshlrev_b32 v172, 16, v22
    v_and_b32 v173, 0xffff0000, v22
    v_lshlrev_b32 v174, 16, v23
    v_and_b32 v175, 0xffff0000, v23
    v_pk_mul_f32 v[160:161], v[160:161], v[152:153] op_sel_hi:[1,0]
    v_pk_mul_f32 v[162:163], v[162:163], v[152:153] op_sel_hi:[1,0]
    v_pk_mul_f32 v[164:165], v[164:165], v[152:153] op_sel_hi:[1,0]
    v_pk_mul_f32 v[166:167], v[166:167], v[152:153] op_sel_hi:[1,0]
    v_pk_mul_f32 v[168:169], v[168:169], v[152:153] op_sel_hi:[1,0]
    v_pk_mul_f32 v[170:171], v[170:171], v[152:153] op_sel_hi:[1,0]
    v_pk_mul_f32 v[172:173], v[172:173], v[152:153] op_sel_hi:[1,0]
    v_pk_mul_f32 v[174:175], v[174:175], v[152:153] op_sel_hi:[1,0]
    v_cvt_pk_bf16_f32 v160, v160, v161
    v_cvt_pk_bf16_f32 v162, v162, v163
    v_cvt_pk_bf16_f32 v164, v164, v165
    v_cvt_pk_bf16_f32 v166, v166, v167
    v_cvt_pk_bf16_f32 v168, v168, v169
    v_cvt_pk_bf16_f32 v170, v170, v171
    v_cvt_pk_bf16_f32 v172, v172, v173
    v_cvt_pk_bf16_f32 v174, v174, v175
    v_accvgpr_write_b32 a16, v160
    v_accvgpr_write_b32 a17, v162
    v_accvgpr_write_b32 a18, v164
    v_accvgpr_write_b32 a19, v166
    v_accvgpr_write_b32 a20, v168
    v_accvgpr_write_b32 a21, v170
    v_accvgpr_write_b32 a22, v172
    v_accvgpr_write_b32 a23, v174
    v_lshlrev_b32 v160, 16, v24
    v_and_b32 v161, 0xffff0000, v24
    v_lshlrev_b32 v162, 16, v25
    v_and_b32 v163, 0xffff0000, v25
    v_lshlrev_b32 v164, 16, v26
    v_and_b32 v165, 0xffff0000, v26
    v_lshlrev_b32 v166, 16, v27
    v_and_b32 v167, 0xffff0000, v27
    v_lshlrev_b32 v168, 16, v28
    v_and_b32 v169, 0xffff0000, v28
    v_lshlrev_b32 v170, 16, v29
    v_and_b32 v171, 0xffff0000, v29
    v_lshlrev_b32 v172, 16, v30
    v_and_b32 v173, 0xffff0000, v30
    v_lshlrev_b32 v174, 16, v31
    v_and_b32 v175, 0xffff0000, v31
    v_pk_add_f32 v[160:161], v[160:161], v[154:155] op_sel_hi:[1,0] neg_lo:[0,1] neg_hi:[0,1]
    v_pk_add_f32 v[162:163], v[162:163], v[154:155] op_sel_hi:[1,0] neg_lo:[0,1] neg_hi:[0,1]
    v_pk_add_f32 v[164:165], v[164:165], v[154:155] op_sel_hi:[1,0] neg_lo:[0,1] neg_hi:[0,1]
    v_pk_add_f32 v[166:167], v[166:167], v[154:155] op_sel_hi:[1,0] neg_lo:[0,1] neg_hi:[0,1]
    v_pk_add_f32 v[168:169], v[168:169], v[154:155] op_sel_hi:[1,0] neg_lo:[0,1] neg_hi:[0,1]
    v_pk_add_f32 v[170:171], v[170:171], v[154:155] op_sel_hi:[1,0] neg_lo:[0,1] neg_hi:[0,1]
    v_pk_add_f32 v[172:173], v[172:173], v[154:155] op_sel_hi:[1,0] neg_lo:[0,1] neg_hi:[0,1]
    v_pk_add_f32 v[174:175], v[174:175], v[154:155] op_sel_hi:[1,0] neg_lo:[0,1] neg_hi:[0,1]
    v_cvt_pk_bf16_f32 v24, v160, v161
    v_cvt_pk_bf16_f32 v25, v162, v163
    v_cvt_pk_bf16_f32 v26, v164, v165
    v_cvt_pk_bf16_f32 v27, v166, v167
    v_cvt_pk_bf16_f32 v28, v168, v169
    v_cvt_pk_bf16_f32 v29, v170, v171
    v_cvt_pk_bf16_f32 v30, v172, v173
    v_cvt_pk_bf16_f32 v31, v174, v175
    v_lshlrev_b32 v160, 16, v24
    v_and_b32 v161, 0xffff0000, v24
    v_lshlrev_b32 v162, 16, v25
    v_and_b32 v163, 0xffff0000, v25
    v_lshlrev_b32 v164, 16, v26
    v_and_b32 v165, 0xffff0000, v26
    v_lshlrev_b32 v166, 16, v27
    v_and_b32 v167, 0xffff0000, v27
    v_lshlrev_b32 v168, 16, v28
    v_and_b32 v169, 0xffff0000, v28
    v_lshlrev_b32 v170, 16, v29
    v_and_b32 v171, 0xffff0000, v29
    v_lshlrev_b32 v172, 16, v30
    v_and_b32 v173, 0xffff0000, v30
    v_lshlrev_b32 v174, 16, v31
    v_and_b32 v175, 0xffff0000, v31
    v_pk_mul_f32 v[160:161], v[160:161], v[152:153] op_sel_hi:[1,0]
    v_pk_mul_f32 v[162:163], v[162:163], v[152:153] op_sel_hi:[1,0]
    v_pk_mul_f32 v[164:165], v[164:165], v[152:153] op_sel_hi:[1,0]
    v_pk_mul_f32 v[166:167], v[166:167], v[152:153] op_sel_hi:[1,0]
    v_pk_mul_f32 v[168:169], v[168:169], v[152:153] op_sel_hi:[1,0]
    v_pk_mul_f32 v[170:171], v[170:171], v[152:153] op_sel_hi:[1,0]
    v_pk_mul_f32 v[172:173], v[172:173], v[152:153] op_sel_hi:[1,0]
    v_pk_mul_f32 v[174:175], v[174:175], v[152:153] op_sel_hi:[1,0]
    v_cvt_pk_bf16_f32 v160, v160, v161
    v_cvt_pk_bf16_f32 v162, v162, v163
    v_cvt_pk_bf16_f32 v164, v164, v165
    v_cvt_pk_bf16_f32 v166, v166, v167
    v_cvt_pk_bf16_f32 v168, v168, v169
    v_cvt_pk_bf16_f32 v170, v170, v171
    v_cvt_pk_bf16_f32 v172, v172, v173
    v_cvt_pk_bf16_f32 v174, v174, v175
    v_accvgpr_write_b32 a24, v160
    v_accvgpr_write_b32 a25, v162
    v_accvgpr_write_b32 a26, v164
    v_accvgpr_write_b32 a27, v166
    v_accvgpr_write_b32 a28, v168
    v_accvgpr_write_b32 a29, v170
    v_accvgpr_write_b32 a30, v172
    v_accvgpr_write_b32 a31, v174
    v_lshlrev_b32 v160, 16, v32
    v_and_b32 v161, 0xffff0000, v32
    v_lshlrev_b32 v162, 16, v33
    v_and_b32 v163, 0xffff0000, v33
    v_lshlrev_b32 v164, 16, v34
    v_and_b32 v165, 0xffff0000, v34
    v_lshlrev_b32 v166, 16, v35
    v_and_b32 v167, 0xffff0000, v35
    v_lshlrev_b32 v168, 16, v36
    v_and_b32 v169, 0xffff0000, v36
    v_lshlrev_b32 v170, 16, v37
    v_and_b32 v171, 0xffff0000, v37
    v_lshlrev_b32 v172, 16, v38
    v_and_b32 v173, 0xffff0000, v38
    v_lshlrev_b32 v174, 16, v39
    v_and_b32 v175, 0xffff0000, v39
    v_pk_add_f32 v[160:161], v[160:161], v[154:155] op_sel_hi:[1,0] neg_lo:[0,1] neg_hi:[0,1]
    v_pk_add_f32 v[162:163], v[162:163], v[154:155] op_sel_hi:[1,0] neg_lo:[0,1] neg_hi:[0,1]
    v_pk_add_f32 v[164:165], v[164:165], v[154:155] op_sel_hi:[1,0] neg_lo:[0,1] neg_hi:[0,1]
    v_pk_add_f32 v[166:167], v[166:167], v[154:155] op_sel_hi:[1,0] neg_lo:[0,1] neg_hi:[0,1]
    v_pk_add_f32 v[168:169], v[168:169], v[154:155] op_sel_hi:[1,0] neg_lo:[0,1] neg_hi:[0,1]
    v_pk_add_f32 v[170:171], v[170:171], v[154:155] op_sel_hi:[1,0] neg_lo:[0,1] neg_hi:[0,1]
    v_pk_add_f32 v[172:173], v[172:173], v[154:155] op_sel_hi:[1,0] neg_lo:[0,1] neg_hi:[0,1]
    v_pk_add_f32 v[174:175], v[174:175], v[154:155] op_sel_hi:[1,0] neg_lo:[0,1] neg_hi:[0,1]
    v_cvt_pk_bf16_f32 v32, v160, v161
    v_cvt_pk_bf16_f32 v33, v162, v163
    v_cvt_pk_bf16_f32 v34, v164, v165
    v_cvt_pk_bf16_f32 v35, v166, v167
    v_cvt_pk_bf16_f32 v36, v168, v169
    v_cvt_pk_bf16_f32 v37, v170, v171
    v_cvt_pk_bf16_f32 v38, v172, v173
    v_cvt_pk_bf16_f32 v39, v174, v175
    v_lshlrev_b32 v160, 16, v32
    v_and_b32 v161, 0xffff0000, v32
    v_lshlrev_b32 v162, 16, v33
    v_and_b32 v163, 0xffff0000, v33
    v_lshlrev_b32 v164, 16, v34
    v_and_b32 v165, 0xffff0000, v34
    v_lshlrev_b32 v166, 16, v35
    v_and_b32 v167, 0xffff0000, v35
    v_lshlrev_b32 v168, 16, v36
    v_and_b32 v169, 0xffff0000, v36
    v_lshlrev_b32 v170, 16, v37
    v_and_b32 v171, 0xffff0000, v37
    v_lshlrev_b32 v172, 16, v38
    v_and_b32 v173, 0xffff0000, v38
    v_lshlrev_b32 v174, 16, v39
    v_and_b32 v175, 0xffff0000, v39
    v_pk_mul_f32 v[160:161], v[160:161], v[152:153] op_sel_hi:[1,0]
    v_pk_mul_f32 v[162:163], v[162:163], v[152:153] op_sel_hi:[1,0]
    v_pk_mul_f32 v[164:165], v[164:165], v[152:153] op_sel_hi:[1,0]
    v_pk_mul_f32 v[166:167], v[166:167], v[152:153] op_sel_hi:[1,0]
    v_pk_mul_f32 v[168:169], v[168:169], v[152:153] op_sel_hi:[1,0]
    v_pk_mul_f32 v[170:171], v[170:171], v[152:153] op_sel_hi:[1,0]
    v_pk_mul_f32 v[172:173], v[172:173], v[152:153] op_sel_hi:[1,0]
    v_pk_mul_f32 v[174:175], v[174:175], v[152:153] op_sel_hi:[1,0]
    v_cvt_pk_bf16_f32 v160, v160, v161
    v_cvt_pk_bf16_f32 v162, v162, v163
    v_cvt_pk_bf16_f32 v164, v164, v165
    v_cvt_pk_bf16_f32 v166, v166, v167
    v_cvt_pk_bf16_f32 v168, v168, v169
    v_cvt_pk_bf16_f32 v170, v170, v171
    v_cvt_pk_bf16_f32 v172, v172, v173
    v_cvt_pk_bf16_f32 v174, v174, v175
    v_accvgpr_write_b32 a32, v160
    v_accvgpr_write_b32 a33, v162
    v_accvgpr_write_b32 a34, v164
    v_accvgpr_write_b32 a35, v166
    v_accvgpr_write_b32 a36, v168
    v_accvgpr_write_b32 a37, v170
    v_accvgpr_write_b32 a38, v172
    v_accvgpr_write_b32 a39, v174
    v_lshlrev_b32 v160, 16, v40
    v_and_b32 v161, 0xffff0000, v40
    v_lshlrev_b32 v162, 16, v41
    v_and_b32 v163, 0xffff0000, v41
    v_lshlrev_b32 v164, 16, v42
    v_and_b32 v165, 0xffff0000, v42
    v_lshlrev_b32 v166, 16, v43
    v_and_b32 v167, 0xffff0000, v43
    v_lshlrev_b32 v168, 16, v44
    v_and_b32 v169, 0xffff0000, v44
    v_lshlrev_b32 v170, 16, v45
    v_and_b32 v171, 0xffff0000, v45
    v_lshlrev_b32 v172, 16, v46
    v_and_b32 v173, 0xffff0000, v46
    v_lshlrev_b32 v174, 16, v47
    v_and_b32 v175, 0xffff0000, v47
    v_pk_add_f32 v[160:161], v[160:161], v[154:155] op_sel_hi:[1,0] neg_lo:[0,1] neg_hi:[0,1]
    v_pk_add_f32 v[162:163], v[162:163], v[154:155] op_sel_hi:[1,0] neg_lo:[0,1] neg_hi:[0,1]
    v_pk_add_f32 v[164:165], v[164:165], v[154:155] op_sel_hi:[1,0] neg_lo:[0,1] neg_hi:[0,1]
    v_pk_add_f32 v[166:167], v[166:167], v[154:155] op_sel_hi:[1,0] neg_lo:[0,1] neg_hi:[0,1]
    v_pk_add_f32 v[168:169], v[168:169], v[154:155] op_sel_hi:[1,0] neg_lo:[0,1] neg_hi:[0,1]
    v_pk_add_f32 v[170:171], v[170:171], v[154:155] op_sel_hi:[1,0] neg_lo:[0,1] neg_hi:[0,1]
    v_pk_add_f32 v[172:173], v[172:173], v[154:155] op_sel_hi:[1,0] neg_lo:[0,1] neg_hi:[0,1]
    v_pk_add_f32 v[174:175], v[174:175], v[154:155] op_sel_hi:[1,0] neg_lo:[0,1] neg_hi:[0,1]
    v_cvt_pk_bf16_f32 v40, v160, v161
    v_cvt_pk_bf16_f32 v41, v162, v163
    v_cvt_pk_bf16_f32 v42, v164, v165
    v_cvt_pk_bf16_f32 v43, v166, v167
    v_cvt_pk_bf16_f32 v44, v168, v169
    v_cvt_pk_bf16_f32 v45, v170, v171
    v_cvt_pk_bf16_f32 v46, v172, v173
    v_cvt_pk_bf16_f32 v47, v174, v175
    v_lshlrev_b32 v160, 16, v40
    v_and_b32 v161, 0xffff0000, v40
    v_lshlrev_b32 v162, 16, v41
    v_and_b32 v163, 0xffff0000, v41
    v_lshlrev_b32 v164, 16, v42
    v_and_b32 v165, 0xffff0000, v42
    v_lshlrev_b32 v166, 16, v43
    v_and_b32 v167, 0xffff0000, v43
    v_lshlrev_b32 v168, 16, v44
    v_and_b32 v169, 0xffff0000, v44
    v_lshlrev_b32 v170, 16, v45
    v_and_b32 v171, 0xffff0000, v45
    v_lshlrev_b32 v172, 16, v46
    v_and_b32 v173, 0xffff0000, v46
    v_lshlrev_b32 v174, 16, v47
    v_and_b32 v175, 0xffff0000, v47
    v_pk_mul_f32 v[160:161], v[160:161], v[152:153] op_sel_hi:[1,0]
    v_pk_mul_f32 v[162:163], v[162:163], v[152:153] op_sel_hi:[1,0]
    v_pk_mul_f32 v[164:165], v[164:165], v[152:153] op_sel_hi:[1,0]
    v_pk_mul_f32 v[166:167], v[166:167], v[152:153] op_sel_hi:[1,0]
    v_pk_mul_f32 v[168:169], v[168:169], v[152:153] op_sel_hi:[1,0]
    v_pk_mul_f32 v[170:171], v[170:171], v[152:153] op_sel_hi:[1,0]
    v_pk_mul_f32 v[172:173], v[172:173], v[152:153] op_sel_hi:[1,0]
    v_pk_mul_f32 v[174:175], v[174:175], v[152:153] op_sel_hi:[1,0]
    v_cvt_pk_bf16_f32 v160, v160, v161
    v_cvt_pk_bf16_f32 v162, v162, v163
    v_cvt_pk_bf16_f32 v164, v164, v165
    v_cvt_pk_bf16_f32 v166, v166, v167
    v_cvt_pk_bf16_f32 v168, v168, v169
    v_cvt_pk_bf16_f32 v170, v170, v171
    v_cvt_pk_bf16_f32 v172, v172, v173
    v_cvt_pk_bf16_f32 v174, v174, v175
    v_accvgpr_write_b32 a40, v160
    v_accvgpr_write_b32 a41, v162
    v_accvgpr_write_b32 a42, v164
    v_accvgpr_write_b32 a43, v166
    v_accvgpr_write_b32 a44, v168
    v_accvgpr_write_b32 a45, v170
    v_accvgpr_write_b32 a46, v172
    v_accvgpr_write_b32 a47, v174
    v_lshlrev_b32 v160, 16, v48
    v_and_b32 v161, 0xffff0000, v48
    v_lshlrev_b32 v162, 16, v49
    v_and_b32 v163, 0xffff0000, v49
    v_lshlrev_b32 v164, 16, v50
    v_and_b32 v165, 0xffff0000, v50
    v_lshlrev_b32 v166, 16, v51
    v_and_b32 v167, 0xffff0000, v51
    v_lshlrev_b32 v168, 16, v52
    v_and_b32 v169, 0xffff0000, v52
    v_lshlrev_b32 v170, 16, v53
    v_and_b32 v171, 0xffff0000, v53
    v_lshlrev_b32 v172, 16, v54
    v_and_b32 v173, 0xffff0000, v54
    v_lshlrev_b32 v174, 16, v55
    v_and_b32 v175, 0xffff0000, v55
    v_pk_add_f32 v[160:161], v[160:161], v[154:155] op_sel_hi:[1,0] neg_lo:[0,1] neg_hi:[0,1]
    v_pk_add_f32 v[162:163], v[162:163], v[154:155] op_sel_hi:[1,0] neg_lo:[0,1] neg_hi:[0,1]
    v_pk_add_f32 v[164:165], v[164:165], v[154:155] op_sel_hi:[1,0] neg_lo:[0,1] neg_hi:[0,1]
    v_pk_add_f32 v[166:167], v[166:167], v[154:155] op_sel_hi:[1,0] neg_lo:[0,1] neg_hi:[0,1]
    v_pk_add_f32 v[168:169], v[168:169], v[154:155] op_sel_hi:[1,0] neg_lo:[0,1] neg_hi:[0,1]
    v_pk_add_f32 v[170:171], v[170:171], v[154:155] op_sel_hi:[1,0] neg_lo:[0,1] neg_hi:[0,1]
    v_pk_add_f32 v[172:173], v[172:173], v[154:155] op_sel_hi:[1,0] neg_lo:[0,1] neg_hi:[0,1]
    v_pk_add_f32 v[174:175], v[174:175], v[154:155] op_sel_hi:[1,0] neg_lo:[0,1] neg_hi:[0,1]
    v_cvt_pk_bf16_f32 v48, v160, v161
    v_cvt_pk_bf16_f32 v49, v162, v163
    v_cvt_pk_bf16_f32 v50, v164, v165
    v_cvt_pk_bf16_f32 v51, v166, v167
    v_cvt_pk_bf16_f32 v52, v168, v169
    v_cvt_pk_bf16_f32 v53, v170, v171
    v_cvt_pk_bf16_f32 v54, v172, v173
    v_cvt_pk_bf16_f32 v55, v174, v175
    v_lshlrev_b32 v160, 16, v48
    v_and_b32 v161, 0xffff0000, v48
    v_lshlrev_b32 v162, 16, v49
    v_and_b32 v163, 0xffff0000, v49
    v_lshlrev_b32 v164, 16, v50
    v_and_b32 v165, 0xffff0000, v50
    v_lshlrev_b32 v166, 16, v51
    v_and_b32 v167, 0xffff0000, v51
    v_lshlrev_b32 v168, 16, v52
    v_and_b32 v169, 0xffff0000, v52
    v_lshlrev_b32 v170, 16, v53
    v_and_b32 v171, 0xffff0000, v53
    v_lshlrev_b32 v172, 16, v54
    v_and_b32 v173, 0xffff0000, v54
    v_lshlrev_b32 v174, 16, v55
    v_and_b32 v175, 0xffff0000, v55
    v_pk_mul_f32 v[160:161], v[160:161], v[152:153] op_sel_hi:[1,0]
    v_pk_mul_f32 v[162:163], v[162:163], v[152:153] op_sel_hi:[1,0]
    v_pk_mul_f32 v[164:165], v[164:165], v[152:153] op_sel_hi:[1,0]
    v_pk_mul_f32 v[166:167], v[166:167], v[152:153] op_sel_hi:[1,0]
    v_pk_mul_f32 v[168:169], v[168:169], v[152:153] op_sel_hi:[1,0]
    v_pk_mul_f32 v[170:171], v[170:171], v[152:153] op_sel_hi:[1,0]
    v_pk_mul_f32 v[172:173], v[172:173], v[152:153] op_sel_hi:[1,0]
    v_pk_mul_f32 v[174:175], v[174:175], v[152:153] op_sel_hi:[1,0]
    v_cvt_pk_bf16_f32 v160, v160, v161
    v_cvt_pk_bf16_f32 v162, v162, v163
    v_cvt_pk_bf16_f32 v164, v164, v165
    v_cvt_pk_bf16_f32 v166, v166, v167
    v_cvt_pk_bf16_f32 v168, v168, v169
    v_cvt_pk_bf16_f32 v170, v170, v171
    v_cvt_pk_bf16_f32 v172, v172, v173
    v_cvt_pk_bf16_f32 v174, v174, v175
    v_accvgpr_write_b32 a48, v160
    v_accvgpr_write_b32 a49, v162
    v_accvgpr_write_b32 a50, v164
    v_accvgpr_write_b32 a51, v166
    v_accvgpr_write_b32 a52, v168
    v_accvgpr_write_b32 a53, v170
    v_accvgpr_write_b32 a54, v172
    v_accvgpr_write_b32 a55, v174
    v_lshlrev_b32 v160, 16, v56
    v_and_b32 v161, 0xffff0000, v56
    v_lshlrev_b32 v162, 16, v57
    v_and_b32 v163, 0xffff0000, v57
    v_lshlrev_b32 v164, 16, v58
    v_and_b32 v165, 0xffff0000, v58
    v_lshlrev_b32 v166, 16, v59
    v_and_b32 v167, 0xffff0000, v59
    v_lshlrev_b32 v168, 16, v60
    v_and_b32 v169, 0xffff0000, v60
    v_lshlrev_b32 v170, 16, v61
    v_and_b32 v171, 0xffff0000, v61
    v_lshlrev_b32 v172, 16, v62
    v_and_b32 v173, 0xffff0000, v62
    v_lshlrev_b32 v174, 16, v63
    v_and_b32 v175, 0xffff0000, v63
    v_pk_add_f32 v[160:161], v[160:161], v[154:155] op_sel_hi:[1,0] neg_lo:[0,1] neg_hi:[0,1]
    v_pk_add_f32 v[162:163], v[162:163], v[154:155] op_sel_hi:[1,0] neg_lo:[0,1] neg_hi:[0,1]
    v_pk_add_f32 v[164:165], v[164:165], v[154:155] op_sel_hi:[1,0] neg_lo:[0,1] neg_hi:[0,1]
    v_pk_add_f32 v[166:167], v[166:167], v[154:155] op_sel_hi:[1,0] neg_lo:[0,1] neg_hi:[0,1]
    v_pk_add_f32 v[168:169], v[168:169], v[154:155] op_sel_hi:[1,0] neg_lo:[0,1] neg_hi:[0,1]
    v_pk_add_f32 v[170:171], v[170:171], v[154:155] op_sel_hi:[1,0] neg_lo:[0,1] neg_hi:[0,1]
    v_pk_add_f32 v[172:173], v[172:173], v[154:155] op_sel_hi:[1,0] neg_lo:[0,1] neg_hi:[0,1]
    v_pk_add_f32 v[174:175], v[174:175], v[154:155] op_sel_hi:[1,0] neg_lo:[0,1] neg_hi:[0,1]
    v_cvt_pk_bf16_f32 v56, v160, v161
    v_cvt_pk_bf16_f32 v57, v162, v163
    v_cvt_pk_bf16_f32 v58, v164, v165
    v_cvt_pk_bf16_f32 v59, v166, v167
    v_cvt_pk_bf16_f32 v60, v168, v169
    v_cvt_pk_bf16_f32 v61, v170, v171
    v_cvt_pk_bf16_f32 v62, v172, v173
    v_cvt_pk_bf16_f32 v63, v174, v175
    v_lshlrev_b32 v160, 16, v56
    v_and_b32 v161, 0xffff0000, v56
    v_lshlrev_b32 v162, 16, v57
    v_and_b32 v163, 0xffff0000, v57
    v_lshlrev_b32 v164, 16, v58
    v_and_b32 v165, 0xffff0000, v58
    v_lshlrev_b32 v166, 16, v59
    v_and_b32 v167, 0xffff0000, v59
    v_lshlrev_b32 v168, 16, v60
    v_and_b32 v169, 0xffff0000, v60
    v_lshlrev_b32 v170, 16, v61
    v_and_b32 v171, 0xffff0000, v61
    v_lshlrev_b32 v172, 16, v62
    v_and_b32 v173, 0xffff0000, v62
    v_lshlrev_b32 v174, 16, v63
    v_and_b32 v175, 0xffff0000, v63
    v_pk_mul_f32 v[160:161], v[160:161], v[152:153] op_sel_hi:[1,0]
    v_pk_mul_f32 v[162:163], v[162:163], v[152:153] op_sel_hi:[1,0]
    v_pk_mul_f32 v[164:165], v[164:165], v[152:153] op_sel_hi:[1,0]
    v_pk_mul_f32 v[166:167], v[166:167], v[152:153] op_sel_hi:[1,0]
    v_pk_mul_f32 v[168:169], v[168:169], v[152:153] op_sel_hi:[1,0]
    v_pk_mul_f32 v[170:171], v[170:171], v[152:153] op_sel_hi:[1,0]
    v_pk_mul_f32 v[172:173], v[172:173], v[152:153] op_sel_hi:[1,0]
    v_pk_mul_f32 v[174:175], v[174:175], v[152:153] op_sel_hi:[1,0]
    v_cvt_pk_bf16_f32 v160, v160, v161
    v_cvt_pk_bf16_f32 v162, v162, v163
    v_cvt_pk_bf16_f32 v164, v164, v165
    v_cvt_pk_bf16_f32 v166, v166, v167
    v_cvt_pk_bf16_f32 v168, v168, v169
    v_cvt_pk_bf16_f32 v170, v170, v171
    v_cvt_pk_bf16_f32 v172, v172, v173
    v_cvt_pk_bf16_f32 v174, v174, v175
    v_accvgpr_write_b32 a56, v160
    v_accvgpr_write_b32 a57, v162
    v_accvgpr_write_b32 a58, v164
    v_accvgpr_write_b32 a59, v166
    v_accvgpr_write_b32 a60, v168
    v_accvgpr_write_b32 a61, v170
    v_accvgpr_write_b32 a62, v172
    v_accvgpr_write_b32 a63, v174
    s_waitcnt vmcnt(0)
    s_lshr_b32 s26, s39, 5
    s_cmp_eq_u32 s26, 0
    s_cselect_b64 s[16:17], s[30:31], s[34:35]
    s_cmp_eq_u32 s26, 1
    s_cselect_b64 s[16:17], s[32:33], s[16:17]
    s_and_b32 s17, s17, 0xffff
    s_cmp_lt_u32 s39, 96
    s_cselect_b32 s18, 0x400000, 0
    s_and_b32 s24, s39, 31
    s_lshl_b32 s24, s24, 8
    s_add_u32 s26, s24, 0x0
    s_add_u32 m0, s29, 0x0
    s_nop 0
    buffer_load_dwordx4 v136, s[16:19], s26 offen lds
    s_add_u32 s26, s24, 0x20000
    s_add_u32 m0, s29, 0x1000
    s_nop 0
    buffer_load_dwordx4 v136, s[16:19], s26 offen lds
    s_add_u32 s26, s24, 0x40000
    s_add_u32 m0, s29, 0x2000
    s_nop 0
    buffer_load_dwordx4 v136, s[16:19], s26 offen lds
    s_add_u32 s26, s24, 0x60000
    s_add_u32 m0, s29, 0x3000
    s_nop 0
    buffer_load_dwordx4 v136, s[16:19], s26 offen lds
    s_add_u32 s26, s24, 0x80000
    s_add_u32 m0, s29, 0x4000
    s_nop 0
    buffer_load_dwordx4 v136, s[16:19], s26 offen lds
    s_add_u32 s26, s24, 0xa0000
    s_add_u32 m0, s29, 0x5000
    s_nop 0
    buffer_load_dwordx4 v136, s[16:19], s26 offen lds
    s_add_u32 s26, s24, 0xc0000
    s_add_u32 m0, s29, 0x6000
    s_nop 0
    buffer_load_dwordx4 v136, s[16:19], s26 offen lds
    s_add_u32 s26, s24, 0xe0000
    s_add_u32 m0, s29, 0x7000
    s_nop 0
    buffer_load_dwordx4 v136, s[16:19], s26 offen lds
    s_add_u32 s26, s24, 0x100000
    s_add_u32 m0, s29, 0x8000
    s_nop 0
    buffer_load_dwordx4 v136, s[16:19], s26 offen lds
    s_add_u32 s26, s24, 0x120000
    s_add_u32 m0, s29, 0x9000
    s_nop 0
    buffer_load_dwordx4 v136, s[16:19], s26 offen lds
    s_add_u32 s26, s24, 0x140000
    s_add_u32 m0, s29, 0xa000
    s_nop 0
    buffer_load_dwordx4 v136, s[16:19], s26 offen lds
    s_add_u32 s26, s24, 0x160000
    s_add_u32 m0, s29, 0xb000
    s_nop 0
    buffer_load_dwordx4 v136, s[16:19], s26 offen lds
    s_add_u32 s26, s24, 0x180000
    s_add_u32 m0, s29, 0xc000
    s_nop 0
    buffer_load_dwordx4 v136, s[16:19], s26 offen lds
    s_add_u32 s26, s24, 0x1a0000
    s_add_u32 m0, s29, 0xd000
    s_nop 0
    buffer_load_dwordx4 v136, s[16:19], s26 offen lds
    s_add_u32 s26, s24, 0x1c0000
    s_add_u32 m0, s29, 0xe000
    s_nop 0
    buffer_load_dwordx4 v136, s[16:19], s26 offen lds
    s_add_u32 s26, s24, 0x1e0000
    s_add_u32 m0, s29, 0xf000
    s_nop 0
    buffer_load_dwordx4 v136, s[16:19], s26 offen lds
    s_add_u32 s26, s24, 0x200000
    s_add_u32 m0, s29, 0x10000
    s_nop 0
    buffer_load_dwordx4 v136, s[16:19], s26 offen lds
    s_add_u32 s26, s24, 0x220000
    s_add_u32 m0, s29, 0x11000
    s_nop 0
    buffer_load_dwordx4 v136, s[16:19], s26 offen lds
    s_add_u32 s26, s24, 0x240000
    s_add_u32 m0, s29, 0x12000
    s_nop 0
    buffer_load_dwordx4 v136, s[16:19], s26 offen lds
    s_add_u32 s26, s24, 0x260000
    s_add_u32 m0, s29, 0x13000
    s_nop 0
    buffer_load_dwordx4 v136, s[16:19], s26 offen lds
    s_add_u32 s26, s24, 0x280000
    s_add_u32 m0, s29, 0x14000
    s_nop 0
    buffer_load_dwordx4 v136, s[16:19], s26 offen lds
    s_add_u32 s26, s24, 0x2a0000
    s_add_u32 m0, s29, 0x15000
    s_nop 0
    buffer_load_dwordx4 v136, s[16:19], s26 offen lds
    s_add_u32 s26, s24, 0x2c0000
    s_add_u32 m0, s29, 0x16000
    s_nop 0
    buffer_load_dwordx4 v136, s[16:19], s26 offen lds
    s_add_u32 s26, s24, 0x2e0000
    s_add_u32 m0, s29, 0x17000
    s_nop 0
    buffer_load_dwordx4 v136, s[16:19], s26 offen lds
    v_pk_mov_b32 v[150:151], 0, 0
    v_pk_mov_b32 v[152:153], 0, 0
    v_dot2_f32_bf16 v150, v64, v158, v150
    v_dot2_f32_bf16 v152, v64, v64, v152
    v_dot2_f32_bf16 v151, v65, v158, v151
    v_dot2_f32_bf16 v153, v65, v65, v153
    v_dot2_f32_bf16 v150, v66, v158, v150
    v_dot2_f32_bf16 v152, v66, v66, v152
    v_dot2_f32_bf16 v151, v67, v158, v151
    v_dot2_f32_bf16 v153, v67, v67, v153
    v_dot2_f32_bf16 v150, v68, v158, v150
    v_dot2_f32_bf16 v152, v68, v68, v152
    v_dot2_f32_bf16 v151, v69, v158, v151
    v_dot2_f32_bf16 v153, v69, v69, v153
    v_dot2_f32_bf16 v150, v70, v158, v150
    v_dot2_f32_bf16 v152, v70, v70, v152
    v_dot2_f32_bf16 v151, v71, v158, v151
    v_dot2_f32_bf16 v153, v71, v71, v153
    v_dot2_f32_bf16 v150, v72, v158, v150
    v_dot2_f32_bf16 v152, v72, v72, v152
    v_dot2_f32_bf16 v151, v73, v158, v151
    v_dot2_f32_bf16 v153, v73, v73, v153
    v_dot2_f32_bf16 v150, v74, v158, v150
    v_dot2_f32_bf16 v152, v74, v74, v152
    v_dot2_f32_bf16 v151, v75, v158, v151
    v_dot2_f32_bf16 v153, v75, v75, v153
    v_dot2_f32_bf16 v150, v76, v158, v150
    v_dot2_f32_bf16 v152, v76, v76, v152
    v_dot2_f32_bf16 v151, v77, v158, v151
    v_dot2_f32_bf16 v153, v77, v77, v153
    v_dot2_f32_bf16 v150, v78, v158, v150
    v_dot2_f32_bf16 v152, v78, v78, v152
    v_dot2_f32_bf16 v151, v79, v158, v151
    v_dot2_f32_bf16 v153, v79, v79, v153
    v_dot2_f32_bf16 v150, v80, v158, v150
    v_dot2_f32_bf16 v152, v80, v80, v152
    v_dot2_f32_bf16 v151, v81, v158, v151
    v_dot2_f32_bf16 v153, v81, v81, v153
    v_dot2_f32_bf16 v150, v82, v158, v150
    v_dot2_f32_bf16 v152, v82, v82, v152
    v_dot2_f32_bf16 v151, v83, v158, v151
    v_dot2_f32_bf16 v153, v83, v83, v153
    v_dot2_f32_bf16 v150, v84, v158, v150
    v_dot2_f32_bf16 v152, v84, v84, v152
    v_dot2_f32_bf16 v151, v85, v158, v151
    v_dot2_f32_bf16 v153, v85, v85, v153
    v_dot2_f32_bf16 v150, v86, v158, v150
    v_dot2_f32_bf16 v152, v86, v86, v152
    v_dot2_f32_bf16 v151, v87, v158, v151
    v_dot2_f32_bf16 v153, v87, v87, v153
    v_dot2_f32_bf16 v150, v88, v158, v150
    v_dot2_f32_bf16 v152, v88, v88, v152
    v_dot2_f32_bf16 v151, v89, v158, v151
    v_dot2_f32_bf16 v153, v89, v89, v153
    v_dot2_f32_bf16 v150, v90, v158, v150
    v_dot2_f32_bf16 v152, v90, v90, v152
    v_dot2_f32_bf16 v151, v91, v158, v151
    v_dot2_f32_bf16 v153, v91, v91, v153
    v_dot2_f32_bf16 v150, v92, v158, v150
    v_dot2_f32_bf16 v152, v92, v92, v152
    v_dot2_f32_bf16 v151, v93, v158, v151
    v_dot2_f32_bf16 v153, v93, v93, v153
    v_dot2_f32_bf16 v150, v94, v158, v150
    v_dot2_f32_bf16 v152, v94, v94, v152
    v_dot2_f32_bf16 v151, v95, v158, v151
    v_dot2_f32_bf16 v153, v95, v95, v153
    v_dot2_f32_bf16 v150, v96, v158, v150
    v_dot2_f32_bf16 v152, v96, v96, v152
    v_dot2_f32_bf16 v151, v97, v158, v151
    v_dot2_f32_bf16 v153, v97, v97, v153
    v_dot2_f32_bf16 v150, v98, v158, v150
    v_dot2_f32_bf16 v152, v98, v98, v152
    v_dot2_f32_bf16 v151, v99, v158, v151
    v_dot2_f32_bf16 v153, v99, v99, v153
    v_dot2_f32_bf16 v150, v100, v158, v150
    v_dot2_f32_bf16 v152, v100, v100, v152
    v_dot2_f32_bf16 v151, v101, v158, v151
    v_dot2_f32_bf16 v153, v101, v101, v153
    v_dot2_f32_bf16 v150, v102, v158, v150
    v_dot2_f32_bf16 v152, v102, v102, v152
    v_dot2_f32_bf16 v151, v103, v158, v151
    v_dot2_f32_bf16 v153, v103, v103, v153
    v_dot2_f32_bf16 v150, v104, v158, v150
    v_dot2_f32_bf16 v152, v104, v104, v152
    v_dot2_f32_bf16 v151, v105, v158, v151
    v_dot2_f32_bf16 v153, v105, v105, v153
    v_dot2_f32_bf16 v150, v106, v158, v150
    v_dot2_f32_bf16 v152, v106, v106, v152
    v_dot2_f32_bf16 v151, v107, v158, v151
    v_dot2_f32_bf16 v153, v107, v107, v153
    v_dot2_f32_bf16 v150, v108, v158, v150
    v_dot2_f32_bf16 v152, v108, v108, v152
    v_dot2_f32_bf16 v151, v109, v158, v151
    v_dot2_f32_bf16 v153, v109, v109, v153
    v_dot2_f32_bf16 v150, v110, v158, v150
    v_dot2_f32_bf16 v152, v110, v110, v152
    v_dot2_f32_bf16 v151, v111, v158, v151
    v_dot2_f32_bf16 v153, v111, v111, v153
    v_dot2_f32_bf16 v150, v112, v158, v150
    v_dot2_f32_bf16 v152, v112, v112, v152
    v_dot2_f32_bf16 v151, v113, v158, v151
    v_dot2_f32_bf16 v153, v113, v113, v153
    v_dot2_f32_bf16 v150, v114, v158, v150
    v_dot2_f32_bf16 v152, v114, v114, v152
    v_dot2_f32_bf16 v151, v115, v158, v151
    v_dot2_f32_bf16 v153, v115, v115, v153
    v_dot2_f32_bf16 v150, v116, v158, v150
    v_dot2_f32_bf16 v152, v116, v116, v152
    v_dot2_f32_bf16 v151, v117, v158, v151
    v_dot2_f32_bf16 v153, v117, v117, v153
    v_dot2_f32_bf16 v150, v118, v158, v150
    v_dot2_f32_bf16 v152, v118, v118, v152
    v_dot2_f32_bf16 v151, v119, v158, v151
    v_dot2_f32_bf16 v153, v119, v119, v153
    v_dot2_f32_bf16 v150, v120, v158, v150
    v_dot2_f32_bf16 v152, v120, v120, v152
    v_dot2_f32_bf16 v151, v121, v158, v151
    v_dot2_f32_bf16 v153, v121, v121, v153
    v_dot2_f32_bf16 v150, v122, v158, v150
    v_dot2_f32_bf16 v152, v122, v122, v152
    v_dot2_f32_bf16 v151, v123, v158, v151
    v_dot2_f32_bf16 v153, v123, v123, v153
    v_dot2_f32_bf16 v150, v124, v158, v150
    v_dot2_f32_bf16 v152, v124, v124, v152
    v_dot2_f32_bf16 v151, v125, v158, v151
    v_dot2_f32_bf16 v153, v125, v125, v153
    v_dot2_f32_bf16 v150, v126, v158, v150
    v_dot2_f32_bf16 v152, v126, v126, v152
    v_dot2_f32_bf16 v151, v127, v158, v151
    v_dot2_f32_bf16 v153, v127, v127, v153
    s_nop 1
    v_add_f32 v150, v150, v151
    v_add_f32 v152, v152, v153
    v_mov_b32 v157, v150
    s_nop 1
    v_permlane32_swap_b32 v157, v150
    v_add_f32 v150, v157, v150
    v_mov_b32 v157, v150
    s_nop 1
    v_permlane16_swap_b32 v157, v150
    v_add_f32 v150, v157, v150
    v_mov_b32 v157, v152
    s_nop 1
    v_permlane32_swap_b32 v157, v152
    v_add_f32 v152, v157, v152
    v_mov_b32 v157, v152
    s_nop 1
    v_permlane16_swap_b32 v157, v152
    v_add_f32 v152, v157, v152
    v_mul_f32 v150, 0x3b000000, v150
    v_cvt_pk_bf16_f32 v154, v150, v150
    v_and_b32 v154, 0xffff0000, v154
    v_sub_f32 v156, v150, v154
    v_mul_f32 v157, v150, v150
    v_mul_f32 v152, 0x3b000000, v152
    v_sub_f32 v152, v152, v157
    v_max_f32 v152, 0, v152
    v_cvt_pk_bf16_f32 v152, v152, v152
    v_and_b32 v152, 0xffff0000, v152
    v_add_f32 v152, 0x3727c5ac, v152
    v_cvt_pk_bf16_f32 v152, v152, v152
    v_and_b32 v152, 0xffff0000, v152
    v_sqrt_f32 v152, v152
    s_nop 0
    v_cvt_pk_bf16_f32 v152, v152, v152
    v_and_b32 v152, 0xffff0000, v152
    v_rcp_f32 v152, v152
    v_lshlrev_b32 v160, 16, v64
    v_and_b32 v161, 0xffff0000, v64
    v_lshlrev_b32 v162, 16, v65
    v_and_b32 v163, 0xffff0000, v65
    v_lshlrev_b32 v164, 16, v66
    v_and_b32 v165, 0xffff0000, v66
    v_lshlrev_b32 v166, 16, v67
    v_and_b32 v167, 0xffff0000, v67
    v_lshlrev_b32 v168, 16, v68
    v_and_b32 v169, 0xffff0000, v68
    v_lshlrev_b32 v170, 16, v69
    v_and_b32 v171, 0xffff0000, v69
    v_lshlrev_b32 v172, 16, v70
    v_and_b32 v173, 0xffff0000, v70
    v_lshlrev_b32 v174, 16, v71
    v_and_b32 v175, 0xffff0000, v71
    v_pk_add_f32 v[160:161], v[160:161], v[154:155] op_sel_hi:[1,0] neg_lo:[0,1] neg_hi:[0,1]
    v_pk_add_f32 v[162:163], v[162:163], v[154:155] op_sel_hi:[1,0] neg_lo:[0,1] neg_hi:[0,1]
    v_pk_add_f32 v[164:165], v[164:165], v[154:155] op_sel_hi:[1,0] neg_lo:[0,1] neg_hi:[0,1]
    v_pk_add_f32 v[166:167], v[166:167], v[154:155] op_sel_hi:[1,0] neg_lo:[0,1] neg_hi:[0,1]
    v_pk_add_f32 v[168:169], v[168:169], v[154:155] op_sel_hi:[1,0] neg_lo:[0,1] neg_hi:[0,1]
    v_pk_add_f32 v[170:171], v[170:171], v[154:155] op_sel_hi:[1,0] neg_lo:[0,1] neg_hi:[0,1]
    v_pk_add_f32 v[172:173], v[172:173], v[154:155] op_sel_hi:[1,0] neg_lo:[0,1] neg_hi:[0,1]
    v_pk_add_f32 v[174:175], v[174:175], v[154:155] op_sel_hi:[1,0] neg_lo:[0,1] neg_hi:[0,1]
    v_cvt_pk_bf16_f32 v64, v160, v161
    v_cvt_pk_bf16_f32 v65, v162, v163
    v_cvt_pk_bf16_f32 v66, v164, v165
    v_cvt_pk_bf16_f32 v67, v166, v167
    v_cvt_pk_bf16_f32 v68, v168, v169
    v_cvt_pk_bf16_f32 v69, v170, v171
    v_cvt_pk_bf16_f32 v70, v172, v173
    v_cvt_pk_bf16_f32 v71, v174, v175
    v_lshlrev_b32 v160, 16, v64
    v_and_b32 v161, 0xffff0000, v64
    v_lshlrev_b32 v162, 16, v65
    v_and_b32 v163, 0xffff0000, v65
    v_lshlrev_b32 v164, 16, v66
    v_and_b32 v165, 0xffff0000, v66
    v_lshlrev_b32 v166, 16, v67
    v_and_b32 v167, 0xffff0000, v67
    v_lshlrev_b32 v168, 16, v68
    v_and_b32 v169, 0xffff0000, v68
    v_lshlrev_b32 v170, 16, v69
    v_and_b32 v171, 0xffff0000, v69
    v_lshlrev_b32 v172, 16, v70
    v_and_b32 v173, 0xffff0000, v70
    v_lshlrev_b32 v174, 16, v71
    v_and_b32 v175, 0xffff0000, v71
    v_pk_mul_f32 v[160:161], v[160:161], v[152:153] op_sel_hi:[1,0]
    v_pk_mul_f32 v[162:163], v[162:163], v[152:153] op_sel_hi:[1,0]
    v_pk_mul_f32 v[164:165], v[164:165], v[152:153] op_sel_hi:[1,0]
    v_pk_mul_f32 v[166:167], v[166:167], v[152:153] op_sel_hi:[1,0]
    v_pk_mul_f32 v[168:169], v[168:169], v[152:153] op_sel_hi:[1,0]
    v_pk_mul_f32 v[170:171], v[170:171], v[152:153] op_sel_hi:[1,0]
    v_pk_mul_f32 v[172:173], v[172:173], v[152:153] op_sel_hi:[1,0]
    v_pk_mul_f32 v[174:175], v[174:175], v[152:153] op_sel_hi:[1,0]
    v_cvt_pk_bf16_f32 v160, v160, v161
    v_cvt_pk_bf16_f32 v162, v162, v163
    v_cvt_pk_bf16_f32 v164, v164, v165
    v_cvt_pk_bf16_f32 v166, v166, v167
    v_cvt_pk_bf16_f32 v168, v168, v169
    v_cvt_pk_bf16_f32 v170, v170, v171
    v_cvt_pk_bf16_f32 v172, v172, v173
    v_cvt_pk_bf16_f32 v174, v174, v175
    v_accvgpr_write_b32 a64, v160
    v_accvgpr_write_b32 a65, v162
    v_accvgpr_write_b32 a66, v164
    v_accvgpr_write_b32 a67, v166
    v_accvgpr_write_b32 a68, v168
    v_accvgpr_write_b32 a69, v170
    v_accvgpr_write_b32 a70, v172
    v_accvgpr_write_b32 a71, v174
    v_lshlrev_b32 v160, 16, v72
    v_and_b32 v161, 0xffff0000, v72
    v_lshlrev_b32 v162, 16, v73
    v_and_b32 v163, 0xffff0000, v73
    v_lshlrev_b32 v164, 16, v74
    v_and_b32 v165, 0xffff0000, v74
    v_lshlrev_b32 v166, 16, v75
    v_and_b32 v167, 0xffff0000, v75
    v_lshlrev_b32 v168, 16, v76
    v_and_b32 v169, 0xffff0000, v76
    v_lshlrev_b32 v170, 16, v77
    v_and_b32 v171, 0xffff0000, v77
    v_lshlrev_b32 v172, 16, v78
    v_and_b32 v173, 0xffff0000, v78
    v_lshlrev_b32 v174, 16, v79
    v_and_b32 v175, 0xffff0000, v79
    v_pk_add_f32 v[160:161], v[160:161], v[154:155] op_sel_hi:[1,0] neg_lo:[0,1] neg_hi:[0,1]
    v_pk_add_f32 v[162:163], v[162:163], v[154:155] op_sel_hi:[1,0] neg_lo:[0,1] neg_hi:[0,1]
    v_pk_add_f32 v[164:165], v[164:165], v[154:155] op_sel_hi:[1,0] neg_lo:[0,1] neg_hi:[0,1]
    v_pk_add_f32 v[166:167], v[166:167], v[154:155] op_sel_hi:[1,0] neg_lo:[0,1] neg_hi:[0,1]
    v_pk_add_f32 v[168:169], v[168:169], v[154:155] op_sel_hi:[1,0] neg_lo:[0,1] neg_hi:[0,1]
    v_pk_add_f32 v[170:171], v[170:171], v[154:155] op_sel_hi:[1,0] neg_lo:[0,1] neg_hi:[0,1]
    v_pk_add_f32 v[172:173], v[172:173], v[154:155] op_sel_hi:[1,0] neg_lo:[0,1] neg_hi:[0,1]
    v_pk_add_f32 v[174:175], v[174:175], v[154:155] op_sel_hi:[1,0] neg_lo:[0,1] neg_hi:[0,1]
    v_cvt_pk_bf16_f32 v72, v160, v161
    v_cvt_pk_bf16_f32 v73, v162, v163
    v_cvt_pk_bf16_f32 v74, v164, v165
    v_cvt_pk_bf16_f32 v75, v166, v167
    v_cvt_pk_bf16_f32 v76, v168, v169
    v_cvt_pk_bf16_f32 v77, v170, v171
    v_cvt_pk_bf16_f32 v78, v172, v173
    v_cvt_pk_bf16_f32 v79, v174, v175
    v_lshlrev_b32 v160, 16, v72
    v_and_b32 v161, 0xffff0000, v72
    v_lshlrev_b32 v162, 16, v73
    v_and_b32 v163, 0xffff0000, v73
    v_lshlrev_b32 v164, 16, v74
    v_and_b32 v165, 0xffff0000, v74
    v_lshlrev_b32 v166, 16, v75
    v_and_b32 v167, 0xffff0000, v75
    v_lshlrev_b32 v168, 16, v76
    v_and_b32 v169, 0xffff0000, v76
    v_lshlrev_b32 v170, 16, v77
    v_and_b32 v171, 0xffff0000, v77
    v_lshlrev_b32 v172, 16, v78
    v_and_b32 v173, 0xffff0000, v78
    v_lshlrev_b32 v174, 16, v79
    v_and_b32 v175, 0xffff0000, v79
    v_pk_mul_f32 v[160:161], v[160:161], v[152:153] op_sel_hi:[1,0]
    v_pk_mul_f32 v[162:163], v[162:163], v[152:153] op_sel_hi:[1,0]
    v_pk_mul_f32 v[164:165], v[164:165], v[152:153] op_sel_hi:[1,0]
    v_pk_mul_f32 v[166:167], v[166:167], v[152:153] op_sel_hi:[1,0]
    v_pk_mul_f32 v[168:169], v[168:169], v[152:153] op_sel_hi:[1,0]
    v_pk_mul_f32 v[170:171], v[170:171], v[152:153] op_sel_hi:[1,0]
    v_pk_mul_f32 v[172:173], v[172:173], v[152:153] op_sel_hi:[1,0]
    v_pk_mul_f32 v[174:175], v[174:175], v[152:153] op_sel_hi:[1,0]
    v_cvt_pk_bf16_f32 v160, v160, v161
    v_cvt_pk_bf16_f32 v162, v162, v163
    v_cvt_pk_bf16_f32 v164, v164, v165
    v_cvt_pk_bf16_f32 v166, v166, v167
    v_cvt_pk_bf16_f32 v168, v168, v169
    v_cvt_pk_bf16_f32 v170, v170, v171
    v_cvt_pk_bf16_f32 v172, v172, v173
    v_cvt_pk_bf16_f32 v174, v174, v175
    v_accvgpr_write_b32 a72, v160
    v_accvgpr_write_b32 a73, v162
    v_accvgpr_write_b32 a74, v164
    v_accvgpr_write_b32 a75, v166
    v_accvgpr_write_b32 a76, v168
    v_accvgpr_write_b32 a77, v170
    v_accvgpr_write_b32 a78, v172
    v_accvgpr_write_b32 a79, v174
    v_lshlrev_b32 v160, 16, v80
    v_and_b32 v161, 0xffff0000, v80
    v_lshlrev_b32 v162, 16, v81
    v_and_b32 v163, 0xffff0000, v81
    v_lshlrev_b32 v164, 16, v82
    v_and_b32 v165, 0xffff0000, v82
    v_lshlrev_b32 v166, 16, v83
    v_and_b32 v167, 0xffff0000, v83
    v_lshlrev_b32 v168, 16, v84
    v_and_b32 v169, 0xffff0000, v84
    v_lshlrev_b32 v170, 16, v85
    v_and_b32 v171, 0xffff0000, v85
    v_lshlrev_b32 v172, 16, v86
    v_and_b32 v173, 0xffff0000, v86
    v_lshlrev_b32 v174, 16, v87
    v_and_b32 v175, 0xffff0000, v87
    v_pk_add_f32 v[160:161], v[160:161], v[154:155] op_sel_hi:[1,0] neg_lo:[0,1] neg_hi:[0,1]
    v_pk_add_f32 v[162:163], v[162:163], v[154:155] op_sel_hi:[1,0] neg_lo:[0,1] neg_hi:[0,1]
    v_pk_add_f32 v[164:165], v[164:165], v[154:155] op_sel_hi:[1,0] neg_lo:[0,1] neg_hi:[0,1]
    v_pk_add_f32 v[166:167], v[166:167], v[154:155] op_sel_hi:[1,0] neg_lo:[0,1] neg_hi:[0,1]
    v_pk_add_f32 v[168:169], v[168:169], v[154:155] op_sel_hi:[1,0] neg_lo:[0,1] neg_hi:[0,1]
    v_pk_add_f32 v[170:171], v[170:171], v[154:155] op_sel_hi:[1,0] neg_lo:[0,1] neg_hi:[0,1]
    v_pk_add_f32 v[172:173], v[172:173], v[154:155] op_sel_hi:[1,0] neg_lo:[0,1] neg_hi:[0,1]
    v_pk_add_f32 v[174:175], v[174:175], v[154:155] op_sel_hi:[1,0] neg_lo:[0,1] neg_hi:[0,1]
    v_cvt_pk_bf16_f32 v80, v160, v161
    v_cvt_pk_bf16_f32 v81, v162, v163
    v_cvt_pk_bf16_f32 v82, v164, v165
    v_cvt_pk_bf16_f32 v83, v166, v167
    v_cvt_pk_bf16_f32 v84, v168, v169
    v_cvt_pk_bf16_f32 v85, v170, v171
    v_cvt_pk_bf16_f32 v86, v172, v173
    v_cvt_pk_bf16_f32 v87, v174, v175
    v_lshlrev_b32 v160, 16, v80
    v_and_b32 v161, 0xffff0000, v80
    v_lshlrev_b32 v162, 16, v81
    v_and_b32 v163, 0xffff0000, v81
    v_lshlrev_b32 v164, 16, v82
    v_and_b32 v165, 0xffff0000, v82
    v_lshlrev_b32 v166, 16, v83
    v_and_b32 v167, 0xffff0000, v83
    v_lshlrev_b32 v168, 16, v84
    v_and_b32 v169, 0xffff0000, v84
    v_lshlrev_b32 v170, 16, v85
    v_and_b32 v171, 0xffff0000, v85
    v_lshlrev_b32 v172, 16, v86
    v_and_b32 v173, 0xffff0000, v86
    v_lshlrev_b32 v174, 16, v87
    v_and_b32 v175, 0xffff0000, v87
    v_pk_mul_f32 v[160:161], v[160:161], v[152:153] op_sel_hi:[1,0]
    v_pk_mul_f32 v[162:163], v[162:163], v[152:153] op_sel_hi:[1,0]
    v_pk_mul_f32 v[164:165], v[164:165], v[152:153] op_sel_hi:[1,0]
    v_pk_mul_f32 v[166:167], v[166:167], v[152:153] op_sel_hi:[1,0]
    v_pk_mul_f32 v[168:169], v[168:169], v[152:153] op_sel_hi:[1,0]
    v_pk_mul_f32 v[170:171], v[170:171], v[152:153] op_sel_hi:[1,0]
    v_pk_mul_f32 v[172:173], v[172:173], v[152:153] op_sel_hi:[1,0]
    v_pk_mul_f32 v[174:175], v[174:175], v[152:153] op_sel_hi:[1,0]
    v_cvt_pk_bf16_f32 v160, v160, v161
    v_cvt_pk_bf16_f32 v162, v162, v163
    v_cvt_pk_bf16_f32 v164, v164, v165
    v_cvt_pk_bf16_f32 v166, v166, v167
    v_cvt_pk_bf16_f32 v168, v168, v169
    v_cvt_pk_bf16_f32 v170, v170, v171
    v_cvt_pk_bf16_f32 v172, v172, v173
    v_cvt_pk_bf16_f32 v174, v174, v175
    v_accvgpr_write_b32 a80, v160
    v_accvgpr_write_b32 a81, v162
    v_accvgpr_write_b32 a82, v164
    v_accvgpr_write_b32 a83, v166
    v_accvgpr_write_b32 a84, v168
    v_accvgpr_write_b32 a85, v170
    v_accvgpr_write_b32 a86, v172
    v_accvgpr_write_b32 a87, v174
    v_lshlrev_b32 v160, 16, v88
    v_and_b32 v161, 0xffff0000, v88
    v_lshlrev_b32 v162, 16, v89
    v_and_b32 v163, 0xffff0000, v89
    v_lshlrev_b32 v164, 16, v90
    v_and_b32 v165, 0xffff0000, v90
    v_lshlrev_b32 v166, 16, v91
    v_and_b32 v167, 0xffff0000, v91
    v_lshlrev_b32 v168, 16, v92
    v_and_b32 v169, 0xffff0000, v92
    v_lshlrev_b32 v170, 16, v93
    v_and_b32 v171, 0xffff0000, v93
    v_lshlrev_b32 v172, 16, v94
    v_and_b32 v173, 0xffff0000, v94
    v_lshlrev_b32 v174, 16, v95
    v_and_b32 v175, 0xffff0000, v95
    v_pk_add_f32 v[160:161], v[160:161], v[154:155] op_sel_hi:[1,0] neg_lo:[0,1] neg_hi:[0,1]
    v_pk_add_f32 v[162:163], v[162:163], v[154:155] op_sel_hi:[1,0] neg_lo:[0,1] neg_hi:[0,1]
    v_pk_add_f32 v[164:165], v[164:165], v[154:155] op_sel_hi:[1,0] neg_lo:[0,1] neg_hi:[0,1]
    v_pk_add_f32 v[166:167], v[166:167], v[154:155] op_sel_hi:[1,0] neg_lo:[0,1] neg_hi:[0,1]
    v_pk_add_f32 v[168:169], v[168:169], v[154:155] op_sel_hi:[1,0] neg_lo:[0,1] neg_hi:[0,1]
    v_pk_add_f32 v[170:171], v[170:171], v[154:155] op_sel_hi:[1,0] neg_lo:[0,1] neg_hi:[0,1]
    v_pk_add_f32 v[172:173], v[172:173], v[154:155] op_sel_hi:[1,0] neg_lo:[0,1] neg_hi:[0,1]
    v_pk_add_f32 v[174:175], v[174:175], v[154:155] op_sel_hi:[1,0] neg_lo:[0,1] neg_hi:[0,1]
    v_cvt_pk_bf16_f32 v88, v160, v161
    v_cvt_pk_bf16_f32 v89, v162, v163
    v_cvt_pk_bf16_f32 v90, v164, v165
    v_cvt_pk_bf16_f32 v91, v166, v167
    v_cvt_pk_bf16_f32 v92, v168, v169
    v_cvt_pk_bf16_f32 v93, v170, v171
    v_cvt_pk_bf16_f32 v94, v172, v173
    v_cvt_pk_bf16_f32 v95, v174, v175
    v_lshlrev_b32 v160, 16, v88
    v_and_b32 v161, 0xffff0000, v88
    v_lshlrev_b32 v162, 16, v89
    v_and_b32 v163, 0xffff0000, v89
    v_lshlrev_b32 v164, 16, v90
    v_and_b32 v165, 0xffff0000, v90
    v_lshlrev_b32 v166, 16, v91
    v_and_b32 v167, 0xffff0000, v91
    v_lshlrev_b32 v168, 16, v92
    v_and_b32 v169, 0xffff0000, v92
    v_lshlrev_b32 v170, 16, v93
    v_and_b32 v171, 0xffff0000, v93
    v_lshlrev_b32 v172, 16, v94
    v_and_b32 v173, 0xffff0000, v94
    v_lshlrev_b32 v174, 16, v95
    v_and_b32 v175, 0xffff0000, v95
    v_pk_mul_f32 v[160:161], v[160:161], v[152:153] op_sel_hi:[1,0]
    v_pk_mul_f32 v[162:163], v[162:163], v[152:153] op_sel_hi:[1,0]
    v_pk_mul_f32 v[164:165], v[164:165], v[152:153] op_sel_hi:[1,0]
    v_pk_mul_f32 v[166:167], v[166:167], v[152:153] op_sel_hi:[1,0]
    v_pk_mul_f32 v[168:169], v[168:169], v[152:153] op_sel_hi:[1,0]
    v_pk_mul_f32 v[170:171], v[170:171], v[152:153] op_sel_hi:[1,0]
    v_pk_mul_f32 v[172:173], v[172:173], v[152:153] op_sel_hi:[1,0]
    v_pk_mul_f32 v[174:175], v[174:175], v[152:153] op_sel_hi:[1,0]
    v_cvt_pk_bf16_f32 v160, v160, v161
    v_cvt_pk_bf16_f32 v162, v162, v163
    v_cvt_pk_bf16_f32 v164, v164, v165
    v_cvt_pk_bf16_f32 v166, v166, v167
    v_cvt_pk_bf16_f32 v168, v168, v169
    v_cvt_pk_bf16_f32 v170, v170, v171
    v_cvt_pk_bf16_f32 v172, v172, v173
    v_cvt_pk_bf16_f32 v174, v174, v175
    v_accvgpr_write_b32 a88, v160
    v_accvgpr_write_b32 a89, v162
    v_accvgpr_write_b32 a90, v164
    v_accvgpr_write_b32 a91, v166
    v_accvgpr_write_b32 a92, v168
    v_accvgpr_write_b32 a93, v170
    v_accvgpr_write_b32 a94, v172
    v_accvgpr_write_b32 a95, v174
    v_lshlrev_b32 v160, 16, v96
    v_and_b32 v161, 0xffff0000, v96
    v_lshlrev_b32 v162, 16, v97
    v_and_b32 v163, 0xffff0000, v97
    v_lshlrev_b32 v164, 16, v98
    v_and_b32 v165, 0xffff0000, v98
    v_lshlrev_b32 v166, 16, v99
    v_and_b32 v167, 0xffff0000, v99
    v_lshlrev_b32 v168, 16, v100
    v_and_b32 v169, 0xffff0000, v100
    v_lshlrev_b32 v170, 16, v101
    v_and_b32 v171, 0xffff0000, v101
    v_lshlrev_b32 v172, 16, v102
    v_and_b32 v173, 0xffff0000, v102
    v_lshlrev_b32 v174, 16, v103
    v_and_b32 v175, 0xffff0000, v103
    v_pk_add_f32 v[160:161], v[160:161], v[154:155] op_sel_hi:[1,0] neg_lo:[0,1] neg_hi:[0,1]
    v_pk_add_f32 v[162:163], v[162:163], v[154:155] op_sel_hi:[1,0] neg_lo:[0,1] neg_hi:[0,1]
    v_pk_add_f32 v[164:165], v[164:165], v[154:155] op_sel_hi:[1,0] neg_lo:[0,1] neg_hi:[0,1]
    v_pk_add_f32 v[166:167], v[166:167], v[154:155] op_sel_hi:[1,0] neg_lo:[0,1] neg_hi:[0,1]
    v_pk_add_f32 v[168:169], v[168:169], v[154:155] op_sel_hi:[1,0] neg_lo:[0,1] neg_hi:[0,1]
    v_pk_add_f32 v[170:171], v[170:171], v[154:155] op_sel_hi:[1,0] neg_lo:[0,1] neg_hi:[0,1]
    v_pk_add_f32 v[172:173], v[172:173], v[154:155] op_sel_hi:[1,0] neg_lo:[0,1] neg_hi:[0,1]
    v_pk_add_f32 v[174:175], v[174:175], v[154:155] op_sel_hi:[1,0] neg_lo:[0,1] neg_hi:[0,1]
    v_cvt_pk_bf16_f32 v96, v160, v161
    v_cvt_pk_bf16_f32 v97, v162, v163
    v_cvt_pk_bf16_f32 v98, v164, v165
    v_cvt_pk_bf16_f32 v99, v166, v167
    v_cvt_pk_bf16_f32 v100, v168, v169
    v_cvt_pk_bf16_f32 v101, v170, v171
    v_cvt_pk_bf16_f32 v102, v172, v173
    v_cvt_pk_bf16_f32 v103, v174, v175
    v_lshlrev_b32 v160, 16, v96
    v_and_b32 v161, 0xffff0000, v96
    v_lshlrev_b32 v162, 16, v97
    v_and_b32 v163, 0xffff0000, v97
    v_lshlrev_b32 v164, 16, v98
    v_and_b32 v165, 0xffff0000, v98
    v_lshlrev_b32 v166, 16, v99
    v_and_b32 v167, 0xffff0000, v99
    v_lshlrev_b32 v168, 16, v100
    v_and_b32 v169, 0xffff0000, v100
    v_lshlrev_b32 v170, 16, v101
    v_and_b32 v171, 0xffff0000, v101
    v_lshlrev_b32 v172, 16, v102
    v_and_b32 v173, 0xffff0000, v102
    v_lshlrev_b32 v174, 16, v103
    v_and_b32 v175, 0xffff0000, v103
    v_pk_mul_f32 v[160:161], v[160:161], v[152:153] op_sel_hi:[1,0]
    v_pk_mul_f32 v[162:163], v[162:163], v[152:153] op_sel_hi:[1,0]
    v_pk_mul_f32 v[164:165], v[164:165], v[152:153] op_sel_hi:[1,0]
    v_pk_mul_f32 v[166:167], v[166:167], v[152:153] op_sel_hi:[1,0]
    v_pk_mul_f32 v[168:169], v[168:169], v[152:153] op_sel_hi:[1,0]
    v_pk_mul_f32 v[170:171], v[170:171], v[152:153] op_sel_hi:[1,0]
    v_pk_mul_f32 v[172:173], v[172:173], v[152:153] op_sel_hi:[1,0]
    v_pk_mul_f32 v[174:175], v[174:175], v[152:153] op_sel_hi:[1,0]
    v_cvt_pk_bf16_f32 v160, v160, v161
    v_cvt_pk_bf16_f32 v162, v162, v163
    v_cvt_pk_bf16_f32 v164, v164, v165
    v_cvt_pk_bf16_f32 v166, v166, v167
    v_cvt_pk_bf16_f32 v168, v168, v169
    v_cvt_pk_bf16_f32 v170, v170, v171
    v_cvt_pk_bf16_f32 v172, v172, v173
    v_cvt_pk_bf16_f32 v174, v174, v175
    v_accvgpr_write_b32 a96, v160
    v_accvgpr_write_b32 a97, v162
    v_accvgpr_write_b32 a98, v164
    v_accvgpr_write_b32 a99, v166
    v_accvgpr_write_b32 a100, v168
    v_accvgpr_write_b32 a101, v170
    v_accvgpr_write_b32 a102, v172
    v_accvgpr_write_b32 a103, v174
    v_lshlrev_b32 v160, 16, v104
    v_and_b32 v161, 0xffff0000, v104
    v_lshlrev_b32 v162, 16, v105
    v_and_b32 v163, 0xffff0000, v105
    v_lshlrev_b32 v164, 16, v106
    v_and_b32 v165, 0xffff0000, v106
    v_lshlrev_b32 v166, 16, v107
    v_and_b32 v167, 0xffff0000, v107
    v_lshlrev_b32 v168, 16, v108
    v_and_b32 v169, 0xffff0000, v108
    v_lshlrev_b32 v170, 16, v109
    v_and_b32 v171, 0xffff0000, v109
    v_lshlrev_b32 v172, 16, v110
    v_and_b32 v173, 0xffff0000, v110
    v_lshlrev_b32 v174, 16, v111
    v_and_b32 v175, 0xffff0000, v111
    v_pk_add_f32 v[160:161], v[160:161], v[154:155] op_sel_hi:[1,0] neg_lo:[0,1] neg_hi:[0,1]
    v_pk_add_f32 v[162:163], v[162:163], v[154:155] op_sel_hi:[1,0] neg_lo:[0,1] neg_hi:[0,1]
    v_pk_add_f32 v[164:165], v[164:165], v[154:155] op_sel_hi:[1,0] neg_lo:[0,1] neg_hi:[0,1]
    v_pk_add_f32 v[166:167], v[166:167], v[154:155] op_sel_hi:[1,0] neg_lo:[0,1] neg_hi:[0,1]
    v_pk_add_f32 v[168:169], v[168:169], v[154:155] op_sel_hi:[1,0] neg_lo:[0,1] neg_hi:[0,1]
    v_pk_add_f32 v[170:171], v[170:171], v[154:155] op_sel_hi:[1,0] neg_lo:[0,1] neg_hi:[0,1]
    v_pk_add_f32 v[172:173], v[172:173], v[154:155] op_sel_hi:[1,0] neg_lo:[0,1] neg_hi:[0,1]
    v_pk_add_f32 v[174:175], v[174:175], v[154:155] op_sel_hi:[1,0] neg_lo:[0,1] neg_hi:[0,1]
    v_cvt_pk_bf16_f32 v104, v160, v161
    v_cvt_pk_bf16_f32 v105, v162, v163
    v_cvt_pk_bf16_f32 v106, v164, v165
    v_cvt_pk_bf16_f32 v107, v166, v167
    v_cvt_pk_bf16_f32 v108, v168, v169
    v_cvt_pk_bf16_f32 v109, v170, v171
    v_cvt_pk_bf16_f32 v110, v172, v173
    v_cvt_pk_bf16_f32 v111, v174, v175
    v_lshlrev_b32 v160, 16, v104
    v_and_b32 v161, 0xffff0000, v104
    v_lshlrev_b32 v162, 16, v105
    v_and_b32 v163, 0xffff0000, v105
    v_lshlrev_b32 v164, 16, v106
    v_and_b32 v165, 0xffff0000, v106
    v_lshlrev_b32 v166, 16, v107
    v_and_b32 v167, 0xffff0000, v107
    v_lshlrev_b32 v168, 16, v108
    v_and_b32 v169, 0xffff0000, v108
    v_lshlrev_b32 v170, 16, v109
    v_and_b32 v171, 0xffff0000, v109
    v_lshlrev_b32 v172, 16, v110
    v_and_b32 v173, 0xffff0000, v110
    v_lshlrev_b32 v174, 16, v111
    v_and_b32 v175, 0xffff0000, v111
    v_pk_mul_f32 v[160:161], v[160:161], v[152:153] op_sel_hi:[1,0]
    v_pk_mul_f32 v[162:163], v[162:163], v[152:153] op_sel_hi:[1,0]
    v_pk_mul_f32 v[164:165], v[164:165], v[152:153] op_sel_hi:[1,0]
    v_pk_mul_f32 v[166:167], v[166:167], v[152:153] op_sel_hi:[1,0]
    v_pk_mul_f32 v[168:169], v[168:169], v[152:153] op_sel_hi:[1,0]
    v_pk_mul_f32 v[170:171], v[170:171], v[152:153] op_sel_hi:[1,0]
    v_pk_mul_f32 v[172:173], v[172:173], v[152:153] op_sel_hi:[1,0]
    v_pk_mul_f32 v[174:175], v[174:175], v[152:153] op_sel_hi:[1,0]
    v_cvt_pk_bf16_f32 v160, v160, v161
    v_cvt_pk_bf16_f32 v162, v162, v163
    v_cvt_pk_bf16_f32 v164, v164, v165
    v_cvt_pk_bf16_f32 v166, v166, v167
    v_cvt_pk_bf16_f32 v168, v168, v169
    v_cvt_pk_bf16_f32 v170, v170, v171
    v_cvt_pk_bf16_f32 v172, v172, v173
    v_cvt_pk_bf16_f32 v174, v174, v175
    v_accvgpr_write_b32 a104, v160
    v_accvgpr_write_b32 a105, v162
    v_accvgpr_write_b32 a106, v164
    v_accvgpr_write_b32 a107, v166
    v_accvgpr_write_b32 a108, v168
    v_accvgpr_write_b32 a109, v170
    v_accvgpr_write_b32 a110, v172
    v_accvgpr_write_b32 a111, v174
    v_lshlrev_b32 v160, 16, v112
    v_and_b32 v161, 0xffff0000, v112
    v_lshlrev_b32 v162, 16, v113
    v_and_b32 v163, 0xffff0000, v113
    v_lshlrev_b32 v164, 16, v114
    v_and_b32 v165, 0xffff0000, v114
    v_lshlrev_b32 v166, 16, v115
    v_and_b32 v167, 0xffff0000, v115
    v_lshlrev_b32 v168, 16, v116
    v_and_b32 v169, 0xffff0000, v116
    v_lshlrev_b32 v170, 16, v117
    v_and_b32 v171, 0xffff0000, v117
    v_lshlrev_b32 v172, 16, v118
    v_and_b32 v173, 0xffff0000, v118
    v_lshlrev_b32 v174, 16, v119
    v_and_b32 v175, 0xffff0000, v119
    v_pk_add_f32 v[160:161], v[160:161], v[154:155] op_sel_hi:[1,0] neg_lo:[0,1] neg_hi:[0,1]
    v_pk_add_f32 v[162:163], v[162:163], v[154:155] op_sel_hi:[1,0] neg_lo:[0,1] neg_hi:[0,1]
    v_pk_add_f32 v[164:165], v[164:165], v[154:155] op_sel_hi:[1,0] neg_lo:[0,1] neg_hi:[0,1]
    v_pk_add_f32 v[166:167], v[166:167], v[154:155] op_sel_hi:[1,0] neg_lo:[0,1] neg_hi:[0,1]
    v_pk_add_f32 v[168:169], v[168:169], v[154:155] op_sel_hi:[1,0] neg_lo:[0,1] neg_hi:[0,1]
    v_pk_add_f32 v[170:171], v[170:171], v[154:155] op_sel_hi:[1,0] neg_lo:[0,1] neg_hi:[0,1]
    v_pk_add_f32 v[172:173], v[172:173], v[154:155] op_sel_hi:[1,0] neg_lo:[0,1] neg_hi:[0,1]
    v_pk_add_f32 v[174:175], v[174:175], v[154:155] op_sel_hi:[1,0] neg_lo:[0,1] neg_hi:[0,1]
    v_cvt_pk_bf16_f32 v112, v160, v161
    v_cvt_pk_bf16_f32 v113, v162, v163
    v_cvt_pk_bf16_f32 v114, v164, v165
    v_cvt_pk_bf16_f32 v115, v166, v167
    v_cvt_pk_bf16_f32 v116, v168, v169
    v_cvt_pk_bf16_f32 v117, v170, v171
    v_cvt_pk_bf16_f32 v118, v172, v173
    v_cvt_pk_bf16_f32 v119, v174, v175
    v_lshlrev_b32 v160, 16, v112
    v_and_b32 v161, 0xffff0000, v112
    v_lshlrev_b32 v162, 16, v113
    v_and_b32 v163, 0xffff0000, v113
    v_lshlrev_b32 v164, 16, v114
    v_and_b32 v165, 0xffff0000, v114
    v_lshlrev_b32 v166, 16, v115
    v_and_b32 v167, 0xffff0000, v115
    v_lshlrev_b32 v168, 16, v116
    v_and_b32 v169, 0xffff0000, v116
    v_lshlrev_b32 v170, 16, v117
    v_and_b32 v171, 0xffff0000, v117
    v_lshlrev_b32 v172, 16, v118
    v_and_b32 v173, 0xffff0000, v118
    v_lshlrev_b32 v174, 16, v119
    v_and_b32 v175, 0xffff0000, v119
    v_pk_mul_f32 v[160:161], v[160:161], v[152:153] op_sel_hi:[1,0]
    v_pk_mul_f32 v[162:163], v[162:163], v[152:153] op_sel_hi:[1,0]
    v_pk_mul_f32 v[164:165], v[164:165], v[152:153] op_sel_hi:[1,0]
    v_pk_mul_f32 v[166:167], v[166:167], v[152:153] op_sel_hi:[1,0]
    v_pk_mul_f32 v[168:169], v[168:169], v[152:153] op_sel_hi:[1,0]
    v_pk_mul_f32 v[170:171], v[170:171], v[152:153] op_sel_hi:[1,0]
    v_pk_mul_f32 v[172:173], v[172:173], v[152:153] op_sel_hi:[1,0]
    v_pk_mul_f32 v[174:175], v[174:175], v[152:153] op_sel_hi:[1,0]
    v_cvt_pk_bf16_f32 v160, v160, v161
    v_cvt_pk_bf16_f32 v162, v162, v163
    v_cvt_pk_bf16_f32 v164, v164, v165
    v_cvt_pk_bf16_f32 v166, v166, v167
    v_cvt_pk_bf16_f32 v168, v168, v169
    v_cvt_pk_bf16_f32 v170, v170, v171
    v_cvt_pk_bf16_f32 v172, v172, v173
    v_cvt_pk_bf16_f32 v174, v174, v175
    v_accvgpr_write_b32 a112, v160
    v_accvgpr_write_b32 a113, v162
    v_accvgpr_write_b32 a114, v164
    v_accvgpr_write_b32 a115, v166
    v_accvgpr_write_b32 a116, v168
    v_accvgpr_write_b32 a117, v170
    v_accvgpr_write_b32 a118, v172
    v_accvgpr_write_b32 a119, v174
    v_lshlrev_b32 v160, 16, v120
    v_and_b32 v161, 0xffff0000, v120
    v_lshlrev_b32 v162, 16, v121
    v_and_b32 v163, 0xffff0000, v121
    v_lshlrev_b32 v164, 16, v122
    v_and_b32 v165, 0xffff0000, v122
    v_lshlrev_b32 v166, 16, v123
    v_and_b32 v167, 0xffff0000, v123
    v_lshlrev_b32 v168, 16, v124
    v_and_b32 v169, 0xffff0000, v124
    v_lshlrev_b32 v170, 16, v125
    v_and_b32 v171, 0xffff0000, v125
    v_lshlrev_b32 v172, 16, v126
    v_and_b32 v173, 0xffff0000, v126
    v_lshlrev_b32 v174, 16, v127
    v_and_b32 v175, 0xffff0000, v127
    v_pk_add_f32 v[160:161], v[160:161], v[154:155] op_sel_hi:[1,0] neg_lo:[0,1] neg_hi:[0,1]
    v_pk_add_f32 v[162:163], v[162:163], v[154:155] op_sel_hi:[1,0] neg_lo:[0,1] neg_hi:[0,1]
    v_pk_add_f32 v[164:165], v[164:165], v[154:155] op_sel_hi:[1,0] neg_lo:[0,1] neg_hi:[0,1]
    v_pk_add_f32 v[166:167], v[166:167], v[154:155] op_sel_hi:[1,0] neg_lo:[0,1] neg_hi:[0,1]
    v_pk_add_f32 v[168:169], v[168:169], v[154:155] op_sel_hi:[1,0] neg_lo:[0,1] neg_hi:[0,1]
    v_pk_add_f32 v[170:171], v[170:171], v[154:155] op_sel_hi:[1,0] neg_lo:[0,1] neg_hi:[0,1]
    v_pk_add_f32 v[172:173], v[172:173], v[154:155] op_sel_hi:[1,0] neg_lo:[0,1] neg_hi:[0,1]
    v_pk_add_f32 v[174:175], v[174:175], v[154:155] op_sel_hi:[1,0] neg_lo:[0,1] neg_hi:[0,1]
    v_cvt_pk_bf16_f32 v120, v160, v161
    v_cvt_pk_bf16_f32 v121, v162, v163
    v_cvt_pk_bf16_f32 v122, v164, v165
    v_cvt_pk_bf16_f32 v123, v166, v167
    v_cvt_pk_bf16_f32 v124, v168, v169
    v_cvt_pk_bf16_f32 v125, v170, v171
    v_cvt_pk_bf16_f32 v126, v172, v173
    v_cvt_pk_bf16_f32 v127, v174, v175
    v_lshlrev_b32 v160, 16, v120
    v_and_b32 v161, 0xffff0000, v120
    v_lshlrev_b32 v162, 16, v121
    v_and_b32 v163, 0xffff0000, v121
    v_lshlrev_b32 v164, 16, v122
    v_and_b32 v165, 0xffff0000, v122
    v_lshlrev_b32 v166, 16, v123
    v_and_b32 v167, 0xffff0000, v123
    v_lshlrev_b32 v168, 16, v124
    v_and_b32 v169, 0xffff0000, v124
    v_lshlrev_b32 v170, 16, v125
    v_and_b32 v171, 0xffff0000, v125
    v_lshlrev_b32 v172, 16, v126
    v_and_b32 v173, 0xffff0000, v126
    v_lshlrev_b32 v174, 16, v127
    v_and_b32 v175, 0xffff0000, v127
    v_pk_mul_f32 v[160:161], v[160:161], v[152:153] op_sel_hi:[1,0]
    v_pk_mul_f32 v[162:163], v[162:163], v[152:153] op_sel_hi:[1,0]
    v_pk_mul_f32 v[164:165], v[164:165], v[152:153] op_sel_hi:[1,0]
    v_pk_mul_f32 v[166:167], v[166:167], v[152:153] op_sel_hi:[1,0]
    v_pk_mul_f32 v[168:169], v[168:169], v[152:153] op_sel_hi:[1,0]
    v_pk_mul_f32 v[170:171], v[170:171], v[152:153] op_sel_hi:[1,0]
    v_pk_mul_f32 v[172:173], v[172:173], v[152:153] op_sel_hi:[1,0]
    v_pk_mul_f32 v[174:175], v[174:175], v[152:153] op_sel_hi:[1,0]
    v_cvt_pk_bf16_f32 v160, v160, v161
    v_cvt_pk_bf16_f32 v162, v162, v163
    v_cvt_pk_bf16_f32 v164, v164, v165
    v_cvt_pk_bf16_f32 v166, v166, v167
    v_cvt_pk_bf16_f32 v168, v168, v169
    v_cvt_pk_bf16_f32 v170, v170, v171
    v_cvt_pk_bf16_f32 v172, v172, v173
    v_cvt_pk_bf16_f32 v174, v174, v175
    v_accvgpr_write_b32 a120, v160
    v_accvgpr_write_b32 a121, v162
    v_accvgpr_write_b32 a122, v164
    v_accvgpr_write_b32 a123, v166
    v_accvgpr_write_b32 a124, v168
    v_accvgpr_write_b32 a125, v170
    v_accvgpr_write_b32 a126, v172
    v_accvgpr_write_b32 a127, v174
    s_nop 4
L_p1_unit:
    s_cmp_ge_u32 s38, 96
    s_cbranch_scc1 L_p1_end
    s_lshr_b32 s26, s38, 5
    s_add_u32 s27, s26, 1
    s_lshl_b32 s25, s27, 24
    s_lshl_b32 s27, s20, 2
    s_add_u32 s27, s27, s21
    s_lshl_b32 s27, s27, 5
    s_and_b32 s28, s38, 31
    s_add_u32 s27, s27, s28
    s_lshl_b32 s27, s27, 13
    s_add_u32 s25, s25, s27
    s_lshr_b32 s26, s38, 5
    s_cmp_eq_u32 s26, 1
    s_cbranch_scc1 L_p1_v
    s_waitcnt vmcnt(16)
    s_barrier
    ds_read_b64_tr_b16 v[64:65], v128
    ds_read_b64_tr_b16 v[66:67], v128 offset:1024
    ds_read_b64_tr_b16 v[68:69], v129
    ds_read_b64_tr_b16 v[70:71], v129 offset:1024
    ds_read_b64_tr_b16 v[72:73], v130
    ds_read_b64_tr_b16 v[74:75], v130 offset:1024
    ds_read_b64_tr_b16 v[76:77], v131
    ds_read_b64_tr_b16 v[78:79], v131 offset:1024
    ds_read_b64_tr_b16 v[80:81], v132
    ds_read_b64_tr_b16 v[82:83], v132 offset:1024
    ds_read_b64_tr_b16 v[84:85], v133
    ds_read_b64_tr_b16 v[86:87], v133 offset:1024
    ds_read_b64_tr_b16 v[88:89], v134
    ds_read_b64_tr_b16 v[90:91], v134 offset:1024
    s_waitcnt lgkmcnt(12)
    v_mfma_f32_16x16x32_bf16 v[0:3], v[64:67], a[0:3], 0
    ds_read_b64_tr_b16 v[92:93], v135
    v_mfma_f32_16x16x32_bf16 v[4:7], v[64:67], a[64:67], 0
    ds_read_b64_tr_b16 v[94:95], v135 offset:1024
    s_add_u32 s26, s24, 0x300000
    s_add_u32 m0, s29, 0x18000
    s_nop 0
    buffer_load_dwordx4 v136, s[16:19], s26 offen lds
    s_waitcnt lgkmcnt(12)
    v_mfma_f32_16x16x32_bf16 v[8:11], v[68:71], a[0:3], 0
    ds_read_b64_tr_b16 v[96:97], v128 offset:8192
    v_mfma_f32_16x16x32_bf16 v[12:15], v[68:71], a[64:67], 0
    ds_read_b64_tr_b16 v[98:99], v128 offset:9216
    s_add_u32 s26, s24, 0x320000
    s_add_u32 m0, s29, 0x19000
    s_nop 0
    buffer_load_dwordx4 v136, s[16:19], s26 offen lds
    s_waitcnt lgkmcnt(12)
    v_mfma_f32_16x16x32_bf16 v[16:19], v[72:75], a[0:3], 0
    ds_read_b64_tr_b16 v[100:101], v129 offset:8192
    v_mfma_f32_16x16x32_bf16 v[20:23], v[72:75], a[64:67], 0
    ds_read_b64_tr_b16 v[102:103], v129 offset:9216
    s_add_u32 s26, s24, 0x340000
    s_add_u32 m0, s29, 0x1a000
    s_nop 0
    buffer_load_dwordx4 v136, s[16:19], s26 offen lds
    s_waitcnt lgkmcnt(12)
    v_mfma_f32_16x16x32_bf16 v[24:27], v[76:79], a[0:3], 0
    ds_read_b64_tr_b16 v[104:105], v130 offset:8192
    v_mfma_f32_16x16x32_bf16 v[28:31], v[76:79], a[64:67], 0
    ds_read_b64_tr_b16 v[106:107], v130 offset:9216
    s_add_u32 s26, s24, 0x360000
    s_add_u32 m0, s29, 0x1b000
    s_nop 0
    buffer_load_dwordx4 v136, s[16:19], s26 offen lds
    s_waitcnt lgkmcnt(12)
    v_mfma_f32_16x16x32_bf16 v[32:35], v[80:83], a[0:3], 0
    ds_read_b64_tr_b16 v[108:109], v131 offset:8192
    v_mfma_f32_16x16x32_bf16 v[36:39], v[80:83], a[64:67], 0
    ds_read_b64_tr_b16 v[110:111], v131 offset:9216
    s_add_u32 s26, s24, 0x380000
    s_add_u32 m0, s29, 0x1c000
    s_nop 0
    buffer_load_dwordx4 v136, s[16:19], s26 offen lds
    s_waitcnt lgkmcnt(12)
    v_mfma_f32_16x16x32_bf16 v[40:43], v[84:87], a[0:3], 0
    ds_read_b64_tr_b16 v[112:113], v132 offset:8192
    v_mfma_f32_16x16x32_bf16 v[44:47], v[84:87], a[64:67], 0
    ds_read_b64_tr_b16 v[114:115], v132 offset:9216
    s_add_u32 s26, s24, 0x3a0000
    s_add_u32 m0, s29, 0x1d000
    s_nop 0
    buffer_load_dwordx4 v136, s[16:19], s26 offen lds
    s_waitcnt lgkmcnt(12)
    v_mfma_f32_16x16x32_bf16 v[48:51], v[88:91], a[0:3], 0
    ds_read_b64_tr_b16 v[116:117], v133 offset:8192
    v_mfma_f32_16x16x32_bf16 v[52:55], v[88:91], a[64:67], 0
    ds_read_b64_tr_b16 v[118:119], v133 offset:9216
    s_add_u32 s26, s24, 0x3c0000
    s_add_u32 m0, s29, 0x1e000
    s_nop 0
    buffer_load_dwordx4 v136, s[16:19], s26 offen lds
    s_waitcnt lgkmcnt(12)
    v_mfma_f32_16x16x32_bf16 v[56:59], v[92:95], a[0:3], 0
    ds_read_b64_tr_b16 v[120:121], v134 offset:8192
    v_mfma_f32_16x16x32_bf16 v[60:63], v[92:95], a[64:67], 0
    ds_read_b64_tr_b16 v[122:123], v134 offset:9216
    s_add_u32 s26, s24, 0x3e0000
    s_add_u32 m0, s29, 0x1f000
    s_nop 0
    buffer_load_dwordx4 v136, s[16:19], s26 offen lds
    s_waitcnt lgkmcnt(12)
    v_mfma_f32_16x16x32_bf16 v[0:3], v[96:99], a[4:7], v[0:3]
    ds_read_b64_tr_b16 v[124:125], v135 offset:8192
    v_mfma_f32_16x16x32_bf16 v[4:7], v[96:99], a[68:71], v[4:7]
    ds_read_b64_tr_b16 v[126:127], v135 offset:9216
    s_waitcnt lgkmcnt(12)
    v_mfma_f32_16x16x32_bf16 v[8:11], v[100:103], a[4:7], v[8:11]
    ds_read_b64_tr_b16 v[64:65], v128 offset:16384
    v_mfma_f32_16x16x32_bf16 v[12:15], v[100:103], a[68:71], v[12:15]
    ds_read_b64_tr_b16 v[66:67], v128 offset:17408
    s_waitcnt lgkmcnt(12)
    v_mfma_f32_16x16x32_bf16 v[16:19], v[104:107], a[4:7], v[16:19]
    ds_read_b64_tr_b16 v[68:69], v129 offset:16384
    v_mfma_f32_16x16x32_bf16 v[20:23], v[104:107], a[68:71], v[20:23]
    ds_read_b64_tr_b16 v[70:71], v129 offset:17408
    s_waitcnt lgkmcnt(12)
    v_mfma_f32_16x16x32_bf16 v[24:27], v[108:111], a[4:7], v[24:27]
    ds_read_b64_tr_b16 v[72:73], v130 offset:16384
    v_mfma_f32_16x16x32_bf16 v[28:31], v[108:111], a[68:71], v[28:31]
    ds_read_b64_tr_b16 v[74:75], v130 offset:17408
    s_waitcnt lgkmcnt(12)
    v_mfma_f32_16x16x32_bf16 v[32:35], v[112:115], a[4:7], v[32:35]
    ds_read_b64_tr_b16 v[76:77], v131 offset:16384
    v_mfma_f32_16x16x32_bf16 v[36:39], v[112:115], a[68:71], v[36:39]
    ds_read_b64_tr_b16 v[78:79], v131 offset:17408
    s_waitcnt lgkmcnt(12)
    v_mfma_f32_16x16x32_bf16 v[40:43], v[116:119], a[4:7], v[40:43]
    ds_read_b64_tr_b16 v[80:81], v132 offset:16384
    v_mfma_f32_16x16x32_bf16 v[44:47], v[116:119], a[68:71], v[44:47]
    ds_read_b64_tr_b16 v[82:83], v132 offset:17408
    s_waitcnt lgkmcnt(12)
    v_mfma_f32_16x16x32_bf16 v[48:51], v[120:123], a[4:7], v[48:51]
    ds_read_b64_tr_b16 v[84:85], v133 offset:16384
    v_mfma_f32_16x16x32_bf16 v[52:55], v[120:123], a[68:71], v[52:55]
    ds_read_b64_tr_b16 v[86:87], v133 offset:17408
    s_waitcnt lgkmcnt(12)
    v_mfma_f32_16x16x32_bf16 v[56:59], v[124:127], a[4:7], v[56:59]
    ds_read_b64_tr_b16 v[88:89], v134 offset:16384
    v_mfma_f32_16x16x32_bf16 v[60:63], v[124:127], a[68:71], v[60:63]
    ds_read_b64_tr_b16 v[90:91], v134 offset:17408
    s_waitcnt lgkmcnt(12)
    v_mfma_f32_16x16x32_bf16 v[0:3], v[64:67], a[8:11], v[0:3]
    ds_read_b64_tr_b16 v[92:93], v135 offset:16384
    v_mfma_f32_16x16x32_bf16 v[4:7], v[64:67], a[72:75], v[4:7]
    ds_read_b64_tr_b16 v[94:95], v135 offset:17408
    s_waitcnt lgkmcnt(12)
    v_mfma_f32_16x16x32_bf16 v[8:11], v[68:71], a[8:11], v[8:11]
    ds_read_b64_tr_b16 v[96:97], v128 offset:24576
    v_mfma_f32_16x16x32_bf16 v[12:15], v[68:71], a[72:75], v[12:15]
    ds_read_b64_tr_b16 v[98:99], v128 offset:25600
    s_waitcnt lgkmcnt(12)
    v_mfma_f32_16x16x32_bf16 v[16:19], v[72:75], a[8:11], v[16:19]
    ds_read_b64_tr_b16 v[100:101], v129 offset:24576
    v_mfma_f32_16x16x32_bf16 v[20:23], v[72:75], a[72:75], v[20:23]
    ds_read_b64_tr_b16 v[102:103], v129 offset:25600
    s_waitcnt lgkmcnt(12)
    v_mfma_f32_16x16x32_bf16 v[24:27], v[76:79], a[8:11], v[24:27]
    ds_read_b64_tr_b16 v[104:105], v130 offset:24576
    v_mfma_f32_16x16x32_bf16 v[28:31], v[76:79], a[72:75], v[28:31]
    ds_read_b64_tr_b16 v[106:107], v130 offset:25600
    s_waitcnt lgkmcnt(12)
    v_mfma_f32_16x16x32_bf16 v[32:35], v[80:83], a[8:11], v[32:35]
    ds_read_b64_tr_b16 v[108:109], v131 offset:24576
    v_mfma_f32_16x16x32_bf16 v[36:39], v[80:83], a[72:75], v[36:39]
    ds_read_b64_tr_b16 v[110:111], v131 offset:25600
    s_waitcnt lgkmcnt(12)
    v_mfma_f32_16x16x32_bf16 v[40:43], v[84:87], a[8:11], v[40:43]
    ds_read_b64_tr_b16 v[112:113], v132 offset:24576
    v_mfma_f32_16x16x32_bf16 v[44:47], v[84:87], a[72:75], v[44:47]
    ds_read_b64_tr_b16 v[114:115], v132 offset:25600
    s_waitcnt lgkmcnt(12)
    v_mfma_f32_16x16x32_bf16 v[48:51], v[88:91], a[8:11], v[48:51]
    ds_read_b64_tr_b16 v[116:117], v133 offset:24576
    v_mfma_f32_16x16x32_bf16 v[52:55], v[88:91], a[72:75], v[52:55]
    ds_read_b64_tr_b16 v[118:119], v133 offset:25600
    s_waitcnt lgkmcnt(12)
    v_mfma_f32_16x16x32_bf16 v[56:59], v[92:95], a[8:11], v[56:59]
    ds_read_b64_tr_b16 v[120:121], v134 offset:24576
    v_mfma_f32_16x16x32_bf16 v[60:63], v[92:95], a[72:75], v[60:63]
    ds_read_b64_tr_b16 v[122:123], v134 offset:25600
    s_waitcnt lgkmcnt(12)
    v_mfma_f32_16x16x32_bf16 v[0:3], v[96:99], a[12:15], v[0:3]
    ds_read_b64_tr_b16 v[124:125], v135 offset:24576
    v_mfma_f32_16x16x32_bf16 v[4:7], v[96:99], a[76:79], v[4:7]
    ds_read_b64_tr_b16 v[126:127], v135 offset:25600
    s_waitcnt lgkmcnt(12)
    v_mfma_f32_16x16x32_bf16 v[8:11], v[100:103], a[12:15], v[8:11]
    v_mfma_f32_16x16x32_bf16 v[12:15], v[100:103], a[76:79], v[12:15]
    s_waitcnt lgkmcnt(10)
    v_mfma_f32_16x16x32_bf16 v[16:19], v[104:107], a[12:15], v[16:19]
    v_mfma_f32_16x16x32_bf16 v[20:23], v[104:107], a[76:79], v[20:23]
    s_waitcnt lgkmcnt(8)
    v_mfma_f32_16x16x32_bf16 v[24:27], v[108:111], a[12:15], v[24:27]
    v_mfma_f32_16x16x32_bf16 v[28:31], v[108:111], a[76:79], v[28:31]
    s_waitcnt lgkmcnt(6)
    v_mfma_f32_16x16x32_bf16 v[32:35], v[112:115], a[12:15], v[32:35]
    v_mfma_f32_16x16x32_bf16 v[36:39], v[112:115], a[76:79], v[36:39]
    s_waitcnt lgkmcnt(4)
    v_mfma_f32_16x16x32_bf16 v[40:43], v[116:119], a[12:15], v[40:43]
    v_mfma_f32_16x16x32_bf16 v[44:47], v[116:119], a[76:79], v[44:47]
    s_waitcnt lgkmcnt(2)
    v_mfma_f32_16x16x32_bf16 v[48:51], v[120:123], a[12:15], v[48:51]
    v_mfma_f32_16x16x32_bf16 v[52:55], v[120:123], a[76:79], v[52:55]
    s_waitcnt lgkmcnt(0)
    v_mfma_f32_16x16x32_bf16 v[56:59], v[124:127], a[12:15], v[56:59]
    v_mfma_f32_16x16x32_bf16 v[60:63], v[124:127], a[76:79], v[60:63]
    s_waitcnt vmcnt(16)
    s_barrier
    ds_read_b64_tr_b16 v[64:65], v128 offset:32768
    ds_read_b64_tr_b16 v[66:67], v128 offset:33792
    ds_read_b64_tr_b16 v[68:69], v129 offset:32768
    ds_read_b64_tr_b16 v[70:71], v129 offset:33792
    ds_read_b64_tr_b16 v[72:73], v130 offset:32768
    ds_read_b64_tr_b16 v[74:75], v130 offset:33792
    ds_read_b64_tr_b16 v[76:77], v131 offset:32768
    ds_read_b64_tr_b16 v[78:79], v131 offset:33792
    ds_read_b64_tr_b16 v[80:81], v132 offset:32768
    ds_read_b64_tr_b16 v[82:83], v132 offset:33792
    ds_read_b64_tr_b16 v[84:85], v133 offset:32768
    ds_read_b64_tr_b16 v[86:87], v133 offset:33792
    ds_read_b64_tr_b16 v[88:89], v134 offset:32768
    ds_read_b64_tr_b16 v[90:91], v134 offset:33792
    s_add_u32 s39, s39, s37
    s_lshr_b32 s26, s39, 5
    s_cmp_eq_u32 s26, 0
    s_cselect_b64 s[16:17], s[30:31], s[34:35]
    s_cmp_eq_u32 s26, 1
    s_cselect_b64 s[16:17], s[32:33], s[16:17]
    s_and_b32 s17, s17, 0xffff
    s_cmp_lt_u32 s39, 96
    s_cselect_b32 s18, 0x400000, 0
    s_and_b32 s24, s39, 31
    s_lshl_b32 s24, s24, 8
    s_waitcnt lgkmcnt(12)
    v_mfma_f32_16x16x32_bf16 v[0:3], v[64:67], a[16:19], v[0:3]
    ds_read_b64_tr_b16 v[92:93], v135 offset:32768
    v_mfma_f32_16x16x32_bf16 v[4:7], v[64:67], a[80:83], v[4:7]
    ds_read_b64_tr_b16 v[94:95], v135 offset:33792
    s_add_u32 s26, s24, 0x0
    s_add_u32 m0, s29, 0x0
    s_nop 0
    buffer_load_dwordx4 v136, s[16:19], s26 offen lds
    s_waitcnt lgkmcnt(12)
    v_mfma_f32_16x16x32_bf16 v[8:11], v[68:71], a[16:19], v[8:11]
    ds_read_b64_tr_b16 v[96:97], v128 offset:40960
    v_mfma_f32_16x16x32_bf16 v[12:15], v[68:71], a[80:83], v[12:15]
    ds_read_b64_tr_b16 v[98:99], v128 offset:41984
    s_add_u32 s26, s24, 0x20000
    s_add_u32 m0, s29, 0x1000
    s_nop 0
    buffer_load_dwordx4 v136, s[16:19], s26 offen lds
    s_waitcnt lgkmcnt(12)
    v_mfma_f32_16x16x32_bf16 v[16:19], v[72:75], a[16:19], v[16:19]
    ds_read_b64_tr_b16 v[100:101], v129 offset:40960
    v_mfma_f32_16x16x32_bf16 v[20:23], v[72:75], a[80:83], v[20:23]
    ds_read_b64_tr_b16 v[102:103], v129 offset:41984
    s_add_u32 s26, s24, 0x40000
    s_add_u32 m0, s29, 0x2000
    s_nop 0
    buffer_load_dwordx4 v136, s[16:19], s26 offen lds
    s_waitcnt lgkmcnt(12)
    v_mfma_f32_16x16x32_bf16 v[24:27], v[76:79], a[16:19], v[24:27]
    ds_read_b64_tr_b16 v[104:105], v130 offset:40960
    v_mfma_f32_16x16x32_bf16 v[28:31], v[76:79], a[80:83], v[28:31]
    ds_read_b64_tr_b16 v[106:107], v130 offset:41984
    s_add_u32 s26, s24, 0x60000
    s_add_u32 m0, s29, 0x3000
    s_nop 0
    buffer_load_dwordx4 v136, s[16:19], s26 offen lds
    s_waitcnt lgkmcnt(12)
    v_mfma_f32_16x16x32_bf16 v[32:35], v[80:83], a[16:19], v[32:35]
    ds_read_b64_tr_b16 v[108:109], v131 offset:40960
    v_mfma_f32_16x16x32_bf16 v[36:39], v[80:83], a[80:83], v[36:39]
    ds_read_b64_tr_b16 v[110:111], v131 offset:41984
    s_add_u32 s26, s24, 0x80000
    s_add_u32 m0, s29, 0x4000
    s_nop 0
    buffer_load_dwordx4 v136, s[16:19], s26 offen lds
    s_waitcnt lgkmcnt(12)
    v_mfma_f32_16x16x32_bf16 v[40:43], v[84:87], a[16:19], v[40:43]
    ds_read_b64_tr_b16 v[112:113], v132 offset:40960
    v_mfma_f32_16x16x32_bf16 v[44:47], v[84:87], a[80:83], v[44:47]
    ds_read_b64_tr_b16 v[114:115], v132 offset:41984
    s_add_u32 s26, s24, 0xa0000
    s_add_u32 m0, s29, 0x5000
    s_nop 0
    buffer_load_dwordx4 v136, s[16:19], s26 offen lds
    s_waitcnt lgkmcnt(12)
    v_mfma_f32_16x16x32_bf16 v[48:51], v[88:91], a[16:19], v[48:51]
    ds_read_b64_tr_b16 v[116:117], v133 offset:40960
    v_mfma_f32_16x16x32_bf16 v[52:55], v[88:91], a[80:83], v[52:55]
    ds_read_b64_tr_b16 v[118:119], v133 offset:41984
    s_add_u32 s26, s24, 0xc0000
    s_add_u32 m0, s29, 0x6000
    s_nop 0
    buffer_load_dwordx4 v136, s[16:19], s26 offen lds
    s_waitcnt lgkmcnt(12)
    v_mfma_f32_16x16x32_bf16 v[56:59], v[92:95], a[16:19], v[56:59]
    ds_read_b64_tr_b16 v[120:121], v134 offset:40960
    v_mfma_f32_16x16x32_bf16 v[60:63], v[92:95], a[80:83], v[60:63]
    ds_read_b64_tr_b16 v[122:123], v134 offset:41984
    s_add_u32 s26, s24, 0xe0000
    s_add_u32 m0, s29, 0x7000
    s_nop 0
    buffer_load_dwordx4 v136, s[16:19], s26 offen lds
    s_waitcnt lgkmcnt(12)
    v_mfma_f32_16x16x32_bf16 v[0:3], v[96:99], a[20:23], v[0:3]
    ds_read_b64_tr_b16 v[124:125], v135 offset:40960
    v_mfma_f32_16x16x32_bf16 v[4:7], v[96:99], a[84:87], v[4:7]
    ds_read_b64_tr_b16 v[126:127], v135 offset:41984
    s_waitcnt lgkmcnt(12)
    v_mfma_f32_16x16x32_bf16 v[8:11], v[100:103], a[20:23], v[8:11]
    ds_read_b64_tr_b16 v[64:65], v128 offset:49152
    v_mfma_f32_16x16x32_bf16 v[12:15], v[100:103], a[84:87], v[12:15]
    ds_read_b64_tr_b16 v[66:67], v128 offset:50176
    s_waitcnt lgkmcnt(12)
    v_mfma_f32_16x16x32_bf16 v[16:19], v[104:107], a[20:23], v[16:19]
    ds_read_b64_tr_b16 v[68:69], v129 offset:49152
    v_mfma_f32_16x16x32_bf16 v[20:23], v[104:107], a[84:87], v[20:23]
    ds_read_b64_tr_b16 v[70:71], v129 offset:50176
    s_waitcnt lgkmcnt(12)
    v_mfma_f32_16x16x32_bf16 v[24:27], v[108:111], a[20:23], v[24:27]
    ds_read_b64_tr_b16 v[72:73], v130 offset:49152
    v_mfma_f32_16x16x32_bf16 v[28:31], v[108:111], a[84:87], v[28:31]
    ds_read_b64_tr_b16 v[74:75], v130 offset:50176
    s_waitcnt lgkmcnt(12)
    v_mfma_f32_16x16x32_bf16 v[32:35], v[112:115], a[20:23], v[32:35]
    ds_read_b64_tr_b16 v[76:77], v131 offset:49152
    v_mfma_f32_16x16x32_bf16 v[36:39], v[112:115], a[84:87], v[36:39]
    ds_read_b64_tr_b16 v[78:79], v131 offset:50176
    s_waitcnt lgkmcnt(12)
    v_mfma_f32_16x16x32_bf16 v[40:43], v[116:119], a[20:23], v[40:43]
    ds_read_b64_tr_b16 v[80:81], v132 offset:49152
    v_mfma_f32_16x16x32_bf16 v[44:47], v[116:119], a[84:87], v[44:47]
    ds_read_b64_tr_b16 v[82:83], v132 offset:50176
    s_waitcnt lgkmcnt(12)
    v_mfma_f32_16x16x32_bf16 v[48:51], v[120:123], a[20:23], v[48:51]
    ds_read_b64_tr_b16 v[84:85], v133 offset:49152
    v_mfma_f32_16x16x32_bf16 v[52:55], v[120:123], a[84:87], v[52:55]
    ds_read_b64_tr_b16 v[86:87], v133 offset:50176
    s_waitcnt lgkmcnt(12)
    v_mfma_f32_16x16x32_bf16 v[56:59], v[124:127], a[20:23], v[56:59]
    ds_read_b64_tr_b16 v[88:89], v134 offset:49152
    v_mfma_f32_16x16x32_bf16 v[60:63], v[124:127], a[84:87], v[60:63]
    ds_read_b64_tr_b16 v[90:91], v134 offset:50176
    s_waitcnt lgkmcnt(12)
    v_mfma_f32_16x16x32_bf16 v[0:3], v[64:67], a[24:27], v[0:3]
    ds_read_b64_tr_b16 v[92:93], v135 offset:49152
    v_mfma_f32_16x16x32_bf16 v[4:7], v[64:67], a[88:91], v[4:7]
    ds_read_b64_tr_b16 v[94:95], v135 offset:50176
    s_waitcnt lgkmcnt(12)
    v_mfma_f32_16x16x32_bf16 v[8:11], v[68:71], a[24:27], v[8:11]
    ds_read_b64_tr_b16 v[96:97], v128 offset:57344
    v_mfma_f32_16x16x32_bf16 v[12:15], v[68:71], a[88:91], v[12:15]
    ds_read_b64_tr_b16 v[98:99], v128 offset:58368
    s_waitcnt lgkmcnt(12)
    v_mfma_f32_16x16x32_bf16 v[16:19], v[72:75], a[24:27], v[16:19]
    ds_read_b64_tr_b16 v[100:101], v129 offset:57344
    v_mfma_f32_16x16x32_bf16 v[20:23], v[72:75], a[88:91], v[20:23]
    ds_read_b64_tr_b16 v[102:103], v129 offset:58368
    s_waitcnt lgkmcnt(12)
    v_mfma_f32_16x16x32_bf16 v[24:27], v[76:79], a[24:27], v[24:27]
    ds_read_b64_tr_b16 v[104:105], v130 offset:57344
    v_mfma_f32_16x16x32_bf16 v[28:31], v[76:79], a[88:91], v[28:31]
    ds_read_b64_tr_b16 v[106:107], v130 offset:58368
    s_waitcnt lgkmcnt(12)
    v_mfma_f32_16x16x32_bf16 v[32:35], v[80:83], a[24:27], v[32:35]
    ds_read_b64_tr_b16 v[108:109], v131 offset:57344
    v_mfma_f32_16x16x32_bf16 v[36:39], v[80:83], a[88:91], v[36:39]
    ds_read_b64_tr_b16 v[110:111], v131 offset:58368
    s_waitcnt lgkmcnt(12)
    v_mfma_f32_16x16x32_bf16 v[40:43], v[84:87], a[24:27], v[40:43]
    ds_read_b64_tr_b16 v[112:113], v132 offset:57344
    v_mfma_f32_16x16x32_bf16 v[44:47], v[84:87], a[88:91], v[44:47]
    ds_read_b64_tr_b16 v[114:115], v132 offset:58368
    s_waitcnt lgkmcnt(12)
    v_mfma_f32_16x16x32_bf16 v[48:51], v[88:91], a[24:27], v[48:51]
    ds_read_b64_tr_b16 v[116:117], v133 offset:57344
    v_mfma_f32_16x16x32_bf16 v[52:55], v[88:91], a[88:91], v[52:55]
    ds_read_b64_tr_b16 v[118:119], v133 offset:58368
    s_waitcnt lgkmcnt(12)
    v_mfma_f32_16x16x32_bf16 v[56:59], v[92:95], a[24:27], v[56:59]
    ds_read_b64_tr_b16 v[120:121], v134 offset:57344
    v_mfma_f32_16x16x32_bf16 v[60:63], v[92:95], a[88:91], v[60:63]
    ds_read_b64_tr_b16 v[122:123], v134 offset:58368
    s_waitcnt lgkmcnt(12)
    v_mfma_f32_16x16x32_bf16 v[0:3], v[96:99], a[28:31], v[0:3]
    ds_read_b64_tr_b16 v[124:125], v135 offset:57344
    v_mfma_f32_16x16x32_bf16 v[4:7], v[96:99], a[92:95], v[4:7]
    ds_read_b64_tr_b16 v[126:127], v135 offset:58368
    s_waitcnt lgkmcnt(12)
    v_mfma_f32_16x16x32_bf16 v[8:11], v[100:103], a[28:31], v[8:11]
    v_mfma_f32_16x16x32_bf16 v[12:15], v[100:103], a[92:95], v[12:15]
    s_waitcnt lgkmcnt(10)
    v_mfma_f32_16x16x32_bf16 v[16:19], v[104:107], a[28:31], v[16:19]
    v_mfma_f32_16x16x32_bf16 v[20:23], v[104:107], a[92:95], v[20:23]
    s_waitcnt lgkmcnt(8)
    v_mfma_f32_16x16x32_bf16 v[24:27], v[108:111], a[28:31], v[24:27]
    v_mfma_f32_16x16x32_bf16 v[28:31], v[108:111], a[92:95], v[28:31]
    s_waitcnt lgkmcnt(6)
    v_mfma_f32_16x16x32_bf16 v[32:35], v[112:115], a[28:31], v[32:35]
    v_mfma_f32_16x16x32_bf16 v[36:39], v[112:115], a[92:95], v[36:39]
    s_waitcnt lgkmcnt(4)
    v_mfma_f32_16x16x32_bf16 v[40:43], v[116:119], a[28:31], v[40:43]
    v_mfma_f32_16x16x32_bf16 v[44:47], v[116:119], a[92:95], v[44:47]
    s_waitcnt lgkmcnt(2)
    v_mfma_f32_16x16x32_bf16 v[48:51], v[120:123], a[28:31], v[48:51]
    v_mfma_f32_16x16x32_bf16 v[52:55], v[120:123], a[92:95], v[52:55]
    s_waitcnt lgkmcnt(0)
    v_mfma_f32_16x16x32_bf16 v[56:59], v[124:127], a[28:31], v[56:59]
    v_mfma_f32_16x16x32_bf16 v[60:63], v[124:127], a[92:95], v[60:63]
    v_xor_b32 v128, 0x10000, v128
    v_xor_b32 v129, 0x10000, v129
    v_xor_b32 v130, 0x10000, v130
    v_xor_b32 v131, 0x10000, v131
    v_xor_b32 v132, 0x10000, v132
    v_xor_b32 v133, 0x10000, v133
    v_xor_b32 v134, 0x10000, v134
    v_xor_b32 v135, 0x10000, v135
    s_waitcnt vmcnt(16)
    s_barrier
    ds_read_b64_tr_b16 v[64:65], v128
    ds_read_b64_tr_b16 v[66:67], v128 offset:1024
    ds_read_b64_tr_b16 v[68:69], v129
    ds_read_b64_tr_b16 v[70:71], v129 offset:1024
    ds_read_b64_tr_b16 v[72:73], v130
    ds_read_b64_tr_b16 v[74:75], v130 offset:1024
    ds_read_b64_tr_b16 v[76:77], v131
    ds_read_b64_tr_b16 v[78:79], v131 offset:1024
    ds_read_b64_tr_b16 v[80:81], v132
    ds_read_b64_tr_b16 v[82:83], v132 offset:1024
    ds_read_b64_tr_b16 v[84:85], v133
    ds_read_b64_tr_b16 v[86:87], v133 offset:1024
    ds_read_b64_tr_b16 v[88:89], v134
    ds_read_b64_tr_b16 v[90:91], v134 offset:1024
    s_cmp_eq_u32 s40, 0
    s_cbranch_scc1 L_nopf_86
    s_cmp_lg_u32 s87, 0
    s_cbranch_scc1 L_modeok_87
    s_mov_b32 s96, 0
L_mode_88:
    buffer_load_dwordx2 v[140:141], off, s[92:95], 0 offset:36 sc1
    s_waitcnt vmcnt(0)
    v_readfirstlane_b32 s87, v140
    v_readfirstlane_b32 s97, v141
    s_nop 0
    s_min_u32 s97, s97, s87
    s_cmp_lg_u32 s97, 0
    s_cbranch_scc1 L_moded_89
    s_sleep 4
    s_add_u32 s96, s96, 1
    s_cmp_lg_u32 s96, 0x100
    s_cbranch_scc1 L_modef_90
    v_mov_b32 v140, 2
    v_mov_b32 v141, 0
    s_mov_b64 exec, 1
    buffer_atomic_cmpswap v[140:141], off, s[92:95], 0 offset:36
    s_mov_b64 exec, -1
L_modef_90:
    s_cmp_lt_u32 s96, 0x10000
    s_cbranch_scc1 L_mode_88
L_moded_89:
    s_cmp_lg_u32 s87, 1
    s_cbranch_scc1 L_fallback
L_modeok_87:
    s_cmp_lg_u32 s100, 0
    s_cbranch_scc1 L_flag_91
    v_mov_b32 v138, 1
    s_mov_b64 exec, 1
    buffer_store_dword v138, off, s[8:11], s40 sc1
    s_mov_b64 exec, -1
L_flag_91:
    s_mov_b32 s40, 0
L_nopf_86:
    s_waitcnt lgkmcnt(12)
    v_mfma_f32_16x16x32_bf16 v[0:3], v[64:67], a[32:35], v[0:3]
    ds_read_b64_tr_b16 v[92:93], v135
    v_mfma_f32_16x16x32_bf16 v[4:7], v[64:67], a[96:99], v[4:7]
    ds_read_b64_tr_b16 v[94:95], v135 offset:1024
    s_add_u32 s26, s24, 0x100000
    s_add_u32 m0, s29, 0x8000
    s_nop 0
    buffer_load_dwordx4 v136, s[16:19], s26 offen lds
    s_waitcnt lgkmcnt(12)
    v_mfma_f32_16x16x32_bf16 v[8:11], v[68:71], a[32:35], v[8:11]
    ds_read_b64_tr_b16 v[96:97], v128 offset:8192
    v_mfma_f32_16x16x32_bf16 v[12:15], v[68:71], a[96:99], v[12:15]
    ds_read_b64_tr_b16 v[98:99], v128 offset:9216
    s_add_u32 s26, s24, 0x120000
    s_add_u32 m0, s29, 0x9000
    s_nop 0
    buffer_load_dwordx4 v136, s[16:19], s26 offen lds
    s_waitcnt lgkmcnt(12)
    v_mfma_f32_16x16x32_bf16 v[16:19], v[72:75], a[32:35], v[16:19]
    ds_read_b64_tr_b16 v[100:101], v129 offset:8192
    v_mfma_f32_16x16x32_bf16 v[20:23], v[72:75], a[96:99], v[20:23]
    ds_read_b64_tr_b16 v[102:103], v129 offset:9216
    s_add_u32 s26, s24, 0x140000
    s_add_u32 m0, s29, 0xa000
    s_nop 0
    buffer_load_dwordx4 v136, s[16:19], s26 offen lds
    s_waitcnt lgkmcnt(12)
    v_mfma_f32_16x16x32_bf16 v[24:27], v[76:79], a[32:35], v[24:27]
    ds_read_b64_tr_b16 v[104:105], v130 offset:8192
    v_mfma_f32_16x16x32_bf16 v[28:31], v[76:79], a[96:99], v[28:31]
    ds_read_b64_tr_b16 v[106:107], v130 offset:9216
    s_add_u32 s26, s24, 0x160000
    s_add_u32 m0, s29, 0xb000
    s_nop 0
    buffer_load_dwordx4 v136, s[16:19], s26 offen lds
    s_waitcnt lgkmcnt(12)
    v_mfma_f32_16x16x32_bf16 v[32:35], v[80:83], a[32:35], v[32:35]
    ds_read_b64_tr_b16 v[108:109], v131 offset:8192
    v_mfma_f32_16x16x32_bf16 v[36:39], v[80:83], a[96:99], v[36:39]
    ds_read_b64_tr_b16 v[110:111], v131 offset:9216
    s_add_u32 s26, s24, 0x180000
    s_add_u32 m0, s29, 0xc000
    s_nop 0
    buffer_load_dwordx4 v136, s[16:19], s26 offen lds
    s_waitcnt lgkmcnt(12)
    v_mfma_f32_16x16x32_bf16 v[40:43], v[84:87], a[32:35], v[40:43]
    ds_read_b64_tr_b16 v[112:113], v132 offset:8192
    v_mfma_f32_16x16x32_bf16 v[44:47], v[84:87], a[96:99], v[44:47]
    ds_read_b64_tr_b16 v[114:115], v132 offset:9216
    s_add_u32 s26, s24, 0x1a0000
    s_add_u32 m0, s29, 0xd000
    s_nop 0
    buffer_load_dwordx4 v136, s[16:19], s26 offen lds
    s_waitcnt lgkmcnt(12)
    v_mfma_f32_16x16x32_bf16 v[48:51], v[88:91], a[32:35], v[48:51]
    ds_read_b64_tr_b16 v[116:117], v133 offset:8192
    v_mfma_f32_16x16x32_bf16 v[52:55], v[88:91], a[96:99], v[52:55]
    ds_read_b64_tr_b16 v[118:119], v133 offset:9216
    s_add_u32 s26, s24, 0x1c0000
    s_add_u32 m0, s29, 0xe000
    s_nop 0
    buffer_load_dwordx4 v136, s[16:19], s26 offen lds
    s_waitcnt lgkmcnt(12)
    v_mfma_f32_16x16x32_bf16 v[56:59], v[92:95], a[32:35], v[56:59]
    ds_read_b64_tr_b16 v[120:121], v134 offset:8192
    v_mfma_f32_16x16x32_bf16 v[60:63], v[92:95], a[96:99], v[60:63]
    ds_read_b64_tr_b16 v[122:123], v134 offset:9216
    s_add_u32 s26, s24, 0x1e0000
    s_add_u32 m0, s29, 0xf000
    s_nop 0
    buffer_load_dwordx4 v136, s[16:19], s26 offen lds
    s_waitcnt lgkmcnt(12)
    v_mfma_f32_16x16x32_bf16 v[0:3], v[96:99], a[36:39], v[0:3]
    ds_read_b64_tr_b16 v[124:125], v135 offset:8192
    v_mfma_f32_16x16x32_bf16 v[4:7], v[96:99], a[100:103], v[4:7]
    ds_read_b64_tr_b16 v[126:127], v135 offset:9216
    s_waitcnt lgkmcnt(12)
    v_mfma_f32_16x16x32_bf16 v[8:11], v[100:103], a[36:39], v[8:11]
    ds_read_b64_tr_b16 v[64:65], v128 offset:16384
    v_mfma_f32_16x16x32_bf16 v[12:15], v[100:103], a[100:103], v[12:15]
    ds_read_b64_tr_b16 v[66:67], v128 offset:17408
    s_waitcnt lgkmcnt(12)
    v_mfma_f32_16x16x32_bf16 v[16:19], v[104:107], a[36:39], v[16:19]
    ds_read_b64_tr_b16 v[68:69], v129 offset:16384
    v_mfma_f32_16x16x32_bf16 v[20:23], v[104:107], a[100:103], v[20:23]
    ds_read_b64_tr_b16 v[70:71], v129 offset:17408
    s_waitcnt lgkmcnt(12)
    v_mfma_f32_16x16x32_bf16 v[24:27], v[108:111], a[36:39], v[24:27]
    ds_read_b64_tr_b16 v[72:73], v130 offset:16384
    v_mfma_f32_16x16x32_bf16 v[28:31], v[108:111], a[100:103], v[28:31]
    ds_read_b64_tr_b16 v[74:75], v130 offset:17408
    s_waitcnt lgkmcnt(12)
    v_mfma_f32_16x16x32_bf16 v[32:35], v[112:115], a[36:39], v[32:35]
    ds_read_b64_tr_b16 v[76:77], v131 offset:16384
    v_mfma_f32_16x16x32_bf16 v[36:39], v[112:115], a[100:103], v[36:39]
    ds_read_b64_tr_b16 v[78:79], v131 offset:17408
    s_waitcnt lgkmcnt(12)
    v_mfma_f32_16x16x32_bf16 v[40:43], v[116:119], a[36:39], v[40:43]
    ds_read_b64_tr_b16 v[80:81], v132 offset:16384
    v_mfma_f32_16x16x32_bf16 v[44:47], v[116:119], a[100:103], v[44:47]
    ds_read_b64_tr_b16 v[82:83], v132 offset:17408
    s_waitcnt lgkmcnt(12)
    v_mfma_f32_16x16x32_bf16 v[48:51], v[120:123], a[36:39], v[48:51]
    ds_read_b64_tr_b16 v[84:85], v133 offset:16384
    v_mfma_f32_16x16x32_bf16 v[52:55], v[120:123], a[100:103], v[52:55]
    ds_read_b64_tr_b16 v[86:87], v133 offset:17408
    s_waitcnt lgkmcnt(12)
    v_mfma_f32_16x16x32_bf16 v[56:59], v[124:127], a[36:39], v[56:59]
    ds_read_b64_tr_b16 v[88:89], v134 offset:16384
    v_mfma_f32_16x16x32_bf16 v[60:63], v[124:127], a[100:103], v[60:63]
    ds_read_b64_tr_b16 v[90:91], v134 offset:17408
    s_waitcnt lgkmcnt(12)
    v_mfma_f32_16x16x32_bf16 v[0:3], v[64:67], a[40:43], v[0:3]
    ds_read_b64_tr_b16 v[92:93], v135 offset:16384
    v_mfma_f32_16x16x32_bf16 v[4:7], v[64:67], a[104:107], v[4:7]
    ds_read_b64_tr_b16 v[94:95], v135 offset:17408
    s_waitcnt lgkmcnt(12)
    v_mfma_f32_16x16x32_bf16 v[8:11], v[68:71], a[40:43], v[8:11]
    ds_read_b64_tr_b16 v[96:97], v128 offset:24576
    v_mfma_f32_16x16x32_bf16 v[12:15], v[68:71], a[104:107], v[12:15]
    ds_read_b64_tr_b16 v[98:99], v128 offset:25600
    s_waitcnt lgkmcnt(12)
    v_mfma_f32_16x16x32_bf16 v[16:19], v[72:75], a[40:43], v[16:19]
    ds_read_b64_tr_b16 v[100:101], v129 offset:24576
    v_mfma_f32_16x16x32_bf16 v[20:23], v[72:75], a[104:107], v[20:23]
    ds_read_b64_tr_b16 v[102:103], v129 offset:25600
    s_waitcnt lgkmcnt(12)
    v_mfma_f32_16x16x32_bf16 v[24:27], v[76:79], a[40:43], v[24:27]
    ds_read_b64_tr_b16 v[104:105], v130 offset:24576
    v_mfma_f32_16x16x32_bf16 v[28:31], v[76:79], a[104:107], v[28:31]
    ds_read_b64_tr_b16 v[106:107], v130 offset:25600
    s_waitcnt lgkmcnt(12)
    v_mfma_f32_16x16x32_bf16 v[32:35], v[80:83], a[40:43], v[32:35]
    ds_read_b64_tr_b16 v[108:109], v131 offset:24576
    v_mfma_f32_16x16x32_bf16 v[36:39], v[80:83], a[104:107], v[36:39]
    ds_read_b64_tr_b16 v[110:111], v131 offset:25600
    s_waitcnt lgkmcnt(12)
    v_mfma_f32_16x16x32_bf16 v[40:43], v[84:87], a[40:43], v[40:43]
    ds_read_b64_tr_b16 v[112:113], v132 offset:24576
    v_mfma_f32_16x16x32_bf16 v[44:47], v[84:87], a[104:107], v[44:47]
    ds_read_b64_tr_b16 v[114:115], v132 offset:25600
    s_waitcnt lgkmcnt(12)
    v_mfma_f32_16x16x32_bf16 v[48:51], v[88:91], a[40:43], v[48:51]
    ds_read_b64_tr_b16 v[116:117], v133 offset:24576
    v_mfma_f32_16x16x32_bf16 v[52:55], v[88:91], a[104:107], v[52:55]
    ds_read_b64_tr_b16 v[118:119], v133 offset:25600
    s_waitcnt lgkmcnt(12)
    v_mfma_f32_16x16x32_bf16 v[56:59], v[92:95], a[40:43], v[56:59]
    ds_read_b64_tr_b16 v[120:121], v134 offset:24576
    v_mfma_f32_16x16x32_bf16 v[60:63], v[92:95], a[104:107], v[60:63]
    ds_read_b64_tr_b16 v[122:123], v134 offset:25600
    s_waitcnt lgkmcnt(12)
    v_mfma_f32_16x16x32_bf16 v[0:3], v[96:99], a[44:47], v[0:3]
    ds_read_b64_tr_b16 v[124:125], v135 offset:24576
    v_mfma_f32_16x16x32_bf16 v[4:7], v[96:99], a[108:111], v[4:7]
    ds_read_b64_tr_b16 v[126:127], v135 offset:25600
    s_waitcnt lgkmcnt(12)
    v_mfma_f32_16x16x32_bf16 v[8:11], v[100:103], a[44:47], v[8:11]
    v_mfma_f32_16x16x32_bf16 v[12:15], v[100:103], a[108:111], v[12:15]
    s_waitcnt lgkmcnt(10)
    v_mfma_f32_16x16x32_bf16 v[16:19], v[104:107], a[44:47], v[16:19]
    v_mfma_f32_16x16x32_bf16 v[20:23], v[104:107], a[108:111], v[20:23]
    s_waitcnt lgkmcnt(8)
    v_mfma_f32_16x16x32_bf16 v[24:27], v[108:111], a[44:47], v[24:27]
    v_mfma_f32_16x16x32_bf16 v[28:31], v[108:111], a[108:111], v[28:31]
    s_waitcnt lgkmcnt(6)
    v_mfma_f32_16x16x32_bf16 v[32:35], v[112:115], a[44:47], v[32:35]
    v_mfma_f32_16x16x32_bf16 v[36:39], v[112:115], a[108:111], v[36:39]
    s_waitcnt lgkmcnt(4)
    v_mfma_f32_16x16x32_bf16 v[40:43], v[116:119], a[44:47], v[40:43]
    v_mfma_f32_16x16x32_bf16 v[44:47], v[116:119], a[108:111], v[44:47]
    s_waitcnt lgkmcnt(2)
    v_mfma_f32_16x16x32_bf16 v[48:51], v[120:123], a[44:47], v[48:51]
    v_mfma_f32_16x16x32_bf16 v[52:55], v[120:123], a[108:111], v[52:55]
    s_waitcnt lgkmcnt(0)
    v_mfma_f32_16x16x32_bf16 v[56:59], v[124:127], a[44:47], v[56:59]
    v_mfma_f32_16x16x32_bf16 v[60:63], v[124:127], a[108:111], v[60:63]
    s_waitcnt vmcnt(16)
    s_barrier
    ds_read_b64_tr_b16 v[64:65], v128 offset:32768
    ds_read_b64_tr_b16 v[66:67], v128 offset:33792
    ds_read_b64_tr_b16 v[68:69], v129 offset:32768
    ds_read_b64_tr_b16 v[70:71], v129 offset:33792
    ds_read_b64_tr_b16 v[72:73], v130 offset:32768
    ds_read_b64_tr_b16 v[74:75], v130 offset:33792
    ds_read_b64_tr_b16 v[76:77], v131 offset:32768
    ds_read_b64_tr_b16 v[78:79], v131 offset:33792
    ds_read_b64_tr_b16 v[80:81], v132 offset:32768
    ds_read_b64_tr_b16 v[82:83], v132 offset:33792
    ds_read_b64_tr_b16 v[84:85], v133 offset:32768
    ds_read_b64_tr_b16 v[86:87], v133 offset:33792
    ds_read_b64_tr_b16 v[88:89], v134 offset:32768
    ds_read_b64_tr_b16 v[90:91], v134 offset:33792
    s_waitcnt lgkmcnt(12)
    v_mfma_f32_16x16x32_bf16 v[0:3], v[64:67], a[48:51], v[0:3]
    ds_read_b64_tr_b16 v[92:93], v135 offset:32768
    v_mfma_f32_16x16x32_bf16 v[4:7], v[64:67], a[112:115], v[4:7]
    ds_read_b64_tr_b16 v[94:95], v135 offset:33792
    s_add_u32 s26, s24, 0x200000
    s_add_u32 m0, s29, 0x10000
    s_nop 0
    buffer_load_dwordx4 v136, s[16:19], s26 offen lds
    s_waitcnt lgkmcnt(12)
    v_mfma_f32_16x16x32_bf16 v[8:11], v[68:71], a[48:51], v[8:11]
    ds_read_b64_tr_b16 v[96:97], v128 offset:40960
    v_mfma_f32_16x16x32_bf16 v[12:15], v[68:71], a[112:115], v[12:15]
    ds_read_b64_tr_b16 v[98:99], v128 offset:41984
    s_add_u32 s26, s24, 0x220000
    s_add_u32 m0, s29, 0x11000
    s_nop 0
    buffer_load_dwordx4 v136, s[16:19], s26 offen lds
    s_waitcnt lgkmcnt(12)
    v_mfma_f32_16x16x32_bf16 v[16:19], v[72:75], a[48:51], v[16:19]
    ds_read_b64_tr_b16 v[100:101], v129 offset:40960
    v_mfma_f32_16x16x32_bf16 v[20:23], v[72:75], a[112:115], v[20:23]
    ds_read_b64_tr_b16 v[102:103], v129 offset:41984
    s_add_u32 s26, s24, 0x240000
    s_add_u32 m0, s29, 0x12000
    s_nop 0
    buffer_load_dwordx4 v136, s[16:19], s26 offen lds
    s_waitcnt lgkmcnt(12)
    v_mfma_f32_16x16x32_bf16 v[24:27], v[76:79], a[48:51], v[24:27]
    ds_read_b64_tr_b16 v[104:105], v130 offset:40960
    v_mfma_f32_16x16x32_bf16 v[28:31], v[76:79], a[112:115], v[28:31]
    ds_read_b64_tr_b16 v[106:107], v130 offset:41984
    s_add_u32 s26, s24, 0x260000
    s_add_u32 m0, s29, 0x13000
    s_nop 0
    buffer_load_dwordx4 v136, s[16:19], s26 offen lds
    s_waitcnt lgkmcnt(12)
    v_mfma_f32_16x16x32_bf16 v[32:35], v[80:83], a[48:51], v[32:35]
    ds_read_b64_tr_b16 v[108:109], v131 offset:40960
    v_mfma_f32_16x16x32_bf16 v[36:39], v[80:83], a[112:115], v[36:39]
    ds_read_b64_tr_b16 v[110:111], v131 offset:41984
    s_add_u32 s26, s24, 0x280000
    s_add_u32 m0, s29, 0x14000
    s_nop 0
    buffer_load_dwordx4 v136, s[16:19], s26 offen lds
    s_waitcnt lgkmcnt(12)
    v_mfma_f32_16x16x32_bf16 v[40:43], v[84:87], a[48:51], v[40:43]
    ds_read_b64_tr_b16 v[112:113], v132 offset:40960
    v_mfma_f32_16x16x32_bf16 v[44:47], v[84:87], a[112:115], v[44:47]
    ds_read_b64_tr_b16 v[114:115], v132 offset:41984
    s_add_u32 s26, s24, 0x2a0000
    s_add_u32 m0, s29, 0x15000
    s_nop 0
    buffer_load_dwordx4 v136, s[16:19], s26 offen lds
    s_waitcnt lgkmcnt(12)
    v_mfma_f32_16x16x32_bf16 v[48:51], v[88:91], a[48:51], v[48:51]
    ds_read_b64_tr_b16 v[116:117], v133 offset:40960
    v_mfma_f32_16x16x32_bf16 v[52:55], v[88:91], a[112:115], v[52:55]
    ds_read_b64_tr_b16 v[118:119], v133 offset:41984
    s_add_u32 s26, s24, 0x2c0000
    s_add_u32 m0, s29, 0x16000
    s_nop 0
    buffer_load_dwordx4 v136, s[16:19], s26 offen lds
    s_waitcnt lgkmcnt(12)
    v_mfma_f32_16x16x32_bf16 v[56:59], v[92:95], a[48:51], v[56:59]
    ds_read_b64_tr_b16 v[120:121], v134 offset:40960
    v_mfma_f32_16x16x32_bf16 v[60:63], v[92:95], a[112:115], v[60:63]
    ds_read_b64_tr_b16 v[122:123], v134 offset:41984
    s_add_u32 s26, s24, 0x2e0000
    s_add_u32 m0, s29, 0x17000
    s_nop 0
    buffer_load_dwordx4 v136, s[16:19], s26 offen lds
    s_waitcnt lgkmcnt(12)
    v_mfma_f32_16x16x32_bf16 v[0:3], v[96:99], a[52:55], v[0:3]
    ds_read_b64_tr_b16 v[124:125], v135 offset:40960
    v_mfma_f32_16x16x32_bf16 v[4:7], v[96:99], a[116:119], v[4:7]
    ds_read_b64_tr_b16 v[126:127], v135 offset:41984
    s_waitcnt lgkmcnt(12)
    v_mfma_f32_16x16x32_bf16 v[8:11], v[100:103], a[52:55], v[8:11]
    ds_read_b64_tr_b16 v[64:65], v128 offset:49152
    v_mfma_f32_16x16x32_bf16 v[12:15], v[100:103], a[116:119], v[12:15]
    ds_read_b64_tr_b16 v[66:67], v128 offset:50176
    s_waitcnt lgkmcnt(12)
    v_mfma_f32_16x16x32_bf16 v[16:19], v[104:107], a[52:55], v[16:19]
    ds_read_b64_tr_b16 v[68:69], v129 offset:49152
    v_mfma_f32_16x16x32_bf16 v[20:23], v[104:107], a[116:119], v[20:23]
    ds_read_b64_tr_b16 v[70:71], v129 offset:50176
    s_waitcnt lgkmcnt(12)
    v_mfma_f32_16x16x32_bf16 v[24:27], v[108:111], a[52:55], v[24:27]
    ds_read_b64_tr_b16 v[72:73], v130 offset:49152
    v_mfma_f32_16x16x32_bf16 v[28:31], v[108:111], a[116:119], v[28:31]
    ds_read_b64_tr_b16 v[74:75], v130 offset:50176
    s_waitcnt lgkmcnt(12)
    v_mfma_f32_16x16x32_bf16 v[32:35], v[112:115], a[52:55], v[32:35]
    ds_read_b64_tr_b16 v[76:77], v131 offset:49152
    v_mfma_f32_16x16x32_bf16 v[36:39], v[112:115], a[116:119], v[36:39]
    ds_read_b64_tr_b16 v[78:79], v131 offset:50176
    s_waitcnt lgkmcnt(12)
    v_mfma_f32_16x16x32_bf16 v[40:43], v[116:119], a[52:55], v[40:43]
    ds_read_b64_tr_b16 v[80:81], v132 offset:49152
    v_mfma_f32_16x16x32_bf16 v[44:47], v[116:119], a[116:119], v[44:47]
    ds_read_b64_tr_b16 v[82:83], v132 offset:50176
    s_waitcnt lgkmcnt(12)
    v_mfma_f32_16x16x32_bf16 v[48:51], v[120:123], a[52:55], v[48:51]
    ds_read_b64_tr_b16 v[84:85], v133 offset:49152
    v_mfma_f32_16x16x32_bf16 v[52:55], v[120:123], a[116:119], v[52:55]
    ds_read_b64_tr_b16 v[86:87], v133 offset:50176
    s_waitcnt lgkmcnt(12)
    v_mfma_f32_16x16x32_bf16 v[56:59], v[124:127], a[52:55], v[56:59]
    ds_read_b64_tr_b16 v[88:89], v134 offset:49152
    v_mfma_f32_16x16x32_bf16 v[60:63], v[124:127], a[116:119], v[60:63]
    ds_read_b64_tr_b16 v[90:91], v134 offset:50176
    s_waitcnt lgkmcnt(12)
    v_mfma_f32_16x16x32_bf16 v[0:3], v[64:67], a[56:59], v[0:3]
    ds_read_b64_tr_b16 v[92:93], v135 offset:49152
    v_mfma_f32_16x16x32_bf16 v[4:7], v[64:67], a[120:123], v[4:7]
    ds_read_b64_tr_b16 v[94:95], v135 offset:50176
    s_waitcnt lgkmcnt(12)
    v_mfma_f32_16x16x32_bf16 v[8:11], v[68:71], a[56:59], v[8:11]
    ds_read_b64_tr_b16 v[96:97], v128 offset:57344
    v_mfma_f32_16x16x32_bf16 v[12:15], v[68:71], a[120:123], v[12:15]
    ds_read_b64_tr_b16 v[98:99], v128 offset:58368
    s_waitcnt lgkmcnt(12)
    v_mfma_f32_16x16x32_bf16 v[16:19], v[72:75], a[56:59], v[16:19]
    ds_read_b64_tr_b16 v[100:101], v129 offset:57344
    v_mfma_f32_16x16x32_bf16 v[20:23], v[72:75], a[120:123], v[20:23]
    ds_read_b64_tr_b16 v[102:103], v129 offset:58368
    s_waitcnt lgkmcnt(12)
    v_mfma_f32_16x16x32_bf16 v[24:27], v[76:79], a[56:59], v[24:27]
    ds_read_b64_tr_b16 v[104:105], v130 offset:57344
    v_mfma_f32_16x16x32_bf16 v[28:31], v[76:79], a[120:123], v[28:31]
    ds_read_b64_tr_b16 v[106:107], v130 offset:58368
    s_waitcnt lgkmcnt(12)
    v_mfma_f32_16x16x32_bf16 v[32:35], v[80:83], a[56:59], v[32:35]
    ds_read_b64_tr_b16 v[108:109], v131 offset:57344
    v_mfma_f32_16x16x32_bf16 v[36:39], v[80:83], a[120:123], v[36:39]
    ds_read_b64_tr_b16 v[110:111], v131 offset:58368
    s_waitcnt lgkmcnt(12)
    v_mfma_f32_16x16x32_bf16 v[40:43], v[84:87], a[56:59], v[40:43]
    ds_read_b64_tr_b16 v[112:113], v132 offset:57344
    v_mfma_f32_16x16x32_bf16 v[44:47], v[84:87], a[120:123], v[44:47]
    ds_read_b64_tr_b16 v[114:115], v132 offset:58368
    s_waitcnt lgkmcnt(12)
    v_mfma_f32_16x16x32_bf16 v[48:51], v[88:91], a[56:59], v[48:51]
    ds_read_b64_tr_b16 v[116:117], v133 offset:57344
    v_mfma_f32_16x16x32_bf16 v[52:55], v[88:91], a[120:123], v[52:55]
    ds_read_b64_tr_b16 v[118:119], v133 offset:58368
    s_waitcnt lgkmcnt(12)
    v_mfma_f32_16x16x32_bf16 v[56:59], v[92:95], a[56:59], v[56:59]
    ds_read_b64_tr_b16 v[120:121], v134 offset:57344
    v_mfma_f32_16x16x32_bf16 v[60:63], v[92:95], a[120:123], v[60:63]
    ds_read_b64_tr_b16 v[122:123], v134 offset:58368
    s_waitcnt lgkmcnt(12)
    v_mfma_f32_16x16x32_bf16 v[0:3], v[96:99], a[60:63], v[0:3]
    ds_read_b64_tr_b16 v[124:125], v135 offset:57344
    v_mfma_f32_16x16x32_bf16 v[4:7], v[96:99], a[124:127], v[4:7]
    ds_read_b64_tr_b16 v[126:127], v135 offset:58368
    s_waitcnt lgkmcnt(12)
    v_mfma_f32_16x16x32_bf16 v[8:11], v[100:103], a[60:63], v[8:11]
    v_mfma_f32_16x16x32_bf16 v[12:15], v[100:103], a[124:127], v[12:15]
    s_waitcnt lgkmcnt(10)
    v_mfma_f32_16x16x32_bf16 v[16:19], v[104:107], a[60:63], v[16:19]
    v_mfma_f32_16x16x32_bf16 v[20:23], v[104:107], a[124:127], v[20:23]
    s_waitcnt lgkmcnt(8)
    v_mfma_f32_16x16x32_bf16 v[24:27], v[108:111], a[60:63], v[24:27]
    v_mfma_f32_16x16x32_bf16 v[28:31], v[108:111], a[124:127], v[28:31]
    s_waitcnt lgkmcnt(6)
    v_mfma_f32_16x16x32_bf16 v[32:35], v[112:115], a[60:63], v[32:35]
    v_mfma_f32_16x16x32_bf16 v[36:39], v[112:115], a[124:127], v[36:39]
    s_waitcnt lgkmcnt(4)
    v_mfma_f32_16x16x32_bf16 v[40:43], v[116:119], a[60:63], v[40:43]
    v_mfma_f32_16x16x32_bf16 v[44:47], v[116:119], a[124:127], v[44:47]
    s_waitcnt lgkmcnt(2)
    v_mfma_f32_16x16x32_bf16 v[48:51], v[120:123], a[60:63], v[48:51]
    v_mfma_f32_16x16x32_bf16 v[52:55], v[120:123], a[124:127], v[52:55]
    s_waitcnt lgkmcnt(0)
    v_mfma_f32_16x16x32_bf16 v[56:59], v[124:127], a[60:63], v[56:59]
    v_mfma_f32_16x16x32_bf16 v[60:63], v[124:127], a[124:127], v[60:63]
    v_xor_b32 v128, 0x10000, v128
    v_xor_b32 v129, 0x10000, v129
    v_xor_b32 v130, 0x10000, v130
    v_xor_b32 v131, 0x10000, v131
    v_xor_b32 v132, 0x10000, v132
    v_xor_b32 v133, 0x10000, v133
    v_xor_b32 v134, 0x10000, v134
    v_xor_b32 v135, 0x10000, v135
    v_cvt_pk_bf16_f32 v144, v0, v8
    v_cvt_pk_bf16_f32 v145, v1, v9
    v_cvt_pk_bf16_f32 v146, v2, v10
    v_cvt_pk_bf16_f32 v147, v3, v11
    buffer_store_dwordx4 v[144:147], v137, s[8:11], s25 offen sc1
    v_cvt_pk_bf16_f32 v148, v16, v24
    v_cvt_pk_bf16_f32 v149, v17, v25
    v_cvt_pk_bf16_f32 v150, v18, v26
    v_cvt_pk_bf16_f32 v151, v19, v27
    buffer_store_dwordx4 v[148:151], v137, s[8:11], s25 offen offset:1024 sc1
    v_cvt_pk_bf16_f32 v152, v32, v40
    v_cvt_pk_bf16_f32 v153, v33, v41
    v_cvt_pk_bf16_f32 v154, v34, v42
    v_cvt_pk_bf16_f32 v155, v35, v43
    buffer_store_dwordx4 v[152:155], v137, s[8:11], s25 offen offset:2048 sc1
    v_cvt_pk_bf16_f32 v156, v48, v56
    v_cvt_pk_bf16_f32 v157, v49, v57
    v_cvt_pk_bf16_f32 v158, v50, v58
    v_cvt_pk_bf16_f32 v159, v51, v59
    buffer_store_dwordx4 v[156:159], v137, s[8:11], s25 offen offset:3072 sc1
    v_cvt_pk_bf16_f32 v144, v4, v12
    v_cvt_pk_bf16_f32 v145, v5, v13
    v_cvt_pk_bf16_f32 v146, v6, v14
    v_cvt_pk_bf16_f32 v147, v7, v15
    s_add_u32 s25, s25, 4096
    buffer_store_dwordx4 v[144:147], v137, s[8:11], s25 offen sc1
    v_cvt_pk_bf16_f32 v148, v20, v28
    v_cvt_pk_bf16_f32 v149, v21, v29
    v_cvt_pk_bf16_f32 v150, v22, v30
    v_cvt_pk_bf16_f32 v151, v23, v31
    buffer_store_dwordx4 v[148:151], v137, s[8:11], s25 offen offset:1024 sc1
    v_cvt_pk_bf16_f32 v152, v36, v44
    v_cvt_pk_bf16_f32 v153, v37, v45
    v_cvt_pk_bf16_f32 v154, v38, v46
    v_cvt_pk_bf16_f32 v155, v39, v47
    buffer_store_dwordx4 v[152:155], v137, s[8:11], s25 offen offset:2048 sc1
    v_cvt_pk_bf16_f32 v156, v52, v60
    v_cvt_pk_bf16_f32 v157, v53, v61
    v_cvt_pk_bf16_f32 v158, v54, v62
    v_cvt_pk_bf16_f32 v159, v55, v63
    buffer_store_dwordx4 v[156:159], v137, s[8:11], s25 offen offset:3072 sc1
    s_branch L_p1_next
L_p1_v:
    s_waitcnt vmcnt(16)
    s_barrier
    ds_read_b64_tr_b16 v[64:65], v128
    ds_read_b64_tr_b16 v[66:67], v128 offset:1024
    ds_read_b64_tr_b16 v[68:69], v129
    ds_read_b64_tr_b16 v[70:71], v129 offset:1024
    ds_read_b64_tr_b16 v[72:73], v130
    ds_read_b64_tr_b16 v[74:75], v130 offset:1024
    ds_read_b64_tr_b16 v[76:77], v131
    ds_read_b64_tr_b16 v[78:79], v131 offset:1024
    ds_read_b64_tr_b16 v[80:81], v132
    ds_read_b64_tr_b16 v[82:83], v132 offset:1024
    ds_read_b64_tr_b16 v[84:85], v133
    ds_read_b64_tr_b16 v[86:87], v133 offset:1024
    ds_read_b64_tr_b16 v[88:89], v134
    ds_read_b64_tr_b16 v[90:91], v134 offset:1024
    s_waitcnt lgkmcnt(12)
    v_mfma_f32_16x16x32_bf16 v[0:3], a[0:3], v[64:67], 0
    ds_read_b64_tr_b16 v[92:93], v135
    v_mfma_f32_16x16x32_bf16 v[4:7], a[64:67], v[64:67], 0
    ds_read_b64_tr_b16 v[94:95], v135 offset:1024
    s_add_u32 s26, s24, 0x300000
    s_add_u32 m0, s29, 0x18000
    s_nop 0
    buffer_load_dwordx4 v136, s[16:19], s26 offen lds
    s_waitcnt lgkmcnt(12)
    v_mfma_f32_16x16x32_bf16 v[8:11], a[0:3], v[68:71], 0
    ds_read_b64_tr_b16 v[96:97], v128 offset:8192
    v_mfma_f32_16x16x32_bf16 v[12:15], a[64:67], v[68:71], 0
    ds_read_b64_tr_b16 v[98:99], v128 offset:9216
    s_add_u32 s26, s24, 0x320000
    s_add_u32 m0, s29, 0x19000
    s_nop 0
    buffer_load_dwordx4 v136, s[16:19], s26 offen lds
    s_waitcnt lgkmcnt(12)
    v_mfma_f32_16x16x32_bf16 v[16:19], a[0:3], v[72:75], 0
    ds_read_b64_tr_b16 v[100:101], v129 offset:8192
    v_mfma_f32_16x16x32_bf16 v[20:23], a[64:67], v[72:75], 0
    ds_read_b64_tr_b16 v[102:103], v129 offset:9216
    s_add_u32 s26, s24, 0x340000
    s_add_u32 m0, s29, 0x1a000
    s_nop 0
    buffer_load_dwordx4 v136, s[16:19], s26 offen lds
    s_waitcnt lgkmcnt(12)
    v_mfma_f32_16x16x32_bf16 v[24:27], a[0:3], v[76:79], 0
    ds_read_b64_tr_b16 v[104:105], v130 offset:8192
    v_mfma_f32_16x16x32_bf16 v[28:31], a[64:67], v[76:79], 0
    ds_read_b64_tr_b16 v[106:107], v130 offset:9216
    s_add_u32 s26, s24, 0x360000
    s_add_u32 m0, s29, 0x1b000
    s_nop 0
    buffer_load_dwordx4 v136, s[16:19], s26 offen lds
    s_waitcnt lgkmcnt(12)
    v_mfma_f32_16x16x32_bf16 v[32:35], a[0:3], v[80:83], 0
    ds_read_b64_tr_b16 v[108:109], v131 offset:8192
    v_mfma_f32_16x16x32_bf16 v[36:39], a[64:67], v[80:83], 0
    ds_read_b64_tr_b16 v[110:111], v131 offset:9216
    s_add_u32 s26, s24, 0x380000
    s_add_u32 m0, s29, 0x1c000
    s_nop 0
    buffer_load_dwordx4 v136, s[16:19], s26 offen lds
    s_waitcnt lgkmcnt(12)
    v_mfma_f32_16x16x32_bf16 v[40:43], a[0:3], v[84:87], 0
    ds_read_b64_tr_b16 v[112:113], v132 offset:8192
    v_mfma_f32_16x16x32_bf16 v[44:47], a[64:67], v[84:87], 0
    ds_read_b64_tr_b16 v[114:115], v132 offset:9216
    s_add_u32 s26, s24, 0x3a0000
    s_add_u32 m0, s29, 0x1d000
    s_nop 0
    buffer_load_dwordx4 v136, s[16:19], s26 offen lds
    s_waitcnt lgkmcnt(12)
    v_mfma_f32_16x16x32_bf16 v[48:51], a[0:3], v[88:91], 0
    ds_read_b64_tr_b16 v[116:117], v133 offset:8192
    v_mfma_f32_16x16x32_bf16 v[52:55], a[64:67], v[88:91], 0
    ds_read_b64_tr_b16 v[118:119], v133 offset:9216
    s_add_u32 s26, s24, 0x3c0000
    s_add_u32 m0, s29, 0x1e000
    s_nop 0
    buffer_load_dwordx4 v136, s[16:19], s26 offen lds
    s_waitcnt lgkmcnt(12)
    v_mfma_f32_16x16x32_bf16 v[56:59], a[0:3], v[92:95], 0
    ds_read_b64_tr_b16 v[120:121], v134 offset:8192
    v_mfma_f32_16x16x32_bf16 v[60:63], a[64:67], v[92:95], 0
    ds_read_b64_tr_b16 v[122:123], v134 offset:9216
    s_add_u32 s26, s24, 0x3e0000
    s_add_u32 m0, s29, 0x1f000
    s_nop 0
    buffer_load_dwordx4 v136, s[16:19], s26 offen lds
    s_waitcnt lgkmcnt(12)
    v_mfma_f32_16x16x32_bf16 v[0:3], a[4:7], v[96:99], v[0:3]
    ds_read_b64_tr_b16 v[124:125], v135 offset:8192
    v_mfma_f32_16x16x32_bf16 v[4:7], a[68:71], v[96:99], v[4:7]
    ds_read_b64_tr_b16 v[126:127], v135 offset:9216
    s_waitcnt lgkmcnt(12)
    v_mfma_f32_16x16x32_bf16 v[8:11], a[4:7], v[100:103], v[8:11]
    ds_read_b64_tr_b16 v[64:65], v128 offset:16384
    v_mfma_f32_16x16x32_bf16 v[12:15], a[68:71], v[100:103], v[12:15]
    ds_read_b64_tr_b16 v[66:67], v128 offset:17408
    s_waitcnt lgkmcnt(12)
    v_mfma_f32_16x16x32_bf16 v[16:19], a[4:7], v[104:107], v[16:19]
    ds_read_b64_tr_b16 v[68:69], v129 offset:16384
    v_mfma_f32_16x16x32_bf16 v[20:23], a[68:71], v[104:107], v[20:23]
    ds_read_b64_tr_b16 v[70:71], v129 offset:17408
    s_waitcnt lgkmcnt(12)
    v_mfma_f32_16x16x32_bf16 v[24:27], a[4:7], v[108:111], v[24:27]
    ds_read_b64_tr_b16 v[72:73], v130 offset:16384
    v_mfma_f32_16x16x32_bf16 v[28:31], a[68:71], v[108:111], v[28:31]
    ds_read_b64_tr_b16 v[74:75], v130 offset:17408
    s_waitcnt lgkmcnt(12)
    v_mfma_f32_16x16x32_bf16 v[32:35], a[4:7], v[112:115], v[32:35]
    ds_read_b64_tr_b16 v[76:77], v131 offset:16384
    v_mfma_f32_16x16x32_bf16 v[36:39], a[68:71], v[112:115], v[36:39]
    ds_read_b64_tr_b16 v[78:79], v131 offset:17408
    s_waitcnt lgkmcnt(12)
    v_mfma_f32_16x16x32_bf16 v[40:43], a[4:7], v[116:119], v[40:43]
    ds_read_b64_tr_b16 v[80:81], v132 offset:16384
    v_mfma_f32_16x16x32_bf16 v[44:47], a[68:71], v[116:119], v[44:47]
    ds_read_b64_tr_b16 v[82:83], v132 offset:17408
    s_waitcnt lgkmcnt(12)
    v_mfma_f32_16x16x32_bf16 v[48:51], a[4:7], v[120:123], v[48:51]
    ds_read_b64_tr_b16 v[84:85], v133 offset:16384
    v_mfma_f32_16x16x32_bf16 v[52:55], a[68:71], v[120:123], v[52:55]
    ds_read_b64_tr_b16 v[86:87], v133 offset:17408
    s_waitcnt lgkmcnt(12)
    v_mfma_f32_16x16x32_bf16 v[56:59], a[4:7], v[124:127], v[56:59]
    ds_read_b64_tr_b16 v[88:89], v134 offset:16384
    v_mfma_f32_16x16x32_bf16 v[60:63], a[68:71], v[124:127], v[60:63]
    ds_read_b64_tr_b16 v[90:91], v134 offset:17408
    s_waitcnt lgkmcnt(12)
    v_mfma_f32_16x16x32_bf16 v[0:3], a[8:11], v[64:67], v[0:3]
    ds_read_b64_tr_b16 v[92:93], v135 offset:16384
    v_mfma_f32_16x16x32_bf16 v[4:7], a[72:75], v[64:67], v[4:7]
    ds_read_b64_tr_b16 v[94:95], v135 offset:17408
    s_waitcnt lgkmcnt(12)
    v_mfma_f32_16x16x32_bf16 v[8:11], a[8:11], v[68:71], v[8:11]
    ds_read_b64_tr_b16 v[96:97], v128 offset:24576
    v_mfma_f32_16x16x32_bf16 v[12:15], a[72:75], v[68:71], v[12:15]
    ds_read_b64_tr_b16 v[98:99], v128 offset:25600
    s_waitcnt lgkmcnt(12)
    v_mfma_f32_16x16x32_bf16 v[16:19], a[8:11], v[72:75], v[16:19]
    ds_read_b64_tr_b16 v[100:101], v129 offset:24576
    v_mfma_f32_16x16x32_bf16 v[20:23], a[72:75], v[72:75], v[20:23]
    ds_read_b64_tr_b16 v[102:103], v129 offset:25600
    s_waitcnt lgkmcnt(12)
    v_mfma_f32_16x16x32_bf16 v[24:27], a[8:11], v[76:79], v[24:27]
    ds_read_b64_tr_b16 v[104:105], v130 offset:24576
    v_mfma_f32_16x16x32_bf16 v[28:31], a[72:75], v[76:79], v[28:31]
    ds_read_b64_tr_b16 v[106:107], v130 offset:25600
    s_waitcnt lgkmcnt(12)
    v_mfma_f32_16x16x32_bf16 v[32:35], a[8:11], v[80:83], v[32:35]
    ds_read_b64_tr_b16 v[108:109], v131 offset:24576
    v_mfma_f32_16x16x32_bf16 v[36:39], a[72:75], v[80:83], v[36:39]
    ds_read_b64_tr_b16 v[110:111], v131 offset:25600
    s_waitcnt lgkmcnt(12)
    v_mfma_f32_16x16x32_bf16 v[40:43], a[8:11], v[84:87], v[40:43]
    ds_read_b64_tr_b16 v[112:113], v132 offset:24576
    v_mfma_f32_16x16x32_bf16 v[44:47], a[72:75], v[84:87], v[44:47]
    ds_read_b64_tr_b16 v[114:115], v132 offset:25600
    s_waitcnt lgkmcnt(12)
    v_mfma_f32_16x16x32_bf16 v[48:51], a[8:11], v[88:91], v[48:51]
    ds_read_b64_tr_b16 v[116:117], v133 offset:24576
    v_mfma_f32_16x16x32_bf16 v[52:55], a[72:75], v[88:91], v[52:55]
    ds_read_b64_tr_b16 v[118:119], v133 offset:25600
    s_waitcnt lgkmcnt(12)
    v_mfma_f32_16x16x32_bf16 v[56:59], a[8:11], v[92:95], v[56:59]
    ds_read_b64_tr_b16 v[120:121], v134 offset:24576
    v_mfma_f32_16x16x32_bf16 v[60:63], a[72:75], v[92:95], v[60:63]
    ds_read_b64_tr_b16 v[122:123], v134 offset:25600
    s_waitcnt lgkmcnt(12)
    v_mfma_f32_16x16x32_bf16 v[0:3], a[12:15], v[96:99], v[0:3]
    ds_read_b64_tr_b16 v[124:125], v135 offset:24576
    v_mfma_f32_16x16x32_bf16 v[4:7], a[76:79], v[96:99], v[4:7]
    ds_read_b64_tr_b16 v[126:127], v135 offset:25600
    s_waitcnt lgkmcnt(12)
    v_mfma_f32_16x16x32_bf16 v[8:11], a[12:15], v[100:103], v[8:11]
    v_mfma_f32_16x16x32_bf16 v[12:15], a[76:79], v[100:103], v[12:15]
    s_waitcnt lgkmcnt(10)
    v_mfma_f32_16x16x32_bf16 v[16:19], a[12:15], v[104:107], v[16:19]
    v_mfma_f32_16x16x32_bf16 v[20:23], a[76:79], v[104:107], v[20:23]
    s_waitcnt lgkmcnt(8)
    v_mfma_f32_16x16x32_bf16 v[24:27], a[12:15], v[108:111], v[24:27]
    v_mfma_f32_16x16x32_bf16 v[28:31], a[76:79], v[108:111], v[28:31]
    s_waitcnt lgkmcnt(6)
    v_mfma_f32_16x16x32_bf16 v[32:35], a[12:15], v[112:115], v[32:35]
    v_mfma_f32_16x16x32_bf16 v[36:39], a[76:79], v[112:115], v[36:39]
    s_waitcnt lgkmcnt(4)
    v_mfma_f32_16x16x32_bf16 v[40:43], a[12:15], v[116:119], v[40:43]
    v_mfma_f32_16x16x32_bf16 v[44:47], a[76:79], v[116:119], v[44:47]
    s_waitcnt lgkmcnt(2)
    v_mfma_f32_16x16x32_bf16 v[48:51], a[12:15], v[120:123], v[48:51]
    v_mfma_f32_16x16x32_bf16 v[52:55], a[76:79], v[120:123], v[52:55]
    s_waitcnt lgkmcnt(0)
    v_mfma_f32_16x16x32_bf16 v[56:59], a[12:15], v[124:127], v[56:59]
    v_mfma_f32_16x16x32_bf16 v[60:63], a[76:79], v[124:127], v[60:63]
    s_waitcnt vmcnt(16)
    s_barrier
    ds_read_b64_tr_b16 v[64:65], v128 offset:32768
    ds_read_b64_tr_b16 v[66:67], v128 offset:33792
    ds_read_b64_tr_b16 v[68:69], v129 offset:32768
    ds_read_b64_tr_b16 v[70:71], v129 offset:33792
    ds_read_b64_tr_b16 v[72:73], v130 offset:32768
    ds_read_b64_tr_b16 v[74:75], v130 offset:33792
    ds_read_b64_tr_b16 v[76:77], v131 offset:32768
    ds_read_b64_tr_b16 v[78:79], v131 offset:33792
    ds_read_b64_tr_b16 v[80:81], v132 offset:32768
    ds_read_b64_tr_b16 v[82:83], v132 offset:33792
    ds_read_b64_tr_b16 v[84:85], v133 offset:32768
    ds_read_b64_tr_b16 v[86:87], v133 offset:33792
    ds_read_b64_tr_b16 v[88:89], v134 offset:32768
    ds_read_b64_tr_b16 v[90:91], v134 offset:33792
    s_add_u32 s39, s39, s37
    s_lshr_b32 s26, s39, 5
    s_cmp_eq_u32 s26, 0
    s_cselect_b64 s[16:17], s[30:31], s[34:35]
    s_cmp_eq_u32 s26, 1
    s_cselect_b64 s[16:17], s[32:33], s[16:17]
    s_and_b32 s17, s17, 0xffff
    s_cmp_lt_u32 s39, 96
    s_cselect_b32 s18, 0x400000, 0
    s_and_b32 s24, s39, 31
    s_lshl_b32 s24, s24, 8
    s_waitcnt lgkmcnt(12)
    v_mfma_f32_16x16x32_bf16 v[0:3], a[16:19], v[64:67], v[0:3]
    ds_read_b64_tr_b16 v[92:93], v135 offset:32768
    v_mfma_f32_16x16x32_bf16 v[4:7], a[80:83], v[64:67], v[4:7]
    ds_read_b64_tr_b16 v[94:95], v135 offset:33792
    s_add_u32 s26, s24, 0x0
    s_add_u32 m0, s29, 0x0
    s_nop 0
    buffer_load_dwordx4 v136, s[16:19], s26 offen lds
    s_waitcnt lgkmcnt(12)
    v_mfma_f32_16x16x32_bf16 v[8:11], a[16:19], v[68:71], v[8:11]
    ds_read_b64_tr_b16 v[96:97], v128 offset:40960
    v_mfma_f32_16x16x32_bf16 v[12:15], a[80:83], v[68:71], v[12:15]
    ds_read_b64_tr_b16 v[98:99], v128 offset:41984
    s_add_u32 s26, s24, 0x20000
    s_add_u32 m0, s29, 0x1000
    s_nop 0
    buffer_load_dwordx4 v136, s[16:19], s26 offen lds
    s_waitcnt lgkmcnt(12)
    v_mfma_f32_16x16x32_bf16 v[16:19], a[16:19], v[72:75], v[16:19]
    ds_read_b64_tr_b16 v[100:101], v129 offset:40960
    v_mfma_f32_16x16x32_bf16 v[20:23], a[80:83], v[72:75], v[20:23]
    ds_read_b64_tr_b16 v[102:103], v129 offset:41984
    s_add_u32 s26, s24, 0x40000
    s_add_u32 m0, s29, 0x2000
    s_nop 0
    buffer_load_dwordx4 v136, s[16:19], s26 offen lds
    s_waitcnt lgkmcnt(12)
    v_mfma_f32_16x16x32_bf16 v[24:27], a[16:19], v[76:79], v[24:27]
    ds_read_b64_tr_b16 v[104:105], v130 offset:40960
    v_mfma_f32_16x16x32_bf16 v[28:31], a[80:83], v[76:79], v[28:31]
    ds_read_b64_tr_b16 v[106:107], v130 offset:41984
    s_add_u32 s26, s24, 0x60000
    s_add_u32 m0, s29, 0x3000
    s_nop 0
    buffer_load_dwordx4 v136, s[16:19], s26 offen lds
    s_waitcnt lgkmcnt(12)
    v_mfma_f32_16x16x32_bf16 v[32:35], a[16:19], v[80:83], v[32:35]
    ds_read_b64_tr_b16 v[108:109], v131 offset:40960
    v_mfma_f32_16x16x32_bf16 v[36:39], a[80:83], v[80:83], v[36:39]
    ds_read_b64_tr_b16 v[110:111], v131 offset:41984
    s_add_u32 s26, s24, 0x80000
    s_add_u32 m0, s29, 0x4000
    s_nop 0
    buffer_load_dwordx4 v136, s[16:19], s26 offen lds
    s_waitcnt lgkmcnt(12)
    v_mfma_f32_16x16x32_bf16 v[40:43], a[16:19], v[84:87], v[40:43]
    ds_read_b64_tr_b16 v[112:113], v132 offset:40960
    v_mfma_f32_16x16x32_bf16 v[44:47], a[80:83], v[84:87], v[44:47]
    ds_read_b64_tr_b16 v[114:115], v132 offset:41984
    s_add_u32 s26, s24, 0xa0000
    s_add_u32 m0, s29, 0x5000
    s_nop 0
    buffer_load_dwordx4 v136, s[16:19], s26 offen lds
    s_waitcnt lgkmcnt(12)
    v_mfma_f32_16x16x32_bf16 v[48:51], a[16:19], v[88:91], v[48:51]
    ds_read_b64_tr_b16 v[116:117], v133 offset:40960
    v_mfma_f32_16x16x32_bf16 v[52:55], a[80:83], v[88:91], v[52:55]
    ds_read_b64_tr_b16 v[118:119], v133 offset:41984
    s_add_u32 s26, s24, 0xc0000
    s_add_u32 m0, s29, 0x6000
    s_nop 0
    buffer_load_dwordx4 v136, s[16:19], s26 offen lds
    s_waitcnt lgkmcnt(12)
    v_mfma_f32_16x16x32_bf16 v[56:59], a[16:19], v[92:95], v[56:59]
    ds_read_b64_tr_b16 v[120:121], v134 offset:40960
    v_mfma_f32_16x16x32_bf16 v[60:63], a[80:83], v[92:95], v[60:63]
    ds_read_b64_tr_b16 v[122:123], v134 offset:41984
    s_add_u32 s26, s24, 0xe0000
    s_add_u32 m0, s29, 0x7000
    s_nop 0
    buffer_load_dwordx4 v136, s[16:19], s26 offen lds
    s_waitcnt lgkmcnt(12)
    v_mfma_f32_16x16x32_bf16 v[0:3], a[20:23], v[96:99], v[0:3]
    ds_read_b64_tr_b16 v[124:125], v135 offset:40960
    v_mfma_f32_16x16x32_bf16 v[4:7], a[84:87], v[96:99], v[4:7]
    ds_read_b64_tr_b16 v[126:127], v135 offset:41984
    s_waitcnt lgkmcnt(12)
    v_mfma_f32_16x16x32_bf16 v[8:11], a[20:23], v[100:103], v[8:11]
    ds_read_b64_tr_b16 v[64:65], v128 offset:49152
    v_mfma_f32_16x16x32_bf16 v[12:15], a[84:87], v[100:103], v[12:15]
    ds_read_b64_tr_b16 v[66:67], v128 offset:50176
    s_waitcnt lgkmcnt(12)
    v_mfma_f32_16x16x32_bf16 v[16:19], a[20:23], v[104:107], v[16:19]
    ds_read_b64_tr_b16 v[68:69], v129 offset:49152
    v_mfma_f32_16x16x32_bf16 v[20:23], a[84:87], v[104:107], v[20:23]
    ds_read_b64_tr_b16 v[70:71], v129 offset:50176
    s_waitcnt lgkmcnt(12)
    v_mfma_f32_16x16x32_bf16 v[24:27], a[20:23], v[108:111], v[24:27]
    ds_read_b64_tr_b16 v[72:73], v130 offset:49152
    v_mfma_f32_16x16x32_bf16 v[28:31], a[84:87], v[108:111], v[28:31]
    ds_read_b64_tr_b16 v[74:75], v130 offset:50176
    s_waitcnt lgkmcnt(12)
    v_mfma_f32_16x16x32_bf16 v[32:35], a[20:23], v[112:115], v[32:35]
    ds_read_b64_tr_b16 v[76:77], v131 offset:49152
    v_mfma_f32_16x16x32_bf16 v[36:39], a[84:87], v[112:115], v[36:39]
    ds_read_b64_tr_b16 v[78:79], v131 offset:50176
    s_waitcnt lgkmcnt(12)
    v_mfma_f32_16x16x32_bf16 v[40:43], a[20:23], v[116:119], v[40:43]
    ds_read_b64_tr_b16 v[80:81], v132 offset:49152
    v_mfma_f32_16x16x32_bf16 v[44:47], a[84:87], v[116:119], v[44:47]
    ds_read_b64_tr_b16 v[82:83], v132 offset:50176
    s_waitcnt lgkmcnt(12)
    v_mfma_f32_16x16x32_bf16 v[48:51], a[20:23], v[120:123], v[48:51]
    ds_read_b64_tr_b16 v[84:85], v133 offset:49152
    v_mfma_f32_16x16x32_bf16 v[52:55], a[84:87], v[120:123], v[52:55]
    ds_read_b64_tr_b16 v[86:87], v133 offset:50176
    s_waitcnt lgkmcnt(12)
    v_mfma_f32_16x16x32_bf16 v[56:59], a[20:23], v[124:127], v[56:59]
    ds_read_b64_tr_b16 v[88:89], v134 offset:49152
    v_mfma_f32_16x16x32_bf16 v[60:63], a[84:87], v[124:127], v[60:63]
    ds_read_b64_tr_b16 v[90:91], v134 offset:50176
    s_waitcnt lgkmcnt(12)
    v_mfma_f32_16x16x32_bf16 v[0:3], a[24:27], v[64:67], v[0:3]
    ds_read_b64_tr_b16 v[92:93], v135 offset:49152
    v_mfma_f32_16x16x32_bf16 v[4:7], a[88:91], v[64:67], v[4:7]
    ds_read_b64_tr_b16 v[94:95], v135 offset:50176
    s_waitcnt lgkmcnt(12)
    v_mfma_f32_16x16x32_bf16 v[8:11], a[24:27], v[68:71], v[8:11]
    ds_read_b64_tr_b16 v[96:97], v128 offset:57344
    v_mfma_f32_16x16x32_bf16 v[12:15], a[88:91], v[68:71], v[12:15]
    ds_read_b64_tr_b16 v[98:99], v128 offset:58368
    s_waitcnt lgkmcnt(12)
    v_mfma_f32_16x16x32_bf16 v[16:19], a[24:27], v[72:75], v[16:19]
    ds_read_b64_tr_b16 v[100:101], v129 offset:57344
    v_mfma_f32_16x16x32_bf16 v[20:23], a[88:91], v[72:75], v[20:23]
    ds_read_b64_tr_b16 v[102:103], v129 offset:58368
    s_waitcnt lgkmcnt(12)
    v_mfma_f32_16x16x32_bf16 v[24:27], a[24:27], v[76:79], v[24:27]
    ds_read_b64_tr_b16 v[104:105], v130 offset:57344
    v_mfma_f32_16x16x32_bf16 v[28:31], a[88:91], v[76:79], v[28:31]
    ds_read_b64_tr_b16 v[106:107], v130 offset:58368
    s_waitcnt lgkmcnt(12)
    v_mfma_f32_16x16x32_bf16 v[32:35], a[24:27], v[80:83], v[32:35]
    ds_read_b64_tr_b16 v[108:109], v131 offset:57344
    v_mfma_f32_16x16x32_bf16 v[36:39], a[88:91], v[80:83], v[36:39]
    ds_read_b64_tr_b16 v[110:111], v131 offset:58368
    s_waitcnt lgkmcnt(12)
    v_mfma_f32_16x16x32_bf16 v[40:43], a[24:27], v[84:87], v[40:43]
    ds_read_b64_tr_b16 v[112:113], v132 offset:57344
    v_mfma_f32_16x16x32_bf16 v[44:47], a[88:91], v[84:87], v[44:47]
    ds_read_b64_tr_b16 v[114:115], v132 offset:58368
    s_waitcnt lgkmcnt(12)
    v_mfma_f32_16x16x32_bf16 v[48:51], a[24:27], v[88:91], v[48:51]
    ds_read_b64_tr_b16 v[116:117], v133 offset:57344
    v_mfma_f32_16x16x32_bf16 v[52:55], a[88:91], v[88:91], v[52:55]
    ds_read_b64_tr_b16 v[118:119], v133 offset:58368
    s_waitcnt lgkmcnt(12)
    v_mfma_f32_16x16x32_bf16 v[56:59], a[24:27], v[92:95], v[56:59]
    ds_read_b64_tr_b16 v[120:121], v134 offset:57344
    v_mfma_f32_16x16x32_bf16 v[60:63], a[88:91], v[92:95], v[60:63]
    ds_read_b64_tr_b16 v[122:123], v134 offset:58368
    s_waitcnt lgkmcnt(12)
    v_mfma_f32_16x16x32_bf16 v[0:3], a[28:31], v[96:99], v[0:3]
    ds_read_b64_tr_b16 v[124:125], v135 offset:57344
    v_mfma_f32_16x16x32_bf16 v[4:7], a[92:95], v[96:99], v[4:7]
    ds_read_b64_tr_b16 v[126:127], v135 offset:58368
    s_waitcnt lgkmcnt(12)
    v_mfma_f32_16x16x32_bf16 v[8:11], a[28:31], v[100:103], v[8:11]
    v_mfma_f32_16x16x32_bf16 v[12:15], a[92:95], v[100:103], v[12:15]
    s_waitcnt lgkmcnt(10)
    v_mfma_f32_16x16x32_bf16 v[16:19], a[28:31], v[104:107], v[16:19]
    v_mfma_f32_16x16x32_bf16 v[20:23], a[92:95], v[104:107], v[20:23]
    s_waitcnt lgkmcnt(8)
    v_mfma_f32_16x16x32_bf16 v[24:27], a[28:31], v[108:111], v[24:27]
    v_mfma_f32_16x16x32_bf16 v[28:31], a[92:95], v[108:111], v[28:31]
    s_waitcnt lgkmcnt(6)
    v_mfma_f32_16x16x32_bf16 v[32:35], a[28:31], v[112:115], v[32:35]
    v_mfma_f32_16x16x32_bf16 v[36:39], a[92:95], v[112:115], v[36:39]
    s_waitcnt lgkmcnt(4)
    v_mfma_f32_16x16x32_bf16 v[40:43], a[28:31], v[116:119], v[40:43]
    v_mfma_f32_16x16x32_bf16 v[44:47], a[92:95], v[116:119], v[44:47]
    s_waitcnt lgkmcnt(2)
    v_mfma_f32_16x16x32_bf16 v[48:51], a[28:31], v[120:123], v[48:51]
    v_mfma_f32_16x16x32_bf16 v[52:55], a[92:95], v[120:123], v[52:55]
    s_waitcnt lgkmcnt(0)
    v_mfma_f32_16x16x32_bf16 v[56:59], a[28:31], v[124:127], v[56:59]
    v_mfma_f32_16x16x32_bf16 v[60:63], a[92:95], v[124:127], v[60:63]
    v_xor_b32 v128, 0x10000, v128
    v_xor_b32 v129, 0x10000, v129
    v_xor_b32 v130, 0x10000, v130
    v_xor_b32 v131, 0x10000, v131
    v_xor_b32 v132, 0x10000, v132
    v_xor_b32 v133, 0x10000, v133
    v_xor_b32 v134, 0x10000, v134
    v_xor_b32 v135, 0x10000, v135
    s_waitcnt vmcnt(16)
    s_barrier
    ds_read_b64_tr_b16 v[64:65], v128
    ds_read_b64_tr_b16 v[66:67], v128 offset:1024
    ds_read_b64_tr_b16 v[68:69], v129
    ds_read_b64_tr_b16 v[70:71], v129 offset:1024
    ds_read_b64_tr_b16 v[72:73], v130
    ds_read_b64_tr_b16 v[74:75], v130 offset:1024
    ds_read_b64_tr_b16 v[76:77], v131
    ds_read_b64_tr_b16 v[78:79], v131 offset:1024
    ds_read_b64_tr_b16 v[80:81], v132
    ds_read_b64_tr_b16 v[82:83], v132 offset:1024
    ds_read_b64_tr_b16 v[84:85], v133
    ds_read_b64_tr_b16 v[86:87], v133 offset:1024
    ds_read_b64_tr_b16 v[88:89], v134
    ds_read_b64_tr_b16 v[90:91], v134 offset:1024
    s_cmp_eq_u32 s40, 0
    s_cbranch_scc1 L_nopf_92
    s_cmp_lg_u32 s87, 0
    s_cbranch_scc1 L_modeok_93
    s_mov_b32 s96, 0
L_mode_94:
    buffer_load_dwordx2 v[140:141], off, s[92:95], 0 offset:36 sc1
    s_waitcnt vmcnt(0)
    v_readfirstlane_b32 s87, v140
    v_readfirstlane_b32 s97, v141
    s_nop 0
    s_min_u32 s97, s97, s87
    s_cmp_lg_u32 s97, 0
    s_cbranch_scc1 L_moded_95
    s_sleep 4
    s_add_u32 s96, s96, 1
    s_cmp_lg_u32 s96, 0x100
    s_cbranch_scc1 L_modef_96
    v_mov_b32 v140, 2
    v_mov_b32 v141, 0
    s_mov_b64 exec, 1
    buffer_atomic_cmpswap v[140:141], off, s[92:95], 0 offset:36
    s_mov_b64 exec, -1
L_modef_96:
    s_cmp_lt_u32 s96, 0x10000
    s_cbranch_scc1 L_mode_94
L_moded_95:
    s_cmp_lg_u32 s87, 1
    s_cbranch_scc1 L_fallback
L_modeok_93:
    s_cmp_lg_u32 s100, 0
    s_cbranch_scc1 L_flag_97
    v_mov_b32 v138, 1
    s_mov_b64 exec, 1
    buffer_store_dword v138, off, s[8:11], s40 sc1
    s_mov_b64 exec, -1
L_flag_97:
    s_mov_b32 s40, 0
L_nopf_92:
    s_waitcnt lgkmcnt(12)
    v_mfma_f32_16x16x32_bf16 v[0:3], a[32:35], v[64:67], v[0:3]
    ds_read_b64_tr_b16 v[92:93], v135
    v_mfma_f32_16x16x32_bf16 v[4:7], a[96:99], v[64:67], v[4:7]
    ds_read_b64_tr_b16 v[94:95], v135 offset:1024
    s_add_u32 s26, s24, 0x100000
    s_add_u32 m0, s29, 0x8000
    s_nop 0
    buffer_load_dwordx4 v136, s[16:19], s26 offen lds
    s_waitcnt lgkmcnt(12)
    v_mfma_f32_16x16x32_bf16 v[8:11], a[32:35], v[68:71], v[8:11]
    ds_read_b64_tr_b16 v[96:97], v128 offset:8192
    v_mfma_f32_16x16x32_bf16 v[12:15], a[96:99], v[68:71], v[12:15]
    ds_read_b64_tr_b16 v[98:99], v128 offset:9216
    s_add_u32 s26, s24, 0x120000
    s_add_u32 m0, s29, 0x9000
    s_nop 0
    buffer_load_dwordx4 v136, s[16:19], s26 offen lds
    s_waitcnt lgkmcnt(12)
    v_mfma_f32_16x16x32_bf16 v[16:19], a[32:35], v[72:75], v[16:19]
    ds_read_b64_tr_b16 v[100:101], v129 offset:8192
    v_mfma_f32_16x16x32_bf16 v[20:23], a[96:99], v[72:75], v[20:23]
    ds_read_b64_tr_b16 v[102:103], v129 offset:9216
    s_add_u32 s26, s24, 0x140000
    s_add_u32 m0, s29, 0xa000
    s_nop 0
    buffer_load_dwordx4 v136, s[16:19], s26 offen lds
    s_waitcnt lgkmcnt(12)
    v_mfma_f32_16x16x32_bf16 v[24:27], a[32:35], v[76:79], v[24:27]
    ds_read_b64_tr_b16 v[104:105], v130 offset:8192
    v_mfma_f32_16x16x32_bf16 v[28:31], a[96:99], v[76:79], v[28:31]
    ds_read_b64_tr_b16 v[106:107], v130 offset:9216
    s_add_u32 s26, s24, 0x160000
    s_add_u32 m0, s29, 0xb000
    s_nop 0
    buffer_load_dwordx4 v136, s[16:19], s26 offen lds
    s_waitcnt lgkmcnt(12)
    v_mfma_f32_16x16x32_bf16 v[32:35], a[32:35], v[80:83], v[32:35]
    ds_read_b64_tr_b16 v[108:109], v131 offset:8192
    v_mfma_f32_16x16x32_bf16 v[36:39], a[96:99], v[80:83], v[36:39]
    ds_read_b64_tr_b16 v[110:111], v131 offset:9216
    s_add_u32 s26, s24, 0x180000
    s_add_u32 m0, s29, 0xc000
    s_nop 0
    buffer_load_dwordx4 v136, s[16:19], s26 offen lds
    s_waitcnt lgkmcnt(12)
    v_mfma_f32_16x16x32_bf16 v[40:43], a[32:35], v[84:87], v[40:43]
    ds_read_b64_tr_b16 v[112:113], v132 offset:8192
    v_mfma_f32_16x16x32_bf16 v[44:47], a[96:99], v[84:87], v[44:47]
    ds_read_b64_tr_b16 v[114:115], v132 offset:9216
    s_add_u32 s26, s24, 0x1a0000
    s_add_u32 m0, s29, 0xd000
    s_nop 0
    buffer_load_dwordx4 v136, s[16:19], s26 offen lds
    s_waitcnt lgkmcnt(12)
    v_mfma_f32_16x16x32_bf16 v[48:51], a[32:35], v[88:91], v[48:51]
    ds_read_b64_tr_b16 v[116:117], v133 offset:8192
    v_mfma_f32_16x16x32_bf16 v[52:55], a[96:99], v[88:91], v[52:55]
    ds_read_b64_tr_b16 v[118:119], v133 offset:9216
    s_add_u32 s26, s24, 0x1c0000
    s_add_u32 m0, s29, 0xe000
    s_nop 0
    buffer_load_dwordx4 v136, s[16:19], s26 offen lds
    s_waitcnt lgkmcnt(12)
    v_mfma_f32_16x16x32_bf16 v[56:59], a[32:35], v[92:95], v[56:59]
    ds_read_b64_tr_b16 v[120:121], v134 offset:8192
    v_mfma_f32_16x16x32_bf16 v[60:63], a[96:99], v[92:95], v[60:63]
    ds_read_b64_tr_b16 v[122:123], v134 offset:9216
    s_add_u32 s26, s24, 0x1e0000
    s_add_u32 m0, s29, 0xf000
    s_nop 0
    buffer_load_dwordx4 v136, s[16:19], s26 offen lds
    s_waitcnt lgkmcnt(12)
    v_mfma_f32_16x16x32_bf16 v[0:3], a[36:39], v[96:99], v[0:3]
    ds_read_b64_tr_b16 v[124:125], v135 offset:8192
    v_mfma_f32_16x16x32_bf16 v[4:7], a[100:103], v[96:99], v[4:7]
    ds_read_b64_tr_b16 v[126:127], v135 offset:9216
    s_waitcnt lgkmcnt(12)
    v_mfma_f32_16x16x32_bf16 v[8:11], a[36:39], v[100:103], v[8:11]
    ds_read_b64_tr_b16 v[64:65], v128 offset:16384
    v_mfma_f32_16x16x32_bf16 v[12:15], a[100:103], v[100:103], v[12:15]
    ds_read_b64_tr_b16 v[66:67], v128 offset:17408
    s_waitcnt lgkmcnt(12)
    v_mfma_f32_16x16x32_bf16 v[16:19], a[36:39], v[104:107], v[16:19]
    ds_read_b64_tr_b16 v[68:69], v129 offset:16384
    v_mfma_f32_16x16x32_bf16 v[20:23], a[100:103], v[104:107], v[20:23]
    ds_read_b64_tr_b16 v[70:71], v129 offset:17408
    s_waitcnt lgkmcnt(12)
    v_mfma_f32_16x16x32_bf16 v[24:27], a[36:39], v[108:111], v[24:27]
    ds_read_b64_tr_b16 v[72:73], v130 offset:16384
    v_mfma_f32_16x16x32_bf16 v[28:31], a[100:103], v[108:111], v[28:31]
    ds_read_b64_tr_b16 v[74:75], v130 offset:17408
    s_waitcnt lgkmcnt(12)
    v_mfma_f32_16x16x32_bf16 v[32:35], a[36:39], v[112:115], v[32:35]
    ds_read_b64_tr_b16 v[76:77], v131 offset:16384
    v_mfma_f32_16x16x32_bf16 v[36:39], a[100:103], v[112:115], v[36:39]
    ds_read_b64_tr_b16 v[78:79], v131 offset:17408
    s_waitcnt lgkmcnt(12)
    v_mfma_f32_16x16x32_bf16 v[40:43], a[36:39], v[116:119], v[40:43]
    ds_read_b64_tr_b16 v[80:81], v132 offset:16384
    v_mfma_f32_16x16x32_bf16 v[44:47], a[100:103], v[116:119], v[44:47]
    ds_read_b64_tr_b16 v[82:83], v132 offset:17408
    s_waitcnt lgkmcnt(12)
    v_mfma_f32_16x16x32_bf16 v[48:51], a[36:39], v[120:123], v[48:51]
    ds_read_b64_tr_b16 v[84:85], v133 offset:16384
    v_mfma_f32_16x16x32_bf16 v[52:55], a[100:103], v[120:123], v[52:55]
    ds_read_b64_tr_b16 v[86:87], v133 offset:17408
    s_waitcnt lgkmcnt(12)
    v_mfma_f32_16x16x32_bf16 v[56:59], a[36:39], v[124:127], v[56:59]
    ds_read_b64_tr_b16 v[88:89], v134 offset:16384
    v_mfma_f32_16x16x32_bf16 v[60:63], a[100:103], v[124:127], v[60:63]
    ds_read_b64_tr_b16 v[90:91], v134 offset:17408
    s_waitcnt lgkmcnt(12)
    v_mfma_f32_16x16x32_bf16 v[0:3], a[40:43], v[64:67], v[0:3]
    ds_read_b64_tr_b16 v[92:93], v135 offset:16384
    v_mfma_f32_16x16x32_bf16 v[4:7], a[104:107], v[64:67], v[4:7]
    ds_read_b64_tr_b16 v[94:95], v135 offset:17408
    s_waitcnt lgkmcnt(12)
    v_mfma_f32_16x16x32_bf16 v[8:11], a[40:43], v[68:71], v[8:11]
    ds_read_b64_tr_b16 v[96:97], v128 offset:24576
    v_mfma_f32_16x16x32_bf16 v[12:15], a[104:107], v[68:71], v[12:15]
    ds_read_b64_tr_b16 v[98:99], v128 offset:25600
    s_waitcnt lgkmcnt(12)
    v_mfma_f32_16x16x32_bf16 v[16:19], a[40:43], v[72:75], v[16:19]
    ds_read_b64_tr_b16 v[100:101], v129 offset:24576
    v_mfma_f32_16x16x32_bf16 v[20:23], a[104:107], v[72:75], v[20:23]
    ds_read_b64_tr_b16 v[102:103], v129 offset:25600
    s_waitcnt lgkmcnt(12)
    v_mfma_f32_16x16x32_bf16 v[24:27], a[40:43], v[76:79], v[24:27]
    ds_read_b64_tr_b16 v[104:105], v130 offset:24576
    v_mfma_f32_16x16x32_bf16 v[28:31], a[104:107], v[76:79], v[28:31]
    ds_read_b64_tr_b16 v[106:107], v130 offset:25600
    s_waitcnt lgkmcnt(12)
    v_mfma_f32_16x16x32_bf16 v[32:35], a[40:43], v[80:83], v[32:35]
    ds_read_b64_tr_b16 v[108:109], v131 offset:24576
    v_mfma_f32_16x16x32_bf16 v[36:39], a[104:107], v[80:83], v[36:39]
    ds_read_b64_tr_b16 v[110:111], v131 offset:25600
    s_waitcnt lgkmcnt(12)
    v_mfma_f32_16x16x32_bf16 v[40:43], a[40:43], v[84:87], v[40:43]
    ds_read_b64_tr_b16 v[112:113], v132 offset:24576
    v_mfma_f32_16x16x32_bf16 v[44:47], a[104:107], v[84:87], v[44:47]
    ds_read_b64_tr_b16 v[114:115], v132 offset:25600
    s_waitcnt lgkmcnt(12)
    v_mfma_f32_16x16x32_bf16 v[48:51], a[40:43], v[88:91], v[48:51]
    ds_read_b64_tr_b16 v[116:117], v133 offset:24576
    v_mfma_f32_16x16x32_bf16 v[52:55], a[104:107], v[88:91], v[52:55]
    ds_read_b64_tr_b16 v[118:119], v133 offset:25600
    s_waitcnt lgkmcnt(12)
    v_mfma_f32_16x16x32_bf16 v[56:59], a[40:43], v[92:95], v[56:59]
    ds_read_b64_tr_b16 v[120:121], v134 offset:24576
    v_mfma_f32_16x16x32_bf16 v[60:63], a[104:107], v[92:95], v[60:63]
    ds_read_b64_tr_b16 v[122:123], v134 offset:25600
    s_waitcnt lgkmcnt(12)
    v_mfma_f32_16x16x32_bf16 v[0:3], a[44:47], v[96:99], v[0:3]
    ds_read_b64_tr_b16 v[124:125], v135 offset:24576
    v_mfma_f32_16x16x32_bf16 v[4:7], a[108:111], v[96:99], v[4:7]
    ds_read_b64_tr_b16 v[126:127], v135 offset:25600
    s_waitcnt lgkmcnt(12)
    v_mfma_f32_16x16x32_bf16 v[8:11], a[44:47], v[100:103], v[8:11]
    v_mfma_f32_16x16x32_bf16 v[12:15], a[108:111], v[100:103], v[12:15]
    s_waitcnt lgkmcnt(10)
    v_mfma_f32_16x16x32_bf16 v[16:19], a[44:47], v[104:107], v[16:19]
    v_mfma_f32_16x16x32_bf16 v[20:23], a[108:111], v[104:107], v[20:23]
    s_waitcnt lgkmcnt(8)
    v_mfma_f32_16x16x32_bf16 v[24:27], a[44:47], v[108:111], v[24:27]
    v_mfma_f32_16x16x32_bf16 v[28:31], a[108:111], v[108:111], v[28:31]
    s_waitcnt lgkmcnt(6)
    v_mfma_f32_16x16x32_bf16 v[32:35], a[44:47], v[112:115], v[32:35]
    v_mfma_f32_16x16x32_bf16 v[36:39], a[108:111], v[112:115], v[36:39]
    s_waitcnt lgkmcnt(4)
    v_mfma_f32_16x16x32_bf16 v[40:43], a[44:47], v[116:119], v[40:43]
    v_mfma_f32_16x16x32_bf16 v[44:47], a[108:111], v[116:119], v[44:47]
    s_waitcnt lgkmcnt(2)
    v_mfma_f32_16x16x32_bf16 v[48:51], a[44:47], v[120:123], v[48:51]
    v_mfma_f32_16x16x32_bf16 v[52:55], a[108:111], v[120:123], v[52:55]
    s_waitcnt lgkmcnt(0)
    v_mfma_f32_16x16x32_bf16 v[56:59], a[44:47], v[124:127], v[56:59]
    v_mfma_f32_16x16x32_bf16 v[60:63], a[108:111], v[124:127], v[60:63]
    s_waitcnt vmcnt(16)
    s_barrier
    ds_read_b64_tr_b16 v[64:65], v128 offset:32768
    ds_read_b64_tr_b16 v[66:67], v128 offset:33792
    ds_read_b64_tr_b16 v[68:69], v129 offset:32768
    ds_read_b64_tr_b16 v[70:71], v129 offset:33792
    ds_read_b64_tr_b16 v[72:73], v130 offset:32768
    ds_read_b64_tr_b16 v[74:75], v130 offset:33792
    ds_read_b64_tr_b16 v[76:77], v131 offset:32768
    ds_read_b64_tr_b16 v[78:79], v131 offset:33792
    ds_read_b64_tr_b16 v[80:81], v132 offset:32768
    ds_read_b64_tr_b16 v[82:83], v132 offset:33792
    ds_read_b64_tr_b16 v[84:85], v133 offset:32768
    ds_read_b64_tr_b16 v[86:87], v133 offset:33792
    ds_read_b64_tr_b16 v[88:89], v134 offset:32768
    ds_read_b64_tr_b16 v[90:91], v134 offset:33792
    s_waitcnt lgkmcnt(12)
    v_mfma_f32_16x16x32_bf16 v[0:3], a[48:51], v[64:67], v[0:3]
    ds_read_b64_tr_b16 v[92:93], v135 offset:32768
    v_mfma_f32_16x16x32_bf16 v[4:7], a[112:115], v[64:67], v[4:7]
    ds_read_b64_tr_b16 v[94:95], v135 offset:33792
    s_add_u32 s26, s24, 0x200000
    s_add_u32 m0, s29, 0x10000
    s_nop 0
    buffer_load_dwordx4 v136, s[16:19], s26 offen lds
    s_waitcnt lgkmcnt(12)
    v_mfma_f32_16x16x32_bf16 v[8:11], a[48:51], v[68:71], v[8:11]
    ds_read_b64_tr_b16 v[96:97], v128 offset:40960
    v_mfma_f32_16x16x32_bf16 v[12:15], a[112:115], v[68:71], v[12:15]
    ds_read_b64_tr_b16 v[98:99], v128 offset:41984
    s_add_u32 s26, s24, 0x220000
    s_add_u32 m0, s29, 0x11000
    s_nop 0
    buffer_load_dwordx4 v136, s[16:19], s26 offen lds
    s_waitcnt lgkmcnt(12)
    v_mfma_f32_16x16x32_bf16 v[16:19], a[48:51], v[72:75], v[16:19]
    ds_read_b64_tr_b16 v[100:101], v129 offset:40960
    v_mfma_f32_16x16x32_bf16 v[20:23], a[112:115], v[72:75], v[20:23]
    ds_read_b64_tr_b16 v[102:103], v129 offset:41984
    s_add_u32 s26, s24, 0x240000
    s_add_u32 m0, s29, 0x12000
    s_nop 0
    buffer_load_dwordx4 v136, s[16:19], s26 offen lds
    s_waitcnt lgkmcnt(12)
    v_mfma_f32_16x16x32_bf16 v[24:27], a[48:51], v[76:79], v[24:27]
    ds_read_b64_tr_b16 v[104:105], v130 offset:40960
    v_mfma_f32_16x16x32_bf16 v[28:31], a[112:115], v[76:79], v[28:31]
    ds_read_b64_tr_b16 v[106:107], v130 offset:41984
    s_add_u32 s26, s24, 0x260000
    s_add_u32 m0, s29, 0x13000
    s_nop 0
    buffer_load_dwordx4 v136, s[16:19], s26 offen lds
    s_waitcnt lgkmcnt(12)
    v_mfma_f32_16x16x32_bf16 v[32:35], a[48:51], v[80:83], v[32:35]
    ds_read_b64_tr_b16 v[108:109], v131 offset:40960
    v_mfma_f32_16x16x32_bf16 v[36:39], a[112:115], v[80:83], v[36:39]
    ds_read_b64_tr_b16 v[110:111], v131 offset:41984
    s_add_u32 s26, s24, 0x280000
    s_add_u32 m0, s29, 0x14000
    s_nop 0
    buffer_load_dwordx4 v136, s[16:19], s26 offen lds
    s_waitcnt lgkmcnt(12)
    v_mfma_f32_16x16x32_bf16 v[40:43], a[48:51], v[84:87], v[40:43]
    ds_read_b64_tr_b16 v[112:113], v132 offset:40960
    v_mfma_f32_16x16x32_bf16 v[44:47], a[112:115], v[84:87], v[44:47]
    ds_read_b64_tr_b16 v[114:115], v132 offset:41984
    s_add_u32 s26, s24, 0x2a0000
    s_add_u32 m0, s29, 0x15000
    s_nop 0
    buffer_load_dwordx4 v136, s[16:19], s26 offen lds
    s_waitcnt lgkmcnt(12)
    v_mfma_f32_16x16x32_bf16 v[48:51], a[48:51], v[88:91], v[48:51]
    ds_read_b64_tr_b16 v[116:117], v133 offset:40960
    v_mfma_f32_16x16x32_bf16 v[52:55], a[112:115], v[88:91], v[52:55]
    ds_read_b64_tr_b16 v[118:119], v133 offset:41984
    s_add_u32 s26, s24, 0x2c0000
    s_add_u32 m0, s29, 0x16000
    s_nop 0
    buffer_load_dwordx4 v136, s[16:19], s26 offen lds
    s_waitcnt lgkmcnt(12)
    v_mfma_f32_16x16x32_bf16 v[56:59], a[48:51], v[92:95], v[56:59]
    ds_read_b64_tr_b16 v[120:121], v134 offset:40960
    v_mfma_f32_16x16x32_bf16 v[60:63], a[112:115], v[92:95], v[60:63]
    ds_read_b64_tr_b16 v[122:123], v134 offset:41984
    s_add_u32 s26, s24, 0x2e0000
    s_add_u32 m0, s29, 0x17000
    s_nop 0
    buffer_load_dwordx4 v136, s[16:19], s26 offen lds
    s_waitcnt lgkmcnt(12)
    v_mfma_f32_16x16x32_bf16 v[0:3], a[52:55], v[96:99], v[0:3]
    ds_read_b64_tr_b16 v[124:125], v135 offset:40960
    v_mfma_f32_16x16x32_bf16 v[4:7], a[116:119], v[96:99], v[4:7]
    ds_read_b64_tr_b16 v[126:127], v135 offset:41984
    s_waitcnt lgkmcnt(12)
    v_mfma_f32_16x16x32_bf16 v[8:11], a[52:55], v[100:103], v[8:11]
    ds_read_b64_tr_b16 v[64:65], v128 offset:49152
    v_mfma_f32_16x16x32_bf16 v[12:15], a[116:119], v[100:103], v[12:15]
    ds_read_b64_tr_b16 v[66:67], v128 offset:50176
    s_waitcnt lgkmcnt(12)
    v_mfma_f32_16x16x32_bf16 v[16:19], a[52:55], v[104:107], v[16:19]
    ds_read_b64_tr_b16 v[68:69], v129 offset:49152
    v_mfma_f32_16x16x32_bf16 v[20:23], a[116:119], v[104:107], v[20:23]
    ds_read_b64_tr_b16 v[70:71], v129 offset:50176
    s_waitcnt lgkmcnt(12)
    v_mfma_f32_16x16x32_bf16 v[24:27], a[52:55], v[108:111], v[24:27]
    ds_read_b64_tr_b16 v[72:73], v130 offset:49152
    v_mfma_f32_16x16x32_bf16 v[28:31], a[116:119], v[108:111], v[28:31]
    ds_read_b64_tr_b16 v[74:75], v130 offset:50176
    s_waitcnt lgkmcnt(12)
    v_mfma_f32_16x16x32_bf16 v[32:35], a[52:55], v[112:115], v[32:35]
    ds_read_b64_tr_b16 v[76:77], v131 offset:49152
    v_mfma_f32_16x16x32_bf16 v[36:39], a[116:119], v[112:115], v[36:39]
    ds_read_b64_tr_b16 v[78:79], v131 offset:50176
    s_waitcnt lgkmcnt(12)
    v_mfma_f32_16x16x32_bf16 v[40:43], a[52:55], v[116:119], v[40:43]
    ds_read_b64_tr_b16 v[80:81], v132 offset:49152
    v_mfma_f32_16x16x32_bf16 v[44:47], a[116:119], v[116:119], v[44:47]
    ds_read_b64_tr_b16 v[82:83], v132 offset:50176
    s_waitcnt lgkmcnt(12)
    v_mfma_f32_16x16x32_bf16 v[48:51], a[52:55], v[120:123], v[48:51]
    ds_read_b64_tr_b16 v[84:85], v133 offset:49152
    v_mfma_f32_16x16x32_bf16 v[52:55], a[116:119], v[120:123], v[52:55]
    ds_read_b64_tr_b16 v[86:87], v133 offset:50176
    s_waitcnt lgkmcnt(12)
    v_mfma_f32_16x16x32_bf16 v[56:59], a[52:55], v[124:127], v[56:59]
    ds_read_b64_tr_b16 v[88:89], v134 offset:49152
    v_mfma_f32_16x16x32_bf16 v[60:63], a[116:119], v[124:127], v[60:63]
    ds_read_b64_tr_b16 v[90:91], v134 offset:50176
    s_waitcnt lgkmcnt(12)
    v_mfma_f32_16x16x32_bf16 v[0:3], a[56:59], v[64:67], v[0:3]
    ds_read_b64_tr_b16 v[92:93], v135 offset:49152
    v_mfma_f32_16x16x32_bf16 v[4:7], a[120:123], v[64:67], v[4:7]
    ds_read_b64_tr_b16 v[94:95], v135 offset:50176
    s_waitcnt lgkmcnt(12)
    v_mfma_f32_16x16x32_bf16 v[8:11], a[56:59], v[68:71], v[8:11]
    ds_read_b64_tr_b16 v[96:97], v128 offset:57344
    v_mfma_f32_16x16x32_bf16 v[12:15], a[120:123], v[68:71], v[12:15]
    ds_read_b64_tr_b16 v[98:99], v128 offset:58368
    s_waitcnt lgkmcnt(12)
    v_mfma_f32_16x16x32_bf16 v[16:19], a[56:59], v[72:75], v[16:19]
    ds_read_b64_tr_b16 v[100:101], v129 offset:57344
    v_mfma_f32_16x16x32_bf16 v[20:23], a[120:123], v[72:75], v[20:23]
    ds_read_b64_tr_b16 v[102:103], v129 offset:58368
    s_waitcnt lgkmcnt(12)
    v_mfma_f32_16x16x32_bf16 v[24:27], a[56:59], v[76:79], v[24:27]
    ds_read_b64_tr_b16 v[104:105], v130 offset:57344
    v_mfma_f32_16x16x32_bf16 v[28:31], a[120:123], v[76:79], v[28:31]
    ds_read_b64_tr_b16 v[106:107], v130 offset:58368
    s_waitcnt lgkmcnt(12)
    v_mfma_f32_16x16x32_bf16 v[32:35], a[56:59], v[80:83], v[32:35]
    ds_read_b64_tr_b16 v[108:109], v131 offset:57344
    v_mfma_f32_16x16x32_bf16 v[36:39], a[120:123], v[80:83], v[36:39]
    ds_read_b64_tr_b16 v[110:111], v131 offset:58368
    s_waitcnt lgkmcnt(12)
    v_mfma_f32_16x16x32_bf16 v[40:43], a[56:59], v[84:87], v[40:43]
    ds_read_b64_tr_b16 v[112:113], v132 offset:57344
    v_mfma_f32_16x16x32_bf16 v[44:47], a[120:123], v[84:87], v[44:47]
    ds_read_b64_tr_b16 v[114:115], v132 offset:58368
    s_waitcnt lgkmcnt(12)
    v_mfma_f32_16x16x32_bf16 v[48:51], a[56:59], v[88:91], v[48:51]
    ds_read_b64_tr_b16 v[116:117], v133 offset:57344
    v_mfma_f32_16x16x32_bf16 v[52:55], a[120:123], v[88:91], v[52:55]
    ds_read_b64_tr_b16 v[118:119], v133 offset:58368
    s_waitcnt lgkmcnt(12)
    v_mfma_f32_16x16x32_bf16 v[56:59], a[56:59], v[92:95], v[56:59]
    ds_read_b64_tr_b16 v[120:121], v134 offset:57344
    v_mfma_f32_16x16x32_bf16 v[60:63], a[120:123], v[92:95], v[60:63]
    ds_read_b64_tr_b16 v[122:123], v134 offset:58368
    s_waitcnt lgkmcnt(12)
    v_mfma_f32_16x16x32_bf16 v[0:3], a[60:63], v[96:99], v[0:3]
    ds_read_b64_tr_b16 v[124:125], v135 offset:57344
    v_mfma_f32_16x16x32_bf16 v[4:7], a[124:127], v[96:99], v[4:7]
    ds_read_b64_tr_b16 v[126:127], v135 offset:58368
    s_waitcnt lgkmcnt(12)
    v_mfma_f32_16x16x32_bf16 v[8:11], a[60:63], v[100:103], v[8:11]
    v_mfma_f32_16x16x32_bf16 v[12:15], a[124:127], v[100:103], v[12:15]
    s_waitcnt lgkmcnt(10)
    v_mfma_f32_16x16x32_bf16 v[16:19], a[60:63], v[104:107], v[16:19]
    v_mfma_f32_16x16x32_bf16 v[20:23], a[124:127], v[104:107], v[20:23]
    s_waitcnt lgkmcnt(8)
    v_mfma_f32_16x16x32_bf16 v[24:27], a[60:63], v[108:111], v[24:27]
    v_mfma_f32_16x16x32_bf16 v[28:31], a[124:127], v[108:111], v[28:31]
    s_waitcnt lgkmcnt(6)
    v_mfma_f32_16x16x32_bf16 v[32:35], a[60:63], v[112:115], v[32:35]
    v_mfma_f32_16x16x32_bf16 v[36:39], a[124:127], v[112:115], v[36:39]
    s_waitcnt lgkmcnt(4)
    v_mfma_f32_16x16x32_bf16 v[40:43], a[60:63], v[116:119], v[40:43]
    v_mfma_f32_16x16x32_bf16 v[44:47], a[124:127], v[116:119], v[44:47]
    s_waitcnt lgkmcnt(2)
    v_mfma_f32_16x16x32_bf16 v[48:51], a[60:63], v[120:123], v[48:51]
    v_mfma_f32_16x16x32_bf16 v[52:55], a[124:127], v[120:123], v[52:55]
    s_waitcnt lgkmcnt(0)
    v_mfma_f32_16x16x32_bf16 v[56:59], a[60:63], v[124:127], v[56:59]
    v_mfma_f32_16x16x32_bf16 v[60:63], a[124:127], v[124:127], v[60:63]
    v_xor_b32 v128, 0x10000, v128
    v_xor_b32 v129, 0x10000, v129
    v_xor_b32 v130, 0x10000, v130
    v_xor_b32 v131, 0x10000, v131
    v_xor_b32 v132, 0x10000, v132
    v_xor_b32 v133, 0x10000, v133
    v_xor_b32 v134, 0x10000, v134
    v_xor_b32 v135, 0x10000, v135
    v_cvt_pk_bf16_f32 v144, v0, v1
    v_cvt_pk_bf16_f32 v145, v2, v3
    v_cvt_pk_bf16_f32 v146, v4, v5
    v_cvt_pk_bf16_f32 v147, v6, v7
    buffer_store_dwordx4 v[144:147], v137, s[8:11], s25 offen sc1
    v_cvt_pk_bf16_f32 v148, v8, v9
    v_cvt_pk_bf16_f32 v149, v10, v11
    v_cvt_pk_bf16_f32 v150, v12, v13
    v_cvt_pk_bf16_f32 v151, v14, v15
    buffer_store_dwordx4 v[148:151], v137, s[8:11], s25 offen offset:1024 sc1
    v_cvt_pk_bf16_f32 v152, v16, v17
    v_cvt_pk_bf16_f32 v153, v18, v19
    v_cvt_pk_bf16_f32 v154, v20, v21
    v_cvt_pk_bf16_f32 v155, v22, v23
    buffer_store_dwordx4 v[152:155], v137, s[8:11], s25 offen offset:2048 sc1
    v_cvt_pk_bf16_f32 v156, v24, v25
    v_cvt_pk_bf16_f32 v157, v26, v27
    v_cvt_pk_bf16_f32 v158, v28, v29
    v_cvt_pk_bf16_f32 v159, v30, v31
    buffer_store_dwordx4 v[156:159], v137, s[8:11], s25 offen offset:3072 sc1
    v_cvt_pk_bf16_f32 v144, v32, v33
    v_cvt_pk_bf16_f32 v145, v34, v35
    v_cvt_pk_bf16_f32 v146, v36, v37
    v_cvt_pk_bf16_f32 v147, v38, v39
    s_add_u32 s25, s25, 4096
    buffer_store_dwordx4 v[144:147], v137, s[8:11], s25 offen sc1
    v_cvt_pk_bf16_f32 v148, v40, v41
    v_cvt_pk_bf16_f32 v149, v42, v43
    v_cvt_pk_bf16_f32 v150, v44, v45
    v_cvt_pk_bf16_f32 v151, v46, v47
    buffer_store_dwordx4 v[148:151], v137, s[8:11], s25 offen offset:1024 sc1
    v_cvt_pk_bf16_f32 v152, v48, v49
    v_cvt_pk_bf16_f32 v153, v50, v51
    v_cvt_pk_bf16_f32 v154, v52, v53
    v_cvt_pk_bf16_f32 v155, v54, v55
    buffer_store_dwordx4 v[152:155], v137, s[8:11], s25 offen offset:2048 sc1
    v_cvt_pk_bf16_f32 v156, v56, v57
    v_cvt_pk_bf16_f32 v157, v58, v59
    v_cvt_pk_bf16_f32 v158, v60, v61
    v_cvt_pk_bf16_f32 v159, v62, v63
    buffer_store_dwordx4 v[156:159], v137, s[8:11], s25 offen offset:3072 sc1
L_p1_next:
    s_add_u32 s80, s80, 1
    s_lshl_b32 s40, s38, 4
    s_add_u32 s40, s40, s20
    s_lshl_b32 s40, s40, 2
    s_add_u32 s40, s40, 0x2000
    s_add_u32 s38, s38, s37
    s_branch L_p1_unit
L_p1_end:
    s_waitcnt vmcnt(0)
    s_barrier
    s_cmp_eq_u32 s40, 0
    s_cbranch_scc1 L_nopf_98
    s_cmp_lg_u32 s87, 0
    s_cbranch_scc1 L_modeok_99
    s_mov_b32 s96, 0
L_mode_100:
    buffer_load_dwordx2 v[140:141], off, s[92:95], 0 offset:36 sc1
    s_waitcnt vmcnt(0)
    v_readfirstlane_b32 s87, v140
    v_readfirstlane_b32 s97, v141
    s_nop 0
    s_min_u32 s97, s97, s87
    s_cmp_lg_u32 s97, 0
    s_cbranch_scc1 L_moded_101
    s_sleep 4
    s_add_u32 s96, s96, 1
    s_cmp_lg_u32 s96, 0x100
    s_cbranch_scc1 L_modef_102
    v_mov_b32 v140, 2
    v_mov_b32 v141, 0
    s_mov_b64 exec, 1
    buffer_atomic_cmpswap v[140:141], off, s[92:95], 0 offset:36
    s_mov_b64 exec, -1
L_modef_102:
    s_cmp_lt_u32 s96, 0x10000
    s_cbranch_scc1 L_mode_100
L_moded_101:
    s_cmp_lg_u32 s87, 1
    s_cbranch_scc1 L_fallback
L_modeok_99:
    s_cmp_lg_u32 s100, 0
    s_cbranch_scc1 L_flag_103
    v_mov_b32 v138, 1
    s_mov_b64 exec, 1
    buffer_store_dword v138, off, s[8:11], s40 sc1
    s_mov_b64 exec, -1
L_flag_103:
    s_mov_b32 s40, 0
L_nopf_98:
    s_cmp_lg_u32 s41, 0
    s_cbranch_scc1 L_p1done
    s_mov_b32 s41, 1
    s_and_b32 s20, s101, 15
    s_lshr_b32 s22, s101, 4
    s_mov_b32 s37, 14
    s_add_u32 s26, s22, 70
    s_add_u32 s27, s22, 56
    s_cmp_ge_u32 s27, 64
    s_cselect_b32 s26, s27, s26
    s_add_u32 s27, s22, 42
    s_add_u32 s28, s22, 28
    s_cmp_ge_u32 s28, 32
    s_cselect_b32 s27, s28, s27
    s_cmp_eq_u32 s20, 3
    s_cselect_b32 s22, s27, s22
    s_cmp_lt_u32 s20, 3
    s_cselect_b32 s22, s26, s22
    s_branch L_p1_pass
L_p1done:
    v_mbcnt_lo_u32_b32 v0, -1, 0
    v_mbcnt_hi_u32_b32 v0, -1, v0
    s_lshl_b32 s96, s100, 6
    v_add_u32 v0, s96, v0
    s_and_b32 s20, s101, 15
    s_lshr_b32 s22, s101, 4
    s_mov_b32 s23, 14
    s_load_dwordx2 s[12:13], s[0:1], 40
    s_waitcnt lgkmcnt(0)
    s_and_b32 s13, s13, 0xffff
    s_mov_b32 s14, 0x400000
    s_mov_b32 s15, 0x20000
    v_lshrrev_b32 v4, 6, v0
    s_nop 0
    v_readfirstlane_b32 s21, v4
    v_and_b32 v1, 63, v0
    v_lshrrev_b32 v2, 4, v1
    v_and_b32 v3, 15, v1
    v_lshrrev_b32 v6, 2, v3
    v_lshlrev_b32 v240, 4, v1
    v_lshlrev_b32 v241, 3, v1
    s_lshl_b32 s27, s21, 10
    s_lshl_b32 s24, s21, 5
    v_xor_b32 v4, s24, v240
    v_add_u32 v8, s27, v4
    v_xor_b32 v9, 128, v8
    v_lshl_add_u32 v4, v2, 2, v6
    v_and_b32 v5, 7, v4
    v_lshlrev_b32 v4, 10, v4
    v_lshl_add_u32 v4, v5, 5, v4
    v_and_b32 v5, 3, v3
    v_lshl_add_u32 v4, v5, 3, v4
    s_lshl_b32 s24, s21, 8
    v_add_u32 v10, s24, v4
    s_lshl_b32 s25, s20, 18
    s_add_u32 s24, s25, 0x0
    s_add_u32 m0, s27, 0x0
    s_nop 0
    buffer_load_dwordx4 v8, s[12:15], s24 offen lds
    s_add_u32 s24, s25, 0x1000
    s_add_u32 m0, s27, 0x1000
    s_nop 0
    buffer_load_dwordx4 v9, s[12:15], s24 offen lds
    s_add_u32 s24, s25, 0x2000
    s_add_u32 m0, s27, 0x2000
    s_nop 0
    buffer_load_dwordx4 v8, s[12:15], s24 offen lds
    s_add_u32 s24, s25, 0x3000
    s_add_u32 m0, s27, 0x3000
    s_nop 0
    buffer_load_dwordx4 v9, s[12:15], s24 offen lds
    s_add_u32 s24, s25, 0x4000
    s_add_u32 m0, s27, 0x4000
    s_nop 0
    buffer_load_dwordx4 v8, s[12:15], s24 offen lds
    s_add_u32 s24, s25, 0x5000
    s_add_u32 m0, s27, 0x5000
    s_nop 0
    buffer_load_dwordx4 v9, s[12:15], s24 offen lds
    s_add_u32 s24, s25, 0x6000
    s_add_u32 m0, s27, 0x6000
    s_nop 0
    buffer_load_dwordx4 v8, s[12:15], s24 offen lds
    s_add_u32 s24, s25, 0x7000
    s_add_u32 m0, s27, 0x7000
    s_nop 0
    buffer_load_dwordx4 v9, s[12:15], s24 offen lds
    s_add_u32 s24, s25, 0x8000
    s_add_u32 m0, s27, 0x8000
    s_nop 0
    buffer_load_dwordx4 v8, s[12:15], s24 offen lds
    s_add_u32 s24, s25, 0x9000
    s_add_u32 m0, s27, 0x9000
    s_nop 0
    buffer_load_dwordx4 v9, s[12:15], s24 offen lds
    s_add_u32 s24, s25, 0xa000
    s_add_u32 m0, s27, 0xa000
    s_nop 0
    buffer_load_dwordx4 v8, s[12:15], s24 offen lds
    s_add_u32 s24, s25, 0xb000
    s_add_u32 m0, s27, 0xb000
    s_nop 0
    buffer_load_dwordx4 v9, s[12:15], s24 offen lds
    s_add_u32 s24, s25, 0xc000
    s_add_u32 m0, s27, 0xc000
    s_nop 0
    buffer_load_dwordx4 v8, s[12:15], s24 offen lds
    s_add_u32 s24, s25, 0xd000
    s_add_u32 m0, s27, 0xd000
    s_nop 0
    buffer_load_dwordx4 v9, s[12:15], s24 offen lds
    s_add_u32 s24, s25, 0xe000
    s_add_u32 m0, s27, 0xe000
    s_nop 0
    buffer_load_dwordx4 v8, s[12:15], s24 offen lds
    s_add_u32 s24, s25, 0xf000
    s_add_u32 m0, s27, 0xf000
    s_nop 0
    buffer_load_dwordx4 v9, s[12:15], s24 offen lds
    s_add_u32 s24, s25, 0x10000
    s_add_u32 m0, s27, 0x10000
    s_nop 0
    buffer_load_dwordx4 v8, s[12:15], s24 offen lds
    s_add_u32 s24, s25, 0x11000
    s_add_u32 m0, s27, 0x11000
    s_nop 0
    buffer_load_dwordx4 v9, s[12:15], s24 offen lds
    s_add_u32 s24, s25, 0x12000
    s_add_u32 m0, s27, 0x12000
    s_nop 0
    buffer_load_dwordx4 v8, s[12:15], s24 offen lds
    s_add_u32 s24, s25, 0x13000
    s_add_u32 m0, s27, 0x13000
    s_nop 0
    buffer_load_dwordx4 v9, s[12:15], s24 offen lds
    s_add_u32 s24, s25, 0x14000
    s_add_u32 m0, s27, 0x14000
    s_nop 0
    buffer_load_dwordx4 v8, s[12:15], s24 offen lds
    s_add_u32 s24, s25, 0x15000
    s_add_u32 m0, s27, 0x15000
    s_nop 0
    buffer_load_dwordx4 v9, s[12:15], s24 offen lds
    s_add_u32 s24, s25, 0x16000
    s_add_u32 m0, s27, 0x16000
    s_nop 0
    buffer_load_dwordx4 v8, s[12:15], s24 offen lds
    s_add_u32 s24, s25, 0x17000
    s_add_u32 m0, s27, 0x17000
    s_nop 0
    buffer_load_dwordx4 v9, s[12:15], s24 offen lds
    s_add_u32 s24, s25, 0x18000
    s_add_u32 m0, s27, 0x18000
    s_nop 0
    buffer_load_dwordx4 v8, s[12:15], s24 offen lds
    s_add_u32 s24, s25, 0x19000
    s_add_u32 m0, s27, 0x19000
    s_nop 0
    buffer_load_dwordx4 v9, s[12:15], s24 offen lds
    s_add_u32 s24, s25, 0x1a000
    s_add_u32 m0, s27, 0x1a000
    s_nop 0
    buffer_load_dwordx4 v8, s[12:15], s24 offen lds
    s_add_u32 s24, s25, 0x1b000
    s_add_u32 m0, s27, 0x1b000
    s_nop 0
    buffer_load_dwordx4 v9, s[12:15], s24 offen lds
    s_add_u32 s24, s25, 0x1c000
    s_add_u32 m0, s27, 0x1c000
    s_nop 0
    buffer_load_dwordx4 v8, s[12:15], s24 offen lds
    s_add_u32 s24, s25, 0x1d000
    s_add_u32 m0, s27, 0x1d000
    s_nop 0
    buffer_load_dwordx4 v9, s[12:15], s24 offen lds
    s_add_u32 s24, s25, 0x1e000
    s_add_u32 m0, s27, 0x1e000
    s_nop 0
    buffer_load_dwordx4 v8, s[12:15], s24 offen lds
    s_add_u32 s24, s25, 0x1f000
    s_add_u32 m0, s27, 0x1f000
    s_nop 0
    buffer_load_dwordx4 v9, s[12:15], s24 offen lds
    s_waitcnt vmcnt(0)
    s_barrier
    v_xor_b32 v11, 0x0, v10
    ds_read_b64_tr_b16 a[0:1], v11
    ds_read_b64_tr_b16 a[2:3], v11 offset:16384
    ds_read_b64_tr_b16 a[32:33], v11 offset:32768
    ds_read_b64_tr_b16 a[34:35], v11 offset:49152
    v_xor_b32 v11, 0x20, v10
    ds_read_b64_tr_b16 a[4:5], v11
    ds_read_b64_tr_b16 a[6:7], v11 offset:16384
    ds_read_b64_tr_b16 a[36:37], v11 offset:32768
    ds_read_b64_tr_b16 a[38:39], v11 offset:49152
    s_waitcnt lgkmcnt(0)
    v_xor_b32 v11, 0x40, v10
    ds_read_b64_tr_b16 a[8:9], v11
    ds_read_b64_tr_b16 a[10:11], v11 offset:16384
    ds_read_b64_tr_b16 a[40:41], v11 offset:32768
    ds_read_b64_tr_b16 a[42:43], v11 offset:49152
    v_xor_b32 v11, 0x60, v10
    ds_read_b64_tr_b16 a[12:13], v11
    ds_read_b64_tr_b16 a[14:15], v11 offset:16384
    ds_read_b64_tr_b16 a[44:45], v11 offset:32768
    ds_read_b64_tr_b16 a[46:47], v11 offset:49152
    s_waitcnt lgkmcnt(0)
    v_xor_b32 v11, 0x80, v10
    ds_read_b64_tr_b16 a[16:17], v11
    ds_read_b64_tr_b16 a[18:19], v11 offset:16384
    ds_read_b64_tr_b16 a[48:49], v11 offset:32768
    ds_read_b64_tr_b16 a[50:51], v11 offset:49152
    v_xor_b32 v11, 0xa0, v10
    ds_read_b64_tr_b16 a[20:21], v11
    ds_read_b64_tr_b16 a[22:23], v11 offset:16384
    ds_read_b64_tr_b16 a[52:53], v11 offset:32768
    ds_read_b64_tr_b16 a[54:55], v11 offset:49152
    s_waitcnt lgkmcnt(0)
    v_xor_b32 v11, 0xc0, v10
    ds_read_b64_tr_b16 a[24:25], v11
    ds_read_b64_tr_b16 a[26:27], v11 offset:16384
    ds_read_b64_tr_b16 a[56:57], v11 offset:32768
    ds_read_b64_tr_b16 a[58:59], v11 offset:49152
    v_xor_b32 v11, 0xe0, v10
    ds_read_b64_tr_b16 a[28:29], v11
    ds_read_b64_tr_b16 a[30:31], v11 offset:16384
    ds_read_b64_tr_b16 a[60:61], v11 offset:32768
    ds_read_b64_tr_b16 a[62:63], v11 offset:49152
    s_waitcnt lgkmcnt(0)
    v_xor_b32 v11, 0x10000, v10
    ds_read_b64_tr_b16 a[64:65], v11
    ds_read_b64_tr_b16 a[66:67], v11 offset:16384
    ds_read_b64_tr_b16 a[96:97], v11 offset:32768
    ds_read_b64_tr_b16 a[98:99], v11 offset:49152
    v_xor_b32 v11, 0x10020, v10
    ds_read_b64_tr_b16 a[68:69], v11
    ds_read_b64_tr_b16 a[70:71], v11 offset:16384
    ds_read_b64_tr_b16 a[100:101], v11 offset:32768
    ds_read_b64_tr_b16 a[102:103], v11 offset:49152
    s_waitcnt lgkmcnt(0)
    v_xor_b32 v11, 0x10040, v10
    ds_read_b64_tr_b16 a[72:73], v11
    ds_read_b64_tr_b16 a[74:75], v11 offset:16384
    ds_read_b64_tr_b16 a[104:105], v11 offset:32768
    ds_read_b64_tr_b16 a[106:107], v11 offset:49152
    v_xor_b32 v11, 0x10060, v10
    ds_read_b64_tr_b16 a[76:77], v11
    ds_read_b64_tr_b16 a[78:79], v11 offset:16384
    ds_read_b64_tr_b16 a[108:109], v11 offset:32768
    ds_read_b64_tr_b16 a[110:111], v11 offset:49152
    s_waitcnt lgkmcnt(0)
    v_xor_b32 v11, 0x10080, v10
    ds_read_b64_tr_b16 a[80:81], v11
    ds_read_b64_tr_b16 a[82:83], v11 offset:16384
    ds_read_b64_tr_b16 a[112:113], v11 offset:32768
    ds_read_b64_tr_b16 a[114:115], v11 offset:49152
    v_xor_b32 v11, 0x100a0, v10
    ds_read_b64_tr_b16 a[84:85], v11
    ds_read_b64_tr_b16 a[86:87], v11 offset:16384
    ds_read_b64_tr_b16 a[116:117], v11 offset:32768
    ds_read_b64_tr_b16 a[118:119], v11 offset:49152
    s_waitcnt lgkmcnt(0)
    v_xor_b32 v11, 0x100c0, v10
    ds_read_b64_tr_b16 a[88:89], v11
    ds_read_b64_tr_b16 a[90:91], v11 offset:16384
    ds_read_b64_tr_b16 a[120:121], v11 offset:32768
    ds_read_b64_tr_b16 a[122:123], v11 offset:49152
    v_xor_b32 v11, 0x100e0, v10
    ds_read_b64_tr_b16 a[92:93], v11
    ds_read_b64_tr_b16 a[94:95], v11 offset:16384
    ds_read_b64_tr_b16 a[124:125], v11 offset:32768
    ds_read_b64_tr_b16 a[126:127], v11 offset:49152
    s_waitcnt lgkmcnt(0)
    s_barrier
    s_lshl_b32 s25, s20, 18
    s_add_u32 s24, s25, 0x20000
    s_add_u32 m0, s27, 0x0
    s_nop 0
    buffer_load_dwordx4 v8, s[12:15], s24 offen lds
    s_add_u32 s24, s25, 0x21000
    s_add_u32 m0, s27, 0x1000
    s_nop 0
    buffer_load_dwordx4 v9, s[12:15], s24 offen lds
    s_add_u32 s24, s25, 0x22000
    s_add_u32 m0, s27, 0x2000
    s_nop 0
    buffer_load_dwordx4 v8, s[12:15], s24 offen lds
    s_add_u32 s24, s25, 0x23000
    s_add_u32 m0, s27, 0x3000
    s_nop 0
    buffer_load_dwordx4 v9, s[12:15], s24 offen lds
    s_add_u32 s24, s25, 0x24000
    s_add_u32 m0, s27, 0x4000
    s_nop 0
    buffer_load_dwordx4 v8, s[12:15], s24 offen lds
    s_add_u32 s24, s25, 0x25000
    s_add_u32 m0, s27, 0x5000
    s_nop 0
    buffer_load_dwordx4 v9, s[12:15], s24 offen lds
    s_add_u32 s24, s25, 0x26000
    s_add_u32 m0, s27, 0x6000
    s_nop 0
    buffer_load_dwordx4 v8, s[12:15], s24 offen lds
    s_add_u32 s24, s25, 0x27000
    s_add_u32 m0, s27, 0x7000
    s_nop 0
    buffer_load_dwordx4 v9, s[12:15], s24 offen lds
    s_add_u32 s24, s25, 0x28000
    s_add_u32 m0, s27, 0x8000
    s_nop 0
    buffer_load_dwordx4 v8, s[12:15], s24 offen lds
    s_add_u32 s24, s25, 0x29000
    s_add_u32 m0, s27, 0x9000
    s_nop 0
    buffer_load_dwordx4 v9, s[12:15], s24 offen lds
    s_add_u32 s24, s25, 0x2a000
    s_add_u32 m0, s27, 0xa000
    s_nop 0
    buffer_load_dwordx4 v8, s[12:15], s24 offen lds
    s_add_u32 s24, s25, 0x2b000
    s_add_u32 m0, s27, 0xb000
    s_nop 0
    buffer_load_dwordx4 v9, s[12:15], s24 offen lds
    s_add_u32 s24, s25, 0x2c000
    s_add_u32 m0, s27, 0xc000
    s_nop 0
    buffer_load_dwordx4 v8, s[12:15], s24 offen lds
    s_add_u32 s24, s25, 0x2d000
    s_add_u32 m0, s27, 0xd000
    s_nop 0
    buffer_load_dwordx4 v9, s[12:15], s24 offen lds
    s_add_u32 s24, s25, 0x2e000
    s_add_u32 m0, s27, 0xe000
    s_nop 0
    buffer_load_dwordx4 v8, s[12:15], s24 offen lds
    s_add_u32 s24, s25, 0x2f000
    s_add_u32 m0, s27, 0xf000
    s_nop 0
    buffer_load_dwordx4 v9, s[12:15], s24 offen lds
    s_add_u32 s24, s25, 0x30000
    s_add_u32 m0, s27, 0x10000
    s_nop 0
    buffer_load_dwordx4 v8, s[12:15], s24 offen lds
    s_add_u32 s24, s25, 0x31000
    s_add_u32 m0, s27, 0x11000
    s_nop 0
    buffer_load_dwordx4 v9, s[12:15], s24 offen lds
    s_add_u32 s24, s25, 0x32000
    s_add_u32 m0, s27, 0x12000
    s_nop 0
    buffer_load_dwordx4 v8, s[12:15], s24 offen lds
    s_add_u32 s24, s25, 0x33000
    s_add_u32 m0, s27, 0x13000
    s_nop 0
    buffer_load_dwordx4 v9, s[12:15], s24 offen lds
    s_add_u32 s24, s25, 0x34000
    s_add_u32 m0, s27, 0x14000
    s_nop 0
    buffer_load_dwordx4 v8, s[12:15], s24 offen lds
    s_add_u32 s24, s25, 0x35000
    s_add_u32 m0, s27, 0x15000
    s_nop 0
    buffer_load_dwordx4 v9, s[12:15], s24 offen lds
    s_add_u32 s24, s25, 0x36000
    s_add_u32 m0, s27, 0x16000
    s_nop 0
    buffer_load_dwordx4 v8, s[12:15], s24 offen lds
    s_add_u32 s24, s25, 0x37000
    s_add_u32 m0, s27, 0x17000
    s_nop 0
    buffer_load_dwordx4 v9, s[12:15], s24 offen lds
    s_add_u32 s24, s25, 0x38000
    s_add_u32 m0, s27, 0x18000
    s_nop 0
    buffer_load_dwordx4 v8, s[12:15], s24 offen lds
    s_add_u32 s24, s25, 0x39000
    s_add_u32 m0, s27, 0x19000
    s_nop 0
    buffer_load_dwordx4 v9, s[12:15], s24 offen lds
    s_add_u32 s24, s25, 0x3a000
    s_add_u32 m0, s27, 0x1a000
    s_nop 0
    buffer_load_dwordx4 v8, s[12:15], s24 offen lds
    s_add_u32 s24, s25, 0x3b000
    s_add_u32 m0, s27, 0x1b000
    s_nop 0
    buffer_load_dwordx4 v9, s[12:15], s24 offen lds
    s_add_u32 s24, s25, 0x3c000
    s_add_u32 m0, s27, 0x1c000
    s_nop 0
    buffer_load_dwordx4 v8, s[12:15], s24 offen lds
    s_add_u32 s24, s25, 0x3d000
    s_add_u32 m0, s27, 0x1d000
    s_nop 0
    buffer_load_dwordx4 v9, s[12:15], s24 offen lds
    s_add_u32 s24, s25, 0x3e000
    s_add_u32 m0, s27, 0x1e000
    s_nop 0
    buffer_load_dwordx4 v8, s[12:15], s24 offen lds
    s_add_u32 s24, s25, 0x3f000
    s_add_u32 m0, s27, 0x1f000
    s_nop 0
    buffer_load_dwordx4 v9, s[12:15], s24 offen lds
    s_waitcnt vmcnt(0)
    s_barrier
    v_xor_b32 v11, 0x0, v10
    ds_read_b64_tr_b16 a[128:129], v11
    ds_read_b64_tr_b16 a[130:131], v11 offset:16384
    ds_read_b64_tr_b16 a[160:161], v11 offset:32768
    ds_read_b64_tr_b16 a[162:163], v11 offset:49152
    v_xor_b32 v11, 0x20, v10
    ds_read_b64_tr_b16 a[132:133], v11
    ds_read_b64_tr_b16 a[134:135], v11 offset:16384
    ds_read_b64_tr_b16 a[164:165], v11 offset:32768
    ds_read_b64_tr_b16 a[166:167], v11 offset:49152
    s_waitcnt lgkmcnt(0)
    v_xor_b32 v11, 0x40, v10
    ds_read_b64_tr_b16 a[136:137], v11
    ds_read_b64_tr_b16 a[138:139], v11 offset:16384
    ds_read_b64_tr_b16 a[168:169], v11 offset:32768
    ds_read_b64_tr_b16 a[170:171], v11 offset:49152
    v_xor_b32 v11, 0x60, v10
    ds_read_b64_tr_b16 a[140:141], v11
    ds_read_b64_tr_b16 a[142:143], v11 offset:16384
    ds_read_b64_tr_b16 a[172:173], v11 offset:32768
    ds_read_b64_tr_b16 a[174:175], v11 offset:49152
    s_waitcnt lgkmcnt(0)
    v_xor_b32 v11, 0x80, v10
    ds_read_b64_tr_b16 a[144:145], v11
    ds_read_b64_tr_b16 a[146:147], v11 offset:16384
    ds_read_b64_tr_b16 a[176:177], v11 offset:32768
    ds_read_b64_tr_b16 a[178:179], v11 offset:49152
    v_xor_b32 v11, 0xa0, v10
    ds_read_b64_tr_b16 a[148:149], v11
    ds_read_b64_tr_b16 a[150:151], v11 offset:16384
    ds_read_b64_tr_b16 a[180:181], v11 offset:32768
    ds_read_b64_tr_b16 a[182:183], v11 offset:49152
    s_waitcnt lgkmcnt(0)
    v_xor_b32 v11, 0xc0, v10
    ds_read_b64_tr_b16 a[152:153], v11
    ds_read_b64_tr_b16 a[154:155], v11 offset:16384
    ds_read_b64_tr_b16 a[184:185], v11 offset:32768
    ds_read_b64_tr_b16 a[186:187], v11 offset:49152
    v_xor_b32 v11, 0xe0, v10
    ds_read_b64_tr_b16 a[156:157], v11
    ds_read_b64_tr_b16 a[158:159], v11 offset:16384
    ds_read_b64_tr_b16 a[188:189], v11 offset:32768
    ds_read_b64_tr_b16 a[190:191], v11 offset:49152
    s_waitcnt lgkmcnt(0)
    v_xor_b32 v11, 0x10000, v10
    ds_read_b64_tr_b16 a[192:193], v11
    ds_read_b64_tr_b16 a[194:195], v11 offset:16384
    ds_read_b64_tr_b16 a[224:225], v11 offset:32768
    ds_read_b64_tr_b16 a[226:227], v11 offset:49152
    v_xor_b32 v11, 0x10020, v10
    ds_read_b64_tr_b16 a[196:197], v11
    ds_read_b64_tr_b16 a[198:199], v11 offset:16384
    ds_read_b64_tr_b16 a[228:229], v11 offset:32768
    ds_read_b64_tr_b16 a[230:231], v11 offset:49152
    s_waitcnt lgkmcnt(0)
    v_xor_b32 v11, 0x10040, v10
    ds_read_b64_tr_b16 a[200:201], v11
    ds_read_b64_tr_b16 a[202:203], v11 offset:16384
    ds_read_b64_tr_b16 a[232:233], v11 offset:32768
    ds_read_b64_tr_b16 a[234:235], v11 offset:49152
    v_xor_b32 v11, 0x10060, v10
    ds_read_b64_tr_b16 a[204:205], v11
    ds_read_b64_tr_b16 a[206:207], v11 offset:16384
    ds_read_b64_tr_b16 a[236:237], v11 offset:32768
    ds_read_b64_tr_b16 a[238:239], v11 offset:49152
    s_waitcnt lgkmcnt(0)
    v_xor_b32 v11, 0x10080, v10
    ds_read_b64_tr_b16 a[208:209], v11
    ds_read_b64_tr_b16 a[210:211], v11 offset:16384
    ds_read_b64_tr_b16 a[240:241], v11 offset:32768
    ds_read_b64_tr_b16 a[242:243], v11 offset:49152
    v_xor_b32 v11, 0x100a0, v10
    ds_read_b64_tr_b16 a[212:213], v11
    ds_read_b64_tr_b16 a[214:215], v11 offset:16384
    ds_read_b64_tr_b16 a[244:245], v11 offset:32768
    ds_read_b64_tr_b16 a[246:247], v11 offset:49152
    s_waitcnt lgkmcnt(0)
    v_xor_b32 v11, 0x100c0, v10
    ds_read_b64_tr_b16 a[216:217], v11
    ds_read_b64_tr_b16 a[218:219], v11 offset:16384
    ds_read_b64_tr_b16 a[248:249], v11 offset:32768
    ds_read_b64_tr_b16 a[250:251], v11 offset:49152
    v_xor_b32 v11, 0x100e0, v10
    ds_read_b64_tr_b16 a[220:221], v11
    ds_read_b64_tr_b16 a[222:223], v11 offset:16384
    ds_read_b64_tr_b16 a[252:253], v11 offset:32768
    ds_read_b64_tr_b16 a[254:255], v11 offset:49152
    s_waitcnt lgkmcnt(0)
    s_barrier
    s_and_b32 s24, s21, 1
    s_lshl_b32 s24, s24, 4
    v_add_u32 v4, s24, v3
    v_lshlrev_b32 v5, 2, v2
    v_sub_u32 v4, v4, v5
    v_cmp_le_i32 s[30:31], 0, v4
    v_cmp_le_i32 s[32:33], 1, v4
    v_cmp_le_i32 s[34:35], 2, v4
    v_cmp_le_i32 s[36:37], 3, v4
    v_cmp_le_i32 s[38:39], 16, v4
    v_cmp_le_i32 s[40:41], 17, v4
    v_cmp_le_i32 s[42:43], 18, v4
    v_cmp_le_i32 s[44:45], 19, v4
    s_mov_b32 s28, 0x3e0293ee
    s_mov_b32 s29, 0x3e0293ee
    s_mov_b32 s53, 0xff000000
    v_mov_b32 v136, 0x3f803f80
    v_mov_b32 v137, 0x3f803f80
    v_mov_b32 v138, 0x3f803f80
    v_mov_b32 v139, 0x3f803f80
    v_lshlrev_b32 v4, 10, v3
    v_lshl_add_u32 v4, v2, 4, v4
    s_lshl_b32 s24, s21, 8
    v_add_u32 v242, s24, v4
    s_lshl_b32 s24, s21, 12
    v_add_u32 v243, s24, v240
    v_mov_b32 v244, v240
    s_add_u32 s24, s24, 0x22000
    v_xor_b32 v7, v2, v6
    v_lshl_add_u32 v4, v2, 4, v7
    v_and_b32 v5, 3, v3
    v_lshl_add_u32 v4, v4, 2, v5
    v_lshl_add_u32 v253, v4, 2, s24
    v_lshl_add_u32 v4, v3, 2, v7
    v_lshl_add_u32 v254, v4, 4, s24
    s_load_dwordx2 s[12:13], s[0:1], 0
    s_waitcnt lgkmcnt(0)
    s_and_b32 s13, s13, 0xffff
    s_mov_b32 s14, 0x200000
    s_mov_b32 s15, 0x20000
    s_load_dwordx2 s[16:17], s[0:1], 96
    s_waitcnt lgkmcnt(0)
    s_and_b32 s17, s17, 0xffff
    s_mov_b32 s18, 0x200000
    s_mov_b32 s19, 0x20000
    s_load_dwordx2 s[56:57], s[0:1], 64
    s_waitcnt lgkmcnt(0)
    s_and_b32 s57, s57, 0xffff
    s_mov_b32 s58, 0x400
    s_mov_b32 s59, 0x20000
    v_and_b32 v100, 63, v0
    v_lshlrev_b32 v240, 4, v100
    v_lshrrev_b32 v101, 2, v100
    v_lshlrev_b32 v101, 6, v101
    v_and_b32 v102, 3, v100
    v_lshl_add_u32 v252, v102, 3, v101
    buffer_load_dwordx2 v[236:237], v252, s[56:59], 0 offen
    buffer_load_dwordx2 v[238:239], v252, s[56:59], 0 offen offset:32
    s_mov_b32 s65, 0x3f80
    s_mov_b32 s66, 0x3f800000
    s_waitcnt vmcnt(0)
    s_sub_u32 s67, s101, 128
    s_cmp_ge_u32 s67, 56
    s_cbranch_scc1 L_nostage_104
    v_lshrrev_b32 v2, 6, v0
    s_nop 0
    v_readfirstlane_b32 s68, v2
    v_and_b32 v1, 63, v0
    s_lshl_b32 s73, s68, 10
    v_lshrrev_b32 v2, 2, v1
    s_lshl_b32 s71, s68, 4
    v_add_u32 v2, s71, v2
    s_movk_i32 s71, 3584
    v_mul_lo_u32 v2, v2, s71
    v_and_b32 v3, 3, v1
    v_lshl_add_u32 v4, v3, 4, v2
    s_load_dwordx2 s[76:77], s[0:1], 72
    s_waitcnt lgkmcnt(0)
    s_and_b32 s77, s77, 0xffff
    s_mov_b32 s78, 0x1c0000
    s_mov_b32 s79, 0x20000
    s_lshl_b32 s71, s67, 6
    s_add_u32 s71, s71, 0x0
    s_add_u32 m0, s73, 0x8000
    s_nop 0
    buffer_load_dwordx4 v4, s[76:79], s71 offen lds
    s_lshl_b32 s71, s67, 6
    s_add_u32 s71, s71, 0x38000
    s_add_u32 m0, s73, 0x9000
    s_nop 0
    buffer_load_dwordx4 v4, s[76:79], s71 offen lds
    s_lshl_b32 s71, s67, 6
    s_add_u32 s71, s71, 0x70000
    s_add_u32 m0, s73, 0xa000
    s_nop 0
    buffer_load_dwordx4 v4, s[76:79], s71 offen lds
    s_lshl_b32 s71, s67, 6
    s_add_u32 s71, s71, 0xa8000
    s_add_u32 m0, s73, 0xb000
    s_nop 0
    buffer_load_dwordx4 v4, s[76:79], s71 offen lds
    s_lshl_b32 s71, s67, 6
    s_add_u32 s71, s71, 0xe0000
    s_add_u32 m0, s73, 0xc000
    s_nop 0
    buffer_load_dwordx4 v4, s[76:79], s71 offen lds
    s_lshl_b32 s71, s67, 6
    s_add_u32 s71, s71, 0x118000
    s_add_u32 m0, s73, 0xd000
    s_nop 0
    buffer_load_dwordx4 v4, s[76:79], s71 offen lds
    s_lshl_b32 s71, s67, 6
    s_add_u32 s71, s71, 0x150000
    s_add_u32 m0, s73, 0xe000
    s_nop 0
    buffer_load_dwordx4 v4, s[76:79], s71 offen lds
    s_lshl_b32 s71, s67, 6
    s_add_u32 s71, s71, 0x188000
    s_add_u32 m0, s73, 0xf000
    s_nop 0
    buffer_load_dwordx4 v4, s[76:79], s71 offen lds
    s_load_dwordx2 s[76:77], s[0:1], 80
    s_waitcnt lgkmcnt(0)
    s_and_b32 s77, s77, 0xffff
    s_mov_b32 s78, 0x1c0000
    s_mov_b32 s79, 0x20000
    s_lshl_b32 s71, s67, 6
    s_add_u32 s71, s71, 0x0
    s_add_u32 m0, s73, 0x10000
    s_nop 0
    buffer_load_dwordx4 v4, s[76:79], s71 offen lds
    s_lshl_b32 s71, s67, 6
    s_add_u32 s71, s71, 0x38000
    s_add_u32 m0, s73, 0x11000
    s_nop 0
    buffer_load_dwordx4 v4, s[76:79], s71 offen lds
    s_lshl_b32 s71, s67, 6
    s_add_u32 s71, s71, 0x70000
    s_add_u32 m0, s73, 0x12000
    s_nop 0
    buffer_load_dwordx4 v4, s[76:79], s71 offen lds
    s_lshl_b32 s71, s67, 6
    s_add_u32 s71, s71, 0xa8000
    s_add_u32 m0, s73, 0x13000
    s_nop 0
    buffer_load_dwordx4 v4, s[76:79], s71 offen lds
    s_lshl_b32 s71, s67, 6
    s_add_u32 s71, s71, 0xe0000
    s_add_u32 m0, s73, 0x14000
    s_nop 0
    buffer_load_dwordx4 v4, s[76:79], s71 offen lds
    s_lshl_b32 s71, s67, 6
    s_add_u32 s71, s71, 0x118000
    s_add_u32 m0, s73, 0x15000
    s_nop 0
    buffer_load_dwordx4 v4, s[76:79], s71 offen lds
    s_lshl_b32 s71, s67, 6
    s_add_u32 s71, s71, 0x150000
    s_add_u32 m0, s73, 0x16000
    s_nop 0
    buffer_load_dwordx4 v4, s[76:79], s71 offen lds
    s_lshl_b32 s71, s67, 6
    s_add_u32 s71, s71, 0x188000
    s_add_u32 m0, s73, 0x17000
    s_nop 0
    buffer_load_dwordx4 v4, s[76:79], s71 offen lds
    s_load_dwordx2 s[76:77], s[0:1], 88
    s_waitcnt lgkmcnt(0)
    s_and_b32 s77, s77, 0xffff
    s_mov_b32 s78, 0x1c0000
    s_mov_b32 s79, 0x20000
    v_lshlrev_b32 v5, 4, v1
    v_add_u32 v5, s73, v5
    s_lshl_b32 s71, s67, 15
    s_add_u32 s71, s71, 0
    s_add_u32 m0, s73, 0x18000
    s_nop 0
    buffer_load_dwordx4 v5, s[76:79], s71 offen lds
    s_lshl_b32 s71, s67, 15
    s_add_u32 s71, s71, 4096
    s_add_u32 m0, s73, 0x19000
    s_nop 0
    buffer_load_dwordx4 v5, s[76:79], s71 offen lds
    s_lshl_b32 s71, s67, 15
    s_add_u32 s71, s71, 8192
    s_add_u32 m0, s73, 0x1a000
    s_nop 0
    buffer_load_dwordx4 v5, s[76:79], s71 offen lds
    s_lshl_b32 s71, s67, 15
    s_add_u32 s71, s71, 12288
    s_add_u32 m0, s73, 0x1b000
    s_nop 0
    buffer_load_dwordx4 v5, s[76:79], s71 offen lds
    s_lshl_b32 s71, s67, 15
    s_add_u32 s71, s71, 16384
    s_add_u32 m0, s73, 0x1c000
    s_nop 0
    buffer_load_dwordx4 v5, s[76:79], s71 offen lds
    s_lshl_b32 s71, s67, 15
    s_add_u32 s71, s71, 20480
    s_add_u32 m0, s73, 0x1d000
    s_nop 0
    buffer_load_dwordx4 v5, s[76:79], s71 offen lds
    s_lshl_b32 s71, s67, 15
    s_add_u32 s71, s71, 24576
    s_add_u32 m0, s73, 0x1e000
    s_nop 0
    buffer_load_dwordx4 v5, s[76:79], s71 offen lds
    s_lshl_b32 s71, s67, 15
    s_add_u32 s71, s71, 28672
    s_add_u32 m0, s73, 0x1f000
    s_nop 0
    buffer_load_dwordx4 v5, s[76:79], s71 offen lds
L_nostage_104:
    v_lshrrev_b32 v246, 2, v240
    s_lshl_b32 s24, s20, 7
    s_add_u32 s24, s24, 0x2000
    s_cmp_lg_u32 s100, 0
    s_cbranch_scc1 L_polls_107
    s_mov_b32 exec_lo, 0xffffffff
    s_mov_b32 exec_hi, 0
    s_mov_b32 s96, 0
L_poll_105:
    buffer_load_dword v247, v246, s[8:11], s24 offen sc1
    s_waitcnt vmcnt(0)
    v_cmp_gt_u32 vcc, 1, v247
    s_cbranch_vccz L_polld_106
    s_sleep 32
    s_add_u32 s96, s96, 1
    s_cmp_lt_u32 s96, 0x10000
    s_cbranch_scc1 L_poll_105
L_polld_106:
    s_mov_b64 exec, -1
L_polls_107:
    s_barrier
    s_lshl_b32 s24, s20, 7
    s_add_u32 s24, s24, 0x2800
    s_cmp_lg_u32 s100, 0
    s_cbranch_scc1 L_polls_110
    s_mov_b32 exec_lo, 0xffffffff
    s_mov_b32 exec_hi, 0
    s_mov_b32 s96, 0
L_poll_108:
    buffer_load_dword v247, v246, s[8:11], s24 offen sc1
    s_waitcnt vmcnt(0)
    v_cmp_gt_u32 vcc, 1, v247
    s_cbranch_vccz L_polld_109
    s_sleep 32
    s_add_u32 s96, s96, 1
    s_cmp_lt_u32 s96, 0x10000
    s_cbranch_scc1 L_poll_108
L_polld_109:
    s_mov_b64 exec, -1
L_polls_110:
    s_barrier
    s_lshl_b32 s24, s20, 7
    s_add_u32 s24, s24, 0x3000
    s_cmp_lg_u32 s100, 0
    s_cbranch_scc1 L_polls_113
    s_mov_b32 exec_lo, 0xffffffff
    s_mov_b32 exec_hi, 0
    s_mov_b32 s96, 0
L_poll_111:
    buffer_load_dword v247, v246, s[8:11], s24 offen sc1
    s_waitcnt vmcnt(0)
    v_cmp_gt_u32 vcc, 1, v247
    s_cbranch_vccz L_polld_112
    s_sleep 32
    s_add_u32 s96, s96, 1
    s_cmp_lt_u32 s96, 0x10000
    s_cbranch_scc1 L_poll_111
L_polld_112:
    s_mov_b64 exec, -1
L_polls_113:
    s_barrier
    s_mov_b32 s80, 0
L_p2_seg:
    s_cmp_ge_u32 s22, 64
    s_cbranch_scc1 L_p2_end
    v_lshrrev_b32 v246, 2, v240
    s_lshl_b32 s24, s20, 7
    s_add_u32 s24, s24, 0x1000
    s_mul_i32 s25, s22, 10
    s_lshr_b32 s25, s25, 4
    s_add_u32 s25, s25, 17
    s_cmp_lg_u32 s100, 0
    s_cbranch_scc1 L_polls_116
    s_mov_b32 exec_lo, 0x1
    s_mov_b32 exec_hi, 0
    s_mov_b32 s96, 0
L_poll_114:
    buffer_load_dword v247, v246, s[8:11], s24 offen sc1
    s_waitcnt vmcnt(0)
    v_cmp_gt_u32 vcc, s25, v247
    s_cbranch_vccz L_polld_115
    v_readfirstlane_b32 s97, v247
    s_nop 0
    s_sub_u32 s97, s25, s97
    s_cmp_lt_i32 s97, 3
    s_cbranch_scc1 L_near_117
    s_sleep 40
    s_cmp_lt_i32 s97, 5
    s_cbranch_scc1 L_near_117
    s_sleep 100
L_near_117:
    s_sleep 8
    s_add_u32 s96, s96, 1
    s_cmp_lt_u32 s96, 0x10000
    s_cbranch_scc1 L_poll_114
L_polld_115:
    s_mov_b64 exec, -1
L_polls_116:
    s_barrier
    s_lshl_b32 s24, s22, 5
    s_lshl_b32 s25, s20, 1
    s_add_u32 s24, s24, s25
    s_lshr_b32 s25, s21, 1
    s_add_u32 s24, s24, s25
    s_lshl_b32 s25, s24, 13
    s_add_u32 s47, s25, 0x1000000
    s_add_u32 s54, s47, 4096
    s_add_u32 s48, s25, 0x2000000
    s_add_u32 s55, s48, 4096
    s_and_b32 s26, s21, 1
    s_lshl_b32 s26, s26, 12
    s_add_u32 s46, s25, s26
    s_add_u32 s46, s46, 0x3000000
    s_lshl_b32 s25, s24, 12
    s_add_u32 s49, s25, 0x240000
    s_lshl_b32 s24, s22, 4
    s_add_u32 s24, s24, s20
    s_lshl_b32 s24, s24, 15
    s_add_u32 s51, s24, 0x4000000
    buffer_load_dwordx4 v[0:3], v240, s[8:11], s46 offen
    buffer_load_dwordx4 v[4:7], v240, s[8:11], s46 offen offset:1024
    buffer_load_dwordx4 v[8:11], v240, s[8:11], s46 offen offset:2048
    buffer_load_dwordx4 v[12:15], v240, s[8:11], s46 offen offset:3072
    buffer_load_dwordx4 v[16:19], v240, s[8:11], s47 offen
    buffer_load_dwordx4 v[20:23], v240, s[8:11], s47 offen offset:1024
    buffer_load_dwordx4 v[24:27], v240, s[8:11], s47 offen offset:2048
    buffer_load_dwordx4 v[28:31], v240, s[8:11], s47 offen offset:3072
    buffer_load_dwordx4 v[32:35], v240, s[8:11], s54 offen
    buffer_load_dwordx4 v[36:39], v240, s[8:11], s54 offen offset:1024
    buffer_load_dwordx4 v[40:43], v240, s[8:11], s54 offen offset:2048
    buffer_load_dwordx4 v[44:47], v240, s[8:11], s54 offen offset:3072
    buffer_load_dwordx4 v[64:67], v240, s[8:11], s48 offen
    buffer_load_dwordx4 v[68:71], v240, s[8:11], s48 offen offset:1024
    buffer_load_dwordx4 v[72:75], v240, s[8:11], s48 offen offset:2048
    buffer_load_dwordx4 v[76:79], v240, s[8:11], s48 offen offset:3072
    buffer_load_dwordx4 v[80:83], v240, s[8:11], s55 offen
    buffer_load_dwordx4 v[84:87], v240, s[8:11], s55 offen offset:1024
    buffer_load_dwordx4 v[88:91], v240, s[8:11], s55 offen offset:2048
    buffer_load_dwordx4 v[92:95], v240, s[8:11], s55 offen offset:3072
    s_waitcnt vmcnt(8)
    v_mfma_f32_16x16x32_bf16 v[116:119], v[16:19], v[0:3], 0
    v_mfma_f32_16x16x32_bf16 v[116:119], v[20:23], v[4:7], v[116:119]
    v_mfma_f32_16x16x32_bf16 v[116:119], v[24:27], v[8:11], v[116:119]
    v_mfma_f32_16x16x32_bf16 v[116:119], v[28:31], v[12:15], v[116:119]
    v_mfma_f32_16x16x32_bf16 v[120:123], v[32:35], v[0:3], 0
    v_mfma_f32_16x16x32_bf16 v[120:123], v[36:39], v[4:7], v[120:123]
    v_mfma_f32_16x16x32_bf16 v[120:123], v[40:43], v[8:11], v[120:123]
    v_mfma_f32_16x16x32_bf16 v[120:123], v[44:47], v[12:15], v[120:123]
    v_mov_b32 v247, s53
    v_cndmask_b32 v116, v247, v116, s[30:31]
    v_cndmask_b32 v117, v247, v117, s[32:33]
    v_cndmask_b32 v118, v247, v118, s[34:35]
    v_cndmask_b32 v119, v247, v119, s[36:37]
    s_nop 2
    v_cndmask_b32 v120, v247, v120, s[38:39]
    v_cndmask_b32 v121, v247, v121, s[40:41]
    v_cndmask_b32 v122, v247, v122, s[42:43]
    v_cndmask_b32 v123, v247, v123, s[44:45]
    v_max3_f32 v251, v116, v117, v118
    v_max3_f32 v251, v251, v119, v120
    v_max3_f32 v251, v251, v121, v122
    v_lshrrev_b32 v246, 2, v240
    s_lshl_b32 s24, s20, 7
    s_add_u32 s24, s24, 0x1000
    s_add_u32 s25, s22, 1
    s_nop 1
    s_cmp_lg_u32 s100, 0
    s_cbranch_scc1 L_polls_120
    s_mov_b32 exec_lo, 0x11
    s_mov_b32 exec_hi, 0
    s_mov_b32 s96, 0
L_poll_118:
    buffer_load_dword v247, v246, s[8:11], s24 offen sc1
    s_waitcnt vmcnt(0)
    v_cmp_gt_u32 vcc, s25, v247
    s_cbranch_vccz L_polld_119
    v_readfirstlane_b32 s97, v247
    s_nop 0
    s_sub_u32 s97, s25, s97
    s_cmp_lt_i32 s97, 3
    s_cbranch_scc1 L_near_121
    s_sleep 40
    s_cmp_lt_i32 s97, 5
    s_cbranch_scc1 L_near_121
    s_sleep 100
L_near_121:
    s_sleep 8
    s_add_u32 s96, s96, 1
    s_cmp_lt_u32 s96, 0x10000
    s_cbranch_scc1 L_poll_118
L_polld_119:
    s_mov_b64 exec, -1
L_polls_120:
    s_barrier
    buffer_load_dwordx4 v[172:175], v240, s[8:11], s49 offen
    buffer_load_dwordx4 v[176:179], v240, s[8:11], s49 offen offset:1024
    buffer_load_dwordx4 v[180:183], v240, s[8:11], s49 offen offset:2048
    buffer_load_dwordx4 v[184:187], v240, s[8:11], s49 offen offset:3072
    s_waitcnt vmcnt(0)
    ds_write_b32 v253, v173
    ds_write_b32 v253, v175 offset:64
    ds_write_b32 v253, v177 offset:1024
    ds_write_b32 v253, v179 offset:1088
    ds_write_b32 v253, v181 offset:2048
    ds_write_b32 v253, v183 offset:2112
    ds_write_b32 v253, v185 offset:3072
    ds_write_b32 v253, v187 offset:3136
    ds_read_b128 v[48:51], v254
    ds_read_b128 v[52:55], v254 offset:1024
    ds_read_b128 v[56:59], v254 offset:2048
    ds_read_b128 v[60:63], v254 offset:3072
    s_waitcnt lgkmcnt(0)
    v_mfma_f32_16x16x32_bf16 v[112:115], v[48:51], v[0:3], 0
    v_mfma_f32_16x16x32_bf16 v[112:115], v[52:55], v[4:7], v[112:115]
    v_mfma_f32_16x16x32_bf16 v[112:115], v[56:59], v[8:11], v[112:115]
    v_mfma_f32_16x16x32_bf16 v[112:115], v[60:63], v[12:15], v[112:115]
    v_mov_b32 v246, v251
    s_nop 6
    v_max3_f32 v246, v246, v123, v112
    v_max_f32 v246, v246, v113
    v_mov_b32 v247, v246
    s_nop 1
    v_permlane32_swap_b32 v247, v246
    v_max_f32 v246, v247, v246
    v_mov_b32 v247, v246
    s_nop 1
    v_permlane16_swap_b32 v247, v246
    v_max_f32 v246, v247, v246
    v_mul_f32 v248, s28, v246
    v_pk_fma_f32 v[116:117], v[116:117], s[28:29], v[248:249] op_sel_hi:[1,1,0] neg_lo:[0,0,1] neg_hi:[0,0,1]
    v_pk_fma_f32 v[118:119], v[118:119], s[28:29], v[248:249] op_sel_hi:[1,1,0] neg_lo:[0,0,1] neg_hi:[0,0,1]
    v_pk_fma_f32 v[120:121], v[120:121], s[28:29], v[248:249] op_sel_hi:[1,1,0] neg_lo:[0,0,1] neg_hi:[0,0,1]
    v_pk_fma_f32 v[122:123], v[122:123], s[28:29], v[248:249] op_sel_hi:[1,1,0] neg_lo:[0,0,1] neg_hi:[0,0,1]
    v_pk_fma_f32 v[112:113], v[112:113], s[28:29], v[248:249] op_sel_hi:[1,1,0] neg_lo:[0,0,1] neg_hi:[0,0,1]
    v_exp_f32 v116, v116
    v_exp_f32 v117, v117
    v_exp_f32 v118, v118
    v_exp_f32 v119, v119
    v_exp_f32 v120, v120
    v_exp_f32 v121, v121
    v_exp_f32 v122, v122
    v_exp_f32 v123, v123
    v_exp_f32 v112, v112
    v_exp_f32 v113, v113
    v_cvt_pk_bf16_f32 v124, v116, v117
    v_cvt_pk_bf16_f32 v125, v118, v119
    v_cvt_pk_bf16_f32 v126, v120, v121
    v_cvt_pk_bf16_f32 v127, v122, v123
    v_cvt_pk_bf16_f32 v128, v112, v113
    v_mov_b32 v129, 0
    v_mfma_f32_16x16x32_bf16 v[132:135], v[136:139], v[124:127], 0
    v_mfma_f32_16x16x32_bf16 v[140:143], v[64:67], v[124:127], 0
    v_mfma_f32_16x16x32_bf16 v[144:147], v[68:71], v[124:127], 0
    v_mfma_f32_16x16x32_bf16 v[148:151], v[72:75], v[124:127], 0
    v_mfma_f32_16x16x32_bf16 v[152:155], v[76:79], v[124:127], 0
    v_mfma_f32_16x16x32_bf16 v[156:159], v[80:83], v[124:127], 0
    v_mfma_f32_16x16x32_bf16 v[160:163], v[84:87], v[124:127], 0
    v_mfma_f32_16x16x32_bf16 v[164:167], v[88:91], v[124:127], 0
    v_mfma_f32_16x16x32_bf16 v[168:171], v[92:95], v[124:127], 0
    v_mfma_f32_16x16x16_bf16 v[132:135], v[136:137], v[128:129], v[132:135]
    v_mfma_f32_16x16x16_bf16 v[140:143], v[172:173], v[128:129], v[140:143]
    v_mfma_f32_16x16x16_bf16 v[144:147], v[174:175], v[128:129], v[144:147]
    v_mfma_f32_16x16x16_bf16 v[148:151], v[176:177], v[128:129], v[148:151]
    v_mfma_f32_16x16x16_bf16 v[152:155], v[178:179], v[128:129], v[152:155]
    v_mfma_f32_16x16x16_bf16 v[156:159], v[180:181], v[128:129], v[156:159]
    v_mfma_f32_16x16x16_bf16 v[160:163], v[182:183], v[128:129], v[160:163]
    v_mfma_f32_16x16x16_bf16 v[164:167], v[184:185], v[128:129], v[164:167]
    v_mfma_f32_16x16x16_bf16 v[168:171], v[186:187], v[128:129], v[168:171]
    v_rcp_f32 v250, v132
    s_nop 0
    v_pk_mul_f32 v[140:141], v[140:141], v[250:251] op_sel_hi:[1,0]
    v_pk_mul_f32 v[142:143], v[142:143], v[250:251] op_sel_hi:[1,0]
    v_pk_mul_f32 v[144:145], v[144:145], v[250:251] op_sel_hi:[1,0]
    v_pk_mul_f32 v[146:147], v[146:147], v[250:251] op_sel_hi:[1,0]
    v_pk_mul_f32 v[148:149], v[148:149], v[250:251] op_sel_hi:[1,0]
    v_pk_mul_f32 v[150:151], v[150:151], v[250:251] op_sel_hi:[1,0]
    v_pk_mul_f32 v[152:153], v[152:153], v[250:251] op_sel_hi:[1,0]
    v_pk_mul_f32 v[154:155], v[154:155], v[250:251] op_sel_hi:[1,0]
    v_pk_mul_f32 v[156:157], v[156:157], v[250:251] op_sel_hi:[1,0]
    v_pk_mul_f32 v[158:159], v[158:159], v[250:251] op_sel_hi:[1,0]
    v_pk_mul_f32 v[160:161], v[160:161], v[250:251] op_sel_hi:[1,0]
    v_pk_mul_f32 v[162:163], v[162:163], v[250:251] op_sel_hi:[1,0]
    v_pk_mul_f32 v[164:165], v[164:165], v[250:251] op_sel_hi:[1,0]
    v_pk_mul_f32 v[166:167], v[166:167], v[250:251] op_sel_hi:[1,0]
    v_pk_mul_f32 v[168:169], v[168:169], v[250:251] op_sel_hi:[1,0]
    v_pk_mul_f32 v[170:171], v[170:171], v[250:251] op_sel_hi:[1,0]
    v_cvt_pk_bf16_f32 v140, v140, v141
    v_cvt_pk_bf16_f32 v141, v142, v143
    v_cvt_pk_bf16_f32 v142, v144, v145
    v_cvt_pk_bf16_f32 v143, v146, v147
    v_cvt_pk_bf16_f32 v144, v148, v149
    v_cvt_pk_bf16_f32 v145, v150, v151
    v_cvt_pk_bf16_f32 v146, v152, v153
    v_cvt_pk_bf16_f32 v147, v154, v155
    v_cvt_pk_bf16_f32 v148, v156, v157
    v_cvt_pk_bf16_f32 v149, v158, v159
    v_cvt_pk_bf16_f32 v150, v160, v161
    v_cvt_pk_bf16_f32 v151, v162, v163
    v_cvt_pk_bf16_f32 v152, v164, v165
    v_cvt_pk_bf16_f32 v153, v166, v167
    v_cvt_pk_bf16_f32 v154, v168, v169
    v_cvt_pk_bf16_f32 v155, v170, v171
    ds_write_b128 v243, v[140:143]
    ds_write_b128 v243, v[144:147] offset:1024
    ds_write_b128 v243, v[148:151] offset:2048
    ds_write_b128 v243, v[152:155] offset:3072
    s_waitcnt lgkmcnt(0)
    s_barrier
    ds_read_b128 v[0:3], v244
    ds_read_b128 v[4:7], v244 offset:1024
    ds_read_b128 v[8:11], v244 offset:2048
    ds_read_b128 v[12:15], v244 offset:3072
    ds_read_b128 v[16:19], v244 offset:4096
    ds_read_b128 v[20:23], v244 offset:5120
    ds_read_b128 v[24:27], v244 offset:6144
    ds_read_b128 v[28:31], v244 offset:7168
    s_waitcnt lgkmcnt(4)
    ds_read_b128 v[32:35], v244 offset:8192
    ds_read_b128 v[36:39], v244 offset:9216
    ds_read_b128 v[40:43], v244 offset:10240
    ds_read_b128 v[44:47], v244 offset:11264
    ds_read_b128 v[48:51], v244 offset:12288
    ds_read_b128 v[52:55], v244 offset:13312
    ds_read_b128 v[56:59], v244 offset:14336
    ds_read_b128 v[60:63], v244 offset:15360
    v_xor_b32 v243, 0x4000, v243
    v_xor_b32 v244, 0x4000, v244
    s_waitcnt lgkmcnt(0)
    v_mfma_f32_16x16x32_bf16 v[172:175], a[0:3], v[0:3], 0
    v_mfma_f32_16x16x32_bf16 v[176:179], a[4:7], v[0:3], 0
    v_mfma_f32_16x16x32_bf16 v[180:183], a[8:11], v[0:3], 0
    v_mfma_f32_16x16x32_bf16 v[184:187], a[12:15], v[0:3], 0
    v_mfma_f32_16x16x32_bf16 v[188:191], a[16:19], v[0:3], 0
    v_mfma_f32_16x16x32_bf16 v[192:195], a[20:23], v[0:3], 0
    v_mfma_f32_16x16x32_bf16 v[196:199], a[24:27], v[0:3], 0
    v_mfma_f32_16x16x32_bf16 v[200:203], a[28:31], v[0:3], 0
    v_mfma_f32_16x16x32_bf16 v[172:175], a[32:35], v[4:7], v[172:175]
    v_mfma_f32_16x16x32_bf16 v[176:179], a[36:39], v[4:7], v[176:179]
    v_mfma_f32_16x16x32_bf16 v[180:183], a[40:43], v[4:7], v[180:183]
    v_mfma_f32_16x16x32_bf16 v[184:187], a[44:47], v[4:7], v[184:187]
    v_mfma_f32_16x16x32_bf16 v[188:191], a[48:51], v[4:7], v[188:191]
    v_mfma_f32_16x16x32_bf16 v[192:195], a[52:55], v[4:7], v[192:195]
    v_mfma_f32_16x16x32_bf16 v[196:199], a[56:59], v[4:7], v[196:199]
    v_mfma_f32_16x16x32_bf16 v[200:203], a[60:63], v[4:7], v[200:203]
    v_mfma_f32_16x16x32_bf16 v[172:175], a[64:67], v[8:11], v[172:175]
    v_mfma_f32_16x16x32_bf16 v[176:179], a[68:71], v[8:11], v[176:179]
    v_mfma_f32_16x16x32_bf16 v[180:183], a[72:75], v[8:11], v[180:183]
    v_mfma_f32_16x16x32_bf16 v[184:187], a[76:79], v[8:11], v[184:187]
    v_mfma_f32_16x16x32_bf16 v[188:191], a[80:83], v[8:11], v[188:191]
    v_mfma_f32_16x16x32_bf16 v[192:195], a[84:87], v[8:11], v[192:195]
    v_mfma_f32_16x16x32_bf16 v[196:199], a[88:91], v[8:11], v[196:199]
    v_mfma_f32_16x16x32_bf16 v[200:203], a[92:95], v[8:11], v[200:203]
    v_mfma_f32_16x16x32_bf16 v[172:175], a[96:99], v[12:15], v[172:175]
    v_mfma_f32_16x16x32_bf16 v[176:179], a[100:103], v[12:15], v[176:179]
    v_mfma_f32_16x16x32_bf16 v[180:183], a[104:107], v[12:15], v[180:183]
    v_mfma_f32_16x16x32_bf16 v[184:187], a[108:111], v[12:15], v[184:187]
    v_mfma_f32_16x16x32_bf16 v[188:191], a[112:115], v[12:15], v[188:191]
    v_mfma_f32_16x16x32_bf16 v[192:195], a[116:119], v[12:15], v[192:195]
    v_mfma_f32_16x16x32_bf16 v[196:199], a[120:123], v[12:15], v[196:199]
    v_mfma_f32_16x16x32_bf16 v[200:203], a[124:127], v[12:15], v[200:203]
    v_mfma_f32_16x16x32_bf16 v[172:175], a[128:131], v[32:35], v[172:175]
    v_mfma_f32_16x16x32_bf16 v[176:179], a[132:135], v[32:35], v[176:179]
    v_mfma_f32_16x16x32_bf16 v[180:183], a[136:139], v[32:35], v[180:183]
    v_mfma_f32_16x16x32_bf16 v[184:187], a[140:143], v[32:35], v[184:187]
    v_mfma_f32_16x16x32_bf16 v[188:191], a[144:147], v[32:35], v[188:191]
    v_mfma_f32_16x16x32_bf16 v[192:195], a[148:151], v[32:35], v[192:195]
    v_mfma_f32_16x16x32_bf16 v[196:199], a[152:155], v[32:35], v[196:199]
    v_mfma_f32_16x16x32_bf16 v[200:203], a[156:159], v[32:35], v[200:203]
    v_mfma_f32_16x16x32_bf16 v[172:175], a[160:163], v[36:39], v[172:175]
    v_mfma_f32_16x16x32_bf16 v[176:179], a[164:167], v[36:39], v[176:179]
    v_mfma_f32_16x16x32_bf16 v[180:183], a[168:171], v[36:39], v[180:183]
    v_mfma_f32_16x16x32_bf16 v[184:187], a[172:175], v[36:39], v[184:187]
    v_mfma_f32_16x16x32_bf16 v[188:191], a[176:179], v[36:39], v[188:191]
    v_mfma_f32_16x16x32_bf16 v[192:195], a[180:183], v[36:39], v[192:195]
    v_mfma_f32_16x16x32_bf16 v[196:199], a[184:187], v[36:39], v[196:199]
    v_mfma_f32_16x16x32_bf16 v[200:203], a[188:191], v[36:39], v[200:203]
    v_mfma_f32_16x16x32_bf16 v[172:175], a[192:195], v[40:43], v[172:175]
    v_mfma_f32_16x16x32_bf16 v[176:179], a[196:199], v[40:43], v[176:179]
    v_mfma_f32_16x16x32_bf16 v[180:183], a[200:203], v[40:43], v[180:183]
    v_mfma_f32_16x16x32_bf16 v[184:187], a[204:207], v[40:43], v[184:187]
    v_mfma_f32_16x16x32_bf16 v[188:191], a[208:211], v[40:43], v[188:191]
    v_mfma_f32_16x16x32_bf16 v[192:195], a[212:215], v[40:43], v[192:195]
    v_mfma_f32_16x16x32_bf16 v[196:199], a[216:219], v[40:43], v[196:199]
    v_mfma_f32_16x16x32_bf16 v[200:203], a[220:223], v[40:43], v[200:203]
    v_mfma_f32_16x16x32_bf16 v[172:175], a[224:227], v[44:47], v[172:175]
    v_mfma_f32_16x16x32_bf16 v[176:179], a[228:231], v[44:47], v[176:179]
    v_mfma_f32_16x16x32_bf16 v[180:183], a[232:235], v[44:47], v[180:183]
    v_mfma_f32_16x16x32_bf16 v[184:187], a[236:239], v[44:47], v[184:187]
    v_mfma_f32_16x16x32_bf16 v[188:191], a[240:243], v[44:47], v[188:191]
    v_mfma_f32_16x16x32_bf16 v[192:195], a[244:247], v[44:47], v[192:195]
    v_mfma_f32_16x16x32_bf16 v[196:199], a[248:251], v[44:47], v[196:199]
    v_mfma_f32_16x16x32_bf16 v[200:203], a[252:255], v[44:47], v[200:203]
    v_mfma_f32_16x16x32_bf16 v[204:207], a[0:3], v[16:19], 0
    v_mfma_f32_16x16x32_bf16 v[208:211], a[4:7], v[16:19], 0
    v_mfma_f32_16x16x32_bf16 v[212:215], a[8:11], v[16:19], 0
    v_mfma_f32_16x16x32_bf16 v[216:219], a[12:15], v[16:19], 0
    v_mfma_f32_16x16x32_bf16 v[220:223], a[16:19], v[16:19], 0
    v_mfma_f32_16x16x32_bf16 v[224:227], a[20:23], v[16:19], 0
    v_mfma_f32_16x16x32_bf16 v[228:231], a[24:27], v[16:19], 0
    v_mfma_f32_16x16x32_bf16 v[232:235], a[28:31], v[16:19], 0
    v_cvt_pk_bf16_f32 v140, v172, v173
    v_cvt_pk_bf16_f32 v141, v174, v175
    v_cvt_pk_bf16_f32 v142, v176, v177
    v_cvt_pk_bf16_f32 v143, v178, v179
    s_add_u32 s24, s51, 0
    buffer_store_dwordx4 v[140:143], v242, s[8:11], s24 offen sc1
    v_mfma_f32_16x16x32_bf16 v[204:207], a[32:35], v[20:23], v[204:207]
    v_mfma_f32_16x16x32_bf16 v[208:211], a[36:39], v[20:23], v[208:211]
    v_mfma_f32_16x16x32_bf16 v[212:215], a[40:43], v[20:23], v[212:215]
    v_mfma_f32_16x16x32_bf16 v[216:219], a[44:47], v[20:23], v[216:219]
    v_mfma_f32_16x16x32_bf16 v[220:223], a[48:51], v[20:23], v[220:223]
    v_mfma_f32_16x16x32_bf16 v[224:227], a[52:55], v[20:23], v[224:227]
    v_mfma_f32_16x16x32_bf16 v[228:231], a[56:59], v[20:23], v[228:231]
    v_mfma_f32_16x16x32_bf16 v[232:235], a[60:63], v[20:23], v[232:235]
    v_cvt_pk_bf16_f32 v144, v180, v181
    v_cvt_pk_bf16_f32 v145, v182, v183
    v_cvt_pk_bf16_f32 v146, v184, v185
    v_cvt_pk_bf16_f32 v147, v186, v187
    buffer_store_dwordx4 v[144:147], v242, s[8:11], s24 offen offset:64 sc1
    v_mfma_f32_16x16x32_bf16 v[204:207], a[64:67], v[24:27], v[204:207]
    v_mfma_f32_16x16x32_bf16 v[208:211], a[68:71], v[24:27], v[208:211]
    v_mfma_f32_16x16x32_bf16 v[212:215], a[72:75], v[24:27], v[212:215]
    v_mfma_f32_16x16x32_bf16 v[216:219], a[76:79], v[24:27], v[216:219]
    v_mfma_f32_16x16x32_bf16 v[220:223], a[80:83], v[24:27], v[220:223]
    v_mfma_f32_16x16x32_bf16 v[224:227], a[84:87], v[24:27], v[224:227]
    v_mfma_f32_16x16x32_bf16 v[228:231], a[88:91], v[24:27], v[228:231]
    v_mfma_f32_16x16x32_bf16 v[232:235], a[92:95], v[24:27], v[232:235]
    v_cvt_pk_bf16_f32 v148, v188, v189
    v_cvt_pk_bf16_f32 v149, v190, v191
    v_cvt_pk_bf16_f32 v150, v192, v193
    v_cvt_pk_bf16_f32 v151, v194, v195
    buffer_store_dwordx4 v[148:151], v242, s[8:11], s24 offen offset:128 sc1
    v_mfma_f32_16x16x32_bf16 v[204:207], a[96:99], v[28:31], v[204:207]
    v_mfma_f32_16x16x32_bf16 v[208:211], a[100:103], v[28:31], v[208:211]
    v_mfma_f32_16x16x32_bf16 v[212:215], a[104:107], v[28:31], v[212:215]
    v_mfma_f32_16x16x32_bf16 v[216:219], a[108:111], v[28:31], v[216:219]
    v_mfma_f32_16x16x32_bf16 v[220:223], a[112:115], v[28:31], v[220:223]
    v_mfma_f32_16x16x32_bf16 v[224:227], a[116:119], v[28:31], v[224:227]
    v_mfma_f32_16x16x32_bf16 v[228:231], a[120:123], v[28:31], v[228:231]
    v_mfma_f32_16x16x32_bf16 v[232:235], a[124:127], v[28:31], v[232:235]
    v_cvt_pk_bf16_f32 v152, v196, v197
    v_cvt_pk_bf16_f32 v153, v198, v199
    v_cvt_pk_bf16_f32 v154, v200, v201
    v_cvt_pk_bf16_f32 v155, v202, v203
    buffer_store_dwordx4 v[152:155], v242, s[8:11], s24 offen offset:192 sc1
    v_mfma_f32_16x16x32_bf16 v[204:207], a[128:131], v[48:51], v[204:207]
    v_mfma_f32_16x16x32_bf16 v[208:211], a[132:135], v[48:51], v[208:211]
    v_mfma_f32_16x16x32_bf16 v[212:215], a[136:139], v[48:51], v[212:215]
    v_mfma_f32_16x16x32_bf16 v[216:219], a[140:143], v[48:51], v[216:219]
    v_mfma_f32_16x16x32_bf16 v[220:223], a[144:147], v[48:51], v[220:223]
    v_mfma_f32_16x16x32_bf16 v[224:227], a[148:151], v[48:51], v[224:227]
    v_mfma_f32_16x16x32_bf16 v[228:231], a[152:155], v[48:51], v[228:231]
    v_mfma_f32_16x16x32_bf16 v[232:235], a[156:159], v[48:51], v[232:235]
    v_mfma_f32_16x16x32_bf16 v[204:207], a[160:163], v[52:55], v[204:207]
    v_mfma_f32_16x16x32_bf16 v[208:211], a[164:167], v[52:55], v[208:211]
    v_mfma_f32_16x16x32_bf16 v[212:215], a[168:171], v[52:55], v[212:215]
    v_mfma_f32_16x16x32_bf16 v[216:219], a[172:175], v[52:55], v[216:219]
    v_mfma_f32_16x16x32_bf16 v[220:223], a[176:179], v[52:55], v[220:223]
    v_mfma_f32_16x16x32_bf16 v[224:227], a[180:183], v[52:55], v[224:227]
    v_mfma_f32_16x16x32_bf16 v[228:231], a[184:187], v[52:55], v[228:231]
    v_mfma_f32_16x16x32_bf16 v[232:235], a[188:191], v[52:55], v[232:235]
    v_mfma_f32_16x16x32_bf16 v[204:207], a[192:195], v[56:59], v[204:207]
    v_mfma_f32_16x16x32_bf16 v[208:211], a[196:199], v[56:59], v[208:211]
    v_mfma_f32_16x16x32_bf16 v[212:215], a[200:203], v[56:59], v[212:215]
    v_mfma_f32_16x16x32_bf16 v[216:219], a[204:207], v[56:59], v[216:219]
    v_mfma_f32_16x16x32_bf16 v[220:223], a[208:211], v[56:59], v[220:223]
    v_mfma_f32_16x16x32_bf16 v[224:227], a[212:215], v[56:59], v[224:227]
    v_mfma_f32_16x16x32_bf16 v[228:231], a[216:219], v[56:59], v[228:231]
    v_mfma_f32_16x16x32_bf16 v[232:235], a[220:223], v[56:59], v[232:235]
    v_mfma_f32_16x16x32_bf16 v[204:207], a[224:227], v[60:63], v[204:207]
    v_mfma_f32_16x16x32_bf16 v[208:211], a[228:231], v[60:63], v[208:211]
    v_mfma_f32_16x16x32_bf16 v[212:215], a[232:235], v[60:63], v[212:215]
    v_mfma_f32_16x16x32_bf16 v[216:219], a[236:239], v[60:63], v[216:219]
    v_mfma_f32_16x16x32_bf16 v[220:223], a[240:243], v[60:63], v[220:223]
    v_mfma_f32_16x16x32_bf16 v[224:227], a[244:247], v[60:63], v[224:227]
    v_mfma_f32_16x16x32_bf16 v[228:231], a[248:251], v[60:63], v[228:231]
    v_mfma_f32_16x16x32_bf16 v[232:235], a[252:255], v[60:63], v[232:235]
    v_cvt_pk_bf16_f32 v140, v204, v205
    v_cvt_pk_bf16_f32 v141, v206, v207
    v_cvt_pk_bf16_f32 v142, v208, v209
    v_cvt_pk_bf16_f32 v143, v210, v211
    s_add_u32 s24, s51, 16384
    buffer_store_dwordx4 v[140:143], v242, s[8:11], s24 offen sc1
    v_cvt_pk_bf16_f32 v144, v212, v213
    v_cvt_pk_bf16_f32 v145, v214, v215
    v_cvt_pk_bf16_f32 v146, v216, v217
    v_cvt_pk_bf16_f32 v147, v218, v219
    buffer_store_dwordx4 v[144:147], v242, s[8:11], s24 offen offset:64 sc1
    v_cvt_pk_bf16_f32 v148, v220, v221
    v_cvt_pk_bf16_f32 v149, v222, v223
    v_cvt_pk_bf16_f32 v150, v224, v225
    v_cvt_pk_bf16_f32 v151, v226, v227
    buffer_store_dwordx4 v[148:151], v242, s[8:11], s24 offen offset:128 sc1
    v_cvt_pk_bf16_f32 v152, v228, v229
    v_cvt_pk_bf16_f32 v153, v230, v231
    v_cvt_pk_bf16_f32 v154, v232, v233
    v_cvt_pk_bf16_f32 v155, v234, v235
    buffer_store_dwordx4 v[152:155], v242, s[8:11], s24 offen offset:192 sc1
    s_waitcnt vmcnt(0)
    s_barrier
    s_lshl_b32 s25, s22, 6
    s_add_u32 s25, s25, 0x4000
    s_lshl_b32 s24, s20, 2
    s_add_u32 s24, s24, s25
    s_cmp_lg_u32 s100, 0
    s_cbranch_scc1 L_flag_122
    v_mov_b32 v246, 1
    s_mov_b64 exec, 1
    buffer_store_dword v246, off, s[8:11], s24 sc1
    s_mov_b64 exec, -1
L_flag_122:
    v_lshrrev_b32 v246, 2, v240
    s_cmp_lg_u32 s100, 0
    s_cbranch_scc1 L_polls_125
    s_mov_b32 exec_lo, 0xffff
    s_mov_b32 exec_hi, 0
    s_mov_b32 s96, 0
L_poll_123:
    buffer_load_dword v247, v246, s[8:11], s25 offen sc1
    s_waitcnt vmcnt(0)
    v_cmp_gt_u32 vcc, 1, v247
    s_cbranch_vccz L_polld_124
    s_sleep 2
    s_add_u32 s96, s96, 1
    s_cmp_lt_u32 s96, 0x10000
    s_cbranch_scc1 L_poll_123
L_polld_124:
    s_mov_b64 exec, -1
L_polls_125:
    s_barrier
    s_cmp_ge_u32 s100, 2
    s_cbranch_scc1 L_nofin_126
    s_lshl_b32 s60, s22, 5
    s_lshl_b32 s24, s20, 1
    s_add_u32 s60, s60, s24
    s_add_u32 s60, s60, s100
    s_lshr_b32 s62, s60, 5
    s_lshl_b32 s62, s62, 19
    s_and_b32 s63, s60, 31
    s_lshl_b32 s63, s63, 10
    s_add_u32 s62, s62, s63
    s_add_u32 s62, s62, 0x4000000
    s_lshl_b32 s64, s60, 10
    buffer_load_dwordx2 v[64:65], v252, s[12:15], s64 offen
    buffer_load_dwordx2 v[66:67], v252, s[12:15], s64 offen offset:32
    buffer_load_dwordx4 v[0:3], v240, s[8:11], s62 offen
    s_add_u32 s62, s62, 32768
    buffer_load_dwordx4 v[4:7], v240, s[8:11], s62 offen
    s_add_u32 s62, s62, 32768
    buffer_load_dwordx4 v[8:11], v240, s[8:11], s62 offen
    s_add_u32 s62, s62, 32768
    buffer_load_dwordx4 v[12:15], v240, s[8:11], s62 offen
    s_add_u32 s62, s62, 32768
    buffer_load_dwordx4 v[16:19], v240, s[8:11], s62 offen
    s_add_u32 s62, s62, 32768
    buffer_load_dwordx4 v[20:23], v240, s[8:11], s62 offen
    s_add_u32 s62, s62, 32768
    buffer_load_dwordx4 v[24:27], v240, s[8:11], s62 offen
    s_add_u32 s62, s62, 32768
    buffer_load_dwordx4 v[28:31], v240, s[8:11], s62 offen
    s_add_u32 s62, s62, 32768
    buffer_load_dwordx4 v[32:35], v240, s[8:11], s62 offen
    s_add_u32 s62, s62, 32768
    buffer_load_dwordx4 v[36:39], v240, s[8:11], s62 offen
    s_add_u32 s62, s62, 32768
    buffer_load_dwordx4 v[40:43], v240, s[8:11], s62 offen
    s_add_u32 s62, s62, 32768
    buffer_load_dwordx4 v[44:47], v240, s[8:11], s62 offen
    s_add_u32 s62, s62, 32768
    buffer_load_dwordx4 v[48:51], v240, s[8:11], s62 offen
    s_add_u32 s62, s62, 32768
    buffer_load_dwordx4 v[52:55], v240, s[8:11], s62 offen
    s_add_u32 s62, s62, 32768
    buffer_load_dwordx4 v[56:59], v240, s[8:11], s62 offen
    s_add_u32 s62, s62, 32768
    buffer_load_dwordx4 v[60:63], v240, s[8:11], s62 offen
    v_mov_b32 v68, 0
    v_mov_b32 v69, 0
    v_mov_b32 v70, 0
    v_mov_b32 v71, 0
    v_mov_b32 v72, 0
    v_mov_b32 v73, 0
    v_mov_b32 v74, 0
    v_mov_b32 v75, 0
    s_waitcnt vmcnt(15)
    v_dot2_f32_bf16 v68, v0, s65, v68
    v_dot2_f32_bf16 v69, v0, s66, v69
    v_dot2_f32_bf16 v70, v1, s65, v70
    v_dot2_f32_bf16 v71, v1, s66, v71
    v_dot2_f32_bf16 v72, v2, s65, v72
    v_dot2_f32_bf16 v73, v2, s66, v73
    v_dot2_f32_bf16 v74, v3, s65, v74
    v_dot2_f32_bf16 v75, v3, s66, v75
    s_waitcnt vmcnt(14)
    v_dot2_f32_bf16 v68, v4, s65, v68
    v_dot2_f32_bf16 v69, v4, s66, v69
    v_dot2_f32_bf16 v70, v5, s65, v70
    v_dot2_f32_bf16 v71, v5, s66, v71
    v_dot2_f32_bf16 v72, v6, s65, v72
    v_dot2_f32_bf16 v73, v6, s66, v73
    v_dot2_f32_bf16 v74, v7, s65, v74
    v_dot2_f32_bf16 v75, v7, s66, v75
    s_waitcnt vmcnt(13)
    v_dot2_f32_bf16 v68, v8, s65, v68
    v_dot2_f32_bf16 v69, v8, s66, v69
    v_dot2_f32_bf16 v70, v9, s65, v70
    v_dot2_f32_bf16 v71, v9, s66, v71
    v_dot2_f32_bf16 v72, v10, s65, v72
    v_dot2_f32_bf16 v73, v10, s66, v73
    v_dot2_f32_bf16 v74, v11, s65, v74
    v_dot2_f32_bf16 v75, v11, s66, v75
    s_waitcnt vmcnt(12)
    v_dot2_f32_bf16 v68, v12, s65, v68
    v_dot2_f32_bf16 v69, v12, s66, v69
    v_dot2_f32_bf16 v70, v13, s65, v70
    v_dot2_f32_bf16 v71, v13, s66, v71
    v_dot2_f32_bf16 v72, v14, s65, v72
    v_dot2_f32_bf16 v73, v14, s66, v73
    v_dot2_f32_bf16 v74, v15, s65, v74
    v_dot2_f32_bf16 v75, v15, s66, v75
    s_waitcnt vmcnt(11)
    v_dot2_f32_bf16 v68, v16, s65, v68
    v_dot2_f32_bf16 v69, v16, s66, v69
    v_dot2_f32_bf16 v70, v17, s65, v70
    v_dot2_f32_bf16 v71, v17, s66, v71
    v_dot2_f32_bf16 v72, v18, s65, v72
    v_dot2_f32_bf16 v73, v18, s66, v73
    v_dot2_f32_bf16 v74, v19, s65, v74
    v_dot2_f32_bf16 v75, v19, s66, v75
    s_waitcnt vmcnt(10)
    v_dot2_f32_bf16 v68, v20, s65, v68
    v_dot2_f32_bf16 v69, v20, s66, v69
    v_dot2_f32_bf16 v70, v21, s65, v70
    v_dot2_f32_bf16 v71, v21, s66, v71
    v_dot2_f32_bf16 v72, v22, s65, v72
    v_dot2_f32_bf16 v73, v22, s66, v73
    v_dot2_f32_bf16 v74, v23, s65, v74
    v_dot2_f32_bf16 v75, v23, s66, v75
    s_waitcnt vmcnt(9)
    v_dot2_f32_bf16 v68, v24, s65, v68
    v_dot2_f32_bf16 v69, v24, s66, v69
    v_dot2_f32_bf16 v70, v25, s65, v70
    v_dot2_f32_bf16 v71, v25, s66, v71
    v_dot2_f32_bf16 v72, v26, s65, v72
    v_dot2_f32_bf16 v73, v26, s66, v73
    v_dot2_f32_bf16 v74, v27, s65, v74
    v_dot2_f32_bf16 v75, v27, s66, v75
    s_waitcnt vmcnt(8)
    v_dot2_f32_bf16 v68, v28, s65, v68
    v_dot2_f32_bf16 v69, v28, s66, v69
    v_dot2_f32_bf16 v70, v29, s65, v70
    v_dot2_f32_bf16 v71, v29, s66, v71
    v_dot2_f32_bf16 v72, v30, s65, v72
    v_dot2_f32_bf16 v73, v30, s66, v73
    v_dot2_f32_bf16 v74, v31, s65, v74
    v_dot2_f32_bf16 v75, v31, s66, v75
    s_waitcnt vmcnt(7)
    v_dot2_f32_bf16 v68, v32, s65, v68
    v_dot2_f32_bf16 v69, v32, s66, v69
    v_dot2_f32_bf16 v70, v33, s65, v70
    v_dot2_f32_bf16 v71, v33, s66, v71
    v_dot2_f32_bf16 v72, v34, s65, v72
    v_dot2_f32_bf16 v73, v34, s66, v73
    v_dot2_f32_bf16 v74, v35, s65, v74
    v_dot2_f32_bf16 v75, v35, s66, v75
    s_waitcnt vmcnt(6)
    v_dot2_f32_bf16 v68, v36, s65, v68
    v_dot2_f32_bf16 v69, v36, s66, v69
    v_dot2_f32_bf16 v70, v37, s65, v70
    v_dot2_f32_bf16 v71, v37, s66, v71
    v_dot2_f32_bf16 v72, v38, s65, v72
    v_dot2_f32_bf16 v73, v38, s66, v73
    v_dot2_f32_bf16 v74, v39, s65, v74
    v_dot2_f32_bf16 v75, v39, s66, v75
    s_waitcnt vmcnt(5)
    v_dot2_f32_bf16 v68, v40, s65, v68
    v_dot2_f32_bf16 v69, v40, s66, v69
    v_dot2_f32_bf16 v70, v41, s65, v70
    v_dot2_f32_bf16 v71, v41, s66, v71
    v_dot2_f32_bf16 v72, v42, s65, v72
    v_dot2_f32_bf16 v73, v42, s66, v73
    v_dot2_f32_bf16 v74, v43, s65, v74
    v_dot2_f32_bf16 v75, v43, s66, v75
    s_waitcnt vmcnt(4)
    v_dot2_f32_bf16 v68, v44, s65, v68
    v_dot2_f32_bf16 v69, v44, s66, v69
    v_dot2_f32_bf16 v70, v45, s65, v70
    v_dot2_f32_bf16 v71, v45, s66, v71
    v_dot2_f32_bf16 v72, v46, s65, v72
    v_dot2_f32_bf16 v73, v46, s66, v73
    v_dot2_f32_bf16 v74, v47, s65, v74
    v_dot2_f32_bf16 v75, v47, s66, v75
    s_waitcnt vmcnt(3)
    v_dot2_f32_bf16 v68, v48, s65, v68
    v_dot2_f32_bf16 v69, v48, s66, v69
    v_dot2_f32_bf16 v70, v49, s65, v70
    v_dot2_f32_bf16 v71, v49, s66, v71
    v_dot2_f32_bf16 v72, v50, s65, v72
    v_dot2_f32_bf16 v73, v50, s66, v73
    v_dot2_f32_bf16 v74, v51, s65, v74
    v_dot2_f32_bf16 v75, v51, s66, v75
    s_waitcnt vmcnt(2)
    v_dot2_f32_bf16 v68, v52, s65, v68
    v_dot2_f32_bf16 v69, v52, s66, v69
    v_dot2_f32_bf16 v70, v53, s65, v70
    v_dot2_f32_bf16 v71, v53, s66, v71
    v_dot2_f32_bf16 v72, v54, s65, v72
    v_dot2_f32_bf16 v73, v54, s66, v73
    v_dot2_f32_bf16 v74, v55, s65, v74
    v_dot2_f32_bf16 v75, v55, s66, v75
    s_waitcnt vmcnt(1)
    v_dot2_f32_bf16 v68, v56, s65, v68
    v_dot2_f32_bf16 v69, v56, s66, v69
    v_dot2_f32_bf16 v70, v57, s65, v70
    v_dot2_f32_bf16 v71, v57, s66, v71
    v_dot2_f32_bf16 v72, v58, s65, v72
    v_dot2_f32_bf16 v73, v58, s66, v73
    v_dot2_f32_bf16 v74, v59, s65, v74
    v_dot2_f32_bf16 v75, v59, s66, v75
    s_waitcnt vmcnt(0)
    v_dot2_f32_bf16 v68, v60, s65, v68
    v_dot2_f32_bf16 v69, v60, s66, v69
    v_dot2_f32_bf16 v70, v61, s65, v70
    v_dot2_f32_bf16 v71, v61, s66, v71
    v_dot2_f32_bf16 v72, v62, s65, v72
    v_dot2_f32_bf16 v73, v62, s66, v73
    v_dot2_f32_bf16 v74, v63, s65, v74
    v_dot2_f32_bf16 v75, v63, s66, v75
    v_cvt_pk_bf16_f32 v0, v68, v69
    v_cvt_pk_bf16_f32 v1, v70, v71
    v_cvt_pk_bf16_f32 v2, v72, v73
    v_cvt_pk_bf16_f32 v3, v74, v75
    v_lshlrev_b32 v68, 16, v0
    v_and_b32 v69, 0xffff0000, v0
    v_lshlrev_b32 v76, 16, v64
    v_and_b32 v77, 0xffff0000, v64
    v_lshlrev_b32 v70, 16, v1
    v_and_b32 v71, 0xffff0000, v1
    v_lshlrev_b32 v78, 16, v65
    v_and_b32 v79, 0xffff0000, v65
    v_lshlrev_b32 v72, 16, v2
    v_and_b32 v73, 0xffff0000, v2
    v_lshlrev_b32 v80, 16, v66
    v_and_b32 v81, 0xffff0000, v66
    v_lshlrev_b32 v74, 16, v3
    v_and_b32 v75, 0xffff0000, v3
    v_lshlrev_b32 v82, 16, v67
    v_and_b32 v83, 0xffff0000, v67
    v_pk_add_f32 v[68:69], v[68:69], v[76:77]
    v_pk_add_f32 v[70:71], v[70:71], v[78:79]
    v_pk_add_f32 v[72:73], v[72:73], v[80:81]
    v_pk_add_f32 v[74:75], v[74:75], v[82:83]
    v_cvt_pk_bf16_f32 v4, v68, v69
    v_cvt_pk_bf16_f32 v5, v70, v71
    v_cvt_pk_bf16_f32 v6, v72, v73
    v_cvt_pk_bf16_f32 v7, v74, v75
    v_lshlrev_b32 v68, 16, v4
    v_and_b32 v69, 0xffff0000, v4
    v_lshlrev_b32 v70, 16, v5
    v_and_b32 v71, 0xffff0000, v5
    v_lshlrev_b32 v72, 16, v6
    v_and_b32 v73, 0xffff0000, v6
    v_lshlrev_b32 v74, 16, v7
    v_and_b32 v75, 0xffff0000, v7
    s_add_u32 s62, s64, 0x6000000
    buffer_store_dwordx2 v[4:5], v252, s[8:11], s62 offen sc1
    buffer_store_dwordx2 v[6:7], v252, s[8:11], s62 offen offset:32 sc1
    v_add_f32 v84, v68, v69
    v_add_f32 v84, v84, v70
    v_add_f32 v84, v84, v71
    v_add_f32 v84, v84, v72
    v_add_f32 v84, v84, v73
    v_add_f32 v84, v84, v74
    v_add_f32 v84, v84, v75
    s_nop 1
    v_add_f32_dpp v84, v84, v84 row_ror:1 row_mask:0xf bank_mask:0xf
    s_nop 1
    v_add_f32_dpp v84, v84, v84 row_ror:2 row_mask:0xf bank_mask:0xf
    s_nop 1
    v_add_f32_dpp v84, v84, v84 row_ror:4 row_mask:0xf bank_mask:0xf
    s_nop 1
    v_add_f32_dpp v84, v84, v84 row_ror:8 row_mask:0xf bank_mask:0xf
    v_mov_b32 v85, v84
    s_nop 1
    v_permlane32_swap_b32 v85, v84
    v_add_f32 v84, v85, v84
    v_mov_b32 v85, v84
    s_nop 1
    v_permlane16_swap_b32 v85, v84
    v_add_f32 v84, v85, v84
    v_mul_f32 v84, 0x3b000000, v84
    v_cvt_pk_bf16_f32 v86, v84, v84
    v_and_b32 v86, 0xffff0000, v86
    v_sub_f32 v87, v84, v86
    v_sub_f32 v76, v68, v86
    v_sub_f32 v77, v69, v86
    v_sub_f32 v78, v70, v86
    v_sub_f32 v79, v71, v86
    v_sub_f32 v80, v72, v86
    v_sub_f32 v81, v73, v86
    v_sub_f32 v82, v74, v86
    v_sub_f32 v83, v75, v86
    v_mul_f32 v100, v76, v76
    v_fmac_f32 v100, v77, v77
    v_fmac_f32 v100, v78, v78
    v_fmac_f32 v100, v79, v79
    v_fmac_f32 v100, v80, v80
    v_fmac_f32 v100, v81, v81
    v_fmac_f32 v100, v82, v82
    v_fmac_f32 v100, v83, v83
    s_nop 1
    v_add_f32_dpp v100, v100, v100 row_ror:1 row_mask:0xf bank_mask:0xf
    s_nop 1
    v_add_f32_dpp v100, v100, v100 row_ror:2 row_mask:0xf bank_mask:0xf
    s_nop 1
    v_add_f32_dpp v100, v100, v100 row_ror:4 row_mask:0xf bank_mask:0xf
    s_nop 1
    v_add_f32_dpp v100, v100, v100 row_ror:8 row_mask:0xf bank_mask:0xf
    v_mov_b32 v85, v100
    s_nop 1
    v_permlane32_swap_b32 v85, v100
    v_add_f32 v100, v85, v100
    v_mov_b32 v85, v100
    s_nop 1
    v_permlane16_swap_b32 v85, v100
    v_add_f32 v100, v85, v100
    v_mul_f32 v85, v87, v87
    v_mul_f32 v100, 0x3b000000, v100
    v_sub_f32 v100, v100, v85
    v_max_f32 v100, 0, v100
    v_cvt_pk_bf16_f32 v100, v100, v100
    v_and_b32 v100, 0xffff0000, v100
    v_add_f32 v100, 0x3727c5ac, v100
    v_cvt_pk_bf16_f32 v100, v100, v100
    v_and_b32 v100, 0xffff0000, v100
    v_sqrt_f32 v100, v100
    s_nop 0
    v_cvt_pk_bf16_f32 v100, v100, v100
    v_and_b32 v100, 0xffff0000, v100
    v_rcp_f32 v100, v100
    v_cvt_pk_bf16_f32 v8, v76, v77
    v_cvt_pk_bf16_f32 v9, v78, v79
    v_cvt_pk_bf16_f32 v10, v80, v81
    v_cvt_pk_bf16_f32 v11, v82, v83
    v_lshlrev_b32 v76, 16, v8
    v_and_b32 v77, 0xffff0000, v8
    v_lshlrev_b32 v78, 16, v9
    v_and_b32 v79, 0xffff0000, v9
    v_lshlrev_b32 v80, 16, v10
    v_and_b32 v81, 0xffff0000, v10
    v_lshlrev_b32 v82, 16, v11
    v_and_b32 v83, 0xffff0000, v11
    v_mul_f32 v76, v100, v76
    v_mul_f32 v77, v100, v77
    v_mul_f32 v78, v100, v78
    v_mul_f32 v79, v100, v79
    v_mul_f32 v80, v100, v80
    v_mul_f32 v81, v100, v81
    v_mul_f32 v82, v100, v82
    v_mul_f32 v83, v100, v83
    v_cvt_pk_bf16_f32 v8, v76, v77
    v_cvt_pk_bf16_f32 v9, v78, v79
    v_cvt_pk_bf16_f32 v10, v80, v81
    v_cvt_pk_bf16_f32 v11, v82, v83
    v_lshlrev_b32 v76, 16, v8
    v_and_b32 v77, 0xffff0000, v8
    v_lshlrev_b32 v78, 16, v9
    v_and_b32 v79, 0xffff0000, v9
    v_lshlrev_b32 v80, 16, v10
    v_and_b32 v81, 0xffff0000, v10
    v_lshlrev_b32 v82, 16, v11
    v_and_b32 v83, 0xffff0000, v11
    s_add_u32 s62, s64, 0x6200000
    buffer_store_dwordx2 v[8:9], v252, s[8:11], s62 offen sc1
    buffer_store_dwordx2 v[10:11], v252, s[8:11], s62 offen offset:32 sc1
    v_pk_add_f32 v[68:69], v[68:69], v[76:77]
    v_pk_add_f32 v[70:71], v[70:71], v[78:79]
    v_pk_add_f32 v[72:73], v[72:73], v[80:81]
    v_pk_add_f32 v[74:75], v[74:75], v[82:83]
    v_cvt_pk_bf16_f32 v12, v68, v69
    v_cvt_pk_bf16_f32 v13, v70, v71
    v_cvt_pk_bf16_f32 v14, v72, v73
    v_cvt_pk_bf16_f32 v15, v74, v75
    buffer_store_dwordx2 v[12:13], v252, s[16:19], s64 offen sc1
    buffer_store_dwordx2 v[14:15], v252, s[16:19], s64 offen offset:32 sc1
    v_lshlrev_b32 v88, 16, v236
    v_and_b32 v89, 0xffff0000, v236
    v_lshlrev_b32 v90, 16, v237
    v_and_b32 v91, 0xffff0000, v237
    v_lshlrev_b32 v92, 16, v238
    v_and_b32 v93, 0xffff0000, v238
    v_lshlrev_b32 v94, 16, v239
    v_and_b32 v95, 0xffff0000, v239
    v_mul_f32 v84, v76, v88
    v_fmac_f32 v84, v77, v89
    v_fmac_f32 v84, v78, v90
    v_fmac_f32 v84, v79, v91
    v_fmac_f32 v84, v80, v92
    v_fmac_f32 v84, v81, v93
    v_fmac_f32 v84, v82, v94
    v_fmac_f32 v84, v83, v95
    s_nop 1
    v_add_f32_dpp v84, v84, v84 row_ror:1 row_mask:0xf bank_mask:0xf
    s_nop 1
    v_add_f32_dpp v84, v84, v84 row_ror:2 row_mask:0xf bank_mask:0xf
    s_nop 1
    v_add_f32_dpp v84, v84, v84 row_ror:4 row_mask:0xf bank_mask:0xf
    s_nop 1
    v_add_f32_dpp v84, v84, v84 row_ror:8 row_mask:0xf bank_mask:0xf
    v_mov_b32 v85, v84
    s_nop 1
    v_permlane32_swap_b32 v85, v84
    v_add_f32 v84, v85, v84
    v_mov_b32 v85, v84
    s_nop 1
    v_permlane16_swap_b32 v85, v84
    v_add_f32 v84, v85, v84
    v_cvt_pk_bf16_f32 v84, v84, v84
    v_and_b32 v84, 0xffff0000, v84
    v_ashrrev_i32 v85, 31, v84
    v_or_b32 v85, 0x80000000, v85
    v_xor_b32 v84, v84, v85
    v_and_b32 v84, 0xffff0000, v84
    s_sub_u32 s62, 0x87ff, s60
    v_or_b32 v84, s62, v84
    s_waitcnt vmcnt(0)
    s_lshl_b32 s62, s60, 2
    s_add_u32 s62, s62, 0x6000
    s_mov_b64 exec, 1
    buffer_store_dword v84, off, s[8:11], s62 sc1
    s_mov_b64 exec, -1
L_nofin_126:
    s_add_u32 s80, s80, 4
    s_add_u32 s22, s22, s23
    s_branch L_p2_seg
L_p2_end:
    s_cmp_ge_u32 s67, 56
    s_cbranch_scc1 L_exit
    s_mov_b32 s74, 0
    s_mov_b32 s75, 0
    v_mov_b32 v202, 0x7ffffff0
    v_mov_b32 v1, 0
    s_and_b32 s71, s101, 15
    s_lshl_b32 s71, s71, 7
    s_add_u32 s71, s71, 0x1000
    s_mov_b32 s72, 61
    s_cmp_lg_u32 s100, 0
    s_cbranch_scc1 L_polls_129
    s_mov_b32 exec_lo, 0x1
    s_mov_b32 exec_hi, 0
    s_mov_b32 s96, 0
L_poll_127:
    buffer_load_dword v2, v1, s[8:11], s71 offen sc1
    s_waitcnt vmcnt(0)
    v_cmp_gt_u32 vcc, s72, v2
    s_cbranch_vccz L_polld_128
    v_readfirstlane_b32 s97, v2
    s_nop 0
    s_sub_u32 s97, s72, s97
    s_cmp_lt_i32 s97, 3
    s_cbranch_scc1 L_near_130
    s_sleep 40
    s_cmp_lt_i32 s97, 5
    s_cbranch_scc1 L_near_130
    s_sleep 100
L_near_130:
    s_sleep 16
    s_add_u32 s96, s96, 1
    s_cmp_lt_u32 s96, 0x10000
    s_cbranch_scc1 L_poll_127
L_polld_128:
    s_mov_b64 exec, -1
L_polls_129:
    s_barrier
L_ffn_round:
    v_mbcnt_lo_u32_b32 v0, -1, 0
    v_mbcnt_hi_u32_b32 v0, -1, v0
    s_lshl_b32 s96, s100, 6
    v_add_u32 v0, s96, v0
    s_cmp_lg_u32 s75, 0
    s_cbranch_scc1 L_ffn_re
    v_lshlrev_b32 v30, 5, v0
    s_mov_b32 s69, 0x6000
    v_cmp_le_u32 vcc, 240, v0
    v_mov_b32 v29, s75
    v_add_u32 v29, -1, v29
    v_cndmask_b32 v19, 0, v29, vcc
    s_mov_b32 s70, 0
L_kpoll_131:
    buffer_load_dwordx4 v[20:23], v30, s[8:11], s69 offen sc1
    buffer_load_dwordx4 v[24:27], v30, s[8:11], s69 offen offset:16 sc1
    s_waitcnt vmcnt(0)
    v_min3_u32 v28, v20, v21, v22
    v_min3_u32 v28, v28, v23, v24
    v_min3_u32 v28, v28, v25, v26
    v_min_u32 v28, v28, v27
    v_or_b32 v28, v28, v19
    v_cmp_eq_u32 vcc, 0, v28
    s_cbranch_vccz L_kpolld_132
    s_sleep 6
    s_add_u32 s70, s70, 1
    s_cmp_lt_u32 s70, 0x10000
    s_cbranch_scc1 L_kpoll_131
L_kpolld_132:
    v_bfi_b32 v20, v19, 0, v20
    v_bfi_b32 v21, v19, 0, v21
    v_bfi_b32 v22, v19, 0, v22
    v_bfi_b32 v23, v19, 0, v23
    v_bfi_b32 v24, v19, 0, v24
    v_bfi_b32 v25, v19, 0, v25
    v_bfi_b32 v26, v19, 0, v26
    v_bfi_b32 v27, v19, 0, v27
    v_lshrrev_b32 v30, 6, v0
    v_lshlrev_b32 v30, 2, v30
    v_add_u32 v30, 0x20400, v30
    v_mov_b32 v31, 0x20400
    s_waitcnt vmcnt(0)
    v_max3_u32 v28, v20, v21, v22
    v_max3_u32 v28, v28, v23, v24
    v_max3_u32 v28, v28, v25, v26
    v_max_u32 v28, v28, v27
    s_nop 1
    v_max_u32_dpp v28, v28, v28 row_ror:1 row_mask:0xf bank_mask:0xf
    s_nop 1
    v_max_u32_dpp v28, v28, v28 row_ror:2 row_mask:0xf bank_mask:0xf
    s_nop 1
    v_max_u32_dpp v28, v28, v28 row_ror:4 row_mask:0xf bank_mask:0xf
    s_nop 1
    v_max_u32_dpp v28, v28, v28 row_ror:8 row_mask:0xf bank_mask:0xf
    v_mov_b32 v29, v28
    s_nop 1
    v_permlane32_swap_b32 v29, v28
    v_max_u32 v28, v29, v28
    v_mov_b32 v29, v28
    s_nop 1
    v_permlane16_swap_b32 v29, v28
    v_max_u32 v28, v29, v28
    ds_write_b32 v30, v28
    s_waitcnt lgkmcnt(0)
    s_barrier
    ds_read_b128 v[16:19], v31
    s_waitcnt lgkmcnt(0)
    v_max3_u32 v28, v16, v17, v18
    v_max_u32 v28, v28, v19
    s_nop 0
    v_readfirstlane_b32 s69, v28
    s_nop 1
    v_cmp_ne_u32 vcc, s69, v20
    s_nop 1
    v_cndmask_b32 v20, 0, v20, vcc
    v_cmp_ne_u32 vcc, s69, v21
    s_nop 1
    v_cndmask_b32 v21, 0, v21, vcc
    v_cmp_ne_u32 vcc, s69, v22
    s_nop 1
    v_cndmask_b32 v22, 0, v22, vcc
    v_cmp_ne_u32 vcc, s69, v23
    s_nop 1
    v_cndmask_b32 v23, 0, v23, vcc
    v_cmp_ne_u32 vcc, s69, v24
    s_nop 1
    v_cndmask_b32 v24, 0, v24, vcc
    v_cmp_ne_u32 vcc, s69, v25
    s_nop 1
    v_cndmask_b32 v25, 0, v25, vcc
    v_cmp_ne_u32 vcc, s69, v26
    s_nop 1
    v_cndmask_b32 v26, 0, v26, vcc
    v_cmp_ne_u32 vcc, s69, v27
    s_nop 1
    v_cndmask_b32 v27, 0, v27, vcc
    v_max3_u32 v28, v20, v21, v22
    v_max3_u32 v28, v28, v23, v24
    v_max3_u32 v28, v28, v25, v26
    v_max_u32 v28, v28, v27
    s_nop 1
    v_max_u32_dpp v28, v28, v28 row_ror:1 row_mask:0xf bank_mask:0xf
    s_nop 1
    v_max_u32_dpp v28, v28, v28 row_ror:2 row_mask:0xf bank_mask:0xf
    s_nop 1
    v_max_u32_dpp v28, v28, v28 row_ror:4 row_mask:0xf bank_mask:0xf
    s_nop 1
    v_max_u32_dpp v28, v28, v28 row_ror:8 row_mask:0xf bank_mask:0xf
    v_mov_b32 v29, v28
    s_nop 1
    v_permlane32_swap_b32 v29, v28
    v_max_u32 v28, v29, v28
    v_mov_b32 v29, v28
    s_nop 1
    v_permlane16_swap_b32 v29, v28
    v_max_u32 v28, v29, v28
    ds_write_b32 v30, v28 offset:16
    s_waitcnt lgkmcnt(0)
    s_barrier
    ds_read_b128 v[16:19], v31 offset:16
    s_waitcnt lgkmcnt(0)
    v_max3_u32 v28, v16, v17, v18
    v_max_u32 v28, v28, v19
    s_nop 0
    v_readfirstlane_b32 s70, v28
    s_barrier
    s_branch L_ffn_sel
L_ffn_re:
    v_and_b32 v24, 63, v0
    v_lshlrev_b32 v24, 3, v24
    s_mov_b32 s71, 0x7e00
    s_mov_b32 s72, 0
L_rsel_133:
    buffer_load_dwordx2 v[20:21], v24, s[8:11], s71 offen sc1
    s_waitcnt vmcnt(0)
    v_min_u32 v22, v20, v21
    v_cmp_eq_u32 vcc, 0, v22
    s_cbranch_vccz L_rseld_134
    s_sleep 3
    s_add_u32 s72, s72, 1
    s_cmp_lt_u32 s72, 0x10000
    s_cbranch_scc1 L_rsel_133
L_rseld_134:
    v_max_u32 v22, v20, v21
    v_cmp_lt_u32 vcc, s70, v22
    s_cbranch_vccz L_rsele_135
    v_max_u32_dpp v22, v22, v22 row_ror:1 row_mask:0xf bank_mask:0xf
    s_nop 1
    v_max_u32_dpp v22, v22, v22 row_ror:2 row_mask:0xf bank_mask:0xf
    s_nop 1
    v_max_u32_dpp v22, v22, v22 row_ror:4 row_mask:0xf bank_mask:0xf
    s_nop 1
    v_max_u32_dpp v22, v22, v22 row_ror:8 row_mask:0xf bank_mask:0xf
    v_mov_b32 v23, v22
    s_nop 1
    v_permlane32_swap_b32 v23, v22
    v_max_u32 v22, v23, v22
    v_mov_b32 v23, v22
    s_nop 1
    v_permlane16_swap_b32 v23, v22
    v_max_u32 v22, v23, v22
    s_nop 0
    v_readfirstlane_b32 s71, v22
    s_nop 1
    v_cmp_ne_u32 vcc, s71, v20
    s_nop 1
    v_cndmask_b32 v20, 0, v20, vcc
    v_cmp_ne_u32 vcc, s71, v21
    s_nop 1
    v_cndmask_b32 v21, 0, v21, vcc
    v_max_u32 v22, v20, v21
    s_nop 1
    v_max_u32_dpp v22, v22, v22 row_ror:1 row_mask:0xf bank_mask:0xf
    s_nop 1
    v_max_u32_dpp v22, v22, v22 row_ror:2 row_mask:0xf bank_mask:0xf
    s_nop 1
    v_max_u32_dpp v22, v22, v22 row_ror:4 row_mask:0xf bank_mask:0xf
    s_nop 1
    v_max_u32_dpp v22, v22, v22 row_ror:8 row_mask:0xf bank_mask:0xf
    v_mov_b32 v23, v22
    s_nop 1
    v_permlane32_swap_b32 v23, v22
    v_max_u32 v22, v23, v22
    v_mov_b32 v23, v22
    s_nop 1
    v_permlane16_swap_b32 v23, v22
    v_max_u32 v22, v23, v22
    s_nop 0
    v_readfirstlane_b32 s72, v22
    s_nop 0
    s_max_u32 s70, s70, s72
    s_min_u32 s72, s71, s69
    s_max_u32 s70, s70, s72
    s_max_u32 s69, s69, s71
L_rsele_135:
L_ffn_sel:
    s_and_b32 s71, s69, 2047
    s_lshl_b32 s71, s71, 11
    s_and_b32 s72, s70, 2047
    s_or_b32 s71, s71, s72
    s_add_u32 s71, s71, 1
    s_cmp_eq_u32 s71, s74
    s_cbranch_scc1 L_ffn_same
    s_mov_b32 s74, s71
    v_and_b32 v1, 63, v0
    v_lshrrev_b32 v2, 4, v1
    v_and_b32 v3, 15, v1
    v_lshrrev_b32 v6, 2, v3
    s_and_b32 s71, s69, 2047
    s_sub_u32 s71, 2047, s71
    s_and_b32 s72, s70, 2047
    s_sub_u32 s72, 2047, s72
    v_and_b32 v4, 1, v3
    v_cmp_eq_u32 vcc, 0, v4
    v_mov_b32 v4, s71
    v_mov_b32 v5, s72
    v_cndmask_b32 v4, v5, v4, vcc
    v_lshlrev_b32 v4, 10, v4
    v_lshl_add_u32 v4, v2, 4, v4
    s_mov_b32 s71, 0x6200000
    buffer_load_dwordx4 v[32:35], v4, s[8:11], s71 offen
    buffer_load_dwordx4 v[36:39], v4, s[8:11], s71 offen offset:64
    buffer_load_dwordx4 v[40:43], v4, s[8:11], s71 offen offset:128
    buffer_load_dwordx4 v[44:47], v4, s[8:11], s71 offen offset:192
    buffer_load_dwordx4 v[48:51], v4, s[8:11], s71 offen offset:256
    buffer_load_dwordx4 v[52:55], v4, s[8:11], s71 offen offset:320
    buffer_load_dwordx4 v[56:59], v4, s[8:11], s71 offen offset:384
    buffer_load_dwordx4 v[60:63], v4, s[8:11], s71 offen offset:448
    buffer_load_dwordx4 v[64:67], v4, s[8:11], s71 offen offset:512
    buffer_load_dwordx4 v[68:71], v4, s[8:11], s71 offen offset:576
    buffer_load_dwordx4 v[72:75], v4, s[8:11], s71 offen offset:640
    buffer_load_dwordx4 v[76:79], v4, s[8:11], s71 offen offset:704
    buffer_load_dwordx4 v[80:83], v4, s[8:11], s71 offen offset:768
    buffer_load_dwordx4 v[84:87], v4, s[8:11], s71 offen offset:832
    buffer_load_dwordx4 v[88:91], v4, s[8:11], s71 offen offset:896
    buffer_load_dwordx4 v[92:95], v4, s[8:11], s71 offen offset:960
    v_lshl_add_u32 v4, v2, 3, v6
    v_lshlrev_b32 v4, 6, v4
    v_and_b32 v5, 3, v3
    v_lshl_add_u32 v4, v5, 3, v4
    s_lshr_b32 s71, s68, 1
    s_lshl_b32 s71, s71, 15
    s_and_b32 s72, s68, 1
    s_lshl_b32 s72, s72, 5
    s_add_u32 s71, s71, s72
    s_add_u32 s71, s71, 0x8000
    v_add_u32 v7, s71, v4
    ds_read_b64_tr_b16 v[96:97], v7
    ds_read_b64_tr_b16 v[98:99], v7 offset:256
    ds_read_b64_tr_b16 v[100:101], v7 offset:2048
    ds_read_b64_tr_b16 v[102:103], v7 offset:2304
    ds_read_b64_tr_b16 v[104:105], v7 offset:4096
    ds_read_b64_tr_b16 v[106:107], v7 offset:4352
    ds_read_b64_tr_b16 v[108:109], v7 offset:6144
    ds_read_b64_tr_b16 v[110:111], v7 offset:6400
    s_waitcnt lgkmcnt(0)
    ds_read_b64_tr_b16 v[112:113], v7 offset:8192
    ds_read_b64_tr_b16 v[114:115], v7 offset:8448
    ds_read_b64_tr_b16 v[116:117], v7 offset:10240
    ds_read_b64_tr_b16 v[118:119], v7 offset:10496
    ds_read_b64_tr_b16 v[120:121], v7 offset:12288
    ds_read_b64_tr_b16 v[122:123], v7 offset:12544
    ds_read_b64_tr_b16 v[124:125], v7 offset:14336
    ds_read_b64_tr_b16 v[126:127], v7 offset:14592
    s_waitcnt lgkmcnt(0)
    ds_read_b64_tr_b16 v[128:129], v7 offset:16384
    ds_read_b64_tr_b16 v[130:131], v7 offset:16640
    ds_read_b64_tr_b16 v[132:133], v7 offset:18432
    ds_read_b64_tr_b16 v[134:135], v7 offset:18688
    ds_read_b64_tr_b16 v[136:137], v7 offset:20480
    ds_read_b64_tr_b16 v[138:139], v7 offset:20736
    ds_read_b64_tr_b16 v[140:141], v7 offset:22528
    ds_read_b64_tr_b16 v[142:143], v7 offset:22784
    s_waitcnt lgkmcnt(0)
    ds_read_b64_tr_b16 v[144:145], v7 offset:24576
    ds_read_b64_tr_b16 v[146:147], v7 offset:24832
    ds_read_b64_tr_b16 v[148:149], v7 offset:26624
    ds_read_b64_tr_b16 v[150:151], v7 offset:26880
    ds_read_b64_tr_b16 v[152:153], v7 offset:28672
    ds_read_b64_tr_b16 v[154:155], v7 offset:28928
    ds_read_b64_tr_b16 v[156:157], v7 offset:30720
    ds_read_b64_tr_b16 v[158:159], v7 offset:30976
    s_waitcnt lgkmcnt(0)
    s_waitcnt vmcnt(0)
    v_mfma_f32_16x16x32_bf16 v[8:11], v[32:35], v[96:99], 0
    v_mfma_f32_16x16x32_bf16 v[8:11], v[36:39], v[100:103], v[8:11]
    v_mfma_f32_16x16x32_bf16 v[8:11], v[40:43], v[104:107], v[8:11]
    v_mfma_f32_16x16x32_bf16 v[8:11], v[44:47], v[108:111], v[8:11]
    v_mfma_f32_16x16x32_bf16 v[8:11], v[48:51], v[112:115], v[8:11]
    v_mfma_f32_16x16x32_bf16 v[8:11], v[52:55], v[116:119], v[8:11]
    v_mfma_f32_16x16x32_bf16 v[8:11], v[56:59], v[120:123], v[8:11]
    v_mfma_f32_16x16x32_bf16 v[8:11], v[60:63], v[124:127], v[8:11]
    v_mfma_f32_16x16x32_bf16 v[8:11], v[64:67], v[128:131], v[8:11]
    v_mfma_f32_16x16x32_bf16 v[8:11], v[68:71], v[132:135], v[8:11]
    v_mfma_f32_16x16x32_bf16 v[8:11], v[72:75], v[136:139], v[8:11]
    v_mfma_f32_16x16x32_bf16 v[8:11], v[76:79], v[140:143], v[8:11]
    v_mfma_f32_16x16x32_bf16 v[8:11], v[80:83], v[144:147], v[8:11]
    v_mfma_f32_16x16x32_bf16 v[8:11], v[84:87], v[148:151], v[8:11]
    v_mfma_f32_16x16x32_bf16 v[8:11], v[88:91], v[152:155], v[8:11]
    v_mfma_f32_16x16x32_bf16 v[8:11], v[92:95], v[156:159], v[8:11]
    s_nop 7
    v_cvt_pk_bf16_f32 v8, v8, v8
    v_and_b32 v8, 0xffff0000, v8
    v_cvt_pk_bf16_f32 v9, v9, v9
    v_and_b32 v9, 0xffff0000, v9
    s_cmp_ge_u32 s68, 2
    s_cbranch_scc1 L_ffn_up_136
    v_mul_f32 v13, 0xbfb8aa3b, v8
    v_exp_f32 v13, v13
    s_nop 0
    v_add_f32 v13, 1.0, v13
    v_rcp_f32 v12, v13
    s_nop 0
    v_mul_f32 v8, v12, v8
    v_cvt_pk_bf16_f32 v8, v8, v8
    v_and_b32 v8, 0xffff0000, v8
    v_mul_f32 v13, 0xbfb8aa3b, v9
    v_exp_f32 v13, v13
    s_nop 0
    v_add_f32 v13, 1.0, v13
    v_rcp_f32 v12, v13
    s_nop 0
    v_mul_f32 v9, v12, v9
    v_cvt_pk_bf16_f32 v9, v9, v9
    v_and_b32 v9, 0xffff0000, v9
    s_nop 4
L_ffn_up_136:
    s_lshr_b32 s71, s68, 1
    s_lshl_b32 s71, s71, 8
    s_and_b32 s72, s68, 1
    s_lshl_b32 s72, s72, 6
    s_add_u32 s71, s71, s72
    s_add_u32 s71, s71, 0x20000
    v_lshlrev_b32 v4, 2, v3
    v_add_u32 v4, s71, v4
    ds_write_b32 v4, v8
    ds_write_b32 v4, v9 offset:128
    s_waitcnt lgkmcnt(0)
    s_barrier
    v_and_b32 v4, 1, v3
    v_lshlrev_b32 v4, 7, v4
    v_lshl_add_u32 v4, v2, 5, v4
    v_add_u32 v4, 0x20000, v4
    ds_read_b128 v[32:35], v4
    ds_read_b128 v[36:39], v4 offset:16
    ds_read_b128 v[40:43], v4 offset:256
    ds_read_b128 v[44:47], v4 offset:272
    v_lshl_add_u32 v5, v2, 3, v6
    v_lshlrev_b32 v5, 10, v5
    v_and_b32 v7, 3, v3
    v_lshl_add_u32 v5, v7, 3, v5
    s_lshl_b32 s71, s68, 8
    s_add_u32 s71, s71, 0x18000
    v_add_u32 v7, s71, v5
    s_waitcnt lgkmcnt(0)
    ds_read_b64_tr_b16 v[96:97], v7
    ds_read_b64_tr_b16 v[98:99], v7 offset:4096
    ds_read_b64_tr_b16 v[100:101], v7 offset:32
    ds_read_b64_tr_b16 v[102:103], v7 offset:4128
    ds_read_b64_tr_b16 v[104:105], v7 offset:64
    ds_read_b64_tr_b16 v[106:107], v7 offset:4160
    ds_read_b64_tr_b16 v[108:109], v7 offset:96
    ds_read_b64_tr_b16 v[110:111], v7 offset:4192
    s_waitcnt lgkmcnt(0)
    ds_read_b64_tr_b16 v[112:113], v7 offset:128
    ds_read_b64_tr_b16 v[114:115], v7 offset:4224
    ds_read_b64_tr_b16 v[116:117], v7 offset:160
    ds_read_b64_tr_b16 v[118:119], v7 offset:4256
    ds_read_b64_tr_b16 v[120:121], v7 offset:192
    ds_read_b64_tr_b16 v[122:123], v7 offset:4288
    ds_read_b64_tr_b16 v[124:125], v7 offset:224
    ds_read_b64_tr_b16 v[126:127], v7 offset:4320
    v_mul_f32 v32, v32, v40
    v_mul_f32 v33, v33, v41
    v_mul_f32 v34, v34, v42
    v_mul_f32 v35, v35, v43
    v_mul_f32 v36, v36, v44
    v_mul_f32 v37, v37, v45
    v_mul_f32 v38, v38, v46
    v_mul_f32 v39, v39, v47
    v_cvt_pk_bf16_f32 v48, v32, v33
    v_cvt_pk_bf16_f32 v49, v34, v35
    v_cvt_pk_bf16_f32 v50, v36, v37
    v_cvt_pk_bf16_f32 v51, v38, v39
    s_waitcnt lgkmcnt(0)
    s_nop 0
    v_mfma_f32_16x16x32_bf16 v[56:59], v[48:51], v[96:99], 0
    v_mfma_f32_16x16x32_bf16 v[60:63], v[48:51], v[100:103], 0
    v_mfma_f32_16x16x32_bf16 v[64:67], v[48:51], v[104:107], 0
    v_mfma_f32_16x16x32_bf16 v[68:71], v[48:51], v[108:111], 0
    v_mfma_f32_16x16x32_bf16 v[72:75], v[48:51], v[112:115], 0
    v_mfma_f32_16x16x32_bf16 v[76:79], v[48:51], v[116:119], 0
    v_mfma_f32_16x16x32_bf16 v[80:83], v[48:51], v[120:123], 0
    v_mfma_f32_16x16x32_bf16 v[84:87], v[48:51], v[124:127], 0
    v_cmp_eq_u32 vcc, 0, v2
    v_lshlrev_b32 v4, 11, v2
    v_lshl_add_u32 v4, v3, 2, v4
    s_lshl_b32 s71, s67, 12
    s_lshl_b32 s72, s68, 9
    s_add_u32 s71, s71, s72
    s_add_u32 s71, s71, 0x6410000
    v_cndmask_b32 v56, v57, v56, vcc
    v_cndmask_b32 v60, v61, v60, vcc
    v_cndmask_b32 v64, v65, v64, vcc
    v_cndmask_b32 v68, v69, v68, vcc
    v_cndmask_b32 v72, v73, v72, vcc
    v_cndmask_b32 v76, v77, v76, vcc
    v_cndmask_b32 v80, v81, v80, vcc
    v_cndmask_b32 v84, v85, v84, vcc
    s_mov_b32 exec_hi, 0
    buffer_store_dword v56, v4, s[8:11], s71 offen sc1
    buffer_store_dword v60, v4, s[8:11], s71 offen offset:64 sc1
    buffer_store_dword v64, v4, s[8:11], s71 offen offset:128 sc1
    buffer_store_dword v68, v4, s[8:11], s71 offen offset:192 sc1
    buffer_store_dword v72, v4, s[8:11], s71 offen offset:256 sc1
    buffer_store_dword v76, v4, s[8:11], s71 offen offset:320 sc1
    buffer_store_dword v80, v4, s[8:11], s71 offen offset:384 sc1
    buffer_store_dword v84, v4, s[8:11], s71 offen offset:448 sc1
    s_mov_b64 exec, -1
    s_waitcnt vmcnt(0)
    s_barrier
    s_lshl_b32 s71, s67, 2
    s_lshl_b32 s72, s75, 8
    s_add_u32 s71, s71, s72
    s_add_u32 s71, s71, 0x8000
    s_cmp_lg_u32 s100, 0
    s_cbranch_scc1 L_flag_137
    v_mov_b32 v2, s74
    s_mov_b64 exec, 1
    buffer_store_dword v2, off, s[8:11], s71 sc1
    s_mov_b64 exec, -1
L_flag_137:
    s_cmp_ge_u32 s67, 8
    s_cbranch_scc1 L_ffn_same
    s_load_dwordx2 s[16:17], s[0:1], 96
    s_waitcnt lgkmcnt(0)
    s_and_b32 s17, s17, 0xffff
    s_mov_b32 s18, 0x200000
    s_mov_b32 s19, 0x20000
    v_and_b32 v3, 63, v0
    s_cmp_lt_u32 s100, 2
    s_cselect_b32 s71, s69, s70
    v_mov_b32 v5, s71
    s_and_b32 s71, s71, 2047
    s_sub_u32 s71, 2047, s71
    s_lshl_b32 s71, s71, 10
    s_lshl_b32 s72, s67, 1
    s_and_b32 s96, s100, 1
    s_add_u32 s72, s72, s96
    s_lshl_b32 s96, s72, 6
    s_add_u32 s71, s71, s96
    v_and_b32 v4, 7, v3
    v_lshlrev_b32 v6, 3, v4
    v_add_u32 v6, s71, v6
    v_lshrrev_b32 v7, 3, v3
    v_lshlrev_b32 v7, 12, v7
    v_lshl_add_u32 v7, v4, 4, v7
    s_lshl_b32 s72, s72, 7
    s_lshr_b32 s96, s100, 1
    s_lshl_b32 s96, s96, 11
    s_add_u32 s72, s72, s96
    v_add_u32 v7, s72, v7
    s_mov_b32 s71, 0x6000000
    s_mov_b32 s72, 0x6200000
    buffer_load_dwordx2 v[8:9], v6, s[8:11], s71 offen sc1
    buffer_load_dwordx2 v[10:11], v6, s[8:11], s72 offen sc1
    v_and_b32 v5, 0xffff0000, v5
    v_ashrrev_i32 v4, 31, v5
    v_not_b32 v4, v4
    v_or_b32 v4, 0x80000000, v4
    v_xor_b32 v5, v5, v4
    v_and_b32 v5, 0xffff0000, v5
    v_mul_f32 v23, 0xbfb8aa3b, v5
    v_exp_f32 v23, v23
    s_nop 0
    v_add_f32 v23, 1.0, v23
    v_rcp_f32 v22, v23
    s_nop 0
    v_cvt_pk_bf16_f32 v22, v22, v22
    v_and_b32 v22, 0xffff0000, v22
    v_lshlrev_b32 v1, 2, v0
    s_lshl_b32 s71, s75, 8
    s_add_u32 s71, s71, 0x8000
    s_cmp_lg_u32 s100, 0
    s_cbranch_scc1 L_polls_140
    s_mov_b32 exec_hi, 0xffffff
    s_mov_b32 s96, 0
L_poll_138:
    buffer_load_dword v2, v1, s[8:11], s71 offen sc1
    s_waitcnt vmcnt(0)
    v_cmp_ne_u32 vcc, s74, v2
    s_cbranch_vccz L_polld_139
    s_sleep 2
    s_add_u32 s96, s96, 1
    s_cmp_lt_u32 s96, 0x10000
    s_cbranch_scc1 L_poll_138
L_polld_139:
    s_mov_b64 exec, -1
L_polls_140:
    s_barrier
    s_mov_b32 s71, 0x6410000
    buffer_load_dwordx4 v[32:35], v7, s[8:11], s71 offen sc1
    s_add_u32 s71, s71, 32768
    buffer_load_dwordx4 v[36:39], v7, s[8:11], s71 offen sc1
    s_add_u32 s71, s71, 32768
    buffer_load_dwordx4 v[40:43], v7, s[8:11], s71 offen sc1
    s_add_u32 s71, s71, 32768
    buffer_load_dwordx4 v[44:47], v7, s[8:11], s71 offen sc1
    s_add_u32 s71, s71, 32768
    buffer_load_dwordx4 v[48:51], v7, s[8:11], s71 offen sc1
    s_add_u32 s71, s71, 32768
    buffer_load_dwordx4 v[52:55], v7, s[8:11], s71 offen sc1
    s_add_u32 s71, s71, 32768
    buffer_load_dwordx4 v[56:59], v7, s[8:11], s71 offen sc1
    s_add_u32 s71, s71, 32768
    s_waitcnt vmcnt(7)
    v_lshlrev_b32 v12, 16, v8
    v_and_b32 v13, 0xffff0000, v8
    v_lshlrev_b32 v16, 16, v10
    v_and_b32 v17, 0xffff0000, v10
    v_lshlrev_b32 v14, 16, v9
    v_and_b32 v15, 0xffff0000, v9
    v_lshlrev_b32 v18, 16, v11
    v_and_b32 v19, 0xffff0000, v11
    s_waitcnt vmcnt(0)
    v_pk_add_f32 v[32:33], v[32:33], v[36:37]
    v_pk_add_f32 v[34:35], v[34:35], v[38:39]
    v_pk_add_f32 v[32:33], v[32:33], v[40:41]
    v_pk_add_f32 v[34:35], v[34:35], v[42:43]
    v_pk_add_f32 v[32:33], v[32:33], v[44:45]
    v_pk_add_f32 v[34:35], v[34:35], v[46:47]
    v_pk_add_f32 v[32:33], v[32:33], v[48:49]
    v_pk_add_f32 v[34:35], v[34:35], v[50:51]
    v_pk_add_f32 v[32:33], v[32:33], v[52:53]
    v_pk_add_f32 v[34:35], v[34:35], v[54:55]
    v_pk_add_f32 v[32:33], v[32:33], v[56:57]
    v_pk_add_f32 v[34:35], v[34:35], v[58:59]
    s_nop 0
    v_add_f32_dpp v32, v32, v32 row_ror:8 row_mask:0xf bank_mask:0xf
    v_add_f32_dpp v33, v33, v33 row_ror:8 row_mask:0xf bank_mask:0xf
    v_add_f32_dpp v34, v34, v34 row_ror:8 row_mask:0xf bank_mask:0xf
    v_add_f32_dpp v35, v35, v35 row_ror:8 row_mask:0xf bank_mask:0xf
    v_mov_b32 v24, v32
    s_nop 1
    v_permlane32_swap_b32 v24, v32
    v_add_f32 v32, v24, v32
    v_mov_b32 v24, v32
    s_nop 1
    v_permlane16_swap_b32 v24, v32
    v_add_f32 v32, v24, v32
    v_mov_b32 v24, v33
    s_nop 1
    v_permlane32_swap_b32 v24, v33
    v_add_f32 v33, v24, v33
    v_mov_b32 v24, v33
    s_nop 1
    v_permlane16_swap_b32 v24, v33
    v_add_f32 v33, v24, v33
    v_mov_b32 v24, v34
    s_nop 1
    v_permlane32_swap_b32 v24, v34
    v_add_f32 v34, v24, v34
    v_mov_b32 v24, v34
    s_nop 1
    v_permlane16_swap_b32 v24, v34
    v_add_f32 v34, v24, v34
    v_mov_b32 v24, v35
    s_nop 1
    v_permlane32_swap_b32 v24, v35
    v_add_f32 v35, v24, v35
    v_mov_b32 v24, v35
    s_nop 1
    v_permlane16_swap_b32 v24, v35
    v_add_f32 v35, v24, v35
    v_cvt_pk_bf16_f32 v32, v32, v32
    v_and_b32 v32, 0xffff0000, v32
    v_mul_f32 v32, v22, v32
    v_cvt_pk_bf16_f32 v32, v32, v32
    v_and_b32 v32, 0xffff0000, v32
    v_add_f32 v32, v16, v32
    v_cvt_pk_bf16_f32 v32, v32, v32
    v_and_b32 v32, 0xffff0000, v32
    v_add_f32 v32, v12, v32
    v_cvt_pk_bf16_f32 v33, v33, v33
    v_and_b32 v33, 0xffff0000, v33
    v_mul_f32 v33, v22, v33
    v_cvt_pk_bf16_f32 v33, v33, v33
    v_and_b32 v33, 0xffff0000, v33
    v_add_f32 v33, v17, v33
    v_cvt_pk_bf16_f32 v33, v33, v33
    v_and_b32 v33, 0xffff0000, v33
    v_add_f32 v33, v13, v33
    v_cvt_pk_bf16_f32 v34, v34, v34
    v_and_b32 v34, 0xffff0000, v34
    v_mul_f32 v34, v22, v34
    v_cvt_pk_bf16_f32 v34, v34, v34
    v_and_b32 v34, 0xffff0000, v34
    v_add_f32 v34, v18, v34
    v_cvt_pk_bf16_f32 v34, v34, v34
    v_and_b32 v34, 0xffff0000, v34
    v_add_f32 v34, v14, v34
    v_cvt_pk_bf16_f32 v35, v35, v35
    v_and_b32 v35, 0xffff0000, v35
    v_mul_f32 v35, v22, v35
    v_cvt_pk_bf16_f32 v35, v35, v35
    v_and_b32 v35, 0xffff0000, v35
    v_add_f32 v35, v19, v35
    v_cvt_pk_bf16_f32 v35, v35, v35
    v_and_b32 v35, 0xffff0000, v35
    v_add_f32 v35, v15, v35
    v_cvt_pk_bf16_f32 v200, v32, v33
    v_cvt_pk_bf16_f32 v201, v34, v35
    v_mov_b32 v202, v6
L_ffn_same:
    s_add_u32 s75, s75, 1
    s_cmp_lt_u32 s75, 2
    s_cbranch_scc1 L_ffn_round
    s_cmp_ge_u32 s67, 8
    s_cbranch_scc1 L_exit
    s_mov_b32 exec_lo, 0xff
    s_mov_b32 exec_hi, 0
    buffer_store_dwordx2 v[200:201], v202, s[16:19], 0 offen
    s_mov_b64 exec, -1
    s_waitcnt vmcnt(0)
L_exit:
    s_endpgm
.section .rodata,"a"
.p2align 6
.amdhsa_kernel sequential_preLN__memory_aug_recurrent_mem_tr__moe_arch_mod__prompt_kernel
  .amdhsa_next_free_vgpr 512
  .amdhsa_next_free_sgpr 102
  .amdhsa_accum_offset 256
  .amdhsa_group_segment_fixed_size 0
  .amdhsa_kernarg_size 120
  .amdhsa_user_sgpr_count 2
  .amdhsa_user_sgpr_kernarg_segment_ptr 1
  .amdhsa_system_sgpr_workgroup_id_x 1
  .amdhsa_float_denorm_mode_32 3
.end_amdhsa_kernel
```

```asm
; @launch grid=(256,1,1) block=(256,1,1) lds=163840
.amdgcn_target "amdgcn-amd-amdhsa--gfx950"
.text
.globl sequential_preLN__memory_aug_recurrent_mem_tr__moe_arch_mod__prompt_kernel
.p2align 8
.type sequential_preLN__memory_aug_recurrent_mem_tr__moe_arch_mod__prompt_kernel,@function
sequential_preLN__memory_aug_recurrent_mem_tr__moe_arch_mod__prompt_kernel:
    s_cmp_ge_u32 s2, 256
    s_cbranch_scc1 L_exit
    s_load_dwordx2 s[8:9], s[0:1], 112
    s_waitcnt lgkmcnt(0)
    s_and_b32 s9, s9, 0xffff
    s_mov_b32 s10, 0x10000000
    s_mov_b32 s11, 0x20000
    s_load_dwordx2 s[92:93], s[0:1], 104
    s_waitcnt lgkmcnt(0)
    s_and_b32 s93, s93, 0xffff
    s_mov_b32 s94, 0x100
    s_mov_b32 s95, 0x20000
    v_lshrrev_b32 v1, 6, v0
    s_nop 0
    v_readfirstlane_b32 s100, v1
    s_getreg_b32 s84, hwreg(HW_REG_XCC_ID)
    s_and_b32 s84, s84, 7
    s_lshl_b32 s97, s84, 4
    s_add_u32 s97, s97, 64
    s_cmp_lg_u32 s100, 0
    s_cbranch_scc1 L_at_1
    s_mov_b64 exec, 1
    v_mov_b32 v2, 1
    buffer_atomic_add v2, off, s[92:95], s97 sc0
    s_mov_b64 exec, -1
L_at_1:
    s_load_dwordx4 s[20:23], s[0:1], 16
    s_load_dwordx4 s[24:27], s[0:1], 32
    v_lshlrev_b32 v3, 6, v0
    s_lshl_b32 s28, s2, 14
    s_cmp_eq_u32 s84, 0
    s_cselect_b32 s14, 0, 0x400000
    s_mov_b32 s15, 0x20000
    s_waitcnt lgkmcnt(0)
    s_mov_b32 s12, s20
    s_and_b32 s13, s21, 0xffff
    buffer_load_dword v255, v3, s[12:15], s28 offen
    s_mov_b32 s12, s22
    s_and_b32 s13, s23, 0xffff
    buffer_load_dword v255, v3, s[12:15], s28 offen
    s_mov_b32 s12, s24
    s_and_b32 s13, s25, 0xffff
    buffer_load_dword v255, v3, s[12:15], s28 offen
    s_mov_b32 s12, s26
    s_and_b32 s13, s27, 0xffff
    buffer_load_dword v255, v3, s[12:15], s28 offen
    s_cmp_lg_u32 s100, 0
    s_cbranch_scc1 L_at2_2
    s_mov_b64 exec, 1
    v_mov_b32 v1, 0
    s_waitcnt vmcnt(4)
    ds_write_b32 v1, v2
    s_waitcnt lgkmcnt(0)
    s_mov_b64 exec, -1
L_at2_2:
    s_barrier
    v_mov_b32 v1, 0
    ds_read_b32 v2, v1
    s_waitcnt lgkmcnt(0)
    v_readfirstlane_b32 s85, v2
    s_mov_b32 s87, 0
    s_cmp_lg_u32 s2, 0
    s_cbranch_scc1 L_noz
    v_mov_b32 v4, 0
    v_mov_b32 v5, 0
    v_mov_b32 v6, 0
    v_mov_b32 v7, 0
    v_lshlrev_b32 v1, 4, v0
    s_mov_b32 s97, 0x0
    buffer_store_dwordx4 v[4:7], v1, s[8:11], s97 offen sc1
    s_mov_b32 s97, 0x1000
    buffer_store_dwordx4 v[4:7], v1, s[8:11], s97 offen sc1
    s_mov_b32 s97, 0x2000
    buffer_store_dwordx4 v[4:7], v1, s[8:11], s97 offen sc1
    s_mov_b32 s97, 0x3000
    buffer_store_dwordx4 v[4:7], v1, s[8:11], s97 offen sc1
    s_mov_b32 s97, 0x4000
    buffer_store_dwordx4 v[4:7], v1, s[8:11], s97 offen sc1
    s_mov_b32 s97, 0x5000
    buffer_store_dwordx4 v[4:7], v1, s[8:11], s97 offen sc1
    s_mov_b32 s97, 0x6000
    buffer_store_dwordx4 v[4:7], v1, s[8:11], s97 offen sc1
    s_mov_b32 s97, 0x7000
    buffer_store_dwordx4 v[4:7], v1, s[8:11], s97 offen sc1
    s_mov_b32 s97, 0x8000
    buffer_store_dwordx4 v[4:7], v1, s[8:11], s97 offen sc1
    s_waitcnt vmcnt(0)
    s_barrier
    s_cmp_lg_u32 s100, 0
    s_cbranch_scc1 L_flag_3
    v_mov_b32 v2, 1
    s_mov_b64 exec, 1
    buffer_store_dword v2, off, s[92:95], 40 sc1
    s_mov_b64 exec, -1
L_flag_3:
L_noz:
    s_cmp_lg_u32 s85, 31
    s_cbranch_scc1 L_nod
    s_cmp_lg_u32 s100, 0
    s_cbranch_scc1 L_nod
    s_mov_b64 exec, 1
    v_mov_b32 v2, 1
    buffer_atomic_add v2, off, s[92:95], 0 offset:32 sc0
    s_waitcnt vmcnt(0)
    v_readfirstlane_b32 s86, v2
    s_nop 0
    s_cmp_lg_u32 s86, 7
    s_cbranch_scc1 L_nod2
    v_mov_b32 v2, 1
    v_mov_b32 v3, 0
    buffer_atomic_cmpswap v[2:3], off, s[92:95], 0 offset:36
L_nod2:
    s_mov_b64 exec, -1
L_nod:
    s_cmp_ge_u32 s85, 32
    s_cbranch_scc1 L_odd
    s_cmp_lg_u32 s84, 0
    s_cbranch_scc1 L_other
    s_mov_b32 s20, s85
    s_mov_b32 s16, s92
    s_mov_b32 s17, s93
    s_mov_b32 s18, s94
    s_mov_b32 s19, s95
    s_mov_b32 s88, s20
    v_lshrrev_b32 v4, 6, v0
    s_nop 0
    v_readfirstlane_b32 s21, v4
    v_and_b32 v1, 63, v0
    v_lshrrev_b32 v2, 4, v1
    v_and_b32 v3, 15, v1
    v_lshrrev_b32 v6, 2, v3
    v_lshlrev_b32 v117, 4, v1
    s_lshl_b32 s51, s21, 10
    s_lshl_b32 s52, s21, 11
    s_load_dwordx8 s[60:67], s[0:1], 16
    s_mov_b32 s14, 0x400000
    s_mov_b32 s15, 0x20000
    s_lshl_b32 s41, s20, 8
    s_lshl_b32 s42, s20, 17
    s_lshr_b32 s43, s21, 1
    s_lshl_b32 s43, s43, 2
    v_or_b32 v5, s43, v2
    v_lshlrev_b32 v5, 1, v5
    v_xor_b32 v5, v5, v3
    v_lshrrev_b32 v14, 2, v5
    v_and_b32 v14, 2, v14
    v_lshlrev_b32 v5, 4, v5
    s_lshl_b32 s43, s21, 4
    v_add_u32 v4, s43, v2
    v_lshl_add_u32 v8, v4, 13, v5
    s_waitcnt lgkmcnt(0)
    s_mov_b32 s12, s60
    s_and_b32 s13, s61, 0xffff
    v_xor_b32 v15, 2, v14
    v_lshl_add_u32 v15, v15, 15, v8
    s_add_u32 s43, s41, 0x0
    s_add_u32 m0, s51, 0x8000
    s_nop 0
    buffer_load_dwordx4 v15, s[12:15], s43 offen lds
    s_add_u32 s43, s41, 0x8000
    s_add_u32 m0, s51, 0x9000
    s_nop 0
    buffer_load_dwordx4 v15, s[12:15], s43 offen lds
    s_add_u32 s43, s41, 0x100000
    s_add_u32 m0, s51, 0xa000
    s_nop 0
    buffer_load_dwordx4 v15, s[12:15], s43 offen lds
    s_add_u32 s43, s41, 0x108000
    s_add_u32 m0, s51, 0xb000
    s_nop 0
    buffer_load_dwordx4 v15, s[12:15], s43 offen lds
    s_add_u32 s43, s41, 0x200000
    s_add_u32 m0, s51, 0xc000
    s_nop 0
    buffer_load_dwordx4 v15, s[12:15], s43 offen lds
    s_add_u32 s43, s41, 0x208000
    s_add_u32 m0, s51, 0xd000
    s_nop 0
    buffer_load_dwordx4 v15, s[12:15], s43 offen lds
    s_add_u32 s43, s41, 0x300000
    s_add_u32 m0, s51, 0xe000
    s_nop 0
    buffer_load_dwordx4 v15, s[12:15], s43 offen lds
    s_add_u32 s43, s41, 0x308000
    s_add_u32 m0, s51, 0xf000
    s_nop 0
    buffer_load_dwordx4 v15, s[12:15], s43 offen lds
    v_xor_b32 v15, 2, v14
    v_lshl_add_u32 v15, v15, 15, v8
    s_add_u32 s43, s41, 0x80000
    s_add_u32 m0, s51, 0x10000
    s_nop 0
    buffer_load_dwordx4 v15, s[12:15], s43 offen lds
    s_add_u32 s43, s41, 0x88000
    s_add_u32 m0, s51, 0x11000
    s_nop 0
    buffer_load_dwordx4 v15, s[12:15], s43 offen lds
    s_add_u32 s43, s41, 0x180000
    s_add_u32 m0, s51, 0x12000
    s_nop 0
    buffer_load_dwordx4 v15, s[12:15], s43 offen lds
    s_add_u32 s43, s41, 0x188000
    s_add_u32 m0, s51, 0x13000
    s_nop 0
    buffer_load_dwordx4 v15, s[12:15], s43 offen lds
    s_add_u32 s43, s41, 0x280000
    s_add_u32 m0, s51, 0x14000
    s_nop 0
    buffer_load_dwordx4 v15, s[12:15], s43 offen lds
    s_add_u32 s43, s41, 0x288000
    s_add_u32 m0, s51, 0x15000
    s_nop 0
    buffer_load_dwordx4 v15, s[12:15], s43 offen lds
    s_add_u32 s43, s41, 0x380000
    s_add_u32 m0, s51, 0x16000
    s_nop 0
    buffer_load_dwordx4 v15, s[12:15], s43 offen lds
    s_add_u32 s43, s41, 0x388000
    s_add_u32 m0, s51, 0x17000
    s_nop 0
    buffer_load_dwordx4 v15, s[12:15], s43 offen lds
    s_mov_b32 s12, s62
    s_and_b32 s13, s63, 0xffff
    v_xor_b32 v15, 2, v14
    v_lshl_add_u32 v15, v15, 15, v8
    s_add_u32 s43, s41, 0x0
    s_add_u32 m0, s51, 0x18000
    s_nop 0
    buffer_load_dwordx4 v15, s[12:15], s43 offen lds
    s_add_u32 s43, s41, 0x8000
    s_add_u32 m0, s51, 0x19000
    s_nop 0
    buffer_load_dwordx4 v15, s[12:15], s43 offen lds
    s_add_u32 s43, s41, 0x100000
    s_add_u32 m0, s51, 0x1a000
    s_nop 0
    buffer_load_dwordx4 v15, s[12:15], s43 offen lds
    s_add_u32 s43, s41, 0x108000
    s_add_u32 m0, s51, 0x1b000
    s_nop 0
    buffer_load_dwordx4 v15, s[12:15], s43 offen lds
    s_add_u32 s43, s41, 0x200000
    s_add_u32 m0, s51, 0x1c000
    s_nop 0
    buffer_load_dwordx4 v15, s[12:15], s43 offen lds
    s_add_u32 s43, s41, 0x208000
    s_add_u32 m0, s51, 0x1d000
    s_nop 0
    buffer_load_dwordx4 v15, s[12:15], s43 offen lds
    s_add_u32 s43, s41, 0x300000
    s_add_u32 m0, s51, 0x1e000
    s_nop 0
    buffer_load_dwordx4 v15, s[12:15], s43 offen lds
    s_add_u32 s43, s41, 0x308000
    s_add_u32 m0, s51, 0x1f000
    s_nop 0
    buffer_load_dwordx4 v15, s[12:15], s43 offen lds
    v_xor_b32 v15, 2, v14
    v_lshl_add_u32 v15, v15, 15, v8
    s_add_u32 s43, s41, 0x80000
    s_add_u32 m0, s51, 0x20000
    s_nop 0
    buffer_load_dwordx4 v15, s[12:15], s43 offen lds
    s_add_u32 s43, s41, 0x88000
    s_add_u32 m0, s51, 0x21000
    s_nop 0
    buffer_load_dwordx4 v15, s[12:15], s43 offen lds
    s_add_u32 s43, s41, 0x180000
    s_add_u32 m0, s51, 0x22000
    s_nop 0
    buffer_load_dwordx4 v15, s[12:15], s43 offen lds
    s_add_u32 s43, s41, 0x188000
    s_add_u32 m0, s51, 0x23000
    s_nop 0
    buffer_load_dwordx4 v15, s[12:15], s43 offen lds
    s_add_u32 s43, s41, 0x280000
    s_add_u32 m0, s51, 0x24000
    s_nop 0
    buffer_load_dwordx4 v15, s[12:15], s43 offen lds
    s_add_u32 s43, s41, 0x288000
    s_add_u32 m0, s51, 0x25000
    s_nop 0
    buffer_load_dwordx4 v15, s[12:15], s43 offen lds
    s_add_u32 s43, s41, 0x380000
    s_add_u32 m0, s51, 0x26000
    s_nop 0
    buffer_load_dwordx4 v15, s[12:15], s43 offen lds
    s_add_u32 s43, s41, 0x388000
    s_add_u32 m0, s51, 0x27000
    s_nop 0
    buffer_load_dwordx4 v15, s[12:15], s43 offen lds
    v_and_b32 v4, 2, v3
    v_cmp_ne_u32 vcc, 0, v4
    v_mov_b32 v4, 0x4444
    v_mov_b32 v5, 0xeeee
    v_cndmask_b32 v116, v4, v5, vcc
    v_lshrrev_b32 v5, 1, v2
    v_lshl_add_u32 v4, v6, 3, v5
    s_lshl_b32 s43, s21, 1
    v_add_u32 v4, s43, v4
    v_add_u32 v5, s20, v4
    v_and_b32 v5, 31, v5
    v_lshl_add_u32 v4, v4, 6, v5
    v_and_b32 v5, 1, v2
    v_lshl_add_u32 v4, v4, 1, v5
    v_and_b32 v5, 3, v3
    v_lshl_add_u32 v4, v4, 2, v5
    v_lshlrev_b32 v118, 4, v4
    v_and_b32 v4, 1, v2
    v_lshlrev_b32 v4, 2, v4
    v_and_b32 v7, 2, v2
    v_add_u32 v4, v4, v7
    v_and_b32 v7, 1, v6
    v_add_u32 v4, v4, v7
    v_lshl_add_u32 v4, v4, 2, v5
    v_lshlrev_b32 v4, 2, v4
    s_and_b32 s43, s21, 1
    s_lshl_b32 s43, s43, 12
    s_lshl_b32 s40, s20, 7
    s_add_u32 s43, s43, s40
    v_add_u32 v119, s43, v4
    v_sub_u32 v7, 0, v2
    v_and_b32 v7, 3, v7
    v_xor_b32 v7, v7, v6
    v_lshl_add_u32 v4, v2, 4, v7
    v_and_b32 v5, 3, v3
    v_lshl_add_u32 v4, v4, 2, v5
    s_add_u32 s43, s51, 16384
    v_lshl_add_u32 v120, v4, 2, s43
    v_sub_u32 v7, 0, v6
    v_and_b32 v7, 3, v7
    v_xor_b32 v7, v7, v2
    v_lshl_add_u32 v4, v3, 2, v7
    v_lshlrev_b32 v121, 4, v4
    v_and_b32 v5, 1, v3
    v_lshl_add_u32 v4, v6, 1, v5
    v_lshl_add_u32 v4, v2, 3, v4
    v_lshlrev_b32 v127, 4, v4
    v_and_or_b32 v122, v116, 8, v127
    s_lshl_b32 s43, s21, 13
    s_add_u32 s43, s43, 32768
    v_add_u32 v123, s43, v117
    v_add_u32 v124, 0x10000, v123
    s_mov_b32 s36, 0xcccccccc
    s_mov_b32 s37, 0xcccccccc
    s_mov_b32 s38, 0x00ff00ff
    s_mov_b32 s39, 0x00ff00ff
    s_mov_b32 s34, 0x3e0293ee
    s_mov_b32 s35, 0x49800000
    s_mov_b32 s50, 0x3f803f80
    v_and_b32 v5, 1, v2
    v_or_b32 v5, 0, v5
    v_xor_b32 v5, v5, v6
    v_lshlrev_b32 v5, 8, v5
    v_and_b32 v7, 3, v3
    v_lshl_add_u32 v7, v7, 4, v5
    s_lshl_b32 s43, s21, 2
    v_add_u32 v4, s43, v2
    v_lshl_add_u32 v10, v4, 10, v7
    v_and_b32 v5, 1, v2
    v_or_b32 v5, 2, v5
    v_xor_b32 v5, v5, v6
    v_lshlrev_b32 v5, 8, v5
    v_and_b32 v7, 3, v3
    v_lshl_add_u32 v7, v7, 4, v5
    s_lshl_b32 s43, s21, 2
    v_add_u32 v4, s43, v2
    v_lshl_add_u32 v9, v4, 10, v7
    v_and_b32 v5, 1, v2
    v_lshl_add_u32 v4, v5, 3, v6
    v_lshrrev_b32 v7, 1, v2
    v_lshl_add_u32 v4, v7, 5, v4
    v_lshlrev_b32 v4, 8, v4
    v_lshl_or_b32 v5, v5, 2, v6
    v_lshlrev_b32 v5, 5, v5
    s_lshl_b32 s43, s21, 6
    v_xor_b32 v5, s43, v5
    v_add_u32 v4, v4, v5
    v_and_b32 v5, 3, v3
    v_lshl_add_u32 v4, v5, 3, v4
    v_add_u32 v11, 32768, v4
    s_and_b32 s43, s21, 1
    s_lshl_b32 s43, s43, 12
    v_add_u32 v11, s43, v11
    v_and_b32 v5, 1, v2
    v_lshlrev_b32 v4, 4, v5
    v_lshl_add_u32 v4, v7, 2, v4
    v_and_b32 v7, 1, v6
    v_add_u32 v4, v4, v7
    s_lshl_b32 s43, s21, 5
    v_add_u32 v4, s43, v4
    v_lshlrev_b32 v4, 8, v4
    v_lshl_or_b32 v5, v5, 1, v7
    v_xor_b32 v5, s21, v5
    v_lshl_add_u32 v4, v5, 6, v4
    v_lshrrev_b32 v5, 1, v6
    v_lshl_add_u32 v4, v5, 5, v4
    v_and_b32 v5, 3, v3
    v_lshl_add_u32 v4, v5, 3, v4
    v_add_u32 v12, 32768, v4
    v_mov_b32 v16, -1
    v_mov_b32 v17, -1
    v_mov_b32 v18, -1
    v_mov_b32 v19, -1
    s_lshl_b32 s43, s20, 13
    s_add_u32 s43, s43, 0x100000
    s_and_b32 s40, s21, 1
    s_lshl_b32 s40, s40, 12
    s_add_u32 s29, s43, s40
    s_add_u32 s43, s43, s52
    s_xor_b32 s40, s43, 0x40000
    buffer_store_dwordx4 v[16:19], v117, s[8:11], s43 offen
    buffer_store_dwordx4 v[16:19], v117, s[8:11], s43 offen offset:1024
    buffer_store_dwordx4 v[16:19], v117, s[8:11], s40 offen
    buffer_store_dwordx4 v[16:19], v117, s[8:11], s40 offen offset:1024
    s_mov_b32 s43, 0x12000
    buffer_store_dword v16, v119, s[8:11], s43 offen
    s_mov_b32 s43, 0x14000
    buffer_store_dword v16, v119, s[8:11], s43 offen
    s_mov_b32 s43, 0x16000
    buffer_store_dword v16, v119, s[8:11], s43 offen
    s_load_dwordx2 s[4:5], s[0:1], 8
    s_waitcnt lgkmcnt(0)
    s_and_b32 s5, s5, 0xffff
    s_mov_b32 s6, 8192
    s_mov_b32 s7, 0x20000
    v_and_b32 v20, 1, v2
    v_and_b32 v21, 1, v6
    v_lshl_add_u32 v20, v20, 1, v21
    v_lshlrev_b32 v20, 9, v20
    v_and_b32 v21, 3, v3
    v_lshl_add_u32 v20, v21, 4, v20
    v_and_b32 v21, 2, v2
    v_add_u32 v20, v20, v21
    s_and_b32 s43, s20, 1
    s_lshl_b32 s43, s43, 11
    s_bfe_u32 s40, s20, 0x20001
    s_lshl_b32 s40, s40, 7
    s_add_u32 s43, s43, s40
    s_and_b32 s40, s21, 1
    s_lshl_b32 s40, s40, 6
    s_add_u32 s43, s43, s40
    s_lshr_b32 s40, s20, 3
    s_lshl_b32 s40, s40, 2
    s_add_u32 s43, s43, s40
    v_add_u32 v20, s43, v20
    v_lshlrev_b32 v20, 1, v20
    buffer_load_dword v21, v20, s[4:7], 0 offen
    s_waitcnt vmcnt(32)
    s_barrier
    v_xor_b32 v13, 0x0, v11
    v_add_u32 v13, 0x0, v13
    ds_read_b64_tr_b16 a[32:33], v13
    ds_read_b64_tr_b16 a[34:35], v13 offset:1024
    ds_read_b64_tr_b16 a[36:37], v13 offset:16384
    ds_read_b64_tr_b16 a[38:39], v13 offset:17408
    v_xor_b32 v13, 0x20, v11
    v_add_u32 v13, 0x0, v13
    ds_read_b64_tr_b16 a[40:41], v13
    ds_read_b64_tr_b16 a[42:43], v13 offset:1024
    ds_read_b64_tr_b16 a[44:45], v13 offset:16384
    ds_read_b64_tr_b16 a[46:47], v13 offset:17408
    v_xor_b32 v13, 0x1000, v11
    v_add_u32 v13, 0x0, v13
    ds_read_b64_tr_b16 a[64:65], v13
    ds_read_b64_tr_b16 a[66:67], v13 offset:1024
    ds_read_b64_tr_b16 a[68:69], v13 offset:16384
    ds_read_b64_tr_b16 a[70:71], v13 offset:17408
    v_xor_b32 v13, 0x1020, v11
    v_add_u32 v13, 0x0, v13
    ds_read_b64_tr_b16 a[72:73], v13
    ds_read_b64_tr_b16 a[74:75], v13 offset:1024
    ds_read_b64_tr_b16 a[76:77], v13 offset:16384
    ds_read_b64_tr_b16 a[78:79], v13 offset:17408
    s_waitcnt lgkmcnt(0)
    s_barrier
    s_mov_b32 s12, s64
    s_and_b32 s13, s65, 0xffff
    v_xor_b32 v15, 0, v14
    v_lshl_add_u32 v15, v15, 15, v8
    s_add_u32 s43, s41, 0x0
    s_add_u32 m0, s51, 0x8000
    s_nop 0
    buffer_load_dwordx4 v15, s[12:15], s43 offen lds
    s_add_u32 s43, s41, 0x8000
    s_add_u32 m0, s51, 0x9000
    s_nop 0
    buffer_load_dwordx4 v15, s[12:15], s43 offen lds
    s_add_u32 s43, s41, 0x100000
    s_add_u32 m0, s51, 0xa000
    s_nop 0
    buffer_load_dwordx4 v15, s[12:15], s43 offen lds
    s_add_u32 s43, s41, 0x108000
    s_add_u32 m0, s51, 0xb000
    s_nop 0
    buffer_load_dwordx4 v15, s[12:15], s43 offen lds
    s_add_u32 s43, s41, 0x200000
    s_add_u32 m0, s51, 0xc000
    s_nop 0
    buffer_load_dwordx4 v15, s[12:15], s43 offen lds
    s_add_u32 s43, s41, 0x208000
    s_add_u32 m0, s51, 0xd000
    s_nop 0
    buffer_load_dwordx4 v15, s[12:15], s43 offen lds
    s_add_u32 s43, s41, 0x300000
    s_add_u32 m0, s51, 0xe000
    s_nop 0
    buffer_load_dwordx4 v15, s[12:15], s43 offen lds
    s_add_u32 s43, s41, 0x308000
    s_add_u32 m0, s51, 0xf000
    s_nop 0
    buffer_load_dwordx4 v15, s[12:15], s43 offen lds
    s_waitcnt vmcnt(32)
    s_barrier
    v_xor_b32 v13, 0x0, v11
    v_add_u32 v13, 0x8000, v13
    ds_read_b64_tr_b16 a[48:49], v13
    ds_read_b64_tr_b16 a[50:51], v13 offset:1024
    ds_read_b64_tr_b16 a[52:53], v13 offset:16384
    ds_read_b64_tr_b16 a[54:55], v13 offset:17408
    v_xor_b32 v13, 0x20, v11
    v_add_u32 v13, 0x8000, v13
    ds_read_b64_tr_b16 a[56:57], v13
    ds_read_b64_tr_b16 a[58:59], v13 offset:1024
    ds_read_b64_tr_b16 a[60:61], v13 offset:16384
    ds_read_b64_tr_b16 a[62:63], v13 offset:17408
    v_xor_b32 v13, 0x1000, v11
    v_add_u32 v13, 0x8000, v13
    ds_read_b64_tr_b16 a[80:81], v13
    ds_read_b64_tr_b16 a[82:83], v13 offset:1024
    ds_read_b64_tr_b16 a[84:85], v13 offset:16384
    ds_read_b64_tr_b16 a[86:87], v13 offset:17408
    v_xor_b32 v13, 0x1020, v11
    v_add_u32 v13, 0x8000, v13
    ds_read_b64_tr_b16 a[88:89], v13
    ds_read_b64_tr_b16 a[90:91], v13 offset:1024
    ds_read_b64_tr_b16 a[92:93], v13 offset:16384
    ds_read_b64_tr_b16 a[94:95], v13 offset:17408
    s_waitcnt lgkmcnt(0)
    s_barrier
    v_xor_b32 v15, 0, v14
    v_lshl_add_u32 v15, v15, 15, v8
    s_add_u32 s43, s41, 0x80000
    s_add_u32 m0, s51, 0x10000
    s_nop 0
    buffer_load_dwordx4 v15, s[12:15], s43 offen lds
    s_add_u32 s43, s41, 0x88000
    s_add_u32 m0, s51, 0x11000
    s_nop 0
    buffer_load_dwordx4 v15, s[12:15], s43 offen lds
    s_add_u32 s43, s41, 0x180000
    s_add_u32 m0, s51, 0x12000
    s_nop 0
    buffer_load_dwordx4 v15, s[12:15], s43 offen lds
    s_add_u32 s43, s41, 0x188000
    s_add_u32 m0, s51, 0x13000
    s_nop 0
    buffer_load_dwordx4 v15, s[12:15], s43 offen lds
    s_add_u32 s43, s41, 0x280000
    s_add_u32 m0, s51, 0x14000
    s_nop 0
    buffer_load_dwordx4 v15, s[12:15], s43 offen lds
    s_add_u32 s43, s41, 0x288000
    s_add_u32 m0, s51, 0x15000
    s_nop 0
    buffer_load_dwordx4 v15, s[12:15], s43 offen lds
    s_add_u32 s43, s41, 0x380000
    s_add_u32 m0, s51, 0x16000
    s_nop 0
    buffer_load_dwordx4 v15, s[12:15], s43 offen lds
    s_add_u32 s43, s41, 0x388000
    s_add_u32 m0, s51, 0x17000
    s_nop 0
    buffer_load_dwordx4 v15, s[12:15], s43 offen lds
    s_waitcnt vmcnt(32)
    s_barrier
    v_xor_b32 v13, 0x0, v11
    v_add_u32 v13, 0x10000, v13
    ds_read_b64_tr_b16 a[128:129], v13
    ds_read_b64_tr_b16 a[130:131], v13 offset:1024
    ds_read_b64_tr_b16 a[132:133], v13 offset:16384
    ds_read_b64_tr_b16 a[134:135], v13 offset:17408
    v_xor_b32 v13, 0x20, v11
    v_add_u32 v13, 0x10000, v13
    ds_read_b64_tr_b16 a[136:137], v13
    ds_read_b64_tr_b16 a[138:139], v13 offset:1024
    ds_read_b64_tr_b16 a[140:141], v13 offset:16384
    ds_read_b64_tr_b16 a[142:143], v13 offset:17408
    v_xor_b32 v13, 0x1000, v11
    v_add_u32 v13, 0x10000, v13
    ds_read_b64_tr_b16 a[160:161], v13
    ds_read_b64_tr_b16 a[162:163], v13 offset:1024
    ds_read_b64_tr_b16 a[164:165], v13 offset:16384
    ds_read_b64_tr_b16 a[166:167], v13 offset:17408
    v_xor_b32 v13, 0x1020, v11
    v_add_u32 v13, 0x10000, v13
    ds_read_b64_tr_b16 a[168:169], v13
    ds_read_b64_tr_b16 a[170:171], v13 offset:1024
    ds_read_b64_tr_b16 a[172:173], v13 offset:16384
    ds_read_b64_tr_b16 a[174:175], v13 offset:17408
    s_waitcnt lgkmcnt(0)
    s_barrier
    v_xor_b32 v15, 2, v14
    v_lshl_add_u32 v15, v15, 15, v8
    s_add_u32 s43, s41, 0x0
    s_add_u32 m0, s51, 0x18000
    s_nop 0
    buffer_load_dwordx4 v15, s[12:15], s43 offen lds
    s_add_u32 s43, s41, 0x8000
    s_add_u32 m0, s51, 0x19000
    s_nop 0
    buffer_load_dwordx4 v15, s[12:15], s43 offen lds
    s_add_u32 s43, s41, 0x100000
    s_add_u32 m0, s51, 0x1a000
    s_nop 0
    buffer_load_dwordx4 v15, s[12:15], s43 offen lds
    s_add_u32 s43, s41, 0x108000
    s_add_u32 m0, s51, 0x1b000
    s_nop 0
    buffer_load_dwordx4 v15, s[12:15], s43 offen lds
    s_add_u32 s43, s41, 0x200000
    s_add_u32 m0, s51, 0x1c000
    s_nop 0
    buffer_load_dwordx4 v15, s[12:15], s43 offen lds
    s_add_u32 s43, s41, 0x208000
    s_add_u32 m0, s51, 0x1d000
    s_nop 0
    buffer_load_dwordx4 v15, s[12:15], s43 offen lds
    s_add_u32 s43, s41, 0x300000
    s_add_u32 m0, s51, 0x1e000
    s_nop 0
    buffer_load_dwordx4 v15, s[12:15], s43 offen lds
    s_add_u32 s43, s41, 0x308000
    s_add_u32 m0, s51, 0x1f000
    s_nop 0
    buffer_load_dwordx4 v15, s[12:15], s43 offen lds
    s_waitcnt vmcnt(32)
    s_barrier
    v_xor_b32 v13, 0x0, v11
    v_add_u32 v13, 0x18000, v13
    ds_read_b64_tr_b16 a[144:145], v13
    ds_read_b64_tr_b16 a[146:147], v13 offset:1024
    ds_read_b64_tr_b16 a[148:149], v13 offset:16384
    ds_read_b64_tr_b16 a[150:151], v13 offset:17408
    v_xor_b32 v13, 0x20, v11
    v_add_u32 v13, 0x18000, v13
    ds_read_b64_tr_b16 a[152:153], v13
    ds_read_b64_tr_b16 a[154:155], v13 offset:1024
    ds_read_b64_tr_b16 a[156:157], v13 offset:16384
    ds_read_b64_tr_b16 a[158:159], v13 offset:17408
    v_xor_b32 v13, 0x1000, v11
    v_add_u32 v13, 0x18000, v13
    ds_read_b64_tr_b16 a[176:177], v13
    ds_read_b64_tr_b16 a[178:179], v13 offset:1024
    ds_read_b64_tr_b16 a[180:181], v13 offset:16384
    ds_read_b64_tr_b16 a[182:183], v13 offset:17408
    v_xor_b32 v13, 0x1020, v11
    v_add_u32 v13, 0x18000, v13
    ds_read_b64_tr_b16 a[184:185], v13
    ds_read_b64_tr_b16 a[186:187], v13 offset:1024
    ds_read_b64_tr_b16 a[188:189], v13 offset:16384
    ds_read_b64_tr_b16 a[190:191], v13 offset:17408
    s_waitcnt lgkmcnt(0)
    s_barrier
    v_xor_b32 v15, 2, v14
    v_lshl_add_u32 v15, v15, 15, v8
    s_add_u32 s43, s41, 0x80000
    s_add_u32 m0, s51, 0x20000
    s_nop 0
    buffer_load_dwordx4 v15, s[12:15], s43 offen lds
    s_add_u32 s43, s41, 0x88000
    s_add_u32 m0, s51, 0x21000
    s_nop 0
    buffer_load_dwordx4 v15, s[12:15], s43 offen lds
    s_add_u32 s43, s41, 0x180000
    s_add_u32 m0, s51, 0x22000
    s_nop 0
    buffer_load_dwordx4 v15, s[12:15], s43 offen lds
    s_add_u32 s43, s41, 0x188000
    s_add_u32 m0, s51, 0x23000
    s_nop 0
    buffer_load_dwordx4 v15, s[12:15], s43 offen lds
    s_add_u32 s43, s41, 0x280000
    s_add_u32 m0, s51, 0x24000
    s_nop 0
    buffer_load_dwordx4 v15, s[12:15], s43 offen lds
    s_add_u32 s43, s41, 0x288000
    s_add_u32 m0, s51, 0x25000
    s_nop 0
    buffer_load_dwordx4 v15, s[12:15], s43 offen lds
    s_add_u32 s43, s41, 0x380000
    s_add_u32 m0, s51, 0x26000
    s_nop 0
    buffer_load_dwordx4 v15, s[12:15], s43 offen lds
    s_add_u32 s43, s41, 0x388000
    s_add_u32 m0, s51, 0x27000
    s_nop 0
    buffer_load_dwordx4 v15, s[12:15], s43 offen lds
    s_waitcnt vmcnt(24)
    v_min_u32 v21, 0xfffffffe, v21
    s_mov_b32 s43, 0x10000
    s_mov_b64 exec, s[38:39]
    buffer_store_dword v21, v119, s[8:11], s43 offen
    s_mov_b64 exec, -1
    s_barrier
    v_xor_b32 v13, 0x0, v11
    v_add_u32 v13, 0x0, v13
    ds_read_b64_tr_b16 a[192:193], v13
    ds_read_b64_tr_b16 a[194:195], v13 offset:1024
    ds_read_b64_tr_b16 a[196:197], v13 offset:16384
    ds_read_b64_tr_b16 a[198:199], v13 offset:17408
    v_xor_b32 v13, 0x20, v11
    v_add_u32 v13, 0x0, v13
    ds_read_b64_tr_b16 a[200:201], v13
    ds_read_b64_tr_b16 a[202:203], v13 offset:1024
    ds_read_b64_tr_b16 a[204:205], v13 offset:16384
    ds_read_b64_tr_b16 a[206:207], v13 offset:17408
    v_xor_b32 v13, 0x1000, v11
    v_add_u32 v13, 0x0, v13
    ds_read_b64_tr_b16 a[224:225], v13
    ds_read_b64_tr_b16 a[226:227], v13 offset:1024
    ds_read_b64_tr_b16 a[228:229], v13 offset:16384
    ds_read_b64_tr_b16 a[230:231], v13 offset:17408
    v_xor_b32 v13, 0x1020, v11
    v_add_u32 v13, 0x0, v13
    ds_read_b64_tr_b16 a[232:233], v13
    ds_read_b64_tr_b16 a[234:235], v13 offset:1024
    ds_read_b64_tr_b16 a[236:237], v13 offset:16384
    ds_read_b64_tr_b16 a[238:239], v13 offset:17408
    s_waitcnt lgkmcnt(0)
    s_barrier
    s_mov_b32 s12, s60
    s_and_b32 s13, s61, 0xffff
    v_xor_b32 v15, 0, v14
    v_lshl_add_u32 v15, v15, 15, v8
    s_add_u32 s43, s41, 0x0
    s_add_u32 m0, s51, 0x8000
    s_nop 0
    buffer_load_dwordx4 v15, s[12:15], s43 offen lds
    s_add_u32 s43, s41, 0x8000
    s_add_u32 m0, s51, 0x9000
    s_nop 0
    buffer_load_dwordx4 v15, s[12:15], s43 offen lds
    s_add_u32 s43, s41, 0x100000
    s_add_u32 m0, s51, 0xa000
    s_nop 0
    buffer_load_dwordx4 v15, s[12:15], s43 offen lds
    s_add_u32 s43, s41, 0x108000
    s_add_u32 m0, s51, 0xb000
    s_nop 0
    buffer_load_dwordx4 v15, s[12:15], s43 offen lds
    s_add_u32 s43, s41, 0x200000
    s_add_u32 m0, s51, 0xc000
    s_nop 0
    buffer_load_dwordx4 v15, s[12:15], s43 offen lds
    s_add_u32 s43, s41, 0x208000
    s_add_u32 m0, s51, 0xd000
    s_nop 0
    buffer_load_dwordx4 v15, s[12:15], s43 offen lds
    s_add_u32 s43, s41, 0x300000
    s_add_u32 m0, s51, 0xe000
    s_nop 0
    buffer_load_dwordx4 v15, s[12:15], s43 offen lds
    s_add_u32 s43, s41, 0x308000
    s_add_u32 m0, s51, 0xf000
    s_nop 0
    buffer_load_dwordx4 v15, s[12:15], s43 offen lds
    s_waitcnt vmcnt(24)
    s_barrier
    v_xor_b32 v13, 0x0, v11
    v_add_u32 v13, 0x8000, v13
    ds_read_b64_tr_b16 a[208:209], v13
    ds_read_b64_tr_b16 a[210:211], v13 offset:1024
    ds_read_b64_tr_b16 a[212:213], v13 offset:16384
    ds_read_b64_tr_b16 a[214:215], v13 offset:17408
    v_xor_b32 v13, 0x20, v11
    v_add_u32 v13, 0x8000, v13
    ds_read_b64_tr_b16 a[216:217], v13
    ds_read_b64_tr_b16 a[218:219], v13 offset:1024
    ds_read_b64_tr_b16 a[220:221], v13 offset:16384
    ds_read_b64_tr_b16 a[222:223], v13 offset:17408
    v_xor_b32 v13, 0x1000, v11
    v_add_u32 v13, 0x8000, v13
    ds_read_b64_tr_b16 a[240:241], v13
    ds_read_b64_tr_b16 a[242:243], v13 offset:1024
    ds_read_b64_tr_b16 a[244:245], v13 offset:16384
    ds_read_b64_tr_b16 a[246:247], v13 offset:17408
    v_xor_b32 v13, 0x1020, v11
    v_add_u32 v13, 0x8000, v13
    ds_read_b64_tr_b16 a[248:249], v13
    ds_read_b64_tr_b16 a[250:251], v13 offset:1024
    ds_read_b64_tr_b16 a[252:253], v13 offset:16384
    ds_read_b64_tr_b16 a[254:255], v13 offset:17408
    s_waitcnt lgkmcnt(0)
    s_barrier
    s_mov_b32 s12, s62
    s_and_b32 s13, s63, 0xffff
    v_xor_b32 v15, 0, v14
    v_lshl_add_u32 v15, v15, 15, v8
    s_add_u32 s43, s41, 0x0
    s_add_u32 m0, s51, 0x10000
    s_nop 0
    buffer_load_dwordx4 v15, s[12:15], s43 offen lds
    s_add_u32 s43, s41, 0x8000
    s_add_u32 m0, s51, 0x11000
    s_nop 0
    buffer_load_dwordx4 v15, s[12:15], s43 offen lds
    s_add_u32 s43, s41, 0x100000
    s_add_u32 m0, s51, 0x12000
    s_nop 0
    buffer_load_dwordx4 v15, s[12:15], s43 offen lds
    s_add_u32 s43, s41, 0x108000
    s_add_u32 m0, s51, 0x13000
    s_nop 0
    buffer_load_dwordx4 v15, s[12:15], s43 offen lds
    s_add_u32 s43, s41, 0x200000
    s_add_u32 m0, s51, 0x14000
    s_nop 0
    buffer_load_dwordx4 v15, s[12:15], s43 offen lds
    s_add_u32 s43, s41, 0x208000
    s_add_u32 m0, s51, 0x15000
    s_nop 0
    buffer_load_dwordx4 v15, s[12:15], s43 offen lds
    s_add_u32 s43, s41, 0x300000
    s_add_u32 m0, s51, 0x16000
    s_nop 0
    buffer_load_dwordx4 v15, s[12:15], s43 offen lds
    s_add_u32 s43, s41, 0x308000
    s_add_u32 m0, s51, 0x17000
    s_nop 0
    buffer_load_dwordx4 v15, s[12:15], s43 offen lds
    s_waitcnt vmcnt(24)
    s_barrier
    v_xor_b32 v13, 0x0, v11
    v_add_u32 v13, 0x10000, v13
    ds_read_b64_tr_b16 v[128:129], v13
    ds_read_b64_tr_b16 v[130:131], v13 offset:1024
    ds_read_b64_tr_b16 v[132:133], v13 offset:16384
    ds_read_b64_tr_b16 v[134:135], v13 offset:17408
    v_xor_b32 v13, 0x20, v11
    v_add_u32 v13, 0x10000, v13
    ds_read_b64_tr_b16 v[136:137], v13
    ds_read_b64_tr_b16 v[138:139], v13 offset:1024
    ds_read_b64_tr_b16 v[140:141], v13 offset:16384
    ds_read_b64_tr_b16 v[142:143], v13 offset:17408
    v_xor_b32 v13, 0x1000, v11
    v_add_u32 v13, 0x10000, v13
    ds_read_b64_tr_b16 v[160:161], v13
    ds_read_b64_tr_b16 v[162:163], v13 offset:1024
    ds_read_b64_tr_b16 v[164:165], v13 offset:16384
    ds_read_b64_tr_b16 v[166:167], v13 offset:17408
    v_xor_b32 v13, 0x1020, v11
    v_add_u32 v13, 0x10000, v13
    ds_read_b64_tr_b16 v[168:169], v13
    ds_read_b64_tr_b16 v[170:171], v13 offset:1024
    ds_read_b64_tr_b16 v[172:173], v13 offset:16384
    ds_read_b64_tr_b16 v[174:175], v13 offset:17408
    s_waitcnt lgkmcnt(0)
    s_barrier
    s_mov_b32 s12, s66
    s_and_b32 s13, s67, 0xffff
    s_add_u32 s43, s42, 0x0
    s_add_u32 m0, s51, 0x18000
    s_nop 0
    buffer_load_dwordx4 v10, s[12:15], s43 offen lds
    s_add_u32 s43, s42, 0x4000
    s_add_u32 m0, s51, 0x19000
    s_nop 0
    buffer_load_dwordx4 v9, s[12:15], s43 offen lds
    s_add_u32 s43, s42, 0x8000
    s_add_u32 m0, s51, 0x1a000
    s_nop 0
    buffer_load_dwordx4 v10, s[12:15], s43 offen lds
    s_add_u32 s43, s42, 0xc000
    s_add_u32 m0, s51, 0x1b000
    s_nop 0
    buffer_load_dwordx4 v9, s[12:15], s43 offen lds
    s_add_u32 s43, s42, 0x10000
    s_add_u32 m0, s51, 0x1c000
    s_nop 0
    buffer_load_dwordx4 v10, s[12:15], s43 offen lds
    s_add_u32 s43, s42, 0x14000
    s_add_u32 m0, s51, 0x1d000
    s_nop 0
    buffer_load_dwordx4 v9, s[12:15], s43 offen lds
    s_add_u32 s43, s42, 0x18000
    s_add_u32 m0, s51, 0x1e000
    s_nop 0
    buffer_load_dwordx4 v10, s[12:15], s43 offen lds
    s_add_u32 s43, s42, 0x1c000
    s_add_u32 m0, s51, 0x1f000
    s_nop 0
    buffer_load_dwordx4 v9, s[12:15], s43 offen lds
    s_waitcnt vmcnt(24)
    s_barrier
    v_xor_b32 v13, 0x0, v11
    v_add_u32 v13, 0x18000, v13
    ds_read_b64_tr_b16 v[144:145], v13
    ds_read_b64_tr_b16 v[146:147], v13 offset:1024
    ds_read_b64_tr_b16 v[148:149], v13 offset:16384
    ds_read_b64_tr_b16 v[150:151], v13 offset:17408
    v_xor_b32 v13, 0x20, v11
    v_add_u32 v13, 0x18000, v13
    ds_read_b64_tr_b16 v[152:153], v13
    ds_read_b64_tr_b16 v[154:155], v13 offset:1024
    ds_read_b64_tr_b16 v[156:157], v13 offset:16384
    ds_read_b64_tr_b16 v[158:159], v13 offset:17408
    v_xor_b32 v13, 0x1000, v11
    v_add_u32 v13, 0x18000, v13
    ds_read_b64_tr_b16 v[176:177], v13
    ds_read_b64_tr_b16 v[178:179], v13 offset:1024
    ds_read_b64_tr_b16 v[180:181], v13 offset:16384
    ds_read_b64_tr_b16 v[182:183], v13 offset:17408
    v_xor_b32 v13, 0x1020, v11
    v_add_u32 v13, 0x18000, v13
    ds_read_b64_tr_b16 v[184:185], v13
    ds_read_b64_tr_b16 v[186:187], v13 offset:1024
    ds_read_b64_tr_b16 v[188:189], v13 offset:16384
    ds_read_b64_tr_b16 v[190:191], v13 offset:17408
    s_waitcnt lgkmcnt(0)
    s_barrier
    s_add_u32 s43, s42, 0x40
    s_add_u32 m0, s51, 0x20000
    s_nop 0
    buffer_load_dwordx4 v10, s[12:15], s43 offen lds
    s_add_u32 s43, s42, 0x4040
    s_add_u32 m0, s51, 0x21000
    s_nop 0
    buffer_load_dwordx4 v9, s[12:15], s43 offen lds
    s_add_u32 s43, s42, 0x8040
    s_add_u32 m0, s51, 0x22000
    s_nop 0
    buffer_load_dwordx4 v10, s[12:15], s43 offen lds
    s_add_u32 s43, s42, 0xc040
    s_add_u32 m0, s51, 0x23000
    s_nop 0
    buffer_load_dwordx4 v9, s[12:15], s43 offen lds
    s_add_u32 s43, s42, 0x10040
    s_add_u32 m0, s51, 0x24000
    s_nop 0
    buffer_load_dwordx4 v10, s[12:15], s43 offen lds
    s_add_u32 s43, s42, 0x14040
    s_add_u32 m0, s51, 0x25000
    s_nop 0
    buffer_load_dwordx4 v9, s[12:15], s43 offen lds
    s_add_u32 s43, s42, 0x18040
    s_add_u32 m0, s51, 0x26000
    s_nop 0
    buffer_load_dwordx4 v10, s[12:15], s43 offen lds
    s_add_u32 s43, s42, 0x1c040
    s_add_u32 m0, s51, 0x27000
    s_nop 0
    buffer_load_dwordx4 v9, s[12:15], s43 offen lds
    s_waitcnt vmcnt(24)
    s_barrier
    v_xor_b32 v13, 0x0, v11
    v_add_u32 v13, 0x0, v13
    ds_read_b64_tr_b16 v[32:33], v13
    ds_read_b64_tr_b16 v[34:35], v13 offset:1024
    ds_read_b64_tr_b16 v[36:37], v13 offset:16384
    ds_read_b64_tr_b16 v[38:39], v13 offset:17408
    v_xor_b32 v13, 0x20, v11
    v_add_u32 v13, 0x0, v13
    ds_read_b64_tr_b16 v[40:41], v13
    ds_read_b64_tr_b16 v[42:43], v13 offset:1024
    ds_read_b64_tr_b16 v[44:45], v13 offset:16384
    ds_read_b64_tr_b16 v[46:47], v13 offset:17408
    v_xor_b32 v13, 0x1000, v11
    v_add_u32 v13, 0x0, v13
    ds_read_b64_tr_b16 a[0:1], v13
    ds_read_b64_tr_b16 a[2:3], v13 offset:1024
    ds_read_b64_tr_b16 a[4:5], v13 offset:16384
    ds_read_b64_tr_b16 a[6:7], v13 offset:17408
    v_xor_b32 v13, 0x1020, v11
    v_add_u32 v13, 0x0, v13
    ds_read_b64_tr_b16 a[8:9], v13
    ds_read_b64_tr_b16 a[10:11], v13 offset:1024
    ds_read_b64_tr_b16 a[12:13], v13 offset:16384
    ds_read_b64_tr_b16 a[14:15], v13 offset:17408
    s_waitcnt lgkmcnt(0)
    s_barrier
    s_mov_b32 s12, s60
    s_and_b32 s13, s61, 0xffff
    v_xor_b32 v15, 0, v14
    v_lshl_add_u32 v15, v15, 15, v8
    s_add_u32 s43, s41, 0x80000
    s_add_u32 m0, s51, 0x8000
    s_nop 0
    buffer_load_dwordx4 v15, s[12:15], s43 offen lds
    s_add_u32 s43, s41, 0x88000
    s_add_u32 m0, s51, 0x9000
    s_nop 0
    buffer_load_dwordx4 v15, s[12:15], s43 offen lds
    s_add_u32 s43, s41, 0x180000
    s_add_u32 m0, s51, 0xa000
    s_nop 0
    buffer_load_dwordx4 v15, s[12:15], s43 offen lds
    s_add_u32 s43, s41, 0x188000
    s_add_u32 m0, s51, 0xb000
    s_nop 0
    buffer_load_dwordx4 v15, s[12:15], s43 offen lds
    s_add_u32 s43, s41, 0x280000
    s_add_u32 m0, s51, 0xc000
    s_nop 0
    buffer_load_dwordx4 v15, s[12:15], s43 offen lds
    s_add_u32 s43, s41, 0x288000
    s_add_u32 m0, s51, 0xd000
    s_nop 0
    buffer_load_dwordx4 v15, s[12:15], s43 offen lds
    s_add_u32 s43, s41, 0x380000
    s_add_u32 m0, s51, 0xe000
    s_nop 0
    buffer_load_dwordx4 v15, s[12:15], s43 offen lds
    s_add_u32 s43, s41, 0x388000
    s_add_u32 m0, s51, 0xf000
    s_nop 0
    buffer_load_dwordx4 v15, s[12:15], s43 offen lds
    s_waitcnt vmcnt(24)
    s_barrier
    s_cmp_lg_u32 s21, 0
    s_cbranch_scc1 L_arr_4
    v_mov_b32 v23, 1
    s_mov_b64 exec, 1
    buffer_atomic_add v23, off, s[16:19], 0 offset:4
    s_mov_b64 exec, -1
L_arr_4:
    v_xor_b32 v13, 0x0, v11
    v_add_u32 v13, 0x8000, v13
    ds_read_b64_tr_b16 v[64:65], v13
    ds_read_b64_tr_b16 v[66:67], v13 offset:1024
    ds_read_b64_tr_b16 v[68:69], v13 offset:16384
    ds_read_b64_tr_b16 v[70:71], v13 offset:17408
    v_xor_b32 v13, 0x20, v11
    v_add_u32 v13, 0x8000, v13
    ds_read_b64_tr_b16 v[72:73], v13
    ds_read_b64_tr_b16 v[74:75], v13 offset:1024
    ds_read_b64_tr_b16 v[76:77], v13 offset:16384
    ds_read_b64_tr_b16 v[78:79], v13 offset:17408
    v_xor_b32 v13, 0x1000, v11
    v_add_u32 v13, 0x8000, v13
    ds_read_b64_tr_b16 a[96:97], v13
    ds_read_b64_tr_b16 a[98:99], v13 offset:1024
    ds_read_b64_tr_b16 a[100:101], v13 offset:16384
    ds_read_b64_tr_b16 a[102:103], v13 offset:17408
    v_xor_b32 v13, 0x1020, v11
    v_add_u32 v13, 0x8000, v13
    ds_read_b64_tr_b16 a[104:105], v13
    ds_read_b64_tr_b16 a[106:107], v13 offset:1024
    ds_read_b64_tr_b16 a[108:109], v13 offset:16384
    ds_read_b64_tr_b16 a[110:111], v13 offset:17408
    s_waitcnt lgkmcnt(0)
    s_barrier
    s_mov_b32 s12, s62
    s_and_b32 s13, s63, 0xffff
    v_xor_b32 v15, 0, v14
    v_lshl_add_u32 v15, v15, 15, v8
    s_add_u32 s43, s41, 0x80000
    s_add_u32 m0, s51, 0x10000
    s_nop 0
    buffer_load_dwordx4 v15, s[12:15], s43 offen lds
    s_add_u32 s43, s41, 0x88000
    s_add_u32 m0, s51, 0x11000
    s_nop 0
    buffer_load_dwordx4 v15, s[12:15], s43 offen lds
    s_add_u32 s43, s41, 0x180000
    s_add_u32 m0, s51, 0x12000
    s_nop 0
    buffer_load_dwordx4 v15, s[12:15], s43 offen lds
    s_add_u32 s43, s41, 0x188000
    s_add_u32 m0, s51, 0x13000
    s_nop 0
    buffer_load_dwordx4 v15, s[12:15], s43 offen lds
    s_add_u32 s43, s41, 0x280000
    s_add_u32 m0, s51, 0x14000
    s_nop 0
    buffer_load_dwordx4 v15, s[12:15], s43 offen lds
    s_add_u32 s43, s41, 0x288000
    s_add_u32 m0, s51, 0x15000
    s_nop 0
    buffer_load_dwordx4 v15, s[12:15], s43 offen lds
    s_add_u32 s43, s41, 0x380000
    s_add_u32 m0, s51, 0x16000
    s_nop 0
    buffer_load_dwordx4 v15, s[12:15], s43 offen lds
    s_add_u32 s43, s41, 0x388000
    s_add_u32 m0, s51, 0x17000
    s_nop 0
    buffer_load_dwordx4 v15, s[12:15], s43 offen lds
    s_waitcnt vmcnt(24)
    s_barrier
    v_xor_b32 v13, 0x0, v12
    v_add_u32 v13, 0x10000, v13
    ds_read_b64_tr_b16 v[192:193], v13
    ds_read_b64_tr_b16 v[194:195], v13 offset:512
    ds_read_b64_tr_b16 v[196:197], v13 offset:2048
    ds_read_b64_tr_b16 v[198:199], v13 offset:2560
    v_xor_b32 v13, 0x2000, v12
    v_add_u32 v13, 0x10000, v13
    ds_read_b64_tr_b16 v[200:201], v13
    ds_read_b64_tr_b16 v[202:203], v13 offset:512
    ds_read_b64_tr_b16 v[204:205], v13 offset:2048
    ds_read_b64_tr_b16 v[206:207], v13 offset:2560
    s_waitcnt lgkmcnt(0)
    v_xor_b32 v13, 0x4000, v12
    v_add_u32 v13, 0x10000, v13
    ds_read_b64_tr_b16 v[208:209], v13
    ds_read_b64_tr_b16 v[210:211], v13 offset:512
    ds_read_b64_tr_b16 v[212:213], v13 offset:2048
    ds_read_b64_tr_b16 v[214:215], v13 offset:2560
    v_xor_b32 v13, 0x6000, v12
    v_add_u32 v13, 0x10000, v13
    ds_read_b64_tr_b16 v[216:217], v13
    ds_read_b64_tr_b16 v[218:219], v13 offset:512
    ds_read_b64_tr_b16 v[220:221], v13 offset:2048
    ds_read_b64_tr_b16 v[222:223], v13 offset:2560
    s_waitcnt lgkmcnt(0)
    s_barrier
    s_mov_b32 s12, s66
    s_and_b32 s13, s67, 0xffff
    s_add_u32 s43, s42, 0x80
    s_add_u32 m0, s51, 0x18000
    s_nop 0
    buffer_load_dwordx4 v10, s[12:15], s43 offen lds
    s_add_u32 s43, s42, 0x4080
    s_add_u32 m0, s51, 0x19000
    s_nop 0
    buffer_load_dwordx4 v9, s[12:15], s43 offen lds
    s_add_u32 s43, s42, 0x8080
    s_add_u32 m0, s51, 0x1a000
    s_nop 0
    buffer_load_dwordx4 v10, s[12:15], s43 offen lds
    s_add_u32 s43, s42, 0xc080
    s_add_u32 m0, s51, 0x1b000
    s_nop 0
    buffer_load_dwordx4 v9, s[12:15], s43 offen lds
    s_add_u32 s43, s42, 0x10080
    s_add_u32 m0, s51, 0x1c000
    s_nop 0
    buffer_load_dwordx4 v10, s[12:15], s43 offen lds
    s_add_u32 s43, s42, 0x14080
    s_add_u32 m0, s51, 0x1d000
    s_nop 0
    buffer_load_dwordx4 v9, s[12:15], s43 offen lds
    s_add_u32 s43, s42, 0x18080
    s_add_u32 m0, s51, 0x1e000
    s_nop 0
    buffer_load_dwordx4 v10, s[12:15], s43 offen lds
    s_add_u32 s43, s42, 0x1c080
    s_add_u32 m0, s51, 0x1f000
    s_nop 0
    buffer_load_dwordx4 v9, s[12:15], s43 offen lds
    s_waitcnt vmcnt(24)
    s_barrier
    v_xor_b32 v13, 0x0, v12
    v_add_u32 v13, 0x18000, v13
    ds_read_b64_tr_b16 v[224:225], v13
    ds_read_b64_tr_b16 v[226:227], v13 offset:512
    ds_read_b64_tr_b16 v[228:229], v13 offset:2048
    ds_read_b64_tr_b16 v[230:231], v13 offset:2560
    v_xor_b32 v13, 0x2000, v12
    v_add_u32 v13, 0x18000, v13
    ds_read_b64_tr_b16 v[232:233], v13
    ds_read_b64_tr_b16 v[234:235], v13 offset:512
    ds_read_b64_tr_b16 v[236:237], v13 offset:2048
    ds_read_b64_tr_b16 v[238:239], v13 offset:2560
    s_waitcnt lgkmcnt(0)
    v_xor_b32 v13, 0x4000, v12
    v_add_u32 v13, 0x18000, v13
    ds_read_b64_tr_b16 v[240:241], v13
    ds_read_b64_tr_b16 v[242:243], v13 offset:512
    ds_read_b64_tr_b16 v[244:245], v13 offset:2048
    ds_read_b64_tr_b16 v[246:247], v13 offset:2560
    v_xor_b32 v13, 0x6000, v12
    v_add_u32 v13, 0x18000, v13
    ds_read_b64_tr_b16 v[248:249], v13
    ds_read_b64_tr_b16 v[250:251], v13 offset:512
    ds_read_b64_tr_b16 v[252:253], v13 offset:2048
    ds_read_b64_tr_b16 v[254:255], v13 offset:2560
    s_waitcnt lgkmcnt(0)
    s_barrier
    s_lshl_b32 s43, s20, 13
    s_add_u32 s43, s43, 0x100000
    s_add_u32 s43, s43, s52
    s_xor_b32 s40, s43, 0x40000
    buffer_load_dwordx4 v[28:31], v117, s[8:11], s43 offen sc1
    buffer_load_dwordx4 v[28:31], v117, s[8:11], s43 offen offset:1024 sc1
    buffer_load_dwordx4 v[28:31], v117, s[8:11], s40 offen sc1
    buffer_load_dwordx4 v[28:31], v117, s[8:11], s40 offen offset:1024 sc1
    s_mov_b32 s43, 0x10000
    buffer_load_dword v28, v119, s[8:11], s43 offen sc1
    s_mov_b32 s43, 0x12000
    buffer_load_dword v28, v119, s[8:11], s43 offen sc1
    s_mov_b32 s43, 0x14000
    buffer_load_dword v28, v119, s[8:11], s43 offen sc1
    s_mov_b32 s43, 0x16000
    buffer_load_dword v28, v119, s[8:11], s43 offen sc1
    s_add_u32 s43, s42, 0xc0
    s_add_u32 m0, s51, 0x20000
    s_nop 0
    buffer_load_dwordx4 v10, s[12:15], s43 offen lds
    s_add_u32 s43, s42, 0x40c0
    s_add_u32 m0, s51, 0x21000
    s_nop 0
    buffer_load_dwordx4 v9, s[12:15], s43 offen lds
    s_add_u32 s43, s42, 0x80c0
    s_add_u32 m0, s51, 0x22000
    s_nop 0
    buffer_load_dwordx4 v10, s[12:15], s43 offen lds
    s_add_u32 s43, s42, 0xc0c0
    s_add_u32 m0, s51, 0x23000
    s_nop 0
    buffer_load_dwordx4 v9, s[12:15], s43 offen lds
    s_add_u32 s43, s42, 0x100c0
    s_add_u32 m0, s51, 0x24000
    s_nop 0
    buffer_load_dwordx4 v10, s[12:15], s43 offen lds
    s_add_u32 s43, s42, 0x140c0
    s_add_u32 m0, s51, 0x25000
    s_nop 0
    buffer_load_dwordx4 v9, s[12:15], s43 offen lds
    s_add_u32 s43, s42, 0x180c0
    s_add_u32 m0, s51, 0x26000
    s_nop 0
    buffer_load_dwordx4 v10, s[12:15], s43 offen lds
    s_add_u32 s43, s42, 0x1c0c0
    s_add_u32 m0, s51, 0x27000
    s_nop 0
    buffer_load_dwordx4 v9, s[12:15], s43 offen lds
    s_waitcnt vmcnt(32)
    s_barrier
    v_xor_b32 v13, 0x0, v11
    v_add_u32 v13, 0x0, v13
    ds_read_b64_tr_b16 v[48:49], v13
    ds_read_b64_tr_b16 v[50:51], v13 offset:1024
    ds_read_b64_tr_b16 v[52:53], v13 offset:16384
    ds_read_b64_tr_b16 v[54:55], v13 offset:17408
    v_xor_b32 v13, 0x20, v11
    v_add_u32 v13, 0x0, v13
    ds_read_b64_tr_b16 v[56:57], v13
    ds_read_b64_tr_b16 v[58:59], v13 offset:1024
    ds_read_b64_tr_b16 v[60:61], v13 offset:16384
    ds_read_b64_tr_b16 v[62:63], v13 offset:17408
    v_xor_b32 v13, 0x1000, v11
    v_add_u32 v13, 0x0, v13
    ds_read_b64_tr_b16 a[16:17], v13
    ds_read_b64_tr_b16 a[18:19], v13 offset:1024
    ds_read_b64_tr_b16 a[20:21], v13 offset:16384
    ds_read_b64_tr_b16 a[22:23], v13 offset:17408
    v_xor_b32 v13, 0x1020, v11
    v_add_u32 v13, 0x0, v13
    ds_read_b64_tr_b16 a[24:25], v13
    ds_read_b64_tr_b16 a[26:27], v13 offset:1024
    ds_read_b64_tr_b16 a[28:29], v13 offset:16384
    ds_read_b64_tr_b16 a[30:31], v13 offset:17408
    s_waitcnt lgkmcnt(0)
    s_barrier
    ds_write_b128 v123, v[32:35]
    ds_write_b128 v123, v[36:39] offset:1024
    ds_write_b128 v123, v[40:43] offset:2048
    ds_write_b128 v123, v[44:47] offset:3072
    ds_write_b128 v123, v[48:51] offset:4096
    ds_write_b128 v123, v[52:55] offset:5120
    ds_write_b128 v123, v[56:59] offset:6144
    ds_write_b128 v123, v[60:63] offset:7168
    s_waitcnt vmcnt(24)
    s_barrier
    v_xor_b32 v13, 0x0, v11
    v_add_u32 v13, 0x8000, v13
    ds_read_b64_tr_b16 v[80:81], v13
    ds_read_b64_tr_b16 v[82:83], v13 offset:1024
    ds_read_b64_tr_b16 v[84:85], v13 offset:16384
    ds_read_b64_tr_b16 v[86:87], v13 offset:17408
    v_xor_b32 v13, 0x20, v11
    v_add_u32 v13, 0x8000, v13
    ds_read_b64_tr_b16 v[88:89], v13
    ds_read_b64_tr_b16 v[90:91], v13 offset:1024
    ds_read_b64_tr_b16 v[92:93], v13 offset:16384
    ds_read_b64_tr_b16 v[94:95], v13 offset:17408
    v_xor_b32 v13, 0x1000, v11
    v_add_u32 v13, 0x8000, v13
    ds_read_b64_tr_b16 a[112:113], v13
    ds_read_b64_tr_b16 a[114:115], v13 offset:1024
    ds_read_b64_tr_b16 a[116:117], v13 offset:16384
    ds_read_b64_tr_b16 a[118:119], v13 offset:17408
    v_xor_b32 v13, 0x1020, v11
    v_add_u32 v13, 0x8000, v13
    ds_read_b64_tr_b16 a[120:121], v13
    ds_read_b64_tr_b16 a[122:123], v13 offset:1024
    ds_read_b64_tr_b16 a[124:125], v13 offset:16384
    ds_read_b64_tr_b16 a[126:127], v13 offset:17408
    s_waitcnt lgkmcnt(0)
    s_barrier
    ds_write_b128 v123, v[64:67] offset:32768
    ds_write_b128 v123, v[68:71] offset:33792
    ds_write_b128 v123, v[72:75] offset:34816
    ds_write_b128 v123, v[76:79] offset:35840
    ds_write_b128 v123, v[80:83] offset:36864
    ds_write_b128 v123, v[84:87] offset:37888
    ds_write_b128 v123, v[88:91] offset:38912
    ds_write_b128 v123, v[92:95] offset:39936
    s_waitcnt vmcnt(16)
    s_barrier
    v_xor_b32 v13, 0x0, v12
    v_add_u32 v13, 0x10000, v13
    ds_read_b64_tr_b16 v[32:33], v13
    ds_read_b64_tr_b16 v[34:35], v13 offset:512
    ds_read_b64_tr_b16 v[36:37], v13 offset:2048
    ds_read_b64_tr_b16 v[38:39], v13 offset:2560
    v_xor_b32 v13, 0x2000, v12
    v_add_u32 v13, 0x10000, v13
    ds_read_b64_tr_b16 v[40:41], v13
    ds_read_b64_tr_b16 v[42:43], v13 offset:512
    ds_read_b64_tr_b16 v[44:45], v13 offset:2048
    ds_read_b64_tr_b16 v[46:47], v13 offset:2560
    s_waitcnt lgkmcnt(0)
    v_xor_b32 v13, 0x4000, v12
    v_add_u32 v13, 0x10000, v13
    ds_read_b64_tr_b16 v[48:49], v13
    ds_read_b64_tr_b16 v[50:51], v13 offset:512
    ds_read_b64_tr_b16 v[52:53], v13 offset:2048
    ds_read_b64_tr_b16 v[54:55], v13 offset:2560
    v_xor_b32 v13, 0x6000, v12
    v_add_u32 v13, 0x10000, v13
    ds_read_b64_tr_b16 v[56:57], v13
    ds_read_b64_tr_b16 v[58:59], v13 offset:512
    ds_read_b64_tr_b16 v[60:61], v13 offset:2048
    ds_read_b64_tr_b16 v[62:63], v13 offset:2560
    s_waitcnt lgkmcnt(0)
    s_barrier
    ds_write_b128 v124, v[32:35]
    ds_write_b128 v124, v[36:39] offset:1024
    ds_write_b128 v124, v[40:43] offset:2048
    ds_write_b128 v124, v[44:47] offset:3072
    ds_write_b128 v124, v[48:51] offset:4096
    ds_write_b128 v124, v[52:55] offset:5120
    ds_write_b128 v124, v[56:59] offset:6144
    ds_write_b128 v124, v[60:63] offset:7168
    s_waitcnt vmcnt(0)
    v_min_u32 v21, 0xfffffffe, v21
    s_mov_b32 s43, 0x10000
    s_mov_b64 exec, s[38:39]
    buffer_store_dword v21, v119, s[8:11], s43 offen
    s_mov_b64 exec, -1
    v_mov_b32 v16, -1
    v_mov_b32 v17, -1
    v_mov_b32 v18, -1
    v_mov_b32 v19, -1
    s_lshl_b32 s43, s20, 13
    s_add_u32 s43, s43, 0x100000
    s_and_b32 s40, s21, 1
    s_lshl_b32 s40, s40, 12
    s_add_u32 s29, s43, s40
    s_add_u32 s43, s43, s52
    s_xor_b32 s40, s43, 0x40000
    buffer_store_dwordx4 v[16:19], v117, s[8:11], s40 offen
    buffer_store_dwordx4 v[16:19], v117, s[8:11], s40 offen offset:1024
    s_mov_b32 s43, 0x12000
    buffer_store_dword v16, v119, s[8:11], s43 offen
    s_mov_b32 s43, 0x14000
    buffer_store_dword v16, v119, s[8:11], s43 offen
    s_mov_b32 s43, 0x16000
    buffer_store_dword v16, v119, s[8:11], s43 offen
    s_barrier
    v_xor_b32 v13, 0x0, v12
    v_add_u32 v13, 0x18000, v13
    ds_read_b64_tr_b16 v[64:65], v13
    ds_read_b64_tr_b16 v[66:67], v13 offset:512
    ds_read_b64_tr_b16 v[68:69], v13 offset:2048
    ds_read_b64_tr_b16 v[70:71], v13 offset:2560
    v_xor_b32 v13, 0x2000, v12
    v_add_u32 v13, 0x18000, v13
    ds_read_b64_tr_b16 v[72:73], v13
    ds_read_b64_tr_b16 v[74:75], v13 offset:512
    ds_read_b64_tr_b16 v[76:77], v13 offset:2048
    ds_read_b64_tr_b16 v[78:79], v13 offset:2560
    s_waitcnt lgkmcnt(0)
    v_xor_b32 v13, 0x4000, v12
    v_add_u32 v13, 0x18000, v13
    ds_read_b64_tr_b16 v[80:81], v13
    ds_read_b64_tr_b16 v[82:83], v13 offset:512
    ds_read_b64_tr_b16 v[84:85], v13 offset:2048
    ds_read_b64_tr_b16 v[86:87], v13 offset:2560
    v_xor_b32 v13, 0x6000, v12
    v_add_u32 v13, 0x18000, v13
    ds_read_b64_tr_b16 v[88:89], v13
    ds_read_b64_tr_b16 v[90:91], v13 offset:512
    ds_read_b64_tr_b16 v[92:93], v13 offset:2048
    ds_read_b64_tr_b16 v[94:95], v13 offset:2560
    s_waitcnt lgkmcnt(0)
    s_barrier
    ds_write_b128 v124, v[64:67] offset:32768
    ds_write_b128 v124, v[68:71] offset:33792
    ds_write_b128 v124, v[72:75] offset:34816
    ds_write_b128 v124, v[76:79] offset:35840
    ds_write_b128 v124, v[80:83] offset:36864
    ds_write_b128 v124, v[84:87] offset:37888
    ds_write_b128 v124, v[88:91] offset:38912
    ds_write_b128 v124, v[92:95] offset:39936
    s_waitcnt lgkmcnt(0)
    s_mov_b32 s96, 0
L_mode_5:
    buffer_load_dwordx2 v[2:3], off, s[92:95], 0 offset:36 sc1
    s_waitcnt vmcnt(0)
    v_readfirstlane_b32 s87, v2
    v_readfirstlane_b32 s97, v3
    s_nop 0
    s_min_u32 s97, s97, s87
    s_cmp_lg_u32 s97, 0
    s_cbranch_scc1 L_moded_6
    s_sleep 4
    s_add_u32 s96, s96, 1
    s_cmp_lg_u32 s96, 0x100
    s_cbranch_scc1 L_modef_7
    v_mov_b32 v2, 2
    v_mov_b32 v3, 0
    s_mov_b64 exec, 1
    buffer_atomic_cmpswap v[2:3], off, s[92:95], 0 offset:36
    s_mov_b64 exec, -1
L_modef_7:
    s_cmp_lt_u32 s96, 0x10000
    s_cbranch_scc1 L_mode_5
L_moded_6:
    s_cmp_lg_u32 s87, 1
    s_cbranch_scc1 L_fallback
    v_lshrrev_b32 v1, 4, v117
    v_and_b32 v2, 15, v1
    v_lshrrev_b32 v1, 4, v1
    v_lshlrev_b32 v1, 11, v1
    v_lshl_add_u32 v1, v2, 2, v1
    s_lshl_b32 s43, s20, 6
    s_add_u32 s43, s43, 0x2000
    s_cmp_lg_u32 s100, 0
    s_cbranch_scc1 L_polls_10
    s_mov_b32 exec_lo, 0x10001
    s_mov_b32 exec_hi, 0
    s_mov_b32 s96, 0
L_poll_8:
    buffer_load_dword v2, v1, s[8:11], s43 offen sc1
    s_waitcnt vmcnt(0)
    v_cmp_gt_u32 vcc, 1, v2
    s_cbranch_vccz L_polld_9
    s_sleep 4
    s_add_u32 s96, s96, 1
    s_cmp_lt_u32 s96, 0x10000
    s_cbranch_scc1 L_poll_8
L_polld_9:
    s_mov_b64 exec, -1
L_polls_10:
    s_barrier
    s_mov_b32 s22, 0
    s_mov_b32 s33, 0
    s_xor_b32 s53, s29, 1024
    s_add_u32 s23, s51, 0x10000
    s_add_u32 s48, s23, 4096
    s_mov_b32 s24, 0x12000
    s_add_u32 s55, s24, 16384
    s_mov_b32 s25, 0x100000
    s_mov_b32 s26, 0x101000
    s_lshl_b32 s43, s20, 13
    v_mov_b32 v112, 0
    v_mov_b32 v113, 0
    v_mov_b32 v114, 0
    v_mov_b32 v115, 0
    s_add_u32 s43, s43, s52
    s_add_u32 s30, s43, 0x1000000
    s_add_u32 s31, s43, 0x2000000
    s_lshr_b32 s43, s43, 1
    s_add_u32 s32, s43, 0x220000
    s_add_u32 m0, s52, 8192
    s_nop 0
    buffer_load_dwordx4 v117, s[8:11], s30 offen lds
    buffer_load_dwordx4 v117, s[8:11], s30 offen offset:1024 lds
    s_add_u32 m0, s52, 0x6000
    s_nop 0
    buffer_load_dwordx4 v117, s[8:11], s31 offen lds
    buffer_load_dwordx4 v117, s[8:11], s31 offen offset:1024 lds
    s_add_u32 m0, s51, 4096
    ds_write_b128 v117, v[112:115] offset:22528
    ds_write_b128 v117, v[112:115] offset:23552
    s_cmp_lg_u32 s21, 0
    s_cselect_b32 s40, -1, 0
    v_mov_b32 v126, s40
    v_bfe_u32 v1, v117, 4, 1
    v_lshlrev_b32 v1, 4, v1
    s_movk_i32 s43, 0x3f80
    v_lshlrev_b32 v125, v1, s43
    v_bfe_u32 v1, v117, 5, 3
    v_cmp_eq_u32 s[68:69], 0, v1
    v_cmp_eq_u32 s[70:71], 1, v1
    v_cmp_eq_u32 s[72:73], 2, v1
    v_cmp_eq_u32 s[74:75], 3, v1
    v_lshrrev_b32 v1, 2, v117
    s_cmp_lt_u32 s21, 2
    s_cselect_b64 vcc, -1, 0
    v_cndmask_b32 v119, v119, v1, vcc
    v_mov_b32 v32, 0
    v_mov_b32 v33, 0
    v_mov_b32 v34, 0
    v_mov_b32 v35, 0
    v_mov_b32 v36, 0
    v_mov_b32 v37, 0
    v_mov_b32 v38, 0
    v_mov_b32 v39, 0
    v_mov_b32 v40, 0
    v_mov_b32 v41, 0
    v_mov_b32 v42, 0
    v_mov_b32 v43, 0
    v_mov_b32 v44, 0
    v_mov_b32 v45, 0
    v_mov_b32 v46, 0
    v_mov_b32 v47, 0
    v_mov_b32 v48, 0
    v_mov_b32 v49, 0
    v_mov_b32 v50, 0
    v_mov_b32 v51, 0
    v_mov_b32 v52, 0
    v_mov_b32 v53, 0
    v_mov_b32 v54, 0
    v_mov_b32 v55, 0
    s_add_u32 s30, s30, 0x40000
    s_add_u32 s31, s31, 0x40000
    s_mov_b32 s45, 0
    s_mov_b32 s46, 0
    s_mov_b32 s47, 0
    s_mov_b32 s76, 0
    s_and_b32 s43, s21, 1
    s_lshl_b32 s43, s43, 5
    s_add_u32 s43, s43, s20
    s_lshl_b32 s43, s43, 6
    s_add_u32 s28, s43, 0x2000
    s_mov_b32 s59, 0
    ds_read_b128 v[80:83], v123
    ds_read_b128 v[84:87], v123 offset:1024
    ds_read_b128 v[56:59], v123 offset:2048
    ds_read_b128 v[60:63], v123 offset:3072
    ds_read_b128 v[64:67], v123 offset:32768
    ds_read_b128 v[68:71], v123 offset:33792
    ds_read_b128 v[72:75], v123 offset:34816
    ds_read_b128 v[76:79], v123 offset:35840
    ds_read_b128 v[88:91], v123 offset:4096
    ds_read_b128 v[92:95], v123 offset:5120
    ds_read_b128 v[96:99], v123 offset:6144
    ds_read_b128 v[100:103], v123 offset:7168
    ds_read_b128 v[104:107], v123 offset:36864
    ds_read_b128 v[108:111], v123 offset:37888
    ds_read_b128 v[24:27], v123 offset:38912
    ds_read_b128 v[28:31], v123 offset:39936
    s_cmp_lg_u32 s21, 0
    s_cbranch_scc1 L_cb_skip_11
    v_mov_b32 v1, 4
    s_mov_b64 exec, 1
    s_mov_b32 s49, 0
L_cb_poll_12:
    buffer_load_dword v3, v1, s[16:19], 0 offen sc1
    s_waitcnt vmcnt(0)
    v_readfirstlane_b32 s43, v3
    s_nop 0
    s_cmp_ge_u32 s43, 32
    s_cbranch_scc1 L_cb_done_13
    s_sleep 2
    s_add_u32 s49, s49, 1
    s_cmp_lt_u32 s49, 0x40000
    s_cbranch_scc1 L_cb_poll_12
L_cb_done_13:
    s_mov_b64 exec, -1
L_cb_skip_11:
    s_mov_b32 s49, 0
    s_lshr_b32 s43, s20, 1
    s_lshl_b32 s43, s43, 7
    s_and_b32 s40, s20, 1
    s_lshl_b32 s40, s40, 4
    s_add_u32 s43, s43, s40
    s_add_u32 s44, s43, 0x1000
    s_cmp_eq_u32 s21, 0
    s_cselect_b32 s44, s44, 0x7ff00000
    s_waitcnt vmcnt(0) lgkmcnt(0)
    s_barrier
    buffer_load_dwordx4 v[0:3], v117, s[8:11], s23 offen sc1
    s_waitcnt vmcnt(0) lgkmcnt(0)
    s_cmp_eq_u32 s21, 1
    s_cbranch_scc1 L_chain_top1_f
    s_cmp_eq_u32 s21, 2
    s_cbranch_scc1 L_chain_top2_f
    s_cmp_eq_u32 s21, 3
    s_cbranch_scc1 L_chain_top3_f
.p2align 6
L_chain_top0_f:
    buffer_load_dwordx4 v[0:3], v117, s[8:11], s23 offen nt
    v_mov_b32 v15, 0
    v_mov_b32 v15, 0
    v_mov_b32 v15, 0
    v_mov_b32 v15, 0
    v_mov_b32 v15, 0
    v_mov_b32 v15, 0
    v_mov_b32 v15, 0
    v_mov_b32 v15, 0
    v_mov_b32 v15, 0
    v_mov_b32 v15, 0
    v_mov_b32 v15, 0
    v_mov_b32 v15, 0
    v_mov_b32 v15, 0
    v_mov_b32 v15, 0
    v_mov_b32 v15, 0
    v_mov_b32 v15, 0
    buffer_load_dwordx4 v[0:3], v117, s[8:11], s23 offen sc1
    v_mov_b32 v15, 0
    v_mov_b32 v15, 0
    v_mov_b32 v15, 0
    v_mov_b32 v15, 0
    v_mov_b32 v15, 0
    v_mov_b32 v15, 0
    v_mov_b32 v15, 0
    v_mov_b32 v15, 0
    v_mov_b32 v15, 0
    v_mov_b32 v15, 0
    v_mov_b32 v15, 0
    v_mov_b32 v15, 0
    v_mov_b32 v15, 0
    v_mov_b32 v15, 0
    v_mov_b32 v15, 0
    v_mov_b32 v15, 0
L_mret_14:
    buffer_load_dwordx4 v[0:3], v117, s[8:11], s23 offen sc1
    s_add_u32 s45, s45, 1
    s_cmp_lt_u32 s45, 0x10000
    s_cselect_b32 s56, -2, -1
    s_nop 3
    v_mov_b32 v32, 0
    v_mov_b32 v33, 0
    v_mov_b32 v34, 0
    v_mov_b32 v35, 0
    s_waitcnt vmcnt(2)
    v_max3_u32 v15, v0, v1, v2
    v_max_u32 v15, v15, v3
    v_cmp_lt_u32 vcc, s56, v15
    v_smfmac_f32_16x16x64_bf16 v[32:35], v[0:3], v[80:87], v116
    s_cbranch_vccnz L_mret_14
    ds_write_b128 v117, v[0:3]
    v_smfmac_f32_16x16x64_bf16 v[36:39], v[0:3], v[56:63], v116
    buffer_load_dwordx4 v[4:7], v117, s[8:11], s48 offen nt
    v_smfmac_f32_16x16x64_bf16 v[40:43], v[0:3], v[64:71], v116
    buffer_load_dwordx4 v117, s[8:11], s48 offen nt lds
    s_mov_b32 m0, 8192
    v_smfmac_f32_16x16x64_bf16 v[44:47], v[0:3], v[72:79], v116
    s_waitcnt lgkmcnt(0)
    s_barrier
    ds_read_b128 v[8:11], v117 offset:1024
    v_smfmac_f32_16x16x64_bf16 v[48:51], v[0:3], a[192:199], v116
    ds_read_b128 v[16:19], v117 offset:2048
    ds_read_b128 v[20:23], v117 offset:3072
    v_smfmac_f32_16x16x64_bf16 v[52:55], v[0:3], a[200:207], v116
    ds_read_b128 v[80:83], v117 offset:14336
    s_waitcnt lgkmcnt(3)
    v_smfmac_f32_16x16x64_bf16 v[32:35], v[8:11], a[0:7], v116
    ds_read_b128 v[84:87], v117 offset:15360
    v_smfmac_f32_16x16x64_bf16 v[36:39], v[8:11], a[8:15], v116
    buffer_store_dwordx4 v[112:115], v117, s[8:11], s32 offen sc1
    s_waitcnt lgkmcnt(3)
    v_smfmac_f32_16x16x64_bf16 v[32:35], v[16:19], a[32:39], v116
    ds_read_b128 v[56:59], v117 offset:8192
    v_smfmac_f32_16x16x64_bf16 v[36:39], v[16:19], a[40:47], v116
    ds_read_b128 v[60:63], v117 offset:9216
    s_waitcnt lgkmcnt(4)
    v_smfmac_f32_16x16x64_bf16 v[32:35], v[20:23], a[64:71], v116
    ds_read_b128 v[64:67], v117 offset:10240
    v_smfmac_f32_16x16x64_bf16 v[36:39], v[20:23], a[72:79], v116
    ds_read_b128 v[68:71], v117 offset:11264
    v_smfmac_f32_16x16x64_bf16 v[40:43], v[8:11], a[96:103], v116
    ds_read_b128 v[72:75], v117 offset:12288
    v_smfmac_f32_16x16x64_bf16 v[40:43], v[16:19], a[128:135], v116
    ds_read_b128 v[76:79], v117 offset:13312
    v_smfmac_f32_16x16x64_bf16 v[40:43], v[20:23], a[160:167], v116
    s_waitcnt vmcnt(2)
    v_max3_u32 v15, v4, v5, v6
    v_smfmac_f32_16x16x64_bf16 v[44:47], v[8:11], a[104:111], v116
    v_max_u32 v15, v15, v7
    v_smfmac_f32_16x16x64_bf16 v[44:47], v[16:19], a[136:143], v116
    s_waitcnt vmcnt(1) lgkmcnt(0)
    v_cmp_lt_u32 vcc, s56, v15
    v_smfmac_f32_16x16x64_bf16 v[44:47], v[20:23], a[168:175], v116
    s_cbranch_vccnz L_mret_15
L_mgo_16:
    v_smfmac_f32_16x16x64_bf16 v[44:47], v[4:7], v[24:31], v116
    s_barrier
    ds_read_b128 v[12:15], v117 offset:5120
    v_smfmac_f32_16x16x64_bf16 v[32:35], v[4:7], v[88:95], v116
    ds_read_b128 v[24:27], v117 offset:6144
    v_smfmac_f32_16x16x64_bf16 v[36:39], v[4:7], v[96:103], v116
    ds_read_b128 v[28:31], v117 offset:7168
    v_smfmac_f32_16x16x64_bf16 v[40:43], v[4:7], v[104:111], v116
    ds_read_b128 v[88:91], v117 offset:24576
    s_waitcnt lgkmcnt(3)
    v_smfmac_f32_16x16x64_bf16 v[32:35], v[12:15], a[16:23], v116
    ds_read_b128 v[92:95], v117 offset:25600
    s_waitcnt lgkmcnt(3)
    v_smfmac_f32_16x16x64_bf16 v[32:35], v[24:27], a[48:55], v116
    buffer_load_dwordx4 v117, s[8:11], s30 offen lds
    s_waitcnt lgkmcnt(2)
    v_smfmac_f32_16x16x64_bf16 v[32:35], v[28:31], a[80:87], v116
    ds_read_b128 v[96:99], v117 offset:23552
    v_smfmac_f32_16x16x64_bf16 v[36:39], v[12:15], a[24:31], v116
    ds_read_b128 v[100:103], v117 offset:23552
    v_smfmac_f32_16x16x64_bf16 v[36:39], v[24:27], a[56:63], v116
    buffer_load_dwordx4 v117, s[8:11], s30 offen offset:1024 lds
    s_add_u32 m0, s52, 0x6000
    v_add_f32 v32, v32, v34
    v_smfmac_f32_16x16x64_bf16 v[36:39], v[28:31], a[88:95], v116
    ds_read_b128 v[104:107], v117 offset:23552
    v_add_f32 v33, v33, v35
    v_smfmac_f32_16x16x64_bf16 v[40:43], v[12:15], a[112:119], v116
    ds_read_b128 v[108:111], v117 offset:23552
    v_mul_f32 v32, s34, v32
    v_smfmac_f32_16x16x64_bf16 v[40:43], v[24:27], a[144:151], v116
    buffer_load_dword v125, v119, s[8:11], s28 offen sc1
    v_mul_f32 v33, s34, v33
    v_smfmac_f32_16x16x64_bf16 v[40:43], v[28:31], a[176:183], v116
    ds_read_b128 v[0:3], v124
    v_add_f32 v36, v36, v38
    v_smfmac_f32_16x16x64_bf16 v[48:51], v[4:7], a[208:215], v116
    v_add_f32 v37, v37, v39
    v_smfmac_f32_16x16x64_bf16 v[52:55], v[4:7], a[216:223], v116
    s_waitcnt lgkmcnt(5)
    buffer_load_dwordx4 v117, s[8:11], s31 offen lds
    v_mul_f32 v36, s34, v36
    v_smfmac_f32_16x16x64_bf16 v[44:47], v[12:15], a[120:127], v116
    ds_read_b128 v[4:7], v124 offset:1024
    v_mul_f32 v37, s34, v37
    v_smfmac_f32_16x16x64_bf16 v[44:47], v[24:27], a[152:159], v116
    v_cvt_pk_bf16_f32 v34, v32, v36
    v_smfmac_f32_16x16x64_bf16 v[44:47], v[28:31], a[184:191], v116
    buffer_load_dwordx4 v117, s[8:11], s31 offen offset:1024 lds
    s_mov_b32 m0, 4096
    v_cvt_pk_bf16_f32 v35, v33, v37
    v_add_f32 v40, v40, v42
    v_smfmac_f32_16x16x64_bf16 v[48:51], v[8:11], a[224:231], v116
    ds_write2_b32 v120, v34, v35 offset0:32 offset1:48
    v_add_f32 v41, v41, v43
    v_smfmac_f32_16x16x64_bf16 v[52:55], v[8:11], a[232:239], v116
    v_add_f32 v44, v44, v46
    v_add_f32 v45, v45, v47
    v_cvt_pk_bf16_f32 v113, v40, v44
    v_cvt_pk_bf16_f32 v115, v41, v45
    v_smfmac_f32_16x16x64_bf16 v[48:51], v[12:15], a[240:247], v116
    ds_write2_b32 v120, v113, v115 offset0:0 offset1:16
    v_smfmac_f32_16x16x64_bf16 v[52:55], v[12:15], a[248:255], v116
    s_cmp_eq_u32 s22, 63
    s_cbranch_scc1 L_chain_last_f
    buffer_store_dword v126, off, s[8:11], s44 sc1
    v_smfmac_f32_16x16x64_bf16 v[48:51], v[16:19], v[128:135], v116
    v_smfmac_f32_16x16x64_bf16 v[48:51], v[20:23], v[160:167], v116
    v_smfmac_f32_16x16x64_bf16 v[48:51], v[24:27], v[144:151], v116
    s_waitcnt lgkmcnt(0)
    s_barrier
    v_smfmac_f32_16x16x64_bf16 v[48:51], v[28:31], v[176:183], v116
    ds_read_b128 v[32:35], v121 offset:16384
    ds_read_b128 v[36:39], v121 offset:17408
    v_smfmac_f32_16x16x64_bf16 v[52:55], v[16:19], v[136:143], v116
    ds_read_b128 v[40:43], v121 offset:18432
    ds_read_b128 v[44:47], v121 offset:19456
    v_smfmac_f32_16x16x64_bf16 v[52:55], v[20:23], v[168:175], v116
    ds_read_b128 v[8:11], v124 offset:32768
    v_add_f32 v48, v48, v50
    v_smfmac_f32_16x16x64_bf16 v[52:55], v[24:27], v[152:159], v116
    ds_read_b128 v[12:15], v124 offset:33792
    v_add_f32 v49, v49, v51
    v_smfmac_f32_16x16x64_bf16 v[52:55], v[28:31], v[184:191], v116
    s_waitcnt lgkmcnt(5)
    v_cvt_pk_bf16_f32 v112, v48, v49
    v_mfma_f32_16x16x32_bf16 v[56:59], v[56:59], v[32:35], 0
    s_waitcnt lgkmcnt(4)
    v_mov_b32 v48, s50
    v_mov_b32 v49, s50
    v_mfma_f32_16x16x32_bf16 v[56:59], v[60:63], v[36:39], v[56:59]
    ds_read_b128 v[16:19], v124 offset:2048
    s_waitcnt lgkmcnt(4)
    v_mov_b32 v50, s50
    v_mov_b32 v51, s50
    v_mfma_f32_16x16x32_bf16 v[56:59], v[64:67], v[40:43], v[56:59]
    ds_read_b128 v[20:23], v124 offset:3072
    s_waitcnt lgkmcnt(4)
    v_add_f32 v52, v52, v54
    v_mfma_f32_16x16x32_bf16 v[56:59], v[68:71], v[44:47], v[56:59]
    ds_read_b128 v[24:27], v124 offset:4096
    v_add_f32 v53, v53, v55
    v_mfma_f32_16x16x32_bf16 v[60:63], v[72:75], v[32:35], 0
    ds_read_b128 v[28:31], v124 offset:5120
    v_cvt_pk_bf16_f32 v114, v52, v53
    v_mov_b32 v53, 0
    v_mfma_f32_16x16x32_bf16 v[60:63], v[76:79], v[36:39], v[60:63]
    v_exp_f32 v56, v56
    v_mfma_f32_16x16x32_bf16 v[60:63], v[80:83], v[40:43], v[60:63]
    v_exp_f32 v57, v57
    v_mfma_f32_16x16x32_bf16 v[60:63], v[84:87], v[44:47], v[60:63]
    v_exp_f32 v58, v58
    v_mfma_f32_16x16x32_bf16 v[64:67], v[32:35], v[32:35], 0
    v_exp_f32 v59, v59
    v_cvt_pk_bf16_f32 v68, v56, v57
    v_mfma_f32_16x16x32_bf16 v[64:67], v[36:39], v[36:39], v[64:67]
    v_exp_f32 v60, v60
    v_cvt_pk_bf16_f32 v69, v58, v59
    v_mfma_f32_16x16x32_bf16 v[64:67], v[40:43], v[40:43], v[64:67]
    v_exp_f32 v61, v61
    v_mfma_f32_16x16x32_bf16 v[64:67], v[44:47], v[44:47], v[64:67]
    v_exp_f32 v62, v62
    v_exp_f32 v63, v63
    v_cvt_pk_bf16_f32 v70, v60, v61
    v_cvt_pk_bf16_f32 v71, v62, v63
    s_nop 1
    v_mfma_f32_16x16x32_bf16 v[72:75], v[88:91], v[68:71], 0
    s_nop 0
    v_exp_f32 v64, v64
    v_mfma_f32_16x16x32_bf16 v[76:79], v[92:95], v[68:71], 0
    v_exp_f32 v65, v65
    v_mfma_f32_16x16x32_bf16 v[80:83], v[48:51], v[68:71], 0
    v_cvt_pk_bf16_f32 v52, v64, v65
    s_nop 1
    v_mfma_f32_16x16x16_bf16 v[72:75], v[112:113], v[52:53], v[72:75]
    ds_read_b128 v[32:35], v124 offset:6144
    v_mfma_f32_16x16x16_bf16 v[76:79], v[114:115], v[52:53], v[76:79]
    ds_read_b128 v[36:39], v124 offset:7168
    v_mfma_f32_16x16x16_bf16 v[80:83], v[48:49], v[52:53], v[80:83]
L_norm_17:
    s_mov_b64 vcc, s[36:37]
    v_mov_b32 v122, v122
    v_mov_b32 v122, v122
    v_mov_b32 v122, v122
    v_cndmask_b32_dpp v76, v72, v76, vcc quad_perm:[2,3,2,3] row_mask:0xf bank_mask:0xf
    v_cndmask_b32_dpp v77, v73, v77, vcc quad_perm:[2,3,2,3] row_mask:0xf bank_mask:0xf
    v_cndmask_b32_dpp v78, v74, v78, vcc quad_perm:[2,3,2,3] row_mask:0xf bank_mask:0xf
    v_cndmask_b32_dpp v79, v75, v79, vcc quad_perm:[2,3,2,3] row_mask:0xf bank_mask:0xf
    v_rcp_f32_dpp v84, v80 quad_perm:[2,3,2,3] row_mask:0xf bank_mask:0xf
    s_nop 0
    v_pk_mul_f32 v[76:77], v[76:77], v[84:85] op_sel_hi:[1,0]
    v_pk_mul_f32 v[78:79], v[78:79], v[84:85] op_sel_hi:[1,0]
    v_cvt_pk_bf16_f32 v72, v76, v77
    v_cvt_pk_bf16_f32 v73, v78, v79
    ds_write_b64 v122, v[72:73] offset:20480
    v_max_f32_dpp v86, v80, v84 quad_perm:[2,3,2,3] row_mask:0xf bank_mask:0xf
    v_mov_b32_dpp v60, v72 quad_perm:[0,1,0,1] row_mask:0xf bank_mask:0xf
    v_mov_b32_dpp v61, v73 quad_perm:[0,1,0,1] row_mask:0xf bank_mask:0xf
    v_cmp_lt_f32 vcc, s35, v86
    v_mov_b32_dpp v62, v72 quad_perm:[2,3,2,3] row_mask:0xf bank_mask:0xf
    v_mov_b32_dpp v63, v73 quad_perm:[2,3,2,3] row_mask:0xf bank_mask:0xf
    s_nop 1
    v_smfmac_f32_16x16x64_bf16 v[96:99], v[60:63], v[192:199], v116
    s_cbranch_vccnz L_smax_18
    v_smfmac_f32_16x16x64_bf16 v[100:103], v[60:63], v[224:231], v116
    s_waitcnt lgkmcnt(0)
    s_barrier
    ds_read_b128 v[92:95], v127 offset:20992
    ds_read_b128 v[80:83], v127 offset:21504
    ds_read_b128 v[84:87], v127 offset:22016
    v_smfmac_f32_16x16x64_bf16 v[104:107], v[60:63], v[0:7], v116
    ds_read_b128 v[40:43], v124 offset:34816
    v_smfmac_f32_16x16x64_bf16 v[108:111], v[60:63], v[8:15], v116
    ds_read_b128 v[56:59], v124 offset:36864
    s_waitcnt lgkmcnt(4)
    v_smfmac_f32_16x16x64_bf16 v[96:99], v[92:95], v[200:207], v116
    s_waitcnt lgkmcnt(3)
    v_smfmac_f32_16x16x64_bf16 v[96:99], v[80:83], v[208:215], v116
    ds_read_b128 v[44:47], v124 offset:35840
    s_waitcnt lgkmcnt(3)
    v_smfmac_f32_16x16x64_bf16 v[96:99], v[84:87], v[216:223], v116
    ds_read_b128 v[68:71], v124 offset:39936
    v_smfmac_f32_16x16x64_bf16 v[100:103], v[92:95], v[232:239], v116
    ds_read_b128 v[64:67], v124 offset:38912
    v_smfmac_f32_16x16x64_bf16 v[100:103], v[80:83], v[240:247], v116
    ds_read_b128 v[60:63], v124 offset:37888
    v_cvt_pk_bf16_f32 v72, v96, v98
    v_smfmac_f32_16x16x64_bf16 v[100:103], v[84:87], v[248:255], v116
    v_and_or_b32 v72, v72, -2, s33
    v_smfmac_f32_16x16x64_bf16 v[104:107], v[92:95], v[16:23], v116
    v_cvt_pk_bf16_f32 v74, v97, v99
    v_smfmac_f32_16x16x64_bf16 v[104:107], v[80:83], v[24:31], v116
    v_cvt_pk_bf16_f32 v73, v100, v102
    v_cvt_pk_bf16_f32 v75, v101, v103
    v_smfmac_f32_16x16x64_bf16 v[104:107], v[84:87], v[32:39], v116
    buffer_store_dwordx4 v[72:75], v118, s[8:11], s25 offen
    s_waitcnt lgkmcnt(3)
    v_smfmac_f32_16x16x64_bf16 v[108:111], v[92:95], v[40:47], v116
    s_waitcnt lgkmcnt(0)
    v_smfmac_f32_16x16x64_bf16 v[108:111], v[80:83], v[56:63], v116
    v_cvt_pk_bf16_f32 v76, v104, v106
    v_smfmac_f32_16x16x64_bf16 v[108:111], v[84:87], v[64:71], v116
    v_and_or_b32 v76, v76, -2, s33
    v_cvt_pk_bf16_f32 v78, v105, v107
    v_mov_b32 v122, v122
    v_mov_b32 v122, v122
    v_mov_b32 v122, v122
    v_mov_b32 v122, v122
    v_mov_b32 v122, v122
    v_mov_b32 v122, v122
    v_cvt_pk_bf16_f32 v77, v108, v110
    v_cvt_pk_bf16_f32 v79, v109, v111
    buffer_store_dwordx4 v[76:79], v118, s[8:11], s26 offen
    s_add_u32 s30, s30, 0x40000
    s_add_u32 s31, s31, 0x40000
    s_add_u32 s32, s32, 0x20000
    s_add_u32 s23, s24, 0
    s_add_u32 s48, s23, 4096
    s_xor_b32 s25, s25, 0x40000
    s_xor_b32 s26, s26, 0x40000
    s_mov_b32 s35, 0x49800000
    v_mov_b32 v126, s22
    s_add_u32 s22, s22, 1
    v_mov_b32 v32, 0
    v_mov_b32 v33, 0
    v_mov_b32 v34, 0
    v_mov_b32 v35, 0
    v_mov_b32 v36, 0
    v_mov_b32 v37, 0
    v_mov_b32 v38, 0
    v_mov_b32 v39, 0
    v_mov_b32 v40, 0
    v_mov_b32 v41, 0
    v_mov_b32 v42, 0
    v_mov_b32 v43, 0
    v_mov_b32 v44, 0
    v_mov_b32 v45, 0
    v_mov_b32 v46, 0
    v_mov_b32 v47, 0
    v_mov_b32 v48, 0
    v_mov_b32 v49, 0
    v_mov_b32 v50, 0
    v_mov_b32 v51, 0
    v_mov_b32 v52, 0
    v_mov_b32 v53, 0
    v_mov_b32 v54, 0
    v_mov_b32 v55, 0
    ds_read_b128 v[80:83], v123
    ds_read_b128 v[84:87], v123 offset:1024
    ds_read_b128 v[56:59], v123 offset:2048
    ds_read_b128 v[60:63], v123 offset:3072
    ds_read_b128 v[64:67], v123 offset:32768
    ds_read_b128 v[68:71], v123 offset:33792
    ds_read_b128 v[72:75], v123 offset:34816
    ds_read_b128 v[76:79], v123 offset:35840
    ds_read_b128 v[88:91], v123 offset:4096
    ds_read_b128 v[92:95], v123 offset:5120
    ds_read_b128 v[96:99], v123 offset:6144
    ds_read_b128 v[100:103], v123 offset:7168
    ds_read_b128 v[104:107], v123 offset:36864
    ds_read_b128 v[108:111], v123 offset:37888
    ds_read_b128 v[24:27], v123 offset:38912
    ds_read_b128 v[28:31], v123 offset:39936
    s_add_u32 s24, s24, 8192
    s_bitset0_b32 s24, 15
    s_xor_b32 s55, s24, 16384
    s_xor_b32 s29, s29, 0x40000
    s_xor_b32 s53, s29, 1024
    s_bfe_u32 s33, s22, 0x10001
    s_add_u32 s40, s22, 5
    s_lshr_b32 s40, s40, 2
    s_min_u32 s40, s40, 16
    s_bfm_b32 s58, s40, 0
    s_waitcnt vmcnt(5)
    v_cmp_eq_u32 vcc, 0, v125
    s_nop 0
    s_and_b64 vcc, vcc, s[58:59]
    s_cbranch_scc1 L_kvw_19
L_kvb_20:
    v_mov_b32 v15, 0
    s_nop 2
    v_mov_b32 v15, 0
    s_nop 2
    v_mov_b32 v15, 0
    s_nop 2
    v_mov_b32 v15, 0
    s_nop 2
    v_mov_b32 v15, 0
    s_nop 2
    v_mov_b32 v15, 0
    s_nop 2
    v_mov_b32 v15, 0
    s_nop 2
    v_mov_b32 v15, 0
    s_nop 2
    v_mov_b32 v15, 0
    s_nop 2
    v_mov_b32 v15, 0
    s_nop 2
    v_mov_b32 v15, 0
    s_nop 2
    v_mov_b32 v15, 0
    s_nop 2
    v_mov_b32 v15, 0
    s_nop 2
    v_mov_b32 v15, 0
    s_nop 2
    v_mov_b32 v15, 0
    s_nop 2
    v_mov_b32 v15, 0
    s_nop 2
    v_mov_b32 v15, 0
    s_nop 2
    v_mov_b32 v15, 0
    s_nop 2
    v_mov_b32 v15, 0
    s_nop 2
    v_mov_b32 v15, 0
    s_nop 2
    v_mov_b32 v15, 0
    s_nop 2
    v_mov_b32 v15, 0
    s_nop 2
    v_mov_b32 v15, 0
    s_nop 2
    v_mov_b32 v15, 0
    s_nop 2
    v_mov_b32 v15, 0
    s_nop 2
    v_mov_b32 v15, 0
    s_nop 2
    v_mov_b32 v15, 0
    s_nop 2
    v_mov_b32 v15, 0
    s_nop 2
    v_mov_b32 v15, 0
    s_nop 2
    v_mov_b32 v15, 0
    s_nop 2
    v_mov_b32 v15, 0
    s_nop 2
    s_waitcnt lgkmcnt(0)
    s_branch L_chain_top0_f
.p2align 6
L_chain_top1_f:
    buffer_load_dwordx4 v[0:3], v117, s[8:11], s23 offen nt
    v_mov_b32 v15, 0
    v_mov_b32 v15, 0
    v_mov_b32 v15, 0
    v_mov_b32 v15, 0
    v_mov_b32 v15, 0
    v_mov_b32 v15, 0
    v_mov_b32 v15, 0
    v_mov_b32 v15, 0
    v_mov_b32 v15, 0
    v_mov_b32 v15, 0
    v_mov_b32 v15, 0
    v_mov_b32 v15, 0
    v_mov_b32 v15, 0
    v_mov_b32 v15, 0
    v_mov_b32 v15, 0
    v_mov_b32 v15, 0
    buffer_load_dwordx4 v[0:3], v117, s[8:11], s23 offen sc1
    v_mov_b32 v15, 0
    v_mov_b32 v15, 0
    v_mov_b32 v15, 0
    v_mov_b32 v15, 0
    v_mov_b32 v15, 0
    v_mov_b32 v15, 0
    v_mov_b32 v15, 0
    v_mov_b32 v15, 0
    v_mov_b32 v15, 0
    v_mov_b32 v15, 0
    v_mov_b32 v15, 0
    v_mov_b32 v15, 0
    v_mov_b32 v15, 0
    v_mov_b32 v15, 0
    v_mov_b32 v15, 0
    v_mov_b32 v15, 0
L_mret_21:
    buffer_load_dwordx4 v[0:3], v117, s[8:11], s23 offen sc1
    s_add_u32 s45, s45, 1
    s_cmp_lt_u32 s45, 0x10000
    s_cselect_b32 s56, -2, -1
    s_nop 3
    v_mov_b32 v32, 0
    v_mov_b32 v33, 0
    v_mov_b32 v34, 0
    v_mov_b32 v35, 0
    s_waitcnt vmcnt(2)
    v_max3_u32 v15, v0, v1, v2
    v_max_u32 v15, v15, v3
    v_cmp_lt_u32 vcc, s56, v15
    v_smfmac_f32_16x16x64_bf16 v[32:35], v[0:3], v[80:87], v116
    s_cbranch_vccnz L_mret_21
    ds_write_b128 v117, v[0:3] offset:1024
    v_smfmac_f32_16x16x64_bf16 v[36:39], v[0:3], v[56:63], v116
    buffer_load_dwordx4 v[4:7], v117, s[8:11], s48 offen nt
    v_smfmac_f32_16x16x64_bf16 v[40:43], v[0:3], v[64:71], v116
    buffer_load_dwordx4 v117, s[8:11], s48 offen nt lds
    s_mov_b32 m0, 10240
    v_smfmac_f32_16x16x64_bf16 v[44:47], v[0:3], v[72:79], v116
    s_waitcnt lgkmcnt(0)
    s_barrier
    ds_read_b128 v[8:11], v117
    v_smfmac_f32_16x16x64_bf16 v[48:51], v[0:3], a[192:199], v116
    ds_read_b128 v[16:19], v117 offset:3072
    ds_read_b128 v[20:23], v117 offset:2048
    v_smfmac_f32_16x16x64_bf16 v[52:55], v[0:3], a[200:207], v116
    ds_read_b128 v[80:83], v117 offset:14336
    s_waitcnt lgkmcnt(3)
    v_smfmac_f32_16x16x64_bf16 v[32:35], v[8:11], a[0:7], v116
    ds_read_b128 v[84:87], v117 offset:15360
    v_smfmac_f32_16x16x64_bf16 v[36:39], v[8:11], a[8:15], v116
    ds_read_b128 v[56:59], v117 offset:8192
    s_waitcnt lgkmcnt(4)
    v_smfmac_f32_16x16x64_bf16 v[32:35], v[16:19], a[32:39], v116
    ds_read_b128 v[60:63], v117 offset:9216
    v_smfmac_f32_16x16x64_bf16 v[36:39], v[16:19], a[40:47], v116
    buffer_store_dwordx4 v[112:115], v117, s[8:11], s32 offen sc1
    s_waitcnt lgkmcnt(4)
    v_smfmac_f32_16x16x64_bf16 v[32:35], v[20:23], a[64:71], v116
    ds_read_b128 v[64:67], v117 offset:10240
    v_smfmac_f32_16x16x64_bf16 v[36:39], v[20:23], a[72:79], v116
    ds_read_b128 v[68:71], v117 offset:11264
    v_smfmac_f32_16x16x64_bf16 v[40:43], v[8:11], a[96:103], v116
    ds_read_b128 v[72:75], v117 offset:12288
    v_smfmac_f32_16x16x64_bf16 v[40:43], v[16:19], a[128:135], v116
    ds_read_b128 v[76:79], v117 offset:13312
    v_smfmac_f32_16x16x64_bf16 v[40:43], v[20:23], a[160:167], v116
    s_waitcnt vmcnt(2)
    v_max3_u32 v15, v4, v5, v6
    v_smfmac_f32_16x16x64_bf16 v[44:47], v[8:11], a[104:111], v116
    v_max_u32 v15, v15, v7
    v_smfmac_f32_16x16x64_bf16 v[44:47], v[16:19], a[136:143], v116
    s_waitcnt vmcnt(1) lgkmcnt(0)
    v_cmp_lt_u32 vcc, s56, v15
    v_smfmac_f32_16x16x64_bf16 v[44:47], v[20:23], a[168:175], v116
    s_cbranch_vccnz L_mret_22
L_mgo_23:
    v_smfmac_f32_16x16x64_bf16 v[44:47], v[4:7], v[24:31], v116
    s_barrier
    ds_read_b128 v[12:15], v117 offset:4096
    v_smfmac_f32_16x16x64_bf16 v[32:35], v[4:7], v[88:95], v116
    ds_read_b128 v[24:27], v117 offset:7168
    v_smfmac_f32_16x16x64_bf16 v[36:39], v[4:7], v[96:103], v116
    ds_read_b128 v[28:31], v117 offset:6144
    v_smfmac_f32_16x16x64_bf16 v[40:43], v[4:7], v[104:111], v116
    ds_read_b128 v[88:91], v117 offset:26624
    s_waitcnt lgkmcnt(3)
    v_smfmac_f32_16x16x64_bf16 v[32:35], v[12:15], a[16:23], v116
    ds_read_b128 v[92:95], v117 offset:27648
    s_waitcnt lgkmcnt(3)
    v_smfmac_f32_16x16x64_bf16 v[32:35], v[24:27], a[48:55], v116
    buffer_load_dwordx4 v117, s[8:11], s30 offen lds
    s_waitcnt lgkmcnt(2)
    v_smfmac_f32_16x16x64_bf16 v[32:35], v[28:31], a[80:87], v116
    ds_read_b128 v[96:99], v117 offset:23552
    v_smfmac_f32_16x16x64_bf16 v[36:39], v[12:15], a[24:31], v116
    ds_read_b128 v[100:103], v117 offset:23552
    v_smfmac_f32_16x16x64_bf16 v[36:39], v[24:27], a[56:63], v116
    buffer_load_dwordx4 v117, s[8:11], s30 offen offset:1024 lds
    s_add_u32 m0, s52, 0x6000
    v_add_f32 v32, v32, v34
    v_smfmac_f32_16x16x64_bf16 v[36:39], v[28:31], a[88:95], v116
    ds_read_b128 v[104:107], v117 offset:23552
    v_add_f32 v33, v33, v35
    v_smfmac_f32_16x16x64_bf16 v[40:43], v[12:15], a[112:119], v116
    ds_read_b128 v[108:111], v117 offset:23552
    v_mul_f32 v32, s34, v32
    v_smfmac_f32_16x16x64_bf16 v[40:43], v[24:27], a[144:151], v116
    buffer_load_dword v125, v119, s[8:11], s28 offen sc1
    v_mul_f32 v33, s34, v33
    v_smfmac_f32_16x16x64_bf16 v[40:43], v[28:31], a[176:183], v116
    ds_read_b128 v[0:3], v124
    v_add_f32 v36, v36, v38
    v_smfmac_f32_16x16x64_bf16 v[48:51], v[4:7], a[208:215], v116
    v_add_f32 v37, v37, v39
    v_smfmac_f32_16x16x64_bf16 v[52:55], v[4:7], a[216:223], v116
    s_waitcnt lgkmcnt(5)
    buffer_load_dwordx4 v117, s[8:11], s31 offen lds
    v_mul_f32 v36, s34, v36
    v_smfmac_f32_16x16x64_bf16 v[44:47], v[12:15], a[120:127], v116
    ds_read_b128 v[4:7], v124 offset:1024
    v_mul_f32 v37, s34, v37
    v_smfmac_f32_16x16x64_bf16 v[44:47], v[24:27], a[152:159], v116
    v_cvt_pk_bf16_f32 v34, v32, v36
    v_smfmac_f32_16x16x64_bf16 v[44:47], v[28:31], a[184:191], v116
    buffer_load_dwordx4 v117, s[8:11], s31 offen offset:1024 lds
    s_mov_b32 m0, 5120
    v_cvt_pk_bf16_f32 v35, v33, v37
    v_add_f32 v40, v40, v42
    v_smfmac_f32_16x16x64_bf16 v[48:51], v[8:11], a[224:231], v116
    ds_write2_b32 v120, v34, v35 offset0:32 offset1:48
    v_add_f32 v41, v41, v43
    v_smfmac_f32_16x16x64_bf16 v[52:55], v[8:11], a[232:239], v116
    v_add_f32 v44, v44, v46
    v_add_f32 v45, v45, v47
    v_cvt_pk_bf16_f32 v113, v40, v44
    v_cvt_pk_bf16_f32 v115, v41, v45
    v_smfmac_f32_16x16x64_bf16 v[48:51], v[12:15], a[240:247], v116
    ds_write2_b32 v120, v113, v115 offset0:0 offset1:16
    v_smfmac_f32_16x16x64_bf16 v[52:55], v[12:15], a[248:255], v116
    s_cmp_eq_u32 s22, 63
    s_cbranch_scc1 L_chain_last_f
    v_smfmac_f32_16x16x64_bf16 v[48:51], v[16:19], v[128:135], v116
    v_smfmac_f32_16x16x64_bf16 v[48:51], v[20:23], v[160:167], v116
    v_smfmac_f32_16x16x64_bf16 v[48:51], v[24:27], v[144:151], v116
    s_waitcnt lgkmcnt(0)
    s_barrier
    v_smfmac_f32_16x16x64_bf16 v[48:51], v[28:31], v[176:183], v116
    ds_read_b128 v[32:35], v121 offset:16384
    ds_read_b128 v[36:39], v121 offset:17408
    v_smfmac_f32_16x16x64_bf16 v[52:55], v[16:19], v[136:143], v116
    ds_read_b128 v[40:43], v121 offset:18432
    ds_read_b128 v[44:47], v121 offset:19456
    v_smfmac_f32_16x16x64_bf16 v[52:55], v[20:23], v[168:175], v116
    ds_read_b128 v[8:11], v124 offset:32768
    v_add_f32 v48, v48, v50
    v_smfmac_f32_16x16x64_bf16 v[52:55], v[24:27], v[152:159], v116
    ds_read_b128 v[12:15], v124 offset:33792
    v_add_f32 v49, v49, v51
    v_smfmac_f32_16x16x64_bf16 v[52:55], v[28:31], v[184:191], v116
    s_waitcnt lgkmcnt(5)
    v_cvt_pk_bf16_f32 v112, v48, v49
    v_mfma_f32_16x16x32_bf16 v[56:59], v[56:59], v[32:35], 0
    s_waitcnt lgkmcnt(4)
    v_mov_b32 v48, s50
    v_mov_b32 v49, s50
    v_mfma_f32_16x16x32_bf16 v[56:59], v[60:63], v[36:39], v[56:59]
    ds_read_b128 v[16:19], v124 offset:2048
    s_waitcnt lgkmcnt(4)
    v_mov_b32 v50, s50
    v_mov_b32 v51, s50
    v_mfma_f32_16x16x32_bf16 v[56:59], v[64:67], v[40:43], v[56:59]
    ds_read_b128 v[20:23], v124 offset:3072
    s_waitcnt lgkmcnt(4)
    v_add_f32 v52, v52, v54
    v_mfma_f32_16x16x32_bf16 v[56:59], v[68:71], v[44:47], v[56:59]
    ds_read_b128 v[24:27], v124 offset:4096
    v_add_f32 v53, v53, v55
    v_mfma_f32_16x16x32_bf16 v[60:63], v[72:75], v[32:35], 0
    ds_read_b128 v[28:31], v124 offset:5120
    v_cvt_pk_bf16_f32 v114, v52, v53
    v_mov_b32 v53, 0
    v_mfma_f32_16x16x32_bf16 v[60:63], v[76:79], v[36:39], v[60:63]
    v_exp_f32 v56, v56
    v_mfma_f32_16x16x32_bf16 v[60:63], v[80:83], v[40:43], v[60:63]
    v_exp_f32 v57, v57
    v_mfma_f32_16x16x32_bf16 v[60:63], v[84:87], v[44:47], v[60:63]
    v_exp_f32 v58, v58
    v_mfma_f32_16x16x32_bf16 v[64:67], v[32:35], v[32:35], 0
    v_exp_f32 v59, v59
    v_cvt_pk_bf16_f32 v68, v56, v57
    v_mfma_f32_16x16x32_bf16 v[64:67], v[36:39], v[36:39], v[64:67]
    v_exp_f32 v60, v60
    v_cvt_pk_bf16_f32 v69, v58, v59
    v_mfma_f32_16x16x32_bf16 v[64:67], v[40:43], v[40:43], v[64:67]
    v_exp_f32 v61, v61
    v_mfma_f32_16x16x32_bf16 v[64:67], v[44:47], v[44:47], v[64:67]
    v_exp_f32 v62, v62
    v_exp_f32 v63, v63
    v_cvt_pk_bf16_f32 v70, v60, v61
    v_cvt_pk_bf16_f32 v71, v62, v63
    s_nop 1
    v_mfma_f32_16x16x32_bf16 v[72:75], v[88:91], v[68:71], 0
    s_nop 0
    v_exp_f32 v64, v64
    v_mfma_f32_16x16x32_bf16 v[76:79], v[92:95], v[68:71], 0
    v_exp_f32 v65, v65
    v_mfma_f32_16x16x32_bf16 v[80:83], v[48:51], v[68:71], 0
    v_cvt_pk_bf16_f32 v52, v64, v65
    s_nop 1
    v_mfma_f32_16x16x16_bf16 v[72:75], v[112:113], v[52:53], v[72:75]
    ds_read_b128 v[32:35], v124 offset:6144
    v_mfma_f32_16x16x16_bf16 v[76:79], v[114:115], v[52:53], v[76:79]
    ds_read_b128 v[36:39], v124 offset:7168
    v_mfma_f32_16x16x16_bf16 v[80:83], v[48:49], v[52:53], v[80:83]
L_norm_24:
    s_mov_b64 vcc, s[36:37]
    v_mov_b32 v122, v122
    v_mov_b32 v122, v122
    v_mov_b32 v122, v122
    v_cndmask_b32_dpp v76, v72, v76, vcc quad_perm:[2,3,2,3] row_mask:0xf bank_mask:0xf
    v_cndmask_b32_dpp v77, v73, v77, vcc quad_perm:[2,3,2,3] row_mask:0xf bank_mask:0xf
    v_cndmask_b32_dpp v78, v74, v78, vcc quad_perm:[2,3,2,3] row_mask:0xf bank_mask:0xf
    v_cndmask_b32_dpp v79, v75, v79, vcc quad_perm:[2,3,2,3] row_mask:0xf bank_mask:0xf
    v_rcp_f32_dpp v84, v80 quad_perm:[2,3,2,3] row_mask:0xf bank_mask:0xf
    s_nop 0
    v_pk_mul_f32 v[76:77], v[76:77], v[84:85] op_sel_hi:[1,0]
    v_pk_mul_f32 v[78:79], v[78:79], v[84:85] op_sel_hi:[1,0]
    v_cvt_pk_bf16_f32 v72, v76, v77
    v_cvt_pk_bf16_f32 v73, v78, v79
    ds_write_b64 v122, v[72:73] offset:20992
    v_max_f32_dpp v86, v80, v84 quad_perm:[2,3,2,3] row_mask:0xf bank_mask:0xf
    v_mov_b32_dpp v60, v72 quad_perm:[0,1,0,1] row_mask:0xf bank_mask:0xf
    v_mov_b32_dpp v61, v73 quad_perm:[0,1,0,1] row_mask:0xf bank_mask:0xf
    v_cmp_lt_f32 vcc, s35, v86
    v_mov_b32_dpp v62, v72 quad_perm:[2,3,2,3] row_mask:0xf bank_mask:0xf
    v_mov_b32_dpp v63, v73 quad_perm:[2,3,2,3] row_mask:0xf bank_mask:0xf
    s_nop 1
    v_smfmac_f32_16x16x64_bf16 v[96:99], v[60:63], v[192:199], v116
    s_cbranch_vccnz L_smax_25
    v_smfmac_f32_16x16x64_bf16 v[100:103], v[60:63], v[224:231], v116
    s_waitcnt lgkmcnt(0)
    s_barrier
    ds_read_b128 v[92:95], v127 offset:20480
    ds_read_b128 v[80:83], v127 offset:22016
    ds_read_b128 v[84:87], v127 offset:21504
    v_smfmac_f32_16x16x64_bf16 v[104:107], v[60:63], v[0:7], v116
    ds_read_b128 v[40:43], v124 offset:34816
    v_smfmac_f32_16x16x64_bf16 v[108:111], v[60:63], v[8:15], v116
    ds_read_b128 v[56:59], v124 offset:36864
    s_waitcnt lgkmcnt(4)
    v_smfmac_f32_16x16x64_bf16 v[96:99], v[92:95], v[200:207], v116
    s_waitcnt lgkmcnt(3)
    v_smfmac_f32_16x16x64_bf16 v[96:99], v[80:83], v[208:215], v116
    ds_read_b128 v[44:47], v124 offset:35840
    s_waitcnt lgkmcnt(3)
    v_smfmac_f32_16x16x64_bf16 v[96:99], v[84:87], v[216:223], v116
    ds_read_b128 v[68:71], v124 offset:39936
    v_smfmac_f32_16x16x64_bf16 v[100:103], v[92:95], v[232:239], v116
    ds_read_b128 v[64:67], v124 offset:38912
    v_smfmac_f32_16x16x64_bf16 v[100:103], v[80:83], v[240:247], v116
    ds_read_b128 v[60:63], v124 offset:37888
    v_cvt_pk_bf16_f32 v72, v96, v98
    v_smfmac_f32_16x16x64_bf16 v[100:103], v[84:87], v[248:255], v116
    v_and_or_b32 v72, v72, -2, s33
    v_smfmac_f32_16x16x64_bf16 v[104:107], v[92:95], v[16:23], v116
    v_cvt_pk_bf16_f32 v74, v97, v99
    v_smfmac_f32_16x16x64_bf16 v[104:107], v[80:83], v[24:31], v116
    v_cvt_pk_bf16_f32 v73, v100, v102
    v_cvt_pk_bf16_f32 v75, v101, v103
    v_smfmac_f32_16x16x64_bf16 v[104:107], v[84:87], v[32:39], v116
    buffer_store_dwordx4 v[72:75], v118, s[8:11], s25 offen
    s_waitcnt lgkmcnt(3)
    v_smfmac_f32_16x16x64_bf16 v[108:111], v[92:95], v[40:47], v116
    s_waitcnt lgkmcnt(0)
    v_smfmac_f32_16x16x64_bf16 v[108:111], v[80:83], v[56:63], v116
    v_cvt_pk_bf16_f32 v76, v104, v106
    v_smfmac_f32_16x16x64_bf16 v[108:111], v[84:87], v[64:71], v116
    v_and_or_b32 v76, v76, -2, s33
    v_cvt_pk_bf16_f32 v78, v105, v107
    v_mov_b32 v122, v122
    v_mov_b32 v122, v122
    v_mov_b32 v122, v122
    v_mov_b32 v122, v122
    v_mov_b32 v122, v122
    v_mov_b32 v122, v122
    v_cvt_pk_bf16_f32 v77, v108, v110
    v_cvt_pk_bf16_f32 v79, v109, v111
    buffer_store_dwordx4 v[76:79], v118, s[8:11], s26 offen
    s_add_u32 s30, s30, 0x40000
    s_add_u32 s31, s31, 0x40000
    s_add_u32 s32, s32, 0x20000
    s_add_u32 s23, s24, 1024
    s_add_u32 s48, s23, 4096
    s_xor_b32 s25, s25, 0x40000
    s_xor_b32 s26, s26, 0x40000
    s_mov_b32 s35, 0x49800000
    s_add_u32 s22, s22, 1
    v_mov_b32 v32, 0
    v_mov_b32 v33, 0
    v_mov_b32 v34, 0
    v_mov_b32 v35, 0
    v_mov_b32 v36, 0
    v_mov_b32 v37, 0
    v_mov_b32 v38, 0
    v_mov_b32 v39, 0
    v_mov_b32 v40, 0
    v_mov_b32 v41, 0
    v_mov_b32 v42, 0
    v_mov_b32 v43, 0
    v_mov_b32 v44, 0
    v_mov_b32 v45, 0
    v_mov_b32 v46, 0
    v_mov_b32 v47, 0
    v_mov_b32 v48, 0
    v_mov_b32 v49, 0
    v_mov_b32 v50, 0
    v_mov_b32 v51, 0
    v_mov_b32 v52, 0
    v_mov_b32 v53, 0
    v_mov_b32 v54, 0
    v_mov_b32 v55, 0
    ds_read_b128 v[80:83], v123
    ds_read_b128 v[84:87], v123 offset:1024
    ds_read_b128 v[56:59], v123 offset:2048
    ds_read_b128 v[60:63], v123 offset:3072
    ds_read_b128 v[64:67], v123 offset:32768
    ds_read_b128 v[68:71], v123 offset:33792
    ds_read_b128 v[72:75], v123 offset:34816
    ds_read_b128 v[76:79], v123 offset:35840
    ds_read_b128 v[88:91], v123 offset:4096
    ds_read_b128 v[92:95], v123 offset:5120
    ds_read_b128 v[96:99], v123 offset:6144
    ds_read_b128 v[100:103], v123 offset:7168
    ds_read_b128 v[104:107], v123 offset:36864
    ds_read_b128 v[108:111], v123 offset:37888
    ds_read_b128 v[24:27], v123 offset:38912
    ds_read_b128 v[28:31], v123 offset:39936
    s_add_u32 s24, s24, 8192
    s_bitset0_b32 s24, 15
    s_xor_b32 s55, s24, 16384
    s_xor_b32 s29, s29, 0x40000
    s_xor_b32 s53, s29, 1024
    s_bfe_u32 s33, s22, 0x10001
    s_add_u32 s40, s22, 5
    s_lshr_b32 s40, s40, 2
    s_min_u32 s40, s40, 16
    s_bfm_b32 s58, s40, 0
    s_waitcnt vmcnt(4)
    v_cmp_eq_u32 vcc, 0, v125
    s_nop 0
    s_and_b64 vcc, vcc, s[58:59]
    s_cbranch_scc1 L_kvw_26
L_kvb_27:
    v_mov_b32 v15, 0
    s_nop 2
    v_mov_b32 v15, 0
    s_nop 2
    v_mov_b32 v15, 0
    s_nop 2
    v_mov_b32 v15, 0
    s_nop 2
    v_mov_b32 v15, 0
    s_nop 2
    v_mov_b32 v15, 0
    s_nop 2
    v_mov_b32 v15, 0
    s_nop 2
    v_mov_b32 v15, 0
    s_nop 2
    v_mov_b32 v15, 0
    s_nop 2
    v_mov_b32 v15, 0
    s_nop 2
    v_mov_b32 v15, 0
    s_nop 2
    v_mov_b32 v15, 0
    s_nop 2
    v_mov_b32 v15, 0
    s_nop 2
    v_mov_b32 v15, 0
    s_nop 2
    v_mov_b32 v15, 0
    s_nop 2
    v_mov_b32 v15, 0
    s_nop 2
    v_mov_b32 v15, 0
    s_nop 2
    v_mov_b32 v15, 0
    s_nop 2
    v_mov_b32 v15, 0
    s_nop 2
    v_mov_b32 v15, 0
    s_nop 2
    v_mov_b32 v15, 0
    s_nop 2
    v_mov_b32 v15, 0
    s_nop 2
    v_mov_b32 v15, 0
    s_nop 2
    v_mov_b32 v15, 0
    s_nop 2
    v_mov_b32 v15, 0
    s_nop 2
    v_mov_b32 v15, 0
    s_nop 2
    v_mov_b32 v15, 0
    s_nop 2
    v_mov_b32 v15, 0
    s_nop 2
    v_mov_b32 v15, 0
    s_nop 2
    v_mov_b32 v15, 0
    s_nop 2
    v_mov_b32 v15, 0
    s_nop 2
    s_waitcnt lgkmcnt(0)
    s_branch L_chain_top1_f
.p2align 6
L_chain_top2_f:
    buffer_load_dwordx4 v[0:3], v117, s[8:11], s23 offen nt
    v_mov_b32 v48, 0
    v_mov_b32 v49, 0
    v_mov_b32 v50, 0
    v_mov_b32 v51, 0
    v_mov_b32 v52, 0
    v_mov_b32 v53, 0
    v_mov_b32 v15, 0
    v_mov_b32 v15, 0
    v_mov_b32 v15, 0
    v_mov_b32 v15, 0
    v_mov_b32 v15, 0
    v_mov_b32 v15, 0
    v_mov_b32 v15, 0
    v_mov_b32 v15, 0
    v_mov_b32 v15, 0
    v_mov_b32 v15, 0
    buffer_load_dwordx4 v[0:3], v117, s[8:11], s23 offen sc1
    s_waitcnt vmcnt(3)
    v_mov_b32 v36, 0
    v_mov_b32 v37, 0
    v_mov_b32 v38, 0
    v_mov_b32 v39, 0
    v_mov_b32 v40, 0
    v_mov_b32 v41, 0
    v_mov_b32 v42, 0
    v_mov_b32 v43, 0
    v_mov_b32 v44, 0
    v_mov_b32 v45, 0
    v_mov_b32 v46, 0
    v_mov_b32 v47, 0
    v_mov_b32 v15, 0
    v_mov_b32 v15, 0
    v_mov_b32 v15, 0
    v_mov_b32 v15, 0
L_mret_28:
    buffer_load_dwordx4 v[0:3], v117, s[8:11], s23 offen sc1
    s_add_u32 s45, s45, 1
    s_cmp_lt_u32 s45, 0x10000
    s_cselect_b32 s56, -2, -1
    s_nop 3
    v_mov_b32 v32, 0
    v_mov_b32 v33, 0
    v_mov_b32 v34, 0
    v_mov_b32 v35, 0
    s_waitcnt vmcnt(2)
    v_max3_u32 v15, v0, v1, v2
    v_max_u32 v15, v15, v3
    v_cmp_lt_u32 vcc, s56, v15
    v_smfmac_f32_16x16x64_bf16 v[32:35], v[0:3], v[80:87], v116
    s_cbranch_vccnz L_mret_28
    ds_write_b128 v117, v[0:3] offset:2048
    v_smfmac_f32_16x16x64_bf16 v[36:39], v[0:3], v[56:63], v116
    buffer_load_dwordx4 v[4:7], v117, s[8:11], s48 offen nt
    v_smfmac_f32_16x16x64_bf16 v[40:43], v[0:3], v[64:71], v116
    buffer_load_dwordx4 v117, s[8:11], s48 offen nt lds
    s_mov_b32 m0, 12288
    v_smfmac_f32_16x16x64_bf16 v[44:47], v[0:3], v[72:79], v116
    s_waitcnt lgkmcnt(0)
    s_barrier
    ds_read_b128 v[8:11], v117 offset:3072
    v_smfmac_f32_16x16x64_bf16 v[48:51], v[0:3], a[192:199], v116
    ds_read_b128 v[16:19], v117
    ds_read_b128 v[20:23], v117 offset:1024
    v_smfmac_f32_16x16x64_bf16 v[52:55], v[0:3], a[200:207], v116
    ds_read_b128 v[80:83], v117 offset:14336
    s_waitcnt lgkmcnt(3)
    v_smfmac_f32_16x16x64_bf16 v[32:35], v[8:11], a[0:7], v116
    ds_read_b128 v[84:87], v117 offset:15360
    v_smfmac_f32_16x16x64_bf16 v[36:39], v[8:11], a[8:15], v116
    ds_read_b128 v[56:59], v117 offset:8192
    s_waitcnt lgkmcnt(4)
    v_smfmac_f32_16x16x64_bf16 v[32:35], v[16:19], a[32:39], v116
    ds_read_b128 v[60:63], v117 offset:9216
    v_smfmac_f32_16x16x64_bf16 v[36:39], v[16:19], a[40:47], v116
    ds_read_b128 v[64:67], v117 offset:10240
    s_waitcnt lgkmcnt(5)
    v_smfmac_f32_16x16x64_bf16 v[32:35], v[20:23], a[64:71], v116
    ds_read_b128 v[68:71], v117 offset:11264
    v_smfmac_f32_16x16x64_bf16 v[36:39], v[20:23], a[72:79], v116
    buffer_store_dwordx4 v[112:115], v117, s[8:11], s32 offen sc1
    v_smfmac_f32_16x16x64_bf16 v[40:43], v[8:11], a[96:103], v116
    ds_read_b128 v[72:75], v117 offset:12288
    v_smfmac_f32_16x16x64_bf16 v[40:43], v[16:19], a[128:135], v116
    ds_read_b128 v[76:79], v117 offset:13312
    v_smfmac_f32_16x16x64_bf16 v[40:43], v[20:23], a[160:167], v116
    s_waitcnt vmcnt(2)
    v_max3_u32 v15, v4, v5, v6
    v_smfmac_f32_16x16x64_bf16 v[44:47], v[8:11], a[104:111], v116
    v_max_u32 v15, v15, v7
    v_smfmac_f32_16x16x64_bf16 v[44:47], v[16:19], a[136:143], v116
    s_waitcnt vmcnt(1) lgkmcnt(0)
    v_cmp_lt_u32 vcc, s56, v15
    v_smfmac_f32_16x16x64_bf16 v[44:47], v[20:23], a[168:175], v116
    s_cbranch_vccnz L_mret_29
L_mgo_30:
    v_smfmac_f32_16x16x64_bf16 v[44:47], v[4:7], v[24:31], v116
    s_barrier
    ds_read_b128 v[12:15], v117 offset:7168
    v_smfmac_f32_16x16x64_bf16 v[32:35], v[4:7], v[88:95], v116
    ds_read_b128 v[24:27], v117 offset:4096
    v_smfmac_f32_16x16x64_bf16 v[36:39], v[4:7], v[96:103], v116
    ds_read_b128 v[28:31], v117 offset:5120
    v_smfmac_f32_16x16x64_bf16 v[40:43], v[4:7], v[104:111], v116
    ds_read_b128 v[88:91], v117 offset:28672
    s_waitcnt lgkmcnt(3)
    v_smfmac_f32_16x16x64_bf16 v[32:35], v[12:15], a[16:23], v116
    ds_read_b128 v[92:95], v117 offset:29696
    s_waitcnt lgkmcnt(3)
    v_smfmac_f32_16x16x64_bf16 v[32:35], v[24:27], a[48:55], v116
    buffer_load_dwordx4 v117, s[8:11], s30 offen lds
    s_waitcnt lgkmcnt(2)
    v_smfmac_f32_16x16x64_bf16 v[32:35], v[28:31], a[80:87], v116
    ds_read_b128 v[96:99], v117 offset:23552
    v_smfmac_f32_16x16x64_bf16 v[36:39], v[12:15], a[24:31], v116
    ds_read_b128 v[100:103], v117 offset:23552
    v_smfmac_f32_16x16x64_bf16 v[36:39], v[24:27], a[56:63], v116
    buffer_load_dwordx4 v117, s[8:11], s30 offen offset:1024 lds
    s_add_u32 m0, s52, 0x6000
    v_add_f32 v32, v32, v34
    v_smfmac_f32_16x16x64_bf16 v[36:39], v[28:31], a[88:95], v116
    ds_read_b128 v[104:107], v117 offset:23552
    v_add_f32 v33, v33, v35
    v_smfmac_f32_16x16x64_bf16 v[40:43], v[12:15], a[112:119], v116
    ds_read_b128 v[108:111], v117 offset:23552
    v_mul_f32 v32, s34, v32
    v_smfmac_f32_16x16x64_bf16 v[40:43], v[24:27], a[144:151], v116
    s_waitcnt lgkmcnt(4)
    buffer_load_dwordx4 v117, s[8:11], s31 offen lds
    v_mul_f32 v33, s34, v33
    v_smfmac_f32_16x16x64_bf16 v[40:43], v[28:31], a[176:183], v116
    ds_read_b128 v[0:3], v124
    v_add_f32 v36, v36, v38
    v_smfmac_f32_16x16x64_bf16 v[48:51], v[4:7], a[208:215], v116
    v_add_f32 v37, v37, v39
    v_smfmac_f32_16x16x64_bf16 v[52:55], v[4:7], a[216:223], v116
    buffer_load_dwordx4 v117, s[8:11], s31 offen offset:1024 lds
    s_mov_b32 m0, 6144
    v_mul_f32 v36, s34, v36
    v_smfmac_f32_16x16x64_bf16 v[44:47], v[12:15], a[120:127], v116
    ds_read_b128 v[4:7], v124 offset:1024
    v_mul_f32 v37, s34, v37
    v_smfmac_f32_16x16x64_bf16 v[44:47], v[24:27], a[152:159], v116
    v_cvt_pk_bf16_f32 v34, v32, v36
    v_smfmac_f32_16x16x64_bf16 v[44:47], v[28:31], a[184:191], v116
    v_cvt_pk_bf16_f32 v35, v33, v37
    v_add_f32 v40, v40, v42
    v_smfmac_f32_16x16x64_bf16 v[48:51], v[8:11], a[224:231], v116
    ds_write2_b32 v120, v34, v35 offset0:32 offset1:48
    v_add_f32 v41, v41, v43
    v_smfmac_f32_16x16x64_bf16 v[52:55], v[8:11], a[232:239], v116
    v_add_f32 v44, v44, v46
    v_add_f32 v45, v45, v47
    v_cvt_pk_bf16_f32 v113, v40, v44
    v_cvt_pk_bf16_f32 v115, v41, v45
    v_smfmac_f32_16x16x64_bf16 v[48:51], v[12:15], a[240:247], v116
    ds_write2_b32 v120, v113, v115 offset0:0 offset1:16
    v_smfmac_f32_16x16x64_bf16 v[52:55], v[12:15], a[248:255], v116
    s_cmp_eq_u32 s22, 63
    s_cbranch_scc1 L_chain_last_f
    v_smfmac_f32_16x16x64_bf16 v[48:51], v[16:19], v[128:135], v116
    buffer_store_dword v126, v119, s[8:11], s55 offen
    v_smfmac_f32_16x16x64_bf16 v[48:51], v[20:23], v[160:167], v116
    v_smfmac_f32_16x16x64_bf16 v[48:51], v[24:27], v[144:151], v116
    s_waitcnt lgkmcnt(0)
    s_barrier
    v_smfmac_f32_16x16x64_bf16 v[48:51], v[28:31], v[176:183], v116
    ds_read_b128 v[32:35], v121 offset:16384
    ds_read_b128 v[36:39], v121 offset:17408
    v_smfmac_f32_16x16x64_bf16 v[52:55], v[16:19], v[136:143], v116
    ds_read_b128 v[40:43], v121 offset:18432
    ds_read_b128 v[44:47], v121 offset:19456
    v_smfmac_f32_16x16x64_bf16 v[52:55], v[20:23], v[168:175], v116
    ds_read_b128 v[8:11], v124 offset:32768
    v_add_f32 v48, v48, v50
    v_smfmac_f32_16x16x64_bf16 v[52:55], v[24:27], v[152:159], v116
    ds_read_b128 v[12:15], v124 offset:33792
    v_add_f32 v49, v49, v51
    v_smfmac_f32_16x16x64_bf16 v[52:55], v[28:31], v[184:191], v116
    s_waitcnt lgkmcnt(5)
    v_cvt_pk_bf16_f32 v112, v48, v49
    v_mfma_f32_16x16x32_bf16 v[56:59], v[56:59], v[32:35], 0
    s_waitcnt lgkmcnt(4)
    v_mov_b32 v48, s50
    v_mov_b32 v49, s50
    v_mfma_f32_16x16x32_bf16 v[56:59], v[60:63], v[36:39], v[56:59]
    ds_read_b128 v[16:19], v124 offset:2048
    s_waitcnt lgkmcnt(4)
    v_mov_b32 v50, s50
    v_mov_b32 v51, s50
    v_mfma_f32_16x16x32_bf16 v[56:59], v[64:67], v[40:43], v[56:59]
    ds_read_b128 v[20:23], v124 offset:3072
    s_waitcnt lgkmcnt(4)
    v_add_f32 v52, v52, v54
    v_mfma_f32_16x16x32_bf16 v[56:59], v[68:71], v[44:47], v[56:59]
    ds_read_b128 v[24:27], v124 offset:4096
    v_add_f32 v53, v53, v55
    v_mfma_f32_16x16x32_bf16 v[60:63], v[72:75], v[32:35], 0
    ds_read_b128 v[28:31], v124 offset:5120
    v_cvt_pk_bf16_f32 v114, v52, v53
    v_mov_b32 v53, 0
    v_mfma_f32_16x16x32_bf16 v[60:63], v[76:79], v[36:39], v[60:63]
    v_exp_f32 v56, v56
    v_mfma_f32_16x16x32_bf16 v[60:63], v[80:83], v[40:43], v[60:63]
    v_exp_f32 v57, v57
    v_mfma_f32_16x16x32_bf16 v[60:63], v[84:87], v[44:47], v[60:63]
    v_exp_f32 v58, v58
    v_mfma_f32_16x16x32_bf16 v[64:67], v[32:35], v[32:35], 0
    v_exp_f32 v59, v59
    v_cvt_pk_bf16_f32 v68, v56, v57
    v_mfma_f32_16x16x32_bf16 v[64:67], v[36:39], v[36:39], v[64:67]
    v_exp_f32 v60, v60
    v_cvt_pk_bf16_f32 v69, v58, v59
    v_mfma_f32_16x16x32_bf16 v[64:67], v[40:43], v[40:43], v[64:67]
    v_exp_f32 v61, v61
    v_mfma_f32_16x16x32_bf16 v[64:67], v[44:47], v[44:47], v[64:67]
    v_exp_f32 v62, v62
    v_exp_f32 v63, v63
    v_cvt_pk_bf16_f32 v70, v60, v61
    v_cvt_pk_bf16_f32 v71, v62, v63
    s_nop 1
    v_mfma_f32_16x16x32_bf16 v[72:75], v[88:91], v[68:71], 0
    s_nop 0
    v_exp_f32 v64, v64
    v_mfma_f32_16x16x32_bf16 v[76:79], v[92:95], v[68:71], 0
    v_exp_f32 v65, v65
    v_mfma_f32_16x16x32_bf16 v[80:83], v[48:51], v[68:71], 0
    v_cvt_pk_bf16_f32 v52, v64, v65
    s_nop 1
    v_mfma_f32_16x16x16_bf16 v[72:75], v[112:113], v[52:53], v[72:75]
    ds_read_b128 v[32:35], v124 offset:6144
    v_mfma_f32_16x16x16_bf16 v[76:79], v[114:115], v[52:53], v[76:79]
    ds_read_b128 v[36:39], v124 offset:7168
    v_mfma_f32_16x16x16_bf16 v[80:83], v[48:49], v[52:53], v[80:83]
L_norm_31:
    s_mov_b64 vcc, s[36:37]
    v_mov_b32 v122, v122
    v_mov_b32 v122, v122
    v_mov_b32 v122, v122
    v_cndmask_b32_dpp v76, v72, v76, vcc quad_perm:[2,3,2,3] row_mask:0xf bank_mask:0xf
    v_cndmask_b32_dpp v77, v73, v77, vcc quad_perm:[2,3,2,3] row_mask:0xf bank_mask:0xf
    v_cndmask_b32_dpp v78, v74, v78, vcc quad_perm:[2,3,2,3] row_mask:0xf bank_mask:0xf
    v_cndmask_b32_dpp v79, v75, v79, vcc quad_perm:[2,3,2,3] row_mask:0xf bank_mask:0xf
    v_rcp_f32_dpp v84, v80 quad_perm:[2,3,2,3] row_mask:0xf bank_mask:0xf
    s_nop 0
    v_pk_mul_f32 v[76:77], v[76:77], v[84:85] op_sel_hi:[1,0]
    v_pk_mul_f32 v[78:79], v[78:79], v[84:85] op_sel_hi:[1,0]
    v_cvt_pk_bf16_f32 v72, v76, v77
    v_cvt_pk_bf16_f32 v73, v78, v79
    ds_write_b64 v122, v[72:73] offset:21504
    v_max_f32_dpp v86, v80, v84 quad_perm:[2,3,2,3] row_mask:0xf bank_mask:0xf
    v_mov_b32_dpp v60, v72 quad_perm:[0,1,0,1] row_mask:0xf bank_mask:0xf
    v_mov_b32_dpp v61, v73 quad_perm:[0,1,0,1] row_mask:0xf bank_mask:0xf
    v_cmp_lt_f32 vcc, s35, v86
    v_mov_b32_dpp v62, v72 quad_perm:[2,3,2,3] row_mask:0xf bank_mask:0xf
    v_mov_b32_dpp v63, v73 quad_perm:[2,3,2,3] row_mask:0xf bank_mask:0xf
    s_nop 1
    v_smfmac_f32_16x16x64_bf16 v[96:99], v[60:63], v[192:199], v116
    s_cbranch_vccnz L_smax_32
    v_smfmac_f32_16x16x64_bf16 v[100:103], v[60:63], v[224:231], v116
    s_waitcnt lgkmcnt(0)
    s_barrier
    ds_read_b128 v[92:95], v127 offset:22016
    ds_read_b128 v[80:83], v127 offset:20480
    ds_read_b128 v[84:87], v127 offset:20992
    v_smfmac_f32_16x16x64_bf16 v[104:107], v[60:63], v[0:7], v116
    ds_read_b128 v[40:43], v124 offset:34816
    v_smfmac_f32_16x16x64_bf16 v[108:111], v[60:63], v[8:15], v116
    ds_read_b128 v[56:59], v124 offset:36864
    s_waitcnt lgkmcnt(4)
    v_smfmac_f32_16x16x64_bf16 v[96:99], v[92:95], v[200:207], v116
    s_waitcnt lgkmcnt(3)
    v_smfmac_f32_16x16x64_bf16 v[96:99], v[80:83], v[208:215], v116
    ds_read_b128 v[44:47], v124 offset:35840
    s_waitcnt lgkmcnt(3)
    v_smfmac_f32_16x16x64_bf16 v[96:99], v[84:87], v[216:223], v116
    ds_read_b128 v[68:71], v124 offset:39936
    v_smfmac_f32_16x16x64_bf16 v[100:103], v[92:95], v[232:239], v116
    ds_read_b128 v[64:67], v124 offset:38912
    v_smfmac_f32_16x16x64_bf16 v[100:103], v[80:83], v[240:247], v116
    ds_read_b128 v[60:63], v124 offset:37888
    v_cvt_pk_bf16_f32 v72, v96, v98
    v_smfmac_f32_16x16x64_bf16 v[100:103], v[84:87], v[248:255], v116
    v_and_or_b32 v72, v72, -2, s33
    v_smfmac_f32_16x16x64_bf16 v[104:107], v[92:95], v[16:23], v116
    v_cvt_pk_bf16_f32 v74, v97, v99
    v_smfmac_f32_16x16x64_bf16 v[104:107], v[80:83], v[24:31], v116
    v_cvt_pk_bf16_f32 v73, v100, v102
    v_cvt_pk_bf16_f32 v75, v101, v103
    v_smfmac_f32_16x16x64_bf16 v[104:107], v[84:87], v[32:39], v116
    buffer_store_dwordx4 v[72:75], v118, s[8:11], s25 offen
    s_waitcnt lgkmcnt(3)
    v_smfmac_f32_16x16x64_bf16 v[108:111], v[92:95], v[40:47], v116
    s_waitcnt lgkmcnt(0)
    v_smfmac_f32_16x16x64_bf16 v[108:111], v[80:83], v[56:63], v116
    v_cvt_pk_bf16_f32 v76, v104, v106
    v_smfmac_f32_16x16x64_bf16 v[108:111], v[84:87], v[64:71], v116
    v_and_or_b32 v76, v76, -2, s33
    v_cvt_pk_bf16_f32 v78, v105, v107
    v_mov_b32 v122, v122
    v_mov_b32 v122, v122
    v_mov_b32 v122, v122
    v_mov_b32 v122, v122
    v_mov_b32 v122, v122
    v_mov_b32 v122, v122
    v_cvt_pk_bf16_f32 v77, v108, v110
    v_cvt_pk_bf16_f32 v79, v109, v111
    buffer_store_dwordx4 v[76:79], v118, s[8:11], s26 offen
    ds_read_b128 v[80:83], v123
    ds_read_b128 v[84:87], v123 offset:1024
    ds_read_b128 v[56:59], v123 offset:2048
    ds_read_b128 v[60:63], v123 offset:3072
    ds_read_b128 v[64:67], v123 offset:32768
    ds_read_b128 v[68:71], v123 offset:33792
    ds_read_b128 v[72:75], v123 offset:34816
    ds_read_b128 v[76:79], v123 offset:35840
    ds_read_b128 v[88:91], v123 offset:4096
    ds_read_b128 v[92:95], v123 offset:5120
    ds_read_b128 v[96:99], v123 offset:6144
    ds_read_b128 v[100:103], v123 offset:7168
    ds_read_b128 v[104:107], v123 offset:36864
    ds_read_b128 v[108:111], v123 offset:37888
    ds_read_b128 v[24:27], v123 offset:38912
    ds_read_b128 v[28:31], v123 offset:39936
    s_add_u32 s30, s30, 0x40000
    s_add_u32 s31, s31, 0x40000
    s_add_u32 s32, s32, 0x20000
    s_add_u32 s23, s24, 2048
    s_add_u32 s48, s23, 4096
    s_xor_b32 s25, s25, 0x40000
    s_xor_b32 s26, s26, 0x40000
    s_mov_b32 s35, 0x49800000
    s_add_u32 s22, s22, 1
    v_cndmask_b32 v12, 0, v125, s[68:69]
    v_cndmask_b32 v13, 0, v125, s[70:71]
    v_cndmask_b32 v14, 0, v125, s[72:73]
    v_cndmask_b32 v15, 0, v125, s[74:75]
    v_mov_b32 v54, 0
    v_mov_b32 v55, 0
    v_mov_b32 v52, 0
    v_mov_b32 v52, 0
    v_mov_b32 v52, 0
    v_mov_b32 v52, 0
    v_mov_b32 v52, 0
    v_mov_b32 v52, 0
    v_mov_b32 v52, 0
    v_mov_b32 v52, 0
    v_mov_b32 v52, 0
    v_mov_b32 v52, 0
    v_mov_b32 v52, 0
    v_mov_b32 v52, 0
    v_mov_b32 v52, 0
    v_mov_b32 v52, 0
    v_mov_b32 v52, 0
    v_mov_b32 v52, 0
    v_mov_b32 v52, 0
    v_mov_b32 v52, 0
    v_mov_b32 v52, 0
    buffer_load_dwordx4 v[4:7], v117, s[8:11], s29 offen nt
    buffer_load_dwordx4 v[8:11], v117, s[8:11], s53 offen nt
    buffer_load_dwordx4 v[16:19], v117, s[8:11], s29 offen offset:2048 nt
    buffer_load_dwordx4 v[20:23], v117, s[8:11], s53 offen offset:2048 nt
    v_mov_b32 v52, 0
    v_mov_b32 v52, 0
    v_mov_b32 v52, 0
    v_mov_b32 v52, 0
    v_mov_b32 v52, 0
    v_mov_b32 v52, 0
    v_mov_b32 v52, 0
    v_mov_b32 v52, 0
    v_mov_b32 v52, 0
    v_mov_b32 v52, 0
    v_mov_b32 v52, 0
    v_mov_b32 v52, 0
    v_mov_b32 v52, 0
    v_mov_b32 v52, 0
    v_mov_b32 v52, 0
    v_mov_b32 v52, 0
    v_mov_b32 v52, 0
    v_mov_b32 v52, 0
    v_mov_b32 v52, 0
    v_mov_b32 v52, 0
    v_mov_b32 v52, 0
    v_mov_b32 v52, 0
    v_mov_b32 v52, 0
    v_mov_b32 v52, 0
    v_mov_b32 v52, 0
    v_mov_b32 v52, 0
    v_mov_b32 v52, 0
    v_mov_b32 v52, 0
    v_mov_b32 v52, 0
    v_mov_b32 v52, 0
    v_mov_b32 v52, 0
    v_mov_b32 v52, 0
    v_mov_b32 v52, 0
    v_mov_b32 v52, 0
    v_mov_b32 v52, 0
    v_mov_b32 v52, 0
    v_mov_b32 v52, 0
    v_mov_b32 v52, 0
    v_mov_b32 v52, 0
    v_mov_b32 v52, 0
    buffer_load_dwordx4 v[32:35], v117, s[8:11], s29 offen sc1
    buffer_load_dwordx4 v[36:39], v117, s[8:11], s53 offen sc1
    buffer_load_dwordx4 v[40:43], v117, s[8:11], s29 offen offset:2048 sc1
    buffer_load_dwordx4 v[44:47], v117, s[8:11], s53 offen offset:2048 sc1
    v_mov_b32 v52, 0
L_rl_33:
    s_waitcnt vmcnt(7)
    v_mfma_f32_16x16x32_bf16 v[48:51], v[4:7], v[12:15], 0
    v_xor_b32 v52, s33, v4
    s_waitcnt vmcnt(6)
    v_mfma_f32_16x16x32_bf16 v[48:51], v[8:11], v[12:15], v[48:51]
    v_xor_b32 v53, s33, v8
    v_or_b32 v52, v52, v53
    s_waitcnt vmcnt(5)
    v_mfma_f32_16x16x32_bf16 v[48:51], v[16:19], v[12:15], v[48:51]
    v_xor_b32 v53, s33, v16
    v_or_b32 v52, v52, v53
    s_waitcnt vmcnt(4)
    v_mfma_f32_16x16x32_bf16 v[48:51], v[20:23], v[12:15], v[48:51]
    v_xor_b32 v53, s33, v20
    v_or_b32 v52, v52, v53
    v_and_b32 v52, 1, v52
    v_cmp_ne_u32 vcc, 0, v52
    s_cbranch_vccnz L_rslow_34
L_rgo_35:
    s_nop 2
    v_permlane32_swap_b32 v48, v50
    v_permlane32_swap_b32 v49, v51
    v_pk_add_f32 v[48:49], v[48:49], v[50:51]
    s_mov_b64 exec, s[38:39]
    v_cvt_pk_bf16_f32 v12, v48, v49
    v_min_u32 v12, 0xfffffffe, v12
    buffer_store_dword v12, v119, s[8:11], s24 offen
    s_mov_b64 exec, -1
    s_add_u32 s24, s24, 8192
    s_bitset0_b32 s24, 15
    s_xor_b32 s55, s24, 16384
    s_xor_b32 s29, s29, 0x40000
    s_xor_b32 s53, s29, 1024
    s_bfe_u32 s33, s22, 0x10001
    s_waitcnt lgkmcnt(0)
    s_branch L_chain_top2_f
.p2align 6
L_chain_top3_f:
    buffer_load_dwordx4 v[0:3], v117, s[8:11], s23 offen nt
    v_mov_b32 v48, 0
    v_mov_b32 v49, 0
    v_mov_b32 v50, 0
    v_mov_b32 v51, 0
    v_mov_b32 v52, 0
    v_mov_b32 v53, 0
    v_mov_b32 v15, 0
    v_mov_b32 v15, 0
    v_mov_b32 v15, 0
    v_mov_b32 v15, 0
    v_mov_b32 v15, 0
    v_mov_b32 v15, 0
    v_mov_b32 v15, 0
    v_mov_b32 v15, 0
    v_mov_b32 v15, 0
    v_mov_b32 v15, 0
    buffer_load_dwordx4 v[0:3], v117, s[8:11], s23 offen sc1
    s_waitcnt vmcnt(3)
    v_mov_b32 v36, 0
    v_mov_b32 v37, 0
    v_mov_b32 v38, 0
    v_mov_b32 v39, 0
    v_mov_b32 v40, 0
    v_mov_b32 v41, 0
    v_mov_b32 v42, 0
    v_mov_b32 v43, 0
    v_mov_b32 v44, 0
    v_mov_b32 v45, 0
    v_mov_b32 v46, 0
    v_mov_b32 v47, 0
    v_mov_b32 v15, 0
    v_mov_b32 v15, 0
    v_mov_b32 v15, 0
    v_mov_b32 v15, 0
L_mret_36:
    buffer_load_dwordx4 v[0:3], v117, s[8:11], s23 offen sc1
    s_add_u32 s45, s45, 1
    s_cmp_lt_u32 s45, 0x10000
    s_cselect_b32 s56, -2, -1
    s_nop 3
    v_mov_b32 v32, 0
    v_mov_b32 v33, 0
    v_mov_b32 v34, 0
    v_mov_b32 v35, 0
    s_waitcnt vmcnt(2)
    v_max3_u32 v15, v0, v1, v2
    v_max_u32 v15, v15, v3
    v_cmp_lt_u32 vcc, s56, v15
    v_smfmac_f32_16x16x64_bf16 v[32:35], v[0:3], v[80:87], v116
    s_cbranch_vccnz L_mret_36
    ds_write_b128 v117, v[0:3] offset:3072
    v_smfmac_f32_16x16x64_bf16 v[36:39], v[0:3], v[56:63], v116
    buffer_load_dwordx4 v[4:7], v117, s[8:11], s48 offen nt
    v_smfmac_f32_16x16x64_bf16 v[40:43], v[0:3], v[64:71], v116
    buffer_load_dwordx4 v117, s[8:11], s48 offen nt lds
    s_mov_b32 m0, 14336
    v_smfmac_f32_16x16x64_bf16 v[44:47], v[0:3], v[72:79], v116
    s_waitcnt lgkmcnt(0)
    s_barrier
    ds_read_b128 v[8:11], v117 offset:2048
    v_smfmac_f32_16x16x64_bf16 v[48:51], v[0:3], a[192:199], v116
    ds_read_b128 v[16:19], v117 offset:1024
    ds_read_b128 v[20:23], v117
    v_smfmac_f32_16x16x64_bf16 v[52:55], v[0:3], a[200:207], v116
    ds_read_b128 v[80:83], v117 offset:14336
    s_waitcnt lgkmcnt(3)
    v_smfmac_f32_16x16x64_bf16 v[32:35], v[8:11], a[0:7], v116
    ds_read_b128 v[84:87], v117 offset:15360
    v_smfmac_f32_16x16x64_bf16 v[36:39], v[8:11], a[8:15], v116
    ds_read_b128 v[56:59], v117 offset:8192
    s_waitcnt lgkmcnt(4)
    v_smfmac_f32_16x16x64_bf16 v[32:35], v[16:19], a[32:39], v116
    ds_read_b128 v[60:63], v117 offset:9216
    v_smfmac_f32_16x16x64_bf16 v[36:39], v[16:19], a[40:47], v116
    ds_read_b128 v[64:67], v117 offset:10240
    s_waitcnt lgkmcnt(5)
    v_smfmac_f32_16x16x64_bf16 v[32:35], v[20:23], a[64:71], v116
    ds_read_b128 v[68:71], v117 offset:11264
    v_smfmac_f32_16x16x64_bf16 v[36:39], v[20:23], a[72:79], v116
    ds_read_b128 v[72:75], v117 offset:12288
    v_smfmac_f32_16x16x64_bf16 v[40:43], v[8:11], a[96:103], v116
    ds_read_b128 v[76:79], v117 offset:13312
    v_smfmac_f32_16x16x64_bf16 v[40:43], v[16:19], a[128:135], v116
    buffer_store_dwordx4 v[112:115], v117, s[8:11], s32 offen sc1
    v_smfmac_f32_16x16x64_bf16 v[40:43], v[20:23], a[160:167], v116
    s_waitcnt vmcnt(2)
    v_max3_u32 v15, v4, v5, v6
    v_smfmac_f32_16x16x64_bf16 v[44:47], v[8:11], a[104:111], v116
    v_max_u32 v15, v15, v7
    v_smfmac_f32_16x16x64_bf16 v[44:47], v[16:19], a[136:143], v116
    s_waitcnt vmcnt(1) lgkmcnt(0)
    v_cmp_lt_u32 vcc, s56, v15
    v_smfmac_f32_16x16x64_bf16 v[44:47], v[20:23], a[168:175], v116
    s_cbranch_vccnz L_mret_37
L_mgo_38:
    v_smfmac_f32_16x16x64_bf16 v[44:47], v[4:7], v[24:31], v116
    s_barrier
    ds_read_b128 v[12:15], v117 offset:6144
    v_smfmac_f32_16x16x64_bf16 v[32:35], v[4:7], v[88:95], v116
    ds_read_b128 v[24:27], v117 offset:5120
    v_smfmac_f32_16x16x64_bf16 v[36:39], v[4:7], v[96:103], v116
    ds_read_b128 v[28:31], v117 offset:4096
    v_smfmac_f32_16x16x64_bf16 v[40:43], v[4:7], v[104:111], v116
    ds_read_b128 v[88:91], v117 offset:30720
    s_waitcnt lgkmcnt(3)
    v_smfmac_f32_16x16x64_bf16 v[32:35], v[12:15], a[16:23], v116
    ds_read_b128 v[92:95], v117 offset:31744
    s_waitcnt lgkmcnt(3)
    v_smfmac_f32_16x16x64_bf16 v[32:35], v[24:27], a[48:55], v116
    ds_read_b128 v[96:99], v117 offset:23552
    s_waitcnt lgkmcnt(3)
    v_smfmac_f32_16x16x64_bf16 v[32:35], v[28:31], a[80:87], v116
    buffer_load_dwordx4 v117, s[8:11], s30 offen lds
    v_smfmac_f32_16x16x64_bf16 v[36:39], v[12:15], a[24:31], v116
    ds_read_b128 v[100:103], v117 offset:23552
    v_smfmac_f32_16x16x64_bf16 v[36:39], v[24:27], a[56:63], v116
    ds_read_b128 v[104:107], v117 offset:23552
    v_add_f32 v32, v32, v34
    v_smfmac_f32_16x16x64_bf16 v[36:39], v[28:31], a[88:95], v116
    buffer_load_dwordx4 v117, s[8:11], s30 offen offset:1024 lds
    s_add_u32 m0, s52, 0x6000
    v_add_f32 v33, v33, v35
    v_smfmac_f32_16x16x64_bf16 v[40:43], v[12:15], a[112:119], v116
    ds_read_b128 v[108:111], v117 offset:23552
    v_mul_f32 v32, s34, v32
    v_smfmac_f32_16x16x64_bf16 v[40:43], v[24:27], a[144:151], v116
    ds_read_b128 v[0:3], v124
    v_mul_f32 v33, s34, v33
    v_smfmac_f32_16x16x64_bf16 v[40:43], v[28:31], a[176:183], v116
    s_waitcnt lgkmcnt(5)
    buffer_load_dwordx4 v117, s[8:11], s31 offen lds
    v_add_f32 v36, v36, v38
    v_smfmac_f32_16x16x64_bf16 v[48:51], v[4:7], a[208:215], v116
    v_add_f32 v37, v37, v39
    v_smfmac_f32_16x16x64_bf16 v[52:55], v[4:7], a[216:223], v116
    ds_read_b128 v[4:7], v124 offset:1024
    v_mul_f32 v36, s34, v36
    v_smfmac_f32_16x16x64_bf16 v[44:47], v[12:15], a[120:127], v116
    buffer_load_dwordx4 v117, s[8:11], s31 offen offset:1024 lds
    s_mov_b32 m0, 7168
    v_mul_f32 v37, s34, v37
    v_smfmac_f32_16x16x64_bf16 v[44:47], v[24:27], a[152:159], v116
    v_cvt_pk_bf16_f32 v34, v32, v36
    v_smfmac_f32_16x16x64_bf16 v[44:47], v[28:31], a[184:191], v116
    v_cvt_pk_bf16_f32 v35, v33, v37
    v_add_f32 v40, v40, v42
    v_smfmac_f32_16x16x64_bf16 v[48:51], v[8:11], a[224:231], v116
    ds_write2_b32 v120, v34, v35 offset0:32 offset1:48
    v_add_f32 v41, v41, v43
    v_smfmac_f32_16x16x64_bf16 v[52:55], v[8:11], a[232:239], v116
    v_add_f32 v44, v44, v46
    v_add_f32 v45, v45, v47
    v_cvt_pk_bf16_f32 v113, v40, v44
    v_cvt_pk_bf16_f32 v115, v41, v45
    v_smfmac_f32_16x16x64_bf16 v[48:51], v[12:15], a[240:247], v116
    ds_write2_b32 v120, v113, v115 offset0:0 offset1:16
    v_smfmac_f32_16x16x64_bf16 v[52:55], v[12:15], a[248:255], v116
    s_cmp_eq_u32 s22, 63
    s_cbranch_scc1 L_chain_last_f
    v_smfmac_f32_16x16x64_bf16 v[48:51], v[16:19], v[128:135], v116
    v_smfmac_f32_16x16x64_bf16 v[48:51], v[20:23], v[160:167], v116
    buffer_store_dword v126, v119, s[8:11], s55 offen
    v_smfmac_f32_16x16x64_bf16 v[48:51], v[24:27], v[144:151], v116
    s_waitcnt lgkmcnt(0)
    s_barrier
    v_smfmac_f32_16x16x64_bf16 v[48:51], v[28:31], v[176:183], v116
    ds_read_b128 v[32:35], v121 offset:16384
    ds_read_b128 v[36:39], v121 offset:17408
    v_smfmac_f32_16x16x64_bf16 v[52:55], v[16:19], v[136:143], v116
    ds_read_b128 v[40:43], v121 offset:18432
    ds_read_b128 v[44:47], v121 offset:19456
    v_smfmac_f32_16x16x64_bf16 v[52:55], v[20:23], v[168:175], v116
    ds_read_b128 v[8:11], v124 offset:32768
    v_add_f32 v48, v48, v50
    v_smfmac_f32_16x16x64_bf16 v[52:55], v[24:27], v[152:159], v116
    ds_read_b128 v[12:15], v124 offset:33792
    v_add_f32 v49, v49, v51
    v_smfmac_f32_16x16x64_bf16 v[52:55], v[28:31], v[184:191], v116
    s_waitcnt lgkmcnt(5)
    v_cvt_pk_bf16_f32 v112, v48, v49
    v_mfma_f32_16x16x32_bf16 v[56:59], v[56:59], v[32:35], 0
    s_waitcnt lgkmcnt(4)
    v_mov_b32 v48, s50
    v_mov_b32 v49, s50
    v_mfma_f32_16x16x32_bf16 v[56:59], v[60:63], v[36:39], v[56:59]
    ds_read_b128 v[16:19], v124 offset:2048
    s_waitcnt lgkmcnt(4)
    v_mov_b32 v50, s50
    v_mov_b32 v51, s50
    v_mfma_f32_16x16x32_bf16 v[56:59], v[64:67], v[40:43], v[56:59]
    ds_read_b128 v[20:23], v124 offset:3072
    s_waitcnt lgkmcnt(4)
    v_add_f32 v52, v52, v54
    v_mfma_f32_16x16x32_bf16 v[56:59], v[68:71], v[44:47], v[56:59]
    ds_read_b128 v[24:27], v124 offset:4096
    v_add_f32 v53, v53, v55
    v_mfma_f32_16x16x32_bf16 v[60:63], v[72:75], v[32:35], 0
    ds_read_b128 v[28:31], v124 offset:5120
    v_cvt_pk_bf16_f32 v114, v52, v53
    v_mov_b32 v53, 0
    v_mfma_f32_16x16x32_bf16 v[60:63], v[76:79], v[36:39], v[60:63]
    v_exp_f32 v56, v56
    v_mfma_f32_16x16x32_bf16 v[60:63], v[80:83], v[40:43], v[60:63]
    v_exp_f32 v57, v57
    v_mfma_f32_16x16x32_bf16 v[60:63], v[84:87], v[44:47], v[60:63]
    v_exp_f32 v58, v58
    v_mfma_f32_16x16x32_bf16 v[64:67], v[32:35], v[32:35], 0
    v_exp_f32 v59, v59
    v_cvt_pk_bf16_f32 v68, v56, v57
    v_mfma_f32_16x16x32_bf16 v[64:67], v[36:39], v[36:39], v[64:67]
    v_exp_f32 v60, v60
    v_cvt_pk_bf16_f32 v69, v58, v59
    v_mfma_f32_16x16x32_bf16 v[64:67], v[40:43], v[40:43], v[64:67]
    v_exp_f32 v61, v61
    v_mfma_f32_16x16x32_bf16 v[64:67], v[44:47], v[44:47], v[64:67]
    v_exp_f32 v62, v62
    v_exp_f32 v63, v63
    v_cvt_pk_bf16_f32 v70, v60, v61
    v_cvt_pk_bf16_f32 v71, v62, v63
    s_nop 1
    v_mfma_f32_16x16x32_bf16 v[72:75], v[88:91], v[68:71], 0
    s_nop 0
    v_exp_f32 v64, v64
    v_mfma_f32_16x16x32_bf16 v[76:79], v[92:95], v[68:71], 0
    v_exp_f32 v65, v65
    v_mfma_f32_16x16x32_bf16 v[80:83], v[48:51], v[68:71], 0
    v_cvt_pk_bf16_f32 v52, v64, v65
    s_nop 1
    v_mfma_f32_16x16x16_bf16 v[72:75], v[112:113], v[52:53], v[72:75]
    ds_read_b128 v[32:35], v124 offset:6144
    v_mfma_f32_16x16x16_bf16 v[76:79], v[114:115], v[52:53], v[76:79]
    ds_read_b128 v[36:39], v124 offset:7168
    v_mfma_f32_16x16x16_bf16 v[80:83], v[48:49], v[52:53], v[80:83]
L_norm_39:
    s_mov_b64 vcc, s[36:37]
    v_mov_b32 v122, v122
    v_mov_b32 v122, v122
    v_mov_b32 v122, v122
    v_cndmask_b32_dpp v76, v72, v76, vcc quad_perm:[2,3,2,3] row_mask:0xf bank_mask:0xf
    v_cndmask_b32_dpp v77, v73, v77, vcc quad_perm:[2,3,2,3] row_mask:0xf bank_mask:0xf
    v_cndmask_b32_dpp v78, v74, v78, vcc quad_perm:[2,3,2,3] row_mask:0xf bank_mask:0xf
    v_cndmask_b32_dpp v79, v75, v79, vcc quad_perm:[2,3,2,3] row_mask:0xf bank_mask:0xf
    v_rcp_f32_dpp v84, v80 quad_perm:[2,3,2,3] row_mask:0xf bank_mask:0xf
    s_nop 0
    v_pk_mul_f32 v[76:77], v[76:77], v[84:85] op_sel_hi:[1,0]
    v_pk_mul_f32 v[78:79], v[78:79], v[84:85] op_sel_hi:[1,0]
    v_cvt_pk_bf16_f32 v72, v76, v77
    v_cvt_pk_bf16_f32 v73, v78, v79
    ds_write_b64 v122, v[72:73] offset:22016
    v_max_f32_dpp v86, v80, v84 quad_perm:[2,3,2,3] row_mask:0xf bank_mask:0xf
    v_mov_b32_dpp v60, v72 quad_perm:[0,1,0,1] row_mask:0xf bank_mask:0xf
    v_mov_b32_dpp v61, v73 quad_perm:[0,1,0,1] row_mask:0xf bank_mask:0xf
    v_cmp_lt_f32 vcc, s35, v86
    v_mov_b32_dpp v62, v72 quad_perm:[2,3,2,3] row_mask:0xf bank_mask:0xf
    v_mov_b32_dpp v63, v73 quad_perm:[2,3,2,3] row_mask:0xf bank_mask:0xf
    s_nop 1
    v_smfmac_f32_16x16x64_bf16 v[96:99], v[60:63], v[192:199], v116
    s_cbranch_vccnz L_smax_40
    v_smfmac_f32_16x16x64_bf16 v[100:103], v[60:63], v[224:231], v116
    s_waitcnt lgkmcnt(0)
    s_barrier
    ds_read_b128 v[92:95], v127 offset:21504
    ds_read_b128 v[80:83], v127 offset:20992
    ds_read_b128 v[84:87], v127 offset:20480
    v_smfmac_f32_16x16x64_bf16 v[104:107], v[60:63], v[0:7], v116
    ds_read_b128 v[40:43], v124 offset:34816
    v_smfmac_f32_16x16x64_bf16 v[108:111], v[60:63], v[8:15], v116
    ds_read_b128 v[56:59], v124 offset:36864
    s_waitcnt lgkmcnt(4)
    v_smfmac_f32_16x16x64_bf16 v[96:99], v[92:95], v[200:207], v116
    s_waitcnt lgkmcnt(3)
    v_smfmac_f32_16x16x64_bf16 v[96:99], v[80:83], v[208:215], v116
    ds_read_b128 v[44:47], v124 offset:35840
    s_waitcnt lgkmcnt(3)
    v_smfmac_f32_16x16x64_bf16 v[96:99], v[84:87], v[216:223], v116
    ds_read_b128 v[68:71], v124 offset:39936
    v_smfmac_f32_16x16x64_bf16 v[100:103], v[92:95], v[232:239], v116
    ds_read_b128 v[64:67], v124 offset:38912
    v_smfmac_f32_16x16x64_bf16 v[100:103], v[80:83], v[240:247], v116
    ds_read_b128 v[60:63], v124 offset:37888
    v_cvt_pk_bf16_f32 v72, v96, v98
    v_smfmac_f32_16x16x64_bf16 v[100:103], v[84:87], v[248:255], v116
    v_and_or_b32 v72, v72, -2, s33
    v_smfmac_f32_16x16x64_bf16 v[104:107], v[92:95], v[16:23], v116
    v_cvt_pk_bf16_f32 v74, v97, v99
    v_smfmac_f32_16x16x64_bf16 v[104:107], v[80:83], v[24:31], v116
    v_cvt_pk_bf16_f32 v73, v100, v102
    v_cvt_pk_bf16_f32 v75, v101, v103
    v_smfmac_f32_16x16x64_bf16 v[104:107], v[84:87], v[32:39], v116
    buffer_store_dwordx4 v[72:75], v118, s[8:11], s25 offen
    s_waitcnt lgkmcnt(3)
    v_smfmac_f32_16x16x64_bf16 v[108:111], v[92:95], v[40:47], v116
    s_waitcnt lgkmcnt(0)
    v_smfmac_f32_16x16x64_bf16 v[108:111], v[80:83], v[56:63], v116
    v_cvt_pk_bf16_f32 v76, v104, v106
    v_smfmac_f32_16x16x64_bf16 v[108:111], v[84:87], v[64:71], v116
    v_and_or_b32 v76, v76, -2, s33
    v_cvt_pk_bf16_f32 v78, v105, v107
    v_mov_b32 v122, v122
    v_mov_b32 v122, v122
    v_mov_b32 v122, v122
    v_mov_b32 v122, v122
    v_mov_b32 v122, v122
    v_mov_b32 v122, v122
    v_cvt_pk_bf16_f32 v77, v108, v110
    v_cvt_pk_bf16_f32 v79, v109, v111
    buffer_store_dwordx4 v[76:79], v118, s[8:11], s26 offen
    ds_read_b128 v[80:83], v123
    ds_read_b128 v[84:87], v123 offset:1024
    ds_read_b128 v[56:59], v123 offset:2048
    ds_read_b128 v[60:63], v123 offset:3072
    ds_read_b128 v[64:67], v123 offset:32768
    ds_read_b128 v[68:71], v123 offset:33792
    ds_read_b128 v[72:75], v123 offset:34816
    ds_read_b128 v[76:79], v123 offset:35840
    ds_read_b128 v[88:91], v123 offset:4096
    ds_read_b128 v[92:95], v123 offset:5120
    ds_read_b128 v[96:99], v123 offset:6144
    ds_read_b128 v[100:103], v123 offset:7168
    ds_read_b128 v[104:107], v123 offset:36864
    ds_read_b128 v[108:111], v123 offset:37888
    ds_read_b128 v[24:27], v123 offset:38912
    ds_read_b128 v[28:31], v123 offset:39936
    s_add_u32 s30, s30, 0x40000
    s_add_u32 s31, s31, 0x40000
    s_add_u32 s32, s32, 0x20000
    s_add_u32 s23, s24, 3072
    s_add_u32 s48, s23, 4096
    s_xor_b32 s25, s25, 0x40000
    s_xor_b32 s26, s26, 0x40000
    s_mov_b32 s35, 0x49800000
    s_add_u32 s22, s22, 1
    v_cndmask_b32 v12, 0, v125, s[68:69]
    v_cndmask_b32 v13, 0, v125, s[70:71]
    v_cndmask_b32 v14, 0, v125, s[72:73]
    v_cndmask_b32 v15, 0, v125, s[74:75]
    v_mov_b32 v54, 0
    v_mov_b32 v55, 0
    v_mov_b32 v52, 0
    v_mov_b32 v52, 0
    v_mov_b32 v52, 0
    v_mov_b32 v52, 0
    v_mov_b32 v52, 0
    v_mov_b32 v52, 0
    v_mov_b32 v52, 0
    v_mov_b32 v52, 0
    v_mov_b32 v52, 0
    v_mov_b32 v52, 0
    v_mov_b32 v52, 0
    v_mov_b32 v52, 0
    v_mov_b32 v52, 0
    v_mov_b32 v52, 0
    v_mov_b32 v52, 0
    v_mov_b32 v52, 0
    v_mov_b32 v52, 0
    v_mov_b32 v52, 0
    v_mov_b32 v52, 0
    v_mov_b32 v52, 0
    v_mov_b32 v52, 0
    v_mov_b32 v52, 0
    v_mov_b32 v52, 0
    v_mov_b32 v52, 0
    v_mov_b32 v52, 0
    v_mov_b32 v52, 0
    v_mov_b32 v52, 0
    v_mov_b32 v52, 0
    v_mov_b32 v52, 0
    v_mov_b32 v52, 0
    v_mov_b32 v52, 0
    v_mov_b32 v52, 0
    v_mov_b32 v52, 0
    v_mov_b32 v52, 0
    v_mov_b32 v52, 0
    v_mov_b32 v52, 0
    v_mov_b32 v52, 0
    v_mov_b32 v52, 0
    v_mov_b32 v52, 0
    v_mov_b32 v52, 0
    v_mov_b32 v52, 0
    v_mov_b32 v52, 0
    v_mov_b32 v52, 0
    v_mov_b32 v52, 0
    v_mov_b32 v52, 0
    v_mov_b32 v52, 0
    v_mov_b32 v52, 0
    v_mov_b32 v52, 0
    v_mov_b32 v52, 0
    buffer_load_dwordx4 v[4:7], v117, s[8:11], s29 offen nt
    buffer_load_dwordx4 v[8:11], v117, s[8:11], s53 offen nt
    buffer_load_dwordx4 v[16:19], v117, s[8:11], s29 offen offset:2048 nt
    buffer_load_dwordx4 v[20:23], v117, s[8:11], s53 offen offset:2048 nt
    v_mov_b32 v52, 0
    v_mov_b32 v52, 0
    v_mov_b32 v52, 0
    v_mov_b32 v52, 0
    v_mov_b32 v52, 0
    v_mov_b32 v52, 0
    v_mov_b32 v52, 0
    v_mov_b32 v52, 0
    v_mov_b32 v52, 0
    v_mov_b32 v52, 0
    v_mov_b32 v52, 0
    v_mov_b32 v52, 0
    v_mov_b32 v52, 0
    v_mov_b32 v52, 0
    v_mov_b32 v52, 0
    v_mov_b32 v52, 0
    v_mov_b32 v52, 0
    v_mov_b32 v52, 0
    v_mov_b32 v52, 0
    v_mov_b32 v52, 0
    v_mov_b32 v52, 0
    v_mov_b32 v52, 0
    v_mov_b32 v52, 0
    v_mov_b32 v52, 0
    v_mov_b32 v52, 0
    v_mov_b32 v52, 0
    v_mov_b32 v52, 0
    v_mov_b32 v52, 0
    v_mov_b32 v52, 0
    v_mov_b32 v52, 0
    buffer_load_dwordx4 v[32:35], v117, s[8:11], s29 offen sc1
    buffer_load_dwordx4 v[36:39], v117, s[8:11], s53 offen sc1
    buffer_load_dwordx4 v[40:43], v117, s[8:11], s29 offen offset:2048 sc1
    buffer_load_dwordx4 v[44:47], v117, s[8:11], s53 offen offset:2048 sc1
    v_mov_b32 v52, 0
L_rl_41:
    s_waitcnt vmcnt(7)
    v_mfma_f32_16x16x32_bf16 v[48:51], v[4:7], v[12:15], 0
    v_xor_b32 v52, s33, v4
    s_waitcnt vmcnt(6)
    v_mfma_f32_16x16x32_bf16 v[48:51], v[8:11], v[12:15], v[48:51]
    v_xor_b32 v53, s33, v8
    v_or_b32 v52, v52, v53
    s_waitcnt vmcnt(5)
    v_mfma_f32_16x16x32_bf16 v[48:51], v[16:19], v[12:15], v[48:51]
    v_xor_b32 v53, s33, v16
    v_or_b32 v52, v52, v53
    s_waitcnt vmcnt(4)
    v_mfma_f32_16x16x32_bf16 v[48:51], v[20:23], v[12:15], v[48:51]
    v_xor_b32 v53, s33, v20
    v_or_b32 v52, v52, v53
    v_and_b32 v52, 1, v52
    v_cmp_ne_u32 vcc, 0, v52
    s_cbranch_vccnz L_rslow_42
L_rgo_43:
    s_nop 2
    v_permlane32_swap_b32 v48, v50
    v_permlane32_swap_b32 v49, v51
    v_pk_add_f32 v[48:49], v[48:49], v[50:51]
    s_mov_b64 exec, s[38:39]
    v_cvt_pk_bf16_f32 v12, v48, v49
    v_min_u32 v12, 0xfffffffe, v12
    buffer_store_dword v12, v119, s[8:11], s24 offen
    s_mov_b64 exec, -1
    s_add_u32 s24, s24, 8192
    s_bitset0_b32 s24, 15
    s_xor_b32 s55, s24, 16384
    s_xor_b32 s29, s29, 0x40000
    s_xor_b32 s53, s29, 1024
    s_bfe_u32 s33, s22, 0x10001
    s_waitcnt lgkmcnt(0)
    s_branch L_chain_top3_f
L_chain_last_f:
    s_nop 1
    v_smfmac_f32_16x16x64_bf16 v[48:51], v[16:19], v[128:135], v116
    v_smfmac_f32_16x16x64_bf16 v[48:51], v[20:23], v[160:167], v116
    v_smfmac_f32_16x16x64_bf16 v[48:51], v[24:27], v[144:151], v116
    v_smfmac_f32_16x16x64_bf16 v[48:51], v[28:31], v[176:183], v116
    v_smfmac_f32_16x16x64_bf16 v[52:55], v[16:19], v[136:143], v116
    v_smfmac_f32_16x16x64_bf16 v[52:55], v[20:23], v[168:175], v116
    v_smfmac_f32_16x16x64_bf16 v[52:55], v[24:27], v[152:159], v116
    v_smfmac_f32_16x16x64_bf16 v[52:55], v[28:31], v[184:191], v116
    v_add_f32 v48, v48, v50
    v_add_f32 v49, v49, v51
    v_cvt_pk_bf16_f32 v112, v48, v49
    s_nop 4
    v_add_f32 v52, v52, v54
    v_add_f32 v53, v53, v55
    v_cvt_pk_bf16_f32 v114, v52, v53
    s_add_u32 s32, s32, 0x20000
    buffer_store_dwordx4 v[112:115], v117, s[8:11], s32 offen sc1
    v_mov_b32 v94, 64
    s_waitcnt vmcnt(0) lgkmcnt(0)
    s_barrier
    s_mov_b64 exec, 1
    buffer_store_dword v94, off, s[8:11], s44 sc1
    s_mov_b64 exec, -1
    s_endpgm
L_mret_15:
    s_mov_b32 s43, m0
    s_mov_b32 m0, 4096
    buffer_load_dwordx4 v[4:7], v117, s[8:11], s48 offen sc1
    buffer_load_dwordx4 v117, s[8:11], s48 offen sc1 lds
    s_mov_b32 m0, 8192
    s_mov_b32 m0, s43
    s_waitcnt vmcnt(0)
    v_max3_u32 v15, v4, v5, v6
    v_max_u32 v15, v15, v7
    v_cmp_lt_u32 vcc, s56, v15
    s_add_u32 s47, s47, 1
    s_add_u32 s49, s49, 1
    s_cmp_ge_u32 s49, 0x10000
    s_cbranch_scc1 L_mgo_16
    s_cbranch_vccnz L_mret_15
    s_branch L_mgo_16
L_smax_18:
    s_add_u32 s47, s47, 1
    s_mov_b32 s35, 0x7f800000
    s_waitcnt lgkmcnt(0)
    s_sub_u32 s43, s30, 0x40000
    s_add_u32 s40, s43, 4096
    s_nop 7
    buffer_load_dwordx4 v[56:59], v117, s[8:11], s43 offen
    buffer_load_dwordx4 v[60:63], v117, s[8:11], s43 offen offset:1024
    buffer_load_dwordx4 v[64:67], v117, s[8:11], s43 offen offset:2048
    buffer_load_dwordx4 v[68:71], v117, s[8:11], s43 offen offset:3072
    buffer_load_dwordx4 v[72:75], v117, s[8:11], s40 offen
    buffer_load_dwordx4 v[76:79], v117, s[8:11], s40 offen offset:1024
    buffer_load_dwordx4 v[80:83], v117, s[8:11], s40 offen offset:2048
    buffer_load_dwordx4 v[84:87], v117, s[8:11], s40 offen offset:3072
    ds_read_b128 v[32:35], v121 offset:16384
    ds_read_b128 v[36:39], v121 offset:17408
    ds_read_b128 v[40:43], v121 offset:18432
    ds_read_b128 v[44:47], v121 offset:19456
    v_mov_b32 v96, 0
    v_mov_b32 v97, 0
    v_mov_b32 v98, 0
    v_mov_b32 v99, 0
    v_mov_b32 v100, 0
    v_mov_b32 v101, 0
    v_mov_b32 v102, 0
    v_mov_b32 v103, 0
    v_mov_b32 v104, 0
    v_mov_b32 v105, 0
    v_mov_b32 v106, 0
    v_mov_b32 v107, 0
    v_mov_b32 v108, 0
    v_mov_b32 v109, 0
    v_mov_b32 v110, 0
    v_mov_b32 v111, 0
    s_waitcnt vmcnt(0) lgkmcnt(0)
    v_mfma_f32_16x16x32_bf16 v[56:59], v[56:59], v[32:35], 0
    v_mfma_f32_16x16x32_bf16 v[56:59], v[60:63], v[36:39], v[56:59]
    v_mfma_f32_16x16x32_bf16 v[56:59], v[64:67], v[40:43], v[56:59]
    v_mfma_f32_16x16x32_bf16 v[56:59], v[68:71], v[44:47], v[56:59]
    v_mfma_f32_16x16x32_bf16 v[60:63], v[72:75], v[32:35], 0
    v_mfma_f32_16x16x32_bf16 v[60:63], v[76:79], v[36:39], v[60:63]
    v_mfma_f32_16x16x32_bf16 v[60:63], v[80:83], v[40:43], v[60:63]
    v_mfma_f32_16x16x32_bf16 v[60:63], v[84:87], v[44:47], v[60:63]
    v_mfma_f32_16x16x32_bf16 v[64:67], v[32:35], v[32:35], 0
    v_mfma_f32_16x16x32_bf16 v[64:67], v[36:39], v[36:39], v[64:67]
    v_mfma_f32_16x16x32_bf16 v[64:67], v[40:43], v[40:43], v[64:67]
    v_mfma_f32_16x16x32_bf16 v[64:67], v[44:47], v[44:47], v[64:67]
    v_max3_f32 v84, v56, v57, v58
    v_max3_f32 v84, v84, v59, v60
    v_max3_f32 v84, v84, v61, v62
    s_nop 4
    v_max3_f32 v84, v84, v63, v64
    v_max_f32 v84, v84, v65
    v_mov_b32 v85, v84
    s_nop 1
    v_permlane32_swap_b32 v85, v84
    v_max_f32 v84, v85, v84
    v_mov_b32 v85, v84
    s_nop 1
    v_permlane16_swap_b32 v85, v84
    v_max_f32 v84, v85, v84
    v_sub_f32 v56, v56, v84
    v_sub_f32 v57, v57, v84
    v_sub_f32 v58, v58, v84
    v_sub_f32 v59, v59, v84
    v_sub_f32 v60, v60, v84
    v_sub_f32 v61, v61, v84
    v_sub_f32 v62, v62, v84
    v_sub_f32 v63, v63, v84
    v_sub_f32 v64, v64, v84
    v_sub_f32 v65, v65, v84
    v_exp_f32 v56, v56
    v_exp_f32 v57, v57
    v_exp_f32 v58, v58
    v_exp_f32 v59, v59
    v_exp_f32 v60, v60
    v_exp_f32 v61, v61
    v_exp_f32 v62, v62
    v_exp_f32 v63, v63
    v_exp_f32 v64, v64
    v_exp_f32 v65, v65
    v_cvt_pk_bf16_f32 v68, v56, v57
    v_cvt_pk_bf16_f32 v69, v58, v59
    v_cvt_pk_bf16_f32 v70, v60, v61
    v_cvt_pk_bf16_f32 v71, v62, v63
    v_cvt_pk_bf16_f32 v52, v64, v65
    s_nop 0
    v_mfma_f32_16x16x32_bf16 v[72:75], v[88:91], v[68:71], 0
    v_mfma_f32_16x16x32_bf16 v[76:79], v[92:95], v[68:71], 0
    v_mfma_f32_16x16x32_bf16 v[80:83], v[48:51], v[68:71], 0
    v_mfma_f32_16x16x16_bf16 v[72:75], v[112:113], v[52:53], v[72:75]
    v_mfma_f32_16x16x16_bf16 v[76:79], v[114:115], v[52:53], v[76:79]
    v_mfma_f32_16x16x16_bf16 v[80:83], v[48:49], v[52:53], v[80:83]
    ds_read_b128 v[32:35], v124 offset:6144
    ds_read_b128 v[36:39], v124 offset:7168
    ds_read_b128 v[40:43], v124 offset:34816
    ds_read_b128 v[44:47], v124 offset:35840
    ds_read_b128 v[56:59], v124 offset:36864
    ds_read_b128 v[64:67], v124 offset:38912
    ds_read_b128 v[68:71], v124 offset:39936
    s_waitcnt lgkmcnt(0)
    s_branch L_norm_17
L_kvw_19:
    s_add_u32 s47, s47, 1
    s_add_u32 s49, s49, 1
    s_cmp_ge_u32 s49, 0x10000
    s_cbranch_scc1 L_kvb_20
    s_sleep 4
    buffer_load_dword v125, v119, s[8:11], s28 offen sc1
    s_waitcnt vmcnt(0)
    v_cmp_eq_u32 vcc, 0, v125
    s_nop 0
    s_and_b64 vcc, vcc, s[58:59]
    s_cbranch_scc1 L_kvw_19
    s_branch L_kvb_20
L_mret_22:
    s_mov_b32 s43, m0
    s_mov_b32 m0, 5120
    buffer_load_dwordx4 v[4:7], v117, s[8:11], s48 offen sc1
    buffer_load_dwordx4 v117, s[8:11], s48 offen sc1 lds
    s_mov_b32 m0, 10240
    s_mov_b32 m0, s43
    s_waitcnt vmcnt(0)
    v_max3_u32 v15, v4, v5, v6
    v_max_u32 v15, v15, v7
    v_cmp_lt_u32 vcc, s56, v15
    s_add_u32 s47, s47, 1
    s_add_u32 s49, s49, 1
    s_cmp_ge_u32 s49, 0x10000
    s_cbranch_scc1 L_mgo_23
    s_cbranch_vccnz L_mret_22
    s_branch L_mgo_23
L_smax_25:
    s_add_u32 s47, s47, 1
    s_mov_b32 s35, 0x7f800000
    s_waitcnt lgkmcnt(0)
    s_sub_u32 s43, s30, 0x40800
    s_add_u32 s40, s43, 4096
    s_nop 7
    buffer_load_dwordx4 v[56:59], v117, s[8:11], s43 offen
    buffer_load_dwordx4 v[60:63], v117, s[8:11], s43 offen offset:1024
    buffer_load_dwordx4 v[64:67], v117, s[8:11], s43 offen offset:2048
    buffer_load_dwordx4 v[68:71], v117, s[8:11], s43 offen offset:3072
    buffer_load_dwordx4 v[72:75], v117, s[8:11], s40 offen
    buffer_load_dwordx4 v[76:79], v117, s[8:11], s40 offen offset:1024
    buffer_load_dwordx4 v[80:83], v117, s[8:11], s40 offen offset:2048
    buffer_load_dwordx4 v[84:87], v117, s[8:11], s40 offen offset:3072
    ds_read_b128 v[32:35], v121 offset:16384
    ds_read_b128 v[36:39], v121 offset:17408
    ds_read_b128 v[40:43], v121 offset:18432
    ds_read_b128 v[44:47], v121 offset:19456
    v_mov_b32 v96, 0
    v_mov_b32 v97, 0
    v_mov_b32 v98, 0
    v_mov_b32 v99, 0
    v_mov_b32 v100, 0
    v_mov_b32 v101, 0
    v_mov_b32 v102, 0
    v_mov_b32 v103, 0
    v_mov_b32 v104, 0
    v_mov_b32 v105, 0
    v_mov_b32 v106, 0
    v_mov_b32 v107, 0
    v_mov_b32 v108, 0
    v_mov_b32 v109, 0
    v_mov_b32 v110, 0
    v_mov_b32 v111, 0
    s_waitcnt vmcnt(0) lgkmcnt(0)
    v_mfma_f32_16x16x32_bf16 v[56:59], v[56:59], v[32:35], 0
    v_mfma_f32_16x16x32_bf16 v[56:59], v[60:63], v[36:39], v[56:59]
    v_mfma_f32_16x16x32_bf16 v[56:59], v[64:67], v[40:43], v[56:59]
    v_mfma_f32_16x16x32_bf16 v[56:59], v[68:71], v[44:47], v[56:59]
    v_mfma_f32_16x16x32_bf16 v[60:63], v[72:75], v[32:35], 0
    v_mfma_f32_16x16x32_bf16 v[60:63], v[76:79], v[36:39], v[60:63]
    v_mfma_f32_16x16x32_bf16 v[60:63], v[80:83], v[40:43], v[60:63]
    v_mfma_f32_16x16x32_bf16 v[60:63], v[84:87], v[44:47], v[60:63]
    v_mfma_f32_16x16x32_bf16 v[64:67], v[32:35], v[32:35], 0
    v_mfma_f32_16x16x32_bf16 v[64:67], v[36:39], v[36:39], v[64:67]
    v_mfma_f32_16x16x32_bf16 v[64:67], v[40:43], v[40:43], v[64:67]
    v_mfma_f32_16x16x32_bf16 v[64:67], v[44:47], v[44:47], v[64:67]
    v_max3_f32 v84, v56, v57, v58
    v_max3_f32 v84, v84, v59, v60
    v_max3_f32 v84, v84, v61, v62
    s_nop 4
    v_max3_f32 v84, v84, v63, v64
    v_max_f32 v84, v84, v65
    v_mov_b32 v85, v84
    s_nop 1
    v_permlane32_swap_b32 v85, v84
    v_max_f32 v84, v85, v84
    v_mov_b32 v85, v84
    s_nop 1
    v_permlane16_swap_b32 v85, v84
    v_max_f32 v84, v85, v84
    v_sub_f32 v56, v56, v84
    v_sub_f32 v57, v57, v84
    v_sub_f32 v58, v58, v84
    v_sub_f32 v59, v59, v84
    v_sub_f32 v60, v60, v84
    v_sub_f32 v61, v61, v84
    v_sub_f32 v62, v62, v84
    v_sub_f32 v63, v63, v84
    v_sub_f32 v64, v64, v84
    v_sub_f32 v65, v65, v84
    v_exp_f32 v56, v56
    v_exp_f32 v57, v57
    v_exp_f32 v58, v58
    v_exp_f32 v59, v59
    v_exp_f32 v60, v60
    v_exp_f32 v61, v61
    v_exp_f32 v62, v62
    v_exp_f32 v63, v63
    v_exp_f32 v64, v64
    v_exp_f32 v65, v65
    v_cvt_pk_bf16_f32 v68, v56, v57
    v_cvt_pk_bf16_f32 v69, v58, v59
    v_cvt_pk_bf16_f32 v70, v60, v61
    v_cvt_pk_bf16_f32 v71, v62, v63
    v_cvt_pk_bf16_f32 v52, v64, v65
    s_nop 0
    v_mfma_f32_16x16x32_bf16 v[72:75], v[88:91], v[68:71], 0
    v_mfma_f32_16x16x32_bf16 v[76:79], v[92:95], v[68:71], 0
    v_mfma_f32_16x16x32_bf16 v[80:83], v[48:51], v[68:71], 0
    v_mfma_f32_16x16x16_bf16 v[72:75], v[112:113], v[52:53], v[72:75]
    v_mfma_f32_16x16x16_bf16 v[76:79], v[114:115], v[52:53], v[76:79]
    v_mfma_f32_16x16x16_bf16 v[80:83], v[48:49], v[52:53], v[80:83]
    ds_read_b128 v[32:35], v124 offset:6144
    ds_read_b128 v[36:39], v124 offset:7168
    ds_read_b128 v[40:43], v124 offset:34816
    ds_read_b128 v[44:47], v124 offset:35840
    ds_read_b128 v[56:59], v124 offset:36864
    ds_read_b128 v[64:67], v124 offset:38912
    ds_read_b128 v[68:71], v124 offset:39936
    s_waitcnt lgkmcnt(0)
    s_branch L_norm_24
L_kvw_26:
    s_add_u32 s47, s47, 1
    s_add_u32 s49, s49, 1
    s_cmp_ge_u32 s49, 0x10000
    s_cbranch_scc1 L_kvb_27
    s_sleep 4
    buffer_load_dword v125, v119, s[8:11], s28 offen sc1
    s_waitcnt vmcnt(0)
    v_cmp_eq_u32 vcc, 0, v125
    s_nop 0
    s_and_b64 vcc, vcc, s[58:59]
    s_cbranch_scc1 L_kvw_26
    s_branch L_kvb_27
L_mret_29:
    s_mov_b32 s43, m0
    s_mov_b32 m0, 6144
    buffer_load_dwordx4 v[4:7], v117, s[8:11], s48 offen sc1
    buffer_load_dwordx4 v117, s[8:11], s48 offen sc1 lds
    s_mov_b32 m0, 12288
    s_mov_b32 m0, s43
    s_waitcnt vmcnt(0)
    v_max3_u32 v15, v4, v5, v6
    v_max_u32 v15, v15, v7
    v_cmp_lt_u32 vcc, s56, v15
    s_add_u32 s47, s47, 1
    s_add_u32 s49, s49, 1
    s_cmp_ge_u32 s49, 0x10000
    s_cbranch_scc1 L_mgo_30
    s_cbranch_vccnz L_mret_29
    s_branch L_mgo_30
L_smax_32:
    s_add_u32 s47, s47, 1
    s_mov_b32 s35, 0x7f800000
    s_waitcnt lgkmcnt(0)
    s_sub_u32 s43, s30, 0x41000
    s_add_u32 s40, s43, 4096
    s_nop 7
    buffer_load_dwordx4 v[56:59], v117, s[8:11], s43 offen
    buffer_load_dwordx4 v[60:63], v117, s[8:11], s43 offen offset:1024
    buffer_load_dwordx4 v[64:67], v117, s[8:11], s43 offen offset:2048
    buffer_load_dwordx4 v[68:71], v117, s[8:11], s43 offen offset:3072
    buffer_load_dwordx4 v[72:75], v117, s[8:11], s40 offen
    buffer_load_dwordx4 v[76:79], v117, s[8:11], s40 offen offset:1024
    buffer_load_dwordx4 v[80:83], v117, s[8:11], s40 offen offset:2048
    buffer_load_dwordx4 v[84:87], v117, s[8:11], s40 offen offset:3072
    ds_read_b128 v[32:35], v121 offset:16384
    ds_read_b128 v[36:39], v121 offset:17408
    ds_read_b128 v[40:43], v121 offset:18432
    ds_read_b128 v[44:47], v121 offset:19456
    v_mov_b32 v96, 0
    v_mov_b32 v97, 0
    v_mov_b32 v98, 0
    v_mov_b32 v99, 0
    v_mov_b32 v100, 0
    v_mov_b32 v101, 0
    v_mov_b32 v102, 0
    v_mov_b32 v103, 0
    v_mov_b32 v104, 0
    v_mov_b32 v105, 0
    v_mov_b32 v106, 0
    v_mov_b32 v107, 0
    v_mov_b32 v108, 0
    v_mov_b32 v109, 0
    v_mov_b32 v110, 0
    v_mov_b32 v111, 0
    s_waitcnt vmcnt(0) lgkmcnt(0)
    v_mfma_f32_16x16x32_bf16 v[56:59], v[56:59], v[32:35], 0
    v_mfma_f32_16x16x32_bf16 v[56:59], v[60:63], v[36:39], v[56:59]
    v_mfma_f32_16x16x32_bf16 v[56:59], v[64:67], v[40:43], v[56:59]
    v_mfma_f32_16x16x32_bf16 v[56:59], v[68:71], v[44:47], v[56:59]
    v_mfma_f32_16x16x32_bf16 v[60:63], v[72:75], v[32:35], 0
    v_mfma_f32_16x16x32_bf16 v[60:63], v[76:79], v[36:39], v[60:63]
    v_mfma_f32_16x16x32_bf16 v[60:63], v[80:83], v[40:43], v[60:63]
    v_mfma_f32_16x16x32_bf16 v[60:63], v[84:87], v[44:47], v[60:63]
    v_mfma_f32_16x16x32_bf16 v[64:67], v[32:35], v[32:35], 0
    v_mfma_f32_16x16x32_bf16 v[64:67], v[36:39], v[36:39], v[64:67]
    v_mfma_f32_16x16x32_bf16 v[64:67], v[40:43], v[40:43], v[64:67]
    v_mfma_f32_16x16x32_bf16 v[64:67], v[44:47], v[44:47], v[64:67]
    v_max3_f32 v84, v56, v57, v58
    v_max3_f32 v84, v84, v59, v60
    v_max3_f32 v84, v84, v61, v62
    s_nop 4
    v_max3_f32 v84, v84, v63, v64
    v_max_f32 v84, v84, v65
    v_mov_b32 v85, v84
    s_nop 1
    v_permlane32_swap_b32 v85, v84
    v_max_f32 v84, v85, v84
    v_mov_b32 v85, v84
    s_nop 1
    v_permlane16_swap_b32 v85, v84
    v_max_f32 v84, v85, v84
    v_sub_f32 v56, v56, v84
    v_sub_f32 v57, v57, v84
    v_sub_f32 v58, v58, v84
    v_sub_f32 v59, v59, v84
    v_sub_f32 v60, v60, v84
    v_sub_f32 v61, v61, v84
    v_sub_f32 v62, v62, v84
    v_sub_f32 v63, v63, v84
    v_sub_f32 v64, v64, v84
    v_sub_f32 v65, v65, v84
    v_exp_f32 v56, v56
    v_exp_f32 v57, v57
    v_exp_f32 v58, v58
    v_exp_f32 v59, v59
    v_exp_f32 v60, v60
    v_exp_f32 v61, v61
    v_exp_f32 v62, v62
    v_exp_f32 v63, v63
    v_exp_f32 v64, v64
    v_exp_f32 v65, v65
    v_cvt_pk_bf16_f32 v68, v56, v57
    v_cvt_pk_bf16_f32 v69, v58, v59
    v_cvt_pk_bf16_f32 v70, v60, v61
    v_cvt_pk_bf16_f32 v71, v62, v63
    v_cvt_pk_bf16_f32 v52, v64, v65
    s_nop 0
    v_mfma_f32_16x16x32_bf16 v[72:75], v[88:91], v[68:71], 0
    v_mfma_f32_16x16x32_bf16 v[76:79], v[92:95], v[68:71], 0
    v_mfma_f32_16x16x32_bf16 v[80:83], v[48:51], v[68:71], 0
    v_mfma_f32_16x16x16_bf16 v[72:75], v[112:113], v[52:53], v[72:75]
    v_mfma_f32_16x16x16_bf16 v[76:79], v[114:115], v[52:53], v[76:79]
    v_mfma_f32_16x16x16_bf16 v[80:83], v[48:49], v[52:53], v[80:83]
    ds_read_b128 v[32:35], v124 offset:6144
    ds_read_b128 v[36:39], v124 offset:7168
    ds_read_b128 v[40:43], v124 offset:34816
    ds_read_b128 v[44:47], v124 offset:35840
    ds_read_b128 v[56:59], v124 offset:36864
    ds_read_b128 v[64:67], v124 offset:38912
    ds_read_b128 v[68:71], v124 offset:39936
    s_waitcnt lgkmcnt(0)
    s_branch L_norm_31
L_rslow_34:
    buffer_load_dwordx4 v[4:7], v117, s[8:11], s29 offen sc1
    buffer_load_dwordx4 v[8:11], v117, s[8:11], s53 offen sc1
    buffer_load_dwordx4 v[16:19], v117, s[8:11], s29 offen offset:2048 sc1
    buffer_load_dwordx4 v[20:23], v117, s[8:11], s53 offen offset:2048 sc1
    s_add_u32 s46, s46, 1
    s_add_u32 s49, s49, 1
    s_cmp_ge_u32 s49, 0x10000
    s_cbranch_scc1 L_rgo_35
    s_waitcnt vmcnt(7)
    v_mfma_f32_16x16x32_bf16 v[48:51], v[32:35], v[12:15], 0
    v_xor_b32 v52, s33, v32
    s_waitcnt vmcnt(6)
    v_mfma_f32_16x16x32_bf16 v[48:51], v[36:39], v[12:15], v[48:51]
    v_xor_b32 v53, s33, v36
    v_or_b32 v52, v52, v53
    s_waitcnt vmcnt(5)
    v_mfma_f32_16x16x32_bf16 v[48:51], v[40:43], v[12:15], v[48:51]
    v_xor_b32 v53, s33, v40
    v_or_b32 v52, v52, v53
    s_waitcnt vmcnt(4)
    v_mfma_f32_16x16x32_bf16 v[48:51], v[44:47], v[12:15], v[48:51]
    v_xor_b32 v53, s33, v44
    v_or_b32 v52, v52, v53
    v_and_b32 v52, 1, v52
    v_cmp_ne_u32 vcc, 0, v52
    s_cbranch_vccz L_rgo_35
    buffer_load_dwordx4 v[32:35], v117, s[8:11], s29 offen sc1
    buffer_load_dwordx4 v[36:39], v117, s[8:11], s53 offen sc1
    buffer_load_dwordx4 v[40:43], v117, s[8:11], s29 offen offset:2048 sc1
    buffer_load_dwordx4 v[44:47], v117, s[8:11], s53 offen offset:2048 sc1
    s_add_u32 s46, s46, 1
    s_branch L_rl_33
L_mret_37:
    s_mov_b32 s43, m0
    s_mov_b32 m0, 7168
    buffer_load_dwordx4 v[4:7], v117, s[8:11], s48 offen sc1
    buffer_load_dwordx4 v117, s[8:11], s48 offen sc1 lds
    s_mov_b32 m0, 14336
    s_mov_b32 m0, s43
    s_waitcnt vmcnt(0)
    v_max3_u32 v15, v4, v5, v6
    v_max_u32 v15, v15, v7
    v_cmp_lt_u32 vcc, s56, v15
    s_add_u32 s47, s47, 1
    s_add_u32 s49, s49, 1
    s_cmp_ge_u32 s49, 0x10000
    s_cbranch_scc1 L_mgo_38
    s_cbranch_vccnz L_mret_37
    s_branch L_mgo_38
L_smax_40:
    s_add_u32 s47, s47, 1
    s_mov_b32 s35, 0x7f800000
    s_waitcnt lgkmcnt(0)
    s_sub_u32 s43, s30, 0x41800
    s_add_u32 s40, s43, 4096
    s_nop 7
    buffer_load_dwordx4 v[56:59], v117, s[8:11], s43 offen
    buffer_load_dwordx4 v[60:63], v117, s[8:11], s43 offen offset:1024
    buffer_load_dwordx4 v[64:67], v117, s[8:11], s43 offen offset:2048
    buffer_load_dwordx4 v[68:71], v117, s[8:11], s43 offen offset:3072
    buffer_load_dwordx4 v[72:75], v117, s[8:11], s40 offen
    buffer_load_dwordx4 v[76:79], v117, s[8:11], s40 offen offset:1024
    buffer_load_dwordx4 v[80:83], v117, s[8:11], s40 offen offset:2048
    buffer_load_dwordx4 v[84:87], v117, s[8:11], s40 offen offset:3072
    ds_read_b128 v[32:35], v121 offset:16384
    ds_read_b128 v[36:39], v121 offset:17408
    ds_read_b128 v[40:43], v121 offset:18432
    ds_read_b128 v[44:47], v121 offset:19456
    v_mov_b32 v96, 0
    v_mov_b32 v97, 0
    v_mov_b32 v98, 0
    v_mov_b32 v99, 0
    v_mov_b32 v100, 0
    v_mov_b32 v101, 0
    v_mov_b32 v102, 0
    v_mov_b32 v103, 0
    v_mov_b32 v104, 0
    v_mov_b32 v105, 0
    v_mov_b32 v106, 0
    v_mov_b32 v107, 0
    v_mov_b32 v108, 0
    v_mov_b32 v109, 0
    v_mov_b32 v110, 0
    v_mov_b32 v111, 0
    s_waitcnt vmcnt(0) lgkmcnt(0)
    v_mfma_f32_16x16x32_bf16 v[56:59], v[56:59], v[32:35], 0
    v_mfma_f32_16x16x32_bf16 v[56:59], v[60:63], v[36:39], v[56:59]
    v_mfma_f32_16x16x32_bf16 v[56:59], v[64:67], v[40:43], v[56:59]
    v_mfma_f32_16x16x32_bf16 v[56:59], v[68:71], v[44:47], v[56:59]
    v_mfma_f32_16x16x32_bf16 v[60:63], v[72:75], v[32:35], 0
    v_mfma_f32_16x16x32_bf16 v[60:63], v[76:79], v[36:39], v[60:63]
    v_mfma_f32_16x16x32_bf16 v[60:63], v[80:83], v[40:43], v[60:63]
    v_mfma_f32_16x16x32_bf16 v[60:63], v[84:87], v[44:47], v[60:63]
    v_mfma_f32_16x16x32_bf16 v[64:67], v[32:35], v[32:35], 0
    v_mfma_f32_16x16x32_bf16 v[64:67], v[36:39], v[36:39], v[64:67]
    v_mfma_f32_16x16x32_bf16 v[64:67], v[40:43], v[40:43], v[64:67]
    v_mfma_f32_16x16x32_bf16 v[64:67], v[44:47], v[44:47], v[64:67]
    v_max3_f32 v84, v56, v57, v58
    v_max3_f32 v84, v84, v59, v60
    v_max3_f32 v84, v84, v61, v62
    s_nop 4
    v_max3_f32 v84, v84, v63, v64
    v_max_f32 v84, v84, v65
    v_mov_b32 v85, v84
    s_nop 1
    v_permlane32_swap_b32 v85, v84
    v_max_f32 v84, v85, v84
    v_mov_b32 v85, v84
    s_nop 1
    v_permlane16_swap_b32 v85, v84
    v_max_f32 v84, v85, v84
    v_sub_f32 v56, v56, v84
    v_sub_f32 v57, v57, v84
    v_sub_f32 v58, v58, v84
    v_sub_f32 v59, v59, v84
    v_sub_f32 v60, v60, v84
    v_sub_f32 v61, v61, v84
    v_sub_f32 v62, v62, v84
    v_sub_f32 v63, v63, v84
    v_sub_f32 v64, v64, v84
    v_sub_f32 v65, v65, v84
    v_exp_f32 v56, v56
    v_exp_f32 v57, v57
    v_exp_f32 v58, v58
    v_exp_f32 v59, v59
    v_exp_f32 v60, v60
    v_exp_f32 v61, v61
    v_exp_f32 v62, v62
    v_exp_f32 v63, v63
    v_exp_f32 v64, v64
    v_exp_f32 v65, v65
    v_cvt_pk_bf16_f32 v68, v56, v57
    v_cvt_pk_bf16_f32 v69, v58, v59
    v_cvt_pk_bf16_f32 v70, v60, v61
    v_cvt_pk_bf16_f32 v71, v62, v63
    v_cvt_pk_bf16_f32 v52, v64, v65
    s_nop 0
    v_mfma_f32_16x16x32_bf16 v[72:75], v[88:91], v[68:71], 0
    v_mfma_f32_16x16x32_bf16 v[76:79], v[92:95], v[68:71], 0
    v_mfma_f32_16x16x32_bf16 v[80:83], v[48:51], v[68:71], 0
    v_mfma_f32_16x16x16_bf16 v[72:75], v[112:113], v[52:53], v[72:75]
    v_mfma_f32_16x16x16_bf16 v[76:79], v[114:115], v[52:53], v[76:79]
    v_mfma_f32_16x16x16_bf16 v[80:83], v[48:49], v[52:53], v[80:83]
    ds_read_b128 v[32:35], v124 offset:6144
    ds_read_b128 v[36:39], v124 offset:7168
    ds_read_b128 v[40:43], v124 offset:34816
    ds_read_b128 v[44:47], v124 offset:35840
    ds_read_b128 v[56:59], v124 offset:36864
    ds_read_b128 v[64:67], v124 offset:38912
    ds_read_b128 v[68:71], v124 offset:39936
    s_waitcnt lgkmcnt(0)
    s_branch L_norm_39
L_rslow_42:
    buffer_load_dwordx4 v[4:7], v117, s[8:11], s29 offen sc1
    buffer_load_dwordx4 v[8:11], v117, s[8:11], s53 offen sc1
    buffer_load_dwordx4 v[16:19], v117, s[8:11], s29 offen offset:2048 sc1
    buffer_load_dwordx4 v[20:23], v117, s[8:11], s53 offen offset:2048 sc1
    s_add_u32 s46, s46, 1
    s_add_u32 s49, s49, 1
    s_cmp_ge_u32 s49, 0x10000
    s_cbranch_scc1 L_rgo_43
    s_waitcnt vmcnt(7)
    v_mfma_f32_16x16x32_bf16 v[48:51], v[32:35], v[12:15], 0
    v_xor_b32 v52, s33, v32
    s_waitcnt vmcnt(6)
    v_mfma_f32_16x16x32_bf16 v[48:51], v[36:39], v[12:15], v[48:51]
    v_xor_b32 v53, s33, v36
    v_or_b32 v52, v52, v53
    s_waitcnt vmcnt(5)
    v_mfma_f32_16x16x32_bf16 v[48:51], v[40:43], v[12:15], v[48:51]
    v_xor_b32 v53, s33, v40
    v_or_b32 v52, v52, v53
    s_waitcnt vmcnt(4)
    v_mfma_f32_16x16x32_bf16 v[48:51], v[44:47], v[12:15], v[48:51]
    v_xor_b32 v53, s33, v44
    v_or_b32 v52, v52, v53
    v_and_b32 v52, 1, v52
    v_cmp_ne_u32 vcc, 0, v52
    s_cbranch_vccz L_rgo_43
    buffer_load_dwordx4 v[32:35], v117, s[8:11], s29 offen sc1
    buffer_load_dwordx4 v[36:39], v117, s[8:11], s53 offen sc1
    buffer_load_dwordx4 v[40:43], v117, s[8:11], s29 offen offset:2048 sc1
    buffer_load_dwordx4 v[44:47], v117, s[8:11], s53 offen offset:2048 sc1
    s_add_u32 s46, s46, 1
    s_branch L_rl_41
L_other:
    s_sub_u32 s101, s84, 1
    s_lshl_b32 s101, s101, 5
    s_add_u32 s101, s101, s85
    s_branch L_bulk
L_odd:
    s_mov_b32 s96, 0
L_mode_44:
    buffer_load_dwordx2 v[2:3], off, s[92:95], 0 offset:36 sc1
    s_waitcnt vmcnt(0)
    v_readfirstlane_b32 s87, v2
    v_readfirstlane_b32 s97, v3
    s_nop 0
    s_min_u32 s97, s97, s87
    s_cmp_lg_u32 s97, 0
    s_cbranch_scc1 L_moded_45
    s_sleep 4
    s_add_u32 s96, s96, 1
    s_cmp_lg_u32 s96, 0x100
    s_cbranch_scc1 L_modef_46
    v_mov_b32 v2, 2
    v_mov_b32 v3, 0
    s_mov_b64 exec, 1
    buffer_atomic_cmpswap v[2:3], off, s[92:95], 0 offset:36
    s_mov_b64 exec, -1
L_modef_46:
    s_cmp_lt_u32 s96, 0x10000
    s_cbranch_scc1 L_mode_44
L_moded_45:
    s_cmp_eq_u32 s87, 1
    s_cbranch_scc1 L_exit
L_fallback:
    s_waitcnt vmcnt(0) lgkmcnt(0)
    s_barrier
    v_mbcnt_lo_u32_b32 v0, -1, 0
    v_mbcnt_hi_u32_b32 v0, -1, v0
    s_lshl_b32 s96, s100, 6
    v_add_u32 v0, s96, v0
    s_mov_b32 s97, 44
    s_cmp_lg_u32 s100, 0
    s_cbranch_scc1 L_at_47
    s_mov_b64 exec, 1
    v_mov_b32 v2, 1
    buffer_atomic_add v2, off, s[92:95], s97 sc0
    s_mov_b64 exec, -1
L_at_47:
    s_cmp_lg_u32 s100, 0
    s_cbranch_scc1 L_at2_48
    s_mov_b64 exec, 1
    v_mov_b32 v1, 8
    s_waitcnt vmcnt(0)
    ds_write_b32 v1, v2
    s_waitcnt lgkmcnt(0)
    s_mov_b64 exec, -1
L_at2_48:
    s_barrier
    v_mov_b32 v1, 8
    ds_read_b32 v2, v1
    s_waitcnt lgkmcnt(0)
    v_readfirstlane_b32 s85, v2
    s_barrier
    s_sub_u32 s101, s85, 32
    s_cmp_ge_u32 s85, 32
    s_cbranch_scc1 L_bulk
    s_mov_b32 s20, s85
    s_mov_b32 s16, s92
    s_mov_b32 s17, s93
    s_mov_b32 s18, s94
    s_mov_b32 s19, s95
    s_mov_b32 s88, s20
    v_lshrrev_b32 v4, 6, v0
    s_nop 0
    v_readfirstlane_b32 s21, v4
    v_and_b32 v1, 63, v0
    v_lshrrev_b32 v2, 4, v1
    v_and_b32 v3, 15, v1
    v_lshrrev_b32 v6, 2, v3
    v_lshlrev_b32 v117, 4, v1
    s_lshl_b32 s51, s21, 10
    s_lshl_b32 s52, s21, 11
    s_load_dwordx8 s[60:67], s[0:1], 16
    s_mov_b32 s14, 0x400000
    s_mov_b32 s15, 0x20000
    s_lshl_b32 s41, s20, 8
    s_lshl_b32 s42, s20, 17
    s_lshr_b32 s43, s21, 1
    s_lshl_b32 s43, s43, 2
    v_or_b32 v5, s43, v2
    v_lshlrev_b32 v5, 1, v5
    v_xor_b32 v5, v5, v3
    v_lshrrev_b32 v14, 2, v5
    v_and_b32 v14, 2, v14
    v_lshlrev_b32 v5, 4, v5
    s_lshl_b32 s43, s21, 4
    v_add_u32 v4, s43, v2
    v_lshl_add_u32 v8, v4, 13, v5
    s_waitcnt lgkmcnt(0)
    s_mov_b32 s12, s60
    s_and_b32 s13, s61, 0xffff
    v_xor_b32 v15, 2, v14
    v_lshl_add_u32 v15, v15, 15, v8
    s_add_u32 s43, s41, 0x0
    s_add_u32 m0, s51, 0x8000
    s_nop 0
    buffer_load_dwordx4 v15, s[12:15], s43 offen lds
    s_add_u32 s43, s41, 0x8000
    s_add_u32 m0, s51, 0x9000
    s_nop 0
    buffer_load_dwordx4 v15, s[12:15], s43 offen lds
    s_add_u32 s43, s41, 0x100000
    s_add_u32 m0, s51, 0xa000
    s_nop 0
    buffer_load_dwordx4 v15, s[12:15], s43 offen lds
    s_add_u32 s43, s41, 0x108000
    s_add_u32 m0, s51, 0xb000
    s_nop 0
    buffer_load_dwordx4 v15, s[12:15], s43 offen lds
    s_add_u32 s43, s41, 0x200000
    s_add_u32 m0, s51, 0xc000
    s_nop 0
    buffer_load_dwordx4 v15, s[12:15], s43 offen lds
    s_add_u32 s43, s41, 0x208000
    s_add_u32 m0, s51, 0xd000
    s_nop 0
    buffer_load_dwordx4 v15, s[12:15], s43 offen lds
    s_add_u32 s43, s41, 0x300000
    s_add_u32 m0, s51, 0xe000
    s_nop 0
    buffer_load_dwordx4 v15, s[12:15], s43 offen lds
    s_add_u32 s43, s41, 0x308000
    s_add_u32 m0, s51, 0xf000
    s_nop 0
    buffer_load_dwordx4 v15, s[12:15], s43 offen lds
    v_xor_b32 v15, 2, v14
    v_lshl_add_u32 v15, v15, 15, v8
    s_add_u32 s43, s41, 0x80000
    s_add_u32 m0, s51, 0x10000
    s_nop 0
    buffer_load_dwordx4 v15, s[12:15], s43 offen lds
    s_add_u32 s43, s41, 0x88000
    s_add_u32 m0, s51, 0x11000
    s_nop 0
    buffer_load_dwordx4 v15, s[12:15], s43 offen lds
    s_add_u32 s43, s41, 0x180000
    s_add_u32 m0, s51, 0x12000
    s_nop 0
    buffer_load_dwordx4 v15, s[12:15], s43 offen lds
    s_add_u32 s43, s41, 0x188000
    s_add_u32 m0, s51, 0x13000
    s_nop 0
    buffer_load_dwordx4 v15, s[12:15], s43 offen lds
    s_add_u32 s43, s41, 0x280000
    s_add_u32 m0, s51, 0x14000
    s_nop 0
    buffer_load_dwordx4 v15, s[12:15], s43 offen lds
    s_add_u32 s43, s41, 0x288000
    s_add_u32 m0, s51, 0x15000
    s_nop 0
    buffer_load_dwordx4 v15, s[12:15], s43 offen lds
    s_add_u32 s43, s41, 0x380000
    s_add_u32 m0, s51, 0x16000
    s_nop 0
    buffer_load_dwordx4 v15, s[12:15], s43 offen lds
    s_add_u32 s43, s41, 0x388000
    s_add_u32 m0, s51, 0x17000
    s_nop 0
    buffer_load_dwordx4 v15, s[12:15], s43 offen lds
    s_mov_b32 s12, s62
    s_and_b32 s13, s63, 0xffff
    v_xor_b32 v15, 2, v14
    v_lshl_add_u32 v15, v15, 15, v8
    s_add_u32 s43, s41, 0x0
    s_add_u32 m0, s51, 0x18000
    s_nop 0
    buffer_load_dwordx4 v15, s[12:15], s43 offen lds
    s_add_u32 s43, s41, 0x8000
    s_add_u32 m0, s51, 0x19000
    s_nop 0
    buffer_load_dwordx4 v15, s[12:15], s43 offen lds
    s_add_u32 s43, s41, 0x100000
    s_add_u32 m0, s51, 0x1a000
    s_nop 0
    buffer_load_dwordx4 v15, s[12:15], s43 offen lds
    s_add_u32 s43, s41, 0x108000
    s_add_u32 m0, s51, 0x1b000
    s_nop 0
    buffer_load_dwordx4 v15, s[12:15], s43 offen lds
    s_add_u32 s43, s41, 0x200000
    s_add_u32 m0, s51, 0x1c000
    s_nop 0
    buffer_load_dwordx4 v15, s[12:15], s43 offen lds
    s_add_u32 s43, s41, 0x208000
    s_add_u32 m0, s51, 0x1d000
    s_nop 0
    buffer_load_dwordx4 v15, s[12:15], s43 offen lds
    s_add_u32 s43, s41, 0x300000
    s_add_u32 m0, s51, 0x1e000
    s_nop 0
    buffer_load_dwordx4 v15, s[12:15], s43 offen lds
    s_add_u32 s43, s41, 0x308000
    s_add_u32 m0, s51, 0x1f000
    s_nop 0
    buffer_load_dwordx4 v15, s[12:15], s43 offen lds
    v_xor_b32 v15, 2, v14
    v_lshl_add_u32 v15, v15, 15, v8
    s_add_u32 s43, s41, 0x80000
    s_add_u32 m0, s51, 0x20000
    s_nop 0
    buffer_load_dwordx4 v15, s[12:15], s43 offen lds
    s_add_u32 s43, s41, 0x88000
    s_add_u32 m0, s51, 0x21000
    s_nop 0
    buffer_load_dwordx4 v15, s[12:15], s43 offen lds
    s_add_u32 s43, s41, 0x180000
    s_add_u32 m0, s51, 0x22000
    s_nop 0
    buffer_load_dwordx4 v15, s[12:15], s43 offen lds
    s_add_u32 s43, s41, 0x188000
    s_add_u32 m0, s51, 0x23000
    s_nop 0
    buffer_load_dwordx4 v15, s[12:15], s43 offen lds
    s_add_u32 s43, s41, 0x280000
    s_add_u32 m0, s51, 0x24000
    s_nop 0
    buffer_load_dwordx4 v15, s[12:15], s43 offen lds
    s_add_u32 s43, s41, 0x288000
    s_add_u32 m0, s51, 0x25000
    s_nop 0
    buffer_load_dwordx4 v15, s[12:15], s43 offen lds
    s_add_u32 s43, s41, 0x380000
    s_add_u32 m0, s51, 0x26000
    s_nop 0
    buffer_load_dwordx4 v15, s[12:15], s43 offen lds
    s_add_u32 s43, s41, 0x388000
    s_add_u32 m0, s51, 0x27000
    s_nop 0
    buffer_load_dwordx4 v15, s[12:15], s43 offen lds
    v_and_b32 v4, 2, v3
    v_cmp_ne_u32 vcc, 0, v4
    v_mov_b32 v4, 0x4444
    v_mov_b32 v5, 0xeeee
    v_cndmask_b32 v116, v4, v5, vcc
    v_lshrrev_b32 v5, 1, v2
    v_lshl_add_u32 v4, v6, 3, v5
    s_lshl_b32 s43, s21, 1
    v_add_u32 v4, s43, v4
    v_add_u32 v5, s20, v4
    v_and_b32 v5, 31, v5
    v_lshl_add_u32 v4, v4, 6, v5
    v_and_b32 v5, 1, v2
    v_lshl_add_u32 v4, v4, 1, v5
    v_and_b32 v5, 3, v3
    v_lshl_add_u32 v4, v4, 2, v5
    v_lshlrev_b32 v118, 4, v4
    v_and_b32 v4, 1, v2
    v_lshlrev_b32 v4, 2, v4
    v_and_b32 v7, 2, v2
    v_add_u32 v4, v4, v7
    v_and_b32 v7, 1, v6
    v_add_u32 v4, v4, v7
    v_lshl_add_u32 v4, v4, 2, v5
    v_lshlrev_b32 v4, 2, v4
    s_and_b32 s43, s21, 1
    s_lshl_b32 s43, s43, 12
    s_lshl_b32 s40, s20, 7
    s_add_u32 s43, s43, s40
    v_add_u32 v119, s43, v4
    v_sub_u32 v7, 0, v2
    v_and_b32 v7, 3, v7
    v_xor_b32 v7, v7, v6
    v_lshl_add_u32 v4, v2, 4, v7
    v_and_b32 v5, 3, v3
    v_lshl_add_u32 v4, v4, 2, v5
    s_add_u32 s43, s51, 16384
    v_lshl_add_u32 v120, v4, 2, s43
    v_sub_u32 v7, 0, v6
    v_and_b32 v7, 3, v7
    v_xor_b32 v7, v7, v2
    v_lshl_add_u32 v4, v3, 2, v7
    v_lshlrev_b32 v121, 4, v4
    v_and_b32 v5, 1, v3
    v_lshl_add_u32 v4, v6, 1, v5
    v_lshl_add_u32 v4, v2, 3, v4
    v_lshlrev_b32 v127, 4, v4
    v_and_or_b32 v122, v116, 8, v127
    s_lshl_b32 s43, s21, 13
    s_add_u32 s43, s43, 32768
    v_add_u32 v123, s43, v117
    v_add_u32 v124, 0x10000, v123
    s_mov_b32 s36, 0xcccccccc
    s_mov_b32 s37, 0xcccccccc
    s_mov_b32 s38, 0x00ff00ff
    s_mov_b32 s39, 0x00ff00ff
    s_mov_b32 s34, 0x3e0293ee
    s_mov_b32 s35, 0x49800000
    s_mov_b32 s50, 0x3f803f80
    v_and_b32 v5, 1, v2
    v_or_b32 v5, 0, v5
    v_xor_b32 v5, v5, v6
    v_lshlrev_b32 v5, 8, v5
    v_and_b32 v7, 3, v3
    v_lshl_add_u32 v7, v7, 4, v5
    s_lshl_b32 s43, s21, 2
    v_add_u32 v4, s43, v2
    v_lshl_add_u32 v10, v4, 10, v7
    v_and_b32 v5, 1, v2
    v_or_b32 v5, 2, v5
    v_xor_b32 v5, v5, v6
    v_lshlrev_b32 v5, 8, v5
    v_and_b32 v7, 3, v3
    v_lshl_add_u32 v7, v7, 4, v5
    s_lshl_b32 s43, s21, 2
    v_add_u32 v4, s43, v2
    v_lshl_add_u32 v9, v4, 10, v7
    v_and_b32 v5, 1, v2
    v_lshl_add_u32 v4, v5, 3, v6
    v_lshrrev_b32 v7, 1, v2
    v_lshl_add_u32 v4, v7, 5, v4
    v_lshlrev_b32 v4, 8, v4
    v_lshl_or_b32 v5, v5, 2, v6
    v_lshlrev_b32 v5, 5, v5
    s_lshl_b32 s43, s21, 6
    v_xor_b32 v5, s43, v5
    v_add_u32 v4, v4, v5
    v_and_b32 v5, 3, v3
    v_lshl_add_u32 v4, v5, 3, v4
    v_add_u32 v11, 32768, v4
    s_and_b32 s43, s21, 1
    s_lshl_b32 s43, s43, 12
    v_add_u32 v11, s43, v11
    v_and_b32 v5, 1, v2
    v_lshlrev_b32 v4, 4, v5
    v_lshl_add_u32 v4, v7, 2, v4
    v_and_b32 v7, 1, v6
    v_add_u32 v4, v4, v7
    s_lshl_b32 s43, s21, 5
    v_add_u32 v4, s43, v4
    v_lshlrev_b32 v4, 8, v4
    v_lshl_or_b32 v5, v5, 1, v7
    v_xor_b32 v5, s21, v5
    v_lshl_add_u32 v4, v5, 6, v4
    v_lshrrev_b32 v5, 1, v6
    v_lshl_add_u32 v4, v5, 5, v4
    v_and_b32 v5, 3, v3
    v_lshl_add_u32 v4, v5, 3, v4
    v_add_u32 v12, 32768, v4
    v_mov_b32 v16, -1
    v_mov_b32 v17, -1
    v_mov_b32 v18, -1
    v_mov_b32 v19, -1
    s_lshl_b32 s43, s20, 13
    s_add_u32 s43, s43, 0x7100000
    s_and_b32 s40, s21, 1
    s_lshl_b32 s40, s40, 12
    s_add_u32 s29, s43, s40
    s_add_u32 s43, s43, s52
    s_xor_b32 s40, s43, 0x40000
    buffer_store_dwordx4 v[16:19], v117, s[8:11], s43 offen sc1
    buffer_store_dwordx4 v[16:19], v117, s[8:11], s43 offen offset:1024 sc1
    buffer_store_dwordx4 v[16:19], v117, s[8:11], s40 offen sc1
    buffer_store_dwordx4 v[16:19], v117, s[8:11], s40 offen offset:1024 sc1
    s_mov_b32 s43, 0x7012000
    buffer_store_dword v16, v119, s[8:11], s43 offen sc1
    s_mov_b32 s43, 0x7014000
    buffer_store_dword v16, v119, s[8:11], s43 offen sc1
    s_mov_b32 s43, 0x7016000
    buffer_store_dword v16, v119, s[8:11], s43 offen sc1
    s_load_dwordx2 s[4:5], s[0:1], 8
    s_waitcnt lgkmcnt(0)
    s_and_b32 s5, s5, 0xffff
    s_mov_b32 s6, 8192
    s_mov_b32 s7, 0x20000
    v_and_b32 v20, 1, v2
    v_and_b32 v21, 1, v6
    v_lshl_add_u32 v20, v20, 1, v21
    v_lshlrev_b32 v20, 9, v20
    v_and_b32 v21, 3, v3
    v_lshl_add_u32 v20, v21, 4, v20
    v_and_b32 v21, 2, v2
    v_add_u32 v20, v20, v21
    s_and_b32 s43, s20, 1
    s_lshl_b32 s43, s43, 11
    s_bfe_u32 s40, s20, 0x20001
    s_lshl_b32 s40, s40, 7
    s_add_u32 s43, s43, s40
    s_and_b32 s40, s21, 1
    s_lshl_b32 s40, s40, 6
    s_add_u32 s43, s43, s40
    s_lshr_b32 s40, s20, 3
    s_lshl_b32 s40, s40, 2
    s_add_u32 s43, s43, s40
    v_add_u32 v20, s43, v20
    v_lshlrev_b32 v20, 1, v20
    buffer_load_dword v21, v20, s[4:7], 0 offen
    s_waitcnt vmcnt(32)
    s_barrier
    v_xor_b32 v13, 0x0, v11
    v_add_u32 v13, 0x0, v13
    ds_read_b64_tr_b16 a[32:33], v13
    ds_read_b64_tr_b16 a[34:35], v13 offset:1024
    ds_read_b64_tr_b16 a[36:37], v13 offset:16384
    ds_read_b64_tr_b16 a[38:39], v13 offset:17408
    v_xor_b32 v13, 0x20, v11
    v_add_u32 v13, 0x0, v13
    ds_read_b64_tr_b16 a[40:41], v13
    ds_read_b64_tr_b16 a[42:43], v13 offset:1024
    ds_read_b64_tr_b16 a[44:45], v13 offset:16384
    ds_read_b64_tr_b16 a[46:47], v13 offset:17408
    v_xor_b32 v13, 0x1000, v11
    v_add_u32 v13, 0x0, v13
    ds_read_b64_tr_b16 a[64:65], v13
    ds_read_b64_tr_b16 a[66:67], v13 offset:1024
    ds_read_b64_tr_b16 a[68:69], v13 offset:16384
    ds_read_b64_tr_b16 a[70:71], v13 offset:17408
    v_xor_b32 v13, 0x1020, v11
    v_add_u32 v13, 0x0, v13
    ds_read_b64_tr_b16 a[72:73], v13
    ds_read_b64_tr_b16 a[74:75], v13 offset:1024
    ds_read_b64_tr_b16 a[76:77], v13 offset:16384
    ds_read_b64_tr_b16 a[78:79], v13 offset:17408
    s_waitcnt lgkmcnt(0)
    s_barrier
    s_mov_b32 s12, s64
    s_and_b32 s13, s65, 0xffff
    v_xor_b32 v15, 0, v14
    v_lshl_add_u32 v15, v15, 15, v8
    s_add_u32 s43, s41, 0x0
    s_add_u32 m0, s51, 0x8000
    s_nop 0
    buffer_load_dwordx4 v15, s[12:15], s43 offen lds
    s_add_u32 s43, s41, 0x8000
    s_add_u32 m0, s51, 0x9000
    s_nop 0
    buffer_load_dwordx4 v15, s[12:15], s43 offen lds
    s_add_u32 s43, s41, 0x100000
    s_add_u32 m0, s51, 0xa000
    s_nop 0
    buffer_load_dwordx4 v15, s[12:15], s43 offen lds
    s_add_u32 s43, s41, 0x108000
    s_add_u32 m0, s51, 0xb000
    s_nop 0
    buffer_load_dwordx4 v15, s[12:15], s43 offen lds
    s_add_u32 s43, s41, 0x200000
    s_add_u32 m0, s51, 0xc000
    s_nop 0
    buffer_load_dwordx4 v15, s[12:15], s43 offen lds
    s_add_u32 s43, s41, 0x208000
    s_add_u32 m0, s51, 0xd000
    s_nop 0
    buffer_load_dwordx4 v15, s[12:15], s43 offen lds
    s_add_u32 s43, s41, 0x300000
    s_add_u32 m0, s51, 0xe000
    s_nop 0
    buffer_load_dwordx4 v15, s[12:15], s43 offen lds
    s_add_u32 s43, s41, 0x308000
    s_add_u32 m0, s51, 0xf000
    s_nop 0
    buffer_load_dwordx4 v15, s[12:15], s43 offen lds
    s_waitcnt vmcnt(32)
    s_barrier
    v_xor_b32 v13, 0x0, v11
    v_add_u32 v13, 0x8000, v13
    ds_read_b64_tr_b16 a[48:49], v13
    ds_read_b64_tr_b16 a[50:51], v13 offset:1024
    ds_read_b64_tr_b16 a[52:53], v13 offset:16384
    ds_read_b64_tr_b16 a[54:55], v13 offset:17408
    v_xor_b32 v13, 0x20, v11
    v_add_u32 v13, 0x8000, v13
    ds_read_b64_tr_b16 a[56:57], v13
    ds_read_b64_tr_b16 a[58:59], v13 offset:1024
    ds_read_b64_tr_b16 a[60:61], v13 offset:16384
    ds_read_b64_tr_b16 a[62:63], v13 offset:17408
    v_xor_b32 v13, 0x1000, v11
    v_add_u32 v13, 0x8000, v13
    ds_read_b64_tr_b16 a[80:81], v13
    ds_read_b64_tr_b16 a[82:83], v13 offset:1024
    ds_read_b64_tr_b16 a[84:85], v13 offset:16384
    ds_read_b64_tr_b16 a[86:87], v13 offset:17408
    v_xor_b32 v13, 0x1020, v11
    v_add_u32 v13, 0x8000, v13
    ds_read_b64_tr_b16 a[88:89], v13
    ds_read_b64_tr_b16 a[90:91], v13 offset:1024
    ds_read_b64_tr_b16 a[92:93], v13 offset:16384
    ds_read_b64_tr_b16 a[94:95], v13 offset:17408
    s_waitcnt lgkmcnt(0)
    s_barrier
    v_xor_b32 v15, 0, v14
    v_lshl_add_u32 v15, v15, 15, v8
    s_add_u32 s43, s41, 0x80000
    s_add_u32 m0, s51, 0x10000
    s_nop 0
    buffer_load_dwordx4 v15, s[12:15], s43 offen lds
    s_add_u32 s43, s41, 0x88000
    s_add_u32 m0, s51, 0x11000
    s_nop 0
    buffer_load_dwordx4 v15, s[12:15], s43 offen lds
    s_add_u32 s43, s41, 0x180000
    s_add_u32 m0, s51, 0x12000
    s_nop 0
    buffer_load_dwordx4 v15, s[12:15], s43 offen lds
    s_add_u32 s43, s41, 0x188000
    s_add_u32 m0, s51, 0x13000
    s_nop 0
    buffer_load_dwordx4 v15, s[12:15], s43 offen lds
    s_add_u32 s43, s41, 0x280000
    s_add_u32 m0, s51, 0x14000
    s_nop 0
    buffer_load_dwordx4 v15, s[12:15], s43 offen lds
    s_add_u32 s43, s41, 0x288000
    s_add_u32 m0, s51, 0x15000
    s_nop 0
    buffer_load_dwordx4 v15, s[12:15], s43 offen lds
    s_add_u32 s43, s41, 0x380000
    s_add_u32 m0, s51, 0x16000
    s_nop 0
    buffer_load_dwordx4 v15, s[12:15], s43 offen lds
    s_add_u32 s43, s41, 0x388000
    s_add_u32 m0, s51, 0x17000
    s_nop 0
    buffer_load_dwordx4 v15, s[12:15], s43 offen lds
    s_waitcnt vmcnt(32)
    s_barrier
    v_xor_b32 v13, 0x0, v11
    v_add_u32 v13, 0x10000, v13
    ds_read_b64_tr_b16 a[128:129], v13
    ds_read_b64_tr_b16 a[130:131], v13 offset:1024
    ds_read_b64_tr_b16 a[132:133], v13 offset:16384
    ds_read_b64_tr_b16 a[134:135], v13 offset:17408
    v_xor_b32 v13, 0x20, v11
    v_add_u32 v13, 0x10000, v13
    ds_read_b64_tr_b16 a[136:137], v13
    ds_read_b64_tr_b16 a[138:139], v13 offset:1024
    ds_read_b64_tr_b16 a[140:141], v13 offset:16384
    ds_read_b64_tr_b16 a[142:143], v13 offset:17408
    v_xor_b32 v13, 0x1000, v11
    v_add_u32 v13, 0x10000, v13
    ds_read_b64_tr_b16 a[160:161], v13
    ds_read_b64_tr_b16 a[162:163], v13 offset:1024
    ds_read_b64_tr_b16 a[164:165], v13 offset:16384
    ds_read_b64_tr_b16 a[166:167], v13 offset:17408
    v_xor_b32 v13, 0x1020, v11
    v_add_u32 v13, 0x10000, v13
    ds_read_b64_tr_b16 a[168:169], v13
    ds_read_b64_tr_b16 a[170:171], v13 offset:1024
    ds_read_b64_tr_b16 a[172:173], v13 offset:16384
    ds_read_b64_tr_b16 a[174:175], v13 offset:17408
    s_waitcnt lgkmcnt(0)
    s_barrier
    v_xor_b32 v15, 2, v14
    v_lshl_add_u32 v15, v15, 15, v8
    s_add_u32 s43, s41, 0x0
    s_add_u32 m0, s51, 0x18000
    s_nop 0
    buffer_load_dwordx4 v15, s[12:15], s43 offen lds
    s_add_u32 s43, s41, 0x8000
    s_add_u32 m0, s51, 0x19000
    s_nop 0
    buffer_load_dwordx4 v15, s[12:15], s43 offen lds
    s_add_u32 s43, s41, 0x100000
    s_add_u32 m0, s51, 0x1a000
    s_nop 0
    buffer_load_dwordx4 v15, s[12:15], s43 offen lds
    s_add_u32 s43, s41, 0x108000
    s_add_u32 m0, s51, 0x1b000
    s_nop 0
    buffer_load_dwordx4 v15, s[12:15], s43 offen lds
    s_add_u32 s43, s41, 0x200000
    s_add_u32 m0, s51, 0x1c000
    s_nop 0
    buffer_load_dwordx4 v15, s[12:15], s43 offen lds
    s_add_u32 s43, s41, 0x208000
    s_add_u32 m0, s51, 0x1d000
    s_nop 0
    buffer_load_dwordx4 v15, s[12:15], s43 offen lds
    s_add_u32 s43, s41, 0x300000
    s_add_u32 m0, s51, 0x1e000
    s_nop 0
    buffer_load_dwordx4 v15, s[12:15], s43 offen lds
    s_add_u32 s43, s41, 0x308000
    s_add_u32 m0, s51, 0x1f000
    s_nop 0
    buffer_load_dwordx4 v15, s[12:15], s43 offen lds
    s_waitcnt vmcnt(32)
    s_barrier
    v_xor_b32 v13, 0x0, v11
    v_add_u32 v13, 0x18000, v13
    ds_read_b64_tr_b16 a[144:145], v13
    ds_read_b64_tr_b16 a[146:147], v13 offset:1024
    ds_read_b64_tr_b16 a[148:149], v13 offset:16384
    ds_read_b64_tr_b16 a[150:151], v13 offset:17408
    v_xor_b32 v13, 0x20, v11
    v_add_u32 v13, 0x18000, v13
    ds_read_b64_tr_b16 a[152:153], v13
    ds_read_b64_tr_b16 a[154:155], v13 offset:1024
    ds_read_b64_tr_b16 a[156:157], v13 offset:16384
    ds_read_b64_tr_b16 a[158:159], v13 offset:17408
    v_xor_b32 v13, 0x1000, v11
    v_add_u32 v13, 0x18000, v13
    ds_read_b64_tr_b16 a[176:177], v13
    ds_read_b64_tr_b16 a[178:179], v13 offset:1024
    ds_read_b64_tr_b16 a[180:181], v13 offset:16384
    ds_read_b64_tr_b16 a[182:183], v13 offset:17408
    v_xor_b32 v13, 0x1020, v11
    v_add_u32 v13, 0x18000, v13
    ds_read_b64_tr_b16 a[184:185], v13
    ds_read_b64_tr_b16 a[186:187], v13 offset:1024
    ds_read_b64_tr_b16 a[188:189], v13 offset:16384
    ds_read_b64_tr_b16 a[190:191], v13 offset:17408
    s_waitcnt lgkmcnt(0)
    s_barrier
    v_xor_b32 v15, 2, v14
    v_lshl_add_u32 v15, v15, 15, v8
    s_add_u32 s43, s41, 0x80000
    s_add_u32 m0, s51, 0x20000
    s_nop 0
    buffer_load_dwordx4 v15, s[12:15], s43 offen lds
    s_add_u32 s43, s41, 0x88000
    s_add_u32 m0, s51, 0x21000
    s_nop 0
    buffer_load_dwordx4 v15, s[12:15], s43 offen lds
    s_add_u32 s43, s41, 0x180000
    s_add_u32 m0, s51, 0x22000
    s_nop 0
    buffer_load_dwordx4 v15, s[12:15], s43 offen lds
    s_add_u32 s43, s41, 0x188000
    s_add_u32 m0, s51, 0x23000
    s_nop 0
    buffer_load_dwordx4 v15, s[12:15], s43 offen lds
    s_add_u32 s43, s41, 0x280000
    s_add_u32 m0, s51, 0x24000
    s_nop 0
    buffer_load_dwordx4 v15, s[12:15], s43 offen lds
    s_add_u32 s43, s41, 0x288000
    s_add_u32 m0, s51, 0x25000
    s_nop 0
    buffer_load_dwordx4 v15, s[12:15], s43 offen lds
    s_add_u32 s43, s41, 0x380000
    s_add_u32 m0, s51, 0x26000
    s_nop 0
    buffer_load_dwordx4 v15, s[12:15], s43 offen lds
    s_add_u32 s43, s41, 0x388000
    s_add_u32 m0, s51, 0x27000
    s_nop 0
    buffer_load_dwordx4 v15, s[12:15], s43 offen lds
    s_waitcnt vmcnt(24)
    v_min_u32 v21, 0xfffffffe, v21
    s_mov_b32 s43, 0x7010000
    s_mov_b64 exec, s[38:39]
    buffer_store_dword v21, v119, s[8:11], s43 offen sc1
    s_mov_b64 exec, -1
    s_barrier
    v_xor_b32 v13, 0x0, v11
    v_add_u32 v13, 0x0, v13
    ds_read_b64_tr_b16 a[192:193], v13
    ds_read_b64_tr_b16 a[194:195], v13 offset:1024
    ds_read_b64_tr_b16 a[196:197], v13 offset:16384
    ds_read_b64_tr_b16 a[198:199], v13 offset:17408
    v_xor_b32 v13, 0x20, v11
    v_add_u32 v13, 0x0, v13
    ds_read_b64_tr_b16 a[200:201], v13
    ds_read_b64_tr_b16 a[202:203], v13 offset:1024
    ds_read_b64_tr_b16 a[204:205], v13 offset:16384
    ds_read_b64_tr_b16 a[206:207], v13 offset:17408
    v_xor_b32 v13, 0x1000, v11
    v_add_u32 v13, 0x0, v13
    ds_read_b64_tr_b16 a[224:225], v13
    ds_read_b64_tr_b16 a[226:227], v13 offset:1024
    ds_read_b64_tr_b16 a[228:229], v13 offset:16384
    ds_read_b64_tr_b16 a[230:231], v13 offset:17408
    v_xor_b32 v13, 0x1020, v11
    v_add_u32 v13, 0x0, v13
    ds_read_b64_tr_b16 a[232:233], v13
    ds_read_b64_tr_b16 a[234:235], v13 offset:1024
    ds_read_b64_tr_b16 a[236:237], v13 offset:16384
    ds_read_b64_tr_b16 a[238:239], v13 offset:17408
    s_waitcnt lgkmcnt(0)
    s_barrier
    s_mov_b32 s12, s60
    s_and_b32 s13, s61, 0xffff
    v_xor_b32 v15, 0, v14
    v_lshl_add_u32 v15, v15, 15, v8
    s_add_u32 s43, s41, 0x0
    s_add_u32 m0, s51, 0x8000
    s_nop 0
    buffer_load_dwordx4 v15, s[12:15], s43 offen lds
    s_add_u32 s43, s41, 0x8000
    s_add_u32 m0, s51, 0x9000
    s_nop 0
    buffer_load_dwordx4 v15, s[12:15], s43 offen lds
    s_add_u32 s43, s41, 0x100000
    s_add_u32 m0, s51, 0xa000
    s_nop 0
    buffer_load_dwordx4 v15, s[12:15], s43 offen lds
    s_add_u32 s43, s41, 0x108000
    s_add_u32 m0, s51, 0xb000
    s_nop 0
    buffer_load_dwordx4 v15, s[12:15], s43 offen lds
    s_add_u32 s43, s41, 0x200000
    s_add_u32 m0, s51, 0xc000
    s_nop 0
    buffer_load_dwordx4 v15, s[12:15], s43 offen lds
    s_add_u32 s43, s41, 0x208000
    s_add_u32 m0, s51, 0xd000
    s_nop 0
    buffer_load_dwordx4 v15, s[12:15], s43 offen lds
    s_add_u32 s43, s41, 0x300000
    s_add_u32 m0, s51, 0xe000
    s_nop 0
    buffer_load_dwordx4 v15, s[12:15], s43 offen lds
    s_add_u32 s43, s41, 0x308000
    s_add_u32 m0, s51, 0xf000
    s_nop 0
    buffer_load_dwordx4 v15, s[12:15], s43 offen lds
    s_waitcnt vmcnt(24)
    s_barrier
    v_xor_b32 v13, 0x0, v11
    v_add_u32 v13, 0x8000, v13
    ds_read_b64_tr_b16 a[208:209], v13
    ds_read_b64_tr_b16 a[210:211], v13 offset:1024
    ds_read_b64_tr_b16 a[212:213], v13 offset:16384
    ds_read_b64_tr_b16 a[214:215], v13 offset:17408
    v_xor_b32 v13, 0x20, v11
    v_add_u32 v13, 0x8000, v13
    ds_read_b64_tr_b16 a[216:217], v13
    ds_read_b64_tr_b16 a[218:219], v13 offset:1024
    ds_read_b64_tr_b16 a[220:221], v13 offset:16384
    ds_read_b64_tr_b16 a[222:223], v13 offset:17408
    v_xor_b32 v13, 0x1000, v11
    v_add_u32 v13, 0x8000, v13
    ds_read_b64_tr_b16 a[240:241], v13
    ds_read_b64_tr_b16 a[242:243], v13 offset:1024
    ds_read_b64_tr_b16 a[244:245], v13 offset:16384
    ds_read_b64_tr_b16 a[246:247], v13 offset:17408
    v_xor_b32 v13, 0x1020, v11
    v_add_u32 v13, 0x8000, v13
    ds_read_b64_tr_b16 a[248:249], v13
    ds_read_b64_tr_b16 a[250:251], v13 offset:1024
    ds_read_b64_tr_b16 a[252:253], v13 offset:16384
    ds_read_b64_tr_b16 a[254:255], v13 offset:17408
    s_waitcnt lgkmcnt(0)
    s_barrier
    s_mov_b32 s12, s62
    s_and_b32 s13, s63, 0xffff
    v_xor_b32 v15, 0, v14
    v_lshl_add_u32 v15, v15, 15, v8
    s_add_u32 s43, s41, 0x0
    s_add_u32 m0, s51, 0x10000
    s_nop 0
    buffer_load_dwordx4 v15, s[12:15], s43 offen lds
    s_add_u32 s43, s41, 0x8000
    s_add_u32 m0, s51, 0x11000
    s_nop 0
    buffer_load_dwordx4 v15, s[12:15], s43 offen lds
    s_add_u32 s43, s41, 0x100000
    s_add_u32 m0, s51, 0x12000
    s_nop 0
    buffer_load_dwordx4 v15, s[12:15], s43 offen lds
    s_add_u32 s43, s41, 0x108000
    s_add_u32 m0, s51, 0x13000
    s_nop 0
    buffer_load_dwordx4 v15, s[12:15], s43 offen lds
    s_add_u32 s43, s41, 0x200000
    s_add_u32 m0, s51, 0x14000
    s_nop 0
    buffer_load_dwordx4 v15, s[12:15], s43 offen lds
    s_add_u32 s43, s41, 0x208000
    s_add_u32 m0, s51, 0x15000
    s_nop 0
    buffer_load_dwordx4 v15, s[12:15], s43 offen lds
    s_add_u32 s43, s41, 0x300000
    s_add_u32 m0, s51, 0x16000
    s_nop 0
    buffer_load_dwordx4 v15, s[12:15], s43 offen lds
    s_add_u32 s43, s41, 0x308000
    s_add_u32 m0, s51, 0x17000
    s_nop 0
    buffer_load_dwordx4 v15, s[12:15], s43 offen lds
    s_waitcnt vmcnt(24)
    s_barrier
    v_xor_b32 v13, 0x0, v11
    v_add_u32 v13, 0x10000, v13
    ds_read_b64_tr_b16 v[128:129], v13
    ds_read_b64_tr_b16 v[130:131], v13 offset:1024
    ds_read_b64_tr_b16 v[132:133], v13 offset:16384
    ds_read_b64_tr_b16 v[134:135], v13 offset:17408
    v_xor_b32 v13, 0x20, v11
    v_add_u32 v13, 0x10000, v13
    ds_read_b64_tr_b16 v[136:137], v13
    ds_read_b64_tr_b16 v[138:139], v13 offset:1024
    ds_read_b64_tr_b16 v[140:141], v13 offset:16384
    ds_read_b64_tr_b16 v[142:143], v13 offset:17408
    v_xor_b32 v13, 0x1000, v11
    v_add_u32 v13, 0x10000, v13
    ds_read_b64_tr_b16 v[160:161], v13
    ds_read_b64_tr_b16 v[162:163], v13 offset:1024
    ds_read_b64_tr_b16 v[164:165], v13 offset:16384
    ds_read_b64_tr_b16 v[166:167], v13 offset:17408
    v_xor_b32 v13, 0x1020, v11
    v_add_u32 v13, 0x10000, v13
    ds_read_b64_tr_b16 v[168:169], v13
    ds_read_b64_tr_b16 v[170:171], v13 offset:1024
    ds_read_b64_tr_b16 v[172:173], v13 offset:16384
    ds_read_b64_tr_b16 v[174:175], v13 offset:17408
    s_waitcnt lgkmcnt(0)
    s_barrier
    s_mov_b32 s12, s66
    s_and_b32 s13, s67, 0xffff
    s_add_u32 s43, s42, 0x0
    s_add_u32 m0, s51, 0x18000
    s_nop 0
    buffer_load_dwordx4 v10, s[12:15], s43 offen lds
    s_add_u32 s43, s42, 0x4000
    s_add_u32 m0, s51, 0x19000
    s_nop 0
    buffer_load_dwordx4 v9, s[12:15], s43 offen lds
    s_add_u32 s43, s42, 0x8000
    s_add_u32 m0, s51, 0x1a000
    s_nop 0
    buffer_load_dwordx4 v10, s[12:15], s43 offen lds
    s_add_u32 s43, s42, 0xc000
    s_add_u32 m0, s51, 0x1b000
    s_nop 0
    buffer_load_dwordx4 v9, s[12:15], s43 offen lds
    s_add_u32 s43, s42, 0x10000
    s_add_u32 m0, s51, 0x1c000
    s_nop 0
    buffer_load_dwordx4 v10, s[12:15], s43 offen lds
    s_add_u32 s43, s42, 0x14000
    s_add_u32 m0, s51, 0x1d000
    s_nop 0
    buffer_load_dwordx4 v9, s[12:15], s43 offen lds
    s_add_u32 s43, s42, 0x18000
    s_add_u32 m0, s51, 0x1e000
    s_nop 0
    buffer_load_dwordx4 v10, s[12:15], s43 offen lds
    s_add_u32 s43, s42, 0x1c000
    s_add_u32 m0, s51, 0x1f000
    s_nop 0
    buffer_load_dwordx4 v9, s[12:15], s43 offen lds
    s_waitcnt vmcnt(24)
    s_barrier
    v_xor_b32 v13, 0x0, v11
    v_add_u32 v13, 0x18000, v13
    ds_read_b64_tr_b16 v[144:145], v13
    ds_read_b64_tr_b16 v[146:147], v13 offset:1024
    ds_read_b64_tr_b16 v[148:149], v13 offset:16384
    ds_read_b64_tr_b16 v[150:151], v13 offset:17408
    v_xor_b32 v13, 0x20, v11
    v_add_u32 v13, 0x18000, v13
    ds_read_b64_tr_b16 v[152:153], v13
    ds_read_b64_tr_b16 v[154:155], v13 offset:1024
    ds_read_b64_tr_b16 v[156:157], v13 offset:16384
    ds_read_b64_tr_b16 v[158:159], v13 offset:17408
    v_xor_b32 v13, 0x1000, v11
    v_add_u32 v13, 0x18000, v13
    ds_read_b64_tr_b16 v[176:177], v13
    ds_read_b64_tr_b16 v[178:179], v13 offset:1024
    ds_read_b64_tr_b16 v[180:181], v13 offset:16384
    ds_read_b64_tr_b16 v[182:183], v13 offset:17408
    v_xor_b32 v13, 0x1020, v11
    v_add_u32 v13, 0x18000, v13
    ds_read_b64_tr_b16 v[184:185], v13
    ds_read_b64_tr_b16 v[186:187], v13 offset:1024
    ds_read_b64_tr_b16 v[188:189], v13 offset:16384
    ds_read_b64_tr_b16 v[190:191], v13 offset:17408
    s_waitcnt lgkmcnt(0)
    s_barrier
    s_add_u32 s43, s42, 0x40
    s_add_u32 m0, s51, 0x20000
    s_nop 0
    buffer_load_dwordx4 v10, s[12:15], s43 offen lds
    s_add_u32 s43, s42, 0x4040
    s_add_u32 m0, s51, 0x21000
    s_nop 0
    buffer_load_dwordx4 v9, s[12:15], s43 offen lds
    s_add_u32 s43, s42, 0x8040
    s_add_u32 m0, s51, 0x22000
    s_nop 0
    buffer_load_dwordx4 v10, s[12:15], s43 offen lds
    s_add_u32 s43, s42, 0xc040
    s_add_u32 m0, s51, 0x23000
    s_nop 0
    buffer_load_dwordx4 v9, s[12:15], s43 offen lds
    s_add_u32 s43, s42, 0x10040
    s_add_u32 m0, s51, 0x24000
    s_nop 0
    buffer_load_dwordx4 v10, s[12:15], s43 offen lds
    s_add_u32 s43, s42, 0x14040
    s_add_u32 m0, s51, 0x25000
    s_nop 0
    buffer_load_dwordx4 v9, s[12:15], s43 offen lds
    s_add_u32 s43, s42, 0x18040
    s_add_u32 m0, s51, 0x26000
    s_nop 0
    buffer_load_dwordx4 v10, s[12:15], s43 offen lds
    s_add_u32 s43, s42, 0x1c040
    s_add_u32 m0, s51, 0x27000
    s_nop 0
    buffer_load_dwordx4 v9, s[12:15], s43 offen lds
    s_waitcnt vmcnt(24)
    s_barrier
    v_xor_b32 v13, 0x0, v11
    v_add_u32 v13, 0x0, v13
    ds_read_b64_tr_b16 v[32:33], v13
    ds_read_b64_tr_b16 v[34:35], v13 offset:1024
    ds_read_b64_tr_b16 v[36:37], v13 offset:16384
    ds_read_b64_tr_b16 v[38:39], v13 offset:17408
    v_xor_b32 v13, 0x20, v11
    v_add_u32 v13, 0x0, v13
    ds_read_b64_tr_b16 v[40:41], v13
    ds_read_b64_tr_b16 v[42:43], v13 offset:1024
    ds_read_b64_tr_b16 v[44:45], v13 offset:16384
    ds_read_b64_tr_b16 v[46:47], v13 offset:17408
    v_xor_b32 v13, 0x1000, v11
    v_add_u32 v13, 0x0, v13
    ds_read_b64_tr_b16 a[0:1], v13
    ds_read_b64_tr_b16 a[2:3], v13 offset:1024
    ds_read_b64_tr_b16 a[4:5], v13 offset:16384
    ds_read_b64_tr_b16 a[6:7], v13 offset:17408
    v_xor_b32 v13, 0x1020, v11
    v_add_u32 v13, 0x0, v13
    ds_read_b64_tr_b16 a[8:9], v13
    ds_read_b64_tr_b16 a[10:11], v13 offset:1024
    ds_read_b64_tr_b16 a[12:13], v13 offset:16384
    ds_read_b64_tr_b16 a[14:15], v13 offset:17408
    s_waitcnt lgkmcnt(0)
    s_barrier
    s_mov_b32 s12, s60
    s_and_b32 s13, s61, 0xffff
    v_xor_b32 v15, 0, v14
    v_lshl_add_u32 v15, v15, 15, v8
    s_add_u32 s43, s41, 0x80000
    s_add_u32 m0, s51, 0x8000
    s_nop 0
    buffer_load_dwordx4 v15, s[12:15], s43 offen lds
    s_add_u32 s43, s41, 0x88000
    s_add_u32 m0, s51, 0x9000
    s_nop 0
    buffer_load_dwordx4 v15, s[12:15], s43 offen lds
    s_add_u32 s43, s41, 0x180000
    s_add_u32 m0, s51, 0xa000
    s_nop 0
    buffer_load_dwordx4 v15, s[12:15], s43 offen lds
    s_add_u32 s43, s41, 0x188000
    s_add_u32 m0, s51, 0xb000
    s_nop 0
    buffer_load_dwordx4 v15, s[12:15], s43 offen lds
    s_add_u32 s43, s41, 0x280000
    s_add_u32 m0, s51, 0xc000
    s_nop 0
    buffer_load_dwordx4 v15, s[12:15], s43 offen lds
    s_add_u32 s43, s41, 0x288000
    s_add_u32 m0, s51, 0xd000
    s_nop 0
    buffer_load_dwordx4 v15, s[12:15], s43 offen lds
    s_add_u32 s43, s41, 0x380000
    s_add_u32 m0, s51, 0xe000
    s_nop 0
    buffer_load_dwordx4 v15, s[12:15], s43 offen lds
    s_add_u32 s43, s41, 0x388000
    s_add_u32 m0, s51, 0xf000
    s_nop 0
    buffer_load_dwordx4 v15, s[12:15], s43 offen lds
    s_waitcnt vmcnt(24)
    s_barrier
    s_cmp_lg_u32 s21, 0
    s_cbranch_scc1 L_arr_49
    v_mov_b32 v23, 1
    s_mov_b64 exec, 1
    buffer_atomic_add v23, off, s[16:19], 0 offset:8
    s_mov_b64 exec, -1
L_arr_49:
    v_xor_b32 v13, 0x0, v11
    v_add_u32 v13, 0x8000, v13
    ds_read_b64_tr_b16 v[64:65], v13
    ds_read_b64_tr_b16 v[66:67], v13 offset:1024
    ds_read_b64_tr_b16 v[68:69], v13 offset:16384
    ds_read_b64_tr_b16 v[70:71], v13 offset:17408
    v_xor_b32 v13, 0x20, v11
    v_add_u32 v13, 0x8000, v13
    ds_read_b64_tr_b16 v[72:73], v13
    ds_read_b64_tr_b16 v[74:75], v13 offset:1024
    ds_read_b64_tr_b16 v[76:77], v13 offset:16384
    ds_read_b64_tr_b16 v[78:79], v13 offset:17408
    v_xor_b32 v13, 0x1000, v11
    v_add_u32 v13, 0x8000, v13
    ds_read_b64_tr_b16 a[96:97], v13
    ds_read_b64_tr_b16 a[98:99], v13 offset:1024
    ds_read_b64_tr_b16 a[100:101], v13 offset:16384
    ds_read_b64_tr_b16 a[102:103], v13 offset:17408
    v_xor_b32 v13, 0x1020, v11
    v_add_u32 v13, 0x8000, v13
    ds_read_b64_tr_b16 a[104:105], v13
    ds_read_b64_tr_b16 a[106:107], v13 offset:1024
    ds_read_b64_tr_b16 a[108:109], v13 offset:16384
    ds_read_b64_tr_b16 a[110:111], v13 offset:17408
    s_waitcnt lgkmcnt(0)
    s_barrier
    s_mov_b32 s12, s62
    s_and_b32 s13, s63, 0xffff
    v_xor_b32 v15, 0, v14
    v_lshl_add_u32 v15, v15, 15, v8
    s_add_u32 s43, s41, 0x80000
    s_add_u32 m0, s51, 0x10000
    s_nop 0
    buffer_load_dwordx4 v15, s[12:15], s43 offen lds
    s_add_u32 s43, s41, 0x88000
    s_add_u32 m0, s51, 0x11000
    s_nop 0
    buffer_load_dwordx4 v15, s[12:15], s43 offen lds
    s_add_u32 s43, s41, 0x180000
    s_add_u32 m0, s51, 0x12000
    s_nop 0
    buffer_load_dwordx4 v15, s[12:15], s43 offen lds
    s_add_u32 s43, s41, 0x188000
    s_add_u32 m0, s51, 0x13000
    s_nop 0
    buffer_load_dwordx4 v15, s[12:15], s43 offen lds
    s_add_u32 s43, s41, 0x280000
    s_add_u32 m0, s51, 0x14000
    s_nop 0
    buffer_load_dwordx4 v15, s[12:15], s43 offen lds
    s_add_u32 s43, s41, 0x288000
    s_add_u32 m0, s51, 0x15000
    s_nop 0
    buffer_load_dwordx4 v15, s[12:15], s43 offen lds
    s_add_u32 s43, s41, 0x380000
    s_add_u32 m0, s51, 0x16000
    s_nop 0
    buffer_load_dwordx4 v15, s[12:15], s43 offen lds
    s_add_u32 s43, s41, 0x388000
    s_add_u32 m0, s51, 0x17000
    s_nop 0
    buffer_load_dwordx4 v15, s[12:15], s43 offen lds
    s_waitcnt vmcnt(24)
    s_barrier
    v_xor_b32 v13, 0x0, v12
    v_add_u32 v13, 0x10000, v13
    ds_read_b64_tr_b16 v[192:193], v13
    ds_read_b64_tr_b16 v[194:195], v13 offset:512
    ds_read_b64_tr_b16 v[196:197], v13 offset:2048
    ds_read_b64_tr_b16 v[198:199], v13 offset:2560
    v_xor_b32 v13, 0x2000, v12
    v_add_u32 v13, 0x10000, v13
    ds_read_b64_tr_b16 v[200:201], v13
    ds_read_b64_tr_b16 v[202:203], v13 offset:512
    ds_read_b64_tr_b16 v[204:205], v13 offset:2048
    ds_read_b64_tr_b16 v[206:207], v13 offset:2560
    s_waitcnt lgkmcnt(0)
    v_xor_b32 v13, 0x4000, v12
    v_add_u32 v13, 0x10000, v13
    ds_read_b64_tr_b16 v[208:209], v13
    ds_read_b64_tr_b16 v[210:211], v13 offset:512
    ds_read_b64_tr_b16 v[212:213], v13 offset:2048
    ds_read_b64_tr_b16 v[214:215], v13 offset:2560
    v_xor_b32 v13, 0x6000, v12
    v_add_u32 v13, 0x10000, v13
    ds_read_b64_tr_b16 v[216:217], v13
    ds_read_b64_tr_b16 v[218:219], v13 offset:512
    ds_read_b64_tr_b16 v[220:221], v13 offset:2048
    ds_read_b64_tr_b16 v[222:223], v13 offset:2560
    s_waitcnt lgkmcnt(0)
    s_barrier
    s_mov_b32 s12, s66
    s_and_b32 s13, s67, 0xffff
    s_add_u32 s43, s42, 0x80
    s_add_u32 m0, s51, 0x18000
    s_nop 0
    buffer_load_dwordx4 v10, s[12:15], s43 offen lds
    s_add_u32 s43, s42, 0x4080
    s_add_u32 m0, s51, 0x19000
    s_nop 0
    buffer_load_dwordx4 v9, s[12:15], s43 offen lds
    s_add_u32 s43, s42, 0x8080
    s_add_u32 m0, s51, 0x1a000
    s_nop 0
    buffer_load_dwordx4 v10, s[12:15], s43 offen lds
    s_add_u32 s43, s42, 0xc080
    s_add_u32 m0, s51, 0x1b000
    s_nop 0
    buffer_load_dwordx4 v9, s[12:15], s43 offen lds
    s_add_u32 s43, s42, 0x10080
    s_add_u32 m0, s51, 0x1c000
    s_nop 0
    buffer_load_dwordx4 v10, s[12:15], s43 offen lds
    s_add_u32 s43, s42, 0x14080
    s_add_u32 m0, s51, 0x1d000
    s_nop 0
    buffer_load_dwordx4 v9, s[12:15], s43 offen lds
    s_add_u32 s43, s42, 0x18080
    s_add_u32 m0, s51, 0x1e000
    s_nop 0
    buffer_load_dwordx4 v10, s[12:15], s43 offen lds
    s_add_u32 s43, s42, 0x1c080
    s_add_u32 m0, s51, 0x1f000
    s_nop 0
    buffer_load_dwordx4 v9, s[12:15], s43 offen lds
    s_waitcnt vmcnt(24)
    s_barrier
    v_xor_b32 v13, 0x0, v12
    v_add_u32 v13, 0x18000, v13
    ds_read_b64_tr_b16 v[224:225], v13
    ds_read_b64_tr_b16 v[226:227], v13 offset:512
    ds_read_b64_tr_b16 v[228:229], v13 offset:2048
    ds_read_b64_tr_b16 v[230:231], v13 offset:2560
    v_xor_b32 v13, 0x2000, v12
    v_add_u32 v13, 0x18000, v13
    ds_read_b64_tr_b16 v[232:233], v13
    ds_read_b64_tr_b16 v[234:235], v13 offset:512
    ds_read_b64_tr_b16 v[236:237], v13 offset:2048
    ds_read_b64_tr_b16 v[238:239], v13 offset:2560
    s_waitcnt lgkmcnt(0)
    v_xor_b32 v13, 0x4000, v12
    v_add_u32 v13, 0x18000, v13
    ds_read_b64_tr_b16 v[240:241], v13
    ds_read_b64_tr_b16 v[242:243], v13 offset:512
    ds_read_b64_tr_b16 v[244:245], v13 offset:2048
    ds_read_b64_tr_b16 v[246:247], v13 offset:2560
    v_xor_b32 v13, 0x6000, v12
    v_add_u32 v13, 0x18000, v13
    ds_read_b64_tr_b16 v[248:249], v13
    ds_read_b64_tr_b16 v[250:251], v13 offset:512
    ds_read_b64_tr_b16 v[252:253], v13 offset:2048
    ds_read_b64_tr_b16 v[254:255], v13 offset:2560
    s_waitcnt lgkmcnt(0)
    s_barrier
    s_add_u32 s43, s42, 0xc0
    s_add_u32 m0, s51, 0x20000
    s_nop 0
    buffer_load_dwordx4 v10, s[12:15], s43 offen lds
    s_add_u32 s43, s42, 0x40c0
    s_add_u32 m0, s51, 0x21000
    s_nop 0
    buffer_load_dwordx4 v9, s[12:15], s43 offen lds
    s_add_u32 s43, s42, 0x80c0
    s_add_u32 m0, s51, 0x22000
    s_nop 0
    buffer_load_dwordx4 v10, s[12:15], s43 offen lds
    s_add_u32 s43, s42, 0xc0c0
    s_add_u32 m0, s51, 0x23000
    s_nop 0
    buffer_load_dwordx4 v9, s[12:15], s43 offen lds
    s_add_u32 s43, s42, 0x100c0
    s_add_u32 m0, s51, 0x24000
    s_nop 0
    buffer_load_dwordx4 v10, s[12:15], s43 offen lds
    s_add_u32 s43, s42, 0x140c0
    s_add_u32 m0, s51, 0x25000
    s_nop 0
    buffer_load_dwordx4 v9, s[12:15], s43 offen lds
    s_add_u32 s43, s42, 0x180c0
    s_add_u32 m0, s51, 0x26000
    s_nop 0
    buffer_load_dwordx4 v10, s[12:15], s43 offen lds
    s_add_u32 s43, s42, 0x1c0c0
    s_add_u32 m0, s51, 0x27000
    s_nop 0
    buffer_load_dwordx4 v9, s[12:15], s43 offen lds
    s_waitcnt vmcnt(24)
    s_barrier
    v_xor_b32 v13, 0x0, v11
    v_add_u32 v13, 0x0, v13
    ds_read_b64_tr_b16 v[48:49], v13
    ds_read_b64_tr_b16 v[50:51], v13 offset:1024
    ds_read_b64_tr_b16 v[52:53], v13 offset:16384
    ds_read_b64_tr_b16 v[54:55], v13 offset:17408
    v_xor_b32 v13, 0x20, v11
    v_add_u32 v13, 0x0, v13
    ds_read_b64_tr_b16 v[56:57], v13
    ds_read_b64_tr_b16 v[58:59], v13 offset:1024
    ds_read_b64_tr_b16 v[60:61], v13 offset:16384
    ds_read_b64_tr_b16 v[62:63], v13 offset:17408
    v_xor_b32 v13, 0x1000, v11
    v_add_u32 v13, 0x0, v13
    ds_read_b64_tr_b16 a[16:17], v13
    ds_read_b64_tr_b16 a[18:19], v13 offset:1024
    ds_read_b64_tr_b16 a[20:21], v13 offset:16384
    ds_read_b64_tr_b16 a[22:23], v13 offset:17408
    v_xor_b32 v13, 0x1020, v11
    v_add_u32 v13, 0x0, v13
    ds_read_b64_tr_b16 a[24:25], v13
    ds_read_b64_tr_b16 a[26:27], v13 offset:1024
    ds_read_b64_tr_b16 a[28:29], v13 offset:16384
    ds_read_b64_tr_b16 a[30:31], v13 offset:17408
    s_waitcnt lgkmcnt(0)
    s_barrier
    ds_write_b128 v123, v[32:35]
    ds_write_b128 v123, v[36:39] offset:1024
    ds_write_b128 v123, v[40:43] offset:2048
    ds_write_b128 v123, v[44:47] offset:3072
    ds_write_b128 v123, v[48:51] offset:4096
    ds_write_b128 v123, v[52:55] offset:5120
    ds_write_b128 v123, v[56:59] offset:6144
    ds_write_b128 v123, v[60:63] offset:7168
    s_waitcnt vmcnt(16)
    s_barrier
    v_xor_b32 v13, 0x0, v11
    v_add_u32 v13, 0x8000, v13
    ds_read_b64_tr_b16 v[80:81], v13
    ds_read_b64_tr_b16 v[82:83], v13 offset:1024
    ds_read_b64_tr_b16 v[84:85], v13 offset:16384
    ds_read_b64_tr_b16 v[86:87], v13 offset:17408
    v_xor_b32 v13, 0x20, v11
    v_add_u32 v13, 0x8000, v13
    ds_read_b64_tr_b16 v[88:89], v13
    ds_read_b64_tr_b16 v[90:91], v13 offset:1024
    ds_read_b64_tr_b16 v[92:93], v13 offset:16384
    ds_read_b64_tr_b16 v[94:95], v13 offset:17408
    v_xor_b32 v13, 0x1000, v11
    v_add_u32 v13, 0x8000, v13
    ds_read_b64_tr_b16 a[112:113], v13
    ds_read_b64_tr_b16 a[114:115], v13 offset:1024
    ds_read_b64_tr_b16 a[116:117], v13 offset:16384
    ds_read_b64_tr_b16 a[118:119], v13 offset:17408
    v_xor_b32 v13, 0x1020, v11
    v_add_u32 v13, 0x8000, v13
    ds_read_b64_tr_b16 a[120:121], v13
    ds_read_b64_tr_b16 a[122:123], v13 offset:1024
    ds_read_b64_tr_b16 a[124:125], v13 offset:16384
    ds_read_b64_tr_b16 a[126:127], v13 offset:17408
    s_waitcnt lgkmcnt(0)
    s_barrier
    ds_write_b128 v123, v[64:67] offset:32768
    ds_write_b128 v123, v[68:71] offset:33792
    ds_write_b128 v123, v[72:75] offset:34816
    ds_write_b128 v123, v[76:79] offset:35840
    ds_write_b128 v123, v[80:83] offset:36864
    ds_write_b128 v123, v[84:87] offset:37888
    ds_write_b128 v123, v[88:91] offset:38912
    ds_write_b128 v123, v[92:95] offset:39936
    s_waitcnt vmcnt(8)
    s_barrier
    v_xor_b32 v13, 0x0, v12
    v_add_u32 v13, 0x10000, v13
    ds_read_b64_tr_b16 v[32:33], v13
    ds_read_b64_tr_b16 v[34:35], v13 offset:512
    ds_read_b64_tr_b16 v[36:37], v13 offset:2048
    ds_read_b64_tr_b16 v[38:39], v13 offset:2560
    v_xor_b32 v13, 0x2000, v12
    v_add_u32 v13, 0x10000, v13
    ds_read_b64_tr_b16 v[40:41], v13
    ds_read_b64_tr_b16 v[42:43], v13 offset:512
    ds_read_b64_tr_b16 v[44:45], v13 offset:2048
    ds_read_b64_tr_b16 v[46:47], v13 offset:2560
    s_waitcnt lgkmcnt(0)
    v_xor_b32 v13, 0x4000, v12
    v_add_u32 v13, 0x10000, v13
    ds_read_b64_tr_b16 v[48:49], v13
    ds_read_b64_tr_b16 v[50:51], v13 offset:512
    ds_read_b64_tr_b16 v[52:53], v13 offset:2048
    ds_read_b64_tr_b16 v[54:55], v13 offset:2560
    v_xor_b32 v13, 0x6000, v12
    v_add_u32 v13, 0x10000, v13
    ds_read_b64_tr_b16 v[56:57], v13
    ds_read_b64_tr_b16 v[58:59], v13 offset:512
    ds_read_b64_tr_b16 v[60:61], v13 offset:2048
    ds_read_b64_tr_b16 v[62:63], v13 offset:2560
    s_waitcnt lgkmcnt(0)
    s_barrier
    ds_write_b128 v124, v[32:35]
    ds_write_b128 v124, v[36:39] offset:1024
    ds_write_b128 v124, v[40:43] offset:2048
    ds_write_b128 v124, v[44:47] offset:3072
    ds_write_b128 v124, v[48:51] offset:4096
    ds_write_b128 v124, v[52:55] offset:5120
    ds_write_b128 v124, v[56:59] offset:6144
    ds_write_b128 v124, v[60:63] offset:7168
    s_waitcnt vmcnt(0)
    s_barrier
    v_xor_b32 v13, 0x0, v12
    v_add_u32 v13, 0x18000, v13
    ds_read_b64_tr_b16 v[64:65], v13
    ds_read_b64_tr_b16 v[66:67], v13 offset:512
    ds_read_b64_tr_b16 v[68:69], v13 offset:2048
    ds_read_b64_tr_b16 v[70:71], v13 offset:2560
    v_xor_b32 v13, 0x2000, v12
    v_add_u32 v13, 0x18000, v13
    ds_read_b64_tr_b16 v[72:73], v13
    ds_read_b64_tr_b16 v[74:75], v13 offset:512
    ds_read_b64_tr_b16 v[76:77], v13 offset:2048
    ds_read_b64_tr_b16 v[78:79], v13 offset:2560
    s_waitcnt lgkmcnt(0)
    v_xor_b32 v13, 0x4000, v12
    v_add_u32 v13, 0x18000, v13
    ds_read_b64_tr_b16 v[80:81], v13
    ds_read_b64_tr_b16 v[82:83], v13 offset:512
    ds_read_b64_tr_b16 v[84:85], v13 offset:2048
    ds_read_b64_tr_b16 v[86:87], v13 offset:2560
    v_xor_b32 v13, 0x6000, v12
    v_add_u32 v13, 0x18000, v13
    ds_read_b64_tr_b16 v[88:89], v13
    ds_read_b64_tr_b16 v[90:91], v13 offset:512
    ds_read_b64_tr_b16 v[92:93], v13 offset:2048
    ds_read_b64_tr_b16 v[94:95], v13 offset:2560
    s_waitcnt lgkmcnt(0)
    s_barrier
    ds_write_b128 v124, v[64:67] offset:32768
    ds_write_b128 v124, v[68:71] offset:33792
    ds_write_b128 v124, v[72:75] offset:34816
    ds_write_b128 v124, v[76:79] offset:35840
    ds_write_b128 v124, v[80:83] offset:36864
    ds_write_b128 v124, v[84:87] offset:37888
    ds_write_b128 v124, v[88:91] offset:38912
    ds_write_b128 v124, v[92:95] offset:39936
    s_waitcnt lgkmcnt(0)
    v_lshrrev_b32 v1, 4, v117
    v_and_b32 v2, 15, v1
    v_lshrrev_b32 v1, 4, v1
    v_lshlrev_b32 v1, 11, v1
    v_lshl_add_u32 v1, v2, 2, v1
    s_lshl_b32 s43, s20, 6
    s_add_u32 s43, s43, 0x2000
    s_cmp_lg_u32 s100, 0
    s_cbranch_scc1 L_polls_52
    s_mov_b32 exec_lo, 0x10001
    s_mov_b32 exec_hi, 0
    s_mov_b32 s96, 0
L_poll_50:
    buffer_load_dword v2, v1, s[8:11], s43 offen sc1
    s_waitcnt vmcnt(0)
    v_cmp_gt_u32 vcc, 1, v2
    s_cbranch_vccz L_polld_51
    s_sleep 4
    s_add_u32 s96, s96, 1
    s_cmp_lt_u32 s96, 0x10000
    s_cbranch_scc1 L_poll_50
L_polld_51:
    s_mov_b64 exec, -1
L_polls_52:
    s_barrier
    s_mov_b32 s22, 0
    s_mov_b32 s33, 0
    s_xor_b32 s53, s29, 1024
    s_add_u32 s23, s51, 0x7010000
    s_add_u32 s48, s23, 4096
    s_mov_b32 s24, 0x7012000
    s_add_u32 s55, s24, 16384
    s_mov_b32 s25, 0x7100000
    s_mov_b32 s26, 0x7101000
    s_lshl_b32 s43, s20, 13
    v_mov_b32 v112, 0
    v_mov_b32 v113, 0
    v_mov_b32 v114, 0
    v_mov_b32 v115, 0
    s_add_u32 s43, s43, s52
    s_add_u32 s30, s43, 0x1000000
    s_add_u32 s31, s43, 0x2000000
    s_lshr_b32 s43, s43, 1
    s_add_u32 s32, s43, 0x220000
    s_add_u32 m0, s52, 8192
    s_nop 0
    buffer_load_dwordx4 v117, s[8:11], s30 offen lds
    buffer_load_dwordx4 v117, s[8:11], s30 offen offset:1024 lds
    s_add_u32 m0, s52, 0x6000
    s_nop 0
    buffer_load_dwordx4 v117, s[8:11], s31 offen lds
    buffer_load_dwordx4 v117, s[8:11], s31 offen offset:1024 lds
    s_add_u32 m0, s51, 4096
    ds_write_b128 v117, v[112:115] offset:22528
    ds_write_b128 v117, v[112:115] offset:23552
    s_cmp_lg_u32 s21, 0
    s_cselect_b32 s40, -1, 0
    v_mov_b32 v126, s40
    v_bfe_u32 v1, v117, 4, 1
    v_lshlrev_b32 v1, 4, v1
    s_movk_i32 s43, 0x3f80
    v_lshlrev_b32 v125, v1, s43
    v_bfe_u32 v1, v117, 5, 3
    v_cmp_eq_u32 s[68:69], 0, v1
    v_cmp_eq_u32 s[70:71], 1, v1
    v_cmp_eq_u32 s[72:73], 2, v1
    v_cmp_eq_u32 s[74:75], 3, v1
    v_lshrrev_b32 v1, 2, v117
    s_cmp_lt_u32 s21, 2
    s_cselect_b64 vcc, -1, 0
    v_cndmask_b32 v119, v119, v1, vcc
    v_mov_b32 v32, 0
    v_mov_b32 v33, 0
    v_mov_b32 v34, 0
    v_mov_b32 v35, 0
    v_mov_b32 v36, 0
    v_mov_b32 v37, 0
    v_mov_b32 v38, 0
    v_mov_b32 v39, 0
    v_mov_b32 v40, 0
    v_mov_b32 v41, 0
    v_mov_b32 v42, 0
    v_mov_b32 v43, 0
    v_mov_b32 v44, 0
    v_mov_b32 v45, 0
    v_mov_b32 v46, 0
    v_mov_b32 v47, 0
    v_mov_b32 v48, 0
    v_mov_b32 v49, 0
    v_mov_b32 v50, 0
    v_mov_b32 v51, 0
    v_mov_b32 v52, 0
    v_mov_b32 v53, 0
    v_mov_b32 v54, 0
    v_mov_b32 v55, 0
    s_add_u32 s30, s30, 0x40000
    s_add_u32 s31, s31, 0x40000
    s_mov_b32 s45, 0
    s_mov_b32 s46, 0
    s_mov_b32 s47, 0
    s_mov_b32 s76, 0
    s_and_b32 s43, s21, 1
    s_lshl_b32 s43, s43, 5
    s_add_u32 s43, s43, s20
    s_lshl_b32 s43, s43, 6
    s_add_u32 s28, s43, 0x2000
    s_mov_b32 s59, 0
    ds_read_b128 v[80:83], v123
    ds_read_b128 v[84:87], v123 offset:1024
    ds_read_b128 v[56:59], v123 offset:2048
    ds_read_b128 v[60:63], v123 offset:3072
    ds_read_b128 v[64:67], v123 offset:32768
    ds_read_b128 v[68:71], v123 offset:33792
    ds_read_b128 v[72:75], v123 offset:34816
    ds_read_b128 v[76:79], v123 offset:35840
    ds_read_b128 v[88:91], v123 offset:4096
    ds_read_b128 v[92:95], v123 offset:5120
    ds_read_b128 v[96:99], v123 offset:6144
    ds_read_b128 v[100:103], v123 offset:7168
    ds_read_b128 v[104:107], v123 offset:36864
    ds_read_b128 v[108:111], v123 offset:37888
    ds_read_b128 v[24:27], v123 offset:38912
    ds_read_b128 v[28:31], v123 offset:39936
    s_cmp_lg_u32 s21, 0
    s_cbranch_scc1 L_cb_skip_53
    v_mov_b32 v1, 8
    s_mov_b64 exec, 1
    s_mov_b32 s49, 0
L_cb_poll_54:
    buffer_load_dword v3, v1, s[16:19], 0 offen sc1
    s_waitcnt vmcnt(0)
    v_readfirstlane_b32 s43, v3
    s_nop 0
    s_cmp_ge_u32 s43, 32
    s_cbranch_scc1 L_cb_done_55
    s_sleep 2
    s_add_u32 s49, s49, 1
    s_cmp_lt_u32 s49, 0x40000
    s_cbranch_scc1 L_cb_poll_54
L_cb_done_55:
    s_mov_b64 exec, -1
L_cb_skip_53:
    s_mov_b32 s49, 0
    s_lshr_b32 s43, s20, 1
    s_lshl_b32 s43, s43, 7
    s_and_b32 s40, s20, 1
    s_lshl_b32 s40, s40, 4
    s_add_u32 s43, s43, s40
    s_add_u32 s44, s43, 0x1000
    s_cmp_eq_u32 s21, 0
    s_cselect_b32 s44, s44, 0x7ff00000
    s_waitcnt vmcnt(0) lgkmcnt(0)
    s_barrier
    buffer_load_dwordx4 v[0:3], v117, s[8:11], s23 offen sc1
    s_waitcnt vmcnt(0) lgkmcnt(0)
    s_cmp_eq_u32 s21, 1
    s_cbranch_scc1 L_chain_top1_s
    s_cmp_eq_u32 s21, 2
    s_cbranch_scc1 L_chain_top2_s
    s_cmp_eq_u32 s21, 3
    s_cbranch_scc1 L_chain_top3_s
.p2align 6
L_chain_top0_s:
    buffer_load_dwordx4 v[0:3], v117, s[8:11], s23 offen sc1
    v_mov_b32 v15, 0
    v_mov_b32 v15, 0
    v_mov_b32 v15, 0
    v_mov_b32 v15, 0
    v_mov_b32 v15, 0
    v_mov_b32 v15, 0
    v_mov_b32 v15, 0
    v_mov_b32 v15, 0
    v_mov_b32 v15, 0
    v_mov_b32 v15, 0
    v_mov_b32 v15, 0
    v_mov_b32 v15, 0
    v_mov_b32 v15, 0
    v_mov_b32 v15, 0
    v_mov_b32 v15, 0
    v_mov_b32 v15, 0
    buffer_load_dwordx4 v[0:3], v117, s[8:11], s23 offen sc1
    v_mov_b32 v15, 0
    v_mov_b32 v15, 0
    v_mov_b32 v15, 0
    v_mov_b32 v15, 0
    v_mov_b32 v15, 0
    v_mov_b32 v15, 0
    v_mov_b32 v15, 0
    v_mov_b32 v15, 0
    v_mov_b32 v15, 0
    v_mov_b32 v15, 0
    v_mov_b32 v15, 0
    v_mov_b32 v15, 0
    v_mov_b32 v15, 0
    v_mov_b32 v15, 0
    v_mov_b32 v15, 0
    v_mov_b32 v15, 0
L_mret_56:
    buffer_load_dwordx4 v[0:3], v117, s[8:11], s23 offen sc1
    s_add_u32 s45, s45, 1
    s_cmp_lt_u32 s45, 0x10000
    s_cselect_b32 s56, -2, -1
    s_nop 3
    v_mov_b32 v32, 0
    v_mov_b32 v33, 0
    v_mov_b32 v34, 0
    v_mov_b32 v35, 0
    s_waitcnt vmcnt(2)
    v_max3_u32 v15, v0, v1, v2
    v_max_u32 v15, v15, v3
    v_cmp_lt_u32 vcc, s56, v15
    v_smfmac_f32_16x16x64_bf16 v[32:35], v[0:3], v[80:87], v116
    s_cbranch_vccnz L_mret_56
    ds_write_b128 v117, v[0:3]
    v_smfmac_f32_16x16x64_bf16 v[36:39], v[0:3], v[56:63], v116
    buffer_load_dwordx4 v[4:7], v117, s[8:11], s48 offen sc1
    v_smfmac_f32_16x16x64_bf16 v[40:43], v[0:3], v[64:71], v116
    buffer_load_dwordx4 v117, s[8:11], s48 offen sc1 lds
    s_mov_b32 m0, 8192
    v_smfmac_f32_16x16x64_bf16 v[44:47], v[0:3], v[72:79], v116
    s_waitcnt lgkmcnt(0)
    s_barrier
    ds_read_b128 v[8:11], v117 offset:1024
    v_smfmac_f32_16x16x64_bf16 v[48:51], v[0:3], a[192:199], v116
    ds_read_b128 v[16:19], v117 offset:2048
    ds_read_b128 v[20:23], v117 offset:3072
    v_smfmac_f32_16x16x64_bf16 v[52:55], v[0:3], a[200:207], v116
    ds_read_b128 v[80:83], v117 offset:14336
    s_waitcnt lgkmcnt(3)
    v_smfmac_f32_16x16x64_bf16 v[32:35], v[8:11], a[0:7], v116
    ds_read_b128 v[84:87], v117 offset:15360
    v_smfmac_f32_16x16x64_bf16 v[36:39], v[8:11], a[8:15], v116
    buffer_store_dwordx4 v[112:115], v117, s[8:11], s32 offen sc1
    s_waitcnt lgkmcnt(3)
    v_smfmac_f32_16x16x64_bf16 v[32:35], v[16:19], a[32:39], v116
    ds_read_b128 v[56:59], v117 offset:8192
    v_smfmac_f32_16x16x64_bf16 v[36:39], v[16:19], a[40:47], v116
    ds_read_b128 v[60:63], v117 offset:9216
    s_waitcnt lgkmcnt(4)
    v_smfmac_f32_16x16x64_bf16 v[32:35], v[20:23], a[64:71], v116
    ds_read_b128 v[64:67], v117 offset:10240
    v_smfmac_f32_16x16x64_bf16 v[36:39], v[20:23], a[72:79], v116
    ds_read_b128 v[68:71], v117 offset:11264
    v_smfmac_f32_16x16x64_bf16 v[40:43], v[8:11], a[96:103], v116
    ds_read_b128 v[72:75], v117 offset:12288
    v_smfmac_f32_16x16x64_bf16 v[40:43], v[16:19], a[128:135], v116
    ds_read_b128 v[76:79], v117 offset:13312
    v_smfmac_f32_16x16x64_bf16 v[40:43], v[20:23], a[160:167], v116
    s_waitcnt vmcnt(2)
    v_max3_u32 v15, v4, v5, v6
    v_smfmac_f32_16x16x64_bf16 v[44:47], v[8:11], a[104:111], v116
    v_max_u32 v15, v15, v7
    v_smfmac_f32_16x16x64_bf16 v[44:47], v[16:19], a[136:143], v116
    s_waitcnt vmcnt(1) lgkmcnt(0)
    v_cmp_lt_u32 vcc, s56, v15
    v_smfmac_f32_16x16x64_bf16 v[44:47], v[20:23], a[168:175], v116
    s_cbranch_vccnz L_mret_57
L_mgo_58:
    v_smfmac_f32_16x16x64_bf16 v[44:47], v[4:7], v[24:31], v116
    s_barrier
    ds_read_b128 v[12:15], v117 offset:5120
    v_smfmac_f32_16x16x64_bf16 v[32:35], v[4:7], v[88:95], v116
    ds_read_b128 v[24:27], v117 offset:6144
    v_smfmac_f32_16x16x64_bf16 v[36:39], v[4:7], v[96:103], v116
    ds_read_b128 v[28:31], v117 offset:7168
    v_smfmac_f32_16x16x64_bf16 v[40:43], v[4:7], v[104:111], v116
    ds_read_b128 v[88:91], v117 offset:24576
    s_waitcnt lgkmcnt(3)
    v_smfmac_f32_16x16x64_bf16 v[32:35], v[12:15], a[16:23], v116
    ds_read_b128 v[92:95], v117 offset:25600
    s_waitcnt lgkmcnt(3)
    v_smfmac_f32_16x16x64_bf16 v[32:35], v[24:27], a[48:55], v116
    buffer_load_dwordx4 v117, s[8:11], s30 offen lds
    s_waitcnt lgkmcnt(2)
    v_smfmac_f32_16x16x64_bf16 v[32:35], v[28:31], a[80:87], v116
    ds_read_b128 v[96:99], v117 offset:23552
    v_smfmac_f32_16x16x64_bf16 v[36:39], v[12:15], a[24:31], v116
    ds_read_b128 v[100:103], v117 offset:23552
    v_smfmac_f32_16x16x64_bf16 v[36:39], v[24:27], a[56:63], v116
    buffer_load_dwordx4 v117, s[8:11], s30 offen offset:1024 lds
    s_add_u32 m0, s52, 0x6000
    v_add_f32 v32, v32, v34
    v_smfmac_f32_16x16x64_bf16 v[36:39], v[28:31], a[88:95], v116
    ds_read_b128 v[104:107], v117 offset:23552
    v_add_f32 v33, v33, v35
    v_smfmac_f32_16x16x64_bf16 v[40:43], v[12:15], a[112:119], v116
    ds_read_b128 v[108:111], v117 offset:23552
    v_mul_f32 v32, s34, v32
    v_smfmac_f32_16x16x64_bf16 v[40:43], v[24:27], a[144:151], v116
    buffer_load_dword v125, v119, s[8:11], s28 offen sc1
    v_mul_f32 v33, s34, v33
    v_smfmac_f32_16x16x64_bf16 v[40:43], v[28:31], a[176:183], v116
    ds_read_b128 v[0:3], v124
    v_add_f32 v36, v36, v38
    v_smfmac_f32_16x16x64_bf16 v[48:51], v[4:7], a[208:215], v116
    v_add_f32 v37, v37, v39
    v_smfmac_f32_16x16x64_bf16 v[52:55], v[4:7], a[216:223], v116
    s_waitcnt lgkmcnt(5)
    buffer_load_dwordx4 v117, s[8:11], s31 offen lds
    v_mul_f32 v36, s34, v36
    v_smfmac_f32_16x16x64_bf16 v[44:47], v[12:15], a[120:127], v116
    ds_read_b128 v[4:7], v124 offset:1024
    v_mul_f32 v37, s34, v37
    v_smfmac_f32_16x16x64_bf16 v[44:47], v[24:27], a[152:159], v116
    v_cvt_pk_bf16_f32 v34, v32, v36
    v_smfmac_f32_16x16x64_bf16 v[44:47], v[28:31], a[184:191], v116
    buffer_load_dwordx4 v117, s[8:11], s31 offen offset:1024 lds
    s_mov_b32 m0, 4096
    v_cvt_pk_bf16_f32 v35, v33, v37
    v_add_f32 v40, v40, v42
    v_smfmac_f32_16x16x64_bf16 v[48:51], v[8:11], a[224:231], v116
    ds_write2_b32 v120, v34, v35 offset0:32 offset1:48
    v_add_f32 v41, v41, v43
    v_smfmac_f32_16x16x64_bf16 v[52:55], v[8:11], a[232:239], v116
    v_add_f32 v44, v44, v46
    v_add_f32 v45, v45, v47
    v_cvt_pk_bf16_f32 v113, v40, v44
    v_cvt_pk_bf16_f32 v115, v41, v45
    v_smfmac_f32_16x16x64_bf16 v[48:51], v[12:15], a[240:247], v116
    ds_write2_b32 v120, v113, v115 offset0:0 offset1:16
    v_smfmac_f32_16x16x64_bf16 v[52:55], v[12:15], a[248:255], v116
    s_cmp_eq_u32 s22, 63
    s_cbranch_scc1 L_chain_last_s
    buffer_store_dword v126, off, s[8:11], s44 sc1
    v_smfmac_f32_16x16x64_bf16 v[48:51], v[16:19], v[128:135], v116
    v_smfmac_f32_16x16x64_bf16 v[48:51], v[20:23], v[160:167], v116
    v_smfmac_f32_16x16x64_bf16 v[48:51], v[24:27], v[144:151], v116
    s_waitcnt lgkmcnt(0)
    s_barrier
    v_smfmac_f32_16x16x64_bf16 v[48:51], v[28:31], v[176:183], v116
    ds_read_b128 v[32:35], v121 offset:16384
    ds_read_b128 v[36:39], v121 offset:17408
    v_smfmac_f32_16x16x64_bf16 v[52:55], v[16:19], v[136:143], v116
    ds_read_b128 v[40:43], v121 offset:18432
    ds_read_b128 v[44:47], v121 offset:19456
    v_smfmac_f32_16x16x64_bf16 v[52:55], v[20:23], v[168:175], v116
    ds_read_b128 v[8:11], v124 offset:32768
    v_add_f32 v48, v48, v50
    v_smfmac_f32_16x16x64_bf16 v[52:55], v[24:27], v[152:159], v116
    ds_read_b128 v[12:15], v124 offset:33792
    v_add_f32 v49, v49, v51
    v_smfmac_f32_16x16x64_bf16 v[52:55], v[28:31], v[184:191], v116
    s_waitcnt lgkmcnt(5)
    v_cvt_pk_bf16_f32 v112, v48, v49
    v_mfma_f32_16x16x32_bf16 v[56:59], v[56:59], v[32:35], 0
    s_waitcnt lgkmcnt(4)
    v_mov_b32 v48, s50
    v_mov_b32 v49, s50
    v_mfma_f32_16x16x32_bf16 v[56:59], v[60:63], v[36:39], v[56:59]
    ds_read_b128 v[16:19], v124 offset:2048
    s_waitcnt lgkmcnt(4)
    v_mov_b32 v50, s50
    v_mov_b32 v51, s50
    v_mfma_f32_16x16x32_bf16 v[56:59], v[64:67], v[40:43], v[56:59]
    ds_read_b128 v[20:23], v124 offset:3072
    s_waitcnt lgkmcnt(4)
    v_add_f32 v52, v52, v54
    v_mfma_f32_16x16x32_bf16 v[56:59], v[68:71], v[44:47], v[56:59]
    ds_read_b128 v[24:27], v124 offset:4096
    v_add_f32 v53, v53, v55
    v_mfma_f32_16x16x32_bf16 v[60:63], v[72:75], v[32:35], 0
    ds_read_b128 v[28:31], v124 offset:5120
    v_cvt_pk_bf16_f32 v114, v52, v53
    v_mov_b32 v53, 0
    v_mfma_f32_16x16x32_bf16 v[60:63], v[76:79], v[36:39], v[60:63]
    v_exp_f32 v56, v56
    v_mfma_f32_16x16x32_bf16 v[60:63], v[80:83], v[40:43], v[60:63]
    v_exp_f32 v57, v57
    v_mfma_f32_16x16x32_bf16 v[60:63], v[84:87], v[44:47], v[60:63]
    v_exp_f32 v58, v58
    v_mfma_f32_16x16x32_bf16 v[64:67], v[32:35], v[32:35], 0
    v_exp_f32 v59, v59
    v_cvt_pk_bf16_f32 v68, v56, v57
    v_mfma_f32_16x16x32_bf16 v[64:67], v[36:39], v[36:39], v[64:67]
    v_exp_f32 v60, v60
    v_cvt_pk_bf16_f32 v69, v58, v59
    v_mfma_f32_16x16x32_bf16 v[64:67], v[40:43], v[40:43], v[64:67]
    v_exp_f32 v61, v61
    v_mfma_f32_16x16x32_bf16 v[64:67], v[44:47], v[44:47], v[64:67]
    v_exp_f32 v62, v62
    v_exp_f32 v63, v63
    v_cvt_pk_bf16_f32 v70, v60, v61
    v_cvt_pk_bf16_f32 v71, v62, v63
    s_nop 1
    v_mfma_f32_16x16x32_bf16 v[72:75], v[88:91], v[68:71], 0
    s_nop 0
    v_exp_f32 v64, v64
    v_mfma_f32_16x16x32_bf16 v[76:79], v[92:95], v[68:71], 0
    v_exp_f32 v65, v65
    v_mfma_f32_16x16x32_bf16 v[80:83], v[48:51], v[68:71], 0
    v_cvt_pk_bf16_f32 v52, v64, v65
    s_nop 1
    v_mfma_f32_16x16x16_bf16 v[72:75], v[112:113], v[52:53], v[72:75]
    ds_read_b128 v[32:35], v124 offset:6144
    v_mfma_f32_16x16x16_bf16 v[76:79], v[114:115], v[52:53], v[76:79]
    ds_read_b128 v[36:39], v124 offset:7168
    v_mfma_f32_16x16x16_bf16 v[80:83], v[48:49], v[52:53], v[80:83]
L_norm_59:
    s_mov_b64 vcc, s[36:37]
    v_mov_b32 v122, v122
    v_mov_b32 v122, v122
    v_mov_b32 v122, v122
    v_cndmask_b32_dpp v76, v72, v76, vcc quad_perm:[2,3,2,3] row_mask:0xf bank_mask:0xf
    v_cndmask_b32_dpp v77, v73, v77, vcc quad_perm:[2,3,2,3] row_mask:0xf bank_mask:0xf
    v_cndmask_b32_dpp v78, v74, v78, vcc quad_perm:[2,3,2,3] row_mask:0xf bank_mask:0xf
    v_cndmask_b32_dpp v79, v75, v79, vcc quad_perm:[2,3,2,3] row_mask:0xf bank_mask:0xf
    v_rcp_f32_dpp v84, v80 quad_perm:[2,3,2,3] row_mask:0xf bank_mask:0xf
    s_nop 0
    v_pk_mul_f32 v[76:77], v[76:77], v[84:85] op_sel_hi:[1,0]
    v_pk_mul_f32 v[78:79], v[78:79], v[84:85] op_sel_hi:[1,0]
    v_cvt_pk_bf16_f32 v72, v76, v77
    v_cvt_pk_bf16_f32 v73, v78, v79
    ds_write_b64 v122, v[72:73] offset:20480
    v_max_f32_dpp v86, v80, v84 quad_perm:[2,3,2,3] row_mask:0xf bank_mask:0xf
    v_mov_b32_dpp v60, v72 quad_perm:[0,1,0,1] row_mask:0xf bank_mask:0xf
    v_mov_b32_dpp v61, v73 quad_perm:[0,1,0,1] row_mask:0xf bank_mask:0xf
    v_cmp_lt_f32 vcc, s35, v86
    v_mov_b32_dpp v62, v72 quad_perm:[2,3,2,3] row_mask:0xf bank_mask:0xf
    v_mov_b32_dpp v63, v73 quad_perm:[2,3,2,3] row_mask:0xf bank_mask:0xf
    s_nop 1
    v_smfmac_f32_16x16x64_bf16 v[96:99], v[60:63], v[192:199], v116
    s_cbranch_vccnz L_smax_60
    v_smfmac_f32_16x16x64_bf16 v[100:103], v[60:63], v[224:231], v116
    s_waitcnt lgkmcnt(0)
    s_barrier
    ds_read_b128 v[92:95], v127 offset:20992
    ds_read_b128 v[80:83], v127 offset:21504
    ds_read_b128 v[84:87], v127 offset:22016
    v_smfmac_f32_16x16x64_bf16 v[104:107], v[60:63], v[0:7], v116
    ds_read_b128 v[40:43], v124 offset:34816
    v_smfmac_f32_16x16x64_bf16 v[108:111], v[60:63], v[8:15], v116
    ds_read_b128 v[56:59], v124 offset:36864
    s_waitcnt lgkmcnt(4)
    v_smfmac_f32_16x16x64_bf16 v[96:99], v[92:95], v[200:207], v116
    s_waitcnt lgkmcnt(3)
    v_smfmac_f32_16x16x64_bf16 v[96:99], v[80:83], v[208:215], v116
    ds_read_b128 v[44:47], v124 offset:35840
    s_waitcnt lgkmcnt(3)
    v_smfmac_f32_16x16x64_bf16 v[96:99], v[84:87], v[216:223], v116
    ds_read_b128 v[68:71], v124 offset:39936
    v_smfmac_f32_16x16x64_bf16 v[100:103], v[92:95], v[232:239], v116
    ds_read_b128 v[64:67], v124 offset:38912
    v_smfmac_f32_16x16x64_bf16 v[100:103], v[80:83], v[240:247], v116
    ds_read_b128 v[60:63], v124 offset:37888
    v_cvt_pk_bf16_f32 v72, v96, v98
    v_smfmac_f32_16x16x64_bf16 v[100:103], v[84:87], v[248:255], v116
    v_and_or_b32 v72, v72, -2, s33
    v_smfmac_f32_16x16x64_bf16 v[104:107], v[92:95], v[16:23], v116
    v_cvt_pk_bf16_f32 v74, v97, v99
    v_smfmac_f32_16x16x64_bf16 v[104:107], v[80:83], v[24:31], v116
    v_cvt_pk_bf16_f32 v73, v100, v102
    v_cvt_pk_bf16_f32 v75, v101, v103
    v_smfmac_f32_16x16x64_bf16 v[104:107], v[84:87], v[32:39], v116
    buffer_store_dwordx4 v[72:75], v118, s[8:11], s25 offen sc1
    s_waitcnt lgkmcnt(3)
    v_smfmac_f32_16x16x64_bf16 v[108:111], v[92:95], v[40:47], v116
    s_waitcnt lgkmcnt(0)
    v_smfmac_f32_16x16x64_bf16 v[108:111], v[80:83], v[56:63], v116
    v_cvt_pk_bf16_f32 v76, v104, v106
    v_smfmac_f32_16x16x64_bf16 v[108:111], v[84:87], v[64:71], v116
    v_and_or_b32 v76, v76, -2, s33
    v_cvt_pk_bf16_f32 v78, v105, v107
    v_mov_b32 v122, v122
    v_mov_b32 v122, v122
    v_mov_b32 v122, v122
    v_mov_b32 v122, v122
    v_mov_b32 v122, v122
    v_mov_b32 v122, v122
    v_cvt_pk_bf16_f32 v77, v108, v110
    v_cvt_pk_bf16_f32 v79, v109, v111
    buffer_store_dwordx4 v[76:79], v118, s[8:11], s26 offen sc1
    s_add_u32 s30, s30, 0x40000
    s_add_u32 s31, s31, 0x40000
    s_add_u32 s32, s32, 0x20000
    s_add_u32 s23, s24, 0
    s_add_u32 s48, s23, 4096
    s_xor_b32 s25, s25, 0x40000
    s_xor_b32 s26, s26, 0x40000
    s_mov_b32 s35, 0x49800000
    v_mov_b32 v126, s22
    s_add_u32 s22, s22, 1
    v_mov_b32 v32, 0
    v_mov_b32 v33, 0
    v_mov_b32 v34, 0
    v_mov_b32 v35, 0
    v_mov_b32 v36, 0
    v_mov_b32 v37, 0
    v_mov_b32 v38, 0
    v_mov_b32 v39, 0
    v_mov_b32 v40, 0
    v_mov_b32 v41, 0
    v_mov_b32 v42, 0
    v_mov_b32 v43, 0
    v_mov_b32 v44, 0
    v_mov_b32 v45, 0
    v_mov_b32 v46, 0
    v_mov_b32 v47, 0
    v_mov_b32 v48, 0
    v_mov_b32 v49, 0
    v_mov_b32 v50, 0
    v_mov_b32 v51, 0
    v_mov_b32 v52, 0
    v_mov_b32 v53, 0
    v_mov_b32 v54, 0
    v_mov_b32 v55, 0
    ds_read_b128 v[80:83], v123
    ds_read_b128 v[84:87], v123 offset:1024
    ds_read_b128 v[56:59], v123 offset:2048
    ds_read_b128 v[60:63], v123 offset:3072
    ds_read_b128 v[64:67], v123 offset:32768
    ds_read_b128 v[68:71], v123 offset:33792
    ds_read_b128 v[72:75], v123 offset:34816
    ds_read_b128 v[76:79], v123 offset:35840
    ds_read_b128 v[88:91], v123 offset:4096
    ds_read_b128 v[92:95], v123 offset:5120
    ds_read_b128 v[96:99], v123 offset:6144
    ds_read_b128 v[100:103], v123 offset:7168
    ds_read_b128 v[104:107], v123 offset:36864
    ds_read_b128 v[108:111], v123 offset:37888
    ds_read_b128 v[24:27], v123 offset:38912
    ds_read_b128 v[28:31], v123 offset:39936
    s_add_u32 s24, s24, 8192
    s_bitset0_b32 s24, 15
    s_xor_b32 s55, s24, 16384
    s_xor_b32 s29, s29, 0x40000
    s_xor_b32 s53, s29, 1024
    s_bfe_u32 s33, s22, 0x10001
    s_add_u32 s40, s22, 5
    s_lshr_b32 s40, s40, 2
    s_min_u32 s40, s40, 16
    s_bfm_b32 s58, s40, 0
    s_waitcnt vmcnt(5)
    v_cmp_eq_u32 vcc, 0, v125
    s_nop 0
    s_and_b64 vcc, vcc, s[58:59]
    s_cbranch_scc1 L_kvw_61
L_kvb_62:
    v_mov_b32 v15, 0
    s_nop 2
    v_mov_b32 v15, 0
    s_nop 2
    v_mov_b32 v15, 0
    s_nop 2
    v_mov_b32 v15, 0
    s_nop 2
    v_mov_b32 v15, 0
    s_nop 2
    v_mov_b32 v15, 0
    s_nop 2
    v_mov_b32 v15, 0
    s_nop 2
    v_mov_b32 v15, 0
    s_nop 2
    v_mov_b32 v15, 0
    s_nop 2
    v_mov_b32 v15, 0
    s_nop 2
    v_mov_b32 v15, 0
    s_nop 2
    v_mov_b32 v15, 0
    s_nop 2
    v_mov_b32 v15, 0
    s_nop 2
    v_mov_b32 v15, 0
    s_nop 2
    v_mov_b32 v15, 0
    s_nop 2
    v_mov_b32 v15, 0
    s_nop 2
    v_mov_b32 v15, 0
    s_nop 2
    v_mov_b32 v15, 0
    s_nop 2
    v_mov_b32 v15, 0
    s_nop 2
    v_mov_b32 v15, 0
    s_nop 2
    v_mov_b32 v15, 0
    s_nop 2
    v_mov_b32 v15, 0
    s_nop 2
    v_mov_b32 v15, 0
    s_nop 2
    v_mov_b32 v15, 0
    s_nop 2
    v_mov_b32 v15, 0
    s_nop 2
    v_mov_b32 v15, 0
    s_nop 2
    v_mov_b32 v15, 0
    s_nop 2
    v_mov_b32 v15, 0
    s_nop 2
    v_mov_b32 v15, 0
    s_nop 2
    v_mov_b32 v15, 0
    s_nop 2
    v_mov_b32 v15, 0
    s_nop 2
    s_waitcnt lgkmcnt(0)
    s_branch L_chain_top0_s
.p2align 6
L_chain_top1_s:
    buffer_load_dwordx4 v[0:3], v117, s[8:11], s23 offen sc1
    v_mov_b32 v15, 0
    v_mov_b32 v15, 0
    v_mov_b32 v15, 0
    v_mov_b32 v15, 0
    v_mov_b32 v15, 0
    v_mov_b32 v15, 0
    v_mov_b32 v15, 0
    v_mov_b32 v15, 0
    v_mov_b32 v15, 0
    v_mov_b32 v15, 0
    v_mov_b32 v15, 0
    v_mov_b32 v15, 0
    v_mov_b32 v15, 0
    v_mov_b32 v15, 0
    v_mov_b32 v15, 0
    v_mov_b32 v15, 0
    buffer_load_dwordx4 v[0:3], v117, s[8:11], s23 offen sc1
    v_mov_b32 v15, 0
    v_mov_b32 v15, 0
    v_mov_b32 v15, 0
    v_mov_b32 v15, 0
    v_mov_b32 v15, 0
    v_mov_b32 v15, 0
    v_mov_b32 v15, 0
    v_mov_b32 v15, 0
    v_mov_b32 v15, 0
    v_mov_b32 v15, 0
    v_mov_b32 v15, 0
    v_mov_b32 v15, 0
    v_mov_b32 v15, 0
    v_mov_b32 v15, 0
    v_mov_b32 v15, 0
    v_mov_b32 v15, 0
L_mret_63:
    buffer_load_dwordx4 v[0:3], v117, s[8:11], s23 offen sc1
    s_add_u32 s45, s45, 1
    s_cmp_lt_u32 s45, 0x10000
    s_cselect_b32 s56, -2, -1
    s_nop 3
    v_mov_b32 v32, 0
    v_mov_b32 v33, 0
    v_mov_b32 v34, 0
    v_mov_b32 v35, 0
    s_waitcnt vmcnt(2)
    v_max3_u32 v15, v0, v1, v2
    v_max_u32 v15, v15, v3
    v_cmp_lt_u32 vcc, s56, v15
    v_smfmac_f32_16x16x64_bf16 v[32:35], v[0:3], v[80:87], v116
    s_cbranch_vccnz L_mret_63
    ds_write_b128 v117, v[0:3] offset:1024
    v_smfmac_f32_16x16x64_bf16 v[36:39], v[0:3], v[56:63], v116
    buffer_load_dwordx4 v[4:7], v117, s[8:11], s48 offen sc1
    v_smfmac_f32_16x16x64_bf16 v[40:43], v[0:3], v[64:71], v116
    buffer_load_dwordx4 v117, s[8:11], s48 offen sc1 lds
    s_mov_b32 m0, 10240
    v_smfmac_f32_16x16x64_bf16 v[44:47], v[0:3], v[72:79], v116
    s_waitcnt lgkmcnt(0)
    s_barrier
    ds_read_b128 v[8:11], v117
    v_smfmac_f32_16x16x64_bf16 v[48:51], v[0:3], a[192:199], v116
    ds_read_b128 v[16:19], v117 offset:3072
    ds_read_b128 v[20:23], v117 offset:2048
    v_smfmac_f32_16x16x64_bf16 v[52:55], v[0:3], a[200:207], v116
    ds_read_b128 v[80:83], v117 offset:14336
    s_waitcnt lgkmcnt(3)
    v_smfmac_f32_16x16x64_bf16 v[32:35], v[8:11], a[0:7], v116
    ds_read_b128 v[84:87], v117 offset:15360
    v_smfmac_f32_16x16x64_bf16 v[36:39], v[8:11], a[8:15], v116
    ds_read_b128 v[56:59], v117 offset:8192
    s_waitcnt lgkmcnt(4)
    v_smfmac_f32_16x16x64_bf16 v[32:35], v[16:19], a[32:39], v116
    ds_read_b128 v[60:63], v117 offset:9216
    v_smfmac_f32_16x16x64_bf16 v[36:39], v[16:19], a[40:47], v116
    buffer_store_dwordx4 v[112:115], v117, s[8:11], s32 offen sc1
    s_waitcnt lgkmcnt(4)
    v_smfmac_f32_16x16x64_bf16 v[32:35], v[20:23], a[64:71], v116
    ds_read_b128 v[64:67], v117 offset:10240
    v_smfmac_f32_16x16x64_bf16 v[36:39], v[20:23], a[72:79], v116
    ds_read_b128 v[68:71], v117 offset:11264
    v_smfmac_f32_16x16x64_bf16 v[40:43], v[8:11], a[96:103], v116
    ds_read_b128 v[72:75], v117 offset:12288
    v_smfmac_f32_16x16x64_bf16 v[40:43], v[16:19], a[128:135], v116
    ds_read_b128 v[76:79], v117 offset:13312
    v_smfmac_f32_16x16x64_bf16 v[40:43], v[20:23], a[160:167], v116
    s_waitcnt vmcnt(2)
    v_max3_u32 v15, v4, v5, v6
    v_smfmac_f32_16x16x64_bf16 v[44:47], v[8:11], a[104:111], v116
    v_max_u32 v15, v15, v7
    v_smfmac_f32_16x16x64_bf16 v[44:47], v[16:19], a[136:143], v116
    s_waitcnt vmcnt(1) lgkmcnt(0)
    v_cmp_lt_u32 vcc, s56, v15
    v_smfmac_f32_16x16x64_bf16 v[44:47], v[20:23], a[168:175], v116
    s_cbranch_vccnz L_mret_64
L_mgo_65:
    v_smfmac_f32_16x16x64_bf16 v[44:47], v[4:7], v[24:31], v116
    s_barrier
    ds_read_b128 v[12:15], v117 offset:4096
    v_smfmac_f32_16x16x64_bf16 v[32:35], v[4:7], v[88:95], v116
    ds_read_b128 v[24:27], v117 offset:7168
    v_smfmac_f32_16x16x64_bf16 v[36:39], v[4:7], v[96:103], v116
    ds_read_b128 v[28:31], v117 offset:6144
    v_smfmac_f32_16x16x64_bf16 v[40:43], v[4:7], v[104:111], v116
    ds_read_b128 v[88:91], v117 offset:26624
    s_waitcnt lgkmcnt(3)
    v_smfmac_f32_16x16x64_bf16 v[32:35], v[12:15], a[16:23], v116
    ds_read_b128 v[92:95], v117 offset:27648
    s_waitcnt lgkmcnt(3)
    v_smfmac_f32_16x16x64_bf16 v[32:35], v[24:27], a[48:55], v116
    buffer_load_dwordx4 v117, s[8:11], s30 offen lds
    s_waitcnt lgkmcnt(2)
    v_smfmac_f32_16x16x64_bf16 v[32:35], v[28:31], a[80:87], v116
    ds_read_b128 v[96:99], v117 offset:23552
    v_smfmac_f32_16x16x64_bf16 v[36:39], v[12:15], a[24:31], v116
    ds_read_b128 v[100:103], v117 offset:23552
    v_smfmac_f32_16x16x64_bf16 v[36:39], v[24:27], a[56:63], v116
    buffer_load_dwordx4 v117, s[8:11], s30 offen offset:1024 lds
    s_add_u32 m0, s52, 0x6000
    v_add_f32 v32, v32, v34
    v_smfmac_f32_16x16x64_bf16 v[36:39], v[28:31], a[88:95], v116
    ds_read_b128 v[104:107], v117 offset:23552
    v_add_f32 v33, v33, v35
    v_smfmac_f32_16x16x64_bf16 v[40:43], v[12:15], a[112:119], v116
    ds_read_b128 v[108:111], v117 offset:23552
    v_mul_f32 v32, s34, v32
    v_smfmac_f32_16x16x64_bf16 v[40:43], v[24:27], a[144:151], v116
    buffer_load_dword v125, v119, s[8:11], s28 offen sc1
    v_mul_f32 v33, s34, v33
    v_smfmac_f32_16x16x64_bf16 v[40:43], v[28:31], a[176:183], v116
    ds_read_b128 v[0:3], v124
    v_add_f32 v36, v36, v38
    v_smfmac_f32_16x16x64_bf16 v[48:51], v[4:7], a[208:215], v116
    v_add_f32 v37, v37, v39
    v_smfmac_f32_16x16x64_bf16 v[52:55], v[4:7], a[216:223], v116
    s_waitcnt lgkmcnt(5)
    buffer_load_dwordx4 v117, s[8:11], s31 offen lds
    v_mul_f32 v36, s34, v36
    v_smfmac_f32_16x16x64_bf16 v[44:47], v[12:15], a[120:127], v116
    ds_read_b128 v[4:7], v124 offset:1024
    v_mul_f32 v37, s34, v37
    v_smfmac_f32_16x16x64_bf16 v[44:47], v[24:27], a[152:159], v116
    v_cvt_pk_bf16_f32 v34, v32, v36
    v_smfmac_f32_16x16x64_bf16 v[44:47], v[28:31], a[184:191], v116
    buffer_load_dwordx4 v117, s[8:11], s31 offen offset:1024 lds
    s_mov_b32 m0, 5120
    v_cvt_pk_bf16_f32 v35, v33, v37
    v_add_f32 v40, v40, v42
    v_smfmac_f32_16x16x64_bf16 v[48:51], v[8:11], a[224:231], v116
    ds_write2_b32 v120, v34, v35 offset0:32 offset1:48
    v_add_f32 v41, v41, v43
    v_smfmac_f32_16x16x64_bf16 v[52:55], v[8:11], a[232:239], v116
    v_add_f32 v44, v44, v46
    v_add_f32 v45, v45, v47
    v_cvt_pk_bf16_f32 v113, v40, v44
    v_cvt_pk_bf16_f32 v115, v41, v45
    v_smfmac_f32_16x16x64_bf16 v[48:51], v[12:15], a[240:247], v116
    ds_write2_b32 v120, v113, v115 offset0:0 offset1:16
    v_smfmac_f32_16x16x64_bf16 v[52:55], v[12:15], a[248:255], v116
    s_cmp_eq_u32 s22, 63
    s_cbranch_scc1 L_chain_last_s
    v_smfmac_f32_16x16x64_bf16 v[48:51], v[16:19], v[128:135], v116
    v_smfmac_f32_16x16x64_bf16 v[48:51], v[20:23], v[160:167], v116
    v_smfmac_f32_16x16x64_bf16 v[48:51], v[24:27], v[144:151], v116
    s_waitcnt lgkmcnt(0)
    s_barrier
    v_smfmac_f32_16x16x64_bf16 v[48:51], v[28:31], v[176:183], v116
    ds_read_b128 v[32:35], v121 offset:16384
    ds_read_b128 v[36:39], v121 offset:17408
    v_smfmac_f32_16x16x64_bf16 v[52:55], v[16:19], v[136:143], v116
    ds_read_b128 v[40:43], v121 offset:18432
    ds_read_b128 v[44:47], v121 offset:19456
    v_smfmac_f32_16x16x64_bf16 v[52:55], v[20:23], v[168:175], v116
    ds_read_b128 v[8:11], v124 offset:32768
    v_add_f32 v48, v48, v50
    v_smfmac_f32_16x16x64_bf16 v[52:55], v[24:27], v[152:159], v116
    ds_read_b128 v[12:15], v124 offset:33792
    v_add_f32 v49, v49, v51
    v_smfmac_f32_16x16x64_bf16 v[52:55], v[28:31], v[184:191], v116
    s_waitcnt lgkmcnt(5)
    v_cvt_pk_bf16_f32 v112, v48, v49
    v_mfma_f32_16x16x32_bf16 v[56:59], v[56:59], v[32:35], 0
    s_waitcnt lgkmcnt(4)
    v_mov_b32 v48, s50
    v_mov_b32 v49, s50
    v_mfma_f32_16x16x32_bf16 v[56:59], v[60:63], v[36:39], v[56:59]
    ds_read_b128 v[16:19], v124 offset:2048
    s_waitcnt lgkmcnt(4)
    v_mov_b32 v50, s50
    v_mov_b32 v51, s50
    v_mfma_f32_16x16x32_bf16 v[56:59], v[64:67], v[40:43], v[56:59]
    ds_read_b128 v[20:23], v124 offset:3072
    s_waitcnt lgkmcnt(4)
    v_add_f32 v52, v52, v54
    v_mfma_f32_16x16x32_bf16 v[56:59], v[68:71], v[44:47], v[56:59]
    ds_read_b128 v[24:27], v124 offset:4096
    v_add_f32 v53, v53, v55
    v_mfma_f32_16x16x32_bf16 v[60:63], v[72:75], v[32:35], 0
    ds_read_b128 v[28:31], v124 offset:5120
    v_cvt_pk_bf16_f32 v114, v52, v53
    v_mov_b32 v53, 0
    v_mfma_f32_16x16x32_bf16 v[60:63], v[76:79], v[36:39], v[60:63]
    v_exp_f32 v56, v56
    v_mfma_f32_16x16x32_bf16 v[60:63], v[80:83], v[40:43], v[60:63]
    v_exp_f32 v57, v57
    v_mfma_f32_16x16x32_bf16 v[60:63], v[84:87], v[44:47], v[60:63]
    v_exp_f32 v58, v58
    v_mfma_f32_16x16x32_bf16 v[64:67], v[32:35], v[32:35], 0
    v_exp_f32 v59, v59
    v_cvt_pk_bf16_f32 v68, v56, v57
    v_mfma_f32_16x16x32_bf16 v[64:67], v[36:39], v[36:39], v[64:67]
    v_exp_f32 v60, v60
    v_cvt_pk_bf16_f32 v69, v58, v59
    v_mfma_f32_16x16x32_bf16 v[64:67], v[40:43], v[40:43], v[64:67]
    v_exp_f32 v61, v61
    v_mfma_f32_16x16x32_bf16 v[64:67], v[44:47], v[44:47], v[64:67]
    v_exp_f32 v62, v62
    v_exp_f32 v63, v63
    v_cvt_pk_bf16_f32 v70, v60, v61
    v_cvt_pk_bf16_f32 v71, v62, v63
    s_nop 1
    v_mfma_f32_16x16x32_bf16 v[72:75], v[88:91], v[68:71], 0
    s_nop 0
    v_exp_f32 v64, v64
    v_mfma_f32_16x16x32_bf16 v[76:79], v[92:95], v[68:71], 0
    v_exp_f32 v65, v65
    v_mfma_f32_16x16x32_bf16 v[80:83], v[48:51], v[68:71], 0
    v_cvt_pk_bf16_f32 v52, v64, v65
    s_nop 1
    v_mfma_f32_16x16x16_bf16 v[72:75], v[112:113], v[52:53], v[72:75]
    ds_read_b128 v[32:35], v124 offset:6144
    v_mfma_f32_16x16x16_bf16 v[76:79], v[114:115], v[52:53], v[76:79]
    ds_read_b128 v[36:39], v124 offset:7168
    v_mfma_f32_16x16x16_bf16 v[80:83], v[48:49], v[52:53], v[80:83]
L_norm_66:
    s_mov_b64 vcc, s[36:37]
    v_mov_b32 v122, v122
    v_mov_b32 v122, v122
    v_mov_b32 v122, v122
    v_cndmask_b32_dpp v76, v72, v76, vcc quad_perm:[2,3,2,3] row_mask:0xf bank_mask:0xf
    v_cndmask_b32_dpp v77, v73, v77, vcc quad_perm:[2,3,2,3] row_mask:0xf bank_mask:0xf
    v_cndmask_b32_dpp v78, v74, v78, vcc quad_perm:[2,3,2,3] row_mask:0xf bank_mask:0xf
    v_cndmask_b32_dpp v79, v75, v79, vcc quad_perm:[2,3,2,3] row_mask:0xf bank_mask:0xf
    v_rcp_f32_dpp v84, v80 quad_perm:[2,3,2,3] row_mask:0xf bank_mask:0xf
    s_nop 0
    v_pk_mul_f32 v[76:77], v[76:77], v[84:85] op_sel_hi:[1,0]
    v_pk_mul_f32 v[78:79], v[78:79], v[84:85] op_sel_hi:[1,0]
    v_cvt_pk_bf16_f32 v72, v76, v77
    v_cvt_pk_bf16_f32 v73, v78, v79
    ds_write_b64 v122, v[72:73] offset:20992
    v_max_f32_dpp v86, v80, v84 quad_perm:[2,3,2,3] row_mask:0xf bank_mask:0xf
    v_mov_b32_dpp v60, v72 quad_perm:[0,1,0,1] row_mask:0xf bank_mask:0xf
    v_mov_b32_dpp v61, v73 quad_perm:[0,1,0,1] row_mask:0xf bank_mask:0xf
    v_cmp_lt_f32 vcc, s35, v86
    v_mov_b32_dpp v62, v72 quad_perm:[2,3,2,3] row_mask:0xf bank_mask:0xf
    v_mov_b32_dpp v63, v73 quad_perm:[2,3,2,3] row_mask:0xf bank_mask:0xf
    s_nop 1
    v_smfmac_f32_16x16x64_bf16 v[96:99], v[60:63], v[192:199], v116
    s_cbranch_vccnz L_smax_67
    v_smfmac_f32_16x16x64_bf16 v[100:103], v[60:63], v[224:231], v116
    s_waitcnt lgkmcnt(0)
    s_barrier
    ds_read_b128 v[92:95], v127 offset:20480
    ds_read_b128 v[80:83], v127 offset:22016
    ds_read_b128 v[84:87], v127 offset:21504
    v_smfmac_f32_16x16x64_bf16 v[104:107], v[60:63], v[0:7], v116
    ds_read_b128 v[40:43], v124 offset:34816
    v_smfmac_f32_16x16x64_bf16 v[108:111], v[60:63], v[8:15], v116
    ds_read_b128 v[56:59], v124 offset:36864
    s_waitcnt lgkmcnt(4)
    v_smfmac_f32_16x16x64_bf16 v[96:99], v[92:95], v[200:207], v116
    s_waitcnt lgkmcnt(3)
    v_smfmac_f32_16x16x64_bf16 v[96:99], v[80:83], v[208:215], v116
    ds_read_b128 v[44:47], v124 offset:35840
    s_waitcnt lgkmcnt(3)
    v_smfmac_f32_16x16x64_bf16 v[96:99], v[84:87], v[216:223], v116
    ds_read_b128 v[68:71], v124 offset:39936
    v_smfmac_f32_16x16x64_bf16 v[100:103], v[92:95], v[232:239], v116
    ds_read_b128 v[64:67], v124 offset:38912
    v_smfmac_f32_16x16x64_bf16 v[100:103], v[80:83], v[240:247], v116
    ds_read_b128 v[60:63], v124 offset:37888
    v_cvt_pk_bf16_f32 v72, v96, v98
    v_smfmac_f32_16x16x64_bf16 v[100:103], v[84:87], v[248:255], v116
    v_and_or_b32 v72, v72, -2, s33
    v_smfmac_f32_16x16x64_bf16 v[104:107], v[92:95], v[16:23], v116
    v_cvt_pk_bf16_f32 v74, v97, v99
    v_smfmac_f32_16x16x64_bf16 v[104:107], v[80:83], v[24:31], v116
    v_cvt_pk_bf16_f32 v73, v100, v102
    v_cvt_pk_bf16_f32 v75, v101, v103
    v_smfmac_f32_16x16x64_bf16 v[104:107], v[84:87], v[32:39], v116
    buffer_store_dwordx4 v[72:75], v118, s[8:11], s25 offen sc1
    s_waitcnt lgkmcnt(3)
    v_smfmac_f32_16x16x64_bf16 v[108:111], v[92:95], v[40:47], v116
    s_waitcnt lgkmcnt(0)
    v_smfmac_f32_16x16x64_bf16 v[108:111], v[80:83], v[56:63], v116
    v_cvt_pk_bf16_f32 v76, v104, v106
    v_smfmac_f32_16x16x64_bf16 v[108:111], v[84:87], v[64:71], v116
    v_and_or_b32 v76, v76, -2, s33
    v_cvt_pk_bf16_f32 v78, v105, v107
    v_mov_b32 v122, v122
    v_mov_b32 v122, v122
    v_mov_b32 v122, v122
    v_mov_b32 v122, v122
    v_mov_b32 v122, v122
    v_mov_b32 v122, v122
    v_cvt_pk_bf16_f32 v77, v108, v110
    v_cvt_pk_bf16_f32 v79, v109, v111
    buffer_store_dwordx4 v[76:79], v118, s[8:11], s26 offen sc1
    s_add_u32 s30, s30, 0x40000
    s_add_u32 s31, s31, 0x40000
    s_add_u32 s32, s32, 0x20000
    s_add_u32 s23, s24, 1024
    s_add_u32 s48, s23, 4096
    s_xor_b32 s25, s25, 0x40000
    s_xor_b32 s26, s26, 0x40000
    s_mov_b32 s35, 0x49800000
    s_add_u32 s22, s22, 1
    v_mov_b32 v32, 0
    v_mov_b32 v33, 0
    v_mov_b32 v34, 0
    v_mov_b32 v35, 0
    v_mov_b32 v36, 0
    v_mov_b32 v37, 0
    v_mov_b32 v38, 0
    v_mov_b32 v39, 0
    v_mov_b32 v40, 0
    v_mov_b32 v41, 0
    v_mov_b32 v42, 0
    v_mov_b32 v43, 0
    v_mov_b32 v44, 0
    v_mov_b32 v45, 0
    v_mov_b32 v46, 0
    v_mov_b32 v47, 0
    v_mov_b32 v48, 0
    v_mov_b32 v49, 0
    v_mov_b32 v50, 0
    v_mov_b32 v51, 0
    v_mov_b32 v52, 0
    v_mov_b32 v53, 0
    v_mov_b32 v54, 0
    v_mov_b32 v55, 0
    ds_read_b128 v[80:83], v123
    ds_read_b128 v[84:87], v123 offset:1024
    ds_read_b128 v[56:59], v123 offset:2048
    ds_read_b128 v[60:63], v123 offset:3072
    ds_read_b128 v[64:67], v123 offset:32768
    ds_read_b128 v[68:71], v123 offset:33792
    ds_read_b128 v[72:75], v123 offset:34816
    ds_read_b128 v[76:79], v123 offset:35840
    ds_read_b128 v[88:91], v123 offset:4096
    ds_read_b128 v[92:95], v123 offset:5120
    ds_read_b128 v[96:99], v123 offset:6144
    ds_read_b128 v[100:103], v123 offset:7168
    ds_read_b128 v[104:107], v123 offset:36864
    ds_read_b128 v[108:111], v123 offset:37888
    ds_read_b128 v[24:27], v123 offset:38912
    ds_read_b128 v[28:31], v123 offset:39936
    s_add_u32 s24, s24, 8192
    s_bitset0_b32 s24, 15
    s_xor_b32 s55, s24, 16384
    s_xor_b32 s29, s29, 0x40000
    s_xor_b32 s53, s29, 1024
    s_bfe_u32 s33, s22, 0x10001
    s_add_u32 s40, s22, 5
    s_lshr_b32 s40, s40, 2
    s_min_u32 s40, s40, 16
    s_bfm_b32 s58, s40, 0
    s_waitcnt vmcnt(4)
    v_cmp_eq_u32 vcc, 0, v125
    s_nop 0
    s_and_b64 vcc, vcc, s[58:59]
    s_cbranch_scc1 L_kvw_68
L_kvb_69:
    v_mov_b32 v15, 0
    s_nop 2
    v_mov_b32 v15, 0
    s_nop 2
    v_mov_b32 v15, 0
    s_nop 2
    v_mov_b32 v15, 0
    s_nop 2
    v_mov_b32 v15, 0
    s_nop 2
    v_mov_b32 v15, 0
    s_nop 2
    v_mov_b32 v15, 0
    s_nop 2
    v_mov_b32 v15, 0
    s_nop 2
    v_mov_b32 v15, 0
    s_nop 2
    v_mov_b32 v15, 0
    s_nop 2
    v_mov_b32 v15, 0
    s_nop 2
    v_mov_b32 v15, 0
    s_nop 2
    v_mov_b32 v15, 0
    s_nop 2
    v_mov_b32 v15, 0
    s_nop 2
    v_mov_b32 v15, 0
    s_nop 2
    v_mov_b32 v15, 0
    s_nop 2
    v_mov_b32 v15, 0
    s_nop 2
    v_mov_b32 v15, 0
    s_nop 2
    v_mov_b32 v15, 0
    s_nop 2
    v_mov_b32 v15, 0
    s_nop 2
    v_mov_b32 v15, 0
    s_nop 2
    v_mov_b32 v15, 0
    s_nop 2
    v_mov_b32 v15, 0
    s_nop 2
    v_mov_b32 v15, 0
    s_nop 2
    v_mov_b32 v15, 0
    s_nop 2
    v_mov_b32 v15, 0
    s_nop 2
    v_mov_b32 v15, 0
    s_nop 2
    v_mov_b32 v15, 0
    s_nop 2
    v_mov_b32 v15, 0
    s_nop 2
    v_mov_b32 v15, 0
    s_nop 2
    v_mov_b32 v15, 0
    s_nop 2
    s_waitcnt lgkmcnt(0)
    s_branch L_chain_top1_s
.p2align 6
L_chain_top2_s:
    buffer_load_dwordx4 v[0:3], v117, s[8:11], s23 offen sc1
    v_mov_b32 v48, 0
    v_mov_b32 v49, 0
    v_mov_b32 v50, 0
    v_mov_b32 v51, 0
    v_mov_b32 v52, 0
    v_mov_b32 v53, 0
    v_mov_b32 v15, 0
    v_mov_b32 v15, 0
    v_mov_b32 v15, 0
    v_mov_b32 v15, 0
    v_mov_b32 v15, 0
    v_mov_b32 v15, 0
    v_mov_b32 v15, 0
    v_mov_b32 v15, 0
    v_mov_b32 v15, 0
    v_mov_b32 v15, 0
    buffer_load_dwordx4 v[0:3], v117, s[8:11], s23 offen sc1
    s_waitcnt vmcnt(3)
    v_mov_b32 v36, 0
    v_mov_b32 v37, 0
    v_mov_b32 v38, 0
    v_mov_b32 v39, 0
    v_mov_b32 v40, 0
    v_mov_b32 v41, 0
    v_mov_b32 v42, 0
    v_mov_b32 v43, 0
    v_mov_b32 v44, 0
    v_mov_b32 v45, 0
    v_mov_b32 v46, 0
    v_mov_b32 v47, 0
    v_mov_b32 v15, 0
    v_mov_b32 v15, 0
    v_mov_b32 v15, 0
    v_mov_b32 v15, 0
L_mret_70:
    buffer_load_dwordx4 v[0:3], v117, s[8:11], s23 offen sc1
    s_add_u32 s45, s45, 1
    s_cmp_lt_u32 s45, 0x10000
    s_cselect_b32 s56, -2, -1
    s_nop 3
    v_mov_b32 v32, 0
    v_mov_b32 v33, 0
    v_mov_b32 v34, 0
    v_mov_b32 v35, 0
    s_waitcnt vmcnt(2)
    v_max3_u32 v15, v0, v1, v2
    v_max_u32 v15, v15, v3
    v_cmp_lt_u32 vcc, s56, v15
    v_smfmac_f32_16x16x64_bf16 v[32:35], v[0:3], v[80:87], v116
    s_cbranch_vccnz L_mret_70
    ds_write_b128 v117, v[0:3] offset:2048
    v_smfmac_f32_16x16x64_bf16 v[36:39], v[0:3], v[56:63], v116
    buffer_load_dwordx4 v[4:7], v117, s[8:11], s48 offen sc1
    v_smfmac_f32_16x16x64_bf16 v[40:43], v[0:3], v[64:71], v116
    buffer_load_dwordx4 v117, s[8:11], s48 offen sc1 lds
    s_mov_b32 m0, 12288
    v_smfmac_f32_16x16x64_bf16 v[44:47], v[0:3], v[72:79], v116
    s_waitcnt lgkmcnt(0)
    s_barrier
    ds_read_b128 v[8:11], v117 offset:3072
    v_smfmac_f32_16x16x64_bf16 v[48:51], v[0:3], a[192:199], v116
    ds_read_b128 v[16:19], v117
    ds_read_b128 v[20:23], v117 offset:1024
    v_smfmac_f32_16x16x64_bf16 v[52:55], v[0:3], a[200:207], v116
    ds_read_b128 v[80:83], v117 offset:14336
    s_waitcnt lgkmcnt(3)
    v_smfmac_f32_16x16x64_bf16 v[32:35], v[8:11], a[0:7], v116
    ds_read_b128 v[84:87], v117 offset:15360
    v_smfmac_f32_16x16x64_bf16 v[36:39], v[8:11], a[8:15], v116
    ds_read_b128 v[56:59], v117 offset:8192
    s_waitcnt lgkmcnt(4)
    v_smfmac_f32_16x16x64_bf16 v[32:35], v[16:19], a[32:39], v116
    ds_read_b128 v[60:63], v117 offset:9216
    v_smfmac_f32_16x16x64_bf16 v[36:39], v[16:19], a[40:47], v116
    ds_read_b128 v[64:67], v117 offset:10240
    s_waitcnt lgkmcnt(5)
    v_smfmac_f32_16x16x64_bf16 v[32:35], v[20:23], a[64:71], v116
    ds_read_b128 v[68:71], v117 offset:11264
    v_smfmac_f32_16x16x64_bf16 v[36:39], v[20:23], a[72:79], v116
    buffer_store_dwordx4 v[112:115], v117, s[8:11], s32 offen sc1
    v_smfmac_f32_16x16x64_bf16 v[40:43], v[8:11], a[96:103], v116
    ds_read_b128 v[72:75], v117 offset:12288
    v_smfmac_f32_16x16x64_bf16 v[40:43], v[16:19], a[128:135], v116
    ds_read_b128 v[76:79], v117 offset:13312
    v_smfmac_f32_16x16x64_bf16 v[40:43], v[20:23], a[160:167], v116
    s_waitcnt vmcnt(2)
    v_max3_u32 v15, v4, v5, v6
    v_smfmac_f32_16x16x64_bf16 v[44:47], v[8:11], a[104:111], v116
    v_max_u32 v15, v15, v7
    v_smfmac_f32_16x16x64_bf16 v[44:47], v[16:19], a[136:143], v116
    s_waitcnt vmcnt(1) lgkmcnt(0)
    v_cmp_lt_u32 vcc, s56, v15
    v_smfmac_f32_16x16x64_bf16 v[44:47], v[20:23], a[168:175], v116
    s_cbranch_vccnz L_mret_71
L_mgo_72:
    v_smfmac_f32_16x16x64_bf16 v[44:47], v[4:7], v[24:31], v116
    s_barrier
    ds_read_b128 v[12:15], v117 offset:7168
    v_smfmac_f32_16x16x64_bf16 v[32:35], v[4:7], v[88:95], v116
    ds_read_b128 v[24:27], v117 offset:4096
    v_smfmac_f32_16x16x64_bf16 v[36:39], v[4:7], v[96:103], v116
    ds_read_b128 v[28:31], v117 offset:5120
    v_smfmac_f32_16x16x64_bf16 v[40:43], v[4:7], v[104:111], v116
    ds_read_b128 v[88:91], v117 offset:28672
    s_waitcnt lgkmcnt(3)
    v_smfmac_f32_16x16x64_bf16 v[32:35], v[12:15], a[16:23], v116
    ds_read_b128 v[92:95], v117 offset:29696
    s_waitcnt lgkmcnt(3)
    v_smfmac_f32_16x16x64_bf16 v[32:35], v[24:27], a[48:55], v116
    buffer_load_dwordx4 v117, s[8:11], s30 offen lds
    s_waitcnt lgkmcnt(2)
    v_smfmac_f32_16x16x64_bf16 v[32:35], v[28:31], a[80:87], v116
    ds_read_b128 v[96:99], v117 offset:23552
    v_smfmac_f32_16x16x64_bf16 v[36:39], v[12:15], a[24:31], v116
    ds_read_b128 v[100:103], v117 offset:23552
    v_smfmac_f32_16x16x64_bf16 v[36:39], v[24:27], a[56:63], v116
    buffer_load_dwordx4 v117, s[8:11], s30 offen offset:1024 lds
    s_add_u32 m0, s52, 0x6000
    v_add_f32 v32, v32, v34
    v_smfmac_f32_16x16x64_bf16 v[36:39], v[28:31], a[88:95], v116
    ds_read_b128 v[104:107], v117 offset:23552
    v_add_f32 v33, v33, v35
    v_smfmac_f32_16x16x64_bf16 v[40:43], v[12:15], a[112:119], v116
    ds_read_b128 v[108:111], v117 offset:23552
    v_mul_f32 v32, s34, v32
    v_smfmac_f32_16x16x64_bf16 v[40:43], v[24:27], a[144:151], v116
    s_waitcnt lgkmcnt(4)
    buffer_load_dwordx4 v117, s[8:11], s31 offen lds
    v_mul_f32 v33, s34, v33
    v_smfmac_f32_16x16x64_bf16 v[40:43], v[28:31], a[176:183], v116
    ds_read_b128 v[0:3], v124
    v_add_f32 v36, v36, v38
    v_smfmac_f32_16x16x64_bf16 v[48:51], v[4:7], a[208:215], v116
    v_add_f32 v37, v37, v39
    v_smfmac_f32_16x16x64_bf16 v[52:55], v[4:7], a[216:223], v116
    buffer_load_dwordx4 v117, s[8:11], s31 offen offset:1024 lds
    s_mov_b32 m0, 6144
    v_mul_f32 v36, s34, v36
    v_smfmac_f32_16x16x64_bf16 v[44:47], v[12:15], a[120:127], v116
    ds_read_b128 v[4:7], v124 offset:1024
    v_mul_f32 v37, s34, v37
    v_smfmac_f32_16x16x64_bf16 v[44:47], v[24:27], a[152:159], v116
    v_cvt_pk_bf16_f32 v34, v32, v36
    v_smfmac_f32_16x16x64_bf16 v[44:47], v[28:31], a[184:191], v116
    v_cvt_pk_bf16_f32 v35, v33, v37
    v_add_f32 v40, v40, v42
    v_smfmac_f32_16x16x64_bf16 v[48:51], v[8:11], a[224:231], v116
    ds_write2_b32 v120, v34, v35 offset0:32 offset1:48
    v_add_f32 v41, v41, v43
    v_smfmac_f32_16x16x64_bf16 v[52:55], v[8:11], a[232:239], v116
    v_add_f32 v44, v44, v46
    v_add_f32 v45, v45, v47
    v_cvt_pk_bf16_f32 v113, v40, v44
    v_cvt_pk_bf16_f32 v115, v41, v45
    v_smfmac_f32_16x16x64_bf16 v[48:51], v[12:15], a[240:247], v116
    ds_write2_b32 v120, v113, v115 offset0:0 offset1:16
    v_smfmac_f32_16x16x64_bf16 v[52:55], v[12:15], a[248:255], v116
    s_cmp_eq_u32 s22, 63
    s_cbranch_scc1 L_chain_last_s
    v_smfmac_f32_16x16x64_bf16 v[48:51], v[16:19], v[128:135], v116
    buffer_store_dword v126, v119, s[8:11], s55 offen sc1
    v_smfmac_f32_16x16x64_bf16 v[48:51], v[20:23], v[160:167], v116
    v_smfmac_f32_16x16x64_bf16 v[48:51], v[24:27], v[144:151], v116
    s_waitcnt lgkmcnt(0)
    s_barrier
    v_smfmac_f32_16x16x64_bf16 v[48:51], v[28:31], v[176:183], v116
    ds_read_b128 v[32:35], v121 offset:16384
    ds_read_b128 v[36:39], v121 offset:17408
    v_smfmac_f32_16x16x64_bf16 v[52:55], v[16:19], v[136:143], v116
    ds_read_b128 v[40:43], v121 offset:18432
    ds_read_b128 v[44:47], v121 offset:19456
    v_smfmac_f32_16x16x64_bf16 v[52:55], v[20:23], v[168:175], v116
    ds_read_b128 v[8:11], v124 offset:32768
    v_add_f32 v48, v48, v50
    v_smfmac_f32_16x16x64_bf16 v[52:55], v[24:27], v[152:159], v116
    ds_read_b128 v[12:15], v124 offset:33792
    v_add_f32 v49, v49, v51
    v_smfmac_f32_16x16x64_bf16 v[52:55], v[28:31], v[184:191], v116
    s_waitcnt lgkmcnt(5)
    v_cvt_pk_bf16_f32 v112, v48, v49
    v_mfma_f32_16x16x32_bf16 v[56:59], v[56:59], v[32:35], 0
    s_waitcnt lgkmcnt(4)
    v_mov_b32 v48, s50
    v_mov_b32 v49, s50
    v_mfma_f32_16x16x32_bf16 v[56:59], v[60:63], v[36:39], v[56:59]
    ds_read_b128 v[16:19], v124 offset:2048
    s_waitcnt lgkmcnt(4)
    v_mov_b32 v50, s50
    v_mov_b32 v51, s50
    v_mfma_f32_16x16x32_bf16 v[56:59], v[64:67], v[40:43], v[56:59]
    ds_read_b128 v[20:23], v124 offset:3072
    s_waitcnt lgkmcnt(4)
    v_add_f32 v52, v52, v54
    v_mfma_f32_16x16x32_bf16 v[56:59], v[68:71], v[44:47], v[56:59]
    ds_read_b128 v[24:27], v124 offset:4096
    v_add_f32 v53, v53, v55
    v_mfma_f32_16x16x32_bf16 v[60:63], v[72:75], v[32:35], 0
    ds_read_b128 v[28:31], v124 offset:5120
    v_cvt_pk_bf16_f32 v114, v52, v53
    v_mov_b32 v53, 0
    v_mfma_f32_16x16x32_bf16 v[60:63], v[76:79], v[36:39], v[60:63]
    v_exp_f32 v56, v56
    v_mfma_f32_16x16x32_bf16 v[60:63], v[80:83], v[40:43], v[60:63]
    v_exp_f32 v57, v57
    v_mfma_f32_16x16x32_bf16 v[60:63], v[84:87], v[44:47], v[60:63]
    v_exp_f32 v58, v58
    v_mfma_f32_16x16x32_bf16 v[64:67], v[32:35], v[32:35], 0
    v_exp_f32 v59, v59
    v_cvt_pk_bf16_f32 v68, v56, v57
    v_mfma_f32_16x16x32_bf16 v[64:67], v[36:39], v[36:39], v[64:67]
    v_exp_f32 v60, v60
    v_cvt_pk_bf16_f32 v69, v58, v59
    v_mfma_f32_16x16x32_bf16 v[64:67], v[40:43], v[40:43], v[64:67]
    v_exp_f32 v61, v61
    v_mfma_f32_16x16x32_bf16 v[64:67], v[44:47], v[44:47], v[64:67]
    v_exp_f32 v62, v62
    v_exp_f32 v63, v63
    v_cvt_pk_bf16_f32 v70, v60, v61
    v_cvt_pk_bf16_f32 v71, v62, v63
    s_nop 1
    v_mfma_f32_16x16x32_bf16 v[72:75], v[88:91], v[68:71], 0
    s_nop 0
    v_exp_f32 v64, v64
    v_mfma_f32_16x16x32_bf16 v[76:79], v[92:95], v[68:71], 0
    v_exp_f32 v65, v65
    v_mfma_f32_16x16x32_bf16 v[80:83], v[48:51], v[68:71], 0
    v_cvt_pk_bf16_f32 v52, v64, v65
    s_nop 1
    v_mfma_f32_16x16x16_bf16 v[72:75], v[112:113], v[52:53], v[72:75]
    ds_read_b128 v[32:35], v124 offset:6144
    v_mfma_f32_16x16x16_bf16 v[76:79], v[114:115], v[52:53], v[76:79]
    ds_read_b128 v[36:39], v124 offset:7168
    v_mfma_f32_16x16x16_bf16 v[80:83], v[48:49], v[52:53], v[80:83]
L_norm_73:
    s_mov_b64 vcc, s[36:37]
    v_mov_b32 v122, v122
    v_mov_b32 v122, v122
    v_mov_b32 v122, v122
    v_cndmask_b32_dpp v76, v72, v76, vcc quad_perm:[2,3,2,3] row_mask:0xf bank_mask:0xf
    v_cndmask_b32_dpp v77, v73, v77, vcc quad_perm:[2,3,2,3] row_mask:0xf bank_mask:0xf
    v_cndmask_b32_dpp v78, v74, v78, vcc quad_perm:[2,3,2,3] row_mask:0xf bank_mask:0xf
    v_cndmask_b32_dpp v79, v75, v79, vcc quad_perm:[2,3,2,3] row_mask:0xf bank_mask:0xf
    v_rcp_f32_dpp v84, v80 quad_perm:[2,3,2,3] row_mask:0xf bank_mask:0xf
    s_nop 0
    v_pk_mul_f32 v[76:77], v[76:77], v[84:85] op_sel_hi:[1,0]
    v_pk_mul_f32 v[78:79], v[78:79], v[84:85] op_sel_hi:[1,0]
    v_cvt_pk_bf16_f32 v72, v76, v77
    v_cvt_pk_bf16_f32 v73, v78, v79
    ds_write_b64 v122, v[72:73] offset:21504
    v_max_f32_dpp v86, v80, v84 quad_perm:[2,3,2,3] row_mask:0xf bank_mask:0xf
    v_mov_b32_dpp v60, v72 quad_perm:[0,1,0,1] row_mask:0xf bank_mask:0xf
    v_mov_b32_dpp v61, v73 quad_perm:[0,1,0,1] row_mask:0xf bank_mask:0xf
    v_cmp_lt_f32 vcc, s35, v86
    v_mov_b32_dpp v62, v72 quad_perm:[2,3,2,3] row_mask:0xf bank_mask:0xf
    v_mov_b32_dpp v63, v73 quad_perm:[2,3,2,3] row_mask:0xf bank_mask:0xf
    s_nop 1
    v_smfmac_f32_16x16x64_bf16 v[96:99], v[60:63], v[192:199], v116
    s_cbranch_vccnz L_smax_74
    v_smfmac_f32_16x16x64_bf16 v[100:103], v[60:63], v[224:231], v116
    s_waitcnt lgkmcnt(0)
    s_barrier
    ds_read_b128 v[92:95], v127 offset:22016
    ds_read_b128 v[80:83], v127 offset:20480
    ds_read_b128 v[84:87], v127 offset:20992
    v_smfmac_f32_16x16x64_bf16 v[104:107], v[60:63], v[0:7], v116
    ds_read_b128 v[40:43], v124 offset:34816
    v_smfmac_f32_16x16x64_bf16 v[108:111], v[60:63], v[8:15], v116
    ds_read_b128 v[56:59], v124 offset:36864
    s_waitcnt lgkmcnt(4)
    v_smfmac_f32_16x16x64_bf16 v[96:99], v[92:95], v[200:207], v116
    s_waitcnt lgkmcnt(3)
    v_smfmac_f32_16x16x64_bf16 v[96:99], v[80:83], v[208:215], v116
    ds_read_b128 v[44:47], v124 offset:35840
    s_waitcnt lgkmcnt(3)
    v_smfmac_f32_16x16x64_bf16 v[96:99], v[84:87], v[216:223], v116
    ds_read_b128 v[68:71], v124 offset:39936
    v_smfmac_f32_16x16x64_bf16 v[100:103], v[92:95], v[232:239], v116
    ds_read_b128 v[64:67], v124 offset:38912
    v_smfmac_f32_16x16x64_bf16 v[100:103], v[80:83], v[240:247], v116
    ds_read_b128 v[60:63], v124 offset:37888
    v_cvt_pk_bf16_f32 v72, v96, v98
    v_smfmac_f32_16x16x64_bf16 v[100:103], v[84:87], v[248:255], v116
    v_and_or_b32 v72, v72, -2, s33
    v_smfmac_f32_16x16x64_bf16 v[104:107], v[92:95], v[16:23], v116
    v_cvt_pk_bf16_f32 v74, v97, v99
    v_smfmac_f32_16x16x64_bf16 v[104:107], v[80:83], v[24:31], v116
    v_cvt_pk_bf16_f32 v73, v100, v102
    v_cvt_pk_bf16_f32 v75, v101, v103
    v_smfmac_f32_16x16x64_bf16 v[104:107], v[84:87], v[32:39], v116
    buffer_store_dwordx4 v[72:75], v118, s[8:11], s25 offen sc1
    s_waitcnt lgkmcnt(3)
    v_smfmac_f32_16x16x64_bf16 v[108:111], v[92:95], v[40:47], v116
    s_waitcnt lgkmcnt(0)
    v_smfmac_f32_16x16x64_bf16 v[108:111], v[80:83], v[56:63], v116
    v_cvt_pk_bf16_f32 v76, v104, v106
    v_smfmac_f32_16x16x64_bf16 v[108:111], v[84:87], v[64:71], v116
    v_and_or_b32 v76, v76, -2, s33
    v_cvt_pk_bf16_f32 v78, v105, v107
    v_mov_b32 v122, v122
    v_mov_b32 v122, v122
    v_mov_b32 v122, v122
    v_mov_b32 v122, v122
    v_mov_b32 v122, v122
    v_mov_b32 v122, v122
    v_cvt_pk_bf16_f32 v77, v108, v110
    v_cvt_pk_bf16_f32 v79, v109, v111
    buffer_store_dwordx4 v[76:79], v118, s[8:11], s26 offen sc1
    ds_read_b128 v[80:83], v123
    ds_read_b128 v[84:87], v123 offset:1024
    ds_read_b128 v[56:59], v123 offset:2048
    ds_read_b128 v[60:63], v123 offset:3072
    ds_read_b128 v[64:67], v123 offset:32768
    ds_read_b128 v[68:71], v123 offset:33792
    ds_read_b128 v[72:75], v123 offset:34816
    ds_read_b128 v[76:79], v123 offset:35840
    ds_read_b128 v[88:91], v123 offset:4096
    ds_read_b128 v[92:95], v123 offset:5120
    ds_read_b128 v[96:99], v123 offset:6144
    ds_read_b128 v[100:103], v123 offset:7168
    ds_read_b128 v[104:107], v123 offset:36864
    ds_read_b128 v[108:111], v123 offset:37888
    ds_read_b128 v[24:27], v123 offset:38912
    ds_read_b128 v[28:31], v123 offset:39936
    s_add_u32 s30, s30, 0x40000
    s_add_u32 s31, s31, 0x40000
    s_add_u32 s32, s32, 0x20000
    s_add_u32 s23, s24, 2048
    s_add_u32 s48, s23, 4096
    s_xor_b32 s25, s25, 0x40000
    s_xor_b32 s26, s26, 0x40000
    s_mov_b32 s35, 0x49800000
    s_add_u32 s22, s22, 1
    v_cndmask_b32 v12, 0, v125, s[68:69]
    v_cndmask_b32 v13, 0, v125, s[70:71]
    v_cndmask_b32 v14, 0, v125, s[72:73]
    v_cndmask_b32 v15, 0, v125, s[74:75]
    v_mov_b32 v54, 0
    v_mov_b32 v55, 0
    v_mov_b32 v52, 0
    v_mov_b32 v52, 0
    v_mov_b32 v52, 0
    v_mov_b32 v52, 0
    v_mov_b32 v52, 0
    v_mov_b32 v52, 0
    v_mov_b32 v52, 0
    v_mov_b32 v52, 0
    v_mov_b32 v52, 0
    v_mov_b32 v52, 0
    v_mov_b32 v52, 0
    v_mov_b32 v52, 0
    v_mov_b32 v52, 0
    v_mov_b32 v52, 0
    v_mov_b32 v52, 0
    v_mov_b32 v52, 0
    v_mov_b32 v52, 0
    v_mov_b32 v52, 0
    v_mov_b32 v52, 0
    buffer_load_dwordx4 v[4:7], v117, s[8:11], s29 offen sc1
    buffer_load_dwordx4 v[8:11], v117, s[8:11], s53 offen sc1
    buffer_load_dwordx4 v[16:19], v117, s[8:11], s29 offen offset:2048 sc1
    buffer_load_dwordx4 v[20:23], v117, s[8:11], s53 offen offset:2048 sc1
    v_mov_b32 v52, 0
    v_mov_b32 v52, 0
    v_mov_b32 v52, 0
    v_mov_b32 v52, 0
    v_mov_b32 v52, 0
    v_mov_b32 v52, 0
    v_mov_b32 v52, 0
    v_mov_b32 v52, 0
    v_mov_b32 v52, 0
    v_mov_b32 v52, 0
    v_mov_b32 v52, 0
    v_mov_b32 v52, 0
    v_mov_b32 v52, 0
    v_mov_b32 v52, 0
    v_mov_b32 v52, 0
    v_mov_b32 v52, 0
    v_mov_b32 v52, 0
    v_mov_b32 v52, 0
    v_mov_b32 v52, 0
    v_mov_b32 v52, 0
    v_mov_b32 v52, 0
    v_mov_b32 v52, 0
    v_mov_b32 v52, 0
    v_mov_b32 v52, 0
    v_mov_b32 v52, 0
    v_mov_b32 v52, 0
    v_mov_b32 v52, 0
    v_mov_b32 v52, 0
    v_mov_b32 v52, 0
    v_mov_b32 v52, 0
    v_mov_b32 v52, 0
    v_mov_b32 v52, 0
    v_mov_b32 v52, 0
    v_mov_b32 v52, 0
    v_mov_b32 v52, 0
    v_mov_b32 v52, 0
    v_mov_b32 v52, 0
    v_mov_b32 v52, 0
    v_mov_b32 v52, 0
    v_mov_b32 v52, 0
    buffer_load_dwordx4 v[32:35], v117, s[8:11], s29 offen sc1
    buffer_load_dwordx4 v[36:39], v117, s[8:11], s53 offen sc1
    buffer_load_dwordx4 v[40:43], v117, s[8:11], s29 offen offset:2048 sc1
    buffer_load_dwordx4 v[44:47], v117, s[8:11], s53 offen offset:2048 sc1
    v_mov_b32 v52, 0
L_rl_75:
    s_waitcnt vmcnt(7)
    v_mfma_f32_16x16x32_bf16 v[48:51], v[4:7], v[12:15], 0
    v_xor_b32 v52, s33, v4
    s_waitcnt vmcnt(6)
    v_mfma_f32_16x16x32_bf16 v[48:51], v[8:11], v[12:15], v[48:51]
    v_xor_b32 v53, s33, v8
    v_or_b32 v52, v52, v53
    s_waitcnt vmcnt(5)
    v_mfma_f32_16x16x32_bf16 v[48:51], v[16:19], v[12:15], v[48:51]
    v_xor_b32 v53, s33, v16
    v_or_b32 v52, v52, v53
    s_waitcnt vmcnt(4)
    v_mfma_f32_16x16x32_bf16 v[48:51], v[20:23], v[12:15], v[48:51]
    v_xor_b32 v53, s33, v20
    v_or_b32 v52, v52, v53
    v_and_b32 v52, 1, v52
    v_cmp_ne_u32 vcc, 0, v52
    s_cbranch_vccnz L_rslow_76
L_rgo_77:
    s_nop 2
    v_permlane32_swap_b32 v48, v50
    v_permlane32_swap_b32 v49, v51
    v_pk_add_f32 v[48:49], v[48:49], v[50:51]
    s_mov_b64 exec, s[38:39]
    v_cvt_pk_bf16_f32 v12, v48, v49
    v_min_u32 v12, 0xfffffffe, v12
    buffer_store_dword v12, v119, s[8:11], s24 offen sc1
    s_mov_b64 exec, -1
    s_add_u32 s24, s24, 8192
    s_bitset0_b32 s24, 15
    s_xor_b32 s55, s24, 16384
    s_xor_b32 s29, s29, 0x40000
    s_xor_b32 s53, s29, 1024
    s_bfe_u32 s33, s22, 0x10001
    s_waitcnt lgkmcnt(0)
    s_branch L_chain_top2_s
.p2align 6
L_chain_top3_s:
    buffer_load_dwordx4 v[0:3], v117, s[8:11], s23 offen sc1
    v_mov_b32 v48, 0
    v_mov_b32 v49, 0
    v_mov_b32 v50, 0
    v_mov_b32 v51, 0
    v_mov_b32 v52, 0
    v_mov_b32 v53, 0
    v_mov_b32 v15, 0
    v_mov_b32 v15, 0
    v_mov_b32 v15, 0
    v_mov_b32 v15, 0
    v_mov_b32 v15, 0
    v_mov_b32 v15, 0
    v_mov_b32 v15, 0
    v_mov_b32 v15, 0
    v_mov_b32 v15, 0
    v_mov_b32 v15, 0
    buffer_load_dwordx4 v[0:3], v117, s[8:11], s23 offen sc1
    s_waitcnt vmcnt(3)
    v_mov_b32 v36, 0
    v_mov_b32 v37, 0
    v_mov_b32 v38, 0
    v_mov_b32 v39, 0
    v_mov_b32 v40, 0
    v_mov_b32 v41, 0
    v_mov_b32 v42, 0
    v_mov_b32 v43, 0
    v_mov_b32 v44, 0
    v_mov_b32 v45, 0
    v_mov_b32 v46, 0
    v_mov_b32 v47, 0
    v_mov_b32 v15, 0
    v_mov_b32 v15, 0
    v_mov_b32 v15, 0
    v_mov_b32 v15, 0
L_mret_78:
    buffer_load_dwordx4 v[0:3], v117, s[8:11], s23 offen sc1
    s_add_u32 s45, s45, 1
    s_cmp_lt_u32 s45, 0x10000
    s_cselect_b32 s56, -2, -1
    s_nop 3
    v_mov_b32 v32, 0
    v_mov_b32 v33, 0
    v_mov_b32 v34, 0
    v_mov_b32 v35, 0
    s_waitcnt vmcnt(2)
    v_max3_u32 v15, v0, v1, v2
    v_max_u32 v15, v15, v3
    v_cmp_lt_u32 vcc, s56, v15
    v_smfmac_f32_16x16x64_bf16 v[32:35], v[0:3], v[80:87], v116
    s_cbranch_vccnz L_mret_78
    ds_write_b128 v117, v[0:3] offset:3072
    v_smfmac_f32_16x16x64_bf16 v[36:39], v[0:3], v[56:63], v116
    buffer_load_dwordx4 v[4:7], v117, s[8:11], s48 offen sc1
    v_smfmac_f32_16x16x64_bf16 v[40:43], v[0:3], v[64:71], v116
    buffer_load_dwordx4 v117, s[8:11], s48 offen sc1 lds
    s_mov_b32 m0, 14336
    v_smfmac_f32_16x16x64_bf16 v[44:47], v[0:3], v[72:79], v116
    s_waitcnt lgkmcnt(0)
    s_barrier
    ds_read_b128 v[8:11], v117 offset:2048
    v_smfmac_f32_16x16x64_bf16 v[48:51], v[0:3], a[192:199], v116
    ds_read_b128 v[16:19], v117 offset:1024
    ds_read_b128 v[20:23], v117
    v_smfmac_f32_16x16x64_bf16 v[52:55], v[0:3], a[200:207], v116
    ds_read_b128 v[80:83], v117 offset:14336
    s_waitcnt lgkmcnt(3)
    v_smfmac_f32_16x16x64_bf16 v[32:35], v[8:11], a[0:7], v116
    ds_read_b128 v[84:87], v117 offset:15360
    v_smfmac_f32_16x16x64_bf16 v[36:39], v[8:11], a[8:15], v116
    ds_read_b128 v[56:59], v117 offset:8192
    s_waitcnt lgkmcnt(4)
    v_smfmac_f32_16x16x64_bf16 v[32:35], v[16:19], a[32:39], v116
    ds_read_b128 v[60:63], v117 offset:9216
    v_smfmac_f32_16x16x64_bf16 v[36:39], v[16:19], a[40:47], v116
    ds_read_b128 v[64:67], v117 offset:10240
    s_waitcnt lgkmcnt(5)
    v_smfmac_f32_16x16x64_bf16 v[32:35], v[20:23], a[64:71], v116
    ds_read_b128 v[68:71], v117 offset:11264
    v_smfmac_f32_16x16x64_bf16 v[36:39], v[20:23], a[72:79], v116
    ds_read_b128 v[72:75], v117 offset:12288
    v_smfmac_f32_16x16x64_bf16 v[40:43], v[8:11], a[96:103], v116
    ds_read_b128 v[76:79], v117 offset:13312
    v_smfmac_f32_16x16x64_bf16 v[40:43], v[16:19], a[128:135], v116
    buffer_store_dwordx4 v[112:115], v117, s[8:11], s32 offen sc1
    v_smfmac_f32_16x16x64_bf16 v[40:43], v[20:23], a[160:167], v116
    s_waitcnt vmcnt(2)
    v_max3_u32 v15, v4, v5, v6
    v_smfmac_f32_16x16x64_bf16 v[44:47], v[8:11], a[104:111], v116
    v_max_u32 v15, v15, v7
    v_smfmac_f32_16x16x64_bf16 v[44:47], v[16:19], a[136:143], v116
    s_waitcnt vmcnt(1) lgkmcnt(0)
    v_cmp_lt_u32 vcc, s56, v15
    v_smfmac_f32_16x16x64_bf16 v[44:47], v[20:23], a[168:175], v116
    s_cbranch_vccnz L_mret_79
L_mgo_80:
    v_smfmac_f32_16x16x64_bf16 v[44:47], v[4:7], v[24:31], v116
    s_barrier
    ds_read_b128 v[12:15], v117 offset:6144
    v_smfmac_f32_16x16x64_bf16 v[32:35], v[4:7], v[88:95], v116
    ds_read_b128 v[24:27], v117 offset:5120
    v_smfmac_f32_16x16x64_bf16 v[36:39], v[4:7], v[96:103], v116
    ds_read_b128 v[28:31], v117 offset:4096
    v_smfmac_f32_16x16x64_bf16 v[40:43], v[4:7], v[104:111], v116
    ds_read_b128 v[88:91], v117 offset:30720
    s_waitcnt lgkmcnt(3)
    v_smfmac_f32_16x16x64_bf16 v[32:35], v[12:15], a[16:23], v116
    ds_read_b128 v[92:95], v117 offset:31744
    s_waitcnt lgkmcnt(3)
    v_smfmac_f32_16x16x64_bf16 v[32:35], v[24:27], a[48:55], v116
    ds_read_b128 v[96:99], v117 offset:23552
    s_waitcnt lgkmcnt(3)
    v_smfmac_f32_16x16x64_bf16 v[32:35], v[28:31], a[80:87], v116
    buffer_load_dwordx4 v117, s[8:11], s30 offen lds
    v_smfmac_f32_16x16x64_bf16 v[36:39], v[12:15], a[24:31], v116
    ds_read_b128 v[100:103], v117 offset:23552
    v_smfmac_f32_16x16x64_bf16 v[36:39], v[24:27], a[56:63], v116
    ds_read_b128 v[104:107], v117 offset:23552
    v_add_f32 v32, v32, v34
    v_smfmac_f32_16x16x64_bf16 v[36:39], v[28:31], a[88:95], v116
    buffer_load_dwordx4 v117, s[8:11], s30 offen offset:1024 lds
    s_add_u32 m0, s52, 0x6000
    v_add_f32 v33, v33, v35
    v_smfmac_f32_16x16x64_bf16 v[40:43], v[12:15], a[112:119], v116
    ds_read_b128 v[108:111], v117 offset:23552
    v_mul_f32 v32, s34, v32
    v_smfmac_f32_16x16x64_bf16 v[40:43], v[24:27], a[144:151], v116
    ds_read_b128 v[0:3], v124
    v_mul_f32 v33, s34, v33
    v_smfmac_f32_16x16x64_bf16 v[40:43], v[28:31], a[176:183], v116
    s_waitcnt lgkmcnt(5)
    buffer_load_dwordx4 v117, s[8:11], s31 offen lds
    v_add_f32 v36, v36, v38
    v_smfmac_f32_16x16x64_bf16 v[48:51], v[4:7], a[208:215], v116
    v_add_f32 v37, v37, v39
    v_smfmac_f32_16x16x64_bf16 v[52:55], v[4:7], a[216:223], v116
    ds_read_b128 v[4:7], v124 offset:1024
    v_mul_f32 v36, s34, v36
    v_smfmac_f32_16x16x64_bf16 v[44:47], v[12:15], a[120:127], v116
    buffer_load_dwordx4 v117, s[8:11], s31 offen offset:1024 lds
    s_mov_b32 m0, 7168
    v_mul_f32 v37, s34, v37
    v_smfmac_f32_16x16x64_bf16 v[44:47], v[24:27], a[152:159], v116
    v_cvt_pk_bf16_f32 v34, v32, v36
    v_smfmac_f32_16x16x64_bf16 v[44:47], v[28:31], a[184:191], v116
    v_cvt_pk_bf16_f32 v35, v33, v37
    v_add_f32 v40, v40, v42
    v_smfmac_f32_16x16x64_bf16 v[48:51], v[8:11], a[224:231], v116
    ds_write2_b32 v120, v34, v35 offset0:32 offset1:48
    v_add_f32 v41, v41, v43
    v_smfmac_f32_16x16x64_bf16 v[52:55], v[8:11], a[232:239], v116
    v_add_f32 v44, v44, v46
    v_add_f32 v45, v45, v47
    v_cvt_pk_bf16_f32 v113, v40, v44
    v_cvt_pk_bf16_f32 v115, v41, v45
    v_smfmac_f32_16x16x64_bf16 v[48:51], v[12:15], a[240:247], v116
    ds_write2_b32 v120, v113, v115 offset0:0 offset1:16
    v_smfmac_f32_16x16x64_bf16 v[52:55], v[12:15], a[248:255], v116
    s_cmp_eq_u32 s22, 63
    s_cbranch_scc1 L_chain_last_s
    v_smfmac_f32_16x16x64_bf16 v[48:51], v[16:19], v[128:135], v116
    v_smfmac_f32_16x16x64_bf16 v[48:51], v[20:23], v[160:167], v116
    buffer_store_dword v126, v119, s[8:11], s55 offen sc1
    v_smfmac_f32_16x16x64_bf16 v[48:51], v[24:27], v[144:151], v116
    s_waitcnt lgkmcnt(0)
    s_barrier
    v_smfmac_f32_16x16x64_bf16 v[48:51], v[28:31], v[176:183], v116
    ds_read_b128 v[32:35], v121 offset:16384
    ds_read_b128 v[36:39], v121 offset:17408
    v_smfmac_f32_16x16x64_bf16 v[52:55], v[16:19], v[136:143], v116
    ds_read_b128 v[40:43], v121 offset:18432
    ds_read_b128 v[44:47], v121 offset:19456
    v_smfmac_f32_16x16x64_bf16 v[52:55], v[20:23], v[168:175], v116
    ds_read_b128 v[8:11], v124 offset:32768
    v_add_f32 v48, v48, v50
    v_smfmac_f32_16x16x64_bf16 v[52:55], v[24:27], v[152:159], v116
    ds_read_b128 v[12:15], v124 offset:33792
    v_add_f32 v49, v49, v51
    v_smfmac_f32_16x16x64_bf16 v[52:55], v[28:31], v[184:191], v116
    s_waitcnt lgkmcnt(5)
    v_cvt_pk_bf16_f32 v112, v48, v49
    v_mfma_f32_16x16x32_bf16 v[56:59], v[56:59], v[32:35], 0
    s_waitcnt lgkmcnt(4)
    v_mov_b32 v48, s50
    v_mov_b32 v49, s50
    v_mfma_f32_16x16x32_bf16 v[56:59], v[60:63], v[36:39], v[56:59]
    ds_read_b128 v[16:19], v124 offset:2048
    s_waitcnt lgkmcnt(4)
    v_mov_b32 v50, s50
    v_mov_b32 v51, s50
    v_mfma_f32_16x16x32_bf16 v[56:59], v[64:67], v[40:43], v[56:59]
    ds_read_b128 v[20:23], v124 offset:3072
    s_waitcnt lgkmcnt(4)
    v_add_f32 v52, v52, v54
    v_mfma_f32_16x16x32_bf16 v[56:59], v[68:71], v[44:47], v[56:59]
    ds_read_b128 v[24:27], v124 offset:4096
    v_add_f32 v53, v53, v55
    v_mfma_f32_16x16x32_bf16 v[60:63], v[72:75], v[32:35], 0
    ds_read_b128 v[28:31], v124 offset:5120
    v_cvt_pk_bf16_f32 v114, v52, v53
    v_mov_b32 v53, 0
    v_mfma_f32_16x16x32_bf16 v[60:63], v[76:79], v[36:39], v[60:63]
    v_exp_f32 v56, v56
    v_mfma_f32_16x16x32_bf16 v[60:63], v[80:83], v[40:43], v[60:63]
    v_exp_f32 v57, v57
    v_mfma_f32_16x16x32_bf16 v[60:63], v[84:87], v[44:47], v[60:63]
    v_exp_f32 v58, v58
    v_mfma_f32_16x16x32_bf16 v[64:67], v[32:35], v[32:35], 0
    v_exp_f32 v59, v59
    v_cvt_pk_bf16_f32 v68, v56, v57
    v_mfma_f32_16x16x32_bf16 v[64:67], v[36:39], v[36:39], v[64:67]
    v_exp_f32 v60, v60
    v_cvt_pk_bf16_f32 v69, v58, v59
    v_mfma_f32_16x16x32_bf16 v[64:67], v[40:43], v[40:43], v[64:67]
    v_exp_f32 v61, v61
    v_mfma_f32_16x16x32_bf16 v[64:67], v[44:47], v[44:47], v[64:67]
    v_exp_f32 v62, v62
    v_exp_f32 v63, v63
    v_cvt_pk_bf16_f32 v70, v60, v61
    v_cvt_pk_bf16_f32 v71, v62, v63
    s_nop 1
    v_mfma_f32_16x16x32_bf16 v[72:75], v[88:91], v[68:71], 0
    s_nop 0
    v_exp_f32 v64, v64
    v_mfma_f32_16x16x32_bf16 v[76:79], v[92:95], v[68:71], 0
    v_exp_f32 v65, v65
    v_mfma_f32_16x16x32_bf16 v[80:83], v[48:51], v[68:71], 0
    v_cvt_pk_bf16_f32 v52, v64, v65
    s_nop 1
    v_mfma_f32_16x16x16_bf16 v[72:75], v[112:113], v[52:53], v[72:75]
    ds_read_b128 v[32:35], v124 offset:6144
    v_mfma_f32_16x16x16_bf16 v[76:79], v[114:115], v[52:53], v[76:79]
    ds_read_b128 v[36:39], v124 offset:7168
    v_mfma_f32_16x16x16_bf16 v[80:83], v[48:49], v[52:53], v[80:83]
L_norm_81:
    s_mov_b64 vcc, s[36:37]
    v_mov_b32 v122, v122
    v_mov_b32 v122, v122
    v_mov_b32 v122, v122
    v_cndmask_b32_dpp v76, v72, v76, vcc quad_perm:[2,3,2,3] row_mask:0xf bank_mask:0xf
    v_cndmask_b32_dpp v77, v73, v77, vcc quad_perm:[2,3,2,3] row_mask:0xf bank_mask:0xf
    v_cndmask_b32_dpp v78, v74, v78, vcc quad_perm:[2,3,2,3] row_mask:0xf bank_mask:0xf
    v_cndmask_b32_dpp v79, v75, v79, vcc quad_perm:[2,3,2,3] row_mask:0xf bank_mask:0xf
    v_rcp_f32_dpp v84, v80 quad_perm:[2,3,2,3] row_mask:0xf bank_mask:0xf
    s_nop 0
    v_pk_mul_f32 v[76:77], v[76:77], v[84:85] op_sel_hi:[1,0]
    v_pk_mul_f32 v[78:79], v[78:79], v[84:85] op_sel_hi:[1,0]
    v_cvt_pk_bf16_f32 v72, v76, v77
    v_cvt_pk_bf16_f32 v73, v78, v79
    ds_write_b64 v122, v[72:73] offset:22016
    v_max_f32_dpp v86, v80, v84 quad_perm:[2,3,2,3] row_mask:0xf bank_mask:0xf
    v_mov_b32_dpp v60, v72 quad_perm:[0,1,0,1] row_mask:0xf bank_mask:0xf
    v_mov_b32_dpp v61, v73 quad_perm:[0,1,0,1] row_mask:0xf bank_mask:0xf
    v_cmp_lt_f32 vcc, s35, v86
    v_mov_b32_dpp v62, v72 quad_perm:[2,3,2,3] row_mask:0xf bank_mask:0xf
    v_mov_b32_dpp v63, v73 quad_perm:[2,3,2,3] row_mask:0xf bank_mask:0xf
    s_nop 1
    v_smfmac_f32_16x16x64_bf16 v[96:99], v[60:63], v[192:199], v116
    s_cbranch_vccnz L_smax_82
    v_smfmac_f32_16x16x64_bf16 v[100:103], v[60:63], v[224:231], v116
    s_waitcnt lgkmcnt(0)
    s_barrier
    ds_read_b128 v[92:95], v127 offset:21504
    ds_read_b128 v[80:83], v127 offset:20992
    ds_read_b128 v[84:87], v127 offset:20480
    v_smfmac_f32_16x16x64_bf16 v[104:107], v[60:63], v[0:7], v116
    ds_read_b128 v[40:43], v124 offset:34816
    v_smfmac_f32_16x16x64_bf16 v[108:111], v[60:63], v[8:15], v116
    ds_read_b128 v[56:59], v124 offset:36864
    s_waitcnt lgkmcnt(4)
    v_smfmac_f32_16x16x64_bf16 v[96:99], v[92:95], v[200:207], v116
    s_waitcnt lgkmcnt(3)
    v_smfmac_f32_16x16x64_bf16 v[96:99], v[80:83], v[208:215], v116
    ds_read_b128 v[44:47], v124 offset:35840
    s_waitcnt lgkmcnt(3)
    v_smfmac_f32_16x16x64_bf16 v[96:99], v[84:87], v[216:223], v116
    ds_read_b128 v[68:71], v124 offset:39936
    v_smfmac_f32_16x16x64_bf16 v[100:103], v[92:95], v[232:239], v116
    ds_read_b128 v[64:67], v124 offset:38912
    v_smfmac_f32_16x16x64_bf16 v[100:103], v[80:83], v[240:247], v116
    ds_read_b128 v[60:63], v124 offset:37888
    v_cvt_pk_bf16_f32 v72, v96, v98
    v_smfmac_f32_16x16x64_bf16 v[100:103], v[84:87], v[248:255], v116
    v_and_or_b32 v72, v72, -2, s33
    v_smfmac_f32_16x16x64_bf16 v[104:107], v[92:95], v[16:23], v116
    v_cvt_pk_bf16_f32 v74, v97, v99
    v_smfmac_f32_16x16x64_bf16 v[104:107], v[80:83], v[24:31], v116
    v_cvt_pk_bf16_f32 v73, v100, v102
    v_cvt_pk_bf16_f32 v75, v101, v103
    v_smfmac_f32_16x16x64_bf16 v[104:107], v[84:87], v[32:39], v116
    buffer_store_dwordx4 v[72:75], v118, s[8:11], s25 offen sc1
    s_waitcnt lgkmcnt(3)
    v_smfmac_f32_16x16x64_bf16 v[108:111], v[92:95], v[40:47], v116
    s_waitcnt lgkmcnt(0)
    v_smfmac_f32_16x16x64_bf16 v[108:111], v[80:83], v[56:63], v116
    v_cvt_pk_bf16_f32 v76, v104, v106
    v_smfmac_f32_16x16x64_bf16 v[108:111], v[84:87], v[64:71], v116
    v_and_or_b32 v76, v76, -2, s33
    v_cvt_pk_bf16_f32 v78, v105, v107
    v_mov_b32 v122, v122
    v_mov_b32 v122, v122
    v_mov_b32 v122, v122
    v_mov_b32 v122, v122
    v_mov_b32 v122, v122
    v_mov_b32 v122, v122
    v_cvt_pk_bf16_f32 v77, v108, v110
    v_cvt_pk_bf16_f32 v79, v109, v111
    buffer_store_dwordx4 v[76:79], v118, s[8:11], s26 offen sc1
    ds_read_b128 v[80:83], v123
    ds_read_b128 v[84:87], v123 offset:1024
    ds_read_b128 v[56:59], v123 offset:2048
    ds_read_b128 v[60:63], v123 offset:3072
    ds_read_b128 v[64:67], v123 offset:32768
    ds_read_b128 v[68:71], v123 offset:33792
    ds_read_b128 v[72:75], v123 offset:34816
    ds_read_b128 v[76:79], v123 offset:35840
    ds_read_b128 v[88:91], v123 offset:4096
    ds_read_b128 v[92:95], v123 offset:5120
    ds_read_b128 v[96:99], v123 offset:6144
    ds_read_b128 v[100:103], v123 offset:7168
    ds_read_b128 v[104:107], v123 offset:36864
    ds_read_b128 v[108:111], v123 offset:37888
    ds_read_b128 v[24:27], v123 offset:38912
    ds_read_b128 v[28:31], v123 offset:39936
    s_add_u32 s30, s30, 0x40000
    s_add_u32 s31, s31, 0x40000
    s_add_u32 s32, s32, 0x20000
    s_add_u32 s23, s24, 3072
    s_add_u32 s48, s23, 4096
    s_xor_b32 s25, s25, 0x40000
    s_xor_b32 s26, s26, 0x40000
    s_mov_b32 s35, 0x49800000
    s_add_u32 s22, s22, 1
    v_cndmask_b32 v12, 0, v125, s[68:69]
    v_cndmask_b32 v13, 0, v125, s[70:71]
    v_cndmask_b32 v14, 0, v125, s[72:73]
    v_cndmask_b32 v15, 0, v125, s[74:75]
    v_mov_b32 v54, 0
    v_mov_b32 v55, 0
    v_mov_b32 v52, 0
    v_mov_b32 v52, 0
    v_mov_b32 v52, 0
    v_mov_b32 v52, 0
    v_mov_b32 v52, 0
    v_mov_b32 v52, 0
    v_mov_b32 v52, 0
    v_mov_b32 v52, 0
    v_mov_b32 v52, 0
    v_mov_b32 v52, 0
    v_mov_b32 v52, 0
    v_mov_b32 v52, 0
    v_mov_b32 v52, 0
    v_mov_b32 v52, 0
    v_mov_b32 v52, 0
    v_mov_b32 v52, 0
    v_mov_b32 v52, 0
    v_mov_b32 v52, 0
    v_mov_b32 v52, 0
    v_mov_b32 v52, 0
    v_mov_b32 v52, 0
    v_mov_b32 v52, 0
    v_mov_b32 v52, 0
    v_mov_b32 v52, 0
    v_mov_b32 v52, 0
    v_mov_b32 v52, 0
    v_mov_b32 v52, 0
    v_mov_b32 v52, 0
    v_mov_b32 v52, 0
    v_mov_b32 v52, 0
    v_mov_b32 v52, 0
    v_mov_b32 v52, 0
    v_mov_b32 v52, 0
    v_mov_b32 v52, 0
    v_mov_b32 v52, 0
    v_mov_b32 v52, 0
    v_mov_b32 v52, 0
    v_mov_b32 v52, 0
    v_mov_b32 v52, 0
    v_mov_b32 v52, 0
    v_mov_b32 v52, 0
    v_mov_b32 v52, 0
    v_mov_b32 v52, 0
    v_mov_b32 v52, 0
    v_mov_b32 v52, 0
    v_mov_b32 v52, 0
    v_mov_b32 v52, 0
    v_mov_b32 v52, 0
    v_mov_b32 v52, 0
    buffer_load_dwordx4 v[4:7], v117, s[8:11], s29 offen sc1
    buffer_load_dwordx4 v[8:11], v117, s[8:11], s53 offen sc1
    buffer_load_dwordx4 v[16:19], v117, s[8:11], s29 offen offset:2048 sc1
    buffer_load_dwordx4 v[20:23], v117, s[8:11], s53 offen offset:2048 sc1
    v_mov_b32 v52, 0
    v_mov_b32 v52, 0
    v_mov_b32 v52, 0
    v_mov_b32 v52, 0
    v_mov_b32 v52, 0
    v_mov_b32 v52, 0
    v_mov_b32 v52, 0
    v_mov_b32 v52, 0
    v_mov_b32 v52, 0
    v_mov_b32 v52, 0
    v_mov_b32 v52, 0
    v_mov_b32 v52, 0
    v_mov_b32 v52, 0
    v_mov_b32 v52, 0
    v_mov_b32 v52, 0
    v_mov_b32 v52, 0
    v_mov_b32 v52, 0
    v_mov_b32 v52, 0
    v_mov_b32 v52, 0
    v_mov_b32 v52, 0
    v_mov_b32 v52, 0
    v_mov_b32 v52, 0
    v_mov_b32 v52, 0
    v_mov_b32 v52, 0
    v_mov_b32 v52, 0
    v_mov_b32 v52, 0
    v_mov_b32 v52, 0
    v_mov_b32 v52, 0
    v_mov_b32 v52, 0
    v_mov_b32 v52, 0
    buffer_load_dwordx4 v[32:35], v117, s[8:11], s29 offen sc1
    buffer_load_dwordx4 v[36:39], v117, s[8:11], s53 offen sc1
    buffer_load_dwordx4 v[40:43], v117, s[8:11], s29 offen offset:2048 sc1
    buffer_load_dwordx4 v[44:47], v117, s[8:11], s53 offen offset:2048 sc1
    v_mov_b32 v52, 0
L_rl_83:
    s_waitcnt vmcnt(7)
    v_mfma_f32_16x16x32_bf16 v[48:51], v[4:7], v[12:15], 0
    v_xor_b32 v52, s33, v4
    s_waitcnt vmcnt(6)
    v_mfma_f32_16x16x32_bf16 v[48:51], v[8:11], v[12:15], v[48:51]
    v_xor_b32 v53, s33, v8
    v_or_b32 v52, v52, v53
    s_waitcnt vmcnt(5)
    v_mfma_f32_16x16x32_bf16 v[48:51], v[16:19], v[12:15], v[48:51]
    v_xor_b32 v53, s33, v16
    v_or_b32 v52, v52, v53
    s_waitcnt vmcnt(4)
    v_mfma_f32_16x16x32_bf16 v[48:51], v[20:23], v[12:15], v[48:51]
    v_xor_b32 v53, s33, v20
    v_or_b32 v52, v52, v53
    v_and_b32 v52, 1, v52
    v_cmp_ne_u32 vcc, 0, v52
    s_cbranch_vccnz L_rslow_84
L_rgo_85:
    s_nop 2
    v_permlane32_swap_b32 v48, v50
    v_permlane32_swap_b32 v49, v51
    v_pk_add_f32 v[48:49], v[48:49], v[50:51]
    s_mov_b64 exec, s[38:39]
    v_cvt_pk_bf16_f32 v12, v48, v49
    v_min_u32 v12, 0xfffffffe, v12
    buffer_store_dword v12, v119, s[8:11], s24 offen sc1
    s_mov_b64 exec, -1
    s_add_u32 s24, s24, 8192
    s_bitset0_b32 s24, 15
    s_xor_b32 s55, s24, 16384
    s_xor_b32 s29, s29, 0x40000
    s_xor_b32 s53, s29, 1024
    s_bfe_u32 s33, s22, 0x10001
    s_waitcnt lgkmcnt(0)
    s_branch L_chain_top3_s
L_chain_last_s:
    s_nop 1
    v_smfmac_f32_16x16x64_bf16 v[48:51], v[16:19], v[128:135], v116
    v_smfmac_f32_16x16x64_bf16 v[48:51], v[20:23], v[160:167], v116
    v_smfmac_f32_16x16x64_bf16 v[48:51], v[24:27], v[144:151], v116
    v_smfmac_f32_16x16x64_bf16 v[48:51], v[28:31], v[176:183], v116
    v_smfmac_f32_16x16x64_bf16 v[52:55], v[16:19], v[136:143], v116
    v_smfmac_f32_16x16x64_bf16 v[52:55], v[20:23], v[168:175], v116
    v_smfmac_f32_16x16x64_bf16 v[52:55], v[24:27], v[152:159], v116
    v_smfmac_f32_16x16x64_bf16 v[52:55], v[28:31], v[184:191], v116
    v_add_f32 v48, v48, v50
    v_add_f32 v49, v49, v51
    v_cvt_pk_bf16_f32 v112, v48, v49
    s_nop 4
    v_add_f32 v52, v52, v54
    v_add_f32 v53, v53, v55
    v_cvt_pk_bf16_f32 v114, v52, v53
    s_add_u32 s32, s32, 0x20000
    buffer_store_dwordx4 v[112:115], v117, s[8:11], s32 offen sc1
    v_mov_b32 v94, 64
    s_waitcnt vmcnt(0) lgkmcnt(0)
    s_barrier
    s_mov_b64 exec, 1
    buffer_store_dword v94, off, s[8:11], s44 sc1
    s_mov_b64 exec, -1
    s_endpgm
L_mret_57:
    s_mov_b32 s43, m0
    s_mov_b32 m0, 4096
    buffer_load_dwordx4 v[4:7], v117, s[8:11], s48 offen sc1
    buffer_load_dwordx4 v117, s[8:11], s48 offen sc1 lds
    s_mov_b32 m0, 8192
    s_mov_b32 m0, s43
    s_waitcnt vmcnt(0)
    v_max3_u32 v15, v4, v5, v6
    v_max_u32 v15, v15, v7
    v_cmp_lt_u32 vcc, s56, v15
    s_add_u32 s47, s47, 1
    s_add_u32 s49, s49, 1
    s_cmp_ge_u32 s49, 0x10000
    s_cbranch_scc1 L_mgo_58
    s_cbranch_vccnz L_mret_57
    s_branch L_mgo_58
L_smax_60:
    s_add_u32 s47, s47, 1
    s_mov_b32 s35, 0x7f800000
    s_waitcnt lgkmcnt(0)
    s_sub_u32 s43, s30, 0x40000
    s_add_u32 s40, s43, 4096
    s_nop 7
    buffer_load_dwordx4 v[56:59], v117, s[8:11], s43 offen
    buffer_load_dwordx4 v[60:63], v117, s[8:11], s43 offen offset:1024
    buffer_load_dwordx4 v[64:67], v117, s[8:11], s43 offen offset:2048
    buffer_load_dwordx4 v[68:71], v117, s[8:11], s43 offen offset:3072
    buffer_load_dwordx4 v[72:75], v117, s[8:11], s40 offen
    buffer_load_dwordx4 v[76:79], v117, s[8:11], s40 offen offset:1024
    buffer_load_dwordx4 v[80:83], v117, s[8:11], s40 offen offset:2048
    buffer_load_dwordx4 v[84:87], v117, s[8:11], s40 offen offset:3072
    ds_read_b128 v[32:35], v121 offset:16384
    ds_read_b128 v[36:39], v121 offset:17408
    ds_read_b128 v[40:43], v121 offset:18432
    ds_read_b128 v[44:47], v121 offset:19456
    v_mov_b32 v96, 0
    v_mov_b32 v97, 0
    v_mov_b32 v98, 0
    v_mov_b32 v99, 0
    v_mov_b32 v100, 0
    v_mov_b32 v101, 0
    v_mov_b32 v102, 0
    v_mov_b32 v103, 0
    v_mov_b32 v104, 0
    v_mov_b32 v105, 0
    v_mov_b32 v106, 0
    v_mov_b32 v107, 0
    v_mov_b32 v108, 0
    v_mov_b32 v109, 0
    v_mov_b32 v110, 0
    v_mov_b32 v111, 0
    s_waitcnt vmcnt(0) lgkmcnt(0)
    v_mfma_f32_16x16x32_bf16 v[56:59], v[56:59], v[32:35], 0
    v_mfma_f32_16x16x32_bf16 v[56:59], v[60:63], v[36:39], v[56:59]
    v_mfma_f32_16x16x32_bf16 v[56:59], v[64:67], v[40:43], v[56:59]
    v_mfma_f32_16x16x32_bf16 v[56:59], v[68:71], v[44:47], v[56:59]
    v_mfma_f32_16x16x32_bf16 v[60:63], v[72:75], v[32:35], 0
    v_mfma_f32_16x16x32_bf16 v[60:63], v[76:79], v[36:39], v[60:63]
    v_mfma_f32_16x16x32_bf16 v[60:63], v[80:83], v[40:43], v[60:63]
    v_mfma_f32_16x16x32_bf16 v[60:63], v[84:87], v[44:47], v[60:63]
    v_mfma_f32_16x16x32_bf16 v[64:67], v[32:35], v[32:35], 0
    v_mfma_f32_16x16x32_bf16 v[64:67], v[36:39], v[36:39], v[64:67]
    v_mfma_f32_16x16x32_bf16 v[64:67], v[40:43], v[40:43], v[64:67]
    v_mfma_f32_16x16x32_bf16 v[64:67], v[44:47], v[44:47], v[64:67]
    v_max3_f32 v84, v56, v57, v58
    v_max3_f32 v84, v84, v59, v60
    v_max3_f32 v84, v84, v61, v62
    s_nop 4
    v_max3_f32 v84, v84, v63, v64
    v_max_f32 v84, v84, v65
    v_mov_b32 v85, v84
    s_nop 1
    v_permlane32_swap_b32 v85, v84
    v_max_f32 v84, v85, v84
    v_mov_b32 v85, v84
    s_nop 1
    v_permlane16_swap_b32 v85, v84
    v_max_f32 v84, v85, v84
    v_sub_f32 v56, v56, v84
    v_sub_f32 v57, v57, v84
    v_sub_f32 v58, v58, v84
    v_sub_f32 v59, v59, v84
    v_sub_f32 v60, v60, v84
    v_sub_f32 v61, v61, v84
    v_sub_f32 v62, v62, v84
    v_sub_f32 v63, v63, v84
    v_sub_f32 v64, v64, v84
    v_sub_f32 v65, v65, v84
    v_exp_f32 v56, v56
    v_exp_f32 v57, v57
    v_exp_f32 v58, v58
    v_exp_f32 v59, v59
    v_exp_f32 v60, v60
    v_exp_f32 v61, v61
    v_exp_f32 v62, v62
    v_exp_f32 v63, v63
    v_exp_f32 v64, v64
    v_exp_f32 v65, v65
    v_cvt_pk_bf16_f32 v68, v56, v57
    v_cvt_pk_bf16_f32 v69, v58, v59
    v_cvt_pk_bf16_f32 v70, v60, v61
    v_cvt_pk_bf16_f32 v71, v62, v63
    v_cvt_pk_bf16_f32 v52, v64, v65
    s_nop 0
    v_mfma_f32_16x16x32_bf16 v[72:75], v[88:91], v[68:71], 0
    v_mfma_f32_16x16x32_bf16 v[76:79], v[92:95], v[68:71], 0
    v_mfma_f32_16x16x32_bf16 v[80:83], v[48:51], v[68:71], 0
    v_mfma_f32_16x16x16_bf16 v[72:75], v[112:113], v[52:53], v[72:75]
    v_mfma_f32_16x16x16_bf16 v[76:79], v[114:115], v[52:53], v[76:79]
    v_mfma_f32_16x16x16_bf16 v[80:83], v[48:49], v[52:53], v[80:83]
    ds_read_b128 v[32:35], v124 offset:6144
    ds_read_b128 v[36:39], v124 offset:7168
    ds_read_b128 v[40:43], v124 offset:34816
    ds_read_b128 v[44:47], v124 offset:35840
    ds_read_b128 v[56:59], v124 offset:36864
    ds_read_b128 v[64:67], v124 offset:38912
    ds_read_b128 v[68:71], v124 offset:39936
    s_waitcnt lgkmcnt(0)
    s_branch L_norm_59
L_kvw_61:
    s_add_u32 s47, s47, 1
    s_add_u32 s49, s49, 1
    s_cmp_ge_u32 s49, 0x10000
    s_cbranch_scc1 L_kvb_62
    s_sleep 4
    buffer_load_dword v125, v119, s[8:11], s28 offen sc1
    s_waitcnt vmcnt(0)
    v_cmp_eq_u32 vcc, 0, v125
    s_nop 0
    s_and_b64 vcc, vcc, s[58:59]
    s_cbranch_scc1 L_kvw_61
    s_branch L_kvb_62
L_mret_64:
    s_mov_b32 s43, m0
    s_mov_b32 m0, 5120
    buffer_load_dwordx4 v[4:7], v117, s[8:11], s48 offen sc1
    buffer_load_dwordx4 v117, s[8:11], s48 offen sc1 lds
    s_mov_b32 m0, 10240
    s_mov_b32 m0, s43
    s_waitcnt vmcnt(0)
    v_max3_u32 v15, v4, v5, v6
    v_max_u32 v15, v15, v7
    v_cmp_lt_u32 vcc, s56, v15
    s_add_u32 s47, s47, 1
    s_add_u32 s49, s49, 1
    s_cmp_ge_u32 s49, 0x10000
    s_cbranch_scc1 L_mgo_65
    s_cbranch_vccnz L_mret_64
    s_branch L_mgo_65
L_smax_67:
    s_add_u32 s47, s47, 1
    s_mov_b32 s35, 0x7f800000
    s_waitcnt lgkmcnt(0)
    s_sub_u32 s43, s30, 0x40800
    s_add_u32 s40, s43, 4096
    s_nop 7
    buffer_load_dwordx4 v[56:59], v117, s[8:11], s43 offen
    buffer_load_dwordx4 v[60:63], v117, s[8:11], s43 offen offset:1024
    buffer_load_dwordx4 v[64:67], v117, s[8:11], s43 offen offset:2048
    buffer_load_dwordx4 v[68:71], v117, s[8:11], s43 offen offset:3072
    buffer_load_dwordx4 v[72:75], v117, s[8:11], s40 offen
    buffer_load_dwordx4 v[76:79], v117, s[8:11], s40 offen offset:1024
    buffer_load_dwordx4 v[80:83], v117, s[8:11], s40 offen offset:2048
    buffer_load_dwordx4 v[84:87], v117, s[8:11], s40 offen offset:3072
    ds_read_b128 v[32:35], v121 offset:16384
    ds_read_b128 v[36:39], v121 offset:17408
    ds_read_b128 v[40:43], v121 offset:18432
    ds_read_b128 v[44:47], v121 offset:19456
    v_mov_b32 v96, 0
    v_mov_b32 v97, 0
    v_mov_b32 v98, 0
    v_mov_b32 v99, 0
    v_mov_b32 v100, 0
    v_mov_b32 v101, 0
    v_mov_b32 v102, 0
    v_mov_b32 v103, 0
    v_mov_b32 v104, 0
    v_mov_b32 v105, 0
    v_mov_b32 v106, 0
    v_mov_b32 v107, 0
    v_mov_b32 v108, 0
    v_mov_b32 v109, 0
    v_mov_b32 v110, 0
    v_mov_b32 v111, 0
    s_waitcnt vmcnt(0) lgkmcnt(0)
    v_mfma_f32_16x16x32_bf16 v[56:59], v[56:59], v[32:35], 0
    v_mfma_f32_16x16x32_bf16 v[56:59], v[60:63], v[36:39], v[56:59]
    v_mfma_f32_16x16x32_bf16 v[56:59], v[64:67], v[40:43], v[56:59]
    v_mfma_f32_16x16x32_bf16 v[56:59], v[68:71], v[44:47], v[56:59]
    v_mfma_f32_16x16x32_bf16 v[60:63], v[72:75], v[32:35], 0
    v_mfma_f32_16x16x32_bf16 v[60:63], v[76:79], v[36:39], v[60:63]
    v_mfma_f32_16x16x32_bf16 v[60:63], v[80:83], v[40:43], v[60:63]
    v_mfma_f32_16x16x32_bf16 v[60:63], v[84:87], v[44:47], v[60:63]
    v_mfma_f32_16x16x32_bf16 v[64:67], v[32:35], v[32:35], 0
    v_mfma_f32_16x16x32_bf16 v[64:67], v[36:39], v[36:39], v[64:67]
    v_mfma_f32_16x16x32_bf16 v[64:67], v[40:43], v[40:43], v[64:67]
    v_mfma_f32_16x16x32_bf16 v[64:67], v[44:47], v[44:47], v[64:67]
    v_max3_f32 v84, v56, v57, v58
    v_max3_f32 v84, v84, v59, v60
    v_max3_f32 v84, v84, v61, v62
    s_nop 4
    v_max3_f32 v84, v84, v63, v64
    v_max_f32 v84, v84, v65
    v_mov_b32 v85, v84
    s_nop 1
    v_permlane32_swap_b32 v85, v84
    v_max_f32 v84, v85, v84
    v_mov_b32 v85, v84
    s_nop 1
    v_permlane16_swap_b32 v85, v84
    v_max_f32 v84, v85, v84
    v_sub_f32 v56, v56, v84
    v_sub_f32 v57, v57, v84
    v_sub_f32 v58, v58, v84
    v_sub_f32 v59, v59, v84
    v_sub_f32 v60, v60, v84
    v_sub_f32 v61, v61, v84
    v_sub_f32 v62, v62, v84
    v_sub_f32 v63, v63, v84
    v_sub_f32 v64, v64, v84
    v_sub_f32 v65, v65, v84
    v_exp_f32 v56, v56
    v_exp_f32 v57, v57
    v_exp_f32 v58, v58
    v_exp_f32 v59, v59
    v_exp_f32 v60, v60
    v_exp_f32 v61, v61
    v_exp_f32 v62, v62
    v_exp_f32 v63, v63
    v_exp_f32 v64, v64
    v_exp_f32 v65, v65
    v_cvt_pk_bf16_f32 v68, v56, v57
    v_cvt_pk_bf16_f32 v69, v58, v59
    v_cvt_pk_bf16_f32 v70, v60, v61
    v_cvt_pk_bf16_f32 v71, v62, v63
    v_cvt_pk_bf16_f32 v52, v64, v65
    s_nop 0
    v_mfma_f32_16x16x32_bf16 v[72:75], v[88:91], v[68:71], 0
    v_mfma_f32_16x16x32_bf16 v[76:79], v[92:95], v[68:71], 0
    v_mfma_f32_16x16x32_bf16 v[80:83], v[48:51], v[68:71], 0
    v_mfma_f32_16x16x16_bf16 v[72:75], v[112:113], v[52:53], v[72:75]
    v_mfma_f32_16x16x16_bf16 v[76:79], v[114:115], v[52:53], v[76:79]
    v_mfma_f32_16x16x16_bf16 v[80:83], v[48:49], v[52:53], v[80:83]
    ds_read_b128 v[32:35], v124 offset:6144
    ds_read_b128 v[36:39], v124 offset:7168
    ds_read_b128 v[40:43], v124 offset:34816
    ds_read_b128 v[44:47], v124 offset:35840
    ds_read_b128 v[56:59], v124 offset:36864
    ds_read_b128 v[64:67], v124 offset:38912
    ds_read_b128 v[68:71], v124 offset:39936
    s_waitcnt lgkmcnt(0)
    s_branch L_norm_66
L_kvw_68:
    s_add_u32 s47, s47, 1
    s_add_u32 s49, s49, 1
    s_cmp_ge_u32 s49, 0x10000
    s_cbranch_scc1 L_kvb_69
    s_sleep 4
    buffer_load_dword v125, v119, s[8:11], s28 offen sc1
    s_waitcnt vmcnt(0)
    v_cmp_eq_u32 vcc, 0, v125
    s_nop 0
    s_and_b64 vcc, vcc, s[58:59]
    s_cbranch_scc1 L_kvw_68
    s_branch L_kvb_69
L_mret_71:
    s_mov_b32 s43, m0
    s_mov_b32 m0, 6144
    buffer_load_dwordx4 v[4:7], v117, s[8:11], s48 offen sc1
    buffer_load_dwordx4 v117, s[8:11], s48 offen sc1 lds
    s_mov_b32 m0, 12288
    s_mov_b32 m0, s43
    s_waitcnt vmcnt(0)
    v_max3_u32 v15, v4, v5, v6
    v_max_u32 v15, v15, v7
    v_cmp_lt_u32 vcc, s56, v15
    s_add_u32 s47, s47, 1
    s_add_u32 s49, s49, 1
    s_cmp_ge_u32 s49, 0x10000
    s_cbranch_scc1 L_mgo_72
    s_cbranch_vccnz L_mret_71
    s_branch L_mgo_72
L_smax_74:
    s_add_u32 s47, s47, 1
    s_mov_b32 s35, 0x7f800000
    s_waitcnt lgkmcnt(0)
    s_sub_u32 s43, s30, 0x41000
    s_add_u32 s40, s43, 4096
    s_nop 7
    buffer_load_dwordx4 v[56:59], v117, s[8:11], s43 offen
    buffer_load_dwordx4 v[60:63], v117, s[8:11], s43 offen offset:1024
    buffer_load_dwordx4 v[64:67], v117, s[8:11], s43 offen offset:2048
    buffer_load_dwordx4 v[68:71], v117, s[8:11], s43 offen offset:3072
    buffer_load_dwordx4 v[72:75], v117, s[8:11], s40 offen
    buffer_load_dwordx4 v[76:79], v117, s[8:11], s40 offen offset:1024
    buffer_load_dwordx4 v[80:83], v117, s[8:11], s40 offen offset:2048
    buffer_load_dwordx4 v[84:87], v117, s[8:11], s40 offen offset:3072
    ds_read_b128 v[32:35], v121 offset:16384
    ds_read_b128 v[36:39], v121 offset:17408
    ds_read_b128 v[40:43], v121 offset:18432
    ds_read_b128 v[44:47], v121 offset:19456
    v_mov_b32 v96, 0
    v_mov_b32 v97, 0
    v_mov_b32 v98, 0
    v_mov_b32 v99, 0
    v_mov_b32 v100, 0
    v_mov_b32 v101, 0
    v_mov_b32 v102, 0
    v_mov_b32 v103, 0
    v_mov_b32 v104, 0
    v_mov_b32 v105, 0
    v_mov_b32 v106, 0
    v_mov_b32 v107, 0
    v_mov_b32 v108, 0
    v_mov_b32 v109, 0
    v_mov_b32 v110, 0
    v_mov_b32 v111, 0
    s_waitcnt vmcnt(0) lgkmcnt(0)
    v_mfma_f32_16x16x32_bf16 v[56:59], v[56:59], v[32:35], 0
    v_mfma_f32_16x16x32_bf16 v[56:59], v[60:63], v[36:39], v[56:59]
    v_mfma_f32_16x16x32_bf16 v[56:59], v[64:67], v[40:43], v[56:59]
    v_mfma_f32_16x16x32_bf16 v[56:59], v[68:71], v[44:47], v[56:59]
    v_mfma_f32_16x16x32_bf16 v[60:63], v[72:75], v[32:35], 0
    v_mfma_f32_16x16x32_bf16 v[60:63], v[76:79], v[36:39], v[60:63]
    v_mfma_f32_16x16x32_bf16 v[60:63], v[80:83], v[40:43], v[60:63]
    v_mfma_f32_16x16x32_bf16 v[60:63], v[84:87], v[44:47], v[60:63]
    v_mfma_f32_16x16x32_bf16 v[64:67], v[32:35], v[32:35], 0
    v_mfma_f32_16x16x32_bf16 v[64:67], v[36:39], v[36:39], v[64:67]
    v_mfma_f32_16x16x32_bf16 v[64:67], v[40:43], v[40:43], v[64:67]
    v_mfma_f32_16x16x32_bf16 v[64:67], v[44:47], v[44:47], v[64:67]
    v_max3_f32 v84, v56, v57, v58
    v_max3_f32 v84, v84, v59, v60
    v_max3_f32 v84, v84, v61, v62
    s_nop 4
    v_max3_f32 v84, v84, v63, v64
    v_max_f32 v84, v84, v65
    v_mov_b32 v85, v84
    s_nop 1
    v_permlane32_swap_b32 v85, v84
    v_max_f32 v84, v85, v84
    v_mov_b32 v85, v84
    s_nop 1
    v_permlane16_swap_b32 v85, v84
    v_max_f32 v84, v85, v84
    v_sub_f32 v56, v56, v84
    v_sub_f32 v57, v57, v84
    v_sub_f32 v58, v58, v84
    v_sub_f32 v59, v59, v84
    v_sub_f32 v60, v60, v84
    v_sub_f32 v61, v61, v84
    v_sub_f32 v62, v62, v84
    v_sub_f32 v63, v63, v84
    v_sub_f32 v64, v64, v84
    v_sub_f32 v65, v65, v84
    v_exp_f32 v56, v56
    v_exp_f32 v57, v57
    v_exp_f32 v58, v58
    v_exp_f32 v59, v59
    v_exp_f32 v60, v60
    v_exp_f32 v61, v61
    v_exp_f32 v62, v62
    v_exp_f32 v63, v63
    v_exp_f32 v64, v64
    v_exp_f32 v65, v65
    v_cvt_pk_bf16_f32 v68, v56, v57
    v_cvt_pk_bf16_f32 v69, v58, v59
    v_cvt_pk_bf16_f32 v70, v60, v61
    v_cvt_pk_bf16_f32 v71, v62, v63
    v_cvt_pk_bf16_f32 v52, v64, v65
    s_nop 0
    v_mfma_f32_16x16x32_bf16 v[72:75], v[88:91], v[68:71], 0
    v_mfma_f32_16x16x32_bf16 v[76:79], v[92:95], v[68:71], 0
    v_mfma_f32_16x16x32_bf16 v[80:83], v[48:51], v[68:71], 0
    v_mfma_f32_16x16x16_bf16 v[72:75], v[112:113], v[52:53], v[72:75]
    v_mfma_f32_16x16x16_bf16 v[76:79], v[114:115], v[52:53], v[76:79]
    v_mfma_f32_16x16x16_bf16 v[80:83], v[48:49], v[52:53], v[80:83]
    ds_read_b128 v[32:35], v124 offset:6144
    ds_read_b128 v[36:39], v124 offset:7168
    ds_read_b128 v[40:43], v124 offset:34816
    ds_read_b128 v[44:47], v124 offset:35840
    ds_read_b128 v[56:59], v124 offset:36864
    ds_read_b128 v[64:67], v124 offset:38912
    ds_read_b128 v[68:71], v124 offset:39936
    s_waitcnt lgkmcnt(0)
    s_branch L_norm_73
L_rslow_76:
    buffer_load_dwordx4 v[4:7], v117, s[8:11], s29 offen sc1
    buffer_load_dwordx4 v[8:11], v117, s[8:11], s53 offen sc1
    buffer_load_dwordx4 v[16:19], v117, s[8:11], s29 offen offset:2048 sc1
    buffer_load_dwordx4 v[20:23], v117, s[8:11], s53 offen offset:2048 sc1
    s_add_u32 s46, s46, 1
    s_add_u32 s49, s49, 1
    s_cmp_ge_u32 s49, 0x10000
    s_cbranch_scc1 L_rgo_77
    s_waitcnt vmcnt(7)
    v_mfma_f32_16x16x32_bf16 v[48:51], v[32:35], v[12:15], 0
    v_xor_b32 v52, s33, v32
    s_waitcnt vmcnt(6)
    v_mfma_f32_16x16x32_bf16 v[48:51], v[36:39], v[12:15], v[48:51]
    v_xor_b32 v53, s33, v36
    v_or_b32 v52, v52, v53
    s_waitcnt vmcnt(5)
    v_mfma_f32_16x16x32_bf16 v[48:51], v[40:43], v[12:15], v[48:51]
    v_xor_b32 v53, s33, v40
    v_or_b32 v52, v52, v53
    s_waitcnt vmcnt(4)
    v_mfma_f32_16x16x32_bf16 v[48:51], v[44:47], v[12:15], v[48:51]
    v_xor_b32 v53, s33, v44
    v_or_b32 v52, v52, v53
    v_and_b32 v52, 1, v52
    v_cmp_ne_u32 vcc, 0, v52
    s_cbranch_vccz L_rgo_77
    buffer_load_dwordx4 v[32:35], v117, s[8:11], s29 offen sc1
    buffer_load_dwordx4 v[36:39], v117, s[8:11], s53 offen sc1
    buffer_load_dwordx4 v[40:43], v117, s[8:11], s29 offen offset:2048 sc1
    buffer_load_dwordx4 v[44:47], v117, s[8:11], s53 offen offset:2048 sc1
    s_add_u32 s46, s46, 1
    s_branch L_rl_75
L_mret_79:
    s_mov_b32 s43, m0
    s_mov_b32 m0, 7168
    buffer_load_dwordx4 v[4:7], v117, s[8:11], s48 offen sc1
    buffer_load_dwordx4 v117, s[8:11], s48 offen sc1 lds
    s_mov_b32 m0, 14336
    s_mov_b32 m0, s43
    s_waitcnt vmcnt(0)
    v_max3_u32 v15, v4, v5, v6
    v_max_u32 v15, v15, v7
    v_cmp_lt_u32 vcc, s56, v15
    s_add_u32 s47, s47, 1
    s_add_u32 s49, s49, 1
    s_cmp_ge_u32 s49, 0x10000
    s_cbranch_scc1 L_mgo_80
    s_cbranch_vccnz L_mret_79
    s_branch L_mgo_80
L_smax_82:
    s_add_u32 s47, s47, 1
    s_mov_b32 s35, 0x7f800000
    s_waitcnt lgkmcnt(0)
    s_sub_u32 s43, s30, 0x41800
    s_add_u32 s40, s43, 4096
    s_nop 7
    buffer_load_dwordx4 v[56:59], v117, s[8:11], s43 offen
    buffer_load_dwordx4 v[60:63], v117, s[8:11], s43 offen offset:1024
    buffer_load_dwordx4 v[64:67], v117, s[8:11], s43 offen offset:2048
    buffer_load_dwordx4 v[68:71], v117, s[8:11], s43 offen offset:3072
    buffer_load_dwordx4 v[72:75], v117, s[8:11], s40 offen
    buffer_load_dwordx4 v[76:79], v117, s[8:11], s40 offen offset:1024
    buffer_load_dwordx4 v[80:83], v117, s[8:11], s40 offen offset:2048
    buffer_load_dwordx4 v[84:87], v117, s[8:11], s40 offen offset:3072
    ds_read_b128 v[32:35], v121 offset:16384
    ds_read_b128 v[36:39], v121 offset:17408
    ds_read_b128 v[40:43], v121 offset:18432
    ds_read_b128 v[44:47], v121 offset:19456
    v_mov_b32 v96, 0
    v_mov_b32 v97, 0
    v_mov_b32 v98, 0
    v_mov_b32 v99, 0
    v_mov_b32 v100, 0
    v_mov_b32 v101, 0
    v_mov_b32 v102, 0
    v_mov_b32 v103, 0
    v_mov_b32 v104, 0
    v_mov_b32 v105, 0
    v_mov_b32 v106, 0
    v_mov_b32 v107, 0
    v_mov_b32 v108, 0
    v_mov_b32 v109, 0
    v_mov_b32 v110, 0
    v_mov_b32 v111, 0
    s_waitcnt vmcnt(0) lgkmcnt(0)
    v_mfma_f32_16x16x32_bf16 v[56:59], v[56:59], v[32:35], 0
    v_mfma_f32_16x16x32_bf16 v[56:59], v[60:63], v[36:39], v[56:59]
    v_mfma_f32_16x16x32_bf16 v[56:59], v[64:67], v[40:43], v[56:59]
    v_mfma_f32_16x16x32_bf16 v[56:59], v[68:71], v[44:47], v[56:59]
    v_mfma_f32_16x16x32_bf16 v[60:63], v[72:75], v[32:35], 0
    v_mfma_f32_16x16x32_bf16 v[60:63], v[76:79], v[36:39], v[60:63]
    v_mfma_f32_16x16x32_bf16 v[60:63], v[80:83], v[40:43], v[60:63]
    v_mfma_f32_16x16x32_bf16 v[60:63], v[84:87], v[44:47], v[60:63]
    v_mfma_f32_16x16x32_bf16 v[64:67], v[32:35], v[32:35], 0
    v_mfma_f32_16x16x32_bf16 v[64:67], v[36:39], v[36:39], v[64:67]
    v_mfma_f32_16x16x32_bf16 v[64:67], v[40:43], v[40:43], v[64:67]
    v_mfma_f32_16x16x32_bf16 v[64:67], v[44:47], v[44:47], v[64:67]
    v_max3_f32 v84, v56, v57, v58
    v_max3_f32 v84, v84, v59, v60
    v_max3_f32 v84, v84, v61, v62
    s_nop 4
    v_max3_f32 v84, v84, v63, v64
    v_max_f32 v84, v84, v65
    v_mov_b32 v85, v84
    s_nop 1
    v_permlane32_swap_b32 v85, v84
    v_max_f32 v84, v85, v84
    v_mov_b32 v85, v84
    s_nop 1
    v_permlane16_swap_b32 v85, v84
    v_max_f32 v84, v85, v84
    v_sub_f32 v56, v56, v84
    v_sub_f32 v57, v57, v84
    v_sub_f32 v58, v58, v84
    v_sub_f32 v59, v59, v84
    v_sub_f32 v60, v60, v84
    v_sub_f32 v61, v61, v84
    v_sub_f32 v62, v62, v84
    v_sub_f32 v63, v63, v84
    v_sub_f32 v64, v64, v84
    v_sub_f32 v65, v65, v84
    v_exp_f32 v56, v56
    v_exp_f32 v57, v57
    v_exp_f32 v58, v58
    v_exp_f32 v59, v59
    v_exp_f32 v60, v60
    v_exp_f32 v61, v61
    v_exp_f32 v62, v62
    v_exp_f32 v63, v63
    v_exp_f32 v64, v64
    v_exp_f32 v65, v65
    v_cvt_pk_bf16_f32 v68, v56, v57
    v_cvt_pk_bf16_f32 v69, v58, v59
    v_cvt_pk_bf16_f32 v70, v60, v61
    v_cvt_pk_bf16_f32 v71, v62, v63
    v_cvt_pk_bf16_f32 v52, v64, v65
    s_nop 0
    v_mfma_f32_16x16x32_bf16 v[72:75], v[88:91], v[68:71], 0
    v_mfma_f32_16x16x32_bf16 v[76:79], v[92:95], v[68:71], 0
    v_mfma_f32_16x16x32_bf16 v[80:83], v[48:51], v[68:71], 0
    v_mfma_f32_16x16x16_bf16 v[72:75], v[112:113], v[52:53], v[72:75]
    v_mfma_f32_16x16x16_bf16 v[76:79], v[114:115], v[52:53], v[76:79]
    v_mfma_f32_16x16x16_bf16 v[80:83], v[48:49], v[52:53], v[80:83]
    ds_read_b128 v[32:35], v124 offset:6144
    ds_read_b128 v[36:39], v124 offset:7168
    ds_read_b128 v[40:43], v124 offset:34816
    ds_read_b128 v[44:47], v124 offset:35840
    ds_read_b128 v[56:59], v124 offset:36864
    ds_read_b128 v[64:67], v124 offset:38912
    ds_read_b128 v[68:71], v124 offset:39936
    s_waitcnt lgkmcnt(0)
    s_branch L_norm_81
L_rslow_84:
    buffer_load_dwordx4 v[4:7], v117, s[8:11], s29 offen sc1
    buffer_load_dwordx4 v[8:11], v117, s[8:11], s53 offen sc1
    buffer_load_dwordx4 v[16:19], v117, s[8:11], s29 offen offset:2048 sc1
    buffer_load_dwordx4 v[20:23], v117, s[8:11], s53 offen offset:2048 sc1
    s_add_u32 s46, s46, 1
    s_add_u32 s49, s49, 1
    s_cmp_ge_u32 s49, 0x10000
    s_cbranch_scc1 L_rgo_85
    s_waitcnt vmcnt(7)
    v_mfma_f32_16x16x32_bf16 v[48:51], v[32:35], v[12:15], 0
    v_xor_b32 v52, s33, v32
    s_waitcnt vmcnt(6)
    v_mfma_f32_16x16x32_bf16 v[48:51], v[36:39], v[12:15], v[48:51]
    v_xor_b32 v53, s33, v36
    v_or_b32 v52, v52, v53
    s_waitcnt vmcnt(5)
    v_mfma_f32_16x16x32_bf16 v[48:51], v[40:43], v[12:15], v[48:51]
    v_xor_b32 v53, s33, v40
    v_or_b32 v52, v52, v53
    s_waitcnt vmcnt(4)
    v_mfma_f32_16x16x32_bf16 v[48:51], v[44:47], v[12:15], v[48:51]
    v_xor_b32 v53, s33, v44
    v_or_b32 v52, v52, v53
    v_and_b32 v52, 1, v52
    v_cmp_ne_u32 vcc, 0, v52
    s_cbranch_vccz L_rgo_85
    buffer_load_dwordx4 v[32:35], v117, s[8:11], s29 offen sc1
    buffer_load_dwordx4 v[36:39], v117, s[8:11], s53 offen sc1
    buffer_load_dwordx4 v[40:43], v117, s[8:11], s29 offen offset:2048 sc1
    buffer_load_dwordx4 v[44:47], v117, s[8:11], s53 offen offset:2048 sc1
    s_add_u32 s46, s46, 1
    s_branch L_rl_83
L_bulk:
    s_add_u32 s88, s101, 32
    s_mov_b32 s41, 0
    s_lshr_b32 s20, s101, 6
    s_and_b32 s22, s101, 63
    s_movk_i32 s37, 1000
L_p1go:
    s_mov_b32 s40, 0
    s_mov_b32 s80, 0
    s_mov_b32 s23, 0
L_p1_pass:
    v_mbcnt_lo_u32_b32 v0, -1, 0
    v_mbcnt_hi_u32_b32 v0, -1, v0
    s_lshl_b32 s96, s100, 6
    v_add_u32 v0, s96, v0
    s_load_dwordx2 s[34:35], s[0:1], 16
    s_load_dwordx2 s[30:31], s[0:1], 24
    s_load_dwordx2 s[32:33], s[0:1], 32
    s_load_dwordx2 s[42:43], s[0:1], 40
    s_load_dwordx2 s[12:13], s[0:1], 0
    s_waitcnt lgkmcnt(0)
    s_and_b32 s13, s13, 0xffff
    s_mov_b32 s14, 0x200000
    s_mov_b32 s15, 0x20000
    v_lshrrev_b32 v147, 6, v0
    s_nop 0
    v_readfirstlane_b32 s21, v147
    v_and_b32 v144, 63, v0
    v_lshrrev_b32 v145, 4, v144
    v_and_b32 v146, 15, v144
    v_lshrrev_b32 v149, 2, v146
    v_lshlrev_b32 v137, 4, v144
    s_lshl_b32 s29, s21, 10
    s_lshl_b32 s26, s20, 7
    s_lshl_b32 s27, s21, 5
    s_add_u32 s26, s26, s27
    v_add_u32 v147, s26, v146
    v_lshlrev_b32 v147, 10, v147
    v_lshl_add_u32 v139, v145, 4, v147
    s_mov_b32 s26, 0x0
    buffer_load_dwordx4 v[0:3], v139, s[12:15], s26 offen
    buffer_load_dwordx4 v[4:7], v139, s[12:15], s26 offen offset:64
    buffer_load_dwordx4 v[8:11], v139, s[12:15], s26 offen offset:128
    buffer_load_dwordx4 v[12:15], v139, s[12:15], s26 offen offset:192
    buffer_load_dwordx4 v[16:19], v139, s[12:15], s26 offen offset:256
    buffer_load_dwordx4 v[20:23], v139, s[12:15], s26 offen offset:320
    buffer_load_dwordx4 v[24:27], v139, s[12:15], s26 offen offset:384
    buffer_load_dwordx4 v[28:31], v139, s[12:15], s26 offen offset:448
    buffer_load_dwordx4 v[32:35], v139, s[12:15], s26 offen offset:512
    buffer_load_dwordx4 v[36:39], v139, s[12:15], s26 offen offset:576
    buffer_load_dwordx4 v[40:43], v139, s[12:15], s26 offen offset:640
    buffer_load_dwordx4 v[44:47], v139, s[12:15], s26 offen offset:704
    buffer_load_dwordx4 v[48:51], v139, s[12:15], s26 offen offset:768
    buffer_load_dwordx4 v[52:55], v139, s[12:15], s26 offen offset:832
    buffer_load_dwordx4 v[56:59], v139, s[12:15], s26 offen offset:896
    buffer_load_dwordx4 v[60:63], v139, s[12:15], s26 offen offset:960
    s_mov_b32 s26, 0x4000
    buffer_load_dwordx4 v[64:67], v139, s[12:15], s26 offen
    buffer_load_dwordx4 v[68:71], v139, s[12:15], s26 offen offset:64
    buffer_load_dwordx4 v[72:75], v139, s[12:15], s26 offen offset:128
    buffer_load_dwordx4 v[76:79], v139, s[12:15], s26 offen offset:192
    buffer_load_dwordx4 v[80:83], v139, s[12:15], s26 offen offset:256
    buffer_load_dwordx4 v[84:87], v139, s[12:15], s26 offen offset:320
    buffer_load_dwordx4 v[88:91], v139, s[12:15], s26 offen offset:384
    buffer_load_dwordx4 v[92:95], v139, s[12:15], s26 offen offset:448
    buffer_load_dwordx4 v[96:99], v139, s[12:15], s26 offen offset:512
    buffer_load_dwordx4 v[100:103], v139, s[12:15], s26 offen offset:576
    buffer_load_dwordx4 v[104:107], v139, s[12:15], s26 offen offset:640
    buffer_load_dwordx4 v[108:111], v139, s[12:15], s26 offen offset:704
    buffer_load_dwordx4 v[112:115], v139, s[12:15], s26 offen offset:768
    buffer_load_dwordx4 v[116:119], v139, s[12:15], s26 offen offset:832
    buffer_load_dwordx4 v[120:123], v139, s[12:15], s26 offen offset:896
    buffer_load_dwordx4 v[124:127], v139, s[12:15], s26 offen offset:960
    s_lshr_b32 s26, s21, 1
    s_lshl_b32 s26, s26, 2
    v_or_b32 v148, s26, v145
    v_lshlrev_b32 v148, 1, v148
    v_xor_b32 v148, v148, v146
    v_lshlrev_b32 v148, 4, v148
    s_lshl_b32 s26, s21, 2
    v_add_u32 v147, s26, v145
    v_lshl_add_u32 v136, v147, 13, v148
    v_lshl_add_u32 v147, v145, 3, v149
    v_lshlrev_b32 v147, 8, v147
    v_and_b32 v148, 1, v145
    v_lshl_or_b32 v148, v148, 2, v149
    v_lshl_add_u32 v147, v148, 5, v147
    v_and_b32 v148, 3, v146
    v_lshl_add_u32 v128, v148, 3, v147
    v_xor_b32 v129, 32, v128
    v_xor_b32 v130, 64, v128
    v_xor_b32 v131, 96, v128
    v_xor_b32 v132, 128, v128
    v_xor_b32 v133, 160, v128
    v_xor_b32 v134, 192, v128
    v_xor_b32 v135, 224, v128
    s_mov_b32 s19, 0x20000
    s_mov_b32 s38, s22
    s_mov_b32 s39, s22
    v_mov_b32 v158, 0x3f803f80
    s_waitcnt vmcnt(16)
    v_pk_mov_b32 v[150:151], 0, 0
    v_pk_mov_b32 v[152:153], 0, 0
    v_dot2_f32_bf16 v150, v0, v158, v150
    v_dot2_f32_bf16 v152, v0, v0, v152
    v_dot2_f32_bf16 v151, v1, v158, v151
    v_dot2_f32_bf16 v153, v1, v1, v153
    v_dot2_f32_bf16 v150, v2, v158, v150
    v_dot2_f32_bf16 v152, v2, v2, v152
    v_dot2_f32_bf16 v151, v3, v158, v151
    v_dot2_f32_bf16 v153, v3, v3, v153
    v_dot2_f32_bf16 v150, v4, v158, v150
    v_dot2_f32_bf16 v152, v4, v4, v152
    v_dot2_f32_bf16 v151, v5, v158, v151
    v_dot2_f32_bf16 v153, v5, v5, v153
    v_dot2_f32_bf16 v150, v6, v158, v150
    v_dot2_f32_bf16 v152, v6, v6, v152
    v_dot2_f32_bf16 v151, v7, v158, v151
    v_dot2_f32_bf16 v153, v7, v7, v153
    v_dot2_f32_bf16 v150, v8, v158, v150
    v_dot2_f32_bf16 v152, v8, v8, v152
    v_dot2_f32_bf16 v151, v9, v158, v151
    v_dot2_f32_bf16 v153, v9, v9, v153
    v_dot2_f32_bf16 v150, v10, v158, v150
    v_dot2_f32_bf16 v152, v10, v10, v152
    v_dot2_f32_bf16 v151, v11, v158, v151
    v_dot2_f32_bf16 v153, v11, v11, v153
    v_dot2_f32_bf16 v150, v12, v158, v150
    v_dot2_f32_bf16 v152, v12, v12, v152
    v_dot2_f32_bf16 v151, v13, v158, v151
    v_dot2_f32_bf16 v153, v13, v13, v153
    v_dot2_f32_bf16 v150, v14, v158, v150
    v_dot2_f32_bf16 v152, v14, v14, v152
    v_dot2_f32_bf16 v151, v15, v158, v151
    v_dot2_f32_bf16 v153, v15, v15, v153
    v_dot2_f32_bf16 v150, v16, v158, v150
    v_dot2_f32_bf16 v152, v16, v16, v152
    v_dot2_f32_bf16 v151, v17, v158, v151
    v_dot2_f32_bf16 v153, v17, v17, v153
    v_dot2_f32_bf16 v150, v18, v158, v150
    v_dot2_f32_bf16 v152, v18, v18, v152
    v_dot2_f32_bf16 v151, v19, v158, v151
    v_dot2_f32_bf16 v153, v19, v19, v153
    v_dot2_f32_bf16 v150, v20, v158, v150
    v_dot2_f32_bf16 v152, v20, v20, v152
    v_dot2_f32_bf16 v151, v21, v158, v151
    v_dot2_f32_bf16 v153, v21, v21, v153
    v_dot2_f32_bf16 v150, v22, v158, v150
    v_dot2_f32_bf16 v152, v22, v22, v152
    v_dot2_f32_bf16 v151, v23, v158, v151
    v_dot2_f32_bf16 v153, v23, v23, v153
    v_dot2_f32_bf16 v150, v24, v158, v150
    v_dot2_f32_bf16 v152, v24, v24, v152
    v_dot2_f32_bf16 v151, v25, v158, v151
    v_dot2_f32_bf16 v153, v25, v25, v153
    v_dot2_f32_bf16 v150, v26, v158, v150
    v_dot2_f32_bf16 v152, v26, v26, v152
    v_dot2_f32_bf16 v151, v27, v158, v151
    v_dot2_f32_bf16 v153, v27, v27, v153
    v_dot2_f32_bf16 v150, v28, v158, v150
    v_dot2_f32_bf16 v152, v28, v28, v152
    v_dot2_f32_bf16 v151, v29, v158, v151
    v_dot2_f32_bf16 v153, v29, v29, v153
    v_dot2_f32_bf16 v150, v30, v158, v150
    v_dot2_f32_bf16 v152, v30, v30, v152
    v_dot2_f32_bf16 v151, v31, v158, v151
    v_dot2_f32_bf16 v153, v31, v31, v153
    v_dot2_f32_bf16 v150, v32, v158, v150
    v_dot2_f32_bf16 v152, v32, v32, v152
    v_dot2_f32_bf16 v151, v33, v158, v151
    v_dot2_f32_bf16 v153, v33, v33, v153
    v_dot2_f32_bf16 v150, v34, v158, v150
    v_dot2_f32_bf16 v152, v34, v34, v152
    v_dot2_f32_bf16 v151, v35, v158, v151
    v_dot2_f32_bf16 v153, v35, v35, v153
    v_dot2_f32_bf16 v150, v36, v158, v150
    v_dot2_f32_bf16 v152, v36, v36, v152
    v_dot2_f32_bf16 v151, v37, v158, v151
    v_dot2_f32_bf16 v153, v37, v37, v153
    v_dot2_f32_bf16 v150, v38, v158, v150
    v_dot2_f32_bf16 v152, v38, v38, v152
    v_dot2_f32_bf16 v151, v39, v158, v151
    v_dot2_f32_bf16 v153, v39, v39, v153
    v_dot2_f32_bf16 v150, v40, v158, v150
    v_dot2_f32_bf16 v152, v40, v40, v152
    v_dot2_f32_bf16 v151, v41, v158, v151
    v_dot2_f32_bf16 v153, v41, v41, v153
    v_dot2_f32_bf16 v150, v42, v158, v150
    v_dot2_f32_bf16 v152, v42, v42, v152
    v_dot2_f32_bf16 v151, v43, v158, v151
    v_dot2_f32_bf16 v153, v43, v43, v153
    v_dot2_f32_bf16 v150, v44, v158, v150
    v_dot2_f32_bf16 v152, v44, v44, v152
    v_dot2_f32_bf16 v151, v45, v158, v151
    v_dot2_f32_bf16 v153, v45, v45, v153
    v_dot2_f32_bf16 v150, v46, v158, v150
    v_dot2_f32_bf16 v152, v46, v46, v152
    v_dot2_f32_bf16 v151, v47, v158, v151
    v_dot2_f32_bf16 v153, v47, v47, v153
    v_dot2_f32_bf16 v150, v48, v158, v150
    v_dot2_f32_bf16 v152, v48, v48, v152
    v_dot2_f32_bf16 v151, v49, v158, v151
    v_dot2_f32_bf16 v153, v49, v49, v153
    v_dot2_f32_bf16 v150, v50, v158, v150
    v_dot2_f32_bf16 v152, v50, v50, v152
    v_dot2_f32_bf16 v151, v51, v158, v151
    v_dot2_f32_bf16 v153, v51, v51, v153
    v_dot2_f32_bf16 v150, v52, v158, v150
    v_dot2_f32_bf16 v152, v52, v52, v152
    v_dot2_f32_bf16 v151, v53, v158, v151
    v_dot2_f32_bf16 v153, v53, v53, v153
    v_dot2_f32_bf16 v150, v54, v158, v150
    v_dot2_f32_bf16 v152, v54, v54, v152
    v_dot2_f32_bf16 v151, v55, v158, v151
    v_dot2_f32_bf16 v153, v55, v55, v153
    v_dot2_f32_bf16 v150, v56, v158, v150
    v_dot2_f32_bf16 v152, v56, v56, v152
    v_dot2_f32_bf16 v151, v57, v158, v151
    v_dot2_f32_bf16 v153, v57, v57, v153
    v_dot2_f32_bf16 v150, v58, v158, v150
    v_dot2_f32_bf16 v152, v58, v58, v152
    v_dot2_f32_bf16 v151, v59, v158, v151
    v_dot2_f32_bf16 v153, v59, v59, v153
    v_dot2_f32_bf16 v150, v60, v158, v150
    v_dot2_f32_bf16 v152, v60, v60, v152
    v_dot2_f32_bf16 v151, v61, v158, v151
    v_dot2_f32_bf16 v153, v61, v61, v153
    v_dot2_f32_bf16 v150, v62, v158, v150
    v_dot2_f32_bf16 v152, v62, v62, v152
    v_dot2_f32_bf16 v151, v63, v158, v151
    v_dot2_f32_bf16 v153, v63, v63, v153
    s_nop 1
    v_add_f32 v150, v150, v151
    v_add_f32 v152, v152, v153
    v_mov_b32 v157, v150
    s_nop 1
    v_permlane32_swap_b32 v157, v150
    v_add_f32 v150, v157, v150
    v_mov_b32 v157, v150
    s_nop 1
    v_permlane16_swap_b32 v157, v150
    v_add_f32 v150, v157, v150
    v_mov_b32 v157, v152
    s_nop 1
    v_permlane32_swap_b32 v157, v152
    v_add_f32 v152, v157, v152
    v_mov_b32 v157, v152
    s_nop 1
    v_permlane16_swap_b32 v157, v152
    v_add_f32 v152, v157, v152
    v_mul_f32 v150, 0x3b000000, v150
    v_cvt_pk_bf16_f32 v154, v150, v150
    v_and_b32 v154, 0xffff0000, v154
    v_sub_f32 v156, v150, v154
    v_mul_f32 v157, v150, v150
    v_mul_f32 v152, 0x3b000000, v152
    v_sub_f32 v152, v152, v157
    v_max_f32 v152, 0, v152
    v_cvt_pk_bf16_f32 v152, v152, v152
    v_and_b32 v152, 0xffff0000, v152
    v_add_f32 v152, 0x3727c5ac, v152
    v_cvt_pk_bf16_f32 v152, v152, v152
    v_and_b32 v152, 0xffff0000, v152
    v_sqrt_f32 v152, v152
    s_nop 0
    v_cvt_pk_bf16_f32 v152, v152, v152
    v_and_b32 v152, 0xffff0000, v152
    v_rcp_f32 v152, v152
    v_lshlrev_b32 v160, 16, v0
    v_and_b32 v161, 0xffff0000, v0
    v_lshlrev_b32 v162, 16, v1
    v_and_b32 v163, 0xffff0000, v1
    v_lshlrev_b32 v164, 16, v2
    v_and_b32 v165, 0xffff0000, v2
    v_lshlrev_b32 v166, 16, v3
    v_and_b32 v167, 0xffff0000, v3
    v_lshlrev_b32 v168, 16, v4
    v_and_b32 v169, 0xffff0000, v4
    v_lshlrev_b32 v170, 16, v5
    v_and_b32 v171, 0xffff0000, v5
    v_lshlrev_b32 v172, 16, v6
    v_and_b32 v173, 0xffff0000, v6
    v_lshlrev_b32 v174, 16, v7
    v_and_b32 v175, 0xffff0000, v7
    v_pk_add_f32 v[160:161], v[160:161], v[154:155] op_sel_hi:[1,0] neg_lo:[0,1] neg_hi:[0,1]
    v_pk_add_f32 v[162:163], v[162:163], v[154:155] op_sel_hi:[1,0] neg_lo:[0,1] neg_hi:[0,1]
    v_pk_add_f32 v[164:165], v[164:165], v[154:155] op_sel_hi:[1,0] neg_lo:[0,1] neg_hi:[0,1]
    v_pk_add_f32 v[166:167], v[166:167], v[154:155] op_sel_hi:[1,0] neg_lo:[0,1] neg_hi:[0,1]
    v_pk_add_f32 v[168:169], v[168:169], v[154:155] op_sel_hi:[1,0] neg_lo:[0,1] neg_hi:[0,1]
    v_pk_add_f32 v[170:171], v[170:171], v[154:155] op_sel_hi:[1,0] neg_lo:[0,1] neg_hi:[0,1]
    v_pk_add_f32 v[172:173], v[172:173], v[154:155] op_sel_hi:[1,0] neg_lo:[0,1] neg_hi:[0,1]
    v_pk_add_f32 v[174:175], v[174:175], v[154:155] op_sel_hi:[1,0] neg_lo:[0,1] neg_hi:[0,1]
    v_cvt_pk_bf16_f32 v0, v160, v161
    v_cvt_pk_bf16_f32 v1, v162, v163
    v_cvt_pk_bf16_f32 v2, v164, v165
    v_cvt_pk_bf16_f32 v3, v166, v167
    v_cvt_pk_bf16_f32 v4, v168, v169
    v_cvt_pk_bf16_f32 v5, v170, v171
    v_cvt_pk_bf16_f32 v6, v172, v173
    v_cvt_pk_bf16_f32 v7, v174, v175
    v_lshlrev_b32 v160, 16, v0
    v_and_b32 v161, 0xffff0000, v0
    v_lshlrev_b32 v162, 16, v1
    v_and_b32 v163, 0xffff0000, v1
    v_lshlrev_b32 v164, 16, v2
    v_and_b32 v165, 0xffff0000, v2
    v_lshlrev_b32 v166, 16, v3
    v_and_b32 v167, 0xffff0000, v3
    v_lshlrev_b32 v168, 16, v4
    v_and_b32 v169, 0xffff0000, v4
    v_lshlrev_b32 v170, 16, v5
    v_and_b32 v171, 0xffff0000, v5
    v_lshlrev_b32 v172, 16, v6
    v_and_b32 v173, 0xffff0000, v6
    v_lshlrev_b32 v174, 16, v7
    v_and_b32 v175, 0xffff0000, v7
    v_pk_mul_f32 v[160:161], v[160:161], v[152:153] op_sel_hi:[1,0]
    v_pk_mul_f32 v[162:163], v[162:163], v[152:153] op_sel_hi:[1,0]
    v_pk_mul_f32 v[164:165], v[164:165], v[152:153] op_sel_hi:[1,0]
    v_pk_mul_f32 v[166:167], v[166:167], v[152:153] op_sel_hi:[1,0]
    v_pk_mul_f32 v[168:169], v[168:169], v[152:153] op_sel_hi:[1,0]
    v_pk_mul_f32 v[170:171], v[170:171], v[152:153] op_sel_hi:[1,0]
    v_pk_mul_f32 v[172:173], v[172:173], v[152:153] op_sel_hi:[1,0]
    v_pk_mul_f32 v[174:175], v[174:175], v[152:153] op_sel_hi:[1,0]
    v_cvt_pk_bf16_f32 v160, v160, v161
    v_cvt_pk_bf16_f32 v162, v162, v163
    v_cvt_pk_bf16_f32 v164, v164, v165
    v_cvt_pk_bf16_f32 v166, v166, v167
    v_cvt_pk_bf16_f32 v168, v168, v169
    v_cvt_pk_bf16_f32 v170, v170, v171
    v_cvt_pk_bf16_f32 v172, v172, v173
    v_cvt_pk_bf16_f32 v174, v174, v175
    v_accvgpr_write_b32 a0, v160
    v_accvgpr_write_b32 a1, v162
    v_accvgpr_write_b32 a2, v164
    v_accvgpr_write_b32 a3, v166
    v_accvgpr_write_b32 a4, v168
    v_accvgpr_write_b32 a5, v170
    v_accvgpr_write_b32 a6, v172
    v_accvgpr_write_b32 a7, v174
    v_lshlrev_b32 v160, 16, v8
    v_and_b32 v161, 0xffff0000, v8
    v_lshlrev_b32 v162, 16, v9
    v_and_b32 v163, 0xffff0000, v9
    v_lshlrev_b32 v164, 16, v10
    v_and_b32 v165, 0xffff0000, v10
    v_lshlrev_b32 v166, 16, v11
    v_and_b32 v167, 0xffff0000, v11
    v_lshlrev_b32 v168, 16, v12
    v_and_b32 v169, 0xffff0000, v12
    v_lshlrev_b32 v170, 16, v13
    v_and_b32 v171, 0xffff0000, v13
    v_lshlrev_b32 v172, 16, v14
    v_and_b32 v173, 0xffff0000, v14
    v_lshlrev_b32 v174, 16, v15
    v_and_b32 v175, 0xffff0000, v15
    v_pk_add_f32 v[160:161], v[160:161], v[154:155] op_sel_hi:[1,0] neg_lo:[0,1] neg_hi:[0,1]
    v_pk_add_f32 v[162:163], v[162:163], v[154:155] op_sel_hi:[1,0] neg_lo:[0,1] neg_hi:[0,1]
    v_pk_add_f32 v[164:165], v[164:165], v[154:155] op_sel_hi:[1,0] neg_lo:[0,1] neg_hi:[0,1]
    v_pk_add_f32 v[166:167], v[166:167], v[154:155] op_sel_hi:[1,0] neg_lo:[0,1] neg_hi:[0,1]
    v_pk_add_f32 v[168:169], v[168:169], v[154:155] op_sel_hi:[1,0] neg_lo:[0,1] neg_hi:[0,1]
    v_pk_add_f32 v[170:171], v[170:171], v[154:155] op_sel_hi:[1,0] neg_lo:[0,1] neg_hi:[0,1]
    v_pk_add_f32 v[172:173], v[172:173], v[154:155] op_sel_hi:[1,0] neg_lo:[0,1] neg_hi:[0,1]
    v_pk_add_f32 v[174:175], v[174:175], v[154:155] op_sel_hi:[1,0] neg_lo:[0,1] neg_hi:[0,1]
    v_cvt_pk_bf16_f32 v8, v160, v161
    v_cvt_pk_bf16_f32 v9, v162, v163
    v_cvt_pk_bf16_f32 v10, v164, v165
    v_cvt_pk_bf16_f32 v11, v166, v167
    v_cvt_pk_bf16_f32 v12, v168, v169
    v_cvt_pk_bf16_f32 v13, v170, v171
    v_cvt_pk_bf16_f32 v14, v172, v173
    v_cvt_pk_bf16_f32 v15, v174, v175
    v_lshlrev_b32 v160, 16, v8
    v_and_b32 v161, 0xffff0000, v8
    v_lshlrev_b32 v162, 16, v9
    v_and_b32 v163, 0xffff0000, v9
    v_lshlrev_b32 v164, 16, v10
    v_and_b32 v165, 0xffff0000, v10
    v_lshlrev_b32 v166, 16, v11
    v_and_b32 v167, 0xffff0000, v11
    v_lshlrev_b32 v168, 16, v12
    v_and_b32 v169, 0xffff0000, v12
    v_lshlrev_b32 v170, 16, v13
    v_and_b32 v171, 0xffff0000, v13
    v_lshlrev_b32 v172, 16, v14
    v_and_b32 v173, 0xffff0000, v14
    v_lshlrev_b32 v174, 16, v15
    v_and_b32 v175, 0xffff0000, v15
    v_pk_mul_f32 v[160:161], v[160:161], v[152:153] op_sel_hi:[1,0]
    v_pk_mul_f32 v[162:163], v[162:163], v[152:153] op_sel_hi:[1,0]
    v_pk_mul_f32 v[164:165], v[164:165], v[152:153] op_sel_hi:[1,0]
    v_pk_mul_f32 v[166:167], v[166:167], v[152:153] op_sel_hi:[1,0]
    v_pk_mul_f32 v[168:169], v[168:169], v[152:153] op_sel_hi:[1,0]
    v_pk_mul_f32 v[170:171], v[170:171], v[152:153] op_sel_hi:[1,0]
    v_pk_mul_f32 v[172:173], v[172:173], v[152:153] op_sel_hi:[1,0]
    v_pk_mul_f32 v[174:175], v[174:175], v[152:153] op_sel_hi:[1,0]
    v_cvt_pk_bf16_f32 v160, v160, v161
    v_cvt_pk_bf16_f32 v162, v162, v163
    v_cvt_pk_bf16_f32 v164, v164, v165
    v_cvt_pk_bf16_f32 v166, v166, v167
    v_cvt_pk_bf16_f32 v168, v168, v169
    v_cvt_pk_bf16_f32 v170, v170, v171
    v_cvt_pk_bf16_f32 v172, v172, v173
    v_cvt_pk_bf16_f32 v174, v174, v175
    v_accvgpr_write_b32 a8, v160
    v_accvgpr_write_b32 a9, v162
    v_accvgpr_write_b32 a10, v164
    v_accvgpr_write_b32 a11, v166
    v_accvgpr_write_b32 a12, v168
    v_accvgpr_write_b32 a13, v170
    v_accvgpr_write_b32 a14, v172
    v_accvgpr_write_b32 a15, v174
    v_lshlrev_b32 v160, 16, v16
    v_and_b32 v161, 0xffff0000, v16
    v_lshlrev_b32 v162, 16, v17
    v_and_b32 v163, 0xffff0000, v17
    v_lshlrev_b32 v164, 16, v18
    v_and_b32 v165, 0xffff0000, v18
    v_lshlrev_b32 v166, 16, v19
    v_and_b32 v167, 0xffff0000, v19
    v_lshlrev_b32 v168, 16, v20
    v_and_b32 v169, 0xffff0000, v20
    v_lshlrev_b32 v170, 16, v21
    v_and_b32 v171, 0xffff0000, v21
    v_lshlrev_b32 v172, 16, v22
    v_and_b32 v173, 0xffff0000, v22
    v_lshlrev_b32 v174, 16, v23
    v_and_b32 v175, 0xffff0000, v23
    v_pk_add_f32 v[160:161], v[160:161], v[154:155] op_sel_hi:[1,0] neg_lo:[0,1] neg_hi:[0,1]
    v_pk_add_f32 v[162:163], v[162:163], v[154:155] op_sel_hi:[1,0] neg_lo:[0,1] neg_hi:[0,1]
    v_pk_add_f32 v[164:165], v[164:165], v[154:155] op_sel_hi:[1,0] neg_lo:[0,1] neg_hi:[0,1]
    v_pk_add_f32 v[166:167], v[166:167], v[154:155] op_sel_hi:[1,0] neg_lo:[0,1] neg_hi:[0,1]
    v_pk_add_f32 v[168:169], v[168:169], v[154:155] op_sel_hi:[1,0] neg_lo:[0,1] neg_hi:[0,1]
    v_pk_add_f32 v[170:171], v[170:171], v[154:155] op_sel_hi:[1,0] neg_lo:[0,1] neg_hi:[0,1]
    v_pk_add_f32 v[172:173], v[172:173], v[154:155] op_sel_hi:[1,0] neg_lo:[0,1] neg_hi:[0,1]
    v_pk_add_f32 v[174:175], v[174:175], v[154:155] op_sel_hi:[1,0] neg_lo:[0,1] neg_hi:[0,1]
    v_cvt_pk_bf16_f32 v16, v160, v161
    v_cvt_pk_bf16_f32 v17, v162, v163
    v_cvt_pk_bf16_f32 v18, v164, v165
    v_cvt_pk_bf16_f32 v19, v166, v167
    v_cvt_pk_bf16_f32 v20, v168, v169
    v_cvt_pk_bf16_f32 v21, v170, v171
    v_cvt_pk_bf16_f32 v22, v172, v173
    v_cvt_pk_bf16_f32 v23, v174, v175
    v_lshlrev_b32 v160, 16, v16
    v_and_b32 v161, 0xffff0000, v16
    v_lshlrev_b32 v162, 16, v17
    v_and_b32 v163, 0xffff0000, v17
    v_lshlrev_b32 v164, 16, v18
    v_and_b32 v165, 0xffff0000, v18
    v_lshlrev_b32 v166, 16, v19
    v_and_b32 v167, 0xffff0000, v19
    v_lshlrev_b32 v168, 16, v20
    v_and_b32 v169, 0xffff0000, v20
    v_lshlrev_b32 v170, 16, v21
    v_and_b32 v171, 0xffff0000, v21
    v_lshlrev_b32 v172, 16, v22
    v_and_b32 v173, 0xffff0000, v22
    v_lshlrev_b32 v174, 16, v23
    v_and_b32 v175, 0xffff0000, v23
    v_pk_mul_f32 v[160:161], v[160:161], v[152:153] op_sel_hi:[1,0]
    v_pk_mul_f32 v[162:163], v[162:163], v[152:153] op_sel_hi:[1,0]
    v_pk_mul_f32 v[164:165], v[164:165], v[152:153] op_sel_hi:[1,0]
    v_pk_mul_f32 v[166:167], v[166:167], v[152:153] op_sel_hi:[1,0]
    v_pk_mul_f32 v[168:169], v[168:169], v[152:153] op_sel_hi:[1,0]
    v_pk_mul_f32 v[170:171], v[170:171], v[152:153] op_sel_hi:[1,0]
    v_pk_mul_f32 v[172:173], v[172:173], v[152:153] op_sel_hi:[1,0]
    v_pk_mul_f32 v[174:175], v[174:175], v[152:153] op_sel_hi:[1,0]
    v_cvt_pk_bf16_f32 v160, v160, v161
    v_cvt_pk_bf16_f32 v162, v162, v163
    v_cvt_pk_bf16_f32 v164, v164, v165
    v_cvt_pk_bf16_f32 v166, v166, v167
    v_cvt_pk_bf16_f32 v168, v168, v169
    v_cvt_pk_bf16_f32 v170, v170, v171
    v_cvt_pk_bf16_f32 v172, v172, v173
    v_cvt_pk_bf16_f32 v174, v174, v175
    v_accvgpr_write_b32 a16, v160
    v_accvgpr_write_b32 a17, v162
    v_accvgpr_write_b32 a18, v164
    v_accvgpr_write_b32 a19, v166
    v_accvgpr_write_b32 a20, v168
    v_accvgpr_write_b32 a21, v170
    v_accvgpr_write_b32 a22, v172
    v_accvgpr_write_b32 a23, v174
    v_lshlrev_b32 v160, 16, v24
    v_and_b32 v161, 0xffff0000, v24
    v_lshlrev_b32 v162, 16, v25
    v_and_b32 v163, 0xffff0000, v25
    v_lshlrev_b32 v164, 16, v26
    v_and_b32 v165, 0xffff0000, v26
    v_lshlrev_b32 v166, 16, v27
    v_and_b32 v167, 0xffff0000, v27
    v_lshlrev_b32 v168, 16, v28
    v_and_b32 v169, 0xffff0000, v28
    v_lshlrev_b32 v170, 16, v29
    v_and_b32 v171, 0xffff0000, v29
    v_lshlrev_b32 v172, 16, v30
    v_and_b32 v173, 0xffff0000, v30
    v_lshlrev_b32 v174, 16, v31
    v_and_b32 v175, 0xffff0000, v31
    v_pk_add_f32 v[160:161], v[160:161], v[154:155] op_sel_hi:[1,0] neg_lo:[0,1] neg_hi:[0,1]
    v_pk_add_f32 v[162:163], v[162:163], v[154:155] op_sel_hi:[1,0] neg_lo:[0,1] neg_hi:[0,1]
    v_pk_add_f32 v[164:165], v[164:165], v[154:155] op_sel_hi:[1,0] neg_lo:[0,1] neg_hi:[0,1]
    v_pk_add_f32 v[166:167], v[166:167], v[154:155] op_sel_hi:[1,0] neg_lo:[0,1] neg_hi:[0,1]
    v_pk_add_f32 v[168:169], v[168:169], v[154:155] op_sel_hi:[1,0] neg_lo:[0,1] neg_hi:[0,1]
    v_pk_add_f32 v[170:171], v[170:171], v[154:155] op_sel_hi:[1,0] neg_lo:[0,1] neg_hi:[0,1]
    v_pk_add_f32 v[172:173], v[172:173], v[154:155] op_sel_hi:[1,0] neg_lo:[0,1] neg_hi:[0,1]
    v_pk_add_f32 v[174:175], v[174:175], v[154:155] op_sel_hi:[1,0] neg_lo:[0,1] neg_hi:[0,1]
    v_cvt_pk_bf16_f32 v24, v160, v161
    v_cvt_pk_bf16_f32 v25, v162, v163
    v_cvt_pk_bf16_f32 v26, v164, v165
    v_cvt_pk_bf16_f32 v27, v166, v167
    v_cvt_pk_bf16_f32 v28, v168, v169
    v_cvt_pk_bf16_f32 v29, v170, v171
    v_cvt_pk_bf16_f32 v30, v172, v173
    v_cvt_pk_bf16_f32 v31, v174, v175
    v_lshlrev_b32 v160, 16, v24
    v_and_b32 v161, 0xffff0000, v24
    v_lshlrev_b32 v162, 16, v25
    v_and_b32 v163, 0xffff0000, v25
    v_lshlrev_b32 v164, 16, v26
    v_and_b32 v165, 0xffff0000, v26
    v_lshlrev_b32 v166, 16, v27
    v_and_b32 v167, 0xffff0000, v27
    v_lshlrev_b32 v168, 16, v28
    v_and_b32 v169, 0xffff0000, v28
    v_lshlrev_b32 v170, 16, v29
    v_and_b32 v171, 0xffff0000, v29
    v_lshlrev_b32 v172, 16, v30
    v_and_b32 v173, 0xffff0000, v30
    v_lshlrev_b32 v174, 16, v31
    v_and_b32 v175, 0xffff0000, v31
    v_pk_mul_f32 v[160:161], v[160:161], v[152:153] op_sel_hi:[1,0]
    v_pk_mul_f32 v[162:163], v[162:163], v[152:153] op_sel_hi:[1,0]
    v_pk_mul_f32 v[164:165], v[164:165], v[152:153] op_sel_hi:[1,0]
    v_pk_mul_f32 v[166:167], v[166:167], v[152:153] op_sel_hi:[1,0]
    v_pk_mul_f32 v[168:169], v[168:169], v[152:153] op_sel_hi:[1,0]
    v_pk_mul_f32 v[170:171], v[170:171], v[152:153] op_sel_hi:[1,0]
    v_pk_mul_f32 v[172:173], v[172:173], v[152:153] op_sel_hi:[1,0]
    v_pk_mul_f32 v[174:175], v[174:175], v[152:153] op_sel_hi:[1,0]
    v_cvt_pk_bf16_f32 v160, v160, v161
    v_cvt_pk_bf16_f32 v162, v162, v163
    v_cvt_pk_bf16_f32 v164, v164, v165
    v_cvt_pk_bf16_f32 v166, v166, v167
    v_cvt_pk_bf16_f32 v168, v168, v169
    v_cvt_pk_bf16_f32 v170, v170, v171
    v_cvt_pk_bf16_f32 v172, v172, v173
    v_cvt_pk_bf16_f32 v174, v174, v175
    v_accvgpr_write_b32 a24, v160
    v_accvgpr_write_b32 a25, v162
    v_accvgpr_write_b32 a26, v164
    v_accvgpr_write_b32 a27, v166
    v_accvgpr_write_b32 a28, v168
    v_accvgpr_write_b32 a29, v170
    v_accvgpr_write_b32 a30, v172
    v_accvgpr_write_b32 a31, v174
    v_lshlrev_b32 v160, 16, v32
    v_and_b32 v161, 0xffff0000, v32
    v_lshlrev_b32 v162, 16, v33
    v_and_b32 v163, 0xffff0000, v33
    v_lshlrev_b32 v164, 16, v34
    v_and_b32 v165, 0xffff0000, v34
    v_lshlrev_b32 v166, 16, v35
    v_and_b32 v167, 0xffff0000, v35
    v_lshlrev_b32 v168, 16, v36
    v_and_b32 v169, 0xffff0000, v36
    v_lshlrev_b32 v170, 16, v37
    v_and_b32 v171, 0xffff0000, v37
    v_lshlrev_b32 v172, 16, v38
    v_and_b32 v173, 0xffff0000, v38
    v_lshlrev_b32 v174, 16, v39
    v_and_b32 v175, 0xffff0000, v39
    v_pk_add_f32 v[160:161], v[160:161], v[154:155] op_sel_hi:[1,0] neg_lo:[0,1] neg_hi:[0,1]
    v_pk_add_f32 v[162:163], v[162:163], v[154:155] op_sel_hi:[1,0] neg_lo:[0,1] neg_hi:[0,1]
    v_pk_add_f32 v[164:165], v[164:165], v[154:155] op_sel_hi:[1,0] neg_lo:[0,1] neg_hi:[0,1]
    v_pk_add_f32 v[166:167], v[166:167], v[154:155] op_sel_hi:[1,0] neg_lo:[0,1] neg_hi:[0,1]
    v_pk_add_f32 v[168:169], v[168:169], v[154:155] op_sel_hi:[1,0] neg_lo:[0,1] neg_hi:[0,1]
    v_pk_add_f32 v[170:171], v[170:171], v[154:155] op_sel_hi:[1,0] neg_lo:[0,1] neg_hi:[0,1]
    v_pk_add_f32 v[172:173], v[172:173], v[154:155] op_sel_hi:[1,0] neg_lo:[0,1] neg_hi:[0,1]
    v_pk_add_f32 v[174:175], v[174:175], v[154:155] op_sel_hi:[1,0] neg_lo:[0,1] neg_hi:[0,1]
    v_cvt_pk_bf16_f32 v32, v160, v161
    v_cvt_pk_bf16_f32 v33, v162, v163
    v_cvt_pk_bf16_f32 v34, v164, v165
    v_cvt_pk_bf16_f32 v35, v166, v167
    v_cvt_pk_bf16_f32 v36, v168, v169
    v_cvt_pk_bf16_f32 v37, v170, v171
    v_cvt_pk_bf16_f32 v38, v172, v173
    v_cvt_pk_bf16_f32 v39, v174, v175
    v_lshlrev_b32 v160, 16, v32
    v_and_b32 v161, 0xffff0000, v32
    v_lshlrev_b32 v162, 16, v33
    v_and_b32 v163, 0xffff0000, v33
    v_lshlrev_b32 v164, 16, v34
    v_and_b32 v165, 0xffff0000, v34
    v_lshlrev_b32 v166, 16, v35
    v_and_b32 v167, 0xffff0000, v35
    v_lshlrev_b32 v168, 16, v36
    v_and_b32 v169, 0xffff0000, v36
    v_lshlrev_b32 v170, 16, v37
    v_and_b32 v171, 0xffff0000, v37
    v_lshlrev_b32 v172, 16, v38
    v_and_b32 v173, 0xffff0000, v38
    v_lshlrev_b32 v174, 16, v39
    v_and_b32 v175, 0xffff0000, v39
    v_pk_mul_f32 v[160:161], v[160:161], v[152:153] op_sel_hi:[1,0]
    v_pk_mul_f32 v[162:163], v[162:163], v[152:153] op_sel_hi:[1,0]
    v_pk_mul_f32 v[164:165], v[164:165], v[152:153] op_sel_hi:[1,0]
    v_pk_mul_f32 v[166:167], v[166:167], v[152:153] op_sel_hi:[1,0]
    v_pk_mul_f32 v[168:169], v[168:169], v[152:153] op_sel_hi:[1,0]
    v_pk_mul_f32 v[170:171], v[170:171], v[152:153] op_sel_hi:[1,0]
    v_pk_mul_f32 v[172:173], v[172:173], v[152:153] op_sel_hi:[1,0]
    v_pk_mul_f32 v[174:175], v[174:175], v[152:153] op_sel_hi:[1,0]
    v_cvt_pk_bf16_f32 v160, v160, v161
    v_cvt_pk_bf16_f32 v162, v162, v163
    v_cvt_pk_bf16_f32 v164, v164, v165
    v_cvt_pk_bf16_f32 v166, v166, v167
    v_cvt_pk_bf16_f32 v168, v168, v169
    v_cvt_pk_bf16_f32 v170, v170, v171
    v_cvt_pk_bf16_f32 v172, v172, v173
    v_cvt_pk_bf16_f32 v174, v174, v175
    v_accvgpr_write_b32 a32, v160
    v_accvgpr_write_b32 a33, v162
    v_accvgpr_write_b32 a34, v164
    v_accvgpr_write_b32 a35, v166
    v_accvgpr_write_b32 a36, v168
    v_accvgpr_write_b32 a37, v170
    v_accvgpr_write_b32 a38, v172
    v_accvgpr_write_b32 a39, v174
    v_lshlrev_b32 v160, 16, v40
    v_and_b32 v161, 0xffff0000, v40
    v_lshlrev_b32 v162, 16, v41
    v_and_b32 v163, 0xffff0000, v41
    v_lshlrev_b32 v164, 16, v42
    v_and_b32 v165, 0xffff0000, v42
    v_lshlrev_b32 v166, 16, v43
    v_and_b32 v167, 0xffff0000, v43
    v_lshlrev_b32 v168, 16, v44
    v_and_b32 v169, 0xffff0000, v44
    v_lshlrev_b32 v170, 16, v45
    v_and_b32 v171, 0xffff0000, v45
    v_lshlrev_b32 v172, 16, v46
    v_and_b32 v173, 0xffff0000, v46
    v_lshlrev_b32 v174, 16, v47
    v_and_b32 v175, 0xffff0000, v47
    v_pk_add_f32 v[160:161], v[160:161], v[154:155] op_sel_hi:[1,0] neg_lo:[0,1] neg_hi:[0,1]
    v_pk_add_f32 v[162:163], v[162:163], v[154:155] op_sel_hi:[1,0] neg_lo:[0,1] neg_hi:[0,1]
    v_pk_add_f32 v[164:165], v[164:165], v[154:155] op_sel_hi:[1,0] neg_lo:[0,1] neg_hi:[0,1]
    v_pk_add_f32 v[166:167], v[166:167], v[154:155] op_sel_hi:[1,0] neg_lo:[0,1] neg_hi:[0,1]
    v_pk_add_f32 v[168:169], v[168:169], v[154:155] op_sel_hi:[1,0] neg_lo:[0,1] neg_hi:[0,1]
    v_pk_add_f32 v[170:171], v[170:171], v[154:155] op_sel_hi:[1,0] neg_lo:[0,1] neg_hi:[0,1]
    v_pk_add_f32 v[172:173], v[172:173], v[154:155] op_sel_hi:[1,0] neg_lo:[0,1] neg_hi:[0,1]
    v_pk_add_f32 v[174:175], v[174:175], v[154:155] op_sel_hi:[1,0] neg_lo:[0,1] neg_hi:[0,1]
    v_cvt_pk_bf16_f32 v40, v160, v161
    v_cvt_pk_bf16_f32 v41, v162, v163
    v_cvt_pk_bf16_f32 v42, v164, v165
    v_cvt_pk_bf16_f32 v43, v166, v167
    v_cvt_pk_bf16_f32 v44, v168, v169
    v_cvt_pk_bf16_f32 v45, v170, v171
    v_cvt_pk_bf16_f32 v46, v172, v173
    v_cvt_pk_bf16_f32 v47, v174, v175
    v_lshlrev_b32 v160, 16, v40
    v_and_b32 v161, 0xffff0000, v40
    v_lshlrev_b32 v162, 16, v41
    v_and_b32 v163, 0xffff0000, v41
    v_lshlrev_b32 v164, 16, v42
    v_and_b32 v165, 0xffff0000, v42
    v_lshlrev_b32 v166, 16, v43
    v_and_b32 v167, 0xffff0000, v43
    v_lshlrev_b32 v168, 16, v44
    v_and_b32 v169, 0xffff0000, v44
    v_lshlrev_b32 v170, 16, v45
    v_and_b32 v171, 0xffff0000, v45
    v_lshlrev_b32 v172, 16, v46
    v_and_b32 v173, 0xffff0000, v46
    v_lshlrev_b32 v174, 16, v47
    v_and_b32 v175, 0xffff0000, v47
    v_pk_mul_f32 v[160:161], v[160:161], v[152:153] op_sel_hi:[1,0]
    v_pk_mul_f32 v[162:163], v[162:163], v[152:153] op_sel_hi:[1,0]
    v_pk_mul_f32 v[164:165], v[164:165], v[152:153] op_sel_hi:[1,0]
    v_pk_mul_f32 v[166:167], v[166:167], v[152:153] op_sel_hi:[1,0]
    v_pk_mul_f32 v[168:169], v[168:169], v[152:153] op_sel_hi:[1,0]
    v_pk_mul_f32 v[170:171], v[170:171], v[152:153] op_sel_hi:[1,0]
    v_pk_mul_f32 v[172:173], v[172:173], v[152:153] op_sel_hi:[1,0]
    v_pk_mul_f32 v[174:175], v[174:175], v[152:153] op_sel_hi:[1,0]
    v_cvt_pk_bf16_f32 v160, v160, v161
    v_cvt_pk_bf16_f32 v162, v162, v163
    v_cvt_pk_bf16_f32 v164, v164, v165
    v_cvt_pk_bf16_f32 v166, v166, v167
    v_cvt_pk_bf16_f32 v168, v168, v169
    v_cvt_pk_bf16_f32 v170, v170, v171
    v_cvt_pk_bf16_f32 v172, v172, v173
    v_cvt_pk_bf16_f32 v174, v174, v175
    v_accvgpr_write_b32 a40, v160
    v_accvgpr_write_b32 a41, v162
    v_accvgpr_write_b32 a42, v164
    v_accvgpr_write_b32 a43, v166
    v_accvgpr_write_b32 a44, v168
    v_accvgpr_write_b32 a45, v170
    v_accvgpr_write_b32 a46, v172
    v_accvgpr_write_b32 a47, v174
    v_lshlrev_b32 v160, 16, v48
    v_and_b32 v161, 0xffff0000, v48
    v_lshlrev_b32 v162, 16, v49
    v_and_b32 v163, 0xffff0000, v49
    v_lshlrev_b32 v164, 16, v50
    v_and_b32 v165, 0xffff0000, v50
    v_lshlrev_b32 v166, 16, v51
    v_and_b32 v167, 0xffff0000, v51
    v_lshlrev_b32 v168, 16, v52
    v_and_b32 v169, 0xffff0000, v52
    v_lshlrev_b32 v170, 16, v53
    v_and_b32 v171, 0xffff0000, v53
    v_lshlrev_b32 v172, 16, v54
    v_and_b32 v173, 0xffff0000, v54
    v_lshlrev_b32 v174, 16, v55
    v_and_b32 v175, 0xffff0000, v55
    v_pk_add_f32 v[160:161], v[160:161], v[154:155] op_sel_hi:[1,0] neg_lo:[0,1] neg_hi:[0,1]
    v_pk_add_f32 v[162:163], v[162:163], v[154:155] op_sel_hi:[1,0] neg_lo:[0,1] neg_hi:[0,1]
    v_pk_add_f32 v[164:165], v[164:165], v[154:155] op_sel_hi:[1,0] neg_lo:[0,1] neg_hi:[0,1]
    v_pk_add_f32 v[166:167], v[166:167], v[154:155] op_sel_hi:[1,0] neg_lo:[0,1] neg_hi:[0,1]
    v_pk_add_f32 v[168:169], v[168:169], v[154:155] op_sel_hi:[1,0] neg_lo:[0,1] neg_hi:[0,1]
    v_pk_add_f32 v[170:171], v[170:171], v[154:155] op_sel_hi:[1,0] neg_lo:[0,1] neg_hi:[0,1]
    v_pk_add_f32 v[172:173], v[172:173], v[154:155] op_sel_hi:[1,0] neg_lo:[0,1] neg_hi:[0,1]
    v_pk_add_f32 v[174:175], v[174:175], v[154:155] op_sel_hi:[1,0] neg_lo:[0,1] neg_hi:[0,1]
    v_cvt_pk_bf16_f32 v48, v160, v161
    v_cvt_pk_bf16_f32 v49, v162, v163
    v_cvt_pk_bf16_f32 v50, v164, v165
    v_cvt_pk_bf16_f32 v51, v166, v167
    v_cvt_pk_bf16_f32 v52, v168, v169
    v_cvt_pk_bf16_f32 v53, v170, v171
    v_cvt_pk_bf16_f32 v54, v172, v173
    v_cvt_pk_bf16_f32 v55, v174, v175
    v_lshlrev_b32 v160, 16, v48
    v_and_b32 v161, 0xffff0000, v48
    v_lshlrev_b32 v162, 16, v49
    v_and_b32 v163, 0xffff0000, v49
    v_lshlrev_b32 v164, 16, v50
    v_and_b32 v165, 0xffff0000, v50
    v_lshlrev_b32 v166, 16, v51
    v_and_b32 v167, 0xffff0000, v51
    v_lshlrev_b32 v168, 16, v52
    v_and_b32 v169, 0xffff0000, v52
    v_lshlrev_b32 v170, 16, v53
    v_and_b32 v171, 0xffff0000, v53
    v_lshlrev_b32 v172, 16, v54
    v_and_b32 v173, 0xffff0000, v54
    v_lshlrev_b32 v174, 16, v55
    v_and_b32 v175, 0xffff0000, v55
    v_pk_mul_f32 v[160:161], v[160:161], v[152:153] op_sel_hi:[1,0]
    v_pk_mul_f32 v[162:163], v[162:163], v[152:153] op_sel_hi:[1,0]
    v_pk_mul_f32 v[164:165], v[164:165], v[152:153] op_sel_hi:[1,0]
    v_pk_mul_f32 v[166:167], v[166:167], v[152:153] op_sel_hi:[1,0]
    v_pk_mul_f32 v[168:169], v[168:169], v[152:153] op_sel_hi:[1,0]
    v_pk_mul_f32 v[170:171], v[170:171], v[152:153] op_sel_hi:[1,0]
    v_pk_mul_f32 v[172:173], v[172:173], v[152:153] op_sel_hi:[1,0]
    v_pk_mul_f32 v[174:175], v[174:175], v[152:153] op_sel_hi:[1,0]
    v_cvt_pk_bf16_f32 v160, v160, v161
    v_cvt_pk_bf16_f32 v162, v162, v163
    v_cvt_pk_bf16_f32 v164, v164, v165
    v_cvt_pk_bf16_f32 v166, v166, v167
    v_cvt_pk_bf16_f32 v168, v168, v169
    v_cvt_pk_bf16_f32 v170, v170, v171
    v_cvt_pk_bf16_f32 v172, v172, v173
    v_cvt_pk_bf16_f32 v174, v174, v175
    v_accvgpr_write_b32 a48, v160
    v_accvgpr_write_b32 a49, v162
    v_accvgpr_write_b32 a50, v164
    v_accvgpr_write_b32 a51, v166
    v_accvgpr_write_b32 a52, v168
    v_accvgpr_write_b32 a53, v170
    v_accvgpr_write_b32 a54, v172
    v_accvgpr_write_b32 a55, v174
    v_lshlrev_b32 v160, 16, v56
    v_and_b32 v161, 0xffff0000, v56
    v_lshlrev_b32 v162, 16, v57
    v_and_b32 v163, 0xffff0000, v57
    v_lshlrev_b32 v164, 16, v58
    v_and_b32 v165, 0xffff0000, v58
    v_lshlrev_b32 v166, 16, v59
    v_and_b32 v167, 0xffff0000, v59
    v_lshlrev_b32 v168, 16, v60
    v_and_b32 v169, 0xffff0000, v60
    v_lshlrev_b32 v170, 16, v61
    v_and_b32 v171, 0xffff0000, v61
    v_lshlrev_b32 v172, 16, v62
    v_and_b32 v173, 0xffff0000, v62
    v_lshlrev_b32 v174, 16, v63
    v_and_b32 v175, 0xffff0000, v63
    v_pk_add_f32 v[160:161], v[160:161], v[154:155] op_sel_hi:[1,0] neg_lo:[0,1] neg_hi:[0,1]
    v_pk_add_f32 v[162:163], v[162:163], v[154:155] op_sel_hi:[1,0] neg_lo:[0,1] neg_hi:[0,1]
    v_pk_add_f32 v[164:165], v[164:165], v[154:155] op_sel_hi:[1,0] neg_lo:[0,1] neg_hi:[0,1]
    v_pk_add_f32 v[166:167], v[166:167], v[154:155] op_sel_hi:[1,0] neg_lo:[0,1] neg_hi:[0,1]
    v_pk_add_f32 v[168:169], v[168:169], v[154:155] op_sel_hi:[1,0] neg_lo:[0,1] neg_hi:[0,1]
    v_pk_add_f32 v[170:171], v[170:171], v[154:155] op_sel_hi:[1,0] neg_lo:[0,1] neg_hi:[0,1]
    v_pk_add_f32 v[172:173], v[172:173], v[154:155] op_sel_hi:[1,0] neg_lo:[0,1] neg_hi:[0,1]
    v_pk_add_f32 v[174:175], v[174:175], v[154:155] op_sel_hi:[1,0] neg_lo:[0,1] neg_hi:[0,1]
    v_cvt_pk_bf16_f32 v56, v160, v161
    v_cvt_pk_bf16_f32 v57, v162, v163
    v_cvt_pk_bf16_f32 v58, v164, v165
    v_cvt_pk_bf16_f32 v59, v166, v167
    v_cvt_pk_bf16_f32 v60, v168, v169
    v_cvt_pk_bf16_f32 v61, v170, v171
    v_cvt_pk_bf16_f32 v62, v172, v173
    v_cvt_pk_bf16_f32 v63, v174, v175
    v_lshlrev_b32 v160, 16, v56
    v_and_b32 v161, 0xffff0000, v56
    v_lshlrev_b32 v162, 16, v57
    v_and_b32 v163, 0xffff0000, v57
    v_lshlrev_b32 v164, 16, v58
    v_and_b32 v165, 0xffff0000, v58
    v_lshlrev_b32 v166, 16, v59
    v_and_b32 v167, 0xffff0000, v59
    v_lshlrev_b32 v168, 16, v60
    v_and_b32 v169, 0xffff0000, v60
    v_lshlrev_b32 v170, 16, v61
    v_and_b32 v171, 0xffff0000, v61
    v_lshlrev_b32 v172, 16, v62
    v_and_b32 v173, 0xffff0000, v62
    v_lshlrev_b32 v174, 16, v63
    v_and_b32 v175, 0xffff0000, v63
    v_pk_mul_f32 v[160:161], v[160:161], v[152:153] op_sel_hi:[1,0]
    v_pk_mul_f32 v[162:163], v[162:163], v[152:153] op_sel_hi:[1,0]
    v_pk_mul_f32 v[164:165], v[164:165], v[152:153] op_sel_hi:[1,0]
    v_pk_mul_f32 v[166:167], v[166:167], v[152:153] op_sel_hi:[1,0]
    v_pk_mul_f32 v[168:169], v[168:169], v[152:153] op_sel_hi:[1,0]
    v_pk_mul_f32 v[170:171], v[170:171], v[152:153] op_sel_hi:[1,0]
    v_pk_mul_f32 v[172:173], v[172:173], v[152:153] op_sel_hi:[1,0]
    v_pk_mul_f32 v[174:175], v[174:175], v[152:153] op_sel_hi:[1,0]
    v_cvt_pk_bf16_f32 v160, v160, v161
    v_cvt_pk_bf16_f32 v162, v162, v163
    v_cvt_pk_bf16_f32 v164, v164, v165
    v_cvt_pk_bf16_f32 v166, v166, v167
    v_cvt_pk_bf16_f32 v168, v168, v169
    v_cvt_pk_bf16_f32 v170, v170, v171
    v_cvt_pk_bf16_f32 v172, v172, v173
    v_cvt_pk_bf16_f32 v174, v174, v175
    v_accvgpr_write_b32 a56, v160
    v_accvgpr_write_b32 a57, v162
    v_accvgpr_write_b32 a58, v164
    v_accvgpr_write_b32 a59, v166
    v_accvgpr_write_b32 a60, v168
    v_accvgpr_write_b32 a61, v170
    v_accvgpr_write_b32 a62, v172
    v_accvgpr_write_b32 a63, v174
    s_waitcnt vmcnt(0)
    s_lshr_b32 s26, s39, 5
    s_cmp_eq_u32 s26, 0
    s_cselect_b64 s[16:17], s[30:31], s[34:35]
    s_cmp_eq_u32 s26, 1
    s_cselect_b64 s[16:17], s[32:33], s[16:17]
    s_and_b32 s17, s17, 0xffff
    s_cmp_lt_u32 s39, 96
    s_cselect_b32 s18, 0x400000, 0
    s_and_b32 s24, s39, 31
    s_lshl_b32 s24, s24, 8
    s_add_u32 s26, s24, 0x0
    s_add_u32 m0, s29, 0x0
    s_nop 0
    buffer_load_dwordx4 v136, s[16:19], s26 offen lds
    s_add_u32 s26, s24, 0x20000
    s_add_u32 m0, s29, 0x1000
    s_nop 0
    buffer_load_dwordx4 v136, s[16:19], s26 offen lds
    s_add_u32 s26, s24, 0x40000
    s_add_u32 m0, s29, 0x2000
    s_nop 0
    buffer_load_dwordx4 v136, s[16:19], s26 offen lds
    s_add_u32 s26, s24, 0x60000
    s_add_u32 m0, s29, 0x3000
    s_nop 0
    buffer_load_dwordx4 v136, s[16:19], s26 offen lds
    s_add_u32 s26, s24, 0x80000
    s_add_u32 m0, s29, 0x4000
    s_nop 0
    buffer_load_dwordx4 v136, s[16:19], s26 offen lds
    s_add_u32 s26, s24, 0xa0000
    s_add_u32 m0, s29, 0x5000
    s_nop 0
    buffer_load_dwordx4 v136, s[16:19], s26 offen lds
    s_add_u32 s26, s24, 0xc0000
    s_add_u32 m0, s29, 0x6000
    s_nop 0
    buffer_load_dwordx4 v136, s[16:19], s26 offen lds
    s_add_u32 s26, s24, 0xe0000
    s_add_u32 m0, s29, 0x7000
    s_nop 0
    buffer_load_dwordx4 v136, s[16:19], s26 offen lds
    s_add_u32 s26, s24, 0x100000
    s_add_u32 m0, s29, 0x8000
    s_nop 0
    buffer_load_dwordx4 v136, s[16:19], s26 offen lds
    s_add_u32 s26, s24, 0x120000
    s_add_u32 m0, s29, 0x9000
    s_nop 0
    buffer_load_dwordx4 v136, s[16:19], s26 offen lds
    s_add_u32 s26, s24, 0x140000
    s_add_u32 m0, s29, 0xa000
    s_nop 0
    buffer_load_dwordx4 v136, s[16:19], s26 offen lds
    s_add_u32 s26, s24, 0x160000
    s_add_u32 m0, s29, 0xb000
    s_nop 0
    buffer_load_dwordx4 v136, s[16:19], s26 offen lds
    s_add_u32 s26, s24, 0x180000
    s_add_u32 m0, s29, 0xc000
    s_nop 0
    buffer_load_dwordx4 v136, s[16:19], s26 offen lds
    s_add_u32 s26, s24, 0x1a0000
    s_add_u32 m0, s29, 0xd000
    s_nop 0
    buffer_load_dwordx4 v136, s[16:19], s26 offen lds
    s_add_u32 s26, s24, 0x1c0000
    s_add_u32 m0, s29, 0xe000
    s_nop 0
    buffer_load_dwordx4 v136, s[16:19], s26 offen lds
    s_add_u32 s26, s24, 0x1e0000
    s_add_u32 m0, s29, 0xf000
    s_nop 0
    buffer_load_dwordx4 v136, s[16:19], s26 offen lds
    s_add_u32 s26, s24, 0x200000
    s_add_u32 m0, s29, 0x10000
    s_nop 0
    buffer_load_dwordx4 v136, s[16:19], s26 offen lds
    s_add_u32 s26, s24, 0x220000
    s_add_u32 m0, s29, 0x11000
    s_nop 0
    buffer_load_dwordx4 v136, s[16:19], s26 offen lds
    s_add_u32 s26, s24, 0x240000
    s_add_u32 m0, s29, 0x12000
    s_nop 0
    buffer_load_dwordx4 v136, s[16:19], s26 offen lds
    s_add_u32 s26, s24, 0x260000
    s_add_u32 m0, s29, 0x13000
    s_nop 0
    buffer_load_dwordx4 v136, s[16:19], s26 offen lds
    s_add_u32 s26, s24, 0x280000
    s_add_u32 m0, s29, 0x14000
    s_nop 0
    buffer_load_dwordx4 v136, s[16:19], s26 offen lds
    s_add_u32 s26, s24, 0x2a0000
    s_add_u32 m0, s29, 0x15000
    s_nop 0
    buffer_load_dwordx4 v136, s[16:19], s26 offen lds
    s_add_u32 s26, s24, 0x2c0000
    s_add_u32 m0, s29, 0x16000
    s_nop 0
    buffer_load_dwordx4 v136, s[16:19], s26 offen lds
    s_add_u32 s26, s24, 0x2e0000
    s_add_u32 m0, s29, 0x17000
    s_nop 0
    buffer_load_dwordx4 v136, s[16:19], s26 offen lds
    v_pk_mov_b32 v[150:151], 0, 0
    v_pk_mov_b32 v[152:153], 0, 0
    v_dot2_f32_bf16 v150, v64, v158, v150
    v_dot2_f32_bf16 v152, v64, v64, v152
    v_dot2_f32_bf16 v151, v65, v158, v151
    v_dot2_f32_bf16 v153, v65, v65, v153
    v_dot2_f32_bf16 v150, v66, v158, v150
    v_dot2_f32_bf16 v152, v66, v66, v152
    v_dot2_f32_bf16 v151, v67, v158, v151
    v_dot2_f32_bf16 v153, v67, v67, v153
    v_dot2_f32_bf16 v150, v68, v158, v150
    v_dot2_f32_bf16 v152, v68, v68, v152
    v_dot2_f32_bf16 v151, v69, v158, v151
    v_dot2_f32_bf16 v153, v69, v69, v153
    v_dot2_f32_bf16 v150, v70, v158, v150
    v_dot2_f32_bf16 v152, v70, v70, v152
    v_dot2_f32_bf16 v151, v71, v158, v151
    v_dot2_f32_bf16 v153, v71, v71, v153
    v_dot2_f32_bf16 v150, v72, v158, v150
    v_dot2_f32_bf16 v152, v72, v72, v152
    v_dot2_f32_bf16 v151, v73, v158, v151
    v_dot2_f32_bf16 v153, v73, v73, v153
    v_dot2_f32_bf16 v150, v74, v158, v150
    v_dot2_f32_bf16 v152, v74, v74, v152
    v_dot2_f32_bf16 v151, v75, v158, v151
    v_dot2_f32_bf16 v153, v75, v75, v153
    v_dot2_f32_bf16 v150, v76, v158, v150
    v_dot2_f32_bf16 v152, v76, v76, v152
    v_dot2_f32_bf16 v151, v77, v158, v151
    v_dot2_f32_bf16 v153, v77, v77, v153
    v_dot2_f32_bf16 v150, v78, v158, v150
    v_dot2_f32_bf16 v152, v78, v78, v152
    v_dot2_f32_bf16 v151, v79, v158, v151
    v_dot2_f32_bf16 v153, v79, v79, v153
    v_dot2_f32_bf16 v150, v80, v158, v150
    v_dot2_f32_bf16 v152, v80, v80, v152
    v_dot2_f32_bf16 v151, v81, v158, v151
    v_dot2_f32_bf16 v153, v81, v81, v153
    v_dot2_f32_bf16 v150, v82, v158, v150
    v_dot2_f32_bf16 v152, v82, v82, v152
    v_dot2_f32_bf16 v151, v83, v158, v151
    v_dot2_f32_bf16 v153, v83, v83, v153
    v_dot2_f32_bf16 v150, v84, v158, v150
    v_dot2_f32_bf16 v152, v84, v84, v152
    v_dot2_f32_bf16 v151, v85, v158, v151
    v_dot2_f32_bf16 v153, v85, v85, v153
    v_dot2_f32_bf16 v150, v86, v158, v150
    v_dot2_f32_bf16 v152, v86, v86, v152
    v_dot2_f32_bf16 v151, v87, v158, v151
    v_dot2_f32_bf16 v153, v87, v87, v153
    v_dot2_f32_bf16 v150, v88, v158, v150
    v_dot2_f32_bf16 v152, v88, v88, v152
    v_dot2_f32_bf16 v151, v89, v158, v151
    v_dot2_f32_bf16 v153, v89, v89, v153
    v_dot2_f32_bf16 v150, v90, v158, v150
    v_dot2_f32_bf16 v152, v90, v90, v152
    v_dot2_f32_bf16 v151, v91, v158, v151
    v_dot2_f32_bf16 v153, v91, v91, v153
    v_dot2_f32_bf16 v150, v92, v158, v150
    v_dot2_f32_bf16 v152, v92, v92, v152
    v_dot2_f32_bf16 v151, v93, v158, v151
    v_dot2_f32_bf16 v153, v93, v93, v153
    v_dot2_f32_bf16 v150, v94, v158, v150
    v_dot2_f32_bf16 v152, v94, v94, v152
    v_dot2_f32_bf16 v151, v95, v158, v151
    v_dot2_f32_bf16 v153, v95, v95, v153
    v_dot2_f32_bf16 v150, v96, v158, v150
    v_dot2_f32_bf16 v152, v96, v96, v152
    v_dot2_f32_bf16 v151, v97, v158, v151
    v_dot2_f32_bf16 v153, v97, v97, v153
    v_dot2_f32_bf16 v150, v98, v158, v150
    v_dot2_f32_bf16 v152, v98, v98, v152
    v_dot2_f32_bf16 v151, v99, v158, v151
    v_dot2_f32_bf16 v153, v99, v99, v153
    v_dot2_f32_bf16 v150, v100, v158, v150
    v_dot2_f32_bf16 v152, v100, v100, v152
    v_dot2_f32_bf16 v151, v101, v158, v151
    v_dot2_f32_bf16 v153, v101, v101, v153
    v_dot2_f32_bf16 v150, v102, v158, v150
    v_dot2_f32_bf16 v152, v102, v102, v152
    v_dot2_f32_bf16 v151, v103, v158, v151
    v_dot2_f32_bf16 v153, v103, v103, v153
    v_dot2_f32_bf16 v150, v104, v158, v150
    v_dot2_f32_bf16 v152, v104, v104, v152
    v_dot2_f32_bf16 v151, v105, v158, v151
    v_dot2_f32_bf16 v153, v105, v105, v153
    v_dot2_f32_bf16 v150, v106, v158, v150
    v_dot2_f32_bf16 v152, v106, v106, v152
    v_dot2_f32_bf16 v151, v107, v158, v151
    v_dot2_f32_bf16 v153, v107, v107, v153
    v_dot2_f32_bf16 v150, v108, v158, v150
    v_dot2_f32_bf16 v152, v108, v108, v152
    v_dot2_f32_bf16 v151, v109, v158, v151
    v_dot2_f32_bf16 v153, v109, v109, v153
    v_dot2_f32_bf16 v150, v110, v158, v150
    v_dot2_f32_bf16 v152, v110, v110, v152
    v_dot2_f32_bf16 v151, v111, v158, v151
    v_dot2_f32_bf16 v153, v111, v111, v153
    v_dot2_f32_bf16 v150, v112, v158, v150
    v_dot2_f32_bf16 v152, v112, v112, v152
    v_dot2_f32_bf16 v151, v113, v158, v151
    v_dot2_f32_bf16 v153, v113, v113, v153
    v_dot2_f32_bf16 v150, v114, v158, v150
    v_dot2_f32_bf16 v152, v114, v114, v152
    v_dot2_f32_bf16 v151, v115, v158, v151
    v_dot2_f32_bf16 v153, v115, v115, v153
    v_dot2_f32_bf16 v150, v116, v158, v150
    v_dot2_f32_bf16 v152, v116, v116, v152
    v_dot2_f32_bf16 v151, v117, v158, v151
    v_dot2_f32_bf16 v153, v117, v117, v153
    v_dot2_f32_bf16 v150, v118, v158, v150
    v_dot2_f32_bf16 v152, v118, v118, v152
    v_dot2_f32_bf16 v151, v119, v158, v151
    v_dot2_f32_bf16 v153, v119, v119, v153
    v_dot2_f32_bf16 v150, v120, v158, v150
    v_dot2_f32_bf16 v152, v120, v120, v152
    v_dot2_f32_bf16 v151, v121, v158, v151
    v_dot2_f32_bf16 v153, v121, v121, v153
    v_dot2_f32_bf16 v150, v122, v158, v150
    v_dot2_f32_bf16 v152, v122, v122, v152
    v_dot2_f32_bf16 v151, v123, v158, v151
    v_dot2_f32_bf16 v153, v123, v123, v153
    v_dot2_f32_bf16 v150, v124, v158, v150
    v_dot2_f32_bf16 v152, v124, v124, v152
    v_dot2_f32_bf16 v151, v125, v158, v151
    v_dot2_f32_bf16 v153, v125, v125, v153
    v_dot2_f32_bf16 v150, v126, v158, v150
    v_dot2_f32_bf16 v152, v126, v126, v152
    v_dot2_f32_bf16 v151, v127, v158, v151
    v_dot2_f32_bf16 v153, v127, v127, v153
    s_nop 1
    v_add_f32 v150, v150, v151
    v_add_f32 v152, v152, v153
    v_mov_b32 v157, v150
    s_nop 1
    v_permlane32_swap_b32 v157, v150
    v_add_f32 v150, v157, v150
    v_mov_b32 v157, v150
    s_nop 1
    v_permlane16_swap_b32 v157, v150
    v_add_f32 v150, v157, v150
    v_mov_b32 v157, v152
    s_nop 1
    v_permlane32_swap_b32 v157, v152
    v_add_f32 v152, v157, v152
    v_mov_b32 v157, v152
    s_nop 1
    v_permlane16_swap_b32 v157, v152
    v_add_f32 v152, v157, v152
    v_mul_f32 v150, 0x3b000000, v150
    v_cvt_pk_bf16_f32 v154, v150, v150
    v_and_b32 v154, 0xffff0000, v154
    v_sub_f32 v156, v150, v154
    v_mul_f32 v157, v150, v150
    v_mul_f32 v152, 0x3b000000, v152
    v_sub_f32 v152, v152, v157
    v_max_f32 v152, 0, v152
    v_cvt_pk_bf16_f32 v152, v152, v152
    v_and_b32 v152, 0xffff0000, v152
    v_add_f32 v152, 0x3727c5ac, v152
    v_cvt_pk_bf16_f32 v152, v152, v152
    v_and_b32 v152, 0xffff0000, v152
    v_sqrt_f32 v152, v152
    s_nop 0
    v_cvt_pk_bf16_f32 v152, v152, v152
    v_and_b32 v152, 0xffff0000, v152
    v_rcp_f32 v152, v152
    v_lshlrev_b32 v160, 16, v64
    v_and_b32 v161, 0xffff0000, v64
    v_lshlrev_b32 v162, 16, v65
    v_and_b32 v163, 0xffff0000, v65
    v_lshlrev_b32 v164, 16, v66
    v_and_b32 v165, 0xffff0000, v66
    v_lshlrev_b32 v166, 16, v67
    v_and_b32 v167, 0xffff0000, v67
    v_lshlrev_b32 v168, 16, v68
    v_and_b32 v169, 0xffff0000, v68
    v_lshlrev_b32 v170, 16, v69
    v_and_b32 v171, 0xffff0000, v69
    v_lshlrev_b32 v172, 16, v70
    v_and_b32 v173, 0xffff0000, v70
    v_lshlrev_b32 v174, 16, v71
    v_and_b32 v175, 0xffff0000, v71
    v_pk_add_f32 v[160:161], v[160:161], v[154:155] op_sel_hi:[1,0] neg_lo:[0,1] neg_hi:[0,1]
    v_pk_add_f32 v[162:163], v[162:163], v[154:155] op_sel_hi:[1,0] neg_lo:[0,1] neg_hi:[0,1]
    v_pk_add_f32 v[164:165], v[164:165], v[154:155] op_sel_hi:[1,0] neg_lo:[0,1] neg_hi:[0,1]
    v_pk_add_f32 v[166:167], v[166:167], v[154:155] op_sel_hi:[1,0] neg_lo:[0,1] neg_hi:[0,1]
    v_pk_add_f32 v[168:169], v[168:169], v[154:155] op_sel_hi:[1,0] neg_lo:[0,1] neg_hi:[0,1]
    v_pk_add_f32 v[170:171], v[170:171], v[154:155] op_sel_hi:[1,0] neg_lo:[0,1] neg_hi:[0,1]
    v_pk_add_f32 v[172:173], v[172:173], v[154:155] op_sel_hi:[1,0] neg_lo:[0,1] neg_hi:[0,1]
    v_pk_add_f32 v[174:175], v[174:175], v[154:155] op_sel_hi:[1,0] neg_lo:[0,1] neg_hi:[0,1]
    v_cvt_pk_bf16_f32 v64, v160, v161
    v_cvt_pk_bf16_f32 v65, v162, v163
    v_cvt_pk_bf16_f32 v66, v164, v165
    v_cvt_pk_bf16_f32 v67, v166, v167
    v_cvt_pk_bf16_f32 v68, v168, v169
    v_cvt_pk_bf16_f32 v69, v170, v171
    v_cvt_pk_bf16_f32 v70, v172, v173
    v_cvt_pk_bf16_f32 v71, v174, v175
    v_lshlrev_b32 v160, 16, v64
    v_and_b32 v161, 0xffff0000, v64
    v_lshlrev_b32 v162, 16, v65
    v_and_b32 v163, 0xffff0000, v65
    v_lshlrev_b32 v164, 16, v66
    v_and_b32 v165, 0xffff0000, v66
    v_lshlrev_b32 v166, 16, v67
    v_and_b32 v167, 0xffff0000, v67
    v_lshlrev_b32 v168, 16, v68
    v_and_b32 v169, 0xffff0000, v68
    v_lshlrev_b32 v170, 16, v69
    v_and_b32 v171, 0xffff0000, v69
    v_lshlrev_b32 v172, 16, v70
    v_and_b32 v173, 0xffff0000, v70
    v_lshlrev_b32 v174, 16, v71
    v_and_b32 v175, 0xffff0000, v71
    v_pk_mul_f32 v[160:161], v[160:161], v[152:153] op_sel_hi:[1,0]
    v_pk_mul_f32 v[162:163], v[162:163], v[152:153] op_sel_hi:[1,0]
    v_pk_mul_f32 v[164:165], v[164:165], v[152:153] op_sel_hi:[1,0]
    v_pk_mul_f32 v[166:167], v[166:167], v[152:153] op_sel_hi:[1,0]
    v_pk_mul_f32 v[168:169], v[168:169], v[152:153] op_sel_hi:[1,0]
    v_pk_mul_f32 v[170:171], v[170:171], v[152:153] op_sel_hi:[1,0]
    v_pk_mul_f32 v[172:173], v[172:173], v[152:153] op_sel_hi:[1,0]
    v_pk_mul_f32 v[174:175], v[174:175], v[152:153] op_sel_hi:[1,0]
    v_cvt_pk_bf16_f32 v160, v160, v161
    v_cvt_pk_bf16_f32 v162, v162, v163
    v_cvt_pk_bf16_f32 v164, v164, v165
    v_cvt_pk_bf16_f32 v166, v166, v167
    v_cvt_pk_bf16_f32 v168, v168, v169
    v_cvt_pk_bf16_f32 v170, v170, v171
    v_cvt_pk_bf16_f32 v172, v172, v173
    v_cvt_pk_bf16_f32 v174, v174, v175
    v_accvgpr_write_b32 a64, v160
    v_accvgpr_write_b32 a65, v162
    v_accvgpr_write_b32 a66, v164
    v_accvgpr_write_b32 a67, v166
    v_accvgpr_write_b32 a68, v168
    v_accvgpr_write_b32 a69, v170
    v_accvgpr_write_b32 a70, v172
    v_accvgpr_write_b32 a71, v174
    v_lshlrev_b32 v160, 16, v72
    v_and_b32 v161, 0xffff0000, v72
    v_lshlrev_b32 v162, 16, v73
    v_and_b32 v163, 0xffff0000, v73
    v_lshlrev_b32 v164, 16, v74
    v_and_b32 v165, 0xffff0000, v74
    v_lshlrev_b32 v166, 16, v75
    v_and_b32 v167, 0xffff0000, v75
    v_lshlrev_b32 v168, 16, v76
    v_and_b32 v169, 0xffff0000, v76
    v_lshlrev_b32 v170, 16, v77
    v_and_b32 v171, 0xffff0000, v77
    v_lshlrev_b32 v172, 16, v78
    v_and_b32 v173, 0xffff0000, v78
    v_lshlrev_b32 v174, 16, v79
    v_and_b32 v175, 0xffff0000, v79
    v_pk_add_f32 v[160:161], v[160:161], v[154:155] op_sel_hi:[1,0] neg_lo:[0,1] neg_hi:[0,1]
    v_pk_add_f32 v[162:163], v[162:163], v[154:155] op_sel_hi:[1,0] neg_lo:[0,1] neg_hi:[0,1]
    v_pk_add_f32 v[164:165], v[164:165], v[154:155] op_sel_hi:[1,0] neg_lo:[0,1] neg_hi:[0,1]
    v_pk_add_f32 v[166:167], v[166:167], v[154:155] op_sel_hi:[1,0] neg_lo:[0,1] neg_hi:[0,1]
    v_pk_add_f32 v[168:169], v[168:169], v[154:155] op_sel_hi:[1,0] neg_lo:[0,1] neg_hi:[0,1]
    v_pk_add_f32 v[170:171], v[170:171], v[154:155] op_sel_hi:[1,0] neg_lo:[0,1] neg_hi:[0,1]
    v_pk_add_f32 v[172:173], v[172:173], v[154:155] op_sel_hi:[1,0] neg_lo:[0,1] neg_hi:[0,1]
    v_pk_add_f32 v[174:175], v[174:175], v[154:155] op_sel_hi:[1,0] neg_lo:[0,1] neg_hi:[0,1]
    v_cvt_pk_bf16_f32 v72, v160, v161
    v_cvt_pk_bf16_f32 v73, v162, v163
    v_cvt_pk_bf16_f32 v74, v164, v165
    v_cvt_pk_bf16_f32 v75, v166, v167
    v_cvt_pk_bf16_f32 v76, v168, v169
    v_cvt_pk_bf16_f32 v77, v170, v171
    v_cvt_pk_bf16_f32 v78, v172, v173
    v_cvt_pk_bf16_f32 v79, v174, v175
    v_lshlrev_b32 v160, 16, v72
    v_and_b32 v161, 0xffff0000, v72
    v_lshlrev_b32 v162, 16, v73
    v_and_b32 v163, 0xffff0000, v73
    v_lshlrev_b32 v164, 16, v74
    v_and_b32 v165, 0xffff0000, v74
    v_lshlrev_b32 v166, 16, v75
    v_and_b32 v167, 0xffff0000, v75
    v_lshlrev_b32 v168, 16, v76
    v_and_b32 v169, 0xffff0000, v76
    v_lshlrev_b32 v170, 16, v77
    v_and_b32 v171, 0xffff0000, v77
    v_lshlrev_b32 v172, 16, v78
    v_and_b32 v173, 0xffff0000, v78
    v_lshlrev_b32 v174, 16, v79
    v_and_b32 v175, 0xffff0000, v79
    v_pk_mul_f32 v[160:161], v[160:161], v[152:153] op_sel_hi:[1,0]
    v_pk_mul_f32 v[162:163], v[162:163], v[152:153] op_sel_hi:[1,0]
    v_pk_mul_f32 v[164:165], v[164:165], v[152:153] op_sel_hi:[1,0]
    v_pk_mul_f32 v[166:167], v[166:167], v[152:153] op_sel_hi:[1,0]
    v_pk_mul_f32 v[168:169], v[168:169], v[152:153] op_sel_hi:[1,0]
    v_pk_mul_f32 v[170:171], v[170:171], v[152:153] op_sel_hi:[1,0]
    v_pk_mul_f32 v[172:173], v[172:173], v[152:153] op_sel_hi:[1,0]
    v_pk_mul_f32 v[174:175], v[174:175], v[152:153] op_sel_hi:[1,0]
    v_cvt_pk_bf16_f32 v160, v160, v161
    v_cvt_pk_bf16_f32 v162, v162, v163
    v_cvt_pk_bf16_f32 v164, v164, v165
    v_cvt_pk_bf16_f32 v166, v166, v167
    v_cvt_pk_bf16_f32 v168, v168, v169
    v_cvt_pk_bf16_f32 v170, v170, v171
    v_cvt_pk_bf16_f32 v172, v172, v173
    v_cvt_pk_bf16_f32 v174, v174, v175
    v_accvgpr_write_b32 a72, v160
    v_accvgpr_write_b32 a73, v162
    v_accvgpr_write_b32 a74, v164
    v_accvgpr_write_b32 a75, v166
    v_accvgpr_write_b32 a76, v168
    v_accvgpr_write_b32 a77, v170
    v_accvgpr_write_b32 a78, v172
    v_accvgpr_write_b32 a79, v174
    v_lshlrev_b32 v160, 16, v80
    v_and_b32 v161, 0xffff0000, v80
    v_lshlrev_b32 v162, 16, v81
    v_and_b32 v163, 0xffff0000, v81
    v_lshlrev_b32 v164, 16, v82
    v_and_b32 v165, 0xffff0000, v82
    v_lshlrev_b32 v166, 16, v83
    v_and_b32 v167, 0xffff0000, v83
    v_lshlrev_b32 v168, 16, v84
    v_and_b32 v169, 0xffff0000, v84
    v_lshlrev_b32 v170, 16, v85
    v_and_b32 v171, 0xffff0000, v85
    v_lshlrev_b32 v172, 16, v86
    v_and_b32 v173, 0xffff0000, v86
    v_lshlrev_b32 v174, 16, v87
    v_and_b32 v175, 0xffff0000, v87
    v_pk_add_f32 v[160:161], v[160:161], v[154:155] op_sel_hi:[1,0] neg_lo:[0,1] neg_hi:[0,1]
    v_pk_add_f32 v[162:163], v[162:163], v[154:155] op_sel_hi:[1,0] neg_lo:[0,1] neg_hi:[0,1]
    v_pk_add_f32 v[164:165], v[164:165], v[154:155] op_sel_hi:[1,0] neg_lo:[0,1] neg_hi:[0,1]
    v_pk_add_f32 v[166:167], v[166:167], v[154:155] op_sel_hi:[1,0] neg_lo:[0,1] neg_hi:[0,1]
    v_pk_add_f32 v[168:169], v[168:169], v[154:155] op_sel_hi:[1,0] neg_lo:[0,1] neg_hi:[0,1]
    v_pk_add_f32 v[170:171], v[170:171], v[154:155] op_sel_hi:[1,0] neg_lo:[0,1] neg_hi:[0,1]
    v_pk_add_f32 v[172:173], v[172:173], v[154:155] op_sel_hi:[1,0] neg_lo:[0,1] neg_hi:[0,1]
    v_pk_add_f32 v[174:175], v[174:175], v[154:155] op_sel_hi:[1,0] neg_lo:[0,1] neg_hi:[0,1]
    v_cvt_pk_bf16_f32 v80, v160, v161
    v_cvt_pk_bf16_f32 v81, v162, v163
    v_cvt_pk_bf16_f32 v82, v164, v165
    v_cvt_pk_bf16_f32 v83, v166, v167
    v_cvt_pk_bf16_f32 v84, v168, v169
    v_cvt_pk_bf16_f32 v85, v170, v171
    v_cvt_pk_bf16_f32 v86, v172, v173
    v_cvt_pk_bf16_f32 v87, v174, v175
    v_lshlrev_b32 v160, 16, v80
    v_and_b32 v161, 0xffff0000, v80
    v_lshlrev_b32 v162, 16, v81
    v_and_b32 v163, 0xffff0000, v81
    v_lshlrev_b32 v164, 16, v82
    v_and_b32 v165, 0xffff0000, v82
    v_lshlrev_b32 v166, 16, v83
    v_and_b32 v167, 0xffff0000, v83
    v_lshlrev_b32 v168, 16, v84
    v_and_b32 v169, 0xffff0000, v84
    v_lshlrev_b32 v170, 16, v85
    v_and_b32 v171, 0xffff0000, v85
    v_lshlrev_b32 v172, 16, v86
    v_and_b32 v173, 0xffff0000, v86
    v_lshlrev_b32 v174, 16, v87
    v_and_b32 v175, 0xffff0000, v87
    v_pk_mul_f32 v[160:161], v[160:161], v[152:153] op_sel_hi:[1,0]
    v_pk_mul_f32 v[162:163], v[162:163], v[152:153] op_sel_hi:[1,0]
    v_pk_mul_f32 v[164:165], v[164:165], v[152:153] op_sel_hi:[1,0]
    v_pk_mul_f32 v[166:167], v[166:167], v[152:153] op_sel_hi:[1,0]
    v_pk_mul_f32 v[168:169], v[168:169], v[152:153] op_sel_hi:[1,0]
    v_pk_mul_f32 v[170:171], v[170:171], v[152:153] op_sel_hi:[1,0]
    v_pk_mul_f32 v[172:173], v[172:173], v[152:153] op_sel_hi:[1,0]
    v_pk_mul_f32 v[174:175], v[174:175], v[152:153] op_sel_hi:[1,0]
    v_cvt_pk_bf16_f32 v160, v160, v161
    v_cvt_pk_bf16_f32 v162, v162, v163
    v_cvt_pk_bf16_f32 v164, v164, v165
    v_cvt_pk_bf16_f32 v166, v166, v167
    v_cvt_pk_bf16_f32 v168, v168, v169
    v_cvt_pk_bf16_f32 v170, v170, v171
    v_cvt_pk_bf16_f32 v172, v172, v173
    v_cvt_pk_bf16_f32 v174, v174, v175
    v_accvgpr_write_b32 a80, v160
    v_accvgpr_write_b32 a81, v162
    v_accvgpr_write_b32 a82, v164
    v_accvgpr_write_b32 a83, v166
    v_accvgpr_write_b32 a84, v168
    v_accvgpr_write_b32 a85, v170
    v_accvgpr_write_b32 a86, v172
    v_accvgpr_write_b32 a87, v174
    v_lshlrev_b32 v160, 16, v88
    v_and_b32 v161, 0xffff0000, v88
    v_lshlrev_b32 v162, 16, v89
    v_and_b32 v163, 0xffff0000, v89
    v_lshlrev_b32 v164, 16, v90
    v_and_b32 v165, 0xffff0000, v90
    v_lshlrev_b32 v166, 16, v91
    v_and_b32 v167, 0xffff0000, v91
    v_lshlrev_b32 v168, 16, v92
    v_and_b32 v169, 0xffff0000, v92
    v_lshlrev_b32 v170, 16, v93
    v_and_b32 v171, 0xffff0000, v93
    v_lshlrev_b32 v172, 16, v94
    v_and_b32 v173, 0xffff0000, v94
    v_lshlrev_b32 v174, 16, v95
    v_and_b32 v175, 0xffff0000, v95
    v_pk_add_f32 v[160:161], v[160:161], v[154:155] op_sel_hi:[1,0] neg_lo:[0,1] neg_hi:[0,1]
    v_pk_add_f32 v[162:163], v[162:163], v[154:155] op_sel_hi:[1,0] neg_lo:[0,1] neg_hi:[0,1]
    v_pk_add_f32 v[164:165], v[164:165], v[154:155] op_sel_hi:[1,0] neg_lo:[0,1] neg_hi:[0,1]
    v_pk_add_f32 v[166:167], v[166:167], v[154:155] op_sel_hi:[1,0] neg_lo:[0,1] neg_hi:[0,1]
    v_pk_add_f32 v[168:169], v[168:169], v[154:155] op_sel_hi:[1,0] neg_lo:[0,1] neg_hi:[0,1]
    v_pk_add_f32 v[170:171], v[170:171], v[154:155] op_sel_hi:[1,0] neg_lo:[0,1] neg_hi:[0,1]
    v_pk_add_f32 v[172:173], v[172:173], v[154:155] op_sel_hi:[1,0] neg_lo:[0,1] neg_hi:[0,1]
    v_pk_add_f32 v[174:175], v[174:175], v[154:155] op_sel_hi:[1,0] neg_lo:[0,1] neg_hi:[0,1]
    v_cvt_pk_bf16_f32 v88, v160, v161
    v_cvt_pk_bf16_f32 v89, v162, v163
    v_cvt_pk_bf16_f32 v90, v164, v165
    v_cvt_pk_bf16_f32 v91, v166, v167
    v_cvt_pk_bf16_f32 v92, v168, v169
    v_cvt_pk_bf16_f32 v93, v170, v171
    v_cvt_pk_bf16_f32 v94, v172, v173
    v_cvt_pk_bf16_f32 v95, v174, v175
    v_lshlrev_b32 v160, 16, v88
    v_and_b32 v161, 0xffff0000, v88
    v_lshlrev_b32 v162, 16, v89
    v_and_b32 v163, 0xffff0000, v89
    v_lshlrev_b32 v164, 16, v90
    v_and_b32 v165, 0xffff0000, v90
    v_lshlrev_b32 v166, 16, v91
    v_and_b32 v167, 0xffff0000, v91
    v_lshlrev_b32 v168, 16, v92
    v_and_b32 v169, 0xffff0000, v92
    v_lshlrev_b32 v170, 16, v93
    v_and_b32 v171, 0xffff0000, v93
    v_lshlrev_b32 v172, 16, v94
    v_and_b32 v173, 0xffff0000, v94
    v_lshlrev_b32 v174, 16, v95
    v_and_b32 v175, 0xffff0000, v95
    v_pk_mul_f32 v[160:161], v[160:161], v[152:153] op_sel_hi:[1,0]
    v_pk_mul_f32 v[162:163], v[162:163], v[152:153] op_sel_hi:[1,0]
    v_pk_mul_f32 v[164:165], v[164:165], v[152:153] op_sel_hi:[1,0]
    v_pk_mul_f32 v[166:167], v[166:167], v[152:153] op_sel_hi:[1,0]
    v_pk_mul_f32 v[168:169], v[168:169], v[152:153] op_sel_hi:[1,0]
    v_pk_mul_f32 v[170:171], v[170:171], v[152:153] op_sel_hi:[1,0]
    v_pk_mul_f32 v[172:173], v[172:173], v[152:153] op_sel_hi:[1,0]
    v_pk_mul_f32 v[174:175], v[174:175], v[152:153] op_sel_hi:[1,0]
    v_cvt_pk_bf16_f32 v160, v160, v161
    v_cvt_pk_bf16_f32 v162, v162, v163
    v_cvt_pk_bf16_f32 v164, v164, v165
    v_cvt_pk_bf16_f32 v166, v166, v167
    v_cvt_pk_bf16_f32 v168, v168, v169
    v_cvt_pk_bf16_f32 v170, v170, v171
    v_cvt_pk_bf16_f32 v172, v172, v173
    v_cvt_pk_bf16_f32 v174, v174, v175
    v_accvgpr_write_b32 a88, v160
    v_accvgpr_write_b32 a89, v162
    v_accvgpr_write_b32 a90, v164
    v_accvgpr_write_b32 a91, v166
    v_accvgpr_write_b32 a92, v168
    v_accvgpr_write_b32 a93, v170
    v_accvgpr_write_b32 a94, v172
    v_accvgpr_write_b32 a95, v174
    v_lshlrev_b32 v160, 16, v96
    v_and_b32 v161, 0xffff0000, v96
    v_lshlrev_b32 v162, 16, v97
    v_and_b32 v163, 0xffff0000, v97
    v_lshlrev_b32 v164, 16, v98
    v_and_b32 v165, 0xffff0000, v98
    v_lshlrev_b32 v166, 16, v99
    v_and_b32 v167, 0xffff0000, v99
    v_lshlrev_b32 v168, 16, v100
    v_and_b32 v169, 0xffff0000, v100
    v_lshlrev_b32 v170, 16, v101
    v_and_b32 v171, 0xffff0000, v101
    v_lshlrev_b32 v172, 16, v102
    v_and_b32 v173, 0xffff0000, v102
    v_lshlrev_b32 v174, 16, v103
    v_and_b32 v175, 0xffff0000, v103
    v_pk_add_f32 v[160:161], v[160:161], v[154:155] op_sel_hi:[1,0] neg_lo:[0,1] neg_hi:[0,1]
    v_pk_add_f32 v[162:163], v[162:163], v[154:155] op_sel_hi:[1,0] neg_lo:[0,1] neg_hi:[0,1]
    v_pk_add_f32 v[164:165], v[164:165], v[154:155] op_sel_hi:[1,0] neg_lo:[0,1] neg_hi:[0,1]
    v_pk_add_f32 v[166:167], v[166:167], v[154:155] op_sel_hi:[1,0] neg_lo:[0,1] neg_hi:[0,1]
    v_pk_add_f32 v[168:169], v[168:169], v[154:155] op_sel_hi:[1,0] neg_lo:[0,1] neg_hi:[0,1]
    v_pk_add_f32 v[170:171], v[170:171], v[154:155] op_sel_hi:[1,0] neg_lo:[0,1] neg_hi:[0,1]
    v_pk_add_f32 v[172:173], v[172:173], v[154:155] op_sel_hi:[1,0] neg_lo:[0,1] neg_hi:[0,1]
    v_pk_add_f32 v[174:175], v[174:175], v[154:155] op_sel_hi:[1,0] neg_lo:[0,1] neg_hi:[0,1]
    v_cvt_pk_bf16_f32 v96, v160, v161
    v_cvt_pk_bf16_f32 v97, v162, v163
    v_cvt_pk_bf16_f32 v98, v164, v165
    v_cvt_pk_bf16_f32 v99, v166, v167
    v_cvt_pk_bf16_f32 v100, v168, v169
    v_cvt_pk_bf16_f32 v101, v170, v171
    v_cvt_pk_bf16_f32 v102, v172, v173
    v_cvt_pk_bf16_f32 v103, v174, v175
    v_lshlrev_b32 v160, 16, v96
    v_and_b32 v161, 0xffff0000, v96
    v_lshlrev_b32 v162, 16, v97
    v_and_b32 v163, 0xffff0000, v97
    v_lshlrev_b32 v164, 16, v98
    v_and_b32 v165, 0xffff0000, v98
    v_lshlrev_b32 v166, 16, v99
    v_and_b32 v167, 0xffff0000, v99
    v_lshlrev_b32 v168, 16, v100
    v_and_b32 v169, 0xffff0000, v100
    v_lshlrev_b32 v170, 16, v101
    v_and_b32 v171, 0xffff0000, v101
    v_lshlrev_b32 v172, 16, v102
    v_and_b32 v173, 0xffff0000, v102
    v_lshlrev_b32 v174, 16, v103
    v_and_b32 v175, 0xffff0000, v103
    v_pk_mul_f32 v[160:161], v[160:161], v[152:153] op_sel_hi:[1,0]
    v_pk_mul_f32 v[162:163], v[162:163], v[152:153] op_sel_hi:[1,0]
    v_pk_mul_f32 v[164:165], v[164:165], v[152:153] op_sel_hi:[1,0]
    v_pk_mul_f32 v[166:167], v[166:167], v[152:153] op_sel_hi:[1,0]
    v_pk_mul_f32 v[168:169], v[168:169], v[152:153] op_sel_hi:[1,0]
    v_pk_mul_f32 v[170:171], v[170:171], v[152:153] op_sel_hi:[1,0]
    v_pk_mul_f32 v[172:173], v[172:173], v[152:153] op_sel_hi:[1,0]
    v_pk_mul_f32 v[174:175], v[174:175], v[152:153] op_sel_hi:[1,0]
    v_cvt_pk_bf16_f32 v160, v160, v161
    v_cvt_pk_bf16_f32 v162, v162, v163
    v_cvt_pk_bf16_f32 v164, v164, v165
    v_cvt_pk_bf16_f32 v166, v166, v167
    v_cvt_pk_bf16_f32 v168, v168, v169
    v_cvt_pk_bf16_f32 v170, v170, v171
    v_cvt_pk_bf16_f32 v172, v172, v173
    v_cvt_pk_bf16_f32 v174, v174, v175
    v_accvgpr_write_b32 a96, v160
    v_accvgpr_write_b32 a97, v162
    v_accvgpr_write_b32 a98, v164
    v_accvgpr_write_b32 a99, v166
    v_accvgpr_write_b32 a100, v168
    v_accvgpr_write_b32 a101, v170
    v_accvgpr_write_b32 a102, v172
    v_accvgpr_write_b32 a103, v174
    v_lshlrev_b32 v160, 16, v104
    v_and_b32 v161, 0xffff0000, v104
    v_lshlrev_b32 v162, 16, v105
    v_and_b32 v163, 0xffff0000, v105
    v_lshlrev_b32 v164, 16, v106
    v_and_b32 v165, 0xffff0000, v106
    v_lshlrev_b32 v166, 16, v107
    v_and_b32 v167, 0xffff0000, v107
    v_lshlrev_b32 v168, 16, v108
    v_and_b32 v169, 0xffff0000, v108
    v_lshlrev_b32 v170, 16, v109
    v_and_b32 v171, 0xffff0000, v109
    v_lshlrev_b32 v172, 16, v110
    v_and_b32 v173, 0xffff0000, v110
    v_lshlrev_b32 v174, 16, v111
    v_and_b32 v175, 0xffff0000, v111
    v_pk_add_f32 v[160:161], v[160:161], v[154:155] op_sel_hi:[1,0] neg_lo:[0,1] neg_hi:[0,1]
    v_pk_add_f32 v[162:163], v[162:163], v[154:155] op_sel_hi:[1,0] neg_lo:[0,1] neg_hi:[0,1]
    v_pk_add_f32 v[164:165], v[164:165], v[154:155] op_sel_hi:[1,0] neg_lo:[0,1] neg_hi:[0,1]
    v_pk_add_f32 v[166:167], v[166:167], v[154:155] op_sel_hi:[1,0] neg_lo:[0,1] neg_hi:[0,1]
    v_pk_add_f32 v[168:169], v[168:169], v[154:155] op_sel_hi:[1,0] neg_lo:[0,1] neg_hi:[0,1]
    v_pk_add_f32 v[170:171], v[170:171], v[154:155] op_sel_hi:[1,0] neg_lo:[0,1] neg_hi:[0,1]
    v_pk_add_f32 v[172:173], v[172:173], v[154:155] op_sel_hi:[1,0] neg_lo:[0,1] neg_hi:[0,1]
    v_pk_add_f32 v[174:175], v[174:175], v[154:155] op_sel_hi:[1,0] neg_lo:[0,1] neg_hi:[0,1]
    v_cvt_pk_bf16_f32 v104, v160, v161
    v_cvt_pk_bf16_f32 v105, v162, v163
    v_cvt_pk_bf16_f32 v106, v164, v165
    v_cvt_pk_bf16_f32 v107, v166, v167
    v_cvt_pk_bf16_f32 v108, v168, v169
    v_cvt_pk_bf16_f32 v109, v170, v171
    v_cvt_pk_bf16_f32 v110, v172, v173
    v_cvt_pk_bf16_f32 v111, v174, v175
    v_lshlrev_b32 v160, 16, v104
    v_and_b32 v161, 0xffff0000, v104
    v_lshlrev_b32 v162, 16, v105
    v_and_b32 v163, 0xffff0000, v105
    v_lshlrev_b32 v164, 16, v106
    v_and_b32 v165, 0xffff0000, v106
    v_lshlrev_b32 v166, 16, v107
    v_and_b32 v167, 0xffff0000, v107
    v_lshlrev_b32 v168, 16, v108
    v_and_b32 v169, 0xffff0000, v108
    v_lshlrev_b32 v170, 16, v109
    v_and_b32 v171, 0xffff0000, v109
    v_lshlrev_b32 v172, 16, v110
    v_and_b32 v173, 0xffff0000, v110
    v_lshlrev_b32 v174, 16, v111
    v_and_b32 v175, 0xffff0000, v111
    v_pk_mul_f32 v[160:161], v[160:161], v[152:153] op_sel_hi:[1,0]
    v_pk_mul_f32 v[162:163], v[162:163], v[152:153] op_sel_hi:[1,0]
    v_pk_mul_f32 v[164:165], v[164:165], v[152:153] op_sel_hi:[1,0]
    v_pk_mul_f32 v[166:167], v[166:167], v[152:153] op_sel_hi:[1,0]
    v_pk_mul_f32 v[168:169], v[168:169], v[152:153] op_sel_hi:[1,0]
    v_pk_mul_f32 v[170:171], v[170:171], v[152:153] op_sel_hi:[1,0]
    v_pk_mul_f32 v[172:173], v[172:173], v[152:153] op_sel_hi:[1,0]
    v_pk_mul_f32 v[174:175], v[174:175], v[152:153] op_sel_hi:[1,0]
    v_cvt_pk_bf16_f32 v160, v160, v161
    v_cvt_pk_bf16_f32 v162, v162, v163
    v_cvt_pk_bf16_f32 v164, v164, v165
    v_cvt_pk_bf16_f32 v166, v166, v167
    v_cvt_pk_bf16_f32 v168, v168, v169
    v_cvt_pk_bf16_f32 v170, v170, v171
    v_cvt_pk_bf16_f32 v172, v172, v173
    v_cvt_pk_bf16_f32 v174, v174, v175
    v_accvgpr_write_b32 a104, v160
    v_accvgpr_write_b32 a105, v162
    v_accvgpr_write_b32 a106, v164
    v_accvgpr_write_b32 a107, v166
    v_accvgpr_write_b32 a108, v168
    v_accvgpr_write_b32 a109, v170
    v_accvgpr_write_b32 a110, v172
    v_accvgpr_write_b32 a111, v174
    v_lshlrev_b32 v160, 16, v112
    v_and_b32 v161, 0xffff0000, v112
    v_lshlrev_b32 v162, 16, v113
    v_and_b32 v163, 0xffff0000, v113
    v_lshlrev_b32 v164, 16, v114
    v_and_b32 v165, 0xffff0000, v114
    v_lshlrev_b32 v166, 16, v115
    v_and_b32 v167, 0xffff0000, v115
    v_lshlrev_b32 v168, 16, v116
    v_and_b32 v169, 0xffff0000, v116
    v_lshlrev_b32 v170, 16, v117
    v_and_b32 v171, 0xffff0000, v117
    v_lshlrev_b32 v172, 16, v118
    v_and_b32 v173, 0xffff0000, v118
    v_lshlrev_b32 v174, 16, v119
    v_and_b32 v175, 0xffff0000, v119
    v_pk_add_f32 v[160:161], v[160:161], v[154:155] op_sel_hi:[1,0] neg_lo:[0,1] neg_hi:[0,1]
    v_pk_add_f32 v[162:163], v[162:163], v[154:155] op_sel_hi:[1,0] neg_lo:[0,1] neg_hi:[0,1]
    v_pk_add_f32 v[164:165], v[164:165], v[154:155] op_sel_hi:[1,0] neg_lo:[0,1] neg_hi:[0,1]
    v_pk_add_f32 v[166:167], v[166:167], v[154:155] op_sel_hi:[1,0] neg_lo:[0,1] neg_hi:[0,1]
    v_pk_add_f32 v[168:169], v[168:169], v[154:155] op_sel_hi:[1,0] neg_lo:[0,1] neg_hi:[0,1]
    v_pk_add_f32 v[170:171], v[170:171], v[154:155] op_sel_hi:[1,0] neg_lo:[0,1] neg_hi:[0,1]
    v_pk_add_f32 v[172:173], v[172:173], v[154:155] op_sel_hi:[1,0] neg_lo:[0,1] neg_hi:[0,1]
    v_pk_add_f32 v[174:175], v[174:175], v[154:155] op_sel_hi:[1,0] neg_lo:[0,1] neg_hi:[0,1]
    v_cvt_pk_bf16_f32 v112, v160, v161
    v_cvt_pk_bf16_f32 v113, v162, v163
    v_cvt_pk_bf16_f32 v114, v164, v165
    v_cvt_pk_bf16_f32 v115, v166, v167
    v_cvt_pk_bf16_f32 v116, v168, v169
    v_cvt_pk_bf16_f32 v117, v170, v171
    v_cvt_pk_bf16_f32 v118, v172, v173
    v_cvt_pk_bf16_f32 v119, v174, v175
    v_lshlrev_b32 v160, 16, v112
    v_and_b32 v161, 0xffff0000, v112
    v_lshlrev_b32 v162, 16, v113
    v_and_b32 v163, 0xffff0000, v113
    v_lshlrev_b32 v164, 16, v114
    v_and_b32 v165, 0xffff0000, v114
    v_lshlrev_b32 v166, 16, v115
    v_and_b32 v167, 0xffff0000, v115
    v_lshlrev_b32 v168, 16, v116
    v_and_b32 v169, 0xffff0000, v116
    v_lshlrev_b32 v170, 16, v117
    v_and_b32 v171, 0xffff0000, v117
    v_lshlrev_b32 v172, 16, v118
    v_and_b32 v173, 0xffff0000, v118
    v_lshlrev_b32 v174, 16, v119
    v_and_b32 v175, 0xffff0000, v119
    v_pk_mul_f32 v[160:161], v[160:161], v[152:153] op_sel_hi:[1,0]
    v_pk_mul_f32 v[162:163], v[162:163], v[152:153] op_sel_hi:[1,0]
    v_pk_mul_f32 v[164:165], v[164:165], v[152:153] op_sel_hi:[1,0]
    v_pk_mul_f32 v[166:167], v[166:167], v[152:153] op_sel_hi:[1,0]
    v_pk_mul_f32 v[168:169], v[168:169], v[152:153] op_sel_hi:[1,0]
    v_pk_mul_f32 v[170:171], v[170:171], v[152:153] op_sel_hi:[1,0]
    v_pk_mul_f32 v[172:173], v[172:173], v[152:153] op_sel_hi:[1,0]
    v_pk_mul_f32 v[174:175], v[174:175], v[152:153] op_sel_hi:[1,0]
    v_cvt_pk_bf16_f32 v160, v160, v161
    v_cvt_pk_bf16_f32 v162, v162, v163
    v_cvt_pk_bf16_f32 v164, v164, v165
    v_cvt_pk_bf16_f32 v166, v166, v167
    v_cvt_pk_bf16_f32 v168, v168, v169
    v_cvt_pk_bf16_f32 v170, v170, v171
    v_cvt_pk_bf16_f32 v172, v172, v173
    v_cvt_pk_bf16_f32 v174, v174, v175
    v_accvgpr_write_b32 a112, v160
    v_accvgpr_write_b32 a113, v162
    v_accvgpr_write_b32 a114, v164
    v_accvgpr_write_b32 a115, v166
    v_accvgpr_write_b32 a116, v168
    v_accvgpr_write_b32 a117, v170
    v_accvgpr_write_b32 a118, v172
    v_accvgpr_write_b32 a119, v174
    v_lshlrev_b32 v160, 16, v120
    v_and_b32 v161, 0xffff0000, v120
    v_lshlrev_b32 v162, 16, v121
    v_and_b32 v163, 0xffff0000, v121
    v_lshlrev_b32 v164, 16, v122
    v_and_b32 v165, 0xffff0000, v122
    v_lshlrev_b32 v166, 16, v123
    v_and_b32 v167, 0xffff0000, v123
    v_lshlrev_b32 v168, 16, v124
    v_and_b32 v169, 0xffff0000, v124
    v_lshlrev_b32 v170, 16, v125
    v_and_b32 v171, 0xffff0000, v125
    v_lshlrev_b32 v172, 16, v126
    v_and_b32 v173, 0xffff0000, v126
    v_lshlrev_b32 v174, 16, v127
    v_and_b32 v175, 0xffff0000, v127
    v_pk_add_f32 v[160:161], v[160:161], v[154:155] op_sel_hi:[1,0] neg_lo:[0,1] neg_hi:[0,1]
    v_pk_add_f32 v[162:163], v[162:163], v[154:155] op_sel_hi:[1,0] neg_lo:[0,1] neg_hi:[0,1]
    v_pk_add_f32 v[164:165], v[164:165], v[154:155] op_sel_hi:[1,0] neg_lo:[0,1] neg_hi:[0,1]
    v_pk_add_f32 v[166:167], v[166:167], v[154:155] op_sel_hi:[1,0] neg_lo:[0,1] neg_hi:[0,1]
    v_pk_add_f32 v[168:169], v[168:169], v[154:155] op_sel_hi:[1,0] neg_lo:[0,1] neg_hi:[0,1]
    v_pk_add_f32 v[170:171], v[170:171], v[154:155] op_sel_hi:[1,0] neg_lo:[0,1] neg_hi:[0,1]
    v_pk_add_f32 v[172:173], v[172:173], v[154:155] op_sel_hi:[1,0] neg_lo:[0,1] neg_hi:[0,1]
    v_pk_add_f32 v[174:175], v[174:175], v[154:155] op_sel_hi:[1,0] neg_lo:[0,1] neg_hi:[0,1]
    v_cvt_pk_bf16_f32 v120, v160, v161
    v_cvt_pk_bf16_f32 v121, v162, v163
    v_cvt_pk_bf16_f32 v122, v164, v165
    v_cvt_pk_bf16_f32 v123, v166, v167
    v_cvt_pk_bf16_f32 v124, v168, v169
    v_cvt_pk_bf16_f32 v125, v170, v171
    v_cvt_pk_bf16_f32 v126, v172, v173
    v_cvt_pk_bf16_f32 v127, v174, v175
    v_lshlrev_b32 v160, 16, v120
    v_and_b32 v161, 0xffff0000, v120
    v_lshlrev_b32 v162, 16, v121
    v_and_b32 v163, 0xffff0000, v121
    v_lshlrev_b32 v164, 16, v122
    v_and_b32 v165, 0xffff0000, v122
    v_lshlrev_b32 v166, 16, v123
    v_and_b32 v167, 0xffff0000, v123
    v_lshlrev_b32 v168, 16, v124
    v_and_b32 v169, 0xffff0000, v124
    v_lshlrev_b32 v170, 16, v125
    v_and_b32 v171, 0xffff0000, v125
    v_lshlrev_b32 v172, 16, v126
    v_and_b32 v173, 0xffff0000, v126
    v_lshlrev_b32 v174, 16, v127
    v_and_b32 v175, 0xffff0000, v127
    v_pk_mul_f32 v[160:161], v[160:161], v[152:153] op_sel_hi:[1,0]
    v_pk_mul_f32 v[162:163], v[162:163], v[152:153] op_sel_hi:[1,0]
    v_pk_mul_f32 v[164:165], v[164:165], v[152:153] op_sel_hi:[1,0]
    v_pk_mul_f32 v[166:167], v[166:167], v[152:153] op_sel_hi:[1,0]
    v_pk_mul_f32 v[168:169], v[168:169], v[152:153] op_sel_hi:[1,0]
    v_pk_mul_f32 v[170:171], v[170:171], v[152:153] op_sel_hi:[1,0]
    v_pk_mul_f32 v[172:173], v[172:173], v[152:153] op_sel_hi:[1,0]
    v_pk_mul_f32 v[174:175], v[174:175], v[152:153] op_sel_hi:[1,0]
    v_cvt_pk_bf16_f32 v160, v160, v161
    v_cvt_pk_bf16_f32 v162, v162, v163
    v_cvt_pk_bf16_f32 v164, v164, v165
    v_cvt_pk_bf16_f32 v166, v166, v167
    v_cvt_pk_bf16_f32 v168, v168, v169
    v_cvt_pk_bf16_f32 v170, v170, v171
    v_cvt_pk_bf16_f32 v172, v172, v173
    v_cvt_pk_bf16_f32 v174, v174, v175
    v_accvgpr_write_b32 a120, v160
    v_accvgpr_write_b32 a121, v162
    v_accvgpr_write_b32 a122, v164
    v_accvgpr_write_b32 a123, v166
    v_accvgpr_write_b32 a124, v168
    v_accvgpr_write_b32 a125, v170
    v_accvgpr_write_b32 a126, v172
    v_accvgpr_write_b32 a127, v174
    s_nop 4
L_p1_unit:
    s_cmp_ge_u32 s38, 96
    s_cbranch_scc1 L_p1_end
    s_lshr_b32 s26, s38, 5
    s_add_u32 s27, s26, 1
    s_lshl_b32 s25, s27, 24
    s_lshl_b32 s27, s20, 2
    s_add_u32 s27, s27, s21
    s_lshl_b32 s27, s27, 5
    s_and_b32 s28, s38, 31
    s_add_u32 s27, s27, s28
    s_lshl_b32 s27, s27, 13
    s_add_u32 s25, s25, s27
    s_lshr_b32 s26, s38, 5
    s_cmp_eq_u32 s26, 1
    s_cbranch_scc1 L_p1_v
    s_waitcnt vmcnt(16)
    s_barrier
    ds_read_b64_tr_b16 v[64:65], v128
    ds_read_b64_tr_b16 v[66:67], v128 offset:1024
    ds_read_b64_tr_b16 v[68:69], v129
    ds_read_b64_tr_b16 v[70:71], v129 offset:1024
    ds_read_b64_tr_b16 v[72:73], v130
    ds_read_b64_tr_b16 v[74:75], v130 offset:1024
    ds_read_b64_tr_b16 v[76:77], v131
    ds_read_b64_tr_b16 v[78:79], v131 offset:1024
    ds_read_b64_tr_b16 v[80:81], v132
    ds_read_b64_tr_b16 v[82:83], v132 offset:1024
    ds_read_b64_tr_b16 v[84:85], v133
    ds_read_b64_tr_b16 v[86:87], v133 offset:1024
    ds_read_b64_tr_b16 v[88:89], v134
    ds_read_b64_tr_b16 v[90:91], v134 offset:1024
    s_waitcnt lgkmcnt(12)
    v_mfma_f32_16x16x32_bf16 v[0:3], v[64:67], a[0:3], 0
    ds_read_b64_tr_b16 v[92:93], v135
    v_mfma_f32_16x16x32_bf16 v[4:7], v[64:67], a[64:67], 0
    ds_read_b64_tr_b16 v[94:95], v135 offset:1024
    s_add_u32 s26, s24, 0x300000
    s_add_u32 m0, s29, 0x18000
    s_nop 0
    buffer_load_dwordx4 v136, s[16:19], s26 offen lds
    s_waitcnt lgkmcnt(12)
    v_mfma_f32_16x16x32_bf16 v[8:11], v[68:71], a[0:3], 0
    ds_read_b64_tr_b16 v[96:97], v128 offset:8192
    v_mfma_f32_16x16x32_bf16 v[12:15], v[68:71], a[64:67], 0
    ds_read_b64_tr_b16 v[98:99], v128 offset:9216
    s_add_u32 s26, s24, 0x320000
    s_add_u32 m0, s29, 0x19000
    s_nop 0
    buffer_load_dwordx4 v136, s[16:19], s26 offen lds
    s_waitcnt lgkmcnt(12)
    v_mfma_f32_16x16x32_bf16 v[16:19], v[72:75], a[0:3], 0
    ds_read_b64_tr_b16 v[100:101], v129 offset:8192
    v_mfma_f32_16x16x32_bf16 v[20:23], v[72:75], a[64:67], 0
    ds_read_b64_tr_b16 v[102:103], v129 offset:9216
    s_add_u32 s26, s24, 0x340000
    s_add_u32 m0, s29, 0x1a000
    s_nop 0
    buffer_load_dwordx4 v136, s[16:19], s26 offen lds
    s_waitcnt lgkmcnt(12)
    v_mfma_f32_16x16x32_bf16 v[24:27], v[76:79], a[0:3], 0
    ds_read_b64_tr_b16 v[104:105], v130 offset:8192
    v_mfma_f32_16x16x32_bf16 v[28:31], v[76:79], a[64:67], 0
    ds_read_b64_tr_b16 v[106:107], v130 offset:9216
    s_add_u32 s26, s24, 0x360000
    s_add_u32 m0, s29, 0x1b000
    s_nop 0
    buffer_load_dwordx4 v136, s[16:19], s26 offen lds
    s_waitcnt lgkmcnt(12)
    v_mfma_f32_16x16x32_bf16 v[32:35], v[80:83], a[0:3], 0
    ds_read_b64_tr_b16 v[108:109], v131 offset:8192
    v_mfma_f32_16x16x32_bf16 v[36:39], v[80:83], a[64:67], 0
    ds_read_b64_tr_b16 v[110:111], v131 offset:9216
    s_add_u32 s26, s24, 0x380000
    s_add_u32 m0, s29, 0x1c000
    s_nop 0
    buffer_load_dwordx4 v136, s[16:19], s26 offen lds
    s_waitcnt lgkmcnt(12)
    v_mfma_f32_16x16x32_bf16 v[40:43], v[84:87], a[0:3], 0
    ds_read_b64_tr_b16 v[112:113], v132 offset:8192
    v_mfma_f32_16x16x32_bf16 v[44:47], v[84:87], a[64:67], 0
    ds_read_b64_tr_b16 v[114:115], v132 offset:9216
    s_add_u32 s26, s24, 0x3a0000
    s_add_u32 m0, s29, 0x1d000
    s_nop 0
    buffer_load_dwordx4 v136, s[16:19], s26 offen lds
    s_waitcnt lgkmcnt(12)
    v_mfma_f32_16x16x32_bf16 v[48:51], v[88:91], a[0:3], 0
    ds_read_b64_tr_b16 v[116:117], v133 offset:8192
    v_mfma_f32_16x16x32_bf16 v[52:55], v[88:91], a[64:67], 0
    ds_read_b64_tr_b16 v[118:119], v133 offset:9216
    s_add_u32 s26, s24, 0x3c0000
    s_add_u32 m0, s29, 0x1e000
    s_nop 0
    buffer_load_dwordx4 v136, s[16:19], s26 offen lds
    s_waitcnt lgkmcnt(12)
    v_mfma_f32_16x16x32_bf16 v[56:59], v[92:95], a[0:3], 0
    ds_read_b64_tr_b16 v[120:121], v134 offset:8192
    v_mfma_f32_16x16x32_bf16 v[60:63], v[92:95], a[64:67], 0
    ds_read_b64_tr_b16 v[122:123], v134 offset:9216
    s_add_u32 s26, s24, 0x3e0000
    s_add_u32 m0, s29, 0x1f000
    s_nop 0
    buffer_load_dwordx4 v136, s[16:19], s26 offen lds
    s_waitcnt lgkmcnt(12)
    v_mfma_f32_16x16x32_bf16 v[0:3], v[96:99], a[4:7], v[0:3]
    ds_read_b64_tr_b16 v[124:125], v135 offset:8192
    v_mfma_f32_16x16x32_bf16 v[4:7], v[96:99], a[68:71], v[4:7]
    ds_read_b64_tr_b16 v[126:127], v135 offset:9216
    s_waitcnt lgkmcnt(12)
    v_mfma_f32_16x16x32_bf16 v[8:11], v[100:103], a[4:7], v[8:11]
    ds_read_b64_tr_b16 v[64:65], v128 offset:16384
    v_mfma_f32_16x16x32_bf16 v[12:15], v[100:103], a[68:71], v[12:15]
    ds_read_b64_tr_b16 v[66:67], v128 offset:17408
    s_waitcnt lgkmcnt(12)
    v_mfma_f32_16x16x32_bf16 v[16:19], v[104:107], a[4:7], v[16:19]
    ds_read_b64_tr_b16 v[68:69], v129 offset:16384
    v_mfma_f32_16x16x32_bf16 v[20:23], v[104:107], a[68:71], v[20:23]
    ds_read_b64_tr_b16 v[70:71], v129 offset:17408
    s_waitcnt lgkmcnt(12)
    v_mfma_f32_16x16x32_bf16 v[24:27], v[108:111], a[4:7], v[24:27]
    ds_read_b64_tr_b16 v[72:73], v130 offset:16384
    v_mfma_f32_16x16x32_bf16 v[28:31], v[108:111], a[68:71], v[28:31]
    ds_read_b64_tr_b16 v[74:75], v130 offset:17408
    s_waitcnt lgkmcnt(12)
    v_mfma_f32_16x16x32_bf16 v[32:35], v[112:115], a[4:7], v[32:35]
    ds_read_b64_tr_b16 v[76:77], v131 offset:16384
    v_mfma_f32_16x16x32_bf16 v[36:39], v[112:115], a[68:71], v[36:39]
    ds_read_b64_tr_b16 v[78:79], v131 offset:17408
    s_waitcnt lgkmcnt(12)
    v_mfma_f32_16x16x32_bf16 v[40:43], v[116:119], a[4:7], v[40:43]
    ds_read_b64_tr_b16 v[80:81], v132 offset:16384
    v_mfma_f32_16x16x32_bf16 v[44:47], v[116:119], a[68:71], v[44:47]
    ds_read_b64_tr_b16 v[82:83], v132 offset:17408
    s_waitcnt lgkmcnt(12)
    v_mfma_f32_16x16x32_bf16 v[48:51], v[120:123], a[4:7], v[48:51]
    ds_read_b64_tr_b16 v[84:85], v133 offset:16384
    v_mfma_f32_16x16x32_bf16 v[52:55], v[120:123], a[68:71], v[52:55]
    ds_read_b64_tr_b16 v[86:87], v133 offset:17408
    s_waitcnt lgkmcnt(12)
    v_mfma_f32_16x16x32_bf16 v[56:59], v[124:127], a[4:7], v[56:59]
    ds_read_b64_tr_b16 v[88:89], v134 offset:16384
    v_mfma_f32_16x16x32_bf16 v[60:63], v[124:127], a[68:71], v[60:63]
    ds_read_b64_tr_b16 v[90:91], v134 offset:17408
    s_waitcnt lgkmcnt(12)
    v_mfma_f32_16x16x32_bf16 v[0:3], v[64:67], a[8:11], v[0:3]
    ds_read_b64_tr_b16 v[92:93], v135 offset:16384
    v_mfma_f32_16x16x32_bf16 v[4:7], v[64:67], a[72:75], v[4:7]
    ds_read_b64_tr_b16 v[94:95], v135 offset:17408
    s_waitcnt lgkmcnt(12)
    v_mfma_f32_16x16x32_bf16 v[8:11], v[68:71], a[8:11], v[8:11]
    ds_read_b64_tr_b16 v[96:97], v128 offset:24576
    v_mfma_f32_16x16x32_bf16 v[12:15], v[68:71], a[72:75], v[12:15]
    ds_read_b64_tr_b16 v[98:99], v128 offset:25600
    s_waitcnt lgkmcnt(12)
    v_mfma_f32_16x16x32_bf16 v[16:19], v[72:75], a[8:11], v[16:19]
    ds_read_b64_tr_b16 v[100:101], v129 offset:24576
    v_mfma_f32_16x16x32_bf16 v[20:23], v[72:75], a[72:75], v[20:23]
    ds_read_b64_tr_b16 v[102:103], v129 offset:25600
    s_waitcnt lgkmcnt(12)
    v_mfma_f32_16x16x32_bf16 v[24:27], v[76:79], a[8:11], v[24:27]
    ds_read_b64_tr_b16 v[104:105], v130 offset:24576
    v_mfma_f32_16x16x32_bf16 v[28:31], v[76:79], a[72:75], v[28:31]
    ds_read_b64_tr_b16 v[106:107], v130 offset:25600
    s_waitcnt lgkmcnt(12)
    v_mfma_f32_16x16x32_bf16 v[32:35], v[80:83], a[8:11], v[32:35]
    ds_read_b64_tr_b16 v[108:109], v131 offset:24576
    v_mfma_f32_16x16x32_bf16 v[36:39], v[80:83], a[72:75], v[36:39]
    ds_read_b64_tr_b16 v[110:111], v131 offset:25600
    s_waitcnt lgkmcnt(12)
    v_mfma_f32_16x16x32_bf16 v[40:43], v[84:87], a[8:11], v[40:43]
    ds_read_b64_tr_b16 v[112:113], v132 offset:24576
    v_mfma_f32_16x16x32_bf16 v[44:47], v[84:87], a[72:75], v[44:47]
    ds_read_b64_tr_b16 v[114:115], v132 offset:25600
    s_waitcnt lgkmcnt(12)
    v_mfma_f32_16x16x32_bf16 v[48:51], v[88:91], a[8:11], v[48:51]
    ds_read_b64_tr_b16 v[116:117], v133 offset:24576
    v_mfma_f32_16x16x32_bf16 v[52:55], v[88:91], a[72:75], v[52:55]
    ds_read_b64_tr_b16 v[118:119], v133 offset:25600
    s_waitcnt lgkmcnt(12)
    v_mfma_f32_16x16x32_bf16 v[56:59], v[92:95], a[8:11], v[56:59]
    ds_read_b64_tr_b16 v[120:121], v134 offset:24576
    v_mfma_f32_16x16x32_bf16 v[60:63], v[92:95], a[72:75], v[60:63]
    ds_read_b64_tr_b16 v[122:123], v134 offset:25600
    s_waitcnt lgkmcnt(12)
    v_mfma_f32_16x16x32_bf16 v[0:3], v[96:99], a[12:15], v[0:3]
    ds_read_b64_tr_b16 v[124:125], v135 offset:24576
    v_mfma_f32_16x16x32_bf16 v[4:7], v[96:99], a[76:79], v[4:7]
    ds_read_b64_tr_b16 v[126:127], v135 offset:25600
    s_waitcnt lgkmcnt(12)
    v_mfma_f32_16x16x32_bf16 v[8:11], v[100:103], a[12:15], v[8:11]
    v_mfma_f32_16x16x32_bf16 v[12:15], v[100:103], a[76:79], v[12:15]
    s_waitcnt lgkmcnt(10)
    v_mfma_f32_16x16x32_bf16 v[16:19], v[104:107], a[12:15], v[16:19]
    v_mfma_f32_16x16x32_bf16 v[20:23], v[104:107], a[76:79], v[20:23]
    s_waitcnt lgkmcnt(8)
    v_mfma_f32_16x16x32_bf16 v[24:27], v[108:111], a[12:15], v[24:27]
    v_mfma_f32_16x16x32_bf16 v[28:31], v[108:111], a[76:79], v[28:31]
    s_waitcnt lgkmcnt(6)
    v_mfma_f32_16x16x32_bf16 v[32:35], v[112:115], a[12:15], v[32:35]
    v_mfma_f32_16x16x32_bf16 v[36:39], v[112:115], a[76:79], v[36:39]
    s_waitcnt lgkmcnt(4)
    v_mfma_f32_16x16x32_bf16 v[40:43], v[116:119], a[12:15], v[40:43]
    v_mfma_f32_16x16x32_bf16 v[44:47], v[116:119], a[76:79], v[44:47]
    s_waitcnt lgkmcnt(2)
    v_mfma_f32_16x16x32_bf16 v[48:51], v[120:123], a[12:15], v[48:51]
    v_mfma_f32_16x16x32_bf16 v[52:55], v[120:123], a[76:79], v[52:55]
    s_waitcnt lgkmcnt(0)
    v_mfma_f32_16x16x32_bf16 v[56:59], v[124:127], a[12:15], v[56:59]
    v_mfma_f32_16x16x32_bf16 v[60:63], v[124:127], a[76:79], v[60:63]
    s_waitcnt vmcnt(16)
    s_barrier
    ds_read_b64_tr_b16 v[64:65], v128 offset:32768
    ds_read_b64_tr_b16 v[66:67], v128 offset:33792
    ds_read_b64_tr_b16 v[68:69], v129 offset:32768
    ds_read_b64_tr_b16 v[70:71], v129 offset:33792
    ds_read_b64_tr_b16 v[72:73], v130 offset:32768
    ds_read_b64_tr_b16 v[74:75], v130 offset:33792
    ds_read_b64_tr_b16 v[76:77], v131 offset:32768
    ds_read_b64_tr_b16 v[78:79], v131 offset:33792
    ds_read_b64_tr_b16 v[80:81], v132 offset:32768
    ds_read_b64_tr_b16 v[82:83], v132 offset:33792
    ds_read_b64_tr_b16 v[84:85], v133 offset:32768
    ds_read_b64_tr_b16 v[86:87], v133 offset:33792
    ds_read_b64_tr_b16 v[88:89], v134 offset:32768
    ds_read_b64_tr_b16 v[90:91], v134 offset:33792
    s_add_u32 s39, s39, s37
    s_lshr_b32 s26, s39, 5
    s_cmp_eq_u32 s26, 0
    s_cselect_b64 s[16:17], s[30:31], s[34:35]
    s_cmp_eq_u32 s26, 1
    s_cselect_b64 s[16:17], s[32:33], s[16:17]
    s_and_b32 s17, s17, 0xffff
    s_cmp_lt_u32 s39, 96
    s_cselect_b32 s18, 0x400000, 0
    s_and_b32 s24, s39, 31
    s_lshl_b32 s24, s24, 8
    s_waitcnt lgkmcnt(12)
    v_mfma_f32_16x16x32_bf16 v[0:3], v[64:67], a[16:19], v[0:3]
    ds_read_b64_tr_b16 v[92:93], v135 offset:32768
    v_mfma_f32_16x16x32_bf16 v[4:7], v[64:67], a[80:83], v[4:7]
    ds_read_b64_tr_b16 v[94:95], v135 offset:33792
    s_add_u32 s26, s24, 0x0
    s_add_u32 m0, s29, 0x0
    s_nop 0
    buffer_load_dwordx4 v136, s[16:19], s26 offen lds
    s_waitcnt lgkmcnt(12)
    v_mfma_f32_16x16x32_bf16 v[8:11], v[68:71], a[16:19], v[8:11]
    ds_read_b64_tr_b16 v[96:97], v128 offset:40960
    v_mfma_f32_16x16x32_bf16 v[12:15], v[68:71], a[80:83], v[12:15]
    ds_read_b64_tr_b16 v[98:99], v128 offset:41984
    s_add_u32 s26, s24, 0x20000
    s_add_u32 m0, s29, 0x1000
    s_nop 0
    buffer_load_dwordx4 v136, s[16:19], s26 offen lds
    s_waitcnt lgkmcnt(12)
    v_mfma_f32_16x16x32_bf16 v[16:19], v[72:75], a[16:19], v[16:19]
    ds_read_b64_tr_b16 v[100:101], v129 offset:40960
    v_mfma_f32_16x16x32_bf16 v[20:23], v[72:75], a[80:83], v[20:23]
    ds_read_b64_tr_b16 v[102:103], v129 offset:41984
    s_add_u32 s26, s24, 0x40000
    s_add_u32 m0, s29, 0x2000
    s_nop 0
    buffer_load_dwordx4 v136, s[16:19], s26 offen lds
    s_waitcnt lgkmcnt(12)
    v_mfma_f32_16x16x32_bf16 v[24:27], v[76:79], a[16:19], v[24:27]
    ds_read_b64_tr_b16 v[104:105], v130 offset:40960
    v_mfma_f32_16x16x32_bf16 v[28:31], v[76:79], a[80:83], v[28:31]
    ds_read_b64_tr_b16 v[106:107], v130 offset:41984
    s_add_u32 s26, s24, 0x60000
    s_add_u32 m0, s29, 0x3000
    s_nop 0
    buffer_load_dwordx4 v136, s[16:19], s26 offen lds
    s_waitcnt lgkmcnt(12)
    v_mfma_f32_16x16x32_bf16 v[32:35], v[80:83], a[16:19], v[32:35]
    ds_read_b64_tr_b16 v[108:109], v131 offset:40960
    v_mfma_f32_16x16x32_bf16 v[36:39], v[80:83], a[80:83], v[36:39]
    ds_read_b64_tr_b16 v[110:111], v131 offset:41984
    s_add_u32 s26, s24, 0x80000
    s_add_u32 m0, s29, 0x4000
    s_nop 0
    buffer_load_dwordx4 v136, s[16:19], s26 offen lds
    s_waitcnt lgkmcnt(12)
    v_mfma_f32_16x16x32_bf16 v[40:43], v[84:87], a[16:19], v[40:43]
    ds_read_b64_tr_b16 v[112:113], v132 offset:40960
    v_mfma_f32_16x16x32_bf16 v[44:47], v[84:87], a[80:83], v[44:47]
    ds_read_b64_tr_b16 v[114:115], v132 offset:41984
    s_add_u32 s26, s24, 0xa0000
    s_add_u32 m0, s29, 0x5000
    s_nop 0
    buffer_load_dwordx4 v136, s[16:19], s26 offen lds
    s_waitcnt lgkmcnt(12)
    v_mfma_f32_16x16x32_bf16 v[48:51], v[88:91], a[16:19], v[48:51]
    ds_read_b64_tr_b16 v[116:117], v133 offset:40960
    v_mfma_f32_16x16x32_bf16 v[52:55], v[88:91], a[80:83], v[52:55]
    ds_read_b64_tr_b16 v[118:119], v133 offset:41984
    s_add_u32 s26, s24, 0xc0000
    s_add_u32 m0, s29, 0x6000
    s_nop 0
    buffer_load_dwordx4 v136, s[16:19], s26 offen lds
    s_waitcnt lgkmcnt(12)
    v_mfma_f32_16x16x32_bf16 v[56:59], v[92:95], a[16:19], v[56:59]
    ds_read_b64_tr_b16 v[120:121], v134 offset:40960
    v_mfma_f32_16x16x32_bf16 v[60:63], v[92:95], a[80:83], v[60:63]
    ds_read_b64_tr_b16 v[122:123], v134 offset:41984
    s_add_u32 s26, s24, 0xe0000
    s_add_u32 m0, s29, 0x7000
    s_nop 0
    buffer_load_dwordx4 v136, s[16:19], s26 offen lds
    s_waitcnt lgkmcnt(12)
    v_mfma_f32_16x16x32_bf16 v[0:3], v[96:99], a[20:23], v[0:3]
    ds_read_b64_tr_b16 v[124:125], v135 offset:40960
    v_mfma_f32_16x16x32_bf16 v[4:7], v[96:99], a[84:87], v[4:7]
    ds_read_b64_tr_b16 v[126:127], v135 offset:41984
    s_waitcnt lgkmcnt(12)
    v_mfma_f32_16x16x32_bf16 v[8:11], v[100:103], a[20:23], v[8:11]
    ds_read_b64_tr_b16 v[64:65], v128 offset:49152
    v_mfma_f32_16x16x32_bf16 v[12:15], v[100:103], a[84:87], v[12:15]
    ds_read_b64_tr_b16 v[66:67], v128 offset:50176
    s_waitcnt lgkmcnt(12)
    v_mfma_f32_16x16x32_bf16 v[16:19], v[104:107], a[20:23], v[16:19]
    ds_read_b64_tr_b16 v[68:69], v129 offset:49152
    v_mfma_f32_16x16x32_bf16 v[20:23], v[104:107], a[84:87], v[20:23]
    ds_read_b64_tr_b16 v[70:71], v129 offset:50176
    s_waitcnt lgkmcnt(12)
    v_mfma_f32_16x16x32_bf16 v[24:27], v[108:111], a[20:23], v[24:27]
    ds_read_b64_tr_b16 v[72:73], v130 offset:49152
    v_mfma_f32_16x16x32_bf16 v[28:31], v[108:111], a[84:87], v[28:31]
    ds_read_b64_tr_b16 v[74:75], v130 offset:50176
    s_waitcnt lgkmcnt(12)
    v_mfma_f32_16x16x32_bf16 v[32:35], v[112:115], a[20:23], v[32:35]
    ds_read_b64_tr_b16 v[76:77], v131 offset:49152
    v_mfma_f32_16x16x32_bf16 v[36:39], v[112:115], a[84:87], v[36:39]
    ds_read_b64_tr_b16 v[78:79], v131 offset:50176
    s_waitcnt lgkmcnt(12)
    v_mfma_f32_16x16x32_bf16 v[40:43], v[116:119], a[20:23], v[40:43]
    ds_read_b64_tr_b16 v[80:81], v132 offset:49152
    v_mfma_f32_16x16x32_bf16 v[44:47], v[116:119], a[84:87], v[44:47]
    ds_read_b64_tr_b16 v[82:83], v132 offset:50176
    s_waitcnt lgkmcnt(12)
    v_mfma_f32_16x16x32_bf16 v[48:51], v[120:123], a[20:23], v[48:51]
    ds_read_b64_tr_b16 v[84:85], v133 offset:49152
    v_mfma_f32_16x16x32_bf16 v[52:55], v[120:123], a[84:87], v[52:55]
    ds_read_b64_tr_b16 v[86:87], v133 offset:50176
    s_waitcnt lgkmcnt(12)
    v_mfma_f32_16x16x32_bf16 v[56:59], v[124:127], a[20:23], v[56:59]
    ds_read_b64_tr_b16 v[88:89], v134 offset:49152
    v_mfma_f32_16x16x32_bf16 v[60:63], v[124:127], a[84:87], v[60:63]
    ds_read_b64_tr_b16 v[90:91], v134 offset:50176
    s_waitcnt lgkmcnt(12)
    v_mfma_f32_16x16x32_bf16 v[0:3], v[64:67], a[24:27], v[0:3]
    ds_read_b64_tr_b16 v[92:93], v135 offset:49152
    v_mfma_f32_16x16x32_bf16 v[4:7], v[64:67], a[88:91], v[4:7]
    ds_read_b64_tr_b16 v[94:95], v135 offset:50176
    s_waitcnt lgkmcnt(12)
    v_mfma_f32_16x16x32_bf16 v[8:11], v[68:71], a[24:27], v[8:11]
    ds_read_b64_tr_b16 v[96:97], v128 offset:57344
    v_mfma_f32_16x16x32_bf16 v[12:15], v[68:71], a[88:91], v[12:15]
    ds_read_b64_tr_b16 v[98:99], v128 offset:58368
    s_waitcnt lgkmcnt(12)
    v_mfma_f32_16x16x32_bf16 v[16:19], v[72:75], a[24:27], v[16:19]
    ds_read_b64_tr_b16 v[100:101], v129 offset:57344
    v_mfma_f32_16x16x32_bf16 v[20:23], v[72:75], a[88:91], v[20:23]
    ds_read_b64_tr_b16 v[102:103], v129 offset:58368
    s_waitcnt lgkmcnt(12)
    v_mfma_f32_16x16x32_bf16 v[24:27], v[76:79], a[24:27], v[24:27]
    ds_read_b64_tr_b16 v[104:105], v130 offset:57344
    v_mfma_f32_16x16x32_bf16 v[28:31], v[76:79], a[88:91], v[28:31]
    ds_read_b64_tr_b16 v[106:107], v130 offset:58368
    s_waitcnt lgkmcnt(12)
    v_mfma_f32_16x16x32_bf16 v[32:35], v[80:83], a[24:27], v[32:35]
    ds_read_b64_tr_b16 v[108:109], v131 offset:57344
    v_mfma_f32_16x16x32_bf16 v[36:39], v[80:83], a[88:91], v[36:39]
    ds_read_b64_tr_b16 v[110:111], v131 offset:58368
    s_waitcnt lgkmcnt(12)
    v_mfma_f32_16x16x32_bf16 v[40:43], v[84:87], a[24:27], v[40:43]
    ds_read_b64_tr_b16 v[112:113], v132 offset:57344
    v_mfma_f32_16x16x32_bf16 v[44:47], v[84:87], a[88:91], v[44:47]
    ds_read_b64_tr_b16 v[114:115], v132 offset:58368
    s_waitcnt lgkmcnt(12)
    v_mfma_f32_16x16x32_bf16 v[48:51], v[88:91], a[24:27], v[48:51]
    ds_read_b64_tr_b16 v[116:117], v133 offset:57344
    v_mfma_f32_16x16x32_bf16 v[52:55], v[88:91], a[88:91], v[52:55]
    ds_read_b64_tr_b16 v[118:119], v133 offset:58368
    s_waitcnt lgkmcnt(12)
    v_mfma_f32_16x16x32_bf16 v[56:59], v[92:95], a[24:27], v[56:59]
    ds_read_b64_tr_b16 v[120:121], v134 offset:57344
    v_mfma_f32_16x16x32_bf16 v[60:63], v[92:95], a[88:91], v[60:63]
    ds_read_b64_tr_b16 v[122:123], v134 offset:58368
    s_waitcnt lgkmcnt(12)
    v_mfma_f32_16x16x32_bf16 v[0:3], v[96:99], a[28:31], v[0:3]
    ds_read_b64_tr_b16 v[124:125], v135 offset:57344
    v_mfma_f32_16x16x32_bf16 v[4:7], v[96:99], a[92:95], v[4:7]
    ds_read_b64_tr_b16 v[126:127], v135 offset:58368
    s_waitcnt lgkmcnt(12)
    v_mfma_f32_16x16x32_bf16 v[8:11], v[100:103], a[28:31], v[8:11]
    v_mfma_f32_16x16x32_bf16 v[12:15], v[100:103], a[92:95], v[12:15]
    s_waitcnt lgkmcnt(10)
    v_mfma_f32_16x16x32_bf16 v[16:19], v[104:107], a[28:31], v[16:19]
    v_mfma_f32_16x16x32_bf16 v[20:23], v[104:107], a[92:95], v[20:23]
    s_waitcnt lgkmcnt(8)
    v_mfma_f32_16x16x32_bf16 v[24:27], v[108:111], a[28:31], v[24:27]
    v_mfma_f32_16x16x32_bf16 v[28:31], v[108:111], a[92:95], v[28:31]
    s_waitcnt lgkmcnt(6)
    v_mfma_f32_16x16x32_bf16 v[32:35], v[112:115], a[28:31], v[32:35]
    v_mfma_f32_16x16x32_bf16 v[36:39], v[112:115], a[92:95], v[36:39]
    s_waitcnt lgkmcnt(4)
    v_mfma_f32_16x16x32_bf16 v[40:43], v[116:119], a[28:31], v[40:43]
    v_mfma_f32_16x16x32_bf16 v[44:47], v[116:119], a[92:95], v[44:47]
    s_waitcnt lgkmcnt(2)
    v_mfma_f32_16x16x32_bf16 v[48:51], v[120:123], a[28:31], v[48:51]
    v_mfma_f32_16x16x32_bf16 v[52:55], v[120:123], a[92:95], v[52:55]
    s_waitcnt lgkmcnt(0)
    v_mfma_f32_16x16x32_bf16 v[56:59], v[124:127], a[28:31], v[56:59]
    v_mfma_f32_16x16x32_bf16 v[60:63], v[124:127], a[92:95], v[60:63]
    v_xor_b32 v128, 0x10000, v128
    v_xor_b32 v129, 0x10000, v129
    v_xor_b32 v130, 0x10000, v130
    v_xor_b32 v131, 0x10000, v131
    v_xor_b32 v132, 0x10000, v132
    v_xor_b32 v133, 0x10000, v133
    v_xor_b32 v134, 0x10000, v134
    v_xor_b32 v135, 0x10000, v135
    s_waitcnt vmcnt(16)
    s_barrier
    ds_read_b64_tr_b16 v[64:65], v128
    ds_read_b64_tr_b16 v[66:67], v128 offset:1024
    ds_read_b64_tr_b16 v[68:69], v129
    ds_read_b64_tr_b16 v[70:71], v129 offset:1024
    ds_read_b64_tr_b16 v[72:73], v130
    ds_read_b64_tr_b16 v[74:75], v130 offset:1024
    ds_read_b64_tr_b16 v[76:77], v131
    ds_read_b64_tr_b16 v[78:79], v131 offset:1024
    ds_read_b64_tr_b16 v[80:81], v132
    ds_read_b64_tr_b16 v[82:83], v132 offset:1024
    ds_read_b64_tr_b16 v[84:85], v133
    ds_read_b64_tr_b16 v[86:87], v133 offset:1024
    ds_read_b64_tr_b16 v[88:89], v134
    ds_read_b64_tr_b16 v[90:91], v134 offset:1024
    s_cmp_eq_u32 s40, 0
    s_cbranch_scc1 L_nopf_86
    s_cmp_lg_u32 s87, 0
    s_cbranch_scc1 L_modeok_87
    s_mov_b32 s96, 0
L_mode_88:
    buffer_load_dwordx2 v[140:141], off, s[92:95], 0 offset:36 sc1
    s_waitcnt vmcnt(0)
    v_readfirstlane_b32 s87, v140
    v_readfirstlane_b32 s97, v141
    s_nop 0
    s_min_u32 s97, s97, s87
    s_cmp_lg_u32 s97, 0
    s_cbranch_scc1 L_moded_89
    s_sleep 4
    s_add_u32 s96, s96, 1
    s_cmp_lg_u32 s96, 0x100
    s_cbranch_scc1 L_modef_90
    v_mov_b32 v140, 2
    v_mov_b32 v141, 0
    s_mov_b64 exec, 1
    buffer_atomic_cmpswap v[140:141], off, s[92:95], 0 offset:36
    s_mov_b64 exec, -1
L_modef_90:
    s_cmp_lt_u32 s96, 0x10000
    s_cbranch_scc1 L_mode_88
L_moded_89:
    s_cmp_lg_u32 s87, 1
    s_cbranch_scc1 L_fallback
L_modeok_87:
    s_cmp_lg_u32 s100, 0
    s_cbranch_scc1 L_flag_91
    v_mov_b32 v138, 1
    s_mov_b64 exec, 1
    buffer_store_dword v138, off, s[8:11], s40 sc1
    s_mov_b64 exec, -1
L_flag_91:
    s_mov_b32 s40, 0
L_nopf_86:
    s_waitcnt lgkmcnt(12)
    v_mfma_f32_16x16x32_bf16 v[0:3], v[64:67], a[32:35], v[0:3]
    ds_read_b64_tr_b16 v[92:93], v135
    v_mfma_f32_16x16x32_bf16 v[4:7], v[64:67], a[96:99], v[4:7]
    ds_read_b64_tr_b16 v[94:95], v135 offset:1024
    s_add_u32 s26, s24, 0x100000
    s_add_u32 m0, s29, 0x8000
    s_nop 0
    buffer_load_dwordx4 v136, s[16:19], s26 offen lds
    s_waitcnt lgkmcnt(12)
    v_mfma_f32_16x16x32_bf16 v[8:11], v[68:71], a[32:35], v[8:11]
    ds_read_b64_tr_b16 v[96:97], v128 offset:8192
    v_mfma_f32_16x16x32_bf16 v[12:15], v[68:71], a[96:99], v[12:15]
    ds_read_b64_tr_b16 v[98:99], v128 offset:9216
    s_add_u32 s26, s24, 0x120000
    s_add_u32 m0, s29, 0x9000
    s_nop 0
    buffer_load_dwordx4 v136, s[16:19], s26 offen lds
    s_waitcnt lgkmcnt(12)
    v_mfma_f32_16x16x32_bf16 v[16:19], v[72:75], a[32:35], v[16:19]
    ds_read_b64_tr_b16 v[100:101], v129 offset:8192
    v_mfma_f32_16x16x32_bf16 v[20:23], v[72:75], a[96:99], v[20:23]
    ds_read_b64_tr_b16 v[102:103], v129 offset:9216
    s_add_u32 s26, s24, 0x140000
    s_add_u32 m0, s29, 0xa000
    s_nop 0
    buffer_load_dwordx4 v136, s[16:19], s26 offen lds
    s_waitcnt lgkmcnt(12)
    v_mfma_f32_16x16x32_bf16 v[24:27], v[76:79], a[32:35], v[24:27]
    ds_read_b64_tr_b16 v[104:105], v130 offset:8192
    v_mfma_f32_16x16x32_bf16 v[28:31], v[76:79], a[96:99], v[28:31]
    ds_read_b64_tr_b16 v[106:107], v130 offset:9216
    s_add_u32 s26, s24, 0x160000
    s_add_u32 m0, s29, 0xb000
    s_nop 0
    buffer_load_dwordx4 v136, s[16:19], s26 offen lds
    s_waitcnt lgkmcnt(12)
    v_mfma_f32_16x16x32_bf16 v[32:35], v[80:83], a[32:35], v[32:35]
    ds_read_b64_tr_b16 v[108:109], v131 offset:8192
    v_mfma_f32_16x16x32_bf16 v[36:39], v[80:83], a[96:99], v[36:39]
    ds_read_b64_tr_b16 v[110:111], v131 offset:9216
    s_add_u32 s26, s24, 0x180000
    s_add_u32 m0, s29, 0xc000
    s_nop 0
    buffer_load_dwordx4 v136, s[16:19], s26 offen lds
    s_waitcnt lgkmcnt(12)
    v_mfma_f32_16x16x32_bf16 v[40:43], v[84:87], a[32:35], v[40:43]
    ds_read_b64_tr_b16 v[112:113], v132 offset:8192
    v_mfma_f32_16x16x32_bf16 v[44:47], v[84:87], a[96:99], v[44:47]
    ds_read_b64_tr_b16 v[114:115], v132 offset:9216
    s_add_u32 s26, s24, 0x1a0000
    s_add_u32 m0, s29, 0xd000
    s_nop 0
    buffer_load_dwordx4 v136, s[16:19], s26 offen lds
    s_waitcnt lgkmcnt(12)
    v_mfma_f32_16x16x32_bf16 v[48:51], v[88:91], a[32:35], v[48:51]
    ds_read_b64_tr_b16 v[116:117], v133 offset:8192
    v_mfma_f32_16x16x32_bf16 v[52:55], v[88:91], a[96:99], v[52:55]
    ds_read_b64_tr_b16 v[118:119], v133 offset:9216
    s_add_u32 s26, s24, 0x1c0000
    s_add_u32 m0, s29, 0xe000
    s_nop 0
    buffer_load_dwordx4 v136, s[16:19], s26 offen lds
    s_waitcnt lgkmcnt(12)
    v_mfma_f32_16x16x32_bf16 v[56:59], v[92:95], a[32:35], v[56:59]
    ds_read_b64_tr_b16 v[120:121], v134 offset:8192
    v_mfma_f32_16x16x32_bf16 v[60:63], v[92:95], a[96:99], v[60:63]
    ds_read_b64_tr_b16 v[122:123], v134 offset:9216
    s_add_u32 s26, s24, 0x1e0000
    s_add_u32 m0, s29, 0xf000
    s_nop 0
    buffer_load_dwordx4 v136, s[16:19], s26 offen lds
    s_waitcnt lgkmcnt(12)
    v_mfma_f32_16x16x32_bf16 v[0:3], v[96:99], a[36:39], v[0:3]
    ds_read_b64_tr_b16 v[124:125], v135 offset:8192
    v_mfma_f32_16x16x32_bf16 v[4:7], v[96:99], a[100:103], v[4:7]
    ds_read_b64_tr_b16 v[126:127], v135 offset:9216
    s_waitcnt lgkmcnt(12)
    v_mfma_f32_16x16x32_bf16 v[8:11], v[100:103], a[36:39], v[8:11]
    ds_read_b64_tr_b16 v[64:65], v128 offset:16384
    v_mfma_f32_16x16x32_bf16 v[12:15], v[100:103], a[100:103], v[12:15]
    ds_read_b64_tr_b16 v[66:67], v128 offset:17408
    s_waitcnt lgkmcnt(12)
    v_mfma_f32_16x16x32_bf16 v[16:19], v[104:107], a[36:39], v[16:19]
    ds_read_b64_tr_b16 v[68:69], v129 offset:16384
    v_mfma_f32_16x16x32_bf16 v[20:23], v[104:107], a[100:103], v[20:23]
    ds_read_b64_tr_b16 v[70:71], v129 offset:17408
    s_waitcnt lgkmcnt(12)
    v_mfma_f32_16x16x32_bf16 v[24:27], v[108:111], a[36:39], v[24:27]
    ds_read_b64_tr_b16 v[72:73], v130 offset:16384
    v_mfma_f32_16x16x32_bf16 v[28:31], v[108:111], a[100:103], v[28:31]
    ds_read_b64_tr_b16 v[74:75], v130 offset:17408
    s_waitcnt lgkmcnt(12)
    v_mfma_f32_16x16x32_bf16 v[32:35], v[112:115], a[36:39], v[32:35]
    ds_read_b64_tr_b16 v[76:77], v131 offset:16384
    v_mfma_f32_16x16x32_bf16 v[36:39], v[112:115], a[100:103], v[36:39]
    ds_read_b64_tr_b16 v[78:79], v131 offset:17408
    s_waitcnt lgkmcnt(12)
    v_mfma_f32_16x16x32_bf16 v[40:43], v[116:119], a[36:39], v[40:43]
    ds_read_b64_tr_b16 v[80:81], v132 offset:16384
    v_mfma_f32_16x16x32_bf16 v[44:47], v[116:119], a[100:103], v[44:47]
    ds_read_b64_tr_b16 v[82:83], v132 offset:17408
    s_waitcnt lgkmcnt(12)
    v_mfma_f32_16x16x32_bf16 v[48:51], v[120:123], a[36:39], v[48:51]
    ds_read_b64_tr_b16 v[84:85], v133 offset:16384
    v_mfma_f32_16x16x32_bf16 v[52:55], v[120:123], a[100:103], v[52:55]
    ds_read_b64_tr_b16 v[86:87], v133 offset:17408
    s_waitcnt lgkmcnt(12)
    v_mfma_f32_16x16x32_bf16 v[56:59], v[124:127], a[36:39], v[56:59]
    ds_read_b64_tr_b16 v[88:89], v134 offset:16384
    v_mfma_f32_16x16x32_bf16 v[60:63], v[124:127], a[100:103], v[60:63]
    ds_read_b64_tr_b16 v[90:91], v134 offset:17408
    s_waitcnt lgkmcnt(12)
    v_mfma_f32_16x16x32_bf16 v[0:3], v[64:67], a[40:43], v[0:3]
    ds_read_b64_tr_b16 v[92:93], v135 offset:16384
    v_mfma_f32_16x16x32_bf16 v[4:7], v[64:67], a[104:107], v[4:7]
    ds_read_b64_tr_b16 v[94:95], v135 offset:17408
    s_waitcnt lgkmcnt(12)
    v_mfma_f32_16x16x32_bf16 v[8:11], v[68:71], a[40:43], v[8:11]
    ds_read_b64_tr_b16 v[96:97], v128 offset:24576
    v_mfma_f32_16x16x32_bf16 v[12:15], v[68:71], a[104:107], v[12:15]
    ds_read_b64_tr_b16 v[98:99], v128 offset:25600
    s_waitcnt lgkmcnt(12)
    v_mfma_f32_16x16x32_bf16 v[16:19], v[72:75], a[40:43], v[16:19]
    ds_read_b64_tr_b16 v[100:101], v129 offset:24576
    v_mfma_f32_16x16x32_bf16 v[20:23], v[72:75], a[104:107], v[20:23]
    ds_read_b64_tr_b16 v[102:103], v129 offset:25600
    s_waitcnt lgkmcnt(12)
    v_mfma_f32_16x16x32_bf16 v[24:27], v[76:79], a[40:43], v[24:27]
    ds_read_b64_tr_b16 v[104:105], v130 offset:24576
    v_mfma_f32_16x16x32_bf16 v[28:31], v[76:79], a[104:107], v[28:31]
    ds_read_b64_tr_b16 v[106:107], v130 offset:25600
    s_waitcnt lgkmcnt(12)
    v_mfma_f32_16x16x32_bf16 v[32:35], v[80:83], a[40:43], v[32:35]
    ds_read_b64_tr_b16 v[108:109], v131 offset:24576
    v_mfma_f32_16x16x32_bf16 v[36:39], v[80:83], a[104:107], v[36:39]
    ds_read_b64_tr_b16 v[110:111], v131 offset:25600
    s_waitcnt lgkmcnt(12)
    v_mfma_f32_16x16x32_bf16 v[40:43], v[84:87], a[40:43], v[40:43]
    ds_read_b64_tr_b16 v[112:113], v132 offset:24576
    v_mfma_f32_16x16x32_bf16 v[44:47], v[84:87], a[104:107], v[44:47]
    ds_read_b64_tr_b16 v[114:115], v132 offset:25600
    s_waitcnt lgkmcnt(12)
    v_mfma_f32_16x16x32_bf16 v[48:51], v[88:91], a[40:43], v[48:51]
    ds_read_b64_tr_b16 v[116:117], v133 offset:24576
    v_mfma_f32_16x16x32_bf16 v[52:55], v[88:91], a[104:107], v[52:55]
    ds_read_b64_tr_b16 v[118:119], v133 offset:25600
    s_waitcnt lgkmcnt(12)
    v_mfma_f32_16x16x32_bf16 v[56:59], v[92:95], a[40:43], v[56:59]
    ds_read_b64_tr_b16 v[120:121], v134 offset:24576
    v_mfma_f32_16x16x32_bf16 v[60:63], v[92:95], a[104:107], v[60:63]
    ds_read_b64_tr_b16 v[122:123], v134 offset:25600
    s_waitcnt lgkmcnt(12)
    v_mfma_f32_16x16x32_bf16 v[0:3], v[96:99], a[44:47], v[0:3]
    ds_read_b64_tr_b16 v[124:125], v135 offset:24576
    v_mfma_f32_16x16x32_bf16 v[4:7], v[96:99], a[108:111], v[4:7]
    ds_read_b64_tr_b16 v[126:127], v135 offset:25600
    s_waitcnt lgkmcnt(12)
    v_mfma_f32_16x16x32_bf16 v[8:11], v[100:103], a[44:47], v[8:11]
    v_mfma_f32_16x16x32_bf16 v[12:15], v[100:103], a[108:111], v[12:15]
    s_waitcnt lgkmcnt(10)
    v_mfma_f32_16x16x32_bf16 v[16:19], v[104:107], a[44:47], v[16:19]
    v_mfma_f32_16x16x32_bf16 v[20:23], v[104:107], a[108:111], v[20:23]
    s_waitcnt lgkmcnt(8)
    v_mfma_f32_16x16x32_bf16 v[24:27], v[108:111], a[44:47], v[24:27]
    v_mfma_f32_16x16x32_bf16 v[28:31], v[108:111], a[108:111], v[28:31]
    s_waitcnt lgkmcnt(6)
    v_mfma_f32_16x16x32_bf16 v[32:35], v[112:115], a[44:47], v[32:35]
    v_mfma_f32_16x16x32_bf16 v[36:39], v[112:115], a[108:111], v[36:39]
    s_waitcnt lgkmcnt(4)
    v_mfma_f32_16x16x32_bf16 v[40:43], v[116:119], a[44:47], v[40:43]
    v_mfma_f32_16x16x32_bf16 v[44:47], v[116:119], a[108:111], v[44:47]
    s_waitcnt lgkmcnt(2)
    v_mfma_f32_16x16x32_bf16 v[48:51], v[120:123], a[44:47], v[48:51]
    v_mfma_f32_16x16x32_bf16 v[52:55], v[120:123], a[108:111], v[52:55]
    s_waitcnt lgkmcnt(0)
    v_mfma_f32_16x16x32_bf16 v[56:59], v[124:127], a[44:47], v[56:59]
    v_mfma_f32_16x16x32_bf16 v[60:63], v[124:127], a[108:111], v[60:63]
    s_waitcnt vmcnt(16)
    s_barrier
    ds_read_b64_tr_b16 v[64:65], v128 offset:32768
    ds_read_b64_tr_b16 v[66:67], v128 offset:33792
    ds_read_b64_tr_b16 v[68:69], v129 offset:32768
    ds_read_b64_tr_b16 v[70:71], v129 offset:33792
    ds_read_b64_tr_b16 v[72:73], v130 offset:32768
    ds_read_b64_tr_b16 v[74:75], v130 offset:33792
    ds_read_b64_tr_b16 v[76:77], v131 offset:32768
    ds_read_b64_tr_b16 v[78:79], v131 offset:33792
    ds_read_b64_tr_b16 v[80:81], v132 offset:32768
    ds_read_b64_tr_b16 v[82:83], v132 offset:33792
    ds_read_b64_tr_b16 v[84:85], v133 offset:32768
    ds_read_b64_tr_b16 v[86:87], v133 offset:33792
    ds_read_b64_tr_b16 v[88:89], v134 offset:32768
    ds_read_b64_tr_b16 v[90:91], v134 offset:33792
    s_waitcnt lgkmcnt(12)
    v_mfma_f32_16x16x32_bf16 v[0:3], v[64:67], a[48:51], v[0:3]
    ds_read_b64_tr_b16 v[92:93], v135 offset:32768
    v_mfma_f32_16x16x32_bf16 v[4:7], v[64:67], a[112:115], v[4:7]
    ds_read_b64_tr_b16 v[94:95], v135 offset:33792
    s_add_u32 s26, s24, 0x200000
    s_add_u32 m0, s29, 0x10000
    s_nop 0
    buffer_load_dwordx4 v136, s[16:19], s26 offen lds
    s_waitcnt lgkmcnt(12)
    v_mfma_f32_16x16x32_bf16 v[8:11], v[68:71], a[48:51], v[8:11]
    ds_read_b64_tr_b16 v[96:97], v128 offset:40960
    v_mfma_f32_16x16x32_bf16 v[12:15], v[68:71], a[112:115], v[12:15]
    ds_read_b64_tr_b16 v[98:99], v128 offset:41984
    s_add_u32 s26, s24, 0x220000
    s_add_u32 m0, s29, 0x11000
    s_nop 0
    buffer_load_dwordx4 v136, s[16:19], s26 offen lds
    s_waitcnt lgkmcnt(12)
    v_mfma_f32_16x16x32_bf16 v[16:19], v[72:75], a[48:51], v[16:19]
    ds_read_b64_tr_b16 v[100:101], v129 offset:40960
    v_mfma_f32_16x16x32_bf16 v[20:23], v[72:75], a[112:115], v[20:23]
    ds_read_b64_tr_b16 v[102:103], v129 offset:41984
    s_add_u32 s26, s24, 0x240000
    s_add_u32 m0, s29, 0x12000
    s_nop 0
    buffer_load_dwordx4 v136, s[16:19], s26 offen lds
    s_waitcnt lgkmcnt(12)
    v_mfma_f32_16x16x32_bf16 v[24:27], v[76:79], a[48:51], v[24:27]
    ds_read_b64_tr_b16 v[104:105], v130 offset:40960
    v_mfma_f32_16x16x32_bf16 v[28:31], v[76:79], a[112:115], v[28:31]
    ds_read_b64_tr_b16 v[106:107], v130 offset:41984
    s_add_u32 s26, s24, 0x260000
    s_add_u32 m0, s29, 0x13000
    s_nop 0
    buffer_load_dwordx4 v136, s[16:19], s26 offen lds
    s_waitcnt lgkmcnt(12)
    v_mfma_f32_16x16x32_bf16 v[32:35], v[80:83], a[48:51], v[32:35]
    ds_read_b64_tr_b16 v[108:109], v131 offset:40960
    v_mfma_f32_16x16x32_bf16 v[36:39], v[80:83], a[112:115], v[36:39]
    ds_read_b64_tr_b16 v[110:111], v131 offset:41984
    s_add_u32 s26, s24, 0x280000
    s_add_u32 m0, s29, 0x14000
    s_nop 0
    buffer_load_dwordx4 v136, s[16:19], s26 offen lds
    s_waitcnt lgkmcnt(12)
    v_mfma_f32_16x16x32_bf16 v[40:43], v[84:87], a[48:51], v[40:43]
    ds_read_b64_tr_b16 v[112:113], v132 offset:40960
    v_mfma_f32_16x16x32_bf16 v[44:47], v[84:87], a[112:115], v[44:47]
    ds_read_b64_tr_b16 v[114:115], v132 offset:41984
    s_add_u32 s26, s24, 0x2a0000
    s_add_u32 m0, s29, 0x15000
    s_nop 0
    buffer_load_dwordx4 v136, s[16:19], s26 offen lds
    s_waitcnt lgkmcnt(12)
    v_mfma_f32_16x16x32_bf16 v[48:51], v[88:91], a[48:51], v[48:51]
    ds_read_b64_tr_b16 v[116:117], v133 offset:40960
    v_mfma_f32_16x16x32_bf16 v[52:55], v[88:91], a[112:115], v[52:55]
    ds_read_b64_tr_b16 v[118:119], v133 offset:41984
    s_add_u32 s26, s24, 0x2c0000
    s_add_u32 m0, s29, 0x16000
    s_nop 0
    buffer_load_dwordx4 v136, s[16:19], s26 offen lds
    s_waitcnt lgkmcnt(12)
    v_mfma_f32_16x16x32_bf16 v[56:59], v[92:95], a[48:51], v[56:59]
    ds_read_b64_tr_b16 v[120:121], v134 offset:40960
    v_mfma_f32_16x16x32_bf16 v[60:63], v[92:95], a[112:115], v[60:63]
    ds_read_b64_tr_b16 v[122:123], v134 offset:41984
    s_add_u32 s26, s24, 0x2e0000
    s_add_u32 m0, s29, 0x17000
    s_nop 0
    buffer_load_dwordx4 v136, s[16:19], s26 offen lds
    s_waitcnt lgkmcnt(12)
    v_mfma_f32_16x16x32_bf16 v[0:3], v[96:99], a[52:55], v[0:3]
    ds_read_b64_tr_b16 v[124:125], v135 offset:40960
    v_mfma_f32_16x16x32_bf16 v[4:7], v[96:99], a[116:119], v[4:7]
    ds_read_b64_tr_b16 v[126:127], v135 offset:41984
    s_waitcnt lgkmcnt(12)
    v_mfma_f32_16x16x32_bf16 v[8:11], v[100:103], a[52:55], v[8:11]
    ds_read_b64_tr_b16 v[64:65], v128 offset:49152
    v_mfma_f32_16x16x32_bf16 v[12:15], v[100:103], a[116:119], v[12:15]
    ds_read_b64_tr_b16 v[66:67], v128 offset:50176
    s_waitcnt lgkmcnt(12)
    v_mfma_f32_16x16x32_bf16 v[16:19], v[104:107], a[52:55], v[16:19]
    ds_read_b64_tr_b16 v[68:69], v129 offset:49152
    v_mfma_f32_16x16x32_bf16 v[20:23], v[104:107], a[116:119], v[20:23]
    ds_read_b64_tr_b16 v[70:71], v129 offset:50176
    s_waitcnt lgkmcnt(12)
    v_mfma_f32_16x16x32_bf16 v[24:27], v[108:111], a[52:55], v[24:27]
    ds_read_b64_tr_b16 v[72:73], v130 offset:49152
    v_mfma_f32_16x16x32_bf16 v[28:31], v[108:111], a[116:119], v[28:31]
    ds_read_b64_tr_b16 v[74:75], v130 offset:50176
    s_waitcnt lgkmcnt(12)
    v_mfma_f32_16x16x32_bf16 v[32:35], v[112:115], a[52:55], v[32:35]
    ds_read_b64_tr_b16 v[76:77], v131 offset:49152
    v_mfma_f32_16x16x32_bf16 v[36:39], v[112:115], a[116:119], v[36:39]
    ds_read_b64_tr_b16 v[78:79], v131 offset:50176
    s_waitcnt lgkmcnt(12)
    v_mfma_f32_16x16x32_bf16 v[40:43], v[116:119], a[52:55], v[40:43]
    ds_read_b64_tr_b16 v[80:81], v132 offset:49152
    v_mfma_f32_16x16x32_bf16 v[44:47], v[116:119], a[116:119], v[44:47]
    ds_read_b64_tr_b16 v[82:83], v132 offset:50176
    s_waitcnt lgkmcnt(12)
    v_mfma_f32_16x16x32_bf16 v[48:51], v[120:123], a[52:55], v[48:51]
    ds_read_b64_tr_b16 v[84:85], v133 offset:49152
    v_mfma_f32_16x16x32_bf16 v[52:55], v[120:123], a[116:119], v[52:55]
    ds_read_b64_tr_b16 v[86:87], v133 offset:50176
    s_waitcnt lgkmcnt(12)
    v_mfma_f32_16x16x32_bf16 v[56:59], v[124:127], a[52:55], v[56:59]
    ds_read_b64_tr_b16 v[88:89], v134 offset:49152
    v_mfma_f32_16x16x32_bf16 v[60:63], v[124:127], a[116:119], v[60:63]
    ds_read_b64_tr_b16 v[90:91], v134 offset:50176
    s_waitcnt lgkmcnt(12)
    v_mfma_f32_16x16x32_bf16 v[0:3], v[64:67], a[56:59], v[0:3]
    ds_read_b64_tr_b16 v[92:93], v135 offset:49152
    v_mfma_f32_16x16x32_bf16 v[4:7], v[64:67], a[120:123], v[4:7]
    ds_read_b64_tr_b16 v[94:95], v135 offset:50176
    s_waitcnt lgkmcnt(12)
    v_mfma_f32_16x16x32_bf16 v[8:11], v[68:71], a[56:59], v[8:11]
    ds_read_b64_tr_b16 v[96:97], v128 offset:57344
    v_mfma_f32_16x16x32_bf16 v[12:15], v[68:71], a[120:123], v[12:15]
    ds_read_b64_tr_b16 v[98:99], v128 offset:58368
    s_waitcnt lgkmcnt(12)
    v_mfma_f32_16x16x32_bf16 v[16:19], v[72:75], a[56:59], v[16:19]
    ds_read_b64_tr_b16 v[100:101], v129 offset:57344
    v_mfma_f32_16x16x32_bf16 v[20:23], v[72:75], a[120:123], v[20:23]
    ds_read_b64_tr_b16 v[102:103], v129 offset:58368
    s_waitcnt lgkmcnt(12)
    v_mfma_f32_16x16x32_bf16 v[24:27], v[76:79], a[56:59], v[24:27]
    ds_read_b64_tr_b16 v[104:105], v130 offset:57344
    v_mfma_f32_16x16x32_bf16 v[28:31], v[76:79], a[120:123], v[28:31]
    ds_read_b64_tr_b16 v[106:107], v130 offset:58368
    s_waitcnt lgkmcnt(12)
    v_mfma_f32_16x16x32_bf16 v[32:35], v[80:83], a[56:59], v[32:35]
    ds_read_b64_tr_b16 v[108:109], v131 offset:57344
    v_mfma_f32_16x16x32_bf16 v[36:39], v[80:83], a[120:123], v[36:39]
    ds_read_b64_tr_b16 v[110:111], v131 offset:58368
    s_waitcnt lgkmcnt(12)
    v_mfma_f32_16x16x32_bf16 v[40:43], v[84:87], a[56:59], v[40:43]
    ds_read_b64_tr_b16 v[112:113], v132 offset:57344
    v_mfma_f32_16x16x32_bf16 v[44:47], v[84:87], a[120:123], v[44:47]
    ds_read_b64_tr_b16 v[114:115], v132 offset:58368
    s_waitcnt lgkmcnt(12)
    v_mfma_f32_16x16x32_bf16 v[48:51], v[88:91], a[56:59], v[48:51]
    ds_read_b64_tr_b16 v[116:117], v133 offset:57344
    v_mfma_f32_16x16x32_bf16 v[52:55], v[88:91], a[120:123], v[52:55]
    ds_read_b64_tr_b16 v[118:119], v133 offset:58368
    s_waitcnt lgkmcnt(12)
    v_mfma_f32_16x16x32_bf16 v[56:59], v[92:95], a[56:59], v[56:59]
    ds_read_b64_tr_b16 v[120:121], v134 offset:57344
    v_mfma_f32_16x16x32_bf16 v[60:63], v[92:95], a[120:123], v[60:63]
    ds_read_b64_tr_b16 v[122:123], v134 offset:58368
    s_waitcnt lgkmcnt(12)
    v_mfma_f32_16x16x32_bf16 v[0:3], v[96:99], a[60:63], v[0:3]
    ds_read_b64_tr_b16 v[124:125], v135 offset:57344
    v_mfma_f32_16x16x32_bf16 v[4:7], v[96:99], a[124:127], v[4:7]
    ds_read_b64_tr_b16 v[126:127], v135 offset:58368
    s_waitcnt lgkmcnt(12)
    v_mfma_f32_16x16x32_bf16 v[8:11], v[100:103], a[60:63], v[8:11]
    v_mfma_f32_16x16x32_bf16 v[12:15], v[100:103], a[124:127], v[12:15]
    s_waitcnt lgkmcnt(10)
    v_mfma_f32_16x16x32_bf16 v[16:19], v[104:107], a[60:63], v[16:19]
    v_mfma_f32_16x16x32_bf16 v[20:23], v[104:107], a[124:127], v[20:23]
    s_waitcnt lgkmcnt(8)
    v_mfma_f32_16x16x32_bf16 v[24:27], v[108:111], a[60:63], v[24:27]
    v_mfma_f32_16x16x32_bf16 v[28:31], v[108:111], a[124:127], v[28:31]
    s_waitcnt lgkmcnt(6)
    v_mfma_f32_16x16x32_bf16 v[32:35], v[112:115], a[60:63], v[32:35]
    v_mfma_f32_16x16x32_bf16 v[36:39], v[112:115], a[124:127], v[36:39]
    s_waitcnt lgkmcnt(4)
    v_mfma_f32_16x16x32_bf16 v[40:43], v[116:119], a[60:63], v[40:43]
    v_mfma_f32_16x16x32_bf16 v[44:47], v[116:119], a[124:127], v[44:47]
    s_waitcnt lgkmcnt(2)
    v_mfma_f32_16x16x32_bf16 v[48:51], v[120:123], a[60:63], v[48:51]
    v_mfma_f32_16x16x32_bf16 v[52:55], v[120:123], a[124:127], v[52:55]
    s_waitcnt lgkmcnt(0)
    v_mfma_f32_16x16x32_bf16 v[56:59], v[124:127], a[60:63], v[56:59]
    v_mfma_f32_16x16x32_bf16 v[60:63], v[124:127], a[124:127], v[60:63]
    v_xor_b32 v128, 0x10000, v128
    v_xor_b32 v129, 0x10000, v129
    v_xor_b32 v130, 0x10000, v130
    v_xor_b32 v131, 0x10000, v131
    v_xor_b32 v132, 0x10000, v132
    v_xor_b32 v133, 0x10000, v133
    v_xor_b32 v134, 0x10000, v134
    v_xor_b32 v135, 0x10000, v135
    v_cvt_pk_bf16_f32 v144, v0, v8
    v_cvt_pk_bf16_f32 v145, v1, v9
    v_cvt_pk_bf16_f32 v146, v2, v10
    v_cvt_pk_bf16_f32 v147, v3, v11
    buffer_store_dwordx4 v[144:147], v137, s[8:11], s25 offen sc1
    v_cvt_pk_bf16_f32 v148, v16, v24
    v_cvt_pk_bf16_f32 v149, v17, v25
    v_cvt_pk_bf16_f32 v150, v18, v26
    v_cvt_pk_bf16_f32 v151, v19, v27
    buffer_store_dwordx4 v[148:151], v137, s[8:11], s25 offen offset:1024 sc1
    v_cvt_pk_bf16_f32 v152, v32, v40
    v_cvt_pk_bf16_f32 v153, v33, v41
    v_cvt_pk_bf16_f32 v154, v34, v42
    v_cvt_pk_bf16_f32 v155, v35, v43
    buffer_store_dwordx4 v[152:155], v137, s[8:11], s25 offen offset:2048 sc1
    v_cvt_pk_bf16_f32 v156, v48, v56
    v_cvt_pk_bf16_f32 v157, v49, v57
    v_cvt_pk_bf16_f32 v158, v50, v58
    v_cvt_pk_bf16_f32 v159, v51, v59
    buffer_store_dwordx4 v[156:159], v137, s[8:11], s25 offen offset:3072 sc1
    v_cvt_pk_bf16_f32 v144, v4, v12
    v_cvt_pk_bf16_f32 v145, v5, v13
    v_cvt_pk_bf16_f32 v146, v6, v14
    v_cvt_pk_bf16_f32 v147, v7, v15
    s_add_u32 s25, s25, 4096
    buffer_store_dwordx4 v[144:147], v137, s[8:11], s25 offen sc1
    v_cvt_pk_bf16_f32 v148, v20, v28
    v_cvt_pk_bf16_f32 v149, v21, v29
    v_cvt_pk_bf16_f32 v150, v22, v30
    v_cvt_pk_bf16_f32 v151, v23, v31
    buffer_store_dwordx4 v[148:151], v137, s[8:11], s25 offen offset:1024 sc1
    v_cvt_pk_bf16_f32 v152, v36, v44
    v_cvt_pk_bf16_f32 v153, v37, v45
    v_cvt_pk_bf16_f32 v154, v38, v46
    v_cvt_pk_bf16_f32 v155, v39, v47
    buffer_store_dwordx4 v[152:155], v137, s[8:11], s25 offen offset:2048 sc1
    v_cvt_pk_bf16_f32 v156, v52, v60
    v_cvt_pk_bf16_f32 v157, v53, v61
    v_cvt_pk_bf16_f32 v158, v54, v62
    v_cvt_pk_bf16_f32 v159, v55, v63
    buffer_store_dwordx4 v[156:159], v137, s[8:11], s25 offen offset:3072 sc1
    s_branch L_p1_next
L_p1_v:
    s_waitcnt vmcnt(16)
    s_barrier
    ds_read_b64_tr_b16 v[64:65], v128
    ds_read_b64_tr_b16 v[66:67], v128 offset:1024
    ds_read_b64_tr_b16 v[68:69], v129
    ds_read_b64_tr_b16 v[70:71], v129 offset:1024
    ds_read_b64_tr_b16 v[72:73], v130
    ds_read_b64_tr_b16 v[74:75], v130 offset:1024
    ds_read_b64_tr_b16 v[76:77], v131
    ds_read_b64_tr_b16 v[78:79], v131 offset:1024
    ds_read_b64_tr_b16 v[80:81], v132
    ds_read_b64_tr_b16 v[82:83], v132 offset:1024
    ds_read_b64_tr_b16 v[84:85], v133
    ds_read_b64_tr_b16 v[86:87], v133 offset:1024
    ds_read_b64_tr_b16 v[88:89], v134
    ds_read_b64_tr_b16 v[90:91], v134 offset:1024
    s_waitcnt lgkmcnt(12)
    v_mfma_f32_16x16x32_bf16 v[0:3], a[0:3], v[64:67], 0
    ds_read_b64_tr_b16 v[92:93], v135
    v_mfma_f32_16x16x32_bf16 v[4:7], a[64:67], v[64:67], 0
    ds_read_b64_tr_b16 v[94:95], v135 offset:1024
    s_add_u32 s26, s24, 0x300000
    s_add_u32 m0, s29, 0x18000
    s_nop 0
    buffer_load_dwordx4 v136, s[16:19], s26 offen lds
    s_waitcnt lgkmcnt(12)
    v_mfma_f32_16x16x32_bf16 v[8:11], a[0:3], v[68:71], 0
    ds_read_b64_tr_b16 v[96:97], v128 offset:8192
    v_mfma_f32_16x16x32_bf16 v[12:15], a[64:67], v[68:71], 0
    ds_read_b64_tr_b16 v[98:99], v128 offset:9216
    s_add_u32 s26, s24, 0x320000
    s_add_u32 m0, s29, 0x19000
    s_nop 0
    buffer_load_dwordx4 v136, s[16:19], s26 offen lds
    s_waitcnt lgkmcnt(12)
    v_mfma_f32_16x16x32_bf16 v[16:19], a[0:3], v[72:75], 0
    ds_read_b64_tr_b16 v[100:101], v129 offset:8192
    v_mfma_f32_16x16x32_bf16 v[20:23], a[64:67], v[72:75], 0
    ds_read_b64_tr_b16 v[102:103], v129 offset:9216
    s_add_u32 s26, s24, 0x340000
    s_add_u32 m0, s29, 0x1a000
    s_nop 0
    buffer_load_dwordx4 v136, s[16:19], s26 offen lds
    s_waitcnt lgkmcnt(12)
    v_mfma_f32_16x16x32_bf16 v[24:27], a[0:3], v[76:79], 0
    ds_read_b64_tr_b16 v[104:105], v130 offset:8192
    v_mfma_f32_16x16x32_bf16 v[28:31], a[64:67], v[76:79], 0
    ds_read_b64_tr_b16 v[106:107], v130 offset:9216
    s_add_u32 s26, s24, 0x360000
    s_add_u32 m0, s29, 0x1b000
    s_nop 0
    buffer_load_dwordx4 v136, s[16:19], s26 offen lds
    s_waitcnt lgkmcnt(12)
    v_mfma_f32_16x16x32_bf16 v[32:35], a[0:3], v[80:83], 0
    ds_read_b64_tr_b16 v[108:109], v131 offset:8192
    v_mfma_f32_16x16x32_bf16 v[36:39], a[64:67], v[80:83], 0
    ds_read_b64_tr_b16 v[110:111], v131 offset:9216
    s_add_u32 s26, s24, 0x380000
    s_add_u32 m0, s29, 0x1c000
    s_nop 0
    buffer_load_dwordx4 v136, s[16:19], s26 offen lds
    s_waitcnt lgkmcnt(12)
    v_mfma_f32_16x16x32_bf16 v[40:43], a[0:3], v[84:87], 0
    ds_read_b64_tr_b16 v[112:113], v132 offset:8192
    v_mfma_f32_16x16x32_bf16 v[44:47], a[64:67], v[84:87], 0
    ds_read_b64_tr_b16 v[114:115], v132 offset:9216
    s_add_u32 s26, s24, 0x3a0000
    s_add_u32 m0, s29, 0x1d000
    s_nop 0
    buffer_load_dwordx4 v136, s[16:19], s26 offen lds
    s_waitcnt lgkmcnt(12)
    v_mfma_f32_16x16x32_bf16 v[48:51], a[0:3], v[88:91], 0
    ds_read_b64_tr_b16 v[116:117], v133 offset:8192
    v_mfma_f32_16x16x32_bf16 v[52:55], a[64:67], v[88:91], 0
    ds_read_b64_tr_b16 v[118:119], v133 offset:9216
    s_add_u32 s26, s24, 0x3c0000
    s_add_u32 m0, s29, 0x1e000
    s_nop 0
    buffer_load_dwordx4 v136, s[16:19], s26 offen lds
    s_waitcnt lgkmcnt(12)
    v_mfma_f32_16x16x32_bf16 v[56:59], a[0:3], v[92:95], 0
    ds_read_b64_tr_b16 v[120:121], v134 offset:8192
    v_mfma_f32_16x16x32_bf16 v[60:63], a[64:67], v[92:95], 0
    ds_read_b64_tr_b16 v[122:123], v134 offset:9216
    s_add_u32 s26, s24, 0x3e0000
    s_add_u32 m0, s29, 0x1f000
    s_nop 0
    buffer_load_dwordx4 v136, s[16:19], s26 offen lds
    s_waitcnt lgkmcnt(12)
    v_mfma_f32_16x16x32_bf16 v[0:3], a[4:7], v[96:99], v[0:3]
    ds_read_b64_tr_b16 v[124:125], v135 offset:8192
    v_mfma_f32_16x16x32_bf16 v[4:7], a[68:71], v[96:99], v[4:7]
    ds_read_b64_tr_b16 v[126:127], v135 offset:9216
    s_waitcnt lgkmcnt(12)
    v_mfma_f32_16x16x32_bf16 v[8:11], a[4:7], v[100:103], v[8:11]
    ds_read_b64_tr_b16 v[64:65], v128 offset:16384
    v_mfma_f32_16x16x32_bf16 v[12:15], a[68:71], v[100:103], v[12:15]
    ds_read_b64_tr_b16 v[66:67], v128 offset:17408
    s_waitcnt lgkmcnt(12)
    v_mfma_f32_16x16x32_bf16 v[16:19], a[4:7], v[104:107], v[16:19]
    ds_read_b64_tr_b16 v[68:69], v129 offset:16384
    v_mfma_f32_16x16x32_bf16 v[20:23], a[68:71], v[104:107], v[20:23]
    ds_read_b64_tr_b16 v[70:71], v129 offset:17408
    s_waitcnt lgkmcnt(12)
    v_mfma_f32_16x16x32_bf16 v[24:27], a[4:7], v[108:111], v[24:27]
    ds_read_b64_tr_b16 v[72:73], v130 offset:16384
    v_mfma_f32_16x16x32_bf16 v[28:31], a[68:71], v[108:111], v[28:31]
    ds_read_b64_tr_b16 v[74:75], v130 offset:17408
    s_waitcnt lgkmcnt(12)
    v_mfma_f32_16x16x32_bf16 v[32:35], a[4:7], v[112:115], v[32:35]
    ds_read_b64_tr_b16 v[76:77], v131 offset:16384
    v_mfma_f32_16x16x32_bf16 v[36:39], a[68:71], v[112:115], v[36:39]
    ds_read_b64_tr_b16 v[78:79], v131 offset:17408
    s_waitcnt lgkmcnt(12)
    v_mfma_f32_16x16x32_bf16 v[40:43], a[4:7], v[116:119], v[40:43]
    ds_read_b64_tr_b16 v[80:81], v132 offset:16384
    v_mfma_f32_16x16x32_bf16 v[44:47], a[68:71], v[116:119], v[44:47]
    ds_read_b64_tr_b16 v[82:83], v132 offset:17408
    s_waitcnt lgkmcnt(12)
    v_mfma_f32_16x16x32_bf16 v[48:51], a[4:7], v[120:123], v[48:51]
    ds_read_b64_tr_b16 v[84:85], v133 offset:16384
    v_mfma_f32_16x16x32_bf16 v[52:55], a[68:71], v[120:123], v[52:55]
    ds_read_b64_tr_b16 v[86:87], v133 offset:17408
    s_waitcnt lgkmcnt(12)
    v_mfma_f32_16x16x32_bf16 v[56:59], a[4:7], v[124:127], v[56:59]
    ds_read_b64_tr_b16 v[88:89], v134 offset:16384
    v_mfma_f32_16x16x32_bf16 v[60:63], a[68:71], v[124:127], v[60:63]
    ds_read_b64_tr_b16 v[90:91], v134 offset:17408
    s_waitcnt lgkmcnt(12)
    v_mfma_f32_16x16x32_bf16 v[0:3], a[8:11], v[64:67], v[0:3]
    ds_read_b64_tr_b16 v[92:93], v135 offset:16384
    v_mfma_f32_16x16x32_bf16 v[4:7], a[72:75], v[64:67], v[4:7]
    ds_read_b64_tr_b16 v[94:95], v135 offset:17408
    s_waitcnt lgkmcnt(12)
    v_mfma_f32_16x16x32_bf16 v[8:11], a[8:11], v[68:71], v[8:11]
    ds_read_b64_tr_b16 v[96:97], v128 offset:24576
    v_mfma_f32_16x16x32_bf16 v[12:15], a[72:75], v[68:71], v[12:15]
    ds_read_b64_tr_b16 v[98:99], v128 offset:25600
    s_waitcnt lgkmcnt(12)
    v_mfma_f32_16x16x32_bf16 v[16:19], a[8:11], v[72:75], v[16:19]
    ds_read_b64_tr_b16 v[100:101], v129 offset:24576
    v_mfma_f32_16x16x32_bf16 v[20:23], a[72:75], v[72:75], v[20:23]
    ds_read_b64_tr_b16 v[102:103], v129 offset:25600
    s_waitcnt lgkmcnt(12)
    v_mfma_f32_16x16x32_bf16 v[24:27], a[8:11], v[76:79], v[24:27]
    ds_read_b64_tr_b16 v[104:105], v130 offset:24576
    v_mfma_f32_16x16x32_bf16 v[28:31], a[72:75], v[76:79], v[28:31]
    ds_read_b64_tr_b16 v[106:107], v130 offset:25600
    s_waitcnt lgkmcnt(12)
    v_mfma_f32_16x16x32_bf16 v[32:35], a[8:11], v[80:83], v[32:35]
    ds_read_b64_tr_b16 v[108:109], v131 offset:24576
    v_mfma_f32_16x16x32_bf16 v[36:39], a[72:75], v[80:83], v[36:39]
    ds_read_b64_tr_b16 v[110:111], v131 offset:25600
    s_waitcnt lgkmcnt(12)
    v_mfma_f32_16x16x32_bf16 v[40:43], a[8:11], v[84:87], v[40:43]
    ds_read_b64_tr_b16 v[112:113], v132 offset:24576
    v_mfma_f32_16x16x32_bf16 v[44:47], a[72:75], v[84:87], v[44:47]
    ds_read_b64_tr_b16 v[114:115], v132 offset:25600
    s_waitcnt lgkmcnt(12)
    v_mfma_f32_16x16x32_bf16 v[48:51], a[8:11], v[88:91], v[48:51]
    ds_read_b64_tr_b16 v[116:117], v133 offset:24576
    v_mfma_f32_16x16x32_bf16 v[52:55], a[72:75], v[88:91], v[52:55]
    ds_read_b64_tr_b16 v[118:119], v133 offset:25600
    s_waitcnt lgkmcnt(12)
    v_mfma_f32_16x16x32_bf16 v[56:59], a[8:11], v[92:95], v[56:59]
    ds_read_b64_tr_b16 v[120:121], v134 offset:24576
    v_mfma_f32_16x16x32_bf16 v[60:63], a[72:75], v[92:95], v[60:63]
    ds_read_b64_tr_b16 v[122:123], v134 offset:25600
    s_waitcnt lgkmcnt(12)
    v_mfma_f32_16x16x32_bf16 v[0:3], a[12:15], v[96:99], v[0:3]
    ds_read_b64_tr_b16 v[124:125], v135 offset:24576
    v_mfma_f32_16x16x32_bf16 v[4:7], a[76:79], v[96:99], v[4:7]
    ds_read_b64_tr_b16 v[126:127], v135 offset:25600
    s_waitcnt lgkmcnt(12)
    v_mfma_f32_16x16x32_bf16 v[8:11], a[12:15], v[100:103], v[8:11]
    v_mfma_f32_16x16x32_bf16 v[12:15], a[76:79], v[100:103], v[12:15]
    s_waitcnt lgkmcnt(10)
    v_mfma_f32_16x16x32_bf16 v[16:19], a[12:15], v[104:107], v[16:19]
    v_mfma_f32_16x16x32_bf16 v[20:23], a[76:79], v[104:107], v[20:23]
    s_waitcnt lgkmcnt(8)
    v_mfma_f32_16x16x32_bf16 v[24:27], a[12:15], v[108:111], v[24:27]
    v_mfma_f32_16x16x32_bf16 v[28:31], a[76:79], v[108:111], v[28:31]
    s_waitcnt lgkmcnt(6)
    v_mfma_f32_16x16x32_bf16 v[32:35], a[12:15], v[112:115], v[32:35]
    v_mfma_f32_16x16x32_bf16 v[36:39], a[76:79], v[112:115], v[36:39]
    s_waitcnt lgkmcnt(4)
    v_mfma_f32_16x16x32_bf16 v[40:43], a[12:15], v[116:119], v[40:43]
    v_mfma_f32_16x16x32_bf16 v[44:47], a[76:79], v[116:119], v[44:47]
    s_waitcnt lgkmcnt(2)
    v_mfma_f32_16x16x32_bf16 v[48:51], a[12:15], v[120:123], v[48:51]
    v_mfma_f32_16x16x32_bf16 v[52:55], a[76:79], v[120:123], v[52:55]
    s_waitcnt lgkmcnt(0)
    v_mfma_f32_16x16x32_bf16 v[56:59], a[12:15], v[124:127], v[56:59]
    v_mfma_f32_16x16x32_bf16 v[60:63], a[76:79], v[124:127], v[60:63]
    s_waitcnt vmcnt(16)
    s_barrier
    ds_read_b64_tr_b16 v[64:65], v128 offset:32768
    ds_read_b64_tr_b16 v[66:67], v128 offset:33792
    ds_read_b64_tr_b16 v[68:69], v129 offset:32768
    ds_read_b64_tr_b16 v[70:71], v129 offset:33792
    ds_read_b64_tr_b16 v[72:73], v130 offset:32768
    ds_read_b64_tr_b16 v[74:75], v130 offset:33792
    ds_read_b64_tr_b16 v[76:77], v131 offset:32768
    ds_read_b64_tr_b16 v[78:79], v131 offset:33792
    ds_read_b64_tr_b16 v[80:81], v132 offset:32768
    ds_read_b64_tr_b16 v[82:83], v132 offset:33792
    ds_read_b64_tr_b16 v[84:85], v133 offset:32768
    ds_read_b64_tr_b16 v[86:87], v133 offset:33792
    ds_read_b64_tr_b16 v[88:89], v134 offset:32768
    ds_read_b64_tr_b16 v[90:91], v134 offset:33792
    s_add_u32 s39, s39, s37
    s_lshr_b32 s26, s39, 5
    s_cmp_eq_u32 s26, 0
    s_cselect_b64 s[16:17], s[30:31], s[34:35]
    s_cmp_eq_u32 s26, 1
    s_cselect_b64 s[16:17], s[32:33], s[16:17]
    s_and_b32 s17, s17, 0xffff
    s_cmp_lt_u32 s39, 96
    s_cselect_b32 s18, 0x400000, 0
    s_and_b32 s24, s39, 31
    s_lshl_b32 s24, s24, 8
    s_waitcnt lgkmcnt(12)
    v_mfma_f32_16x16x32_bf16 v[0:3], a[16:19], v[64:67], v[0:3]
    ds_read_b64_tr_b16 v[92:93], v135 offset:32768
    v_mfma_f32_16x16x32_bf16 v[4:7], a[80:83], v[64:67], v[4:7]
    ds_read_b64_tr_b16 v[94:95], v135 offset:33792
    s_add_u32 s26, s24, 0x0
    s_add_u32 m0, s29, 0x0
    s_nop 0
    buffer_load_dwordx4 v136, s[16:19], s26 offen lds
    s_waitcnt lgkmcnt(12)
    v_mfma_f32_16x16x32_bf16 v[8:11], a[16:19], v[68:71], v[8:11]
    ds_read_b64_tr_b16 v[96:97], v128 offset:40960
    v_mfma_f32_16x16x32_bf16 v[12:15], a[80:83], v[68:71], v[12:15]
    ds_read_b64_tr_b16 v[98:99], v128 offset:41984
    s_add_u32 s26, s24, 0x20000
    s_add_u32 m0, s29, 0x1000
    s_nop 0
    buffer_load_dwordx4 v136, s[16:19], s26 offen lds
    s_waitcnt lgkmcnt(12)
    v_mfma_f32_16x16x32_bf16 v[16:19], a[16:19], v[72:75], v[16:19]
    ds_read_b64_tr_b16 v[100:101], v129 offset:40960
    v_mfma_f32_16x16x32_bf16 v[20:23], a[80:83], v[72:75], v[20:23]
    ds_read_b64_tr_b16 v[102:103], v129 offset:41984
    s_add_u32 s26, s24, 0x40000
    s_add_u32 m0, s29, 0x2000
    s_nop 0
    buffer_load_dwordx4 v136, s[16:19], s26 offen lds
    s_waitcnt lgkmcnt(12)
    v_mfma_f32_16x16x32_bf16 v[24:27], a[16:19], v[76:79], v[24:27]
    ds_read_b64_tr_b16 v[104:105], v130 offset:40960
    v_mfma_f32_16x16x32_bf16 v[28:31], a[80:83], v[76:79], v[28:31]
    ds_read_b64_tr_b16 v[106:107], v130 offset:41984
    s_add_u32 s26, s24, 0x60000
    s_add_u32 m0, s29, 0x3000
    s_nop 0
    buffer_load_dwordx4 v136, s[16:19], s26 offen lds
    s_waitcnt lgkmcnt(12)
    v_mfma_f32_16x16x32_bf16 v[32:35], a[16:19], v[80:83], v[32:35]
    ds_read_b64_tr_b16 v[108:109], v131 offset:40960
    v_mfma_f32_16x16x32_bf16 v[36:39], a[80:83], v[80:83], v[36:39]
    ds_read_b64_tr_b16 v[110:111], v131 offset:41984
    s_add_u32 s26, s24, 0x80000
    s_add_u32 m0, s29, 0x4000
    s_nop 0
    buffer_load_dwordx4 v136, s[16:19], s26 offen lds
    s_waitcnt lgkmcnt(12)
    v_mfma_f32_16x16x32_bf16 v[40:43], a[16:19], v[84:87], v[40:43]
    ds_read_b64_tr_b16 v[112:113], v132 offset:40960
    v_mfma_f32_16x16x32_bf16 v[44:47], a[80:83], v[84:87], v[44:47]
    ds_read_b64_tr_b16 v[114:115], v132 offset:41984
    s_add_u32 s26, s24, 0xa0000
    s_add_u32 m0, s29, 0x5000
    s_nop 0
    buffer_load_dwordx4 v136, s[16:19], s26 offen lds
    s_waitcnt lgkmcnt(12)
    v_mfma_f32_16x16x32_bf16 v[48:51], a[16:19], v[88:91], v[48:51]
    ds_read_b64_tr_b16 v[116:117], v133 offset:40960
    v_mfma_f32_16x16x32_bf16 v[52:55], a[80:83], v[88:91], v[52:55]
    ds_read_b64_tr_b16 v[118:119], v133 offset:41984
    s_add_u32 s26, s24, 0xc0000
    s_add_u32 m0, s29, 0x6000
    s_nop 0
    buffer_load_dwordx4 v136, s[16:19], s26 offen lds
    s_waitcnt lgkmcnt(12)
    v_mfma_f32_16x16x32_bf16 v[56:59], a[16:19], v[92:95], v[56:59]
    ds_read_b64_tr_b16 v[120:121], v134 offset:40960
    v_mfma_f32_16x16x32_bf16 v[60:63], a[80:83], v[92:95], v[60:63]
    ds_read_b64_tr_b16 v[122:123], v134 offset:41984
    s_add_u32 s26, s24, 0xe0000
    s_add_u32 m0, s29, 0x7000
    s_nop 0
    buffer_load_dwordx4 v136, s[16:19], s26 offen lds
    s_waitcnt lgkmcnt(12)
    v_mfma_f32_16x16x32_bf16 v[0:3], a[20:23], v[96:99], v[0:3]
    ds_read_b64_tr_b16 v[124:125], v135 offset:40960
    v_mfma_f32_16x16x32_bf16 v[4:7], a[84:87], v[96:99], v[4:7]
    ds_read_b64_tr_b16 v[126:127], v135 offset:41984
    s_waitcnt lgkmcnt(12)
    v_mfma_f32_16x16x32_bf16 v[8:11], a[20:23], v[100:103], v[8:11]
    ds_read_b64_tr_b16 v[64:65], v128 offset:49152
    v_mfma_f32_16x16x32_bf16 v[12:15], a[84:87], v[100:103], v[12:15]
    ds_read_b64_tr_b16 v[66:67], v128 offset:50176
    s_waitcnt lgkmcnt(12)
    v_mfma_f32_16x16x32_bf16 v[16:19], a[20:23], v[104:107], v[16:19]
    ds_read_b64_tr_b16 v[68:69], v129 offset:49152
    v_mfma_f32_16x16x32_bf16 v[20:23], a[84:87], v[104:107], v[20:23]
    ds_read_b64_tr_b16 v[70:71], v129 offset:50176
    s_waitcnt lgkmcnt(12)
    v_mfma_f32_16x16x32_bf16 v[24:27], a[20:23], v[108:111], v[24:27]
    ds_read_b64_tr_b16 v[72:73], v130 offset:49152
    v_mfma_f32_16x16x32_bf16 v[28:31], a[84:87], v[108:111], v[28:31]
    ds_read_b64_tr_b16 v[74:75], v130 offset:50176
    s_waitcnt lgkmcnt(12)
    v_mfma_f32_16x16x32_bf16 v[32:35], a[20:23], v[112:115], v[32:35]
    ds_read_b64_tr_b16 v[76:77], v131 offset:49152
    v_mfma_f32_16x16x32_bf16 v[36:39], a[84:87], v[112:115], v[36:39]
    ds_read_b64_tr_b16 v[78:79], v131 offset:50176
    s_waitcnt lgkmcnt(12)
    v_mfma_f32_16x16x32_bf16 v[40:43], a[20:23], v[116:119], v[40:43]
    ds_read_b64_tr_b16 v[80:81], v132 offset:49152
    v_mfma_f32_16x16x32_bf16 v[44:47], a[84:87], v[116:119], v[44:47]
    ds_read_b64_tr_b16 v[82:83], v132 offset:50176
    s_waitcnt lgkmcnt(12)
    v_mfma_f32_16x16x32_bf16 v[48:51], a[20:23], v[120:123], v[48:51]
    ds_read_b64_tr_b16 v[84:85], v133 offset:49152
    v_mfma_f32_16x16x32_bf16 v[52:55], a[84:87], v[120:123], v[52:55]
    ds_read_b64_tr_b16 v[86:87], v133 offset:50176
    s_waitcnt lgkmcnt(12)
    v_mfma_f32_16x16x32_bf16 v[56:59], a[20:23], v[124:127], v[56:59]
    ds_read_b64_tr_b16 v[88:89], v134 offset:49152
    v_mfma_f32_16x16x32_bf16 v[60:63], a[84:87], v[124:127], v[60:63]
    ds_read_b64_tr_b16 v[90:91], v134 offset:50176
    s_waitcnt lgkmcnt(12)
    v_mfma_f32_16x16x32_bf16 v[0:3], a[24:27], v[64:67], v[0:3]
    ds_read_b64_tr_b16 v[92:93], v135 offset:49152
    v_mfma_f32_16x16x32_bf16 v[4:7], a[88:91], v[64:67], v[4:7]
    ds_read_b64_tr_b16 v[94:95], v135 offset:50176
    s_waitcnt lgkmcnt(12)
    v_mfma_f32_16x16x32_bf16 v[8:11], a[24:27], v[68:71], v[8:11]
    ds_read_b64_tr_b16 v[96:97], v128 offset:57344
    v_mfma_f32_16x16x32_bf16 v[12:15], a[88:91], v[68:71], v[12:15]
    ds_read_b64_tr_b16 v[98:99], v128 offset:58368
    s_waitcnt lgkmcnt(12)
    v_mfma_f32_16x16x32_bf16 v[16:19], a[24:27], v[72:75], v[16:19]
    ds_read_b64_tr_b16 v[100:101], v129 offset:57344
    v_mfma_f32_16x16x32_bf16 v[20:23], a[88:91], v[72:75], v[20:23]
    ds_read_b64_tr_b16 v[102:103], v129 offset:58368
    s_waitcnt lgkmcnt(12)
    v_mfma_f32_16x16x32_bf16 v[24:27], a[24:27], v[76:79], v[24:27]
    ds_read_b64_tr_b16 v[104:105], v130 offset:57344
    v_mfma_f32_16x16x32_bf16 v[28:31], a[88:91], v[76:79], v[28:31]
    ds_read_b64_tr_b16 v[106:107], v130 offset:58368
    s_waitcnt lgkmcnt(12)
    v_mfma_f32_16x16x32_bf16 v[32:35], a[24:27], v[80:83], v[32:35]
    ds_read_b64_tr_b16 v[108:109], v131 offset:57344
    v_mfma_f32_16x16x32_bf16 v[36:39], a[88:91], v[80:83], v[36:39]
    ds_read_b64_tr_b16 v[110:111], v131 offset:58368
    s_waitcnt lgkmcnt(12)
    v_mfma_f32_16x16x32_bf16 v[40:43], a[24:27], v[84:87], v[40:43]
    ds_read_b64_tr_b16 v[112:113], v132 offset:57344
    v_mfma_f32_16x16x32_bf16 v[44:47], a[88:91], v[84:87], v[44:47]
    ds_read_b64_tr_b16 v[114:115], v132 offset:58368
    s_waitcnt lgkmcnt(12)
    v_mfma_f32_16x16x32_bf16 v[48:51], a[24:27], v[88:91], v[48:51]
    ds_read_b64_tr_b16 v[116:117], v133 offset:57344
    v_mfma_f32_16x16x32_bf16 v[52:55], a[88:91], v[88:91], v[52:55]
    ds_read_b64_tr_b16 v[118:119], v133 offset:58368
    s_waitcnt lgkmcnt(12)
    v_mfma_f32_16x16x32_bf16 v[56:59], a[24:27], v[92:95], v[56:59]
    ds_read_b64_tr_b16 v[120:121], v134 offset:57344
    v_mfma_f32_16x16x32_bf16 v[60:63], a[88:91], v[92:95], v[60:63]
    ds_read_b64_tr_b16 v[122:123], v134 offset:58368
    s_waitcnt lgkmcnt(12)
    v_mfma_f32_16x16x32_bf16 v[0:3], a[28:31], v[96:99], v[0:3]
    ds_read_b64_tr_b16 v[124:125], v135 offset:57344
    v_mfma_f32_16x16x32_bf16 v[4:7], a[92:95], v[96:99], v[4:7]
    ds_read_b64_tr_b16 v[126:127], v135 offset:58368
    s_waitcnt lgkmcnt(12)
    v_mfma_f32_16x16x32_bf16 v[8:11], a[28:31], v[100:103], v[8:11]
    v_mfma_f32_16x16x32_bf16 v[12:15], a[92:95], v[100:103], v[12:15]
    s_waitcnt lgkmcnt(10)
    v_mfma_f32_16x16x32_bf16 v[16:19], a[28:31], v[104:107], v[16:19]
    v_mfma_f32_16x16x32_bf16 v[20:23], a[92:95], v[104:107], v[20:23]
    s_waitcnt lgkmcnt(8)
    v_mfma_f32_16x16x32_bf16 v[24:27], a[28:31], v[108:111], v[24:27]
    v_mfma_f32_16x16x32_bf16 v[28:31], a[92:95], v[108:111], v[28:31]
    s_waitcnt lgkmcnt(6)
    v_mfma_f32_16x16x32_bf16 v[32:35], a[28:31], v[112:115], v[32:35]
    v_mfma_f32_16x16x32_bf16 v[36:39], a[92:95], v[112:115], v[36:39]
    s_waitcnt lgkmcnt(4)
    v_mfma_f32_16x16x32_bf16 v[40:43], a[28:31], v[116:119], v[40:43]
    v_mfma_f32_16x16x32_bf16 v[44:47], a[92:95], v[116:119], v[44:47]
    s_waitcnt lgkmcnt(2)
    v_mfma_f32_16x16x32_bf16 v[48:51], a[28:31], v[120:123], v[48:51]
    v_mfma_f32_16x16x32_bf16 v[52:55], a[92:95], v[120:123], v[52:55]
    s_waitcnt lgkmcnt(0)
    v_mfma_f32_16x16x32_bf16 v[56:59], a[28:31], v[124:127], v[56:59]
    v_mfma_f32_16x16x32_bf16 v[60:63], a[92:95], v[124:127], v[60:63]
    v_xor_b32 v128, 0x10000, v128
    v_xor_b32 v129, 0x10000, v129
    v_xor_b32 v130, 0x10000, v130
    v_xor_b32 v131, 0x10000, v131
    v_xor_b32 v132, 0x10000, v132
    v_xor_b32 v133, 0x10000, v133
    v_xor_b32 v134, 0x10000, v134
    v_xor_b32 v135, 0x10000, v135
    s_waitcnt vmcnt(16)
    s_barrier
    ds_read_b64_tr_b16 v[64:65], v128
    ds_read_b64_tr_b16 v[66:67], v128 offset:1024
    ds_read_b64_tr_b16 v[68:69], v129
    ds_read_b64_tr_b16 v[70:71], v129 offset:1024
    ds_read_b64_tr_b16 v[72:73], v130
    ds_read_b64_tr_b16 v[74:75], v130 offset:1024
    ds_read_b64_tr_b16 v[76:77], v131
    ds_read_b64_tr_b16 v[78:79], v131 offset:1024
    ds_read_b64_tr_b16 v[80:81], v132
    ds_read_b64_tr_b16 v[82:83], v132 offset:1024
    ds_read_b64_tr_b16 v[84:85], v133
    ds_read_b64_tr_b16 v[86:87], v133 offset:1024
    ds_read_b64_tr_b16 v[88:89], v134
    ds_read_b64_tr_b16 v[90:91], v134 offset:1024
    s_cmp_eq_u32 s40, 0
    s_cbranch_scc1 L_nopf_92
    s_cmp_lg_u32 s87, 0
    s_cbranch_scc1 L_modeok_93
    s_mov_b32 s96, 0
L_mode_94:
    buffer_load_dwordx2 v[140:141], off, s[92:95], 0 offset:36 sc1
    s_waitcnt vmcnt(0)
    v_readfirstlane_b32 s87, v140
    v_readfirstlane_b32 s97, v141
    s_nop 0
    s_min_u32 s97, s97, s87
    s_cmp_lg_u32 s97, 0
    s_cbranch_scc1 L_moded_95
    s_sleep 4
    s_add_u32 s96, s96, 1
    s_cmp_lg_u32 s96, 0x100
    s_cbranch_scc1 L_modef_96
    v_mov_b32 v140, 2
    v_mov_b32 v141, 0
    s_mov_b64 exec, 1
    buffer_atomic_cmpswap v[140:141], off, s[92:95], 0 offset:36
    s_mov_b64 exec, -1
L_modef_96:
    s_cmp_lt_u32 s96, 0x10000
    s_cbranch_scc1 L_mode_94
L_moded_95:
    s_cmp_lg_u32 s87, 1
    s_cbranch_scc1 L_fallback
L_modeok_93:
    s_cmp_lg_u32 s100, 0
    s_cbranch_scc1 L_flag_97
    v_mov_b32 v138, 1
    s_mov_b64 exec, 1
    buffer_store_dword v138, off, s[8:11], s40 sc1
    s_mov_b64 exec, -1
L_flag_97:
    s_mov_b32 s40, 0
L_nopf_92:
    s_waitcnt lgkmcnt(12)
    v_mfma_f32_16x16x32_bf16 v[0:3], a[32:35], v[64:67], v[0:3]
    ds_read_b64_tr_b16 v[92:93], v135
    v_mfma_f32_16x16x32_bf16 v[4:7], a[96:99], v[64:67], v[4:7]
    ds_read_b64_tr_b16 v[94:95], v135 offset:1024
    s_add_u32 s26, s24, 0x100000
    s_add_u32 m0, s29, 0x8000
    s_nop 0
    buffer_load_dwordx4 v136, s[16:19], s26 offen lds
    s_waitcnt lgkmcnt(12)
    v_mfma_f32_16x16x32_bf16 v[8:11], a[32:35], v[68:71], v[8:11]
    ds_read_b64_tr_b16 v[96:97], v128 offset:8192
    v_mfma_f32_16x16x32_bf16 v[12:15], a[96:99], v[68:71], v[12:15]
    ds_read_b64_tr_b16 v[98:99], v128 offset:9216
    s_add_u32 s26, s24, 0x120000
    s_add_u32 m0, s29, 0x9000
    s_nop 0
    buffer_load_dwordx4 v136, s[16:19], s26 offen lds
    s_waitcnt lgkmcnt(12)
    v_mfma_f32_16x16x32_bf16 v[16:19], a[32:35], v[72:75], v[16:19]
    ds_read_b64_tr_b16 v[100:101], v129 offset:8192
    v_mfma_f32_16x16x32_bf16 v[20:23], a[96:99], v[72:75], v[20:23]
    ds_read_b64_tr_b16 v[102:103], v129 offset:9216
    s_add_u32 s26, s24, 0x140000
    s_add_u32 m0, s29, 0xa000
    s_nop 0
    buffer_load_dwordx4 v136, s[16:19], s26 offen lds
    s_waitcnt lgkmcnt(12)
    v_mfma_f32_16x16x32_bf16 v[24:27], a[32:35], v[76:79], v[24:27]
    ds_read_b64_tr_b16 v[104:105], v130 offset:8192
    v_mfma_f32_16x16x32_bf16 v[28:31], a[96:99], v[76:79], v[28:31]
    ds_read_b64_tr_b16 v[106:107], v130 offset:9216
    s_add_u32 s26, s24, 0x160000
    s_add_u32 m0, s29, 0xb000
    s_nop 0
    buffer_load_dwordx4 v136, s[16:19], s26 offen lds
    s_waitcnt lgkmcnt(12)
    v_mfma_f32_16x16x32_bf16 v[32:35], a[32:35], v[80:83], v[32:35]
    ds_read_b64_tr_b16 v[108:109], v131 offset:8192
    v_mfma_f32_16x16x32_bf16 v[36:39], a[96:99], v[80:83], v[36:39]
    ds_read_b64_tr_b16 v[110:111], v131 offset:9216
    s_add_u32 s26, s24, 0x180000
    s_add_u32 m0, s29, 0xc000
    s_nop 0
    buffer_load_dwordx4 v136, s[16:19], s26 offen lds
    s_waitcnt lgkmcnt(12)
    v_mfma_f32_16x16x32_bf16 v[40:43], a[32:35], v[84:87], v[40:43]
    ds_read_b64_tr_b16 v[112:113], v132 offset:8192
    v_mfma_f32_16x16x32_bf16 v[44:47], a[96:99], v[84:87], v[44:47]
    ds_read_b64_tr_b16 v[114:115], v132 offset:9216
    s_add_u32 s26, s24, 0x1a0000
    s_add_u32 m0, s29, 0xd000
    s_nop 0
    buffer_load_dwordx4 v136, s[16:19], s26 offen lds
    s_waitcnt lgkmcnt(12)
    v_mfma_f32_16x16x32_bf16 v[48:51], a[32:35], v[88:91], v[48:51]
    ds_read_b64_tr_b16 v[116:117], v133 offset:8192
    v_mfma_f32_16x16x32_bf16 v[52:55], a[96:99], v[88:91], v[52:55]
    ds_read_b64_tr_b16 v[118:119], v133 offset:9216
    s_add_u32 s26, s24, 0x1c0000
    s_add_u32 m0, s29, 0xe000
    s_nop 0
    buffer_load_dwordx4 v136, s[16:19], s26 offen lds
    s_waitcnt lgkmcnt(12)
    v_mfma_f32_16x16x32_bf16 v[56:59], a[32:35], v[92:95], v[56:59]
    ds_read_b64_tr_b16 v[120:121], v134 offset:8192
    v_mfma_f32_16x16x32_bf16 v[60:63], a[96:99], v[92:95], v[60:63]
    ds_read_b64_tr_b16 v[122:123], v134 offset:9216
    s_add_u32 s26, s24, 0x1e0000
    s_add_u32 m0, s29, 0xf000
    s_nop 0
    buffer_load_dwordx4 v136, s[16:19], s26 offen lds
    s_waitcnt lgkmcnt(12)
    v_mfma_f32_16x16x32_bf16 v[0:3], a[36:39], v[96:99], v[0:3]
    ds_read_b64_tr_b16 v[124:125], v135 offset:8192
    v_mfma_f32_16x16x32_bf16 v[4:7], a[100:103], v[96:99], v[4:7]
    ds_read_b64_tr_b16 v[126:127], v135 offset:9216
    s_waitcnt lgkmcnt(12)
    v_mfma_f32_16x16x32_bf16 v[8:11], a[36:39], v[100:103], v[8:11]
    ds_read_b64_tr_b16 v[64:65], v128 offset:16384
    v_mfma_f32_16x16x32_bf16 v[12:15], a[100:103], v[100:103], v[12:15]
    ds_read_b64_tr_b16 v[66:67], v128 offset:17408
    s_waitcnt lgkmcnt(12)
    v_mfma_f32_16x16x32_bf16 v[16:19], a[36:39], v[104:107], v[16:19]
    ds_read_b64_tr_b16 v[68:69], v129 offset:16384
    v_mfma_f32_16x16x32_bf16 v[20:23], a[100:103], v[104:107], v[20:23]
    ds_read_b64_tr_b16 v[70:71], v129 offset:17408
    s_waitcnt lgkmcnt(12)
    v_mfma_f32_16x16x32_bf16 v[24:27], a[36:39], v[108:111], v[24:27]
    ds_read_b64_tr_b16 v[72:73], v130 offset:16384
    v_mfma_f32_16x16x32_bf16 v[28:31], a[100:103], v[108:111], v[28:31]
    ds_read_b64_tr_b16 v[74:75], v130 offset:17408
    s_waitcnt lgkmcnt(12)
    v_mfma_f32_16x16x32_bf16 v[32:35], a[36:39], v[112:115], v[32:35]
    ds_read_b64_tr_b16 v[76:77], v131 offset:16384
    v_mfma_f32_16x16x32_bf16 v[36:39], a[100:103], v[112:115], v[36:39]
    ds_read_b64_tr_b16 v[78:79], v131 offset:17408
    s_waitcnt lgkmcnt(12)
    v_mfma_f32_16x16x32_bf16 v[40:43], a[36:39], v[116:119], v[40:43]
    ds_read_b64_tr_b16 v[80:81], v132 offset:16384
    v_mfma_f32_16x16x32_bf16 v[44:47], a[100:103], v[116:119], v[44:47]
    ds_read_b64_tr_b16 v[82:83], v132 offset:17408
    s_waitcnt lgkmcnt(12)
    v_mfma_f32_16x16x32_bf16 v[48:51], a[36:39], v[120:123], v[48:51]
    ds_read_b64_tr_b16 v[84:85], v133 offset:16384
    v_mfma_f32_16x16x32_bf16 v[52:55], a[100:103], v[120:123], v[52:55]
    ds_read_b64_tr_b16 v[86:87], v133 offset:17408
    s_waitcnt lgkmcnt(12)
    v_mfma_f32_16x16x32_bf16 v[56:59], a[36:39], v[124:127], v[56:59]
    ds_read_b64_tr_b16 v[88:89], v134 offset:16384
    v_mfma_f32_16x16x32_bf16 v[60:63], a[100:103], v[124:127], v[60:63]
    ds_read_b64_tr_b16 v[90:91], v134 offset:17408
    s_waitcnt lgkmcnt(12)
    v_mfma_f32_16x16x32_bf16 v[0:3], a[40:43], v[64:67], v[0:3]
    ds_read_b64_tr_b16 v[92:93], v135 offset:16384
    v_mfma_f32_16x16x32_bf16 v[4:7], a[104:107], v[64:67], v[4:7]
    ds_read_b64_tr_b16 v[94:95], v135 offset:17408
    s_waitcnt lgkmcnt(12)
    v_mfma_f32_16x16x32_bf16 v[8:11], a[40:43], v[68:71], v[8:11]
    ds_read_b64_tr_b16 v[96:97], v128 offset:24576
    v_mfma_f32_16x16x32_bf16 v[12:15], a[104:107], v[68:71], v[12:15]
    ds_read_b64_tr_b16 v[98:99], v128 offset:25600
    s_waitcnt lgkmcnt(12)
    v_mfma_f32_16x16x32_bf16 v[16:19], a[40:43], v[72:75], v[16:19]
    ds_read_b64_tr_b16 v[100:101], v129 offset:24576
    v_mfma_f32_16x16x32_bf16 v[20:23], a[104:107], v[72:75], v[20:23]
    ds_read_b64_tr_b16 v[102:103], v129 offset:25600
    s_waitcnt lgkmcnt(12)
    v_mfma_f32_16x16x32_bf16 v[24:27], a[40:43], v[76:79], v[24:27]
    ds_read_b64_tr_b16 v[104:105], v130 offset:24576
    v_mfma_f32_16x16x32_bf16 v[28:31], a[104:107], v[76:79], v[28:31]
    ds_read_b64_tr_b16 v[106:107], v130 offset:25600
    s_waitcnt lgkmcnt(12)
    v_mfma_f32_16x16x32_bf16 v[32:35], a[40:43], v[80:83], v[32:35]
    ds_read_b64_tr_b16 v[108:109], v131 offset:24576
    v_mfma_f32_16x16x32_bf16 v[36:39], a[104:107], v[80:83], v[36:39]
    ds_read_b64_tr_b16 v[110:111], v131 offset:25600
    s_waitcnt lgkmcnt(12)
    v_mfma_f32_16x16x32_bf16 v[40:43], a[40:43], v[84:87], v[40:43]
    ds_read_b64_tr_b16 v[112:113], v132 offset:24576
    v_mfma_f32_16x16x32_bf16 v[44:47], a[104:107], v[84:87], v[44:47]
    ds_read_b64_tr_b16 v[114:115], v132 offset:25600
    s_waitcnt lgkmcnt(12)
    v_mfma_f32_16x16x32_bf16 v[48:51], a[40:43], v[88:91], v[48:51]
    ds_read_b64_tr_b16 v[116:117], v133 offset:24576
    v_mfma_f32_16x16x32_bf16 v[52:55], a[104:107], v[88:91], v[52:55]
    ds_read_b64_tr_b16 v[118:119], v133 offset:25600
    s_waitcnt lgkmcnt(12)
    v_mfma_f32_16x16x32_bf16 v[56:59], a[40:43], v[92:95], v[56:59]
    ds_read_b64_tr_b16 v[120:121], v134 offset:24576
    v_mfma_f32_16x16x32_bf16 v[60:63], a[104:107], v[92:95], v[60:63]
    ds_read_b64_tr_b16 v[122:123], v134 offset:25600
    s_waitcnt lgkmcnt(12)
    v_mfma_f32_16x16x32_bf16 v[0:3], a[44:47], v[96:99], v[0:3]
    ds_read_b64_tr_b16 v[124:125], v135 offset:24576
    v_mfma_f32_16x16x32_bf16 v[4:7], a[108:111], v[96:99], v[4:7]
    ds_read_b64_tr_b16 v[126:127], v135 offset:25600
    s_waitcnt lgkmcnt(12)
    v_mfma_f32_16x16x32_bf16 v[8:11], a[44:47], v[100:103], v[8:11]
    v_mfma_f32_16x16x32_bf16 v[12:15], a[108:111], v[100:103], v[12:15]
    s_waitcnt lgkmcnt(10)
    v_mfma_f32_16x16x32_bf16 v[16:19], a[44:47], v[104:107], v[16:19]
    v_mfma_f32_16x16x32_bf16 v[20:23], a[108:111], v[104:107], v[20:23]
    s_waitcnt lgkmcnt(8)
    v_mfma_f32_16x16x32_bf16 v[24:27], a[44:47], v[108:111], v[24:27]
    v_mfma_f32_16x16x32_bf16 v[28:31], a[108:111], v[108:111], v[28:31]
    s_waitcnt lgkmcnt(6)
    v_mfma_f32_16x16x32_bf16 v[32:35], a[44:47], v[112:115], v[32:35]
    v_mfma_f32_16x16x32_bf16 v[36:39], a[108:111], v[112:115], v[36:39]
    s_waitcnt lgkmcnt(4)
    v_mfma_f32_16x16x32_bf16 v[40:43], a[44:47], v[116:119], v[40:43]
    v_mfma_f32_16x16x32_bf16 v[44:47], a[108:111], v[116:119], v[44:47]
    s_waitcnt lgkmcnt(2)
    v_mfma_f32_16x16x32_bf16 v[48:51], a[44:47], v[120:123], v[48:51]
    v_mfma_f32_16x16x32_bf16 v[52:55], a[108:111], v[120:123], v[52:55]
    s_waitcnt lgkmcnt(0)
    v_mfma_f32_16x16x32_bf16 v[56:59], a[44:47], v[124:127], v[56:59]
    v_mfma_f32_16x16x32_bf16 v[60:63], a[108:111], v[124:127], v[60:63]
    s_waitcnt vmcnt(16)
    s_barrier
    ds_read_b64_tr_b16 v[64:65], v128 offset:32768
    ds_read_b64_tr_b16 v[66:67], v128 offset:33792
    ds_read_b64_tr_b16 v[68:69], v129 offset:32768
    ds_read_b64_tr_b16 v[70:71], v129 offset:33792
    ds_read_b64_tr_b16 v[72:73], v130 offset:32768
    ds_read_b64_tr_b16 v[74:75], v130 offset:33792
    ds_read_b64_tr_b16 v[76:77], v131 offset:32768
    ds_read_b64_tr_b16 v[78:79], v131 offset:33792
    ds_read_b64_tr_b16 v[80:81], v132 offset:32768
    ds_read_b64_tr_b16 v[82:83], v132 offset:33792
    ds_read_b64_tr_b16 v[84:85], v133 offset:32768
    ds_read_b64_tr_b16 v[86:87], v133 offset:33792
    ds_read_b64_tr_b16 v[88:89], v134 offset:32768
    ds_read_b64_tr_b16 v[90:91], v134 offset:33792
    s_waitcnt lgkmcnt(12)
    v_mfma_f32_16x16x32_bf16 v[0:3], a[48:51], v[64:67], v[0:3]
    ds_read_b64_tr_b16 v[92:93], v135 offset:32768
    v_mfma_f32_16x16x32_bf16 v[4:7], a[112:115], v[64:67], v[4:7]
    ds_read_b64_tr_b16 v[94:95], v135 offset:33792
    s_add_u32 s26, s24, 0x200000
    s_add_u32 m0, s29, 0x10000
    s_nop 0
    buffer_load_dwordx4 v136, s[16:19], s26 offen lds
    s_waitcnt lgkmcnt(12)
    v_mfma_f32_16x16x32_bf16 v[8:11], a[48:51], v[68:71], v[8:11]
    ds_read_b64_tr_b16 v[96:97], v128 offset:40960
    v_mfma_f32_16x16x32_bf16 v[12:15], a[112:115], v[68:71], v[12:15]
    ds_read_b64_tr_b16 v[98:99], v128 offset:41984
    s_add_u32 s26, s24, 0x220000
    s_add_u32 m0, s29, 0x11000
    s_nop 0
    buffer_load_dwordx4 v136, s[16:19], s26 offen lds
    s_waitcnt lgkmcnt(12)
    v_mfma_f32_16x16x32_bf16 v[16:19], a[48:51], v[72:75], v[16:19]
    ds_read_b64_tr_b16 v[100:101], v129 offset:40960
    v_mfma_f32_16x16x32_bf16 v[20:23], a[112:115], v[72:75], v[20:23]
    ds_read_b64_tr_b16 v[102:103], v129 offset:41984
    s_add_u32 s26, s24, 0x240000
    s_add_u32 m0, s29, 0x12000
    s_nop 0
    buffer_load_dwordx4 v136, s[16:19], s26 offen lds
    s_waitcnt lgkmcnt(12)
    v_mfma_f32_16x16x32_bf16 v[24:27], a[48:51], v[76:79], v[24:27]
    ds_read_b64_tr_b16 v[104:105], v130 offset:40960
    v_mfma_f32_16x16x32_bf16 v[28:31], a[112:115], v[76:79], v[28:31]
    ds_read_b64_tr_b16 v[106:107], v130 offset:41984
    s_add_u32 s26, s24, 0x260000
    s_add_u32 m0, s29, 0x13000
    s_nop 0
    buffer_load_dwordx4 v136, s[16:19], s26 offen lds
    s_waitcnt lgkmcnt(12)
    v_mfma_f32_16x16x32_bf16 v[32:35], a[48:51], v[80:83], v[32:35]
    ds_read_b64_tr_b16 v[108:109], v131 offset:40960
    v_mfma_f32_16x16x32_bf16 v[36:39], a[112:115], v[80:83], v[36:39]
    ds_read_b64_tr_b16 v[110:111], v131 offset:41984
    s_add_u32 s26, s24, 0x280000
    s_add_u32 m0, s29, 0x14000
    s_nop 0
    buffer_load_dwordx4 v136, s[16:19], s26 offen lds
    s_waitcnt lgkmcnt(12)
    v_mfma_f32_16x16x32_bf16 v[40:43], a[48:51], v[84:87], v[40:43]
    ds_read_b64_tr_b16 v[112:113], v132 offset:40960
    v_mfma_f32_16x16x32_bf16 v[44:47], a[112:115], v[84:87], v[44:47]
    ds_read_b64_tr_b16 v[114:115], v132 offset:41984
    s_add_u32 s26, s24, 0x2a0000
    s_add_u32 m0, s29, 0x15000
    s_nop 0
    buffer_load_dwordx4 v136, s[16:19], s26 offen lds
    s_waitcnt lgkmcnt(12)
    v_mfma_f32_16x16x32_bf16 v[48:51], a[48:51], v[88:91], v[48:51]
    ds_read_b64_tr_b16 v[116:117], v133 offset:40960
    v_mfma_f32_16x16x32_bf16 v[52:55], a[112:115], v[88:91], v[52:55]
    ds_read_b64_tr_b16 v[118:119], v133 offset:41984
    s_add_u32 s26, s24, 0x2c0000
    s_add_u32 m0, s29, 0x16000
    s_nop 0
    buffer_load_dwordx4 v136, s[16:19], s26 offen lds
    s_waitcnt lgkmcnt(12)
    v_mfma_f32_16x16x32_bf16 v[56:59], a[48:51], v[92:95], v[56:59]
    ds_read_b64_tr_b16 v[120:121], v134 offset:40960
    v_mfma_f32_16x16x32_bf16 v[60:63], a[112:115], v[92:95], v[60:63]
    ds_read_b64_tr_b16 v[122:123], v134 offset:41984
    s_add_u32 s26, s24, 0x2e0000
    s_add_u32 m0, s29, 0x17000
    s_nop 0
    buffer_load_dwordx4 v136, s[16:19], s26 offen lds
    s_waitcnt lgkmcnt(12)
    v_mfma_f32_16x16x32_bf16 v[0:3], a[52:55], v[96:99], v[0:3]
    ds_read_b64_tr_b16 v[124:125], v135 offset:40960
    v_mfma_f32_16x16x32_bf16 v[4:7], a[116:119], v[96:99], v[4:7]
    ds_read_b64_tr_b16 v[126:127], v135 offset:41984
    s_waitcnt lgkmcnt(12)
    v_mfma_f32_16x16x32_bf16 v[8:11], a[52:55], v[100:103], v[8:11]
    ds_read_b64_tr_b16 v[64:65], v128 offset:49152
    v_mfma_f32_16x16x32_bf16 v[12:15], a[116:119], v[100:103], v[12:15]
    ds_read_b64_tr_b16 v[66:67], v128 offset:50176
    s_waitcnt lgkmcnt(12)
    v_mfma_f32_16x16x32_bf16 v[16:19], a[52:55], v[104:107], v[16:19]
    ds_read_b64_tr_b16 v[68:69], v129 offset:49152
    v_mfma_f32_16x16x32_bf16 v[20:23], a[116:119], v[104:107], v[20:23]
    ds_read_b64_tr_b16 v[70:71], v129 offset:50176
    s_waitcnt lgkmcnt(12)
    v_mfma_f32_16x16x32_bf16 v[24:27], a[52:55], v[108:111], v[24:27]
    ds_read_b64_tr_b16 v[72:73], v130 offset:49152
    v_mfma_f32_16x16x32_bf16 v[28:31], a[116:119], v[108:111], v[28:31]
    ds_read_b64_tr_b16 v[74:75], v130 offset:50176
    s_waitcnt lgkmcnt(12)
    v_mfma_f32_16x16x32_bf16 v[32:35], a[52:55], v[112:115], v[32:35]
    ds_read_b64_tr_b16 v[76:77], v131 offset:49152
    v_mfma_f32_16x16x32_bf16 v[36:39], a[116:119], v[112:115], v[36:39]
    ds_read_b64_tr_b16 v[78:79], v131 offset:50176
    s_waitcnt lgkmcnt(12)
    v_mfma_f32_16x16x32_bf16 v[40:43], a[52:55], v[116:119], v[40:43]
    ds_read_b64_tr_b16 v[80:81], v132 offset:49152
    v_mfma_f32_16x16x32_bf16 v[44:47], a[116:119], v[116:119], v[44:47]
    ds_read_b64_tr_b16 v[82:83], v132 offset:50176
    s_waitcnt lgkmcnt(12)
    v_mfma_f32_16x16x32_bf16 v[48:51], a[52:55], v[120:123], v[48:51]
    ds_read_b64_tr_b16 v[84:85], v133 offset:49152
    v_mfma_f32_16x16x32_bf16 v[52:55], a[116:119], v[120:123], v[52:55]
    ds_read_b64_tr_b16 v[86:87], v133 offset:50176
    s_waitcnt lgkmcnt(12)
    v_mfma_f32_16x16x32_bf16 v[56:59], a[52:55], v[124:127], v[56:59]
    ds_read_b64_tr_b16 v[88:89], v134 offset:49152
    v_mfma_f32_16x16x32_bf16 v[60:63], a[116:119], v[124:127], v[60:63]
    ds_read_b64_tr_b16 v[90:91], v134 offset:50176
    s_waitcnt lgkmcnt(12)
    v_mfma_f32_16x16x32_bf16 v[0:3], a[56:59], v[64:67], v[0:3]
    ds_read_b64_tr_b16 v[92:93], v135 offset:49152
    v_mfma_f32_16x16x32_bf16 v[4:7], a[120:123], v[64:67], v[4:7]
    ds_read_b64_tr_b16 v[94:95], v135 offset:50176
    s_waitcnt lgkmcnt(12)
    v_mfma_f32_16x16x32_bf16 v[8:11], a[56:59], v[68:71], v[8:11]
    ds_read_b64_tr_b16 v[96:97], v128 offset:57344
    v_mfma_f32_16x16x32_bf16 v[12:15], a[120:123], v[68:71], v[12:15]
    ds_read_b64_tr_b16 v[98:99], v128 offset:58368
    s_waitcnt lgkmcnt(12)
    v_mfma_f32_16x16x32_bf16 v[16:19], a[56:59], v[72:75], v[16:19]
    ds_read_b64_tr_b16 v[100:101], v129 offset:57344
    v_mfma_f32_16x16x32_bf16 v[20:23], a[120:123], v[72:75], v[20:23]
    ds_read_b64_tr_b16 v[102:103], v129 offset:58368
    s_waitcnt lgkmcnt(12)
    v_mfma_f32_16x16x32_bf16 v[24:27], a[56:59], v[76:79], v[24:27]
    ds_read_b64_tr_b16 v[104:105], v130 offset:57344
    v_mfma_f32_16x16x32_bf16 v[28:31], a[120:123], v[76:79], v[28:31]
    ds_read_b64_tr_b16 v[106:107], v130 offset:58368
    s_waitcnt lgkmcnt(12)
    v_mfma_f32_16x16x32_bf16 v[32:35], a[56:59], v[80:83], v[32:35]
    ds_read_b64_tr_b16 v[108:109], v131 offset:57344
    v_mfma_f32_16x16x32_bf16 v[36:39], a[120:123], v[80:83], v[36:39]
    ds_read_b64_tr_b16 v[110:111], v131 offset:58368
    s_waitcnt lgkmcnt(12)
    v_mfma_f32_16x16x32_bf16 v[40:43], a[56:59], v[84:87], v[40:43]
    ds_read_b64_tr_b16 v[112:113], v132 offset:57344
    v_mfma_f32_16x16x32_bf16 v[44:47], a[120:123], v[84:87], v[44:47]
    ds_read_b64_tr_b16 v[114:115], v132 offset:58368
    s_waitcnt lgkmcnt(12)
    v_mfma_f32_16x16x32_bf16 v[48:51], a[56:59], v[88:91], v[48:51]
    ds_read_b64_tr_b16 v[116:117], v133 offset:57344
    v_mfma_f32_16x16x32_bf16 v[52:55], a[120:123], v[88:91], v[52:55]
    ds_read_b64_tr_b16 v[118:119], v133 offset:58368
    s_waitcnt lgkmcnt(12)
    v_mfma_f32_16x16x32_bf16 v[56:59], a[56:59], v[92:95], v[56:59]
    ds_read_b64_tr_b16 v[120:121], v134 offset:57344
    v_mfma_f32_16x16x32_bf16 v[60:63], a[120:123], v[92:95], v[60:63]
    ds_read_b64_tr_b16 v[122:123], v134 offset:58368
    s_waitcnt lgkmcnt(12)
    v_mfma_f32_16x16x32_bf16 v[0:3], a[60:63], v[96:99], v[0:3]
    ds_read_b64_tr_b16 v[124:125], v135 offset:57344
    v_mfma_f32_16x16x32_bf16 v[4:7], a[124:127], v[96:99], v[4:7]
    ds_read_b64_tr_b16 v[126:127], v135 offset:58368
    s_waitcnt lgkmcnt(12)
    v_mfma_f32_16x16x32_bf16 v[8:11], a[60:63], v[100:103], v[8:11]
    v_mfma_f32_16x16x32_bf16 v[12:15], a[124:127], v[100:103], v[12:15]
    s_waitcnt lgkmcnt(10)
    v_mfma_f32_16x16x32_bf16 v[16:19], a[60:63], v[104:107], v[16:19]
    v_mfma_f32_16x16x32_bf16 v[20:23], a[124:127], v[104:107], v[20:23]
    s_waitcnt lgkmcnt(8)
    v_mfma_f32_16x16x32_bf16 v[24:27], a[60:63], v[108:111], v[24:27]
    v_mfma_f32_16x16x32_bf16 v[28:31], a[124:127], v[108:111], v[28:31]
    s_waitcnt lgkmcnt(6)
    v_mfma_f32_16x16x32_bf16 v[32:35], a[60:63], v[112:115], v[32:35]
    v_mfma_f32_16x16x32_bf16 v[36:39], a[124:127], v[112:115], v[36:39]
    s_waitcnt lgkmcnt(4)
    v_mfma_f32_16x16x32_bf16 v[40:43], a[60:63], v[116:119], v[40:43]
    v_mfma_f32_16x16x32_bf16 v[44:47], a[124:127], v[116:119], v[44:47]
    s_waitcnt lgkmcnt(2)
    v_mfma_f32_16x16x32_bf16 v[48:51], a[60:63], v[120:123], v[48:51]
    v_mfma_f32_16x16x32_bf16 v[52:55], a[124:127], v[120:123], v[52:55]
    s_waitcnt lgkmcnt(0)
    v_mfma_f32_16x16x32_bf16 v[56:59], a[60:63], v[124:127], v[56:59]
    v_mfma_f32_16x16x32_bf16 v[60:63], a[124:127], v[124:127], v[60:63]
    v_xor_b32 v128, 0x10000, v128
    v_xor_b32 v129, 0x10000, v129
    v_xor_b32 v130, 0x10000, v130
    v_xor_b32 v131, 0x10000, v131
    v_xor_b32 v132, 0x10000, v132
    v_xor_b32 v133, 0x10000, v133
    v_xor_b32 v134, 0x10000, v134
    v_xor_b32 v135, 0x10000, v135
    v_cvt_pk_bf16_f32 v144, v0, v1
    v_cvt_pk_bf16_f32 v145, v2, v3
    v_cvt_pk_bf16_f32 v146, v4, v5
    v_cvt_pk_bf16_f32 v147, v6, v7
    buffer_store_dwordx4 v[144:147], v137, s[8:11], s25 offen sc1
    v_cvt_pk_bf16_f32 v148, v8, v9
    v_cvt_pk_bf16_f32 v149, v10, v11
    v_cvt_pk_bf16_f32 v150, v12, v13
    v_cvt_pk_bf16_f32 v151, v14, v15
    buffer_store_dwordx4 v[148:151], v137, s[8:11], s25 offen offset:1024 sc1
    v_cvt_pk_bf16_f32 v152, v16, v17
    v_cvt_pk_bf16_f32 v153, v18, v19
    v_cvt_pk_bf16_f32 v154, v20, v21
    v_cvt_pk_bf16_f32 v155, v22, v23
    buffer_store_dwordx4 v[152:155], v137, s[8:11], s25 offen offset:2048 sc1
    v_cvt_pk_bf16_f32 v156, v24, v25
    v_cvt_pk_bf16_f32 v157, v26, v27
    v_cvt_pk_bf16_f32 v158, v28, v29
    v_cvt_pk_bf16_f32 v159, v30, v31
    buffer_store_dwordx4 v[156:159], v137, s[8:11], s25 offen offset:3072 sc1
    v_cvt_pk_bf16_f32 v144, v32, v33
    v_cvt_pk_bf16_f32 v145, v34, v35
    v_cvt_pk_bf16_f32 v146, v36, v37
    v_cvt_pk_bf16_f32 v147, v38, v39
    s_add_u32 s25, s25, 4096
    buffer_store_dwordx4 v[144:147], v137, s[8:11], s25 offen sc1
    v_cvt_pk_bf16_f32 v148, v40, v41
    v_cvt_pk_bf16_f32 v149, v42, v43
    v_cvt_pk_bf16_f32 v150, v44, v45
    v_cvt_pk_bf16_f32 v151, v46, v47
    buffer_store_dwordx4 v[148:151], v137, s[8:11], s25 offen offset:1024 sc1
    v_cvt_pk_bf16_f32 v152, v48, v49
    v_cvt_pk_bf16_f32 v153, v50, v51
    v_cvt_pk_bf16_f32 v154, v52, v53
    v_cvt_pk_bf16_f32 v155, v54, v55
    buffer_store_dwordx4 v[152:155], v137, s[8:11], s25 offen offset:2048 sc1
    v_cvt_pk_bf16_f32 v156, v56, v57
    v_cvt_pk_bf16_f32 v157, v58, v59
    v_cvt_pk_bf16_f32 v158, v60, v61
    v_cvt_pk_bf16_f32 v159, v62, v63
    buffer_store_dwordx4 v[156:159], v137, s[8:11], s25 offen offset:3072 sc1
L_p1_next:
    s_add_u32 s80, s80, 1
    s_lshl_b32 s40, s38, 4
    s_add_u32 s40, s40, s20
    s_lshl_b32 s40, s40, 2
    s_add_u32 s40, s40, 0x2000
    s_add_u32 s38, s38, s37
    s_branch L_p1_unit
L_p1_end:
    s_waitcnt vmcnt(0)
    s_barrier
    s_cmp_eq_u32 s40, 0
    s_cbranch_scc1 L_nopf_98
    s_cmp_lg_u32 s87, 0
    s_cbranch_scc1 L_modeok_99
    s_mov_b32 s96, 0
L_mode_100:
    buffer_load_dwordx2 v[140:141], off, s[92:95], 0 offset:36 sc1
    s_waitcnt vmcnt(0)
    v_readfirstlane_b32 s87, v140
    v_readfirstlane_b32 s97, v141
    s_nop 0
    s_min_u32 s97, s97, s87
    s_cmp_lg_u32 s97, 0
    s_cbranch_scc1 L_moded_101
    s_sleep 4
    s_add_u32 s96, s96, 1
    s_cmp_lg_u32 s96, 0x100
    s_cbranch_scc1 L_modef_102
    v_mov_b32 v140, 2
    v_mov_b32 v141, 0
    s_mov_b64 exec, 1
    buffer_atomic_cmpswap v[140:141], off, s[92:95], 0 offset:36
    s_mov_b64 exec, -1
L_modef_102:
    s_cmp_lt_u32 s96, 0x10000
    s_cbranch_scc1 L_mode_100
L_moded_101:
    s_cmp_lg_u32 s87, 1
    s_cbranch_scc1 L_fallback
L_modeok_99:
    s_cmp_lg_u32 s100, 0
    s_cbranch_scc1 L_flag_103
    v_mov_b32 v138, 1
    s_mov_b64 exec, 1
    buffer_store_dword v138, off, s[8:11], s40 sc1
    s_mov_b64 exec, -1
L_flag_103:
    s_mov_b32 s40, 0
L_nopf_98:
    s_cmp_lg_u32 s41, 0
    s_cbranch_scc1 L_p1done
    s_mov_b32 s41, 1
    s_and_b32 s20, s101, 15
    s_lshr_b32 s22, s101, 4
    s_mov_b32 s37, 14
    s_add_u32 s26, s22, 70
    s_add_u32 s27, s22, 56
    s_cmp_ge_u32 s27, 64
    s_cselect_b32 s26, s27, s26
    s_add_u32 s27, s22, 42
    s_add_u32 s28, s22, 28
    s_cmp_ge_u32 s28, 32
    s_cselect_b32 s27, s28, s27
    s_cmp_eq_u32 s20, 3
    s_cselect_b32 s22, s27, s22
    s_cmp_lt_u32 s20, 3
    s_cselect_b32 s22, s26, s22
    s_branch L_p1_pass
L_p1done:
    v_mbcnt_lo_u32_b32 v0, -1, 0
    v_mbcnt_hi_u32_b32 v0, -1, v0
    s_lshl_b32 s96, s100, 6
    v_add_u32 v0, s96, v0
    s_and_b32 s20, s101, 15
    s_lshr_b32 s22, s101, 4
    s_mov_b32 s23, 14
    s_load_dwordx2 s[12:13], s[0:1], 40
    s_waitcnt lgkmcnt(0)
    s_and_b32 s13, s13, 0xffff
    s_mov_b32 s14, 0x400000
    s_mov_b32 s15, 0x20000
    v_lshrrev_b32 v4, 6, v0
    s_nop 0
    v_readfirstlane_b32 s21, v4
    v_and_b32 v1, 63, v0
    v_lshrrev_b32 v2, 4, v1
    v_and_b32 v3, 15, v1
    v_lshrrev_b32 v6, 2, v3
    v_lshlrev_b32 v240, 4, v1
    v_lshlrev_b32 v241, 3, v1
    s_lshl_b32 s27, s21, 10
    s_lshl_b32 s24, s21, 5
    v_xor_b32 v4, s24, v240
    v_add_u32 v8, s27, v4
    v_xor_b32 v9, 128, v8
    v_lshl_add_u32 v4, v2, 2, v6
    v_and_b32 v5, 7, v4
    v_lshlrev_b32 v4, 10, v4
    v_lshl_add_u32 v4, v5, 5, v4
    v_and_b32 v5, 3, v3
    v_lshl_add_u32 v4, v5, 3, v4
    s_lshl_b32 s24, s21, 8
    v_add_u32 v10, s24, v4
    s_lshl_b32 s25, s20, 18
    s_add_u32 s24, s25, 0x0
    s_add_u32 m0, s27, 0x0
    s_nop 0
    buffer_load_dwordx4 v8, s[12:15], s24 offen lds
    s_add_u32 s24, s25, 0x1000
    s_add_u32 m0, s27, 0x1000
    s_nop 0
    buffer_load_dwordx4 v9, s[12:15], s24 offen lds
    s_add_u32 s24, s25, 0x2000
    s_add_u32 m0, s27, 0x2000
    s_nop 0
    buffer_load_dwordx4 v8, s[12:15], s24 offen lds
    s_add_u32 s24, s25, 0x3000
    s_add_u32 m0, s27, 0x3000
    s_nop 0
    buffer_load_dwordx4 v9, s[12:15], s24 offen lds
    s_add_u32 s24, s25, 0x4000
    s_add_u32 m0, s27, 0x4000
    s_nop 0
    buffer_load_dwordx4 v8, s[12:15], s24 offen lds
    s_add_u32 s24, s25, 0x5000
    s_add_u32 m0, s27, 0x5000
    s_nop 0
    buffer_load_dwordx4 v9, s[12:15], s24 offen lds
    s_add_u32 s24, s25, 0x6000
    s_add_u32 m0, s27, 0x6000
    s_nop 0
    buffer_load_dwordx4 v8, s[12:15], s24 offen lds
    s_add_u32 s24, s25, 0x7000
    s_add_u32 m0, s27, 0x7000
    s_nop 0
    buffer_load_dwordx4 v9, s[12:15], s24 offen lds
    s_add_u32 s24, s25, 0x8000
    s_add_u32 m0, s27, 0x8000
    s_nop 0
    buffer_load_dwordx4 v8, s[12:15], s24 offen lds
    s_add_u32 s24, s25, 0x9000
    s_add_u32 m0, s27, 0x9000
    s_nop 0
    buffer_load_dwordx4 v9, s[12:15], s24 offen lds
    s_add_u32 s24, s25, 0xa000
    s_add_u32 m0, s27, 0xa000
    s_nop 0
    buffer_load_dwordx4 v8, s[12:15], s24 offen lds
    s_add_u32 s24, s25, 0xb000
    s_add_u32 m0, s27, 0xb000
    s_nop 0
    buffer_load_dwordx4 v9, s[12:15], s24 offen lds
    s_add_u32 s24, s25, 0xc000
    s_add_u32 m0, s27, 0xc000
    s_nop 0
    buffer_load_dwordx4 v8, s[12:15], s24 offen lds
    s_add_u32 s24, s25, 0xd000
    s_add_u32 m0, s27, 0xd000
    s_nop 0
    buffer_load_dwordx4 v9, s[12:15], s24 offen lds
    s_add_u32 s24, s25, 0xe000
    s_add_u32 m0, s27, 0xe000
    s_nop 0
    buffer_load_dwordx4 v8, s[12:15], s24 offen lds
    s_add_u32 s24, s25, 0xf000
    s_add_u32 m0, s27, 0xf000
    s_nop 0
    buffer_load_dwordx4 v9, s[12:15], s24 offen lds
    s_add_u32 s24, s25, 0x10000
    s_add_u32 m0, s27, 0x10000
    s_nop 0
    buffer_load_dwordx4 v8, s[12:15], s24 offen lds
    s_add_u32 s24, s25, 0x11000
    s_add_u32 m0, s27, 0x11000
    s_nop 0
    buffer_load_dwordx4 v9, s[12:15], s24 offen lds
    s_add_u32 s24, s25, 0x12000
    s_add_u32 m0, s27, 0x12000
    s_nop 0
    buffer_load_dwordx4 v8, s[12:15], s24 offen lds
    s_add_u32 s24, s25, 0x13000
    s_add_u32 m0, s27, 0x13000
    s_nop 0
    buffer_load_dwordx4 v9, s[12:15], s24 offen lds
    s_add_u32 s24, s25, 0x14000
    s_add_u32 m0, s27, 0x14000
    s_nop 0
    buffer_load_dwordx4 v8, s[12:15], s24 offen lds
    s_add_u32 s24, s25, 0x15000
    s_add_u32 m0, s27, 0x15000
    s_nop 0
    buffer_load_dwordx4 v9, s[12:15], s24 offen lds
    s_add_u32 s24, s25, 0x16000
    s_add_u32 m0, s27, 0x16000
    s_nop 0
    buffer_load_dwordx4 v8, s[12:15], s24 offen lds
    s_add_u32 s24, s25, 0x17000
    s_add_u32 m0, s27, 0x17000
    s_nop 0
    buffer_load_dwordx4 v9, s[12:15], s24 offen lds
    s_add_u32 s24, s25, 0x18000
    s_add_u32 m0, s27, 0x18000
    s_nop 0
    buffer_load_dwordx4 v8, s[12:15], s24 offen lds
    s_add_u32 s24, s25, 0x19000
    s_add_u32 m0, s27, 0x19000
    s_nop 0
    buffer_load_dwordx4 v9, s[12:15], s24 offen lds
    s_add_u32 s24, s25, 0x1a000
    s_add_u32 m0, s27, 0x1a000
    s_nop 0
    buffer_load_dwordx4 v8, s[12:15], s24 offen lds
    s_add_u32 s24, s25, 0x1b000
    s_add_u32 m0, s27, 0x1b000
    s_nop 0
    buffer_load_dwordx4 v9, s[12:15], s24 offen lds
    s_add_u32 s24, s25, 0x1c000
    s_add_u32 m0, s27, 0x1c000
    s_nop 0
    buffer_load_dwordx4 v8, s[12:15], s24 offen lds
    s_add_u32 s24, s25, 0x1d000
    s_add_u32 m0, s27, 0x1d000
    s_nop 0
    buffer_load_dwordx4 v9, s[12:15], s24 offen lds
    s_add_u32 s24, s25, 0x1e000
    s_add_u32 m0, s27, 0x1e000
    s_nop 0
    buffer_load_dwordx4 v8, s[12:15], s24 offen lds
    s_add_u32 s24, s25, 0x1f000
    s_add_u32 m0, s27, 0x1f000
    s_nop 0
    buffer_load_dwordx4 v9, s[12:15], s24 offen lds
    s_waitcnt vmcnt(0)
    s_barrier
    v_xor_b32 v11, 0x0, v10
    ds_read_b64_tr_b16 a[0:1], v11
    ds_read_b64_tr_b16 a[2:3], v11 offset:16384
    ds_read_b64_tr_b16 a[32:33], v11 offset:32768
    ds_read_b64_tr_b16 a[34:35], v11 offset:49152
    v_xor_b32 v11, 0x20, v10
    ds_read_b64_tr_b16 a[4:5], v11
    ds_read_b64_tr_b16 a[6:7], v11 offset:16384
    ds_read_b64_tr_b16 a[36:37], v11 offset:32768
    ds_read_b64_tr_b16 a[38:39], v11 offset:49152
    s_waitcnt lgkmcnt(0)
    v_xor_b32 v11, 0x40, v10
    ds_read_b64_tr_b16 a[8:9], v11
    ds_read_b64_tr_b16 a[10:11], v11 offset:16384
    ds_read_b64_tr_b16 a[40:41], v11 offset:32768
    ds_read_b64_tr_b16 a[42:43], v11 offset:49152
    v_xor_b32 v11, 0x60, v10
    ds_read_b64_tr_b16 a[12:13], v11
    ds_read_b64_tr_b16 a[14:15], v11 offset:16384
    ds_read_b64_tr_b16 a[44:45], v11 offset:32768
    ds_read_b64_tr_b16 a[46:47], v11 offset:49152
    s_waitcnt lgkmcnt(0)
    v_xor_b32 v11, 0x80, v10
    ds_read_b64_tr_b16 a[16:17], v11
    ds_read_b64_tr_b16 a[18:19], v11 offset:16384
    ds_read_b64_tr_b16 a[48:49], v11 offset:32768
    ds_read_b64_tr_b16 a[50:51], v11 offset:49152
    v_xor_b32 v11, 0xa0, v10
    ds_read_b64_tr_b16 a[20:21], v11
    ds_read_b64_tr_b16 a[22:23], v11 offset:16384
    ds_read_b64_tr_b16 a[52:53], v11 offset:32768
    ds_read_b64_tr_b16 a[54:55], v11 offset:49152
    s_waitcnt lgkmcnt(0)
    v_xor_b32 v11, 0xc0, v10
    ds_read_b64_tr_b16 a[24:25], v11
    ds_read_b64_tr_b16 a[26:27], v11 offset:16384
    ds_read_b64_tr_b16 a[56:57], v11 offset:32768
    ds_read_b64_tr_b16 a[58:59], v11 offset:49152
    v_xor_b32 v11, 0xe0, v10
    ds_read_b64_tr_b16 a[28:29], v11
    ds_read_b64_tr_b16 a[30:31], v11 offset:16384
    ds_read_b64_tr_b16 a[60:61], v11 offset:32768
    ds_read_b64_tr_b16 a[62:63], v11 offset:49152
    s_waitcnt lgkmcnt(0)
    v_xor_b32 v11, 0x10000, v10
    ds_read_b64_tr_b16 a[64:65], v11
    ds_read_b64_tr_b16 a[66:67], v11 offset:16384
    ds_read_b64_tr_b16 a[96:97], v11 offset:32768
    ds_read_b64_tr_b16 a[98:99], v11 offset:49152
    v_xor_b32 v11, 0x10020, v10
    ds_read_b64_tr_b16 a[68:69], v11
    ds_read_b64_tr_b16 a[70:71], v11 offset:16384
    ds_read_b64_tr_b16 a[100:101], v11 offset:32768
    ds_read_b64_tr_b16 a[102:103], v11 offset:49152
    s_waitcnt lgkmcnt(0)
    v_xor_b32 v11, 0x10040, v10
    ds_read_b64_tr_b16 a[72:73], v11
    ds_read_b64_tr_b16 a[74:75], v11 offset:16384
    ds_read_b64_tr_b16 a[104:105], v11 offset:32768
    ds_read_b64_tr_b16 a[106:107], v11 offset:49152
    v_xor_b32 v11, 0x10060, v10
    ds_read_b64_tr_b16 a[76:77], v11
    ds_read_b64_tr_b16 a[78:79], v11 offset:16384
    ds_read_b64_tr_b16 a[108:109], v11 offset:32768
    ds_read_b64_tr_b16 a[110:111], v11 offset:49152
    s_waitcnt lgkmcnt(0)
    v_xor_b32 v11, 0x10080, v10
    ds_read_b64_tr_b16 a[80:81], v11
    ds_read_b64_tr_b16 a[82:83], v11 offset:16384
    ds_read_b64_tr_b16 a[112:113], v11 offset:32768
    ds_read_b64_tr_b16 a[114:115], v11 offset:49152
    v_xor_b32 v11, 0x100a0, v10
    ds_read_b64_tr_b16 a[84:85], v11
    ds_read_b64_tr_b16 a[86:87], v11 offset:16384
    ds_read_b64_tr_b16 a[116:117], v11 offset:32768
    ds_read_b64_tr_b16 a[118:119], v11 offset:49152
    s_waitcnt lgkmcnt(0)
    v_xor_b32 v11, 0x100c0, v10
    ds_read_b64_tr_b16 a[88:89], v11
    ds_read_b64_tr_b16 a[90:91], v11 offset:16384
    ds_read_b64_tr_b16 a[120:121], v11 offset:32768
    ds_read_b64_tr_b16 a[122:123], v11 offset:49152
    v_xor_b32 v11, 0x100e0, v10
    ds_read_b64_tr_b16 a[92:93], v11
    ds_read_b64_tr_b16 a[94:95], v11 offset:16384
    ds_read_b64_tr_b16 a[124:125], v11 offset:32768
    ds_read_b64_tr_b16 a[126:127], v11 offset:49152
    s_waitcnt lgkmcnt(0)
    s_barrier
    s_lshl_b32 s25, s20, 18
    s_add_u32 s24, s25, 0x20000
    s_add_u32 m0, s27, 0x0
    s_nop 0
    buffer_load_dwordx4 v8, s[12:15], s24 offen lds
    s_add_u32 s24, s25, 0x21000
    s_add_u32 m0, s27, 0x1000
    s_nop 0
    buffer_load_dwordx4 v9, s[12:15], s24 offen lds
    s_add_u32 s24, s25, 0x22000
    s_add_u32 m0, s27, 0x2000
    s_nop 0
    buffer_load_dwordx4 v8, s[12:15], s24 offen lds
    s_add_u32 s24, s25, 0x23000
    s_add_u32 m0, s27, 0x3000
    s_nop 0
    buffer_load_dwordx4 v9, s[12:15], s24 offen lds
    s_add_u32 s24, s25, 0x24000
    s_add_u32 m0, s27, 0x4000
    s_nop 0
    buffer_load_dwordx4 v8, s[12:15], s24 offen lds
    s_add_u32 s24, s25, 0x25000
    s_add_u32 m0, s27, 0x5000
    s_nop 0
    buffer_load_dwordx4 v9, s[12:15], s24 offen lds
    s_add_u32 s24, s25, 0x26000
    s_add_u32 m0, s27, 0x6000
    s_nop 0
    buffer_load_dwordx4 v8, s[12:15], s24 offen lds
    s_add_u32 s24, s25, 0x27000
    s_add_u32 m0, s27, 0x7000
    s_nop 0
    buffer_load_dwordx4 v9, s[12:15], s24 offen lds
    s_add_u32 s24, s25, 0x28000
    s_add_u32 m0, s27, 0x8000
    s_nop 0
    buffer_load_dwordx4 v8, s[12:15], s24 offen lds
    s_add_u32 s24, s25, 0x29000
    s_add_u32 m0, s27, 0x9000
    s_nop 0
    buffer_load_dwordx4 v9, s[12:15], s24 offen lds
    s_add_u32 s24, s25, 0x2a000
    s_add_u32 m0, s27, 0xa000
    s_nop 0
    buffer_load_dwordx4 v8, s[12:15], s24 offen lds
    s_add_u32 s24, s25, 0x2b000
    s_add_u32 m0, s27, 0xb000
    s_nop 0
    buffer_load_dwordx4 v9, s[12:15], s24 offen lds
    s_add_u32 s24, s25, 0x2c000
    s_add_u32 m0, s27, 0xc000
    s_nop 0
    buffer_load_dwordx4 v8, s[12:15], s24 offen lds
    s_add_u32 s24, s25, 0x2d000
    s_add_u32 m0, s27, 0xd000
    s_nop 0
    buffer_load_dwordx4 v9, s[12:15], s24 offen lds
    s_add_u32 s24, s25, 0x2e000
    s_add_u32 m0, s27, 0xe000
    s_nop 0
    buffer_load_dwordx4 v8, s[12:15], s24 offen lds
    s_add_u32 s24, s25, 0x2f000
    s_add_u32 m0, s27, 0xf000
    s_nop 0
    buffer_load_dwordx4 v9, s[12:15], s24 offen lds
    s_add_u32 s24, s25, 0x30000
    s_add_u32 m0, s27, 0x10000
    s_nop 0
    buffer_load_dwordx4 v8, s[12:15], s24 offen lds
    s_add_u32 s24, s25, 0x31000
    s_add_u32 m0, s27, 0x11000
    s_nop 0
    buffer_load_dwordx4 v9, s[12:15], s24 offen lds
    s_add_u32 s24, s25, 0x32000
    s_add_u32 m0, s27, 0x12000
    s_nop 0
    buffer_load_dwordx4 v8, s[12:15], s24 offen lds
    s_add_u32 s24, s25, 0x33000
    s_add_u32 m0, s27, 0x13000
    s_nop 0
    buffer_load_dwordx4 v9, s[12:15], s24 offen lds
    s_add_u32 s24, s25, 0x34000
    s_add_u32 m0, s27, 0x14000
    s_nop 0
    buffer_load_dwordx4 v8, s[12:15], s24 offen lds
    s_add_u32 s24, s25, 0x35000
    s_add_u32 m0, s27, 0x15000
    s_nop 0
    buffer_load_dwordx4 v9, s[12:15], s24 offen lds
    s_add_u32 s24, s25, 0x36000
    s_add_u32 m0, s27, 0x16000
    s_nop 0
    buffer_load_dwordx4 v8, s[12:15], s24 offen lds
    s_add_u32 s24, s25, 0x37000
    s_add_u32 m0, s27, 0x17000
    s_nop 0
    buffer_load_dwordx4 v9, s[12:15], s24 offen lds
    s_add_u32 s24, s25, 0x38000
    s_add_u32 m0, s27, 0x18000
    s_nop 0
    buffer_load_dwordx4 v8, s[12:15], s24 offen lds
    s_add_u32 s24, s25, 0x39000
    s_add_u32 m0, s27, 0x19000
    s_nop 0
    buffer_load_dwordx4 v9, s[12:15], s24 offen lds
    s_add_u32 s24, s25, 0x3a000
    s_add_u32 m0, s27, 0x1a000
    s_nop 0
    buffer_load_dwordx4 v8, s[12:15], s24 offen lds
    s_add_u32 s24, s25, 0x3b000
    s_add_u32 m0, s27, 0x1b000
    s_nop 0
    buffer_load_dwordx4 v9, s[12:15], s24 offen lds
    s_add_u32 s24, s25, 0x3c000
    s_add_u32 m0, s27, 0x1c000
    s_nop 0
    buffer_load_dwordx4 v8, s[12:15], s24 offen lds
    s_add_u32 s24, s25, 0x3d000
    s_add_u32 m0, s27, 0x1d000
    s_nop 0
    buffer_load_dwordx4 v9, s[12:15], s24 offen lds
    s_add_u32 s24, s25, 0x3e000
    s_add_u32 m0, s27, 0x1e000
    s_nop 0
    buffer_load_dwordx4 v8, s[12:15], s24 offen lds
    s_add_u32 s24, s25, 0x3f000
    s_add_u32 m0, s27, 0x1f000
    s_nop 0
    buffer_load_dwordx4 v9, s[12:15], s24 offen lds
    s_waitcnt vmcnt(0)
    s_barrier
    v_xor_b32 v11, 0x0, v10
    ds_read_b64_tr_b16 a[128:129], v11
    ds_read_b64_tr_b16 a[130:131], v11 offset:16384
    ds_read_b64_tr_b16 a[160:161], v11 offset:32768
    ds_read_b64_tr_b16 a[162:163], v11 offset:49152
    v_xor_b32 v11, 0x20, v10
    ds_read_b64_tr_b16 a[132:133], v11
    ds_read_b64_tr_b16 a[134:135], v11 offset:16384
    ds_read_b64_tr_b16 a[164:165], v11 offset:32768
    ds_read_b64_tr_b16 a[166:167], v11 offset:49152
    s_waitcnt lgkmcnt(0)
    v_xor_b32 v11, 0x40, v10
    ds_read_b64_tr_b16 a[136:137], v11
    ds_read_b64_tr_b16 a[138:139], v11 offset:16384
    ds_read_b64_tr_b16 a[168:169], v11 offset:32768
    ds_read_b64_tr_b16 a[170:171], v11 offset:49152
    v_xor_b32 v11, 0x60, v10
    ds_read_b64_tr_b16 a[140:141], v11
    ds_read_b64_tr_b16 a[142:143], v11 offset:16384
    ds_read_b64_tr_b16 a[172:173], v11 offset:32768
    ds_read_b64_tr_b16 a[174:175], v11 offset:49152
    s_waitcnt lgkmcnt(0)
    v_xor_b32 v11, 0x80, v10
    ds_read_b64_tr_b16 a[144:145], v11
    ds_read_b64_tr_b16 a[146:147], v11 offset:16384
    ds_read_b64_tr_b16 a[176:177], v11 offset:32768
    ds_read_b64_tr_b16 a[178:179], v11 offset:49152
    v_xor_b32 v11, 0xa0, v10
    ds_read_b64_tr_b16 a[148:149], v11
    ds_read_b64_tr_b16 a[150:151], v11 offset:16384
    ds_read_b64_tr_b16 a[180:181], v11 offset:32768
    ds_read_b64_tr_b16 a[182:183], v11 offset:49152
    s_waitcnt lgkmcnt(0)
    v_xor_b32 v11, 0xc0, v10
    ds_read_b64_tr_b16 a[152:153], v11
    ds_read_b64_tr_b16 a[154:155], v11 offset:16384
    ds_read_b64_tr_b16 a[184:185], v11 offset:32768
    ds_read_b64_tr_b16 a[186:187], v11 offset:49152
    v_xor_b32 v11, 0xe0, v10
    ds_read_b64_tr_b16 a[156:157], v11
    ds_read_b64_tr_b16 a[158:159], v11 offset:16384
    ds_read_b64_tr_b16 a[188:189], v11 offset:32768
    ds_read_b64_tr_b16 a[190:191], v11 offset:49152
    s_waitcnt lgkmcnt(0)
    v_xor_b32 v11, 0x10000, v10
    ds_read_b64_tr_b16 a[192:193], v11
    ds_read_b64_tr_b16 a[194:195], v11 offset:16384
    ds_read_b64_tr_b16 a[224:225], v11 offset:32768
    ds_read_b64_tr_b16 a[226:227], v11 offset:49152
    v_xor_b32 v11, 0x10020, v10
    ds_read_b64_tr_b16 a[196:197], v11
    ds_read_b64_tr_b16 a[198:199], v11 offset:16384
    ds_read_b64_tr_b16 a[228:229], v11 offset:32768
    ds_read_b64_tr_b16 a[230:231], v11 offset:49152
    s_waitcnt lgkmcnt(0)
    v_xor_b32 v11, 0x10040, v10
    ds_read_b64_tr_b16 a[200:201], v11
    ds_read_b64_tr_b16 a[202:203], v11 offset:16384
    ds_read_b64_tr_b16 a[232:233], v11 offset:32768
    ds_read_b64_tr_b16 a[234:235], v11 offset:49152
    v_xor_b32 v11, 0x10060, v10
    ds_read_b64_tr_b16 a[204:205], v11
    ds_read_b64_tr_b16 a[206:207], v11 offset:16384
    ds_read_b64_tr_b16 a[236:237], v11 offset:32768
    ds_read_b64_tr_b16 a[238:239], v11 offset:49152
    s_waitcnt lgkmcnt(0)
    v_xor_b32 v11, 0x10080, v10
    ds_read_b64_tr_b16 a[208:209], v11
    ds_read_b64_tr_b16 a[210:211], v11 offset:16384
    ds_read_b64_tr_b16 a[240:241], v11 offset:32768
    ds_read_b64_tr_b16 a[242:243], v11 offset:49152
    v_xor_b32 v11, 0x100a0, v10
    ds_read_b64_tr_b16 a[212:213], v11
    ds_read_b64_tr_b16 a[214:215], v11 offset:16384
    ds_read_b64_tr_b16 a[244:245], v11 offset:32768
    ds_read_b64_tr_b16 a[246:247], v11 offset:49152
    s_waitcnt lgkmcnt(0)
    v_xor_b32 v11, 0x100c0, v10
    ds_read_b64_tr_b16 a[216:217], v11
    ds_read_b64_tr_b16 a[218:219], v11 offset:16384
    ds_read_b64_tr_b16 a[248:249], v11 offset:32768
    ds_read_b64_tr_b16 a[250:251], v11 offset:49152
    v_xor_b32 v11, 0x100e0, v10
    ds_read_b64_tr_b16 a[220:221], v11
    ds_read_b64_tr_b16 a[222:223], v11 offset:16384
    ds_read_b64_tr_b16 a[252:253], v11 offset:32768
    ds_read_b64_tr_b16 a[254:255], v11 offset:49152
    s_waitcnt lgkmcnt(0)
    s_barrier
    s_and_b32 s24, s21, 1
    s_lshl_b32 s24, s24, 4
    v_add_u32 v4, s24, v3
    v_lshlrev_b32 v5, 2, v2
    v_sub_u32 v4, v4, v5
    v_cmp_le_i32 s[30:31], 0, v4
    v_cmp_le_i32 s[32:33], 1, v4
    v_cmp_le_i32 s[34:35], 2, v4
    v_cmp_le_i32 s[36:37], 3, v4
    v_cmp_le_i32 s[38:39], 16, v4
    v_cmp_le_i32 s[40:41], 17, v4
    v_cmp_le_i32 s[42:43], 18, v4
    v_cmp_le_i32 s[44:45], 19, v4
    s_mov_b32 s28, 0x3e0293ee
    s_mov_b32 s29, 0x3e0293ee
    s_mov_b32 s53, 0xff000000
    v_mov_b32 v136, 0x3f803f80
    v_mov_b32 v137, 0x3f803f80
    v_mov_b32 v138, 0x3f803f80
    v_mov_b32 v139, 0x3f803f80
    v_lshlrev_b32 v4, 10, v3
    v_lshl_add_u32 v4, v2, 4, v4
    s_lshl_b32 s24, s21, 8
    v_add_u32 v242, s24, v4
    s_lshl_b32 s24, s21, 12
    v_add_u32 v243, s24, v240
    v_mov_b32 v244, v240
    s_add_u32 s24, s24, 0x22000
    v_xor_b32 v7, v2, v6
    v_lshl_add_u32 v4, v2, 4, v7
    v_and_b32 v5, 3, v3
    v_lshl_add_u32 v4, v4, 2, v5
    v_lshl_add_u32 v253, v4, 2, s24
    v_lshl_add_u32 v4, v3, 2, v7
    v_lshl_add_u32 v254, v4, 4, s24
    s_load_dwordx2 s[12:13], s[0:1], 0
    s_waitcnt lgkmcnt(0)
    s_and_b32 s13, s13, 0xffff
    s_mov_b32 s14, 0x200000
    s_mov_b32 s15, 0x20000
    s_load_dwordx2 s[16:17], s[0:1], 96
    s_waitcnt lgkmcnt(0)
    s_and_b32 s17, s17, 0xffff
    s_mov_b32 s18, 0x200000
    s_mov_b32 s19, 0x20000
    s_load_dwordx2 s[56:57], s[0:1], 64
    s_waitcnt lgkmcnt(0)
    s_and_b32 s57, s57, 0xffff
    s_mov_b32 s58, 0x400
    s_mov_b32 s59, 0x20000
    v_and_b32 v100, 63, v0
    v_lshlrev_b32 v240, 4, v100
    v_lshrrev_b32 v101, 2, v100
    v_lshlrev_b32 v101, 6, v101
    v_and_b32 v102, 3, v100
    v_lshl_add_u32 v252, v102, 3, v101
    buffer_load_dwordx2 v[236:237], v252, s[56:59], 0 offen
    buffer_load_dwordx2 v[238:239], v252, s[56:59], 0 offen offset:32
    s_mov_b32 s65, 0x3f80
    s_mov_b32 s66, 0x3f800000
    s_waitcnt vmcnt(0)
    s_sub_u32 s67, s101, 128
    s_cmp_ge_u32 s67, 56
    s_cbranch_scc1 L_nostage_104
    v_lshrrev_b32 v2, 6, v0
    s_nop 0
    v_readfirstlane_b32 s68, v2
    v_and_b32 v1, 63, v0
    s_lshl_b32 s73, s68, 10
    v_lshrrev_b32 v2, 2, v1
    s_lshl_b32 s71, s68, 4
    v_add_u32 v2, s71, v2
    s_movk_i32 s71, 3584
    v_mul_lo_u32 v2, v2, s71
    v_and_b32 v3, 3, v1
    v_lshl_add_u32 v4, v3, 4, v2
    s_load_dwordx2 s[76:77], s[0:1], 72
    s_waitcnt lgkmcnt(0)
    s_and_b32 s77, s77, 0xffff
    s_mov_b32 s78, 0x1c0000
    s_mov_b32 s79, 0x20000
    s_lshl_b32 s71, s67, 6
    s_add_u32 s71, s71, 0x0
    s_add_u32 m0, s73, 0x8000
    s_nop 0
    buffer_load_dwordx4 v4, s[76:79], s71 offen lds
    s_lshl_b32 s71, s67, 6
    s_add_u32 s71, s71, 0x38000
    s_add_u32 m0, s73, 0x9000
    s_nop 0
    buffer_load_dwordx4 v4, s[76:79], s71 offen lds
    s_lshl_b32 s71, s67, 6
    s_add_u32 s71, s71, 0x70000
    s_add_u32 m0, s73, 0xa000
    s_nop 0
    buffer_load_dwordx4 v4, s[76:79], s71 offen lds
    s_lshl_b32 s71, s67, 6
    s_add_u32 s71, s71, 0xa8000
    s_add_u32 m0, s73, 0xb000
    s_nop 0
    buffer_load_dwordx4 v4, s[76:79], s71 offen lds
    s_lshl_b32 s71, s67, 6
    s_add_u32 s71, s71, 0xe0000
    s_add_u32 m0, s73, 0xc000
    s_nop 0
    buffer_load_dwordx4 v4, s[76:79], s71 offen lds
    s_lshl_b32 s71, s67, 6
    s_add_u32 s71, s71, 0x118000
    s_add_u32 m0, s73, 0xd000
    s_nop 0
    buffer_load_dwordx4 v4, s[76:79], s71 offen lds
    s_lshl_b32 s71, s67, 6
    s_add_u32 s71, s71, 0x150000
    s_add_u32 m0, s73, 0xe000
    s_nop 0
    buffer_load_dwordx4 v4, s[76:79], s71 offen lds
    s_lshl_b32 s71, s67, 6
    s_add_u32 s71, s71, 0x188000
    s_add_u32 m0, s73, 0xf000
    s_nop 0
    buffer_load_dwordx4 v4, s[76:79], s71 offen lds
    s_load_dwordx2 s[76:77], s[0:1], 80
    s_waitcnt lgkmcnt(0)
    s_and_b32 s77, s77, 0xffff
    s_mov_b32 s78, 0x1c0000
    s_mov_b32 s79, 0x20000
    s_lshl_b32 s71, s67, 6
    s_add_u32 s71, s71, 0x0
    s_add_u32 m0, s73, 0x10000
    s_nop 0
    buffer_load_dwordx4 v4, s[76:79], s71 offen lds
    s_lshl_b32 s71, s67, 6
    s_add_u32 s71, s71, 0x38000
    s_add_u32 m0, s73, 0x11000
    s_nop 0
    buffer_load_dwordx4 v4, s[76:79], s71 offen lds
    s_lshl_b32 s71, s67, 6
    s_add_u32 s71, s71, 0x70000
    s_add_u32 m0, s73, 0x12000
    s_nop 0
    buffer_load_dwordx4 v4, s[76:79], s71 offen lds
    s_lshl_b32 s71, s67, 6
    s_add_u32 s71, s71, 0xa8000
    s_add_u32 m0, s73, 0x13000
    s_nop 0
    buffer_load_dwordx4 v4, s[76:79], s71 offen lds
    s_lshl_b32 s71, s67, 6
    s_add_u32 s71, s71, 0xe0000
    s_add_u32 m0, s73, 0x14000
    s_nop 0
    buffer_load_dwordx4 v4, s[76:79], s71 offen lds
    s_lshl_b32 s71, s67, 6
    s_add_u32 s71, s71, 0x118000
    s_add_u32 m0, s73, 0x15000
    s_nop 0
    buffer_load_dwordx4 v4, s[76:79], s71 offen lds
    s_lshl_b32 s71, s67, 6
    s_add_u32 s71, s71, 0x150000
    s_add_u32 m0, s73, 0x16000
    s_nop 0
    buffer_load_dwordx4 v4, s[76:79], s71 offen lds
    s_lshl_b32 s71, s67, 6
    s_add_u32 s71, s71, 0x188000
    s_add_u32 m0, s73, 0x17000
    s_nop 0
    buffer_load_dwordx4 v4, s[76:79], s71 offen lds
    s_load_dwordx2 s[76:77], s[0:1], 88
    s_waitcnt lgkmcnt(0)
    s_and_b32 s77, s77, 0xffff
    s_mov_b32 s78, 0x1c0000
    s_mov_b32 s79, 0x20000
    v_lshlrev_b32 v5, 4, v1
    v_add_u32 v5, s73, v5
    s_lshl_b32 s71, s67, 15
    s_add_u32 s71, s71, 0
    s_add_u32 m0, s73, 0x18000
    s_nop 0
    buffer_load_dwordx4 v5, s[76:79], s71 offen lds
    s_lshl_b32 s71, s67, 15
    s_add_u32 s71, s71, 4096
    s_add_u32 m0, s73, 0x19000
    s_nop 0
    buffer_load_dwordx4 v5, s[76:79], s71 offen lds
    s_lshl_b32 s71, s67, 15
    s_add_u32 s71, s71, 8192
    s_add_u32 m0, s73, 0x1a000
    s_nop 0
    buffer_load_dwordx4 v5, s[76:79], s71 offen lds
    s_lshl_b32 s71, s67, 15
    s_add_u32 s71, s71, 12288
    s_add_u32 m0, s73, 0x1b000
    s_nop 0
    buffer_load_dwordx4 v5, s[76:79], s71 offen lds
    s_lshl_b32 s71, s67, 15
    s_add_u32 s71, s71, 16384
    s_add_u32 m0, s73, 0x1c000
    s_nop 0
    buffer_load_dwordx4 v5, s[76:79], s71 offen lds
    s_lshl_b32 s71, s67, 15
    s_add_u32 s71, s71, 20480
    s_add_u32 m0, s73, 0x1d000
    s_nop 0
    buffer_load_dwordx4 v5, s[76:79], s71 offen lds
    s_lshl_b32 s71, s67, 15
    s_add_u32 s71, s71, 24576
    s_add_u32 m0, s73, 0x1e000
    s_nop 0
    buffer_load_dwordx4 v5, s[76:79], s71 offen lds
    s_lshl_b32 s71, s67, 15
    s_add_u32 s71, s71, 28672
    s_add_u32 m0, s73, 0x1f000
    s_nop 0
    buffer_load_dwordx4 v5, s[76:79], s71 offen lds
L_nostage_104:
    v_lshrrev_b32 v246, 2, v240
    s_lshl_b32 s24, s20, 7
    s_add_u32 s24, s24, 0x2000
    s_cmp_lg_u32 s100, 0
    s_cbranch_scc1 L_polls_107
    s_mov_b32 exec_lo, 0xffffffff
    s_mov_b32 exec_hi, 0
    s_mov_b32 s96, 0
L_poll_105:
    buffer_load_dword v247, v246, s[8:11], s24 offen sc1
    s_waitcnt vmcnt(0)
    v_cmp_gt_u32 vcc, 1, v247
    s_cbranch_vccz L_polld_106
    s_sleep 32
    s_add_u32 s96, s96, 1
    s_cmp_lt_u32 s96, 0x10000
    s_cbranch_scc1 L_poll_105
L_polld_106:
    s_mov_b64 exec, -1
L_polls_107:
    s_barrier
    s_lshl_b32 s24, s20, 7
    s_add_u32 s24, s24, 0x2800
    s_cmp_lg_u32 s100, 0
    s_cbranch_scc1 L_polls_110
    s_mov_b32 exec_lo, 0xffffffff
    s_mov_b32 exec_hi, 0
    s_mov_b32 s96, 0
L_poll_108:
    buffer_load_dword v247, v246, s[8:11], s24 offen sc1
    s_waitcnt vmcnt(0)
    v_cmp_gt_u32 vcc, 1, v247
    s_cbranch_vccz L_polld_109
    s_sleep 32
    s_add_u32 s96, s96, 1
    s_cmp_lt_u32 s96, 0x10000
    s_cbranch_scc1 L_poll_108
L_polld_109:
    s_mov_b64 exec, -1
L_polls_110:
    s_barrier
    s_lshl_b32 s24, s20, 7
    s_add_u32 s24, s24, 0x3000
    s_cmp_lg_u32 s100, 0
    s_cbranch_scc1 L_polls_113
    s_mov_b32 exec_lo, 0xffffffff
    s_mov_b32 exec_hi, 0
    s_mov_b32 s96, 0
L_poll_111:
    buffer_load_dword v247, v246, s[8:11], s24 offen sc1
    s_waitcnt vmcnt(0)
    v_cmp_gt_u32 vcc, 1, v247
    s_cbranch_vccz L_polld_112
    s_sleep 32
    s_add_u32 s96, s96, 1
    s_cmp_lt_u32 s96, 0x10000
    s_cbranch_scc1 L_poll_111
L_polld_112:
    s_mov_b64 exec, -1
L_polls_113:
    s_barrier
    s_mov_b32 s80, 0
L_p2_seg:
    s_cmp_ge_u32 s22, 64
    s_cbranch_scc1 L_p2_end
    v_lshrrev_b32 v246, 2, v240
    s_lshl_b32 s24, s20, 7
    s_add_u32 s24, s24, 0x1000
    s_mul_i32 s25, s22, 10
    s_lshr_b32 s25, s25, 4
    s_add_u32 s25, s25, 17
    s_cmp_lg_u32 s100, 0
    s_cbranch_scc1 L_polls_116
    s_mov_b32 exec_lo, 0x1
    s_mov_b32 exec_hi, 0
    s_mov_b32 s96, 0
L_poll_114:
    buffer_load_dword v247, v246, s[8:11], s24 offen sc1
    s_waitcnt vmcnt(0)
    v_cmp_gt_u32 vcc, s25, v247
    s_cbranch_vccz L_polld_115
    v_readfirstlane_b32 s97, v247
    s_nop 0
    s_sub_u32 s97, s25, s97
    s_cmp_lt_i32 s97, 3
    s_cbranch_scc1 L_near_117
    s_sleep 40
    s_cmp_lt_i32 s97, 5
    s_cbranch_scc1 L_near_117
    s_sleep 100
L_near_117:
    s_sleep 8
    s_add_u32 s96, s96, 1
    s_cmp_lt_u32 s96, 0x10000
    s_cbranch_scc1 L_poll_114
L_polld_115:
    s_mov_b64 exec, -1
L_polls_116:
    s_barrier
    s_lshl_b32 s24, s22, 5
    s_lshl_b32 s25, s20, 1
    s_add_u32 s24, s24, s25
    s_lshr_b32 s25, s21, 1
    s_add_u32 s24, s24, s25
    s_lshl_b32 s25, s24, 13
    s_add_u32 s47, s25, 0x1000000
    s_add_u32 s54, s47, 4096
    s_add_u32 s48, s25, 0x2000000
    s_add_u32 s55, s48, 4096
    s_and_b32 s26, s21, 1
    s_lshl_b32 s26, s26, 12
    s_add_u32 s46, s25, s26
    s_add_u32 s46, s46, 0x3000000
    s_lshl_b32 s25, s24, 12
    s_add_u32 s49, s25, 0x240000
    s_lshl_b32 s24, s22, 4
    s_add_u32 s24, s24, s20
    s_lshl_b32 s24, s24, 15
    s_add_u32 s51, s24, 0x4000000
    buffer_load_dwordx4 v[0:3], v240, s[8:11], s46 offen
    buffer_load_dwordx4 v[4:7], v240, s[8:11], s46 offen offset:1024
    buffer_load_dwordx4 v[8:11], v240, s[8:11], s46 offen offset:2048
    buffer_load_dwordx4 v[12:15], v240, s[8:11], s46 offen offset:3072
    buffer_load_dwordx4 v[16:19], v240, s[8:11], s47 offen
    buffer_load_dwordx4 v[20:23], v240, s[8:11], s47 offen offset:1024
    buffer_load_dwordx4 v[24:27], v240, s[8:11], s47 offen offset:2048
    buffer_load_dwordx4 v[28:31], v240, s[8:11], s47 offen offset:3072
    buffer_load_dwordx4 v[32:35], v240, s[8:11], s54 offen
    buffer_load_dwordx4 v[36:39], v240, s[8:11], s54 offen offset:1024
    buffer_load_dwordx4 v[40:43], v240, s[8:11], s54 offen offset:2048
    buffer_load_dwordx4 v[44:47], v240, s[8:11], s54 offen offset:3072
    buffer_load_dwordx4 v[64:67], v240, s[8:11], s48 offen
    buffer_load_dwordx4 v[68:71], v240, s[8:11], s48 offen offset:1024
    buffer_load_dwordx4 v[72:75], v240, s[8:11], s48 offen offset:2048
    buffer_load_dwordx4 v[76:79], v240, s[8:11], s48 offen offset:3072
    buffer_load_dwordx4 v[80:83], v240, s[8:11], s55 offen
    buffer_load_dwordx4 v[84:87], v240, s[8:11], s55 offen offset:1024
    buffer_load_dwordx4 v[88:91], v240, s[8:11], s55 offen offset:2048
    buffer_load_dwordx4 v[92:95], v240, s[8:11], s55 offen offset:3072
    s_waitcnt vmcnt(8)
    v_mfma_f32_16x16x32_bf16 v[116:119], v[16:19], v[0:3], 0
    v_mfma_f32_16x16x32_bf16 v[116:119], v[20:23], v[4:7], v[116:119]
    v_mfma_f32_16x16x32_bf16 v[116:119], v[24:27], v[8:11], v[116:119]
    v_mfma_f32_16x16x32_bf16 v[116:119], v[28:31], v[12:15], v[116:119]
    v_mfma_f32_16x16x32_bf16 v[120:123], v[32:35], v[0:3], 0
    v_mfma_f32_16x16x32_bf16 v[120:123], v[36:39], v[4:7], v[120:123]
    v_mfma_f32_16x16x32_bf16 v[120:123], v[40:43], v[8:11], v[120:123]
    v_mfma_f32_16x16x32_bf16 v[120:123], v[44:47], v[12:15], v[120:123]
    v_mov_b32 v247, s53
    v_cndmask_b32 v116, v247, v116, s[30:31]
    v_cndmask_b32 v117, v247, v117, s[32:33]
    v_cndmask_b32 v118, v247, v118, s[34:35]
    v_cndmask_b32 v119, v247, v119, s[36:37]
    s_nop 2
    v_cndmask_b32 v120, v247, v120, s[38:39]
    v_cndmask_b32 v121, v247, v121, s[40:41]
    v_cndmask_b32 v122, v247, v122, s[42:43]
    v_cndmask_b32 v123, v247, v123, s[44:45]
    v_max3_f32 v251, v116, v117, v118
    v_max3_f32 v251, v251, v119, v120
    v_max3_f32 v251, v251, v121, v122
    v_lshrrev_b32 v246, 2, v240
    s_lshl_b32 s24, s20, 7
    s_add_u32 s24, s24, 0x1000
    s_add_u32 s25, s22, 1
    s_nop 1
    s_cmp_lg_u32 s100, 0
    s_cbranch_scc1 L_polls_120
    s_mov_b32 exec_lo, 0x11
    s_mov_b32 exec_hi, 0
    s_mov_b32 s96, 0
L_poll_118:
    buffer_load_dword v247, v246, s[8:11], s24 offen sc1
    s_waitcnt vmcnt(0)
    v_cmp_gt_u32 vcc, s25, v247
    s_cbranch_vccz L_polld_119
    v_readfirstlane_b32 s97, v247
    s_nop 0
    s_sub_u32 s97, s25, s97
    s_cmp_lt_i32 s97, 3
    s_cbranch_scc1 L_near_121
    s_sleep 40
    s_cmp_lt_i32 s97, 5
    s_cbranch_scc1 L_near_121
    s_sleep 100
L_near_121:
    s_sleep 8
    s_add_u32 s96, s96, 1
    s_cmp_lt_u32 s96, 0x10000
    s_cbranch_scc1 L_poll_118
L_polld_119:
    s_mov_b64 exec, -1
L_polls_120:
    s_barrier
    buffer_load_dwordx4 v[172:175], v240, s[8:11], s49 offen
    buffer_load_dwordx4 v[176:179], v240, s[8:11], s49 offen offset:1024
    buffer_load_dwordx4 v[180:183], v240, s[8:11], s49 offen offset:2048
    buffer_load_dwordx4 v[184:187], v240, s[8:11], s49 offen offset:3072
    s_waitcnt vmcnt(0)
    ds_write_b32 v253, v173
    ds_write_b32 v253, v175 offset:64
    ds_write_b32 v253, v177 offset:1024
    ds_write_b32 v253, v179 offset:1088
    ds_write_b32 v253, v181 offset:2048
    ds_write_b32 v253, v183 offset:2112
    ds_write_b32 v253, v185 offset:3072
    ds_write_b32 v253, v187 offset:3136
    ds_read_b128 v[48:51], v254
    ds_read_b128 v[52:55], v254 offset:1024
    ds_read_b128 v[56:59], v254 offset:2048
    ds_read_b128 v[60:63], v254 offset:3072
    s_waitcnt lgkmcnt(0)
    v_mfma_f32_16x16x32_bf16 v[112:115], v[48:51], v[0:3], 0
    v_mfma_f32_16x16x32_bf16 v[112:115], v[52:55], v[4:7], v[112:115]
    v_mfma_f32_16x16x32_bf16 v[112:115], v[56:59], v[8:11], v[112:115]
    v_mfma_f32_16x16x32_bf16 v[112:115], v[60:63], v[12:15], v[112:115]
    v_mov_b32 v246, v251
    s_nop 6
    v_max3_f32 v246, v246, v123, v112
    v_max_f32 v246, v246, v113
    v_mov_b32 v247, v246
    s_nop 1
    v_permlane32_swap_b32 v247, v246
    v_max_f32 v246, v247, v246
    v_mov_b32 v247, v246
    s_nop 1
    v_permlane16_swap_b32 v247, v246
    v_max_f32 v246, v247, v246
    v_mul_f32 v248, s28, v246
    v_pk_fma_f32 v[116:117], v[116:117], s[28:29], v[248:249] op_sel_hi:[1,1,0] neg_lo:[0,0,1] neg_hi:[0,0,1]
    v_pk_fma_f32 v[118:119], v[118:119], s[28:29], v[248:249] op_sel_hi:[1,1,0] neg_lo:[0,0,1] neg_hi:[0,0,1]
    v_pk_fma_f32 v[120:121], v[120:121], s[28:29], v[248:249] op_sel_hi:[1,1,0] neg_lo:[0,0,1] neg_hi:[0,0,1]
    v_pk_fma_f32 v[122:123], v[122:123], s[28:29], v[248:249] op_sel_hi:[1,1,0] neg_lo:[0,0,1] neg_hi:[0,0,1]
    v_pk_fma_f32 v[112:113], v[112:113], s[28:29], v[248:249] op_sel_hi:[1,1,0] neg_lo:[0,0,1] neg_hi:[0,0,1]
    v_exp_f32 v116, v116
    v_exp_f32 v117, v117
    v_exp_f32 v118, v118
    v_exp_f32 v119, v119
    v_exp_f32 v120, v120
    v_exp_f32 v121, v121
    v_exp_f32 v122, v122
    v_exp_f32 v123, v123
    v_exp_f32 v112, v112
    v_exp_f32 v113, v113
    v_cvt_pk_bf16_f32 v124, v116, v117
    v_cvt_pk_bf16_f32 v125, v118, v119
    v_cvt_pk_bf16_f32 v126, v120, v121
    v_cvt_pk_bf16_f32 v127, v122, v123
    v_cvt_pk_bf16_f32 v128, v112, v113
    v_mov_b32 v129, 0
    v_mfma_f32_16x16x32_bf16 v[132:135], v[136:139], v[124:127], 0
    v_mfma_f32_16x16x32_bf16 v[140:143], v[64:67], v[124:127], 0
    v_mfma_f32_16x16x32_bf16 v[144:147], v[68:71], v[124:127], 0
    v_mfma_f32_16x16x32_bf16 v[148:151], v[72:75], v[124:127], 0
    v_mfma_f32_16x16x32_bf16 v[152:155], v[76:79], v[124:127], 0
    v_mfma_f32_16x16x32_bf16 v[156:159], v[80:83], v[124:127], 0
    v_mfma_f32_16x16x32_bf16 v[160:163], v[84:87], v[124:127], 0
    v_mfma_f32_16x16x32_bf16 v[164:167], v[88:91], v[124:127], 0
    v_mfma_f32_16x16x32_bf16 v[168:171], v[92:95], v[124:127], 0
    v_mfma_f32_16x16x16_bf16 v[132:135], v[136:137], v[128:129], v[132:135]
    v_mfma_f32_16x16x16_bf16 v[140:143], v[172:173], v[128:129], v[140:143]
    v_mfma_f32_16x16x16_bf16 v[144:147], v[174:175], v[128:129], v[144:147]
    v_mfma_f32_16x16x16_bf16 v[148:151], v[176:177], v[128:129], v[148:151]
    v_mfma_f32_16x16x16_bf16 v[152:155], v[178:179], v[128:129], v[152:155]
    v_mfma_f32_16x16x16_bf16 v[156:159], v[180:181], v[128:129], v[156:159]
    v_mfma_f32_16x16x16_bf16 v[160:163], v[182:183], v[128:129], v[160:163]
    v_mfma_f32_16x16x16_bf16 v[164:167], v[184:185], v[128:129], v[164:167]
    v_mfma_f32_16x16x16_bf16 v[168:171], v[186:187], v[128:129], v[168:171]
    v_rcp_f32 v250, v132
    s_nop 0
    v_pk_mul_f32 v[140:141], v[140:141], v[250:251] op_sel_hi:[1,0]
    v_pk_mul_f32 v[142:143], v[142:143], v[250:251] op_sel_hi:[1,0]
    v_pk_mul_f32 v[144:145], v[144:145], v[250:251] op_sel_hi:[1,0]
    v_pk_mul_f32 v[146:147], v[146:147], v[250:251] op_sel_hi:[1,0]
    v_pk_mul_f32 v[148:149], v[148:149], v[250:251] op_sel_hi:[1,0]
    v_pk_mul_f32 v[150:151], v[150:151], v[250:251] op_sel_hi:[1,0]
    v_pk_mul_f32 v[152:153], v[152:153], v[250:251] op_sel_hi:[1,0]
    v_pk_mul_f32 v[154:155], v[154:155], v[250:251] op_sel_hi:[1,0]
    v_pk_mul_f32 v[156:157], v[156:157], v[250:251] op_sel_hi:[1,0]
    v_pk_mul_f32 v[158:159], v[158:159], v[250:251] op_sel_hi:[1,0]
    v_pk_mul_f32 v[160:161], v[160:161], v[250:251] op_sel_hi:[1,0]
    v_pk_mul_f32 v[162:163], v[162:163], v[250:251] op_sel_hi:[1,0]
    v_pk_mul_f32 v[164:165], v[164:165], v[250:251] op_sel_hi:[1,0]
    v_pk_mul_f32 v[166:167], v[166:167], v[250:251] op_sel_hi:[1,0]
    v_pk_mul_f32 v[168:169], v[168:169], v[250:251] op_sel_hi:[1,0]
    v_pk_mul_f32 v[170:171], v[170:171], v[250:251] op_sel_hi:[1,0]
    v_cvt_pk_bf16_f32 v140, v140, v141
    v_cvt_pk_bf16_f32 v141, v142, v143
    v_cvt_pk_bf16_f32 v142, v144, v145
    v_cvt_pk_bf16_f32 v143, v146, v147
    v_cvt_pk_bf16_f32 v144, v148, v149
    v_cvt_pk_bf16_f32 v145, v150, v151
    v_cvt_pk_bf16_f32 v146, v152, v153
    v_cvt_pk_bf16_f32 v147, v154, v155
    v_cvt_pk_bf16_f32 v148, v156, v157
    v_cvt_pk_bf16_f32 v149, v158, v159
    v_cvt_pk_bf16_f32 v150, v160, v161
    v_cvt_pk_bf16_f32 v151, v162, v163
    v_cvt_pk_bf16_f32 v152, v164, v165
    v_cvt_pk_bf16_f32 v153, v166, v167
    v_cvt_pk_bf16_f32 v154, v168, v169
    v_cvt_pk_bf16_f32 v155, v170, v171
    ds_write_b128 v243, v[140:143]
    ds_write_b128 v243, v[144:147] offset:1024
    ds_write_b128 v243, v[148:151] offset:2048
    ds_write_b128 v243, v[152:155] offset:3072
    s_waitcnt lgkmcnt(0)
    s_barrier
    ds_read_b128 v[0:3], v244
    ds_read_b128 v[4:7], v244 offset:1024
    ds_read_b128 v[8:11], v244 offset:2048
    ds_read_b128 v[12:15], v244 offset:3072
    ds_read_b128 v[16:19], v244 offset:4096
    ds_read_b128 v[20:23], v244 offset:5120
    ds_read_b128 v[24:27], v244 offset:6144
    ds_read_b128 v[28:31], v244 offset:7168
    s_waitcnt lgkmcnt(4)
    ds_read_b128 v[32:35], v244 offset:8192
    ds_read_b128 v[36:39], v244 offset:9216
    ds_read_b128 v[40:43], v244 offset:10240
    ds_read_b128 v[44:47], v244 offset:11264
    ds_read_b128 v[48:51], v244 offset:12288
    ds_read_b128 v[52:55], v244 offset:13312
    ds_read_b128 v[56:59], v244 offset:14336
    ds_read_b128 v[60:63], v244 offset:15360
    v_xor_b32 v243, 0x4000, v243
    v_xor_b32 v244, 0x4000, v244
    s_waitcnt lgkmcnt(0)
    v_mfma_f32_16x16x32_bf16 v[172:175], a[0:3], v[0:3], 0
    v_mfma_f32_16x16x32_bf16 v[176:179], a[4:7], v[0:3], 0
    v_mfma_f32_16x16x32_bf16 v[180:183], a[8:11], v[0:3], 0
    v_mfma_f32_16x16x32_bf16 v[184:187], a[12:15], v[0:3], 0
    v_mfma_f32_16x16x32_bf16 v[188:191], a[16:19], v[0:3], 0
    v_mfma_f32_16x16x32_bf16 v[192:195], a[20:23], v[0:3], 0
    v_mfma_f32_16x16x32_bf16 v[196:199], a[24:27], v[0:3], 0
    v_mfma_f32_16x16x32_bf16 v[200:203], a[28:31], v[0:3], 0
    v_mfma_f32_16x16x32_bf16 v[172:175], a[32:35], v[4:7], v[172:175]
    v_mfma_f32_16x16x32_bf16 v[176:179], a[36:39], v[4:7], v[176:179]
    v_mfma_f32_16x16x32_bf16 v[180:183], a[40:43], v[4:7], v[180:183]
    v_mfma_f32_16x16x32_bf16 v[184:187], a[44:47], v[4:7], v[184:187]
    v_mfma_f32_16x16x32_bf16 v[188:191], a[48:51], v[4:7], v[188:191]
    v_mfma_f32_16x16x32_bf16 v[192:195], a[52:55], v[4:7], v[192:195]
    v_mfma_f32_16x16x32_bf16 v[196:199], a[56:59], v[4:7], v[196:199]
    v_mfma_f32_16x16x32_bf16 v[200:203], a[60:63], v[4:7], v[200:203]
    v_mfma_f32_16x16x32_bf16 v[172:175], a[64:67], v[8:11], v[172:175]
    v_mfma_f32_16x16x32_bf16 v[176:179], a[68:71], v[8:11], v[176:179]
    v_mfma_f32_16x16x32_bf16 v[180:183], a[72:75], v[8:11], v[180:183]
    v_mfma_f32_16x16x32_bf16 v[184:187], a[76:79], v[8:11], v[184:187]
    v_mfma_f32_16x16x32_bf16 v[188:191], a[80:83], v[8:11], v[188:191]
    v_mfma_f32_16x16x32_bf16 v[192:195], a[84:87], v[8:11], v[192:195]
    v_mfma_f32_16x16x32_bf16 v[196:199], a[88:91], v[8:11], v[196:199]
    v_mfma_f32_16x16x32_bf16 v[200:203], a[92:95], v[8:11], v[200:203]
    v_mfma_f32_16x16x32_bf16 v[172:175], a[96:99], v[12:15], v[172:175]
    v_mfma_f32_16x16x32_bf16 v[176:179], a[100:103], v[12:15], v[176:179]
    v_mfma_f32_16x16x32_bf16 v[180:183], a[104:107], v[12:15], v[180:183]
    v_mfma_f32_16x16x32_bf16 v[184:187], a[108:111], v[12:15], v[184:187]
    v_mfma_f32_16x16x32_bf16 v[188:191], a[112:115], v[12:15], v[188:191]
    v_mfma_f32_16x16x32_bf16 v[192:195], a[116:119], v[12:15], v[192:195]
    v_mfma_f32_16x16x32_bf16 v[196:199], a[120:123], v[12:15], v[196:199]
    v_mfma_f32_16x16x32_bf16 v[200:203], a[124:127], v[12:15], v[200:203]
    v_mfma_f32_16x16x32_bf16 v[172:175], a[128:131], v[32:35], v[172:175]
    v_mfma_f32_16x16x32_bf16 v[176:179], a[132:135], v[32:35], v[176:179]
    v_mfma_f32_16x16x32_bf16 v[180:183], a[136:139], v[32:35], v[180:183]
    v_mfma_f32_16x16x32_bf16 v[184:187], a[140:143], v[32:35], v[184:187]
    v_mfma_f32_16x16x32_bf16 v[188:191], a[144:147], v[32:35], v[188:191]
    v_mfma_f32_16x16x32_bf16 v[192:195], a[148:151], v[32:35], v[192:195]
    v_mfma_f32_16x16x32_bf16 v[196:199], a[152:155], v[32:35], v[196:199]
    v_mfma_f32_16x16x32_bf16 v[200:203], a[156:159], v[32:35], v[200:203]
    v_mfma_f32_16x16x32_bf16 v[172:175], a[160:163], v[36:39], v[172:175]
    v_mfma_f32_16x16x32_bf16 v[176:179], a[164:167], v[36:39], v[176:179]
    v_mfma_f32_16x16x32_bf16 v[180:183], a[168:171], v[36:39], v[180:183]
    v_mfma_f32_16x16x32_bf16 v[184:187], a[172:175], v[36:39], v[184:187]
    v_mfma_f32_16x16x32_bf16 v[188:191], a[176:179], v[36:39], v[188:191]
    v_mfma_f32_16x16x32_bf16 v[192:195], a[180:183], v[36:39], v[192:195]
    v_mfma_f32_16x16x32_bf16 v[196:199], a[184:187], v[36:39], v[196:199]
    v_mfma_f32_16x16x32_bf16 v[200:203], a[188:191], v[36:39], v[200:203]
    v_mfma_f32_16x16x32_bf16 v[172:175], a[192:195], v[40:43], v[172:175]
    v_mfma_f32_16x16x32_bf16 v[176:179], a[196:199], v[40:43], v[176:179]
    v_mfma_f32_16x16x32_bf16 v[180:183], a[200:203], v[40:43], v[180:183]
    v_mfma_f32_16x16x32_bf16 v[184:187], a[204:207], v[40:43], v[184:187]
    v_mfma_f32_16x16x32_bf16 v[188:191], a[208:211], v[40:43], v[188:191]
    v_mfma_f32_16x16x32_bf16 v[192:195], a[212:215], v[40:43], v[192:195]
    v_mfma_f32_16x16x32_bf16 v[196:199], a[216:219], v[40:43], v[196:199]
    v_mfma_f32_16x16x32_bf16 v[200:203], a[220:223], v[40:43], v[200:203]
    v_mfma_f32_16x16x32_bf16 v[172:175], a[224:227], v[44:47], v[172:175]
    v_mfma_f32_16x16x32_bf16 v[176:179], a[228:231], v[44:47], v[176:179]
    v_mfma_f32_16x16x32_bf16 v[180:183], a[232:235], v[44:47], v[180:183]
    v_mfma_f32_16x16x32_bf16 v[184:187], a[236:239], v[44:47], v[184:187]
    v_mfma_f32_16x16x32_bf16 v[188:191], a[240:243], v[44:47], v[188:191]
    v_mfma_f32_16x16x32_bf16 v[192:195], a[244:247], v[44:47], v[192:195]
    v_mfma_f32_16x16x32_bf16 v[196:199], a[248:251], v[44:47], v[196:199]
    v_mfma_f32_16x16x32_bf16 v[200:203], a[252:255], v[44:47], v[200:203]
    v_mfma_f32_16x16x32_bf16 v[204:207], a[0:3], v[16:19], 0
    v_mfma_f32_16x16x32_bf16 v[208:211], a[4:7], v[16:19], 0
    v_mfma_f32_16x16x32_bf16 v[212:215], a[8:11], v[16:19], 0
    v_mfma_f32_16x16x32_bf16 v[216:219], a[12:15], v[16:19], 0
    v_mfma_f32_16x16x32_bf16 v[220:223], a[16:19], v[16:19], 0
    v_mfma_f32_16x16x32_bf16 v[224:227], a[20:23], v[16:19], 0
    v_mfma_f32_16x16x32_bf16 v[228:231], a[24:27], v[16:19], 0
    v_mfma_f32_16x16x32_bf16 v[232:235], a[28:31], v[16:19], 0
    v_cvt_pk_bf16_f32 v140, v172, v173
    v_cvt_pk_bf16_f32 v141, v174, v175
    v_cvt_pk_bf16_f32 v142, v176, v177
    v_cvt_pk_bf16_f32 v143, v178, v179
    s_add_u32 s24, s51, 0
    buffer_store_dwordx4 v[140:143], v242, s[8:11], s24 offen sc1
    v_mfma_f32_16x16x32_bf16 v[204:207], a[32:35], v[20:23], v[204:207]
    v_mfma_f32_16x16x32_bf16 v[208:211], a[36:39], v[20:23], v[208:211]
    v_mfma_f32_16x16x32_bf16 v[212:215], a[40:43], v[20:23], v[212:215]
    v_mfma_f32_16x16x32_bf16 v[216:219], a[44:47], v[20:23], v[216:219]
    v_mfma_f32_16x16x32_bf16 v[220:223], a[48:51], v[20:23], v[220:223]
    v_mfma_f32_16x16x32_bf16 v[224:227], a[52:55], v[20:23], v[224:227]
    v_mfma_f32_16x16x32_bf16 v[228:231], a[56:59], v[20:23], v[228:231]
    v_mfma_f32_16x16x32_bf16 v[232:235], a[60:63], v[20:23], v[232:235]
    v_cvt_pk_bf16_f32 v144, v180, v181
    v_cvt_pk_bf16_f32 v145, v182, v183
    v_cvt_pk_bf16_f32 v146, v184, v185
    v_cvt_pk_bf16_f32 v147, v186, v187
    buffer_store_dwordx4 v[144:147], v242, s[8:11], s24 offen offset:64 sc1
    v_mfma_f32_16x16x32_bf16 v[204:207], a[64:67], v[24:27], v[204:207]
    v_mfma_f32_16x16x32_bf16 v[208:211], a[68:71], v[24:27], v[208:211]
    v_mfma_f32_16x16x32_bf16 v[212:215], a[72:75], v[24:27], v[212:215]
    v_mfma_f32_16x16x32_bf16 v[216:219], a[76:79], v[24:27], v[216:219]
    v_mfma_f32_16x16x32_bf16 v[220:223], a[80:83], v[24:27], v[220:223]
    v_mfma_f32_16x16x32_bf16 v[224:227], a[84:87], v[24:27], v[224:227]
    v_mfma_f32_16x16x32_bf16 v[228:231], a[88:91], v[24:27], v[228:231]
    v_mfma_f32_16x16x32_bf16 v[232:235], a[92:95], v[24:27], v[232:235]
    v_cvt_pk_bf16_f32 v148, v188, v189
    v_cvt_pk_bf16_f32 v149, v190, v191
    v_cvt_pk_bf16_f32 v150, v192, v193
    v_cvt_pk_bf16_f32 v151, v194, v195
    buffer_store_dwordx4 v[148:151], v242, s[8:11], s24 offen offset:128 sc1
    v_mfma_f32_16x16x32_bf16 v[204:207], a[96:99], v[28:31], v[204:207]
    v_mfma_f32_16x16x32_bf16 v[208:211], a[100:103], v[28:31], v[208:211]
    v_mfma_f32_16x16x32_bf16 v[212:215], a[104:107], v[28:31], v[212:215]
    v_mfma_f32_16x16x32_bf16 v[216:219], a[108:111], v[28:31], v[216:219]
    v_mfma_f32_16x16x32_bf16 v[220:223], a[112:115], v[28:31], v[220:223]
    v_mfma_f32_16x16x32_bf16 v[224:227], a[116:119], v[28:31], v[224:227]
    v_mfma_f32_16x16x32_bf16 v[228:231], a[120:123], v[28:31], v[228:231]
    v_mfma_f32_16x16x32_bf16 v[232:235], a[124:127], v[28:31], v[232:235]
    v_cvt_pk_bf16_f32 v152, v196, v197
    v_cvt_pk_bf16_f32 v153, v198, v199
    v_cvt_pk_bf16_f32 v154, v200, v201
    v_cvt_pk_bf16_f32 v155, v202, v203
    buffer_store_dwordx4 v[152:155], v242, s[8:11], s24 offen offset:192 sc1
    v_mfma_f32_16x16x32_bf16 v[204:207], a[128:131], v[48:51], v[204:207]
    v_mfma_f32_16x16x32_bf16 v[208:211], a[132:135], v[48:51], v[208:211]
    v_mfma_f32_16x16x32_bf16 v[212:215], a[136:139], v[48:51], v[212:215]
    v_mfma_f32_16x16x32_bf16 v[216:219], a[140:143], v[48:51], v[216:219]
    v_mfma_f32_16x16x32_bf16 v[220:223], a[144:147], v[48:51], v[220:223]
    v_mfma_f32_16x16x32_bf16 v[224:227], a[148:151], v[48:51], v[224:227]
    v_mfma_f32_16x16x32_bf16 v[228:231], a[152:155], v[48:51], v[228:231]
    v_mfma_f32_16x16x32_bf16 v[232:235], a[156:159], v[48:51], v[232:235]
    v_mfma_f32_16x16x32_bf16 v[204:207], a[160:163], v[52:55], v[204:207]
    v_mfma_f32_16x16x32_bf16 v[208:211], a[164:167], v[52:55], v[208:211]
    v_mfma_f32_16x16x32_bf16 v[212:215], a[168:171], v[52:55], v[212:215]
    v_mfma_f32_16x16x32_bf16 v[216:219], a[172:175], v[52:55], v[216:219]
    v_mfma_f32_16x16x32_bf16 v[220:223], a[176:179], v[52:55], v[220:223]
    v_mfma_f32_16x16x32_bf16 v[224:227], a[180:183], v[52:55], v[224:227]
    v_mfma_f32_16x16x32_bf16 v[228:231], a[184:187], v[52:55], v[228:231]
    v_mfma_f32_16x16x32_bf16 v[232:235], a[188:191], v[52:55], v[232:235]
    v_mfma_f32_16x16x32_bf16 v[204:207], a[192:195], v[56:59], v[204:207]
    v_mfma_f32_16x16x32_bf16 v[208:211], a[196:199], v[56:59], v[208:211]
    v_mfma_f32_16x16x32_bf16 v[212:215], a[200:203], v[56:59], v[212:215]
    v_mfma_f32_16x16x32_bf16 v[216:219], a[204:207], v[56:59], v[216:219]
    v_mfma_f32_16x16x32_bf16 v[220:223], a[208:211], v[56:59], v[220:223]
    v_mfma_f32_16x16x32_bf16 v[224:227], a[212:215], v[56:59], v[224:227]
    v_mfma_f32_16x16x32_bf16 v[228:231], a[216:219], v[56:59], v[228:231]
    v_mfma_f32_16x16x32_bf16 v[232:235], a[220:223], v[56:59], v[232:235]
    v_mfma_f32_16x16x32_bf16 v[204:207], a[224:227], v[60:63], v[204:207]
    v_mfma_f32_16x16x32_bf16 v[208:211], a[228:231], v[60:63], v[208:211]
    v_mfma_f32_16x16x32_bf16 v[212:215], a[232:235], v[60:63], v[212:215]
    v_mfma_f32_16x16x32_bf16 v[216:219], a[236:239], v[60:63], v[216:219]
    v_mfma_f32_16x16x32_bf16 v[220:223], a[240:243], v[60:63], v[220:223]
    v_mfma_f32_16x16x32_bf16 v[224:227], a[244:247], v[60:63], v[224:227]
    v_mfma_f32_16x16x32_bf16 v[228:231], a[248:251], v[60:63], v[228:231]
    v_mfma_f32_16x16x32_bf16 v[232:235], a[252:255], v[60:63], v[232:235]
    v_cvt_pk_bf16_f32 v140, v204, v205
    v_cvt_pk_bf16_f32 v141, v206, v207
    v_cvt_pk_bf16_f32 v142, v208, v209
    v_cvt_pk_bf16_f32 v143, v210, v211
    s_add_u32 s24, s51, 16384
    buffer_store_dwordx4 v[140:143], v242, s[8:11], s24 offen sc1
    v_cvt_pk_bf16_f32 v144, v212, v213
    v_cvt_pk_bf16_f32 v145, v214, v215
    v_cvt_pk_bf16_f32 v146, v216, v217
    v_cvt_pk_bf16_f32 v147, v218, v219
    buffer_store_dwordx4 v[144:147], v242, s[8:11], s24 offen offset:64 sc1
    v_cvt_pk_bf16_f32 v148, v220, v221
    v_cvt_pk_bf16_f32 v149, v222, v223
    v_cvt_pk_bf16_f32 v150, v224, v225
    v_cvt_pk_bf16_f32 v151, v226, v227
    buffer_store_dwordx4 v[148:151], v242, s[8:11], s24 offen offset:128 sc1
    v_cvt_pk_bf16_f32 v152, v228, v229
    v_cvt_pk_bf16_f32 v153, v230, v231
    v_cvt_pk_bf16_f32 v154, v232, v233
    v_cvt_pk_bf16_f32 v155, v234, v235
    buffer_store_dwordx4 v[152:155], v242, s[8:11], s24 offen offset:192 sc1
    s_waitcnt vmcnt(0)
    s_barrier
    s_lshl_b32 s25, s22, 6
    s_add_u32 s25, s25, 0x4000
    s_lshl_b32 s24, s20, 2
    s_add_u32 s24, s24, s25
    s_cmp_lg_u32 s100, 0
    s_cbranch_scc1 L_flag_122
    v_mov_b32 v246, 1
    s_mov_b64 exec, 1
    buffer_store_dword v246, off, s[8:11], s24 sc1
    s_mov_b64 exec, -1
L_flag_122:
    v_lshrrev_b32 v246, 2, v240
    s_cmp_lg_u32 s100, 0
    s_cbranch_scc1 L_polls_125
    s_mov_b32 exec_lo, 0xffff
    s_mov_b32 exec_hi, 0
    s_mov_b32 s96, 0
L_poll_123:
    buffer_load_dword v247, v246, s[8:11], s25 offen sc1
    s_waitcnt vmcnt(0)
    v_cmp_gt_u32 vcc, 1, v247
    s_cbranch_vccz L_polld_124
    s_sleep 2
    s_add_u32 s96, s96, 1
    s_cmp_lt_u32 s96, 0x10000
    s_cbranch_scc1 L_poll_123
L_polld_124:
    s_mov_b64 exec, -1
L_polls_125:
    s_barrier
    s_cmp_ge_u32 s100, 2
    s_cbranch_scc1 L_nofin_126
    s_lshl_b32 s60, s22, 5
    s_lshl_b32 s24, s20, 1
    s_add_u32 s60, s60, s24
    s_add_u32 s60, s60, s100
    s_lshr_b32 s62, s60, 5
    s_lshl_b32 s62, s62, 19
    s_and_b32 s63, s60, 31
    s_lshl_b32 s63, s63, 10
    s_add_u32 s62, s62, s63
    s_add_u32 s62, s62, 0x4000000
    s_lshl_b32 s64, s60, 10
    buffer_load_dwordx2 v[64:65], v252, s[12:15], s64 offen
    buffer_load_dwordx2 v[66:67], v252, s[12:15], s64 offen offset:32
    buffer_load_dwordx4 v[0:3], v240, s[8:11], s62 offen
    s_add_u32 s62, s62, 32768
    buffer_load_dwordx4 v[4:7], v240, s[8:11], s62 offen
    s_add_u32 s62, s62, 32768
    buffer_load_dwordx4 v[8:11], v240, s[8:11], s62 offen
    s_add_u32 s62, s62, 32768
    buffer_load_dwordx4 v[12:15], v240, s[8:11], s62 offen
    s_add_u32 s62, s62, 32768
    buffer_load_dwordx4 v[16:19], v240, s[8:11], s62 offen
    s_add_u32 s62, s62, 32768
    buffer_load_dwordx4 v[20:23], v240, s[8:11], s62 offen
    s_add_u32 s62, s62, 32768
    buffer_load_dwordx4 v[24:27], v240, s[8:11], s62 offen
    s_add_u32 s62, s62, 32768
    buffer_load_dwordx4 v[28:31], v240, s[8:11], s62 offen
    s_add_u32 s62, s62, 32768
    buffer_load_dwordx4 v[32:35], v240, s[8:11], s62 offen
    s_add_u32 s62, s62, 32768
    buffer_load_dwordx4 v[36:39], v240, s[8:11], s62 offen
    s_add_u32 s62, s62, 32768
    buffer_load_dwordx4 v[40:43], v240, s[8:11], s62 offen
    s_add_u32 s62, s62, 32768
    buffer_load_dwordx4 v[44:47], v240, s[8:11], s62 offen
    s_add_u32 s62, s62, 32768
    buffer_load_dwordx4 v[48:51], v240, s[8:11], s62 offen
    s_add_u32 s62, s62, 32768
    buffer_load_dwordx4 v[52:55], v240, s[8:11], s62 offen
    s_add_u32 s62, s62, 32768
    buffer_load_dwordx4 v[56:59], v240, s[8:11], s62 offen
    s_add_u32 s62, s62, 32768
    buffer_load_dwordx4 v[60:63], v240, s[8:11], s62 offen
    v_mov_b32 v68, 0
    v_mov_b32 v69, 0
    v_mov_b32 v70, 0
    v_mov_b32 v71, 0
    v_mov_b32 v72, 0
    v_mov_b32 v73, 0
    v_mov_b32 v74, 0
    v_mov_b32 v75, 0
    s_waitcnt vmcnt(15)
    v_dot2_f32_bf16 v68, v0, s65, v68
    v_dot2_f32_bf16 v69, v0, s66, v69
    v_dot2_f32_bf16 v70, v1, s65, v70
    v_dot2_f32_bf16 v71, v1, s66, v71
    v_dot2_f32_bf16 v72, v2, s65, v72
    v_dot2_f32_bf16 v73, v2, s66, v73
    v_dot2_f32_bf16 v74, v3, s65, v74
    v_dot2_f32_bf16 v75, v3, s66, v75
    s_waitcnt vmcnt(14)
    v_dot2_f32_bf16 v68, v4, s65, v68
    v_dot2_f32_bf16 v69, v4, s66, v69
    v_dot2_f32_bf16 v70, v5, s65, v70
    v_dot2_f32_bf16 v71, v5, s66, v71
    v_dot2_f32_bf16 v72, v6, s65, v72
    v_dot2_f32_bf16 v73, v6, s66, v73
    v_dot2_f32_bf16 v74, v7, s65, v74
    v_dot2_f32_bf16 v75, v7, s66, v75
    s_waitcnt vmcnt(13)
    v_dot2_f32_bf16 v68, v8, s65, v68
    v_dot2_f32_bf16 v69, v8, s66, v69
    v_dot2_f32_bf16 v70, v9, s65, v70
    v_dot2_f32_bf16 v71, v9, s66, v71
    v_dot2_f32_bf16 v72, v10, s65, v72
    v_dot2_f32_bf16 v73, v10, s66, v73
    v_dot2_f32_bf16 v74, v11, s65, v74
    v_dot2_f32_bf16 v75, v11, s66, v75
    s_waitcnt vmcnt(12)
    v_dot2_f32_bf16 v68, v12, s65, v68
    v_dot2_f32_bf16 v69, v12, s66, v69
    v_dot2_f32_bf16 v70, v13, s65, v70
    v_dot2_f32_bf16 v71, v13, s66, v71
    v_dot2_f32_bf16 v72, v14, s65, v72
    v_dot2_f32_bf16 v73, v14, s66, v73
    v_dot2_f32_bf16 v74, v15, s65, v74
    v_dot2_f32_bf16 v75, v15, s66, v75
    s_waitcnt vmcnt(11)
    v_dot2_f32_bf16 v68, v16, s65, v68
    v_dot2_f32_bf16 v69, v16, s66, v69
    v_dot2_f32_bf16 v70, v17, s65, v70
    v_dot2_f32_bf16 v71, v17, s66, v71
    v_dot2_f32_bf16 v72, v18, s65, v72
    v_dot2_f32_bf16 v73, v18, s66, v73
    v_dot2_f32_bf16 v74, v19, s65, v74
    v_dot2_f32_bf16 v75, v19, s66, v75
    s_waitcnt vmcnt(10)
    v_dot2_f32_bf16 v68, v20, s65, v68
    v_dot2_f32_bf16 v69, v20, s66, v69
    v_dot2_f32_bf16 v70, v21, s65, v70
    v_dot2_f32_bf16 v71, v21, s66, v71
    v_dot2_f32_bf16 v72, v22, s65, v72
    v_dot2_f32_bf16 v73, v22, s66, v73
    v_dot2_f32_bf16 v74, v23, s65, v74
    v_dot2_f32_bf16 v75, v23, s66, v75
    s_waitcnt vmcnt(9)
    v_dot2_f32_bf16 v68, v24, s65, v68
    v_dot2_f32_bf16 v69, v24, s66, v69
    v_dot2_f32_bf16 v70, v25, s65, v70
    v_dot2_f32_bf16 v71, v25, s66, v71
    v_dot2_f32_bf16 v72, v26, s65, v72
    v_dot2_f32_bf16 v73, v26, s66, v73
    v_dot2_f32_bf16 v74, v27, s65, v74
    v_dot2_f32_bf16 v75, v27, s66, v75
    s_waitcnt vmcnt(8)
    v_dot2_f32_bf16 v68, v28, s65, v68
    v_dot2_f32_bf16 v69, v28, s66, v69
    v_dot2_f32_bf16 v70, v29, s65, v70
    v_dot2_f32_bf16 v71, v29, s66, v71
    v_dot2_f32_bf16 v72, v30, s65, v72
    v_dot2_f32_bf16 v73, v30, s66, v73
    v_dot2_f32_bf16 v74, v31, s65, v74
    v_dot2_f32_bf16 v75, v31, s66, v75
    s_waitcnt vmcnt(7)
    v_dot2_f32_bf16 v68, v32, s65, v68
    v_dot2_f32_bf16 v69, v32, s66, v69
    v_dot2_f32_bf16 v70, v33, s65, v70
    v_dot2_f32_bf16 v71, v33, s66, v71
    v_dot2_f32_bf16 v72, v34, s65, v72
    v_dot2_f32_bf16 v73, v34, s66, v73
    v_dot2_f32_bf16 v74, v35, s65, v74
    v_dot2_f32_bf16 v75, v35, s66, v75
    s_waitcnt vmcnt(6)
    v_dot2_f32_bf16 v68, v36, s65, v68
    v_dot2_f32_bf16 v69, v36, s66, v69
    v_dot2_f32_bf16 v70, v37, s65, v70
    v_dot2_f32_bf16 v71, v37, s66, v71
    v_dot2_f32_bf16 v72, v38, s65, v72
    v_dot2_f32_bf16 v73, v38, s66, v73
    v_dot2_f32_bf16 v74, v39, s65, v74
    v_dot2_f32_bf16 v75, v39, s66, v75
    s_waitcnt vmcnt(5)
    v_dot2_f32_bf16 v68, v40, s65, v68
    v_dot2_f32_bf16 v69, v40, s66, v69
    v_dot2_f32_bf16 v70, v41, s65, v70
    v_dot2_f32_bf16 v71, v41, s66, v71
    v_dot2_f32_bf16 v72, v42, s65, v72
    v_dot2_f32_bf16 v73, v42, s66, v73
    v_dot2_f32_bf16 v74, v43, s65, v74
    v_dot2_f32_bf16 v75, v43, s66, v75
    s_waitcnt vmcnt(4)
    v_dot2_f32_bf16 v68, v44, s65, v68
    v_dot2_f32_bf16 v69, v44, s66, v69
    v_dot2_f32_bf16 v70, v45, s65, v70
    v_dot2_f32_bf16 v71, v45, s66, v71
    v_dot2_f32_bf16 v72, v46, s65, v72
    v_dot2_f32_bf16 v73, v46, s66, v73
    v_dot2_f32_bf16 v74, v47, s65, v74
    v_dot2_f32_bf16 v75, v47, s66, v75
    s_waitcnt vmcnt(3)
    v_dot2_f32_bf16 v68, v48, s65, v68
    v_dot2_f32_bf16 v69, v48, s66, v69
    v_dot2_f32_bf16 v70, v49, s65, v70
    v_dot2_f32_bf16 v71, v49, s66, v71
    v_dot2_f32_bf16 v72, v50, s65, v72
    v_dot2_f32_bf16 v73, v50, s66, v73
    v_dot2_f32_bf16 v74, v51, s65, v74
    v_dot2_f32_bf16 v75, v51, s66, v75
    s_waitcnt vmcnt(2)
    v_dot2_f32_bf16 v68, v52, s65, v68
    v_dot2_f32_bf16 v69, v52, s66, v69
    v_dot2_f32_bf16 v70, v53, s65, v70
    v_dot2_f32_bf16 v71, v53, s66, v71
    v_dot2_f32_bf16 v72, v54, s65, v72
    v_dot2_f32_bf16 v73, v54, s66, v73
    v_dot2_f32_bf16 v74, v55, s65, v74
    v_dot2_f32_bf16 v75, v55, s66, v75
    s_waitcnt vmcnt(1)
    v_dot2_f32_bf16 v68, v56, s65, v68
    v_dot2_f32_bf16 v69, v56, s66, v69
    v_dot2_f32_bf16 v70, v57, s65, v70
    v_dot2_f32_bf16 v71, v57, s66, v71
    v_dot2_f32_bf16 v72, v58, s65, v72
    v_dot2_f32_bf16 v73, v58, s66, v73
    v_dot2_f32_bf16 v74, v59, s65, v74
    v_dot2_f32_bf16 v75, v59, s66, v75
    s_waitcnt vmcnt(0)
    v_dot2_f32_bf16 v68, v60, s65, v68
    v_dot2_f32_bf16 v69, v60, s66, v69
    v_dot2_f32_bf16 v70, v61, s65, v70
    v_dot2_f32_bf16 v71, v61, s66, v71
    v_dot2_f32_bf16 v72, v62, s65, v72
    v_dot2_f32_bf16 v73, v62, s66, v73
    v_dot2_f32_bf16 v74, v63, s65, v74
    v_dot2_f32_bf16 v75, v63, s66, v75
    v_cvt_pk_bf16_f32 v0, v68, v69
    v_cvt_pk_bf16_f32 v1, v70, v71
    v_cvt_pk_bf16_f32 v2, v72, v73
    v_cvt_pk_bf16_f32 v3, v74, v75
    v_lshlrev_b32 v68, 16, v0
    v_and_b32 v69, 0xffff0000, v0
    v_lshlrev_b32 v76, 16, v64
    v_and_b32 v77, 0xffff0000, v64
    v_lshlrev_b32 v70, 16, v1
    v_and_b32 v71, 0xffff0000, v1
    v_lshlrev_b32 v78, 16, v65
    v_and_b32 v79, 0xffff0000, v65
    v_lshlrev_b32 v72, 16, v2
    v_and_b32 v73, 0xffff0000, v2
    v_lshlrev_b32 v80, 16, v66
    v_and_b32 v81, 0xffff0000, v66
    v_lshlrev_b32 v74, 16, v3
    v_and_b32 v75, 0xffff0000, v3
    v_lshlrev_b32 v82, 16, v67
    v_and_b32 v83, 0xffff0000, v67
    v_pk_add_f32 v[68:69], v[68:69], v[76:77]
    v_pk_add_f32 v[70:71], v[70:71], v[78:79]
    v_pk_add_f32 v[72:73], v[72:73], v[80:81]
    v_pk_add_f32 v[74:75], v[74:75], v[82:83]
    v_cvt_pk_bf16_f32 v4, v68, v69
    v_cvt_pk_bf16_f32 v5, v70, v71
    v_cvt_pk_bf16_f32 v6, v72, v73
    v_cvt_pk_bf16_f32 v7, v74, v75
    v_lshlrev_b32 v68, 16, v4
    v_and_b32 v69, 0xffff0000, v4
    v_lshlrev_b32 v70, 16, v5
    v_and_b32 v71, 0xffff0000, v5
    v_lshlrev_b32 v72, 16, v6
    v_and_b32 v73, 0xffff0000, v6
    v_lshlrev_b32 v74, 16, v7
    v_and_b32 v75, 0xffff0000, v7
    s_add_u32 s62, s64, 0x6000000
    buffer_store_dwordx2 v[4:5], v252, s[8:11], s62 offen sc1
    buffer_store_dwordx2 v[6:7], v252, s[8:11], s62 offen offset:32 sc1
    v_add_f32 v84, v68, v69
    v_add_f32 v84, v84, v70
    v_add_f32 v84, v84, v71
    v_add_f32 v84, v84, v72
    v_add_f32 v84, v84, v73
    v_add_f32 v84, v84, v74
    v_add_f32 v84, v84, v75
    s_nop 1
    v_add_f32_dpp v84, v84, v84 row_ror:1 row_mask:0xf bank_mask:0xf
    s_nop 1
    v_add_f32_dpp v84, v84, v84 row_ror:2 row_mask:0xf bank_mask:0xf
    s_nop 1
    v_add_f32_dpp v84, v84, v84 row_ror:4 row_mask:0xf bank_mask:0xf
    s_nop 1
    v_add_f32_dpp v84, v84, v84 row_ror:8 row_mask:0xf bank_mask:0xf
    v_mov_b32 v85, v84
    s_nop 1
    v_permlane32_swap_b32 v85, v84
    v_add_f32 v84, v85, v84
    v_mov_b32 v85, v84
    s_nop 1
    v_permlane16_swap_b32 v85, v84
    v_add_f32 v84, v85, v84
    v_mul_f32 v84, 0x3b000000, v84
    v_cvt_pk_bf16_f32 v86, v84, v84
    v_and_b32 v86, 0xffff0000, v86
    v_sub_f32 v87, v84, v86
    v_sub_f32 v76, v68, v86
    v_sub_f32 v77, v69, v86
    v_sub_f32 v78, v70, v86
    v_sub_f32 v79, v71, v86
    v_sub_f32 v80, v72, v86
    v_sub_f32 v81, v73, v86
    v_sub_f32 v82, v74, v86
    v_sub_f32 v83, v75, v86
    v_mul_f32 v100, v76, v76
    v_fmac_f32 v100, v77, v77
    v_fmac_f32 v100, v78, v78
    v_fmac_f32 v100, v79, v79
    v_fmac_f32 v100, v80, v80
    v_fmac_f32 v100, v81, v81
    v_fmac_f32 v100, v82, v82
    v_fmac_f32 v100, v83, v83
    s_nop 1
    v_add_f32_dpp v100, v100, v100 row_ror:1 row_mask:0xf bank_mask:0xf
    s_nop 1
    v_add_f32_dpp v100, v100, v100 row_ror:2 row_mask:0xf bank_mask:0xf
    s_nop 1
    v_add_f32_dpp v100, v100, v100 row_ror:4 row_mask:0xf bank_mask:0xf
    s_nop 1
    v_add_f32_dpp v100, v100, v100 row_ror:8 row_mask:0xf bank_mask:0xf
    v_mov_b32 v85, v100
    s_nop 1
    v_permlane32_swap_b32 v85, v100
    v_add_f32 v100, v85, v100
    v_mov_b32 v85, v100
    s_nop 1
    v_permlane16_swap_b32 v85, v100
    v_add_f32 v100, v85, v100
    v_mul_f32 v85, v87, v87
    v_mul_f32 v100, 0x3b000000, v100
    v_sub_f32 v100, v100, v85
    v_max_f32 v100, 0, v100
    v_cvt_pk_bf16_f32 v100, v100, v100
    v_and_b32 v100, 0xffff0000, v100
    v_add_f32 v100, 0x3727c5ac, v100
    v_cvt_pk_bf16_f32 v100, v100, v100
    v_and_b32 v100, 0xffff0000, v100
    v_sqrt_f32 v100, v100
    s_nop 0
    v_cvt_pk_bf16_f32 v100, v100, v100
    v_and_b32 v100, 0xffff0000, v100
    v_rcp_f32 v100, v100
    v_cvt_pk_bf16_f32 v8, v76, v77
    v_cvt_pk_bf16_f32 v9, v78, v79
    v_cvt_pk_bf16_f32 v10, v80, v81
    v_cvt_pk_bf16_f32 v11, v82, v83
    v_lshlrev_b32 v76, 16, v8
    v_and_b32 v77, 0xffff0000, v8
    v_lshlrev_b32 v78, 16, v9
    v_and_b32 v79, 0xffff0000, v9
    v_lshlrev_b32 v80, 16, v10
    v_and_b32 v81, 0xffff0000, v10
    v_lshlrev_b32 v82, 16, v11
    v_and_b32 v83, 0xffff0000, v11
    v_mul_f32 v76, v100, v76
    v_mul_f32 v77, v100, v77
    v_mul_f32 v78, v100, v78
    v_mul_f32 v79, v100, v79
    v_mul_f32 v80, v100, v80
    v_mul_f32 v81, v100, v81
    v_mul_f32 v82, v100, v82
    v_mul_f32 v83, v100, v83
    v_cvt_pk_bf16_f32 v8, v76, v77
    v_cvt_pk_bf16_f32 v9, v78, v79
    v_cvt_pk_bf16_f32 v10, v80, v81
    v_cvt_pk_bf16_f32 v11, v82, v83
    v_lshlrev_b32 v76, 16, v8
    v_and_b32 v77, 0xffff0000, v8
    v_lshlrev_b32 v78, 16, v9
    v_and_b32 v79, 0xffff0000, v9
    v_lshlrev_b32 v80, 16, v10
    v_and_b32 v81, 0xffff0000, v10
    v_lshlrev_b32 v82, 16, v11
    v_and_b32 v83, 0xffff0000, v11
    s_add_u32 s62, s64, 0x6200000
    buffer_store_dwordx2 v[8:9], v252, s[8:11], s62 offen sc1
    buffer_store_dwordx2 v[10:11], v252, s[8:11], s62 offen offset:32 sc1
    v_pk_add_f32 v[68:69], v[68:69], v[76:77]
    v_pk_add_f32 v[70:71], v[70:71], v[78:79]
    v_pk_add_f32 v[72:73], v[72:73], v[80:81]
    v_pk_add_f32 v[74:75], v[74:75], v[82:83]
    v_cvt_pk_bf16_f32 v12, v68, v69
    v_cvt_pk_bf16_f32 v13, v70, v71
    v_cvt_pk_bf16_f32 v14, v72, v73
    v_cvt_pk_bf16_f32 v15, v74, v75
    buffer_store_dwordx2 v[12:13], v252, s[16:19], s64 offen sc1
    buffer_store_dwordx2 v[14:15], v252, s[16:19], s64 offen offset:32 sc1
    v_lshlrev_b32 v88, 16, v236
    v_and_b32 v89, 0xffff0000, v236
    v_lshlrev_b32 v90, 16, v237
    v_and_b32 v91, 0xffff0000, v237
    v_lshlrev_b32 v92, 16, v238
    v_and_b32 v93, 0xffff0000, v238
    v_lshlrev_b32 v94, 16, v239
    v_and_b32 v95, 0xffff0000, v239
    v_mul_f32 v84, v76, v88
    v_fmac_f32 v84, v77, v89
    v_fmac_f32 v84, v78, v90
    v_fmac_f32 v84, v79, v91
    v_fmac_f32 v84, v80, v92
    v_fmac_f32 v84, v81, v93
    v_fmac_f32 v84, v82, v94
    v_fmac_f32 v84, v83, v95
    s_nop 1
    v_add_f32_dpp v84, v84, v84 row_ror:1 row_mask:0xf bank_mask:0xf
    s_nop 1
    v_add_f32_dpp v84, v84, v84 row_ror:2 row_mask:0xf bank_mask:0xf
    s_nop 1
    v_add_f32_dpp v84, v84, v84 row_ror:4 row_mask:0xf bank_mask:0xf
    s_nop 1
    v_add_f32_dpp v84, v84, v84 row_ror:8 row_mask:0xf bank_mask:0xf
    v_mov_b32 v85, v84
    s_nop 1
    v_permlane32_swap_b32 v85, v84
    v_add_f32 v84, v85, v84
    v_mov_b32 v85, v84
    s_nop 1
    v_permlane16_swap_b32 v85, v84
    v_add_f32 v84, v85, v84
    v_cvt_pk_bf16_f32 v84, v84, v84
    v_and_b32 v84, 0xffff0000, v84
    v_ashrrev_i32 v85, 31, v84
    v_or_b32 v85, 0x80000000, v85
    v_xor_b32 v84, v84, v85
    v_and_b32 v84, 0xffff0000, v84
    s_sub_u32 s62, 0x87ff, s60
    v_or_b32 v84, s62, v84
    s_waitcnt vmcnt(0)
    s_lshl_b32 s62, s60, 2
    s_add_u32 s62, s62, 0x6000
    s_mov_b64 exec, 1
    buffer_store_dword v84, off, s[8:11], s62 sc1
    s_mov_b64 exec, -1
L_nofin_126:
    s_add_u32 s80, s80, 4
    s_add_u32 s22, s22, s23
    s_branch L_p2_seg
L_p2_end:
    s_cmp_ge_u32 s67, 56
    s_cbranch_scc1 L_exit
    s_mov_b32 s74, 0
    s_mov_b32 s75, 0
    v_mov_b32 v202, 0x7ffffff0
    v_mov_b32 v1, 0
    s_and_b32 s71, s101, 15
    s_lshl_b32 s71, s71, 7
    s_add_u32 s71, s71, 0x1000
    s_mov_b32 s72, 61
    s_cmp_lg_u32 s100, 0
    s_cbranch_scc1 L_polls_129
    s_mov_b32 exec_lo, 0x1
    s_mov_b32 exec_hi, 0
    s_mov_b32 s96, 0
L_poll_127:
    buffer_load_dword v2, v1, s[8:11], s71 offen sc1
    s_waitcnt vmcnt(0)
    v_cmp_gt_u32 vcc, s72, v2
    s_cbranch_vccz L_polld_128
    v_readfirstlane_b32 s97, v2
    s_nop 0
    s_sub_u32 s97, s72, s97
    s_cmp_lt_i32 s97, 3
    s_cbranch_scc1 L_near_130
    s_sleep 40
    s_cmp_lt_i32 s97, 5
    s_cbranch_scc1 L_near_130
    s_sleep 100
L_near_130:
    s_sleep 16
    s_add_u32 s96, s96, 1
    s_cmp_lt_u32 s96, 0x10000
    s_cbranch_scc1 L_poll_127
L_polld_128:
    s_mov_b64 exec, -1
L_polls_129:
    s_barrier
L_ffn_round:
    v_mbcnt_lo_u32_b32 v0, -1, 0
    v_mbcnt_hi_u32_b32 v0, -1, v0
    s_lshl_b32 s96, s100, 6
    v_add_u32 v0, s96, v0
    s_cmp_lg_u32 s75, 0
    s_cbranch_scc1 L_ffn_re
    v_lshlrev_b32 v30, 5, v0
    s_mov_b32 s69, 0x6000
    v_cmp_le_u32 vcc, 240, v0
    v_mov_b32 v29, s75
    v_add_u32 v29, -1, v29
    v_cndmask_b32 v19, 0, v29, vcc
    s_mov_b32 s70, 0
L_kpoll_131:
    buffer_load_dwordx4 v[20:23], v30, s[8:11], s69 offen sc1
    buffer_load_dwordx4 v[24:27], v30, s[8:11], s69 offen offset:16 sc1
    s_waitcnt vmcnt(0)
    v_min3_u32 v28, v20, v21, v22
    v_min3_u32 v28, v28, v23, v24
    v_min3_u32 v28, v28, v25, v26
    v_min_u32 v28, v28, v27
    v_or_b32 v28, v28, v19
    v_cmp_eq_u32 vcc, 0, v28
    s_cbranch_vccz L_kpolld_132
    s_sleep 6
    s_add_u32 s70, s70, 1
    s_cmp_lt_u32 s70, 0x10000
    s_cbranch_scc1 L_kpoll_131
L_kpolld_132:
    v_bfi_b32 v20, v19, 0, v20
    v_bfi_b32 v21, v19, 0, v21
    v_bfi_b32 v22, v19, 0, v22
    v_bfi_b32 v23, v19, 0, v23
    v_bfi_b32 v24, v19, 0, v24
    v_bfi_b32 v25, v19, 0, v25
    v_bfi_b32 v26, v19, 0, v26
    v_bfi_b32 v27, v19, 0, v27
    v_lshrrev_b32 v30, 6, v0
    v_lshlrev_b32 v30, 2, v30
    v_add_u32 v30, 0x20400, v30
    v_mov_b32 v31, 0x20400
    s_waitcnt vmcnt(0)
    v_max3_u32 v28, v20, v21, v22
    v_max3_u32 v28, v28, v23, v24
    v_max3_u32 v28, v28, v25, v26
    v_max_u32 v28, v28, v27
    s_nop 1
    v_max_u32_dpp v28, v28, v28 row_ror:1 row_mask:0xf bank_mask:0xf
    s_nop 1
    v_max_u32_dpp v28, v28, v28 row_ror:2 row_mask:0xf bank_mask:0xf
    s_nop 1
    v_max_u32_dpp v28, v28, v28 row_ror:4 row_mask:0xf bank_mask:0xf
    s_nop 1
    v_max_u32_dpp v28, v28, v28 row_ror:8 row_mask:0xf bank_mask:0xf
    v_mov_b32 v29, v28
    s_nop 1
    v_permlane32_swap_b32 v29, v28
    v_max_u32 v28, v29, v28
    v_mov_b32 v29, v28
    s_nop 1
    v_permlane16_swap_b32 v29, v28
    v_max_u32 v28, v29, v28
    ds_write_b32 v30, v28
    s_waitcnt lgkmcnt(0)
    s_barrier
    ds_read_b128 v[16:19], v31
    s_waitcnt lgkmcnt(0)
    v_max3_u32 v28, v16, v17, v18
    v_max_u32 v28, v28, v19
    s_nop 0
    v_readfirstlane_b32 s69, v28
    s_nop 1
    v_cmp_ne_u32 vcc, s69, v20
    s_nop 1
    v_cndmask_b32 v20, 0, v20, vcc
    v_cmp_ne_u32 vcc, s69, v21
    s_nop 1
    v_cndmask_b32 v21, 0, v21, vcc
    v_cmp_ne_u32 vcc, s69, v22
    s_nop 1
    v_cndmask_b32 v22, 0, v22, vcc
    v_cmp_ne_u32 vcc, s69, v23
    s_nop 1
    v_cndmask_b32 v23, 0, v23, vcc
    v_cmp_ne_u32 vcc, s69, v24
    s_nop 1
    v_cndmask_b32 v24, 0, v24, vcc
    v_cmp_ne_u32 vcc, s69, v25
    s_nop 1
    v_cndmask_b32 v25, 0, v25, vcc
    v_cmp_ne_u32 vcc, s69, v26
    s_nop 1
    v_cndmask_b32 v26, 0, v26, vcc
    v_cmp_ne_u32 vcc, s69, v27
    s_nop 1
    v_cndmask_b32 v27, 0, v27, vcc
    v_max3_u32 v28, v20, v21, v22
    v_max3_u32 v28, v28, v23, v24
    v_max3_u32 v28, v28, v25, v26
    v_max_u32 v28, v28, v27
    s_nop 1
    v_max_u32_dpp v28, v28, v28 row_ror:1 row_mask:0xf bank_mask:0xf
    s_nop 1
    v_max_u32_dpp v28, v28, v28 row_ror:2 row_mask:0xf bank_mask:0xf
    s_nop 1
    v_max_u32_dpp v28, v28, v28 row_ror:4 row_mask:0xf bank_mask:0xf
    s_nop 1
    v_max_u32_dpp v28, v28, v28 row_ror:8 row_mask:0xf bank_mask:0xf
    v_mov_b32 v29, v28
    s_nop 1
    v_permlane32_swap_b32 v29, v28
    v_max_u32 v28, v29, v28
    v_mov_b32 v29, v28
    s_nop 1
    v_permlane16_swap_b32 v29, v28
    v_max_u32 v28, v29, v28
    ds_write_b32 v30, v28 offset:16
    s_waitcnt lgkmcnt(0)
    s_barrier
    ds_read_b128 v[16:19], v31 offset:16
    s_waitcnt lgkmcnt(0)
    v_max3_u32 v28, v16, v17, v18
    v_max_u32 v28, v28, v19
    s_nop 0
    v_readfirstlane_b32 s70, v28
    s_barrier
    s_branch L_ffn_sel
L_ffn_re:
    v_and_b32 v24, 63, v0
    v_lshlrev_b32 v24, 3, v24
    s_mov_b32 s71, 0x7e00
    s_mov_b32 s72, 0
L_rsel_133:
    buffer_load_dwordx2 v[20:21], v24, s[8:11], s71 offen sc1
    s_waitcnt vmcnt(0)
    v_min_u32 v22, v20, v21
    v_cmp_eq_u32 vcc, 0, v22
    s_cbranch_vccz L_rseld_134
    s_sleep 3
    s_add_u32 s72, s72, 1
    s_cmp_lt_u32 s72, 0x10000
    s_cbranch_scc1 L_rsel_133
L_rseld_134:
    v_max_u32 v22, v20, v21
    v_cmp_lt_u32 vcc, s70, v22
    s_cbranch_vccz L_rsele_135
    v_max_u32_dpp v22, v22, v22 row_ror:1 row_mask:0xf bank_mask:0xf
    s_nop 1
    v_max_u32_dpp v22, v22, v22 row_ror:2 row_mask:0xf bank_mask:0xf
    s_nop 1
    v_max_u32_dpp v22, v22, v22 row_ror:4 row_mask:0xf bank_mask:0xf
    s_nop 1
    v_max_u32_dpp v22, v22, v22 row_ror:8 row_mask:0xf bank_mask:0xf
    v_mov_b32 v23, v22
    s_nop 1
    v_permlane32_swap_b32 v23, v22
    v_max_u32 v22, v23, v22
    v_mov_b32 v23, v22
    s_nop 1
    v_permlane16_swap_b32 v23, v22
    v_max_u32 v22, v23, v22
    s_nop 0
    v_readfirstlane_b32 s71, v22
    s_nop 1
    v_cmp_ne_u32 vcc, s71, v20
    s_nop 1
    v_cndmask_b32 v20, 0, v20, vcc
    v_cmp_ne_u32 vcc, s71, v21
    s_nop 1
    v_cndmask_b32 v21, 0, v21, vcc
    v_max_u32 v22, v20, v21
    s_nop 1
    v_max_u32_dpp v22, v22, v22 row_ror:1 row_mask:0xf bank_mask:0xf
    s_nop 1
    v_max_u32_dpp v22, v22, v22 row_ror:2 row_mask:0xf bank_mask:0xf
    s_nop 1
    v_max_u32_dpp v22, v22, v22 row_ror:4 row_mask:0xf bank_mask:0xf
    s_nop 1
    v_max_u32_dpp v22, v22, v22 row_ror:8 row_mask:0xf bank_mask:0xf
    v_mov_b32 v23, v22
    s_nop 1
    v_permlane32_swap_b32 v23, v22
    v_max_u32 v22, v23, v22
    v_mov_b32 v23, v22
    s_nop 1
    v_permlane16_swap_b32 v23, v22
    v_max_u32 v22, v23, v22
    s_nop 0
    v_readfirstlane_b32 s72, v22
    s_nop 0
    s_max_u32 s70, s70, s72
    s_min_u32 s72, s71, s69
    s_max_u32 s70, s70, s72
    s_max_u32 s69, s69, s71
L_rsele_135:
L_ffn_sel:
    s_and_b32 s71, s69, 2047
    s_lshl_b32 s71, s71, 11
    s_and_b32 s72, s70, 2047
    s_or_b32 s71, s71, s72
    s_add_u32 s71, s71, 1
    s_cmp_eq_u32 s71, s74
    s_cbranch_scc1 L_ffn_same
    s_mov_b32 s74, s71
    v_and_b32 v1, 63, v0
    v_lshrrev_b32 v2, 4, v1
    v_and_b32 v3, 15, v1
    v_lshrrev_b32 v6, 2, v3
    s_and_b32 s71, s69, 2047
    s_sub_u32 s71, 2047, s71
    s_and_b32 s72, s70, 2047
    s_sub_u32 s72, 2047, s72
    v_and_b32 v4, 1, v3
    v_cmp_eq_u32 vcc, 0, v4
    v_mov_b32 v4, s71
    v_mov_b32 v5, s72
    v_cndmask_b32 v4, v5, v4, vcc
    v_lshlrev_b32 v4, 10, v4
    v_lshl_add_u32 v4, v2, 4, v4
    s_mov_b32 s71, 0x6200000
    buffer_load_dwordx4 v[32:35], v4, s[8:11], s71 offen
    buffer_load_dwordx4 v[36:39], v4, s[8:11], s71 offen offset:64
    buffer_load_dwordx4 v[40:43], v4, s[8:11], s71 offen offset:128
    buffer_load_dwordx4 v[44:47], v4, s[8:11], s71 offen offset:192
    buffer_load_dwordx4 v[48:51], v4, s[8:11], s71 offen offset:256
    buffer_load_dwordx4 v[52:55], v4, s[8:11], s71 offen offset:320
    buffer_load_dwordx4 v[56:59], v4, s[8:11], s71 offen offset:384
    buffer_load_dwordx4 v[60:63], v4, s[8:11], s71 offen offset:448
    buffer_load_dwordx4 v[64:67], v4, s[8:11], s71 offen offset:512
    buffer_load_dwordx4 v[68:71], v4, s[8:11], s71 offen offset:576
    buffer_load_dwordx4 v[72:75], v4, s[8:11], s71 offen offset:640
    buffer_load_dwordx4 v[76:79], v4, s[8:11], s71 offen offset:704
    buffer_load_dwordx4 v[80:83], v4, s[8:11], s71 offen offset:768
    buffer_load_dwordx4 v[84:87], v4, s[8:11], s71 offen offset:832
    buffer_load_dwordx4 v[88:91], v4, s[8:11], s71 offen offset:896
    buffer_load_dwordx4 v[92:95], v4, s[8:11], s71 offen offset:960
    v_lshl_add_u32 v4, v2, 3, v6
    v_lshlrev_b32 v4, 6, v4
    v_and_b32 v5, 3, v3
    v_lshl_add_u32 v4, v5, 3, v4
    s_lshr_b32 s71, s68, 1
    s_lshl_b32 s71, s71, 15
    s_and_b32 s72, s68, 1
    s_lshl_b32 s72, s72, 5
    s_add_u32 s71, s71, s72
    s_add_u32 s71, s71, 0x8000
    v_add_u32 v7, s71, v4
    ds_read_b64_tr_b16 v[96:97], v7
    ds_read_b64_tr_b16 v[98:99], v7 offset:256
    ds_read_b64_tr_b16 v[100:101], v7 offset:2048
    ds_read_b64_tr_b16 v[102:103], v7 offset:2304
    ds_read_b64_tr_b16 v[104:105], v7 offset:4096
    ds_read_b64_tr_b16 v[106:107], v7 offset:4352
    ds_read_b64_tr_b16 v[108:109], v7 offset:6144
    ds_read_b64_tr_b16 v[110:111], v7 offset:6400
    s_waitcnt lgkmcnt(0)
    ds_read_b64_tr_b16 v[112:113], v7 offset:8192
    ds_read_b64_tr_b16 v[114:115], v7 offset:8448
    ds_read_b64_tr_b16 v[116:117], v7 offset:10240
    ds_read_b64_tr_b16 v[118:119], v7 offset:10496
    ds_read_b64_tr_b16 v[120:121], v7 offset:12288
    ds_read_b64_tr_b16 v[122:123], v7 offset:12544
    ds_read_b64_tr_b16 v[124:125], v7 offset:14336
    ds_read_b64_tr_b16 v[126:127], v7 offset:14592
    s_waitcnt lgkmcnt(0)
    ds_read_b64_tr_b16 v[128:129], v7 offset:16384
    ds_read_b64_tr_b16 v[130:131], v7 offset:16640
    ds_read_b64_tr_b16 v[132:133], v7 offset:18432
    ds_read_b64_tr_b16 v[134:135], v7 offset:18688
    ds_read_b64_tr_b16 v[136:137], v7 offset:20480
    ds_read_b64_tr_b16 v[138:139], v7 offset:20736
    ds_read_b64_tr_b16 v[140:141], v7 offset:22528
    ds_read_b64_tr_b16 v[142:143], v7 offset:22784
    s_waitcnt lgkmcnt(0)
    ds_read_b64_tr_b16 v[144:145], v7 offset:24576
    ds_read_b64_tr_b16 v[146:147], v7 offset:24832
    ds_read_b64_tr_b16 v[148:149], v7 offset:26624
    ds_read_b64_tr_b16 v[150:151], v7 offset:26880
    ds_read_b64_tr_b16 v[152:153], v7 offset:28672
    ds_read_b64_tr_b16 v[154:155], v7 offset:28928
    ds_read_b64_tr_b16 v[156:157], v7 offset:30720
    ds_read_b64_tr_b16 v[158:159], v7 offset:30976
    s_waitcnt lgkmcnt(0)
    s_waitcnt vmcnt(0)
    v_mfma_f32_16x16x32_bf16 v[8:11], v[32:35], v[96:99], 0
    v_mfma_f32_16x16x32_bf16 v[8:11], v[36:39], v[100:103], v[8:11]
    v_mfma_f32_16x16x32_bf16 v[8:11], v[40:43], v[104:107], v[8:11]
    v_mfma_f32_16x16x32_bf16 v[8:11], v[44:47], v[108:111], v[8:11]
    v_mfma_f32_16x16x32_bf16 v[8:11], v[48:51], v[112:115], v[8:11]
    v_mfma_f32_16x16x32_bf16 v[8:11], v[52:55], v[116:119], v[8:11]
    v_mfma_f32_16x16x32_bf16 v[8:11], v[56:59], v[120:123], v[8:11]
    v_mfma_f32_16x16x32_bf16 v[8:11], v[60:63], v[124:127], v[8:11]
    v_mfma_f32_16x16x32_bf16 v[8:11], v[64:67], v[128:131], v[8:11]
    v_mfma_f32_16x16x32_bf16 v[8:11], v[68:71], v[132:135], v[8:11]
    v_mfma_f32_16x16x32_bf16 v[8:11], v[72:75], v[136:139], v[8:11]
    v_mfma_f32_16x16x32_bf16 v[8:11], v[76:79], v[140:143], v[8:11]
    v_mfma_f32_16x16x32_bf16 v[8:11], v[80:83], v[144:147], v[8:11]
    v_mfma_f32_16x16x32_bf16 v[8:11], v[84:87], v[148:151], v[8:11]
    v_mfma_f32_16x16x32_bf16 v[8:11], v[88:91], v[152:155], v[8:11]
    v_mfma_f32_16x16x32_bf16 v[8:11], v[92:95], v[156:159], v[8:11]
    s_nop 7
    v_cvt_pk_bf16_f32 v8, v8, v8
    v_and_b32 v8, 0xffff0000, v8
    v_cvt_pk_bf16_f32 v9, v9, v9
    v_and_b32 v9, 0xffff0000, v9
    s_cmp_ge_u32 s68, 2
    s_cbranch_scc1 L_ffn_up_136
    v_mul_f32 v13, 0xbfb8aa3b, v8
    v_exp_f32 v13, v13
    s_nop 0
    v_add_f32 v13, 1.0, v13
    v_rcp_f32 v12, v13
    s_nop 0
    v_mul_f32 v8, v12, v8
    v_cvt_pk_bf16_f32 v8, v8, v8
    v_and_b32 v8, 0xffff0000, v8
    v_mul_f32 v13, 0xbfb8aa3b, v9
    v_exp_f32 v13, v13
    s_nop 0
    v_add_f32 v13, 1.0, v13
    v_rcp_f32 v12, v13
    s_nop 0
    v_mul_f32 v9, v12, v9
    v_cvt_pk_bf16_f32 v9, v9, v9
    v_and_b32 v9, 0xffff0000, v9
    s_nop 4
L_ffn_up_136:
    s_lshr_b32 s71, s68, 1
    s_lshl_b32 s71, s71, 8
    s_and_b32 s72, s68, 1
    s_lshl_b32 s72, s72, 6
    s_add_u32 s71, s71, s72
    s_add_u32 s71, s71, 0x20000
    v_lshlrev_b32 v4, 2, v3
    v_add_u32 v4, s71, v4
    ds_write_b32 v4, v8
    ds_write_b32 v4, v9 offset:128
    s_waitcnt lgkmcnt(0)
    s_barrier
    v_and_b32 v4, 1, v3
    v_lshlrev_b32 v4, 7, v4
    v_lshl_add_u32 v4, v2, 5, v4
    v_add_u32 v4, 0x20000, v4
    ds_read_b128 v[32:35], v4
    ds_read_b128 v[36:39], v4 offset:16
    ds_read_b128 v[40:43], v4 offset:256
    ds_read_b128 v[44:47], v4 offset:272
    v_lshl_add_u32 v5, v2, 3, v6
    v_lshlrev_b32 v5, 10, v5
    v_and_b32 v7, 3, v3
    v_lshl_add_u32 v5, v7, 3, v5
    s_lshl_b32 s71, s68, 8
    s_add_u32 s71, s71, 0x18000
    v_add_u32 v7, s71, v5
    s_waitcnt lgkmcnt(0)
    ds_read_b64_tr_b16 v[96:97], v7
    ds_read_b64_tr_b16 v[98:99], v7 offset:4096
    ds_read_b64_tr_b16 v[100:101], v7 offset:32
    ds_read_b64_tr_b16 v[102:103], v7 offset:4128
    ds_read_b64_tr_b16 v[104:105], v7 offset:64
    ds_read_b64_tr_b16 v[106:107], v7 offset:4160
    ds_read_b64_tr_b16 v[108:109], v7 offset:96
    ds_read_b64_tr_b16 v[110:111], v7 offset:4192
    s_waitcnt lgkmcnt(0)
    ds_read_b64_tr_b16 v[112:113], v7 offset:128
    ds_read_b64_tr_b16 v[114:115], v7 offset:4224
    ds_read_b64_tr_b16 v[116:117], v7 offset:160
    ds_read_b64_tr_b16 v[118:119], v7 offset:4256
    ds_read_b64_tr_b16 v[120:121], v7 offset:192
    ds_read_b64_tr_b16 v[122:123], v7 offset:4288
    ds_read_b64_tr_b16 v[124:125], v7 offset:224
    ds_read_b64_tr_b16 v[126:127], v7 offset:4320
    v_mul_f32 v32, v32, v40
    v_mul_f32 v33, v33, v41
    v_mul_f32 v34, v34, v42
    v_mul_f32 v35, v35, v43
    v_mul_f32 v36, v36, v44
    v_mul_f32 v37, v37, v45
    v_mul_f32 v38, v38, v46
    v_mul_f32 v39, v39, v47
    v_cvt_pk_bf16_f32 v48, v32, v33
    v_cvt_pk_bf16_f32 v49, v34, v35
    v_cvt_pk_bf16_f32 v50, v36, v37
    v_cvt_pk_bf16_f32 v51, v38, v39
    s_waitcnt lgkmcnt(0)
    s_nop 0
    v_mfma_f32_16x16x32_bf16 v[56:59], v[48:51], v[96:99], 0
    v_mfma_f32_16x16x32_bf16 v[60:63], v[48:51], v[100:103], 0
    v_mfma_f32_16x16x32_bf16 v[64:67], v[48:51], v[104:107], 0
    v_mfma_f32_16x16x32_bf16 v[68:71], v[48:51], v[108:111], 0
    v_mfma_f32_16x16x32_bf16 v[72:75], v[48:51], v[112:115], 0
    v_mfma_f32_16x16x32_bf16 v[76:79], v[48:51], v[116:119], 0
    v_mfma_f32_16x16x32_bf16 v[80:83], v[48:51], v[120:123], 0
    v_mfma_f32_16x16x32_bf16 v[84:87], v[48:51], v[124:127], 0
    v_cmp_eq_u32 vcc, 0, v2
    v_lshlrev_b32 v4, 11, v2
    v_lshl_add_u32 v4, v3, 2, v4
    s_lshl_b32 s71, s67, 12
    s_lshl_b32 s72, s68, 9
    s_add_u32 s71, s71, s72
    s_add_u32 s71, s71, 0x6410000
    v_cndmask_b32 v56, v57, v56, vcc
    v_cndmask_b32 v60, v61, v60, vcc
    v_cndmask_b32 v64, v65, v64, vcc
    v_cndmask_b32 v68, v69, v68, vcc
    v_cndmask_b32 v72, v73, v72, vcc
    v_cndmask_b32 v76, v77, v76, vcc
    v_cndmask_b32 v80, v81, v80, vcc
    v_cndmask_b32 v84, v85, v84, vcc
    s_mov_b32 exec_hi, 0
    buffer_store_dword v56, v4, s[8:11], s71 offen sc1
    buffer_store_dword v60, v4, s[8:11], s71 offen offset:64 sc1
    buffer_store_dword v64, v4, s[8:11], s71 offen offset:128 sc1
    buffer_store_dword v68, v4, s[8:11], s71 offen offset:192 sc1
    buffer_store_dword v72, v4, s[8:11], s71 offen offset:256 sc1
    buffer_store_dword v76, v4, s[8:11], s71 offen offset:320 sc1
    buffer_store_dword v80, v4, s[8:11], s71 offen offset:384 sc1
    buffer_store_dword v84, v4, s[8:11], s71 offen offset:448 sc1
    s_mov_b64 exec, -1
    s_waitcnt vmcnt(0)
    s_barrier
    s_lshl_b32 s71, s67, 2
    s_lshl_b32 s72, s75, 8
    s_add_u32 s71, s71, s72
    s_add_u32 s71, s71, 0x8000
    s_cmp_lg_u32 s100, 0
    s_cbranch_scc1 L_flag_137
    v_mov_b32 v2, s74
    s_mov_b64 exec, 1
    buffer_store_dword v2, off, s[8:11], s71 sc1
    s_mov_b64 exec, -1
L_flag_137:
    s_cmp_ge_u32 s67, 8
    s_cbranch_scc1 L_ffn_same
    s_load_dwordx2 s[16:17], s[0:1], 96
    s_waitcnt lgkmcnt(0)
    s_and_b32 s17, s17, 0xffff
    s_mov_b32 s18, 0x200000
    s_mov_b32 s19, 0x20000
    v_and_b32 v3, 63, v0
    s_cmp_lt_u32 s100, 2
    s_cselect_b32 s71, s69, s70
    v_mov_b32 v5, s71
    s_and_b32 s71, s71, 2047
    s_sub_u32 s71, 2047, s71
    s_lshl_b32 s71, s71, 10
    s_lshl_b32 s72, s67, 1
    s_and_b32 s96, s100, 1
    s_add_u32 s72, s72, s96
    s_lshl_b32 s96, s72, 6
    s_add_u32 s71, s71, s96
    v_and_b32 v4, 7, v3
    v_lshlrev_b32 v6, 3, v4
    v_add_u32 v6, s71, v6
    v_lshrrev_b32 v7, 3, v3
    v_lshlrev_b32 v7, 12, v7
    v_lshl_add_u32 v7, v4, 4, v7
    s_lshl_b32 s72, s72, 7
    s_lshr_b32 s96, s100, 1
    s_lshl_b32 s96, s96, 11
    s_add_u32 s72, s72, s96
    v_add_u32 v7, s72, v7
    s_mov_b32 s71, 0x6000000
    s_mov_b32 s72, 0x6200000
    buffer_load_dwordx2 v[8:9], v6, s[8:11], s71 offen sc1
    buffer_load_dwordx2 v[10:11], v6, s[8:11], s72 offen sc1
    v_and_b32 v5, 0xffff0000, v5
    v_ashrrev_i32 v4, 31, v5
    v_not_b32 v4, v4
    v_or_b32 v4, 0x80000000, v4
    v_xor_b32 v5, v5, v4
    v_and_b32 v5, 0xffff0000, v5
    v_mul_f32 v23, 0xbfb8aa3b, v5
    v_exp_f32 v23, v23
    s_nop 0
    v_add_f32 v23, 1.0, v23
    v_rcp_f32 v22, v23
    s_nop 0
    v_cvt_pk_bf16_f32 v22, v22, v22
    v_and_b32 v22, 0xffff0000, v22
    v_lshlrev_b32 v1, 2, v0
    s_lshl_b32 s71, s75, 8
    s_add_u32 s71, s71, 0x8000
    s_cmp_lg_u32 s100, 0
    s_cbranch_scc1 L_polls_140
    s_mov_b32 exec_hi, 0xffffff
    s_mov_b32 s96, 0
L_poll_138:
    buffer_load_dword v2, v1, s[8:11], s71 offen sc1
    s_waitcnt vmcnt(0)
    v_cmp_ne_u32 vcc, s74, v2
    s_cbranch_vccz L_polld_139
    s_sleep 2
    s_add_u32 s96, s96, 1
    s_cmp_lt_u32 s96, 0x10000
    s_cbranch_scc1 L_poll_138
L_polld_139:
    s_mov_b64 exec, -1
L_polls_140:
    s_barrier
    s_mov_b32 s71, 0x6410000
    buffer_load_dwordx4 v[32:35], v7, s[8:11], s71 offen sc1
    s_add_u32 s71, s71, 32768
    buffer_load_dwordx4 v[36:39], v7, s[8:11], s71 offen sc1
    s_add_u32 s71, s71, 32768
    buffer_load_dwordx4 v[40:43], v7, s[8:11], s71 offen sc1
    s_add_u32 s71, s71, 32768
    buffer_load_dwordx4 v[44:47], v7, s[8:11], s71 offen sc1
    s_add_u32 s71, s71, 32768
    buffer_load_dwordx4 v[48:51], v7, s[8:11], s71 offen sc1
    s_add_u32 s71, s71, 32768
    buffer_load_dwordx4 v[52:55], v7, s[8:11], s71 offen sc1
    s_add_u32 s71, s71, 32768
    buffer_load_dwordx4 v[56:59], v7, s[8:11], s71 offen sc1
    s_add_u32 s71, s71, 32768
    s_waitcnt vmcnt(7)
    v_lshlrev_b32 v12, 16, v8
    v_and_b32 v13, 0xffff0000, v8
    v_lshlrev_b32 v16, 16, v10
    v_and_b32 v17, 0xffff0000, v10
    v_lshlrev_b32 v14, 16, v9
    v_and_b32 v15, 0xffff0000, v9
    v_lshlrev_b32 v18, 16, v11
    v_and_b32 v19, 0xffff0000, v11
    s_waitcnt vmcnt(0)
    v_pk_add_f32 v[32:33], v[32:33], v[36:37]
    v_pk_add_f32 v[34:35], v[34:35], v[38:39]
    v_pk_add_f32 v[32:33], v[32:33], v[40:41]
    v_pk_add_f32 v[34:35], v[34:35], v[42:43]
    v_pk_add_f32 v[32:33], v[32:33], v[44:45]
    v_pk_add_f32 v[34:35], v[34:35], v[46:47]
    v_pk_add_f32 v[32:33], v[32:33], v[48:49]
    v_pk_add_f32 v[34:35], v[34:35], v[50:51]
    v_pk_add_f32 v[32:33], v[32:33], v[52:53]
    v_pk_add_f32 v[34:35], v[34:35], v[54:55]
    v_pk_add_f32 v[32:33], v[32:33], v[56:57]
    v_pk_add_f32 v[34:35], v[34:35], v[58:59]
    s_nop 0
    v_add_f32_dpp v32, v32, v32 row_ror:8 row_mask:0xf bank_mask:0xf
    v_add_f32_dpp v33, v33, v33 row_ror:8 row_mask:0xf bank_mask:0xf
    v_add_f32_dpp v34, v34, v34 row_ror:8 row_mask:0xf bank_mask:0xf
    v_add_f32_dpp v35, v35, v35 row_ror:8 row_mask:0xf bank_mask:0xf
    v_mov_b32 v24, v32
    s_nop 1
    v_permlane32_swap_b32 v24, v32
    v_add_f32 v32, v24, v32
    v_mov_b32 v24, v32
    s_nop 1
    v_permlane16_swap_b32 v24, v32
    v_add_f32 v32, v24, v32
    v_mov_b32 v24, v33
    s_nop 1
    v_permlane32_swap_b32 v24, v33
    v_add_f32 v33, v24, v33
    v_mov_b32 v24, v33
    s_nop 1
    v_permlane16_swap_b32 v24, v33
    v_add_f32 v33, v24, v33
    v_mov_b32 v24, v34
    s_nop 1
    v_permlane32_swap_b32 v24, v34
    v_add_f32 v34, v24, v34
    v_mov_b32 v24, v34
    s_nop 1
    v_permlane16_swap_b32 v24, v34
    v_add_f32 v34, v24, v34
    v_mov_b32 v24, v35
    s_nop 1
    v_permlane32_swap_b32 v24, v35
    v_add_f32 v35, v24, v35
    v_mov_b32 v24, v35
    s_nop 1
    v_permlane16_swap_b32 v24, v35
    v_add_f32 v35, v24, v35
    v_cvt_pk_bf16_f32 v32, v32, v32
    v_and_b32 v32, 0xffff0000, v32
    v_mul_f32 v32, v22, v32
    v_cvt_pk_bf16_f32 v32, v32, v32
    v_and_b32 v32, 0xffff0000, v32
    v_add_f32 v32, v16, v32
    v_cvt_pk_bf16_f32 v32, v32, v32
    v_and_b32 v32, 0xffff0000, v32
    v_add_f32 v32, v12, v32
    v_cvt_pk_bf16_f32 v33, v33, v33
    v_and_b32 v33, 0xffff0000, v33
    v_mul_f32 v33, v22, v33
    v_cvt_pk_bf16_f32 v33, v33, v33
    v_and_b32 v33, 0xffff0000, v33
    v_add_f32 v33, v17, v33
    v_cvt_pk_bf16_f32 v33, v33, v33
    v_and_b32 v33, 0xffff0000, v33
    v_add_f32 v33, v13, v33
    v_cvt_pk_bf16_f32 v34, v34, v34
    v_and_b32 v34, 0xffff0000, v34
    v_mul_f32 v34, v22, v34
    v_cvt_pk_bf16_f32 v34, v34, v34
    v_and_b32 v34, 0xffff0000, v34
    v_add_f32 v34, v18, v34
    v_cvt_pk_bf16_f32 v34, v34, v34
    v_and_b32 v34, 0xffff0000, v34
    v_add_f32 v34, v14, v34
    v_cvt_pk_bf16_f32 v35, v35, v35
    v_and_b32 v35, 0xffff0000, v35
    v_mul_f32 v35, v22, v35
    v_cvt_pk_bf16_f32 v35, v35, v35
    v_and_b32 v35, 0xffff0000, v35
    v_add_f32 v35, v19, v35
    v_cvt_pk_bf16_f32 v35, v35, v35
    v_and_b32 v35, 0xffff0000, v35
    v_add_f32 v35, v15, v35
    v_cvt_pk_bf16_f32 v200, v32, v33
    v_cvt_pk_bf16_f32 v201, v34, v35
    v_mov_b32 v202, v6
L_ffn_same:
    s_add_u32 s75, s75, 1
    s_cmp_lt_u32 s75, 2
    s_cbranch_scc1 L_ffn_round
    s_cmp_ge_u32 s67, 8
    s_cbranch_scc1 L_exit
    s_mov_b32 exec_lo, 0xff
    s_mov_b32 exec_hi, 0
    buffer_store_dwordx2 v[200:201], v202, s[16:19], 0 offen
    s_mov_b64 exec, -1
    s_waitcnt vmcnt(0)
L_exit:
    s_endpgm
.section .rodata,"a"
.p2align 6
.amdhsa_kernel sequential_preLN__memory_aug_recurrent_mem_tr__moe_arch_mod__prompt_kernel
  .amdhsa_next_free_vgpr 512
  .amdhsa_next_free_sgpr 102
  .amdhsa_accum_offset 256
  .amdhsa_group_segment_fixed_size 0
  .amdhsa_kernarg_size 120
  .amdhsa_user_sgpr_count 2
  .amdhsa_user_sgpr_kernarg_segment_ptr 1
  .amdhsa_system_sgpr_workgroup_id_x 1
  .amdhsa_float_denorm_mode_32 3
.end_amdhsa_kernel
```

```asm
; @launch grid=(256,1,1) block=(256,1,1) lds=163840
.amdgcn_target "amdgcn-amd-amdhsa--gfx950"
.text
.globl sequential_preLN__memory_aug_recurrent_mem_tr__moe_arch_mod__prompt_kernel
.p2align 8
.type sequential_preLN__memory_aug_recurrent_mem_tr__moe_arch_mod__prompt_kernel,@function
sequential_preLN__memory_aug_recurrent_mem_tr__moe_arch_mod__prompt_kernel:
    s_cmp_ge_u32 s2, 256
    s_cbranch_scc1 L_exit
    s_load_dwordx2 s[8:9], s[0:1], 112
    s_load_dwordx2 s[92:93], s[0:1], 104
    s_load_dwordx8 s[60:67], s[0:1], 16
    v_lshrrev_b32 v1, 6, v0
    s_nop 0
    v_readfirstlane_b32 s100, v1
    s_getreg_b32 s84, hwreg(HW_REG_XCC_ID)
    s_and_b32 s84, s84, 7
    s_lshr_b32 s85, s2, 3
    s_mov_b32 s87, 0
    s_lshl_b32 s97, s84, 4
    s_lshl_b32 s96, 1, s85
    v_mov_b32 v2, s96
    v_mov_b32 v3, 256
    s_waitcnt lgkmcnt(0)
    s_and_b32 s9, s9, 0xffff
    s_mov_b32 s10, 0x10000000
    s_mov_b32 s11, 0x20000
    s_and_b32 s93, s93, 0xffff
    s_mov_b32 s94, 0x100
    s_mov_b32 s95, 0x20000
    s_cmp_lg_u32 s100, 0
    s_cbranch_scc1 L_reg
    s_mov_b64 exec, 1
    buffer_atomic_add_x2 v[2:3], off, s[92:95], s97 offset:64
    s_mov_b64 exec, -1
L_reg:
    s_cmp_eq_u32 s2, 7
    s_cbranch_scc1 L_zero
L_noz:
    s_cmp_lg_u32 s84, 0
    s_cbranch_scc1 L_other
    s_xor_b32 s20, s85, 0
    s_mov_b32 s16, s92
    s_mov_b32 s17, s93
    s_mov_b32 s18, s94
    s_mov_b32 s19, s95
    s_mov_b32 s88, s20
    v_lshrrev_b32 v4, 6, v0
    s_nop 0
    v_readfirstlane_b32 s21, v4
    v_and_b32 v1, 63, v0
    v_lshrrev_b32 v2, 4, v1
    v_and_b32 v3, 15, v1
    v_lshrrev_b32 v6, 2, v3
    v_lshlrev_b32 v117, 4, v1
    s_lshl_b32 s51, s21, 10
    s_lshl_b32 s52, s21, 11
    s_mov_b32 s14, 0x400000
    s_mov_b32 s15, 0x20000
    s_lshl_b32 s41, s20, 8
    s_lshl_b32 s42, s20, 17
    s_lshr_b32 s43, s21, 1
    s_lshl_b32 s43, s43, 2
    v_or_b32 v5, s43, v2
    v_lshlrev_b32 v5, 1, v5
    v_xor_b32 v5, v5, v3
    v_lshrrev_b32 v14, 2, v5
    v_and_b32 v14, 2, v14
    v_lshlrev_b32 v5, 4, v5
    s_lshl_b32 s43, s21, 4
    v_add_u32 v4, s43, v2
    v_lshl_add_u32 v8, v4, 13, v5
    s_waitcnt lgkmcnt(0)
    s_lshr_b32 s27, s60, 8
    s_add_u32 s27, s27, s20
    s_and_b32 s27, s27, 3
    v_mul_u32_u24 v22, 57, v0
    v_lshrrev_b32 v22, 11, v22
    v_mul_u32_u24 v23, 36, v22
    v_sub_u32 v23, v0, v23
    v_and_b32 v25, 3, v23
    v_and_or_b32 v23, v23, 60, 1
    v_min_u32 v23, 31, v23
    v_lshl_add_u32 v23, v23, 2, v25
    v_lshlrev_b32 v31, 6, v23
    s_add_u32 s43, s20, 2
    s_lshr_b32 s43, s43, 2
    s_sub_u32 s43, s20, s43
    s_mul_i32 s43, s43, 7
    v_add_u32 v22, s43, v22
    s_mov_b32 s4, s60
    s_and_b32 s5, s61, 0xffff
    s_lshr_b32 s6, 0x5ddddddd, s20
    s_and_b32 s6, s6, 1
    s_lshl_b32 s6, s6, 22
    s_mov_b32 s7, 0x20000
    v_add_u32 v23, 0, v22
    v_and_b32 v25, 448, v23
    v_add_u32 v23, v23, v25
    v_lshl_add_u32 v23, v23, 13, v31
    s_mov_b32 s43, 0x80000
    buffer_load_dword v30, v23, s[4:7], s43 offen
    s_mov_b32 s4, s60
    s_and_b32 s5, s61, 0xffff
    s_lshr_b32 s6, 0x5ddddddd, s20
    s_and_b32 s6, s6, 1
    s_lshl_b32 s6, s6, 22
    s_mov_b32 s7, 0x20000
    v_add_u32 v23, 161, v22
    v_and_b32 v25, 448, v23
    v_add_u32 v23, v23, v25
    v_lshl_add_u32 v23, v23, 13, v31
    s_mov_b32 s43, 0x80000
    buffer_load_dword v30, v23, s[4:7], s43 offen
    s_mov_b32 s12, s60
    s_and_b32 s13, s61, 0xffff
    v_xor_b32 v15, 0, v14
    v_lshl_add_u32 v15, v15, 15, v8
    s_add_u32 s43, s41, 0x0
    s_add_u32 m0, s51, 0x8000
    s_nop 0
    buffer_load_dwordx4 v15, s[12:15], s43 offen lds
    s_add_u32 s43, s41, 0x8000
    s_add_u32 m0, s51, 0x9000
    s_nop 0
    buffer_load_dwordx4 v15, s[12:15], s43 offen lds
    s_add_u32 s43, s41, 0x100000
    s_add_u32 m0, s51, 0xa000
    s_nop 0
    buffer_load_dwordx4 v15, s[12:15], s43 offen lds
    s_add_u32 s43, s41, 0x108000
    s_add_u32 m0, s51, 0xb000
    s_nop 0
    buffer_load_dwordx4 v15, s[12:15], s43 offen lds
    s_add_u32 s43, s41, 0x200000
    s_add_u32 m0, s51, 0xc000
    s_nop 0
    buffer_load_dwordx4 v15, s[12:15], s43 offen lds
    s_add_u32 s43, s41, 0x208000
    s_add_u32 m0, s51, 0xd000
    s_nop 0
    buffer_load_dwordx4 v15, s[12:15], s43 offen lds
    s_add_u32 s43, s41, 0x300000
    s_add_u32 m0, s51, 0xe000
    s_nop 0
    buffer_load_dwordx4 v15, s[12:15], s43 offen lds
    s_add_u32 s43, s41, 0x308000
    s_add_u32 m0, s51, 0xf000
    s_nop 0
    buffer_load_dwordx4 v15, s[12:15], s43 offen lds
    v_xor_b32 v15, 2, v14
    v_lshl_add_u32 v15, v15, 15, v8
    s_add_u32 s43, s41, 0x0
    s_add_u32 m0, s51, 0x10000
    s_nop 0
    buffer_load_dwordx4 v15, s[12:15], s43 offen lds
    s_add_u32 s43, s41, 0x8000
    s_add_u32 m0, s51, 0x11000
    s_nop 0
    buffer_load_dwordx4 v15, s[12:15], s43 offen lds
    s_add_u32 s43, s41, 0x100000
    s_add_u32 m0, s51, 0x12000
    s_nop 0
    buffer_load_dwordx4 v15, s[12:15], s43 offen lds
    s_add_u32 s43, s41, 0x108000
    s_add_u32 m0, s51, 0x13000
    s_nop 0
    buffer_load_dwordx4 v15, s[12:15], s43 offen lds
    s_add_u32 s43, s41, 0x200000
    s_add_u32 m0, s51, 0x14000
    s_nop 0
    buffer_load_dwordx4 v15, s[12:15], s43 offen lds
    s_add_u32 s43, s41, 0x208000
    s_add_u32 m0, s51, 0x15000
    s_nop 0
    buffer_load_dwordx4 v15, s[12:15], s43 offen lds
    s_add_u32 s43, s41, 0x300000
    s_add_u32 m0, s51, 0x16000
    s_nop 0
    buffer_load_dwordx4 v15, s[12:15], s43 offen lds
    s_add_u32 s43, s41, 0x308000
    s_add_u32 m0, s51, 0x17000
    s_nop 0
    buffer_load_dwordx4 v15, s[12:15], s43 offen lds
    v_xor_b32 v15, 0, v14
    v_lshl_add_u32 v15, v15, 15, v8
    s_add_u32 s43, s41, 0x80000
    s_add_u32 m0, s51, 0x18000
    s_nop 0
    buffer_load_dwordx4 v15, s[12:15], s43 offen lds
    s_add_u32 s43, s41, 0x88000
    s_add_u32 m0, s51, 0x19000
    s_nop 0
    buffer_load_dwordx4 v15, s[12:15], s43 offen lds
    s_add_u32 s43, s41, 0x180000
    s_add_u32 m0, s51, 0x1a000
    s_nop 0
    buffer_load_dwordx4 v15, s[12:15], s43 offen lds
    s_add_u32 s43, s41, 0x188000
    s_add_u32 m0, s51, 0x1b000
    s_nop 0
    buffer_load_dwordx4 v15, s[12:15], s43 offen lds
    v_and_b32 v4, 2, v3
    v_cmp_ne_u32 vcc, 0, v4
    v_mov_b32 v4, 0x4444
    v_mov_b32 v5, 0xeeee
    v_cndmask_b32 v116, v4, v5, vcc
    v_lshrrev_b32 v5, 1, v2
    v_lshl_add_u32 v4, v6, 3, v5
    s_lshl_b32 s43, s21, 1
    v_add_u32 v4, s43, v4
    v_add_u32 v5, s20, v4
    v_and_b32 v5, 31, v5
    v_lshl_add_u32 v4, v4, 6, v5
    v_and_b32 v5, 1, v2
    v_lshl_add_u32 v4, v4, 1, v5
    v_and_b32 v5, 3, v3
    v_lshl_add_u32 v4, v4, 2, v5
    v_lshlrev_b32 v118, 4, v4
    v_and_b32 v4, 1, v2
    v_lshlrev_b32 v4, 2, v4
    v_and_b32 v7, 2, v2
    v_add_u32 v4, v4, v7
    v_and_b32 v7, 1, v6
    v_add_u32 v4, v4, v7
    v_lshl_add_u32 v4, v4, 2, v5
    v_lshlrev_b32 v4, 2, v4
    s_and_b32 s43, s21, 1
    s_lshl_b32 s43, s43, 12
    s_lshl_b32 s40, s20, 7
    s_add_u32 s43, s43, s40
    v_add_u32 v119, s43, v4
    v_sub_u32 v7, 0, v2
    v_and_b32 v7, 3, v7
    v_xor_b32 v7, v7, v6
    v_lshl_add_u32 v4, v2, 4, v7
    v_and_b32 v5, 3, v3
    v_lshl_add_u32 v4, v4, 2, v5
    s_add_u32 s43, s51, 16384
    v_lshl_add_u32 v120, v4, 2, s43
    v_sub_u32 v7, 0, v6
    v_and_b32 v7, 3, v7
    v_xor_b32 v7, v7, v2
    v_lshl_add_u32 v4, v3, 2, v7
    v_lshlrev_b32 v121, 4, v4
    v_and_b32 v5, 1, v3
    v_lshl_add_u32 v4, v6, 1, v5
    v_lshl_add_u32 v4, v2, 3, v4
    v_lshlrev_b32 v127, 4, v4
    v_and_or_b32 v122, v116, 8, v127
    s_lshl_b32 s43, s21, 13
    s_add_u32 s43, s43, 32768
    v_add_u32 v123, s43, v117
    v_add_u32 v124, 0x10000, v123
    s_mov_b32 s36, 0xcccccccc
    s_mov_b32 s37, 0xcccccccc
    s_mov_b32 s38, 0x00ff00ff
    s_mov_b32 s39, 0x00ff00ff
    s_mov_b32 s34, 0x3e0293ee
    s_mov_b32 s35, 0x49800000
    s_mov_b32 s50, 0x3f803f80
    v_and_b32 v5, 1, v2
    v_or_b32 v5, 0, v5
    v_xor_b32 v5, v5, v6
    v_and_b32 v7, 2, v5
    v_add_u32 v5, v5, v7
    v_lshlrev_b32 v5, 6, v5
    v_and_b32 v7, 3, v3
    v_lshl_add_u32 v7, v7, 4, v5
    s_lshl_b32 s43, s21, 2
    v_add_u32 v4, s43, v2
    v_lshl_add_u32 v10, v4, 10, v7
    v_and_b32 v5, 1, v2
    v_or_b32 v5, 2, v5
    v_xor_b32 v5, v5, v6
    v_and_b32 v7, 2, v5
    v_add_u32 v5, v5, v7
    v_lshlrev_b32 v5, 6, v5
    v_and_b32 v7, 3, v3
    v_lshl_add_u32 v7, v7, 4, v5
    s_lshl_b32 s43, s21, 2
    v_add_u32 v4, s43, v2
    v_lshl_add_u32 v9, v4, 10, v7
    v_and_b32 v5, 1, v2
    v_lshl_add_u32 v4, v5, 3, v6
    v_lshrrev_b32 v7, 1, v2
    v_lshl_add_u32 v4, v7, 5, v4
    v_lshlrev_b32 v4, 8, v4
    v_lshl_or_b32 v5, v5, 2, v6
    v_lshlrev_b32 v5, 5, v5
    s_lshl_b32 s43, s21, 6
    v_xor_b32 v5, s43, v5
    v_add_u32 v4, v4, v5
    v_and_b32 v5, 3, v3
    v_lshl_add_u32 v4, v5, 3, v4
    v_add_u32 v11, 32768, v4
    s_and_b32 s43, s21, 1
    s_lshl_b32 s43, s43, 12
    v_add_u32 v11, s43, v11
    v_and_b32 v5, 1, v2
    v_lshlrev_b32 v4, 4, v5
    v_lshl_add_u32 v4, v7, 2, v4
    v_and_b32 v7, 1, v6
    v_add_u32 v4, v4, v7
    s_lshl_b32 s43, s21, 5
    v_add_u32 v4, s43, v4
    v_lshlrev_b32 v4, 8, v4
    v_lshl_or_b32 v5, v5, 1, v7
    s_lshl_b32 s43, s21, 1
    s_and_b32 s43, s43, 3
    v_xor_b32 v5, s43, v5
    v_lshl_add_u32 v4, v5, 6, v4
    v_lshrrev_b32 v5, 1, v6
    v_lshl_add_u32 v4, v5, 5, v4
    v_and_b32 v5, 3, v3
    v_lshl_add_u32 v4, v5, 3, v4
    v_add_u32 v12, 32768, v4
    v_mov_b32 v16, -1
    v_mov_b32 v17, -1
    v_mov_b32 v18, -1
    v_mov_b32 v19, -1
    s_lshl_b32 s43, s20, 13
    s_add_u32 s43, s43, 0x100000
    s_and_b32 s40, s21, 1
    s_lshl_b32 s40, s40, 12
    s_add_u32 s29, s43, s40
    s_add_u32 s43, s43, s52
    s_xor_b32 s40, s43, 0x40000
    buffer_store_dwordx4 v[16:19], v117, s[8:11], s43 offen
    buffer_store_dwordx4 v[16:19], v117, s[8:11], s43 offen offset:1024
    buffer_store_dwordx4 v[16:19], v117, s[8:11], s40 offen
    buffer_store_dwordx4 v[16:19], v117, s[8:11], s40 offen offset:1024
    s_mov_b32 s43, 0x12000
    buffer_store_dword v16, v119, s[8:11], s43 offen
    s_mov_b32 s43, 0x14000
    buffer_store_dword v16, v119, s[8:11], s43 offen
    s_mov_b32 s43, 0x16000
    buffer_store_dword v16, v119, s[8:11], s43 offen
    s_load_dwordx2 s[4:5], s[0:1], 8
    s_waitcnt lgkmcnt(0)
    s_and_b32 s5, s5, 0xffff
    s_mov_b32 s6, 8192
    s_mov_b32 s7, 0x20000
    v_and_b32 v20, 1, v2
    v_and_b32 v21, 1, v6
    v_lshl_add_u32 v20, v20, 1, v21
    v_lshlrev_b32 v20, 9, v20
    v_and_b32 v21, 3, v3
    v_lshl_add_u32 v20, v21, 4, v20
    v_and_b32 v21, 2, v2
    v_add_u32 v20, v20, v21
    s_and_b32 s43, s20, 1
    s_lshl_b32 s43, s43, 11
    s_bfe_u32 s40, s20, 0x20001
    s_lshl_b32 s40, s40, 7
    s_add_u32 s43, s43, s40
    s_and_b32 s40, s21, 1
    s_lshl_b32 s40, s40, 6
    s_add_u32 s43, s43, s40
    s_lshr_b32 s40, s20, 3
    s_lshl_b32 s40, s40, 2
    s_add_u32 s43, s43, s40
    v_add_u32 v20, s43, v20
    v_lshlrev_b32 v20, 1, v20
    buffer_load_dword v21, v20, s[4:7], 0 offen
    s_mov_b32 s57, 0
    s_lshl_b32 s43, s20, 13
    s_add_u32 s43, s43, s52
    s_add_u32 s30, s43, 0x1000000
    s_add_u32 s31, s43, 0x2000000
    s_lshr_b32 s43, s43, 1
    s_add_u32 s32, s43, 0x220000
    s_waitcnt vmcnt(20)
    s_barrier
    v_xor_b32 v13, 0x0, v11
    v_add_u32 v13, 0x0, v13
    ds_read_b64_tr_b16 v[32:33], v13
    ds_read_b64_tr_b16 v[34:35], v13 offset:1024
    ds_read_b64_tr_b16 v[36:37], v13 offset:16384
    ds_read_b64_tr_b16 v[38:39], v13 offset:17408
    v_xor_b32 v13, 0x20, v11
    v_add_u32 v13, 0x0, v13
    ds_read_b64_tr_b16 v[40:41], v13
    ds_read_b64_tr_b16 v[42:43], v13 offset:1024
    ds_read_b64_tr_b16 v[44:45], v13 offset:16384
    ds_read_b64_tr_b16 v[46:47], v13 offset:17408
    v_xor_b32 v13, 0x1000, v11
    v_add_u32 v13, 0x0, v13
    ds_read_b64_tr_b16 a[0:1], v13
    ds_read_b64_tr_b16 a[2:3], v13 offset:1024
    ds_read_b64_tr_b16 a[4:5], v13 offset:16384
    ds_read_b64_tr_b16 a[6:7], v13 offset:17408
    v_xor_b32 v13, 0x1020, v11
    v_add_u32 v13, 0x0, v13
    ds_read_b64_tr_b16 a[8:9], v13
    ds_read_b64_tr_b16 a[10:11], v13 offset:1024
    ds_read_b64_tr_b16 a[12:13], v13 offset:16384
    ds_read_b64_tr_b16 a[14:15], v13 offset:17408
    s_waitcnt lgkmcnt(0)
    s_barrier
    s_mov_b32 s4, s62
    s_and_b32 s5, s63, 0xffff
    s_lshr_b32 s6, 0x5ddddddd, s20
    s_and_b32 s6, s6, 1
    s_lshl_b32 s6, s6, 22
    s_mov_b32 s7, 0x20000
    v_add_u32 v23, 0, v22
    v_and_b32 v25, 448, v23
    v_add_u32 v23, v23, v25
    v_lshl_add_u32 v23, v23, 13, v31
    s_mov_b32 s43, 0x0
    buffer_load_dword v30, v23, s[4:7], s43 offen
    s_add_u32 s43, s41, 0x280000
    s_add_u32 m0, s51, 0x1c000
    s_nop 0
    buffer_load_dwordx4 v15, s[12:15], s43 offen lds
    s_add_u32 s43, s41, 0x288000
    s_add_u32 m0, s51, 0x1d000
    s_nop 0
    buffer_load_dwordx4 v15, s[12:15], s43 offen lds
    s_add_u32 s43, s41, 0x380000
    s_add_u32 m0, s51, 0x1e000
    s_nop 0
    buffer_load_dwordx4 v15, s[12:15], s43 offen lds
    s_add_u32 s43, s41, 0x388000
    s_add_u32 m0, s51, 0x1f000
    s_nop 0
    buffer_load_dwordx4 v15, s[12:15], s43 offen lds
    v_xor_b32 v15, 2, v14
    v_lshl_add_u32 v15, v15, 15, v8
    s_add_u32 s43, s41, 0x80000
    s_add_u32 m0, s51, 0x20000
    s_nop 0
    buffer_load_dwordx4 v15, s[12:15], s43 offen lds
    s_add_u32 s43, s41, 0x88000
    s_add_u32 m0, s51, 0x21000
    s_nop 0
    buffer_load_dwordx4 v15, s[12:15], s43 offen lds
    s_add_u32 s43, s41, 0x180000
    s_add_u32 m0, s51, 0x22000
    s_nop 0
    buffer_load_dwordx4 v15, s[12:15], s43 offen lds
    s_add_u32 s43, s41, 0x188000
    s_add_u32 m0, s51, 0x23000
    s_nop 0
    buffer_load_dwordx4 v15, s[12:15], s43 offen lds
    s_waitcnt vmcnt(21)
    s_barrier
    v_xor_b32 v13, 0x0, v11
    v_add_u32 v13, 0x8000, v13
    ds_read_b64_tr_b16 a[32:33], v13
    ds_read_b64_tr_b16 a[34:35], v13 offset:1024
    ds_read_b64_tr_b16 a[36:37], v13 offset:16384
    ds_read_b64_tr_b16 a[38:39], v13 offset:17408
    v_xor_b32 v13, 0x20, v11
    v_add_u32 v13, 0x8000, v13
    ds_read_b64_tr_b16 a[40:41], v13
    ds_read_b64_tr_b16 a[42:43], v13 offset:1024
    ds_read_b64_tr_b16 a[44:45], v13 offset:16384
    ds_read_b64_tr_b16 a[46:47], v13 offset:17408
    v_xor_b32 v13, 0x1000, v11
    v_add_u32 v13, 0x8000, v13
    ds_read_b64_tr_b16 a[64:65], v13
    ds_read_b64_tr_b16 a[66:67], v13 offset:1024
    ds_read_b64_tr_b16 a[68:69], v13 offset:16384
    ds_read_b64_tr_b16 a[70:71], v13 offset:17408
    v_xor_b32 v13, 0x1020, v11
    v_add_u32 v13, 0x8000, v13
    ds_read_b64_tr_b16 a[72:73], v13
    ds_read_b64_tr_b16 a[74:75], v13 offset:1024
    ds_read_b64_tr_b16 a[76:77], v13 offset:16384
    ds_read_b64_tr_b16 a[78:79], v13 offset:17408
    s_waitcnt lgkmcnt(0)
    s_barrier
    s_add_u32 s43, s41, 0x280000
    s_add_u32 m0, s51, 0x24000
    s_nop 0
    buffer_load_dwordx4 v15, s[12:15], s43 offen lds
    s_add_u32 s43, s41, 0x288000
    s_add_u32 m0, s51, 0x25000
    s_nop 0
    buffer_load_dwordx4 v15, s[12:15], s43 offen lds
    s_add_u32 s43, s41, 0x380000
    s_add_u32 m0, s51, 0x26000
    s_nop 0
    buffer_load_dwordx4 v15, s[12:15], s43 offen lds
    s_add_u32 s43, s41, 0x388000
    s_add_u32 m0, s51, 0x27000
    s_nop 0
    buffer_load_dwordx4 v15, s[12:15], s43 offen lds
    s_mov_b32 s12, s62
    s_and_b32 s13, s63, 0xffff
    v_xor_b32 v15, 0, v14
    v_lshl_add_u32 v15, v15, 15, v8
    s_add_u32 s43, s41, 0x0
    s_add_u32 m0, s51, 0x8000
    s_nop 0
    buffer_load_dwordx4 v15, s[12:15], s43 offen lds
    s_add_u32 s43, s41, 0x8000
    s_add_u32 m0, s51, 0x9000
    s_nop 0
    buffer_load_dwordx4 v15, s[12:15], s43 offen lds
    s_add_u32 s43, s41, 0x100000
    s_add_u32 m0, s51, 0xa000
    s_nop 0
    buffer_load_dwordx4 v15, s[12:15], s43 offen lds
    s_add_u32 s43, s41, 0x108000
    s_add_u32 m0, s51, 0xb000
    s_nop 0
    buffer_load_dwordx4 v15, s[12:15], s43 offen lds
    s_waitcnt vmcnt(12)
    s_barrier
    v_xor_b32 v13, 0x0, v11
    v_add_u32 v13, 0x10000, v13
    ds_read_b64_tr_b16 v[48:49], v13
    ds_read_b64_tr_b16 v[50:51], v13 offset:1024
    ds_read_b64_tr_b16 v[52:53], v13 offset:16384
    ds_read_b64_tr_b16 v[54:55], v13 offset:17408
    v_xor_b32 v13, 0x20, v11
    v_add_u32 v13, 0x10000, v13
    ds_read_b64_tr_b16 v[56:57], v13
    ds_read_b64_tr_b16 v[58:59], v13 offset:1024
    ds_read_b64_tr_b16 v[60:61], v13 offset:16384
    ds_read_b64_tr_b16 v[62:63], v13 offset:17408
    v_xor_b32 v13, 0x1000, v11
    v_add_u32 v13, 0x10000, v13
    ds_read_b64_tr_b16 a[16:17], v13
    ds_read_b64_tr_b16 a[18:19], v13 offset:1024
    ds_read_b64_tr_b16 a[20:21], v13 offset:16384
    ds_read_b64_tr_b16 a[22:23], v13 offset:17408
    v_xor_b32 v13, 0x1020, v11
    v_add_u32 v13, 0x10000, v13
    ds_read_b64_tr_b16 a[24:25], v13
    ds_read_b64_tr_b16 a[26:27], v13 offset:1024
    ds_read_b64_tr_b16 a[28:29], v13 offset:16384
    ds_read_b64_tr_b16 a[30:31], v13 offset:17408
    s_waitcnt lgkmcnt(0)
    s_barrier
    s_add_u32 s43, s41, 0x200000
    s_add_u32 m0, s51, 0xc000
    s_nop 0
    buffer_load_dwordx4 v15, s[12:15], s43 offen lds
    s_add_u32 s43, s41, 0x208000
    s_add_u32 m0, s51, 0xd000
    s_nop 0
    buffer_load_dwordx4 v15, s[12:15], s43 offen lds
    s_add_u32 s43, s41, 0x300000
    s_add_u32 m0, s51, 0xe000
    s_nop 0
    buffer_load_dwordx4 v15, s[12:15], s43 offen lds
    s_add_u32 s43, s41, 0x308000
    s_add_u32 m0, s51, 0xf000
    s_nop 0
    buffer_load_dwordx4 v15, s[12:15], s43 offen lds
    v_xor_b32 v15, 2, v14
    v_lshl_add_u32 v15, v15, 15, v8
    s_add_u32 s43, s41, 0x0
    s_add_u32 m0, s51, 0x10000
    s_nop 0
    buffer_load_dwordx4 v15, s[12:15], s43 offen lds
    s_add_u32 s43, s41, 0x8000
    s_add_u32 m0, s51, 0x11000
    s_nop 0
    buffer_load_dwordx4 v15, s[12:15], s43 offen lds
    s_add_u32 s43, s41, 0x100000
    s_add_u32 m0, s51, 0x12000
    s_nop 0
    buffer_load_dwordx4 v15, s[12:15], s43 offen lds
    s_add_u32 s43, s41, 0x108000
    s_add_u32 m0, s51, 0x13000
    s_nop 0
    buffer_load_dwordx4 v15, s[12:15], s43 offen lds
    s_waitcnt vmcnt(12)
    s_barrier
    v_xor_b32 v13, 0x0, v11
    v_add_u32 v13, 0x18000, v13
    ds_read_b64_tr_b16 a[48:49], v13
    ds_read_b64_tr_b16 a[50:51], v13 offset:1024
    ds_read_b64_tr_b16 a[52:53], v13 offset:16384
    ds_read_b64_tr_b16 a[54:55], v13 offset:17408
    v_xor_b32 v13, 0x20, v11
    v_add_u32 v13, 0x18000, v13
    ds_read_b64_tr_b16 a[56:57], v13
    ds_read_b64_tr_b16 a[58:59], v13 offset:1024
    ds_read_b64_tr_b16 a[60:61], v13 offset:16384
    ds_read_b64_tr_b16 a[62:63], v13 offset:17408
    v_xor_b32 v13, 0x1000, v11
    v_add_u32 v13, 0x18000, v13
    ds_read_b64_tr_b16 a[80:81], v13
    ds_read_b64_tr_b16 a[82:83], v13 offset:1024
    ds_read_b64_tr_b16 a[84:85], v13 offset:16384
    ds_read_b64_tr_b16 a[86:87], v13 offset:17408
    v_xor_b32 v13, 0x1020, v11
    v_add_u32 v13, 0x18000, v13
    ds_read_b64_tr_b16 a[88:89], v13
    ds_read_b64_tr_b16 a[90:91], v13 offset:1024
    ds_read_b64_tr_b16 a[92:93], v13 offset:16384
    ds_read_b64_tr_b16 a[94:95], v13 offset:17408
    s_waitcnt lgkmcnt(0)
    s_barrier
    s_add_u32 s43, s41, 0x200000
    s_add_u32 m0, s51, 0x14000
    s_nop 0
    buffer_load_dwordx4 v15, s[12:15], s43 offen lds
    s_add_u32 s43, s41, 0x208000
    s_add_u32 m0, s51, 0x15000
    s_nop 0
    buffer_load_dwordx4 v15, s[12:15], s43 offen lds
    s_add_u32 s43, s41, 0x300000
    s_add_u32 m0, s51, 0x16000
    s_nop 0
    buffer_load_dwordx4 v15, s[12:15], s43 offen lds
    s_add_u32 s43, s41, 0x308000
    s_add_u32 m0, s51, 0x17000
    s_nop 0
    buffer_load_dwordx4 v15, s[12:15], s43 offen lds
    v_xor_b32 v15, 0, v14
    v_lshl_add_u32 v15, v15, 15, v8
    s_add_u32 s43, s41, 0x80000
    s_add_u32 m0, s51, 0x18000
    s_nop 0
    buffer_load_dwordx4 v15, s[12:15], s43 offen lds
    s_add_u32 s43, s41, 0x88000
    s_add_u32 m0, s51, 0x19000
    s_nop 0
    buffer_load_dwordx4 v15, s[12:15], s43 offen lds
    s_add_u32 s43, s41, 0x180000
    s_add_u32 m0, s51, 0x1a000
    s_nop 0
    buffer_load_dwordx4 v15, s[12:15], s43 offen lds
    s_add_u32 s43, s41, 0x188000
    s_add_u32 m0, s51, 0x1b000
    s_nop 0
    buffer_load_dwordx4 v15, s[12:15], s43 offen lds
    s_waitcnt vmcnt(12)
    v_min_u32 v21, 0xfffffffe, v21
    s_mov_b32 s43, 0x10000
    s_mov_b64 exec, s[38:39]
    buffer_store_dword v21, v119, s[8:11], s43 offen
    s_mov_b64 exec, -1
    s_barrier
    v_xor_b32 v13, 0x0, v11
    v_add_u32 v13, 0x0, v13
    ds_read_b64_tr_b16 v[64:65], v13
    ds_read_b64_tr_b16 v[66:67], v13 offset:1024
    ds_read_b64_tr_b16 v[68:69], v13 offset:16384
    ds_read_b64_tr_b16 v[70:71], v13 offset:17408
    v_xor_b32 v13, 0x20, v11
    v_add_u32 v13, 0x0, v13
    ds_read_b64_tr_b16 v[72:73], v13
    ds_read_b64_tr_b16 v[74:75], v13 offset:1024
    ds_read_b64_tr_b16 v[76:77], v13 offset:16384
    ds_read_b64_tr_b16 v[78:79], v13 offset:17408
    v_xor_b32 v13, 0x1000, v11
    v_add_u32 v13, 0x0, v13
    ds_read_b64_tr_b16 a[96:97], v13
    ds_read_b64_tr_b16 a[98:99], v13 offset:1024
    ds_read_b64_tr_b16 a[100:101], v13 offset:16384
    ds_read_b64_tr_b16 a[102:103], v13 offset:17408
    v_xor_b32 v13, 0x1020, v11
    v_add_u32 v13, 0x0, v13
    ds_read_b64_tr_b16 a[104:105], v13
    ds_read_b64_tr_b16 a[106:107], v13 offset:1024
    ds_read_b64_tr_b16 a[108:109], v13 offset:16384
    ds_read_b64_tr_b16 a[110:111], v13 offset:17408
    s_waitcnt lgkmcnt(0)
    s_barrier
    v_lshlrev_b32 v25, 2, v117
    s_lshl_b32 s43, s21, 12
    s_getpc_b64 s[4:5]
L_pc_1:
    s_add_u32 s4, s4, L_chain_warm-L_pc_1
    s_addc_u32 s5, s5, 0
    v_add_u32 v25, s43, v25
    v_min_u32 v25, L_code_end-L_chain_warm-4, v25
    global_load_dword v29, v25, s[4:5]
    s_add_u32 s43, s41, 0x280000
    s_add_u32 m0, s51, 0x1c000
    s_nop 0
    buffer_load_dwordx4 v15, s[12:15], s43 offen lds
    s_add_u32 s43, s41, 0x288000
    s_add_u32 m0, s51, 0x1d000
    s_nop 0
    buffer_load_dwordx4 v15, s[12:15], s43 offen lds
    s_add_u32 s43, s41, 0x380000
    s_add_u32 m0, s51, 0x1e000
    s_nop 0
    buffer_load_dwordx4 v15, s[12:15], s43 offen lds
    s_add_u32 s43, s41, 0x388000
    s_add_u32 m0, s51, 0x1f000
    s_nop 0
    buffer_load_dwordx4 v15, s[12:15], s43 offen lds
    v_xor_b32 v15, 2, v14
    v_lshl_add_u32 v15, v15, 15, v8
    s_add_u32 s43, s41, 0x80000
    s_add_u32 m0, s51, 0x20000
    s_nop 0
    buffer_load_dwordx4 v15, s[12:15], s43 offen lds
    s_add_u32 s43, s41, 0x88000
    s_add_u32 m0, s51, 0x21000
    s_nop 0
    buffer_load_dwordx4 v15, s[12:15], s43 offen lds
    s_add_u32 s43, s41, 0x180000
    s_add_u32 m0, s51, 0x22000
    s_nop 0
    buffer_load_dwordx4 v15, s[12:15], s43 offen lds
    s_add_u32 s43, s41, 0x188000
    s_add_u32 m0, s51, 0x23000
    s_nop 0
    buffer_load_dwordx4 v15, s[12:15], s43 offen lds
    s_waitcnt vmcnt(13)
    s_barrier
    v_xor_b32 v13, 0x0, v11
    v_add_u32 v13, 0x8000, v13
    ds_read_b64_tr_b16 a[128:129], v13
    ds_read_b64_tr_b16 a[130:131], v13 offset:1024
    ds_read_b64_tr_b16 a[132:133], v13 offset:16384
    ds_read_b64_tr_b16 a[134:135], v13 offset:17408
    v_xor_b32 v13, 0x20, v11
    v_add_u32 v13, 0x8000, v13
    ds_read_b64_tr_b16 a[136:137], v13
    ds_read_b64_tr_b16 a[138:139], v13 offset:1024
    ds_read_b64_tr_b16 a[140:141], v13 offset:16384
    ds_read_b64_tr_b16 a[142:143], v13 offset:17408
    v_xor_b32 v13, 0x1000, v11
    v_add_u32 v13, 0x8000, v13
    ds_read_b64_tr_b16 a[160:161], v13
    ds_read_b64_tr_b16 a[162:163], v13 offset:1024
    ds_read_b64_tr_b16 a[164:165], v13 offset:16384
    ds_read_b64_tr_b16 a[166:167], v13 offset:17408
    v_xor_b32 v13, 0x1020, v11
    v_add_u32 v13, 0x8000, v13
    ds_read_b64_tr_b16 a[168:169], v13
    ds_read_b64_tr_b16 a[170:171], v13 offset:1024
    ds_read_b64_tr_b16 a[172:173], v13 offset:16384
    ds_read_b64_tr_b16 a[174:175], v13 offset:17408
    s_waitcnt lgkmcnt(0)
    s_barrier
    buffer_load_dwordx2 v[26:27], off, s[16:19], 0 offset:36 sc1
    s_add_u32 s43, s41, 0x280000
    s_add_u32 m0, s51, 0x24000
    s_nop 0
    buffer_load_dwordx4 v15, s[12:15], s43 offen lds
    s_add_u32 s43, s41, 0x288000
    s_add_u32 m0, s51, 0x25000
    s_nop 0
    buffer_load_dwordx4 v15, s[12:15], s43 offen lds
    s_add_u32 s43, s41, 0x380000
    s_add_u32 m0, s51, 0x26000
    s_nop 0
    buffer_load_dwordx4 v15, s[12:15], s43 offen lds
    s_add_u32 s43, s41, 0x388000
    s_add_u32 m0, s51, 0x27000
    s_nop 0
    buffer_load_dwordx4 v15, s[12:15], s43 offen lds
    s_mov_b32 s12, s64
    s_and_b32 s13, s65, 0xffff
    v_xor_b32 v15, 0, v14
    v_lshl_add_u32 v15, v15, 15, v8
    s_add_u32 s43, s41, 0x0
    s_add_u32 m0, s51, 0x8000
    s_nop 0
    buffer_load_dwordx4 v15, s[12:15], s43 offen lds
    s_add_u32 s43, s41, 0x8000
    s_add_u32 m0, s51, 0x9000
    s_nop 0
    buffer_load_dwordx4 v15, s[12:15], s43 offen lds
    s_add_u32 s43, s41, 0x100000
    s_add_u32 m0, s51, 0xa000
    s_nop 0
    buffer_load_dwordx4 v15, s[12:15], s43 offen lds
    s_add_u32 s43, s41, 0x108000
    s_add_u32 m0, s51, 0xb000
    s_nop 0
    buffer_load_dwordx4 v15, s[12:15], s43 offen lds
    s_waitcnt vmcnt(13)
    s_barrier
    v_xor_b32 v13, 0x0, v11
    v_add_u32 v13, 0x10000, v13
    ds_read_b64_tr_b16 v[80:81], v13
    ds_read_b64_tr_b16 v[82:83], v13 offset:1024
    ds_read_b64_tr_b16 v[84:85], v13 offset:16384
    ds_read_b64_tr_b16 v[86:87], v13 offset:17408
    v_xor_b32 v13, 0x20, v11
    v_add_u32 v13, 0x10000, v13
    ds_read_b64_tr_b16 v[88:89], v13
    ds_read_b64_tr_b16 v[90:91], v13 offset:1024
    ds_read_b64_tr_b16 v[92:93], v13 offset:16384
    ds_read_b64_tr_b16 v[94:95], v13 offset:17408
    v_xor_b32 v13, 0x1000, v11
    v_add_u32 v13, 0x10000, v13
    ds_read_b64_tr_b16 a[112:113], v13
    ds_read_b64_tr_b16 a[114:115], v13 offset:1024
    ds_read_b64_tr_b16 a[116:117], v13 offset:16384
    ds_read_b64_tr_b16 a[118:119], v13 offset:17408
    v_xor_b32 v13, 0x1020, v11
    v_add_u32 v13, 0x10000, v13
    ds_read_b64_tr_b16 a[120:121], v13
    ds_read_b64_tr_b16 a[122:123], v13 offset:1024
    ds_read_b64_tr_b16 a[124:125], v13 offset:16384
    ds_read_b64_tr_b16 a[126:127], v13 offset:17408
    s_waitcnt lgkmcnt(0)
    s_barrier
    s_add_u32 s43, s41, 0x200000
    s_add_u32 m0, s51, 0xc000
    s_nop 0
    buffer_load_dwordx4 v15, s[12:15], s43 offen lds
    s_add_u32 s43, s41, 0x208000
    s_add_u32 m0, s51, 0xd000
    s_nop 0
    buffer_load_dwordx4 v15, s[12:15], s43 offen lds
    s_add_u32 s43, s41, 0x300000
    s_add_u32 m0, s51, 0xe000
    s_nop 0
    buffer_load_dwordx4 v15, s[12:15], s43 offen lds
    s_add_u32 s43, s41, 0x308000
    s_add_u32 m0, s51, 0xf000
    s_nop 0
    buffer_load_dwordx4 v15, s[12:15], s43 offen lds
    v_xor_b32 v15, 2, v14
    v_lshl_add_u32 v15, v15, 15, v8
    s_add_u32 s43, s41, 0x0
    s_add_u32 m0, s51, 0x10000
    s_nop 0
    buffer_load_dwordx4 v15, s[12:15], s43 offen lds
    s_add_u32 s43, s41, 0x8000
    s_add_u32 m0, s51, 0x11000
    s_nop 0
    buffer_load_dwordx4 v15, s[12:15], s43 offen lds
    s_add_u32 s43, s41, 0x100000
    s_add_u32 m0, s51, 0x12000
    s_nop 0
    buffer_load_dwordx4 v15, s[12:15], s43 offen lds
    s_add_u32 s43, s41, 0x108000
    s_add_u32 m0, s51, 0x13000
    s_nop 0
    buffer_load_dwordx4 v15, s[12:15], s43 offen lds
    s_waitcnt vmcnt(12)
    s_barrier
    v_xor_b32 v13, 0x0, v11
    v_add_u32 v13, 0x18000, v13
    ds_read_b64_tr_b16 a[144:145], v13
    ds_read_b64_tr_b16 a[146:147], v13 offset:1024
    ds_read_b64_tr_b16 a[148:149], v13 offset:16384
    ds_read_b64_tr_b16 a[150:151], v13 offset:17408
    v_xor_b32 v13, 0x20, v11
    v_add_u32 v13, 0x18000, v13
    ds_read_b64_tr_b16 a[152:153], v13
    ds_read_b64_tr_b16 a[154:155], v13 offset:1024
    ds_read_b64_tr_b16 a[156:157], v13 offset:16384
    ds_read_b64_tr_b16 a[158:159], v13 offset:17408
    v_xor_b32 v13, 0x1000, v11
    v_add_u32 v13, 0x18000, v13
    ds_read_b64_tr_b16 a[176:177], v13
    ds_read_b64_tr_b16 a[178:179], v13 offset:1024
    ds_read_b64_tr_b16 a[180:181], v13 offset:16384
    ds_read_b64_tr_b16 a[182:183], v13 offset:17408
    v_xor_b32 v13, 0x1020, v11
    v_add_u32 v13, 0x18000, v13
    ds_read_b64_tr_b16 a[184:185], v13
    ds_read_b64_tr_b16 a[186:187], v13 offset:1024
    ds_read_b64_tr_b16 a[188:189], v13 offset:16384
    ds_read_b64_tr_b16 a[190:191], v13 offset:17408
    s_waitcnt lgkmcnt(0)
    s_barrier
    s_add_u32 s43, s41, 0x200000
    s_add_u32 m0, s51, 0x14000
    s_nop 0
    buffer_load_dwordx4 v15, s[12:15], s43 offen lds
    s_add_u32 s43, s41, 0x208000
    s_add_u32 m0, s51, 0x15000
    s_nop 0
    buffer_load_dwordx4 v15, s[12:15], s43 offen lds
    s_add_u32 s43, s41, 0x300000
    s_add_u32 m0, s51, 0x16000
    s_nop 0
    buffer_load_dwordx4 v15, s[12:15], s43 offen lds
    s_add_u32 s43, s41, 0x308000
    s_add_u32 m0, s51, 0x17000
    s_nop 0
    buffer_load_dwordx4 v15, s[12:15], s43 offen lds
    s_mov_b32 s12, s66
    s_and_b32 s13, s67, 0xffff
    s_add_u32 s43, s42, 0x0
    s_add_u32 m0, s51, 0x18000
    s_nop 0
    buffer_load_dwordx4 v10, s[12:15], s43 offen lds
    s_add_u32 s43, s42, 0x4000
    s_add_u32 m0, s51, 0x19000
    s_nop 0
    buffer_load_dwordx4 v9, s[12:15], s43 offen lds
    s_add_u32 s43, s42, 0x8000
    s_add_u32 m0, s51, 0x1a000
    s_nop 0
    buffer_load_dwordx4 v10, s[12:15], s43 offen lds
    s_add_u32 s43, s42, 0xc000
    s_add_u32 m0, s51, 0x1b000
    s_nop 0
    buffer_load_dwordx4 v9, s[12:15], s43 offen lds
    s_waitcnt vmcnt(12)
    s_barrier
    v_xor_b32 v13, 0x0, v11
    v_add_u32 v13, 0x0, v13
    ds_read_b64_tr_b16 a[192:193], v13
    ds_read_b64_tr_b16 a[194:195], v13 offset:1024
    ds_read_b64_tr_b16 a[196:197], v13 offset:16384
    ds_read_b64_tr_b16 a[198:199], v13 offset:17408
    v_xor_b32 v13, 0x20, v11
    v_add_u32 v13, 0x0, v13
    ds_read_b64_tr_b16 a[200:201], v13
    ds_read_b64_tr_b16 a[202:203], v13 offset:1024
    ds_read_b64_tr_b16 a[204:205], v13 offset:16384
    ds_read_b64_tr_b16 a[206:207], v13 offset:17408
    v_xor_b32 v13, 0x1000, v11
    v_add_u32 v13, 0x0, v13
    ds_read_b64_tr_b16 a[224:225], v13
    ds_read_b64_tr_b16 a[226:227], v13 offset:1024
    ds_read_b64_tr_b16 a[228:229], v13 offset:16384
    ds_read_b64_tr_b16 a[230:231], v13 offset:17408
    v_xor_b32 v13, 0x1020, v11
    v_add_u32 v13, 0x0, v13
    ds_read_b64_tr_b16 a[232:233], v13
    ds_read_b64_tr_b16 a[234:235], v13 offset:1024
    ds_read_b64_tr_b16 a[236:237], v13 offset:16384
    ds_read_b64_tr_b16 a[238:239], v13 offset:17408
    s_waitcnt lgkmcnt(0)
    s_barrier
    s_add_u32 s43, s42, 0x10200
    s_add_u32 m0, s51, 0x1c000
    s_nop 0
    buffer_load_dwordx4 v10, s[12:15], s43 offen lds
    s_add_u32 s43, s42, 0x14200
    s_add_u32 m0, s51, 0x1d000
    s_nop 0
    buffer_load_dwordx4 v9, s[12:15], s43 offen lds
    s_add_u32 s43, s42, 0x18200
    s_add_u32 m0, s51, 0x1e000
    s_nop 0
    buffer_load_dwordx4 v10, s[12:15], s43 offen lds
    s_add_u32 s43, s42, 0x1c200
    s_add_u32 m0, s51, 0x1f000
    s_nop 0
    buffer_load_dwordx4 v9, s[12:15], s43 offen lds
    s_add_u32 s43, s42, 0x10000
    s_add_u32 m0, s51, 0x20000
    s_nop 0
    buffer_load_dwordx4 v10, s[12:15], s43 offen lds
    s_add_u32 s43, s42, 0x14000
    s_add_u32 m0, s51, 0x21000
    s_nop 0
    buffer_load_dwordx4 v9, s[12:15], s43 offen lds
    s_add_u32 s43, s42, 0x18000
    s_add_u32 m0, s51, 0x22000
    s_nop 0
    buffer_load_dwordx4 v10, s[12:15], s43 offen lds
    s_add_u32 s43, s42, 0x1c000
    s_add_u32 m0, s51, 0x23000
    s_nop 0
    buffer_load_dwordx4 v9, s[12:15], s43 offen lds
    s_waitcnt vmcnt(12)
    v_readfirstlane_b32 s57, v26
    v_readfirstlane_b32 s43, v27
    s_nop 0
    s_cmp_lg_u32 s43, 0
    s_cselect_b32 s57, s57, 0
    s_barrier
    s_cmp_lg_u32 s21, 0
    s_cbranch_scc1 L_arr_2
    v_mov_b32 v23, 1
    s_mov_b64 exec, 1
    buffer_atomic_add v23, off, s[16:19], 0 offset:4
    s_mov_b64 exec, -1
L_arr_2:
    v_xor_b32 v13, 0x0, v11
    v_add_u32 v13, 0x8000, v13
    ds_read_b64_tr_b16 v[128:129], v13
    ds_read_b64_tr_b16 v[130:131], v13 offset:1024
    ds_read_b64_tr_b16 v[132:133], v13 offset:16384
    ds_read_b64_tr_b16 v[134:135], v13 offset:17408
    v_xor_b32 v13, 0x20, v11
    v_add_u32 v13, 0x8000, v13
    ds_read_b64_tr_b16 v[136:137], v13
    ds_read_b64_tr_b16 v[138:139], v13 offset:1024
    ds_read_b64_tr_b16 v[140:141], v13 offset:16384
    ds_read_b64_tr_b16 v[142:143], v13 offset:17408
    v_xor_b32 v13, 0x1000, v11
    v_add_u32 v13, 0x8000, v13
    ds_read_b64_tr_b16 v[160:161], v13
    ds_read_b64_tr_b16 v[162:163], v13 offset:1024
    ds_read_b64_tr_b16 v[164:165], v13 offset:16384
    ds_read_b64_tr_b16 v[166:167], v13 offset:17408
    v_xor_b32 v13, 0x1020, v11
    v_add_u32 v13, 0x8000, v13
    ds_read_b64_tr_b16 v[168:169], v13
    ds_read_b64_tr_b16 v[170:171], v13 offset:1024
    ds_read_b64_tr_b16 v[172:173], v13 offset:16384
    ds_read_b64_tr_b16 v[174:175], v13 offset:17408
    s_waitcnt lgkmcnt(0)
    s_barrier
    s_add_u32 s43, s42, 0x200
    s_add_u32 m0, s51, 0x24000
    s_nop 0
    buffer_load_dwordx4 v10, s[12:15], s43 offen lds
    s_add_u32 s43, s42, 0x4200
    s_add_u32 m0, s51, 0x25000
    s_nop 0
    buffer_load_dwordx4 v9, s[12:15], s43 offen lds
    s_add_u32 s43, s42, 0x8200
    s_add_u32 m0, s51, 0x26000
    s_nop 0
    buffer_load_dwordx4 v10, s[12:15], s43 offen lds
    s_add_u32 s43, s42, 0xc200
    s_add_u32 m0, s51, 0x27000
    s_nop 0
    buffer_load_dwordx4 v9, s[12:15], s43 offen lds
    s_mov_b32 s12, s64
    s_and_b32 s13, s65, 0xffff
    v_xor_b32 v15, 0, v14
    v_lshl_add_u32 v15, v15, 15, v8
    s_add_u32 s43, s41, 0x80000
    s_add_u32 m0, s51, 0x8000
    s_nop 0
    buffer_load_dwordx4 v15, s[12:15], s43 offen lds
    s_add_u32 s43, s41, 0x88000
    s_add_u32 m0, s51, 0x9000
    s_nop 0
    buffer_load_dwordx4 v15, s[12:15], s43 offen lds
    s_add_u32 s43, s41, 0x180000
    s_add_u32 m0, s51, 0xa000
    s_nop 0
    buffer_load_dwordx4 v15, s[12:15], s43 offen lds
    s_add_u32 s43, s41, 0x188000
    s_add_u32 m0, s51, 0xb000
    s_nop 0
    buffer_load_dwordx4 v15, s[12:15], s43 offen lds
    s_waitcnt vmcnt(12)
    s_barrier
    v_xor_b32 v13, 0x0, v12
    v_add_u32 v13, 0x10000, v13
    ds_read_b64_tr_b16 v[192:193], v13
    ds_read_b64_tr_b16 v[194:195], v13 offset:512
    ds_read_b64_tr_b16 v[196:197], v13 offset:2048
    ds_read_b64_tr_b16 v[198:199], v13 offset:2560
    v_xor_b32 v13, 0x2000, v12
    v_add_u32 v13, 0x10000, v13
    ds_read_b64_tr_b16 v[200:201], v13
    ds_read_b64_tr_b16 v[202:203], v13 offset:512
    ds_read_b64_tr_b16 v[204:205], v13 offset:2048
    ds_read_b64_tr_b16 v[206:207], v13 offset:2560
    v_xor_b32 v13, 0x40, v12
    v_add_u32 v13, 0x10000, v13
    ds_read_b64_tr_b16 v[224:225], v13
    ds_read_b64_tr_b16 v[226:227], v13 offset:512
    ds_read_b64_tr_b16 v[228:229], v13 offset:2048
    ds_read_b64_tr_b16 v[230:231], v13 offset:2560
    v_xor_b32 v13, 0x2040, v12
    v_add_u32 v13, 0x10000, v13
    ds_read_b64_tr_b16 v[232:233], v13
    ds_read_b64_tr_b16 v[234:235], v13 offset:512
    ds_read_b64_tr_b16 v[236:237], v13 offset:2048
    ds_read_b64_tr_b16 v[238:239], v13 offset:2560
    s_waitcnt lgkmcnt(0)
    s_barrier
    s_add_u32 s43, s41, 0x280000
    s_add_u32 m0, s51, 0xc000
    s_nop 0
    buffer_load_dwordx4 v15, s[12:15], s43 offen lds
    s_add_u32 s43, s41, 0x288000
    s_add_u32 m0, s51, 0xd000
    s_nop 0
    buffer_load_dwordx4 v15, s[12:15], s43 offen lds
    s_add_u32 s43, s41, 0x380000
    s_add_u32 m0, s51, 0xe000
    s_nop 0
    buffer_load_dwordx4 v15, s[12:15], s43 offen lds
    s_add_u32 s43, s41, 0x388000
    s_add_u32 m0, s51, 0xf000
    s_nop 0
    buffer_load_dwordx4 v15, s[12:15], s43 offen lds
    v_xor_b32 v15, 2, v14
    v_lshl_add_u32 v15, v15, 15, v8
    s_add_u32 s43, s41, 0x80000
    s_add_u32 m0, s51, 0x10000
    s_nop 0
    buffer_load_dwordx4 v15, s[12:15], s43 offen lds
    s_add_u32 s43, s41, 0x88000
    s_add_u32 m0, s51, 0x11000
    s_nop 0
    buffer_load_dwordx4 v15, s[12:15], s43 offen lds
    s_add_u32 s43, s41, 0x180000
    s_add_u32 m0, s51, 0x12000
    s_nop 0
    buffer_load_dwordx4 v15, s[12:15], s43 offen lds
    s_add_u32 s43, s41, 0x188000
    s_add_u32 m0, s51, 0x13000
    s_nop 0
    buffer_load_dwordx4 v15, s[12:15], s43 offen lds
    s_waitcnt vmcnt(12)
    s_barrier
    v_xor_b32 v13, 0x0, v12
    v_add_u32 v13, 0x18000, v13
    ds_read_b64_tr_b16 v[208:209], v13
    ds_read_b64_tr_b16 v[210:211], v13 offset:512
    ds_read_b64_tr_b16 v[212:213], v13 offset:2048
    ds_read_b64_tr_b16 v[214:215], v13 offset:2560
    v_xor_b32 v13, 0x2000, v12
    v_add_u32 v13, 0x18000, v13
    ds_read_b64_tr_b16 v[216:217], v13
    ds_read_b64_tr_b16 v[218:219], v13 offset:512
    ds_read_b64_tr_b16 v[220:221], v13 offset:2048
    ds_read_b64_tr_b16 v[222:223], v13 offset:2560
    v_xor_b32 v13, 0x40, v12
    v_add_u32 v13, 0x18000, v13
    ds_read_b64_tr_b16 v[240:241], v13
    ds_read_b64_tr_b16 v[242:243], v13 offset:512
    ds_read_b64_tr_b16 v[244:245], v13 offset:2048
    ds_read_b64_tr_b16 v[246:247], v13 offset:2560
    v_xor_b32 v13, 0x2040, v12
    v_add_u32 v13, 0x18000, v13
    ds_read_b64_tr_b16 v[248:249], v13
    ds_read_b64_tr_b16 v[250:251], v13 offset:512
    ds_read_b64_tr_b16 v[252:253], v13 offset:2048
    ds_read_b64_tr_b16 v[254:255], v13 offset:2560
    s_waitcnt lgkmcnt(0)
    s_barrier
    s_lshl_b32 s43, s20, 13
    s_add_u32 s43, s43, 0x100000
    s_add_u32 s43, s43, s52
    s_xor_b32 s40, s43, 0x40000
    buffer_load_dwordx4 v[28:31], v117, s[8:11], s43 offen sc1
    buffer_load_dwordx4 v[28:31], v117, s[8:11], s43 offen offset:1024 sc1
    buffer_load_dwordx4 v[28:31], v117, s[8:11], s40 offen sc1
    buffer_load_dwordx4 v[28:31], v117, s[8:11], s40 offen offset:1024 sc1
    s_mov_b32 s43, 0x10000
    buffer_load_dword v28, v119, s[8:11], s43 offen sc1
    s_mov_b32 s43, 0x12000
    buffer_load_dword v28, v119, s[8:11], s43 offen sc1
    s_mov_b32 s43, 0x14000
    buffer_load_dword v28, v119, s[8:11], s43 offen sc1
    s_mov_b32 s43, 0x16000
    buffer_load_dword v28, v119, s[8:11], s43 offen sc1
    s_add_u32 s43, s41, 0x280000
    s_add_u32 m0, s51, 0x14000
    s_nop 0
    buffer_load_dwordx4 v15, s[12:15], s43 offen lds
    s_add_u32 s43, s41, 0x288000
    s_add_u32 m0, s51, 0x15000
    s_nop 0
    buffer_load_dwordx4 v15, s[12:15], s43 offen lds
    s_add_u32 s43, s41, 0x380000
    s_add_u32 m0, s51, 0x16000
    s_nop 0
    buffer_load_dwordx4 v15, s[12:15], s43 offen lds
    s_add_u32 s43, s41, 0x388000
    s_add_u32 m0, s51, 0x17000
    s_nop 0
    buffer_load_dwordx4 v15, s[12:15], s43 offen lds
    s_mov_b32 s12, s66
    s_and_b32 s13, s67, 0xffff
    s_add_u32 s43, s42, 0x80
    s_add_u32 m0, s51, 0x18000
    s_nop 0
    buffer_load_dwordx4 v10, s[12:15], s43 offen lds
    s_add_u32 s43, s42, 0x4080
    s_add_u32 m0, s51, 0x19000
    s_nop 0
    buffer_load_dwordx4 v9, s[12:15], s43 offen lds
    s_add_u32 s43, s42, 0x8080
    s_add_u32 m0, s51, 0x1a000
    s_nop 0
    buffer_load_dwordx4 v10, s[12:15], s43 offen lds
    s_add_u32 s43, s42, 0xc080
    s_add_u32 m0, s51, 0x1b000
    s_nop 0
    buffer_load_dwordx4 v9, s[12:15], s43 offen lds
    s_waitcnt vmcnt(20)
    s_barrier
    v_xor_b32 v13, 0x0, v11
    v_add_u32 v13, 0x0, v13
    ds_read_b64_tr_b16 a[208:209], v13
    ds_read_b64_tr_b16 a[210:211], v13 offset:1024
    ds_read_b64_tr_b16 a[212:213], v13 offset:16384
    ds_read_b64_tr_b16 a[214:215], v13 offset:17408
    v_xor_b32 v13, 0x20, v11
    v_add_u32 v13, 0x0, v13
    ds_read_b64_tr_b16 a[216:217], v13
    ds_read_b64_tr_b16 a[218:219], v13 offset:1024
    ds_read_b64_tr_b16 a[220:221], v13 offset:16384
    ds_read_b64_tr_b16 a[222:223], v13 offset:17408
    v_xor_b32 v13, 0x1000, v11
    v_add_u32 v13, 0x0, v13
    ds_read_b64_tr_b16 a[240:241], v13
    ds_read_b64_tr_b16 a[242:243], v13 offset:1024
    ds_read_b64_tr_b16 a[244:245], v13 offset:16384
    ds_read_b64_tr_b16 a[246:247], v13 offset:17408
    v_xor_b32 v13, 0x1020, v11
    v_add_u32 v13, 0x0, v13
    ds_read_b64_tr_b16 a[248:249], v13
    ds_read_b64_tr_b16 a[250:251], v13 offset:1024
    ds_read_b64_tr_b16 a[252:253], v13 offset:16384
    ds_read_b64_tr_b16 a[254:255], v13 offset:17408
    s_waitcnt lgkmcnt(0)
    s_barrier
L_chain_warm:
    s_add_u32 s43, s42, 0x10280
    s_add_u32 m0, s51, 0x1c000
    s_nop 0
    buffer_load_dwordx4 v10, s[12:15], s43 offen lds
    s_add_u32 s43, s42, 0x14280
    s_add_u32 m0, s51, 0x1d000
    s_nop 0
    buffer_load_dwordx4 v9, s[12:15], s43 offen lds
    s_add_u32 s43, s42, 0x18280
    s_add_u32 m0, s51, 0x1e000
    s_nop 0
    buffer_load_dwordx4 v10, s[12:15], s43 offen lds
    s_add_u32 s43, s42, 0x1c280
    s_add_u32 m0, s51, 0x1f000
    s_nop 0
    buffer_load_dwordx4 v9, s[12:15], s43 offen lds
    s_add_u32 s43, s42, 0x10080
    s_add_u32 m0, s51, 0x20000
    s_nop 0
    buffer_load_dwordx4 v10, s[12:15], s43 offen lds
    s_add_u32 s43, s42, 0x14080
    s_add_u32 m0, s51, 0x21000
    s_nop 0
    buffer_load_dwordx4 v9, s[12:15], s43 offen lds
    s_add_u32 s43, s42, 0x18080
    s_add_u32 m0, s51, 0x22000
    s_nop 0
    buffer_load_dwordx4 v10, s[12:15], s43 offen lds
    s_add_u32 s43, s42, 0x1c080
    s_add_u32 m0, s51, 0x23000
    s_nop 0
    buffer_load_dwordx4 v9, s[12:15], s43 offen lds
    ds_write_b128 v123, v[32:35]
    ds_write_b128 v123, v[36:39] offset:1024
    ds_write_b128 v123, v[40:43] offset:2048
    ds_write_b128 v123, v[44:47] offset:3072
    ds_write_b128 v123, v[48:51] offset:4096
    ds_write_b128 v123, v[52:55] offset:5120
    ds_write_b128 v123, v[56:59] offset:6144
    ds_write_b128 v123, v[60:63] offset:7168
    s_waitcnt vmcnt(12)
    s_barrier
    v_xor_b32 v13, 0x0, v11
    v_add_u32 v13, 0x8000, v13
    ds_read_b64_tr_b16 v[144:145], v13
    ds_read_b64_tr_b16 v[146:147], v13 offset:1024
    ds_read_b64_tr_b16 v[148:149], v13 offset:16384
    ds_read_b64_tr_b16 v[150:151], v13 offset:17408
    v_xor_b32 v13, 0x20, v11
    v_add_u32 v13, 0x8000, v13
    ds_read_b64_tr_b16 v[152:153], v13
    ds_read_b64_tr_b16 v[154:155], v13 offset:1024
    ds_read_b64_tr_b16 v[156:157], v13 offset:16384
    ds_read_b64_tr_b16 v[158:159], v13 offset:17408
    v_xor_b32 v13, 0x1000, v11
    v_add_u32 v13, 0x8000, v13
    ds_read_b64_tr_b16 v[176:177], v13
    ds_read_b64_tr_b16 v[178:179], v13 offset:1024
    ds_read_b64_tr_b16 v[180:181], v13 offset:16384
    ds_read_b64_tr_b16 v[182:183], v13 offset:17408
    v_xor_b32 v13, 0x1020, v11
    v_add_u32 v13, 0x8000, v13
    ds_read_b64_tr_b16 v[184:185], v13
    ds_read_b64_tr_b16 v[186:187], v13 offset:1024
    ds_read_b64_tr_b16 v[188:189], v13 offset:16384
    ds_read_b64_tr_b16 v[190:191], v13 offset:17408
    s_waitcnt lgkmcnt(0)
    s_barrier
    s_add_u32 s43, s42, 0x280
    s_add_u32 m0, s51, 0x24000
    s_nop 0
    buffer_load_dwordx4 v10, s[12:15], s43 offen lds
    s_add_u32 s43, s42, 0x4280
    s_add_u32 m0, s51, 0x25000
    s_nop 0
    buffer_load_dwordx4 v9, s[12:15], s43 offen lds
    s_add_u32 s43, s42, 0x8280
    s_add_u32 m0, s51, 0x26000
    s_nop 0
    buffer_load_dwordx4 v10, s[12:15], s43 offen lds
    s_add_u32 s43, s42, 0xc280
    s_add_u32 m0, s51, 0x27000
    s_nop 0
    buffer_load_dwordx4 v9, s[12:15], s43 offen lds
    v_lshlrev_b32 v26, 3, v117
    v_and_b32 v26, 2048, v26
    s_lshl_b32 s43, s20, 6
    s_add_u32 s43, s43, 0x2000
    buffer_load_dword v26, v26, s[8:11], s43 offen sc1
    buffer_load_dword v27, off, s[16:19], 0 offset:4 sc1
    ds_write_b128 v123, v[64:67] offset:32768
    ds_write_b128 v123, v[68:71] offset:33792
    ds_write_b128 v123, v[72:75] offset:34816
    ds_write_b128 v123, v[76:79] offset:35840
    ds_write_b128 v123, v[80:83] offset:36864
    ds_write_b128 v123, v[84:87] offset:37888
    ds_write_b128 v123, v[88:91] offset:38912
    ds_write_b128 v123, v[92:95] offset:39936
    s_waitcnt vmcnt(0)
    v_readlane_b32 s43, v26, 0
    v_readlane_b32 s40, v26, 16
    s_nop 0
    s_min_u32 s43, s43, s40
    s_cmp_lg_u32 s43, 0
    s_cselect_b32 s57, s57, 0
    v_readfirstlane_b32 s43, v27
    s_nop 0
    s_cmp_ge_u32 s43, 32
    s_cselect_b32 s57, s57, 0
    s_cmp_lg_u32 s57, 1
    s_cbranch_scc1 L_nokv_3
    s_add_u32 m0, s52, 8192
    s_nop 0
    buffer_load_dwordx4 v117, s[8:11], s30 offen lds
    buffer_load_dwordx4 v117, s[8:11], s30 offen offset:1024 lds
    s_add_u32 m0, s52, 0x6000
    s_nop 0
    buffer_load_dwordx4 v117, s[8:11], s31 offen lds
    buffer_load_dwordx4 v117, s[8:11], s31 offen offset:1024 lds
L_nokv_3:
    v_min_u32 v21, 0xfffffffe, v21
    s_mov_b32 s43, 0x10000
    s_mov_b64 exec, s[38:39]
    buffer_store_dword v21, v119, s[8:11], s43 offen
    s_mov_b64 exec, -1
    v_mov_b32 v16, -1
    v_mov_b32 v17, -1
    v_mov_b32 v18, -1
    v_mov_b32 v19, -1
    s_lshl_b32 s43, s20, 13
    s_add_u32 s43, s43, 0x100000
    s_and_b32 s40, s21, 1
    s_lshl_b32 s40, s40, 12
    s_add_u32 s29, s43, s40
    s_add_u32 s43, s43, s52
    s_xor_b32 s40, s43, 0x40000
    buffer_store_dwordx4 v[16:19], v117, s[8:11], s40 offen
    buffer_store_dwordx4 v[16:19], v117, s[8:11], s40 offen offset:1024
    s_mov_b32 s43, 0x12000
    buffer_store_dword v16, v119, s[8:11], s43 offen
    s_mov_b32 s43, 0x14000
    buffer_store_dword v16, v119, s[8:11], s43 offen
    s_mov_b32 s43, 0x16000
    buffer_store_dword v16, v119, s[8:11], s43 offen
    s_barrier
    v_xor_b32 v13, 0x0, v12
    v_add_u32 v13, 0x10000, v13
    ds_read_b64_tr_b16 v[32:33], v13
    ds_read_b64_tr_b16 v[34:35], v13 offset:512
    ds_read_b64_tr_b16 v[36:37], v13 offset:2048
    ds_read_b64_tr_b16 v[38:39], v13 offset:2560
    v_xor_b32 v13, 0x2000, v12
    v_add_u32 v13, 0x10000, v13
    ds_read_b64_tr_b16 v[40:41], v13
    ds_read_b64_tr_b16 v[42:43], v13 offset:512
    ds_read_b64_tr_b16 v[44:45], v13 offset:2048
    ds_read_b64_tr_b16 v[46:47], v13 offset:2560
    v_xor_b32 v13, 0x40, v12
    v_add_u32 v13, 0x10000, v13
    ds_read_b64_tr_b16 v[64:65], v13
    ds_read_b64_tr_b16 v[66:67], v13 offset:512
    ds_read_b64_tr_b16 v[68:69], v13 offset:2048
    ds_read_b64_tr_b16 v[70:71], v13 offset:2560
    v_xor_b32 v13, 0x2040, v12
    v_add_u32 v13, 0x10000, v13
    ds_read_b64_tr_b16 v[72:73], v13
    ds_read_b64_tr_b16 v[74:75], v13 offset:512
    ds_read_b64_tr_b16 v[76:77], v13 offset:2048
    ds_read_b64_tr_b16 v[78:79], v13 offset:2560
    v_xor_b32 v13, 0x0, v12
    v_add_u32 v13, 0x18000, v13
    ds_read_b64_tr_b16 v[48:49], v13
    ds_read_b64_tr_b16 v[50:51], v13 offset:512
    ds_read_b64_tr_b16 v[52:53], v13 offset:2048
    ds_read_b64_tr_b16 v[54:55], v13 offset:2560
    v_xor_b32 v13, 0x2000, v12
    v_add_u32 v13, 0x18000, v13
    ds_read_b64_tr_b16 v[56:57], v13
    ds_read_b64_tr_b16 v[58:59], v13 offset:512
    ds_read_b64_tr_b16 v[60:61], v13 offset:2048
    ds_read_b64_tr_b16 v[62:63], v13 offset:2560
    v_xor_b32 v13, 0x40, v12
    v_add_u32 v13, 0x18000, v13
    ds_read_b64_tr_b16 v[80:81], v13
    ds_read_b64_tr_b16 v[82:83], v13 offset:512
    ds_read_b64_tr_b16 v[84:85], v13 offset:2048
    ds_read_b64_tr_b16 v[86:87], v13 offset:2560
    v_xor_b32 v13, 0x2040, v12
    v_add_u32 v13, 0x18000, v13
    ds_read_b64_tr_b16 v[88:89], v13
    ds_read_b64_tr_b16 v[90:91], v13 offset:512
    ds_read_b64_tr_b16 v[92:93], v13 offset:2048
    ds_read_b64_tr_b16 v[94:95], v13 offset:2560
    s_waitcnt lgkmcnt(0)
    s_barrier
    ds_write_b128 v124, v[32:35]
    ds_write_b128 v124, v[36:39] offset:1024
    ds_write_b128 v124, v[40:43] offset:2048
    ds_write_b128 v124, v[44:47] offset:3072
    ds_write_b128 v124, v[48:51] offset:4096
    ds_write_b128 v124, v[52:55] offset:5120
    ds_write_b128 v124, v[56:59] offset:6144
    ds_write_b128 v124, v[60:63] offset:7168
    ds_write_b128 v124, v[64:67] offset:32768
    ds_write_b128 v124, v[68:71] offset:33792
    ds_write_b128 v124, v[72:75] offset:34816
    ds_write_b128 v124, v[76:79] offset:35840
    ds_write_b128 v124, v[80:83] offset:36864
    ds_write_b128 v124, v[84:87] offset:37888
    ds_write_b128 v124, v[88:91] offset:38912
    ds_write_b128 v124, v[92:95] offset:39936
    s_waitcnt lgkmcnt(0)
    s_cmp_eq_u32 s57, 1
    s_cbranch_scc1 L_started_4
    s_mov_b32 s96, 0
L_mode_5:
    buffer_load_dwordx2 v[2:3], off, s[92:95], 0 offset:36 sc1
    s_waitcnt vmcnt(0)
    v_readfirstlane_b32 s87, v2
    v_readfirstlane_b32 s97, v3
    s_nop 0
    s_min_u32 s97, s97, s87
    s_cmp_lg_u32 s97, 0
    s_cbranch_scc1 L_moded_6
    s_sleep 4
    s_add_u32 s96, s96, 1
    s_cmp_lg_u32 s96, 0x100
    s_cbranch_scc1 L_modef_7
    v_mov_b32 v2, 2
    v_mov_b32 v3, 0
    s_mov_b64 exec, 1
    buffer_atomic_cmpswap v[2:3], off, s[92:95], 0 offset:36
    s_mov_b64 exec, -1
L_modef_7:
    s_cmp_lt_u32 s96, 0x10000
    s_cbranch_scc1 L_mode_5
L_moded_6:
    s_cmp_lg_u32 s87, 1
    s_cbranch_scc1 L_fallback
    v_lshrrev_b32 v1, 4, v117
    v_and_b32 v2, 15, v1
    v_lshrrev_b32 v1, 4, v1
    v_lshlrev_b32 v1, 11, v1
    v_lshl_add_u32 v1, v2, 2, v1
    s_lshl_b32 s43, s20, 6
    s_add_u32 s43, s43, 0x2000
    s_mov_b32 exec_lo, 0x10001
    s_mov_b32 exec_hi, 0
    s_mov_b32 s96, 0
L_poll_8:
    buffer_load_dword v2, v1, s[8:11], s43 offen sc1
    s_waitcnt vmcnt(0)
    v_cmp_gt_u32 vcc, 1, v2
    s_cbranch_vccz L_polld_9
    s_sleep 8
    s_add_u32 s96, s96, 1
    s_cmp_lt_u32 s96, 0x10000
    s_cbranch_scc1 L_poll_8
L_polld_9:
    s_mov_b64 exec, -1
    s_add_u32 m0, s52, 8192
    s_nop 0
    buffer_load_dwordx4 v117, s[8:11], s30 offen lds
    buffer_load_dwordx4 v117, s[8:11], s30 offen offset:1024 lds
    s_add_u32 m0, s52, 0x6000
    s_nop 0
    buffer_load_dwordx4 v117, s[8:11], s31 offen lds
    buffer_load_dwordx4 v117, s[8:11], s31 offen offset:1024 lds
    s_mov_b32 s49, 0
L_cb_poll_11:
    buffer_load_dword v3, off, s[16:19], 0 offset:4 sc1
    s_waitcnt vmcnt(0)
    v_readfirstlane_b32 s43, v3
    s_nop 0
    s_cmp_ge_u32 s43, 32
    s_cbranch_scc1 L_started_4
    s_sleep 8
    s_add_u32 s49, s49, 1
    s_cmp_lt_u32 s49, 0x40000
    s_cbranch_scc1 L_cb_poll_11
L_started_4:
    s_lshr_b32 s43, s20, 1
    s_lshl_b32 s43, s43, 7
    s_and_b32 s40, s20, 1
    s_lshl_b32 s40, s40, 4
    s_add_u32 s43, s43, s40
    s_add_u32 s44, s43, 0x1000
    s_cmp_eq_u32 s21, 0
    s_cselect_b32 s44, s44, 0x7ff00000
    s_mov_b32 s22, 0
    s_mov_b32 s33, 0
    s_xor_b32 s53, s29, 1024
    s_add_u32 s23, s51, 0x10000
    s_add_u32 s48, s23, 4096
    s_mov_b32 s24, 0x12000
    s_add_u32 s55, s24, 16384
    s_mov_b32 s25, 0x100000
    s_mov_b32 s26, 0x101000
    v_mov_b32 v112, 0
    v_mov_b32 v113, 0
    v_mov_b32 v114, 0
    v_mov_b32 v115, 0
    s_add_u32 m0, s51, 4096
    ds_write_b128 v117, v[112:115] offset:22528
    ds_write_b128 v117, v[112:115] offset:23552
    s_cmp_lg_u32 s21, 0
    s_cselect_b32 s40, -1, 0
    v_mov_b32 v126, s40
    v_bfe_u32 v1, v117, 4, 1
    v_lshlrev_b32 v1, 4, v1
    s_movk_i32 s43, 0x3f80
    v_lshlrev_b32 v125, v1, s43
    v_bfe_u32 v1, v117, 5, 3
    v_cmp_eq_u32 s[68:69], 0, v1
    v_cmp_eq_u32 s[70:71], 1, v1
    v_cmp_eq_u32 s[72:73], 2, v1
    v_cmp_eq_u32 s[74:75], 3, v1
    v_lshrrev_b32 v1, 2, v117
    s_cmp_lt_u32 s21, 2
    s_cselect_b64 vcc, -1, 0
    v_cndmask_b32 v119, v119, v1, vcc
    v_mov_b32 v32, 0
    v_mov_b32 v33, 0
    v_mov_b32 v34, 0
    v_mov_b32 v35, 0
    v_mov_b32 v36, 0
    v_mov_b32 v37, 0
    v_mov_b32 v38, 0
    v_mov_b32 v39, 0
    v_mov_b32 v40, 0
    v_mov_b32 v41, 0
    v_mov_b32 v42, 0
    v_mov_b32 v43, 0
    v_mov_b32 v44, 0
    v_mov_b32 v45, 0
    v_mov_b32 v46, 0
    v_mov_b32 v47, 0
    v_mov_b32 v48, 0
    v_mov_b32 v49, 0
    v_mov_b32 v50, 0
    v_mov_b32 v51, 0
    v_mov_b32 v52, 0
    v_mov_b32 v53, 0
    v_mov_b32 v54, 0
    v_mov_b32 v55, 0
    s_add_u32 s30, s30, 0x40000
    s_add_u32 s31, s31, 0x40000
    s_mov_b32 s45, 0
    s_mov_b32 s46, 0
    s_mov_b32 s47, 0
    s_mov_b32 s76, 0
    s_and_b32 s43, s21, 1
    s_lshl_b32 s43, s43, 5
    s_add_u32 s43, s43, s20
    s_lshl_b32 s43, s43, 6
    s_add_u32 s28, s43, 0x2000
    s_mov_b32 s59, 0
    ds_read_b128 v[80:83], v123
    ds_read_b128 v[84:87], v123 offset:1024
    ds_read_b128 v[56:59], v123 offset:2048
    ds_read_b128 v[60:63], v123 offset:3072
    ds_read_b128 v[64:67], v123 offset:32768
    ds_read_b128 v[68:71], v123 offset:33792
    ds_read_b128 v[72:75], v123 offset:34816
    ds_read_b128 v[76:79], v123 offset:35840
    ds_read_b128 v[88:91], v123 offset:4096
    ds_read_b128 v[92:95], v123 offset:5120
    ds_read_b128 v[96:99], v123 offset:6144
    ds_read_b128 v[100:103], v123 offset:7168
    ds_read_b128 v[104:107], v123 offset:36864
    ds_read_b128 v[108:111], v123 offset:37888
    ds_read_b128 v[24:27], v123 offset:38912
    ds_read_b128 v[28:31], v123 offset:39936
    s_mov_b32 s49, 0
    s_waitcnt vmcnt(0) lgkmcnt(0)
    s_barrier
    s_waitcnt vmcnt(0) lgkmcnt(0)
    s_cmp_eq_u32 s21, 1
    s_cbranch_scc1 L_chain_top1_f
    s_cmp_eq_u32 s21, 2
    s_cbranch_scc1 L_chain_top2_f
    s_cmp_eq_u32 s21, 3
    s_cbranch_scc1 L_chain_top3_f
.p2align 6
L_chain_top0_f:
    buffer_load_dwordx4 v[0:3], v117, s[8:11], s23 offen nt
    v_mov_b32 v15, 0
    v_mov_b32 v15, 0
    v_mov_b32 v15, 0
    v_mov_b32 v15, 0
    v_mov_b32 v15, 0
    v_mov_b32 v15, 0
    v_mov_b32 v15, 0
    v_mov_b32 v15, 0
    v_mov_b32 v15, 0
    v_mov_b32 v15, 0
    v_mov_b32 v15, 0
    v_mov_b32 v15, 0
    v_mov_b32 v15, 0
    v_mov_b32 v15, 0
    v_mov_b32 v15, 0
    v_mov_b32 v15, 0
    buffer_load_dwordx4 v[0:3], v117, s[8:11], s23 offen sc1
    v_mov_b32 v15, 0
    v_mov_b32 v15, 0
    v_mov_b32 v15, 0
    v_mov_b32 v15, 0
    v_mov_b32 v15, 0
    v_mov_b32 v15, 0
    v_mov_b32 v15, 0
    v_mov_b32 v15, 0
    v_mov_b32 v15, 0
    v_mov_b32 v15, 0
    v_mov_b32 v15, 0
    v_mov_b32 v15, 0
    v_mov_b32 v15, 0
    v_mov_b32 v15, 0
    v_mov_b32 v15, 0
    v_mov_b32 v15, 0
L_mret_13:
    buffer_load_dwordx4 v[0:3], v117, s[8:11], s23 offen sc1
    s_add_u32 s45, s45, 1
    s_cmp_lt_u32 s45, 0x10000
    s_cselect_b32 s56, -2, -1
    s_nop 3
    v_mov_b32 v32, 0
    v_mov_b32 v33, 0
    v_mov_b32 v34, 0
    v_mov_b32 v35, 0
    s_waitcnt vmcnt(2)
    v_max3_u32 v15, v0, v1, v2
    v_max_u32 v15, v15, v3
    v_cmp_lt_u32 vcc, s56, v15
    v_smfmac_f32_16x16x64_bf16 v[32:35], v[0:3], v[80:87], v116
    s_cbranch_vccnz L_mret_13
    ds_write_b128 v117, v[0:3]
    v_smfmac_f32_16x16x64_bf16 v[36:39], v[0:3], v[56:63], v116
    buffer_load_dwordx4 v[4:7], v117, s[8:11], s48 offen nt
    v_smfmac_f32_16x16x64_bf16 v[40:43], v[0:3], v[64:71], v116
    buffer_load_dwordx4 v117, s[8:11], s48 offen nt lds
    s_mov_b32 m0, 8192
    v_smfmac_f32_16x16x64_bf16 v[44:47], v[0:3], v[72:79], v116
    s_waitcnt lgkmcnt(0)
    s_barrier
    ds_read_b128 v[8:11], v117 offset:1024
    v_smfmac_f32_16x16x64_bf16 v[48:51], v[0:3], a[192:199], v116
    ds_read_b128 v[16:19], v117 offset:2048
    ds_read_b128 v[20:23], v117 offset:3072
    v_smfmac_f32_16x16x64_bf16 v[52:55], v[0:3], a[200:207], v116
    ds_read_b128 v[80:83], v117 offset:14336
    s_waitcnt lgkmcnt(3)
    v_smfmac_f32_16x16x64_bf16 v[32:35], v[8:11], a[0:7], v116
    ds_read_b128 v[84:87], v117 offset:15360
    v_smfmac_f32_16x16x64_bf16 v[36:39], v[8:11], a[8:15], v116
    buffer_store_dwordx4 v[112:115], v117, s[8:11], s32 offen sc1
    s_waitcnt lgkmcnt(3)
    v_smfmac_f32_16x16x64_bf16 v[32:35], v[16:19], a[32:39], v116
    ds_read_b128 v[56:59], v117 offset:8192
    v_smfmac_f32_16x16x64_bf16 v[36:39], v[16:19], a[40:47], v116
    ds_read_b128 v[60:63], v117 offset:9216
    s_waitcnt lgkmcnt(4)
    v_smfmac_f32_16x16x64_bf16 v[32:35], v[20:23], a[64:71], v116
    ds_read_b128 v[64:67], v117 offset:10240
    v_smfmac_f32_16x16x64_bf16 v[36:39], v[20:23], a[72:79], v116
    ds_read_b128 v[68:71], v117 offset:11264
    v_smfmac_f32_16x16x64_bf16 v[40:43], v[8:11], a[96:103], v116
    ds_read_b128 v[72:75], v117 offset:12288
    v_smfmac_f32_16x16x64_bf16 v[40:43], v[16:19], a[128:135], v116
    ds_read_b128 v[76:79], v117 offset:13312
    v_smfmac_f32_16x16x64_bf16 v[40:43], v[20:23], a[160:167], v116
    s_waitcnt vmcnt(2)
    v_max3_u32 v15, v4, v5, v6
    v_smfmac_f32_16x16x64_bf16 v[44:47], v[8:11], a[104:111], v116
    v_max_u32 v15, v15, v7
    v_smfmac_f32_16x16x64_bf16 v[44:47], v[16:19], a[136:143], v116
    s_waitcnt vmcnt(1) lgkmcnt(0)
    v_cmp_lt_u32 vcc, s56, v15
    v_smfmac_f32_16x16x64_bf16 v[44:47], v[20:23], a[168:175], v116
    s_cbranch_vccnz L_mret_14
L_mgo_15:
    v_smfmac_f32_16x16x64_bf16 v[44:47], v[4:7], v[24:31], v116
    s_barrier
    ds_read_b128 v[12:15], v117 offset:5120
    v_smfmac_f32_16x16x64_bf16 v[32:35], v[4:7], v[88:95], v116
    ds_read_b128 v[24:27], v117 offset:6144
    v_smfmac_f32_16x16x64_bf16 v[36:39], v[4:7], v[96:103], v116
    ds_read_b128 v[28:31], v117 offset:7168
    v_smfmac_f32_16x16x64_bf16 v[40:43], v[4:7], v[104:111], v116
    ds_read_b128 v[88:91], v117 offset:24576
    s_waitcnt lgkmcnt(3)
    v_smfmac_f32_16x16x64_bf16 v[32:35], v[12:15], a[16:23], v116
    ds_read_b128 v[92:95], v117 offset:25600
    s_waitcnt lgkmcnt(3)
    v_smfmac_f32_16x16x64_bf16 v[32:35], v[24:27], a[48:55], v116
    buffer_load_dwordx4 v117, s[8:11], s30 offen lds
    s_waitcnt lgkmcnt(2)
    v_smfmac_f32_16x16x64_bf16 v[32:35], v[28:31], a[80:87], v116
    ds_read_b128 v[96:99], v117 offset:23552
    v_smfmac_f32_16x16x64_bf16 v[36:39], v[12:15], a[24:31], v116
    ds_read_b128 v[100:103], v117 offset:23552
    v_smfmac_f32_16x16x64_bf16 v[36:39], v[24:27], a[56:63], v116
    buffer_load_dwordx4 v117, s[8:11], s30 offen offset:1024 lds
    s_add_u32 m0, s52, 0x6000
    v_add_f32 v32, v32, v34
    v_smfmac_f32_16x16x64_bf16 v[36:39], v[28:31], a[88:95], v116
    ds_read_b128 v[104:107], v117 offset:23552
    v_add_f32 v33, v33, v35
    v_smfmac_f32_16x16x64_bf16 v[40:43], v[12:15], a[112:119], v116
    ds_read_b128 v[108:111], v117 offset:23552
    v_mul_f32 v32, s34, v32
    v_smfmac_f32_16x16x64_bf16 v[40:43], v[24:27], a[144:151], v116
    buffer_load_dword v125, v119, s[8:11], s28 offen sc1
    v_mul_f32 v33, s34, v33
    v_smfmac_f32_16x16x64_bf16 v[40:43], v[28:31], a[176:183], v116
    ds_read_b128 v[0:3], v124
    v_add_f32 v36, v36, v38
    v_smfmac_f32_16x16x64_bf16 v[48:51], v[4:7], a[208:215], v116
    v_add_f32 v37, v37, v39
    v_smfmac_f32_16x16x64_bf16 v[52:55], v[4:7], a[216:223], v116
    s_waitcnt lgkmcnt(5)
    buffer_load_dwordx4 v117, s[8:11], s31 offen lds
    v_mul_f32 v36, s34, v36
    v_smfmac_f32_16x16x64_bf16 v[44:47], v[12:15], a[120:127], v116
    ds_read_b128 v[4:7], v124 offset:1024
    v_mul_f32 v37, s34, v37
    v_smfmac_f32_16x16x64_bf16 v[44:47], v[24:27], a[152:159], v116
    v_cvt_pk_bf16_f32 v34, v32, v36
    v_smfmac_f32_16x16x64_bf16 v[44:47], v[28:31], a[184:191], v116
    buffer_load_dwordx4 v117, s[8:11], s31 offen offset:1024 lds
    s_mov_b32 m0, 4096
    v_cvt_pk_bf16_f32 v35, v33, v37
    v_add_f32 v40, v40, v42
    v_smfmac_f32_16x16x64_bf16 v[48:51], v[8:11], a[224:231], v116
    ds_write2_b32 v120, v34, v35 offset0:32 offset1:48
    v_add_f32 v41, v41, v43
    v_smfmac_f32_16x16x64_bf16 v[52:55], v[8:11], a[232:239], v116
    v_add_f32 v44, v44, v46
    v_add_f32 v45, v45, v47
    v_cvt_pk_bf16_f32 v113, v40, v44
    v_cvt_pk_bf16_f32 v115, v41, v45
    v_smfmac_f32_16x16x64_bf16 v[48:51], v[12:15], a[240:247], v116
    ds_write2_b32 v120, v113, v115 offset0:0 offset1:16
    v_smfmac_f32_16x16x64_bf16 v[52:55], v[12:15], a[248:255], v116
    s_cmp_eq_u32 s22, 63
    s_cbranch_scc1 L_chain_last_f
    buffer_store_dword v126, off, s[8:11], s44 sc1
    v_smfmac_f32_16x16x64_bf16 v[48:51], v[16:19], v[128:135], v116
    v_smfmac_f32_16x16x64_bf16 v[48:51], v[20:23], v[160:167], v116
    v_smfmac_f32_16x16x64_bf16 v[48:51], v[24:27], v[144:151], v116
    s_waitcnt lgkmcnt(0)
    s_barrier
    v_smfmac_f32_16x16x64_bf16 v[48:51], v[28:31], v[176:183], v116
    ds_read_b128 v[32:35], v121 offset:16384
    ds_read_b128 v[36:39], v121 offset:17408
    v_smfmac_f32_16x16x64_bf16 v[52:55], v[16:19], v[136:143], v116
    ds_read_b128 v[40:43], v121 offset:18432
    ds_read_b128 v[44:47], v121 offset:19456
    v_smfmac_f32_16x16x64_bf16 v[52:55], v[20:23], v[168:175], v116
    ds_read_b128 v[8:11], v124 offset:32768
    v_add_f32 v48, v48, v50
    v_smfmac_f32_16x16x64_bf16 v[52:55], v[24:27], v[152:159], v116
    ds_read_b128 v[12:15], v124 offset:33792
    v_add_f32 v49, v49, v51
    v_smfmac_f32_16x16x64_bf16 v[52:55], v[28:31], v[184:191], v116
    s_waitcnt lgkmcnt(5)
    v_cvt_pk_bf16_f32 v112, v48, v49
    v_mfma_f32_16x16x32_bf16 v[56:59], v[56:59], v[32:35], 0
    s_waitcnt lgkmcnt(4)
    v_mov_b32 v48, s50
    v_mov_b32 v49, s50
    v_mfma_f32_16x16x32_bf16 v[56:59], v[60:63], v[36:39], v[56:59]
    ds_read_b128 v[16:19], v124 offset:2048
    s_waitcnt lgkmcnt(4)
    v_mov_b32 v50, s50
    v_mov_b32 v51, s50
    v_mfma_f32_16x16x32_bf16 v[56:59], v[64:67], v[40:43], v[56:59]
    ds_read_b128 v[20:23], v124 offset:3072
    s_waitcnt lgkmcnt(4)
    v_add_f32 v52, v52, v54
    v_mfma_f32_16x16x32_bf16 v[56:59], v[68:71], v[44:47], v[56:59]
    ds_read_b128 v[24:27], v124 offset:4096
    v_add_f32 v53, v53, v55
    v_mfma_f32_16x16x32_bf16 v[60:63], v[72:75], v[32:35], 0
    ds_read_b128 v[28:31], v124 offset:5120
    v_cvt_pk_bf16_f32 v114, v52, v53
    v_mov_b32 v53, 0
    v_mfma_f32_16x16x32_bf16 v[60:63], v[76:79], v[36:39], v[60:63]
    v_exp_f32 v56, v56
    v_mfma_f32_16x16x32_bf16 v[60:63], v[80:83], v[40:43], v[60:63]
    v_exp_f32 v57, v57
    v_mfma_f32_16x16x32_bf16 v[60:63], v[84:87], v[44:47], v[60:63]
    v_exp_f32 v58, v58
    v_mfma_f32_16x16x32_bf16 v[64:67], v[32:35], v[32:35], 0
    v_exp_f32 v59, v59
    v_cvt_pk_bf16_f32 v68, v56, v57
    v_mfma_f32_16x16x32_bf16 v[64:67], v[36:39], v[36:39], v[64:67]
    v_exp_f32 v60, v60
    v_cvt_pk_bf16_f32 v69, v58, v59
    v_mfma_f32_16x16x32_bf16 v[64:67], v[40:43], v[40:43], v[64:67]
    v_exp_f32 v61, v61
    v_mfma_f32_16x16x32_bf16 v[64:67], v[44:47], v[44:47], v[64:67]
    v_exp_f32 v62, v62
    v_exp_f32 v63, v63
    v_cvt_pk_bf16_f32 v70, v60, v61
    v_cvt_pk_bf16_f32 v71, v62, v63
    s_nop 1
    v_mfma_f32_16x16x32_bf16 v[72:75], v[88:91], v[68:71], 0
    s_nop 0
    v_exp_f32 v64, v64
    v_mfma_f32_16x16x32_bf16 v[76:79], v[92:95], v[68:71], 0
    v_exp_f32 v65, v65
    v_mfma_f32_16x16x32_bf16 v[80:83], v[48:51], v[68:71], 0
    v_cvt_pk_bf16_f32 v52, v64, v65
    s_nop 1
    v_mfma_f32_16x16x16_bf16 v[72:75], v[112:113], v[52:53], v[72:75]
    ds_read_b128 v[32:35], v124 offset:6144
    v_mfma_f32_16x16x16_bf16 v[76:79], v[114:115], v[52:53], v[76:79]
    ds_read_b128 v[36:39], v124 offset:7168
    v_mfma_f32_16x16x16_bf16 v[80:83], v[48:49], v[52:53], v[80:83]
L_norm_16:
    s_mov_b64 vcc, s[36:37]
    v_mov_b32 v122, v122
    v_mov_b32 v122, v122
    v_mov_b32 v122, v122
    v_cndmask_b32_dpp v76, v72, v76, vcc quad_perm:[2,3,2,3] row_mask:0xf bank_mask:0xf
    v_cndmask_b32_dpp v77, v73, v77, vcc quad_perm:[2,3,2,3] row_mask:0xf bank_mask:0xf
    v_cndmask_b32_dpp v78, v74, v78, vcc quad_perm:[2,3,2,3] row_mask:0xf bank_mask:0xf
    v_cndmask_b32_dpp v79, v75, v79, vcc quad_perm:[2,3,2,3] row_mask:0xf bank_mask:0xf
    v_rcp_f32_dpp v84, v80 quad_perm:[2,3,2,3] row_mask:0xf bank_mask:0xf
    s_nop 0
    v_pk_mul_f32 v[76:77], v[76:77], v[84:85] op_sel_hi:[1,0]
    v_pk_mul_f32 v[78:79], v[78:79], v[84:85] op_sel_hi:[1,0]
    v_cvt_pk_bf16_f32 v72, v76, v77
    v_cvt_pk_bf16_f32 v73, v78, v79
    ds_write_b64 v122, v[72:73] offset:20480
    v_max_f32_dpp v86, v80, v84 quad_perm:[2,3,2,3] row_mask:0xf bank_mask:0xf
    v_mov_b32_dpp v60, v72 quad_perm:[0,1,0,1] row_mask:0xf bank_mask:0xf
    v_mov_b32_dpp v61, v73 quad_perm:[0,1,0,1] row_mask:0xf bank_mask:0xf
    v_cmp_lt_f32 vcc, s35, v86
    v_mov_b32_dpp v62, v72 quad_perm:[2,3,2,3] row_mask:0xf bank_mask:0xf
    v_mov_b32_dpp v63, v73 quad_perm:[2,3,2,3] row_mask:0xf bank_mask:0xf
    s_nop 1
    v_smfmac_f32_16x16x64_bf16 v[96:99], v[60:63], v[192:199], v116
    s_cbranch_vccnz L_smax_17
    v_smfmac_f32_16x16x64_bf16 v[100:103], v[60:63], v[224:231], v116
    s_waitcnt lgkmcnt(0)
    s_barrier
    ds_read_b128 v[92:95], v127 offset:20992
    ds_read_b128 v[80:83], v127 offset:21504
    ds_read_b128 v[84:87], v127 offset:22016
    v_smfmac_f32_16x16x64_bf16 v[104:107], v[60:63], v[0:7], v116
    ds_read_b128 v[40:43], v124 offset:34816
    v_smfmac_f32_16x16x64_bf16 v[108:111], v[60:63], v[8:15], v116
    ds_read_b128 v[56:59], v124 offset:36864
    s_waitcnt lgkmcnt(4)
    v_smfmac_f32_16x16x64_bf16 v[96:99], v[92:95], v[200:207], v116
    s_waitcnt lgkmcnt(3)
    v_smfmac_f32_16x16x64_bf16 v[96:99], v[80:83], v[208:215], v116
    ds_read_b128 v[44:47], v124 offset:35840
    s_waitcnt lgkmcnt(3)
    v_smfmac_f32_16x16x64_bf16 v[96:99], v[84:87], v[216:223], v116
    ds_read_b128 v[68:71], v124 offset:39936
    v_smfmac_f32_16x16x64_bf16 v[100:103], v[92:95], v[232:239], v116
    ds_read_b128 v[64:67], v124 offset:38912
    v_smfmac_f32_16x16x64_bf16 v[100:103], v[80:83], v[240:247], v116
    ds_read_b128 v[60:63], v124 offset:37888
    v_cvt_pk_bf16_f32 v72, v96, v98
    v_smfmac_f32_16x16x64_bf16 v[100:103], v[84:87], v[248:255], v116
    v_and_or_b32 v72, v72, -2, s33
    v_smfmac_f32_16x16x64_bf16 v[104:107], v[92:95], v[16:23], v116
    v_cvt_pk_bf16_f32 v74, v97, v99
    v_smfmac_f32_16x16x64_bf16 v[104:107], v[80:83], v[24:31], v116
    v_cvt_pk_bf16_f32 v73, v100, v102
    v_cvt_pk_bf16_f32 v75, v101, v103
    v_smfmac_f32_16x16x64_bf16 v[104:107], v[84:87], v[32:39], v116
    buffer_store_dwordx4 v[72:75], v118, s[8:11], s25 offen
    s_waitcnt lgkmcnt(3)
    v_smfmac_f32_16x16x64_bf16 v[108:111], v[92:95], v[40:47], v116
    s_waitcnt lgkmcnt(0)
    v_smfmac_f32_16x16x64_bf16 v[108:111], v[80:83], v[56:63], v116
    v_cvt_pk_bf16_f32 v76, v104, v106
    v_smfmac_f32_16x16x64_bf16 v[108:111], v[84:87], v[64:71], v116
    v_and_or_b32 v76, v76, -2, s33
    v_cvt_pk_bf16_f32 v78, v105, v107
    v_mov_b32 v122, v122
    v_mov_b32 v122, v122
    v_mov_b32 v122, v122
    v_mov_b32 v122, v122
    v_mov_b32 v122, v122
    v_mov_b32 v122, v122
    v_cvt_pk_bf16_f32 v77, v108, v110
    v_cvt_pk_bf16_f32 v79, v109, v111
    buffer_store_dwordx4 v[76:79], v118, s[8:11], s26 offen
    s_add_u32 s30, s30, 0x40000
    s_add_u32 s31, s31, 0x40000
    s_add_u32 s32, s32, 0x20000
    s_add_u32 s23, s24, 0
    s_add_u32 s48, s23, 4096
    s_xor_b32 s25, s25, 0x40000
    s_xor_b32 s26, s26, 0x40000
    s_mov_b32 s35, 0x49800000
    v_mov_b32 v126, s22
    s_add_u32 s22, s22, 1
    v_mov_b32 v32, 0
    v_mov_b32 v33, 0
    v_mov_b32 v34, 0
    v_mov_b32 v35, 0
    v_mov_b32 v36, 0
    v_mov_b32 v37, 0
    v_mov_b32 v38, 0
    v_mov_b32 v39, 0
    v_mov_b32 v40, 0
    v_mov_b32 v41, 0
    v_mov_b32 v42, 0
    v_mov_b32 v43, 0
    v_mov_b32 v44, 0
    v_mov_b32 v45, 0
    v_mov_b32 v46, 0
    v_mov_b32 v47, 0
    v_mov_b32 v48, 0
    v_mov_b32 v49, 0
    v_mov_b32 v50, 0
    v_mov_b32 v51, 0
    v_mov_b32 v52, 0
    v_mov_b32 v53, 0
    v_mov_b32 v54, 0
    v_mov_b32 v55, 0
    ds_read_b128 v[80:83], v123
    ds_read_b128 v[84:87], v123 offset:1024
    ds_read_b128 v[56:59], v123 offset:2048
    ds_read_b128 v[60:63], v123 offset:3072
    ds_read_b128 v[64:67], v123 offset:32768
    ds_read_b128 v[68:71], v123 offset:33792
    ds_read_b128 v[72:75], v123 offset:34816
    ds_read_b128 v[76:79], v123 offset:35840
    ds_read_b128 v[88:91], v123 offset:4096
    ds_read_b128 v[92:95], v123 offset:5120
    ds_read_b128 v[96:99], v123 offset:6144
    ds_read_b128 v[100:103], v123 offset:7168
    ds_read_b128 v[104:107], v123 offset:36864
    ds_read_b128 v[108:111], v123 offset:37888
    ds_read_b128 v[24:27], v123 offset:38912
    ds_read_b128 v[28:31], v123 offset:39936
    s_add_u32 s24, s24, 8192
    s_bitset0_b32 s24, 15
    s_xor_b32 s55, s24, 16384
    s_xor_b32 s29, s29, 0x40000
    s_xor_b32 s53, s29, 1024
    s_bfe_u32 s33, s22, 0x10001
    s_add_u32 s40, s22, 5
    s_lshr_b32 s40, s40, 2
    s_min_u32 s40, s40, 16
    s_bfm_b32 s58, s40, 0
    s_waitcnt vmcnt(5)
    v_cmp_eq_u32 vcc, 0, v125
    s_nop 0
    s_and_b64 vcc, vcc, s[58:59]
    s_cbranch_scc1 L_kvw_18
L_kvb_19:
    v_mov_b32 v15, 0
    s_nop 2
    v_mov_b32 v15, 0
    s_nop 2
    v_mov_b32 v15, 0
    s_nop 2
    v_mov_b32 v15, 0
    s_nop 2
    v_mov_b32 v15, 0
    s_nop 2
    v_mov_b32 v15, 0
    s_nop 2
    v_mov_b32 v15, 0
    s_nop 2
    v_mov_b32 v15, 0
    s_nop 2
    v_mov_b32 v15, 0
    s_nop 2
    v_mov_b32 v15, 0
    s_nop 2
    v_mov_b32 v15, 0
    s_nop 2
    v_mov_b32 v15, 0
    s_nop 2
    v_mov_b32 v15, 0
    s_nop 2
    v_mov_b32 v15, 0
    s_nop 2
    v_mov_b32 v15, 0
    s_nop 2
    v_mov_b32 v15, 0
    s_nop 2
    v_mov_b32 v15, 0
    s_nop 2
    v_mov_b32 v15, 0
    s_nop 2
    v_mov_b32 v15, 0
    s_nop 2
    v_mov_b32 v15, 0
    s_nop 2
    v_mov_b32 v15, 0
    s_nop 2
    v_mov_b32 v15, 0
    s_nop 2
    v_mov_b32 v15, 0
    s_nop 2
    v_mov_b32 v15, 0
    s_nop 2
    v_mov_b32 v15, 0
    s_nop 2
    v_mov_b32 v15, 0
    s_nop 2
    v_mov_b32 v15, 0
    s_nop 2
    v_mov_b32 v15, 0
    s_nop 2
    v_mov_b32 v15, 0
    s_nop 2
    v_mov_b32 v15, 0
    s_nop 2
    v_mov_b32 v15, 0
    s_nop 2
    s_waitcnt lgkmcnt(0)
    s_branch L_chain_top0_f
.p2align 6
L_chain_top1_f:
    buffer_load_dwordx4 v[0:3], v117, s[8:11], s23 offen nt
    v_mov_b32 v15, 0
    v_mov_b32 v15, 0
    v_mov_b32 v15, 0
    v_mov_b32 v15, 0
    v_mov_b32 v15, 0
    v_mov_b32 v15, 0
    v_mov_b32 v15, 0
    v_mov_b32 v15, 0
    v_mov_b32 v15, 0
    v_mov_b32 v15, 0
    v_mov_b32 v15, 0
    v_mov_b32 v15, 0
    v_mov_b32 v15, 0
    v_mov_b32 v15, 0
    v_mov_b32 v15, 0
    v_mov_b32 v15, 0
    buffer_load_dwordx4 v[0:3], v117, s[8:11], s23 offen sc1
    v_mov_b32 v15, 0
    v_mov_b32 v15, 0
    v_mov_b32 v15, 0
    v_mov_b32 v15, 0
    v_mov_b32 v15, 0
    v_mov_b32 v15, 0
    v_mov_b32 v15, 0
    v_mov_b32 v15, 0
    v_mov_b32 v15, 0
    v_mov_b32 v15, 0
    v_mov_b32 v15, 0
    v_mov_b32 v15, 0
    v_mov_b32 v15, 0
    v_mov_b32 v15, 0
    v_mov_b32 v15, 0
    v_mov_b32 v15, 0
L_mret_20:
    buffer_load_dwordx4 v[0:3], v117, s[8:11], s23 offen sc1
    s_add_u32 s45, s45, 1
    s_cmp_lt_u32 s45, 0x10000
    s_cselect_b32 s56, -2, -1
    s_nop 3
    v_mov_b32 v32, 0
    v_mov_b32 v33, 0
    v_mov_b32 v34, 0
    v_mov_b32 v35, 0
    s_waitcnt vmcnt(2)
    v_max3_u32 v15, v0, v1, v2
    v_max_u32 v15, v15, v3
    v_cmp_lt_u32 vcc, s56, v15
    v_smfmac_f32_16x16x64_bf16 v[32:35], v[0:3], v[80:87], v116
    s_cbranch_vccnz L_mret_20
    ds_write_b128 v117, v[0:3] offset:1024
    v_smfmac_f32_16x16x64_bf16 v[36:39], v[0:3], v[56:63], v116
    buffer_load_dwordx4 v[4:7], v117, s[8:11], s48 offen nt
    v_smfmac_f32_16x16x64_bf16 v[40:43], v[0:3], v[64:71], v116
    buffer_load_dwordx4 v117, s[8:11], s48 offen nt lds
    s_mov_b32 m0, 10240
    v_smfmac_f32_16x16x64_bf16 v[44:47], v[0:3], v[72:79], v116
    s_waitcnt lgkmcnt(0)
    s_barrier
    ds_read_b128 v[8:11], v117
    v_smfmac_f32_16x16x64_bf16 v[48:51], v[0:3], a[192:199], v116
    ds_read_b128 v[16:19], v117 offset:3072
    ds_read_b128 v[20:23], v117 offset:2048
    v_smfmac_f32_16x16x64_bf16 v[52:55], v[0:3], a[200:207], v116
    ds_read_b128 v[80:83], v117 offset:14336
    s_waitcnt lgkmcnt(3)
    v_smfmac_f32_16x16x64_bf16 v[32:35], v[8:11], a[0:7], v116
    ds_read_b128 v[84:87], v117 offset:15360
    v_smfmac_f32_16x16x64_bf16 v[36:39], v[8:11], a[8:15], v116
    ds_read_b128 v[56:59], v117 offset:8192
    s_waitcnt lgkmcnt(4)
    v_smfmac_f32_16x16x64_bf16 v[32:35], v[16:19], a[32:39], v116
    ds_read_b128 v[60:63], v117 offset:9216
    v_smfmac_f32_16x16x64_bf16 v[36:39], v[16:19], a[40:47], v116
    buffer_store_dwordx4 v[112:115], v117, s[8:11], s32 offen sc1
    s_waitcnt lgkmcnt(4)
    v_smfmac_f32_16x16x64_bf16 v[32:35], v[20:23], a[64:71], v116
    ds_read_b128 v[64:67], v117 offset:10240
    v_smfmac_f32_16x16x64_bf16 v[36:39], v[20:23], a[72:79], v116
    ds_read_b128 v[68:71], v117 offset:11264
    v_smfmac_f32_16x16x64_bf16 v[40:43], v[8:11], a[96:103], v116
    ds_read_b128 v[72:75], v117 offset:12288
    v_smfmac_f32_16x16x64_bf16 v[40:43], v[16:19], a[128:135], v116
    ds_read_b128 v[76:79], v117 offset:13312
    v_smfmac_f32_16x16x64_bf16 v[40:43], v[20:23], a[160:167], v116
    s_waitcnt vmcnt(2)
    v_max3_u32 v15, v4, v5, v6
    v_smfmac_f32_16x16x64_bf16 v[44:47], v[8:11], a[104:111], v116
    v_max_u32 v15, v15, v7
    v_smfmac_f32_16x16x64_bf16 v[44:47], v[16:19], a[136:143], v116
    s_waitcnt vmcnt(1) lgkmcnt(0)
    v_cmp_lt_u32 vcc, s56, v15
    v_smfmac_f32_16x16x64_bf16 v[44:47], v[20:23], a[168:175], v116
    s_cbranch_vccnz L_mret_21
L_mgo_22:
    v_smfmac_f32_16x16x64_bf16 v[44:47], v[4:7], v[24:31], v116
    s_barrier
    ds_read_b128 v[12:15], v117 offset:4096
    v_smfmac_f32_16x16x64_bf16 v[32:35], v[4:7], v[88:95], v116
    ds_read_b128 v[24:27], v117 offset:7168
    v_smfmac_f32_16x16x64_bf16 v[36:39], v[4:7], v[96:103], v116
    ds_read_b128 v[28:31], v117 offset:6144
    v_smfmac_f32_16x16x64_bf16 v[40:43], v[4:7], v[104:111], v116
    ds_read_b128 v[88:91], v117 offset:26624
    s_waitcnt lgkmcnt(3)
    v_smfmac_f32_16x16x64_bf16 v[32:35], v[12:15], a[16:23], v116
    ds_read_b128 v[92:95], v117 offset:27648
    s_waitcnt lgkmcnt(3)
    v_smfmac_f32_16x16x64_bf16 v[32:35], v[24:27], a[48:55], v116
    buffer_load_dwordx4 v117, s[8:11], s30 offen lds
    s_waitcnt lgkmcnt(2)
    v_smfmac_f32_16x16x64_bf16 v[32:35], v[28:31], a[80:87], v116
    ds_read_b128 v[96:99], v117 offset:23552
    v_smfmac_f32_16x16x64_bf16 v[36:39], v[12:15], a[24:31], v116
    ds_read_b128 v[100:103], v117 offset:23552
    v_smfmac_f32_16x16x64_bf16 v[36:39], v[24:27], a[56:63], v116
    buffer_load_dwordx4 v117, s[8:11], s30 offen offset:1024 lds
    s_add_u32 m0, s52, 0x6000
    v_add_f32 v32, v32, v34
    v_smfmac_f32_16x16x64_bf16 v[36:39], v[28:31], a[88:95], v116
    ds_read_b128 v[104:107], v117 offset:23552
    v_add_f32 v33, v33, v35
    v_smfmac_f32_16x16x64_bf16 v[40:43], v[12:15], a[112:119], v116
    ds_read_b128 v[108:111], v117 offset:23552
    v_mul_f32 v32, s34, v32
    v_smfmac_f32_16x16x64_bf16 v[40:43], v[24:27], a[144:151], v116
    buffer_load_dword v125, v119, s[8:11], s28 offen sc1
    v_mul_f32 v33, s34, v33
    v_smfmac_f32_16x16x64_bf16 v[40:43], v[28:31], a[176:183], v116
    ds_read_b128 v[0:3], v124
    v_add_f32 v36, v36, v38
    v_smfmac_f32_16x16x64_bf16 v[48:51], v[4:7], a[208:215], v116
    v_add_f32 v37, v37, v39
    v_smfmac_f32_16x16x64_bf16 v[52:55], v[4:7], a[216:223], v116
    s_waitcnt lgkmcnt(5)
    buffer_load_dwordx4 v117, s[8:11], s31 offen lds
    v_mul_f32 v36, s34, v36
    v_smfmac_f32_16x16x64_bf16 v[44:47], v[12:15], a[120:127], v116
    ds_read_b128 v[4:7], v124 offset:1024
    v_mul_f32 v37, s34, v37
    v_smfmac_f32_16x16x64_bf16 v[44:47], v[24:27], a[152:159], v116
    v_cvt_pk_bf16_f32 v34, v32, v36
    v_smfmac_f32_16x16x64_bf16 v[44:47], v[28:31], a[184:191], v116
    buffer_load_dwordx4 v117, s[8:11], s31 offen offset:1024 lds
    s_mov_b32 m0, 5120
    v_cvt_pk_bf16_f32 v35, v33, v37
    v_add_f32 v40, v40, v42
    v_smfmac_f32_16x16x64_bf16 v[48:51], v[8:11], a[224:231], v116
    ds_write2_b32 v120, v34, v35 offset0:32 offset1:48
    v_add_f32 v41, v41, v43
    v_smfmac_f32_16x16x64_bf16 v[52:55], v[8:11], a[232:239], v116
    v_add_f32 v44, v44, v46
    v_add_f32 v45, v45, v47
    v_cvt_pk_bf16_f32 v113, v40, v44
    v_cvt_pk_bf16_f32 v115, v41, v45
    v_smfmac_f32_16x16x64_bf16 v[48:51], v[12:15], a[240:247], v116
    ds_write2_b32 v120, v113, v115 offset0:0 offset1:16
    v_smfmac_f32_16x16x64_bf16 v[52:55], v[12:15], a[248:255], v116
    s_cmp_eq_u32 s22, 63
    s_cbranch_scc1 L_chain_last_f
    v_smfmac_f32_16x16x64_bf16 v[48:51], v[16:19], v[128:135], v116
    v_smfmac_f32_16x16x64_bf16 v[48:51], v[20:23], v[160:167], v116
    v_smfmac_f32_16x16x64_bf16 v[48:51], v[24:27], v[144:151], v116
    s_waitcnt lgkmcnt(0)
    s_barrier
    v_smfmac_f32_16x16x64_bf16 v[48:51], v[28:31], v[176:183], v116
    ds_read_b128 v[32:35], v121 offset:16384
    ds_read_b128 v[36:39], v121 offset:17408
    v_smfmac_f32_16x16x64_bf16 v[52:55], v[16:19], v[136:143], v116
    ds_read_b128 v[40:43], v121 offset:18432
    ds_read_b128 v[44:47], v121 offset:19456
    v_smfmac_f32_16x16x64_bf16 v[52:55], v[20:23], v[168:175], v116
    ds_read_b128 v[8:11], v124 offset:32768
    v_add_f32 v48, v48, v50
    v_smfmac_f32_16x16x64_bf16 v[52:55], v[24:27], v[152:159], v116
    ds_read_b128 v[12:15], v124 offset:33792
    v_add_f32 v49, v49, v51
    v_smfmac_f32_16x16x64_bf16 v[52:55], v[28:31], v[184:191], v116
    s_waitcnt lgkmcnt(5)
    v_cvt_pk_bf16_f32 v112, v48, v49
    v_mfma_f32_16x16x32_bf16 v[56:59], v[56:59], v[32:35], 0
    s_waitcnt lgkmcnt(4)
    v_mov_b32 v48, s50
    v_mov_b32 v49, s50
    v_mfma_f32_16x16x32_bf16 v[56:59], v[60:63], v[36:39], v[56:59]
    ds_read_b128 v[16:19], v124 offset:2048
    s_waitcnt lgkmcnt(4)
    v_mov_b32 v50, s50
    v_mov_b32 v51, s50
    v_mfma_f32_16x16x32_bf16 v[56:59], v[64:67], v[40:43], v[56:59]
    ds_read_b128 v[20:23], v124 offset:3072
    s_waitcnt lgkmcnt(4)
    v_add_f32 v52, v52, v54
    v_mfma_f32_16x16x32_bf16 v[56:59], v[68:71], v[44:47], v[56:59]
    ds_read_b128 v[24:27], v124 offset:4096
    v_add_f32 v53, v53, v55
    v_mfma_f32_16x16x32_bf16 v[60:63], v[72:75], v[32:35], 0
    ds_read_b128 v[28:31], v124 offset:5120
    v_cvt_pk_bf16_f32 v114, v52, v53
    v_mov_b32 v53, 0
    v_mfma_f32_16x16x32_bf16 v[60:63], v[76:79], v[36:39], v[60:63]
    v_exp_f32 v56, v56
    v_mfma_f32_16x16x32_bf16 v[60:63], v[80:83], v[40:43], v[60:63]
    v_exp_f32 v57, v57
    v_mfma_f32_16x16x32_bf16 v[60:63], v[84:87], v[44:47], v[60:63]
    v_exp_f32 v58, v58
    v_mfma_f32_16x16x32_bf16 v[64:67], v[32:35], v[32:35], 0
    v_exp_f32 v59, v59
    v_cvt_pk_bf16_f32 v68, v56, v57
    v_mfma_f32_16x16x32_bf16 v[64:67], v[36:39], v[36:39], v[64:67]
    v_exp_f32 v60, v60
    v_cvt_pk_bf16_f32 v69, v58, v59
    v_mfma_f32_16x16x32_bf16 v[64:67], v[40:43], v[40:43], v[64:67]
    v_exp_f32 v61, v61
    v_mfma_f32_16x16x32_bf16 v[64:67], v[44:47], v[44:47], v[64:67]
    v_exp_f32 v62, v62
    v_exp_f32 v63, v63
    v_cvt_pk_bf16_f32 v70, v60, v61
    v_cvt_pk_bf16_f32 v71, v62, v63
    s_nop 1
    v_mfma_f32_16x16x32_bf16 v[72:75], v[88:91], v[68:71], 0
    s_nop 0
    v_exp_f32 v64, v64
    v_mfma_f32_16x16x32_bf16 v[76:79], v[92:95], v[68:71], 0
    v_exp_f32 v65, v65
    v_mfma_f32_16x16x32_bf16 v[80:83], v[48:51], v[68:71], 0
    v_cvt_pk_bf16_f32 v52, v64, v65
    s_nop 1
    v_mfma_f32_16x16x16_bf16 v[72:75], v[112:113], v[52:53], v[72:75]
    ds_read_b128 v[32:35], v124 offset:6144
    v_mfma_f32_16x16x16_bf16 v[76:79], v[114:115], v[52:53], v[76:79]
    ds_read_b128 v[36:39], v124 offset:7168
    v_mfma_f32_16x16x16_bf16 v[80:83], v[48:49], v[52:53], v[80:83]
L_norm_23:
    s_mov_b64 vcc, s[36:37]
    v_mov_b32 v122, v122
    v_mov_b32 v122, v122
    v_mov_b32 v122, v122
    v_cndmask_b32_dpp v76, v72, v76, vcc quad_perm:[2,3,2,3] row_mask:0xf bank_mask:0xf
    v_cndmask_b32_dpp v77, v73, v77, vcc quad_perm:[2,3,2,3] row_mask:0xf bank_mask:0xf
    v_cndmask_b32_dpp v78, v74, v78, vcc quad_perm:[2,3,2,3] row_mask:0xf bank_mask:0xf
    v_cndmask_b32_dpp v79, v75, v79, vcc quad_perm:[2,3,2,3] row_mask:0xf bank_mask:0xf
    v_rcp_f32_dpp v84, v80 quad_perm:[2,3,2,3] row_mask:0xf bank_mask:0xf
    s_nop 0
    v_pk_mul_f32 v[76:77], v[76:77], v[84:85] op_sel_hi:[1,0]
    v_pk_mul_f32 v[78:79], v[78:79], v[84:85] op_sel_hi:[1,0]
    v_cvt_pk_bf16_f32 v72, v76, v77
    v_cvt_pk_bf16_f32 v73, v78, v79
    ds_write_b64 v122, v[72:73] offset:20992
    v_max_f32_dpp v86, v80, v84 quad_perm:[2,3,2,3] row_mask:0xf bank_mask:0xf
    v_mov_b32_dpp v60, v72 quad_perm:[0,1,0,1] row_mask:0xf bank_mask:0xf
    v_mov_b32_dpp v61, v73 quad_perm:[0,1,0,1] row_mask:0xf bank_mask:0xf
    v_cmp_lt_f32 vcc, s35, v86
    v_mov_b32_dpp v62, v72 quad_perm:[2,3,2,3] row_mask:0xf bank_mask:0xf
    v_mov_b32_dpp v63, v73 quad_perm:[2,3,2,3] row_mask:0xf bank_mask:0xf
    s_nop 1
    v_smfmac_f32_16x16x64_bf16 v[96:99], v[60:63], v[192:199], v116
    s_cbranch_vccnz L_smax_24
    v_smfmac_f32_16x16x64_bf16 v[100:103], v[60:63], v[224:231], v116
    s_waitcnt lgkmcnt(0)
    s_barrier
    ds_read_b128 v[92:95], v127 offset:20480
    ds_read_b128 v[80:83], v127 offset:22016
    ds_read_b128 v[84:87], v127 offset:21504
    v_smfmac_f32_16x16x64_bf16 v[104:107], v[60:63], v[0:7], v116
    ds_read_b128 v[40:43], v124 offset:34816
    v_smfmac_f32_16x16x64_bf16 v[108:111], v[60:63], v[8:15], v116
    ds_read_b128 v[56:59], v124 offset:36864
    s_waitcnt lgkmcnt(4)
    v_smfmac_f32_16x16x64_bf16 v[96:99], v[92:95], v[200:207], v116
    s_waitcnt lgkmcnt(3)
    v_smfmac_f32_16x16x64_bf16 v[96:99], v[80:83], v[208:215], v116
    ds_read_b128 v[44:47], v124 offset:35840
    s_waitcnt lgkmcnt(3)
    v_smfmac_f32_16x16x64_bf16 v[96:99], v[84:87], v[216:223], v116
    ds_read_b128 v[68:71], v124 offset:39936
    v_smfmac_f32_16x16x64_bf16 v[100:103], v[92:95], v[232:239], v116
    ds_read_b128 v[64:67], v124 offset:38912
    v_smfmac_f32_16x16x64_bf16 v[100:103], v[80:83], v[240:247], v116
    ds_read_b128 v[60:63], v124 offset:37888
    v_cvt_pk_bf16_f32 v72, v96, v98
    v_smfmac_f32_16x16x64_bf16 v[100:103], v[84:87], v[248:255], v116
    v_and_or_b32 v72, v72, -2, s33
    v_smfmac_f32_16x16x64_bf16 v[104:107], v[92:95], v[16:23], v116
    v_cvt_pk_bf16_f32 v74, v97, v99
    v_smfmac_f32_16x16x64_bf16 v[104:107], v[80:83], v[24:31], v116
    v_cvt_pk_bf16_f32 v73, v100, v102
    v_cvt_pk_bf16_f32 v75, v101, v103
    v_smfmac_f32_16x16x64_bf16 v[104:107], v[84:87], v[32:39], v116
    buffer_store_dwordx4 v[72:75], v118, s[8:11], s25 offen
    s_waitcnt lgkmcnt(3)
    v_smfmac_f32_16x16x64_bf16 v[108:111], v[92:95], v[40:47], v116
    s_waitcnt lgkmcnt(0)
    v_smfmac_f32_16x16x64_bf16 v[108:111], v[80:83], v[56:63], v116
    v_cvt_pk_bf16_f32 v76, v104, v106
    v_smfmac_f32_16x16x64_bf16 v[108:111], v[84:87], v[64:71], v116
    v_and_or_b32 v76, v76, -2, s33
    v_cvt_pk_bf16_f32 v78, v105, v107
    v_mov_b32 v122, v122
    v_mov_b32 v122, v122
    v_mov_b32 v122, v122
    v_mov_b32 v122, v122
    v_mov_b32 v122, v122
    v_mov_b32 v122, v122
    v_cvt_pk_bf16_f32 v77, v108, v110
    v_cvt_pk_bf16_f32 v79, v109, v111
    buffer_store_dwordx4 v[76:79], v118, s[8:11], s26 offen
    s_add_u32 s30, s30, 0x40000
    s_add_u32 s31, s31, 0x40000
    s_add_u32 s32, s32, 0x20000
    s_add_u32 s23, s24, 1024
    s_add_u32 s48, s23, 4096
    s_xor_b32 s25, s25, 0x40000
    s_xor_b32 s26, s26, 0x40000
    s_mov_b32 s35, 0x49800000
    s_add_u32 s22, s22, 1
    v_mov_b32 v32, 0
    v_mov_b32 v33, 0
    v_mov_b32 v34, 0
    v_mov_b32 v35, 0
    v_mov_b32 v36, 0
    v_mov_b32 v37, 0
    v_mov_b32 v38, 0
    v_mov_b32 v39, 0
    v_mov_b32 v40, 0
    v_mov_b32 v41, 0
    v_mov_b32 v42, 0
    v_mov_b32 v43, 0
    v_mov_b32 v44, 0
    v_mov_b32 v45, 0
    v_mov_b32 v46, 0
    v_mov_b32 v47, 0
    v_mov_b32 v48, 0
    v_mov_b32 v49, 0
    v_mov_b32 v50, 0
    v_mov_b32 v51, 0
    v_mov_b32 v52, 0
    v_mov_b32 v53, 0
    v_mov_b32 v54, 0
    v_mov_b32 v55, 0
    ds_read_b128 v[80:83], v123
    ds_read_b128 v[84:87], v123 offset:1024
    ds_read_b128 v[56:59], v123 offset:2048
    ds_read_b128 v[60:63], v123 offset:3072
    ds_read_b128 v[64:67], v123 offset:32768
    ds_read_b128 v[68:71], v123 offset:33792
    ds_read_b128 v[72:75], v123 offset:34816
    ds_read_b128 v[76:79], v123 offset:35840
    ds_read_b128 v[88:91], v123 offset:4096
    ds_read_b128 v[92:95], v123 offset:5120
    ds_read_b128 v[96:99], v123 offset:6144
    ds_read_b128 v[100:103], v123 offset:7168
    ds_read_b128 v[104:107], v123 offset:36864
    ds_read_b128 v[108:111], v123 offset:37888
    ds_read_b128 v[24:27], v123 offset:38912
    ds_read_b128 v[28:31], v123 offset:39936
    s_add_u32 s24, s24, 8192
    s_bitset0_b32 s24, 15
    s_xor_b32 s55, s24, 16384
    s_xor_b32 s29, s29, 0x40000
    s_xor_b32 s53, s29, 1024
    s_bfe_u32 s33, s22, 0x10001
    s_add_u32 s40, s22, 5
    s_lshr_b32 s40, s40, 2
    s_min_u32 s40, s40, 16
    s_bfm_b32 s58, s40, 0
    s_waitcnt vmcnt(4)
    v_cmp_eq_u32 vcc, 0, v125
    s_nop 0
    s_and_b64 vcc, vcc, s[58:59]
    s_cbranch_scc1 L_kvw_25
L_kvb_26:
    v_mov_b32 v15, 0
    s_nop 2
    v_mov_b32 v15, 0
    s_nop 2
    v_mov_b32 v15, 0
    s_nop 2
    v_mov_b32 v15, 0
    s_nop 2
    v_mov_b32 v15, 0
    s_nop 2
    v_mov_b32 v15, 0
    s_nop 2
    v_mov_b32 v15, 0
    s_nop 2
    v_mov_b32 v15, 0
    s_nop 2
    v_mov_b32 v15, 0
    s_nop 2
    v_mov_b32 v15, 0
    s_nop 2
    v_mov_b32 v15, 0
    s_nop 2
    v_mov_b32 v15, 0
    s_nop 2
    v_mov_b32 v15, 0
    s_nop 2
    v_mov_b32 v15, 0
    s_nop 2
    v_mov_b32 v15, 0
    s_nop 2
    v_mov_b32 v15, 0
    s_nop 2
    v_mov_b32 v15, 0
    s_nop 2
    v_mov_b32 v15, 0
    s_nop 2
    v_mov_b32 v15, 0
    s_nop 2
    v_mov_b32 v15, 0
    s_nop 2
    v_mov_b32 v15, 0
    s_nop 2
    v_mov_b32 v15, 0
    s_nop 2
    v_mov_b32 v15, 0
    s_nop 2
    v_mov_b32 v15, 0
    s_nop 2
    v_mov_b32 v15, 0
    s_nop 2
    v_mov_b32 v15, 0
    s_nop 2
    v_mov_b32 v15, 0
    s_nop 2
    v_mov_b32 v15, 0
    s_nop 2
    v_mov_b32 v15, 0
    s_nop 2
    v_mov_b32 v15, 0
    s_nop 2
    v_mov_b32 v15, 0
    s_nop 2
    s_waitcnt lgkmcnt(0)
    s_branch L_chain_top1_f
.p2align 6
L_chain_top2_f:
    buffer_load_dwordx4 v[0:3], v117, s[8:11], s23 offen nt
    v_mov_b32 v48, 0
    v_mov_b32 v49, 0
    v_mov_b32 v50, 0
    v_mov_b32 v51, 0
    v_mov_b32 v52, 0
    v_mov_b32 v53, 0
    v_mov_b32 v15, 0
    v_mov_b32 v15, 0
    v_mov_b32 v15, 0
    v_mov_b32 v15, 0
    v_mov_b32 v15, 0
    v_mov_b32 v15, 0
    v_mov_b32 v15, 0
    v_mov_b32 v15, 0
    v_mov_b32 v15, 0
    v_mov_b32 v15, 0
    buffer_load_dwordx4 v[0:3], v117, s[8:11], s23 offen sc1
    s_waitcnt vmcnt(3)
    v_mov_b32 v36, 0
    v_mov_b32 v37, 0
    v_mov_b32 v38, 0
    v_mov_b32 v39, 0
    v_mov_b32 v40, 0
    v_mov_b32 v41, 0
    v_mov_b32 v42, 0
    v_mov_b32 v43, 0
    v_mov_b32 v44, 0
    v_mov_b32 v45, 0
    v_mov_b32 v46, 0
    v_mov_b32 v47, 0
    v_mov_b32 v15, 0
    v_mov_b32 v15, 0
    v_mov_b32 v15, 0
    v_mov_b32 v15, 0
L_mret_27:
    buffer_load_dwordx4 v[0:3], v117, s[8:11], s23 offen sc1
    s_add_u32 s45, s45, 1
    s_cmp_lt_u32 s45, 0x10000
    s_cselect_b32 s56, -2, -1
    s_nop 3
    v_mov_b32 v32, 0
    v_mov_b32 v33, 0
    v_mov_b32 v34, 0
    v_mov_b32 v35, 0
    s_waitcnt vmcnt(2)
    v_max3_u32 v15, v0, v1, v2
    v_max_u32 v15, v15, v3
    v_cmp_lt_u32 vcc, s56, v15
    v_smfmac_f32_16x16x64_bf16 v[32:35], v[0:3], v[80:87], v116
    s_cbranch_vccnz L_mret_27
    ds_write_b128 v117, v[0:3] offset:2048
    v_smfmac_f32_16x16x64_bf16 v[36:39], v[0:3], v[56:63], v116
    buffer_load_dwordx4 v[4:7], v117, s[8:11], s48 offen nt
    v_smfmac_f32_16x16x64_bf16 v[40:43], v[0:3], v[64:71], v116
    buffer_load_dwordx4 v117, s[8:11], s48 offen nt lds
    s_mov_b32 m0, 12288
    v_smfmac_f32_16x16x64_bf16 v[44:47], v[0:3], v[72:79], v116
    s_waitcnt lgkmcnt(0)
    s_barrier
    ds_read_b128 v[8:11], v117 offset:3072
    v_smfmac_f32_16x16x64_bf16 v[48:51], v[0:3], a[192:199], v116
    ds_read_b128 v[16:19], v117
    ds_read_b128 v[20:23], v117 offset:1024
    v_smfmac_f32_16x16x64_bf16 v[52:55], v[0:3], a[200:207], v116
    ds_read_b128 v[80:83], v117 offset:14336
    s_waitcnt lgkmcnt(3)
    v_smfmac_f32_16x16x64_bf16 v[32:35], v[8:11], a[0:7], v116
    ds_read_b128 v[84:87], v117 offset:15360
    v_smfmac_f32_16x16x64_bf16 v[36:39], v[8:11], a[8:15], v116
    ds_read_b128 v[56:59], v117 offset:8192
    s_waitcnt lgkmcnt(4)
    v_smfmac_f32_16x16x64_bf16 v[32:35], v[16:19], a[32:39], v116
    ds_read_b128 v[60:63], v117 offset:9216
    v_smfmac_f32_16x16x64_bf16 v[36:39], v[16:19], a[40:47], v116
    ds_read_b128 v[64:67], v117 offset:10240
    s_waitcnt lgkmcnt(5)
    v_smfmac_f32_16x16x64_bf16 v[32:35], v[20:23], a[64:71], v116
    ds_read_b128 v[68:71], v117 offset:11264
    v_smfmac_f32_16x16x64_bf16 v[36:39], v[20:23], a[72:79], v116
    buffer_store_dwordx4 v[112:115], v117, s[8:11], s32 offen sc1
    v_smfmac_f32_16x16x64_bf16 v[40:43], v[8:11], a[96:103], v116
    ds_read_b128 v[72:75], v117 offset:12288
    v_smfmac_f32_16x16x64_bf16 v[40:43], v[16:19], a[128:135], v116
    ds_read_b128 v[76:79], v117 offset:13312
    v_smfmac_f32_16x16x64_bf16 v[40:43], v[20:23], a[160:167], v116
    s_waitcnt vmcnt(2)
    v_max3_u32 v15, v4, v5, v6
    v_smfmac_f32_16x16x64_bf16 v[44:47], v[8:11], a[104:111], v116
    v_max_u32 v15, v15, v7
    v_smfmac_f32_16x16x64_bf16 v[44:47], v[16:19], a[136:143], v116
    s_waitcnt vmcnt(1) lgkmcnt(0)
    v_cmp_lt_u32 vcc, s56, v15
    v_smfmac_f32_16x16x64_bf16 v[44:47], v[20:23], a[168:175], v116
    s_cbranch_vccnz L_mret_28
L_mgo_29:
    v_smfmac_f32_16x16x64_bf16 v[44:47], v[4:7], v[24:31], v116
    s_barrier
    ds_read_b128 v[12:15], v117 offset:7168
    v_smfmac_f32_16x16x64_bf16 v[32:35], v[4:7], v[88:95], v116
    ds_read_b128 v[24:27], v117 offset:4096
    v_smfmac_f32_16x16x64_bf16 v[36:39], v[4:7], v[96:103], v116
    ds_read_b128 v[28:31], v117 offset:5120
    v_smfmac_f32_16x16x64_bf16 v[40:43], v[4:7], v[104:111], v116
    ds_read_b128 v[88:91], v117 offset:28672
    s_waitcnt lgkmcnt(3)
    v_smfmac_f32_16x16x64_bf16 v[32:35], v[12:15], a[16:23], v116
    ds_read_b128 v[92:95], v117 offset:29696
    s_waitcnt lgkmcnt(3)
    v_smfmac_f32_16x16x64_bf16 v[32:35], v[24:27], a[48:55], v116
    buffer_load_dwordx4 v117, s[8:11], s30 offen lds
    s_waitcnt lgkmcnt(2)
    v_smfmac_f32_16x16x64_bf16 v[32:35], v[28:31], a[80:87], v116
    ds_read_b128 v[96:99], v117 offset:23552
    v_smfmac_f32_16x16x64_bf16 v[36:39], v[12:15], a[24:31], v116
    ds_read_b128 v[100:103], v117 offset:23552
    v_smfmac_f32_16x16x64_bf16 v[36:39], v[24:27], a[56:63], v116
    buffer_load_dwordx4 v117, s[8:11], s30 offen offset:1024 lds
    s_add_u32 m0, s52, 0x6000
    v_add_f32 v32, v32, v34
    v_smfmac_f32_16x16x64_bf16 v[36:39], v[28:31], a[88:95], v116
    ds_read_b128 v[104:107], v117 offset:23552
    v_add_f32 v33, v33, v35
    v_smfmac_f32_16x16x64_bf16 v[40:43], v[12:15], a[112:119], v116
    ds_read_b128 v[108:111], v117 offset:23552
    v_mul_f32 v32, s34, v32
    v_smfmac_f32_16x16x64_bf16 v[40:43], v[24:27], a[144:151], v116
    s_waitcnt lgkmcnt(4)
    buffer_load_dwordx4 v117, s[8:11], s31 offen lds
    v_mul_f32 v33, s34, v33
    v_smfmac_f32_16x16x64_bf16 v[40:43], v[28:31], a[176:183], v116
    ds_read_b128 v[0:3], v124
    v_add_f32 v36, v36, v38
    v_smfmac_f32_16x16x64_bf16 v[48:51], v[4:7], a[208:215], v116
    v_add_f32 v37, v37, v39
    v_smfmac_f32_16x16x64_bf16 v[52:55], v[4:7], a[216:223], v116
    buffer_load_dwordx4 v117, s[8:11], s31 offen offset:1024 lds
    s_mov_b32 m0, 6144
    v_mul_f32 v36, s34, v36
    v_smfmac_f32_16x16x64_bf16 v[44:47], v[12:15], a[120:127], v116
    ds_read_b128 v[4:7], v124 offset:1024
    v_mul_f32 v37, s34, v37
    v_smfmac_f32_16x16x64_bf16 v[44:47], v[24:27], a[152:159], v116
    v_cvt_pk_bf16_f32 v34, v32, v36
    v_smfmac_f32_16x16x64_bf16 v[44:47], v[28:31], a[184:191], v116
    v_cvt_pk_bf16_f32 v35, v33, v37
    v_add_f32 v40, v40, v42
    v_smfmac_f32_16x16x64_bf16 v[48:51], v[8:11], a[224:231], v116
    ds_write2_b32 v120, v34, v35 offset0:32 offset1:48
    v_add_f32 v41, v41, v43
    v_smfmac_f32_16x16x64_bf16 v[52:55], v[8:11], a[232:239], v116
    v_add_f32 v44, v44, v46
    v_add_f32 v45, v45, v47
    v_cvt_pk_bf16_f32 v113, v40, v44
    v_cvt_pk_bf16_f32 v115, v41, v45
    v_smfmac_f32_16x16x64_bf16 v[48:51], v[12:15], a[240:247], v116
    ds_write2_b32 v120, v113, v115 offset0:0 offset1:16
    v_smfmac_f32_16x16x64_bf16 v[52:55], v[12:15], a[248:255], v116
    s_cmp_eq_u32 s22, 63
    s_cbranch_scc1 L_chain_last_f
    v_smfmac_f32_16x16x64_bf16 v[48:51], v[16:19], v[128:135], v116
    buffer_store_dword v126, v119, s[8:11], s55 offen
    v_smfmac_f32_16x16x64_bf16 v[48:51], v[20:23], v[160:167], v116
    v_smfmac_f32_16x16x64_bf16 v[48:51], v[24:27], v[144:151], v116
    s_waitcnt lgkmcnt(0)
    s_barrier
    v_smfmac_f32_16x16x64_bf16 v[48:51], v[28:31], v[176:183], v116
    ds_read_b128 v[32:35], v121 offset:16384
    ds_read_b128 v[36:39], v121 offset:17408
    v_smfmac_f32_16x16x64_bf16 v[52:55], v[16:19], v[136:143], v116
    ds_read_b128 v[40:43], v121 offset:18432
    ds_read_b128 v[44:47], v121 offset:19456
    v_smfmac_f32_16x16x64_bf16 v[52:55], v[20:23], v[168:175], v116
    ds_read_b128 v[8:11], v124 offset:32768
    v_add_f32 v48, v48, v50
    v_smfmac_f32_16x16x64_bf16 v[52:55], v[24:27], v[152:159], v116
    ds_read_b128 v[12:15], v124 offset:33792
    v_add_f32 v49, v49, v51
    v_smfmac_f32_16x16x64_bf16 v[52:55], v[28:31], v[184:191], v116
    s_waitcnt lgkmcnt(5)
    v_cvt_pk_bf16_f32 v112, v48, v49
    v_mfma_f32_16x16x32_bf16 v[56:59], v[56:59], v[32:35], 0
    s_waitcnt lgkmcnt(4)
    v_mov_b32 v48, s50
    v_mov_b32 v49, s50
    v_mfma_f32_16x16x32_bf16 v[56:59], v[60:63], v[36:39], v[56:59]
    ds_read_b128 v[16:19], v124 offset:2048
    s_waitcnt lgkmcnt(4)
    v_mov_b32 v50, s50
    v_mov_b32 v51, s50
    v_mfma_f32_16x16x32_bf16 v[56:59], v[64:67], v[40:43], v[56:59]
    ds_read_b128 v[20:23], v124 offset:3072
    s_waitcnt lgkmcnt(4)
    v_add_f32 v52, v52, v54
    v_mfma_f32_16x16x32_bf16 v[56:59], v[68:71], v[44:47], v[56:59]
    ds_read_b128 v[24:27], v124 offset:4096
    v_add_f32 v53, v53, v55
    v_mfma_f32_16x16x32_bf16 v[60:63], v[72:75], v[32:35], 0
    ds_read_b128 v[28:31], v124 offset:5120
    v_cvt_pk_bf16_f32 v114, v52, v53
    v_mov_b32 v53, 0
    v_mfma_f32_16x16x32_bf16 v[60:63], v[76:79], v[36:39], v[60:63]
    v_exp_f32 v56, v56
    v_mfma_f32_16x16x32_bf16 v[60:63], v[80:83], v[40:43], v[60:63]
    v_exp_f32 v57, v57
    v_mfma_f32_16x16x32_bf16 v[60:63], v[84:87], v[44:47], v[60:63]
    v_exp_f32 v58, v58
    v_mfma_f32_16x16x32_bf16 v[64:67], v[32:35], v[32:35], 0
    v_exp_f32 v59, v59
    v_cvt_pk_bf16_f32 v68, v56, v57
    v_mfma_f32_16x16x32_bf16 v[64:67], v[36:39], v[36:39], v[64:67]
    v_exp_f32 v60, v60
    v_cvt_pk_bf16_f32 v69, v58, v59
    v_mfma_f32_16x16x32_bf16 v[64:67], v[40:43], v[40:43], v[64:67]
    v_exp_f32 v61, v61
    v_mfma_f32_16x16x32_bf16 v[64:67], v[44:47], v[44:47], v[64:67]
    v_exp_f32 v62, v62
    v_exp_f32 v63, v63
    v_cvt_pk_bf16_f32 v70, v60, v61
    v_cvt_pk_bf16_f32 v71, v62, v63
    s_nop 1
    v_mfma_f32_16x16x32_bf16 v[72:75], v[88:91], v[68:71], 0
    s_nop 0
    v_exp_f32 v64, v64
    v_mfma_f32_16x16x32_bf16 v[76:79], v[92:95], v[68:71], 0
    v_exp_f32 v65, v65
    v_mfma_f32_16x16x32_bf16 v[80:83], v[48:51], v[68:71], 0
    v_cvt_pk_bf16_f32 v52, v64, v65
    s_nop 1
    v_mfma_f32_16x16x16_bf16 v[72:75], v[112:113], v[52:53], v[72:75]
    ds_read_b128 v[32:35], v124 offset:6144
    v_mfma_f32_16x16x16_bf16 v[76:79], v[114:115], v[52:53], v[76:79]
    ds_read_b128 v[36:39], v124 offset:7168
    v_mfma_f32_16x16x16_bf16 v[80:83], v[48:49], v[52:53], v[80:83]
L_norm_30:
    s_mov_b64 vcc, s[36:37]
    v_mov_b32 v122, v122
    v_mov_b32 v122, v122
    v_mov_b32 v122, v122
    v_cndmask_b32_dpp v76, v72, v76, vcc quad_perm:[2,3,2,3] row_mask:0xf bank_mask:0xf
    v_cndmask_b32_dpp v77, v73, v77, vcc quad_perm:[2,3,2,3] row_mask:0xf bank_mask:0xf
    v_cndmask_b32_dpp v78, v74, v78, vcc quad_perm:[2,3,2,3] row_mask:0xf bank_mask:0xf
    v_cndmask_b32_dpp v79, v75, v79, vcc quad_perm:[2,3,2,3] row_mask:0xf bank_mask:0xf
    v_rcp_f32_dpp v84, v80 quad_perm:[2,3,2,3] row_mask:0xf bank_mask:0xf
    s_nop 0
    v_pk_mul_f32 v[76:77], v[76:77], v[84:85] op_sel_hi:[1,0]
    v_pk_mul_f32 v[78:79], v[78:79], v[84:85] op_sel_hi:[1,0]
    v_cvt_pk_bf16_f32 v72, v76, v77
    v_cvt_pk_bf16_f32 v73, v78, v79
    ds_write_b64 v122, v[72:73] offset:21504
    v_max_f32_dpp v86, v80, v84 quad_perm:[2,3,2,3] row_mask:0xf bank_mask:0xf
    v_mov_b32_dpp v60, v72 quad_perm:[0,1,0,1] row_mask:0xf bank_mask:0xf
    v_mov_b32_dpp v61, v73 quad_perm:[0,1,0,1] row_mask:0xf bank_mask:0xf
    v_cmp_lt_f32 vcc, s35, v86
    v_mov_b32_dpp v62, v72 quad_perm:[2,3,2,3] row_mask:0xf bank_mask:0xf
    v_mov_b32_dpp v63, v73 quad_perm:[2,3,2,3] row_mask:0xf bank_mask:0xf
    s_nop 1
    v_smfmac_f32_16x16x64_bf16 v[96:99], v[60:63], v[192:199], v116
    s_cbranch_vccnz L_smax_31
    v_smfmac_f32_16x16x64_bf16 v[100:103], v[60:63], v[224:231], v116
    s_waitcnt lgkmcnt(0)
    s_barrier
    ds_read_b128 v[92:95], v127 offset:22016
    ds_read_b128 v[80:83], v127 offset:20480
    ds_read_b128 v[84:87], v127 offset:20992
    v_smfmac_f32_16x16x64_bf16 v[104:107], v[60:63], v[0:7], v116
    ds_read_b128 v[40:43], v124 offset:34816
    v_smfmac_f32_16x16x64_bf16 v[108:111], v[60:63], v[8:15], v116
    ds_read_b128 v[56:59], v124 offset:36864
    s_waitcnt lgkmcnt(4)
    v_smfmac_f32_16x16x64_bf16 v[96:99], v[92:95], v[200:207], v116
    s_waitcnt lgkmcnt(3)
    v_smfmac_f32_16x16x64_bf16 v[96:99], v[80:83], v[208:215], v116
    ds_read_b128 v[44:47], v124 offset:35840
    s_waitcnt lgkmcnt(3)
    v_smfmac_f32_16x16x64_bf16 v[96:99], v[84:87], v[216:223], v116
    ds_read_b128 v[68:71], v124 offset:39936
    v_smfmac_f32_16x16x64_bf16 v[100:103], v[92:95], v[232:239], v116
    ds_read_b128 v[64:67], v124 offset:38912
    v_smfmac_f32_16x16x64_bf16 v[100:103], v[80:83], v[240:247], v116
    ds_read_b128 v[60:63], v124 offset:37888
    v_cvt_pk_bf16_f32 v72, v96, v98
    v_smfmac_f32_16x16x64_bf16 v[100:103], v[84:87], v[248:255], v116
    v_and_or_b32 v72, v72, -2, s33
    v_smfmac_f32_16x16x64_bf16 v[104:107], v[92:95], v[16:23], v116
    v_cvt_pk_bf16_f32 v74, v97, v99
    v_smfmac_f32_16x16x64_bf16 v[104:107], v[80:83], v[24:31], v116
    v_cvt_pk_bf16_f32 v73, v100, v102
    v_cvt_pk_bf16_f32 v75, v101, v103
    v_smfmac_f32_16x16x64_bf16 v[104:107], v[84:87], v[32:39], v116
    buffer_store_dwordx4 v[72:75], v118, s[8:11], s25 offen
    s_waitcnt lgkmcnt(3)
    v_smfmac_f32_16x16x64_bf16 v[108:111], v[92:95], v[40:47], v116
    s_waitcnt lgkmcnt(0)
    v_smfmac_f32_16x16x64_bf16 v[108:111], v[80:83], v[56:63], v116
    v_cvt_pk_bf16_f32 v76, v104, v106
    v_smfmac_f32_16x16x64_bf16 v[108:111], v[84:87], v[64:71], v116
    v_and_or_b32 v76, v76, -2, s33
    v_cvt_pk_bf16_f32 v78, v105, v107
    v_mov_b32 v122, v122
    v_mov_b32 v122, v122
    v_mov_b32 v122, v122
    v_mov_b32 v122, v122
    v_mov_b32 v122, v122
    v_mov_b32 v122, v122
    v_cvt_pk_bf16_f32 v77, v108, v110
    v_cvt_pk_bf16_f32 v79, v109, v111
    buffer_store_dwordx4 v[76:79], v118, s[8:11], s26 offen
    ds_read_b128 v[80:83], v123
    ds_read_b128 v[84:87], v123 offset:1024
    ds_read_b128 v[56:59], v123 offset:2048
    ds_read_b128 v[60:63], v123 offset:3072
    ds_read_b128 v[64:67], v123 offset:32768
    ds_read_b128 v[68:71], v123 offset:33792
    ds_read_b128 v[72:75], v123 offset:34816
    ds_read_b128 v[76:79], v123 offset:35840
    ds_read_b128 v[88:91], v123 offset:4096
    ds_read_b128 v[92:95], v123 offset:5120
    ds_read_b128 v[96:99], v123 offset:6144
    ds_read_b128 v[100:103], v123 offset:7168
    ds_read_b128 v[104:107], v123 offset:36864
    ds_read_b128 v[108:111], v123 offset:37888
    ds_read_b128 v[24:27], v123 offset:38912
    ds_read_b128 v[28:31], v123 offset:39936
    s_add_u32 s30, s30, 0x40000
    s_add_u32 s31, s31, 0x40000
    s_add_u32 s32, s32, 0x20000
    s_add_u32 s23, s24, 2048
    s_add_u32 s48, s23, 4096
    s_xor_b32 s25, s25, 0x40000
    s_xor_b32 s26, s26, 0x40000
    s_mov_b32 s35, 0x49800000
    s_add_u32 s22, s22, 1
    v_cndmask_b32 v12, 0, v125, s[68:69]
    v_cndmask_b32 v13, 0, v125, s[70:71]
    v_cndmask_b32 v14, 0, v125, s[72:73]
    v_cndmask_b32 v15, 0, v125, s[74:75]
    v_mov_b32 v54, 0
    v_mov_b32 v55, 0
    v_mov_b32 v52, 0
    v_mov_b32 v52, 0
    v_mov_b32 v52, 0
    v_mov_b32 v52, 0
    v_mov_b32 v52, 0
    v_mov_b32 v52, 0
    v_mov_b32 v52, 0
    v_mov_b32 v52, 0
    v_mov_b32 v52, 0
    v_mov_b32 v52, 0
    v_mov_b32 v52, 0
    v_mov_b32 v52, 0
    v_mov_b32 v52, 0
    v_mov_b32 v52, 0
    v_mov_b32 v52, 0
    v_mov_b32 v52, 0
    v_mov_b32 v52, 0
    v_mov_b32 v52, 0
    v_mov_b32 v52, 0
    buffer_load_dwordx4 v[4:7], v117, s[8:11], s29 offen nt
    buffer_load_dwordx4 v[8:11], v117, s[8:11], s53 offen nt
    buffer_load_dwordx4 v[16:19], v117, s[8:11], s29 offen offset:2048 nt
    buffer_load_dwordx4 v[20:23], v117, s[8:11], s53 offen offset:2048 nt
    v_mov_b32 v52, 0
    v_mov_b32 v52, 0
    v_mov_b32 v52, 0
    v_mov_b32 v52, 0
    v_mov_b32 v52, 0
    v_mov_b32 v52, 0
    v_mov_b32 v52, 0
    v_mov_b32 v52, 0
    v_mov_b32 v52, 0
    v_mov_b32 v52, 0
    v_mov_b32 v52, 0
    v_mov_b32 v52, 0
    v_mov_b32 v52, 0
    v_mov_b32 v52, 0
    v_mov_b32 v52, 0
    v_mov_b32 v52, 0
    v_mov_b32 v52, 0
    v_mov_b32 v52, 0
    v_mov_b32 v52, 0
    v_mov_b32 v52, 0
    v_mov_b32 v52, 0
    v_mov_b32 v52, 0
    v_mov_b32 v52, 0
    v_mov_b32 v52, 0
    v_mov_b32 v52, 0
    v_mov_b32 v52, 0
    v_mov_b32 v52, 0
    v_mov_b32 v52, 0
    v_mov_b32 v52, 0
    v_mov_b32 v52, 0
    v_mov_b32 v52, 0
    v_mov_b32 v52, 0
    v_mov_b32 v52, 0
    v_mov_b32 v52, 0
    v_mov_b32 v52, 0
    v_mov_b32 v52, 0
    v_mov_b32 v52, 0
    v_mov_b32 v52, 0
    v_mov_b32 v52, 0
    v_mov_b32 v52, 0
    buffer_load_dwordx4 v[32:35], v117, s[8:11], s29 offen sc1
    buffer_load_dwordx4 v[36:39], v117, s[8:11], s53 offen sc1
    buffer_load_dwordx4 v[40:43], v117, s[8:11], s29 offen offset:2048 sc1
    buffer_load_dwordx4 v[44:47], v117, s[8:11], s53 offen offset:2048 sc1
    v_mov_b32 v52, 0
L_rl_32:
    s_waitcnt vmcnt(7)
    v_mfma_f32_16x16x32_bf16 v[48:51], v[4:7], v[12:15], 0
    v_xor_b32 v52, s33, v4
    s_waitcnt vmcnt(6)
    v_mfma_f32_16x16x32_bf16 v[48:51], v[8:11], v[12:15], v[48:51]
    v_xor_b32 v53, s33, v8
    v_or_b32 v52, v52, v53
    s_waitcnt vmcnt(5)
    v_mfma_f32_16x16x32_bf16 v[48:51], v[16:19], v[12:15], v[48:51]
    v_xor_b32 v53, s33, v16
    v_or_b32 v52, v52, v53
    s_waitcnt vmcnt(4)
    v_mfma_f32_16x16x32_bf16 v[48:51], v[20:23], v[12:15], v[48:51]
    v_xor_b32 v53, s33, v20
    v_or_b32 v52, v52, v53
    v_and_b32 v52, 1, v52
    v_cmp_ne_u32 vcc, 0, v52
    s_cbranch_vccnz L_rslow_33
L_rgo_34:
    s_nop 2
    v_permlane32_swap_b32 v48, v50
    v_permlane32_swap_b32 v49, v51
    v_pk_add_f32 v[48:49], v[48:49], v[50:51]
    s_mov_b64 exec, s[38:39]
    v_cvt_pk_bf16_f32 v12, v48, v49
    v_min_u32 v12, 0xfffffffe, v12
    buffer_store_dword v12, v119, s[8:11], s24 offen
    s_mov_b64 exec, -1
    s_add_u32 s24, s24, 8192
    s_bitset0_b32 s24, 15
    s_xor_b32 s55, s24, 16384
    s_xor_b32 s29, s29, 0x40000
    s_xor_b32 s53, s29, 1024
    s_bfe_u32 s33, s22, 0x10001
    s_waitcnt lgkmcnt(0)
    s_branch L_chain_top2_f
.p2align 6
L_chain_top3_f:
    buffer_load_dwordx4 v[0:3], v117, s[8:11], s23 offen nt
    v_mov_b32 v48, 0
    v_mov_b32 v49, 0
    v_mov_b32 v50, 0
    v_mov_b32 v51, 0
    v_mov_b32 v52, 0
    v_mov_b32 v53, 0
    v_mov_b32 v15, 0
    v_mov_b32 v15, 0
    v_mov_b32 v15, 0
    v_mov_b32 v15, 0
    v_mov_b32 v15, 0
    v_mov_b32 v15, 0
    v_mov_b32 v15, 0
    v_mov_b32 v15, 0
    v_mov_b32 v15, 0
    v_mov_b32 v15, 0
    buffer_load_dwordx4 v[0:3], v117, s[8:11], s23 offen sc1
    s_waitcnt vmcnt(3)
    v_mov_b32 v36, 0
    v_mov_b32 v37, 0
    v_mov_b32 v38, 0
    v_mov_b32 v39, 0
    v_mov_b32 v40, 0
    v_mov_b32 v41, 0
    v_mov_b32 v42, 0
    v_mov_b32 v43, 0
    v_mov_b32 v44, 0
    v_mov_b32 v45, 0
    v_mov_b32 v46, 0
    v_mov_b32 v47, 0
    v_mov_b32 v15, 0
    v_mov_b32 v15, 0
    v_mov_b32 v15, 0
    v_mov_b32 v15, 0
L_mret_35:
    buffer_load_dwordx4 v[0:3], v117, s[8:11], s23 offen sc1
    s_add_u32 s45, s45, 1
    s_cmp_lt_u32 s45, 0x10000
    s_cselect_b32 s56, -2, -1
    s_nop 3
    v_mov_b32 v32, 0
    v_mov_b32 v33, 0
    v_mov_b32 v34, 0
    v_mov_b32 v35, 0
    s_waitcnt vmcnt(2)
    v_max3_u32 v15, v0, v1, v2
    v_max_u32 v15, v15, v3
    v_cmp_lt_u32 vcc, s56, v15
    v_smfmac_f32_16x16x64_bf16 v[32:35], v[0:3], v[80:87], v116
    s_cbranch_vccnz L_mret_35
    ds_write_b128 v117, v[0:3] offset:3072
    v_smfmac_f32_16x16x64_bf16 v[36:39], v[0:3], v[56:63], v116
    buffer_load_dwordx4 v[4:7], v117, s[8:11], s48 offen nt
    v_smfmac_f32_16x16x64_bf16 v[40:43], v[0:3], v[64:71], v116
    buffer_load_dwordx4 v117, s[8:11], s48 offen nt lds
    s_mov_b32 m0, 14336
    v_smfmac_f32_16x16x64_bf16 v[44:47], v[0:3], v[72:79], v116
    s_waitcnt lgkmcnt(0)
    s_barrier
    ds_read_b128 v[8:11], v117 offset:2048
    v_smfmac_f32_16x16x64_bf16 v[48:51], v[0:3], a[192:199], v116
    ds_read_b128 v[16:19], v117 offset:1024
    ds_read_b128 v[20:23], v117
    v_smfmac_f32_16x16x64_bf16 v[52:55], v[0:3], a[200:207], v116
    ds_read_b128 v[80:83], v117 offset:14336
    s_waitcnt lgkmcnt(3)
    v_smfmac_f32_16x16x64_bf16 v[32:35], v[8:11], a[0:7], v116
    ds_read_b128 v[84:87], v117 offset:15360
    v_smfmac_f32_16x16x64_bf16 v[36:39], v[8:11], a[8:15], v116
    ds_read_b128 v[56:59], v117 offset:8192
    s_waitcnt lgkmcnt(4)
    v_smfmac_f32_16x16x64_bf16 v[32:35], v[16:19], a[32:39], v116
    ds_read_b128 v[60:63], v117 offset:9216
    v_smfmac_f32_16x16x64_bf16 v[36:39], v[16:19], a[40:47], v116
    ds_read_b128 v[64:67], v117 offset:10240
    s_waitcnt lgkmcnt(5)
    v_smfmac_f32_16x16x64_bf16 v[32:35], v[20:23], a[64:71], v116
    ds_read_b128 v[68:71], v117 offset:11264
    v_smfmac_f32_16x16x64_bf16 v[36:39], v[20:23], a[72:79], v116
    ds_read_b128 v[72:75], v117 offset:12288
    v_smfmac_f32_16x16x64_bf16 v[40:43], v[8:11], a[96:103], v116
    ds_read_b128 v[76:79], v117 offset:13312
    v_smfmac_f32_16x16x64_bf16 v[40:43], v[16:19], a[128:135], v116
    buffer_store_dwordx4 v[112:115], v117, s[8:11], s32 offen sc1
    v_smfmac_f32_16x16x64_bf16 v[40:43], v[20:23], a[160:167], v116
    s_waitcnt vmcnt(2)
    v_max3_u32 v15, v4, v5, v6
    v_smfmac_f32_16x16x64_bf16 v[44:47], v[8:11], a[104:111], v116
    v_max_u32 v15, v15, v7
    v_smfmac_f32_16x16x64_bf16 v[44:47], v[16:19], a[136:143], v116
    s_waitcnt vmcnt(1) lgkmcnt(0)
    v_cmp_lt_u32 vcc, s56, v15
    v_smfmac_f32_16x16x64_bf16 v[44:47], v[20:23], a[168:175], v116
    s_cbranch_vccnz L_mret_36
L_mgo_37:
    v_smfmac_f32_16x16x64_bf16 v[44:47], v[4:7], v[24:31], v116
    s_barrier
    ds_read_b128 v[12:15], v117 offset:6144
    v_smfmac_f32_16x16x64_bf16 v[32:35], v[4:7], v[88:95], v116
    ds_read_b128 v[24:27], v117 offset:5120
    v_smfmac_f32_16x16x64_bf16 v[36:39], v[4:7], v[96:103], v116
    ds_read_b128 v[28:31], v117 offset:4096
    v_smfmac_f32_16x16x64_bf16 v[40:43], v[4:7], v[104:111], v116
    ds_read_b128 v[88:91], v117 offset:30720
    s_waitcnt lgkmcnt(3)
    v_smfmac_f32_16x16x64_bf16 v[32:35], v[12:15], a[16:23], v116
    ds_read_b128 v[92:95], v117 offset:31744
    s_waitcnt lgkmcnt(3)
    v_smfmac_f32_16x16x64_bf16 v[32:35], v[24:27], a[48:55], v116
    ds_read_b128 v[96:99], v117 offset:23552
    s_waitcnt lgkmcnt(3)
    v_smfmac_f32_16x16x64_bf16 v[32:35], v[28:31], a[80:87], v116
    buffer_load_dwordx4 v117, s[8:11], s30 offen lds
    v_smfmac_f32_16x16x64_bf16 v[36:39], v[12:15], a[24:31], v116
    ds_read_b128 v[100:103], v117 offset:23552
    v_smfmac_f32_16x16x64_bf16 v[36:39], v[24:27], a[56:63], v116
    ds_read_b128 v[104:107], v117 offset:23552
    v_add_f32 v32, v32, v34
    v_smfmac_f32_16x16x64_bf16 v[36:39], v[28:31], a[88:95], v116
    buffer_load_dwordx4 v117, s[8:11], s30 offen offset:1024 lds
    s_add_u32 m0, s52, 0x6000
    v_add_f32 v33, v33, v35
    v_smfmac_f32_16x16x64_bf16 v[40:43], v[12:15], a[112:119], v116
    ds_read_b128 v[108:111], v117 offset:23552
    v_mul_f32 v32, s34, v32
    v_smfmac_f32_16x16x64_bf16 v[40:43], v[24:27], a[144:151], v116
    ds_read_b128 v[0:3], v124
    v_mul_f32 v33, s34, v33
    v_smfmac_f32_16x16x64_bf16 v[40:43], v[28:31], a[176:183], v116
    s_waitcnt lgkmcnt(5)
    buffer_load_dwordx4 v117, s[8:11], s31 offen lds
    v_add_f32 v36, v36, v38
    v_smfmac_f32_16x16x64_bf16 v[48:51], v[4:7], a[208:215], v116
    v_add_f32 v37, v37, v39
    v_smfmac_f32_16x16x64_bf16 v[52:55], v[4:7], a[216:223], v116
    ds_read_b128 v[4:7], v124 offset:1024
    v_mul_f32 v36, s34, v36
    v_smfmac_f32_16x16x64_bf16 v[44:47], v[12:15], a[120:127], v116
    buffer_load_dwordx4 v117, s[8:11], s31 offen offset:1024 lds
    s_mov_b32 m0, 7168
    v_mul_f32 v37, s34, v37
    v_smfmac_f32_16x16x64_bf16 v[44:47], v[24:27], a[152:159], v116
    v_cvt_pk_bf16_f32 v34, v32, v36
    v_smfmac_f32_16x16x64_bf16 v[44:47], v[28:31], a[184:191], v116
    v_cvt_pk_bf16_f32 v35, v33, v37
    v_add_f32 v40, v40, v42
    v_smfmac_f32_16x16x64_bf16 v[48:51], v[8:11], a[224:231], v116
    ds_write2_b32 v120, v34, v35 offset0:32 offset1:48
    v_add_f32 v41, v41, v43
    v_smfmac_f32_16x16x64_bf16 v[52:55], v[8:11], a[232:239], v116
    v_add_f32 v44, v44, v46
    v_add_f32 v45, v45, v47
    v_cvt_pk_bf16_f32 v113, v40, v44
    v_cvt_pk_bf16_f32 v115, v41, v45
    v_smfmac_f32_16x16x64_bf16 v[48:51], v[12:15], a[240:247], v116
    ds_write2_b32 v120, v113, v115 offset0:0 offset1:16
    v_smfmac_f32_16x16x64_bf16 v[52:55], v[12:15], a[248:255], v116
    s_cmp_eq_u32 s22, 63
    s_cbranch_scc1 L_chain_last_f
    v_smfmac_f32_16x16x64_bf16 v[48:51], v[16:19], v[128:135], v116
    v_smfmac_f32_16x16x64_bf16 v[48:51], v[20:23], v[160:167], v116
    buffer_store_dword v126, v119, s[8:11], s55 offen
    v_smfmac_f32_16x16x64_bf16 v[48:51], v[24:27], v[144:151], v116
    s_waitcnt lgkmcnt(0)
    s_barrier
    v_smfmac_f32_16x16x64_bf16 v[48:51], v[28:31], v[176:183], v116
    ds_read_b128 v[32:35], v121 offset:16384
    ds_read_b128 v[36:39], v121 offset:17408
    v_smfmac_f32_16x16x64_bf16 v[52:55], v[16:19], v[136:143], v116
    ds_read_b128 v[40:43], v121 offset:18432
    ds_read_b128 v[44:47], v121 offset:19456
    v_smfmac_f32_16x16x64_bf16 v[52:55], v[20:23], v[168:175], v116
    ds_read_b128 v[8:11], v124 offset:32768
    v_add_f32 v48, v48, v50
    v_smfmac_f32_16x16x64_bf16 v[52:55], v[24:27], v[152:159], v116
    ds_read_b128 v[12:15], v124 offset:33792
    v_add_f32 v49, v49, v51
    v_smfmac_f32_16x16x64_bf16 v[52:55], v[28:31], v[184:191], v116
    s_waitcnt lgkmcnt(5)
    v_cvt_pk_bf16_f32 v112, v48, v49
    v_mfma_f32_16x16x32_bf16 v[56:59], v[56:59], v[32:35], 0
    s_waitcnt lgkmcnt(4)
    v_mov_b32 v48, s50
    v_mov_b32 v49, s50
    v_mfma_f32_16x16x32_bf16 v[56:59], v[60:63], v[36:39], v[56:59]
    ds_read_b128 v[16:19], v124 offset:2048
    s_waitcnt lgkmcnt(4)
    v_mov_b32 v50, s50
    v_mov_b32 v51, s50
    v_mfma_f32_16x16x32_bf16 v[56:59], v[64:67], v[40:43], v[56:59]
    ds_read_b128 v[20:23], v124 offset:3072
    s_waitcnt lgkmcnt(4)
    v_add_f32 v52, v52, v54
    v_mfma_f32_16x16x32_bf16 v[56:59], v[68:71], v[44:47], v[56:59]
    ds_read_b128 v[24:27], v124 offset:4096
    v_add_f32 v53, v53, v55
    v_mfma_f32_16x16x32_bf16 v[60:63], v[72:75], v[32:35], 0
    ds_read_b128 v[28:31], v124 offset:5120
    v_cvt_pk_bf16_f32 v114, v52, v53
    v_mov_b32 v53, 0
    v_mfma_f32_16x16x32_bf16 v[60:63], v[76:79], v[36:39], v[60:63]
    v_exp_f32 v56, v56
    v_mfma_f32_16x16x32_bf16 v[60:63], v[80:83], v[40:43], v[60:63]
    v_exp_f32 v57, v57
    v_mfma_f32_16x16x32_bf16 v[60:63], v[84:87], v[44:47], v[60:63]
    v_exp_f32 v58, v58
    v_mfma_f32_16x16x32_bf16 v[64:67], v[32:35], v[32:35], 0
    v_exp_f32 v59, v59
    v_cvt_pk_bf16_f32 v68, v56, v57
    v_mfma_f32_16x16x32_bf16 v[64:67], v[36:39], v[36:39], v[64:67]
    v_exp_f32 v60, v60
    v_cvt_pk_bf16_f32 v69, v58, v59
    v_mfma_f32_16x16x32_bf16 v[64:67], v[40:43], v[40:43], v[64:67]
    v_exp_f32 v61, v61
    v_mfma_f32_16x16x32_bf16 v[64:67], v[44:47], v[44:47], v[64:67]
    v_exp_f32 v62, v62
    v_exp_f32 v63, v63
    v_cvt_pk_bf16_f32 v70, v60, v61
    v_cvt_pk_bf16_f32 v71, v62, v63
    s_nop 1
    v_mfma_f32_16x16x32_bf16 v[72:75], v[88:91], v[68:71], 0
    s_nop 0
    v_exp_f32 v64, v64
    v_mfma_f32_16x16x32_bf16 v[76:79], v[92:95], v[68:71], 0
    v_exp_f32 v65, v65
    v_mfma_f32_16x16x32_bf16 v[80:83], v[48:51], v[68:71], 0
    v_cvt_pk_bf16_f32 v52, v64, v65
    s_nop 1
    v_mfma_f32_16x16x16_bf16 v[72:75], v[112:113], v[52:53], v[72:75]
    ds_read_b128 v[32:35], v124 offset:6144
    v_mfma_f32_16x16x16_bf16 v[76:79], v[114:115], v[52:53], v[76:79]
    ds_read_b128 v[36:39], v124 offset:7168
    v_mfma_f32_16x16x16_bf16 v[80:83], v[48:49], v[52:53], v[80:83]
L_norm_38:
    s_mov_b64 vcc, s[36:37]
    v_mov_b32 v122, v122
    v_mov_b32 v122, v122
    v_mov_b32 v122, v122
    v_cndmask_b32_dpp v76, v72, v76, vcc quad_perm:[2,3,2,3] row_mask:0xf bank_mask:0xf
    v_cndmask_b32_dpp v77, v73, v77, vcc quad_perm:[2,3,2,3] row_mask:0xf bank_mask:0xf
    v_cndmask_b32_dpp v78, v74, v78, vcc quad_perm:[2,3,2,3] row_mask:0xf bank_mask:0xf
    v_cndmask_b32_dpp v79, v75, v79, vcc quad_perm:[2,3,2,3] row_mask:0xf bank_mask:0xf
    v_rcp_f32_dpp v84, v80 quad_perm:[2,3,2,3] row_mask:0xf bank_mask:0xf
    s_nop 0
    v_pk_mul_f32 v[76:77], v[76:77], v[84:85] op_sel_hi:[1,0]
    v_pk_mul_f32 v[78:79], v[78:79], v[84:85] op_sel_hi:[1,0]
    v_cvt_pk_bf16_f32 v72, v76, v77
    v_cvt_pk_bf16_f32 v73, v78, v79
    ds_write_b64 v122, v[72:73] offset:22016
    v_max_f32_dpp v86, v80, v84 quad_perm:[2,3,2,3] row_mask:0xf bank_mask:0xf
    v_mov_b32_dpp v60, v72 quad_perm:[0,1,0,1] row_mask:0xf bank_mask:0xf
    v_mov_b32_dpp v61, v73 quad_perm:[0,1,0,1] row_mask:0xf bank_mask:0xf
    v_cmp_lt_f32 vcc, s35, v86
    v_mov_b32_dpp v62, v72 quad_perm:[2,3,2,3] row_mask:0xf bank_mask:0xf
    v_mov_b32_dpp v63, v73 quad_perm:[2,3,2,3] row_mask:0xf bank_mask:0xf
    s_nop 1
    v_smfmac_f32_16x16x64_bf16 v[96:99], v[60:63], v[192:199], v116
    s_cbranch_vccnz L_smax_39
    v_smfmac_f32_16x16x64_bf16 v[100:103], v[60:63], v[224:231], v116
    s_waitcnt lgkmcnt(0)
    s_barrier
    ds_read_b128 v[92:95], v127 offset:21504
    ds_read_b128 v[80:83], v127 offset:20992
    ds_read_b128 v[84:87], v127 offset:20480
    v_smfmac_f32_16x16x64_bf16 v[104:107], v[60:63], v[0:7], v116
    ds_read_b128 v[40:43], v124 offset:34816
    v_smfmac_f32_16x16x64_bf16 v[108:111], v[60:63], v[8:15], v116
    ds_read_b128 v[56:59], v124 offset:36864
    s_waitcnt lgkmcnt(4)
    v_smfmac_f32_16x16x64_bf16 v[96:99], v[92:95], v[200:207], v116
    s_waitcnt lgkmcnt(3)
    v_smfmac_f32_16x16x64_bf16 v[96:99], v[80:83], v[208:215], v116
    ds_read_b128 v[44:47], v124 offset:35840
    s_waitcnt lgkmcnt(3)
    v_smfmac_f32_16x16x64_bf16 v[96:99], v[84:87], v[216:223], v116
    ds_read_b128 v[68:71], v124 offset:39936
    v_smfmac_f32_16x16x64_bf16 v[100:103], v[92:95], v[232:239], v116
    ds_read_b128 v[64:67], v124 offset:38912
    v_smfmac_f32_16x16x64_bf16 v[100:103], v[80:83], v[240:247], v116
    ds_read_b128 v[60:63], v124 offset:37888
    v_cvt_pk_bf16_f32 v72, v96, v98
    v_smfmac_f32_16x16x64_bf16 v[100:103], v[84:87], v[248:255], v116
    v_and_or_b32 v72, v72, -2, s33
    v_smfmac_f32_16x16x64_bf16 v[104:107], v[92:95], v[16:23], v116
    v_cvt_pk_bf16_f32 v74, v97, v99
    v_smfmac_f32_16x16x64_bf16 v[104:107], v[80:83], v[24:31], v116
    v_cvt_pk_bf16_f32 v73, v100, v102
    v_cvt_pk_bf16_f32 v75, v101, v103
    v_smfmac_f32_16x16x64_bf16 v[104:107], v[84:87], v[32:39], v116
    buffer_store_dwordx4 v[72:75], v118, s[8:11], s25 offen
    s_waitcnt lgkmcnt(3)
    v_smfmac_f32_16x16x64_bf16 v[108:111], v[92:95], v[40:47], v116
    s_waitcnt lgkmcnt(0)
    v_smfmac_f32_16x16x64_bf16 v[108:111], v[80:83], v[56:63], v116
    v_cvt_pk_bf16_f32 v76, v104, v106
    v_smfmac_f32_16x16x64_bf16 v[108:111], v[84:87], v[64:71], v116
    v_and_or_b32 v76, v76, -2, s33
    v_cvt_pk_bf16_f32 v78, v105, v107
    v_mov_b32 v122, v122
    v_mov_b32 v122, v122
    v_mov_b32 v122, v122
    v_mov_b32 v122, v122
    v_mov_b32 v122, v122
    v_mov_b32 v122, v122
    v_cvt_pk_bf16_f32 v77, v108, v110
    v_cvt_pk_bf16_f32 v79, v109, v111
    buffer_store_dwordx4 v[76:79], v118, s[8:11], s26 offen
    ds_read_b128 v[80:83], v123
    ds_read_b128 v[84:87], v123 offset:1024
    ds_read_b128 v[56:59], v123 offset:2048
    ds_read_b128 v[60:63], v123 offset:3072
    ds_read_b128 v[64:67], v123 offset:32768
    ds_read_b128 v[68:71], v123 offset:33792
    ds_read_b128 v[72:75], v123 offset:34816
    ds_read_b128 v[76:79], v123 offset:35840
    ds_read_b128 v[88:91], v123 offset:4096
    ds_read_b128 v[92:95], v123 offset:5120
    ds_read_b128 v[96:99], v123 offset:6144
    ds_read_b128 v[100:103], v123 offset:7168
    ds_read_b128 v[104:107], v123 offset:36864
    ds_read_b128 v[108:111], v123 offset:37888
    ds_read_b128 v[24:27], v123 offset:38912
    ds_read_b128 v[28:31], v123 offset:39936
    s_add_u32 s30, s30, 0x40000
    s_add_u32 s31, s31, 0x40000
    s_add_u32 s32, s32, 0x20000
    s_add_u32 s23, s24, 3072
    s_add_u32 s48, s23, 4096
    s_xor_b32 s25, s25, 0x40000
    s_xor_b32 s26, s26, 0x40000
    s_mov_b32 s35, 0x49800000
    s_add_u32 s22, s22, 1
    v_cndmask_b32 v12, 0, v125, s[68:69]
    v_cndmask_b32 v13, 0, v125, s[70:71]
    v_cndmask_b32 v14, 0, v125, s[72:73]
    v_cndmask_b32 v15, 0, v125, s[74:75]
    v_mov_b32 v54, 0
    v_mov_b32 v55, 0
    v_mov_b32 v52, 0
    v_mov_b32 v52, 0
    v_mov_b32 v52, 0
    v_mov_b32 v52, 0
    v_mov_b32 v52, 0
    v_mov_b32 v52, 0
    v_mov_b32 v52, 0
    v_mov_b32 v52, 0
    v_mov_b32 v52, 0
    v_mov_b32 v52, 0
    v_mov_b32 v52, 0
    v_mov_b32 v52, 0
    v_mov_b32 v52, 0
    v_mov_b32 v52, 0
    v_mov_b32 v52, 0
    v_mov_b32 v52, 0
    v_mov_b32 v52, 0
    v_mov_b32 v52, 0
    v_mov_b32 v52, 0
    v_mov_b32 v52, 0
    v_mov_b32 v52, 0
    v_mov_b32 v52, 0
    v_mov_b32 v52, 0
    v_mov_b32 v52, 0
    v_mov_b32 v52, 0
    v_mov_b32 v52, 0
    v_mov_b32 v52, 0
    v_mov_b32 v52, 0
    v_mov_b32 v52, 0
    v_mov_b32 v52, 0
    v_mov_b32 v52, 0
    v_mov_b32 v52, 0
    v_mov_b32 v52, 0
    v_mov_b32 v52, 0
    v_mov_b32 v52, 0
    v_mov_b32 v52, 0
    v_mov_b32 v52, 0
    v_mov_b32 v52, 0
    v_mov_b32 v52, 0
    v_mov_b32 v52, 0
    v_mov_b32 v52, 0
    v_mov_b32 v52, 0
    v_mov_b32 v52, 0
    v_mov_b32 v52, 0
    v_mov_b32 v52, 0
    v_mov_b32 v52, 0
    v_mov_b32 v52, 0
    v_mov_b32 v52, 0
    v_mov_b32 v52, 0
    buffer_load_dwordx4 v[4:7], v117, s[8:11], s29 offen nt
    buffer_load_dwordx4 v[8:11], v117, s[8:11], s53 offen nt
    buffer_load_dwordx4 v[16:19], v117, s[8:11], s29 offen offset:2048 nt
    buffer_load_dwordx4 v[20:23], v117, s[8:11], s53 offen offset:2048 nt
    v_mov_b32 v52, 0
    v_mov_b32 v52, 0
    v_mov_b32 v52, 0
    v_mov_b32 v52, 0
    v_mov_b32 v52, 0
    v_mov_b32 v52, 0
    v_mov_b32 v52, 0
    v_mov_b32 v52, 0
    v_mov_b32 v52, 0
    v_mov_b32 v52, 0
    v_mov_b32 v52, 0
    v_mov_b32 v52, 0
    v_mov_b32 v52, 0
    v_mov_b32 v52, 0
    v_mov_b32 v52, 0
    v_mov_b32 v52, 0
    v_mov_b32 v52, 0
    v_mov_b32 v52, 0
    v_mov_b32 v52, 0
    v_mov_b32 v52, 0
    v_mov_b32 v52, 0
    v_mov_b32 v52, 0
    v_mov_b32 v52, 0
    v_mov_b32 v52, 0
    v_mov_b32 v52, 0
    v_mov_b32 v52, 0
    v_mov_b32 v52, 0
    v_mov_b32 v52, 0
    v_mov_b32 v52, 0
    v_mov_b32 v52, 0
    buffer_load_dwordx4 v[32:35], v117, s[8:11], s29 offen sc1
    buffer_load_dwordx4 v[36:39], v117, s[8:11], s53 offen sc1
    buffer_load_dwordx4 v[40:43], v117, s[8:11], s29 offen offset:2048 sc1
    buffer_load_dwordx4 v[44:47], v117, s[8:11], s53 offen offset:2048 sc1
    v_mov_b32 v52, 0
L_rl_40:
    s_waitcnt vmcnt(7)
    v_mfma_f32_16x16x32_bf16 v[48:51], v[4:7], v[12:15], 0
    v_xor_b32 v52, s33, v4
    s_waitcnt vmcnt(6)
    v_mfma_f32_16x16x32_bf16 v[48:51], v[8:11], v[12:15], v[48:51]
    v_xor_b32 v53, s33, v8
    v_or_b32 v52, v52, v53
    s_waitcnt vmcnt(5)
    v_mfma_f32_16x16x32_bf16 v[48:51], v[16:19], v[12:15], v[48:51]
    v_xor_b32 v53, s33, v16
    v_or_b32 v52, v52, v53
    s_waitcnt vmcnt(4)
    v_mfma_f32_16x16x32_bf16 v[48:51], v[20:23], v[12:15], v[48:51]
    v_xor_b32 v53, s33, v20
    v_or_b32 v52, v52, v53
    v_and_b32 v52, 1, v52
    v_cmp_ne_u32 vcc, 0, v52
    s_cbranch_vccnz L_rslow_41
L_rgo_42:
    s_nop 2
    v_permlane32_swap_b32 v48, v50
    v_permlane32_swap_b32 v49, v51
    v_pk_add_f32 v[48:49], v[48:49], v[50:51]
    s_mov_b64 exec, s[38:39]
    v_cvt_pk_bf16_f32 v12, v48, v49
    v_min_u32 v12, 0xfffffffe, v12
    buffer_store_dword v12, v119, s[8:11], s24 offen
    s_mov_b64 exec, -1
    s_add_u32 s24, s24, 8192
    s_bitset0_b32 s24, 15
    s_xor_b32 s55, s24, 16384
    s_xor_b32 s29, s29, 0x40000
    s_xor_b32 s53, s29, 1024
    s_bfe_u32 s33, s22, 0x10001
    s_waitcnt lgkmcnt(0)
    s_branch L_chain_top3_f
L_chain_last_f:
    s_nop 1
    v_smfmac_f32_16x16x64_bf16 v[48:51], v[16:19], v[128:135], v116
    v_smfmac_f32_16x16x64_bf16 v[48:51], v[20:23], v[160:167], v116
    v_smfmac_f32_16x16x64_bf16 v[48:51], v[24:27], v[144:151], v116
    v_smfmac_f32_16x16x64_bf16 v[48:51], v[28:31], v[176:183], v116
    v_smfmac_f32_16x16x64_bf16 v[52:55], v[16:19], v[136:143], v116
    v_smfmac_f32_16x16x64_bf16 v[52:55], v[20:23], v[168:175], v116
    v_smfmac_f32_16x16x64_bf16 v[52:55], v[24:27], v[152:159], v116
    v_smfmac_f32_16x16x64_bf16 v[52:55], v[28:31], v[184:191], v116
    v_add_f32 v48, v48, v50
    v_add_f32 v49, v49, v51
    v_cvt_pk_bf16_f32 v112, v48, v49
    s_nop 4
    v_add_f32 v52, v52, v54
    v_add_f32 v53, v53, v55
    v_cvt_pk_bf16_f32 v114, v52, v53
    s_add_u32 s32, s32, 0x20000
    buffer_store_dwordx4 v[112:115], v117, s[8:11], s32 offen sc1
    v_mov_b32 v94, 64
    s_waitcnt vmcnt(0) lgkmcnt(0)
    s_barrier
    s_mov_b64 exec, 1
    buffer_store_dword v94, off, s[8:11], s44 sc1
    s_mov_b64 exec, -1
    s_endpgm
L_mret_14:
    s_mov_b32 s43, m0
    s_mov_b32 m0, 4096
    buffer_load_dwordx4 v[4:7], v117, s[8:11], s48 offen sc1
    buffer_load_dwordx4 v117, s[8:11], s48 offen sc1 lds
    s_mov_b32 m0, 8192
    s_mov_b32 m0, s43
    s_waitcnt vmcnt(0)
    v_max3_u32 v15, v4, v5, v6
    v_max_u32 v15, v15, v7
    v_cmp_lt_u32 vcc, s56, v15
    s_add_u32 s47, s47, 1
    s_add_u32 s49, s49, 1
    s_cmp_ge_u32 s49, 0x10000
    s_cbranch_scc1 L_mgo_15
    s_cbranch_vccnz L_mret_14
    s_branch L_mgo_15
L_smax_17:
    s_add_u32 s47, s47, 1
    s_mov_b32 s35, 0x7f800000
    s_waitcnt lgkmcnt(0)
    s_sub_u32 s43, s30, 0x40000
    s_add_u32 s40, s43, 4096
    s_nop 7
    buffer_load_dwordx4 v[56:59], v117, s[8:11], s43 offen
    buffer_load_dwordx4 v[60:63], v117, s[8:11], s43 offen offset:1024
    buffer_load_dwordx4 v[64:67], v117, s[8:11], s43 offen offset:2048
    buffer_load_dwordx4 v[68:71], v117, s[8:11], s43 offen offset:3072
    buffer_load_dwordx4 v[72:75], v117, s[8:11], s40 offen
    buffer_load_dwordx4 v[76:79], v117, s[8:11], s40 offen offset:1024
    buffer_load_dwordx4 v[80:83], v117, s[8:11], s40 offen offset:2048
    buffer_load_dwordx4 v[84:87], v117, s[8:11], s40 offen offset:3072
    ds_read_b128 v[32:35], v121 offset:16384
    ds_read_b128 v[36:39], v121 offset:17408
    ds_read_b128 v[40:43], v121 offset:18432
    ds_read_b128 v[44:47], v121 offset:19456
    v_mov_b32 v96, 0
    v_mov_b32 v97, 0
    v_mov_b32 v98, 0
    v_mov_b32 v99, 0
    v_mov_b32 v100, 0
    v_mov_b32 v101, 0
    v_mov_b32 v102, 0
    v_mov_b32 v103, 0
    v_mov_b32 v104, 0
    v_mov_b32 v105, 0
    v_mov_b32 v106, 0
    v_mov_b32 v107, 0
    v_mov_b32 v108, 0
    v_mov_b32 v109, 0
    v_mov_b32 v110, 0
    v_mov_b32 v111, 0
    s_waitcnt vmcnt(0) lgkmcnt(0)
    v_mfma_f32_16x16x32_bf16 v[56:59], v[56:59], v[32:35], 0
    v_mfma_f32_16x16x32_bf16 v[56:59], v[60:63], v[36:39], v[56:59]
    v_mfma_f32_16x16x32_bf16 v[56:59], v[64:67], v[40:43], v[56:59]
    v_mfma_f32_16x16x32_bf16 v[56:59], v[68:71], v[44:47], v[56:59]
    v_mfma_f32_16x16x32_bf16 v[60:63], v[72:75], v[32:35], 0
    v_mfma_f32_16x16x32_bf16 v[60:63], v[76:79], v[36:39], v[60:63]
    v_mfma_f32_16x16x32_bf16 v[60:63], v[80:83], v[40:43], v[60:63]
    v_mfma_f32_16x16x32_bf16 v[60:63], v[84:87], v[44:47], v[60:63]
    v_mfma_f32_16x16x32_bf16 v[64:67], v[32:35], v[32:35], 0
    v_mfma_f32_16x16x32_bf16 v[64:67], v[36:39], v[36:39], v[64:67]
    v_mfma_f32_16x16x32_bf16 v[64:67], v[40:43], v[40:43], v[64:67]
    v_mfma_f32_16x16x32_bf16 v[64:67], v[44:47], v[44:47], v[64:67]
    v_max3_f32 v84, v56, v57, v58
    v_max3_f32 v84, v84, v59, v60
    v_max3_f32 v84, v84, v61, v62
    s_nop 4
    v_max3_f32 v84, v84, v63, v64
    v_max_f32 v84, v84, v65
    v_mov_b32 v85, v84
    s_nop 1
    v_permlane32_swap_b32 v85, v84
    v_max_f32 v84, v85, v84
    v_mov_b32 v85, v84
    s_nop 1
    v_permlane16_swap_b32 v85, v84
    v_max_f32 v84, v85, v84
    v_sub_f32 v56, v56, v84
    v_sub_f32 v57, v57, v84
    v_sub_f32 v58, v58, v84
    v_sub_f32 v59, v59, v84
    v_sub_f32 v60, v60, v84
    v_sub_f32 v61, v61, v84
    v_sub_f32 v62, v62, v84
    v_sub_f32 v63, v63, v84
    v_sub_f32 v64, v64, v84
    v_sub_f32 v65, v65, v84
    v_exp_f32 v56, v56
    v_exp_f32 v57, v57
    v_exp_f32 v58, v58
    v_exp_f32 v59, v59
    v_exp_f32 v60, v60
    v_exp_f32 v61, v61
    v_exp_f32 v62, v62
    v_exp_f32 v63, v63
    v_exp_f32 v64, v64
    v_exp_f32 v65, v65
    v_cvt_pk_bf16_f32 v68, v56, v57
    v_cvt_pk_bf16_f32 v69, v58, v59
    v_cvt_pk_bf16_f32 v70, v60, v61
    v_cvt_pk_bf16_f32 v71, v62, v63
    v_cvt_pk_bf16_f32 v52, v64, v65
    s_nop 0
    v_mfma_f32_16x16x32_bf16 v[72:75], v[88:91], v[68:71], 0
    v_mfma_f32_16x16x32_bf16 v[76:79], v[92:95], v[68:71], 0
    v_mfma_f32_16x16x32_bf16 v[80:83], v[48:51], v[68:71], 0
    v_mfma_f32_16x16x16_bf16 v[72:75], v[112:113], v[52:53], v[72:75]
    v_mfma_f32_16x16x16_bf16 v[76:79], v[114:115], v[52:53], v[76:79]
    v_mfma_f32_16x16x16_bf16 v[80:83], v[48:49], v[52:53], v[80:83]
    ds_read_b128 v[32:35], v124 offset:6144
    ds_read_b128 v[36:39], v124 offset:7168
    ds_read_b128 v[40:43], v124 offset:34816
    ds_read_b128 v[44:47], v124 offset:35840
    ds_read_b128 v[56:59], v124 offset:36864
    ds_read_b128 v[64:67], v124 offset:38912
    ds_read_b128 v[68:71], v124 offset:39936
    s_waitcnt lgkmcnt(0)
    s_branch L_norm_16
L_kvw_18:
    s_add_u32 s47, s47, 1
    s_add_u32 s49, s49, 1
    s_cmp_ge_u32 s49, 0x10000
    s_cbranch_scc1 L_kvb_19
    s_sleep 4
    buffer_load_dword v125, v119, s[8:11], s28 offen sc1
    s_waitcnt vmcnt(0)
    v_cmp_eq_u32 vcc, 0, v125
    s_nop 0
    s_and_b64 vcc, vcc, s[58:59]
    s_cbranch_scc1 L_kvw_18
    s_branch L_kvb_19
L_mret_21:
    s_mov_b32 s43, m0
    s_mov_b32 m0, 5120
    buffer_load_dwordx4 v[4:7], v117, s[8:11], s48 offen sc1
    buffer_load_dwordx4 v117, s[8:11], s48 offen sc1 lds
    s_mov_b32 m0, 10240
    s_mov_b32 m0, s43
    s_waitcnt vmcnt(0)
    v_max3_u32 v15, v4, v5, v6
    v_max_u32 v15, v15, v7
    v_cmp_lt_u32 vcc, s56, v15
    s_add_u32 s47, s47, 1
    s_add_u32 s49, s49, 1
    s_cmp_ge_u32 s49, 0x10000
    s_cbranch_scc1 L_mgo_22
    s_cbranch_vccnz L_mret_21
    s_branch L_mgo_22
L_smax_24:
    s_add_u32 s47, s47, 1
    s_mov_b32 s35, 0x7f800000
    s_waitcnt lgkmcnt(0)
    s_sub_u32 s43, s30, 0x40800
    s_add_u32 s40, s43, 4096
    s_nop 7
    buffer_load_dwordx4 v[56:59], v117, s[8:11], s43 offen
    buffer_load_dwordx4 v[60:63], v117, s[8:11], s43 offen offset:1024
    buffer_load_dwordx4 v[64:67], v117, s[8:11], s43 offen offset:2048
    buffer_load_dwordx4 v[68:71], v117, s[8:11], s43 offen offset:3072
    buffer_load_dwordx4 v[72:75], v117, s[8:11], s40 offen
    buffer_load_dwordx4 v[76:79], v117, s[8:11], s40 offen offset:1024
    buffer_load_dwordx4 v[80:83], v117, s[8:11], s40 offen offset:2048
    buffer_load_dwordx4 v[84:87], v117, s[8:11], s40 offen offset:3072
    ds_read_b128 v[32:35], v121 offset:16384
    ds_read_b128 v[36:39], v121 offset:17408
    ds_read_b128 v[40:43], v121 offset:18432
    ds_read_b128 v[44:47], v121 offset:19456
    v_mov_b32 v96, 0
    v_mov_b32 v97, 0
    v_mov_b32 v98, 0
    v_mov_b32 v99, 0
    v_mov_b32 v100, 0
    v_mov_b32 v101, 0
    v_mov_b32 v102, 0
    v_mov_b32 v103, 0
    v_mov_b32 v104, 0
    v_mov_b32 v105, 0
    v_mov_b32 v106, 0
    v_mov_b32 v107, 0
    v_mov_b32 v108, 0
    v_mov_b32 v109, 0
    v_mov_b32 v110, 0
    v_mov_b32 v111, 0
    s_waitcnt vmcnt(0) lgkmcnt(0)
    v_mfma_f32_16x16x32_bf16 v[56:59], v[56:59], v[32:35], 0
    v_mfma_f32_16x16x32_bf16 v[56:59], v[60:63], v[36:39], v[56:59]
    v_mfma_f32_16x16x32_bf16 v[56:59], v[64:67], v[40:43], v[56:59]
    v_mfma_f32_16x16x32_bf16 v[56:59], v[68:71], v[44:47], v[56:59]
    v_mfma_f32_16x16x32_bf16 v[60:63], v[72:75], v[32:35], 0
    v_mfma_f32_16x16x32_bf16 v[60:63], v[76:79], v[36:39], v[60:63]
    v_mfma_f32_16x16x32_bf16 v[60:63], v[80:83], v[40:43], v[60:63]
    v_mfma_f32_16x16x32_bf16 v[60:63], v[84:87], v[44:47], v[60:63]
    v_mfma_f32_16x16x32_bf16 v[64:67], v[32:35], v[32:35], 0
    v_mfma_f32_16x16x32_bf16 v[64:67], v[36:39], v[36:39], v[64:67]
    v_mfma_f32_16x16x32_bf16 v[64:67], v[40:43], v[40:43], v[64:67]
    v_mfma_f32_16x16x32_bf16 v[64:67], v[44:47], v[44:47], v[64:67]
    v_max3_f32 v84, v56, v57, v58
    v_max3_f32 v84, v84, v59, v60
    v_max3_f32 v84, v84, v61, v62
    s_nop 4
    v_max3_f32 v84, v84, v63, v64
    v_max_f32 v84, v84, v65
    v_mov_b32 v85, v84
    s_nop 1
    v_permlane32_swap_b32 v85, v84
    v_max_f32 v84, v85, v84
    v_mov_b32 v85, v84
    s_nop 1
    v_permlane16_swap_b32 v85, v84
    v_max_f32 v84, v85, v84
    v_sub_f32 v56, v56, v84
    v_sub_f32 v57, v57, v84
    v_sub_f32 v58, v58, v84
    v_sub_f32 v59, v59, v84
    v_sub_f32 v60, v60, v84
    v_sub_f32 v61, v61, v84
    v_sub_f32 v62, v62, v84
    v_sub_f32 v63, v63, v84
    v_sub_f32 v64, v64, v84
    v_sub_f32 v65, v65, v84
    v_exp_f32 v56, v56
    v_exp_f32 v57, v57
    v_exp_f32 v58, v58
    v_exp_f32 v59, v59
    v_exp_f32 v60, v60
    v_exp_f32 v61, v61
    v_exp_f32 v62, v62
    v_exp_f32 v63, v63
    v_exp_f32 v64, v64
    v_exp_f32 v65, v65
    v_cvt_pk_bf16_f32 v68, v56, v57
    v_cvt_pk_bf16_f32 v69, v58, v59
    v_cvt_pk_bf16_f32 v70, v60, v61
    v_cvt_pk_bf16_f32 v71, v62, v63
    v_cvt_pk_bf16_f32 v52, v64, v65
    s_nop 0
    v_mfma_f32_16x16x32_bf16 v[72:75], v[88:91], v[68:71], 0
    v_mfma_f32_16x16x32_bf16 v[76:79], v[92:95], v[68:71], 0
    v_mfma_f32_16x16x32_bf16 v[80:83], v[48:51], v[68:71], 0
    v_mfma_f32_16x16x16_bf16 v[72:75], v[112:113], v[52:53], v[72:75]
    v_mfma_f32_16x16x16_bf16 v[76:79], v[114:115], v[52:53], v[76:79]
    v_mfma_f32_16x16x16_bf16 v[80:83], v[48:49], v[52:53], v[80:83]
    ds_read_b128 v[32:35], v124 offset:6144
    ds_read_b128 v[36:39], v124 offset:7168
    ds_read_b128 v[40:43], v124 offset:34816
    ds_read_b128 v[44:47], v124 offset:35840
    ds_read_b128 v[56:59], v124 offset:36864
    ds_read_b128 v[64:67], v124 offset:38912
    ds_read_b128 v[68:71], v124 offset:39936
    s_waitcnt lgkmcnt(0)
    s_branch L_norm_23
L_kvw_25:
    s_add_u32 s47, s47, 1
    s_add_u32 s49, s49, 1
    s_cmp_ge_u32 s49, 0x10000
    s_cbranch_scc1 L_kvb_26
    s_sleep 4
    buffer_load_dword v125, v119, s[8:11], s28 offen sc1
    s_waitcnt vmcnt(0)
    v_cmp_eq_u32 vcc, 0, v125
    s_nop 0
    s_and_b64 vcc, vcc, s[58:59]
    s_cbranch_scc1 L_kvw_25
    s_branch L_kvb_26
L_mret_28:
    s_mov_b32 s43, m0
    s_mov_b32 m0, 6144
    buffer_load_dwordx4 v[4:7], v117, s[8:11], s48 offen sc1
    buffer_load_dwordx4 v117, s[8:11], s48 offen sc1 lds
    s_mov_b32 m0, 12288
    s_mov_b32 m0, s43
    s_waitcnt vmcnt(0)
    v_max3_u32 v15, v4, v5, v6
    v_max_u32 v15, v15, v7
    v_cmp_lt_u32 vcc, s56, v15
    s_add_u32 s47, s47, 1
    s_add_u32 s49, s49, 1
    s_cmp_ge_u32 s49, 0x10000
    s_cbranch_scc1 L_mgo_29
    s_cbranch_vccnz L_mret_28
    s_branch L_mgo_29
L_smax_31:
    s_add_u32 s47, s47, 1
    s_mov_b32 s35, 0x7f800000
    s_waitcnt lgkmcnt(0)
    s_sub_u32 s43, s30, 0x41000
    s_add_u32 s40, s43, 4096
    s_nop 7
    buffer_load_dwordx4 v[56:59], v117, s[8:11], s43 offen
    buffer_load_dwordx4 v[60:63], v117, s[8:11], s43 offen offset:1024
    buffer_load_dwordx4 v[64:67], v117, s[8:11], s43 offen offset:2048
    buffer_load_dwordx4 v[68:71], v117, s[8:11], s43 offen offset:3072
    buffer_load_dwordx4 v[72:75], v117, s[8:11], s40 offen
    buffer_load_dwordx4 v[76:79], v117, s[8:11], s40 offen offset:1024
    buffer_load_dwordx4 v[80:83], v117, s[8:11], s40 offen offset:2048
    buffer_load_dwordx4 v[84:87], v117, s[8:11], s40 offen offset:3072
    ds_read_b128 v[32:35], v121 offset:16384
    ds_read_b128 v[36:39], v121 offset:17408
    ds_read_b128 v[40:43], v121 offset:18432
    ds_read_b128 v[44:47], v121 offset:19456
    v_mov_b32 v96, 0
    v_mov_b32 v97, 0
    v_mov_b32 v98, 0
    v_mov_b32 v99, 0
    v_mov_b32 v100, 0
    v_mov_b32 v101, 0
    v_mov_b32 v102, 0
    v_mov_b32 v103, 0
    v_mov_b32 v104, 0
    v_mov_b32 v105, 0
    v_mov_b32 v106, 0
    v_mov_b32 v107, 0
    v_mov_b32 v108, 0
    v_mov_b32 v109, 0
    v_mov_b32 v110, 0
    v_mov_b32 v111, 0
    s_waitcnt vmcnt(0) lgkmcnt(0)
    v_mfma_f32_16x16x32_bf16 v[56:59], v[56:59], v[32:35], 0
    v_mfma_f32_16x16x32_bf16 v[56:59], v[60:63], v[36:39], v[56:59]
    v_mfma_f32_16x16x32_bf16 v[56:59], v[64:67], v[40:43], v[56:59]
    v_mfma_f32_16x16x32_bf16 v[56:59], v[68:71], v[44:47], v[56:59]
    v_mfma_f32_16x16x32_bf16 v[60:63], v[72:75], v[32:35], 0
    v_mfma_f32_16x16x32_bf16 v[60:63], v[76:79], v[36:39], v[60:63]
    v_mfma_f32_16x16x32_bf16 v[60:63], v[80:83], v[40:43], v[60:63]
    v_mfma_f32_16x16x32_bf16 v[60:63], v[84:87], v[44:47], v[60:63]
    v_mfma_f32_16x16x32_bf16 v[64:67], v[32:35], v[32:35], 0
    v_mfma_f32_16x16x32_bf16 v[64:67], v[36:39], v[36:39], v[64:67]
    v_mfma_f32_16x16x32_bf16 v[64:67], v[40:43], v[40:43], v[64:67]
    v_mfma_f32_16x16x32_bf16 v[64:67], v[44:47], v[44:47], v[64:67]
    v_max3_f32 v84, v56, v57, v58
    v_max3_f32 v84, v84, v59, v60
    v_max3_f32 v84, v84, v61, v62
    s_nop 4
    v_max3_f32 v84, v84, v63, v64
    v_max_f32 v84, v84, v65
    v_mov_b32 v85, v84
    s_nop 1
    v_permlane32_swap_b32 v85, v84
    v_max_f32 v84, v85, v84
    v_mov_b32 v85, v84
    s_nop 1
    v_permlane16_swap_b32 v85, v84
    v_max_f32 v84, v85, v84
    v_sub_f32 v56, v56, v84
    v_sub_f32 v57, v57, v84
    v_sub_f32 v58, v58, v84
    v_sub_f32 v59, v59, v84
    v_sub_f32 v60, v60, v84
    v_sub_f32 v61, v61, v84
    v_sub_f32 v62, v62, v84
    v_sub_f32 v63, v63, v84
    v_sub_f32 v64, v64, v84
    v_sub_f32 v65, v65, v84
    v_exp_f32 v56, v56
    v_exp_f32 v57, v57
    v_exp_f32 v58, v58
    v_exp_f32 v59, v59
    v_exp_f32 v60, v60
    v_exp_f32 v61, v61
    v_exp_f32 v62, v62
    v_exp_f32 v63, v63
    v_exp_f32 v64, v64
    v_exp_f32 v65, v65
    v_cvt_pk_bf16_f32 v68, v56, v57
    v_cvt_pk_bf16_f32 v69, v58, v59
    v_cvt_pk_bf16_f32 v70, v60, v61
    v_cvt_pk_bf16_f32 v71, v62, v63
    v_cvt_pk_bf16_f32 v52, v64, v65
    s_nop 0
    v_mfma_f32_16x16x32_bf16 v[72:75], v[88:91], v[68:71], 0
    v_mfma_f32_16x16x32_bf16 v[76:79], v[92:95], v[68:71], 0
    v_mfma_f32_16x16x32_bf16 v[80:83], v[48:51], v[68:71], 0
    v_mfma_f32_16x16x16_bf16 v[72:75], v[112:113], v[52:53], v[72:75]
    v_mfma_f32_16x16x16_bf16 v[76:79], v[114:115], v[52:53], v[76:79]
    v_mfma_f32_16x16x16_bf16 v[80:83], v[48:49], v[52:53], v[80:83]
    ds_read_b128 v[32:35], v124 offset:6144
    ds_read_b128 v[36:39], v124 offset:7168
    ds_read_b128 v[40:43], v124 offset:34816
    ds_read_b128 v[44:47], v124 offset:35840
    ds_read_b128 v[56:59], v124 offset:36864
    ds_read_b128 v[64:67], v124 offset:38912
    ds_read_b128 v[68:71], v124 offset:39936
    s_waitcnt lgkmcnt(0)
    s_branch L_norm_30
L_rslow_33:
    buffer_load_dwordx4 v[4:7], v117, s[8:11], s29 offen sc1
    buffer_load_dwordx4 v[8:11], v117, s[8:11], s53 offen sc1
    buffer_load_dwordx4 v[16:19], v117, s[8:11], s29 offen offset:2048 sc1
    buffer_load_dwordx4 v[20:23], v117, s[8:11], s53 offen offset:2048 sc1
    s_add_u32 s46, s46, 1
    s_add_u32 s49, s49, 1
    s_cmp_ge_u32 s49, 0x10000
    s_cbranch_scc1 L_rgo_34
    s_waitcnt vmcnt(7)
    v_mfma_f32_16x16x32_bf16 v[48:51], v[32:35], v[12:15], 0
    v_xor_b32 v52, s33, v32
    s_waitcnt vmcnt(6)
    v_mfma_f32_16x16x32_bf16 v[48:51], v[36:39], v[12:15], v[48:51]
    v_xor_b32 v53, s33, v36
    v_or_b32 v52, v52, v53
    s_waitcnt vmcnt(5)
    v_mfma_f32_16x16x32_bf16 v[48:51], v[40:43], v[12:15], v[48:51]
    v_xor_b32 v53, s33, v40
    v_or_b32 v52, v52, v53
    s_waitcnt vmcnt(4)
    v_mfma_f32_16x16x32_bf16 v[48:51], v[44:47], v[12:15], v[48:51]
    v_xor_b32 v53, s33, v44
    v_or_b32 v52, v52, v53
    v_and_b32 v52, 1, v52
    v_cmp_ne_u32 vcc, 0, v52
    s_cbranch_vccz L_rgo_34
    buffer_load_dwordx4 v[32:35], v117, s[8:11], s29 offen sc1
    buffer_load_dwordx4 v[36:39], v117, s[8:11], s53 offen sc1
    buffer_load_dwordx4 v[40:43], v117, s[8:11], s29 offen offset:2048 sc1
    buffer_load_dwordx4 v[44:47], v117, s[8:11], s53 offen offset:2048 sc1
    s_add_u32 s46, s46, 1
    s_branch L_rl_32
L_mret_36:
    s_mov_b32 s43, m0
    s_mov_b32 m0, 7168
    buffer_load_dwordx4 v[4:7], v117, s[8:11], s48 offen sc1
    buffer_load_dwordx4 v117, s[8:11], s48 offen sc1 lds
    s_mov_b32 m0, 14336
    s_mov_b32 m0, s43
    s_waitcnt vmcnt(0)
    v_max3_u32 v15, v4, v5, v6
    v_max_u32 v15, v15, v7
    v_cmp_lt_u32 vcc, s56, v15
    s_add_u32 s47, s47, 1
    s_add_u32 s49, s49, 1
    s_cmp_ge_u32 s49, 0x10000
    s_cbranch_scc1 L_mgo_37
    s_cbranch_vccnz L_mret_36
    s_branch L_mgo_37
L_smax_39:
    s_add_u32 s47, s47, 1
    s_mov_b32 s35, 0x7f800000
    s_waitcnt lgkmcnt(0)
    s_sub_u32 s43, s30, 0x41800
    s_add_u32 s40, s43, 4096
    s_nop 7
    buffer_load_dwordx4 v[56:59], v117, s[8:11], s43 offen
    buffer_load_dwordx4 v[60:63], v117, s[8:11], s43 offen offset:1024
    buffer_load_dwordx4 v[64:67], v117, s[8:11], s43 offen offset:2048
    buffer_load_dwordx4 v[68:71], v117, s[8:11], s43 offen offset:3072
    buffer_load_dwordx4 v[72:75], v117, s[8:11], s40 offen
    buffer_load_dwordx4 v[76:79], v117, s[8:11], s40 offen offset:1024
    buffer_load_dwordx4 v[80:83], v117, s[8:11], s40 offen offset:2048
    buffer_load_dwordx4 v[84:87], v117, s[8:11], s40 offen offset:3072
    ds_read_b128 v[32:35], v121 offset:16384
    ds_read_b128 v[36:39], v121 offset:17408
    ds_read_b128 v[40:43], v121 offset:18432
    ds_read_b128 v[44:47], v121 offset:19456
    v_mov_b32 v96, 0
    v_mov_b32 v97, 0
    v_mov_b32 v98, 0
    v_mov_b32 v99, 0
    v_mov_b32 v100, 0
    v_mov_b32 v101, 0
    v_mov_b32 v102, 0
    v_mov_b32 v103, 0
    v_mov_b32 v104, 0
    v_mov_b32 v105, 0
    v_mov_b32 v106, 0
    v_mov_b32 v107, 0
    v_mov_b32 v108, 0
    v_mov_b32 v109, 0
    v_mov_b32 v110, 0
    v_mov_b32 v111, 0
    s_waitcnt vmcnt(0) lgkmcnt(0)
    v_mfma_f32_16x16x32_bf16 v[56:59], v[56:59], v[32:35], 0
    v_mfma_f32_16x16x32_bf16 v[56:59], v[60:63], v[36:39], v[56:59]
    v_mfma_f32_16x16x32_bf16 v[56:59], v[64:67], v[40:43], v[56:59]
    v_mfma_f32_16x16x32_bf16 v[56:59], v[68:71], v[44:47], v[56:59]
    v_mfma_f32_16x16x32_bf16 v[60:63], v[72:75], v[32:35], 0
    v_mfma_f32_16x16x32_bf16 v[60:63], v[76:79], v[36:39], v[60:63]
    v_mfma_f32_16x16x32_bf16 v[60:63], v[80:83], v[40:43], v[60:63]
    v_mfma_f32_16x16x32_bf16 v[60:63], v[84:87], v[44:47], v[60:63]
    v_mfma_f32_16x16x32_bf16 v[64:67], v[32:35], v[32:35], 0
    v_mfma_f32_16x16x32_bf16 v[64:67], v[36:39], v[36:39], v[64:67]
    v_mfma_f32_16x16x32_bf16 v[64:67], v[40:43], v[40:43], v[64:67]
    v_mfma_f32_16x16x32_bf16 v[64:67], v[44:47], v[44:47], v[64:67]
    v_max3_f32 v84, v56, v57, v58
    v_max3_f32 v84, v84, v59, v60
    v_max3_f32 v84, v84, v61, v62
    s_nop 4
    v_max3_f32 v84, v84, v63, v64
    v_max_f32 v84, v84, v65
    v_mov_b32 v85, v84
    s_nop 1
    v_permlane32_swap_b32 v85, v84
    v_max_f32 v84, v85, v84
    v_mov_b32 v85, v84
    s_nop 1
    v_permlane16_swap_b32 v85, v84
    v_max_f32 v84, v85, v84
    v_sub_f32 v56, v56, v84
    v_sub_f32 v57, v57, v84
    v_sub_f32 v58, v58, v84
    v_sub_f32 v59, v59, v84
    v_sub_f32 v60, v60, v84
    v_sub_f32 v61, v61, v84
    v_sub_f32 v62, v62, v84
    v_sub_f32 v63, v63, v84
    v_sub_f32 v64, v64, v84
    v_sub_f32 v65, v65, v84
    v_exp_f32 v56, v56
    v_exp_f32 v57, v57
    v_exp_f32 v58, v58
    v_exp_f32 v59, v59
    v_exp_f32 v60, v60
    v_exp_f32 v61, v61
    v_exp_f32 v62, v62
    v_exp_f32 v63, v63
    v_exp_f32 v64, v64
    v_exp_f32 v65, v65
    v_cvt_pk_bf16_f32 v68, v56, v57
    v_cvt_pk_bf16_f32 v69, v58, v59
    v_cvt_pk_bf16_f32 v70, v60, v61
    v_cvt_pk_bf16_f32 v71, v62, v63
    v_cvt_pk_bf16_f32 v52, v64, v65
    s_nop 0
    v_mfma_f32_16x16x32_bf16 v[72:75], v[88:91], v[68:71], 0
    v_mfma_f32_16x16x32_bf16 v[76:79], v[92:95], v[68:71], 0
    v_mfma_f32_16x16x32_bf16 v[80:83], v[48:51], v[68:71], 0
    v_mfma_f32_16x16x16_bf16 v[72:75], v[112:113], v[52:53], v[72:75]
    v_mfma_f32_16x16x16_bf16 v[76:79], v[114:115], v[52:53], v[76:79]
    v_mfma_f32_16x16x16_bf16 v[80:83], v[48:49], v[52:53], v[80:83]
    ds_read_b128 v[32:35], v124 offset:6144
    ds_read_b128 v[36:39], v124 offset:7168
    ds_read_b128 v[40:43], v124 offset:34816
    ds_read_b128 v[44:47], v124 offset:35840
    ds_read_b128 v[56:59], v124 offset:36864
    ds_read_b128 v[64:67], v124 offset:38912
    ds_read_b128 v[68:71], v124 offset:39936
    s_waitcnt lgkmcnt(0)
    s_branch L_norm_38
L_rslow_41:
    buffer_load_dwordx4 v[4:7], v117, s[8:11], s29 offen sc1
    buffer_load_dwordx4 v[8:11], v117, s[8:11], s53 offen sc1
    buffer_load_dwordx4 v[16:19], v117, s[8:11], s29 offen offset:2048 sc1
    buffer_load_dwordx4 v[20:23], v117, s[8:11], s53 offen offset:2048 sc1
    s_add_u32 s46, s46, 1
    s_add_u32 s49, s49, 1
    s_cmp_ge_u32 s49, 0x10000
    s_cbranch_scc1 L_rgo_42
    s_waitcnt vmcnt(7)
    v_mfma_f32_16x16x32_bf16 v[48:51], v[32:35], v[12:15], 0
    v_xor_b32 v52, s33, v32
    s_waitcnt vmcnt(6)
    v_mfma_f32_16x16x32_bf16 v[48:51], v[36:39], v[12:15], v[48:51]
    v_xor_b32 v53, s33, v36
    v_or_b32 v52, v52, v53
    s_waitcnt vmcnt(5)
    v_mfma_f32_16x16x32_bf16 v[48:51], v[40:43], v[12:15], v[48:51]
    v_xor_b32 v53, s33, v40
    v_or_b32 v52, v52, v53
    s_waitcnt vmcnt(4)
    v_mfma_f32_16x16x32_bf16 v[48:51], v[44:47], v[12:15], v[48:51]
    v_xor_b32 v53, s33, v44
    v_or_b32 v52, v52, v53
    v_and_b32 v52, 1, v52
    v_cmp_ne_u32 vcc, 0, v52
    s_cbranch_vccz L_rgo_42
    buffer_load_dwordx4 v[32:35], v117, s[8:11], s29 offen sc1
    buffer_load_dwordx4 v[36:39], v117, s[8:11], s53 offen sc1
    buffer_load_dwordx4 v[40:43], v117, s[8:11], s29 offen offset:2048 sc1
    buffer_load_dwordx4 v[44:47], v117, s[8:11], s53 offen offset:2048 sc1
    s_add_u32 s46, s46, 1
    s_branch L_rl_40
L_other:
    s_sub_u32 s101, s84, 1
    s_lshl_b32 s101, s101, 5
    s_add_u32 s101, s101, s85
    s_branch L_bulk
L_zero:
    v_mov_b32 v4, 0
    v_mov_b32 v5, 0
    v_mov_b32 v6, 0
    v_mov_b32 v7, 0
    v_lshlrev_b32 v1, 4, v0
    s_mov_b32 s97, 0x0
    buffer_store_dwordx4 v[4:7], v1, s[8:11], s97 offen sc1
    s_mov_b32 s97, 0x1000
    buffer_store_dwordx4 v[4:7], v1, s[8:11], s97 offen sc1
    s_mov_b32 s97, 0x2000
    buffer_store_dwordx4 v[4:7], v1, s[8:11], s97 offen sc1
    s_mov_b32 s97, 0x3000
    buffer_store_dwordx4 v[4:7], v1, s[8:11], s97 offen sc1
    s_mov_b32 s97, 0x4000
    buffer_store_dwordx4 v[4:7], v1, s[8:11], s97 offen sc1
    s_mov_b32 s97, 0x5000
    buffer_store_dwordx4 v[4:7], v1, s[8:11], s97 offen sc1
    s_mov_b32 s97, 0x6000
    buffer_store_dwordx4 v[4:7], v1, s[8:11], s97 offen sc1
    s_mov_b32 s97, 0x7000
    buffer_store_dwordx4 v[4:7], v1, s[8:11], s97 offen sc1
    s_mov_b32 s97, 0x8000
    buffer_store_dwordx4 v[4:7], v1, s[8:11], s97 offen sc1
    s_waitcnt vmcnt(0)
    s_barrier
    s_cmp_lg_u32 s100, 0
    s_cbranch_scc1 L_flag_43
    v_mov_b32 v2, 1
    s_mov_b64 exec, 1
    buffer_store_dword v2, off, s[92:95], 40 sc1
    s_mov_b64 exec, -1
L_flag_43:
    s_cmp_lg_u32 s100, 0
    s_cbranch_scc1 L_noz
    s_mov_b64 exec, 0xff
    s_mov_b32 s96, 0
L_count:
    buffer_load_dwordx2 v[2:3], v1, s[92:95], 0 offen offset:64 sc1
    s_waitcnt vmcnt(0)
    v_cmp_le_u32 vcc, 8192, v3
    v_add_u32 v2, 1, v2
    v_xor_b32 v3, 8192, v3
    v_or_b32 v2, v2, v3
    s_mov_b32 s4, vcc_lo
    v_cmp_eq_u32 vcc, 0, v2
    v_mov_b32 v2, 1
    s_nop 1
    s_cmp_eq_u32 vcc_lo, 0xff
    s_cbranch_scc1 L_propose
    v_mov_b32 v2, 2
    s_andn2_b32 s4, s4, vcc_lo
    s_cbranch_scc1 L_propose
    s_sleep 2
    s_add_u32 s96, s96, 1
    s_cmp_lt_u32 s96, 0x100
    s_cbranch_scc1 L_count
L_propose:
    v_mov_b32 v3, 0
    s_mov_b64 exec, 1
    buffer_atomic_cmpswap v[2:3], off, s[92:95], 0 offset:36
    s_mov_b64 exec, -1
    s_branch L_noz
L_fallback:
    s_waitcnt vmcnt(0) lgkmcnt(0)
    s_barrier
    v_mbcnt_lo_u32_b32 v0, -1, 0
    v_mbcnt_hi_u32_b32 v0, -1, v0
    s_lshl_b32 s96, s100, 6
    v_add_u32 v0, s96, v0
    s_mov_b32 s97, 44
    s_cmp_lg_u32 s100, 0
    s_cbranch_scc1 L_at_44
    s_mov_b64 exec, 1
    v_mov_b32 v2, 1
    buffer_atomic_add v2, off, s[92:95], s97 sc0
    s_mov_b64 exec, -1
L_at_44:
    s_cmp_lg_u32 s100, 0
    s_cbranch_scc1 L_at2_45
    s_mov_b64 exec, 1
    v_mov_b32 v1, 8
    s_waitcnt vmcnt(0)
    ds_write_b32 v1, v2
    s_waitcnt lgkmcnt(0)
    s_mov_b64 exec, -1
L_at2_45:
    s_barrier
    v_mov_b32 v1, 8
    ds_read_b32 v2, v1
    s_waitcnt lgkmcnt(0)
    v_readfirstlane_b32 s85, v2
    s_barrier
    s_sub_u32 s101, s85, 32
    s_cmp_ge_u32 s85, 32
    s_cbranch_scc1 L_bulk
    s_mov_b32 s20, s85
    s_mov_b32 s16, s92
    s_mov_b32 s17, s93
    s_mov_b32 s18, s94
    s_mov_b32 s19, s95
    s_mov_b32 s88, s20
    v_lshrrev_b32 v4, 6, v0
    s_nop 0
    v_readfirstlane_b32 s21, v4
    v_and_b32 v1, 63, v0
    v_lshrrev_b32 v2, 4, v1
    v_and_b32 v3, 15, v1
    v_lshrrev_b32 v6, 2, v3
    v_lshlrev_b32 v117, 4, v1
    s_lshl_b32 s51, s21, 10
    s_lshl_b32 s52, s21, 11
    s_load_dwordx8 s[60:67], s[0:1], 16
    s_mov_b32 s14, 0x400000
    s_mov_b32 s15, 0x20000
    s_lshl_b32 s41, s20, 8
    s_lshl_b32 s42, s20, 17
    s_lshr_b32 s43, s21, 1
    s_lshl_b32 s43, s43, 2
    v_or_b32 v5, s43, v2
    v_lshlrev_b32 v5, 1, v5
    v_xor_b32 v5, v5, v3
    v_lshrrev_b32 v14, 2, v5
    v_and_b32 v14, 2, v14
    v_lshlrev_b32 v5, 4, v5
    s_lshl_b32 s43, s21, 4
    v_add_u32 v4, s43, v2
    v_lshl_add_u32 v8, v4, 13, v5
    s_waitcnt lgkmcnt(0)
    s_lshr_b32 s27, s60, 8
    s_add_u32 s27, s27, s20
    s_and_b32 s27, s27, 3
    s_mov_b32 s12, s60
    s_and_b32 s13, s61, 0xffff
    v_xor_b32 v15, 0, v14
    v_lshl_add_u32 v15, v15, 15, v8
    s_add_u32 s43, s41, 0x0
    s_add_u32 m0, s51, 0x8000
    s_nop 0
    buffer_load_dwordx4 v15, s[12:15], s43 offen lds
    s_add_u32 s43, s41, 0x8000
    s_add_u32 m0, s51, 0x9000
    s_nop 0
    buffer_load_dwordx4 v15, s[12:15], s43 offen lds
    s_add_u32 s43, s41, 0x100000
    s_add_u32 m0, s51, 0xa000
    s_nop 0
    buffer_load_dwordx4 v15, s[12:15], s43 offen lds
    s_add_u32 s43, s41, 0x108000
    s_add_u32 m0, s51, 0xb000
    s_nop 0
    buffer_load_dwordx4 v15, s[12:15], s43 offen lds
    s_add_u32 s43, s41, 0x200000
    s_add_u32 m0, s51, 0xc000
    s_nop 0
    buffer_load_dwordx4 v15, s[12:15], s43 offen lds
    s_add_u32 s43, s41, 0x208000
    s_add_u32 m0, s51, 0xd000
    s_nop 0
    buffer_load_dwordx4 v15, s[12:15], s43 offen lds
    s_add_u32 s43, s41, 0x300000
    s_add_u32 m0, s51, 0xe000
    s_nop 0
    buffer_load_dwordx4 v15, s[12:15], s43 offen lds
    s_add_u32 s43, s41, 0x308000
    s_add_u32 m0, s51, 0xf000
    s_nop 0
    buffer_load_dwordx4 v15, s[12:15], s43 offen lds
    v_xor_b32 v15, 2, v14
    v_lshl_add_u32 v15, v15, 15, v8
    s_add_u32 s43, s41, 0x0
    s_add_u32 m0, s51, 0x10000
    s_nop 0
    buffer_load_dwordx4 v15, s[12:15], s43 offen lds
    s_add_u32 s43, s41, 0x8000
    s_add_u32 m0, s51, 0x11000
    s_nop 0
    buffer_load_dwordx4 v15, s[12:15], s43 offen lds
    s_add_u32 s43, s41, 0x100000
    s_add_u32 m0, s51, 0x12000
    s_nop 0
    buffer_load_dwordx4 v15, s[12:15], s43 offen lds
    s_add_u32 s43, s41, 0x108000
    s_add_u32 m0, s51, 0x13000
    s_nop 0
    buffer_load_dwordx4 v15, s[12:15], s43 offen lds
    s_add_u32 s43, s41, 0x200000
    s_add_u32 m0, s51, 0x14000
    s_nop 0
    buffer_load_dwordx4 v15, s[12:15], s43 offen lds
    s_add_u32 s43, s41, 0x208000
    s_add_u32 m0, s51, 0x15000
    s_nop 0
    buffer_load_dwordx4 v15, s[12:15], s43 offen lds
    s_add_u32 s43, s41, 0x300000
    s_add_u32 m0, s51, 0x16000
    s_nop 0
    buffer_load_dwordx4 v15, s[12:15], s43 offen lds
    s_add_u32 s43, s41, 0x308000
    s_add_u32 m0, s51, 0x17000
    s_nop 0
    buffer_load_dwordx4 v15, s[12:15], s43 offen lds
    v_xor_b32 v15, 0, v14
    v_lshl_add_u32 v15, v15, 15, v8
    s_add_u32 s43, s41, 0x80000
    s_add_u32 m0, s51, 0x18000
    s_nop 0
    buffer_load_dwordx4 v15, s[12:15], s43 offen lds
    s_add_u32 s43, s41, 0x88000
    s_add_u32 m0, s51, 0x19000
    s_nop 0
    buffer_load_dwordx4 v15, s[12:15], s43 offen lds
    s_add_u32 s43, s41, 0x180000
    s_add_u32 m0, s51, 0x1a000
    s_nop 0
    buffer_load_dwordx4 v15, s[12:15], s43 offen lds
    s_add_u32 s43, s41, 0x188000
    s_add_u32 m0, s51, 0x1b000
    s_nop 0
    buffer_load_dwordx4 v15, s[12:15], s43 offen lds
    v_and_b32 v4, 2, v3
    v_cmp_ne_u32 vcc, 0, v4
    v_mov_b32 v4, 0x4444
    v_mov_b32 v5, 0xeeee
    v_cndmask_b32 v116, v4, v5, vcc
    v_lshrrev_b32 v5, 1, v2
    v_lshl_add_u32 v4, v6, 3, v5
    s_lshl_b32 s43, s21, 1
    v_add_u32 v4, s43, v4
    v_add_u32 v5, s20, v4
    v_and_b32 v5, 31, v5
    v_lshl_add_u32 v4, v4, 6, v5
    v_and_b32 v5, 1, v2
    v_lshl_add_u32 v4, v4, 1, v5
    v_and_b32 v5, 3, v3
    v_lshl_add_u32 v4, v4, 2, v5
    v_lshlrev_b32 v118, 4, v4
    v_and_b32 v4, 1, v2
    v_lshlrev_b32 v4, 2, v4
    v_and_b32 v7, 2, v2
    v_add_u32 v4, v4, v7
    v_and_b32 v7, 1, v6
    v_add_u32 v4, v4, v7
    v_lshl_add_u32 v4, v4, 2, v5
    v_lshlrev_b32 v4, 2, v4
    s_and_b32 s43, s21, 1
    s_lshl_b32 s43, s43, 12
    s_lshl_b32 s40, s20, 7
    s_add_u32 s43, s43, s40
    v_add_u32 v119, s43, v4
    v_sub_u32 v7, 0, v2
    v_and_b32 v7, 3, v7
    v_xor_b32 v7, v7, v6
    v_lshl_add_u32 v4, v2, 4, v7
    v_and_b32 v5, 3, v3
    v_lshl_add_u32 v4, v4, 2, v5
    s_add_u32 s43, s51, 16384
    v_lshl_add_u32 v120, v4, 2, s43
    v_sub_u32 v7, 0, v6
    v_and_b32 v7, 3, v7
    v_xor_b32 v7, v7, v2
    v_lshl_add_u32 v4, v3, 2, v7
    v_lshlrev_b32 v121, 4, v4
    v_and_b32 v5, 1, v3
    v_lshl_add_u32 v4, v6, 1, v5
    v_lshl_add_u32 v4, v2, 3, v4
    v_lshlrev_b32 v127, 4, v4
    v_and_or_b32 v122, v116, 8, v127
    s_lshl_b32 s43, s21, 13
    s_add_u32 s43, s43, 32768
    v_add_u32 v123, s43, v117
    v_add_u32 v124, 0x10000, v123
    s_mov_b32 s36, 0xcccccccc
    s_mov_b32 s37, 0xcccccccc
    s_mov_b32 s38, 0x00ff00ff
    s_mov_b32 s39, 0x00ff00ff
    s_mov_b32 s34, 0x3e0293ee
    s_mov_b32 s35, 0x49800000
    s_mov_b32 s50, 0x3f803f80
    v_and_b32 v5, 1, v2
    v_or_b32 v5, 0, v5
    v_xor_b32 v5, v5, v6
    v_and_b32 v7, 2, v5
    v_add_u32 v5, v5, v7
    v_lshlrev_b32 v5, 6, v5
    v_and_b32 v7, 3, v3
    v_lshl_add_u32 v7, v7, 4, v5
    s_lshl_b32 s43, s21, 2
    v_add_u32 v4, s43, v2
    v_lshl_add_u32 v10, v4, 10, v7
    v_and_b32 v5, 1, v2
    v_or_b32 v5, 2, v5
    v_xor_b32 v5, v5, v6
    v_and_b32 v7, 2, v5
    v_add_u32 v5, v5, v7
    v_lshlrev_b32 v5, 6, v5
    v_and_b32 v7, 3, v3
    v_lshl_add_u32 v7, v7, 4, v5
    s_lshl_b32 s43, s21, 2
    v_add_u32 v4, s43, v2
    v_lshl_add_u32 v9, v4, 10, v7
    v_and_b32 v5, 1, v2
    v_lshl_add_u32 v4, v5, 3, v6
    v_lshrrev_b32 v7, 1, v2
    v_lshl_add_u32 v4, v7, 5, v4
    v_lshlrev_b32 v4, 8, v4
    v_lshl_or_b32 v5, v5, 2, v6
    v_lshlrev_b32 v5, 5, v5
    s_lshl_b32 s43, s21, 6
    v_xor_b32 v5, s43, v5
    v_add_u32 v4, v4, v5
    v_and_b32 v5, 3, v3
    v_lshl_add_u32 v4, v5, 3, v4
    v_add_u32 v11, 32768, v4
    s_and_b32 s43, s21, 1
    s_lshl_b32 s43, s43, 12
    v_add_u32 v11, s43, v11
    v_and_b32 v5, 1, v2
    v_lshlrev_b32 v4, 4, v5
    v_lshl_add_u32 v4, v7, 2, v4
    v_and_b32 v7, 1, v6
    v_add_u32 v4, v4, v7
    s_lshl_b32 s43, s21, 5
    v_add_u32 v4, s43, v4
    v_lshlrev_b32 v4, 8, v4
    v_lshl_or_b32 v5, v5, 1, v7
    s_lshl_b32 s43, s21, 1
    s_and_b32 s43, s43, 3
    v_xor_b32 v5, s43, v5
    v_lshl_add_u32 v4, v5, 6, v4
    v_lshrrev_b32 v5, 1, v6
    v_lshl_add_u32 v4, v5, 5, v4
    v_and_b32 v5, 3, v3
    v_lshl_add_u32 v4, v5, 3, v4
    v_add_u32 v12, 32768, v4
    v_mov_b32 v16, -1
    v_mov_b32 v17, -1
    v_mov_b32 v18, -1
    v_mov_b32 v19, -1
    s_lshl_b32 s43, s20, 13
    s_add_u32 s43, s43, 0x7100000
    s_and_b32 s40, s21, 1
    s_lshl_b32 s40, s40, 12
    s_add_u32 s29, s43, s40
    s_add_u32 s43, s43, s52
    s_xor_b32 s40, s43, 0x40000
    buffer_store_dwordx4 v[16:19], v117, s[8:11], s43 offen sc1
    buffer_store_dwordx4 v[16:19], v117, s[8:11], s43 offen offset:1024 sc1
    buffer_store_dwordx4 v[16:19], v117, s[8:11], s40 offen sc1
    buffer_store_dwordx4 v[16:19], v117, s[8:11], s40 offen offset:1024 sc1
    s_mov_b32 s43, 0x7012000
    buffer_store_dword v16, v119, s[8:11], s43 offen sc1
    s_mov_b32 s43, 0x7014000
    buffer_store_dword v16, v119, s[8:11], s43 offen sc1
    s_mov_b32 s43, 0x7016000
    buffer_store_dword v16, v119, s[8:11], s43 offen sc1
    s_load_dwordx2 s[4:5], s[0:1], 8
    s_waitcnt lgkmcnt(0)
    s_and_b32 s5, s5, 0xffff
    s_mov_b32 s6, 8192
    s_mov_b32 s7, 0x20000
    v_and_b32 v20, 1, v2
    v_and_b32 v21, 1, v6
    v_lshl_add_u32 v20, v20, 1, v21
    v_lshlrev_b32 v20, 9, v20
    v_and_b32 v21, 3, v3
    v_lshl_add_u32 v20, v21, 4, v20
    v_and_b32 v21, 2, v2
    v_add_u32 v20, v20, v21
    s_and_b32 s43, s20, 1
    s_lshl_b32 s43, s43, 11
    s_bfe_u32 s40, s20, 0x20001
    s_lshl_b32 s40, s40, 7
    s_add_u32 s43, s43, s40
    s_and_b32 s40, s21, 1
    s_lshl_b32 s40, s40, 6
    s_add_u32 s43, s43, s40
    s_lshr_b32 s40, s20, 3
    s_lshl_b32 s40, s40, 2
    s_add_u32 s43, s43, s40
    v_add_u32 v20, s43, v20
    v_lshlrev_b32 v20, 1, v20
    buffer_load_dword v21, v20, s[4:7], 0 offen
    s_mov_b32 s57, 0
    s_lshl_b32 s43, s20, 13
    s_add_u32 s43, s43, s52
    s_add_u32 s30, s43, 0x1000000
    s_add_u32 s31, s43, 0x2000000
    s_lshr_b32 s43, s43, 1
    s_add_u32 s32, s43, 0x220000
    s_waitcnt vmcnt(20)
    s_barrier
    v_xor_b32 v13, 0x0, v11
    v_add_u32 v13, 0x0, v13
    ds_read_b64_tr_b16 v[32:33], v13
    ds_read_b64_tr_b16 v[34:35], v13 offset:1024
    ds_read_b64_tr_b16 v[36:37], v13 offset:16384
    ds_read_b64_tr_b16 v[38:39], v13 offset:17408
    v_xor_b32 v13, 0x20, v11
    v_add_u32 v13, 0x0, v13
    ds_read_b64_tr_b16 v[40:41], v13
    ds_read_b64_tr_b16 v[42:43], v13 offset:1024
    ds_read_b64_tr_b16 v[44:45], v13 offset:16384
    ds_read_b64_tr_b16 v[46:47], v13 offset:17408
    v_xor_b32 v13, 0x1000, v11
    v_add_u32 v13, 0x0, v13
    ds_read_b64_tr_b16 a[0:1], v13
    ds_read_b64_tr_b16 a[2:3], v13 offset:1024
    ds_read_b64_tr_b16 a[4:5], v13 offset:16384
    ds_read_b64_tr_b16 a[6:7], v13 offset:17408
    v_xor_b32 v13, 0x1020, v11
    v_add_u32 v13, 0x0, v13
    ds_read_b64_tr_b16 a[8:9], v13
    ds_read_b64_tr_b16 a[10:11], v13 offset:1024
    ds_read_b64_tr_b16 a[12:13], v13 offset:16384
    ds_read_b64_tr_b16 a[14:15], v13 offset:17408
    s_waitcnt lgkmcnt(0)
    s_barrier
    s_add_u32 s43, s41, 0x280000
    s_add_u32 m0, s51, 0x1c000
    s_nop 0
    buffer_load_dwordx4 v15, s[12:15], s43 offen lds
    s_add_u32 s43, s41, 0x288000
    s_add_u32 m0, s51, 0x1d000
    s_nop 0
    buffer_load_dwordx4 v15, s[12:15], s43 offen lds
    s_add_u32 s43, s41, 0x380000
    s_add_u32 m0, s51, 0x1e000
    s_nop 0
    buffer_load_dwordx4 v15, s[12:15], s43 offen lds
    s_add_u32 s43, s41, 0x388000
    s_add_u32 m0, s51, 0x1f000
    s_nop 0
    buffer_load_dwordx4 v15, s[12:15], s43 offen lds
    v_xor_b32 v15, 2, v14
    v_lshl_add_u32 v15, v15, 15, v8
    s_add_u32 s43, s41, 0x80000
    s_add_u32 m0, s51, 0x20000
    s_nop 0
    buffer_load_dwordx4 v15, s[12:15], s43 offen lds
    s_add_u32 s43, s41, 0x88000
    s_add_u32 m0, s51, 0x21000
    s_nop 0
    buffer_load_dwordx4 v15, s[12:15], s43 offen lds
    s_add_u32 s43, s41, 0x180000
    s_add_u32 m0, s51, 0x22000
    s_nop 0
    buffer_load_dwordx4 v15, s[12:15], s43 offen lds
    s_add_u32 s43, s41, 0x188000
    s_add_u32 m0, s51, 0x23000
    s_nop 0
    buffer_load_dwordx4 v15, s[12:15], s43 offen lds
    s_waitcnt vmcnt(20)
    s_barrier
    v_xor_b32 v13, 0x0, v11
    v_add_u32 v13, 0x8000, v13
    ds_read_b64_tr_b16 a[32:33], v13
    ds_read_b64_tr_b16 a[34:35], v13 offset:1024
    ds_read_b64_tr_b16 a[36:37], v13 offset:16384
    ds_read_b64_tr_b16 a[38:39], v13 offset:17408
    v_xor_b32 v13, 0x20, v11
    v_add_u32 v13, 0x8000, v13
    ds_read_b64_tr_b16 a[40:41], v13
    ds_read_b64_tr_b16 a[42:43], v13 offset:1024
    ds_read_b64_tr_b16 a[44:45], v13 offset:16384
    ds_read_b64_tr_b16 a[46:47], v13 offset:17408
    v_xor_b32 v13, 0x1000, v11
    v_add_u32 v13, 0x8000, v13
    ds_read_b64_tr_b16 a[64:65], v13
    ds_read_b64_tr_b16 a[66:67], v13 offset:1024
    ds_read_b64_tr_b16 a[68:69], v13 offset:16384
    ds_read_b64_tr_b16 a[70:71], v13 offset:17408
    v_xor_b32 v13, 0x1020, v11
    v_add_u32 v13, 0x8000, v13
    ds_read_b64_tr_b16 a[72:73], v13
    ds_read_b64_tr_b16 a[74:75], v13 offset:1024
    ds_read_b64_tr_b16 a[76:77], v13 offset:16384
    ds_read_b64_tr_b16 a[78:79], v13 offset:17408
    s_waitcnt lgkmcnt(0)
    s_barrier
    s_add_u32 s43, s41, 0x280000
    s_add_u32 m0, s51, 0x24000
    s_nop 0
    buffer_load_dwordx4 v15, s[12:15], s43 offen lds
    s_add_u32 s43, s41, 0x288000
    s_add_u32 m0, s51, 0x25000
    s_nop 0
    buffer_load_dwordx4 v15, s[12:15], s43 offen lds
    s_add_u32 s43, s41, 0x380000
    s_add_u32 m0, s51, 0x26000
    s_nop 0
    buffer_load_dwordx4 v15, s[12:15], s43 offen lds
    s_add_u32 s43, s41, 0x388000
    s_add_u32 m0, s51, 0x27000
    s_nop 0
    buffer_load_dwordx4 v15, s[12:15], s43 offen lds
    s_mov_b32 s12, s62
    s_and_b32 s13, s63, 0xffff
    v_xor_b32 v15, 0, v14
    v_lshl_add_u32 v15, v15, 15, v8
    s_add_u32 s43, s41, 0x0
    s_add_u32 m0, s51, 0x8000
    s_nop 0
    buffer_load_dwordx4 v15, s[12:15], s43 offen lds
    s_add_u32 s43, s41, 0x8000
    s_add_u32 m0, s51, 0x9000
    s_nop 0
    buffer_load_dwordx4 v15, s[12:15], s43 offen lds
    s_add_u32 s43, s41, 0x100000
    s_add_u32 m0, s51, 0xa000
    s_nop 0
    buffer_load_dwordx4 v15, s[12:15], s43 offen lds
    s_add_u32 s43, s41, 0x108000
    s_add_u32 m0, s51, 0xb000
    s_nop 0
    buffer_load_dwordx4 v15, s[12:15], s43 offen lds
    s_waitcnt vmcnt(12)
    s_barrier
    v_xor_b32 v13, 0x0, v11
    v_add_u32 v13, 0x10000, v13
    ds_read_b64_tr_b16 v[48:49], v13
    ds_read_b64_tr_b16 v[50:51], v13 offset:1024
    ds_read_b64_tr_b16 v[52:53], v13 offset:16384
    ds_read_b64_tr_b16 v[54:55], v13 offset:17408
    v_xor_b32 v13, 0x20, v11
    v_add_u32 v13, 0x10000, v13
    ds_read_b64_tr_b16 v[56:57], v13
    ds_read_b64_tr_b16 v[58:59], v13 offset:1024
    ds_read_b64_tr_b16 v[60:61], v13 offset:16384
    ds_read_b64_tr_b16 v[62:63], v13 offset:17408
    v_xor_b32 v13, 0x1000, v11
    v_add_u32 v13, 0x10000, v13
    ds_read_b64_tr_b16 a[16:17], v13
    ds_read_b64_tr_b16 a[18:19], v13 offset:1024
    ds_read_b64_tr_b16 a[20:21], v13 offset:16384
    ds_read_b64_tr_b16 a[22:23], v13 offset:17408
    v_xor_b32 v13, 0x1020, v11
    v_add_u32 v13, 0x10000, v13
    ds_read_b64_tr_b16 a[24:25], v13
    ds_read_b64_tr_b16 a[26:27], v13 offset:1024
    ds_read_b64_tr_b16 a[28:29], v13 offset:16384
    ds_read_b64_tr_b16 a[30:31], v13 offset:17408
    s_waitcnt lgkmcnt(0)
    s_barrier
    s_add_u32 s43, s41, 0x200000
    s_add_u32 m0, s51, 0xc000
    s_nop 0
    buffer_load_dwordx4 v15, s[12:15], s43 offen lds
    s_add_u32 s43, s41, 0x208000
    s_add_u32 m0, s51, 0xd000
    s_nop 0
    buffer_load_dwordx4 v15, s[12:15], s43 offen lds
    s_add_u32 s43, s41, 0x300000
    s_add_u32 m0, s51, 0xe000
    s_nop 0
    buffer_load_dwordx4 v15, s[12:15], s43 offen lds
    s_add_u32 s43, s41, 0x308000
    s_add_u32 m0, s51, 0xf000
    s_nop 0
    buffer_load_dwordx4 v15, s[12:15], s43 offen lds
    v_xor_b32 v15, 2, v14
    v_lshl_add_u32 v15, v15, 15, v8
    s_add_u32 s43, s41, 0x0
    s_add_u32 m0, s51, 0x10000
    s_nop 0
    buffer_load_dwordx4 v15, s[12:15], s43 offen lds
    s_add_u32 s43, s41, 0x8000
    s_add_u32 m0, s51, 0x11000
    s_nop 0
    buffer_load_dwordx4 v15, s[12:15], s43 offen lds
    s_add_u32 s43, s41, 0x100000
    s_add_u32 m0, s51, 0x12000
    s_nop 0
    buffer_load_dwordx4 v15, s[12:15], s43 offen lds
    s_add_u32 s43, s41, 0x108000
    s_add_u32 m0, s51, 0x13000
    s_nop 0
    buffer_load_dwordx4 v15, s[12:15], s43 offen lds
    s_waitcnt vmcnt(12)
    s_barrier
    v_xor_b32 v13, 0x0, v11
    v_add_u32 v13, 0x18000, v13
    ds_read_b64_tr_b16 a[48:49], v13
    ds_read_b64_tr_b16 a[50:51], v13 offset:1024
    ds_read_b64_tr_b16 a[52:53], v13 offset:16384
    ds_read_b64_tr_b16 a[54:55], v13 offset:17408
    v_xor_b32 v13, 0x20, v11
    v_add_u32 v13, 0x18000, v13
    ds_read_b64_tr_b16 a[56:57], v13
    ds_read_b64_tr_b16 a[58:59], v13 offset:1024
    ds_read_b64_tr_b16 a[60:61], v13 offset:16384
    ds_read_b64_tr_b16 a[62:63], v13 offset:17408
    v_xor_b32 v13, 0x1000, v11
    v_add_u32 v13, 0x18000, v13
    ds_read_b64_tr_b16 a[80:81], v13
    ds_read_b64_tr_b16 a[82:83], v13 offset:1024
    ds_read_b64_tr_b16 a[84:85], v13 offset:16384
    ds_read_b64_tr_b16 a[86:87], v13 offset:17408
    v_xor_b32 v13, 0x1020, v11
    v_add_u32 v13, 0x18000, v13
    ds_read_b64_tr_b16 a[88:89], v13
    ds_read_b64_tr_b16 a[90:91], v13 offset:1024
    ds_read_b64_tr_b16 a[92:93], v13 offset:16384
    ds_read_b64_tr_b16 a[94:95], v13 offset:17408
    s_waitcnt lgkmcnt(0)
    s_barrier
    s_add_u32 s43, s41, 0x200000
    s_add_u32 m0, s51, 0x14000
    s_nop 0
    buffer_load_dwordx4 v15, s[12:15], s43 offen lds
    s_add_u32 s43, s41, 0x208000
    s_add_u32 m0, s51, 0x15000
    s_nop 0
    buffer_load_dwordx4 v15, s[12:15], s43 offen lds
    s_add_u32 s43, s41, 0x300000
    s_add_u32 m0, s51, 0x16000
    s_nop 0
    buffer_load_dwordx4 v15, s[12:15], s43 offen lds
    s_add_u32 s43, s41, 0x308000
    s_add_u32 m0, s51, 0x17000
    s_nop 0
    buffer_load_dwordx4 v15, s[12:15], s43 offen lds
    v_xor_b32 v15, 0, v14
    v_lshl_add_u32 v15, v15, 15, v8
    s_add_u32 s43, s41, 0x80000
    s_add_u32 m0, s51, 0x18000
    s_nop 0
    buffer_load_dwordx4 v15, s[12:15], s43 offen lds
    s_add_u32 s43, s41, 0x88000
    s_add_u32 m0, s51, 0x19000
    s_nop 0
    buffer_load_dwordx4 v15, s[12:15], s43 offen lds
    s_add_u32 s43, s41, 0x180000
    s_add_u32 m0, s51, 0x1a000
    s_nop 0
    buffer_load_dwordx4 v15, s[12:15], s43 offen lds
    s_add_u32 s43, s41, 0x188000
    s_add_u32 m0, s51, 0x1b000
    s_nop 0
    buffer_load_dwordx4 v15, s[12:15], s43 offen lds
    s_waitcnt vmcnt(12)
    v_min_u32 v21, 0xfffffffe, v21
    s_mov_b32 s43, 0x7010000
    s_mov_b64 exec, s[38:39]
    buffer_store_dword v21, v119, s[8:11], s43 offen sc1
    s_mov_b64 exec, -1
    s_barrier
    v_xor_b32 v13, 0x0, v11
    v_add_u32 v13, 0x0, v13
    ds_read_b64_tr_b16 v[64:65], v13
    ds_read_b64_tr_b16 v[66:67], v13 offset:1024
    ds_read_b64_tr_b16 v[68:69], v13 offset:16384
    ds_read_b64_tr_b16 v[70:71], v13 offset:17408
    v_xor_b32 v13, 0x20, v11
    v_add_u32 v13, 0x0, v13
    ds_read_b64_tr_b16 v[72:73], v13
    ds_read_b64_tr_b16 v[74:75], v13 offset:1024
    ds_read_b64_tr_b16 v[76:77], v13 offset:16384
    ds_read_b64_tr_b16 v[78:79], v13 offset:17408
    v_xor_b32 v13, 0x1000, v11
    v_add_u32 v13, 0x0, v13
    ds_read_b64_tr_b16 a[96:97], v13
    ds_read_b64_tr_b16 a[98:99], v13 offset:1024
    ds_read_b64_tr_b16 a[100:101], v13 offset:16384
    ds_read_b64_tr_b16 a[102:103], v13 offset:17408
    v_xor_b32 v13, 0x1020, v11
    v_add_u32 v13, 0x0, v13
    ds_read_b64_tr_b16 a[104:105], v13
    ds_read_b64_tr_b16 a[106:107], v13 offset:1024
    ds_read_b64_tr_b16 a[108:109], v13 offset:16384
    ds_read_b64_tr_b16 a[110:111], v13 offset:17408
    s_waitcnt lgkmcnt(0)
    s_barrier
    s_add_u32 s43, s41, 0x280000
    s_add_u32 m0, s51, 0x1c000
    s_nop 0
    buffer_load_dwordx4 v15, s[12:15], s43 offen lds
    s_add_u32 s43, s41, 0x288000
    s_add_u32 m0, s51, 0x1d000
    s_nop 0
    buffer_load_dwordx4 v15, s[12:15], s43 offen lds
    s_add_u32 s43, s41, 0x380000
    s_add_u32 m0, s51, 0x1e000
    s_nop 0
    buffer_load_dwordx4 v15, s[12:15], s43 offen lds
    s_add_u32 s43, s41, 0x388000
    s_add_u32 m0, s51, 0x1f000
    s_nop 0
    buffer_load_dwordx4 v15, s[12:15], s43 offen lds
    v_xor_b32 v15, 2, v14
    v_lshl_add_u32 v15, v15, 15, v8
    s_add_u32 s43, s41, 0x80000
    s_add_u32 m0, s51, 0x20000
    s_nop 0
    buffer_load_dwordx4 v15, s[12:15], s43 offen lds
    s_add_u32 s43, s41, 0x88000
    s_add_u32 m0, s51, 0x21000
    s_nop 0
    buffer_load_dwordx4 v15, s[12:15], s43 offen lds
    s_add_u32 s43, s41, 0x180000
    s_add_u32 m0, s51, 0x22000
    s_nop 0
    buffer_load_dwordx4 v15, s[12:15], s43 offen lds
    s_add_u32 s43, s41, 0x188000
    s_add_u32 m0, s51, 0x23000
    s_nop 0
    buffer_load_dwordx4 v15, s[12:15], s43 offen lds
    s_waitcnt vmcnt(12)
    s_barrier
    v_xor_b32 v13, 0x0, v11
    v_add_u32 v13, 0x8000, v13
    ds_read_b64_tr_b16 a[128:129], v13
    ds_read_b64_tr_b16 a[130:131], v13 offset:1024
    ds_read_b64_tr_b16 a[132:133], v13 offset:16384
    ds_read_b64_tr_b16 a[134:135], v13 offset:17408
    v_xor_b32 v13, 0x20, v11
    v_add_u32 v13, 0x8000, v13
    ds_read_b64_tr_b16 a[136:137], v13
    ds_read_b64_tr_b16 a[138:139], v13 offset:1024
    ds_read_b64_tr_b16 a[140:141], v13 offset:16384
    ds_read_b64_tr_b16 a[142:143], v13 offset:17408
    v_xor_b32 v13, 0x1000, v11
    v_add_u32 v13, 0x8000, v13
    ds_read_b64_tr_b16 a[160:161], v13
    ds_read_b64_tr_b16 a[162:163], v13 offset:1024
    ds_read_b64_tr_b16 a[164:165], v13 offset:16384
    ds_read_b64_tr_b16 a[166:167], v13 offset:17408
    v_xor_b32 v13, 0x1020, v11
    v_add_u32 v13, 0x8000, v13
    ds_read_b64_tr_b16 a[168:169], v13
    ds_read_b64_tr_b16 a[170:171], v13 offset:1024
    ds_read_b64_tr_b16 a[172:173], v13 offset:16384
    ds_read_b64_tr_b16 a[174:175], v13 offset:17408
    s_waitcnt lgkmcnt(0)
    s_barrier
    s_add_u32 s43, s41, 0x280000
    s_add_u32 m0, s51, 0x24000
    s_nop 0
    buffer_load_dwordx4 v15, s[12:15], s43 offen lds
    s_add_u32 s43, s41, 0x288000
    s_add_u32 m0, s51, 0x25000
    s_nop 0
    buffer_load_dwordx4 v15, s[12:15], s43 offen lds
    s_add_u32 s43, s41, 0x380000
    s_add_u32 m0, s51, 0x26000
    s_nop 0
    buffer_load_dwordx4 v15, s[12:15], s43 offen lds
    s_add_u32 s43, s41, 0x388000
    s_add_u32 m0, s51, 0x27000
    s_nop 0
    buffer_load_dwordx4 v15, s[12:15], s43 offen lds
    s_mov_b32 s12, s64
    s_and_b32 s13, s65, 0xffff
    v_xor_b32 v15, 0, v14
    v_lshl_add_u32 v15, v15, 15, v8
    s_add_u32 s43, s41, 0x0
    s_add_u32 m0, s51, 0x8000
    s_nop 0
    buffer_load_dwordx4 v15, s[12:15], s43 offen lds
    s_add_u32 s43, s41, 0x8000
    s_add_u32 m0, s51, 0x9000
    s_nop 0
    buffer_load_dwordx4 v15, s[12:15], s43 offen lds
    s_add_u32 s43, s41, 0x100000
    s_add_u32 m0, s51, 0xa000
    s_nop 0
    buffer_load_dwordx4 v15, s[12:15], s43 offen lds
    s_add_u32 s43, s41, 0x108000
    s_add_u32 m0, s51, 0xb000
    s_nop 0
    buffer_load_dwordx4 v15, s[12:15], s43 offen lds
    s_waitcnt vmcnt(12)
    s_barrier
    v_xor_b32 v13, 0x0, v11
    v_add_u32 v13, 0x10000, v13
    ds_read_b64_tr_b16 v[80:81], v13
    ds_read_b64_tr_b16 v[82:83], v13 offset:1024
    ds_read_b64_tr_b16 v[84:85], v13 offset:16384
    ds_read_b64_tr_b16 v[86:87], v13 offset:17408
    v_xor_b32 v13, 0x20, v11
    v_add_u32 v13, 0x10000, v13
    ds_read_b64_tr_b16 v[88:89], v13
    ds_read_b64_tr_b16 v[90:91], v13 offset:1024
    ds_read_b64_tr_b16 v[92:93], v13 offset:16384
    ds_read_b64_tr_b16 v[94:95], v13 offset:17408
    v_xor_b32 v13, 0x1000, v11
    v_add_u32 v13, 0x10000, v13
    ds_read_b64_tr_b16 a[112:113], v13
    ds_read_b64_tr_b16 a[114:115], v13 offset:1024
    ds_read_b64_tr_b16 a[116:117], v13 offset:16384
    ds_read_b64_tr_b16 a[118:119], v13 offset:17408
    v_xor_b32 v13, 0x1020, v11
    v_add_u32 v13, 0x10000, v13
    ds_read_b64_tr_b16 a[120:121], v13
    ds_read_b64_tr_b16 a[122:123], v13 offset:1024
    ds_read_b64_tr_b16 a[124:125], v13 offset:16384
    ds_read_b64_tr_b16 a[126:127], v13 offset:17408
    s_waitcnt lgkmcnt(0)
    s_barrier
    s_add_u32 s43, s41, 0x200000
    s_add_u32 m0, s51, 0xc000
    s_nop 0
    buffer_load_dwordx4 v15, s[12:15], s43 offen lds
    s_add_u32 s43, s41, 0x208000
    s_add_u32 m0, s51, 0xd000
    s_nop 0
    buffer_load_dwordx4 v15, s[12:15], s43 offen lds
    s_add_u32 s43, s41, 0x300000
    s_add_u32 m0, s51, 0xe000
    s_nop 0
    buffer_load_dwordx4 v15, s[12:15], s43 offen lds
    s_add_u32 s43, s41, 0x308000
    s_add_u32 m0, s51, 0xf000
    s_nop 0
    buffer_load_dwordx4 v15, s[12:15], s43 offen lds
    v_xor_b32 v15, 2, v14
    v_lshl_add_u32 v15, v15, 15, v8
    s_add_u32 s43, s41, 0x0
    s_add_u32 m0, s51, 0x10000
    s_nop 0
    buffer_load_dwordx4 v15, s[12:15], s43 offen lds
    s_add_u32 s43, s41, 0x8000
    s_add_u32 m0, s51, 0x11000
    s_nop 0
    buffer_load_dwordx4 v15, s[12:15], s43 offen lds
    s_add_u32 s43, s41, 0x100000
    s_add_u32 m0, s51, 0x12000
    s_nop 0
    buffer_load_dwordx4 v15, s[12:15], s43 offen lds
    s_add_u32 s43, s41, 0x108000
    s_add_u32 m0, s51, 0x13000
    s_nop 0
    buffer_load_dwordx4 v15, s[12:15], s43 offen lds
    s_waitcnt vmcnt(12)
    s_barrier
    v_xor_b32 v13, 0x0, v11
    v_add_u32 v13, 0x18000, v13
    ds_read_b64_tr_b16 a[144:145], v13
    ds_read_b64_tr_b16 a[146:147], v13 offset:1024
    ds_read_b64_tr_b16 a[148:149], v13 offset:16384
    ds_read_b64_tr_b16 a[150:151], v13 offset:17408
    v_xor_b32 v13, 0x20, v11
    v_add_u32 v13, 0x18000, v13
    ds_read_b64_tr_b16 a[152:153], v13
    ds_read_b64_tr_b16 a[154:155], v13 offset:1024
    ds_read_b64_tr_b16 a[156:157], v13 offset:16384
    ds_read_b64_tr_b16 a[158:159], v13 offset:17408
    v_xor_b32 v13, 0x1000, v11
    v_add_u32 v13, 0x18000, v13
    ds_read_b64_tr_b16 a[176:177], v13
    ds_read_b64_tr_b16 a[178:179], v13 offset:1024
    ds_read_b64_tr_b16 a[180:181], v13 offset:16384
    ds_read_b64_tr_b16 a[182:183], v13 offset:17408
    v_xor_b32 v13, 0x1020, v11
    v_add_u32 v13, 0x18000, v13
    ds_read_b64_tr_b16 a[184:185], v13
    ds_read_b64_tr_b16 a[186:187], v13 offset:1024
    ds_read_b64_tr_b16 a[188:189], v13 offset:16384
    ds_read_b64_tr_b16 a[190:191], v13 offset:17408
    s_waitcnt lgkmcnt(0)
    s_barrier
    s_add_u32 s43, s41, 0x200000
    s_add_u32 m0, s51, 0x14000
    s_nop 0
    buffer_load_dwordx4 v15, s[12:15], s43 offen lds
    s_add_u32 s43, s41, 0x208000
    s_add_u32 m0, s51, 0x15000
    s_nop 0
    buffer_load_dwordx4 v15, s[12:15], s43 offen lds
    s_add_u32 s43, s41, 0x300000
    s_add_u32 m0, s51, 0x16000
    s_nop 0
    buffer_load_dwordx4 v15, s[12:15], s43 offen lds
    s_add_u32 s43, s41, 0x308000
    s_add_u32 m0, s51, 0x17000
    s_nop 0
    buffer_load_dwordx4 v15, s[12:15], s43 offen lds
    s_mov_b32 s12, s66
    s_and_b32 s13, s67, 0xffff
    s_add_u32 s43, s42, 0x0
    s_add_u32 m0, s51, 0x18000
    s_nop 0
    buffer_load_dwordx4 v10, s[12:15], s43 offen lds
    s_add_u32 s43, s42, 0x4000
    s_add_u32 m0, s51, 0x19000
    s_nop 0
    buffer_load_dwordx4 v9, s[12:15], s43 offen lds
    s_add_u32 s43, s42, 0x8000
    s_add_u32 m0, s51, 0x1a000
    s_nop 0
    buffer_load_dwordx4 v10, s[12:15], s43 offen lds
    s_add_u32 s43, s42, 0xc000
    s_add_u32 m0, s51, 0x1b000
    s_nop 0
    buffer_load_dwordx4 v9, s[12:15], s43 offen lds
    s_waitcnt vmcnt(12)
    s_barrier
    v_xor_b32 v13, 0x0, v11
    v_add_u32 v13, 0x0, v13
    ds_read_b64_tr_b16 a[192:193], v13
    ds_read_b64_tr_b16 a[194:195], v13 offset:1024
    ds_read_b64_tr_b16 a[196:197], v13 offset:16384
    ds_read_b64_tr_b16 a[198:199], v13 offset:17408
    v_xor_b32 v13, 0x20, v11
    v_add_u32 v13, 0x0, v13
    ds_read_b64_tr_b16 a[200:201], v13
    ds_read_b64_tr_b16 a[202:203], v13 offset:1024
    ds_read_b64_tr_b16 a[204:205], v13 offset:16384
    ds_read_b64_tr_b16 a[206:207], v13 offset:17408
    v_xor_b32 v13, 0x1000, v11
    v_add_u32 v13, 0x0, v13
    ds_read_b64_tr_b16 a[224:225], v13
    ds_read_b64_tr_b16 a[226:227], v13 offset:1024
    ds_read_b64_tr_b16 a[228:229], v13 offset:16384
    ds_read_b64_tr_b16 a[230:231], v13 offset:17408
    v_xor_b32 v13, 0x1020, v11
    v_add_u32 v13, 0x0, v13
    ds_read_b64_tr_b16 a[232:233], v13
    ds_read_b64_tr_b16 a[234:235], v13 offset:1024
    ds_read_b64_tr_b16 a[236:237], v13 offset:16384
    ds_read_b64_tr_b16 a[238:239], v13 offset:17408
    s_waitcnt lgkmcnt(0)
    s_barrier
    s_add_u32 s43, s42, 0x10200
    s_add_u32 m0, s51, 0x1c000
    s_nop 0
    buffer_load_dwordx4 v10, s[12:15], s43 offen lds
    s_add_u32 s43, s42, 0x14200
    s_add_u32 m0, s51, 0x1d000
    s_nop 0
    buffer_load_dwordx4 v9, s[12:15], s43 offen lds
    s_add_u32 s43, s42, 0x18200
    s_add_u32 m0, s51, 0x1e000
    s_nop 0
    buffer_load_dwordx4 v10, s[12:15], s43 offen lds
    s_add_u32 s43, s42, 0x1c200
    s_add_u32 m0, s51, 0x1f000
    s_nop 0
    buffer_load_dwordx4 v9, s[12:15], s43 offen lds
    s_add_u32 s43, s42, 0x10000
    s_add_u32 m0, s51, 0x20000
    s_nop 0
    buffer_load_dwordx4 v10, s[12:15], s43 offen lds
    s_add_u32 s43, s42, 0x14000
    s_add_u32 m0, s51, 0x21000
    s_nop 0
    buffer_load_dwordx4 v9, s[12:15], s43 offen lds
    s_add_u32 s43, s42, 0x18000
    s_add_u32 m0, s51, 0x22000
    s_nop 0
    buffer_load_dwordx4 v10, s[12:15], s43 offen lds
    s_add_u32 s43, s42, 0x1c000
    s_add_u32 m0, s51, 0x23000
    s_nop 0
    buffer_load_dwordx4 v9, s[12:15], s43 offen lds
    s_waitcnt vmcnt(12)
    s_barrier
    s_cmp_lg_u32 s21, 0
    s_cbranch_scc1 L_arr_46
    v_mov_b32 v23, 1
    s_mov_b64 exec, 1
    buffer_atomic_add v23, off, s[16:19], 0 offset:8
    s_mov_b64 exec, -1
L_arr_46:
    v_xor_b32 v13, 0x0, v11
    v_add_u32 v13, 0x8000, v13
    ds_read_b64_tr_b16 v[128:129], v13
    ds_read_b64_tr_b16 v[130:131], v13 offset:1024
    ds_read_b64_tr_b16 v[132:133], v13 offset:16384
    ds_read_b64_tr_b16 v[134:135], v13 offset:17408
    v_xor_b32 v13, 0x20, v11
    v_add_u32 v13, 0x8000, v13
    ds_read_b64_tr_b16 v[136:137], v13
    ds_read_b64_tr_b16 v[138:139], v13 offset:1024
    ds_read_b64_tr_b16 v[140:141], v13 offset:16384
    ds_read_b64_tr_b16 v[142:143], v13 offset:17408
    v_xor_b32 v13, 0x1000, v11
    v_add_u32 v13, 0x8000, v13
    ds_read_b64_tr_b16 v[160:161], v13
    ds_read_b64_tr_b16 v[162:163], v13 offset:1024
    ds_read_b64_tr_b16 v[164:165], v13 offset:16384
    ds_read_b64_tr_b16 v[166:167], v13 offset:17408
    v_xor_b32 v13, 0x1020, v11
    v_add_u32 v13, 0x8000, v13
    ds_read_b64_tr_b16 v[168:169], v13
    ds_read_b64_tr_b16 v[170:171], v13 offset:1024
    ds_read_b64_tr_b16 v[172:173], v13 offset:16384
    ds_read_b64_tr_b16 v[174:175], v13 offset:17408
    s_waitcnt lgkmcnt(0)
    s_barrier
    s_add_u32 s43, s42, 0x200
    s_add_u32 m0, s51, 0x24000
    s_nop 0
    buffer_load_dwordx4 v10, s[12:15], s43 offen lds
    s_add_u32 s43, s42, 0x4200
    s_add_u32 m0, s51, 0x25000
    s_nop 0
    buffer_load_dwordx4 v9, s[12:15], s43 offen lds
    s_add_u32 s43, s42, 0x8200
    s_add_u32 m0, s51, 0x26000
    s_nop 0
    buffer_load_dwordx4 v10, s[12:15], s43 offen lds
    s_add_u32 s43, s42, 0xc200
    s_add_u32 m0, s51, 0x27000
    s_nop 0
    buffer_load_dwordx4 v9, s[12:15], s43 offen lds
    s_mov_b32 s12, s64
    s_and_b32 s13, s65, 0xffff
    v_xor_b32 v15, 0, v14
    v_lshl_add_u32 v15, v15, 15, v8
    s_add_u32 s43, s41, 0x80000
    s_add_u32 m0, s51, 0x8000
    s_nop 0
    buffer_load_dwordx4 v15, s[12:15], s43 offen lds
    s_add_u32 s43, s41, 0x88000
    s_add_u32 m0, s51, 0x9000
    s_nop 0
    buffer_load_dwordx4 v15, s[12:15], s43 offen lds
    s_add_u32 s43, s41, 0x180000
    s_add_u32 m0, s51, 0xa000
    s_nop 0
    buffer_load_dwordx4 v15, s[12:15], s43 offen lds
    s_add_u32 s43, s41, 0x188000
    s_add_u32 m0, s51, 0xb000
    s_nop 0
    buffer_load_dwordx4 v15, s[12:15], s43 offen lds
    s_waitcnt vmcnt(12)
    s_barrier
    v_xor_b32 v13, 0x0, v12
    v_add_u32 v13, 0x10000, v13
    ds_read_b64_tr_b16 v[192:193], v13
    ds_read_b64_tr_b16 v[194:195], v13 offset:512
    ds_read_b64_tr_b16 v[196:197], v13 offset:2048
    ds_read_b64_tr_b16 v[198:199], v13 offset:2560
    v_xor_b32 v13, 0x2000, v12
    v_add_u32 v13, 0x10000, v13
    ds_read_b64_tr_b16 v[200:201], v13
    ds_read_b64_tr_b16 v[202:203], v13 offset:512
    ds_read_b64_tr_b16 v[204:205], v13 offset:2048
    ds_read_b64_tr_b16 v[206:207], v13 offset:2560
    v_xor_b32 v13, 0x40, v12
    v_add_u32 v13, 0x10000, v13
    ds_read_b64_tr_b16 v[224:225], v13
    ds_read_b64_tr_b16 v[226:227], v13 offset:512
    ds_read_b64_tr_b16 v[228:229], v13 offset:2048
    ds_read_b64_tr_b16 v[230:231], v13 offset:2560
    v_xor_b32 v13, 0x2040, v12
    v_add_u32 v13, 0x10000, v13
    ds_read_b64_tr_b16 v[232:233], v13
    ds_read_b64_tr_b16 v[234:235], v13 offset:512
    ds_read_b64_tr_b16 v[236:237], v13 offset:2048
    ds_read_b64_tr_b16 v[238:239], v13 offset:2560
    s_waitcnt lgkmcnt(0)
    s_barrier
    s_add_u32 s43, s41, 0x280000
    s_add_u32 m0, s51, 0xc000
    s_nop 0
    buffer_load_dwordx4 v15, s[12:15], s43 offen lds
    s_add_u32 s43, s41, 0x288000
    s_add_u32 m0, s51, 0xd000
    s_nop 0
    buffer_load_dwordx4 v15, s[12:15], s43 offen lds
    s_add_u32 s43, s41, 0x380000
    s_add_u32 m0, s51, 0xe000
    s_nop 0
    buffer_load_dwordx4 v15, s[12:15], s43 offen lds
    s_add_u32 s43, s41, 0x388000
    s_add_u32 m0, s51, 0xf000
    s_nop 0
    buffer_load_dwordx4 v15, s[12:15], s43 offen lds
    v_xor_b32 v15, 2, v14
    v_lshl_add_u32 v15, v15, 15, v8
    s_add_u32 s43, s41, 0x80000
    s_add_u32 m0, s51, 0x10000
    s_nop 0
    buffer_load_dwordx4 v15, s[12:15], s43 offen lds
    s_add_u32 s43, s41, 0x88000
    s_add_u32 m0, s51, 0x11000
    s_nop 0
    buffer_load_dwordx4 v15, s[12:15], s43 offen lds
    s_add_u32 s43, s41, 0x180000
    s_add_u32 m0, s51, 0x12000
    s_nop 0
    buffer_load_dwordx4 v15, s[12:15], s43 offen lds
    s_add_u32 s43, s41, 0x188000
    s_add_u32 m0, s51, 0x13000
    s_nop 0
    buffer_load_dwordx4 v15, s[12:15], s43 offen lds
    s_waitcnt vmcnt(12)
    s_barrier
    v_xor_b32 v13, 0x0, v12
    v_add_u32 v13, 0x18000, v13
    ds_read_b64_tr_b16 v[208:209], v13
    ds_read_b64_tr_b16 v[210:211], v13 offset:512
    ds_read_b64_tr_b16 v[212:213], v13 offset:2048
    ds_read_b64_tr_b16 v[214:215], v13 offset:2560
    v_xor_b32 v13, 0x2000, v12
    v_add_u32 v13, 0x18000, v13
    ds_read_b64_tr_b16 v[216:217], v13
    ds_read_b64_tr_b16 v[218:219], v13 offset:512
    ds_read_b64_tr_b16 v[220:221], v13 offset:2048
    ds_read_b64_tr_b16 v[222:223], v13 offset:2560
    v_xor_b32 v13, 0x40, v12
    v_add_u32 v13, 0x18000, v13
    ds_read_b64_tr_b16 v[240:241], v13
    ds_read_b64_tr_b16 v[242:243], v13 offset:512
    ds_read_b64_tr_b16 v[244:245], v13 offset:2048
    ds_read_b64_tr_b16 v[246:247], v13 offset:2560
    v_xor_b32 v13, 0x2040, v12
    v_add_u32 v13, 0x18000, v13
    ds_read_b64_tr_b16 v[248:249], v13
    ds_read_b64_tr_b16 v[250:251], v13 offset:512
    ds_read_b64_tr_b16 v[252:253], v13 offset:2048
    ds_read_b64_tr_b16 v[254:255], v13 offset:2560
    s_waitcnt lgkmcnt(0)
    s_barrier
    s_add_u32 s43, s41, 0x280000
    s_add_u32 m0, s51, 0x14000
    s_nop 0
    buffer_load_dwordx4 v15, s[12:15], s43 offen lds
    s_add_u32 s43, s41, 0x288000
    s_add_u32 m0, s51, 0x15000
    s_nop 0
    buffer_load_dwordx4 v15, s[12:15], s43 offen lds
    s_add_u32 s43, s41, 0x380000
    s_add_u32 m0, s51, 0x16000
    s_nop 0
    buffer_load_dwordx4 v15, s[12:15], s43 offen lds
    s_add_u32 s43, s41, 0x388000
    s_add_u32 m0, s51, 0x17000
    s_nop 0
    buffer_load_dwordx4 v15, s[12:15], s43 offen lds
    s_mov_b32 s12, s66
    s_and_b32 s13, s67, 0xffff
    s_add_u32 s43, s42, 0x80
    s_add_u32 m0, s51, 0x18000
    s_nop 0
    buffer_load_dwordx4 v10, s[12:15], s43 offen lds
    s_add_u32 s43, s42, 0x4080
    s_add_u32 m0, s51, 0x19000
    s_nop 0
    buffer_load_dwordx4 v9, s[12:15], s43 offen lds
    s_add_u32 s43, s42, 0x8080
    s_add_u32 m0, s51, 0x1a000
    s_nop 0
    buffer_load_dwordx4 v10, s[12:15], s43 offen lds
    s_add_u32 s43, s42, 0xc080
    s_add_u32 m0, s51, 0x1b000
    s_nop 0
    buffer_load_dwordx4 v9, s[12:15], s43 offen lds
    s_waitcnt vmcnt(12)
    s_barrier
    v_xor_b32 v13, 0x0, v11
    v_add_u32 v13, 0x0, v13
    ds_read_b64_tr_b16 a[208:209], v13
    ds_read_b64_tr_b16 a[210:211], v13 offset:1024
    ds_read_b64_tr_b16 a[212:213], v13 offset:16384
    ds_read_b64_tr_b16 a[214:215], v13 offset:17408
    v_xor_b32 v13, 0x20, v11
    v_add_u32 v13, 0x0, v13
    ds_read_b64_tr_b16 a[216:217], v13
    ds_read_b64_tr_b16 a[218:219], v13 offset:1024
    ds_read_b64_tr_b16 a[220:221], v13 offset:16384
    ds_read_b64_tr_b16 a[222:223], v13 offset:17408
    v_xor_b32 v13, 0x1000, v11
    v_add_u32 v13, 0x0, v13
    ds_read_b64_tr_b16 a[240:241], v13
    ds_read_b64_tr_b16 a[242:243], v13 offset:1024
    ds_read_b64_tr_b16 a[244:245], v13 offset:16384
    ds_read_b64_tr_b16 a[246:247], v13 offset:17408
    v_xor_b32 v13, 0x1020, v11
    v_add_u32 v13, 0x0, v13
    ds_read_b64_tr_b16 a[248:249], v13
    ds_read_b64_tr_b16 a[250:251], v13 offset:1024
    ds_read_b64_tr_b16 a[252:253], v13 offset:16384
    ds_read_b64_tr_b16 a[254:255], v13 offset:17408
    s_waitcnt lgkmcnt(0)
    s_barrier
    s_add_u32 s43, s42, 0x10280
    s_add_u32 m0, s51, 0x1c000
    s_nop 0
    buffer_load_dwordx4 v10, s[12:15], s43 offen lds
    s_add_u32 s43, s42, 0x14280
    s_add_u32 m0, s51, 0x1d000
    s_nop 0
    buffer_load_dwordx4 v9, s[12:15], s43 offen lds
    s_add_u32 s43, s42, 0x18280
    s_add_u32 m0, s51, 0x1e000
    s_nop 0
    buffer_load_dwordx4 v10, s[12:15], s43 offen lds
    s_add_u32 s43, s42, 0x1c280
    s_add_u32 m0, s51, 0x1f000
    s_nop 0
    buffer_load_dwordx4 v9, s[12:15], s43 offen lds
    s_add_u32 s43, s42, 0x10080
    s_add_u32 m0, s51, 0x20000
    s_nop 0
    buffer_load_dwordx4 v10, s[12:15], s43 offen lds
    s_add_u32 s43, s42, 0x14080
    s_add_u32 m0, s51, 0x21000
    s_nop 0
    buffer_load_dwordx4 v9, s[12:15], s43 offen lds
    s_add_u32 s43, s42, 0x18080
    s_add_u32 m0, s51, 0x22000
    s_nop 0
    buffer_load_dwordx4 v10, s[12:15], s43 offen lds
    s_add_u32 s43, s42, 0x1c080
    s_add_u32 m0, s51, 0x23000
    s_nop 0
    buffer_load_dwordx4 v9, s[12:15], s43 offen lds
    ds_write_b128 v123, v[32:35]
    ds_write_b128 v123, v[36:39] offset:1024
    ds_write_b128 v123, v[40:43] offset:2048
    ds_write_b128 v123, v[44:47] offset:3072
    ds_write_b128 v123, v[48:51] offset:4096
    ds_write_b128 v123, v[52:55] offset:5120
    ds_write_b128 v123, v[56:59] offset:6144
    ds_write_b128 v123, v[60:63] offset:7168
    s_waitcnt vmcnt(12)
    s_barrier
    v_xor_b32 v13, 0x0, v11
    v_add_u32 v13, 0x8000, v13
    ds_read_b64_tr_b16 v[144:145], v13
    ds_read_b64_tr_b16 v[146:147], v13 offset:1024
    ds_read_b64_tr_b16 v[148:149], v13 offset:16384
    ds_read_b64_tr_b16 v[150:151], v13 offset:17408
    v_xor_b32 v13, 0x20, v11
    v_add_u32 v13, 0x8000, v13
    ds_read_b64_tr_b16 v[152:153], v13
    ds_read_b64_tr_b16 v[154:155], v13 offset:1024
    ds_read_b64_tr_b16 v[156:157], v13 offset:16384
    ds_read_b64_tr_b16 v[158:159], v13 offset:17408
    v_xor_b32 v13, 0x1000, v11
    v_add_u32 v13, 0x8000, v13
    ds_read_b64_tr_b16 v[176:177], v13
    ds_read_b64_tr_b16 v[178:179], v13 offset:1024
    ds_read_b64_tr_b16 v[180:181], v13 offset:16384
    ds_read_b64_tr_b16 v[182:183], v13 offset:17408
    v_xor_b32 v13, 0x1020, v11
    v_add_u32 v13, 0x8000, v13
    ds_read_b64_tr_b16 v[184:185], v13
    ds_read_b64_tr_b16 v[186:187], v13 offset:1024
    ds_read_b64_tr_b16 v[188:189], v13 offset:16384
    ds_read_b64_tr_b16 v[190:191], v13 offset:17408
    s_waitcnt lgkmcnt(0)
    s_barrier
    s_add_u32 s43, s42, 0x280
    s_add_u32 m0, s51, 0x24000
    s_nop 0
    buffer_load_dwordx4 v10, s[12:15], s43 offen lds
    s_add_u32 s43, s42, 0x4280
    s_add_u32 m0, s51, 0x25000
    s_nop 0
    buffer_load_dwordx4 v9, s[12:15], s43 offen lds
    s_add_u32 s43, s42, 0x8280
    s_add_u32 m0, s51, 0x26000
    s_nop 0
    buffer_load_dwordx4 v10, s[12:15], s43 offen lds
    s_add_u32 s43, s42, 0xc280
    s_add_u32 m0, s51, 0x27000
    s_nop 0
    buffer_load_dwordx4 v9, s[12:15], s43 offen lds
    ds_write_b128 v123, v[64:67] offset:32768
    ds_write_b128 v123, v[68:71] offset:33792
    ds_write_b128 v123, v[72:75] offset:34816
    ds_write_b128 v123, v[76:79] offset:35840
    ds_write_b128 v123, v[80:83] offset:36864
    ds_write_b128 v123, v[84:87] offset:37888
    ds_write_b128 v123, v[88:91] offset:38912
    ds_write_b128 v123, v[92:95] offset:39936
    s_waitcnt vmcnt(8)
    s_barrier
    v_xor_b32 v13, 0x0, v12
    v_add_u32 v13, 0x10000, v13
    ds_read_b64_tr_b16 v[32:33], v13
    ds_read_b64_tr_b16 v[34:35], v13 offset:512
    ds_read_b64_tr_b16 v[36:37], v13 offset:2048
    ds_read_b64_tr_b16 v[38:39], v13 offset:2560
    v_xor_b32 v13, 0x2000, v12
    v_add_u32 v13, 0x10000, v13
    ds_read_b64_tr_b16 v[40:41], v13
    ds_read_b64_tr_b16 v[42:43], v13 offset:512
    ds_read_b64_tr_b16 v[44:45], v13 offset:2048
    ds_read_b64_tr_b16 v[46:47], v13 offset:2560
    v_xor_b32 v13, 0x40, v12
    v_add_u32 v13, 0x10000, v13
    ds_read_b64_tr_b16 v[64:65], v13
    ds_read_b64_tr_b16 v[66:67], v13 offset:512
    ds_read_b64_tr_b16 v[68:69], v13 offset:2048
    ds_read_b64_tr_b16 v[70:71], v13 offset:2560
    v_xor_b32 v13, 0x2040, v12
    v_add_u32 v13, 0x10000, v13
    ds_read_b64_tr_b16 v[72:73], v13
    ds_read_b64_tr_b16 v[74:75], v13 offset:512
    ds_read_b64_tr_b16 v[76:77], v13 offset:2048
    ds_read_b64_tr_b16 v[78:79], v13 offset:2560
    s_waitcnt lgkmcnt(0)
    s_barrier
    s_waitcnt vmcnt(0)
    s_barrier
    v_xor_b32 v13, 0x0, v12
    v_add_u32 v13, 0x18000, v13
    ds_read_b64_tr_b16 v[48:49], v13
    ds_read_b64_tr_b16 v[50:51], v13 offset:512
    ds_read_b64_tr_b16 v[52:53], v13 offset:2048
    ds_read_b64_tr_b16 v[54:55], v13 offset:2560
    v_xor_b32 v13, 0x2000, v12
    v_add_u32 v13, 0x18000, v13
    ds_read_b64_tr_b16 v[56:57], v13
    ds_read_b64_tr_b16 v[58:59], v13 offset:512
    ds_read_b64_tr_b16 v[60:61], v13 offset:2048
    ds_read_b64_tr_b16 v[62:63], v13 offset:2560
    v_xor_b32 v13, 0x40, v12
    v_add_u32 v13, 0x18000, v13
    ds_read_b64_tr_b16 v[80:81], v13
    ds_read_b64_tr_b16 v[82:83], v13 offset:512
    ds_read_b64_tr_b16 v[84:85], v13 offset:2048
    ds_read_b64_tr_b16 v[86:87], v13 offset:2560
    v_xor_b32 v13, 0x2040, v12
    v_add_u32 v13, 0x18000, v13
    ds_read_b64_tr_b16 v[88:89], v13
    ds_read_b64_tr_b16 v[90:91], v13 offset:512
    ds_read_b64_tr_b16 v[92:93], v13 offset:2048
    ds_read_b64_tr_b16 v[94:95], v13 offset:2560
    s_waitcnt lgkmcnt(0)
    s_barrier
    ds_write_b128 v124, v[32:35]
    ds_write_b128 v124, v[36:39] offset:1024
    ds_write_b128 v124, v[40:43] offset:2048
    ds_write_b128 v124, v[44:47] offset:3072
    ds_write_b128 v124, v[48:51] offset:4096
    ds_write_b128 v124, v[52:55] offset:5120
    ds_write_b128 v124, v[56:59] offset:6144
    ds_write_b128 v124, v[60:63] offset:7168
    ds_write_b128 v124, v[64:67] offset:32768
    ds_write_b128 v124, v[68:71] offset:33792
    ds_write_b128 v124, v[72:75] offset:34816
    ds_write_b128 v124, v[76:79] offset:35840
    ds_write_b128 v124, v[80:83] offset:36864
    ds_write_b128 v124, v[84:87] offset:37888
    ds_write_b128 v124, v[88:91] offset:38912
    ds_write_b128 v124, v[92:95] offset:39936
    s_waitcnt lgkmcnt(0)
    s_cmp_eq_u32 s57, 1
    s_cbranch_scc1 L_started_47
    v_lshrrev_b32 v1, 4, v117
    v_and_b32 v2, 15, v1
    v_lshrrev_b32 v1, 4, v1
    v_lshlrev_b32 v1, 11, v1
    v_lshl_add_u32 v1, v2, 2, v1
    s_lshl_b32 s43, s20, 6
    s_add_u32 s43, s43, 0x2000
    s_mov_b32 exec_lo, 0x10001
    s_mov_b32 exec_hi, 0
    s_mov_b32 s96, 0
L_poll_48:
    buffer_load_dword v2, v1, s[8:11], s43 offen sc1
    s_waitcnt vmcnt(0)
    v_cmp_gt_u32 vcc, 1, v2
    s_cbranch_vccz L_polld_49
    s_sleep 8
    s_add_u32 s96, s96, 1
    s_cmp_lt_u32 s96, 0x10000
    s_cbranch_scc1 L_poll_48
L_polld_49:
    s_mov_b64 exec, -1
    s_add_u32 m0, s52, 8192
    s_nop 0
    buffer_load_dwordx4 v117, s[8:11], s30 offen lds
    buffer_load_dwordx4 v117, s[8:11], s30 offen offset:1024 lds
    s_add_u32 m0, s52, 0x6000
    s_nop 0
    buffer_load_dwordx4 v117, s[8:11], s31 offen lds
    buffer_load_dwordx4 v117, s[8:11], s31 offen offset:1024 lds
    s_mov_b32 s49, 0
L_cb_poll_51:
    buffer_load_dword v3, off, s[16:19], 0 offset:8 sc1
    s_waitcnt vmcnt(0)
    v_readfirstlane_b32 s43, v3
    s_nop 0
    s_cmp_ge_u32 s43, 32
    s_cbranch_scc1 L_started_47
    s_sleep 8
    s_add_u32 s49, s49, 1
    s_cmp_lt_u32 s49, 0x40000
    s_cbranch_scc1 L_cb_poll_51
L_started_47:
    s_lshr_b32 s43, s20, 1
    s_lshl_b32 s43, s43, 7
    s_and_b32 s40, s20, 1
    s_lshl_b32 s40, s40, 4
    s_add_u32 s43, s43, s40
    s_add_u32 s44, s43, 0x1000
    s_cmp_eq_u32 s21, 0
    s_cselect_b32 s44, s44, 0x7ff00000
    s_mov_b32 s22, 0
    s_mov_b32 s33, 0
    s_xor_b32 s53, s29, 1024
    s_add_u32 s23, s51, 0x7010000
    s_add_u32 s48, s23, 4096
    s_mov_b32 s24, 0x7012000
    s_add_u32 s55, s24, 16384
    s_mov_b32 s25, 0x7100000
    s_mov_b32 s26, 0x7101000
    v_mov_b32 v112, 0
    v_mov_b32 v113, 0
    v_mov_b32 v114, 0
    v_mov_b32 v115, 0
    s_add_u32 m0, s51, 4096
    ds_write_b128 v117, v[112:115] offset:22528
    ds_write_b128 v117, v[112:115] offset:23552
    s_cmp_lg_u32 s21, 0
    s_cselect_b32 s40, -1, 0
    v_mov_b32 v126, s40
    v_bfe_u32 v1, v117, 4, 1
    v_lshlrev_b32 v1, 4, v1
    s_movk_i32 s43, 0x3f80
    v_lshlrev_b32 v125, v1, s43
    v_bfe_u32 v1, v117, 5, 3
    v_cmp_eq_u32 s[68:69], 0, v1
    v_cmp_eq_u32 s[70:71], 1, v1
    v_cmp_eq_u32 s[72:73], 2, v1
    v_cmp_eq_u32 s[74:75], 3, v1
    v_lshrrev_b32 v1, 2, v117
    s_cmp_lt_u32 s21, 2
    s_cselect_b64 vcc, -1, 0
    v_cndmask_b32 v119, v119, v1, vcc
    v_mov_b32 v32, 0
    v_mov_b32 v33, 0
    v_mov_b32 v34, 0
    v_mov_b32 v35, 0
    v_mov_b32 v36, 0
    v_mov_b32 v37, 0
    v_mov_b32 v38, 0
    v_mov_b32 v39, 0
    v_mov_b32 v40, 0
    v_mov_b32 v41, 0
    v_mov_b32 v42, 0
    v_mov_b32 v43, 0
    v_mov_b32 v44, 0
    v_mov_b32 v45, 0
    v_mov_b32 v46, 0
    v_mov_b32 v47, 0
    v_mov_b32 v48, 0
    v_mov_b32 v49, 0
    v_mov_b32 v50, 0
    v_mov_b32 v51, 0
    v_mov_b32 v52, 0
    v_mov_b32 v53, 0
    v_mov_b32 v54, 0
    v_mov_b32 v55, 0
    s_add_u32 s30, s30, 0x40000
    s_add_u32 s31, s31, 0x40000
    s_mov_b32 s45, 0
    s_mov_b32 s46, 0
    s_mov_b32 s47, 0
    s_mov_b32 s76, 0
    s_and_b32 s43, s21, 1
    s_lshl_b32 s43, s43, 5
    s_add_u32 s43, s43, s20
    s_lshl_b32 s43, s43, 6
    s_add_u32 s28, s43, 0x2000
    s_mov_b32 s59, 0
    ds_read_b128 v[80:83], v123
    ds_read_b128 v[84:87], v123 offset:1024
    ds_read_b128 v[56:59], v123 offset:2048
    ds_read_b128 v[60:63], v123 offset:3072
    ds_read_b128 v[64:67], v123 offset:32768
    ds_read_b128 v[68:71], v123 offset:33792
    ds_read_b128 v[72:75], v123 offset:34816
    ds_read_b128 v[76:79], v123 offset:35840
    ds_read_b128 v[88:91], v123 offset:4096
    ds_read_b128 v[92:95], v123 offset:5120
    ds_read_b128 v[96:99], v123 offset:6144
    ds_read_b128 v[100:103], v123 offset:7168
    ds_read_b128 v[104:107], v123 offset:36864
    ds_read_b128 v[108:111], v123 offset:37888
    ds_read_b128 v[24:27], v123 offset:38912
    ds_read_b128 v[28:31], v123 offset:39936
    s_mov_b32 s49, 0
    s_waitcnt vmcnt(0) lgkmcnt(0)
    s_barrier
    s_waitcnt vmcnt(0) lgkmcnt(0)
    s_cmp_eq_u32 s21, 1
    s_cbranch_scc1 L_chain_top1_s
    s_cmp_eq_u32 s21, 2
    s_cbranch_scc1 L_chain_top2_s
    s_cmp_eq_u32 s21, 3
    s_cbranch_scc1 L_chain_top3_s
.p2align 6
L_chain_top0_s:
    buffer_load_dwordx4 v[0:3], v117, s[8:11], s23 offen sc1
    v_mov_b32 v15, 0
    v_mov_b32 v15, 0
    v_mov_b32 v15, 0
    v_mov_b32 v15, 0
    v_mov_b32 v15, 0
    v_mov_b32 v15, 0
    v_mov_b32 v15, 0
    v_mov_b32 v15, 0
    v_mov_b32 v15, 0
    v_mov_b32 v15, 0
    v_mov_b32 v15, 0
    v_mov_b32 v15, 0
    v_mov_b32 v15, 0
    v_mov_b32 v15, 0
    v_mov_b32 v15, 0
    v_mov_b32 v15, 0
    buffer_load_dwordx4 v[0:3], v117, s[8:11], s23 offen sc1
    v_mov_b32 v15, 0
    v_mov_b32 v15, 0
    v_mov_b32 v15, 0
    v_mov_b32 v15, 0
    v_mov_b32 v15, 0
    v_mov_b32 v15, 0
    v_mov_b32 v15, 0
    v_mov_b32 v15, 0
    v_mov_b32 v15, 0
    v_mov_b32 v15, 0
    v_mov_b32 v15, 0
    v_mov_b32 v15, 0
    v_mov_b32 v15, 0
    v_mov_b32 v15, 0
    v_mov_b32 v15, 0
    v_mov_b32 v15, 0
L_mret_53:
    buffer_load_dwordx4 v[0:3], v117, s[8:11], s23 offen sc1
    s_add_u32 s45, s45, 1
    s_cmp_lt_u32 s45, 0x10000
    s_cselect_b32 s56, -2, -1
    s_nop 3
    v_mov_b32 v32, 0
    v_mov_b32 v33, 0
    v_mov_b32 v34, 0
    v_mov_b32 v35, 0
    s_waitcnt vmcnt(2)
    v_max3_u32 v15, v0, v1, v2
    v_max_u32 v15, v15, v3
    v_cmp_lt_u32 vcc, s56, v15
    v_smfmac_f32_16x16x64_bf16 v[32:35], v[0:3], v[80:87], v116
    s_cbranch_vccnz L_mret_53
    ds_write_b128 v117, v[0:3]
    v_smfmac_f32_16x16x64_bf16 v[36:39], v[0:3], v[56:63], v116
    buffer_load_dwordx4 v[4:7], v117, s[8:11], s48 offen sc1
    v_smfmac_f32_16x16x64_bf16 v[40:43], v[0:3], v[64:71], v116
    buffer_load_dwordx4 v117, s[8:11], s48 offen sc1 lds
    s_mov_b32 m0, 8192
    v_smfmac_f32_16x16x64_bf16 v[44:47], v[0:3], v[72:79], v116
    s_waitcnt lgkmcnt(0)
    s_barrier
    ds_read_b128 v[8:11], v117 offset:1024
    v_smfmac_f32_16x16x64_bf16 v[48:51], v[0:3], a[192:199], v116
    ds_read_b128 v[16:19], v117 offset:2048
    ds_read_b128 v[20:23], v117 offset:3072
    v_smfmac_f32_16x16x64_bf16 v[52:55], v[0:3], a[200:207], v116
    ds_read_b128 v[80:83], v117 offset:14336
    s_waitcnt lgkmcnt(3)
    v_smfmac_f32_16x16x64_bf16 v[32:35], v[8:11], a[0:7], v116
    ds_read_b128 v[84:87], v117 offset:15360
    v_smfmac_f32_16x16x64_bf16 v[36:39], v[8:11], a[8:15], v116
    buffer_store_dwordx4 v[112:115], v117, s[8:11], s32 offen sc1
    s_waitcnt lgkmcnt(3)
    v_smfmac_f32_16x16x64_bf16 v[32:35], v[16:19], a[32:39], v116
    ds_read_b128 v[56:59], v117 offset:8192
    v_smfmac_f32_16x16x64_bf16 v[36:39], v[16:19], a[40:47], v116
    ds_read_b128 v[60:63], v117 offset:9216
    s_waitcnt lgkmcnt(4)
    v_smfmac_f32_16x16x64_bf16 v[32:35], v[20:23], a[64:71], v116
    ds_read_b128 v[64:67], v117 offset:10240
    v_smfmac_f32_16x16x64_bf16 v[36:39], v[20:23], a[72:79], v116
    ds_read_b128 v[68:71], v117 offset:11264
    v_smfmac_f32_16x16x64_bf16 v[40:43], v[8:11], a[96:103], v116
    ds_read_b128 v[72:75], v117 offset:12288
    v_smfmac_f32_16x16x64_bf16 v[40:43], v[16:19], a[128:135], v116
    ds_read_b128 v[76:79], v117 offset:13312
    v_smfmac_f32_16x16x64_bf16 v[40:43], v[20:23], a[160:167], v116
    s_waitcnt vmcnt(2)
    v_max3_u32 v15, v4, v5, v6
    v_smfmac_f32_16x16x64_bf16 v[44:47], v[8:11], a[104:111], v116
    v_max_u32 v15, v15, v7
    v_smfmac_f32_16x16x64_bf16 v[44:47], v[16:19], a[136:143], v116
    s_waitcnt vmcnt(1) lgkmcnt(0)
    v_cmp_lt_u32 vcc, s56, v15
    v_smfmac_f32_16x16x64_bf16 v[44:47], v[20:23], a[168:175], v116
    s_cbranch_vccnz L_mret_54
L_mgo_55:
    v_smfmac_f32_16x16x64_bf16 v[44:47], v[4:7], v[24:31], v116
    s_barrier
    ds_read_b128 v[12:15], v117 offset:5120
    v_smfmac_f32_16x16x64_bf16 v[32:35], v[4:7], v[88:95], v116
    ds_read_b128 v[24:27], v117 offset:6144
    v_smfmac_f32_16x16x64_bf16 v[36:39], v[4:7], v[96:103], v116
    ds_read_b128 v[28:31], v117 offset:7168
    v_smfmac_f32_16x16x64_bf16 v[40:43], v[4:7], v[104:111], v116
    ds_read_b128 v[88:91], v117 offset:24576
    s_waitcnt lgkmcnt(3)
    v_smfmac_f32_16x16x64_bf16 v[32:35], v[12:15], a[16:23], v116
    ds_read_b128 v[92:95], v117 offset:25600
    s_waitcnt lgkmcnt(3)
    v_smfmac_f32_16x16x64_bf16 v[32:35], v[24:27], a[48:55], v116
    buffer_load_dwordx4 v117, s[8:11], s30 offen lds
    s_waitcnt lgkmcnt(2)
    v_smfmac_f32_16x16x64_bf16 v[32:35], v[28:31], a[80:87], v116
    ds_read_b128 v[96:99], v117 offset:23552
    v_smfmac_f32_16x16x64_bf16 v[36:39], v[12:15], a[24:31], v116
    ds_read_b128 v[100:103], v117 offset:23552
    v_smfmac_f32_16x16x64_bf16 v[36:39], v[24:27], a[56:63], v116
    buffer_load_dwordx4 v117, s[8:11], s30 offen offset:1024 lds
    s_add_u32 m0, s52, 0x6000
    v_add_f32 v32, v32, v34
    v_smfmac_f32_16x16x64_bf16 v[36:39], v[28:31], a[88:95], v116
    ds_read_b128 v[104:107], v117 offset:23552
    v_add_f32 v33, v33, v35
    v_smfmac_f32_16x16x64_bf16 v[40:43], v[12:15], a[112:119], v116
    ds_read_b128 v[108:111], v117 offset:23552
    v_mul_f32 v32, s34, v32
    v_smfmac_f32_16x16x64_bf16 v[40:43], v[24:27], a[144:151], v116
    buffer_load_dword v125, v119, s[8:11], s28 offen sc1
    v_mul_f32 v33, s34, v33
    v_smfmac_f32_16x16x64_bf16 v[40:43], v[28:31], a[176:183], v116
    ds_read_b128 v[0:3], v124
    v_add_f32 v36, v36, v38
    v_smfmac_f32_16x16x64_bf16 v[48:51], v[4:7], a[208:215], v116
    v_add_f32 v37, v37, v39
    v_smfmac_f32_16x16x64_bf16 v[52:55], v[4:7], a[216:223], v116
    s_waitcnt lgkmcnt(5)
    buffer_load_dwordx4 v117, s[8:11], s31 offen lds
    v_mul_f32 v36, s34, v36
    v_smfmac_f32_16x16x64_bf16 v[44:47], v[12:15], a[120:127], v116
    ds_read_b128 v[4:7], v124 offset:1024
    v_mul_f32 v37, s34, v37
    v_smfmac_f32_16x16x64_bf16 v[44:47], v[24:27], a[152:159], v116
    v_cvt_pk_bf16_f32 v34, v32, v36
    v_smfmac_f32_16x16x64_bf16 v[44:47], v[28:31], a[184:191], v116
    buffer_load_dwordx4 v117, s[8:11], s31 offen offset:1024 lds
    s_mov_b32 m0, 4096
    v_cvt_pk_bf16_f32 v35, v33, v37
    v_add_f32 v40, v40, v42
    v_smfmac_f32_16x16x64_bf16 v[48:51], v[8:11], a[224:231], v116
    ds_write2_b32 v120, v34, v35 offset0:32 offset1:48
    v_add_f32 v41, v41, v43
    v_smfmac_f32_16x16x64_bf16 v[52:55], v[8:11], a[232:239], v116
    v_add_f32 v44, v44, v46
    v_add_f32 v45, v45, v47
    v_cvt_pk_bf16_f32 v113, v40, v44
    v_cvt_pk_bf16_f32 v115, v41, v45
    v_smfmac_f32_16x16x64_bf16 v[48:51], v[12:15], a[240:247], v116
    ds_write2_b32 v120, v113, v115 offset0:0 offset1:16
    v_smfmac_f32_16x16x64_bf16 v[52:55], v[12:15], a[248:255], v116
    s_cmp_eq_u32 s22, 63
    s_cbranch_scc1 L_chain_last_s
    buffer_store_dword v126, off, s[8:11], s44 sc1
    v_smfmac_f32_16x16x64_bf16 v[48:51], v[16:19], v[128:135], v116
    v_smfmac_f32_16x16x64_bf16 v[48:51], v[20:23], v[160:167], v116
    v_smfmac_f32_16x16x64_bf16 v[48:51], v[24:27], v[144:151], v116
    s_waitcnt lgkmcnt(0)
    s_barrier
    v_smfmac_f32_16x16x64_bf16 v[48:51], v[28:31], v[176:183], v116
    ds_read_b128 v[32:35], v121 offset:16384
    ds_read_b128 v[36:39], v121 offset:17408
    v_smfmac_f32_16x16x64_bf16 v[52:55], v[16:19], v[136:143], v116
    ds_read_b128 v[40:43], v121 offset:18432
    ds_read_b128 v[44:47], v121 offset:19456
    v_smfmac_f32_16x16x64_bf16 v[52:55], v[20:23], v[168:175], v116
    ds_read_b128 v[8:11], v124 offset:32768
    v_add_f32 v48, v48, v50
    v_smfmac_f32_16x16x64_bf16 v[52:55], v[24:27], v[152:159], v116
    ds_read_b128 v[12:15], v124 offset:33792
    v_add_f32 v49, v49, v51
    v_smfmac_f32_16x16x64_bf16 v[52:55], v[28:31], v[184:191], v116
    s_waitcnt lgkmcnt(5)
    v_cvt_pk_bf16_f32 v112, v48, v49
    v_mfma_f32_16x16x32_bf16 v[56:59], v[56:59], v[32:35], 0
    s_waitcnt lgkmcnt(4)
    v_mov_b32 v48, s50
    v_mov_b32 v49, s50
    v_mfma_f32_16x16x32_bf16 v[56:59], v[60:63], v[36:39], v[56:59]
    ds_read_b128 v[16:19], v124 offset:2048
    s_waitcnt lgkmcnt(4)
    v_mov_b32 v50, s50
    v_mov_b32 v51, s50
    v_mfma_f32_16x16x32_bf16 v[56:59], v[64:67], v[40:43], v[56:59]
    ds_read_b128 v[20:23], v124 offset:3072
    s_waitcnt lgkmcnt(4)
    v_add_f32 v52, v52, v54
    v_mfma_f32_16x16x32_bf16 v[56:59], v[68:71], v[44:47], v[56:59]
    ds_read_b128 v[24:27], v124 offset:4096
    v_add_f32 v53, v53, v55
    v_mfma_f32_16x16x32_bf16 v[60:63], v[72:75], v[32:35], 0
    ds_read_b128 v[28:31], v124 offset:5120
    v_cvt_pk_bf16_f32 v114, v52, v53
    v_mov_b32 v53, 0
    v_mfma_f32_16x16x32_bf16 v[60:63], v[76:79], v[36:39], v[60:63]
    v_exp_f32 v56, v56
    v_mfma_f32_16x16x32_bf16 v[60:63], v[80:83], v[40:43], v[60:63]
    v_exp_f32 v57, v57
    v_mfma_f32_16x16x32_bf16 v[60:63], v[84:87], v[44:47], v[60:63]
    v_exp_f32 v58, v58
    v_mfma_f32_16x16x32_bf16 v[64:67], v[32:35], v[32:35], 0
    v_exp_f32 v59, v59
    v_cvt_pk_bf16_f32 v68, v56, v57
    v_mfma_f32_16x16x32_bf16 v[64:67], v[36:39], v[36:39], v[64:67]
    v_exp_f32 v60, v60
    v_cvt_pk_bf16_f32 v69, v58, v59
    v_mfma_f32_16x16x32_bf16 v[64:67], v[40:43], v[40:43], v[64:67]
    v_exp_f32 v61, v61
    v_mfma_f32_16x16x32_bf16 v[64:67], v[44:47], v[44:47], v[64:67]
    v_exp_f32 v62, v62
    v_exp_f32 v63, v63
    v_cvt_pk_bf16_f32 v70, v60, v61
    v_cvt_pk_bf16_f32 v71, v62, v63
    s_nop 1
    v_mfma_f32_16x16x32_bf16 v[72:75], v[88:91], v[68:71], 0
    s_nop 0
    v_exp_f32 v64, v64
    v_mfma_f32_16x16x32_bf16 v[76:79], v[92:95], v[68:71], 0
    v_exp_f32 v65, v65
    v_mfma_f32_16x16x32_bf16 v[80:83], v[48:51], v[68:71], 0
    v_cvt_pk_bf16_f32 v52, v64, v65
    s_nop 1
    v_mfma_f32_16x16x16_bf16 v[72:75], v[112:113], v[52:53], v[72:75]
    ds_read_b128 v[32:35], v124 offset:6144
    v_mfma_f32_16x16x16_bf16 v[76:79], v[114:115], v[52:53], v[76:79]
    ds_read_b128 v[36:39], v124 offset:7168
    v_mfma_f32_16x16x16_bf16 v[80:83], v[48:49], v[52:53], v[80:83]
L_norm_56:
    s_mov_b64 vcc, s[36:37]
    v_mov_b32 v122, v122
    v_mov_b32 v122, v122
    v_mov_b32 v122, v122
    v_cndmask_b32_dpp v76, v72, v76, vcc quad_perm:[2,3,2,3] row_mask:0xf bank_mask:0xf
    v_cndmask_b32_dpp v77, v73, v77, vcc quad_perm:[2,3,2,3] row_mask:0xf bank_mask:0xf
    v_cndmask_b32_dpp v78, v74, v78, vcc quad_perm:[2,3,2,3] row_mask:0xf bank_mask:0xf
    v_cndmask_b32_dpp v79, v75, v79, vcc quad_perm:[2,3,2,3] row_mask:0xf bank_mask:0xf
    v_rcp_f32_dpp v84, v80 quad_perm:[2,3,2,3] row_mask:0xf bank_mask:0xf
    s_nop 0
    v_pk_mul_f32 v[76:77], v[76:77], v[84:85] op_sel_hi:[1,0]
    v_pk_mul_f32 v[78:79], v[78:79], v[84:85] op_sel_hi:[1,0]
    v_cvt_pk_bf16_f32 v72, v76, v77
    v_cvt_pk_bf16_f32 v73, v78, v79
    ds_write_b64 v122, v[72:73] offset:20480
    v_max_f32_dpp v86, v80, v84 quad_perm:[2,3,2,3] row_mask:0xf bank_mask:0xf
    v_mov_b32_dpp v60, v72 quad_perm:[0,1,0,1] row_mask:0xf bank_mask:0xf
    v_mov_b32_dpp v61, v73 quad_perm:[0,1,0,1] row_mask:0xf bank_mask:0xf
    v_cmp_lt_f32 vcc, s35, v86
    v_mov_b32_dpp v62, v72 quad_perm:[2,3,2,3] row_mask:0xf bank_mask:0xf
    v_mov_b32_dpp v63, v73 quad_perm:[2,3,2,3] row_mask:0xf bank_mask:0xf
    s_nop 1
    v_smfmac_f32_16x16x64_bf16 v[96:99], v[60:63], v[192:199], v116
    s_cbranch_vccnz L_smax_57
    v_smfmac_f32_16x16x64_bf16 v[100:103], v[60:63], v[224:231], v116
    s_waitcnt lgkmcnt(0)
    s_barrier
    ds_read_b128 v[92:95], v127 offset:20992
    ds_read_b128 v[80:83], v127 offset:21504
    ds_read_b128 v[84:87], v127 offset:22016
    v_smfmac_f32_16x16x64_bf16 v[104:107], v[60:63], v[0:7], v116
    ds_read_b128 v[40:43], v124 offset:34816
    v_smfmac_f32_16x16x64_bf16 v[108:111], v[60:63], v[8:15], v116
    ds_read_b128 v[56:59], v124 offset:36864
    s_waitcnt lgkmcnt(4)
    v_smfmac_f32_16x16x64_bf16 v[96:99], v[92:95], v[200:207], v116
    s_waitcnt lgkmcnt(3)
    v_smfmac_f32_16x16x64_bf16 v[96:99], v[80:83], v[208:215], v116
    ds_read_b128 v[44:47], v124 offset:35840
    s_waitcnt lgkmcnt(3)
    v_smfmac_f32_16x16x64_bf16 v[96:99], v[84:87], v[216:223], v116
    ds_read_b128 v[68:71], v124 offset:39936
    v_smfmac_f32_16x16x64_bf16 v[100:103], v[92:95], v[232:239], v116
    ds_read_b128 v[64:67], v124 offset:38912
    v_smfmac_f32_16x16x64_bf16 v[100:103], v[80:83], v[240:247], v116
    ds_read_b128 v[60:63], v124 offset:37888
    v_cvt_pk_bf16_f32 v72, v96, v98
    v_smfmac_f32_16x16x64_bf16 v[100:103], v[84:87], v[248:255], v116
    v_and_or_b32 v72, v72, -2, s33
    v_smfmac_f32_16x16x64_bf16 v[104:107], v[92:95], v[16:23], v116
    v_cvt_pk_bf16_f32 v74, v97, v99
    v_smfmac_f32_16x16x64_bf16 v[104:107], v[80:83], v[24:31], v116
    v_cvt_pk_bf16_f32 v73, v100, v102
    v_cvt_pk_bf16_f32 v75, v101, v103
    v_smfmac_f32_16x16x64_bf16 v[104:107], v[84:87], v[32:39], v116
    buffer_store_dwordx4 v[72:75], v118, s[8:11], s25 offen sc1
    s_waitcnt lgkmcnt(3)
    v_smfmac_f32_16x16x64_bf16 v[108:111], v[92:95], v[40:47], v116
    s_waitcnt lgkmcnt(0)
    v_smfmac_f32_16x16x64_bf16 v[108:111], v[80:83], v[56:63], v116
    v_cvt_pk_bf16_f32 v76, v104, v106
    v_smfmac_f32_16x16x64_bf16 v[108:111], v[84:87], v[64:71], v116
    v_and_or_b32 v76, v76, -2, s33
    v_cvt_pk_bf16_f32 v78, v105, v107
    v_mov_b32 v122, v122
    v_mov_b32 v122, v122
    v_mov_b32 v122, v122
    v_mov_b32 v122, v122
    v_mov_b32 v122, v122
    v_mov_b32 v122, v122
    v_cvt_pk_bf16_f32 v77, v108, v110
    v_cvt_pk_bf16_f32 v79, v109, v111
    buffer_store_dwordx4 v[76:79], v118, s[8:11], s26 offen sc1
    s_add_u32 s30, s30, 0x40000
    s_add_u32 s31, s31, 0x40000
    s_add_u32 s32, s32, 0x20000
    s_add_u32 s23, s24, 0
    s_add_u32 s48, s23, 4096
    s_xor_b32 s25, s25, 0x40000
    s_xor_b32 s26, s26, 0x40000
    s_mov_b32 s35, 0x49800000
    v_mov_b32 v126, s22
    s_add_u32 s22, s22, 1
    v_mov_b32 v32, 0
    v_mov_b32 v33, 0
    v_mov_b32 v34, 0
    v_mov_b32 v35, 0
    v_mov_b32 v36, 0
    v_mov_b32 v37, 0
    v_mov_b32 v38, 0
    v_mov_b32 v39, 0
    v_mov_b32 v40, 0
    v_mov_b32 v41, 0
    v_mov_b32 v42, 0
    v_mov_b32 v43, 0
    v_mov_b32 v44, 0
    v_mov_b32 v45, 0
    v_mov_b32 v46, 0
    v_mov_b32 v47, 0
    v_mov_b32 v48, 0
    v_mov_b32 v49, 0
    v_mov_b32 v50, 0
    v_mov_b32 v51, 0
    v_mov_b32 v52, 0
    v_mov_b32 v53, 0
    v_mov_b32 v54, 0
    v_mov_b32 v55, 0
    ds_read_b128 v[80:83], v123
    ds_read_b128 v[84:87], v123 offset:1024
    ds_read_b128 v[56:59], v123 offset:2048
    ds_read_b128 v[60:63], v123 offset:3072
    ds_read_b128 v[64:67], v123 offset:32768
    ds_read_b128 v[68:71], v123 offset:33792
    ds_read_b128 v[72:75], v123 offset:34816
    ds_read_b128 v[76:79], v123 offset:35840
    ds_read_b128 v[88:91], v123 offset:4096
    ds_read_b128 v[92:95], v123 offset:5120
    ds_read_b128 v[96:99], v123 offset:6144
    ds_read_b128 v[100:103], v123 offset:7168
    ds_read_b128 v[104:107], v123 offset:36864
    ds_read_b128 v[108:111], v123 offset:37888
    ds_read_b128 v[24:27], v123 offset:38912
    ds_read_b128 v[28:31], v123 offset:39936
    s_add_u32 s24, s24, 8192
    s_bitset0_b32 s24, 15
    s_xor_b32 s55, s24, 16384
    s_xor_b32 s29, s29, 0x40000
    s_xor_b32 s53, s29, 1024
    s_bfe_u32 s33, s22, 0x10001
    s_add_u32 s40, s22, 5
    s_lshr_b32 s40, s40, 2
    s_min_u32 s40, s40, 16
    s_bfm_b32 s58, s40, 0
    s_waitcnt vmcnt(5)
    v_cmp_eq_u32 vcc, 0, v125
    s_nop 0
    s_and_b64 vcc, vcc, s[58:59]
    s_cbranch_scc1 L_kvw_58
L_kvb_59:
    v_mov_b32 v15, 0
    s_nop 2
    v_mov_b32 v15, 0
    s_nop 2
    v_mov_b32 v15, 0
    s_nop 2
    v_mov_b32 v15, 0
    s_nop 2
    v_mov_b32 v15, 0
    s_nop 2
    v_mov_b32 v15, 0
    s_nop 2
    v_mov_b32 v15, 0
    s_nop 2
    v_mov_b32 v15, 0
    s_nop 2
    v_mov_b32 v15, 0
    s_nop 2
    v_mov_b32 v15, 0
    s_nop 2
    v_mov_b32 v15, 0
    s_nop 2
    v_mov_b32 v15, 0
    s_nop 2
    v_mov_b32 v15, 0
    s_nop 2
    v_mov_b32 v15, 0
    s_nop 2
    v_mov_b32 v15, 0
    s_nop 2
    v_mov_b32 v15, 0
    s_nop 2
    v_mov_b32 v15, 0
    s_nop 2
    v_mov_b32 v15, 0
    s_nop 2
    v_mov_b32 v15, 0
    s_nop 2
    v_mov_b32 v15, 0
    s_nop 2
    v_mov_b32 v15, 0
    s_nop 2
    v_mov_b32 v15, 0
    s_nop 2
    v_mov_b32 v15, 0
    s_nop 2
    v_mov_b32 v15, 0
    s_nop 2
    v_mov_b32 v15, 0
    s_nop 2
    v_mov_b32 v15, 0
    s_nop 2
    v_mov_b32 v15, 0
    s_nop 2
    v_mov_b32 v15, 0
    s_nop 2
    v_mov_b32 v15, 0
    s_nop 2
    v_mov_b32 v15, 0
    s_nop 2
    v_mov_b32 v15, 0
    s_nop 2
    s_waitcnt lgkmcnt(0)
    s_branch L_chain_top0_s
.p2align 6
L_chain_top1_s:
    buffer_load_dwordx4 v[0:3], v117, s[8:11], s23 offen sc1
    v_mov_b32 v15, 0
    v_mov_b32 v15, 0
    v_mov_b32 v15, 0
    v_mov_b32 v15, 0
    v_mov_b32 v15, 0
    v_mov_b32 v15, 0
    v_mov_b32 v15, 0
    v_mov_b32 v15, 0
    v_mov_b32 v15, 0
    v_mov_b32 v15, 0
    v_mov_b32 v15, 0
    v_mov_b32 v15, 0
    v_mov_b32 v15, 0
    v_mov_b32 v15, 0
    v_mov_b32 v15, 0
    v_mov_b32 v15, 0
    buffer_load_dwordx4 v[0:3], v117, s[8:11], s23 offen sc1
    v_mov_b32 v15, 0
    v_mov_b32 v15, 0
    v_mov_b32 v15, 0
    v_mov_b32 v15, 0
    v_mov_b32 v15, 0
    v_mov_b32 v15, 0
    v_mov_b32 v15, 0
    v_mov_b32 v15, 0
    v_mov_b32 v15, 0
    v_mov_b32 v15, 0
    v_mov_b32 v15, 0
    v_mov_b32 v15, 0
    v_mov_b32 v15, 0
    v_mov_b32 v15, 0
    v_mov_b32 v15, 0
    v_mov_b32 v15, 0
L_mret_60:
    buffer_load_dwordx4 v[0:3], v117, s[8:11], s23 offen sc1
    s_add_u32 s45, s45, 1
    s_cmp_lt_u32 s45, 0x10000
    s_cselect_b32 s56, -2, -1
    s_nop 3
    v_mov_b32 v32, 0
    v_mov_b32 v33, 0
    v_mov_b32 v34, 0
    v_mov_b32 v35, 0
    s_waitcnt vmcnt(2)
    v_max3_u32 v15, v0, v1, v2
    v_max_u32 v15, v15, v3
    v_cmp_lt_u32 vcc, s56, v15
    v_smfmac_f32_16x16x64_bf16 v[32:35], v[0:3], v[80:87], v116
    s_cbranch_vccnz L_mret_60
    ds_write_b128 v117, v[0:3] offset:1024
    v_smfmac_f32_16x16x64_bf16 v[36:39], v[0:3], v[56:63], v116
    buffer_load_dwordx4 v[4:7], v117, s[8:11], s48 offen sc1
    v_smfmac_f32_16x16x64_bf16 v[40:43], v[0:3], v[64:71], v116
    buffer_load_dwordx4 v117, s[8:11], s48 offen sc1 lds
    s_mov_b32 m0, 10240
    v_smfmac_f32_16x16x64_bf16 v[44:47], v[0:3], v[72:79], v116
    s_waitcnt lgkmcnt(0)
    s_barrier
    ds_read_b128 v[8:11], v117
    v_smfmac_f32_16x16x64_bf16 v[48:51], v[0:3], a[192:199], v116
    ds_read_b128 v[16:19], v117 offset:3072
    ds_read_b128 v[20:23], v117 offset:2048
    v_smfmac_f32_16x16x64_bf16 v[52:55], v[0:3], a[200:207], v116
    ds_read_b128 v[80:83], v117 offset:14336
    s_waitcnt lgkmcnt(3)
    v_smfmac_f32_16x16x64_bf16 v[32:35], v[8:11], a[0:7], v116
    ds_read_b128 v[84:87], v117 offset:15360
    v_smfmac_f32_16x16x64_bf16 v[36:39], v[8:11], a[8:15], v116
    ds_read_b128 v[56:59], v117 offset:8192
    s_waitcnt lgkmcnt(4)
    v_smfmac_f32_16x16x64_bf16 v[32:35], v[16:19], a[32:39], v116
    ds_read_b128 v[60:63], v117 offset:9216
    v_smfmac_f32_16x16x64_bf16 v[36:39], v[16:19], a[40:47], v116
    buffer_store_dwordx4 v[112:115], v117, s[8:11], s32 offen sc1
    s_waitcnt lgkmcnt(4)
    v_smfmac_f32_16x16x64_bf16 v[32:35], v[20:23], a[64:71], v116
    ds_read_b128 v[64:67], v117 offset:10240
    v_smfmac_f32_16x16x64_bf16 v[36:39], v[20:23], a[72:79], v116
    ds_read_b128 v[68:71], v117 offset:11264
    v_smfmac_f32_16x16x64_bf16 v[40:43], v[8:11], a[96:103], v116
    ds_read_b128 v[72:75], v117 offset:12288
    v_smfmac_f32_16x16x64_bf16 v[40:43], v[16:19], a[128:135], v116
    ds_read_b128 v[76:79], v117 offset:13312
    v_smfmac_f32_16x16x64_bf16 v[40:43], v[20:23], a[160:167], v116
    s_waitcnt vmcnt(2)
    v_max3_u32 v15, v4, v5, v6
    v_smfmac_f32_16x16x64_bf16 v[44:47], v[8:11], a[104:111], v116
    v_max_u32 v15, v15, v7
    v_smfmac_f32_16x16x64_bf16 v[44:47], v[16:19], a[136:143], v116
    s_waitcnt vmcnt(1) lgkmcnt(0)
    v_cmp_lt_u32 vcc, s56, v15
    v_smfmac_f32_16x16x64_bf16 v[44:47], v[20:23], a[168:175], v116
    s_cbranch_vccnz L_mret_61
L_mgo_62:
    v_smfmac_f32_16x16x64_bf16 v[44:47], v[4:7], v[24:31], v116
    s_barrier
    ds_read_b128 v[12:15], v117 offset:4096
    v_smfmac_f32_16x16x64_bf16 v[32:35], v[4:7], v[88:95], v116
    ds_read_b128 v[24:27], v117 offset:7168
    v_smfmac_f32_16x16x64_bf16 v[36:39], v[4:7], v[96:103], v116
    ds_read_b128 v[28:31], v117 offset:6144
    v_smfmac_f32_16x16x64_bf16 v[40:43], v[4:7], v[104:111], v116
    ds_read_b128 v[88:91], v117 offset:26624
    s_waitcnt lgkmcnt(3)
    v_smfmac_f32_16x16x64_bf16 v[32:35], v[12:15], a[16:23], v116
    ds_read_b128 v[92:95], v117 offset:27648
    s_waitcnt lgkmcnt(3)
    v_smfmac_f32_16x16x64_bf16 v[32:35], v[24:27], a[48:55], v116
    buffer_load_dwordx4 v117, s[8:11], s30 offen lds
    s_waitcnt lgkmcnt(2)
    v_smfmac_f32_16x16x64_bf16 v[32:35], v[28:31], a[80:87], v116
    ds_read_b128 v[96:99], v117 offset:23552
    v_smfmac_f32_16x16x64_bf16 v[36:39], v[12:15], a[24:31], v116
    ds_read_b128 v[100:103], v117 offset:23552
    v_smfmac_f32_16x16x64_bf16 v[36:39], v[24:27], a[56:63], v116
    buffer_load_dwordx4 v117, s[8:11], s30 offen offset:1024 lds
    s_add_u32 m0, s52, 0x6000
    v_add_f32 v32, v32, v34
    v_smfmac_f32_16x16x64_bf16 v[36:39], v[28:31], a[88:95], v116
    ds_read_b128 v[104:107], v117 offset:23552
    v_add_f32 v33, v33, v35
    v_smfmac_f32_16x16x64_bf16 v[40:43], v[12:15], a[112:119], v116
    ds_read_b128 v[108:111], v117 offset:23552
    v_mul_f32 v32, s34, v32
    v_smfmac_f32_16x16x64_bf16 v[40:43], v[24:27], a[144:151], v116
    buffer_load_dword v125, v119, s[8:11], s28 offen sc1
    v_mul_f32 v33, s34, v33
    v_smfmac_f32_16x16x64_bf16 v[40:43], v[28:31], a[176:183], v116
    ds_read_b128 v[0:3], v124
    v_add_f32 v36, v36, v38
    v_smfmac_f32_16x16x64_bf16 v[48:51], v[4:7], a[208:215], v116
    v_add_f32 v37, v37, v39
    v_smfmac_f32_16x16x64_bf16 v[52:55], v[4:7], a[216:223], v116
    s_waitcnt lgkmcnt(5)
    buffer_load_dwordx4 v117, s[8:11], s31 offen lds
    v_mul_f32 v36, s34, v36
    v_smfmac_f32_16x16x64_bf16 v[44:47], v[12:15], a[120:127], v116
    ds_read_b128 v[4:7], v124 offset:1024
    v_mul_f32 v37, s34, v37
    v_smfmac_f32_16x16x64_bf16 v[44:47], v[24:27], a[152:159], v116
    v_cvt_pk_bf16_f32 v34, v32, v36
    v_smfmac_f32_16x16x64_bf16 v[44:47], v[28:31], a[184:191], v116
    buffer_load_dwordx4 v117, s[8:11], s31 offen offset:1024 lds
    s_mov_b32 m0, 5120
    v_cvt_pk_bf16_f32 v35, v33, v37
    v_add_f32 v40, v40, v42
    v_smfmac_f32_16x16x64_bf16 v[48:51], v[8:11], a[224:231], v116
    ds_write2_b32 v120, v34, v35 offset0:32 offset1:48
    v_add_f32 v41, v41, v43
    v_smfmac_f32_16x16x64_bf16 v[52:55], v[8:11], a[232:239], v116
    v_add_f32 v44, v44, v46
    v_add_f32 v45, v45, v47
    v_cvt_pk_bf16_f32 v113, v40, v44
    v_cvt_pk_bf16_f32 v115, v41, v45
    v_smfmac_f32_16x16x64_bf16 v[48:51], v[12:15], a[240:247], v116
    ds_write2_b32 v120, v113, v115 offset0:0 offset1:16
    v_smfmac_f32_16x16x64_bf16 v[52:55], v[12:15], a[248:255], v116
    s_cmp_eq_u32 s22, 63
    s_cbranch_scc1 L_chain_last_s
    v_smfmac_f32_16x16x64_bf16 v[48:51], v[16:19], v[128:135], v116
    v_smfmac_f32_16x16x64_bf16 v[48:51], v[20:23], v[160:167], v116
    v_smfmac_f32_16x16x64_bf16 v[48:51], v[24:27], v[144:151], v116
    s_waitcnt lgkmcnt(0)
    s_barrier
    v_smfmac_f32_16x16x64_bf16 v[48:51], v[28:31], v[176:183], v116
    ds_read_b128 v[32:35], v121 offset:16384
    ds_read_b128 v[36:39], v121 offset:17408
    v_smfmac_f32_16x16x64_bf16 v[52:55], v[16:19], v[136:143], v116
    ds_read_b128 v[40:43], v121 offset:18432
    ds_read_b128 v[44:47], v121 offset:19456
    v_smfmac_f32_16x16x64_bf16 v[52:55], v[20:23], v[168:175], v116
    ds_read_b128 v[8:11], v124 offset:32768
    v_add_f32 v48, v48, v50
    v_smfmac_f32_16x16x64_bf16 v[52:55], v[24:27], v[152:159], v116
    ds_read_b128 v[12:15], v124 offset:33792
    v_add_f32 v49, v49, v51
    v_smfmac_f32_16x16x64_bf16 v[52:55], v[28:31], v[184:191], v116
    s_waitcnt lgkmcnt(5)
    v_cvt_pk_bf16_f32 v112, v48, v49
    v_mfma_f32_16x16x32_bf16 v[56:59], v[56:59], v[32:35], 0
    s_waitcnt lgkmcnt(4)
    v_mov_b32 v48, s50
    v_mov_b32 v49, s50
    v_mfma_f32_16x16x32_bf16 v[56:59], v[60:63], v[36:39], v[56:59]
    ds_read_b128 v[16:19], v124 offset:2048
    s_waitcnt lgkmcnt(4)
    v_mov_b32 v50, s50
    v_mov_b32 v51, s50
    v_mfma_f32_16x16x32_bf16 v[56:59], v[64:67], v[40:43], v[56:59]
    ds_read_b128 v[20:23], v124 offset:3072
    s_waitcnt lgkmcnt(4)
    v_add_f32 v52, v52, v54
    v_mfma_f32_16x16x32_bf16 v[56:59], v[68:71], v[44:47], v[56:59]
    ds_read_b128 v[24:27], v124 offset:4096
    v_add_f32 v53, v53, v55
    v_mfma_f32_16x16x32_bf16 v[60:63], v[72:75], v[32:35], 0
    ds_read_b128 v[28:31], v124 offset:5120
    v_cvt_pk_bf16_f32 v114, v52, v53
    v_mov_b32 v53, 0
    v_mfma_f32_16x16x32_bf16 v[60:63], v[76:79], v[36:39], v[60:63]
    v_exp_f32 v56, v56
    v_mfma_f32_16x16x32_bf16 v[60:63], v[80:83], v[40:43], v[60:63]
    v_exp_f32 v57, v57
    v_mfma_f32_16x16x32_bf16 v[60:63], v[84:87], v[44:47], v[60:63]
    v_exp_f32 v58, v58
    v_mfma_f32_16x16x32_bf16 v[64:67], v[32:35], v[32:35], 0
    v_exp_f32 v59, v59
    v_cvt_pk_bf16_f32 v68, v56, v57
    v_mfma_f32_16x16x32_bf16 v[64:67], v[36:39], v[36:39], v[64:67]
    v_exp_f32 v60, v60
    v_cvt_pk_bf16_f32 v69, v58, v59
    v_mfma_f32_16x16x32_bf16 v[64:67], v[40:43], v[40:43], v[64:67]
    v_exp_f32 v61, v61
    v_mfma_f32_16x16x32_bf16 v[64:67], v[44:47], v[44:47], v[64:67]
    v_exp_f32 v62, v62
    v_exp_f32 v63, v63
    v_cvt_pk_bf16_f32 v70, v60, v61
    v_cvt_pk_bf16_f32 v71, v62, v63
    s_nop 1
    v_mfma_f32_16x16x32_bf16 v[72:75], v[88:91], v[68:71], 0
    s_nop 0
    v_exp_f32 v64, v64
    v_mfma_f32_16x16x32_bf16 v[76:79], v[92:95], v[68:71], 0
    v_exp_f32 v65, v65
    v_mfma_f32_16x16x32_bf16 v[80:83], v[48:51], v[68:71], 0
    v_cvt_pk_bf16_f32 v52, v64, v65
    s_nop 1
    v_mfma_f32_16x16x16_bf16 v[72:75], v[112:113], v[52:53], v[72:75]
    ds_read_b128 v[32:35], v124 offset:6144
    v_mfma_f32_16x16x16_bf16 v[76:79], v[114:115], v[52:53], v[76:79]
    ds_read_b128 v[36:39], v124 offset:7168
    v_mfma_f32_16x16x16_bf16 v[80:83], v[48:49], v[52:53], v[80:83]
L_norm_63:
    s_mov_b64 vcc, s[36:37]
    v_mov_b32 v122, v122
    v_mov_b32 v122, v122
    v_mov_b32 v122, v122
    v_cndmask_b32_dpp v76, v72, v76, vcc quad_perm:[2,3,2,3] row_mask:0xf bank_mask:0xf
    v_cndmask_b32_dpp v77, v73, v77, vcc quad_perm:[2,3,2,3] row_mask:0xf bank_mask:0xf
    v_cndmask_b32_dpp v78, v74, v78, vcc quad_perm:[2,3,2,3] row_mask:0xf bank_mask:0xf
    v_cndmask_b32_dpp v79, v75, v79, vcc quad_perm:[2,3,2,3] row_mask:0xf bank_mask:0xf
    v_rcp_f32_dpp v84, v80 quad_perm:[2,3,2,3] row_mask:0xf bank_mask:0xf
    s_nop 0
    v_pk_mul_f32 v[76:77], v[76:77], v[84:85] op_sel_hi:[1,0]
    v_pk_mul_f32 v[78:79], v[78:79], v[84:85] op_sel_hi:[1,0]
    v_cvt_pk_bf16_f32 v72, v76, v77
    v_cvt_pk_bf16_f32 v73, v78, v79
    ds_write_b64 v122, v[72:73] offset:20992
    v_max_f32_dpp v86, v80, v84 quad_perm:[2,3,2,3] row_mask:0xf bank_mask:0xf
    v_mov_b32_dpp v60, v72 quad_perm:[0,1,0,1] row_mask:0xf bank_mask:0xf
    v_mov_b32_dpp v61, v73 quad_perm:[0,1,0,1] row_mask:0xf bank_mask:0xf
    v_cmp_lt_f32 vcc, s35, v86
    v_mov_b32_dpp v62, v72 quad_perm:[2,3,2,3] row_mask:0xf bank_mask:0xf
    v_mov_b32_dpp v63, v73 quad_perm:[2,3,2,3] row_mask:0xf bank_mask:0xf
    s_nop 1
    v_smfmac_f32_16x16x64_bf16 v[96:99], v[60:63], v[192:199], v116
    s_cbranch_vccnz L_smax_64
    v_smfmac_f32_16x16x64_bf16 v[100:103], v[60:63], v[224:231], v116
    s_waitcnt lgkmcnt(0)
    s_barrier
    ds_read_b128 v[92:95], v127 offset:20480
    ds_read_b128 v[80:83], v127 offset:22016
    ds_read_b128 v[84:87], v127 offset:21504
    v_smfmac_f32_16x16x64_bf16 v[104:107], v[60:63], v[0:7], v116
    ds_read_b128 v[40:43], v124 offset:34816
    v_smfmac_f32_16x16x64_bf16 v[108:111], v[60:63], v[8:15], v116
    ds_read_b128 v[56:59], v124 offset:36864
    s_waitcnt lgkmcnt(4)
    v_smfmac_f32_16x16x64_bf16 v[96:99], v[92:95], v[200:207], v116
    s_waitcnt lgkmcnt(3)
    v_smfmac_f32_16x16x64_bf16 v[96:99], v[80:83], v[208:215], v116
    ds_read_b128 v[44:47], v124 offset:35840
    s_waitcnt lgkmcnt(3)
    v_smfmac_f32_16x16x64_bf16 v[96:99], v[84:87], v[216:223], v116
    ds_read_b128 v[68:71], v124 offset:39936
    v_smfmac_f32_16x16x64_bf16 v[100:103], v[92:95], v[232:239], v116
    ds_read_b128 v[64:67], v124 offset:38912
    v_smfmac_f32_16x16x64_bf16 v[100:103], v[80:83], v[240:247], v116
    ds_read_b128 v[60:63], v124 offset:37888
    v_cvt_pk_bf16_f32 v72, v96, v98
    v_smfmac_f32_16x16x64_bf16 v[100:103], v[84:87], v[248:255], v116
    v_and_or_b32 v72, v72, -2, s33
    v_smfmac_f32_16x16x64_bf16 v[104:107], v[92:95], v[16:23], v116
    v_cvt_pk_bf16_f32 v74, v97, v99
    v_smfmac_f32_16x16x64_bf16 v[104:107], v[80:83], v[24:31], v116
    v_cvt_pk_bf16_f32 v73, v100, v102
    v_cvt_pk_bf16_f32 v75, v101, v103
    v_smfmac_f32_16x16x64_bf16 v[104:107], v[84:87], v[32:39], v116
    buffer_store_dwordx4 v[72:75], v118, s[8:11], s25 offen sc1
    s_waitcnt lgkmcnt(3)
    v_smfmac_f32_16x16x64_bf16 v[108:111], v[92:95], v[40:47], v116
    s_waitcnt lgkmcnt(0)
    v_smfmac_f32_16x16x64_bf16 v[108:111], v[80:83], v[56:63], v116
    v_cvt_pk_bf16_f32 v76, v104, v106
    v_smfmac_f32_16x16x64_bf16 v[108:111], v[84:87], v[64:71], v116
    v_and_or_b32 v76, v76, -2, s33
    v_cvt_pk_bf16_f32 v78, v105, v107
    v_mov_b32 v122, v122
    v_mov_b32 v122, v122
    v_mov_b32 v122, v122
    v_mov_b32 v122, v122
    v_mov_b32 v122, v122
    v_mov_b32 v122, v122
    v_cvt_pk_bf16_f32 v77, v108, v110
    v_cvt_pk_bf16_f32 v79, v109, v111
    buffer_store_dwordx4 v[76:79], v118, s[8:11], s26 offen sc1
    s_add_u32 s30, s30, 0x40000
    s_add_u32 s31, s31, 0x40000
    s_add_u32 s32, s32, 0x20000
    s_add_u32 s23, s24, 1024
    s_add_u32 s48, s23, 4096
    s_xor_b32 s25, s25, 0x40000
    s_xor_b32 s26, s26, 0x40000
    s_mov_b32 s35, 0x49800000
    s_add_u32 s22, s22, 1
    v_mov_b32 v32, 0
    v_mov_b32 v33, 0
    v_mov_b32 v34, 0
    v_mov_b32 v35, 0
    v_mov_b32 v36, 0
    v_mov_b32 v37, 0
    v_mov_b32 v38, 0
    v_mov_b32 v39, 0
    v_mov_b32 v40, 0
    v_mov_b32 v41, 0
    v_mov_b32 v42, 0
    v_mov_b32 v43, 0
    v_mov_b32 v44, 0
    v_mov_b32 v45, 0
    v_mov_b32 v46, 0
    v_mov_b32 v47, 0
    v_mov_b32 v48, 0
    v_mov_b32 v49, 0
    v_mov_b32 v50, 0
    v_mov_b32 v51, 0
    v_mov_b32 v52, 0
    v_mov_b32 v53, 0
    v_mov_b32 v54, 0
    v_mov_b32 v55, 0
    ds_read_b128 v[80:83], v123
    ds_read_b128 v[84:87], v123 offset:1024
    ds_read_b128 v[56:59], v123 offset:2048
    ds_read_b128 v[60:63], v123 offset:3072
    ds_read_b128 v[64:67], v123 offset:32768
    ds_read_b128 v[68:71], v123 offset:33792
    ds_read_b128 v[72:75], v123 offset:34816
    ds_read_b128 v[76:79], v123 offset:35840
    ds_read_b128 v[88:91], v123 offset:4096
    ds_read_b128 v[92:95], v123 offset:5120
    ds_read_b128 v[96:99], v123 offset:6144
    ds_read_b128 v[100:103], v123 offset:7168
    ds_read_b128 v[104:107], v123 offset:36864
    ds_read_b128 v[108:111], v123 offset:37888
    ds_read_b128 v[24:27], v123 offset:38912
    ds_read_b128 v[28:31], v123 offset:39936
    s_add_u32 s24, s24, 8192
    s_bitset0_b32 s24, 15
    s_xor_b32 s55, s24, 16384
    s_xor_b32 s29, s29, 0x40000
    s_xor_b32 s53, s29, 1024
    s_bfe_u32 s33, s22, 0x10001
    s_add_u32 s40, s22, 5
    s_lshr_b32 s40, s40, 2
    s_min_u32 s40, s40, 16
    s_bfm_b32 s58, s40, 0
    s_waitcnt vmcnt(4)
    v_cmp_eq_u32 vcc, 0, v125
    s_nop 0
    s_and_b64 vcc, vcc, s[58:59]
    s_cbranch_scc1 L_kvw_65
L_kvb_66:
    v_mov_b32 v15, 0
    s_nop 2
    v_mov_b32 v15, 0
    s_nop 2
    v_mov_b32 v15, 0
    s_nop 2
    v_mov_b32 v15, 0
    s_nop 2
    v_mov_b32 v15, 0
    s_nop 2
    v_mov_b32 v15, 0
    s_nop 2
    v_mov_b32 v15, 0
    s_nop 2
    v_mov_b32 v15, 0
    s_nop 2
    v_mov_b32 v15, 0
    s_nop 2
    v_mov_b32 v15, 0
    s_nop 2
    v_mov_b32 v15, 0
    s_nop 2
    v_mov_b32 v15, 0
    s_nop 2
    v_mov_b32 v15, 0
    s_nop 2
    v_mov_b32 v15, 0
    s_nop 2
    v_mov_b32 v15, 0
    s_nop 2
    v_mov_b32 v15, 0
    s_nop 2
    v_mov_b32 v15, 0
    s_nop 2
    v_mov_b32 v15, 0
    s_nop 2
    v_mov_b32 v15, 0
    s_nop 2
    v_mov_b32 v15, 0
    s_nop 2
    v_mov_b32 v15, 0
    s_nop 2
    v_mov_b32 v15, 0
    s_nop 2
    v_mov_b32 v15, 0
    s_nop 2
    v_mov_b32 v15, 0
    s_nop 2
    v_mov_b32 v15, 0
    s_nop 2
    v_mov_b32 v15, 0
    s_nop 2
    v_mov_b32 v15, 0
    s_nop 2
    v_mov_b32 v15, 0
    s_nop 2
    v_mov_b32 v15, 0
    s_nop 2
    v_mov_b32 v15, 0
    s_nop 2
    v_mov_b32 v15, 0
    s_nop 2
    s_waitcnt lgkmcnt(0)
    s_branch L_chain_top1_s
.p2align 6
L_chain_top2_s:
    buffer_load_dwordx4 v[0:3], v117, s[8:11], s23 offen sc1
    v_mov_b32 v48, 0
    v_mov_b32 v49, 0
    v_mov_b32 v50, 0
    v_mov_b32 v51, 0
    v_mov_b32 v52, 0
    v_mov_b32 v53, 0
    v_mov_b32 v15, 0
    v_mov_b32 v15, 0
    v_mov_b32 v15, 0
    v_mov_b32 v15, 0
    v_mov_b32 v15, 0
    v_mov_b32 v15, 0
    v_mov_b32 v15, 0
    v_mov_b32 v15, 0
    v_mov_b32 v15, 0
    v_mov_b32 v15, 0
    buffer_load_dwordx4 v[0:3], v117, s[8:11], s23 offen sc1
    s_waitcnt vmcnt(3)
    v_mov_b32 v36, 0
    v_mov_b32 v37, 0
    v_mov_b32 v38, 0
    v_mov_b32 v39, 0
    v_mov_b32 v40, 0
    v_mov_b32 v41, 0
    v_mov_b32 v42, 0
    v_mov_b32 v43, 0
    v_mov_b32 v44, 0
    v_mov_b32 v45, 0
    v_mov_b32 v46, 0
    v_mov_b32 v47, 0
    v_mov_b32 v15, 0
    v_mov_b32 v15, 0
    v_mov_b32 v15, 0
    v_mov_b32 v15, 0
L_mret_67:
    buffer_load_dwordx4 v[0:3], v117, s[8:11], s23 offen sc1
    s_add_u32 s45, s45, 1
    s_cmp_lt_u32 s45, 0x10000
    s_cselect_b32 s56, -2, -1
    s_nop 3
    v_mov_b32 v32, 0
    v_mov_b32 v33, 0
    v_mov_b32 v34, 0
    v_mov_b32 v35, 0
    s_waitcnt vmcnt(2)
    v_max3_u32 v15, v0, v1, v2
    v_max_u32 v15, v15, v3
    v_cmp_lt_u32 vcc, s56, v15
    v_smfmac_f32_16x16x64_bf16 v[32:35], v[0:3], v[80:87], v116
    s_cbranch_vccnz L_mret_67
    ds_write_b128 v117, v[0:3] offset:2048
    v_smfmac_f32_16x16x64_bf16 v[36:39], v[0:3], v[56:63], v116
    buffer_load_dwordx4 v[4:7], v117, s[8:11], s48 offen sc1
    v_smfmac_f32_16x16x64_bf16 v[40:43], v[0:3], v[64:71], v116
    buffer_load_dwordx4 v117, s[8:11], s48 offen sc1 lds
    s_mov_b32 m0, 12288
    v_smfmac_f32_16x16x64_bf16 v[44:47], v[0:3], v[72:79], v116
    s_waitcnt lgkmcnt(0)
    s_barrier
    ds_read_b128 v[8:11], v117 offset:3072
    v_smfmac_f32_16x16x64_bf16 v[48:51], v[0:3], a[192:199], v116
    ds_read_b128 v[16:19], v117
    ds_read_b128 v[20:23], v117 offset:1024
    v_smfmac_f32_16x16x64_bf16 v[52:55], v[0:3], a[200:207], v116
    ds_read_b128 v[80:83], v117 offset:14336
    s_waitcnt lgkmcnt(3)
    v_smfmac_f32_16x16x64_bf16 v[32:35], v[8:11], a[0:7], v116
    ds_read_b128 v[84:87], v117 offset:15360
    v_smfmac_f32_16x16x64_bf16 v[36:39], v[8:11], a[8:15], v116
    ds_read_b128 v[56:59], v117 offset:8192
    s_waitcnt lgkmcnt(4)
    v_smfmac_f32_16x16x64_bf16 v[32:35], v[16:19], a[32:39], v116
    ds_read_b128 v[60:63], v117 offset:9216
    v_smfmac_f32_16x16x64_bf16 v[36:39], v[16:19], a[40:47], v116
    ds_read_b128 v[64:67], v117 offset:10240
    s_waitcnt lgkmcnt(5)
    v_smfmac_f32_16x16x64_bf16 v[32:35], v[20:23], a[64:71], v116
    ds_read_b128 v[68:71], v117 offset:11264
    v_smfmac_f32_16x16x64_bf16 v[36:39], v[20:23], a[72:79], v116
    buffer_store_dwordx4 v[112:115], v117, s[8:11], s32 offen sc1
    v_smfmac_f32_16x16x64_bf16 v[40:43], v[8:11], a[96:103], v116
    ds_read_b128 v[72:75], v117 offset:12288
    v_smfmac_f32_16x16x64_bf16 v[40:43], v[16:19], a[128:135], v116
    ds_read_b128 v[76:79], v117 offset:13312
    v_smfmac_f32_16x16x64_bf16 v[40:43], v[20:23], a[160:167], v116
    s_waitcnt vmcnt(2)
    v_max3_u32 v15, v4, v5, v6
    v_smfmac_f32_16x16x64_bf16 v[44:47], v[8:11], a[104:111], v116
    v_max_u32 v15, v15, v7
    v_smfmac_f32_16x16x64_bf16 v[44:47], v[16:19], a[136:143], v116
    s_waitcnt vmcnt(1) lgkmcnt(0)
    v_cmp_lt_u32 vcc, s56, v15
    v_smfmac_f32_16x16x64_bf16 v[44:47], v[20:23], a[168:175], v116
    s_cbranch_vccnz L_mret_68
L_mgo_69:
    v_smfmac_f32_16x16x64_bf16 v[44:47], v[4:7], v[24:31], v116
    s_barrier
    ds_read_b128 v[12:15], v117 offset:7168
    v_smfmac_f32_16x16x64_bf16 v[32:35], v[4:7], v[88:95], v116
    ds_read_b128 v[24:27], v117 offset:4096
    v_smfmac_f32_16x16x64_bf16 v[36:39], v[4:7], v[96:103], v116
    ds_read_b128 v[28:31], v117 offset:5120
    v_smfmac_f32_16x16x64_bf16 v[40:43], v[4:7], v[104:111], v116
    ds_read_b128 v[88:91], v117 offset:28672
    s_waitcnt lgkmcnt(3)
    v_smfmac_f32_16x16x64_bf16 v[32:35], v[12:15], a[16:23], v116
    ds_read_b128 v[92:95], v117 offset:29696
    s_waitcnt lgkmcnt(3)
    v_smfmac_f32_16x16x64_bf16 v[32:35], v[24:27], a[48:55], v116
    buffer_load_dwordx4 v117, s[8:11], s30 offen lds
    s_waitcnt lgkmcnt(2)
    v_smfmac_f32_16x16x64_bf16 v[32:35], v[28:31], a[80:87], v116
    ds_read_b128 v[96:99], v117 offset:23552
    v_smfmac_f32_16x16x64_bf16 v[36:39], v[12:15], a[24:31], v116
    ds_read_b128 v[100:103], v117 offset:23552
    v_smfmac_f32_16x16x64_bf16 v[36:39], v[24:27], a[56:63], v116
    buffer_load_dwordx4 v117, s[8:11], s30 offen offset:1024 lds
    s_add_u32 m0, s52, 0x6000
    v_add_f32 v32, v32, v34
    v_smfmac_f32_16x16x64_bf16 v[36:39], v[28:31], a[88:95], v116
    ds_read_b128 v[104:107], v117 offset:23552
    v_add_f32 v33, v33, v35
    v_smfmac_f32_16x16x64_bf16 v[40:43], v[12:15], a[112:119], v116
    ds_read_b128 v[108:111], v117 offset:23552
    v_mul_f32 v32, s34, v32
    v_smfmac_f32_16x16x64_bf16 v[40:43], v[24:27], a[144:151], v116
    s_waitcnt lgkmcnt(4)
    buffer_load_dwordx4 v117, s[8:11], s31 offen lds
    v_mul_f32 v33, s34, v33
    v_smfmac_f32_16x16x64_bf16 v[40:43], v[28:31], a[176:183], v116
    ds_read_b128 v[0:3], v124
    v_add_f32 v36, v36, v38
    v_smfmac_f32_16x16x64_bf16 v[48:51], v[4:7], a[208:215], v116
    v_add_f32 v37, v37, v39
    v_smfmac_f32_16x16x64_bf16 v[52:55], v[4:7], a[216:223], v116
    buffer_load_dwordx4 v117, s[8:11], s31 offen offset:1024 lds
    s_mov_b32 m0, 6144
    v_mul_f32 v36, s34, v36
    v_smfmac_f32_16x16x64_bf16 v[44:47], v[12:15], a[120:127], v116
    ds_read_b128 v[4:7], v124 offset:1024
    v_mul_f32 v37, s34, v37
    v_smfmac_f32_16x16x64_bf16 v[44:47], v[24:27], a[152:159], v116
    v_cvt_pk_bf16_f32 v34, v32, v36
    v_smfmac_f32_16x16x64_bf16 v[44:47], v[28:31], a[184:191], v116
    v_cvt_pk_bf16_f32 v35, v33, v37
    v_add_f32 v40, v40, v42
    v_smfmac_f32_16x16x64_bf16 v[48:51], v[8:11], a[224:231], v116
    ds_write2_b32 v120, v34, v35 offset0:32 offset1:48
    v_add_f32 v41, v41, v43
    v_smfmac_f32_16x16x64_bf16 v[52:55], v[8:11], a[232:239], v116
    v_add_f32 v44, v44, v46
    v_add_f32 v45, v45, v47
    v_cvt_pk_bf16_f32 v113, v40, v44
    v_cvt_pk_bf16_f32 v115, v41, v45
    v_smfmac_f32_16x16x64_bf16 v[48:51], v[12:15], a[240:247], v116
    ds_write2_b32 v120, v113, v115 offset0:0 offset1:16
    v_smfmac_f32_16x16x64_bf16 v[52:55], v[12:15], a[248:255], v116
    s_cmp_eq_u32 s22, 63
    s_cbranch_scc1 L_chain_last_s
    v_smfmac_f32_16x16x64_bf16 v[48:51], v[16:19], v[128:135], v116
    buffer_store_dword v126, v119, s[8:11], s55 offen sc1
    v_smfmac_f32_16x16x64_bf16 v[48:51], v[20:23], v[160:167], v116
    v_smfmac_f32_16x16x64_bf16 v[48:51], v[24:27], v[144:151], v116
    s_waitcnt lgkmcnt(0)
    s_barrier
    v_smfmac_f32_16x16x64_bf16 v[48:51], v[28:31], v[176:183], v116
    ds_read_b128 v[32:35], v121 offset:16384
    ds_read_b128 v[36:39], v121 offset:17408
    v_smfmac_f32_16x16x64_bf16 v[52:55], v[16:19], v[136:143], v116
    ds_read_b128 v[40:43], v121 offset:18432
    ds_read_b128 v[44:47], v121 offset:19456
    v_smfmac_f32_16x16x64_bf16 v[52:55], v[20:23], v[168:175], v116
    ds_read_b128 v[8:11], v124 offset:32768
    v_add_f32 v48, v48, v50
    v_smfmac_f32_16x16x64_bf16 v[52:55], v[24:27], v[152:159], v116
    ds_read_b128 v[12:15], v124 offset:33792
    v_add_f32 v49, v49, v51
    v_smfmac_f32_16x16x64_bf16 v[52:55], v[28:31], v[184:191], v116
    s_waitcnt lgkmcnt(5)
    v_cvt_pk_bf16_f32 v112, v48, v49
    v_mfma_f32_16x16x32_bf16 v[56:59], v[56:59], v[32:35], 0
    s_waitcnt lgkmcnt(4)
    v_mov_b32 v48, s50
    v_mov_b32 v49, s50
    v_mfma_f32_16x16x32_bf16 v[56:59], v[60:63], v[36:39], v[56:59]
    ds_read_b128 v[16:19], v124 offset:2048
    s_waitcnt lgkmcnt(4)
    v_mov_b32 v50, s50
    v_mov_b32 v51, s50
    v_mfma_f32_16x16x32_bf16 v[56:59], v[64:67], v[40:43], v[56:59]
    ds_read_b128 v[20:23], v124 offset:3072
    s_waitcnt lgkmcnt(4)
    v_add_f32 v52, v52, v54
    v_mfma_f32_16x16x32_bf16 v[56:59], v[68:71], v[44:47], v[56:59]
    ds_read_b128 v[24:27], v124 offset:4096
    v_add_f32 v53, v53, v55
    v_mfma_f32_16x16x32_bf16 v[60:63], v[72:75], v[32:35], 0
    ds_read_b128 v[28:31], v124 offset:5120
    v_cvt_pk_bf16_f32 v114, v52, v53
    v_mov_b32 v53, 0
    v_mfma_f32_16x16x32_bf16 v[60:63], v[76:79], v[36:39], v[60:63]
    v_exp_f32 v56, v56
    v_mfma_f32_16x16x32_bf16 v[60:63], v[80:83], v[40:43], v[60:63]
    v_exp_f32 v57, v57
    v_mfma_f32_16x16x32_bf16 v[60:63], v[84:87], v[44:47], v[60:63]
    v_exp_f32 v58, v58
    v_mfma_f32_16x16x32_bf16 v[64:67], v[32:35], v[32:35], 0
    v_exp_f32 v59, v59
    v_cvt_pk_bf16_f32 v68, v56, v57
    v_mfma_f32_16x16x32_bf16 v[64:67], v[36:39], v[36:39], v[64:67]
    v_exp_f32 v60, v60
    v_cvt_pk_bf16_f32 v69, v58, v59
    v_mfma_f32_16x16x32_bf16 v[64:67], v[40:43], v[40:43], v[64:67]
    v_exp_f32 v61, v61
    v_mfma_f32_16x16x32_bf16 v[64:67], v[44:47], v[44:47], v[64:67]
    v_exp_f32 v62, v62
    v_exp_f32 v63, v63
    v_cvt_pk_bf16_f32 v70, v60, v61
    v_cvt_pk_bf16_f32 v71, v62, v63
    s_nop 1
    v_mfma_f32_16x16x32_bf16 v[72:75], v[88:91], v[68:71], 0
    s_nop 0
    v_exp_f32 v64, v64
    v_mfma_f32_16x16x32_bf16 v[76:79], v[92:95], v[68:71], 0
    v_exp_f32 v65, v65
    v_mfma_f32_16x16x32_bf16 v[80:83], v[48:51], v[68:71], 0
    v_cvt_pk_bf16_f32 v52, v64, v65
    s_nop 1
    v_mfma_f32_16x16x16_bf16 v[72:75], v[112:113], v[52:53], v[72:75]
    ds_read_b128 v[32:35], v124 offset:6144
    v_mfma_f32_16x16x16_bf16 v[76:79], v[114:115], v[52:53], v[76:79]
    ds_read_b128 v[36:39], v124 offset:7168
    v_mfma_f32_16x16x16_bf16 v[80:83], v[48:49], v[52:53], v[80:83]
L_norm_70:
    s_mov_b64 vcc, s[36:37]
    v_mov_b32 v122, v122
    v_mov_b32 v122, v122
    v_mov_b32 v122, v122
    v_cndmask_b32_dpp v76, v72, v76, vcc quad_perm:[2,3,2,3] row_mask:0xf bank_mask:0xf
    v_cndmask_b32_dpp v77, v73, v77, vcc quad_perm:[2,3,2,3] row_mask:0xf bank_mask:0xf
    v_cndmask_b32_dpp v78, v74, v78, vcc quad_perm:[2,3,2,3] row_mask:0xf bank_mask:0xf
    v_cndmask_b32_dpp v79, v75, v79, vcc quad_perm:[2,3,2,3] row_mask:0xf bank_mask:0xf
    v_rcp_f32_dpp v84, v80 quad_perm:[2,3,2,3] row_mask:0xf bank_mask:0xf
    s_nop 0
    v_pk_mul_f32 v[76:77], v[76:77], v[84:85] op_sel_hi:[1,0]
    v_pk_mul_f32 v[78:79], v[78:79], v[84:85] op_sel_hi:[1,0]
    v_cvt_pk_bf16_f32 v72, v76, v77
    v_cvt_pk_bf16_f32 v73, v78, v79
    ds_write_b64 v122, v[72:73] offset:21504
    v_max_f32_dpp v86, v80, v84 quad_perm:[2,3,2,3] row_mask:0xf bank_mask:0xf
    v_mov_b32_dpp v60, v72 quad_perm:[0,1,0,1] row_mask:0xf bank_mask:0xf
    v_mov_b32_dpp v61, v73 quad_perm:[0,1,0,1] row_mask:0xf bank_mask:0xf
    v_cmp_lt_f32 vcc, s35, v86
    v_mov_b32_dpp v62, v72 quad_perm:[2,3,2,3] row_mask:0xf bank_mask:0xf
    v_mov_b32_dpp v63, v73 quad_perm:[2,3,2,3] row_mask:0xf bank_mask:0xf
    s_nop 1
    v_smfmac_f32_16x16x64_bf16 v[96:99], v[60:63], v[192:199], v116
    s_cbranch_vccnz L_smax_71
    v_smfmac_f32_16x16x64_bf16 v[100:103], v[60:63], v[224:231], v116
    s_waitcnt lgkmcnt(0)
    s_barrier
    ds_read_b128 v[92:95], v127 offset:22016
    ds_read_b128 v[80:83], v127 offset:20480
    ds_read_b128 v[84:87], v127 offset:20992
    v_smfmac_f32_16x16x64_bf16 v[104:107], v[60:63], v[0:7], v116
    ds_read_b128 v[40:43], v124 offset:34816
    v_smfmac_f32_16x16x64_bf16 v[108:111], v[60:63], v[8:15], v116
    ds_read_b128 v[56:59], v124 offset:36864
    s_waitcnt lgkmcnt(4)
    v_smfmac_f32_16x16x64_bf16 v[96:99], v[92:95], v[200:207], v116
    s_waitcnt lgkmcnt(3)
    v_smfmac_f32_16x16x64_bf16 v[96:99], v[80:83], v[208:215], v116
    ds_read_b128 v[44:47], v124 offset:35840
    s_waitcnt lgkmcnt(3)
    v_smfmac_f32_16x16x64_bf16 v[96:99], v[84:87], v[216:223], v116
    ds_read_b128 v[68:71], v124 offset:39936
    v_smfmac_f32_16x16x64_bf16 v[100:103], v[92:95], v[232:239], v116
    ds_read_b128 v[64:67], v124 offset:38912
    v_smfmac_f32_16x16x64_bf16 v[100:103], v[80:83], v[240:247], v116
    ds_read_b128 v[60:63], v124 offset:37888
    v_cvt_pk_bf16_f32 v72, v96, v98
    v_smfmac_f32_16x16x64_bf16 v[100:103], v[84:87], v[248:255], v116
    v_and_or_b32 v72, v72, -2, s33
    v_smfmac_f32_16x16x64_bf16 v[104:107], v[92:95], v[16:23], v116
    v_cvt_pk_bf16_f32 v74, v97, v99
    v_smfmac_f32_16x16x64_bf16 v[104:107], v[80:83], v[24:31], v116
    v_cvt_pk_bf16_f32 v73, v100, v102
    v_cvt_pk_bf16_f32 v75, v101, v103
    v_smfmac_f32_16x16x64_bf16 v[104:107], v[84:87], v[32:39], v116
    buffer_store_dwordx4 v[72:75], v118, s[8:11], s25 offen sc1
    s_waitcnt lgkmcnt(3)
    v_smfmac_f32_16x16x64_bf16 v[108:111], v[92:95], v[40:47], v116
    s_waitcnt lgkmcnt(0)
    v_smfmac_f32_16x16x64_bf16 v[108:111], v[80:83], v[56:63], v116
    v_cvt_pk_bf16_f32 v76, v104, v106
    v_smfmac_f32_16x16x64_bf16 v[108:111], v[84:87], v[64:71], v116
    v_and_or_b32 v76, v76, -2, s33
    v_cvt_pk_bf16_f32 v78, v105, v107
    v_mov_b32 v122, v122
    v_mov_b32 v122, v122
    v_mov_b32 v122, v122
    v_mov_b32 v122, v122
    v_mov_b32 v122, v122
    v_mov_b32 v122, v122
    v_cvt_pk_bf16_f32 v77, v108, v110
    v_cvt_pk_bf16_f32 v79, v109, v111
    buffer_store_dwordx4 v[76:79], v118, s[8:11], s26 offen sc1
    ds_read_b128 v[80:83], v123
    ds_read_b128 v[84:87], v123 offset:1024
    ds_read_b128 v[56:59], v123 offset:2048
    ds_read_b128 v[60:63], v123 offset:3072
    ds_read_b128 v[64:67], v123 offset:32768
    ds_read_b128 v[68:71], v123 offset:33792
    ds_read_b128 v[72:75], v123 offset:34816
    ds_read_b128 v[76:79], v123 offset:35840
    ds_read_b128 v[88:91], v123 offset:4096
    ds_read_b128 v[92:95], v123 offset:5120
    ds_read_b128 v[96:99], v123 offset:6144
    ds_read_b128 v[100:103], v123 offset:7168
    ds_read_b128 v[104:107], v123 offset:36864
    ds_read_b128 v[108:111], v123 offset:37888
    ds_read_b128 v[24:27], v123 offset:38912
    ds_read_b128 v[28:31], v123 offset:39936
    s_add_u32 s30, s30, 0x40000
    s_add_u32 s31, s31, 0x40000
    s_add_u32 s32, s32, 0x20000
    s_add_u32 s23, s24, 2048
    s_add_u32 s48, s23, 4096
    s_xor_b32 s25, s25, 0x40000
    s_xor_b32 s26, s26, 0x40000
    s_mov_b32 s35, 0x49800000
    s_add_u32 s22, s22, 1
    v_cndmask_b32 v12, 0, v125, s[68:69]
    v_cndmask_b32 v13, 0, v125, s[70:71]
    v_cndmask_b32 v14, 0, v125, s[72:73]
    v_cndmask_b32 v15, 0, v125, s[74:75]
    v_mov_b32 v54, 0
    v_mov_b32 v55, 0
    v_mov_b32 v52, 0
    v_mov_b32 v52, 0
    v_mov_b32 v52, 0
    v_mov_b32 v52, 0
    v_mov_b32 v52, 0
    v_mov_b32 v52, 0
    v_mov_b32 v52, 0
    v_mov_b32 v52, 0
    v_mov_b32 v52, 0
    v_mov_b32 v52, 0
    v_mov_b32 v52, 0
    v_mov_b32 v52, 0
    v_mov_b32 v52, 0
    v_mov_b32 v52, 0
    v_mov_b32 v52, 0
    v_mov_b32 v52, 0
    v_mov_b32 v52, 0
    v_mov_b32 v52, 0
    v_mov_b32 v52, 0
    buffer_load_dwordx4 v[4:7], v117, s[8:11], s29 offen sc1
    buffer_load_dwordx4 v[8:11], v117, s[8:11], s53 offen sc1
    buffer_load_dwordx4 v[16:19], v117, s[8:11], s29 offen offset:2048 sc1
    buffer_load_dwordx4 v[20:23], v117, s[8:11], s53 offen offset:2048 sc1
    v_mov_b32 v52, 0
    v_mov_b32 v52, 0
    v_mov_b32 v52, 0
    v_mov_b32 v52, 0
    v_mov_b32 v52, 0
    v_mov_b32 v52, 0
    v_mov_b32 v52, 0
    v_mov_b32 v52, 0
    v_mov_b32 v52, 0
    v_mov_b32 v52, 0
    v_mov_b32 v52, 0
    v_mov_b32 v52, 0
    v_mov_b32 v52, 0
    v_mov_b32 v52, 0
    v_mov_b32 v52, 0
    v_mov_b32 v52, 0
    v_mov_b32 v52, 0
    v_mov_b32 v52, 0
    v_mov_b32 v52, 0
    v_mov_b32 v52, 0
    v_mov_b32 v52, 0
    v_mov_b32 v52, 0
    v_mov_b32 v52, 0
    v_mov_b32 v52, 0
    v_mov_b32 v52, 0
    v_mov_b32 v52, 0
    v_mov_b32 v52, 0
    v_mov_b32 v52, 0
    v_mov_b32 v52, 0
    v_mov_b32 v52, 0
    v_mov_b32 v52, 0
    v_mov_b32 v52, 0
    v_mov_b32 v52, 0
    v_mov_b32 v52, 0
    v_mov_b32 v52, 0
    v_mov_b32 v52, 0
    v_mov_b32 v52, 0
    v_mov_b32 v52, 0
    v_mov_b32 v52, 0
    v_mov_b32 v52, 0
    buffer_load_dwordx4 v[32:35], v117, s[8:11], s29 offen sc1
    buffer_load_dwordx4 v[36:39], v117, s[8:11], s53 offen sc1
    buffer_load_dwordx4 v[40:43], v117, s[8:11], s29 offen offset:2048 sc1
    buffer_load_dwordx4 v[44:47], v117, s[8:11], s53 offen offset:2048 sc1
    v_mov_b32 v52, 0
L_rl_72:
    s_waitcnt vmcnt(7)
    v_mfma_f32_16x16x32_bf16 v[48:51], v[4:7], v[12:15], 0
    v_xor_b32 v52, s33, v4
    s_waitcnt vmcnt(6)
    v_mfma_f32_16x16x32_bf16 v[48:51], v[8:11], v[12:15], v[48:51]
    v_xor_b32 v53, s33, v8
    v_or_b32 v52, v52, v53
    s_waitcnt vmcnt(5)
    v_mfma_f32_16x16x32_bf16 v[48:51], v[16:19], v[12:15], v[48:51]
    v_xor_b32 v53, s33, v16
    v_or_b32 v52, v52, v53
    s_waitcnt vmcnt(4)
    v_mfma_f32_16x16x32_bf16 v[48:51], v[20:23], v[12:15], v[48:51]
    v_xor_b32 v53, s33, v20
    v_or_b32 v52, v52, v53
    v_and_b32 v52, 1, v52
    v_cmp_ne_u32 vcc, 0, v52
    s_cbranch_vccnz L_rslow_73
L_rgo_74:
    s_nop 2
    v_permlane32_swap_b32 v48, v50
    v_permlane32_swap_b32 v49, v51
    v_pk_add_f32 v[48:49], v[48:49], v[50:51]
    s_mov_b64 exec, s[38:39]
    v_cvt_pk_bf16_f32 v12, v48, v49
    v_min_u32 v12, 0xfffffffe, v12
    buffer_store_dword v12, v119, s[8:11], s24 offen sc1
    s_mov_b64 exec, -1
    s_add_u32 s24, s24, 8192
    s_bitset0_b32 s24, 15
    s_xor_b32 s55, s24, 16384
    s_xor_b32 s29, s29, 0x40000
    s_xor_b32 s53, s29, 1024
    s_bfe_u32 s33, s22, 0x10001
    s_waitcnt lgkmcnt(0)
    s_branch L_chain_top2_s
.p2align 6
L_chain_top3_s:
    buffer_load_dwordx4 v[0:3], v117, s[8:11], s23 offen sc1
    v_mov_b32 v48, 0
    v_mov_b32 v49, 0
    v_mov_b32 v50, 0
    v_mov_b32 v51, 0
    v_mov_b32 v52, 0
    v_mov_b32 v53, 0
    v_mov_b32 v15, 0
    v_mov_b32 v15, 0
    v_mov_b32 v15, 0
    v_mov_b32 v15, 0
    v_mov_b32 v15, 0
    v_mov_b32 v15, 0
    v_mov_b32 v15, 0
    v_mov_b32 v15, 0
    v_mov_b32 v15, 0
    v_mov_b32 v15, 0
    buffer_load_dwordx4 v[0:3], v117, s[8:11], s23 offen sc1
    s_waitcnt vmcnt(3)
    v_mov_b32 v36, 0
    v_mov_b32 v37, 0
    v_mov_b32 v38, 0
    v_mov_b32 v39, 0
    v_mov_b32 v40, 0
    v_mov_b32 v41, 0
    v_mov_b32 v42, 0
    v_mov_b32 v43, 0
    v_mov_b32 v44, 0
    v_mov_b32 v45, 0
    v_mov_b32 v46, 0
    v_mov_b32 v47, 0
    v_mov_b32 v15, 0
    v_mov_b32 v15, 0
    v_mov_b32 v15, 0
    v_mov_b32 v15, 0
L_mret_75:
    buffer_load_dwordx4 v[0:3], v117, s[8:11], s23 offen sc1
    s_add_u32 s45, s45, 1
    s_cmp_lt_u32 s45, 0x10000
    s_cselect_b32 s56, -2, -1
    s_nop 3
    v_mov_b32 v32, 0
    v_mov_b32 v33, 0
    v_mov_b32 v34, 0
    v_mov_b32 v35, 0
    s_waitcnt vmcnt(2)
    v_max3_u32 v15, v0, v1, v2
    v_max_u32 v15, v15, v3
    v_cmp_lt_u32 vcc, s56, v15
    v_smfmac_f32_16x16x64_bf16 v[32:35], v[0:3], v[80:87], v116
    s_cbranch_vccnz L_mret_75
    ds_write_b128 v117, v[0:3] offset:3072
    v_smfmac_f32_16x16x64_bf16 v[36:39], v[0:3], v[56:63], v116
    buffer_load_dwordx4 v[4:7], v117, s[8:11], s48 offen sc1
    v_smfmac_f32_16x16x64_bf16 v[40:43], v[0:3], v[64:71], v116
    buffer_load_dwordx4 v117, s[8:11], s48 offen sc1 lds
    s_mov_b32 m0, 14336
    v_smfmac_f32_16x16x64_bf16 v[44:47], v[0:3], v[72:79], v116
    s_waitcnt lgkmcnt(0)
    s_barrier
    ds_read_b128 v[8:11], v117 offset:2048
    v_smfmac_f32_16x16x64_bf16 v[48:51], v[0:3], a[192:199], v116
    ds_read_b128 v[16:19], v117 offset:1024
    ds_read_b128 v[20:23], v117
    v_smfmac_f32_16x16x64_bf16 v[52:55], v[0:3], a[200:207], v116
    ds_read_b128 v[80:83], v117 offset:14336
    s_waitcnt lgkmcnt(3)
    v_smfmac_f32_16x16x64_bf16 v[32:35], v[8:11], a[0:7], v116
    ds_read_b128 v[84:87], v117 offset:15360
    v_smfmac_f32_16x16x64_bf16 v[36:39], v[8:11], a[8:15], v116
    ds_read_b128 v[56:59], v117 offset:8192
    s_waitcnt lgkmcnt(4)
    v_smfmac_f32_16x16x64_bf16 v[32:35], v[16:19], a[32:39], v116
    ds_read_b128 v[60:63], v117 offset:9216
    v_smfmac_f32_16x16x64_bf16 v[36:39], v[16:19], a[40:47], v116
    ds_read_b128 v[64:67], v117 offset:10240
    s_waitcnt lgkmcnt(5)
    v_smfmac_f32_16x16x64_bf16 v[32:35], v[20:23], a[64:71], v116
    ds_read_b128 v[68:71], v117 offset:11264
    v_smfmac_f32_16x16x64_bf16 v[36:39], v[20:23], a[72:79], v116
    ds_read_b128 v[72:75], v117 offset:12288
    v_smfmac_f32_16x16x64_bf16 v[40:43], v[8:11], a[96:103], v116
    ds_read_b128 v[76:79], v117 offset:13312
    v_smfmac_f32_16x16x64_bf16 v[40:43], v[16:19], a[128:135], v116
    buffer_store_dwordx4 v[112:115], v117, s[8:11], s32 offen sc1
    v_smfmac_f32_16x16x64_bf16 v[40:43], v[20:23], a[160:167], v116
    s_waitcnt vmcnt(2)
    v_max3_u32 v15, v4, v5, v6
    v_smfmac_f32_16x16x64_bf16 v[44:47], v[8:11], a[104:111], v116
    v_max_u32 v15, v15, v7
    v_smfmac_f32_16x16x64_bf16 v[44:47], v[16:19], a[136:143], v116
    s_waitcnt vmcnt(1) lgkmcnt(0)
    v_cmp_lt_u32 vcc, s56, v15
    v_smfmac_f32_16x16x64_bf16 v[44:47], v[20:23], a[168:175], v116
    s_cbranch_vccnz L_mret_76
L_mgo_77:
    v_smfmac_f32_16x16x64_bf16 v[44:47], v[4:7], v[24:31], v116
    s_barrier
    ds_read_b128 v[12:15], v117 offset:6144
    v_smfmac_f32_16x16x64_bf16 v[32:35], v[4:7], v[88:95], v116
    ds_read_b128 v[24:27], v117 offset:5120
    v_smfmac_f32_16x16x64_bf16 v[36:39], v[4:7], v[96:103], v116
    ds_read_b128 v[28:31], v117 offset:4096
    v_smfmac_f32_16x16x64_bf16 v[40:43], v[4:7], v[104:111], v116
    ds_read_b128 v[88:91], v117 offset:30720
    s_waitcnt lgkmcnt(3)
    v_smfmac_f32_16x16x64_bf16 v[32:35], v[12:15], a[16:23], v116
    ds_read_b128 v[92:95], v117 offset:31744
    s_waitcnt lgkmcnt(3)
    v_smfmac_f32_16x16x64_bf16 v[32:35], v[24:27], a[48:55], v116
    ds_read_b128 v[96:99], v117 offset:23552
    s_waitcnt lgkmcnt(3)
    v_smfmac_f32_16x16x64_bf16 v[32:35], v[28:31], a[80:87], v116
    buffer_load_dwordx4 v117, s[8:11], s30 offen lds
    v_smfmac_f32_16x16x64_bf16 v[36:39], v[12:15], a[24:31], v116
    ds_read_b128 v[100:103], v117 offset:23552
    v_smfmac_f32_16x16x64_bf16 v[36:39], v[24:27], a[56:63], v116
    ds_read_b128 v[104:107], v117 offset:23552
    v_add_f32 v32, v32, v34
    v_smfmac_f32_16x16x64_bf16 v[36:39], v[28:31], a[88:95], v116
    buffer_load_dwordx4 v117, s[8:11], s30 offen offset:1024 lds
    s_add_u32 m0, s52, 0x6000
    v_add_f32 v33, v33, v35
    v_smfmac_f32_16x16x64_bf16 v[40:43], v[12:15], a[112:119], v116
    ds_read_b128 v[108:111], v117 offset:23552
    v_mul_f32 v32, s34, v32
    v_smfmac_f32_16x16x64_bf16 v[40:43], v[24:27], a[144:151], v116
    ds_read_b128 v[0:3], v124
    v_mul_f32 v33, s34, v33
    v_smfmac_f32_16x16x64_bf16 v[40:43], v[28:31], a[176:183], v116
    s_waitcnt lgkmcnt(5)
    buffer_load_dwordx4 v117, s[8:11], s31 offen lds
    v_add_f32 v36, v36, v38
    v_smfmac_f32_16x16x64_bf16 v[48:51], v[4:7], a[208:215], v116
    v_add_f32 v37, v37, v39
    v_smfmac_f32_16x16x64_bf16 v[52:55], v[4:7], a[216:223], v116
    ds_read_b128 v[4:7], v124 offset:1024
    v_mul_f32 v36, s34, v36
    v_smfmac_f32_16x16x64_bf16 v[44:47], v[12:15], a[120:127], v116
    buffer_load_dwordx4 v117, s[8:11], s31 offen offset:1024 lds
    s_mov_b32 m0, 7168
    v_mul_f32 v37, s34, v37
    v_smfmac_f32_16x16x64_bf16 v[44:47], v[24:27], a[152:159], v116
    v_cvt_pk_bf16_f32 v34, v32, v36
    v_smfmac_f32_16x16x64_bf16 v[44:47], v[28:31], a[184:191], v116
    v_cvt_pk_bf16_f32 v35, v33, v37
    v_add_f32 v40, v40, v42
    v_smfmac_f32_16x16x64_bf16 v[48:51], v[8:11], a[224:231], v116
    ds_write2_b32 v120, v34, v35 offset0:32 offset1:48
    v_add_f32 v41, v41, v43
    v_smfmac_f32_16x16x64_bf16 v[52:55], v[8:11], a[232:239], v116
    v_add_f32 v44, v44, v46
    v_add_f32 v45, v45, v47
    v_cvt_pk_bf16_f32 v113, v40, v44
    v_cvt_pk_bf16_f32 v115, v41, v45
    v_smfmac_f32_16x16x64_bf16 v[48:51], v[12:15], a[240:247], v116
    ds_write2_b32 v120, v113, v115 offset0:0 offset1:16
    v_smfmac_f32_16x16x64_bf16 v[52:55], v[12:15], a[248:255], v116
    s_cmp_eq_u32 s22, 63
    s_cbranch_scc1 L_chain_last_s
    v_smfmac_f32_16x16x64_bf16 v[48:51], v[16:19], v[128:135], v116
    v_smfmac_f32_16x16x64_bf16 v[48:51], v[20:23], v[160:167], v116
    buffer_store_dword v126, v119, s[8:11], s55 offen sc1
    v_smfmac_f32_16x16x64_bf16 v[48:51], v[24:27], v[144:151], v116
    s_waitcnt lgkmcnt(0)
    s_barrier
    v_smfmac_f32_16x16x64_bf16 v[48:51], v[28:31], v[176:183], v116
    ds_read_b128 v[32:35], v121 offset:16384
    ds_read_b128 v[36:39], v121 offset:17408
    v_smfmac_f32_16x16x64_bf16 v[52:55], v[16:19], v[136:143], v116
    ds_read_b128 v[40:43], v121 offset:18432
    ds_read_b128 v[44:47], v121 offset:19456
    v_smfmac_f32_16x16x64_bf16 v[52:55], v[20:23], v[168:175], v116
    ds_read_b128 v[8:11], v124 offset:32768
    v_add_f32 v48, v48, v50
    v_smfmac_f32_16x16x64_bf16 v[52:55], v[24:27], v[152:159], v116
    ds_read_b128 v[12:15], v124 offset:33792
    v_add_f32 v49, v49, v51
    v_smfmac_f32_16x16x64_bf16 v[52:55], v[28:31], v[184:191], v116
    s_waitcnt lgkmcnt(5)
    v_cvt_pk_bf16_f32 v112, v48, v49
    v_mfma_f32_16x16x32_bf16 v[56:59], v[56:59], v[32:35], 0
    s_waitcnt lgkmcnt(4)
    v_mov_b32 v48, s50
    v_mov_b32 v49, s50
    v_mfma_f32_16x16x32_bf16 v[56:59], v[60:63], v[36:39], v[56:59]
    ds_read_b128 v[16:19], v124 offset:2048
    s_waitcnt lgkmcnt(4)
    v_mov_b32 v50, s50
    v_mov_b32 v51, s50
    v_mfma_f32_16x16x32_bf16 v[56:59], v[64:67], v[40:43], v[56:59]
    ds_read_b128 v[20:23], v124 offset:3072
    s_waitcnt lgkmcnt(4)
    v_add_f32 v52, v52, v54
    v_mfma_f32_16x16x32_bf16 v[56:59], v[68:71], v[44:47], v[56:59]
    ds_read_b128 v[24:27], v124 offset:4096
    v_add_f32 v53, v53, v55
    v_mfma_f32_16x16x32_bf16 v[60:63], v[72:75], v[32:35], 0
    ds_read_b128 v[28:31], v124 offset:5120
    v_cvt_pk_bf16_f32 v114, v52, v53
    v_mov_b32 v53, 0
    v_mfma_f32_16x16x32_bf16 v[60:63], v[76:79], v[36:39], v[60:63]
    v_exp_f32 v56, v56
    v_mfma_f32_16x16x32_bf16 v[60:63], v[80:83], v[40:43], v[60:63]
    v_exp_f32 v57, v57
    v_mfma_f32_16x16x32_bf16 v[60:63], v[84:87], v[44:47], v[60:63]
    v_exp_f32 v58, v58
    v_mfma_f32_16x16x32_bf16 v[64:67], v[32:35], v[32:35], 0
    v_exp_f32 v59, v59
    v_cvt_pk_bf16_f32 v68, v56, v57
    v_mfma_f32_16x16x32_bf16 v[64:67], v[36:39], v[36:39], v[64:67]
    v_exp_f32 v60, v60
    v_cvt_pk_bf16_f32 v69, v58, v59
    v_mfma_f32_16x16x32_bf16 v[64:67], v[40:43], v[40:43], v[64:67]
    v_exp_f32 v61, v61
    v_mfma_f32_16x16x32_bf16 v[64:67], v[44:47], v[44:47], v[64:67]
    v_exp_f32 v62, v62
    v_exp_f32 v63, v63
    v_cvt_pk_bf16_f32 v70, v60, v61
    v_cvt_pk_bf16_f32 v71, v62, v63
    s_nop 1
    v_mfma_f32_16x16x32_bf16 v[72:75], v[88:91], v[68:71], 0
    s_nop 0
    v_exp_f32 v64, v64
    v_mfma_f32_16x16x32_bf16 v[76:79], v[92:95], v[68:71], 0
    v_exp_f32 v65, v65
    v_mfma_f32_16x16x32_bf16 v[80:83], v[48:51], v[68:71], 0
    v_cvt_pk_bf16_f32 v52, v64, v65
    s_nop 1
    v_mfma_f32_16x16x16_bf16 v[72:75], v[112:113], v[52:53], v[72:75]
    ds_read_b128 v[32:35], v124 offset:6144
    v_mfma_f32_16x16x16_bf16 v[76:79], v[114:115], v[52:53], v[76:79]
    ds_read_b128 v[36:39], v124 offset:7168
    v_mfma_f32_16x16x16_bf16 v[80:83], v[48:49], v[52:53], v[80:83]
L_norm_78:
    s_mov_b64 vcc, s[36:37]
    v_mov_b32 v122, v122
    v_mov_b32 v122, v122
    v_mov_b32 v122, v122
    v_cndmask_b32_dpp v76, v72, v76, vcc quad_perm:[2,3,2,3] row_mask:0xf bank_mask:0xf
    v_cndmask_b32_dpp v77, v73, v77, vcc quad_perm:[2,3,2,3] row_mask:0xf bank_mask:0xf
    v_cndmask_b32_dpp v78, v74, v78, vcc quad_perm:[2,3,2,3] row_mask:0xf bank_mask:0xf
    v_cndmask_b32_dpp v79, v75, v79, vcc quad_perm:[2,3,2,3] row_mask:0xf bank_mask:0xf
    v_rcp_f32_dpp v84, v80 quad_perm:[2,3,2,3] row_mask:0xf bank_mask:0xf
    s_nop 0
    v_pk_mul_f32 v[76:77], v[76:77], v[84:85] op_sel_hi:[1,0]
    v_pk_mul_f32 v[78:79], v[78:79], v[84:85] op_sel_hi:[1,0]
    v_cvt_pk_bf16_f32 v72, v76, v77
    v_cvt_pk_bf16_f32 v73, v78, v79
    ds_write_b64 v122, v[72:73] offset:22016
    v_max_f32_dpp v86, v80, v84 quad_perm:[2,3,2,3] row_mask:0xf bank_mask:0xf
    v_mov_b32_dpp v60, v72 quad_perm:[0,1,0,1] row_mask:0xf bank_mask:0xf
    v_mov_b32_dpp v61, v73 quad_perm:[0,1,0,1] row_mask:0xf bank_mask:0xf
    v_cmp_lt_f32 vcc, s35, v86
    v_mov_b32_dpp v62, v72 quad_perm:[2,3,2,3] row_mask:0xf bank_mask:0xf
    v_mov_b32_dpp v63, v73 quad_perm:[2,3,2,3] row_mask:0xf bank_mask:0xf
    s_nop 1
    v_smfmac_f32_16x16x64_bf16 v[96:99], v[60:63], v[192:199], v116
    s_cbranch_vccnz L_smax_79
    v_smfmac_f32_16x16x64_bf16 v[100:103], v[60:63], v[224:231], v116
    s_waitcnt lgkmcnt(0)
    s_barrier
    ds_read_b128 v[92:95], v127 offset:21504
    ds_read_b128 v[80:83], v127 offset:20992
    ds_read_b128 v[84:87], v127 offset:20480
    v_smfmac_f32_16x16x64_bf16 v[104:107], v[60:63], v[0:7], v116
    ds_read_b128 v[40:43], v124 offset:34816
    v_smfmac_f32_16x16x64_bf16 v[108:111], v[60:63], v[8:15], v116
    ds_read_b128 v[56:59], v124 offset:36864
    s_waitcnt lgkmcnt(4)
    v_smfmac_f32_16x16x64_bf16 v[96:99], v[92:95], v[200:207], v116
    s_waitcnt lgkmcnt(3)
    v_smfmac_f32_16x16x64_bf16 v[96:99], v[80:83], v[208:215], v116
    ds_read_b128 v[44:47], v124 offset:35840
    s_waitcnt lgkmcnt(3)
    v_smfmac_f32_16x16x64_bf16 v[96:99], v[84:87], v[216:223], v116
    ds_read_b128 v[68:71], v124 offset:39936
    v_smfmac_f32_16x16x64_bf16 v[100:103], v[92:95], v[232:239], v116
    ds_read_b128 v[64:67], v124 offset:38912
    v_smfmac_f32_16x16x64_bf16 v[100:103], v[80:83], v[240:247], v116
    ds_read_b128 v[60:63], v124 offset:37888
    v_cvt_pk_bf16_f32 v72, v96, v98
    v_smfmac_f32_16x16x64_bf16 v[100:103], v[84:87], v[248:255], v116
    v_and_or_b32 v72, v72, -2, s33
    v_smfmac_f32_16x16x64_bf16 v[104:107], v[92:95], v[16:23], v116
    v_cvt_pk_bf16_f32 v74, v97, v99
    v_smfmac_f32_16x16x64_bf16 v[104:107], v[80:83], v[24:31], v116
    v_cvt_pk_bf16_f32 v73, v100, v102
    v_cvt_pk_bf16_f32 v75, v101, v103
    v_smfmac_f32_16x16x64_bf16 v[104:107], v[84:87], v[32:39], v116
    buffer_store_dwordx4 v[72:75], v118, s[8:11], s25 offen sc1
    s_waitcnt lgkmcnt(3)
    v_smfmac_f32_16x16x64_bf16 v[108:111], v[92:95], v[40:47], v116
    s_waitcnt lgkmcnt(0)
    v_smfmac_f32_16x16x64_bf16 v[108:111], v[80:83], v[56:63], v116
    v_cvt_pk_bf16_f32 v76, v104, v106
    v_smfmac_f32_16x16x64_bf16 v[108:111], v[84:87], v[64:71], v116
    v_and_or_b32 v76, v76, -2, s33
    v_cvt_pk_bf16_f32 v78, v105, v107
    v_mov_b32 v122, v122
    v_mov_b32 v122, v122
    v_mov_b32 v122, v122
    v_mov_b32 v122, v122
    v_mov_b32 v122, v122
    v_mov_b32 v122, v122
    v_cvt_pk_bf16_f32 v77, v108, v110
    v_cvt_pk_bf16_f32 v79, v109, v111
    buffer_store_dwordx4 v[76:79], v118, s[8:11], s26 offen sc1
    ds_read_b128 v[80:83], v123
    ds_read_b128 v[84:87], v123 offset:1024
    ds_read_b128 v[56:59], v123 offset:2048
    ds_read_b128 v[60:63], v123 offset:3072
    ds_read_b128 v[64:67], v123 offset:32768
    ds_read_b128 v[68:71], v123 offset:33792
    ds_read_b128 v[72:75], v123 offset:34816
    ds_read_b128 v[76:79], v123 offset:35840
    ds_read_b128 v[88:91], v123 offset:4096
    ds_read_b128 v[92:95], v123 offset:5120
    ds_read_b128 v[96:99], v123 offset:6144
    ds_read_b128 v[100:103], v123 offset:7168
    ds_read_b128 v[104:107], v123 offset:36864
    ds_read_b128 v[108:111], v123 offset:37888
    ds_read_b128 v[24:27], v123 offset:38912
    ds_read_b128 v[28:31], v123 offset:39936
    s_add_u32 s30, s30, 0x40000
    s_add_u32 s31, s31, 0x40000
    s_add_u32 s32, s32, 0x20000
    s_add_u32 s23, s24, 3072
    s_add_u32 s48, s23, 4096
    s_xor_b32 s25, s25, 0x40000
    s_xor_b32 s26, s26, 0x40000
    s_mov_b32 s35, 0x49800000
    s_add_u32 s22, s22, 1
    v_cndmask_b32 v12, 0, v125, s[68:69]
    v_cndmask_b32 v13, 0, v125, s[70:71]
    v_cndmask_b32 v14, 0, v125, s[72:73]
    v_cndmask_b32 v15, 0, v125, s[74:75]
    v_mov_b32 v54, 0
    v_mov_b32 v55, 0
    v_mov_b32 v52, 0
    v_mov_b32 v52, 0
    v_mov_b32 v52, 0
    v_mov_b32 v52, 0
    v_mov_b32 v52, 0
    v_mov_b32 v52, 0
    v_mov_b32 v52, 0
    v_mov_b32 v52, 0
    v_mov_b32 v52, 0
    v_mov_b32 v52, 0
    v_mov_b32 v52, 0
    v_mov_b32 v52, 0
    v_mov_b32 v52, 0
    v_mov_b32 v52, 0
    v_mov_b32 v52, 0
    v_mov_b32 v52, 0
    v_mov_b32 v52, 0
    v_mov_b32 v52, 0
    v_mov_b32 v52, 0
    v_mov_b32 v52, 0
    v_mov_b32 v52, 0
    v_mov_b32 v52, 0
    v_mov_b32 v52, 0
    v_mov_b32 v52, 0
    v_mov_b32 v52, 0
    v_mov_b32 v52, 0
    v_mov_b32 v52, 0
    v_mov_b32 v52, 0
    v_mov_b32 v52, 0
    v_mov_b32 v52, 0
    v_mov_b32 v52, 0
    v_mov_b32 v52, 0
    v_mov_b32 v52, 0
    v_mov_b32 v52, 0
    v_mov_b32 v52, 0
    v_mov_b32 v52, 0
    v_mov_b32 v52, 0
    v_mov_b32 v52, 0
    v_mov_b32 v52, 0
    v_mov_b32 v52, 0
    v_mov_b32 v52, 0
    v_mov_b32 v52, 0
    v_mov_b32 v52, 0
    v_mov_b32 v52, 0
    v_mov_b32 v52, 0
    v_mov_b32 v52, 0
    v_mov_b32 v52, 0
    v_mov_b32 v52, 0
    v_mov_b32 v52, 0
    buffer_load_dwordx4 v[4:7], v117, s[8:11], s29 offen sc1
    buffer_load_dwordx4 v[8:11], v117, s[8:11], s53 offen sc1
    buffer_load_dwordx4 v[16:19], v117, s[8:11], s29 offen offset:2048 sc1
    buffer_load_dwordx4 v[20:23], v117, s[8:11], s53 offen offset:2048 sc1
    v_mov_b32 v52, 0
    v_mov_b32 v52, 0
    v_mov_b32 v52, 0
    v_mov_b32 v52, 0
    v_mov_b32 v52, 0
    v_mov_b32 v52, 0
    v_mov_b32 v52, 0
    v_mov_b32 v52, 0
    v_mov_b32 v52, 0
    v_mov_b32 v52, 0
    v_mov_b32 v52, 0
    v_mov_b32 v52, 0
    v_mov_b32 v52, 0
    v_mov_b32 v52, 0
    v_mov_b32 v52, 0
    v_mov_b32 v52, 0
    v_mov_b32 v52, 0
    v_mov_b32 v52, 0
    v_mov_b32 v52, 0
    v_mov_b32 v52, 0
    v_mov_b32 v52, 0
    v_mov_b32 v52, 0
    v_mov_b32 v52, 0
    v_mov_b32 v52, 0
    v_mov_b32 v52, 0
    v_mov_b32 v52, 0
    v_mov_b32 v52, 0
    v_mov_b32 v52, 0
    v_mov_b32 v52, 0
    v_mov_b32 v52, 0
    buffer_load_dwordx4 v[32:35], v117, s[8:11], s29 offen sc1
    buffer_load_dwordx4 v[36:39], v117, s[8:11], s53 offen sc1
    buffer_load_dwordx4 v[40:43], v117, s[8:11], s29 offen offset:2048 sc1
    buffer_load_dwordx4 v[44:47], v117, s[8:11], s53 offen offset:2048 sc1
    v_mov_b32 v52, 0
L_rl_80:
    s_waitcnt vmcnt(7)
    v_mfma_f32_16x16x32_bf16 v[48:51], v[4:7], v[12:15], 0
    v_xor_b32 v52, s33, v4
    s_waitcnt vmcnt(6)
    v_mfma_f32_16x16x32_bf16 v[48:51], v[8:11], v[12:15], v[48:51]
    v_xor_b32 v53, s33, v8
    v_or_b32 v52, v52, v53
    s_waitcnt vmcnt(5)
    v_mfma_f32_16x16x32_bf16 v[48:51], v[16:19], v[12:15], v[48:51]
    v_xor_b32 v53, s33, v16
    v_or_b32 v52, v52, v53
    s_waitcnt vmcnt(4)
    v_mfma_f32_16x16x32_bf16 v[48:51], v[20:23], v[12:15], v[48:51]
    v_xor_b32 v53, s33, v20
    v_or_b32 v52, v52, v53
    v_and_b32 v52, 1, v52
    v_cmp_ne_u32 vcc, 0, v52
    s_cbranch_vccnz L_rslow_81
L_rgo_82:
    s_nop 2
    v_permlane32_swap_b32 v48, v50
    v_permlane32_swap_b32 v49, v51
    v_pk_add_f32 v[48:49], v[48:49], v[50:51]
    s_mov_b64 exec, s[38:39]
    v_cvt_pk_bf16_f32 v12, v48, v49
    v_min_u32 v12, 0xfffffffe, v12
    buffer_store_dword v12, v119, s[8:11], s24 offen sc1
    s_mov_b64 exec, -1
    s_add_u32 s24, s24, 8192
    s_bitset0_b32 s24, 15
    s_xor_b32 s55, s24, 16384
    s_xor_b32 s29, s29, 0x40000
    s_xor_b32 s53, s29, 1024
    s_bfe_u32 s33, s22, 0x10001
    s_waitcnt lgkmcnt(0)
    s_branch L_chain_top3_s
L_chain_last_s:
    s_nop 1
    v_smfmac_f32_16x16x64_bf16 v[48:51], v[16:19], v[128:135], v116
    v_smfmac_f32_16x16x64_bf16 v[48:51], v[20:23], v[160:167], v116
    v_smfmac_f32_16x16x64_bf16 v[48:51], v[24:27], v[144:151], v116
    v_smfmac_f32_16x16x64_bf16 v[48:51], v[28:31], v[176:183], v116
    v_smfmac_f32_16x16x64_bf16 v[52:55], v[16:19], v[136:143], v116
    v_smfmac_f32_16x16x64_bf16 v[52:55], v[20:23], v[168:175], v116
    v_smfmac_f32_16x16x64_bf16 v[52:55], v[24:27], v[152:159], v116
    v_smfmac_f32_16x16x64_bf16 v[52:55], v[28:31], v[184:191], v116
    v_add_f32 v48, v48, v50
    v_add_f32 v49, v49, v51
    v_cvt_pk_bf16_f32 v112, v48, v49
    s_nop 4
    v_add_f32 v52, v52, v54
    v_add_f32 v53, v53, v55
    v_cvt_pk_bf16_f32 v114, v52, v53
    s_add_u32 s32, s32, 0x20000
    buffer_store_dwordx4 v[112:115], v117, s[8:11], s32 offen sc1
    v_mov_b32 v94, 64
    s_waitcnt vmcnt(0) lgkmcnt(0)
    s_barrier
    s_mov_b64 exec, 1
    buffer_store_dword v94, off, s[8:11], s44 sc1
    s_mov_b64 exec, -1
    s_endpgm
L_mret_54:
    s_mov_b32 s43, m0
    s_mov_b32 m0, 4096
    buffer_load_dwordx4 v[4:7], v117, s[8:11], s48 offen sc1
    buffer_load_dwordx4 v117, s[8:11], s48 offen sc1 lds
    s_mov_b32 m0, 8192
    s_mov_b32 m0, s43
    s_waitcnt vmcnt(0)
    v_max3_u32 v15, v4, v5, v6
    v_max_u32 v15, v15, v7
    v_cmp_lt_u32 vcc, s56, v15
    s_add_u32 s47, s47, 1
    s_add_u32 s49, s49, 1
    s_cmp_ge_u32 s49, 0x10000
    s_cbranch_scc1 L_mgo_55
    s_cbranch_vccnz L_mret_54
    s_branch L_mgo_55
L_smax_57:
    s_add_u32 s47, s47, 1
    s_mov_b32 s35, 0x7f800000
    s_waitcnt lgkmcnt(0)
    s_sub_u32 s43, s30, 0x40000
    s_add_u32 s40, s43, 4096
    s_nop 7
    buffer_load_dwordx4 v[56:59], v117, s[8:11], s43 offen
    buffer_load_dwordx4 v[60:63], v117, s[8:11], s43 offen offset:1024
    buffer_load_dwordx4 v[64:67], v117, s[8:11], s43 offen offset:2048
    buffer_load_dwordx4 v[68:71], v117, s[8:11], s43 offen offset:3072
    buffer_load_dwordx4 v[72:75], v117, s[8:11], s40 offen
    buffer_load_dwordx4 v[76:79], v117, s[8:11], s40 offen offset:1024
    buffer_load_dwordx4 v[80:83], v117, s[8:11], s40 offen offset:2048
    buffer_load_dwordx4 v[84:87], v117, s[8:11], s40 offen offset:3072
    ds_read_b128 v[32:35], v121 offset:16384
    ds_read_b128 v[36:39], v121 offset:17408
    ds_read_b128 v[40:43], v121 offset:18432
    ds_read_b128 v[44:47], v121 offset:19456
    v_mov_b32 v96, 0
    v_mov_b32 v97, 0
    v_mov_b32 v98, 0
    v_mov_b32 v99, 0
    v_mov_b32 v100, 0
    v_mov_b32 v101, 0
    v_mov_b32 v102, 0
    v_mov_b32 v103, 0
    v_mov_b32 v104, 0
    v_mov_b32 v105, 0
    v_mov_b32 v106, 0
    v_mov_b32 v107, 0
    v_mov_b32 v108, 0
    v_mov_b32 v109, 0
    v_mov_b32 v110, 0
    v_mov_b32 v111, 0
    s_waitcnt vmcnt(0) lgkmcnt(0)
    v_mfma_f32_16x16x32_bf16 v[56:59], v[56:59], v[32:35], 0
    v_mfma_f32_16x16x32_bf16 v[56:59], v[60:63], v[36:39], v[56:59]
    v_mfma_f32_16x16x32_bf16 v[56:59], v[64:67], v[40:43], v[56:59]
    v_mfma_f32_16x16x32_bf16 v[56:59], v[68:71], v[44:47], v[56:59]
    v_mfma_f32_16x16x32_bf16 v[60:63], v[72:75], v[32:35], 0
    v_mfma_f32_16x16x32_bf16 v[60:63], v[76:79], v[36:39], v[60:63]
    v_mfma_f32_16x16x32_bf16 v[60:63], v[80:83], v[40:43], v[60:63]
    v_mfma_f32_16x16x32_bf16 v[60:63], v[84:87], v[44:47], v[60:63]
    v_mfma_f32_16x16x32_bf16 v[64:67], v[32:35], v[32:35], 0
    v_mfma_f32_16x16x32_bf16 v[64:67], v[36:39], v[36:39], v[64:67]
    v_mfma_f32_16x16x32_bf16 v[64:67], v[40:43], v[40:43], v[64:67]
    v_mfma_f32_16x16x32_bf16 v[64:67], v[44:47], v[44:47], v[64:67]
    v_max3_f32 v84, v56, v57, v58
    v_max3_f32 v84, v84, v59, v60
    v_max3_f32 v84, v84, v61, v62
    s_nop 4
    v_max3_f32 v84, v84, v63, v64
    v_max_f32 v84, v84, v65
    v_mov_b32 v85, v84
    s_nop 1
    v_permlane32_swap_b32 v85, v84
    v_max_f32 v84, v85, v84
    v_mov_b32 v85, v84
    s_nop 1
    v_permlane16_swap_b32 v85, v84
    v_max_f32 v84, v85, v84
    v_sub_f32 v56, v56, v84
    v_sub_f32 v57, v57, v84
    v_sub_f32 v58, v58, v84
    v_sub_f32 v59, v59, v84
    v_sub_f32 v60, v60, v84
    v_sub_f32 v61, v61, v84
    v_sub_f32 v62, v62, v84
    v_sub_f32 v63, v63, v84
    v_sub_f32 v64, v64, v84
    v_sub_f32 v65, v65, v84
    v_exp_f32 v56, v56
    v_exp_f32 v57, v57
    v_exp_f32 v58, v58
    v_exp_f32 v59, v59
    v_exp_f32 v60, v60
    v_exp_f32 v61, v61
    v_exp_f32 v62, v62
    v_exp_f32 v63, v63
    v_exp_f32 v64, v64
    v_exp_f32 v65, v65
    v_cvt_pk_bf16_f32 v68, v56, v57
    v_cvt_pk_bf16_f32 v69, v58, v59
    v_cvt_pk_bf16_f32 v70, v60, v61
    v_cvt_pk_bf16_f32 v71, v62, v63
    v_cvt_pk_bf16_f32 v52, v64, v65
    s_nop 0
    v_mfma_f32_16x16x32_bf16 v[72:75], v[88:91], v[68:71], 0
    v_mfma_f32_16x16x32_bf16 v[76:79], v[92:95], v[68:71], 0
    v_mfma_f32_16x16x32_bf16 v[80:83], v[48:51], v[68:71], 0
    v_mfma_f32_16x16x16_bf16 v[72:75], v[112:113], v[52:53], v[72:75]
    v_mfma_f32_16x16x16_bf16 v[76:79], v[114:115], v[52:53], v[76:79]
    v_mfma_f32_16x16x16_bf16 v[80:83], v[48:49], v[52:53], v[80:83]
    ds_read_b128 v[32:35], v124 offset:6144
    ds_read_b128 v[36:39], v124 offset:7168
    ds_read_b128 v[40:43], v124 offset:34816
    ds_read_b128 v[44:47], v124 offset:35840
    ds_read_b128 v[56:59], v124 offset:36864
    ds_read_b128 v[64:67], v124 offset:38912
    ds_read_b128 v[68:71], v124 offset:39936
    s_waitcnt lgkmcnt(0)
    s_branch L_norm_56
L_kvw_58:
    s_add_u32 s47, s47, 1
    s_add_u32 s49, s49, 1
    s_cmp_ge_u32 s49, 0x10000
    s_cbranch_scc1 L_kvb_59
    s_sleep 4
    buffer_load_dword v125, v119, s[8:11], s28 offen sc1
    s_waitcnt vmcnt(0)
    v_cmp_eq_u32 vcc, 0, v125
    s_nop 0
    s_and_b64 vcc, vcc, s[58:59]
    s_cbranch_scc1 L_kvw_58
    s_branch L_kvb_59
L_mret_61:
    s_mov_b32 s43, m0
    s_mov_b32 m0, 5120
    buffer_load_dwordx4 v[4:7], v117, s[8:11], s48 offen sc1
    buffer_load_dwordx4 v117, s[8:11], s48 offen sc1 lds
    s_mov_b32 m0, 10240
    s_mov_b32 m0, s43
    s_waitcnt vmcnt(0)
    v_max3_u32 v15, v4, v5, v6
    v_max_u32 v15, v15, v7
    v_cmp_lt_u32 vcc, s56, v15
    s_add_u32 s47, s47, 1
    s_add_u32 s49, s49, 1
    s_cmp_ge_u32 s49, 0x10000
    s_cbranch_scc1 L_mgo_62
    s_cbranch_vccnz L_mret_61
    s_branch L_mgo_62
L_smax_64:
    s_add_u32 s47, s47, 1
    s_mov_b32 s35, 0x7f800000
    s_waitcnt lgkmcnt(0)
    s_sub_u32 s43, s30, 0x40800
    s_add_u32 s40, s43, 4096
    s_nop 7
    buffer_load_dwordx4 v[56:59], v117, s[8:11], s43 offen
    buffer_load_dwordx4 v[60:63], v117, s[8:11], s43 offen offset:1024
    buffer_load_dwordx4 v[64:67], v117, s[8:11], s43 offen offset:2048
    buffer_load_dwordx4 v[68:71], v117, s[8:11], s43 offen offset:3072
    buffer_load_dwordx4 v[72:75], v117, s[8:11], s40 offen
    buffer_load_dwordx4 v[76:79], v117, s[8:11], s40 offen offset:1024
    buffer_load_dwordx4 v[80:83], v117, s[8:11], s40 offen offset:2048
    buffer_load_dwordx4 v[84:87], v117, s[8:11], s40 offen offset:3072
    ds_read_b128 v[32:35], v121 offset:16384
    ds_read_b128 v[36:39], v121 offset:17408
    ds_read_b128 v[40:43], v121 offset:18432
    ds_read_b128 v[44:47], v121 offset:19456
    v_mov_b32 v96, 0
    v_mov_b32 v97, 0
    v_mov_b32 v98, 0
    v_mov_b32 v99, 0
    v_mov_b32 v100, 0
    v_mov_b32 v101, 0
    v_mov_b32 v102, 0
    v_mov_b32 v103, 0
    v_mov_b32 v104, 0
    v_mov_b32 v105, 0
    v_mov_b32 v106, 0
    v_mov_b32 v107, 0
    v_mov_b32 v108, 0
    v_mov_b32 v109, 0
    v_mov_b32 v110, 0
    v_mov_b32 v111, 0
    s_waitcnt vmcnt(0) lgkmcnt(0)
    v_mfma_f32_16x16x32_bf16 v[56:59], v[56:59], v[32:35], 0
    v_mfma_f32_16x16x32_bf16 v[56:59], v[60:63], v[36:39], v[56:59]
    v_mfma_f32_16x16x32_bf16 v[56:59], v[64:67], v[40:43], v[56:59]
    v_mfma_f32_16x16x32_bf16 v[56:59], v[68:71], v[44:47], v[56:59]
    v_mfma_f32_16x16x32_bf16 v[60:63], v[72:75], v[32:35], 0
    v_mfma_f32_16x16x32_bf16 v[60:63], v[76:79], v[36:39], v[60:63]
    v_mfma_f32_16x16x32_bf16 v[60:63], v[80:83], v[40:43], v[60:63]
    v_mfma_f32_16x16x32_bf16 v[60:63], v[84:87], v[44:47], v[60:63]
    v_mfma_f32_16x16x32_bf16 v[64:67], v[32:35], v[32:35], 0
    v_mfma_f32_16x16x32_bf16 v[64:67], v[36:39], v[36:39], v[64:67]
    v_mfma_f32_16x16x32_bf16 v[64:67], v[40:43], v[40:43], v[64:67]
    v_mfma_f32_16x16x32_bf16 v[64:67], v[44:47], v[44:47], v[64:67]
    v_max3_f32 v84, v56, v57, v58
    v_max3_f32 v84, v84, v59, v60
    v_max3_f32 v84, v84, v61, v62
    s_nop 4
    v_max3_f32 v84, v84, v63, v64
    v_max_f32 v84, v84, v65
    v_mov_b32 v85, v84
    s_nop 1
    v_permlane32_swap_b32 v85, v84
    v_max_f32 v84, v85, v84
    v_mov_b32 v85, v84
    s_nop 1
    v_permlane16_swap_b32 v85, v84
    v_max_f32 v84, v85, v84
    v_sub_f32 v56, v56, v84
    v_sub_f32 v57, v57, v84
    v_sub_f32 v58, v58, v84
    v_sub_f32 v59, v59, v84
    v_sub_f32 v60, v60, v84
    v_sub_f32 v61, v61, v84
    v_sub_f32 v62, v62, v84
    v_sub_f32 v63, v63, v84
    v_sub_f32 v64, v64, v84
    v_sub_f32 v65, v65, v84
    v_exp_f32 v56, v56
    v_exp_f32 v57, v57
    v_exp_f32 v58, v58
    v_exp_f32 v59, v59
    v_exp_f32 v60, v60
    v_exp_f32 v61, v61
    v_exp_f32 v62, v62
    v_exp_f32 v63, v63
    v_exp_f32 v64, v64
    v_exp_f32 v65, v65
    v_cvt_pk_bf16_f32 v68, v56, v57
    v_cvt_pk_bf16_f32 v69, v58, v59
    v_cvt_pk_bf16_f32 v70, v60, v61
    v_cvt_pk_bf16_f32 v71, v62, v63
    v_cvt_pk_bf16_f32 v52, v64, v65
    s_nop 0
    v_mfma_f32_16x16x32_bf16 v[72:75], v[88:91], v[68:71], 0
    v_mfma_f32_16x16x32_bf16 v[76:79], v[92:95], v[68:71], 0
    v_mfma_f32_16x16x32_bf16 v[80:83], v[48:51], v[68:71], 0
    v_mfma_f32_16x16x16_bf16 v[72:75], v[112:113], v[52:53], v[72:75]
    v_mfma_f32_16x16x16_bf16 v[76:79], v[114:115], v[52:53], v[76:79]
    v_mfma_f32_16x16x16_bf16 v[80:83], v[48:49], v[52:53], v[80:83]
    ds_read_b128 v[32:35], v124 offset:6144
    ds_read_b128 v[36:39], v124 offset:7168
    ds_read_b128 v[40:43], v124 offset:34816
    ds_read_b128 v[44:47], v124 offset:35840
    ds_read_b128 v[56:59], v124 offset:36864
    ds_read_b128 v[64:67], v124 offset:38912
    ds_read_b128 v[68:71], v124 offset:39936
    s_waitcnt lgkmcnt(0)
    s_branch L_norm_63
L_kvw_65:
    s_add_u32 s47, s47, 1
    s_add_u32 s49, s49, 1
    s_cmp_ge_u32 s49, 0x10000
    s_cbranch_scc1 L_kvb_66
    s_sleep 4
    buffer_load_dword v125, v119, s[8:11], s28 offen sc1
    s_waitcnt vmcnt(0)
    v_cmp_eq_u32 vcc, 0, v125
    s_nop 0
    s_and_b64 vcc, vcc, s[58:59]
    s_cbranch_scc1 L_kvw_65
    s_branch L_kvb_66
L_mret_68:
    s_mov_b32 s43, m0
    s_mov_b32 m0, 6144
    buffer_load_dwordx4 v[4:7], v117, s[8:11], s48 offen sc1
    buffer_load_dwordx4 v117, s[8:11], s48 offen sc1 lds
    s_mov_b32 m0, 12288
    s_mov_b32 m0, s43
    s_waitcnt vmcnt(0)
    v_max3_u32 v15, v4, v5, v6
    v_max_u32 v15, v15, v7
    v_cmp_lt_u32 vcc, s56, v15
    s_add_u32 s47, s47, 1
    s_add_u32 s49, s49, 1
    s_cmp_ge_u32 s49, 0x10000
    s_cbranch_scc1 L_mgo_69
    s_cbranch_vccnz L_mret_68
    s_branch L_mgo_69
L_smax_71:
    s_add_u32 s47, s47, 1
    s_mov_b32 s35, 0x7f800000
    s_waitcnt lgkmcnt(0)
    s_sub_u32 s43, s30, 0x41000
    s_add_u32 s40, s43, 4096
    s_nop 7
    buffer_load_dwordx4 v[56:59], v117, s[8:11], s43 offen
    buffer_load_dwordx4 v[60:63], v117, s[8:11], s43 offen offset:1024
    buffer_load_dwordx4 v[64:67], v117, s[8:11], s43 offen offset:2048
    buffer_load_dwordx4 v[68:71], v117, s[8:11], s43 offen offset:3072
    buffer_load_dwordx4 v[72:75], v117, s[8:11], s40 offen
    buffer_load_dwordx4 v[76:79], v117, s[8:11], s40 offen offset:1024
    buffer_load_dwordx4 v[80:83], v117, s[8:11], s40 offen offset:2048
    buffer_load_dwordx4 v[84:87], v117, s[8:11], s40 offen offset:3072
    ds_read_b128 v[32:35], v121 offset:16384
    ds_read_b128 v[36:39], v121 offset:17408
    ds_read_b128 v[40:43], v121 offset:18432
    ds_read_b128 v[44:47], v121 offset:19456
    v_mov_b32 v96, 0
    v_mov_b32 v97, 0
    v_mov_b32 v98, 0
    v_mov_b32 v99, 0
    v_mov_b32 v100, 0
    v_mov_b32 v101, 0
    v_mov_b32 v102, 0
    v_mov_b32 v103, 0
    v_mov_b32 v104, 0
    v_mov_b32 v105, 0
    v_mov_b32 v106, 0
    v_mov_b32 v107, 0
    v_mov_b32 v108, 0
    v_mov_b32 v109, 0
    v_mov_b32 v110, 0
    v_mov_b32 v111, 0
    s_waitcnt vmcnt(0) lgkmcnt(0)
    v_mfma_f32_16x16x32_bf16 v[56:59], v[56:59], v[32:35], 0
    v_mfma_f32_16x16x32_bf16 v[56:59], v[60:63], v[36:39], v[56:59]
    v_mfma_f32_16x16x32_bf16 v[56:59], v[64:67], v[40:43], v[56:59]
    v_mfma_f32_16x16x32_bf16 v[56:59], v[68:71], v[44:47], v[56:59]
    v_mfma_f32_16x16x32_bf16 v[60:63], v[72:75], v[32:35], 0
    v_mfma_f32_16x16x32_bf16 v[60:63], v[76:79], v[36:39], v[60:63]
    v_mfma_f32_16x16x32_bf16 v[60:63], v[80:83], v[40:43], v[60:63]
    v_mfma_f32_16x16x32_bf16 v[60:63], v[84:87], v[44:47], v[60:63]
    v_mfma_f32_16x16x32_bf16 v[64:67], v[32:35], v[32:35], 0
    v_mfma_f32_16x16x32_bf16 v[64:67], v[36:39], v[36:39], v[64:67]
    v_mfma_f32_16x16x32_bf16 v[64:67], v[40:43], v[40:43], v[64:67]
    v_mfma_f32_16x16x32_bf16 v[64:67], v[44:47], v[44:47], v[64:67]
    v_max3_f32 v84, v56, v57, v58
    v_max3_f32 v84, v84, v59, v60
    v_max3_f32 v84, v84, v61, v62
    s_nop 4
    v_max3_f32 v84, v84, v63, v64
    v_max_f32 v84, v84, v65
    v_mov_b32 v85, v84
    s_nop 1
    v_permlane32_swap_b32 v85, v84
    v_max_f32 v84, v85, v84
    v_mov_b32 v85, v84
    s_nop 1
    v_permlane16_swap_b32 v85, v84
    v_max_f32 v84, v85, v84
    v_sub_f32 v56, v56, v84
    v_sub_f32 v57, v57, v84
    v_sub_f32 v58, v58, v84
    v_sub_f32 v59, v59, v84
    v_sub_f32 v60, v60, v84
    v_sub_f32 v61, v61, v84
    v_sub_f32 v62, v62, v84
    v_sub_f32 v63, v63, v84
    v_sub_f32 v64, v64, v84
    v_sub_f32 v65, v65, v84
    v_exp_f32 v56, v56
    v_exp_f32 v57, v57
    v_exp_f32 v58, v58
    v_exp_f32 v59, v59
    v_exp_f32 v60, v60
    v_exp_f32 v61, v61
    v_exp_f32 v62, v62
    v_exp_f32 v63, v63
    v_exp_f32 v64, v64
    v_exp_f32 v65, v65
    v_cvt_pk_bf16_f32 v68, v56, v57
    v_cvt_pk_bf16_f32 v69, v58, v59
    v_cvt_pk_bf16_f32 v70, v60, v61
    v_cvt_pk_bf16_f32 v71, v62, v63
    v_cvt_pk_bf16_f32 v52, v64, v65
    s_nop 0
    v_mfma_f32_16x16x32_bf16 v[72:75], v[88:91], v[68:71], 0
    v_mfma_f32_16x16x32_bf16 v[76:79], v[92:95], v[68:71], 0
    v_mfma_f32_16x16x32_bf16 v[80:83], v[48:51], v[68:71], 0
    v_mfma_f32_16x16x16_bf16 v[72:75], v[112:113], v[52:53], v[72:75]
    v_mfma_f32_16x16x16_bf16 v[76:79], v[114:115], v[52:53], v[76:79]
    v_mfma_f32_16x16x16_bf16 v[80:83], v[48:49], v[52:53], v[80:83]
    ds_read_b128 v[32:35], v124 offset:6144
    ds_read_b128 v[36:39], v124 offset:7168
    ds_read_b128 v[40:43], v124 offset:34816
    ds_read_b128 v[44:47], v124 offset:35840
    ds_read_b128 v[56:59], v124 offset:36864
    ds_read_b128 v[64:67], v124 offset:38912
    ds_read_b128 v[68:71], v124 offset:39936
    s_waitcnt lgkmcnt(0)
    s_branch L_norm_70
L_rslow_73:
    buffer_load_dwordx4 v[4:7], v117, s[8:11], s29 offen sc1
    buffer_load_dwordx4 v[8:11], v117, s[8:11], s53 offen sc1
    buffer_load_dwordx4 v[16:19], v117, s[8:11], s29 offen offset:2048 sc1
    buffer_load_dwordx4 v[20:23], v117, s[8:11], s53 offen offset:2048 sc1
    s_add_u32 s46, s46, 1
    s_add_u32 s49, s49, 1
    s_cmp_ge_u32 s49, 0x10000
    s_cbranch_scc1 L_rgo_74
    s_waitcnt vmcnt(7)
    v_mfma_f32_16x16x32_bf16 v[48:51], v[32:35], v[12:15], 0
    v_xor_b32 v52, s33, v32
    s_waitcnt vmcnt(6)
    v_mfma_f32_16x16x32_bf16 v[48:51], v[36:39], v[12:15], v[48:51]
    v_xor_b32 v53, s33, v36
    v_or_b32 v52, v52, v53
    s_waitcnt vmcnt(5)
    v_mfma_f32_16x16x32_bf16 v[48:51], v[40:43], v[12:15], v[48:51]
    v_xor_b32 v53, s33, v40
    v_or_b32 v52, v52, v53
    s_waitcnt vmcnt(4)
    v_mfma_f32_16x16x32_bf16 v[48:51], v[44:47], v[12:15], v[48:51]
    v_xor_b32 v53, s33, v44
    v_or_b32 v52, v52, v53
    v_and_b32 v52, 1, v52
    v_cmp_ne_u32 vcc, 0, v52
    s_cbranch_vccz L_rgo_74
    buffer_load_dwordx4 v[32:35], v117, s[8:11], s29 offen sc1
    buffer_load_dwordx4 v[36:39], v117, s[8:11], s53 offen sc1
    buffer_load_dwordx4 v[40:43], v117, s[8:11], s29 offen offset:2048 sc1
    buffer_load_dwordx4 v[44:47], v117, s[8:11], s53 offen offset:2048 sc1
    s_add_u32 s46, s46, 1
    s_branch L_rl_72
L_mret_76:
    s_mov_b32 s43, m0
    s_mov_b32 m0, 7168
    buffer_load_dwordx4 v[4:7], v117, s[8:11], s48 offen sc1
    buffer_load_dwordx4 v117, s[8:11], s48 offen sc1 lds
    s_mov_b32 m0, 14336
    s_mov_b32 m0, s43
    s_waitcnt vmcnt(0)
    v_max3_u32 v15, v4, v5, v6
    v_max_u32 v15, v15, v7
    v_cmp_lt_u32 vcc, s56, v15
    s_add_u32 s47, s47, 1
    s_add_u32 s49, s49, 1
    s_cmp_ge_u32 s49, 0x10000
    s_cbranch_scc1 L_mgo_77
    s_cbranch_vccnz L_mret_76
    s_branch L_mgo_77
L_smax_79:
    s_add_u32 s47, s47, 1
    s_mov_b32 s35, 0x7f800000
    s_waitcnt lgkmcnt(0)
    s_sub_u32 s43, s30, 0x41800
    s_add_u32 s40, s43, 4096
    s_nop 7
    buffer_load_dwordx4 v[56:59], v117, s[8:11], s43 offen
    buffer_load_dwordx4 v[60:63], v117, s[8:11], s43 offen offset:1024
    buffer_load_dwordx4 v[64:67], v117, s[8:11], s43 offen offset:2048
    buffer_load_dwordx4 v[68:71], v117, s[8:11], s43 offen offset:3072
    buffer_load_dwordx4 v[72:75], v117, s[8:11], s40 offen
    buffer_load_dwordx4 v[76:79], v117, s[8:11], s40 offen offset:1024
    buffer_load_dwordx4 v[80:83], v117, s[8:11], s40 offen offset:2048
    buffer_load_dwordx4 v[84:87], v117, s[8:11], s40 offen offset:3072
    ds_read_b128 v[32:35], v121 offset:16384
    ds_read_b128 v[36:39], v121 offset:17408
    ds_read_b128 v[40:43], v121 offset:18432
    ds_read_b128 v[44:47], v121 offset:19456
    v_mov_b32 v96, 0
    v_mov_b32 v97, 0
    v_mov_b32 v98, 0
    v_mov_b32 v99, 0
    v_mov_b32 v100, 0
    v_mov_b32 v101, 0
    v_mov_b32 v102, 0
    v_mov_b32 v103, 0
    v_mov_b32 v104, 0
    v_mov_b32 v105, 0
    v_mov_b32 v106, 0
    v_mov_b32 v107, 0
    v_mov_b32 v108, 0
    v_mov_b32 v109, 0
    v_mov_b32 v110, 0
    v_mov_b32 v111, 0
    s_waitcnt vmcnt(0) lgkmcnt(0)
    v_mfma_f32_16x16x32_bf16 v[56:59], v[56:59], v[32:35], 0
    v_mfma_f32_16x16x32_bf16 v[56:59], v[60:63], v[36:39], v[56:59]
    v_mfma_f32_16x16x32_bf16 v[56:59], v[64:67], v[40:43], v[56:59]
    v_mfma_f32_16x16x32_bf16 v[56:59], v[68:71], v[44:47], v[56:59]
    v_mfma_f32_16x16x32_bf16 v[60:63], v[72:75], v[32:35], 0
    v_mfma_f32_16x16x32_bf16 v[60:63], v[76:79], v[36:39], v[60:63]
    v_mfma_f32_16x16x32_bf16 v[60:63], v[80:83], v[40:43], v[60:63]
    v_mfma_f32_16x16x32_bf16 v[60:63], v[84:87], v[44:47], v[60:63]
    v_mfma_f32_16x16x32_bf16 v[64:67], v[32:35], v[32:35], 0
    v_mfma_f32_16x16x32_bf16 v[64:67], v[36:39], v[36:39], v[64:67]
    v_mfma_f32_16x16x32_bf16 v[64:67], v[40:43], v[40:43], v[64:67]
    v_mfma_f32_16x16x32_bf16 v[64:67], v[44:47], v[44:47], v[64:67]
    v_max3_f32 v84, v56, v57, v58
    v_max3_f32 v84, v84, v59, v60
    v_max3_f32 v84, v84, v61, v62
    s_nop 4
    v_max3_f32 v84, v84, v63, v64
    v_max_f32 v84, v84, v65
    v_mov_b32 v85, v84
    s_nop 1
    v_permlane32_swap_b32 v85, v84
    v_max_f32 v84, v85, v84
    v_mov_b32 v85, v84
    s_nop 1
    v_permlane16_swap_b32 v85, v84
    v_max_f32 v84, v85, v84
    v_sub_f32 v56, v56, v84
    v_sub_f32 v57, v57, v84
    v_sub_f32 v58, v58, v84
    v_sub_f32 v59, v59, v84
    v_sub_f32 v60, v60, v84
    v_sub_f32 v61, v61, v84
    v_sub_f32 v62, v62, v84
    v_sub_f32 v63, v63, v84
    v_sub_f32 v64, v64, v84
    v_sub_f32 v65, v65, v84
    v_exp_f32 v56, v56
    v_exp_f32 v57, v57
    v_exp_f32 v58, v58
    v_exp_f32 v59, v59
    v_exp_f32 v60, v60
    v_exp_f32 v61, v61
    v_exp_f32 v62, v62
    v_exp_f32 v63, v63
    v_exp_f32 v64, v64
    v_exp_f32 v65, v65
    v_cvt_pk_bf16_f32 v68, v56, v57
    v_cvt_pk_bf16_f32 v69, v58, v59
    v_cvt_pk_bf16_f32 v70, v60, v61
    v_cvt_pk_bf16_f32 v71, v62, v63
    v_cvt_pk_bf16_f32 v52, v64, v65
    s_nop 0
    v_mfma_f32_16x16x32_bf16 v[72:75], v[88:91], v[68:71], 0
    v_mfma_f32_16x16x32_bf16 v[76:79], v[92:95], v[68:71], 0
    v_mfma_f32_16x16x32_bf16 v[80:83], v[48:51], v[68:71], 0
    v_mfma_f32_16x16x16_bf16 v[72:75], v[112:113], v[52:53], v[72:75]
    v_mfma_f32_16x16x16_bf16 v[76:79], v[114:115], v[52:53], v[76:79]
    v_mfma_f32_16x16x16_bf16 v[80:83], v[48:49], v[52:53], v[80:83]
    ds_read_b128 v[32:35], v124 offset:6144
    ds_read_b128 v[36:39], v124 offset:7168
    ds_read_b128 v[40:43], v124 offset:34816
    ds_read_b128 v[44:47], v124 offset:35840
    ds_read_b128 v[56:59], v124 offset:36864
    ds_read_b128 v[64:67], v124 offset:38912
    ds_read_b128 v[68:71], v124 offset:39936
    s_waitcnt lgkmcnt(0)
    s_branch L_norm_78
L_rslow_81:
    buffer_load_dwordx4 v[4:7], v117, s[8:11], s29 offen sc1
    buffer_load_dwordx4 v[8:11], v117, s[8:11], s53 offen sc1
    buffer_load_dwordx4 v[16:19], v117, s[8:11], s29 offen offset:2048 sc1
    buffer_load_dwordx4 v[20:23], v117, s[8:11], s53 offen offset:2048 sc1
    s_add_u32 s46, s46, 1
    s_add_u32 s49, s49, 1
    s_cmp_ge_u32 s49, 0x10000
    s_cbranch_scc1 L_rgo_82
    s_waitcnt vmcnt(7)
    v_mfma_f32_16x16x32_bf16 v[48:51], v[32:35], v[12:15], 0
    v_xor_b32 v52, s33, v32
    s_waitcnt vmcnt(6)
    v_mfma_f32_16x16x32_bf16 v[48:51], v[36:39], v[12:15], v[48:51]
    v_xor_b32 v53, s33, v36
    v_or_b32 v52, v52, v53
    s_waitcnt vmcnt(5)
    v_mfma_f32_16x16x32_bf16 v[48:51], v[40:43], v[12:15], v[48:51]
    v_xor_b32 v53, s33, v40
    v_or_b32 v52, v52, v53
    s_waitcnt vmcnt(4)
    v_mfma_f32_16x16x32_bf16 v[48:51], v[44:47], v[12:15], v[48:51]
    v_xor_b32 v53, s33, v44
    v_or_b32 v52, v52, v53
    v_and_b32 v52, 1, v52
    v_cmp_ne_u32 vcc, 0, v52
    s_cbranch_vccz L_rgo_82
    buffer_load_dwordx4 v[32:35], v117, s[8:11], s29 offen sc1
    buffer_load_dwordx4 v[36:39], v117, s[8:11], s53 offen sc1
    buffer_load_dwordx4 v[40:43], v117, s[8:11], s29 offen offset:2048 sc1
    buffer_load_dwordx4 v[44:47], v117, s[8:11], s53 offen offset:2048 sc1
    s_add_u32 s46, s46, 1
    s_branch L_rl_80
L_bulk:
    s_add_u32 s88, s101, 32
    s_mov_b32 s41, 0
    s_lshr_b32 s20, s101, 6
    s_and_b32 s22, s101, 63
    s_cmp_ge_u32 s101, 192
    s_cselect_b32 s37, 32, 1000
L_p1go:
    s_mov_b32 s40, 0
    s_mov_b32 s80, 0
    s_mov_b32 s23, 0
L_p1_pass:
    v_mbcnt_lo_u32_b32 v0, -1, 0
    v_mbcnt_hi_u32_b32 v0, -1, v0
    s_lshl_b32 s96, s100, 6
    v_add_u32 v0, s96, v0
    s_load_dwordx2 s[34:35], s[0:1], 16
    s_load_dwordx2 s[30:31], s[0:1], 24
    s_load_dwordx2 s[32:33], s[0:1], 32
    s_load_dwordx2 s[42:43], s[0:1], 40
    s_load_dwordx2 s[12:13], s[0:1], 0
    s_waitcnt lgkmcnt(0)
    s_and_b32 s13, s13, 0xffff
    s_mov_b32 s14, 0x200000
    s_mov_b32 s15, 0x20000
    v_lshrrev_b32 v147, 6, v0
    s_nop 0
    v_readfirstlane_b32 s21, v147
    v_and_b32 v144, 63, v0
    v_lshrrev_b32 v145, 4, v144
    v_and_b32 v146, 15, v144
    v_lshrrev_b32 v149, 2, v146
    v_lshlrev_b32 v137, 4, v144
    s_lshl_b32 s29, s21, 10
    s_lshl_b32 s26, s20, 7
    s_lshl_b32 s27, s21, 5
    s_add_u32 s26, s26, s27
    v_add_u32 v147, s26, v146
    v_lshlrev_b32 v147, 10, v147
    v_lshl_add_u32 v139, v145, 4, v147
    s_mov_b32 s26, 0x0
    buffer_load_dwordx4 v[0:3], v139, s[12:15], s26 offen
    buffer_load_dwordx4 v[4:7], v139, s[12:15], s26 offen offset:64
    buffer_load_dwordx4 v[8:11], v139, s[12:15], s26 offen offset:128
    buffer_load_dwordx4 v[12:15], v139, s[12:15], s26 offen offset:192
    buffer_load_dwordx4 v[16:19], v139, s[12:15], s26 offen offset:256
    buffer_load_dwordx4 v[20:23], v139, s[12:15], s26 offen offset:320
    buffer_load_dwordx4 v[24:27], v139, s[12:15], s26 offen offset:384
    buffer_load_dwordx4 v[28:31], v139, s[12:15], s26 offen offset:448
    buffer_load_dwordx4 v[32:35], v139, s[12:15], s26 offen offset:512
    buffer_load_dwordx4 v[36:39], v139, s[12:15], s26 offen offset:576
    buffer_load_dwordx4 v[40:43], v139, s[12:15], s26 offen offset:640
    buffer_load_dwordx4 v[44:47], v139, s[12:15], s26 offen offset:704
    buffer_load_dwordx4 v[48:51], v139, s[12:15], s26 offen offset:768
    buffer_load_dwordx4 v[52:55], v139, s[12:15], s26 offen offset:832
    buffer_load_dwordx4 v[56:59], v139, s[12:15], s26 offen offset:896
    buffer_load_dwordx4 v[60:63], v139, s[12:15], s26 offen offset:960
    s_mov_b32 s26, 0x4000
    buffer_load_dwordx4 v[64:67], v139, s[12:15], s26 offen
    buffer_load_dwordx4 v[68:71], v139, s[12:15], s26 offen offset:64
    buffer_load_dwordx4 v[72:75], v139, s[12:15], s26 offen offset:128
    buffer_load_dwordx4 v[76:79], v139, s[12:15], s26 offen offset:192
    buffer_load_dwordx4 v[80:83], v139, s[12:15], s26 offen offset:256
    buffer_load_dwordx4 v[84:87], v139, s[12:15], s26 offen offset:320
    buffer_load_dwordx4 v[88:91], v139, s[12:15], s26 offen offset:384
    buffer_load_dwordx4 v[92:95], v139, s[12:15], s26 offen offset:448
    buffer_load_dwordx4 v[96:99], v139, s[12:15], s26 offen offset:512
    buffer_load_dwordx4 v[100:103], v139, s[12:15], s26 offen offset:576
    buffer_load_dwordx4 v[104:107], v139, s[12:15], s26 offen offset:640
    buffer_load_dwordx4 v[108:111], v139, s[12:15], s26 offen offset:704
    buffer_load_dwordx4 v[112:115], v139, s[12:15], s26 offen offset:768
    buffer_load_dwordx4 v[116:119], v139, s[12:15], s26 offen offset:832
    buffer_load_dwordx4 v[120:123], v139, s[12:15], s26 offen offset:896
    buffer_load_dwordx4 v[124:127], v139, s[12:15], s26 offen offset:960
    s_lshr_b32 s26, s21, 1
    s_lshl_b32 s26, s26, 2
    v_or_b32 v148, s26, v145
    v_lshlrev_b32 v148, 1, v148
    v_xor_b32 v148, v148, v146
    v_lshlrev_b32 v148, 4, v148
    s_lshl_b32 s26, s21, 2
    v_add_u32 v147, s26, v145
    v_lshl_add_u32 v136, v147, 13, v148
    v_lshl_add_u32 v147, v145, 3, v149
    v_lshlrev_b32 v147, 8, v147
    v_and_b32 v148, 1, v145
    v_lshl_or_b32 v148, v148, 2, v149
    v_lshl_add_u32 v147, v148, 5, v147
    v_and_b32 v148, 3, v146
    v_lshl_add_u32 v128, v148, 3, v147
    v_xor_b32 v129, 32, v128
    v_xor_b32 v130, 64, v128
    v_xor_b32 v131, 96, v128
    v_xor_b32 v132, 128, v128
    v_xor_b32 v133, 160, v128
    v_xor_b32 v134, 192, v128
    v_xor_b32 v135, 224, v128
    s_mov_b32 s19, 0x20000
    s_mov_b32 s38, s22
    s_mov_b32 s39, s22
    v_mov_b32 v158, 0x3f803f80
    s_waitcnt vmcnt(16)
    v_pk_mov_b32 v[150:151], 0, 0
    v_pk_mov_b32 v[152:153], 0, 0
    v_dot2_f32_bf16 v150, v0, v158, v150
    v_dot2_f32_bf16 v152, v0, v0, v152
    v_dot2_f32_bf16 v151, v1, v158, v151
    v_dot2_f32_bf16 v153, v1, v1, v153
    v_dot2_f32_bf16 v150, v2, v158, v150
    v_dot2_f32_bf16 v152, v2, v2, v152
    v_dot2_f32_bf16 v151, v3, v158, v151
    v_dot2_f32_bf16 v153, v3, v3, v153
    v_dot2_f32_bf16 v150, v4, v158, v150
    v_dot2_f32_bf16 v152, v4, v4, v152
    v_dot2_f32_bf16 v151, v5, v158, v151
    v_dot2_f32_bf16 v153, v5, v5, v153
    v_dot2_f32_bf16 v150, v6, v158, v150
    v_dot2_f32_bf16 v152, v6, v6, v152
    v_dot2_f32_bf16 v151, v7, v158, v151
    v_dot2_f32_bf16 v153, v7, v7, v153
    v_dot2_f32_bf16 v150, v8, v158, v150
    v_dot2_f32_bf16 v152, v8, v8, v152
    v_dot2_f32_bf16 v151, v9, v158, v151
    v_dot2_f32_bf16 v153, v9, v9, v153
    v_dot2_f32_bf16 v150, v10, v158, v150
    v_dot2_f32_bf16 v152, v10, v10, v152
    v_dot2_f32_bf16 v151, v11, v158, v151
    v_dot2_f32_bf16 v153, v11, v11, v153
    v_dot2_f32_bf16 v150, v12, v158, v150
    v_dot2_f32_bf16 v152, v12, v12, v152
    v_dot2_f32_bf16 v151, v13, v158, v151
    v_dot2_f32_bf16 v153, v13, v13, v153
    v_dot2_f32_bf16 v150, v14, v158, v150
    v_dot2_f32_bf16 v152, v14, v14, v152
    v_dot2_f32_bf16 v151, v15, v158, v151
    v_dot2_f32_bf16 v153, v15, v15, v153
    v_dot2_f32_bf16 v150, v16, v158, v150
    v_dot2_f32_bf16 v152, v16, v16, v152
    v_dot2_f32_bf16 v151, v17, v158, v151
    v_dot2_f32_bf16 v153, v17, v17, v153
    v_dot2_f32_bf16 v150, v18, v158, v150
    v_dot2_f32_bf16 v152, v18, v18, v152
    v_dot2_f32_bf16 v151, v19, v158, v151
    v_dot2_f32_bf16 v153, v19, v19, v153
    v_dot2_f32_bf16 v150, v20, v158, v150
    v_dot2_f32_bf16 v152, v20, v20, v152
    v_dot2_f32_bf16 v151, v21, v158, v151
    v_dot2_f32_bf16 v153, v21, v21, v153
    v_dot2_f32_bf16 v150, v22, v158, v150
    v_dot2_f32_bf16 v152, v22, v22, v152
    v_dot2_f32_bf16 v151, v23, v158, v151
    v_dot2_f32_bf16 v153, v23, v23, v153
    v_dot2_f32_bf16 v150, v24, v158, v150
    v_dot2_f32_bf16 v152, v24, v24, v152
    v_dot2_f32_bf16 v151, v25, v158, v151
    v_dot2_f32_bf16 v153, v25, v25, v153
    v_dot2_f32_bf16 v150, v26, v158, v150
    v_dot2_f32_bf16 v152, v26, v26, v152
    v_dot2_f32_bf16 v151, v27, v158, v151
    v_dot2_f32_bf16 v153, v27, v27, v153
    v_dot2_f32_bf16 v150, v28, v158, v150
    v_dot2_f32_bf16 v152, v28, v28, v152
    v_dot2_f32_bf16 v151, v29, v158, v151
    v_dot2_f32_bf16 v153, v29, v29, v153
    v_dot2_f32_bf16 v150, v30, v158, v150
    v_dot2_f32_bf16 v152, v30, v30, v152
    v_dot2_f32_bf16 v151, v31, v158, v151
    v_dot2_f32_bf16 v153, v31, v31, v153
    v_dot2_f32_bf16 v150, v32, v158, v150
    v_dot2_f32_bf16 v152, v32, v32, v152
    v_dot2_f32_bf16 v151, v33, v158, v151
    v_dot2_f32_bf16 v153, v33, v33, v153
    v_dot2_f32_bf16 v150, v34, v158, v150
    v_dot2_f32_bf16 v152, v34, v34, v152
    v_dot2_f32_bf16 v151, v35, v158, v151
    v_dot2_f32_bf16 v153, v35, v35, v153
    v_dot2_f32_bf16 v150, v36, v158, v150
    v_dot2_f32_bf16 v152, v36, v36, v152
    v_dot2_f32_bf16 v151, v37, v158, v151
    v_dot2_f32_bf16 v153, v37, v37, v153
    v_dot2_f32_bf16 v150, v38, v158, v150
    v_dot2_f32_bf16 v152, v38, v38, v152
    v_dot2_f32_bf16 v151, v39, v158, v151
    v_dot2_f32_bf16 v153, v39, v39, v153
    v_dot2_f32_bf16 v150, v40, v158, v150
    v_dot2_f32_bf16 v152, v40, v40, v152
    v_dot2_f32_bf16 v151, v41, v158, v151
    v_dot2_f32_bf16 v153, v41, v41, v153
    v_dot2_f32_bf16 v150, v42, v158, v150
    v_dot2_f32_bf16 v152, v42, v42, v152
    v_dot2_f32_bf16 v151, v43, v158, v151
    v_dot2_f32_bf16 v153, v43, v43, v153
    v_dot2_f32_bf16 v150, v44, v158, v150
    v_dot2_f32_bf16 v152, v44, v44, v152
    v_dot2_f32_bf16 v151, v45, v158, v151
    v_dot2_f32_bf16 v153, v45, v45, v153
    v_dot2_f32_bf16 v150, v46, v158, v150
    v_dot2_f32_bf16 v152, v46, v46, v152
    v_dot2_f32_bf16 v151, v47, v158, v151
    v_dot2_f32_bf16 v153, v47, v47, v153
    v_dot2_f32_bf16 v150, v48, v158, v150
    v_dot2_f32_bf16 v152, v48, v48, v152
    v_dot2_f32_bf16 v151, v49, v158, v151
    v_dot2_f32_bf16 v153, v49, v49, v153
    v_dot2_f32_bf16 v150, v50, v158, v150
    v_dot2_f32_bf16 v152, v50, v50, v152
    v_dot2_f32_bf16 v151, v51, v158, v151
    v_dot2_f32_bf16 v153, v51, v51, v153
    v_dot2_f32_bf16 v150, v52, v158, v150
    v_dot2_f32_bf16 v152, v52, v52, v152
    v_dot2_f32_bf16 v151, v53, v158, v151
    v_dot2_f32_bf16 v153, v53, v53, v153
    v_dot2_f32_bf16 v150, v54, v158, v150
    v_dot2_f32_bf16 v152, v54, v54, v152
    v_dot2_f32_bf16 v151, v55, v158, v151
    v_dot2_f32_bf16 v153, v55, v55, v153
    v_dot2_f32_bf16 v150, v56, v158, v150
    v_dot2_f32_bf16 v152, v56, v56, v152
    v_dot2_f32_bf16 v151, v57, v158, v151
    v_dot2_f32_bf16 v153, v57, v57, v153
    v_dot2_f32_bf16 v150, v58, v158, v150
    v_dot2_f32_bf16 v152, v58, v58, v152
    v_dot2_f32_bf16 v151, v59, v158, v151
    v_dot2_f32_bf16 v153, v59, v59, v153
    v_dot2_f32_bf16 v150, v60, v158, v150
    v_dot2_f32_bf16 v152, v60, v60, v152
    v_dot2_f32_bf16 v151, v61, v158, v151
    v_dot2_f32_bf16 v153, v61, v61, v153
    v_dot2_f32_bf16 v150, v62, v158, v150
    v_dot2_f32_bf16 v152, v62, v62, v152
    v_dot2_f32_bf16 v151, v63, v158, v151
    v_dot2_f32_bf16 v153, v63, v63, v153
    s_nop 1
    v_add_f32 v150, v150, v151
    v_add_f32 v152, v152, v153
    v_mov_b32 v157, v150
    s_nop 1
    v_permlane32_swap_b32 v157, v150
    v_add_f32 v150, v157, v150
    v_mov_b32 v157, v150
    s_nop 1
    v_permlane16_swap_b32 v157, v150
    v_add_f32 v150, v157, v150
    v_mov_b32 v157, v152
    s_nop 1
    v_permlane32_swap_b32 v157, v152
    v_add_f32 v152, v157, v152
    v_mov_b32 v157, v152
    s_nop 1
    v_permlane16_swap_b32 v157, v152
    v_add_f32 v152, v157, v152
    v_mul_f32 v150, 0x3b000000, v150
    v_cvt_pk_bf16_f32 v154, v150, v150
    v_and_b32 v154, 0xffff0000, v154
    v_sub_f32 v156, v150, v154
    v_mul_f32 v157, v150, v150
    v_mul_f32 v152, 0x3b000000, v152
    v_sub_f32 v152, v152, v157
    v_max_f32 v152, 0, v152
    v_cvt_pk_bf16_f32 v152, v152, v152
    v_and_b32 v152, 0xffff0000, v152
    v_add_f32 v152, 0x3727c5ac, v152
    v_cvt_pk_bf16_f32 v152, v152, v152
    v_and_b32 v152, 0xffff0000, v152
    v_sqrt_f32 v152, v152
    s_nop 0
    v_cvt_pk_bf16_f32 v152, v152, v152
    v_and_b32 v152, 0xffff0000, v152
    v_rcp_f32 v152, v152
    v_lshlrev_b32 v160, 16, v0
    v_and_b32 v161, 0xffff0000, v0
    v_lshlrev_b32 v162, 16, v1
    v_and_b32 v163, 0xffff0000, v1
    v_lshlrev_b32 v164, 16, v2
    v_and_b32 v165, 0xffff0000, v2
    v_lshlrev_b32 v166, 16, v3
    v_and_b32 v167, 0xffff0000, v3
    v_lshlrev_b32 v168, 16, v4
    v_and_b32 v169, 0xffff0000, v4
    v_lshlrev_b32 v170, 16, v5
    v_and_b32 v171, 0xffff0000, v5
    v_lshlrev_b32 v172, 16, v6
    v_and_b32 v173, 0xffff0000, v6
    v_lshlrev_b32 v174, 16, v7
    v_and_b32 v175, 0xffff0000, v7
    v_pk_add_f32 v[160:161], v[160:161], v[154:155] op_sel_hi:[1,0] neg_lo:[0,1] neg_hi:[0,1]
    v_pk_add_f32 v[162:163], v[162:163], v[154:155] op_sel_hi:[1,0] neg_lo:[0,1] neg_hi:[0,1]
    v_pk_add_f32 v[164:165], v[164:165], v[154:155] op_sel_hi:[1,0] neg_lo:[0,1] neg_hi:[0,1]
    v_pk_add_f32 v[166:167], v[166:167], v[154:155] op_sel_hi:[1,0] neg_lo:[0,1] neg_hi:[0,1]
    v_pk_add_f32 v[168:169], v[168:169], v[154:155] op_sel_hi:[1,0] neg_lo:[0,1] neg_hi:[0,1]
    v_pk_add_f32 v[170:171], v[170:171], v[154:155] op_sel_hi:[1,0] neg_lo:[0,1] neg_hi:[0,1]
    v_pk_add_f32 v[172:173], v[172:173], v[154:155] op_sel_hi:[1,0] neg_lo:[0,1] neg_hi:[0,1]
    v_pk_add_f32 v[174:175], v[174:175], v[154:155] op_sel_hi:[1,0] neg_lo:[0,1] neg_hi:[0,1]
    v_cvt_pk_bf16_f32 v0, v160, v161
    v_cvt_pk_bf16_f32 v1, v162, v163
    v_cvt_pk_bf16_f32 v2, v164, v165
    v_cvt_pk_bf16_f32 v3, v166, v167
    v_cvt_pk_bf16_f32 v4, v168, v169
    v_cvt_pk_bf16_f32 v5, v170, v171
    v_cvt_pk_bf16_f32 v6, v172, v173
    v_cvt_pk_bf16_f32 v7, v174, v175
    v_lshlrev_b32 v160, 16, v0
    v_and_b32 v161, 0xffff0000, v0
    v_lshlrev_b32 v162, 16, v1
    v_and_b32 v163, 0xffff0000, v1
    v_lshlrev_b32 v164, 16, v2
    v_and_b32 v165, 0xffff0000, v2
    v_lshlrev_b32 v166, 16, v3
    v_and_b32 v167, 0xffff0000, v3
    v_lshlrev_b32 v168, 16, v4
    v_and_b32 v169, 0xffff0000, v4
    v_lshlrev_b32 v170, 16, v5
    v_and_b32 v171, 0xffff0000, v5
    v_lshlrev_b32 v172, 16, v6
    v_and_b32 v173, 0xffff0000, v6
    v_lshlrev_b32 v174, 16, v7
    v_and_b32 v175, 0xffff0000, v7
    v_pk_mul_f32 v[160:161], v[160:161], v[152:153] op_sel_hi:[1,0]
    v_pk_mul_f32 v[162:163], v[162:163], v[152:153] op_sel_hi:[1,0]
    v_pk_mul_f32 v[164:165], v[164:165], v[152:153] op_sel_hi:[1,0]
    v_pk_mul_f32 v[166:167], v[166:167], v[152:153] op_sel_hi:[1,0]
    v_pk_mul_f32 v[168:169], v[168:169], v[152:153] op_sel_hi:[1,0]
    v_pk_mul_f32 v[170:171], v[170:171], v[152:153] op_sel_hi:[1,0]
    v_pk_mul_f32 v[172:173], v[172:173], v[152:153] op_sel_hi:[1,0]
    v_pk_mul_f32 v[174:175], v[174:175], v[152:153] op_sel_hi:[1,0]
    v_cvt_pk_bf16_f32 v160, v160, v161
    v_cvt_pk_bf16_f32 v162, v162, v163
    v_cvt_pk_bf16_f32 v164, v164, v165
    v_cvt_pk_bf16_f32 v166, v166, v167
    v_cvt_pk_bf16_f32 v168, v168, v169
    v_cvt_pk_bf16_f32 v170, v170, v171
    v_cvt_pk_bf16_f32 v172, v172, v173
    v_cvt_pk_bf16_f32 v174, v174, v175
    v_accvgpr_write_b32 a0, v160
    v_accvgpr_write_b32 a1, v162
    v_accvgpr_write_b32 a2, v164
    v_accvgpr_write_b32 a3, v166
    v_accvgpr_write_b32 a4, v168
    v_accvgpr_write_b32 a5, v170
    v_accvgpr_write_b32 a6, v172
    v_accvgpr_write_b32 a7, v174
    v_lshlrev_b32 v160, 16, v8
    v_and_b32 v161, 0xffff0000, v8
    v_lshlrev_b32 v162, 16, v9
    v_and_b32 v163, 0xffff0000, v9
    v_lshlrev_b32 v164, 16, v10
    v_and_b32 v165, 0xffff0000, v10
    v_lshlrev_b32 v166, 16, v11
    v_and_b32 v167, 0xffff0000, v11
    v_lshlrev_b32 v168, 16, v12
    v_and_b32 v169, 0xffff0000, v12
    v_lshlrev_b32 v170, 16, v13
    v_and_b32 v171, 0xffff0000, v13
    v_lshlrev_b32 v172, 16, v14
    v_and_b32 v173, 0xffff0000, v14
    v_lshlrev_b32 v174, 16, v15
    v_and_b32 v175, 0xffff0000, v15
    v_pk_add_f32 v[160:161], v[160:161], v[154:155] op_sel_hi:[1,0] neg_lo:[0,1] neg_hi:[0,1]
    v_pk_add_f32 v[162:163], v[162:163], v[154:155] op_sel_hi:[1,0] neg_lo:[0,1] neg_hi:[0,1]
    v_pk_add_f32 v[164:165], v[164:165], v[154:155] op_sel_hi:[1,0] neg_lo:[0,1] neg_hi:[0,1]
    v_pk_add_f32 v[166:167], v[166:167], v[154:155] op_sel_hi:[1,0] neg_lo:[0,1] neg_hi:[0,1]
    v_pk_add_f32 v[168:169], v[168:169], v[154:155] op_sel_hi:[1,0] neg_lo:[0,1] neg_hi:[0,1]
    v_pk_add_f32 v[170:171], v[170:171], v[154:155] op_sel_hi:[1,0] neg_lo:[0,1] neg_hi:[0,1]
    v_pk_add_f32 v[172:173], v[172:173], v[154:155] op_sel_hi:[1,0] neg_lo:[0,1] neg_hi:[0,1]
    v_pk_add_f32 v[174:175], v[174:175], v[154:155] op_sel_hi:[1,0] neg_lo:[0,1] neg_hi:[0,1]
    v_cvt_pk_bf16_f32 v8, v160, v161
    v_cvt_pk_bf16_f32 v9, v162, v163
    v_cvt_pk_bf16_f32 v10, v164, v165
    v_cvt_pk_bf16_f32 v11, v166, v167
    v_cvt_pk_bf16_f32 v12, v168, v169
    v_cvt_pk_bf16_f32 v13, v170, v171
    v_cvt_pk_bf16_f32 v14, v172, v173
    v_cvt_pk_bf16_f32 v15, v174, v175
    v_lshlrev_b32 v160, 16, v8
    v_and_b32 v161, 0xffff0000, v8
    v_lshlrev_b32 v162, 16, v9
    v_and_b32 v163, 0xffff0000, v9
    v_lshlrev_b32 v164, 16, v10
    v_and_b32 v165, 0xffff0000, v10
    v_lshlrev_b32 v166, 16, v11
    v_and_b32 v167, 0xffff0000, v11
    v_lshlrev_b32 v168, 16, v12
    v_and_b32 v169, 0xffff0000, v12
    v_lshlrev_b32 v170, 16, v13
    v_and_b32 v171, 0xffff0000, v13
    v_lshlrev_b32 v172, 16, v14
    v_and_b32 v173, 0xffff0000, v14
    v_lshlrev_b32 v174, 16, v15
    v_and_b32 v175, 0xffff0000, v15
    v_pk_mul_f32 v[160:161], v[160:161], v[152:153] op_sel_hi:[1,0]
    v_pk_mul_f32 v[162:163], v[162:163], v[152:153] op_sel_hi:[1,0]
    v_pk_mul_f32 v[164:165], v[164:165], v[152:153] op_sel_hi:[1,0]
    v_pk_mul_f32 v[166:167], v[166:167], v[152:153] op_sel_hi:[1,0]
    v_pk_mul_f32 v[168:169], v[168:169], v[152:153] op_sel_hi:[1,0]
    v_pk_mul_f32 v[170:171], v[170:171], v[152:153] op_sel_hi:[1,0]
    v_pk_mul_f32 v[172:173], v[172:173], v[152:153] op_sel_hi:[1,0]
    v_pk_mul_f32 v[174:175], v[174:175], v[152:153] op_sel_hi:[1,0]
    v_cvt_pk_bf16_f32 v160, v160, v161
    v_cvt_pk_bf16_f32 v162, v162, v163
    v_cvt_pk_bf16_f32 v164, v164, v165
    v_cvt_pk_bf16_f32 v166, v166, v167
    v_cvt_pk_bf16_f32 v168, v168, v169
    v_cvt_pk_bf16_f32 v170, v170, v171
    v_cvt_pk_bf16_f32 v172, v172, v173
    v_cvt_pk_bf16_f32 v174, v174, v175
    v_accvgpr_write_b32 a8, v160
    v_accvgpr_write_b32 a9, v162
    v_accvgpr_write_b32 a10, v164
    v_accvgpr_write_b32 a11, v166
    v_accvgpr_write_b32 a12, v168
    v_accvgpr_write_b32 a13, v170
    v_accvgpr_write_b32 a14, v172
    v_accvgpr_write_b32 a15, v174
    v_lshlrev_b32 v160, 16, v16
    v_and_b32 v161, 0xffff0000, v16
    v_lshlrev_b32 v162, 16, v17
    v_and_b32 v163, 0xffff0000, v17
    v_lshlrev_b32 v164, 16, v18
    v_and_b32 v165, 0xffff0000, v18
    v_lshlrev_b32 v166, 16, v19
    v_and_b32 v167, 0xffff0000, v19
    v_lshlrev_b32 v168, 16, v20
    v_and_b32 v169, 0xffff0000, v20
    v_lshlrev_b32 v170, 16, v21
    v_and_b32 v171, 0xffff0000, v21
    v_lshlrev_b32 v172, 16, v22
    v_and_b32 v173, 0xffff0000, v22
    v_lshlrev_b32 v174, 16, v23
    v_and_b32 v175, 0xffff0000, v23
    v_pk_add_f32 v[160:161], v[160:161], v[154:155] op_sel_hi:[1,0] neg_lo:[0,1] neg_hi:[0,1]
    v_pk_add_f32 v[162:163], v[162:163], v[154:155] op_sel_hi:[1,0] neg_lo:[0,1] neg_hi:[0,1]
    v_pk_add_f32 v[164:165], v[164:165], v[154:155] op_sel_hi:[1,0] neg_lo:[0,1] neg_hi:[0,1]
    v_pk_add_f32 v[166:167], v[166:167], v[154:155] op_sel_hi:[1,0] neg_lo:[0,1] neg_hi:[0,1]
    v_pk_add_f32 v[168:169], v[168:169], v[154:155] op_sel_hi:[1,0] neg_lo:[0,1] neg_hi:[0,1]
    v_pk_add_f32 v[170:171], v[170:171], v[154:155] op_sel_hi:[1,0] neg_lo:[0,1] neg_hi:[0,1]
    v_pk_add_f32 v[172:173], v[172:173], v[154:155] op_sel_hi:[1,0] neg_lo:[0,1] neg_hi:[0,1]
    v_pk_add_f32 v[174:175], v[174:175], v[154:155] op_sel_hi:[1,0] neg_lo:[0,1] neg_hi:[0,1]
    v_cvt_pk_bf16_f32 v16, v160, v161
    v_cvt_pk_bf16_f32 v17, v162, v163
    v_cvt_pk_bf16_f32 v18, v164, v165
    v_cvt_pk_bf16_f32 v19, v166, v167
    v_cvt_pk_bf16_f32 v20, v168, v169
    v_cvt_pk_bf16_f32 v21, v170, v171
    v_cvt_pk_bf16_f32 v22, v172, v173
    v_cvt_pk_bf16_f32 v23, v174, v175
    v_lshlrev_b32 v160, 16, v16
    v_and_b32 v161, 0xffff0000, v16
    v_lshlrev_b32 v162, 16, v17
    v_and_b32 v163, 0xffff0000, v17
    v_lshlrev_b32 v164, 16, v18
    v_and_b32 v165, 0xffff0000, v18
    v_lshlrev_b32 v166, 16, v19
    v_and_b32 v167, 0xffff0000, v19
    v_lshlrev_b32 v168, 16, v20
    v_and_b32 v169, 0xffff0000, v20
    v_lshlrev_b32 v170, 16, v21
    v_and_b32 v171, 0xffff0000, v21
    v_lshlrev_b32 v172, 16, v22
    v_and_b32 v173, 0xffff0000, v22
    v_lshlrev_b32 v174, 16, v23
    v_and_b32 v175, 0xffff0000, v23
    v_pk_mul_f32 v[160:161], v[160:161], v[152:153] op_sel_hi:[1,0]
    v_pk_mul_f32 v[162:163], v[162:163], v[152:153] op_sel_hi:[1,0]
    v_pk_mul_f32 v[164:165], v[164:165], v[152:153] op_sel_hi:[1,0]
    v_pk_mul_f32 v[166:167], v[166:167], v[152:153] op_sel_hi:[1,0]
    v_pk_mul_f32 v[168:169], v[168:169], v[152:153] op_sel_hi:[1,0]
    v_pk_mul_f32 v[170:171], v[170:171], v[152:153] op_sel_hi:[1,0]
    v_pk_mul_f32 v[172:173], v[172:173], v[152:153] op_sel_hi:[1,0]
    v_pk_mul_f32 v[174:175], v[174:175], v[152:153] op_sel_hi:[1,0]
    v_cvt_pk_bf16_f32 v160, v160, v161
    v_cvt_pk_bf16_f32 v162, v162, v163
    v_cvt_pk_bf16_f32 v164, v164, v165
    v_cvt_pk_bf16_f32 v166, v166, v167
    v_cvt_pk_bf16_f32 v168, v168, v169
    v_cvt_pk_bf16_f32 v170, v170, v171
    v_cvt_pk_bf16_f32 v172, v172, v173
    v_cvt_pk_bf16_f32 v174, v174, v175
    v_accvgpr_write_b32 a16, v160
    v_accvgpr_write_b32 a17, v162
    v_accvgpr_write_b32 a18, v164
    v_accvgpr_write_b32 a19, v166
    v_accvgpr_write_b32 a20, v168
    v_accvgpr_write_b32 a21, v170
    v_accvgpr_write_b32 a22, v172
    v_accvgpr_write_b32 a23, v174
    v_lshlrev_b32 v160, 16, v24
    v_and_b32 v161, 0xffff0000, v24
    v_lshlrev_b32 v162, 16, v25
    v_and_b32 v163, 0xffff0000, v25
    v_lshlrev_b32 v164, 16, v26
    v_and_b32 v165, 0xffff0000, v26
    v_lshlrev_b32 v166, 16, v27
    v_and_b32 v167, 0xffff0000, v27
    v_lshlrev_b32 v168, 16, v28
    v_and_b32 v169, 0xffff0000, v28
    v_lshlrev_b32 v170, 16, v29
    v_and_b32 v171, 0xffff0000, v29
    v_lshlrev_b32 v172, 16, v30
    v_and_b32 v173, 0xffff0000, v30
    v_lshlrev_b32 v174, 16, v31
    v_and_b32 v175, 0xffff0000, v31
    v_pk_add_f32 v[160:161], v[160:161], v[154:155] op_sel_hi:[1,0] neg_lo:[0,1] neg_hi:[0,1]
    v_pk_add_f32 v[162:163], v[162:163], v[154:155] op_sel_hi:[1,0] neg_lo:[0,1] neg_hi:[0,1]
    v_pk_add_f32 v[164:165], v[164:165], v[154:155] op_sel_hi:[1,0] neg_lo:[0,1] neg_hi:[0,1]
    v_pk_add_f32 v[166:167], v[166:167], v[154:155] op_sel_hi:[1,0] neg_lo:[0,1] neg_hi:[0,1]
    v_pk_add_f32 v[168:169], v[168:169], v[154:155] op_sel_hi:[1,0] neg_lo:[0,1] neg_hi:[0,1]
    v_pk_add_f32 v[170:171], v[170:171], v[154:155] op_sel_hi:[1,0] neg_lo:[0,1] neg_hi:[0,1]
    v_pk_add_f32 v[172:173], v[172:173], v[154:155] op_sel_hi:[1,0] neg_lo:[0,1] neg_hi:[0,1]
    v_pk_add_f32 v[174:175], v[174:175], v[154:155] op_sel_hi:[1,0] neg_lo:[0,1] neg_hi:[0,1]
    v_cvt_pk_bf16_f32 v24, v160, v161
    v_cvt_pk_bf16_f32 v25, v162, v163
    v_cvt_pk_bf16_f32 v26, v164, v165
    v_cvt_pk_bf16_f32 v27, v166, v167
    v_cvt_pk_bf16_f32 v28, v168, v169
    v_cvt_pk_bf16_f32 v29, v170, v171
    v_cvt_pk_bf16_f32 v30, v172, v173
    v_cvt_pk_bf16_f32 v31, v174, v175
    v_lshlrev_b32 v160, 16, v24
    v_and_b32 v161, 0xffff0000, v24
    v_lshlrev_b32 v162, 16, v25
    v_and_b32 v163, 0xffff0000, v25
    v_lshlrev_b32 v164, 16, v26
    v_and_b32 v165, 0xffff0000, v26
    v_lshlrev_b32 v166, 16, v27
    v_and_b32 v167, 0xffff0000, v27
    v_lshlrev_b32 v168, 16, v28
    v_and_b32 v169, 0xffff0000, v28
    v_lshlrev_b32 v170, 16, v29
    v_and_b32 v171, 0xffff0000, v29
    v_lshlrev_b32 v172, 16, v30
    v_and_b32 v173, 0xffff0000, v30
    v_lshlrev_b32 v174, 16, v31
    v_and_b32 v175, 0xffff0000, v31
    v_pk_mul_f32 v[160:161], v[160:161], v[152:153] op_sel_hi:[1,0]
    v_pk_mul_f32 v[162:163], v[162:163], v[152:153] op_sel_hi:[1,0]
    v_pk_mul_f32 v[164:165], v[164:165], v[152:153] op_sel_hi:[1,0]
    v_pk_mul_f32 v[166:167], v[166:167], v[152:153] op_sel_hi:[1,0]
    v_pk_mul_f32 v[168:169], v[168:169], v[152:153] op_sel_hi:[1,0]
    v_pk_mul_f32 v[170:171], v[170:171], v[152:153] op_sel_hi:[1,0]
    v_pk_mul_f32 v[172:173], v[172:173], v[152:153] op_sel_hi:[1,0]
    v_pk_mul_f32 v[174:175], v[174:175], v[152:153] op_sel_hi:[1,0]
    v_cvt_pk_bf16_f32 v160, v160, v161
    v_cvt_pk_bf16_f32 v162, v162, v163
    v_cvt_pk_bf16_f32 v164, v164, v165
    v_cvt_pk_bf16_f32 v166, v166, v167
    v_cvt_pk_bf16_f32 v168, v168, v169
    v_cvt_pk_bf16_f32 v170, v170, v171
    v_cvt_pk_bf16_f32 v172, v172, v173
    v_cvt_pk_bf16_f32 v174, v174, v175
    v_accvgpr_write_b32 a24, v160
    v_accvgpr_write_b32 a25, v162
    v_accvgpr_write_b32 a26, v164
    v_accvgpr_write_b32 a27, v166
    v_accvgpr_write_b32 a28, v168
    v_accvgpr_write_b32 a29, v170
    v_accvgpr_write_b32 a30, v172
    v_accvgpr_write_b32 a31, v174
    v_lshlrev_b32 v160, 16, v32
    v_and_b32 v161, 0xffff0000, v32
    v_lshlrev_b32 v162, 16, v33
    v_and_b32 v163, 0xffff0000, v33
    v_lshlrev_b32 v164, 16, v34
    v_and_b32 v165, 0xffff0000, v34
    v_lshlrev_b32 v166, 16, v35
    v_and_b32 v167, 0xffff0000, v35
    v_lshlrev_b32 v168, 16, v36
    v_and_b32 v169, 0xffff0000, v36
    v_lshlrev_b32 v170, 16, v37
    v_and_b32 v171, 0xffff0000, v37
    v_lshlrev_b32 v172, 16, v38
    v_and_b32 v173, 0xffff0000, v38
    v_lshlrev_b32 v174, 16, v39
    v_and_b32 v175, 0xffff0000, v39
    v_pk_add_f32 v[160:161], v[160:161], v[154:155] op_sel_hi:[1,0] neg_lo:[0,1] neg_hi:[0,1]
    v_pk_add_f32 v[162:163], v[162:163], v[154:155] op_sel_hi:[1,0] neg_lo:[0,1] neg_hi:[0,1]
    v_pk_add_f32 v[164:165], v[164:165], v[154:155] op_sel_hi:[1,0] neg_lo:[0,1] neg_hi:[0,1]
    v_pk_add_f32 v[166:167], v[166:167], v[154:155] op_sel_hi:[1,0] neg_lo:[0,1] neg_hi:[0,1]
    v_pk_add_f32 v[168:169], v[168:169], v[154:155] op_sel_hi:[1,0] neg_lo:[0,1] neg_hi:[0,1]
    v_pk_add_f32 v[170:171], v[170:171], v[154:155] op_sel_hi:[1,0] neg_lo:[0,1] neg_hi:[0,1]
    v_pk_add_f32 v[172:173], v[172:173], v[154:155] op_sel_hi:[1,0] neg_lo:[0,1] neg_hi:[0,1]
    v_pk_add_f32 v[174:175], v[174:175], v[154:155] op_sel_hi:[1,0] neg_lo:[0,1] neg_hi:[0,1]
    v_cvt_pk_bf16_f32 v32, v160, v161
    v_cvt_pk_bf16_f32 v33, v162, v163
    v_cvt_pk_bf16_f32 v34, v164, v165
    v_cvt_pk_bf16_f32 v35, v166, v167
    v_cvt_pk_bf16_f32 v36, v168, v169
    v_cvt_pk_bf16_f32 v37, v170, v171
    v_cvt_pk_bf16_f32 v38, v172, v173
    v_cvt_pk_bf16_f32 v39, v174, v175
    v_lshlrev_b32 v160, 16, v32
    v_and_b32 v161, 0xffff0000, v32
    v_lshlrev_b32 v162, 16, v33
    v_and_b32 v163, 0xffff0000, v33
    v_lshlrev_b32 v164, 16, v34
    v_and_b32 v165, 0xffff0000, v34
    v_lshlrev_b32 v166, 16, v35
    v_and_b32 v167, 0xffff0000, v35
    v_lshlrev_b32 v168, 16, v36
    v_and_b32 v169, 0xffff0000, v36
    v_lshlrev_b32 v170, 16, v37
    v_and_b32 v171, 0xffff0000, v37
    v_lshlrev_b32 v172, 16, v38
    v_and_b32 v173, 0xffff0000, v38
    v_lshlrev_b32 v174, 16, v39
    v_and_b32 v175, 0xffff0000, v39
    v_pk_mul_f32 v[160:161], v[160:161], v[152:153] op_sel_hi:[1,0]
    v_pk_mul_f32 v[162:163], v[162:163], v[152:153] op_sel_hi:[1,0]
    v_pk_mul_f32 v[164:165], v[164:165], v[152:153] op_sel_hi:[1,0]
    v_pk_mul_f32 v[166:167], v[166:167], v[152:153] op_sel_hi:[1,0]
    v_pk_mul_f32 v[168:169], v[168:169], v[152:153] op_sel_hi:[1,0]
    v_pk_mul_f32 v[170:171], v[170:171], v[152:153] op_sel_hi:[1,0]
    v_pk_mul_f32 v[172:173], v[172:173], v[152:153] op_sel_hi:[1,0]
    v_pk_mul_f32 v[174:175], v[174:175], v[152:153] op_sel_hi:[1,0]
    v_cvt_pk_bf16_f32 v160, v160, v161
    v_cvt_pk_bf16_f32 v162, v162, v163
    v_cvt_pk_bf16_f32 v164, v164, v165
    v_cvt_pk_bf16_f32 v166, v166, v167
    v_cvt_pk_bf16_f32 v168, v168, v169
    v_cvt_pk_bf16_f32 v170, v170, v171
    v_cvt_pk_bf16_f32 v172, v172, v173
    v_cvt_pk_bf16_f32 v174, v174, v175
    v_accvgpr_write_b32 a32, v160
    v_accvgpr_write_b32 a33, v162
    v_accvgpr_write_b32 a34, v164
    v_accvgpr_write_b32 a35, v166
    v_accvgpr_write_b32 a36, v168
    v_accvgpr_write_b32 a37, v170
    v_accvgpr_write_b32 a38, v172
    v_accvgpr_write_b32 a39, v174
    v_lshlrev_b32 v160, 16, v40
    v_and_b32 v161, 0xffff0000, v40
    v_lshlrev_b32 v162, 16, v41
    v_and_b32 v163, 0xffff0000, v41
    v_lshlrev_b32 v164, 16, v42
    v_and_b32 v165, 0xffff0000, v42
    v_lshlrev_b32 v166, 16, v43
    v_and_b32 v167, 0xffff0000, v43
    v_lshlrev_b32 v168, 16, v44
    v_and_b32 v169, 0xffff0000, v44
    v_lshlrev_b32 v170, 16, v45
    v_and_b32 v171, 0xffff0000, v45
    v_lshlrev_b32 v172, 16, v46
    v_and_b32 v173, 0xffff0000, v46
    v_lshlrev_b32 v174, 16, v47
    v_and_b32 v175, 0xffff0000, v47
    v_pk_add_f32 v[160:161], v[160:161], v[154:155] op_sel_hi:[1,0] neg_lo:[0,1] neg_hi:[0,1]
    v_pk_add_f32 v[162:163], v[162:163], v[154:155] op_sel_hi:[1,0] neg_lo:[0,1] neg_hi:[0,1]
    v_pk_add_f32 v[164:165], v[164:165], v[154:155] op_sel_hi:[1,0] neg_lo:[0,1] neg_hi:[0,1]
    v_pk_add_f32 v[166:167], v[166:167], v[154:155] op_sel_hi:[1,0] neg_lo:[0,1] neg_hi:[0,1]
    v_pk_add_f32 v[168:169], v[168:169], v[154:155] op_sel_hi:[1,0] neg_lo:[0,1] neg_hi:[0,1]
    v_pk_add_f32 v[170:171], v[170:171], v[154:155] op_sel_hi:[1,0] neg_lo:[0,1] neg_hi:[0,1]
    v_pk_add_f32 v[172:173], v[172:173], v[154:155] op_sel_hi:[1,0] neg_lo:[0,1] neg_hi:[0,1]
    v_pk_add_f32 v[174:175], v[174:175], v[154:155] op_sel_hi:[1,0] neg_lo:[0,1] neg_hi:[0,1]
    v_cvt_pk_bf16_f32 v40, v160, v161
    v_cvt_pk_bf16_f32 v41, v162, v163
    v_cvt_pk_bf16_f32 v42, v164, v165
    v_cvt_pk_bf16_f32 v43, v166, v167
    v_cvt_pk_bf16_f32 v44, v168, v169
    v_cvt_pk_bf16_f32 v45, v170, v171
    v_cvt_pk_bf16_f32 v46, v172, v173
    v_cvt_pk_bf16_f32 v47, v174, v175
    v_lshlrev_b32 v160, 16, v40
    v_and_b32 v161, 0xffff0000, v40
    v_lshlrev_b32 v162, 16, v41
    v_and_b32 v163, 0xffff0000, v41
    v_lshlrev_b32 v164, 16, v42
    v_and_b32 v165, 0xffff0000, v42
    v_lshlrev_b32 v166, 16, v43
    v_and_b32 v167, 0xffff0000, v43
    v_lshlrev_b32 v168, 16, v44
    v_and_b32 v169, 0xffff0000, v44
    v_lshlrev_b32 v170, 16, v45
    v_and_b32 v171, 0xffff0000, v45
    v_lshlrev_b32 v172, 16, v46
    v_and_b32 v173, 0xffff0000, v46
    v_lshlrev_b32 v174, 16, v47
    v_and_b32 v175, 0xffff0000, v47
    v_pk_mul_f32 v[160:161], v[160:161], v[152:153] op_sel_hi:[1,0]
    v_pk_mul_f32 v[162:163], v[162:163], v[152:153] op_sel_hi:[1,0]
    v_pk_mul_f32 v[164:165], v[164:165], v[152:153] op_sel_hi:[1,0]
    v_pk_mul_f32 v[166:167], v[166:167], v[152:153] op_sel_hi:[1,0]
    v_pk_mul_f32 v[168:169], v[168:169], v[152:153] op_sel_hi:[1,0]
    v_pk_mul_f32 v[170:171], v[170:171], v[152:153] op_sel_hi:[1,0]
    v_pk_mul_f32 v[172:173], v[172:173], v[152:153] op_sel_hi:[1,0]
    v_pk_mul_f32 v[174:175], v[174:175], v[152:153] op_sel_hi:[1,0]
    v_cvt_pk_bf16_f32 v160, v160, v161
    v_cvt_pk_bf16_f32 v162, v162, v163
    v_cvt_pk_bf16_f32 v164, v164, v165
    v_cvt_pk_bf16_f32 v166, v166, v167
    v_cvt_pk_bf16_f32 v168, v168, v169
    v_cvt_pk_bf16_f32 v170, v170, v171
    v_cvt_pk_bf16_f32 v172, v172, v173
    v_cvt_pk_bf16_f32 v174, v174, v175
    v_accvgpr_write_b32 a40, v160
    v_accvgpr_write_b32 a41, v162
    v_accvgpr_write_b32 a42, v164
    v_accvgpr_write_b32 a43, v166
    v_accvgpr_write_b32 a44, v168
    v_accvgpr_write_b32 a45, v170
    v_accvgpr_write_b32 a46, v172
    v_accvgpr_write_b32 a47, v174
    v_lshlrev_b32 v160, 16, v48
    v_and_b32 v161, 0xffff0000, v48
    v_lshlrev_b32 v162, 16, v49
    v_and_b32 v163, 0xffff0000, v49
    v_lshlrev_b32 v164, 16, v50
    v_and_b32 v165, 0xffff0000, v50
    v_lshlrev_b32 v166, 16, v51
    v_and_b32 v167, 0xffff0000, v51
    v_lshlrev_b32 v168, 16, v52
    v_and_b32 v169, 0xffff0000, v52
    v_lshlrev_b32 v170, 16, v53
    v_and_b32 v171, 0xffff0000, v53
    v_lshlrev_b32 v172, 16, v54
    v_and_b32 v173, 0xffff0000, v54
    v_lshlrev_b32 v174, 16, v55
    v_and_b32 v175, 0xffff0000, v55
    v_pk_add_f32 v[160:161], v[160:161], v[154:155] op_sel_hi:[1,0] neg_lo:[0,1] neg_hi:[0,1]
    v_pk_add_f32 v[162:163], v[162:163], v[154:155] op_sel_hi:[1,0] neg_lo:[0,1] neg_hi:[0,1]
    v_pk_add_f32 v[164:165], v[164:165], v[154:155] op_sel_hi:[1,0] neg_lo:[0,1] neg_hi:[0,1]
    v_pk_add_f32 v[166:167], v[166:167], v[154:155] op_sel_hi:[1,0] neg_lo:[0,1] neg_hi:[0,1]
    v_pk_add_f32 v[168:169], v[168:169], v[154:155] op_sel_hi:[1,0] neg_lo:[0,1] neg_hi:[0,1]
    v_pk_add_f32 v[170:171], v[170:171], v[154:155] op_sel_hi:[1,0] neg_lo:[0,1] neg_hi:[0,1]
    v_pk_add_f32 v[172:173], v[172:173], v[154:155] op_sel_hi:[1,0] neg_lo:[0,1] neg_hi:[0,1]
    v_pk_add_f32 v[174:175], v[174:175], v[154:155] op_sel_hi:[1,0] neg_lo:[0,1] neg_hi:[0,1]
    v_cvt_pk_bf16_f32 v48, v160, v161
    v_cvt_pk_bf16_f32 v49, v162, v163
    v_cvt_pk_bf16_f32 v50, v164, v165
    v_cvt_pk_bf16_f32 v51, v166, v167
    v_cvt_pk_bf16_f32 v52, v168, v169
    v_cvt_pk_bf16_f32 v53, v170, v171
    v_cvt_pk_bf16_f32 v54, v172, v173
    v_cvt_pk_bf16_f32 v55, v174, v175
    v_lshlrev_b32 v160, 16, v48
    v_and_b32 v161, 0xffff0000, v48
    v_lshlrev_b32 v162, 16, v49
    v_and_b32 v163, 0xffff0000, v49
    v_lshlrev_b32 v164, 16, v50
    v_and_b32 v165, 0xffff0000, v50
    v_lshlrev_b32 v166, 16, v51
    v_and_b32 v167, 0xffff0000, v51
    v_lshlrev_b32 v168, 16, v52
    v_and_b32 v169, 0xffff0000, v52
    v_lshlrev_b32 v170, 16, v53
    v_and_b32 v171, 0xffff0000, v53
    v_lshlrev_b32 v172, 16, v54
    v_and_b32 v173, 0xffff0000, v54
    v_lshlrev_b32 v174, 16, v55
    v_and_b32 v175, 0xffff0000, v55
    v_pk_mul_f32 v[160:161], v[160:161], v[152:153] op_sel_hi:[1,0]
    v_pk_mul_f32 v[162:163], v[162:163], v[152:153] op_sel_hi:[1,0]
    v_pk_mul_f32 v[164:165], v[164:165], v[152:153] op_sel_hi:[1,0]
    v_pk_mul_f32 v[166:167], v[166:167], v[152:153] op_sel_hi:[1,0]
    v_pk_mul_f32 v[168:169], v[168:169], v[152:153] op_sel_hi:[1,0]
    v_pk_mul_f32 v[170:171], v[170:171], v[152:153] op_sel_hi:[1,0]
    v_pk_mul_f32 v[172:173], v[172:173], v[152:153] op_sel_hi:[1,0]
    v_pk_mul_f32 v[174:175], v[174:175], v[152:153] op_sel_hi:[1,0]
    v_cvt_pk_bf16_f32 v160, v160, v161
    v_cvt_pk_bf16_f32 v162, v162, v163
    v_cvt_pk_bf16_f32 v164, v164, v165
    v_cvt_pk_bf16_f32 v166, v166, v167
    v_cvt_pk_bf16_f32 v168, v168, v169
    v_cvt_pk_bf16_f32 v170, v170, v171
    v_cvt_pk_bf16_f32 v172, v172, v173
    v_cvt_pk_bf16_f32 v174, v174, v175
    v_accvgpr_write_b32 a48, v160
    v_accvgpr_write_b32 a49, v162
    v_accvgpr_write_b32 a50, v164
    v_accvgpr_write_b32 a51, v166
    v_accvgpr_write_b32 a52, v168
    v_accvgpr_write_b32 a53, v170
    v_accvgpr_write_b32 a54, v172
    v_accvgpr_write_b32 a55, v174
    v_lshlrev_b32 v160, 16, v56
    v_and_b32 v161, 0xffff0000, v56
    v_lshlrev_b32 v162, 16, v57
    v_and_b32 v163, 0xffff0000, v57
    v_lshlrev_b32 v164, 16, v58
    v_and_b32 v165, 0xffff0000, v58
    v_lshlrev_b32 v166, 16, v59
    v_and_b32 v167, 0xffff0000, v59
    v_lshlrev_b32 v168, 16, v60
    v_and_b32 v169, 0xffff0000, v60
    v_lshlrev_b32 v170, 16, v61
    v_and_b32 v171, 0xffff0000, v61
    v_lshlrev_b32 v172, 16, v62
    v_and_b32 v173, 0xffff0000, v62
    v_lshlrev_b32 v174, 16, v63
    v_and_b32 v175, 0xffff0000, v63
    v_pk_add_f32 v[160:161], v[160:161], v[154:155] op_sel_hi:[1,0] neg_lo:[0,1] neg_hi:[0,1]
    v_pk_add_f32 v[162:163], v[162:163], v[154:155] op_sel_hi:[1,0] neg_lo:[0,1] neg_hi:[0,1]
    v_pk_add_f32 v[164:165], v[164:165], v[154:155] op_sel_hi:[1,0] neg_lo:[0,1] neg_hi:[0,1]
    v_pk_add_f32 v[166:167], v[166:167], v[154:155] op_sel_hi:[1,0] neg_lo:[0,1] neg_hi:[0,1]
    v_pk_add_f32 v[168:169], v[168:169], v[154:155] op_sel_hi:[1,0] neg_lo:[0,1] neg_hi:[0,1]
    v_pk_add_f32 v[170:171], v[170:171], v[154:155] op_sel_hi:[1,0] neg_lo:[0,1] neg_hi:[0,1]
    v_pk_add_f32 v[172:173], v[172:173], v[154:155] op_sel_hi:[1,0] neg_lo:[0,1] neg_hi:[0,1]
    v_pk_add_f32 v[174:175], v[174:175], v[154:155] op_sel_hi:[1,0] neg_lo:[0,1] neg_hi:[0,1]
    v_cvt_pk_bf16_f32 v56, v160, v161
    v_cvt_pk_bf16_f32 v57, v162, v163
    v_cvt_pk_bf16_f32 v58, v164, v165
    v_cvt_pk_bf16_f32 v59, v166, v167
    v_cvt_pk_bf16_f32 v60, v168, v169
    v_cvt_pk_bf16_f32 v61, v170, v171
    v_cvt_pk_bf16_f32 v62, v172, v173
    v_cvt_pk_bf16_f32 v63, v174, v175
    v_lshlrev_b32 v160, 16, v56
    v_and_b32 v161, 0xffff0000, v56
    v_lshlrev_b32 v162, 16, v57
    v_and_b32 v163, 0xffff0000, v57
    v_lshlrev_b32 v164, 16, v58
    v_and_b32 v165, 0xffff0000, v58
    v_lshlrev_b32 v166, 16, v59
    v_and_b32 v167, 0xffff0000, v59
    v_lshlrev_b32 v168, 16, v60
    v_and_b32 v169, 0xffff0000, v60
    v_lshlrev_b32 v170, 16, v61
    v_and_b32 v171, 0xffff0000, v61
    v_lshlrev_b32 v172, 16, v62
    v_and_b32 v173, 0xffff0000, v62
    v_lshlrev_b32 v174, 16, v63
    v_and_b32 v175, 0xffff0000, v63
    v_pk_mul_f32 v[160:161], v[160:161], v[152:153] op_sel_hi:[1,0]
    v_pk_mul_f32 v[162:163], v[162:163], v[152:153] op_sel_hi:[1,0]
    v_pk_mul_f32 v[164:165], v[164:165], v[152:153] op_sel_hi:[1,0]
    v_pk_mul_f32 v[166:167], v[166:167], v[152:153] op_sel_hi:[1,0]
    v_pk_mul_f32 v[168:169], v[168:169], v[152:153] op_sel_hi:[1,0]
    v_pk_mul_f32 v[170:171], v[170:171], v[152:153] op_sel_hi:[1,0]
    v_pk_mul_f32 v[172:173], v[172:173], v[152:153] op_sel_hi:[1,0]
    v_pk_mul_f32 v[174:175], v[174:175], v[152:153] op_sel_hi:[1,0]
    v_cvt_pk_bf16_f32 v160, v160, v161
    v_cvt_pk_bf16_f32 v162, v162, v163
    v_cvt_pk_bf16_f32 v164, v164, v165
    v_cvt_pk_bf16_f32 v166, v166, v167
    v_cvt_pk_bf16_f32 v168, v168, v169
    v_cvt_pk_bf16_f32 v170, v170, v171
    v_cvt_pk_bf16_f32 v172, v172, v173
    v_cvt_pk_bf16_f32 v174, v174, v175
    v_accvgpr_write_b32 a56, v160
    v_accvgpr_write_b32 a57, v162
    v_accvgpr_write_b32 a58, v164
    v_accvgpr_write_b32 a59, v166
    v_accvgpr_write_b32 a60, v168
    v_accvgpr_write_b32 a61, v170
    v_accvgpr_write_b32 a62, v172
    v_accvgpr_write_b32 a63, v174
    s_waitcnt vmcnt(0)
    v_lshlrev_b32 v138, 2, v137
    s_mul_i32 s26, s101, 18752
    s_mul_i32 s27, s21, 4736
    s_add_u32 s26, s26, s27
    s_add_u32 s27, s26, 4096
    s_cmp_eq_u32 s41, 0
    s_cselect_b32 s6, 0x400000, 0
    s_mov_b32 s7, 0x20000
    s_mov_b32 s4, s42
    s_and_b32 s5, s43, 0xffff
    buffer_load_dword v143, v138, s[4:7], s26 offen
    s_mov_b32 exec_lo, 0x3ff
    s_mov_b32 exec_hi, 0
    buffer_load_dword v143, v138, s[4:7], s27 offen
    s_mov_b64 exec, -1
    s_lshr_b32 s26, s39, 5
    s_cmp_eq_u32 s26, 0
    s_cselect_b64 s[16:17], s[30:31], s[34:35]
    s_cmp_eq_u32 s26, 1
    s_cselect_b64 s[16:17], s[32:33], s[16:17]
    s_and_b32 s17, s17, 0xffff
    s_cmp_lt_u32 s39, 96
    s_cselect_b32 s18, 0x400000, 0
    s_and_b32 s24, s39, 31
    s_lshl_b32 s24, s24, 8
    s_add_u32 s26, s24, 0x0
    s_add_u32 m0, s29, 0x0
    s_nop 0
    buffer_load_dwordx4 v136, s[16:19], s26 offen lds
    s_add_u32 s26, s24, 0x20000
    s_add_u32 m0, s29, 0x1000
    s_nop 0
    buffer_load_dwordx4 v136, s[16:19], s26 offen lds
    s_add_u32 s26, s24, 0x40000
    s_add_u32 m0, s29, 0x2000
    s_nop 0
    buffer_load_dwordx4 v136, s[16:19], s26 offen lds
    s_add_u32 s26, s24, 0x60000
    s_add_u32 m0, s29, 0x3000
    s_nop 0
    buffer_load_dwordx4 v136, s[16:19], s26 offen lds
    s_add_u32 s26, s24, 0x80000
    s_add_u32 m0, s29, 0x4000
    s_nop 0
    buffer_load_dwordx4 v136, s[16:19], s26 offen lds
    s_add_u32 s26, s24, 0xa0000
    s_add_u32 m0, s29, 0x5000
    s_nop 0
    buffer_load_dwordx4 v136, s[16:19], s26 offen lds
    s_add_u32 s26, s24, 0xc0000
    s_add_u32 m0, s29, 0x6000
    s_nop 0
    buffer_load_dwordx4 v136, s[16:19], s26 offen lds
    s_add_u32 s26, s24, 0xe0000
    s_add_u32 m0, s29, 0x7000
    s_nop 0
    buffer_load_dwordx4 v136, s[16:19], s26 offen lds
    s_add_u32 s26, s24, 0x100000
    s_add_u32 m0, s29, 0x8000
    s_nop 0
    buffer_load_dwordx4 v136, s[16:19], s26 offen lds
    s_add_u32 s26, s24, 0x120000
    s_add_u32 m0, s29, 0x9000
    s_nop 0
    buffer_load_dwordx4 v136, s[16:19], s26 offen lds
    s_add_u32 s26, s24, 0x140000
    s_add_u32 m0, s29, 0xa000
    s_nop 0
    buffer_load_dwordx4 v136, s[16:19], s26 offen lds
    s_add_u32 s26, s24, 0x160000
    s_add_u32 m0, s29, 0xb000
    s_nop 0
    buffer_load_dwordx4 v136, s[16:19], s26 offen lds
    s_add_u32 s26, s24, 0x180000
    s_add_u32 m0, s29, 0xc000
    s_nop 0
    buffer_load_dwordx4 v136, s[16:19], s26 offen lds
    s_add_u32 s26, s24, 0x1a0000
    s_add_u32 m0, s29, 0xd000
    s_nop 0
    buffer_load_dwordx4 v136, s[16:19], s26 offen lds
    s_add_u32 s26, s24, 0x1c0000
    s_add_u32 m0, s29, 0xe000
    s_nop 0
    buffer_load_dwordx4 v136, s[16:19], s26 offen lds
    s_add_u32 s26, s24, 0x1e0000
    s_add_u32 m0, s29, 0xf000
    s_nop 0
    buffer_load_dwordx4 v136, s[16:19], s26 offen lds
    s_add_u32 s26, s24, 0x200000
    s_add_u32 m0, s29, 0x10000
    s_nop 0
    buffer_load_dwordx4 v136, s[16:19], s26 offen lds
    s_add_u32 s26, s24, 0x220000
    s_add_u32 m0, s29, 0x11000
    s_nop 0
    buffer_load_dwordx4 v136, s[16:19], s26 offen lds
    s_add_u32 s26, s24, 0x240000
    s_add_u32 m0, s29, 0x12000
    s_nop 0
    buffer_load_dwordx4 v136, s[16:19], s26 offen lds
    s_add_u32 s26, s24, 0x260000
    s_add_u32 m0, s29, 0x13000
    s_nop 0
    buffer_load_dwordx4 v136, s[16:19], s26 offen lds
    s_add_u32 s26, s24, 0x280000
    s_add_u32 m0, s29, 0x14000
    s_nop 0
    buffer_load_dwordx4 v136, s[16:19], s26 offen lds
    s_add_u32 s26, s24, 0x2a0000
    s_add_u32 m0, s29, 0x15000
    s_nop 0
    buffer_load_dwordx4 v136, s[16:19], s26 offen lds
    s_add_u32 s26, s24, 0x2c0000
    s_add_u32 m0, s29, 0x16000
    s_nop 0
    buffer_load_dwordx4 v136, s[16:19], s26 offen lds
    s_add_u32 s26, s24, 0x2e0000
    s_add_u32 m0, s29, 0x17000
    s_nop 0
    buffer_load_dwordx4 v136, s[16:19], s26 offen lds
    v_pk_mov_b32 v[150:151], 0, 0
    v_pk_mov_b32 v[152:153], 0, 0
    v_dot2_f32_bf16 v150, v64, v158, v150
    v_dot2_f32_bf16 v152, v64, v64, v152
    v_dot2_f32_bf16 v151, v65, v158, v151
    v_dot2_f32_bf16 v153, v65, v65, v153
    v_dot2_f32_bf16 v150, v66, v158, v150
    v_dot2_f32_bf16 v152, v66, v66, v152
    v_dot2_f32_bf16 v151, v67, v158, v151
    v_dot2_f32_bf16 v153, v67, v67, v153
    v_dot2_f32_bf16 v150, v68, v158, v150
    v_dot2_f32_bf16 v152, v68, v68, v152
    v_dot2_f32_bf16 v151, v69, v158, v151
    v_dot2_f32_bf16 v153, v69, v69, v153
    v_dot2_f32_bf16 v150, v70, v158, v150
    v_dot2_f32_bf16 v152, v70, v70, v152
    v_dot2_f32_bf16 v151, v71, v158, v151
    v_dot2_f32_bf16 v153, v71, v71, v153
    v_dot2_f32_bf16 v150, v72, v158, v150
    v_dot2_f32_bf16 v152, v72, v72, v152
    v_dot2_f32_bf16 v151, v73, v158, v151
    v_dot2_f32_bf16 v153, v73, v73, v153
    v_dot2_f32_bf16 v150, v74, v158, v150
    v_dot2_f32_bf16 v152, v74, v74, v152
    v_dot2_f32_bf16 v151, v75, v158, v151
    v_dot2_f32_bf16 v153, v75, v75, v153
    v_dot2_f32_bf16 v150, v76, v158, v150
    v_dot2_f32_bf16 v152, v76, v76, v152
    v_dot2_f32_bf16 v151, v77, v158, v151
    v_dot2_f32_bf16 v153, v77, v77, v153
    v_dot2_f32_bf16 v150, v78, v158, v150
    v_dot2_f32_bf16 v152, v78, v78, v152
    v_dot2_f32_bf16 v151, v79, v158, v151
    v_dot2_f32_bf16 v153, v79, v79, v153
    v_dot2_f32_bf16 v150, v80, v158, v150
    v_dot2_f32_bf16 v152, v80, v80, v152
    v_dot2_f32_bf16 v151, v81, v158, v151
    v_dot2_f32_bf16 v153, v81, v81, v153
    v_dot2_f32_bf16 v150, v82, v158, v150
    v_dot2_f32_bf16 v152, v82, v82, v152
    v_dot2_f32_bf16 v151, v83, v158, v151
    v_dot2_f32_bf16 v153, v83, v83, v153
    v_dot2_f32_bf16 v150, v84, v158, v150
    v_dot2_f32_bf16 v152, v84, v84, v152
    v_dot2_f32_bf16 v151, v85, v158, v151
    v_dot2_f32_bf16 v153, v85, v85, v153
    v_dot2_f32_bf16 v150, v86, v158, v150
    v_dot2_f32_bf16 v152, v86, v86, v152
    v_dot2_f32_bf16 v151, v87, v158, v151
    v_dot2_f32_bf16 v153, v87, v87, v153
    v_dot2_f32_bf16 v150, v88, v158, v150
    v_dot2_f32_bf16 v152, v88, v88, v152
    v_dot2_f32_bf16 v151, v89, v158, v151
    v_dot2_f32_bf16 v153, v89, v89, v153
    v_dot2_f32_bf16 v150, v90, v158, v150
    v_dot2_f32_bf16 v152, v90, v90, v152
    v_dot2_f32_bf16 v151, v91, v158, v151
    v_dot2_f32_bf16 v153, v91, v91, v153
    v_dot2_f32_bf16 v150, v92, v158, v150
    v_dot2_f32_bf16 v152, v92, v92, v152
    v_dot2_f32_bf16 v151, v93, v158, v151
    v_dot2_f32_bf16 v153, v93, v93, v153
    v_dot2_f32_bf16 v150, v94, v158, v150
    v_dot2_f32_bf16 v152, v94, v94, v152
    v_dot2_f32_bf16 v151, v95, v158, v151
    v_dot2_f32_bf16 v153, v95, v95, v153
    v_dot2_f32_bf16 v150, v96, v158, v150
    v_dot2_f32_bf16 v152, v96, v96, v152
    v_dot2_f32_bf16 v151, v97, v158, v151
    v_dot2_f32_bf16 v153, v97, v97, v153
    v_dot2_f32_bf16 v150, v98, v158, v150
    v_dot2_f32_bf16 v152, v98, v98, v152
    v_dot2_f32_bf16 v151, v99, v158, v151
    v_dot2_f32_bf16 v153, v99, v99, v153
    v_dot2_f32_bf16 v150, v100, v158, v150
    v_dot2_f32_bf16 v152, v100, v100, v152
    v_dot2_f32_bf16 v151, v101, v158, v151
    v_dot2_f32_bf16 v153, v101, v101, v153
    v_dot2_f32_bf16 v150, v102, v158, v150
    v_dot2_f32_bf16 v152, v102, v102, v152
    v_dot2_f32_bf16 v151, v103, v158, v151
    v_dot2_f32_bf16 v153, v103, v103, v153
    v_dot2_f32_bf16 v150, v104, v158, v150
    v_dot2_f32_bf16 v152, v104, v104, v152
    v_dot2_f32_bf16 v151, v105, v158, v151
    v_dot2_f32_bf16 v153, v105, v105, v153
    v_dot2_f32_bf16 v150, v106, v158, v150
    v_dot2_f32_bf16 v152, v106, v106, v152
    v_dot2_f32_bf16 v151, v107, v158, v151
    v_dot2_f32_bf16 v153, v107, v107, v153
    v_dot2_f32_bf16 v150, v108, v158, v150
    v_dot2_f32_bf16 v152, v108, v108, v152
    v_dot2_f32_bf16 v151, v109, v158, v151
    v_dot2_f32_bf16 v153, v109, v109, v153
    v_dot2_f32_bf16 v150, v110, v158, v150
    v_dot2_f32_bf16 v152, v110, v110, v152
    v_dot2_f32_bf16 v151, v111, v158, v151
    v_dot2_f32_bf16 v153, v111, v111, v153
    v_dot2_f32_bf16 v150, v112, v158, v150
    v_dot2_f32_bf16 v152, v112, v112, v152
    v_dot2_f32_bf16 v151, v113, v158, v151
    v_dot2_f32_bf16 v153, v113, v113, v153
    v_dot2_f32_bf16 v150, v114, v158, v150
    v_dot2_f32_bf16 v152, v114, v114, v152
    v_dot2_f32_bf16 v151, v115, v158, v151
    v_dot2_f32_bf16 v153, v115, v115, v153
    v_dot2_f32_bf16 v150, v116, v158, v150
    v_dot2_f32_bf16 v152, v116, v116, v152
    v_dot2_f32_bf16 v151, v117, v158, v151
    v_dot2_f32_bf16 v153, v117, v117, v153
    v_dot2_f32_bf16 v150, v118, v158, v150
    v_dot2_f32_bf16 v152, v118, v118, v152
    v_dot2_f32_bf16 v151, v119, v158, v151
    v_dot2_f32_bf16 v153, v119, v119, v153
    v_dot2_f32_bf16 v150, v120, v158, v150
    v_dot2_f32_bf16 v152, v120, v120, v152
    v_dot2_f32_bf16 v151, v121, v158, v151
    v_dot2_f32_bf16 v153, v121, v121, v153
    v_dot2_f32_bf16 v150, v122, v158, v150
    v_dot2_f32_bf16 v152, v122, v122, v152
    v_dot2_f32_bf16 v151, v123, v158, v151
    v_dot2_f32_bf16 v153, v123, v123, v153
    v_dot2_f32_bf16 v150, v124, v158, v150
    v_dot2_f32_bf16 v152, v124, v124, v152
    v_dot2_f32_bf16 v151, v125, v158, v151
    v_dot2_f32_bf16 v153, v125, v125, v153
    v_dot2_f32_bf16 v150, v126, v158, v150
    v_dot2_f32_bf16 v152, v126, v126, v152
    v_dot2_f32_bf16 v151, v127, v158, v151
    v_dot2_f32_bf16 v153, v127, v127, v153
    s_nop 1
    v_add_f32 v150, v150, v151
    v_add_f32 v152, v152, v153
    v_mov_b32 v157, v150
    s_nop 1
    v_permlane32_swap_b32 v157, v150
    v_add_f32 v150, v157, v150
    v_mov_b32 v157, v150
    s_nop 1
    v_permlane16_swap_b32 v157, v150
    v_add_f32 v150, v157, v150
    v_mov_b32 v157, v152
    s_nop 1
    v_permlane32_swap_b32 v157, v152
    v_add_f32 v152, v157, v152
    v_mov_b32 v157, v152
    s_nop 1
    v_permlane16_swap_b32 v157, v152
    v_add_f32 v152, v157, v152
    v_mul_f32 v150, 0x3b000000, v150
    v_cvt_pk_bf16_f32 v154, v150, v150
    v_and_b32 v154, 0xffff0000, v154
    v_sub_f32 v156, v150, v154
    v_mul_f32 v157, v150, v150
    v_mul_f32 v152, 0x3b000000, v152
    v_sub_f32 v152, v152, v157
    v_max_f32 v152, 0, v152
    v_cvt_pk_bf16_f32 v152, v152, v152
    v_and_b32 v152, 0xffff0000, v152
    v_add_f32 v152, 0x3727c5ac, v152
    v_cvt_pk_bf16_f32 v152, v152, v152
    v_and_b32 v152, 0xffff0000, v152
    v_sqrt_f32 v152, v152
    s_nop 0
    v_cvt_pk_bf16_f32 v152, v152, v152
    v_and_b32 v152, 0xffff0000, v152
    v_rcp_f32 v152, v152
    v_lshlrev_b32 v160, 16, v64
    v_and_b32 v161, 0xffff0000, v64
    v_lshlrev_b32 v162, 16, v65
    v_and_b32 v163, 0xffff0000, v65
    v_lshlrev_b32 v164, 16, v66
    v_and_b32 v165, 0xffff0000, v66
    v_lshlrev_b32 v166, 16, v67
    v_and_b32 v167, 0xffff0000, v67
    v_lshlrev_b32 v168, 16, v68
    v_and_b32 v169, 0xffff0000, v68
    v_lshlrev_b32 v170, 16, v69
    v_and_b32 v171, 0xffff0000, v69
    v_lshlrev_b32 v172, 16, v70
    v_and_b32 v173, 0xffff0000, v70
    v_lshlrev_b32 v174, 16, v71
    v_and_b32 v175, 0xffff0000, v71
    v_pk_add_f32 v[160:161], v[160:161], v[154:155] op_sel_hi:[1,0] neg_lo:[0,1] neg_hi:[0,1]
    v_pk_add_f32 v[162:163], v[162:163], v[154:155] op_sel_hi:[1,0] neg_lo:[0,1] neg_hi:[0,1]
    v_pk_add_f32 v[164:165], v[164:165], v[154:155] op_sel_hi:[1,0] neg_lo:[0,1] neg_hi:[0,1]
    v_pk_add_f32 v[166:167], v[166:167], v[154:155] op_sel_hi:[1,0] neg_lo:[0,1] neg_hi:[0,1]
    v_pk_add_f32 v[168:169], v[168:169], v[154:155] op_sel_hi:[1,0] neg_lo:[0,1] neg_hi:[0,1]
    v_pk_add_f32 v[170:171], v[170:171], v[154:155] op_sel_hi:[1,0] neg_lo:[0,1] neg_hi:[0,1]
    v_pk_add_f32 v[172:173], v[172:173], v[154:155] op_sel_hi:[1,0] neg_lo:[0,1] neg_hi:[0,1]
    v_pk_add_f32 v[174:175], v[174:175], v[154:155] op_sel_hi:[1,0] neg_lo:[0,1] neg_hi:[0,1]
    v_cvt_pk_bf16_f32 v64, v160, v161
    v_cvt_pk_bf16_f32 v65, v162, v163
    v_cvt_pk_bf16_f32 v66, v164, v165
    v_cvt_pk_bf16_f32 v67, v166, v167
    v_cvt_pk_bf16_f32 v68, v168, v169
    v_cvt_pk_bf16_f32 v69, v170, v171
    v_cvt_pk_bf16_f32 v70, v172, v173
    v_cvt_pk_bf16_f32 v71, v174, v175
    v_lshlrev_b32 v160, 16, v64
    v_and_b32 v161, 0xffff0000, v64
    v_lshlrev_b32 v162, 16, v65
    v_and_b32 v163, 0xffff0000, v65
    v_lshlrev_b32 v164, 16, v66
    v_and_b32 v165, 0xffff0000, v66
    v_lshlrev_b32 v166, 16, v67
    v_and_b32 v167, 0xffff0000, v67
    v_lshlrev_b32 v168, 16, v68
    v_and_b32 v169, 0xffff0000, v68
    v_lshlrev_b32 v170, 16, v69
    v_and_b32 v171, 0xffff0000, v69
    v_lshlrev_b32 v172, 16, v70
    v_and_b32 v173, 0xffff0000, v70
    v_lshlrev_b32 v174, 16, v71
    v_and_b32 v175, 0xffff0000, v71
    v_pk_mul_f32 v[160:161], v[160:161], v[152:153] op_sel_hi:[1,0]
    v_pk_mul_f32 v[162:163], v[162:163], v[152:153] op_sel_hi:[1,0]
    v_pk_mul_f32 v[164:165], v[164:165], v[152:153] op_sel_hi:[1,0]
    v_pk_mul_f32 v[166:167], v[166:167], v[152:153] op_sel_hi:[1,0]
    v_pk_mul_f32 v[168:169], v[168:169], v[152:153] op_sel_hi:[1,0]
    v_pk_mul_f32 v[170:171], v[170:171], v[152:153] op_sel_hi:[1,0]
    v_pk_mul_f32 v[172:173], v[172:173], v[152:153] op_sel_hi:[1,0]
    v_pk_mul_f32 v[174:175], v[174:175], v[152:153] op_sel_hi:[1,0]
    v_cvt_pk_bf16_f32 v160, v160, v161
    v_cvt_pk_bf16_f32 v162, v162, v163
    v_cvt_pk_bf16_f32 v164, v164, v165
    v_cvt_pk_bf16_f32 v166, v166, v167
    v_cvt_pk_bf16_f32 v168, v168, v169
    v_cvt_pk_bf16_f32 v170, v170, v171
    v_cvt_pk_bf16_f32 v172, v172, v173
    v_cvt_pk_bf16_f32 v174, v174, v175
    v_accvgpr_write_b32 a64, v160
    v_accvgpr_write_b32 a65, v162
    v_accvgpr_write_b32 a66, v164
    v_accvgpr_write_b32 a67, v166
    v_accvgpr_write_b32 a68, v168
    v_accvgpr_write_b32 a69, v170
    v_accvgpr_write_b32 a70, v172
    v_accvgpr_write_b32 a71, v174
    v_lshlrev_b32 v160, 16, v72
    v_and_b32 v161, 0xffff0000, v72
    v_lshlrev_b32 v162, 16, v73
    v_and_b32 v163, 0xffff0000, v73
    v_lshlrev_b32 v164, 16, v74
    v_and_b32 v165, 0xffff0000, v74
    v_lshlrev_b32 v166, 16, v75
    v_and_b32 v167, 0xffff0000, v75
    v_lshlrev_b32 v168, 16, v76
    v_and_b32 v169, 0xffff0000, v76
    v_lshlrev_b32 v170, 16, v77
    v_and_b32 v171, 0xffff0000, v77
    v_lshlrev_b32 v172, 16, v78
    v_and_b32 v173, 0xffff0000, v78
    v_lshlrev_b32 v174, 16, v79
    v_and_b32 v175, 0xffff0000, v79
    v_pk_add_f32 v[160:161], v[160:161], v[154:155] op_sel_hi:[1,0] neg_lo:[0,1] neg_hi:[0,1]
    v_pk_add_f32 v[162:163], v[162:163], v[154:155] op_sel_hi:[1,0] neg_lo:[0,1] neg_hi:[0,1]
    v_pk_add_f32 v[164:165], v[164:165], v[154:155] op_sel_hi:[1,0] neg_lo:[0,1] neg_hi:[0,1]
    v_pk_add_f32 v[166:167], v[166:167], v[154:155] op_sel_hi:[1,0] neg_lo:[0,1] neg_hi:[0,1]
    v_pk_add_f32 v[168:169], v[168:169], v[154:155] op_sel_hi:[1,0] neg_lo:[0,1] neg_hi:[0,1]
    v_pk_add_f32 v[170:171], v[170:171], v[154:155] op_sel_hi:[1,0] neg_lo:[0,1] neg_hi:[0,1]
    v_pk_add_f32 v[172:173], v[172:173], v[154:155] op_sel_hi:[1,0] neg_lo:[0,1] neg_hi:[0,1]
    v_pk_add_f32 v[174:175], v[174:175], v[154:155] op_sel_hi:[1,0] neg_lo:[0,1] neg_hi:[0,1]
    v_cvt_pk_bf16_f32 v72, v160, v161
    v_cvt_pk_bf16_f32 v73, v162, v163
    v_cvt_pk_bf16_f32 v74, v164, v165
    v_cvt_pk_bf16_f32 v75, v166, v167
    v_cvt_pk_bf16_f32 v76, v168, v169
    v_cvt_pk_bf16_f32 v77, v170, v171
    v_cvt_pk_bf16_f32 v78, v172, v173
    v_cvt_pk_bf16_f32 v79, v174, v175
    v_lshlrev_b32 v160, 16, v72
    v_and_b32 v161, 0xffff0000, v72
    v_lshlrev_b32 v162, 16, v73
    v_and_b32 v163, 0xffff0000, v73
    v_lshlrev_b32 v164, 16, v74
    v_and_b32 v165, 0xffff0000, v74
    v_lshlrev_b32 v166, 16, v75
    v_and_b32 v167, 0xffff0000, v75
    v_lshlrev_b32 v168, 16, v76
    v_and_b32 v169, 0xffff0000, v76
    v_lshlrev_b32 v170, 16, v77
    v_and_b32 v171, 0xffff0000, v77
    v_lshlrev_b32 v172, 16, v78
    v_and_b32 v173, 0xffff0000, v78
    v_lshlrev_b32 v174, 16, v79
    v_and_b32 v175, 0xffff0000, v79
    v_pk_mul_f32 v[160:161], v[160:161], v[152:153] op_sel_hi:[1,0]
    v_pk_mul_f32 v[162:163], v[162:163], v[152:153] op_sel_hi:[1,0]
    v_pk_mul_f32 v[164:165], v[164:165], v[152:153] op_sel_hi:[1,0]
    v_pk_mul_f32 v[166:167], v[166:167], v[152:153] op_sel_hi:[1,0]
    v_pk_mul_f32 v[168:169], v[168:169], v[152:153] op_sel_hi:[1,0]
    v_pk_mul_f32 v[170:171], v[170:171], v[152:153] op_sel_hi:[1,0]
    v_pk_mul_f32 v[172:173], v[172:173], v[152:153] op_sel_hi:[1,0]
    v_pk_mul_f32 v[174:175], v[174:175], v[152:153] op_sel_hi:[1,0]
    v_cvt_pk_bf16_f32 v160, v160, v161
    v_cvt_pk_bf16_f32 v162, v162, v163
    v_cvt_pk_bf16_f32 v164, v164, v165
    v_cvt_pk_bf16_f32 v166, v166, v167
    v_cvt_pk_bf16_f32 v168, v168, v169
    v_cvt_pk_bf16_f32 v170, v170, v171
    v_cvt_pk_bf16_f32 v172, v172, v173
    v_cvt_pk_bf16_f32 v174, v174, v175
    v_accvgpr_write_b32 a72, v160
    v_accvgpr_write_b32 a73, v162
    v_accvgpr_write_b32 a74, v164
    v_accvgpr_write_b32 a75, v166
    v_accvgpr_write_b32 a76, v168
    v_accvgpr_write_b32 a77, v170
    v_accvgpr_write_b32 a78, v172
    v_accvgpr_write_b32 a79, v174
    v_lshlrev_b32 v160, 16, v80
    v_and_b32 v161, 0xffff0000, v80
    v_lshlrev_b32 v162, 16, v81
    v_and_b32 v163, 0xffff0000, v81
    v_lshlrev_b32 v164, 16, v82
    v_and_b32 v165, 0xffff0000, v82
    v_lshlrev_b32 v166, 16, v83
    v_and_b32 v167, 0xffff0000, v83
    v_lshlrev_b32 v168, 16, v84
    v_and_b32 v169, 0xffff0000, v84
    v_lshlrev_b32 v170, 16, v85
    v_and_b32 v171, 0xffff0000, v85
    v_lshlrev_b32 v172, 16, v86
    v_and_b32 v173, 0xffff0000, v86
    v_lshlrev_b32 v174, 16, v87
    v_and_b32 v175, 0xffff0000, v87
    v_pk_add_f32 v[160:161], v[160:161], v[154:155] op_sel_hi:[1,0] neg_lo:[0,1] neg_hi:[0,1]
    v_pk_add_f32 v[162:163], v[162:163], v[154:155] op_sel_hi:[1,0] neg_lo:[0,1] neg_hi:[0,1]
    v_pk_add_f32 v[164:165], v[164:165], v[154:155] op_sel_hi:[1,0] neg_lo:[0,1] neg_hi:[0,1]
    v_pk_add_f32 v[166:167], v[166:167], v[154:155] op_sel_hi:[1,0] neg_lo:[0,1] neg_hi:[0,1]
    v_pk_add_f32 v[168:169], v[168:169], v[154:155] op_sel_hi:[1,0] neg_lo:[0,1] neg_hi:[0,1]
    v_pk_add_f32 v[170:171], v[170:171], v[154:155] op_sel_hi:[1,0] neg_lo:[0,1] neg_hi:[0,1]
    v_pk_add_f32 v[172:173], v[172:173], v[154:155] op_sel_hi:[1,0] neg_lo:[0,1] neg_hi:[0,1]
    v_pk_add_f32 v[174:175], v[174:175], v[154:155] op_sel_hi:[1,0] neg_lo:[0,1] neg_hi:[0,1]
    v_cvt_pk_bf16_f32 v80, v160, v161
    v_cvt_pk_bf16_f32 v81, v162, v163
    v_cvt_pk_bf16_f32 v82, v164, v165
    v_cvt_pk_bf16_f32 v83, v166, v167
    v_cvt_pk_bf16_f32 v84, v168, v169
    v_cvt_pk_bf16_f32 v85, v170, v171
    v_cvt_pk_bf16_f32 v86, v172, v173
    v_cvt_pk_bf16_f32 v87, v174, v175
    v_lshlrev_b32 v160, 16, v80
    v_and_b32 v161, 0xffff0000, v80
    v_lshlrev_b32 v162, 16, v81
    v_and_b32 v163, 0xffff0000, v81
    v_lshlrev_b32 v164, 16, v82
    v_and_b32 v165, 0xffff0000, v82
    v_lshlrev_b32 v166, 16, v83
    v_and_b32 v167, 0xffff0000, v83
    v_lshlrev_b32 v168, 16, v84
    v_and_b32 v169, 0xffff0000, v84
    v_lshlrev_b32 v170, 16, v85
    v_and_b32 v171, 0xffff0000, v85
    v_lshlrev_b32 v172, 16, v86
    v_and_b32 v173, 0xffff0000, v86
    v_lshlrev_b32 v174, 16, v87
    v_and_b32 v175, 0xffff0000, v87
    v_pk_mul_f32 v[160:161], v[160:161], v[152:153] op_sel_hi:[1,0]
    v_pk_mul_f32 v[162:163], v[162:163], v[152:153] op_sel_hi:[1,0]
    v_pk_mul_f32 v[164:165], v[164:165], v[152:153] op_sel_hi:[1,0]
    v_pk_mul_f32 v[166:167], v[166:167], v[152:153] op_sel_hi:[1,0]
    v_pk_mul_f32 v[168:169], v[168:169], v[152:153] op_sel_hi:[1,0]
    v_pk_mul_f32 v[170:171], v[170:171], v[152:153] op_sel_hi:[1,0]
    v_pk_mul_f32 v[172:173], v[172:173], v[152:153] op_sel_hi:[1,0]
    v_pk_mul_f32 v[174:175], v[174:175], v[152:153] op_sel_hi:[1,0]
    v_cvt_pk_bf16_f32 v160, v160, v161
    v_cvt_pk_bf16_f32 v162, v162, v163
    v_cvt_pk_bf16_f32 v164, v164, v165
    v_cvt_pk_bf16_f32 v166, v166, v167
    v_cvt_pk_bf16_f32 v168, v168, v169
    v_cvt_pk_bf16_f32 v170, v170, v171
    v_cvt_pk_bf16_f32 v172, v172, v173
    v_cvt_pk_bf16_f32 v174, v174, v175
    v_accvgpr_write_b32 a80, v160
    v_accvgpr_write_b32 a81, v162
    v_accvgpr_write_b32 a82, v164
    v_accvgpr_write_b32 a83, v166
    v_accvgpr_write_b32 a84, v168
    v_accvgpr_write_b32 a85, v170
    v_accvgpr_write_b32 a86, v172
    v_accvgpr_write_b32 a87, v174
    v_lshlrev_b32 v160, 16, v88
    v_and_b32 v161, 0xffff0000, v88
    v_lshlrev_b32 v162, 16, v89
    v_and_b32 v163, 0xffff0000, v89
    v_lshlrev_b32 v164, 16, v90
    v_and_b32 v165, 0xffff0000, v90
    v_lshlrev_b32 v166, 16, v91
    v_and_b32 v167, 0xffff0000, v91
    v_lshlrev_b32 v168, 16, v92
    v_and_b32 v169, 0xffff0000, v92
    v_lshlrev_b32 v170, 16, v93
    v_and_b32 v171, 0xffff0000, v93
    v_lshlrev_b32 v172, 16, v94
    v_and_b32 v173, 0xffff0000, v94
    v_lshlrev_b32 v174, 16, v95
    v_and_b32 v175, 0xffff0000, v95
    v_pk_add_f32 v[160:161], v[160:161], v[154:155] op_sel_hi:[1,0] neg_lo:[0,1] neg_hi:[0,1]
    v_pk_add_f32 v[162:163], v[162:163], v[154:155] op_sel_hi:[1,0] neg_lo:[0,1] neg_hi:[0,1]
    v_pk_add_f32 v[164:165], v[164:165], v[154:155] op_sel_hi:[1,0] neg_lo:[0,1] neg_hi:[0,1]
    v_pk_add_f32 v[166:167], v[166:167], v[154:155] op_sel_hi:[1,0] neg_lo:[0,1] neg_hi:[0,1]
    v_pk_add_f32 v[168:169], v[168:169], v[154:155] op_sel_hi:[1,0] neg_lo:[0,1] neg_hi:[0,1]
    v_pk_add_f32 v[170:171], v[170:171], v[154:155] op_sel_hi:[1,0] neg_lo:[0,1] neg_hi:[0,1]
    v_pk_add_f32 v[172:173], v[172:173], v[154:155] op_sel_hi:[1,0] neg_lo:[0,1] neg_hi:[0,1]
    v_pk_add_f32 v[174:175], v[174:175], v[154:155] op_sel_hi:[1,0] neg_lo:[0,1] neg_hi:[0,1]
    v_cvt_pk_bf16_f32 v88, v160, v161
    v_cvt_pk_bf16_f32 v89, v162, v163
    v_cvt_pk_bf16_f32 v90, v164, v165
    v_cvt_pk_bf16_f32 v91, v166, v167
    v_cvt_pk_bf16_f32 v92, v168, v169
    v_cvt_pk_bf16_f32 v93, v170, v171
    v_cvt_pk_bf16_f32 v94, v172, v173
    v_cvt_pk_bf16_f32 v95, v174, v175
    v_lshlrev_b32 v160, 16, v88
    v_and_b32 v161, 0xffff0000, v88
    v_lshlrev_b32 v162, 16, v89
    v_and_b32 v163, 0xffff0000, v89
    v_lshlrev_b32 v164, 16, v90
    v_and_b32 v165, 0xffff0000, v90
    v_lshlrev_b32 v166, 16, v91
    v_and_b32 v167, 0xffff0000, v91
    v_lshlrev_b32 v168, 16, v92
    v_and_b32 v169, 0xffff0000, v92
    v_lshlrev_b32 v170, 16, v93
    v_and_b32 v171, 0xffff0000, v93
    v_lshlrev_b32 v172, 16, v94
    v_and_b32 v173, 0xffff0000, v94
    v_lshlrev_b32 v174, 16, v95
    v_and_b32 v175, 0xffff0000, v95
    v_pk_mul_f32 v[160:161], v[160:161], v[152:153] op_sel_hi:[1,0]
    v_pk_mul_f32 v[162:163], v[162:163], v[152:153] op_sel_hi:[1,0]
    v_pk_mul_f32 v[164:165], v[164:165], v[152:153] op_sel_hi:[1,0]
    v_pk_mul_f32 v[166:167], v[166:167], v[152:153] op_sel_hi:[1,0]
    v_pk_mul_f32 v[168:169], v[168:169], v[152:153] op_sel_hi:[1,0]
    v_pk_mul_f32 v[170:171], v[170:171], v[152:153] op_sel_hi:[1,0]
    v_pk_mul_f32 v[172:173], v[172:173], v[152:153] op_sel_hi:[1,0]
    v_pk_mul_f32 v[174:175], v[174:175], v[152:153] op_sel_hi:[1,0]
    v_cvt_pk_bf16_f32 v160, v160, v161
    v_cvt_pk_bf16_f32 v162, v162, v163
    v_cvt_pk_bf16_f32 v164, v164, v165
    v_cvt_pk_bf16_f32 v166, v166, v167
    v_cvt_pk_bf16_f32 v168, v168, v169
    v_cvt_pk_bf16_f32 v170, v170, v171
    v_cvt_pk_bf16_f32 v172, v172, v173
    v_cvt_pk_bf16_f32 v174, v174, v175
    v_accvgpr_write_b32 a88, v160
    v_accvgpr_write_b32 a89, v162
    v_accvgpr_write_b32 a90, v164
    v_accvgpr_write_b32 a91, v166
    v_accvgpr_write_b32 a92, v168
    v_accvgpr_write_b32 a93, v170
    v_accvgpr_write_b32 a94, v172
    v_accvgpr_write_b32 a95, v174
    v_lshlrev_b32 v160, 16, v96
    v_and_b32 v161, 0xffff0000, v96
    v_lshlrev_b32 v162, 16, v97
    v_and_b32 v163, 0xffff0000, v97
    v_lshlrev_b32 v164, 16, v98
    v_and_b32 v165, 0xffff0000, v98
    v_lshlrev_b32 v166, 16, v99
    v_and_b32 v167, 0xffff0000, v99
    v_lshlrev_b32 v168, 16, v100
    v_and_b32 v169, 0xffff0000, v100
    v_lshlrev_b32 v170, 16, v101
    v_and_b32 v171, 0xffff0000, v101
    v_lshlrev_b32 v172, 16, v102
    v_and_b32 v173, 0xffff0000, v102
    v_lshlrev_b32 v174, 16, v103
    v_and_b32 v175, 0xffff0000, v103
    v_pk_add_f32 v[160:161], v[160:161], v[154:155] op_sel_hi:[1,0] neg_lo:[0,1] neg_hi:[0,1]
    v_pk_add_f32 v[162:163], v[162:163], v[154:155] op_sel_hi:[1,0] neg_lo:[0,1] neg_hi:[0,1]
    v_pk_add_f32 v[164:165], v[164:165], v[154:155] op_sel_hi:[1,0] neg_lo:[0,1] neg_hi:[0,1]
    v_pk_add_f32 v[166:167], v[166:167], v[154:155] op_sel_hi:[1,0] neg_lo:[0,1] neg_hi:[0,1]
    v_pk_add_f32 v[168:169], v[168:169], v[154:155] op_sel_hi:[1,0] neg_lo:[0,1] neg_hi:[0,1]
    v_pk_add_f32 v[170:171], v[170:171], v[154:155] op_sel_hi:[1,0] neg_lo:[0,1] neg_hi:[0,1]
    v_pk_add_f32 v[172:173], v[172:173], v[154:155] op_sel_hi:[1,0] neg_lo:[0,1] neg_hi:[0,1]
    v_pk_add_f32 v[174:175], v[174:175], v[154:155] op_sel_hi:[1,0] neg_lo:[0,1] neg_hi:[0,1]
    v_cvt_pk_bf16_f32 v96, v160, v161
    v_cvt_pk_bf16_f32 v97, v162, v163
    v_cvt_pk_bf16_f32 v98, v164, v165
    v_cvt_pk_bf16_f32 v99, v166, v167
    v_cvt_pk_bf16_f32 v100, v168, v169
    v_cvt_pk_bf16_f32 v101, v170, v171
    v_cvt_pk_bf16_f32 v102, v172, v173
    v_cvt_pk_bf16_f32 v103, v174, v175
    v_lshlrev_b32 v160, 16, v96
    v_and_b32 v161, 0xffff0000, v96
    v_lshlrev_b32 v162, 16, v97
    v_and_b32 v163, 0xffff0000, v97
    v_lshlrev_b32 v164, 16, v98
    v_and_b32 v165, 0xffff0000, v98
    v_lshlrev_b32 v166, 16, v99
    v_and_b32 v167, 0xffff0000, v99
    v_lshlrev_b32 v168, 16, v100
    v_and_b32 v169, 0xffff0000, v100
    v_lshlrev_b32 v170, 16, v101
    v_and_b32 v171, 0xffff0000, v101
    v_lshlrev_b32 v172, 16, v102
    v_and_b32 v173, 0xffff0000, v102
    v_lshlrev_b32 v174, 16, v103
    v_and_b32 v175, 0xffff0000, v103
    v_pk_mul_f32 v[160:161], v[160:161], v[152:153] op_sel_hi:[1,0]
    v_pk_mul_f32 v[162:163], v[162:163], v[152:153] op_sel_hi:[1,0]
    v_pk_mul_f32 v[164:165], v[164:165], v[152:153] op_sel_hi:[1,0]
    v_pk_mul_f32 v[166:167], v[166:167], v[152:153] op_sel_hi:[1,0]
    v_pk_mul_f32 v[168:169], v[168:169], v[152:153] op_sel_hi:[1,0]
    v_pk_mul_f32 v[170:171], v[170:171], v[152:153] op_sel_hi:[1,0]
    v_pk_mul_f32 v[172:173], v[172:173], v[152:153] op_sel_hi:[1,0]
    v_pk_mul_f32 v[174:175], v[174:175], v[152:153] op_sel_hi:[1,0]
    v_cvt_pk_bf16_f32 v160, v160, v161
    v_cvt_pk_bf16_f32 v162, v162, v163
    v_cvt_pk_bf16_f32 v164, v164, v165
    v_cvt_pk_bf16_f32 v166, v166, v167
    v_cvt_pk_bf16_f32 v168, v168, v169
    v_cvt_pk_bf16_f32 v170, v170, v171
    v_cvt_pk_bf16_f32 v172, v172, v173
    v_cvt_pk_bf16_f32 v174, v174, v175
    v_accvgpr_write_b32 a96, v160
    v_accvgpr_write_b32 a97, v162
    v_accvgpr_write_b32 a98, v164
    v_accvgpr_write_b32 a99, v166
    v_accvgpr_write_b32 a100, v168
    v_accvgpr_write_b32 a101, v170
    v_accvgpr_write_b32 a102, v172
    v_accvgpr_write_b32 a103, v174
    v_lshlrev_b32 v160, 16, v104
    v_and_b32 v161, 0xffff0000, v104
    v_lshlrev_b32 v162, 16, v105
    v_and_b32 v163, 0xffff0000, v105
    v_lshlrev_b32 v164, 16, v106
    v_and_b32 v165, 0xffff0000, v106
    v_lshlrev_b32 v166, 16, v107
    v_and_b32 v167, 0xffff0000, v107
    v_lshlrev_b32 v168, 16, v108
    v_and_b32 v169, 0xffff0000, v108
    v_lshlrev_b32 v170, 16, v109
    v_and_b32 v171, 0xffff0000, v109
    v_lshlrev_b32 v172, 16, v110
    v_and_b32 v173, 0xffff0000, v110
    v_lshlrev_b32 v174, 16, v111
    v_and_b32 v175, 0xffff0000, v111
    v_pk_add_f32 v[160:161], v[160:161], v[154:155] op_sel_hi:[1,0] neg_lo:[0,1] neg_hi:[0,1]
    v_pk_add_f32 v[162:163], v[162:163], v[154:155] op_sel_hi:[1,0] neg_lo:[0,1] neg_hi:[0,1]
    v_pk_add_f32 v[164:165], v[164:165], v[154:155] op_sel_hi:[1,0] neg_lo:[0,1] neg_hi:[0,1]
    v_pk_add_f32 v[166:167], v[166:167], v[154:155] op_sel_hi:[1,0] neg_lo:[0,1] neg_hi:[0,1]
    v_pk_add_f32 v[168:169], v[168:169], v[154:155] op_sel_hi:[1,0] neg_lo:[0,1] neg_hi:[0,1]
    v_pk_add_f32 v[170:171], v[170:171], v[154:155] op_sel_hi:[1,0] neg_lo:[0,1] neg_hi:[0,1]
    v_pk_add_f32 v[172:173], v[172:173], v[154:155] op_sel_hi:[1,0] neg_lo:[0,1] neg_hi:[0,1]
    v_pk_add_f32 v[174:175], v[174:175], v[154:155] op_sel_hi:[1,0] neg_lo:[0,1] neg_hi:[0,1]
    v_cvt_pk_bf16_f32 v104, v160, v161
    v_cvt_pk_bf16_f32 v105, v162, v163
    v_cvt_pk_bf16_f32 v106, v164, v165
    v_cvt_pk_bf16_f32 v107, v166, v167
    v_cvt_pk_bf16_f32 v108, v168, v169
    v_cvt_pk_bf16_f32 v109, v170, v171
    v_cvt_pk_bf16_f32 v110, v172, v173
    v_cvt_pk_bf16_f32 v111, v174, v175
    v_lshlrev_b32 v160, 16, v104
    v_and_b32 v161, 0xffff0000, v104
    v_lshlrev_b32 v162, 16, v105
    v_and_b32 v163, 0xffff0000, v105
    v_lshlrev_b32 v164, 16, v106
    v_and_b32 v165, 0xffff0000, v106
    v_lshlrev_b32 v166, 16, v107
    v_and_b32 v167, 0xffff0000, v107
    v_lshlrev_b32 v168, 16, v108
    v_and_b32 v169, 0xffff0000, v108
    v_lshlrev_b32 v170, 16, v109
    v_and_b32 v171, 0xffff0000, v109
    v_lshlrev_b32 v172, 16, v110
    v_and_b32 v173, 0xffff0000, v110
    v_lshlrev_b32 v174, 16, v111
    v_and_b32 v175, 0xffff0000, v111
    v_pk_mul_f32 v[160:161], v[160:161], v[152:153] op_sel_hi:[1,0]
    v_pk_mul_f32 v[162:163], v[162:163], v[152:153] op_sel_hi:[1,0]
    v_pk_mul_f32 v[164:165], v[164:165], v[152:153] op_sel_hi:[1,0]
    v_pk_mul_f32 v[166:167], v[166:167], v[152:153] op_sel_hi:[1,0]
    v_pk_mul_f32 v[168:169], v[168:169], v[152:153] op_sel_hi:[1,0]
    v_pk_mul_f32 v[170:171], v[170:171], v[152:153] op_sel_hi:[1,0]
    v_pk_mul_f32 v[172:173], v[172:173], v[152:153] op_sel_hi:[1,0]
    v_pk_mul_f32 v[174:175], v[174:175], v[152:153] op_sel_hi:[1,0]
    v_cvt_pk_bf16_f32 v160, v160, v161
    v_cvt_pk_bf16_f32 v162, v162, v163
    v_cvt_pk_bf16_f32 v164, v164, v165
    v_cvt_pk_bf16_f32 v166, v166, v167
    v_cvt_pk_bf16_f32 v168, v168, v169
    v_cvt_pk_bf16_f32 v170, v170, v171
    v_cvt_pk_bf16_f32 v172, v172, v173
    v_cvt_pk_bf16_f32 v174, v174, v175
    v_accvgpr_write_b32 a104, v160
    v_accvgpr_write_b32 a105, v162
    v_accvgpr_write_b32 a106, v164
    v_accvgpr_write_b32 a107, v166
    v_accvgpr_write_b32 a108, v168
    v_accvgpr_write_b32 a109, v170
    v_accvgpr_write_b32 a110, v172
    v_accvgpr_write_b32 a111, v174
    v_lshlrev_b32 v160, 16, v112
    v_and_b32 v161, 0xffff0000, v112
    v_lshlrev_b32 v162, 16, v113
    v_and_b32 v163, 0xffff0000, v113
    v_lshlrev_b32 v164, 16, v114
    v_and_b32 v165, 0xffff0000, v114
    v_lshlrev_b32 v166, 16, v115
    v_and_b32 v167, 0xffff0000, v115
    v_lshlrev_b32 v168, 16, v116
    v_and_b32 v169, 0xffff0000, v116
    v_lshlrev_b32 v170, 16, v117
    v_and_b32 v171, 0xffff0000, v117
    v_lshlrev_b32 v172, 16, v118
    v_and_b32 v173, 0xffff0000, v118
    v_lshlrev_b32 v174, 16, v119
    v_and_b32 v175, 0xffff0000, v119
    v_pk_add_f32 v[160:161], v[160:161], v[154:155] op_sel_hi:[1,0] neg_lo:[0,1] neg_hi:[0,1]
    v_pk_add_f32 v[162:163], v[162:163], v[154:155] op_sel_hi:[1,0] neg_lo:[0,1] neg_hi:[0,1]
    v_pk_add_f32 v[164:165], v[164:165], v[154:155] op_sel_hi:[1,0] neg_lo:[0,1] neg_hi:[0,1]
    v_pk_add_f32 v[166:167], v[166:167], v[154:155] op_sel_hi:[1,0] neg_lo:[0,1] neg_hi:[0,1]
    v_pk_add_f32 v[168:169], v[168:169], v[154:155] op_sel_hi:[1,0] neg_lo:[0,1] neg_hi:[0,1]
    v_pk_add_f32 v[170:171], v[170:171], v[154:155] op_sel_hi:[1,0] neg_lo:[0,1] neg_hi:[0,1]
    v_pk_add_f32 v[172:173], v[172:173], v[154:155] op_sel_hi:[1,0] neg_lo:[0,1] neg_hi:[0,1]
    v_pk_add_f32 v[174:175], v[174:175], v[154:155] op_sel_hi:[1,0] neg_lo:[0,1] neg_hi:[0,1]
    v_cvt_pk_bf16_f32 v112, v160, v161
    v_cvt_pk_bf16_f32 v113, v162, v163
    v_cvt_pk_bf16_f32 v114, v164, v165
    v_cvt_pk_bf16_f32 v115, v166, v167
    v_cvt_pk_bf16_f32 v116, v168, v169
    v_cvt_pk_bf16_f32 v117, v170, v171
    v_cvt_pk_bf16_f32 v118, v172, v173
    v_cvt_pk_bf16_f32 v119, v174, v175
    v_lshlrev_b32 v160, 16, v112
    v_and_b32 v161, 0xffff0000, v112
    v_lshlrev_b32 v162, 16, v113
    v_and_b32 v163, 0xffff0000, v113
    v_lshlrev_b32 v164, 16, v114
    v_and_b32 v165, 0xffff0000, v114
    v_lshlrev_b32 v166, 16, v115
    v_and_b32 v167, 0xffff0000, v115
    v_lshlrev_b32 v168, 16, v116
    v_and_b32 v169, 0xffff0000, v116
    v_lshlrev_b32 v170, 16, v117
    v_and_b32 v171, 0xffff0000, v117
    v_lshlrev_b32 v172, 16, v118
    v_and_b32 v173, 0xffff0000, v118
    v_lshlrev_b32 v174, 16, v119
    v_and_b32 v175, 0xffff0000, v119
    v_pk_mul_f32 v[160:161], v[160:161], v[152:153] op_sel_hi:[1,0]
    v_pk_mul_f32 v[162:163], v[162:163], v[152:153] op_sel_hi:[1,0]
    v_pk_mul_f32 v[164:165], v[164:165], v[152:153] op_sel_hi:[1,0]
    v_pk_mul_f32 v[166:167], v[166:167], v[152:153] op_sel_hi:[1,0]
    v_pk_mul_f32 v[168:169], v[168:169], v[152:153] op_sel_hi:[1,0]
    v_pk_mul_f32 v[170:171], v[170:171], v[152:153] op_sel_hi:[1,0]
    v_pk_mul_f32 v[172:173], v[172:173], v[152:153] op_sel_hi:[1,0]
    v_pk_mul_f32 v[174:175], v[174:175], v[152:153] op_sel_hi:[1,0]
    v_cvt_pk_bf16_f32 v160, v160, v161
    v_cvt_pk_bf16_f32 v162, v162, v163
    v_cvt_pk_bf16_f32 v164, v164, v165
    v_cvt_pk_bf16_f32 v166, v166, v167
    v_cvt_pk_bf16_f32 v168, v168, v169
    v_cvt_pk_bf16_f32 v170, v170, v171
    v_cvt_pk_bf16_f32 v172, v172, v173
    v_cvt_pk_bf16_f32 v174, v174, v175
    v_accvgpr_write_b32 a112, v160
    v_accvgpr_write_b32 a113, v162
    v_accvgpr_write_b32 a114, v164
    v_accvgpr_write_b32 a115, v166
    v_accvgpr_write_b32 a116, v168
    v_accvgpr_write_b32 a117, v170
    v_accvgpr_write_b32 a118, v172
    v_accvgpr_write_b32 a119, v174
    v_lshlrev_b32 v160, 16, v120
    v_and_b32 v161, 0xffff0000, v120
    v_lshlrev_b32 v162, 16, v121
    v_and_b32 v163, 0xffff0000, v121
    v_lshlrev_b32 v164, 16, v122
    v_and_b32 v165, 0xffff0000, v122
    v_lshlrev_b32 v166, 16, v123
    v_and_b32 v167, 0xffff0000, v123
    v_lshlrev_b32 v168, 16, v124
    v_and_b32 v169, 0xffff0000, v124
    v_lshlrev_b32 v170, 16, v125
    v_and_b32 v171, 0xffff0000, v125
    v_lshlrev_b32 v172, 16, v126
    v_and_b32 v173, 0xffff0000, v126
    v_lshlrev_b32 v174, 16, v127
    v_and_b32 v175, 0xffff0000, v127
    v_pk_add_f32 v[160:161], v[160:161], v[154:155] op_sel_hi:[1,0] neg_lo:[0,1] neg_hi:[0,1]
    v_pk_add_f32 v[162:163], v[162:163], v[154:155] op_sel_hi:[1,0] neg_lo:[0,1] neg_hi:[0,1]
    v_pk_add_f32 v[164:165], v[164:165], v[154:155] op_sel_hi:[1,0] neg_lo:[0,1] neg_hi:[0,1]
    v_pk_add_f32 v[166:167], v[166:167], v[154:155] op_sel_hi:[1,0] neg_lo:[0,1] neg_hi:[0,1]
    v_pk_add_f32 v[168:169], v[168:169], v[154:155] op_sel_hi:[1,0] neg_lo:[0,1] neg_hi:[0,1]
    v_pk_add_f32 v[170:171], v[170:171], v[154:155] op_sel_hi:[1,0] neg_lo:[0,1] neg_hi:[0,1]
    v_pk_add_f32 v[172:173], v[172:173], v[154:155] op_sel_hi:[1,0] neg_lo:[0,1] neg_hi:[0,1]
    v_pk_add_f32 v[174:175], v[174:175], v[154:155] op_sel_hi:[1,0] neg_lo:[0,1] neg_hi:[0,1]
    v_cvt_pk_bf16_f32 v120, v160, v161
    v_cvt_pk_bf16_f32 v121, v162, v163
    v_cvt_pk_bf16_f32 v122, v164, v165
    v_cvt_pk_bf16_f32 v123, v166, v167
    v_cvt_pk_bf16_f32 v124, v168, v169
    v_cvt_pk_bf16_f32 v125, v170, v171
    v_cvt_pk_bf16_f32 v126, v172, v173
    v_cvt_pk_bf16_f32 v127, v174, v175
    v_lshlrev_b32 v160, 16, v120
    v_and_b32 v161, 0xffff0000, v120
    v_lshlrev_b32 v162, 16, v121
    v_and_b32 v163, 0xffff0000, v121
    v_lshlrev_b32 v164, 16, v122
    v_and_b32 v165, 0xffff0000, v122
    v_lshlrev_b32 v166, 16, v123
    v_and_b32 v167, 0xffff0000, v123
    v_lshlrev_b32 v168, 16, v124
    v_and_b32 v169, 0xffff0000, v124
    v_lshlrev_b32 v170, 16, v125
    v_and_b32 v171, 0xffff0000, v125
    v_lshlrev_b32 v172, 16, v126
    v_and_b32 v173, 0xffff0000, v126
    v_lshlrev_b32 v174, 16, v127
    v_and_b32 v175, 0xffff0000, v127
    v_pk_mul_f32 v[160:161], v[160:161], v[152:153] op_sel_hi:[1,0]
    v_pk_mul_f32 v[162:163], v[162:163], v[152:153] op_sel_hi:[1,0]
    v_pk_mul_f32 v[164:165], v[164:165], v[152:153] op_sel_hi:[1,0]
    v_pk_mul_f32 v[166:167], v[166:167], v[152:153] op_sel_hi:[1,0]
    v_pk_mul_f32 v[168:169], v[168:169], v[152:153] op_sel_hi:[1,0]
    v_pk_mul_f32 v[170:171], v[170:171], v[152:153] op_sel_hi:[1,0]
    v_pk_mul_f32 v[172:173], v[172:173], v[152:153] op_sel_hi:[1,0]
    v_pk_mul_f32 v[174:175], v[174:175], v[152:153] op_sel_hi:[1,0]
    v_cvt_pk_bf16_f32 v160, v160, v161
    v_cvt_pk_bf16_f32 v162, v162, v163
    v_cvt_pk_bf16_f32 v164, v164, v165
    v_cvt_pk_bf16_f32 v166, v166, v167
    v_cvt_pk_bf16_f32 v168, v168, v169
    v_cvt_pk_bf16_f32 v170, v170, v171
    v_cvt_pk_bf16_f32 v172, v172, v173
    v_cvt_pk_bf16_f32 v174, v174, v175
    v_accvgpr_write_b32 a120, v160
    v_accvgpr_write_b32 a121, v162
    v_accvgpr_write_b32 a122, v164
    v_accvgpr_write_b32 a123, v166
    v_accvgpr_write_b32 a124, v168
    v_accvgpr_write_b32 a125, v170
    v_accvgpr_write_b32 a126, v172
    v_accvgpr_write_b32 a127, v174
    s_nop 4
L_p1_unit:
    s_cmp_ge_u32 s38, 96
    s_cbranch_scc1 L_p1_end
    s_lshr_b32 s26, s38, 5
    s_add_u32 s27, s26, 1
    s_lshl_b32 s25, s27, 24
    s_lshl_b32 s27, s20, 2
    s_add_u32 s27, s27, s21
    s_lshl_b32 s27, s27, 5
    s_and_b32 s28, s38, 31
    s_add_u32 s27, s27, s28
    s_lshl_b32 s27, s27, 13
    s_add_u32 s25, s25, s27
    s_lshr_b32 s26, s38, 5
    s_cmp_eq_u32 s26, 1
    s_cbranch_scc1 L_p1_v
    s_waitcnt vmcnt(16)
    s_barrier
    ds_read_b64_tr_b16 v[64:65], v128
    ds_read_b64_tr_b16 v[66:67], v128 offset:1024
    ds_read_b64_tr_b16 v[68:69], v129
    ds_read_b64_tr_b16 v[70:71], v129 offset:1024
    ds_read_b64_tr_b16 v[72:73], v130
    ds_read_b64_tr_b16 v[74:75], v130 offset:1024
    ds_read_b64_tr_b16 v[76:77], v131
    ds_read_b64_tr_b16 v[78:79], v131 offset:1024
    ds_read_b64_tr_b16 v[80:81], v132
    ds_read_b64_tr_b16 v[82:83], v132 offset:1024
    ds_read_b64_tr_b16 v[84:85], v133
    ds_read_b64_tr_b16 v[86:87], v133 offset:1024
    ds_read_b64_tr_b16 v[88:89], v134
    ds_read_b64_tr_b16 v[90:91], v134 offset:1024
    s_waitcnt lgkmcnt(12)
    v_mfma_f32_16x16x32_bf16 v[0:3], v[64:67], a[0:3], 0
    ds_read_b64_tr_b16 v[92:93], v135
    v_mfma_f32_16x16x32_bf16 v[4:7], v[64:67], a[64:67], 0
    ds_read_b64_tr_b16 v[94:95], v135 offset:1024
    s_add_u32 s26, s24, 0x300000
    s_add_u32 m0, s29, 0x18000
    s_nop 0
    buffer_load_dwordx4 v136, s[16:19], s26 offen lds
    s_waitcnt lgkmcnt(12)
    v_mfma_f32_16x16x32_bf16 v[8:11], v[68:71], a[0:3], 0
    ds_read_b64_tr_b16 v[96:97], v128 offset:8192
    v_mfma_f32_16x16x32_bf16 v[12:15], v[68:71], a[64:67], 0
    ds_read_b64_tr_b16 v[98:99], v128 offset:9216
    s_add_u32 s26, s24, 0x320000
    s_add_u32 m0, s29, 0x19000
    s_nop 0
    buffer_load_dwordx4 v136, s[16:19], s26 offen lds
    s_waitcnt lgkmcnt(12)
    v_mfma_f32_16x16x32_bf16 v[16:19], v[72:75], a[0:3], 0
    ds_read_b64_tr_b16 v[100:101], v129 offset:8192
    v_mfma_f32_16x16x32_bf16 v[20:23], v[72:75], a[64:67], 0
    ds_read_b64_tr_b16 v[102:103], v129 offset:9216
    s_add_u32 s26, s24, 0x340000
    s_add_u32 m0, s29, 0x1a000
    s_nop 0
    buffer_load_dwordx4 v136, s[16:19], s26 offen lds
    s_waitcnt lgkmcnt(12)
    v_mfma_f32_16x16x32_bf16 v[24:27], v[76:79], a[0:3], 0
    ds_read_b64_tr_b16 v[104:105], v130 offset:8192
    v_mfma_f32_16x16x32_bf16 v[28:31], v[76:79], a[64:67], 0
    ds_read_b64_tr_b16 v[106:107], v130 offset:9216
    s_add_u32 s26, s24, 0x360000
    s_add_u32 m0, s29, 0x1b000
    s_nop 0
    buffer_load_dwordx4 v136, s[16:19], s26 offen lds
    s_waitcnt lgkmcnt(12)
    v_mfma_f32_16x16x32_bf16 v[32:35], v[80:83], a[0:3], 0
    ds_read_b64_tr_b16 v[108:109], v131 offset:8192
    v_mfma_f32_16x16x32_bf16 v[36:39], v[80:83], a[64:67], 0
    ds_read_b64_tr_b16 v[110:111], v131 offset:9216
    s_add_u32 s26, s24, 0x380000
    s_add_u32 m0, s29, 0x1c000
    s_nop 0
    buffer_load_dwordx4 v136, s[16:19], s26 offen lds
    s_waitcnt lgkmcnt(12)
    v_mfma_f32_16x16x32_bf16 v[40:43], v[84:87], a[0:3], 0
    ds_read_b64_tr_b16 v[112:113], v132 offset:8192
    v_mfma_f32_16x16x32_bf16 v[44:47], v[84:87], a[64:67], 0
    ds_read_b64_tr_b16 v[114:115], v132 offset:9216
    s_add_u32 s26, s24, 0x3a0000
    s_add_u32 m0, s29, 0x1d000
    s_nop 0
    buffer_load_dwordx4 v136, s[16:19], s26 offen lds
    s_waitcnt lgkmcnt(12)
    v_mfma_f32_16x16x32_bf16 v[48:51], v[88:91], a[0:3], 0
    ds_read_b64_tr_b16 v[116:117], v133 offset:8192
    v_mfma_f32_16x16x32_bf16 v[52:55], v[88:91], a[64:67], 0
    ds_read_b64_tr_b16 v[118:119], v133 offset:9216
    s_add_u32 s26, s24, 0x3c0000
    s_add_u32 m0, s29, 0x1e000
    s_nop 0
    buffer_load_dwordx4 v136, s[16:19], s26 offen lds
    s_waitcnt lgkmcnt(12)
    v_mfma_f32_16x16x32_bf16 v[56:59], v[92:95], a[0:3], 0
    ds_read_b64_tr_b16 v[120:121], v134 offset:8192
    v_mfma_f32_16x16x32_bf16 v[60:63], v[92:95], a[64:67], 0
    ds_read_b64_tr_b16 v[122:123], v134 offset:9216
    s_add_u32 s26, s24, 0x3e0000
    s_add_u32 m0, s29, 0x1f000
    s_nop 0
    buffer_load_dwordx4 v136, s[16:19], s26 offen lds
    s_waitcnt lgkmcnt(12)
    v_mfma_f32_16x16x32_bf16 v[0:3], v[96:99], a[4:7], v[0:3]
    ds_read_b64_tr_b16 v[124:125], v135 offset:8192
    v_mfma_f32_16x16x32_bf16 v[4:7], v[96:99], a[68:71], v[4:7]
    ds_read_b64_tr_b16 v[126:127], v135 offset:9216
    s_waitcnt lgkmcnt(12)
    v_mfma_f32_16x16x32_bf16 v[8:11], v[100:103], a[4:7], v[8:11]
    ds_read_b64_tr_b16 v[64:65], v128 offset:16384
    v_mfma_f32_16x16x32_bf16 v[12:15], v[100:103], a[68:71], v[12:15]
    ds_read_b64_tr_b16 v[66:67], v128 offset:17408
    s_waitcnt lgkmcnt(12)
    v_mfma_f32_16x16x32_bf16 v[16:19], v[104:107], a[4:7], v[16:19]
    ds_read_b64_tr_b16 v[68:69], v129 offset:16384
    v_mfma_f32_16x16x32_bf16 v[20:23], v[104:107], a[68:71], v[20:23]
    ds_read_b64_tr_b16 v[70:71], v129 offset:17408
    s_waitcnt lgkmcnt(12)
    v_mfma_f32_16x16x32_bf16 v[24:27], v[108:111], a[4:7], v[24:27]
    ds_read_b64_tr_b16 v[72:73], v130 offset:16384
    v_mfma_f32_16x16x32_bf16 v[28:31], v[108:111], a[68:71], v[28:31]
    ds_read_b64_tr_b16 v[74:75], v130 offset:17408
    s_waitcnt lgkmcnt(12)
    v_mfma_f32_16x16x32_bf16 v[32:35], v[112:115], a[4:7], v[32:35]
    ds_read_b64_tr_b16 v[76:77], v131 offset:16384
    v_mfma_f32_16x16x32_bf16 v[36:39], v[112:115], a[68:71], v[36:39]
    ds_read_b64_tr_b16 v[78:79], v131 offset:17408
    s_waitcnt lgkmcnt(12)
    v_mfma_f32_16x16x32_bf16 v[40:43], v[116:119], a[4:7], v[40:43]
    ds_read_b64_tr_b16 v[80:81], v132 offset:16384
    v_mfma_f32_16x16x32_bf16 v[44:47], v[116:119], a[68:71], v[44:47]
    ds_read_b64_tr_b16 v[82:83], v132 offset:17408
    s_waitcnt lgkmcnt(12)
    v_mfma_f32_16x16x32_bf16 v[48:51], v[120:123], a[4:7], v[48:51]
    ds_read_b64_tr_b16 v[84:85], v133 offset:16384
    v_mfma_f32_16x16x32_bf16 v[52:55], v[120:123], a[68:71], v[52:55]
    ds_read_b64_tr_b16 v[86:87], v133 offset:17408
    s_waitcnt lgkmcnt(12)
    v_mfma_f32_16x16x32_bf16 v[56:59], v[124:127], a[4:7], v[56:59]
    ds_read_b64_tr_b16 v[88:89], v134 offset:16384
    v_mfma_f32_16x16x32_bf16 v[60:63], v[124:127], a[68:71], v[60:63]
    ds_read_b64_tr_b16 v[90:91], v134 offset:17408
    s_waitcnt lgkmcnt(12)
    v_mfma_f32_16x16x32_bf16 v[0:3], v[64:67], a[8:11], v[0:3]
    ds_read_b64_tr_b16 v[92:93], v135 offset:16384
    v_mfma_f32_16x16x32_bf16 v[4:7], v[64:67], a[72:75], v[4:7]
    ds_read_b64_tr_b16 v[94:95], v135 offset:17408
    s_waitcnt lgkmcnt(12)
    v_mfma_f32_16x16x32_bf16 v[8:11], v[68:71], a[8:11], v[8:11]
    ds_read_b64_tr_b16 v[96:97], v128 offset:24576
    v_mfma_f32_16x16x32_bf16 v[12:15], v[68:71], a[72:75], v[12:15]
    ds_read_b64_tr_b16 v[98:99], v128 offset:25600
    s_waitcnt lgkmcnt(12)
    v_mfma_f32_16x16x32_bf16 v[16:19], v[72:75], a[8:11], v[16:19]
    ds_read_b64_tr_b16 v[100:101], v129 offset:24576
    v_mfma_f32_16x16x32_bf16 v[20:23], v[72:75], a[72:75], v[20:23]
    ds_read_b64_tr_b16 v[102:103], v129 offset:25600
    s_waitcnt lgkmcnt(12)
    v_mfma_f32_16x16x32_bf16 v[24:27], v[76:79], a[8:11], v[24:27]
    ds_read_b64_tr_b16 v[104:105], v130 offset:24576
    v_mfma_f32_16x16x32_bf16 v[28:31], v[76:79], a[72:75], v[28:31]
    ds_read_b64_tr_b16 v[106:107], v130 offset:25600
    s_waitcnt lgkmcnt(12)
    v_mfma_f32_16x16x32_bf16 v[32:35], v[80:83], a[8:11], v[32:35]
    ds_read_b64_tr_b16 v[108:109], v131 offset:24576
    v_mfma_f32_16x16x32_bf16 v[36:39], v[80:83], a[72:75], v[36:39]
    ds_read_b64_tr_b16 v[110:111], v131 offset:25600
    s_waitcnt lgkmcnt(12)
    v_mfma_f32_16x16x32_bf16 v[40:43], v[84:87], a[8:11], v[40:43]
    ds_read_b64_tr_b16 v[112:113], v132 offset:24576
    v_mfma_f32_16x16x32_bf16 v[44:47], v[84:87], a[72:75], v[44:47]
    ds_read_b64_tr_b16 v[114:115], v132 offset:25600
    s_waitcnt lgkmcnt(12)
    v_mfma_f32_16x16x32_bf16 v[48:51], v[88:91], a[8:11], v[48:51]
    ds_read_b64_tr_b16 v[116:117], v133 offset:24576
    v_mfma_f32_16x16x32_bf16 v[52:55], v[88:91], a[72:75], v[52:55]
    ds_read_b64_tr_b16 v[118:119], v133 offset:25600
    s_waitcnt lgkmcnt(12)
    v_mfma_f32_16x16x32_bf16 v[56:59], v[92:95], a[8:11], v[56:59]
    ds_read_b64_tr_b16 v[120:121], v134 offset:24576
    v_mfma_f32_16x16x32_bf16 v[60:63], v[92:95], a[72:75], v[60:63]
    ds_read_b64_tr_b16 v[122:123], v134 offset:25600
    s_waitcnt lgkmcnt(12)
    v_mfma_f32_16x16x32_bf16 v[0:3], v[96:99], a[12:15], v[0:3]
    ds_read_b64_tr_b16 v[124:125], v135 offset:24576
    v_mfma_f32_16x16x32_bf16 v[4:7], v[96:99], a[76:79], v[4:7]
    ds_read_b64_tr_b16 v[126:127], v135 offset:25600
    s_waitcnt lgkmcnt(12)
    v_mfma_f32_16x16x32_bf16 v[8:11], v[100:103], a[12:15], v[8:11]
    v_mfma_f32_16x16x32_bf16 v[12:15], v[100:103], a[76:79], v[12:15]
    s_waitcnt lgkmcnt(10)
    v_mfma_f32_16x16x32_bf16 v[16:19], v[104:107], a[12:15], v[16:19]
    v_mfma_f32_16x16x32_bf16 v[20:23], v[104:107], a[76:79], v[20:23]
    s_waitcnt lgkmcnt(8)
    v_mfma_f32_16x16x32_bf16 v[24:27], v[108:111], a[12:15], v[24:27]
    v_mfma_f32_16x16x32_bf16 v[28:31], v[108:111], a[76:79], v[28:31]
    s_waitcnt lgkmcnt(6)
    v_mfma_f32_16x16x32_bf16 v[32:35], v[112:115], a[12:15], v[32:35]
    v_mfma_f32_16x16x32_bf16 v[36:39], v[112:115], a[76:79], v[36:39]
    s_waitcnt lgkmcnt(4)
    v_mfma_f32_16x16x32_bf16 v[40:43], v[116:119], a[12:15], v[40:43]
    v_mfma_f32_16x16x32_bf16 v[44:47], v[116:119], a[76:79], v[44:47]
    s_waitcnt lgkmcnt(2)
    v_mfma_f32_16x16x32_bf16 v[48:51], v[120:123], a[12:15], v[48:51]
    v_mfma_f32_16x16x32_bf16 v[52:55], v[120:123], a[76:79], v[52:55]
    s_waitcnt lgkmcnt(0)
    v_mfma_f32_16x16x32_bf16 v[56:59], v[124:127], a[12:15], v[56:59]
    v_mfma_f32_16x16x32_bf16 v[60:63], v[124:127], a[76:79], v[60:63]
    s_waitcnt vmcnt(16)
    s_barrier
    ds_read_b64_tr_b16 v[64:65], v128 offset:32768
    ds_read_b64_tr_b16 v[66:67], v128 offset:33792
    ds_read_b64_tr_b16 v[68:69], v129 offset:32768
    ds_read_b64_tr_b16 v[70:71], v129 offset:33792
    ds_read_b64_tr_b16 v[72:73], v130 offset:32768
    ds_read_b64_tr_b16 v[74:75], v130 offset:33792
    ds_read_b64_tr_b16 v[76:77], v131 offset:32768
    ds_read_b64_tr_b16 v[78:79], v131 offset:33792
    ds_read_b64_tr_b16 v[80:81], v132 offset:32768
    ds_read_b64_tr_b16 v[82:83], v132 offset:33792
    ds_read_b64_tr_b16 v[84:85], v133 offset:32768
    ds_read_b64_tr_b16 v[86:87], v133 offset:33792
    ds_read_b64_tr_b16 v[88:89], v134 offset:32768
    ds_read_b64_tr_b16 v[90:91], v134 offset:33792
    s_add_u32 s39, s39, s37
    s_lshr_b32 s26, s39, 5
    s_cmp_eq_u32 s26, 0
    s_cselect_b64 s[16:17], s[30:31], s[34:35]
    s_cmp_eq_u32 s26, 1
    s_cselect_b64 s[16:17], s[32:33], s[16:17]
    s_and_b32 s17, s17, 0xffff
    s_cmp_lt_u32 s39, 96
    s_cselect_b32 s18, 0x400000, 0
    s_and_b32 s24, s39, 31
    s_lshl_b32 s24, s24, 8
    s_waitcnt lgkmcnt(12)
    v_mfma_f32_16x16x32_bf16 v[0:3], v[64:67], a[16:19], v[0:3]
    ds_read_b64_tr_b16 v[92:93], v135 offset:32768
    v_mfma_f32_16x16x32_bf16 v[4:7], v[64:67], a[80:83], v[4:7]
    ds_read_b64_tr_b16 v[94:95], v135 offset:33792
    s_add_u32 s26, s24, 0x0
    s_add_u32 m0, s29, 0x0
    s_nop 0
    buffer_load_dwordx4 v136, s[16:19], s26 offen lds
    s_waitcnt lgkmcnt(12)
    v_mfma_f32_16x16x32_bf16 v[8:11], v[68:71], a[16:19], v[8:11]
    ds_read_b64_tr_b16 v[96:97], v128 offset:40960
    v_mfma_f32_16x16x32_bf16 v[12:15], v[68:71], a[80:83], v[12:15]
    ds_read_b64_tr_b16 v[98:99], v128 offset:41984
    s_add_u32 s26, s24, 0x20000
    s_add_u32 m0, s29, 0x1000
    s_nop 0
    buffer_load_dwordx4 v136, s[16:19], s26 offen lds
    s_waitcnt lgkmcnt(12)
    v_mfma_f32_16x16x32_bf16 v[16:19], v[72:75], a[16:19], v[16:19]
    ds_read_b64_tr_b16 v[100:101], v129 offset:40960
    v_mfma_f32_16x16x32_bf16 v[20:23], v[72:75], a[80:83], v[20:23]
    ds_read_b64_tr_b16 v[102:103], v129 offset:41984
    s_add_u32 s26, s24, 0x40000
    s_add_u32 m0, s29, 0x2000
    s_nop 0
    buffer_load_dwordx4 v136, s[16:19], s26 offen lds
    s_waitcnt lgkmcnt(12)
    v_mfma_f32_16x16x32_bf16 v[24:27], v[76:79], a[16:19], v[24:27]
    ds_read_b64_tr_b16 v[104:105], v130 offset:40960
    v_mfma_f32_16x16x32_bf16 v[28:31], v[76:79], a[80:83], v[28:31]
    ds_read_b64_tr_b16 v[106:107], v130 offset:41984
    s_add_u32 s26, s24, 0x60000
    s_add_u32 m0, s29, 0x3000
    s_nop 0
    buffer_load_dwordx4 v136, s[16:19], s26 offen lds
    s_waitcnt lgkmcnt(12)
    v_mfma_f32_16x16x32_bf16 v[32:35], v[80:83], a[16:19], v[32:35]
    ds_read_b64_tr_b16 v[108:109], v131 offset:40960
    v_mfma_f32_16x16x32_bf16 v[36:39], v[80:83], a[80:83], v[36:39]
    ds_read_b64_tr_b16 v[110:111], v131 offset:41984
    s_add_u32 s26, s24, 0x80000
    s_add_u32 m0, s29, 0x4000
    s_nop 0
    buffer_load_dwordx4 v136, s[16:19], s26 offen lds
    s_waitcnt lgkmcnt(12)
    v_mfma_f32_16x16x32_bf16 v[40:43], v[84:87], a[16:19], v[40:43]
    ds_read_b64_tr_b16 v[112:113], v132 offset:40960
    v_mfma_f32_16x16x32_bf16 v[44:47], v[84:87], a[80:83], v[44:47]
    ds_read_b64_tr_b16 v[114:115], v132 offset:41984
    s_add_u32 s26, s24, 0xa0000
    s_add_u32 m0, s29, 0x5000
    s_nop 0
    buffer_load_dwordx4 v136, s[16:19], s26 offen lds
    s_waitcnt lgkmcnt(12)
    v_mfma_f32_16x16x32_bf16 v[48:51], v[88:91], a[16:19], v[48:51]
    ds_read_b64_tr_b16 v[116:117], v133 offset:40960
    v_mfma_f32_16x16x32_bf16 v[52:55], v[88:91], a[80:83], v[52:55]
    ds_read_b64_tr_b16 v[118:119], v133 offset:41984
    s_add_u32 s26, s24, 0xc0000
    s_add_u32 m0, s29, 0x6000
    s_nop 0
    buffer_load_dwordx4 v136, s[16:19], s26 offen lds
    s_waitcnt lgkmcnt(12)
    v_mfma_f32_16x16x32_bf16 v[56:59], v[92:95], a[16:19], v[56:59]
    ds_read_b64_tr_b16 v[120:121], v134 offset:40960
    v_mfma_f32_16x16x32_bf16 v[60:63], v[92:95], a[80:83], v[60:63]
    ds_read_b64_tr_b16 v[122:123], v134 offset:41984
    s_add_u32 s26, s24, 0xe0000
    s_add_u32 m0, s29, 0x7000
    s_nop 0
    buffer_load_dwordx4 v136, s[16:19], s26 offen lds
    s_waitcnt lgkmcnt(12)
    v_mfma_f32_16x16x32_bf16 v[0:3], v[96:99], a[20:23], v[0:3]
    ds_read_b64_tr_b16 v[124:125], v135 offset:40960
    v_mfma_f32_16x16x32_bf16 v[4:7], v[96:99], a[84:87], v[4:7]
    ds_read_b64_tr_b16 v[126:127], v135 offset:41984
    s_waitcnt lgkmcnt(12)
    v_mfma_f32_16x16x32_bf16 v[8:11], v[100:103], a[20:23], v[8:11]
    ds_read_b64_tr_b16 v[64:65], v128 offset:49152
    v_mfma_f32_16x16x32_bf16 v[12:15], v[100:103], a[84:87], v[12:15]
    ds_read_b64_tr_b16 v[66:67], v128 offset:50176
    s_waitcnt lgkmcnt(12)
    v_mfma_f32_16x16x32_bf16 v[16:19], v[104:107], a[20:23], v[16:19]
    ds_read_b64_tr_b16 v[68:69], v129 offset:49152
    v_mfma_f32_16x16x32_bf16 v[20:23], v[104:107], a[84:87], v[20:23]
    ds_read_b64_tr_b16 v[70:71], v129 offset:50176
    s_waitcnt lgkmcnt(12)
    v_mfma_f32_16x16x32_bf16 v[24:27], v[108:111], a[20:23], v[24:27]
    ds_read_b64_tr_b16 v[72:73], v130 offset:49152
    v_mfma_f32_16x16x32_bf16 v[28:31], v[108:111], a[84:87], v[28:31]
    ds_read_b64_tr_b16 v[74:75], v130 offset:50176
    s_waitcnt lgkmcnt(12)
    v_mfma_f32_16x16x32_bf16 v[32:35], v[112:115], a[20:23], v[32:35]
    ds_read_b64_tr_b16 v[76:77], v131 offset:49152
    v_mfma_f32_16x16x32_bf16 v[36:39], v[112:115], a[84:87], v[36:39]
    ds_read_b64_tr_b16 v[78:79], v131 offset:50176
    s_waitcnt lgkmcnt(12)
    v_mfma_f32_16x16x32_bf16 v[40:43], v[116:119], a[20:23], v[40:43]
    ds_read_b64_tr_b16 v[80:81], v132 offset:49152
    v_mfma_f32_16x16x32_bf16 v[44:47], v[116:119], a[84:87], v[44:47]
    ds_read_b64_tr_b16 v[82:83], v132 offset:50176
    s_waitcnt lgkmcnt(12)
    v_mfma_f32_16x16x32_bf16 v[48:51], v[120:123], a[20:23], v[48:51]
    ds_read_b64_tr_b16 v[84:85], v133 offset:49152
    v_mfma_f32_16x16x32_bf16 v[52:55], v[120:123], a[84:87], v[52:55]
    ds_read_b64_tr_b16 v[86:87], v133 offset:50176
    s_waitcnt lgkmcnt(12)
    v_mfma_f32_16x16x32_bf16 v[56:59], v[124:127], a[20:23], v[56:59]
    ds_read_b64_tr_b16 v[88:89], v134 offset:49152
    v_mfma_f32_16x16x32_bf16 v[60:63], v[124:127], a[84:87], v[60:63]
    ds_read_b64_tr_b16 v[90:91], v134 offset:50176
    s_waitcnt lgkmcnt(12)
    v_mfma_f32_16x16x32_bf16 v[0:3], v[64:67], a[24:27], v[0:3]
    ds_read_b64_tr_b16 v[92:93], v135 offset:49152
    v_mfma_f32_16x16x32_bf16 v[4:7], v[64:67], a[88:91], v[4:7]
    ds_read_b64_tr_b16 v[94:95], v135 offset:50176
    s_waitcnt lgkmcnt(12)
    v_mfma_f32_16x16x32_bf16 v[8:11], v[68:71], a[24:27], v[8:11]
    ds_read_b64_tr_b16 v[96:97], v128 offset:57344
    v_mfma_f32_16x16x32_bf16 v[12:15], v[68:71], a[88:91], v[12:15]
    ds_read_b64_tr_b16 v[98:99], v128 offset:58368
    s_waitcnt lgkmcnt(12)
    v_mfma_f32_16x16x32_bf16 v[16:19], v[72:75], a[24:27], v[16:19]
    ds_read_b64_tr_b16 v[100:101], v129 offset:57344
    v_mfma_f32_16x16x32_bf16 v[20:23], v[72:75], a[88:91], v[20:23]
    ds_read_b64_tr_b16 v[102:103], v129 offset:58368
    s_waitcnt lgkmcnt(12)
    v_mfma_f32_16x16x32_bf16 v[24:27], v[76:79], a[24:27], v[24:27]
    ds_read_b64_tr_b16 v[104:105], v130 offset:57344
    v_mfma_f32_16x16x32_bf16 v[28:31], v[76:79], a[88:91], v[28:31]
    ds_read_b64_tr_b16 v[106:107], v130 offset:58368
    s_waitcnt lgkmcnt(12)
    v_mfma_f32_16x16x32_bf16 v[32:35], v[80:83], a[24:27], v[32:35]
    ds_read_b64_tr_b16 v[108:109], v131 offset:57344
    v_mfma_f32_16x16x32_bf16 v[36:39], v[80:83], a[88:91], v[36:39]
    ds_read_b64_tr_b16 v[110:111], v131 offset:58368
    s_waitcnt lgkmcnt(12)
    v_mfma_f32_16x16x32_bf16 v[40:43], v[84:87], a[24:27], v[40:43]
    ds_read_b64_tr_b16 v[112:113], v132 offset:57344
    v_mfma_f32_16x16x32_bf16 v[44:47], v[84:87], a[88:91], v[44:47]
    ds_read_b64_tr_b16 v[114:115], v132 offset:58368
    s_waitcnt lgkmcnt(12)
    v_mfma_f32_16x16x32_bf16 v[48:51], v[88:91], a[24:27], v[48:51]
    ds_read_b64_tr_b16 v[116:117], v133 offset:57344
    v_mfma_f32_16x16x32_bf16 v[52:55], v[88:91], a[88:91], v[52:55]
    ds_read_b64_tr_b16 v[118:119], v133 offset:58368
    s_waitcnt lgkmcnt(12)
    v_mfma_f32_16x16x32_bf16 v[56:59], v[92:95], a[24:27], v[56:59]
    ds_read_b64_tr_b16 v[120:121], v134 offset:57344
    v_mfma_f32_16x16x32_bf16 v[60:63], v[92:95], a[88:91], v[60:63]
    ds_read_b64_tr_b16 v[122:123], v134 offset:58368
    s_waitcnt lgkmcnt(12)
    v_mfma_f32_16x16x32_bf16 v[0:3], v[96:99], a[28:31], v[0:3]
    ds_read_b64_tr_b16 v[124:125], v135 offset:57344
    v_mfma_f32_16x16x32_bf16 v[4:7], v[96:99], a[92:95], v[4:7]
    ds_read_b64_tr_b16 v[126:127], v135 offset:58368
    s_waitcnt lgkmcnt(12)
    v_mfma_f32_16x16x32_bf16 v[8:11], v[100:103], a[28:31], v[8:11]
    v_mfma_f32_16x16x32_bf16 v[12:15], v[100:103], a[92:95], v[12:15]
    s_waitcnt lgkmcnt(10)
    v_mfma_f32_16x16x32_bf16 v[16:19], v[104:107], a[28:31], v[16:19]
    v_mfma_f32_16x16x32_bf16 v[20:23], v[104:107], a[92:95], v[20:23]
    s_waitcnt lgkmcnt(8)
    v_mfma_f32_16x16x32_bf16 v[24:27], v[108:111], a[28:31], v[24:27]
    v_mfma_f32_16x16x32_bf16 v[28:31], v[108:111], a[92:95], v[28:31]
    s_waitcnt lgkmcnt(6)
    v_mfma_f32_16x16x32_bf16 v[32:35], v[112:115], a[28:31], v[32:35]
    v_mfma_f32_16x16x32_bf16 v[36:39], v[112:115], a[92:95], v[36:39]
    s_waitcnt lgkmcnt(4)
    v_mfma_f32_16x16x32_bf16 v[40:43], v[116:119], a[28:31], v[40:43]
    v_mfma_f32_16x16x32_bf16 v[44:47], v[116:119], a[92:95], v[44:47]
    s_waitcnt lgkmcnt(2)
    v_mfma_f32_16x16x32_bf16 v[48:51], v[120:123], a[28:31], v[48:51]
    v_mfma_f32_16x16x32_bf16 v[52:55], v[120:123], a[92:95], v[52:55]
    s_waitcnt lgkmcnt(0)
    v_mfma_f32_16x16x32_bf16 v[56:59], v[124:127], a[28:31], v[56:59]
    v_mfma_f32_16x16x32_bf16 v[60:63], v[124:127], a[92:95], v[60:63]
    v_xor_b32 v128, 0x10000, v128
    v_xor_b32 v129, 0x10000, v129
    v_xor_b32 v130, 0x10000, v130
    v_xor_b32 v131, 0x10000, v131
    v_xor_b32 v132, 0x10000, v132
    v_xor_b32 v133, 0x10000, v133
    v_xor_b32 v134, 0x10000, v134
    v_xor_b32 v135, 0x10000, v135
    s_waitcnt vmcnt(16)
    s_barrier
    ds_read_b64_tr_b16 v[64:65], v128
    ds_read_b64_tr_b16 v[66:67], v128 offset:1024
    ds_read_b64_tr_b16 v[68:69], v129
    ds_read_b64_tr_b16 v[70:71], v129 offset:1024
    ds_read_b64_tr_b16 v[72:73], v130
    ds_read_b64_tr_b16 v[74:75], v130 offset:1024
    ds_read_b64_tr_b16 v[76:77], v131
    ds_read_b64_tr_b16 v[78:79], v131 offset:1024
    ds_read_b64_tr_b16 v[80:81], v132
    ds_read_b64_tr_b16 v[82:83], v132 offset:1024
    ds_read_b64_tr_b16 v[84:85], v133
    ds_read_b64_tr_b16 v[86:87], v133 offset:1024
    ds_read_b64_tr_b16 v[88:89], v134
    ds_read_b64_tr_b16 v[90:91], v134 offset:1024
    s_cmp_eq_u32 s40, 0
    s_cbranch_scc1 L_nopf_83
    s_cmp_lg_u32 s87, 0
    s_cbranch_scc1 L_modeok_84
    s_mov_b32 s96, 0
L_mode_85:
    buffer_load_dwordx2 v[140:141], off, s[92:95], 0 offset:36 sc1
    s_waitcnt vmcnt(0)
    v_readfirstlane_b32 s87, v140
    v_readfirstlane_b32 s97, v141
    s_nop 0
    s_min_u32 s97, s97, s87
    s_cmp_lg_u32 s97, 0
    s_cbranch_scc1 L_moded_86
    s_sleep 4
    s_add_u32 s96, s96, 1
    s_cmp_lg_u32 s96, 0x100
    s_cbranch_scc1 L_modef_87
    v_mov_b32 v140, 2
    v_mov_b32 v141, 0
    s_mov_b64 exec, 1
    buffer_atomic_cmpswap v[140:141], off, s[92:95], 0 offset:36
    s_mov_b64 exec, -1
L_modef_87:
    s_cmp_lt_u32 s96, 0x10000
    s_cbranch_scc1 L_mode_85
L_moded_86:
    s_cmp_lg_u32 s87, 1
    s_cbranch_scc1 L_fallback
L_modeok_84:
    s_cmp_lg_u32 s100, 0
    s_cbranch_scc1 L_flag_88
    v_mov_b32 v138, 1
    s_mov_b64 exec, 1
    buffer_store_dword v138, off, s[8:11], s40 sc1
    s_mov_b64 exec, -1
L_flag_88:
    s_mov_b32 s40, 0
L_nopf_83:
    s_waitcnt lgkmcnt(12)
    v_mfma_f32_16x16x32_bf16 v[0:3], v[64:67], a[32:35], v[0:3]
    ds_read_b64_tr_b16 v[92:93], v135
    v_mfma_f32_16x16x32_bf16 v[4:7], v[64:67], a[96:99], v[4:7]
    ds_read_b64_tr_b16 v[94:95], v135 offset:1024
    s_add_u32 s26, s24, 0x100000
    s_add_u32 m0, s29, 0x8000
    s_nop 0
    buffer_load_dwordx4 v136, s[16:19], s26 offen lds
    s_waitcnt lgkmcnt(12)
    v_mfma_f32_16x16x32_bf16 v[8:11], v[68:71], a[32:35], v[8:11]
    ds_read_b64_tr_b16 v[96:97], v128 offset:8192
    v_mfma_f32_16x16x32_bf16 v[12:15], v[68:71], a[96:99], v[12:15]
    ds_read_b64_tr_b16 v[98:99], v128 offset:9216
    s_add_u32 s26, s24, 0x120000
    s_add_u32 m0, s29, 0x9000
    s_nop 0
    buffer_load_dwordx4 v136, s[16:19], s26 offen lds
    s_waitcnt lgkmcnt(12)
    v_mfma_f32_16x16x32_bf16 v[16:19], v[72:75], a[32:35], v[16:19]
    ds_read_b64_tr_b16 v[100:101], v129 offset:8192
    v_mfma_f32_16x16x32_bf16 v[20:23], v[72:75], a[96:99], v[20:23]
    ds_read_b64_tr_b16 v[102:103], v129 offset:9216
    s_add_u32 s26, s24, 0x140000
    s_add_u32 m0, s29, 0xa000
    s_nop 0
    buffer_load_dwordx4 v136, s[16:19], s26 offen lds
    s_waitcnt lgkmcnt(12)
    v_mfma_f32_16x16x32_bf16 v[24:27], v[76:79], a[32:35], v[24:27]
    ds_read_b64_tr_b16 v[104:105], v130 offset:8192
    v_mfma_f32_16x16x32_bf16 v[28:31], v[76:79], a[96:99], v[28:31]
    ds_read_b64_tr_b16 v[106:107], v130 offset:9216
    s_add_u32 s26, s24, 0x160000
    s_add_u32 m0, s29, 0xb000
    s_nop 0
    buffer_load_dwordx4 v136, s[16:19], s26 offen lds
    s_waitcnt lgkmcnt(12)
    v_mfma_f32_16x16x32_bf16 v[32:35], v[80:83], a[32:35], v[32:35]
    ds_read_b64_tr_b16 v[108:109], v131 offset:8192
    v_mfma_f32_16x16x32_bf16 v[36:39], v[80:83], a[96:99], v[36:39]
    ds_read_b64_tr_b16 v[110:111], v131 offset:9216
    s_add_u32 s26, s24, 0x180000
    s_add_u32 m0, s29, 0xc000
    s_nop 0
    buffer_load_dwordx4 v136, s[16:19], s26 offen lds
    s_waitcnt lgkmcnt(12)
    v_mfma_f32_16x16x32_bf16 v[40:43], v[84:87], a[32:35], v[40:43]
    ds_read_b64_tr_b16 v[112:113], v132 offset:8192
    v_mfma_f32_16x16x32_bf16 v[44:47], v[84:87], a[96:99], v[44:47]
    ds_read_b64_tr_b16 v[114:115], v132 offset:9216
    s_add_u32 s26, s24, 0x1a0000
    s_add_u32 m0, s29, 0xd000
    s_nop 0
    buffer_load_dwordx4 v136, s[16:19], s26 offen lds
    s_waitcnt lgkmcnt(12)
    v_mfma_f32_16x16x32_bf16 v[48:51], v[88:91], a[32:35], v[48:51]
    ds_read_b64_tr_b16 v[116:117], v133 offset:8192
    v_mfma_f32_16x16x32_bf16 v[52:55], v[88:91], a[96:99], v[52:55]
    ds_read_b64_tr_b16 v[118:119], v133 offset:9216
    s_add_u32 s26, s24, 0x1c0000
    s_add_u32 m0, s29, 0xe000
    s_nop 0
    buffer_load_dwordx4 v136, s[16:19], s26 offen lds
    s_waitcnt lgkmcnt(12)
    v_mfma_f32_16x16x32_bf16 v[56:59], v[92:95], a[32:35], v[56:59]
    ds_read_b64_tr_b16 v[120:121], v134 offset:8192
    v_mfma_f32_16x16x32_bf16 v[60:63], v[92:95], a[96:99], v[60:63]
    ds_read_b64_tr_b16 v[122:123], v134 offset:9216
    s_add_u32 s26, s24, 0x1e0000
    s_add_u32 m0, s29, 0xf000
    s_nop 0
    buffer_load_dwordx4 v136, s[16:19], s26 offen lds
    s_waitcnt lgkmcnt(12)
    v_mfma_f32_16x16x32_bf16 v[0:3], v[96:99], a[36:39], v[0:3]
    ds_read_b64_tr_b16 v[124:125], v135 offset:8192
    v_mfma_f32_16x16x32_bf16 v[4:7], v[96:99], a[100:103], v[4:7]
    ds_read_b64_tr_b16 v[126:127], v135 offset:9216
    s_waitcnt lgkmcnt(12)
    v_mfma_f32_16x16x32_bf16 v[8:11], v[100:103], a[36:39], v[8:11]
    ds_read_b64_tr_b16 v[64:65], v128 offset:16384
    v_mfma_f32_16x16x32_bf16 v[12:15], v[100:103], a[100:103], v[12:15]
    ds_read_b64_tr_b16 v[66:67], v128 offset:17408
    s_waitcnt lgkmcnt(12)
    v_mfma_f32_16x16x32_bf16 v[16:19], v[104:107], a[36:39], v[16:19]
    ds_read_b64_tr_b16 v[68:69], v129 offset:16384
    v_mfma_f32_16x16x32_bf16 v[20:23], v[104:107], a[100:103], v[20:23]
    ds_read_b64_tr_b16 v[70:71], v129 offset:17408
    s_waitcnt lgkmcnt(12)
    v_mfma_f32_16x16x32_bf16 v[24:27], v[108:111], a[36:39], v[24:27]
    ds_read_b64_tr_b16 v[72:73], v130 offset:16384
    v_mfma_f32_16x16x32_bf16 v[28:31], v[108:111], a[100:103], v[28:31]
    ds_read_b64_tr_b16 v[74:75], v130 offset:17408
    s_waitcnt lgkmcnt(12)
    v_mfma_f32_16x16x32_bf16 v[32:35], v[112:115], a[36:39], v[32:35]
    ds_read_b64_tr_b16 v[76:77], v131 offset:16384
    v_mfma_f32_16x16x32_bf16 v[36:39], v[112:115], a[100:103], v[36:39]
    ds_read_b64_tr_b16 v[78:79], v131 offset:17408
    s_waitcnt lgkmcnt(12)
    v_mfma_f32_16x16x32_bf16 v[40:43], v[116:119], a[36:39], v[40:43]
    ds_read_b64_tr_b16 v[80:81], v132 offset:16384
    v_mfma_f32_16x16x32_bf16 v[44:47], v[116:119], a[100:103], v[44:47]
    ds_read_b64_tr_b16 v[82:83], v132 offset:17408
    s_waitcnt lgkmcnt(12)
    v_mfma_f32_16x16x32_bf16 v[48:51], v[120:123], a[36:39], v[48:51]
    ds_read_b64_tr_b16 v[84:85], v133 offset:16384
    v_mfma_f32_16x16x32_bf16 v[52:55], v[120:123], a[100:103], v[52:55]
    ds_read_b64_tr_b16 v[86:87], v133 offset:17408
    s_waitcnt lgkmcnt(12)
    v_mfma_f32_16x16x32_bf16 v[56:59], v[124:127], a[36:39], v[56:59]
    ds_read_b64_tr_b16 v[88:89], v134 offset:16384
    v_mfma_f32_16x16x32_bf16 v[60:63], v[124:127], a[100:103], v[60:63]
    ds_read_b64_tr_b16 v[90:91], v134 offset:17408
    s_waitcnt lgkmcnt(12)
    v_mfma_f32_16x16x32_bf16 v[0:3], v[64:67], a[40:43], v[0:3]
    ds_read_b64_tr_b16 v[92:93], v135 offset:16384
    v_mfma_f32_16x16x32_bf16 v[4:7], v[64:67], a[104:107], v[4:7]
    ds_read_b64_tr_b16 v[94:95], v135 offset:17408
    s_waitcnt lgkmcnt(12)
    v_mfma_f32_16x16x32_bf16 v[8:11], v[68:71], a[40:43], v[8:11]
    ds_read_b64_tr_b16 v[96:97], v128 offset:24576
    v_mfma_f32_16x16x32_bf16 v[12:15], v[68:71], a[104:107], v[12:15]
    ds_read_b64_tr_b16 v[98:99], v128 offset:25600
    s_waitcnt lgkmcnt(12)
    v_mfma_f32_16x16x32_bf16 v[16:19], v[72:75], a[40:43], v[16:19]
    ds_read_b64_tr_b16 v[100:101], v129 offset:24576
    v_mfma_f32_16x16x32_bf16 v[20:23], v[72:75], a[104:107], v[20:23]
    ds_read_b64_tr_b16 v[102:103], v129 offset:25600
    s_waitcnt lgkmcnt(12)
    v_mfma_f32_16x16x32_bf16 v[24:27], v[76:79], a[40:43], v[24:27]
    ds_read_b64_tr_b16 v[104:105], v130 offset:24576
    v_mfma_f32_16x16x32_bf16 v[28:31], v[76:79], a[104:107], v[28:31]
    ds_read_b64_tr_b16 v[106:107], v130 offset:25600
    s_waitcnt lgkmcnt(12)
    v_mfma_f32_16x16x32_bf16 v[32:35], v[80:83], a[40:43], v[32:35]
    ds_read_b64_tr_b16 v[108:109], v131 offset:24576
    v_mfma_f32_16x16x32_bf16 v[36:39], v[80:83], a[104:107], v[36:39]
    ds_read_b64_tr_b16 v[110:111], v131 offset:25600
    s_waitcnt lgkmcnt(12)
    v_mfma_f32_16x16x32_bf16 v[40:43], v[84:87], a[40:43], v[40:43]
    ds_read_b64_tr_b16 v[112:113], v132 offset:24576
    v_mfma_f32_16x16x32_bf16 v[44:47], v[84:87], a[104:107], v[44:47]
    ds_read_b64_tr_b16 v[114:115], v132 offset:25600
    s_waitcnt lgkmcnt(12)
    v_mfma_f32_16x16x32_bf16 v[48:51], v[88:91], a[40:43], v[48:51]
    ds_read_b64_tr_b16 v[116:117], v133 offset:24576
    v_mfma_f32_16x16x32_bf16 v[52:55], v[88:91], a[104:107], v[52:55]
    ds_read_b64_tr_b16 v[118:119], v133 offset:25600
    s_waitcnt lgkmcnt(12)
    v_mfma_f32_16x16x32_bf16 v[56:59], v[92:95], a[40:43], v[56:59]
    ds_read_b64_tr_b16 v[120:121], v134 offset:24576
    v_mfma_f32_16x16x32_bf16 v[60:63], v[92:95], a[104:107], v[60:63]
    ds_read_b64_tr_b16 v[122:123], v134 offset:25600
    s_waitcnt lgkmcnt(12)
    v_mfma_f32_16x16x32_bf16 v[0:3], v[96:99], a[44:47], v[0:3]
    ds_read_b64_tr_b16 v[124:125], v135 offset:24576
    v_mfma_f32_16x16x32_bf16 v[4:7], v[96:99], a[108:111], v[4:7]
    ds_read_b64_tr_b16 v[126:127], v135 offset:25600
    s_waitcnt lgkmcnt(12)
    v_mfma_f32_16x16x32_bf16 v[8:11], v[100:103], a[44:47], v[8:11]
    v_mfma_f32_16x16x32_bf16 v[12:15], v[100:103], a[108:111], v[12:15]
    s_waitcnt lgkmcnt(10)
    v_mfma_f32_16x16x32_bf16 v[16:19], v[104:107], a[44:47], v[16:19]
    v_mfma_f32_16x16x32_bf16 v[20:23], v[104:107], a[108:111], v[20:23]
    s_waitcnt lgkmcnt(8)
    v_mfma_f32_16x16x32_bf16 v[24:27], v[108:111], a[44:47], v[24:27]
    v_mfma_f32_16x16x32_bf16 v[28:31], v[108:111], a[108:111], v[28:31]
    s_waitcnt lgkmcnt(6)
    v_mfma_f32_16x16x32_bf16 v[32:35], v[112:115], a[44:47], v[32:35]
    v_mfma_f32_16x16x32_bf16 v[36:39], v[112:115], a[108:111], v[36:39]
    s_waitcnt lgkmcnt(4)
    v_mfma_f32_16x16x32_bf16 v[40:43], v[116:119], a[44:47], v[40:43]
    v_mfma_f32_16x16x32_bf16 v[44:47], v[116:119], a[108:111], v[44:47]
    s_waitcnt lgkmcnt(2)
    v_mfma_f32_16x16x32_bf16 v[48:51], v[120:123], a[44:47], v[48:51]
    v_mfma_f32_16x16x32_bf16 v[52:55], v[120:123], a[108:111], v[52:55]
    s_waitcnt lgkmcnt(0)
    v_mfma_f32_16x16x32_bf16 v[56:59], v[124:127], a[44:47], v[56:59]
    v_mfma_f32_16x16x32_bf16 v[60:63], v[124:127], a[108:111], v[60:63]
    s_waitcnt vmcnt(16)
    s_barrier
    ds_read_b64_tr_b16 v[64:65], v128 offset:32768
    ds_read_b64_tr_b16 v[66:67], v128 offset:33792
    ds_read_b64_tr_b16 v[68:69], v129 offset:32768
    ds_read_b64_tr_b16 v[70:71], v129 offset:33792
    ds_read_b64_tr_b16 v[72:73], v130 offset:32768
    ds_read_b64_tr_b16 v[74:75], v130 offset:33792
    ds_read_b64_tr_b16 v[76:77], v131 offset:32768
    ds_read_b64_tr_b16 v[78:79], v131 offset:33792
    ds_read_b64_tr_b16 v[80:81], v132 offset:32768
    ds_read_b64_tr_b16 v[82:83], v132 offset:33792
    ds_read_b64_tr_b16 v[84:85], v133 offset:32768
    ds_read_b64_tr_b16 v[86:87], v133 offset:33792
    ds_read_b64_tr_b16 v[88:89], v134 offset:32768
    ds_read_b64_tr_b16 v[90:91], v134 offset:33792
    s_waitcnt lgkmcnt(12)
    v_mfma_f32_16x16x32_bf16 v[0:3], v[64:67], a[48:51], v[0:3]
    ds_read_b64_tr_b16 v[92:93], v135 offset:32768
    v_mfma_f32_16x16x32_bf16 v[4:7], v[64:67], a[112:115], v[4:7]
    ds_read_b64_tr_b16 v[94:95], v135 offset:33792
    s_add_u32 s26, s24, 0x200000
    s_add_u32 m0, s29, 0x10000
    s_nop 0
    buffer_load_dwordx4 v136, s[16:19], s26 offen lds
    s_waitcnt lgkmcnt(12)
    v_mfma_f32_16x16x32_bf16 v[8:11], v[68:71], a[48:51], v[8:11]
    ds_read_b64_tr_b16 v[96:97], v128 offset:40960
    v_mfma_f32_16x16x32_bf16 v[12:15], v[68:71], a[112:115], v[12:15]
    ds_read_b64_tr_b16 v[98:99], v128 offset:41984
    s_add_u32 s26, s24, 0x220000
    s_add_u32 m0, s29, 0x11000
    s_nop 0
    buffer_load_dwordx4 v136, s[16:19], s26 offen lds
    s_waitcnt lgkmcnt(12)
    v_mfma_f32_16x16x32_bf16 v[16:19], v[72:75], a[48:51], v[16:19]
    ds_read_b64_tr_b16 v[100:101], v129 offset:40960
    v_mfma_f32_16x16x32_bf16 v[20:23], v[72:75], a[112:115], v[20:23]
    ds_read_b64_tr_b16 v[102:103], v129 offset:41984
    s_add_u32 s26, s24, 0x240000
    s_add_u32 m0, s29, 0x12000
    s_nop 0
    buffer_load_dwordx4 v136, s[16:19], s26 offen lds
    s_waitcnt lgkmcnt(12)
    v_mfma_f32_16x16x32_bf16 v[24:27], v[76:79], a[48:51], v[24:27]
    ds_read_b64_tr_b16 v[104:105], v130 offset:40960
    v_mfma_f32_16x16x32_bf16 v[28:31], v[76:79], a[112:115], v[28:31]
    ds_read_b64_tr_b16 v[106:107], v130 offset:41984
    s_add_u32 s26, s24, 0x260000
    s_add_u32 m0, s29, 0x13000
    s_nop 0
    buffer_load_dwordx4 v136, s[16:19], s26 offen lds
    s_waitcnt lgkmcnt(12)
    v_mfma_f32_16x16x32_bf16 v[32:35], v[80:83], a[48:51], v[32:35]
    ds_read_b64_tr_b16 v[108:109], v131 offset:40960
    v_mfma_f32_16x16x32_bf16 v[36:39], v[80:83], a[112:115], v[36:39]
    ds_read_b64_tr_b16 v[110:111], v131 offset:41984
    s_add_u32 s26, s24, 0x280000
    s_add_u32 m0, s29, 0x14000
    s_nop 0
    buffer_load_dwordx4 v136, s[16:19], s26 offen lds
    s_waitcnt lgkmcnt(12)
    v_mfma_f32_16x16x32_bf16 v[40:43], v[84:87], a[48:51], v[40:43]
    ds_read_b64_tr_b16 v[112:113], v132 offset:40960
    v_mfma_f32_16x16x32_bf16 v[44:47], v[84:87], a[112:115], v[44:47]
    ds_read_b64_tr_b16 v[114:115], v132 offset:41984
    s_add_u32 s26, s24, 0x2a0000
    s_add_u32 m0, s29, 0x15000
    s_nop 0
    buffer_load_dwordx4 v136, s[16:19], s26 offen lds
    s_waitcnt lgkmcnt(12)
    v_mfma_f32_16x16x32_bf16 v[48:51], v[88:91], a[48:51], v[48:51]
    ds_read_b64_tr_b16 v[116:117], v133 offset:40960
    v_mfma_f32_16x16x32_bf16 v[52:55], v[88:91], a[112:115], v[52:55]
    ds_read_b64_tr_b16 v[118:119], v133 offset:41984
    s_add_u32 s26, s24, 0x2c0000
    s_add_u32 m0, s29, 0x16000
    s_nop 0
    buffer_load_dwordx4 v136, s[16:19], s26 offen lds
    s_waitcnt lgkmcnt(12)
    v_mfma_f32_16x16x32_bf16 v[56:59], v[92:95], a[48:51], v[56:59]
    ds_read_b64_tr_b16 v[120:121], v134 offset:40960
    v_mfma_f32_16x16x32_bf16 v[60:63], v[92:95], a[112:115], v[60:63]
    ds_read_b64_tr_b16 v[122:123], v134 offset:41984
    s_add_u32 s26, s24, 0x2e0000
    s_add_u32 m0, s29, 0x17000
    s_nop 0
    buffer_load_dwordx4 v136, s[16:19], s26 offen lds
    s_waitcnt lgkmcnt(12)
    v_mfma_f32_16x16x32_bf16 v[0:3], v[96:99], a[52:55], v[0:3]
    ds_read_b64_tr_b16 v[124:125], v135 offset:40960
    v_mfma_f32_16x16x32_bf16 v[4:7], v[96:99], a[116:119], v[4:7]
    ds_read_b64_tr_b16 v[126:127], v135 offset:41984
    s_waitcnt lgkmcnt(12)
    v_mfma_f32_16x16x32_bf16 v[8:11], v[100:103], a[52:55], v[8:11]
    ds_read_b64_tr_b16 v[64:65], v128 offset:49152
    v_mfma_f32_16x16x32_bf16 v[12:15], v[100:103], a[116:119], v[12:15]
    ds_read_b64_tr_b16 v[66:67], v128 offset:50176
    s_waitcnt lgkmcnt(12)
    v_mfma_f32_16x16x32_bf16 v[16:19], v[104:107], a[52:55], v[16:19]
    ds_read_b64_tr_b16 v[68:69], v129 offset:49152
    v_mfma_f32_16x16x32_bf16 v[20:23], v[104:107], a[116:119], v[20:23]
    ds_read_b64_tr_b16 v[70:71], v129 offset:50176
    s_waitcnt lgkmcnt(12)
    v_mfma_f32_16x16x32_bf16 v[24:27], v[108:111], a[52:55], v[24:27]
    ds_read_b64_tr_b16 v[72:73], v130 offset:49152
    v_mfma_f32_16x16x32_bf16 v[28:31], v[108:111], a[116:119], v[28:31]
    ds_read_b64_tr_b16 v[74:75], v130 offset:50176
    s_waitcnt lgkmcnt(12)
    v_mfma_f32_16x16x32_bf16 v[32:35], v[112:115], a[52:55], v[32:35]
    ds_read_b64_tr_b16 v[76:77], v131 offset:49152
    v_mfma_f32_16x16x32_bf16 v[36:39], v[112:115], a[116:119], v[36:39]
    ds_read_b64_tr_b16 v[78:79], v131 offset:50176
    s_waitcnt lgkmcnt(12)
    v_mfma_f32_16x16x32_bf16 v[40:43], v[116:119], a[52:55], v[40:43]
    ds_read_b64_tr_b16 v[80:81], v132 offset:49152
    v_mfma_f32_16x16x32_bf16 v[44:47], v[116:119], a[116:119], v[44:47]
    ds_read_b64_tr_b16 v[82:83], v132 offset:50176
    s_waitcnt lgkmcnt(12)
    v_mfma_f32_16x16x32_bf16 v[48:51], v[120:123], a[52:55], v[48:51]
    ds_read_b64_tr_b16 v[84:85], v133 offset:49152
    v_mfma_f32_16x16x32_bf16 v[52:55], v[120:123], a[116:119], v[52:55]
    ds_read_b64_tr_b16 v[86:87], v133 offset:50176
    s_waitcnt lgkmcnt(12)
    v_mfma_f32_16x16x32_bf16 v[56:59], v[124:127], a[52:55], v[56:59]
    ds_read_b64_tr_b16 v[88:89], v134 offset:49152
    v_mfma_f32_16x16x32_bf16 v[60:63], v[124:127], a[116:119], v[60:63]
    ds_read_b64_tr_b16 v[90:91], v134 offset:50176
    s_waitcnt lgkmcnt(12)
    v_mfma_f32_16x16x32_bf16 v[0:3], v[64:67], a[56:59], v[0:3]
    ds_read_b64_tr_b16 v[92:93], v135 offset:49152
    v_mfma_f32_16x16x32_bf16 v[4:7], v[64:67], a[120:123], v[4:7]
    ds_read_b64_tr_b16 v[94:95], v135 offset:50176
    s_waitcnt lgkmcnt(12)
    v_mfma_f32_16x16x32_bf16 v[8:11], v[68:71], a[56:59], v[8:11]
    ds_read_b64_tr_b16 v[96:97], v128 offset:57344
    v_mfma_f32_16x16x32_bf16 v[12:15], v[68:71], a[120:123], v[12:15]
    ds_read_b64_tr_b16 v[98:99], v128 offset:58368
    s_waitcnt lgkmcnt(12)
    v_mfma_f32_16x16x32_bf16 v[16:19], v[72:75], a[56:59], v[16:19]
    ds_read_b64_tr_b16 v[100:101], v129 offset:57344
    v_mfma_f32_16x16x32_bf16 v[20:23], v[72:75], a[120:123], v[20:23]
    ds_read_b64_tr_b16 v[102:103], v129 offset:58368
    s_waitcnt lgkmcnt(12)
    v_mfma_f32_16x16x32_bf16 v[24:27], v[76:79], a[56:59], v[24:27]
    ds_read_b64_tr_b16 v[104:105], v130 offset:57344
    v_mfma_f32_16x16x32_bf16 v[28:31], v[76:79], a[120:123], v[28:31]
    ds_read_b64_tr_b16 v[106:107], v130 offset:58368
    s_waitcnt lgkmcnt(12)
    v_mfma_f32_16x16x32_bf16 v[32:35], v[80:83], a[56:59], v[32:35]
    ds_read_b64_tr_b16 v[108:109], v131 offset:57344
    v_mfma_f32_16x16x32_bf16 v[36:39], v[80:83], a[120:123], v[36:39]
    ds_read_b64_tr_b16 v[110:111], v131 offset:58368
    s_waitcnt lgkmcnt(12)
    v_mfma_f32_16x16x32_bf16 v[40:43], v[84:87], a[56:59], v[40:43]
    ds_read_b64_tr_b16 v[112:113], v132 offset:57344
    v_mfma_f32_16x16x32_bf16 v[44:47], v[84:87], a[120:123], v[44:47]
    ds_read_b64_tr_b16 v[114:115], v132 offset:58368
    s_waitcnt lgkmcnt(12)
    v_mfma_f32_16x16x32_bf16 v[48:51], v[88:91], a[56:59], v[48:51]
    ds_read_b64_tr_b16 v[116:117], v133 offset:57344
    v_mfma_f32_16x16x32_bf16 v[52:55], v[88:91], a[120:123], v[52:55]
    ds_read_b64_tr_b16 v[118:119], v133 offset:58368
    s_waitcnt lgkmcnt(12)
    v_mfma_f32_16x16x32_bf16 v[56:59], v[92:95], a[56:59], v[56:59]
    ds_read_b64_tr_b16 v[120:121], v134 offset:57344
    v_mfma_f32_16x16x32_bf16 v[60:63], v[92:95], a[120:123], v[60:63]
    ds_read_b64_tr_b16 v[122:123], v134 offset:58368
    s_waitcnt lgkmcnt(12)
    v_mfma_f32_16x16x32_bf16 v[0:3], v[96:99], a[60:63], v[0:3]
    ds_read_b64_tr_b16 v[124:125], v135 offset:57344
    v_mfma_f32_16x16x32_bf16 v[4:7], v[96:99], a[124:127], v[4:7]
    ds_read_b64_tr_b16 v[126:127], v135 offset:58368
    s_waitcnt lgkmcnt(12)
    v_mfma_f32_16x16x32_bf16 v[8:11], v[100:103], a[60:63], v[8:11]
    v_mfma_f32_16x16x32_bf16 v[12:15], v[100:103], a[124:127], v[12:15]
    s_waitcnt lgkmcnt(10)
    v_mfma_f32_16x16x32_bf16 v[16:19], v[104:107], a[60:63], v[16:19]
    v_mfma_f32_16x16x32_bf16 v[20:23], v[104:107], a[124:127], v[20:23]
    s_waitcnt lgkmcnt(8)
    v_mfma_f32_16x16x32_bf16 v[24:27], v[108:111], a[60:63], v[24:27]
    v_mfma_f32_16x16x32_bf16 v[28:31], v[108:111], a[124:127], v[28:31]
    s_waitcnt lgkmcnt(6)
    v_mfma_f32_16x16x32_bf16 v[32:35], v[112:115], a[60:63], v[32:35]
    v_mfma_f32_16x16x32_bf16 v[36:39], v[112:115], a[124:127], v[36:39]
    s_waitcnt lgkmcnt(4)
    v_mfma_f32_16x16x32_bf16 v[40:43], v[116:119], a[60:63], v[40:43]
    v_mfma_f32_16x16x32_bf16 v[44:47], v[116:119], a[124:127], v[44:47]
    s_waitcnt lgkmcnt(2)
    v_mfma_f32_16x16x32_bf16 v[48:51], v[120:123], a[60:63], v[48:51]
    v_mfma_f32_16x16x32_bf16 v[52:55], v[120:123], a[124:127], v[52:55]
    s_waitcnt lgkmcnt(0)
    v_mfma_f32_16x16x32_bf16 v[56:59], v[124:127], a[60:63], v[56:59]
    v_mfma_f32_16x16x32_bf16 v[60:63], v[124:127], a[124:127], v[60:63]
    v_xor_b32 v128, 0x10000, v128
    v_xor_b32 v129, 0x10000, v129
    v_xor_b32 v130, 0x10000, v130
    v_xor_b32 v131, 0x10000, v131
    v_xor_b32 v132, 0x10000, v132
    v_xor_b32 v133, 0x10000, v133
    v_xor_b32 v134, 0x10000, v134
    v_xor_b32 v135, 0x10000, v135
    v_cvt_pk_bf16_f32 v144, v0, v8
    v_cvt_pk_bf16_f32 v145, v1, v9
    v_cvt_pk_bf16_f32 v146, v2, v10
    v_cvt_pk_bf16_f32 v147, v3, v11
    buffer_store_dwordx4 v[144:147], v137, s[8:11], s25 offen sc1
    v_cvt_pk_bf16_f32 v148, v16, v24
    v_cvt_pk_bf16_f32 v149, v17, v25
    v_cvt_pk_bf16_f32 v150, v18, v26
    v_cvt_pk_bf16_f32 v151, v19, v27
    buffer_store_dwordx4 v[148:151], v137, s[8:11], s25 offen offset:1024 sc1
    v_cvt_pk_bf16_f32 v152, v32, v40
    v_cvt_pk_bf16_f32 v153, v33, v41
    v_cvt_pk_bf16_f32 v154, v34, v42
    v_cvt_pk_bf16_f32 v155, v35, v43
    buffer_store_dwordx4 v[152:155], v137, s[8:11], s25 offen offset:2048 sc1
    v_cvt_pk_bf16_f32 v156, v48, v56
    v_cvt_pk_bf16_f32 v157, v49, v57
    v_cvt_pk_bf16_f32 v158, v50, v58
    v_cvt_pk_bf16_f32 v159, v51, v59
    buffer_store_dwordx4 v[156:159], v137, s[8:11], s25 offen offset:3072 sc1
    v_cvt_pk_bf16_f32 v144, v4, v12
    v_cvt_pk_bf16_f32 v145, v5, v13
    v_cvt_pk_bf16_f32 v146, v6, v14
    v_cvt_pk_bf16_f32 v147, v7, v15
    s_add_u32 s25, s25, 4096
    buffer_store_dwordx4 v[144:147], v137, s[8:11], s25 offen sc1
    v_cvt_pk_bf16_f32 v148, v20, v28
    v_cvt_pk_bf16_f32 v149, v21, v29
    v_cvt_pk_bf16_f32 v150, v22, v30
    v_cvt_pk_bf16_f32 v151, v23, v31
    buffer_store_dwordx4 v[148:151], v137, s[8:11], s25 offen offset:1024 sc1
    v_cvt_pk_bf16_f32 v152, v36, v44
    v_cvt_pk_bf16_f32 v153, v37, v45
    v_cvt_pk_bf16_f32 v154, v38, v46
    v_cvt_pk_bf16_f32 v155, v39, v47
    buffer_store_dwordx4 v[152:155], v137, s[8:11], s25 offen offset:2048 sc1
    v_cvt_pk_bf16_f32 v156, v52, v60
    v_cvt_pk_bf16_f32 v157, v53, v61
    v_cvt_pk_bf16_f32 v158, v54, v62
    v_cvt_pk_bf16_f32 v159, v55, v63
    buffer_store_dwordx4 v[156:159], v137, s[8:11], s25 offen offset:3072 sc1
    s_branch L_p1_next
L_p1_v:
    s_waitcnt vmcnt(16)
    s_barrier
    ds_read_b64_tr_b16 v[64:65], v128
    ds_read_b64_tr_b16 v[66:67], v128 offset:1024
    ds_read_b64_tr_b16 v[68:69], v129
    ds_read_b64_tr_b16 v[70:71], v129 offset:1024
    ds_read_b64_tr_b16 v[72:73], v130
    ds_read_b64_tr_b16 v[74:75], v130 offset:1024
    ds_read_b64_tr_b16 v[76:77], v131
    ds_read_b64_tr_b16 v[78:79], v131 offset:1024
    ds_read_b64_tr_b16 v[80:81], v132
    ds_read_b64_tr_b16 v[82:83], v132 offset:1024
    ds_read_b64_tr_b16 v[84:85], v133
    ds_read_b64_tr_b16 v[86:87], v133 offset:1024
    ds_read_b64_tr_b16 v[88:89], v134
    ds_read_b64_tr_b16 v[90:91], v134 offset:1024
    s_waitcnt lgkmcnt(12)
    v_mfma_f32_16x16x32_bf16 v[0:3], a[0:3], v[64:67], 0
    ds_read_b64_tr_b16 v[92:93], v135
    v_mfma_f32_16x16x32_bf16 v[4:7], a[64:67], v[64:67], 0
    ds_read_b64_tr_b16 v[94:95], v135 offset:1024
    s_add_u32 s26, s24, 0x300000
    s_add_u32 m0, s29, 0x18000
    s_nop 0
    buffer_load_dwordx4 v136, s[16:19], s26 offen lds
    s_waitcnt lgkmcnt(12)
    v_mfma_f32_16x16x32_bf16 v[8:11], a[0:3], v[68:71], 0
    ds_read_b64_tr_b16 v[96:97], v128 offset:8192
    v_mfma_f32_16x16x32_bf16 v[12:15], a[64:67], v[68:71], 0
    ds_read_b64_tr_b16 v[98:99], v128 offset:9216
    s_add_u32 s26, s24, 0x320000
    s_add_u32 m0, s29, 0x19000
    s_nop 0
    buffer_load_dwordx4 v136, s[16:19], s26 offen lds
    s_waitcnt lgkmcnt(12)
    v_mfma_f32_16x16x32_bf16 v[16:19], a[0:3], v[72:75], 0
    ds_read_b64_tr_b16 v[100:101], v129 offset:8192
    v_mfma_f32_16x16x32_bf16 v[20:23], a[64:67], v[72:75], 0
    ds_read_b64_tr_b16 v[102:103], v129 offset:9216
    s_add_u32 s26, s24, 0x340000
    s_add_u32 m0, s29, 0x1a000
    s_nop 0
    buffer_load_dwordx4 v136, s[16:19], s26 offen lds
    s_waitcnt lgkmcnt(12)
    v_mfma_f32_16x16x32_bf16 v[24:27], a[0:3], v[76:79], 0
    ds_read_b64_tr_b16 v[104:105], v130 offset:8192
    v_mfma_f32_16x16x32_bf16 v[28:31], a[64:67], v[76:79], 0
    ds_read_b64_tr_b16 v[106:107], v130 offset:9216
    s_add_u32 s26, s24, 0x360000
    s_add_u32 m0, s29, 0x1b000
    s_nop 0
    buffer_load_dwordx4 v136, s[16:19], s26 offen lds
    s_waitcnt lgkmcnt(12)
    v_mfma_f32_16x16x32_bf16 v[32:35], a[0:3], v[80:83], 0
    ds_read_b64_tr_b16 v[108:109], v131 offset:8192
    v_mfma_f32_16x16x32_bf16 v[36:39], a[64:67], v[80:83], 0
    ds_read_b64_tr_b16 v[110:111], v131 offset:9216
    s_add_u32 s26, s24, 0x380000
    s_add_u32 m0, s29, 0x1c000
    s_nop 0
    buffer_load_dwordx4 v136, s[16:19], s26 offen lds
    s_waitcnt lgkmcnt(12)
    v_mfma_f32_16x16x32_bf16 v[40:43], a[0:3], v[84:87], 0
    ds_read_b64_tr_b16 v[112:113], v132 offset:8192
    v_mfma_f32_16x16x32_bf16 v[44:47], a[64:67], v[84:87], 0
    ds_read_b64_tr_b16 v[114:115], v132 offset:9216
    s_add_u32 s26, s24, 0x3a0000
    s_add_u32 m0, s29, 0x1d000
    s_nop 0
    buffer_load_dwordx4 v136, s[16:19], s26 offen lds
    s_waitcnt lgkmcnt(12)
    v_mfma_f32_16x16x32_bf16 v[48:51], a[0:3], v[88:91], 0
    ds_read_b64_tr_b16 v[116:117], v133 offset:8192
    v_mfma_f32_16x16x32_bf16 v[52:55], a[64:67], v[88:91], 0
    ds_read_b64_tr_b16 v[118:119], v133 offset:9216
    s_add_u32 s26, s24, 0x3c0000
    s_add_u32 m0, s29, 0x1e000
    s_nop 0
    buffer_load_dwordx4 v136, s[16:19], s26 offen lds
    s_waitcnt lgkmcnt(12)
    v_mfma_f32_16x16x32_bf16 v[56:59], a[0:3], v[92:95], 0
    ds_read_b64_tr_b16 v[120:121], v134 offset:8192
    v_mfma_f32_16x16x32_bf16 v[60:63], a[64:67], v[92:95], 0
    ds_read_b64_tr_b16 v[122:123], v134 offset:9216
    s_add_u32 s26, s24, 0x3e0000
    s_add_u32 m0, s29, 0x1f000
    s_nop 0
    buffer_load_dwordx4 v136, s[16:19], s26 offen lds
    s_waitcnt lgkmcnt(12)
    v_mfma_f32_16x16x32_bf16 v[0:3], a[4:7], v[96:99], v[0:3]
    ds_read_b64_tr_b16 v[124:125], v135 offset:8192
    v_mfma_f32_16x16x32_bf16 v[4:7], a[68:71], v[96:99], v[4:7]
    ds_read_b64_tr_b16 v[126:127], v135 offset:9216
    s_waitcnt lgkmcnt(12)
    v_mfma_f32_16x16x32_bf16 v[8:11], a[4:7], v[100:103], v[8:11]
    ds_read_b64_tr_b16 v[64:65], v128 offset:16384
    v_mfma_f32_16x16x32_bf16 v[12:15], a[68:71], v[100:103], v[12:15]
    ds_read_b64_tr_b16 v[66:67], v128 offset:17408
    s_waitcnt lgkmcnt(12)
    v_mfma_f32_16x16x32_bf16 v[16:19], a[4:7], v[104:107], v[16:19]
    ds_read_b64_tr_b16 v[68:69], v129 offset:16384
    v_mfma_f32_16x16x32_bf16 v[20:23], a[68:71], v[104:107], v[20:23]
    ds_read_b64_tr_b16 v[70:71], v129 offset:17408
    s_waitcnt lgkmcnt(12)
    v_mfma_f32_16x16x32_bf16 v[24:27], a[4:7], v[108:111], v[24:27]
    ds_read_b64_tr_b16 v[72:73], v130 offset:16384
    v_mfma_f32_16x16x32_bf16 v[28:31], a[68:71], v[108:111], v[28:31]
    ds_read_b64_tr_b16 v[74:75], v130 offset:17408
    s_waitcnt lgkmcnt(12)
    v_mfma_f32_16x16x32_bf16 v[32:35], a[4:7], v[112:115], v[32:35]
    ds_read_b64_tr_b16 v[76:77], v131 offset:16384
    v_mfma_f32_16x16x32_bf16 v[36:39], a[68:71], v[112:115], v[36:39]
    ds_read_b64_tr_b16 v[78:79], v131 offset:17408
    s_waitcnt lgkmcnt(12)
    v_mfma_f32_16x16x32_bf16 v[40:43], a[4:7], v[116:119], v[40:43]
    ds_read_b64_tr_b16 v[80:81], v132 offset:16384
    v_mfma_f32_16x16x32_bf16 v[44:47], a[68:71], v[116:119], v[44:47]
    ds_read_b64_tr_b16 v[82:83], v132 offset:17408
    s_waitcnt lgkmcnt(12)
    v_mfma_f32_16x16x32_bf16 v[48:51], a[4:7], v[120:123], v[48:51]
    ds_read_b64_tr_b16 v[84:85], v133 offset:16384
    v_mfma_f32_16x16x32_bf16 v[52:55], a[68:71], v[120:123], v[52:55]
    ds_read_b64_tr_b16 v[86:87], v133 offset:17408
    s_waitcnt lgkmcnt(12)
    v_mfma_f32_16x16x32_bf16 v[56:59], a[4:7], v[124:127], v[56:59]
    ds_read_b64_tr_b16 v[88:89], v134 offset:16384
    v_mfma_f32_16x16x32_bf16 v[60:63], a[68:71], v[124:127], v[60:63]
    ds_read_b64_tr_b16 v[90:91], v134 offset:17408
    s_waitcnt lgkmcnt(12)
    v_mfma_f32_16x16x32_bf16 v[0:3], a[8:11], v[64:67], v[0:3]
    ds_read_b64_tr_b16 v[92:93], v135 offset:16384
    v_mfma_f32_16x16x32_bf16 v[4:7], a[72:75], v[64:67], v[4:7]
    ds_read_b64_tr_b16 v[94:95], v135 offset:17408
    s_waitcnt lgkmcnt(12)
    v_mfma_f32_16x16x32_bf16 v[8:11], a[8:11], v[68:71], v[8:11]
    ds_read_b64_tr_b16 v[96:97], v128 offset:24576
    v_mfma_f32_16x16x32_bf16 v[12:15], a[72:75], v[68:71], v[12:15]
    ds_read_b64_tr_b16 v[98:99], v128 offset:25600
    s_waitcnt lgkmcnt(12)
    v_mfma_f32_16x16x32_bf16 v[16:19], a[8:11], v[72:75], v[16:19]
    ds_read_b64_tr_b16 v[100:101], v129 offset:24576
    v_mfma_f32_16x16x32_bf16 v[20:23], a[72:75], v[72:75], v[20:23]
    ds_read_b64_tr_b16 v[102:103], v129 offset:25600
    s_waitcnt lgkmcnt(12)
    v_mfma_f32_16x16x32_bf16 v[24:27], a[8:11], v[76:79], v[24:27]
    ds_read_b64_tr_b16 v[104:105], v130 offset:24576
    v_mfma_f32_16x16x32_bf16 v[28:31], a[72:75], v[76:79], v[28:31]
    ds_read_b64_tr_b16 v[106:107], v130 offset:25600
    s_waitcnt lgkmcnt(12)
    v_mfma_f32_16x16x32_bf16 v[32:35], a[8:11], v[80:83], v[32:35]
    ds_read_b64_tr_b16 v[108:109], v131 offset:24576
    v_mfma_f32_16x16x32_bf16 v[36:39], a[72:75], v[80:83], v[36:39]
    ds_read_b64_tr_b16 v[110:111], v131 offset:25600
    s_waitcnt lgkmcnt(12)
    v_mfma_f32_16x16x32_bf16 v[40:43], a[8:11], v[84:87], v[40:43]
    ds_read_b64_tr_b16 v[112:113], v132 offset:24576
    v_mfma_f32_16x16x32_bf16 v[44:47], a[72:75], v[84:87], v[44:47]
    ds_read_b64_tr_b16 v[114:115], v132 offset:25600
    s_waitcnt lgkmcnt(12)
    v_mfma_f32_16x16x32_bf16 v[48:51], a[8:11], v[88:91], v[48:51]
    ds_read_b64_tr_b16 v[116:117], v133 offset:24576
    v_mfma_f32_16x16x32_bf16 v[52:55], a[72:75], v[88:91], v[52:55]
    ds_read_b64_tr_b16 v[118:119], v133 offset:25600
    s_waitcnt lgkmcnt(12)
    v_mfma_f32_16x16x32_bf16 v[56:59], a[8:11], v[92:95], v[56:59]
    ds_read_b64_tr_b16 v[120:121], v134 offset:24576
    v_mfma_f32_16x16x32_bf16 v[60:63], a[72:75], v[92:95], v[60:63]
    ds_read_b64_tr_b16 v[122:123], v134 offset:25600
    s_waitcnt lgkmcnt(12)
    v_mfma_f32_16x16x32_bf16 v[0:3], a[12:15], v[96:99], v[0:3]
    ds_read_b64_tr_b16 v[124:125], v135 offset:24576
    v_mfma_f32_16x16x32_bf16 v[4:7], a[76:79], v[96:99], v[4:7]
    ds_read_b64_tr_b16 v[126:127], v135 offset:25600
    s_waitcnt lgkmcnt(12)
    v_mfma_f32_16x16x32_bf16 v[8:11], a[12:15], v[100:103], v[8:11]
    v_mfma_f32_16x16x32_bf16 v[12:15], a[76:79], v[100:103], v[12:15]
    s_waitcnt lgkmcnt(10)
    v_mfma_f32_16x16x32_bf16 v[16:19], a[12:15], v[104:107], v[16:19]
    v_mfma_f32_16x16x32_bf16 v[20:23], a[76:79], v[104:107], v[20:23]
    s_waitcnt lgkmcnt(8)
    v_mfma_f32_16x16x32_bf16 v[24:27], a[12:15], v[108:111], v[24:27]
    v_mfma_f32_16x16x32_bf16 v[28:31], a[76:79], v[108:111], v[28:31]
    s_waitcnt lgkmcnt(6)
    v_mfma_f32_16x16x32_bf16 v[32:35], a[12:15], v[112:115], v[32:35]
    v_mfma_f32_16x16x32_bf16 v[36:39], a[76:79], v[112:115], v[36:39]
    s_waitcnt lgkmcnt(4)
    v_mfma_f32_16x16x32_bf16 v[40:43], a[12:15], v[116:119], v[40:43]
    v_mfma_f32_16x16x32_bf16 v[44:47], a[76:79], v[116:119], v[44:47]
    s_waitcnt lgkmcnt(2)
    v_mfma_f32_16x16x32_bf16 v[48:51], a[12:15], v[120:123], v[48:51]
    v_mfma_f32_16x16x32_bf16 v[52:55], a[76:79], v[120:123], v[52:55]
    s_waitcnt lgkmcnt(0)
    v_mfma_f32_16x16x32_bf16 v[56:59], a[12:15], v[124:127], v[56:59]
    v_mfma_f32_16x16x32_bf16 v[60:63], a[76:79], v[124:127], v[60:63]
    s_waitcnt vmcnt(16)
    s_barrier
    ds_read_b64_tr_b16 v[64:65], v128 offset:32768
    ds_read_b64_tr_b16 v[66:67], v128 offset:33792
    ds_read_b64_tr_b16 v[68:69], v129 offset:32768
    ds_read_b64_tr_b16 v[70:71], v129 offset:33792
    ds_read_b64_tr_b16 v[72:73], v130 offset:32768
    ds_read_b64_tr_b16 v[74:75], v130 offset:33792
    ds_read_b64_tr_b16 v[76:77], v131 offset:32768
    ds_read_b64_tr_b16 v[78:79], v131 offset:33792
    ds_read_b64_tr_b16 v[80:81], v132 offset:32768
    ds_read_b64_tr_b16 v[82:83], v132 offset:33792
    ds_read_b64_tr_b16 v[84:85], v133 offset:32768
    ds_read_b64_tr_b16 v[86:87], v133 offset:33792
    ds_read_b64_tr_b16 v[88:89], v134 offset:32768
    ds_read_b64_tr_b16 v[90:91], v134 offset:33792
    s_add_u32 s39, s39, s37
    s_lshr_b32 s26, s39, 5
    s_cmp_eq_u32 s26, 0
    s_cselect_b64 s[16:17], s[30:31], s[34:35]
    s_cmp_eq_u32 s26, 1
    s_cselect_b64 s[16:17], s[32:33], s[16:17]
    s_and_b32 s17, s17, 0xffff
    s_cmp_lt_u32 s39, 96
    s_cselect_b32 s18, 0x400000, 0
    s_and_b32 s24, s39, 31
    s_lshl_b32 s24, s24, 8
    s_waitcnt lgkmcnt(12)
    v_mfma_f32_16x16x32_bf16 v[0:3], a[16:19], v[64:67], v[0:3]
    ds_read_b64_tr_b16 v[92:93], v135 offset:32768
    v_mfma_f32_16x16x32_bf16 v[4:7], a[80:83], v[64:67], v[4:7]
    ds_read_b64_tr_b16 v[94:95], v135 offset:33792
    s_add_u32 s26, s24, 0x0
    s_add_u32 m0, s29, 0x0
    s_nop 0
    buffer_load_dwordx4 v136, s[16:19], s26 offen lds
    s_waitcnt lgkmcnt(12)
    v_mfma_f32_16x16x32_bf16 v[8:11], a[16:19], v[68:71], v[8:11]
    ds_read_b64_tr_b16 v[96:97], v128 offset:40960
    v_mfma_f32_16x16x32_bf16 v[12:15], a[80:83], v[68:71], v[12:15]
    ds_read_b64_tr_b16 v[98:99], v128 offset:41984
    s_add_u32 s26, s24, 0x20000
    s_add_u32 m0, s29, 0x1000
    s_nop 0
    buffer_load_dwordx4 v136, s[16:19], s26 offen lds
    s_waitcnt lgkmcnt(12)
    v_mfma_f32_16x16x32_bf16 v[16:19], a[16:19], v[72:75], v[16:19]
    ds_read_b64_tr_b16 v[100:101], v129 offset:40960
    v_mfma_f32_16x16x32_bf16 v[20:23], a[80:83], v[72:75], v[20:23]
    ds_read_b64_tr_b16 v[102:103], v129 offset:41984
    s_add_u32 s26, s24, 0x40000
    s_add_u32 m0, s29, 0x2000
    s_nop 0
    buffer_load_dwordx4 v136, s[16:19], s26 offen lds
    s_waitcnt lgkmcnt(12)
    v_mfma_f32_16x16x32_bf16 v[24:27], a[16:19], v[76:79], v[24:27]
    ds_read_b64_tr_b16 v[104:105], v130 offset:40960
    v_mfma_f32_16x16x32_bf16 v[28:31], a[80:83], v[76:79], v[28:31]
    ds_read_b64_tr_b16 v[106:107], v130 offset:41984
    s_add_u32 s26, s24, 0x60000
    s_add_u32 m0, s29, 0x3000
    s_nop 0
    buffer_load_dwordx4 v136, s[16:19], s26 offen lds
    s_waitcnt lgkmcnt(12)
    v_mfma_f32_16x16x32_bf16 v[32:35], a[16:19], v[80:83], v[32:35]
    ds_read_b64_tr_b16 v[108:109], v131 offset:40960
    v_mfma_f32_16x16x32_bf16 v[36:39], a[80:83], v[80:83], v[36:39]
    ds_read_b64_tr_b16 v[110:111], v131 offset:41984
    s_add_u32 s26, s24, 0x80000
    s_add_u32 m0, s29, 0x4000
    s_nop 0
    buffer_load_dwordx4 v136, s[16:19], s26 offen lds
    s_waitcnt lgkmcnt(12)
    v_mfma_f32_16x16x32_bf16 v[40:43], a[16:19], v[84:87], v[40:43]
    ds_read_b64_tr_b16 v[112:113], v132 offset:40960
    v_mfma_f32_16x16x32_bf16 v[44:47], a[80:83], v[84:87], v[44:47]
    ds_read_b64_tr_b16 v[114:115], v132 offset:41984
    s_add_u32 s26, s24, 0xa0000
    s_add_u32 m0, s29, 0x5000
    s_nop 0
    buffer_load_dwordx4 v136, s[16:19], s26 offen lds
    s_waitcnt lgkmcnt(12)
    v_mfma_f32_16x16x32_bf16 v[48:51], a[16:19], v[88:91], v[48:51]
    ds_read_b64_tr_b16 v[116:117], v133 offset:40960
    v_mfma_f32_16x16x32_bf16 v[52:55], a[80:83], v[88:91], v[52:55]
    ds_read_b64_tr_b16 v[118:119], v133 offset:41984
    s_add_u32 s26, s24, 0xc0000
    s_add_u32 m0, s29, 0x6000
    s_nop 0
    buffer_load_dwordx4 v136, s[16:19], s26 offen lds
    s_waitcnt lgkmcnt(12)
    v_mfma_f32_16x16x32_bf16 v[56:59], a[16:19], v[92:95], v[56:59]
    ds_read_b64_tr_b16 v[120:121], v134 offset:40960
    v_mfma_f32_16x16x32_bf16 v[60:63], a[80:83], v[92:95], v[60:63]
    ds_read_b64_tr_b16 v[122:123], v134 offset:41984
    s_add_u32 s26, s24, 0xe0000
    s_add_u32 m0, s29, 0x7000
    s_nop 0
    buffer_load_dwordx4 v136, s[16:19], s26 offen lds
    s_waitcnt lgkmcnt(12)
    v_mfma_f32_16x16x32_bf16 v[0:3], a[20:23], v[96:99], v[0:3]
    ds_read_b64_tr_b16 v[124:125], v135 offset:40960
    v_mfma_f32_16x16x32_bf16 v[4:7], a[84:87], v[96:99], v[4:7]
    ds_read_b64_tr_b16 v[126:127], v135 offset:41984
    s_waitcnt lgkmcnt(12)
    v_mfma_f32_16x16x32_bf16 v[8:11], a[20:23], v[100:103], v[8:11]
    ds_read_b64_tr_b16 v[64:65], v128 offset:49152
    v_mfma_f32_16x16x32_bf16 v[12:15], a[84:87], v[100:103], v[12:15]
    ds_read_b64_tr_b16 v[66:67], v128 offset:50176
    s_waitcnt lgkmcnt(12)
    v_mfma_f32_16x16x32_bf16 v[16:19], a[20:23], v[104:107], v[16:19]
    ds_read_b64_tr_b16 v[68:69], v129 offset:49152
    v_mfma_f32_16x16x32_bf16 v[20:23], a[84:87], v[104:107], v[20:23]
    ds_read_b64_tr_b16 v[70:71], v129 offset:50176
    s_waitcnt lgkmcnt(12)
    v_mfma_f32_16x16x32_bf16 v[24:27], a[20:23], v[108:111], v[24:27]
    ds_read_b64_tr_b16 v[72:73], v130 offset:49152
    v_mfma_f32_16x16x32_bf16 v[28:31], a[84:87], v[108:111], v[28:31]
    ds_read_b64_tr_b16 v[74:75], v130 offset:50176
    s_waitcnt lgkmcnt(12)
    v_mfma_f32_16x16x32_bf16 v[32:35], a[20:23], v[112:115], v[32:35]
    ds_read_b64_tr_b16 v[76:77], v131 offset:49152
    v_mfma_f32_16x16x32_bf16 v[36:39], a[84:87], v[112:115], v[36:39]
    ds_read_b64_tr_b16 v[78:79], v131 offset:50176
    s_waitcnt lgkmcnt(12)
    v_mfma_f32_16x16x32_bf16 v[40:43], a[20:23], v[116:119], v[40:43]
    ds_read_b64_tr_b16 v[80:81], v132 offset:49152
    v_mfma_f32_16x16x32_bf16 v[44:47], a[84:87], v[116:119], v[44:47]
    ds_read_b64_tr_b16 v[82:83], v132 offset:50176
    s_waitcnt lgkmcnt(12)
    v_mfma_f32_16x16x32_bf16 v[48:51], a[20:23], v[120:123], v[48:51]
    ds_read_b64_tr_b16 v[84:85], v133 offset:49152
    v_mfma_f32_16x16x32_bf16 v[52:55], a[84:87], v[120:123], v[52:55]
    ds_read_b64_tr_b16 v[86:87], v133 offset:50176
    s_waitcnt lgkmcnt(12)
    v_mfma_f32_16x16x32_bf16 v[56:59], a[20:23], v[124:127], v[56:59]
    ds_read_b64_tr_b16 v[88:89], v134 offset:49152
    v_mfma_f32_16x16x32_bf16 v[60:63], a[84:87], v[124:127], v[60:63]
    ds_read_b64_tr_b16 v[90:91], v134 offset:50176
    s_waitcnt lgkmcnt(12)
    v_mfma_f32_16x16x32_bf16 v[0:3], a[24:27], v[64:67], v[0:3]
    ds_read_b64_tr_b16 v[92:93], v135 offset:49152
    v_mfma_f32_16x16x32_bf16 v[4:7], a[88:91], v[64:67], v[4:7]
    ds_read_b64_tr_b16 v[94:95], v135 offset:50176
    s_waitcnt lgkmcnt(12)
    v_mfma_f32_16x16x32_bf16 v[8:11], a[24:27], v[68:71], v[8:11]
    ds_read_b64_tr_b16 v[96:97], v128 offset:57344
    v_mfma_f32_16x16x32_bf16 v[12:15], a[88:91], v[68:71], v[12:15]
    ds_read_b64_tr_b16 v[98:99], v128 offset:58368
    s_waitcnt lgkmcnt(12)
    v_mfma_f32_16x16x32_bf16 v[16:19], a[24:27], v[72:75], v[16:19]
    ds_read_b64_tr_b16 v[100:101], v129 offset:57344
    v_mfma_f32_16x16x32_bf16 v[20:23], a[88:91], v[72:75], v[20:23]
    ds_read_b64_tr_b16 v[102:103], v129 offset:58368
    s_waitcnt lgkmcnt(12)
    v_mfma_f32_16x16x32_bf16 v[24:27], a[24:27], v[76:79], v[24:27]
    ds_read_b64_tr_b16 v[104:105], v130 offset:57344
    v_mfma_f32_16x16x32_bf16 v[28:31], a[88:91], v[76:79], v[28:31]
    ds_read_b64_tr_b16 v[106:107], v130 offset:58368
    s_waitcnt lgkmcnt(12)
    v_mfma_f32_16x16x32_bf16 v[32:35], a[24:27], v[80:83], v[32:35]
    ds_read_b64_tr_b16 v[108:109], v131 offset:57344
    v_mfma_f32_16x16x32_bf16 v[36:39], a[88:91], v[80:83], v[36:39]
    ds_read_b64_tr_b16 v[110:111], v131 offset:58368
    s_waitcnt lgkmcnt(12)
    v_mfma_f32_16x16x32_bf16 v[40:43], a[24:27], v[84:87], v[40:43]
    ds_read_b64_tr_b16 v[112:113], v132 offset:57344
    v_mfma_f32_16x16x32_bf16 v[44:47], a[88:91], v[84:87], v[44:47]
    ds_read_b64_tr_b16 v[114:115], v132 offset:58368
    s_waitcnt lgkmcnt(12)
    v_mfma_f32_16x16x32_bf16 v[48:51], a[24:27], v[88:91], v[48:51]
    ds_read_b64_tr_b16 v[116:117], v133 offset:57344
    v_mfma_f32_16x16x32_bf16 v[52:55], a[88:91], v[88:91], v[52:55]
    ds_read_b64_tr_b16 v[118:119], v133 offset:58368
    s_waitcnt lgkmcnt(12)
    v_mfma_f32_16x16x32_bf16 v[56:59], a[24:27], v[92:95], v[56:59]
    ds_read_b64_tr_b16 v[120:121], v134 offset:57344
    v_mfma_f32_16x16x32_bf16 v[60:63], a[88:91], v[92:95], v[60:63]
    ds_read_b64_tr_b16 v[122:123], v134 offset:58368
    s_waitcnt lgkmcnt(12)
    v_mfma_f32_16x16x32_bf16 v[0:3], a[28:31], v[96:99], v[0:3]
    ds_read_b64_tr_b16 v[124:125], v135 offset:57344
    v_mfma_f32_16x16x32_bf16 v[4:7], a[92:95], v[96:99], v[4:7]
    ds_read_b64_tr_b16 v[126:127], v135 offset:58368
    s_waitcnt lgkmcnt(12)
    v_mfma_f32_16x16x32_bf16 v[8:11], a[28:31], v[100:103], v[8:11]
    v_mfma_f32_16x16x32_bf16 v[12:15], a[92:95], v[100:103], v[12:15]
    s_waitcnt lgkmcnt(10)
    v_mfma_f32_16x16x32_bf16 v[16:19], a[28:31], v[104:107], v[16:19]
    v_mfma_f32_16x16x32_bf16 v[20:23], a[92:95], v[104:107], v[20:23]
    s_waitcnt lgkmcnt(8)
    v_mfma_f32_16x16x32_bf16 v[24:27], a[28:31], v[108:111], v[24:27]
    v_mfma_f32_16x16x32_bf16 v[28:31], a[92:95], v[108:111], v[28:31]
    s_waitcnt lgkmcnt(6)
    v_mfma_f32_16x16x32_bf16 v[32:35], a[28:31], v[112:115], v[32:35]
    v_mfma_f32_16x16x32_bf16 v[36:39], a[92:95], v[112:115], v[36:39]
    s_waitcnt lgkmcnt(4)
    v_mfma_f32_16x16x32_bf16 v[40:43], a[28:31], v[116:119], v[40:43]
    v_mfma_f32_16x16x32_bf16 v[44:47], a[92:95], v[116:119], v[44:47]
    s_waitcnt lgkmcnt(2)
    v_mfma_f32_16x16x32_bf16 v[48:51], a[28:31], v[120:123], v[48:51]
    v_mfma_f32_16x16x32_bf16 v[52:55], a[92:95], v[120:123], v[52:55]
    s_waitcnt lgkmcnt(0)
    v_mfma_f32_16x16x32_bf16 v[56:59], a[28:31], v[124:127], v[56:59]
    v_mfma_f32_16x16x32_bf16 v[60:63], a[92:95], v[124:127], v[60:63]
    v_xor_b32 v128, 0x10000, v128
    v_xor_b32 v129, 0x10000, v129
    v_xor_b32 v130, 0x10000, v130
    v_xor_b32 v131, 0x10000, v131
    v_xor_b32 v132, 0x10000, v132
    v_xor_b32 v133, 0x10000, v133
    v_xor_b32 v134, 0x10000, v134
    v_xor_b32 v135, 0x10000, v135
    s_waitcnt vmcnt(16)
    s_barrier
    ds_read_b64_tr_b16 v[64:65], v128
    ds_read_b64_tr_b16 v[66:67], v128 offset:1024
    ds_read_b64_tr_b16 v[68:69], v129
    ds_read_b64_tr_b16 v[70:71], v129 offset:1024
    ds_read_b64_tr_b16 v[72:73], v130
    ds_read_b64_tr_b16 v[74:75], v130 offset:1024
    ds_read_b64_tr_b16 v[76:77], v131
    ds_read_b64_tr_b16 v[78:79], v131 offset:1024
    ds_read_b64_tr_b16 v[80:81], v132
    ds_read_b64_tr_b16 v[82:83], v132 offset:1024
    ds_read_b64_tr_b16 v[84:85], v133
    ds_read_b64_tr_b16 v[86:87], v133 offset:1024
    ds_read_b64_tr_b16 v[88:89], v134
    ds_read_b64_tr_b16 v[90:91], v134 offset:1024
    s_cmp_eq_u32 s40, 0
    s_cbranch_scc1 L_nopf_89
    s_cmp_lg_u32 s87, 0
    s_cbranch_scc1 L_modeok_90
    s_mov_b32 s96, 0
L_mode_91:
    buffer_load_dwordx2 v[140:141], off, s[92:95], 0 offset:36 sc1
    s_waitcnt vmcnt(0)
    v_readfirstlane_b32 s87, v140
    v_readfirstlane_b32 s97, v141
    s_nop 0
    s_min_u32 s97, s97, s87
    s_cmp_lg_u32 s97, 0
    s_cbranch_scc1 L_moded_92
    s_sleep 4
    s_add_u32 s96, s96, 1
    s_cmp_lg_u32 s96, 0x100
    s_cbranch_scc1 L_modef_93
    v_mov_b32 v140, 2
    v_mov_b32 v141, 0
    s_mov_b64 exec, 1
    buffer_atomic_cmpswap v[140:141], off, s[92:95], 0 offset:36
    s_mov_b64 exec, -1
L_modef_93:
    s_cmp_lt_u32 s96, 0x10000
    s_cbranch_scc1 L_mode_91
L_moded_92:
    s_cmp_lg_u32 s87, 1
    s_cbranch_scc1 L_fallback
L_modeok_90:
    s_cmp_lg_u32 s100, 0
    s_cbranch_scc1 L_flag_94
    v_mov_b32 v138, 1
    s_mov_b64 exec, 1
    buffer_store_dword v138, off, s[8:11], s40 sc1
    s_mov_b64 exec, -1
L_flag_94:
    s_mov_b32 s40, 0
L_nopf_89:
    s_waitcnt lgkmcnt(12)
    v_mfma_f32_16x16x32_bf16 v[0:3], a[32:35], v[64:67], v[0:3]
    ds_read_b64_tr_b16 v[92:93], v135
    v_mfma_f32_16x16x32_bf16 v[4:7], a[96:99], v[64:67], v[4:7]
    ds_read_b64_tr_b16 v[94:95], v135 offset:1024
    s_add_u32 s26, s24, 0x100000
    s_add_u32 m0, s29, 0x8000
    s_nop 0
    buffer_load_dwordx4 v136, s[16:19], s26 offen lds
    s_waitcnt lgkmcnt(12)
    v_mfma_f32_16x16x32_bf16 v[8:11], a[32:35], v[68:71], v[8:11]
    ds_read_b64_tr_b16 v[96:97], v128 offset:8192
    v_mfma_f32_16x16x32_bf16 v[12:15], a[96:99], v[68:71], v[12:15]
    ds_read_b64_tr_b16 v[98:99], v128 offset:9216
    s_add_u32 s26, s24, 0x120000
    s_add_u32 m0, s29, 0x9000
    s_nop 0
    buffer_load_dwordx4 v136, s[16:19], s26 offen lds
    s_waitcnt lgkmcnt(12)
    v_mfma_f32_16x16x32_bf16 v[16:19], a[32:35], v[72:75], v[16:19]
    ds_read_b64_tr_b16 v[100:101], v129 offset:8192
    v_mfma_f32_16x16x32_bf16 v[20:23], a[96:99], v[72:75], v[20:23]
    ds_read_b64_tr_b16 v[102:103], v129 offset:9216
    s_add_u32 s26, s24, 0x140000
    s_add_u32 m0, s29, 0xa000
    s_nop 0
    buffer_load_dwordx4 v136, s[16:19], s26 offen lds
    s_waitcnt lgkmcnt(12)
    v_mfma_f32_16x16x32_bf16 v[24:27], a[32:35], v[76:79], v[24:27]
    ds_read_b64_tr_b16 v[104:105], v130 offset:8192
    v_mfma_f32_16x16x32_bf16 v[28:31], a[96:99], v[76:79], v[28:31]
    ds_read_b64_tr_b16 v[106:107], v130 offset:9216
    s_add_u32 s26, s24, 0x160000
    s_add_u32 m0, s29, 0xb000
    s_nop 0
    buffer_load_dwordx4 v136, s[16:19], s26 offen lds
    s_waitcnt lgkmcnt(12)
    v_mfma_f32_16x16x32_bf16 v[32:35], a[32:35], v[80:83], v[32:35]
    ds_read_b64_tr_b16 v[108:109], v131 offset:8192
    v_mfma_f32_16x16x32_bf16 v[36:39], a[96:99], v[80:83], v[36:39]
    ds_read_b64_tr_b16 v[110:111], v131 offset:9216
    s_add_u32 s26, s24, 0x180000
    s_add_u32 m0, s29, 0xc000
    s_nop 0
    buffer_load_dwordx4 v136, s[16:19], s26 offen lds
    s_waitcnt lgkmcnt(12)
    v_mfma_f32_16x16x32_bf16 v[40:43], a[32:35], v[84:87], v[40:43]
    ds_read_b64_tr_b16 v[112:113], v132 offset:8192
    v_mfma_f32_16x16x32_bf16 v[44:47], a[96:99], v[84:87], v[44:47]
    ds_read_b64_tr_b16 v[114:115], v132 offset:9216
    s_add_u32 s26, s24, 0x1a0000
    s_add_u32 m0, s29, 0xd000
    s_nop 0
    buffer_load_dwordx4 v136, s[16:19], s26 offen lds
    s_waitcnt lgkmcnt(12)
    v_mfma_f32_16x16x32_bf16 v[48:51], a[32:35], v[88:91], v[48:51]
    ds_read_b64_tr_b16 v[116:117], v133 offset:8192
    v_mfma_f32_16x16x32_bf16 v[52:55], a[96:99], v[88:91], v[52:55]
    ds_read_b64_tr_b16 v[118:119], v133 offset:9216
    s_add_u32 s26, s24, 0x1c0000
    s_add_u32 m0, s29, 0xe000
    s_nop 0
    buffer_load_dwordx4 v136, s[16:19], s26 offen lds
    s_waitcnt lgkmcnt(12)
    v_mfma_f32_16x16x32_bf16 v[56:59], a[32:35], v[92:95], v[56:59]
    ds_read_b64_tr_b16 v[120:121], v134 offset:8192
    v_mfma_f32_16x16x32_bf16 v[60:63], a[96:99], v[92:95], v[60:63]
    ds_read_b64_tr_b16 v[122:123], v134 offset:9216
    s_add_u32 s26, s24, 0x1e0000
    s_add_u32 m0, s29, 0xf000
    s_nop 0
    buffer_load_dwordx4 v136, s[16:19], s26 offen lds
    s_waitcnt lgkmcnt(12)
    v_mfma_f32_16x16x32_bf16 v[0:3], a[36:39], v[96:99], v[0:3]
    ds_read_b64_tr_b16 v[124:125], v135 offset:8192
    v_mfma_f32_16x16x32_bf16 v[4:7], a[100:103], v[96:99], v[4:7]
    ds_read_b64_tr_b16 v[126:127], v135 offset:9216
    s_waitcnt lgkmcnt(12)
    v_mfma_f32_16x16x32_bf16 v[8:11], a[36:39], v[100:103], v[8:11]
    ds_read_b64_tr_b16 v[64:65], v128 offset:16384
    v_mfma_f32_16x16x32_bf16 v[12:15], a[100:103], v[100:103], v[12:15]
    ds_read_b64_tr_b16 v[66:67], v128 offset:17408
    s_waitcnt lgkmcnt(12)
    v_mfma_f32_16x16x32_bf16 v[16:19], a[36:39], v[104:107], v[16:19]
    ds_read_b64_tr_b16 v[68:69], v129 offset:16384
    v_mfma_f32_16x16x32_bf16 v[20:23], a[100:103], v[104:107], v[20:23]
    ds_read_b64_tr_b16 v[70:71], v129 offset:17408
    s_waitcnt lgkmcnt(12)
    v_mfma_f32_16x16x32_bf16 v[24:27], a[36:39], v[108:111], v[24:27]
    ds_read_b64_tr_b16 v[72:73], v130 offset:16384
    v_mfma_f32_16x16x32_bf16 v[28:31], a[100:103], v[108:111], v[28:31]
    ds_read_b64_tr_b16 v[74:75], v130 offset:17408
    s_waitcnt lgkmcnt(12)
    v_mfma_f32_16x16x32_bf16 v[32:35], a[36:39], v[112:115], v[32:35]
    ds_read_b64_tr_b16 v[76:77], v131 offset:16384
    v_mfma_f32_16x16x32_bf16 v[36:39], a[100:103], v[112:115], v[36:39]
    ds_read_b64_tr_b16 v[78:79], v131 offset:17408
    s_waitcnt lgkmcnt(12)
    v_mfma_f32_16x16x32_bf16 v[40:43], a[36:39], v[116:119], v[40:43]
    ds_read_b64_tr_b16 v[80:81], v132 offset:16384
    v_mfma_f32_16x16x32_bf16 v[44:47], a[100:103], v[116:119], v[44:47]
    ds_read_b64_tr_b16 v[82:83], v132 offset:17408
    s_waitcnt lgkmcnt(12)
    v_mfma_f32_16x16x32_bf16 v[48:51], a[36:39], v[120:123], v[48:51]
    ds_read_b64_tr_b16 v[84:85], v133 offset:16384
    v_mfma_f32_16x16x32_bf16 v[52:55], a[100:103], v[120:123], v[52:55]
    ds_read_b64_tr_b16 v[86:87], v133 offset:17408
    s_waitcnt lgkmcnt(12)
    v_mfma_f32_16x16x32_bf16 v[56:59], a[36:39], v[124:127], v[56:59]
    ds_read_b64_tr_b16 v[88:89], v134 offset:16384
    v_mfma_f32_16x16x32_bf16 v[60:63], a[100:103], v[124:127], v[60:63]
    ds_read_b64_tr_b16 v[90:91], v134 offset:17408
    s_waitcnt lgkmcnt(12)
    v_mfma_f32_16x16x32_bf16 v[0:3], a[40:43], v[64:67], v[0:3]
    ds_read_b64_tr_b16 v[92:93], v135 offset:16384
    v_mfma_f32_16x16x32_bf16 v[4:7], a[104:107], v[64:67], v[4:7]
    ds_read_b64_tr_b16 v[94:95], v135 offset:17408
    s_waitcnt lgkmcnt(12)
    v_mfma_f32_16x16x32_bf16 v[8:11], a[40:43], v[68:71], v[8:11]
    ds_read_b64_tr_b16 v[96:97], v128 offset:24576
    v_mfma_f32_16x16x32_bf16 v[12:15], a[104:107], v[68:71], v[12:15]
    ds_read_b64_tr_b16 v[98:99], v128 offset:25600
    s_waitcnt lgkmcnt(12)
    v_mfma_f32_16x16x32_bf16 v[16:19], a[40:43], v[72:75], v[16:19]
    ds_read_b64_tr_b16 v[100:101], v129 offset:24576
    v_mfma_f32_16x16x32_bf16 v[20:23], a[104:107], v[72:75], v[20:23]
    ds_read_b64_tr_b16 v[102:103], v129 offset:25600
    s_waitcnt lgkmcnt(12)
    v_mfma_f32_16x16x32_bf16 v[24:27], a[40:43], v[76:79], v[24:27]
    ds_read_b64_tr_b16 v[104:105], v130 offset:24576
    v_mfma_f32_16x16x32_bf16 v[28:31], a[104:107], v[76:79], v[28:31]
    ds_read_b64_tr_b16 v[106:107], v130 offset:25600
    s_waitcnt lgkmcnt(12)
    v_mfma_f32_16x16x32_bf16 v[32:35], a[40:43], v[80:83], v[32:35]
    ds_read_b64_tr_b16 v[108:109], v131 offset:24576
    v_mfma_f32_16x16x32_bf16 v[36:39], a[104:107], v[80:83], v[36:39]
    ds_read_b64_tr_b16 v[110:111], v131 offset:25600
    s_waitcnt lgkmcnt(12)
    v_mfma_f32_16x16x32_bf16 v[40:43], a[40:43], v[84:87], v[40:43]
    ds_read_b64_tr_b16 v[112:113], v132 offset:24576
    v_mfma_f32_16x16x32_bf16 v[44:47], a[104:107], v[84:87], v[44:47]
    ds_read_b64_tr_b16 v[114:115], v132 offset:25600
    s_waitcnt lgkmcnt(12)
    v_mfma_f32_16x16x32_bf16 v[48:51], a[40:43], v[88:91], v[48:51]
    ds_read_b64_tr_b16 v[116:117], v133 offset:24576
    v_mfma_f32_16x16x32_bf16 v[52:55], a[104:107], v[88:91], v[52:55]
    ds_read_b64_tr_b16 v[118:119], v133 offset:25600
    s_waitcnt lgkmcnt(12)
    v_mfma_f32_16x16x32_bf16 v[56:59], a[40:43], v[92:95], v[56:59]
    ds_read_b64_tr_b16 v[120:121], v134 offset:24576
    v_mfma_f32_16x16x32_bf16 v[60:63], a[104:107], v[92:95], v[60:63]
    ds_read_b64_tr_b16 v[122:123], v134 offset:25600
    s_waitcnt lgkmcnt(12)
    v_mfma_f32_16x16x32_bf16 v[0:3], a[44:47], v[96:99], v[0:3]
    ds_read_b64_tr_b16 v[124:125], v135 offset:24576
    v_mfma_f32_16x16x32_bf16 v[4:7], a[108:111], v[96:99], v[4:7]
    ds_read_b64_tr_b16 v[126:127], v135 offset:25600
    s_waitcnt lgkmcnt(12)
    v_mfma_f32_16x16x32_bf16 v[8:11], a[44:47], v[100:103], v[8:11]
    v_mfma_f32_16x16x32_bf16 v[12:15], a[108:111], v[100:103], v[12:15]
    s_waitcnt lgkmcnt(10)
    v_mfma_f32_16x16x32_bf16 v[16:19], a[44:47], v[104:107], v[16:19]
    v_mfma_f32_16x16x32_bf16 v[20:23], a[108:111], v[104:107], v[20:23]
    s_waitcnt lgkmcnt(8)
    v_mfma_f32_16x16x32_bf16 v[24:27], a[44:47], v[108:111], v[24:27]
    v_mfma_f32_16x16x32_bf16 v[28:31], a[108:111], v[108:111], v[28:31]
    s_waitcnt lgkmcnt(6)
    v_mfma_f32_16x16x32_bf16 v[32:35], a[44:47], v[112:115], v[32:35]
    v_mfma_f32_16x16x32_bf16 v[36:39], a[108:111], v[112:115], v[36:39]
    s_waitcnt lgkmcnt(4)
    v_mfma_f32_16x16x32_bf16 v[40:43], a[44:47], v[116:119], v[40:43]
    v_mfma_f32_16x16x32_bf16 v[44:47], a[108:111], v[116:119], v[44:47]
    s_waitcnt lgkmcnt(2)
    v_mfma_f32_16x16x32_bf16 v[48:51], a[44:47], v[120:123], v[48:51]
    v_mfma_f32_16x16x32_bf16 v[52:55], a[108:111], v[120:123], v[52:55]
    s_waitcnt lgkmcnt(0)
    v_mfma_f32_16x16x32_bf16 v[56:59], a[44:47], v[124:127], v[56:59]
    v_mfma_f32_16x16x32_bf16 v[60:63], a[108:111], v[124:127], v[60:63]
    s_waitcnt vmcnt(16)
    s_barrier
    ds_read_b64_tr_b16 v[64:65], v128 offset:32768
    ds_read_b64_tr_b16 v[66:67], v128 offset:33792
    ds_read_b64_tr_b16 v[68:69], v129 offset:32768
    ds_read_b64_tr_b16 v[70:71], v129 offset:33792
    ds_read_b64_tr_b16 v[72:73], v130 offset:32768
    ds_read_b64_tr_b16 v[74:75], v130 offset:33792
    ds_read_b64_tr_b16 v[76:77], v131 offset:32768
    ds_read_b64_tr_b16 v[78:79], v131 offset:33792
    ds_read_b64_tr_b16 v[80:81], v132 offset:32768
    ds_read_b64_tr_b16 v[82:83], v132 offset:33792
    ds_read_b64_tr_b16 v[84:85], v133 offset:32768
    ds_read_b64_tr_b16 v[86:87], v133 offset:33792
    ds_read_b64_tr_b16 v[88:89], v134 offset:32768
    ds_read_b64_tr_b16 v[90:91], v134 offset:33792
    s_waitcnt lgkmcnt(12)
    v_mfma_f32_16x16x32_bf16 v[0:3], a[48:51], v[64:67], v[0:3]
    ds_read_b64_tr_b16 v[92:93], v135 offset:32768
    v_mfma_f32_16x16x32_bf16 v[4:7], a[112:115], v[64:67], v[4:7]
    ds_read_b64_tr_b16 v[94:95], v135 offset:33792
    s_add_u32 s26, s24, 0x200000
    s_add_u32 m0, s29, 0x10000
    s_nop 0
    buffer_load_dwordx4 v136, s[16:19], s26 offen lds
    s_waitcnt lgkmcnt(12)
    v_mfma_f32_16x16x32_bf16 v[8:11], a[48:51], v[68:71], v[8:11]
    ds_read_b64_tr_b16 v[96:97], v128 offset:40960
    v_mfma_f32_16x16x32_bf16 v[12:15], a[112:115], v[68:71], v[12:15]
    ds_read_b64_tr_b16 v[98:99], v128 offset:41984
    s_add_u32 s26, s24, 0x220000
    s_add_u32 m0, s29, 0x11000
    s_nop 0
    buffer_load_dwordx4 v136, s[16:19], s26 offen lds
    s_waitcnt lgkmcnt(12)
    v_mfma_f32_16x16x32_bf16 v[16:19], a[48:51], v[72:75], v[16:19]
    ds_read_b64_tr_b16 v[100:101], v129 offset:40960
    v_mfma_f32_16x16x32_bf16 v[20:23], a[112:115], v[72:75], v[20:23]
    ds_read_b64_tr_b16 v[102:103], v129 offset:41984
    s_add_u32 s26, s24, 0x240000
    s_add_u32 m0, s29, 0x12000
    s_nop 0
    buffer_load_dwordx4 v136, s[16:19], s26 offen lds
    s_waitcnt lgkmcnt(12)
    v_mfma_f32_16x16x32_bf16 v[24:27], a[48:51], v[76:79], v[24:27]
    ds_read_b64_tr_b16 v[104:105], v130 offset:40960
    v_mfma_f32_16x16x32_bf16 v[28:31], a[112:115], v[76:79], v[28:31]
    ds_read_b64_tr_b16 v[106:107], v130 offset:41984
    s_add_u32 s26, s24, 0x260000
    s_add_u32 m0, s29, 0x13000
    s_nop 0
    buffer_load_dwordx4 v136, s[16:19], s26 offen lds
    s_waitcnt lgkmcnt(12)
    v_mfma_f32_16x16x32_bf16 v[32:35], a[48:51], v[80:83], v[32:35]
    ds_read_b64_tr_b16 v[108:109], v131 offset:40960
    v_mfma_f32_16x16x32_bf16 v[36:39], a[112:115], v[80:83], v[36:39]
    ds_read_b64_tr_b16 v[110:111], v131 offset:41984
    s_add_u32 s26, s24, 0x280000
    s_add_u32 m0, s29, 0x14000
    s_nop 0
    buffer_load_dwordx4 v136, s[16:19], s26 offen lds
    s_waitcnt lgkmcnt(12)
    v_mfma_f32_16x16x32_bf16 v[40:43], a[48:51], v[84:87], v[40:43]
    ds_read_b64_tr_b16 v[112:113], v132 offset:40960
    v_mfma_f32_16x16x32_bf16 v[44:47], a[112:115], v[84:87], v[44:47]
    ds_read_b64_tr_b16 v[114:115], v132 offset:41984
    s_add_u32 s26, s24, 0x2a0000
    s_add_u32 m0, s29, 0x15000
    s_nop 0
    buffer_load_dwordx4 v136, s[16:19], s26 offen lds
    s_waitcnt lgkmcnt(12)
    v_mfma_f32_16x16x32_bf16 v[48:51], a[48:51], v[88:91], v[48:51]
    ds_read_b64_tr_b16 v[116:117], v133 offset:40960
    v_mfma_f32_16x16x32_bf16 v[52:55], a[112:115], v[88:91], v[52:55]
    ds_read_b64_tr_b16 v[118:119], v133 offset:41984
    s_add_u32 s26, s24, 0x2c0000
    s_add_u32 m0, s29, 0x16000
    s_nop 0
    buffer_load_dwordx4 v136, s[16:19], s26 offen lds
    s_waitcnt lgkmcnt(12)
    v_mfma_f32_16x16x32_bf16 v[56:59], a[48:51], v[92:95], v[56:59]
    ds_read_b64_tr_b16 v[120:121], v134 offset:40960
    v_mfma_f32_16x16x32_bf16 v[60:63], a[112:115], v[92:95], v[60:63]
    ds_read_b64_tr_b16 v[122:123], v134 offset:41984
    s_add_u32 s26, s24, 0x2e0000
    s_add_u32 m0, s29, 0x17000
    s_nop 0
    buffer_load_dwordx4 v136, s[16:19], s26 offen lds
    s_waitcnt lgkmcnt(12)
    v_mfma_f32_16x16x32_bf16 v[0:3], a[52:55], v[96:99], v[0:3]
    ds_read_b64_tr_b16 v[124:125], v135 offset:40960
    v_mfma_f32_16x16x32_bf16 v[4:7], a[116:119], v[96:99], v[4:7]
    ds_read_b64_tr_b16 v[126:127], v135 offset:41984
    s_waitcnt lgkmcnt(12)
    v_mfma_f32_16x16x32_bf16 v[8:11], a[52:55], v[100:103], v[8:11]
    ds_read_b64_tr_b16 v[64:65], v128 offset:49152
    v_mfma_f32_16x16x32_bf16 v[12:15], a[116:119], v[100:103], v[12:15]
    ds_read_b64_tr_b16 v[66:67], v128 offset:50176
    s_waitcnt lgkmcnt(12)
    v_mfma_f32_16x16x32_bf16 v[16:19], a[52:55], v[104:107], v[16:19]
    ds_read_b64_tr_b16 v[68:69], v129 offset:49152
    v_mfma_f32_16x16x32_bf16 v[20:23], a[116:119], v[104:107], v[20:23]
    ds_read_b64_tr_b16 v[70:71], v129 offset:50176
    s_waitcnt lgkmcnt(12)
    v_mfma_f32_16x16x32_bf16 v[24:27], a[52:55], v[108:111], v[24:27]
    ds_read_b64_tr_b16 v[72:73], v130 offset:49152
    v_mfma_f32_16x16x32_bf16 v[28:31], a[116:119], v[108:111], v[28:31]
    ds_read_b64_tr_b16 v[74:75], v130 offset:50176
    s_waitcnt lgkmcnt(12)
    v_mfma_f32_16x16x32_bf16 v[32:35], a[52:55], v[112:115], v[32:35]
    ds_read_b64_tr_b16 v[76:77], v131 offset:49152
    v_mfma_f32_16x16x32_bf16 v[36:39], a[116:119], v[112:115], v[36:39]
    ds_read_b64_tr_b16 v[78:79], v131 offset:50176
    s_waitcnt lgkmcnt(12)
    v_mfma_f32_16x16x32_bf16 v[40:43], a[52:55], v[116:119], v[40:43]
    ds_read_b64_tr_b16 v[80:81], v132 offset:49152
    v_mfma_f32_16x16x32_bf16 v[44:47], a[116:119], v[116:119], v[44:47]
    ds_read_b64_tr_b16 v[82:83], v132 offset:50176
    s_waitcnt lgkmcnt(12)
    v_mfma_f32_16x16x32_bf16 v[48:51], a[52:55], v[120:123], v[48:51]
    ds_read_b64_tr_b16 v[84:85], v133 offset:49152
    v_mfma_f32_16x16x32_bf16 v[52:55], a[116:119], v[120:123], v[52:55]
    ds_read_b64_tr_b16 v[86:87], v133 offset:50176
    s_waitcnt lgkmcnt(12)
    v_mfma_f32_16x16x32_bf16 v[56:59], a[52:55], v[124:127], v[56:59]
    ds_read_b64_tr_b16 v[88:89], v134 offset:49152
    v_mfma_f32_16x16x32_bf16 v[60:63], a[116:119], v[124:127], v[60:63]
    ds_read_b64_tr_b16 v[90:91], v134 offset:50176
    s_waitcnt lgkmcnt(12)
    v_mfma_f32_16x16x32_bf16 v[0:3], a[56:59], v[64:67], v[0:3]
    ds_read_b64_tr_b16 v[92:93], v135 offset:49152
    v_mfma_f32_16x16x32_bf16 v[4:7], a[120:123], v[64:67], v[4:7]
    ds_read_b64_tr_b16 v[94:95], v135 offset:50176
    s_waitcnt lgkmcnt(12)
    v_mfma_f32_16x16x32_bf16 v[8:11], a[56:59], v[68:71], v[8:11]
    ds_read_b64_tr_b16 v[96:97], v128 offset:57344
    v_mfma_f32_16x16x32_bf16 v[12:15], a[120:123], v[68:71], v[12:15]
    ds_read_b64_tr_b16 v[98:99], v128 offset:58368
    s_waitcnt lgkmcnt(12)
    v_mfma_f32_16x16x32_bf16 v[16:19], a[56:59], v[72:75], v[16:19]
    ds_read_b64_tr_b16 v[100:101], v129 offset:57344
    v_mfma_f32_16x16x32_bf16 v[20:23], a[120:123], v[72:75], v[20:23]
    ds_read_b64_tr_b16 v[102:103], v129 offset:58368
    s_waitcnt lgkmcnt(12)
    v_mfma_f32_16x16x32_bf16 v[24:27], a[56:59], v[76:79], v[24:27]
    ds_read_b64_tr_b16 v[104:105], v130 offset:57344
    v_mfma_f32_16x16x32_bf16 v[28:31], a[120:123], v[76:79], v[28:31]
    ds_read_b64_tr_b16 v[106:107], v130 offset:58368
    s_waitcnt lgkmcnt(12)
    v_mfma_f32_16x16x32_bf16 v[32:35], a[56:59], v[80:83], v[32:35]
    ds_read_b64_tr_b16 v[108:109], v131 offset:57344
    v_mfma_f32_16x16x32_bf16 v[36:39], a[120:123], v[80:83], v[36:39]
    ds_read_b64_tr_b16 v[110:111], v131 offset:58368
    s_waitcnt lgkmcnt(12)
    v_mfma_f32_16x16x32_bf16 v[40:43], a[56:59], v[84:87], v[40:43]
    ds_read_b64_tr_b16 v[112:113], v132 offset:57344
    v_mfma_f32_16x16x32_bf16 v[44:47], a[120:123], v[84:87], v[44:47]
    ds_read_b64_tr_b16 v[114:115], v132 offset:58368
    s_waitcnt lgkmcnt(12)
    v_mfma_f32_16x16x32_bf16 v[48:51], a[56:59], v[88:91], v[48:51]
    ds_read_b64_tr_b16 v[116:117], v133 offset:57344
    v_mfma_f32_16x16x32_bf16 v[52:55], a[120:123], v[88:91], v[52:55]
    ds_read_b64_tr_b16 v[118:119], v133 offset:58368
    s_waitcnt lgkmcnt(12)
    v_mfma_f32_16x16x32_bf16 v[56:59], a[56:59], v[92:95], v[56:59]
    ds_read_b64_tr_b16 v[120:121], v134 offset:57344
    v_mfma_f32_16x16x32_bf16 v[60:63], a[120:123], v[92:95], v[60:63]
    ds_read_b64_tr_b16 v[122:123], v134 offset:58368
    s_waitcnt lgkmcnt(12)
    v_mfma_f32_16x16x32_bf16 v[0:3], a[60:63], v[96:99], v[0:3]
    ds_read_b64_tr_b16 v[124:125], v135 offset:57344
    v_mfma_f32_16x16x32_bf16 v[4:7], a[124:127], v[96:99], v[4:7]
    ds_read_b64_tr_b16 v[126:127], v135 offset:58368
    s_waitcnt lgkmcnt(12)
    v_mfma_f32_16x16x32_bf16 v[8:11], a[60:63], v[100:103], v[8:11]
    v_mfma_f32_16x16x32_bf16 v[12:15], a[124:127], v[100:103], v[12:15]
    s_waitcnt lgkmcnt(10)
    v_mfma_f32_16x16x32_bf16 v[16:19], a[60:63], v[104:107], v[16:19]
    v_mfma_f32_16x16x32_bf16 v[20:23], a[124:127], v[104:107], v[20:23]
    s_waitcnt lgkmcnt(8)
    v_mfma_f32_16x16x32_bf16 v[24:27], a[60:63], v[108:111], v[24:27]
    v_mfma_f32_16x16x32_bf16 v[28:31], a[124:127], v[108:111], v[28:31]
    s_waitcnt lgkmcnt(6)
    v_mfma_f32_16x16x32_bf16 v[32:35], a[60:63], v[112:115], v[32:35]
    v_mfma_f32_16x16x32_bf16 v[36:39], a[124:127], v[112:115], v[36:39]
    s_waitcnt lgkmcnt(4)
    v_mfma_f32_16x16x32_bf16 v[40:43], a[60:63], v[116:119], v[40:43]
    v_mfma_f32_16x16x32_bf16 v[44:47], a[124:127], v[116:119], v[44:47]
    s_waitcnt lgkmcnt(2)
    v_mfma_f32_16x16x32_bf16 v[48:51], a[60:63], v[120:123], v[48:51]
    v_mfma_f32_16x16x32_bf16 v[52:55], a[124:127], v[120:123], v[52:55]
    s_waitcnt lgkmcnt(0)
    v_mfma_f32_16x16x32_bf16 v[56:59], a[60:63], v[124:127], v[56:59]
    v_mfma_f32_16x16x32_bf16 v[60:63], a[124:127], v[124:127], v[60:63]
    v_xor_b32 v128, 0x10000, v128
    v_xor_b32 v129, 0x10000, v129
    v_xor_b32 v130, 0x10000, v130
    v_xor_b32 v131, 0x10000, v131
    v_xor_b32 v132, 0x10000, v132
    v_xor_b32 v133, 0x10000, v133
    v_xor_b32 v134, 0x10000, v134
    v_xor_b32 v135, 0x10000, v135
    v_cvt_pk_bf16_f32 v144, v0, v1
    v_cvt_pk_bf16_f32 v145, v2, v3
    v_cvt_pk_bf16_f32 v146, v4, v5
    v_cvt_pk_bf16_f32 v147, v6, v7
    buffer_store_dwordx4 v[144:147], v137, s[8:11], s25 offen sc1
    v_cvt_pk_bf16_f32 v148, v8, v9
    v_cvt_pk_bf16_f32 v149, v10, v11
    v_cvt_pk_bf16_f32 v150, v12, v13
    v_cvt_pk_bf16_f32 v151, v14, v15
    buffer_store_dwordx4 v[148:151], v137, s[8:11], s25 offen offset:1024 sc1
    v_cvt_pk_bf16_f32 v152, v16, v17
    v_cvt_pk_bf16_f32 v153, v18, v19
    v_cvt_pk_bf16_f32 v154, v20, v21
    v_cvt_pk_bf16_f32 v155, v22, v23
    buffer_store_dwordx4 v[152:155], v137, s[8:11], s25 offen offset:2048 sc1
    v_cvt_pk_bf16_f32 v156, v24, v25
    v_cvt_pk_bf16_f32 v157, v26, v27
    v_cvt_pk_bf16_f32 v158, v28, v29
    v_cvt_pk_bf16_f32 v159, v30, v31
    buffer_store_dwordx4 v[156:159], v137, s[8:11], s25 offen offset:3072 sc1
    v_cvt_pk_bf16_f32 v144, v32, v33
    v_cvt_pk_bf16_f32 v145, v34, v35
    v_cvt_pk_bf16_f32 v146, v36, v37
    v_cvt_pk_bf16_f32 v147, v38, v39
    s_add_u32 s25, s25, 4096
    buffer_store_dwordx4 v[144:147], v137, s[8:11], s25 offen sc1
    v_cvt_pk_bf16_f32 v148, v40, v41
    v_cvt_pk_bf16_f32 v149, v42, v43
    v_cvt_pk_bf16_f32 v150, v44, v45
    v_cvt_pk_bf16_f32 v151, v46, v47
    buffer_store_dwordx4 v[148:151], v137, s[8:11], s25 offen offset:1024 sc1
    v_cvt_pk_bf16_f32 v152, v48, v49
    v_cvt_pk_bf16_f32 v153, v50, v51
    v_cvt_pk_bf16_f32 v154, v52, v53
    v_cvt_pk_bf16_f32 v155, v54, v55
    buffer_store_dwordx4 v[152:155], v137, s[8:11], s25 offen offset:2048 sc1
    v_cvt_pk_bf16_f32 v156, v56, v57
    v_cvt_pk_bf16_f32 v157, v58, v59
    v_cvt_pk_bf16_f32 v158, v60, v61
    v_cvt_pk_bf16_f32 v159, v62, v63
    buffer_store_dwordx4 v[156:159], v137, s[8:11], s25 offen offset:3072 sc1
L_p1_next:
    s_add_u32 s80, s80, 1
    s_lshl_b32 s40, s38, 4
    s_add_u32 s40, s40, s20
    s_lshl_b32 s40, s40, 2
    s_add_u32 s40, s40, 0x2000
    s_sub_u32 s44, s25, 4095
    s_add_u32 s38, s38, s37
    s_branch L_p1_unit
L_p1_end:
    s_waitcnt vmcnt(0)
    s_barrier
    s_cmp_eq_u32 s40, 0
    s_cbranch_scc1 L_nopf_95
    s_cmp_lg_u32 s87, 0
    s_cbranch_scc1 L_modeok_96
    s_mov_b32 s96, 0
L_mode_97:
    buffer_load_dwordx2 v[140:141], off, s[92:95], 0 offset:36 sc1
    s_waitcnt vmcnt(0)
    v_readfirstlane_b32 s87, v140
    v_readfirstlane_b32 s97, v141
    s_nop 0
    s_min_u32 s97, s97, s87
    s_cmp_lg_u32 s97, 0
    s_cbranch_scc1 L_moded_98
    s_sleep 4
    s_add_u32 s96, s96, 1
    s_cmp_lg_u32 s96, 0x100
    s_cbranch_scc1 L_modef_99
    v_mov_b32 v140, 2
    v_mov_b32 v141, 0
    s_mov_b64 exec, 1
    buffer_atomic_cmpswap v[140:141], off, s[92:95], 0 offset:36
    s_mov_b64 exec, -1
L_modef_99:
    s_cmp_lt_u32 s96, 0x10000
    s_cbranch_scc1 L_mode_97
L_moded_98:
    s_cmp_lg_u32 s87, 1
    s_cbranch_scc1 L_fallback
L_modeok_96:
    s_cmp_lg_u32 s100, 0
    s_cbranch_scc1 L_flag_100
    v_mov_b32 v138, 1
    s_mov_b64 exec, 1
    buffer_store_dword v138, off, s[8:11], s40 sc1
    s_mov_b64 exec, -1
L_flag_100:
    s_mov_b32 s40, 0
L_nopf_95:
    s_cmp_lg_u32 s41, 0
    s_cbranch_scc1 L_p1done
    s_mov_b32 s41, 1
    s_mul_i32 s22, s101, 171
    s_lshr_b32 s22, s22, 11
    s_mul_i32 s26, s22, 12
    s_sub_u32 s20, s101, s26
    s_add_u32 s20, s20, 4
    s_mul_i32 s27, s101, 683
    s_lshr_b32 s27, s27, 11
    s_mul_i32 s26, s27, 3
    s_sub_u32 s26, s101, s26
    s_cmp_eq_u32 s26, 2
    s_cselect_b32 s28, 10, 11
    s_cmp_ge_u32 s101, 192
    s_cselect_b32 s20, s26, s20
    s_cselect_b32 s22, s27, s22
    s_cselect_b32 s37, s28, 16
    s_branch L_p1_pass
L_p1done:
    v_mbcnt_lo_u32_b32 v0, -1, 0
    v_mbcnt_hi_u32_b32 v0, -1, v0
    s_lshl_b32 s96, s100, 6
    v_add_u32 v0, s96, v0
    s_and_b32 s20, s101, 15
    s_lshr_b32 s22, s101, 4
    s_mov_b32 s23, 14
    v_mov_b32 v1, 0
    s_lshl_b32 s24, s20, 7
    s_add_u32 s24, s24, 0x1000
    s_mul_i32 s25, s22, 14
    s_lshr_b32 s25, s25, 4
    s_add_u32 s25, s25, 12
    s_cmp_lg_u32 s100, 0
    s_cbranch_scc1 L_polls_103
    s_mov_b32 exec_lo, 0x1
    s_mov_b32 exec_hi, 0
    s_mov_b32 s96, 0
L_poll_101:
    buffer_load_dword v2, v1, s[8:11], s24 offen sc1
    s_waitcnt vmcnt(0)
    v_cmp_gt_u32 vcc, s25, v2
    s_cbranch_vccz L_polld_102
    v_readfirstlane_b32 s97, v2
    s_nop 0
    s_sub_u32 s97, s25, s97
    s_cmp_lt_i32 s97, 3
    s_cbranch_scc1 L_near_104
    s_sleep 40
    s_cmp_lt_i32 s97, 5
    s_cbranch_scc1 L_near_104
    s_sleep 100
L_near_104:
    s_sleep 8
    s_add_u32 s96, s96, 1
    s_cmp_lt_u32 s96, 0x10000
    s_cbranch_scc1 L_poll_101
L_polld_102:
    s_mov_b64 exec, -1
L_polls_103:
    s_barrier
    s_load_dwordx2 s[12:13], s[0:1], 40
    s_waitcnt lgkmcnt(0)
    s_and_b32 s13, s13, 0xffff
    s_mov_b32 s14, 0x400000
    s_mov_b32 s15, 0x20000
    v_lshrrev_b32 v4, 6, v0
    s_nop 0
    v_readfirstlane_b32 s21, v4
    v_and_b32 v1, 63, v0
    v_lshrrev_b32 v2, 4, v1
    v_and_b32 v3, 15, v1
    v_lshrrev_b32 v6, 2, v3
    v_lshlrev_b32 v240, 4, v1
    v_lshlrev_b32 v241, 3, v1
    s_lshl_b32 s27, s21, 10
    s_lshl_b32 s24, s21, 5
    v_xor_b32 v4, s24, v240
    v_add_u32 v8, s27, v4
    v_xor_b32 v9, 128, v8
    v_lshl_add_u32 v4, v2, 2, v6
    v_and_b32 v5, 7, v4
    v_lshlrev_b32 v4, 10, v4
    v_lshl_add_u32 v4, v5, 5, v4
    v_and_b32 v5, 3, v3
    v_lshlrev_b32 v5, 4, v5
    v_xor_b32 v4, v5, v4
    s_lshl_b32 s24, s21, 8
    v_add_u32 v10, s24, v4
    s_lshl_b32 s25, s20, 18
    s_add_u32 s24, s25, 0x0
    s_add_u32 m0, s27, 0x0
    s_nop 0
    buffer_load_dwordx4 v8, s[12:15], s24 offen lds
    s_add_u32 s24, s25, 0x1000
    s_add_u32 m0, s27, 0x1000
    s_nop 0
    buffer_load_dwordx4 v9, s[12:15], s24 offen lds
    s_add_u32 s24, s25, 0x2000
    s_add_u32 m0, s27, 0x2000
    s_nop 0
    buffer_load_dwordx4 v8, s[12:15], s24 offen lds
    s_add_u32 s24, s25, 0x3000
    s_add_u32 m0, s27, 0x3000
    s_nop 0
    buffer_load_dwordx4 v9, s[12:15], s24 offen lds
    s_add_u32 s24, s25, 0x4000
    s_add_u32 m0, s27, 0x4000
    s_nop 0
    buffer_load_dwordx4 v8, s[12:15], s24 offen lds
    s_add_u32 s24, s25, 0x5000
    s_add_u32 m0, s27, 0x5000
    s_nop 0
    buffer_load_dwordx4 v9, s[12:15], s24 offen lds
    s_add_u32 s24, s25, 0x6000
    s_add_u32 m0, s27, 0x6000
    s_nop 0
    buffer_load_dwordx4 v8, s[12:15], s24 offen lds
    s_add_u32 s24, s25, 0x7000
    s_add_u32 m0, s27, 0x7000
    s_nop 0
    buffer_load_dwordx4 v9, s[12:15], s24 offen lds
    s_add_u32 s24, s25, 0x8000
    s_add_u32 m0, s27, 0x8000
    s_nop 0
    buffer_load_dwordx4 v8, s[12:15], s24 offen lds
    s_add_u32 s24, s25, 0x9000
    s_add_u32 m0, s27, 0x9000
    s_nop 0
    buffer_load_dwordx4 v9, s[12:15], s24 offen lds
    s_add_u32 s24, s25, 0xa000
    s_add_u32 m0, s27, 0xa000
    s_nop 0
    buffer_load_dwordx4 v8, s[12:15], s24 offen lds
    s_add_u32 s24, s25, 0xb000
    s_add_u32 m0, s27, 0xb000
    s_nop 0
    buffer_load_dwordx4 v9, s[12:15], s24 offen lds
    s_add_u32 s24, s25, 0xc000
    s_add_u32 m0, s27, 0xc000
    s_nop 0
    buffer_load_dwordx4 v8, s[12:15], s24 offen lds
    s_add_u32 s24, s25, 0xd000
    s_add_u32 m0, s27, 0xd000
    s_nop 0
    buffer_load_dwordx4 v9, s[12:15], s24 offen lds
    s_add_u32 s24, s25, 0xe000
    s_add_u32 m0, s27, 0xe000
    s_nop 0
    buffer_load_dwordx4 v8, s[12:15], s24 offen lds
    s_add_u32 s24, s25, 0xf000
    s_add_u32 m0, s27, 0xf000
    s_nop 0
    buffer_load_dwordx4 v9, s[12:15], s24 offen lds
    s_add_u32 s24, s25, 0x10000
    s_add_u32 m0, s27, 0x10000
    s_nop 0
    buffer_load_dwordx4 v8, s[12:15], s24 offen lds
    s_add_u32 s24, s25, 0x11000
    s_add_u32 m0, s27, 0x11000
    s_nop 0
    buffer_load_dwordx4 v9, s[12:15], s24 offen lds
    s_add_u32 s24, s25, 0x12000
    s_add_u32 m0, s27, 0x12000
    s_nop 0
    buffer_load_dwordx4 v8, s[12:15], s24 offen lds
    s_add_u32 s24, s25, 0x13000
    s_add_u32 m0, s27, 0x13000
    s_nop 0
    buffer_load_dwordx4 v9, s[12:15], s24 offen lds
    s_add_u32 s24, s25, 0x14000
    s_add_u32 m0, s27, 0x14000
    s_nop 0
    buffer_load_dwordx4 v8, s[12:15], s24 offen lds
    s_add_u32 s24, s25, 0x15000
    s_add_u32 m0, s27, 0x15000
    s_nop 0
    buffer_load_dwordx4 v9, s[12:15], s24 offen lds
    s_add_u32 s24, s25, 0x16000
    s_add_u32 m0, s27, 0x16000
    s_nop 0
    buffer_load_dwordx4 v8, s[12:15], s24 offen lds
    s_add_u32 s24, s25, 0x17000
    s_add_u32 m0, s27, 0x17000
    s_nop 0
    buffer_load_dwordx4 v9, s[12:15], s24 offen lds
    s_add_u32 s24, s25, 0x18000
    s_add_u32 m0, s27, 0x18000
    s_nop 0
    buffer_load_dwordx4 v8, s[12:15], s24 offen lds
    s_add_u32 s24, s25, 0x19000
    s_add_u32 m0, s27, 0x19000
    s_nop 0
    buffer_load_dwordx4 v9, s[12:15], s24 offen lds
    s_add_u32 s24, s25, 0x1a000
    s_add_u32 m0, s27, 0x1a000
    s_nop 0
    buffer_load_dwordx4 v8, s[12:15], s24 offen lds
    s_add_u32 s24, s25, 0x1b000
    s_add_u32 m0, s27, 0x1b000
    s_nop 0
    buffer_load_dwordx4 v9, s[12:15], s24 offen lds
    s_add_u32 s24, s25, 0x1c000
    s_add_u32 m0, s27, 0x1c000
    s_nop 0
    buffer_load_dwordx4 v8, s[12:15], s24 offen lds
    s_add_u32 s24, s25, 0x1d000
    s_add_u32 m0, s27, 0x1d000
    s_nop 0
    buffer_load_dwordx4 v9, s[12:15], s24 offen lds
    s_add_u32 s24, s25, 0x1e000
    s_add_u32 m0, s27, 0x1e000
    s_nop 0
    buffer_load_dwordx4 v8, s[12:15], s24 offen lds
    s_add_u32 s24, s25, 0x1f000
    s_add_u32 m0, s27, 0x1f000
    s_nop 0
    buffer_load_dwordx4 v9, s[12:15], s24 offen lds
    s_waitcnt vmcnt(0)
    s_barrier
    v_xor_b32 v11, 0x0, v10
    ds_read_b64_tr_b16 a[0:1], v11
    ds_read_b64_tr_b16 a[2:3], v11 offset:16384
    ds_read_b64_tr_b16 a[32:33], v11 offset:32768
    ds_read_b64_tr_b16 a[34:35], v11 offset:49152
    v_xor_b32 v11, 0x8, v10
    ds_read_b64_tr_b16 a[4:5], v11
    ds_read_b64_tr_b16 a[6:7], v11 offset:16384
    ds_read_b64_tr_b16 a[36:37], v11 offset:32768
    ds_read_b64_tr_b16 a[38:39], v11 offset:49152
    s_waitcnt lgkmcnt(0)
    v_xor_b32 v11, 0x40, v10
    ds_read_b64_tr_b16 a[8:9], v11
    ds_read_b64_tr_b16 a[10:11], v11 offset:16384
    ds_read_b64_tr_b16 a[40:41], v11 offset:32768
    ds_read_b64_tr_b16 a[42:43], v11 offset:49152
    v_xor_b32 v11, 0x48, v10
    ds_read_b64_tr_b16 a[12:13], v11
    ds_read_b64_tr_b16 a[14:15], v11 offset:16384
    ds_read_b64_tr_b16 a[44:45], v11 offset:32768
    ds_read_b64_tr_b16 a[46:47], v11 offset:49152
    s_waitcnt lgkmcnt(0)
    v_xor_b32 v11, 0x80, v10
    ds_read_b64_tr_b16 a[16:17], v11
    ds_read_b64_tr_b16 a[18:19], v11 offset:16384
    ds_read_b64_tr_b16 a[48:49], v11 offset:32768
    ds_read_b64_tr_b16 a[50:51], v11 offset:49152
    v_xor_b32 v11, 0x88, v10
    ds_read_b64_tr_b16 a[20:21], v11
    ds_read_b64_tr_b16 a[22:23], v11 offset:16384
    ds_read_b64_tr_b16 a[52:53], v11 offset:32768
    ds_read_b64_tr_b16 a[54:55], v11 offset:49152
    s_waitcnt lgkmcnt(0)
    v_xor_b32 v11, 0xc0, v10
    ds_read_b64_tr_b16 a[24:25], v11
    ds_read_b64_tr_b16 a[26:27], v11 offset:16384
    ds_read_b64_tr_b16 a[56:57], v11 offset:32768
    ds_read_b64_tr_b16 a[58:59], v11 offset:49152
    v_xor_b32 v11, 0xc8, v10
    ds_read_b64_tr_b16 a[28:29], v11
    ds_read_b64_tr_b16 a[30:31], v11 offset:16384
    ds_read_b64_tr_b16 a[60:61], v11 offset:32768
    ds_read_b64_tr_b16 a[62:63], v11 offset:49152
    s_waitcnt lgkmcnt(0)
    v_xor_b32 v11, 0x10000, v10
    ds_read_b64_tr_b16 a[64:65], v11
    ds_read_b64_tr_b16 a[66:67], v11 offset:16384
    ds_read_b64_tr_b16 a[96:97], v11 offset:32768
    ds_read_b64_tr_b16 a[98:99], v11 offset:49152
    v_xor_b32 v11, 0x10008, v10
    ds_read_b64_tr_b16 a[68:69], v11
    ds_read_b64_tr_b16 a[70:71], v11 offset:16384
    ds_read_b64_tr_b16 a[100:101], v11 offset:32768
    ds_read_b64_tr_b16 a[102:103], v11 offset:49152
    s_waitcnt lgkmcnt(0)
    v_xor_b32 v11, 0x10040, v10
    ds_read_b64_tr_b16 a[72:73], v11
    ds_read_b64_tr_b16 a[74:75], v11 offset:16384
    ds_read_b64_tr_b16 a[104:105], v11 offset:32768
    ds_read_b64_tr_b16 a[106:107], v11 offset:49152
    v_xor_b32 v11, 0x10048, v10
    ds_read_b64_tr_b16 a[76:77], v11
    ds_read_b64_tr_b16 a[78:79], v11 offset:16384
    ds_read_b64_tr_b16 a[108:109], v11 offset:32768
    ds_read_b64_tr_b16 a[110:111], v11 offset:49152
    s_waitcnt lgkmcnt(0)
    v_xor_b32 v11, 0x10080, v10
    ds_read_b64_tr_b16 a[80:81], v11
    ds_read_b64_tr_b16 a[82:83], v11 offset:16384
    ds_read_b64_tr_b16 a[112:113], v11 offset:32768
    ds_read_b64_tr_b16 a[114:115], v11 offset:49152
    v_xor_b32 v11, 0x10088, v10
    ds_read_b64_tr_b16 a[84:85], v11
    ds_read_b64_tr_b16 a[86:87], v11 offset:16384
    ds_read_b64_tr_b16 a[116:117], v11 offset:32768
    ds_read_b64_tr_b16 a[118:119], v11 offset:49152
    s_waitcnt lgkmcnt(0)
    v_xor_b32 v11, 0x100c0, v10
    ds_read_b64_tr_b16 a[88:89], v11
    ds_read_b64_tr_b16 a[90:91], v11 offset:16384
    ds_read_b64_tr_b16 a[120:121], v11 offset:32768
    ds_read_b64_tr_b16 a[122:123], v11 offset:49152
    v_xor_b32 v11, 0x100c8, v10
    ds_read_b64_tr_b16 a[92:93], v11
    ds_read_b64_tr_b16 a[94:95], v11 offset:16384
    ds_read_b64_tr_b16 a[124:125], v11 offset:32768
    ds_read_b64_tr_b16 a[126:127], v11 offset:49152
    s_waitcnt lgkmcnt(0)
    s_barrier
    s_lshl_b32 s25, s20, 18
    s_add_u32 s24, s25, 0x20000
    s_add_u32 m0, s27, 0x0
    s_nop 0
    buffer_load_dwordx4 v8, s[12:15], s24 offen lds
    s_add_u32 s24, s25, 0x21000
    s_add_u32 m0, s27, 0x1000
    s_nop 0
    buffer_load_dwordx4 v9, s[12:15], s24 offen lds
    s_add_u32 s24, s25, 0x22000
    s_add_u32 m0, s27, 0x2000
    s_nop 0
    buffer_load_dwordx4 v8, s[12:15], s24 offen lds
    s_add_u32 s24, s25, 0x23000
    s_add_u32 m0, s27, 0x3000
    s_nop 0
    buffer_load_dwordx4 v9, s[12:15], s24 offen lds
    s_add_u32 s24, s25, 0x24000
    s_add_u32 m0, s27, 0x4000
    s_nop 0
    buffer_load_dwordx4 v8, s[12:15], s24 offen lds
    s_add_u32 s24, s25, 0x25000
    s_add_u32 m0, s27, 0x5000
    s_nop 0
    buffer_load_dwordx4 v9, s[12:15], s24 offen lds
    s_add_u32 s24, s25, 0x26000
    s_add_u32 m0, s27, 0x6000
    s_nop 0
    buffer_load_dwordx4 v8, s[12:15], s24 offen lds
    s_add_u32 s24, s25, 0x27000
    s_add_u32 m0, s27, 0x7000
    s_nop 0
    buffer_load_dwordx4 v9, s[12:15], s24 offen lds
    s_add_u32 s24, s25, 0x28000
    s_add_u32 m0, s27, 0x8000
    s_nop 0
    buffer_load_dwordx4 v8, s[12:15], s24 offen lds
    s_add_u32 s24, s25, 0x29000
    s_add_u32 m0, s27, 0x9000
    s_nop 0
    buffer_load_dwordx4 v9, s[12:15], s24 offen lds
    s_add_u32 s24, s25, 0x2a000
    s_add_u32 m0, s27, 0xa000
    s_nop 0
    buffer_load_dwordx4 v8, s[12:15], s24 offen lds
    s_add_u32 s24, s25, 0x2b000
    s_add_u32 m0, s27, 0xb000
    s_nop 0
    buffer_load_dwordx4 v9, s[12:15], s24 offen lds
    s_add_u32 s24, s25, 0x2c000
    s_add_u32 m0, s27, 0xc000
    s_nop 0
    buffer_load_dwordx4 v8, s[12:15], s24 offen lds
    s_add_u32 s24, s25, 0x2d000
    s_add_u32 m0, s27, 0xd000
    s_nop 0
    buffer_load_dwordx4 v9, s[12:15], s24 offen lds
    s_add_u32 s24, s25, 0x2e000
    s_add_u32 m0, s27, 0xe000
    s_nop 0
    buffer_load_dwordx4 v8, s[12:15], s24 offen lds
    s_add_u32 s24, s25, 0x2f000
    s_add_u32 m0, s27, 0xf000
    s_nop 0
    buffer_load_dwordx4 v9, s[12:15], s24 offen lds
    s_add_u32 s24, s25, 0x30000
    s_add_u32 m0, s27, 0x10000
    s_nop 0
    buffer_load_dwordx4 v8, s[12:15], s24 offen lds
    s_add_u32 s24, s25, 0x31000
    s_add_u32 m0, s27, 0x11000
    s_nop 0
    buffer_load_dwordx4 v9, s[12:15], s24 offen lds
    s_add_u32 s24, s25, 0x32000
    s_add_u32 m0, s27, 0x12000
    s_nop 0
    buffer_load_dwordx4 v8, s[12:15], s24 offen lds
    s_add_u32 s24, s25, 0x33000
    s_add_u32 m0, s27, 0x13000
    s_nop 0
    buffer_load_dwordx4 v9, s[12:15], s24 offen lds
    s_add_u32 s24, s25, 0x34000
    s_add_u32 m0, s27, 0x14000
    s_nop 0
    buffer_load_dwordx4 v8, s[12:15], s24 offen lds
    s_add_u32 s24, s25, 0x35000
    s_add_u32 m0, s27, 0x15000
    s_nop 0
    buffer_load_dwordx4 v9, s[12:15], s24 offen lds
    s_add_u32 s24, s25, 0x36000
    s_add_u32 m0, s27, 0x16000
    s_nop 0
    buffer_load_dwordx4 v8, s[12:15], s24 offen lds
    s_add_u32 s24, s25, 0x37000
    s_add_u32 m0, s27, 0x17000
    s_nop 0
    buffer_load_dwordx4 v9, s[12:15], s24 offen lds
    s_add_u32 s24, s25, 0x38000
    s_add_u32 m0, s27, 0x18000
    s_nop 0
    buffer_load_dwordx4 v8, s[12:15], s24 offen lds
    s_add_u32 s24, s25, 0x39000
    s_add_u32 m0, s27, 0x19000
    s_nop 0
    buffer_load_dwordx4 v9, s[12:15], s24 offen lds
    s_add_u32 s24, s25, 0x3a000
    s_add_u32 m0, s27, 0x1a000
    s_nop 0
    buffer_load_dwordx4 v8, s[12:15], s24 offen lds
    s_add_u32 s24, s25, 0x3b000
    s_add_u32 m0, s27, 0x1b000
    s_nop 0
    buffer_load_dwordx4 v9, s[12:15], s24 offen lds
    s_add_u32 s24, s25, 0x3c000
    s_add_u32 m0, s27, 0x1c000
    s_nop 0
    buffer_load_dwordx4 v8, s[12:15], s24 offen lds
    s_add_u32 s24, s25, 0x3d000
    s_add_u32 m0, s27, 0x1d000
    s_nop 0
    buffer_load_dwordx4 v9, s[12:15], s24 offen lds
    s_add_u32 s24, s25, 0x3e000
    s_add_u32 m0, s27, 0x1e000
    s_nop 0
    buffer_load_dwordx4 v8, s[12:15], s24 offen lds
    s_add_u32 s24, s25, 0x3f000
    s_add_u32 m0, s27, 0x1f000
    s_nop 0
    buffer_load_dwordx4 v9, s[12:15], s24 offen lds
    s_waitcnt vmcnt(0)
    s_barrier
    v_xor_b32 v11, 0x0, v10
    ds_read_b64_tr_b16 a[128:129], v11
    ds_read_b64_tr_b16 a[130:131], v11 offset:16384
    ds_read_b64_tr_b16 a[160:161], v11 offset:32768
    ds_read_b64_tr_b16 a[162:163], v11 offset:49152
    v_xor_b32 v11, 0x8, v10
    ds_read_b64_tr_b16 a[132:133], v11
    ds_read_b64_tr_b16 a[134:135], v11 offset:16384
    ds_read_b64_tr_b16 a[164:165], v11 offset:32768
    ds_read_b64_tr_b16 a[166:167], v11 offset:49152
    s_waitcnt lgkmcnt(0)
    v_xor_b32 v11, 0x40, v10
    ds_read_b64_tr_b16 a[136:137], v11
    ds_read_b64_tr_b16 a[138:139], v11 offset:16384
    ds_read_b64_tr_b16 a[168:169], v11 offset:32768
    ds_read_b64_tr_b16 a[170:171], v11 offset:49152
    v_xor_b32 v11, 0x48, v10
    ds_read_b64_tr_b16 a[140:141], v11
    ds_read_b64_tr_b16 a[142:143], v11 offset:16384
    ds_read_b64_tr_b16 a[172:173], v11 offset:32768
    ds_read_b64_tr_b16 a[174:175], v11 offset:49152
    s_waitcnt lgkmcnt(0)
    v_xor_b32 v11, 0x80, v10
    ds_read_b64_tr_b16 a[144:145], v11
    ds_read_b64_tr_b16 a[146:147], v11 offset:16384
    ds_read_b64_tr_b16 a[176:177], v11 offset:32768
    ds_read_b64_tr_b16 a[178:179], v11 offset:49152
    v_xor_b32 v11, 0x88, v10
    ds_read_b64_tr_b16 a[148:149], v11
    ds_read_b64_tr_b16 a[150:151], v11 offset:16384
    ds_read_b64_tr_b16 a[180:181], v11 offset:32768
    ds_read_b64_tr_b16 a[182:183], v11 offset:49152
    s_waitcnt lgkmcnt(0)
    v_xor_b32 v11, 0xc0, v10
    ds_read_b64_tr_b16 a[152:153], v11
    ds_read_b64_tr_b16 a[154:155], v11 offset:16384
    ds_read_b64_tr_b16 a[184:185], v11 offset:32768
    ds_read_b64_tr_b16 a[186:187], v11 offset:49152
    v_xor_b32 v11, 0xc8, v10
    ds_read_b64_tr_b16 a[156:157], v11
    ds_read_b64_tr_b16 a[158:159], v11 offset:16384
    ds_read_b64_tr_b16 a[188:189], v11 offset:32768
    ds_read_b64_tr_b16 a[190:191], v11 offset:49152
    s_waitcnt lgkmcnt(0)
    v_xor_b32 v11, 0x10000, v10
    ds_read_b64_tr_b16 a[192:193], v11
    ds_read_b64_tr_b16 a[194:195], v11 offset:16384
    ds_read_b64_tr_b16 a[224:225], v11 offset:32768
    ds_read_b64_tr_b16 a[226:227], v11 offset:49152
    v_xor_b32 v11, 0x10008, v10
    ds_read_b64_tr_b16 a[196:197], v11
    ds_read_b64_tr_b16 a[198:199], v11 offset:16384
    ds_read_b64_tr_b16 a[228:229], v11 offset:32768
    ds_read_b64_tr_b16 a[230:231], v11 offset:49152
    s_waitcnt lgkmcnt(0)
    v_xor_b32 v11, 0x10040, v10
    ds_read_b64_tr_b16 a[200:201], v11
    ds_read_b64_tr_b16 a[202:203], v11 offset:16384
    ds_read_b64_tr_b16 a[232:233], v11 offset:32768
    ds_read_b64_tr_b16 a[234:235], v11 offset:49152
    v_xor_b32 v11, 0x10048, v10
    ds_read_b64_tr_b16 a[204:205], v11
    ds_read_b64_tr_b16 a[206:207], v11 offset:16384
    ds_read_b64_tr_b16 a[236:237], v11 offset:32768
    ds_read_b64_tr_b16 a[238:239], v11 offset:49152
    s_waitcnt lgkmcnt(0)
    v_xor_b32 v11, 0x10080, v10
    ds_read_b64_tr_b16 a[208:209], v11
    ds_read_b64_tr_b16 a[210:211], v11 offset:16384
    ds_read_b64_tr_b16 a[240:241], v11 offset:32768
    ds_read_b64_tr_b16 a[242:243], v11 offset:49152
    v_xor_b32 v11, 0x10088, v10
    ds_read_b64_tr_b16 a[212:213], v11
    ds_read_b64_tr_b16 a[214:215], v11 offset:16384
    ds_read_b64_tr_b16 a[244:245], v11 offset:32768
    ds_read_b64_tr_b16 a[246:247], v11 offset:49152
    s_waitcnt lgkmcnt(0)
    v_xor_b32 v11, 0x100c0, v10
    ds_read_b64_tr_b16 a[216:217], v11
    ds_read_b64_tr_b16 a[218:219], v11 offset:16384
    ds_read_b64_tr_b16 a[248:249], v11 offset:32768
    ds_read_b64_tr_b16 a[250:251], v11 offset:49152
    v_xor_b32 v11, 0x100c8, v10
    ds_read_b64_tr_b16 a[220:221], v11
    ds_read_b64_tr_b16 a[222:223], v11 offset:16384
    ds_read_b64_tr_b16 a[252:253], v11 offset:32768
    ds_read_b64_tr_b16 a[254:255], v11 offset:49152
    s_waitcnt lgkmcnt(0)
    s_barrier
    s_and_b32 s24, s21, 1
    s_lshl_b32 s24, s24, 4
    v_add_u32 v4, s24, v3
    v_lshlrev_b32 v5, 2, v2
    v_sub_u32 v4, v4, v5
    v_cmp_le_i32 s[30:31], 0, v4
    v_cmp_le_i32 s[32:33], 1, v4
    v_cmp_le_i32 s[34:35], 2, v4
    v_cmp_le_i32 s[36:37], 3, v4
    v_cmp_le_i32 s[38:39], 16, v4
    v_cmp_le_i32 s[40:41], 17, v4
    v_cmp_le_i32 s[42:43], 18, v4
    v_cmp_le_i32 s[44:45], 19, v4
    s_mov_b32 s28, 0x3e0293ee
    s_mov_b32 s29, 0x3e0293ee
    s_mov_b32 s53, 0xff000000
    v_mov_b32 v136, 0x3f803f80
    v_mov_b32 v137, 0x3f803f80
    v_mov_b32 v138, 0x3f803f80
    v_mov_b32 v139, 0x3f803f80
    v_lshlrev_b32 v4, 10, v3
    v_lshl_add_u32 v4, v2, 4, v4
    s_lshl_b32 s24, s21, 8
    v_add_u32 v242, s24, v4
    s_lshl_b32 s24, s21, 12
    v_add_u32 v243, s24, v240
    v_mov_b32 v244, v240
    s_add_u32 s24, s24, 0x22000
    v_xor_b32 v7, v2, v6
    v_lshl_add_u32 v4, v2, 4, v7
    v_and_b32 v5, 3, v3
    v_lshl_add_u32 v4, v4, 2, v5
    v_lshl_add_u32 v253, v4, 2, s24
    v_lshl_add_u32 v4, v3, 2, v7
    v_lshl_add_u32 v254, v4, 4, s24
    s_load_dwordx2 s[12:13], s[0:1], 0
    s_waitcnt lgkmcnt(0)
    s_and_b32 s13, s13, 0xffff
    s_mov_b32 s14, 0x200000
    s_mov_b32 s15, 0x20000
    s_load_dwordx2 s[16:17], s[0:1], 96
    s_waitcnt lgkmcnt(0)
    s_and_b32 s17, s17, 0xffff
    s_mov_b32 s18, 0x200000
    s_mov_b32 s19, 0x20000
    s_load_dwordx2 s[56:57], s[0:1], 64
    s_waitcnt lgkmcnt(0)
    s_and_b32 s57, s57, 0xffff
    s_mov_b32 s58, 0x400
    s_mov_b32 s59, 0x20000
    v_and_b32 v100, 63, v0
    v_lshlrev_b32 v240, 4, v100
    buffer_load_dwordx4 v[236:239], v240, s[56:59], 0 offen
    s_mov_b32 s65, 0x3f80
    s_mov_b32 s66, 0x3f800000
    s_waitcnt vmcnt(0)
    s_sub_u32 s67, s101, 128
    s_cmp_ge_u32 s67, 56
    s_cbranch_scc1 L_nostage_105
L_nostage_105:
    v_lshrrev_b32 v246, 2, v240
    s_lshl_b32 s24, s20, 7
    s_add_u32 s24, s24, 0x2000
    s_cmp_lg_u32 s100, 0
    s_cbranch_scc1 L_polls_108
    s_mov_b32 exec_lo, 0xffffffff
    s_mov_b32 exec_hi, 0
    s_mov_b32 s96, 0
L_poll_106:
    buffer_load_dword v247, v246, s[8:11], s24 offen sc1
    s_waitcnt vmcnt(0)
    v_cmp_gt_u32 vcc, 1, v247
    s_cbranch_vccz L_polld_107
    s_sleep 32
    s_add_u32 s96, s96, 1
    s_cmp_lt_u32 s96, 0x10000
    s_cbranch_scc1 L_poll_106
L_polld_107:
    s_mov_b64 exec, -1
L_polls_108:
    s_barrier
    s_lshl_b32 s24, s20, 7
    s_add_u32 s24, s24, 0x2800
    s_cmp_lg_u32 s100, 0
    s_cbranch_scc1 L_polls_111
    s_mov_b32 exec_lo, 0xffffffff
    s_mov_b32 exec_hi, 0
    s_mov_b32 s96, 0
L_poll_109:
    buffer_load_dword v247, v246, s[8:11], s24 offen sc1
    s_waitcnt vmcnt(0)
    v_cmp_gt_u32 vcc, 1, v247
    s_cbranch_vccz L_polld_110
    s_sleep 32
    s_add_u32 s96, s96, 1
    s_cmp_lt_u32 s96, 0x10000
    s_cbranch_scc1 L_poll_109
L_polld_110:
    s_mov_b64 exec, -1
L_polls_111:
    s_barrier
    s_lshl_b32 s24, s20, 7
    s_add_u32 s24, s24, 0x3000
    s_cmp_lg_u32 s100, 0
    s_cbranch_scc1 L_polls_114
    s_mov_b32 exec_lo, 0xffffffff
    s_mov_b32 exec_hi, 0
    s_mov_b32 s96, 0
L_poll_112:
    buffer_load_dword v247, v246, s[8:11], s24 offen sc1
    s_waitcnt vmcnt(0)
    v_cmp_gt_u32 vcc, 1, v247
    s_cbranch_vccz L_polld_113
    s_sleep 32
    s_add_u32 s96, s96, 1
    s_cmp_lt_u32 s96, 0x10000
    s_cbranch_scc1 L_poll_112
L_polld_113:
    s_mov_b64 exec, -1
L_polls_114:
    s_barrier
    s_mov_b32 s80, 0
L_p2_seg:
    s_cmp_ge_u32 s22, 64
    s_cbranch_scc1 L_p2_end
    v_lshrrev_b32 v246, 2, v240
    s_lshl_b32 s24, s20, 7
    s_add_u32 s24, s24, 0x1000
    s_mul_i32 s25, s22, 10
    s_lshr_b32 s25, s25, 4
    s_add_u32 s25, s25, 17
    s_cmp_lg_u32 s100, 0
    s_cbranch_scc1 L_polls_117
    s_mov_b32 exec_lo, 0x1
    s_mov_b32 exec_hi, 0
    s_mov_b32 s96, 0
L_poll_115:
    buffer_load_dword v247, v246, s[8:11], s24 offen sc1
    s_waitcnt vmcnt(0)
    v_cmp_gt_u32 vcc, s25, v247
    s_cbranch_vccz L_polld_116
    v_readfirstlane_b32 s97, v247
    s_nop 0
    s_sub_u32 s97, s25, s97
    s_cmp_lt_i32 s97, 3
    s_cbranch_scc1 L_near_118
    s_sleep 40
    s_cmp_lt_i32 s97, 5
    s_cbranch_scc1 L_near_118
    s_sleep 100
L_near_118:
    s_sleep 8
    s_add_u32 s96, s96, 1
    s_cmp_lt_u32 s96, 0x10000
    s_cbranch_scc1 L_poll_115
L_polld_116:
    s_mov_b64 exec, -1
L_polls_117:
    s_barrier
    s_cmp_ge_u32 s67, 56
    s_cbranch_scc1 L_nostage_119
    v_mbcnt_lo_u32_b32 v0, -1, 0
    v_mbcnt_hi_u32_b32 v0, -1, v0
    s_lshl_b32 s96, s100, 6
    v_add_u32 v0, s96, v0
    v_lshrrev_b32 v2, 6, v0
    s_nop 0
    v_readfirstlane_b32 s68, v2
    v_and_b32 v1, 63, v0
    s_lshl_b32 s73, s68, 10
    v_lshrrev_b32 v2, 2, v1
    s_lshl_b32 s71, s68, 4
    v_add_u32 v2, s71, v2
    s_movk_i32 s71, 3584
    v_mul_lo_u32 v2, v2, s71
    v_and_b32 v3, 3, v1
    v_lshl_add_u32 v4, v3, 4, v2
    s_cmp_lg_u32 s80, 0
    s_cbranch_scc1 L_part_120
    s_load_dwordx2 s[76:77], s[0:1], 72
    s_waitcnt lgkmcnt(0)
    s_and_b32 s77, s77, 0xffff
    s_mov_b32 s78, 0x1c0000
    s_mov_b32 s79, 0x20000
    s_lshl_b32 s71, s67, 6
    s_add_u32 s71, s71, 0x0
    s_add_u32 m0, s73, 0x8000
    s_nop 0
    buffer_load_dwordx4 v4, s[76:79], s71 offen lds
    s_lshl_b32 s71, s67, 6
    s_add_u32 s71, s71, 0x38000
    s_add_u32 m0, s73, 0x9000
    s_nop 0
    buffer_load_dwordx4 v4, s[76:79], s71 offen lds
    s_lshl_b32 s71, s67, 6
    s_add_u32 s71, s71, 0x70000
    s_add_u32 m0, s73, 0xa000
    s_nop 0
    buffer_load_dwordx4 v4, s[76:79], s71 offen lds
    s_lshl_b32 s71, s67, 6
    s_add_u32 s71, s71, 0xa8000
    s_add_u32 m0, s73, 0xb000
    s_nop 0
    buffer_load_dwordx4 v4, s[76:79], s71 offen lds
    s_lshl_b32 s71, s67, 6
    s_add_u32 s71, s71, 0xe0000
    s_add_u32 m0, s73, 0xc000
    s_nop 0
    buffer_load_dwordx4 v4, s[76:79], s71 offen lds
    s_lshl_b32 s71, s67, 6
    s_add_u32 s71, s71, 0x118000
    s_add_u32 m0, s73, 0xd000
    s_nop 0
    buffer_load_dwordx4 v4, s[76:79], s71 offen lds
    s_lshl_b32 s71, s67, 6
    s_add_u32 s71, s71, 0x150000
    s_add_u32 m0, s73, 0xe000
    s_nop 0
    buffer_load_dwordx4 v4, s[76:79], s71 offen lds
    s_lshl_b32 s71, s67, 6
    s_add_u32 s71, s71, 0x188000
    s_add_u32 m0, s73, 0xf000
    s_nop 0
    buffer_load_dwordx4 v4, s[76:79], s71 offen lds
L_part_120:
    s_cmp_lg_u32 s80, 4
    s_cbranch_scc1 L_part_121
    s_load_dwordx2 s[76:77], s[0:1], 80
    s_waitcnt lgkmcnt(0)
    s_and_b32 s77, s77, 0xffff
    s_mov_b32 s78, 0x1c0000
    s_mov_b32 s79, 0x20000
    s_lshl_b32 s71, s67, 6
    s_add_u32 s71, s71, 0x0
    s_add_u32 m0, s73, 0x10000
    s_nop 0
    buffer_load_dwordx4 v4, s[76:79], s71 offen lds
    s_lshl_b32 s71, s67, 6
    s_add_u32 s71, s71, 0x38000
    s_add_u32 m0, s73, 0x11000
    s_nop 0
    buffer_load_dwordx4 v4, s[76:79], s71 offen lds
    s_lshl_b32 s71, s67, 6
    s_add_u32 s71, s71, 0x70000
    s_add_u32 m0, s73, 0x12000
    s_nop 0
    buffer_load_dwordx4 v4, s[76:79], s71 offen lds
    s_lshl_b32 s71, s67, 6
    s_add_u32 s71, s71, 0xa8000
    s_add_u32 m0, s73, 0x13000
    s_nop 0
    buffer_load_dwordx4 v4, s[76:79], s71 offen lds
    s_lshl_b32 s71, s67, 6
    s_add_u32 s71, s71, 0xe0000
    s_add_u32 m0, s73, 0x14000
    s_nop 0
    buffer_load_dwordx4 v4, s[76:79], s71 offen lds
    s_lshl_b32 s71, s67, 6
    s_add_u32 s71, s71, 0x118000
    s_add_u32 m0, s73, 0x15000
    s_nop 0
    buffer_load_dwordx4 v4, s[76:79], s71 offen lds
    s_lshl_b32 s71, s67, 6
    s_add_u32 s71, s71, 0x150000
    s_add_u32 m0, s73, 0x16000
    s_nop 0
    buffer_load_dwordx4 v4, s[76:79], s71 offen lds
    s_lshl_b32 s71, s67, 6
    s_add_u32 s71, s71, 0x188000
    s_add_u32 m0, s73, 0x17000
    s_nop 0
    buffer_load_dwordx4 v4, s[76:79], s71 offen lds
L_part_121:
    s_cmp_lg_u32 s80, 8
    s_cbranch_scc1 L_part_122
    s_load_dwordx2 s[76:77], s[0:1], 88
    s_waitcnt lgkmcnt(0)
    s_and_b32 s77, s77, 0xffff
    s_mov_b32 s78, 0x1c0000
    s_mov_b32 s79, 0x20000
    v_lshlrev_b32 v5, 4, v1
    v_add_u32 v5, s73, v5
    s_lshl_b32 s71, s67, 15
    s_add_u32 s71, s71, 0
    s_add_u32 m0, s73, 0x18000
    s_nop 0
    buffer_load_dwordx4 v5, s[76:79], s71 offen lds
    s_lshl_b32 s71, s67, 15
    s_add_u32 s71, s71, 4096
    s_add_u32 m0, s73, 0x19000
    s_nop 0
    buffer_load_dwordx4 v5, s[76:79], s71 offen lds
    s_lshl_b32 s71, s67, 15
    s_add_u32 s71, s71, 8192
    s_add_u32 m0, s73, 0x1a000
    s_nop 0
    buffer_load_dwordx4 v5, s[76:79], s71 offen lds
    s_lshl_b32 s71, s67, 15
    s_add_u32 s71, s71, 12288
    s_add_u32 m0, s73, 0x1b000
    s_nop 0
    buffer_load_dwordx4 v5, s[76:79], s71 offen lds
    s_lshl_b32 s71, s67, 15
    s_add_u32 s71, s71, 16384
    s_add_u32 m0, s73, 0x1c000
    s_nop 0
    buffer_load_dwordx4 v5, s[76:79], s71 offen lds
    s_lshl_b32 s71, s67, 15
    s_add_u32 s71, s71, 20480
    s_add_u32 m0, s73, 0x1d000
    s_nop 0
    buffer_load_dwordx4 v5, s[76:79], s71 offen lds
    s_lshl_b32 s71, s67, 15
    s_add_u32 s71, s71, 24576
    s_add_u32 m0, s73, 0x1e000
    s_nop 0
    buffer_load_dwordx4 v5, s[76:79], s71 offen lds
    s_lshl_b32 s71, s67, 15
    s_add_u32 s71, s71, 28672
    s_add_u32 m0, s73, 0x1f000
    s_nop 0
    buffer_load_dwordx4 v5, s[76:79], s71 offen lds
L_part_122:
L_nostage_119:
    s_lshl_b32 s24, s22, 5
    s_lshl_b32 s25, s20, 1
    s_add_u32 s24, s24, s25
    s_lshr_b32 s25, s21, 1
    s_add_u32 s24, s24, s25
    s_lshl_b32 s25, s24, 13
    s_add_u32 s47, s25, 0x1000000
    s_add_u32 s54, s47, 4096
    s_add_u32 s48, s25, 0x2000000
    s_add_u32 s55, s48, 4096
    s_and_b32 s26, s21, 1
    s_lshl_b32 s26, s26, 12
    s_add_u32 s46, s25, s26
    s_add_u32 s46, s46, 0x3000000
    s_lshl_b32 s25, s24, 12
    s_add_u32 s49, s25, 0x240000
    s_lshl_b32 s24, s22, 4
    s_add_u32 s24, s24, s20
    s_lshl_b32 s24, s24, 15
    s_add_u32 s51, s24, 0x4000000
    buffer_load_dwordx4 v[0:3], v240, s[8:11], s46 offen
    buffer_load_dwordx4 v[4:7], v240, s[8:11], s46 offen offset:1024
    buffer_load_dwordx4 v[8:11], v240, s[8:11], s46 offen offset:2048
    buffer_load_dwordx4 v[12:15], v240, s[8:11], s46 offen offset:3072
    buffer_load_dwordx4 v[16:19], v240, s[8:11], s47 offen
    buffer_load_dwordx4 v[20:23], v240, s[8:11], s47 offen offset:1024
    buffer_load_dwordx4 v[24:27], v240, s[8:11], s47 offen offset:2048
    buffer_load_dwordx4 v[28:31], v240, s[8:11], s47 offen offset:3072
    buffer_load_dwordx4 v[32:35], v240, s[8:11], s54 offen
    buffer_load_dwordx4 v[36:39], v240, s[8:11], s54 offen offset:1024
    buffer_load_dwordx4 v[40:43], v240, s[8:11], s54 offen offset:2048
    buffer_load_dwordx4 v[44:47], v240, s[8:11], s54 offen offset:3072
    buffer_load_dwordx4 v[64:67], v240, s[8:11], s48 offen
    buffer_load_dwordx4 v[68:71], v240, s[8:11], s48 offen offset:1024
    buffer_load_dwordx4 v[72:75], v240, s[8:11], s48 offen offset:2048
    buffer_load_dwordx4 v[76:79], v240, s[8:11], s48 offen offset:3072
    buffer_load_dwordx4 v[80:83], v240, s[8:11], s55 offen
    buffer_load_dwordx4 v[84:87], v240, s[8:11], s55 offen offset:1024
    buffer_load_dwordx4 v[88:91], v240, s[8:11], s55 offen offset:2048
    buffer_load_dwordx4 v[92:95], v240, s[8:11], s55 offen offset:3072
    s_waitcnt vmcnt(8)
    v_mfma_f32_16x16x32_bf16 v[116:119], v[16:19], v[0:3], 0
    v_mfma_f32_16x16x32_bf16 v[116:119], v[20:23], v[4:7], v[116:119]
    v_mfma_f32_16x16x32_bf16 v[116:119], v[24:27], v[8:11], v[116:119]
    v_mfma_f32_16x16x32_bf16 v[116:119], v[28:31], v[12:15], v[116:119]
    v_mfma_f32_16x16x32_bf16 v[120:123], v[32:35], v[0:3], 0
    v_mfma_f32_16x16x32_bf16 v[120:123], v[36:39], v[4:7], v[120:123]
    v_mfma_f32_16x16x32_bf16 v[120:123], v[40:43], v[8:11], v[120:123]
    v_mfma_f32_16x16x32_bf16 v[120:123], v[44:47], v[12:15], v[120:123]
    v_mov_b32 v247, s53
    v_cndmask_b32 v116, v247, v116, s[30:31]
    v_cndmask_b32 v117, v247, v117, s[32:33]
    v_cndmask_b32 v118, v247, v118, s[34:35]
    v_cndmask_b32 v119, v247, v119, s[36:37]
    s_nop 2
    v_cndmask_b32 v120, v247, v120, s[38:39]
    v_cndmask_b32 v121, v247, v121, s[40:41]
    v_cndmask_b32 v122, v247, v122, s[42:43]
    v_cndmask_b32 v123, v247, v123, s[44:45]
    v_max3_f32 v251, v116, v117, v118
    v_max3_f32 v251, v251, v119, v120
    v_max3_f32 v251, v251, v121, v122
    v_lshrrev_b32 v246, 2, v240
    s_lshl_b32 s24, s20, 7
    s_add_u32 s24, s24, 0x1000
    s_add_u32 s25, s22, 1
    s_nop 1
    s_cmp_lg_u32 s100, 0
    s_cbranch_scc1 L_polls_125
    s_mov_b32 exec_lo, 0x11
    s_mov_b32 exec_hi, 0
    s_mov_b32 s96, 0
L_poll_123:
    buffer_load_dword v247, v246, s[8:11], s24 offen sc1
    s_waitcnt vmcnt(0)
    v_cmp_gt_u32 vcc, s25, v247
    s_cbranch_vccz L_polld_124
    v_readfirstlane_b32 s97, v247
    s_nop 0
    s_sub_u32 s97, s25, s97
    s_cmp_lt_i32 s97, 3
    s_cbranch_scc1 L_near_126
    s_sleep 40
    s_cmp_lt_i32 s97, 5
    s_cbranch_scc1 L_near_126
    s_sleep 100
L_near_126:
    s_sleep 8
    s_add_u32 s96, s96, 1
    s_cmp_lt_u32 s96, 0x10000
    s_cbranch_scc1 L_poll_123
L_polld_124:
    s_mov_b64 exec, -1
L_polls_125:
    s_barrier
    buffer_load_dwordx4 v[172:175], v240, s[8:11], s49 offen
    buffer_load_dwordx4 v[176:179], v240, s[8:11], s49 offen offset:1024
    buffer_load_dwordx4 v[180:183], v240, s[8:11], s49 offen offset:2048
    buffer_load_dwordx4 v[184:187], v240, s[8:11], s49 offen offset:3072
    s_waitcnt vmcnt(0)
    ds_write_b32 v253, v173
    ds_write_b32 v253, v175 offset:64
    ds_write_b32 v253, v177 offset:1024
    ds_write_b32 v253, v179 offset:1088
    ds_write_b32 v253, v181 offset:2048
    ds_write_b32 v253, v183 offset:2112
    ds_write_b32 v253, v185 offset:3072
    ds_write_b32 v253, v187 offset:3136
    ds_read_b128 v[48:51], v254
    ds_read_b128 v[52:55], v254 offset:1024
    ds_read_b128 v[56:59], v254 offset:2048
    ds_read_b128 v[60:63], v254 offset:3072
    s_waitcnt lgkmcnt(0)
    v_mfma_f32_16x16x32_bf16 v[112:115], v[48:51], v[0:3], 0
    v_mfma_f32_16x16x32_bf16 v[112:115], v[52:55], v[4:7], v[112:115]
    v_mfma_f32_16x16x32_bf16 v[112:115], v[56:59], v[8:11], v[112:115]
    v_mfma_f32_16x16x32_bf16 v[112:115], v[60:63], v[12:15], v[112:115]
    v_mov_b32 v246, v251
    s_nop 6
    v_max3_f32 v246, v246, v123, v112
    v_max_f32 v246, v246, v113
    v_mov_b32 v247, v246
    s_nop 1
    v_permlane32_swap_b32 v247, v246
    v_max_f32 v246, v247, v246
    v_mov_b32 v247, v246
    s_nop 1
    v_permlane16_swap_b32 v247, v246
    v_max_f32 v246, v247, v246
    v_mul_f32 v248, s28, v246
    v_pk_fma_f32 v[116:117], v[116:117], s[28:29], v[248:249] op_sel_hi:[1,1,0] neg_lo:[0,0,1] neg_hi:[0,0,1]
    v_pk_fma_f32 v[118:119], v[118:119], s[28:29], v[248:249] op_sel_hi:[1,1,0] neg_lo:[0,0,1] neg_hi:[0,0,1]
    v_pk_fma_f32 v[120:121], v[120:121], s[28:29], v[248:249] op_sel_hi:[1,1,0] neg_lo:[0,0,1] neg_hi:[0,0,1]
    v_pk_fma_f32 v[122:123], v[122:123], s[28:29], v[248:249] op_sel_hi:[1,1,0] neg_lo:[0,0,1] neg_hi:[0,0,1]
    v_pk_fma_f32 v[112:113], v[112:113], s[28:29], v[248:249] op_sel_hi:[1,1,0] neg_lo:[0,0,1] neg_hi:[0,0,1]
    v_exp_f32 v116, v116
    v_exp_f32 v117, v117
    v_exp_f32 v118, v118
    v_exp_f32 v119, v119
    v_exp_f32 v120, v120
    v_exp_f32 v121, v121
    v_exp_f32 v122, v122
    v_exp_f32 v123, v123
    v_exp_f32 v112, v112
    v_exp_f32 v113, v113
    v_cvt_pk_bf16_f32 v124, v116, v117
    v_cvt_pk_bf16_f32 v125, v118, v119
    v_cvt_pk_bf16_f32 v126, v120, v121
    v_cvt_pk_bf16_f32 v127, v122, v123
    v_cvt_pk_bf16_f32 v128, v112, v113
    v_mov_b32 v129, 0
    v_mfma_f32_16x16x32_bf16 v[132:135], v[136:139], v[124:127], 0
    v_mfma_f32_16x16x32_bf16 v[140:143], v[64:67], v[124:127], 0
    v_mfma_f32_16x16x32_bf16 v[144:147], v[68:71], v[124:127], 0
    v_mfma_f32_16x16x32_bf16 v[148:151], v[72:75], v[124:127], 0
    v_mfma_f32_16x16x32_bf16 v[152:155], v[76:79], v[124:127], 0
    v_mfma_f32_16x16x32_bf16 v[156:159], v[80:83], v[124:127], 0
    v_mfma_f32_16x16x32_bf16 v[160:163], v[84:87], v[124:127], 0
    v_mfma_f32_16x16x32_bf16 v[164:167], v[88:91], v[124:127], 0
    v_mfma_f32_16x16x32_bf16 v[168:171], v[92:95], v[124:127], 0
    v_mfma_f32_16x16x16_bf16 v[132:135], v[136:137], v[128:129], v[132:135]
    v_mfma_f32_16x16x16_bf16 v[140:143], v[172:173], v[128:129], v[140:143]
    v_mfma_f32_16x16x16_bf16 v[144:147], v[174:175], v[128:129], v[144:147]
    v_mfma_f32_16x16x16_bf16 v[148:151], v[176:177], v[128:129], v[148:151]
    v_mfma_f32_16x16x16_bf16 v[152:155], v[178:179], v[128:129], v[152:155]
    v_mfma_f32_16x16x16_bf16 v[156:159], v[180:181], v[128:129], v[156:159]
    v_mfma_f32_16x16x16_bf16 v[160:163], v[182:183], v[128:129], v[160:163]
    v_mfma_f32_16x16x16_bf16 v[164:167], v[184:185], v[128:129], v[164:167]
    v_mfma_f32_16x16x16_bf16 v[168:171], v[186:187], v[128:129], v[168:171]
    v_rcp_f32 v250, v132
    s_nop 0
    v_pk_mul_f32 v[140:141], v[140:141], v[250:251] op_sel_hi:[1,0]
    v_pk_mul_f32 v[142:143], v[142:143], v[250:251] op_sel_hi:[1,0]
    v_pk_mul_f32 v[144:145], v[144:145], v[250:251] op_sel_hi:[1,0]
    v_pk_mul_f32 v[146:147], v[146:147], v[250:251] op_sel_hi:[1,0]
    v_pk_mul_f32 v[148:149], v[148:149], v[250:251] op_sel_hi:[1,0]
    v_pk_mul_f32 v[150:151], v[150:151], v[250:251] op_sel_hi:[1,0]
    v_pk_mul_f32 v[152:153], v[152:153], v[250:251] op_sel_hi:[1,0]
    v_pk_mul_f32 v[154:155], v[154:155], v[250:251] op_sel_hi:[1,0]
    v_pk_mul_f32 v[156:157], v[156:157], v[250:251] op_sel_hi:[1,0]
    v_pk_mul_f32 v[158:159], v[158:159], v[250:251] op_sel_hi:[1,0]
    v_pk_mul_f32 v[160:161], v[160:161], v[250:251] op_sel_hi:[1,0]
    v_pk_mul_f32 v[162:163], v[162:163], v[250:251] op_sel_hi:[1,0]
    v_pk_mul_f32 v[164:165], v[164:165], v[250:251] op_sel_hi:[1,0]
    v_pk_mul_f32 v[166:167], v[166:167], v[250:251] op_sel_hi:[1,0]
    v_pk_mul_f32 v[168:169], v[168:169], v[250:251] op_sel_hi:[1,0]
    v_pk_mul_f32 v[170:171], v[170:171], v[250:251] op_sel_hi:[1,0]
    v_cvt_pk_bf16_f32 v140, v140, v141
    v_cvt_pk_bf16_f32 v141, v142, v143
    v_cvt_pk_bf16_f32 v142, v144, v145
    v_cvt_pk_bf16_f32 v143, v146, v147
    v_cvt_pk_bf16_f32 v144, v148, v149
    v_cvt_pk_bf16_f32 v145, v150, v151
    v_cvt_pk_bf16_f32 v146, v152, v153
    v_cvt_pk_bf16_f32 v147, v154, v155
    v_cvt_pk_bf16_f32 v148, v156, v157
    v_cvt_pk_bf16_f32 v149, v158, v159
    v_cvt_pk_bf16_f32 v150, v160, v161
    v_cvt_pk_bf16_f32 v151, v162, v163
    v_cvt_pk_bf16_f32 v152, v164, v165
    v_cvt_pk_bf16_f32 v153, v166, v167
    v_cvt_pk_bf16_f32 v154, v168, v169
    v_cvt_pk_bf16_f32 v155, v170, v171
    ds_write_b128 v243, v[140:143]
    ds_write_b128 v243, v[144:147] offset:1024
    ds_write_b128 v243, v[148:151] offset:2048
    ds_write_b128 v243, v[152:155] offset:3072
    s_waitcnt lgkmcnt(0)
    s_barrier
    ds_read_b128 v[0:3], v244
    ds_read_b128 v[4:7], v244 offset:1024
    ds_read_b128 v[8:11], v244 offset:2048
    ds_read_b128 v[12:15], v244 offset:3072
    ds_read_b128 v[16:19], v244 offset:4096
    ds_read_b128 v[20:23], v244 offset:5120
    ds_read_b128 v[24:27], v244 offset:6144
    ds_read_b128 v[28:31], v244 offset:7168
    s_waitcnt lgkmcnt(4)
    ds_read_b128 v[32:35], v244 offset:8192
    ds_read_b128 v[36:39], v244 offset:9216
    ds_read_b128 v[40:43], v244 offset:10240
    ds_read_b128 v[44:47], v244 offset:11264
    ds_read_b128 v[48:51], v244 offset:12288
    ds_read_b128 v[52:55], v244 offset:13312
    ds_read_b128 v[56:59], v244 offset:14336
    ds_read_b128 v[60:63], v244 offset:15360
    v_xor_b32 v243, 0x4000, v243
    v_xor_b32 v244, 0x4000, v244
    s_waitcnt lgkmcnt(0)
    v_mfma_f32_16x16x32_bf16 v[172:175], a[0:3], v[0:3], 0
    v_mfma_f32_16x16x32_bf16 v[176:179], a[4:7], v[0:3], 0
    v_mfma_f32_16x16x32_bf16 v[180:183], a[8:11], v[0:3], 0
    v_mfma_f32_16x16x32_bf16 v[184:187], a[12:15], v[0:3], 0
    v_mfma_f32_16x16x32_bf16 v[188:191], a[16:19], v[0:3], 0
    v_mfma_f32_16x16x32_bf16 v[192:195], a[20:23], v[0:3], 0
    v_mfma_f32_16x16x32_bf16 v[196:199], a[24:27], v[0:3], 0
    v_mfma_f32_16x16x32_bf16 v[200:203], a[28:31], v[0:3], 0
    v_mfma_f32_16x16x32_bf16 v[172:175], a[32:35], v[4:7], v[172:175]
    v_mfma_f32_16x16x32_bf16 v[176:179], a[36:39], v[4:7], v[176:179]
    v_mfma_f32_16x16x32_bf16 v[180:183], a[40:43], v[4:7], v[180:183]
    v_mfma_f32_16x16x32_bf16 v[184:187], a[44:47], v[4:7], v[184:187]
    v_mfma_f32_16x16x32_bf16 v[188:191], a[48:51], v[4:7], v[188:191]
    v_mfma_f32_16x16x32_bf16 v[192:195], a[52:55], v[4:7], v[192:195]
    v_mfma_f32_16x16x32_bf16 v[196:199], a[56:59], v[4:7], v[196:199]
    v_mfma_f32_16x16x32_bf16 v[200:203], a[60:63], v[4:7], v[200:203]
    v_mfma_f32_16x16x32_bf16 v[172:175], a[64:67], v[8:11], v[172:175]
    v_mfma_f32_16x16x32_bf16 v[176:179], a[68:71], v[8:11], v[176:179]
    v_mfma_f32_16x16x32_bf16 v[180:183], a[72:75], v[8:11], v[180:183]
    v_mfma_f32_16x16x32_bf16 v[184:187], a[76:79], v[8:11], v[184:187]
    v_mfma_f32_16x16x32_bf16 v[188:191], a[80:83], v[8:11], v[188:191]
    v_mfma_f32_16x16x32_bf16 v[192:195], a[84:87], v[8:11], v[192:195]
    v_mfma_f32_16x16x32_bf16 v[196:199], a[88:91], v[8:11], v[196:199]
    v_mfma_f32_16x16x32_bf16 v[200:203], a[92:95], v[8:11], v[200:203]
    v_mfma_f32_16x16x32_bf16 v[172:175], a[96:99], v[12:15], v[172:175]
    v_mfma_f32_16x16x32_bf16 v[176:179], a[100:103], v[12:15], v[176:179]
    v_mfma_f32_16x16x32_bf16 v[180:183], a[104:107], v[12:15], v[180:183]
    v_mfma_f32_16x16x32_bf16 v[184:187], a[108:111], v[12:15], v[184:187]
    v_mfma_f32_16x16x32_bf16 v[188:191], a[112:115], v[12:15], v[188:191]
    v_mfma_f32_16x16x32_bf16 v[192:195], a[116:119], v[12:15], v[192:195]
    v_mfma_f32_16x16x32_bf16 v[196:199], a[120:123], v[12:15], v[196:199]
    v_mfma_f32_16x16x32_bf16 v[200:203], a[124:127], v[12:15], v[200:203]
    v_mfma_f32_16x16x32_bf16 v[172:175], a[128:131], v[32:35], v[172:175]
    v_mfma_f32_16x16x32_bf16 v[176:179], a[132:135], v[32:35], v[176:179]
    v_mfma_f32_16x16x32_bf16 v[180:183], a[136:139], v[32:35], v[180:183]
    v_mfma_f32_16x16x32_bf16 v[184:187], a[140:143], v[32:35], v[184:187]
    v_mfma_f32_16x16x32_bf16 v[188:191], a[144:147], v[32:35], v[188:191]
    v_mfma_f32_16x16x32_bf16 v[192:195], a[148:151], v[32:35], v[192:195]
    v_mfma_f32_16x16x32_bf16 v[196:199], a[152:155], v[32:35], v[196:199]
    v_mfma_f32_16x16x32_bf16 v[200:203], a[156:159], v[32:35], v[200:203]
    v_mfma_f32_16x16x32_bf16 v[172:175], a[160:163], v[36:39], v[172:175]
    v_mfma_f32_16x16x32_bf16 v[176:179], a[164:167], v[36:39], v[176:179]
    v_mfma_f32_16x16x32_bf16 v[180:183], a[168:171], v[36:39], v[180:183]
    v_mfma_f32_16x16x32_bf16 v[184:187], a[172:175], v[36:39], v[184:187]
    v_mfma_f32_16x16x32_bf16 v[188:191], a[176:179], v[36:39], v[188:191]
    v_mfma_f32_16x16x32_bf16 v[192:195], a[180:183], v[36:39], v[192:195]
    v_mfma_f32_16x16x32_bf16 v[196:199], a[184:187], v[36:39], v[196:199]
    v_mfma_f32_16x16x32_bf16 v[200:203], a[188:191], v[36:39], v[200:203]
    v_mfma_f32_16x16x32_bf16 v[172:175], a[192:195], v[40:43], v[172:175]
    v_mfma_f32_16x16x32_bf16 v[176:179], a[196:199], v[40:43], v[176:179]
    v_mfma_f32_16x16x32_bf16 v[180:183], a[200:203], v[40:43], v[180:183]
    v_mfma_f32_16x16x32_bf16 v[184:187], a[204:207], v[40:43], v[184:187]
    v_mfma_f32_16x16x32_bf16 v[188:191], a[208:211], v[40:43], v[188:191]
    v_mfma_f32_16x16x32_bf16 v[192:195], a[212:215], v[40:43], v[192:195]
    v_mfma_f32_16x16x32_bf16 v[196:199], a[216:219], v[40:43], v[196:199]
    v_mfma_f32_16x16x32_bf16 v[200:203], a[220:223], v[40:43], v[200:203]
    v_mfma_f32_16x16x32_bf16 v[172:175], a[224:227], v[44:47], v[172:175]
    v_mfma_f32_16x16x32_bf16 v[176:179], a[228:231], v[44:47], v[176:179]
    v_mfma_f32_16x16x32_bf16 v[180:183], a[232:235], v[44:47], v[180:183]
    v_mfma_f32_16x16x32_bf16 v[184:187], a[236:239], v[44:47], v[184:187]
    v_mfma_f32_16x16x32_bf16 v[188:191], a[240:243], v[44:47], v[188:191]
    v_mfma_f32_16x16x32_bf16 v[192:195], a[244:247], v[44:47], v[192:195]
    v_mfma_f32_16x16x32_bf16 v[196:199], a[248:251], v[44:47], v[196:199]
    v_mfma_f32_16x16x32_bf16 v[200:203], a[252:255], v[44:47], v[200:203]
    v_mfma_f32_16x16x32_bf16 v[204:207], a[0:3], v[16:19], 0
    v_mfma_f32_16x16x32_bf16 v[208:211], a[4:7], v[16:19], 0
    v_mfma_f32_16x16x32_bf16 v[212:215], a[8:11], v[16:19], 0
    v_mfma_f32_16x16x32_bf16 v[216:219], a[12:15], v[16:19], 0
    v_mfma_f32_16x16x32_bf16 v[220:223], a[16:19], v[16:19], 0
    v_mfma_f32_16x16x32_bf16 v[224:227], a[20:23], v[16:19], 0
    v_mfma_f32_16x16x32_bf16 v[228:231], a[24:27], v[16:19], 0
    v_mfma_f32_16x16x32_bf16 v[232:235], a[28:31], v[16:19], 0
    v_cvt_pk_bf16_f32 v140, v172, v173
    v_cvt_pk_bf16_f32 v141, v174, v175
    v_cvt_pk_bf16_f32 v142, v176, v177
    v_cvt_pk_bf16_f32 v143, v178, v179
    s_add_u32 s24, s51, 0
    buffer_store_dwordx4 v[140:143], v242, s[8:11], s24 offen sc1
    v_mfma_f32_16x16x32_bf16 v[204:207], a[32:35], v[20:23], v[204:207]
    v_mfma_f32_16x16x32_bf16 v[208:211], a[36:39], v[20:23], v[208:211]
    v_mfma_f32_16x16x32_bf16 v[212:215], a[40:43], v[20:23], v[212:215]
    v_mfma_f32_16x16x32_bf16 v[216:219], a[44:47], v[20:23], v[216:219]
    v_mfma_f32_16x16x32_bf16 v[220:223], a[48:51], v[20:23], v[220:223]
    v_mfma_f32_16x16x32_bf16 v[224:227], a[52:55], v[20:23], v[224:227]
    v_mfma_f32_16x16x32_bf16 v[228:231], a[56:59], v[20:23], v[228:231]
    v_mfma_f32_16x16x32_bf16 v[232:235], a[60:63], v[20:23], v[232:235]
    v_cvt_pk_bf16_f32 v144, v180, v181
    v_cvt_pk_bf16_f32 v145, v182, v183
    v_cvt_pk_bf16_f32 v146, v184, v185
    v_cvt_pk_bf16_f32 v147, v186, v187
    buffer_store_dwordx4 v[144:147], v242, s[8:11], s24 offen offset:64 sc1
    v_mfma_f32_16x16x32_bf16 v[204:207], a[64:67], v[24:27], v[204:207]
    v_mfma_f32_16x16x32_bf16 v[208:211], a[68:71], v[24:27], v[208:211]
    v_mfma_f32_16x16x32_bf16 v[212:215], a[72:75], v[24:27], v[212:215]
    v_mfma_f32_16x16x32_bf16 v[216:219], a[76:79], v[24:27], v[216:219]
    v_mfma_f32_16x16x32_bf16 v[220:223], a[80:83], v[24:27], v[220:223]
    v_mfma_f32_16x16x32_bf16 v[224:227], a[84:87], v[24:27], v[224:227]
    v_mfma_f32_16x16x32_bf16 v[228:231], a[88:91], v[24:27], v[228:231]
    v_mfma_f32_16x16x32_bf16 v[232:235], a[92:95], v[24:27], v[232:235]
    v_cvt_pk_bf16_f32 v148, v188, v189
    v_cvt_pk_bf16_f32 v149, v190, v191
    v_cvt_pk_bf16_f32 v150, v192, v193
    v_cvt_pk_bf16_f32 v151, v194, v195
    buffer_store_dwordx4 v[148:151], v242, s[8:11], s24 offen offset:128 sc1
    v_mfma_f32_16x16x32_bf16 v[204:207], a[96:99], v[28:31], v[204:207]
    v_mfma_f32_16x16x32_bf16 v[208:211], a[100:103], v[28:31], v[208:211]
    v_mfma_f32_16x16x32_bf16 v[212:215], a[104:107], v[28:31], v[212:215]
    v_mfma_f32_16x16x32_bf16 v[216:219], a[108:111], v[28:31], v[216:219]
    v_mfma_f32_16x16x32_bf16 v[220:223], a[112:115], v[28:31], v[220:223]
    v_mfma_f32_16x16x32_bf16 v[224:227], a[116:119], v[28:31], v[224:227]
    v_mfma_f32_16x16x32_bf16 v[228:231], a[120:123], v[28:31], v[228:231]
    v_mfma_f32_16x16x32_bf16 v[232:235], a[124:127], v[28:31], v[232:235]
    v_cvt_pk_bf16_f32 v152, v196, v197
    v_cvt_pk_bf16_f32 v153, v198, v199
    v_cvt_pk_bf16_f32 v154, v200, v201
    v_cvt_pk_bf16_f32 v155, v202, v203
    buffer_store_dwordx4 v[152:155], v242, s[8:11], s24 offen offset:192 sc1
    v_mfma_f32_16x16x32_bf16 v[204:207], a[128:131], v[48:51], v[204:207]
    v_mfma_f32_16x16x32_bf16 v[208:211], a[132:135], v[48:51], v[208:211]
    v_mfma_f32_16x16x32_bf16 v[212:215], a[136:139], v[48:51], v[212:215]
    v_mfma_f32_16x16x32_bf16 v[216:219], a[140:143], v[48:51], v[216:219]
    v_mfma_f32_16x16x32_bf16 v[220:223], a[144:147], v[48:51], v[220:223]
    v_mfma_f32_16x16x32_bf16 v[224:227], a[148:151], v[48:51], v[224:227]
    v_mfma_f32_16x16x32_bf16 v[228:231], a[152:155], v[48:51], v[228:231]
    v_mfma_f32_16x16x32_bf16 v[232:235], a[156:159], v[48:51], v[232:235]
    v_mfma_f32_16x16x32_bf16 v[204:207], a[160:163], v[52:55], v[204:207]
    v_mfma_f32_16x16x32_bf16 v[208:211], a[164:167], v[52:55], v[208:211]
    v_mfma_f32_16x16x32_bf16 v[212:215], a[168:171], v[52:55], v[212:215]
    v_mfma_f32_16x16x32_bf16 v[216:219], a[172:175], v[52:55], v[216:219]
    v_mfma_f32_16x16x32_bf16 v[220:223], a[176:179], v[52:55], v[220:223]
    v_mfma_f32_16x16x32_bf16 v[224:227], a[180:183], v[52:55], v[224:227]
    v_mfma_f32_16x16x32_bf16 v[228:231], a[184:187], v[52:55], v[228:231]
    v_mfma_f32_16x16x32_bf16 v[232:235], a[188:191], v[52:55], v[232:235]
    v_mfma_f32_16x16x32_bf16 v[204:207], a[192:195], v[56:59], v[204:207]
    v_mfma_f32_16x16x32_bf16 v[208:211], a[196:199], v[56:59], v[208:211]
    v_mfma_f32_16x16x32_bf16 v[212:215], a[200:203], v[56:59], v[212:215]
    v_mfma_f32_16x16x32_bf16 v[216:219], a[204:207], v[56:59], v[216:219]
    v_mfma_f32_16x16x32_bf16 v[220:223], a[208:211], v[56:59], v[220:223]
    v_mfma_f32_16x16x32_bf16 v[224:227], a[212:215], v[56:59], v[224:227]
    v_mfma_f32_16x16x32_bf16 v[228:231], a[216:219], v[56:59], v[228:231]
    v_mfma_f32_16x16x32_bf16 v[232:235], a[220:223], v[56:59], v[232:235]
    v_mfma_f32_16x16x32_bf16 v[204:207], a[224:227], v[60:63], v[204:207]
    v_mfma_f32_16x16x32_bf16 v[208:211], a[228:231], v[60:63], v[208:211]
    v_mfma_f32_16x16x32_bf16 v[212:215], a[232:235], v[60:63], v[212:215]
    v_mfma_f32_16x16x32_bf16 v[216:219], a[236:239], v[60:63], v[216:219]
    v_mfma_f32_16x16x32_bf16 v[220:223], a[240:243], v[60:63], v[220:223]
    v_mfma_f32_16x16x32_bf16 v[224:227], a[244:247], v[60:63], v[224:227]
    v_mfma_f32_16x16x32_bf16 v[228:231], a[248:251], v[60:63], v[228:231]
    v_mfma_f32_16x16x32_bf16 v[232:235], a[252:255], v[60:63], v[232:235]
    v_cvt_pk_bf16_f32 v140, v204, v205
    v_cvt_pk_bf16_f32 v141, v206, v207
    v_cvt_pk_bf16_f32 v142, v208, v209
    v_cvt_pk_bf16_f32 v143, v210, v211
    s_add_u32 s24, s51, 16384
    buffer_store_dwordx4 v[140:143], v242, s[8:11], s24 offen sc1
    v_cvt_pk_bf16_f32 v144, v212, v213
    v_cvt_pk_bf16_f32 v145, v214, v215
    v_cvt_pk_bf16_f32 v146, v216, v217
    v_cvt_pk_bf16_f32 v147, v218, v219
    buffer_store_dwordx4 v[144:147], v242, s[8:11], s24 offen offset:64 sc1
    v_cvt_pk_bf16_f32 v148, v220, v221
    v_cvt_pk_bf16_f32 v149, v222, v223
    v_cvt_pk_bf16_f32 v150, v224, v225
    v_cvt_pk_bf16_f32 v151, v226, v227
    buffer_store_dwordx4 v[148:151], v242, s[8:11], s24 offen offset:128 sc1
    v_cvt_pk_bf16_f32 v152, v228, v229
    v_cvt_pk_bf16_f32 v153, v230, v231
    v_cvt_pk_bf16_f32 v154, v232, v233
    v_cvt_pk_bf16_f32 v155, v234, v235
    buffer_store_dwordx4 v[152:155], v242, s[8:11], s24 offen offset:192 sc1
    s_waitcnt vmcnt(0)
    s_barrier
    s_lshl_b32 s25, s22, 6
    s_add_u32 s25, s25, 0x4000
    s_lshl_b32 s24, s20, 2
    s_add_u32 s24, s24, s25
    s_cmp_lg_u32 s100, 0
    s_cbranch_scc1 L_flag_127
    v_mov_b32 v246, 1
    s_mov_b64 exec, 1
    buffer_store_dword v246, off, s[8:11], s24 sc1
    s_mov_b64 exec, -1
L_flag_127:
    v_lshrrev_b32 v246, 2, v240
    s_cmp_lg_u32 s100, 0
    s_cbranch_scc1 L_polls_130
    s_mov_b32 exec_lo, 0xffff
    s_mov_b32 exec_hi, 0
    s_mov_b32 s96, 0
L_poll_128:
    buffer_load_dword v247, v246, s[8:11], s25 offen sc1
    s_waitcnt vmcnt(0)
    v_cmp_gt_u32 vcc, 1, v247
    s_cbranch_vccz L_polld_129
    s_sleep 2
    s_add_u32 s96, s96, 1
    s_cmp_lt_u32 s96, 0x10000
    s_cbranch_scc1 L_poll_128
L_polld_129:
    s_mov_b64 exec, -1
L_polls_130:
    s_barrier
    s_cmp_ge_u32 s100, 2
    s_cbranch_scc1 L_nofin_131
    s_lshl_b32 s60, s22, 5
    s_lshl_b32 s24, s20, 1
    s_add_u32 s60, s60, s24
    s_add_u32 s60, s60, s100
    s_lshr_b32 s62, s60, 5
    s_lshl_b32 s62, s62, 19
    s_and_b32 s63, s60, 31
    s_lshl_b32 s63, s63, 10
    s_add_u32 s62, s62, s63
    s_add_u32 s62, s62, 0x4000000
    s_lshl_b32 s64, s60, 10
    buffer_load_dwordx4 v[64:67], v240, s[12:15], s64 offen
    buffer_load_dwordx4 v[0:3], v240, s[8:11], s62 offen
    s_add_u32 s62, s62, 32768
    buffer_load_dwordx4 v[4:7], v240, s[8:11], s62 offen
    s_add_u32 s62, s62, 32768
    buffer_load_dwordx4 v[8:11], v240, s[8:11], s62 offen
    s_add_u32 s62, s62, 32768
    buffer_load_dwordx4 v[12:15], v240, s[8:11], s62 offen
    s_add_u32 s62, s62, 32768
    buffer_load_dwordx4 v[16:19], v240, s[8:11], s62 offen
    s_add_u32 s62, s62, 32768
    buffer_load_dwordx4 v[20:23], v240, s[8:11], s62 offen
    s_add_u32 s62, s62, 32768
    buffer_load_dwordx4 v[24:27], v240, s[8:11], s62 offen
    s_add_u32 s62, s62, 32768
    buffer_load_dwordx4 v[28:31], v240, s[8:11], s62 offen
    s_add_u32 s62, s62, 32768
    buffer_load_dwordx4 v[32:35], v240, s[8:11], s62 offen
    s_add_u32 s62, s62, 32768
    buffer_load_dwordx4 v[36:39], v240, s[8:11], s62 offen
    s_add_u32 s62, s62, 32768
    buffer_load_dwordx4 v[40:43], v240, s[8:11], s62 offen
    s_add_u32 s62, s62, 32768
    buffer_load_dwordx4 v[44:47], v240, s[8:11], s62 offen
    s_add_u32 s62, s62, 32768
    buffer_load_dwordx4 v[48:51], v240, s[8:11], s62 offen
    s_add_u32 s62, s62, 32768
    buffer_load_dwordx4 v[52:55], v240, s[8:11], s62 offen
    s_add_u32 s62, s62, 32768
    buffer_load_dwordx4 v[56:59], v240, s[8:11], s62 offen
    s_add_u32 s62, s62, 32768
    buffer_load_dwordx4 v[60:63], v240, s[8:11], s62 offen
    v_mov_b32 v68, 0
    v_mov_b32 v69, 0
    v_mov_b32 v70, 0
    v_mov_b32 v71, 0
    v_mov_b32 v72, 0
    v_mov_b32 v73, 0
    v_mov_b32 v74, 0
    v_mov_b32 v75, 0
    s_waitcnt vmcnt(15)
    v_dot2_f32_bf16 v68, v0, s65, v68
    v_dot2_f32_bf16 v69, v0, s66, v69
    v_dot2_f32_bf16 v70, v1, s65, v70
    v_dot2_f32_bf16 v71, v1, s66, v71
    v_dot2_f32_bf16 v72, v2, s65, v72
    v_dot2_f32_bf16 v73, v2, s66, v73
    v_dot2_f32_bf16 v74, v3, s65, v74
    v_dot2_f32_bf16 v75, v3, s66, v75
    s_waitcnt vmcnt(14)
    v_dot2_f32_bf16 v68, v4, s65, v68
    v_dot2_f32_bf16 v69, v4, s66, v69
    v_dot2_f32_bf16 v70, v5, s65, v70
    v_dot2_f32_bf16 v71, v5, s66, v71
    v_dot2_f32_bf16 v72, v6, s65, v72
    v_dot2_f32_bf16 v73, v6, s66, v73
    v_dot2_f32_bf16 v74, v7, s65, v74
    v_dot2_f32_bf16 v75, v7, s66, v75
    s_waitcnt vmcnt(13)
    v_dot2_f32_bf16 v68, v8, s65, v68
    v_dot2_f32_bf16 v69, v8, s66, v69
    v_dot2_f32_bf16 v70, v9, s65, v70
    v_dot2_f32_bf16 v71, v9, s66, v71
    v_dot2_f32_bf16 v72, v10, s65, v72
    v_dot2_f32_bf16 v73, v10, s66, v73
    v_dot2_f32_bf16 v74, v11, s65, v74
    v_dot2_f32_bf16 v75, v11, s66, v75
    s_waitcnt vmcnt(12)
    v_dot2_f32_bf16 v68, v12, s65, v68
    v_dot2_f32_bf16 v69, v12, s66, v69
    v_dot2_f32_bf16 v70, v13, s65, v70
    v_dot2_f32_bf16 v71, v13, s66, v71
    v_dot2_f32_bf16 v72, v14, s65, v72
    v_dot2_f32_bf16 v73, v14, s66, v73
    v_dot2_f32_bf16 v74, v15, s65, v74
    v_dot2_f32_bf16 v75, v15, s66, v75
    s_waitcnt vmcnt(11)
    v_dot2_f32_bf16 v68, v16, s65, v68
    v_dot2_f32_bf16 v69, v16, s66, v69
    v_dot2_f32_bf16 v70, v17, s65, v70
    v_dot2_f32_bf16 v71, v17, s66, v71
    v_dot2_f32_bf16 v72, v18, s65, v72
    v_dot2_f32_bf16 v73, v18, s66, v73
    v_dot2_f32_bf16 v74, v19, s65, v74
    v_dot2_f32_bf16 v75, v19, s66, v75
    s_waitcnt vmcnt(10)
    v_dot2_f32_bf16 v68, v20, s65, v68
    v_dot2_f32_bf16 v69, v20, s66, v69
    v_dot2_f32_bf16 v70, v21, s65, v70
    v_dot2_f32_bf16 v71, v21, s66, v71
    v_dot2_f32_bf16 v72, v22, s65, v72
    v_dot2_f32_bf16 v73, v22, s66, v73
    v_dot2_f32_bf16 v74, v23, s65, v74
    v_dot2_f32_bf16 v75, v23, s66, v75
    s_waitcnt vmcnt(9)
    v_dot2_f32_bf16 v68, v24, s65, v68
    v_dot2_f32_bf16 v69, v24, s66, v69
    v_dot2_f32_bf16 v70, v25, s65, v70
    v_dot2_f32_bf16 v71, v25, s66, v71
    v_dot2_f32_bf16 v72, v26, s65, v72
    v_dot2_f32_bf16 v73, v26, s66, v73
    v_dot2_f32_bf16 v74, v27, s65, v74
    v_dot2_f32_bf16 v75, v27, s66, v75
    s_waitcnt vmcnt(8)
    v_dot2_f32_bf16 v68, v28, s65, v68
    v_dot2_f32_bf16 v69, v28, s66, v69
    v_dot2_f32_bf16 v70, v29, s65, v70
    v_dot2_f32_bf16 v71, v29, s66, v71
    v_dot2_f32_bf16 v72, v30, s65, v72
    v_dot2_f32_bf16 v73, v30, s66, v73
    v_dot2_f32_bf16 v74, v31, s65, v74
    v_dot2_f32_bf16 v75, v31, s66, v75
    s_waitcnt vmcnt(7)
    v_dot2_f32_bf16 v68, v32, s65, v68
    v_dot2_f32_bf16 v69, v32, s66, v69
    v_dot2_f32_bf16 v70, v33, s65, v70
    v_dot2_f32_bf16 v71, v33, s66, v71
    v_dot2_f32_bf16 v72, v34, s65, v72
    v_dot2_f32_bf16 v73, v34, s66, v73
    v_dot2_f32_bf16 v74, v35, s65, v74
    v_dot2_f32_bf16 v75, v35, s66, v75
    s_waitcnt vmcnt(6)
    v_dot2_f32_bf16 v68, v36, s65, v68
    v_dot2_f32_bf16 v69, v36, s66, v69
    v_dot2_f32_bf16 v70, v37, s65, v70
    v_dot2_f32_bf16 v71, v37, s66, v71
    v_dot2_f32_bf16 v72, v38, s65, v72
    v_dot2_f32_bf16 v73, v38, s66, v73
    v_dot2_f32_bf16 v74, v39, s65, v74
    v_dot2_f32_bf16 v75, v39, s66, v75
    s_waitcnt vmcnt(5)
    v_dot2_f32_bf16 v68, v40, s65, v68
    v_dot2_f32_bf16 v69, v40, s66, v69
    v_dot2_f32_bf16 v70, v41, s65, v70
    v_dot2_f32_bf16 v71, v41, s66, v71
    v_dot2_f32_bf16 v72, v42, s65, v72
    v_dot2_f32_bf16 v73, v42, s66, v73
    v_dot2_f32_bf16 v74, v43, s65, v74
    v_dot2_f32_bf16 v75, v43, s66, v75
    s_waitcnt vmcnt(4)
    v_dot2_f32_bf16 v68, v44, s65, v68
    v_dot2_f32_bf16 v69, v44, s66, v69
    v_dot2_f32_bf16 v70, v45, s65, v70
    v_dot2_f32_bf16 v71, v45, s66, v71
    v_dot2_f32_bf16 v72, v46, s65, v72
    v_dot2_f32_bf16 v73, v46, s66, v73
    v_dot2_f32_bf16 v74, v47, s65, v74
    v_dot2_f32_bf16 v75, v47, s66, v75
    s_waitcnt vmcnt(3)
    v_dot2_f32_bf16 v68, v48, s65, v68
    v_dot2_f32_bf16 v69, v48, s66, v69
    v_dot2_f32_bf16 v70, v49, s65, v70
    v_dot2_f32_bf16 v71, v49, s66, v71
    v_dot2_f32_bf16 v72, v50, s65, v72
    v_dot2_f32_bf16 v73, v50, s66, v73
    v_dot2_f32_bf16 v74, v51, s65, v74
    v_dot2_f32_bf16 v75, v51, s66, v75
    s_waitcnt vmcnt(2)
    v_dot2_f32_bf16 v68, v52, s65, v68
    v_dot2_f32_bf16 v69, v52, s66, v69
    v_dot2_f32_bf16 v70, v53, s65, v70
    v_dot2_f32_bf16 v71, v53, s66, v71
    v_dot2_f32_bf16 v72, v54, s65, v72
    v_dot2_f32_bf16 v73, v54, s66, v73
    v_dot2_f32_bf16 v74, v55, s65, v74
    v_dot2_f32_bf16 v75, v55, s66, v75
    s_waitcnt vmcnt(1)
    v_dot2_f32_bf16 v68, v56, s65, v68
    v_dot2_f32_bf16 v69, v56, s66, v69
    v_dot2_f32_bf16 v70, v57, s65, v70
    v_dot2_f32_bf16 v71, v57, s66, v71
    v_dot2_f32_bf16 v72, v58, s65, v72
    v_dot2_f32_bf16 v73, v58, s66, v73
    v_dot2_f32_bf16 v74, v59, s65, v74
    v_dot2_f32_bf16 v75, v59, s66, v75
    s_waitcnt vmcnt(0)
    v_dot2_f32_bf16 v68, v60, s65, v68
    v_dot2_f32_bf16 v69, v60, s66, v69
    v_dot2_f32_bf16 v70, v61, s65, v70
    v_dot2_f32_bf16 v71, v61, s66, v71
    v_dot2_f32_bf16 v72, v62, s65, v72
    v_dot2_f32_bf16 v73, v62, s66, v73
    v_dot2_f32_bf16 v74, v63, s65, v74
    v_dot2_f32_bf16 v75, v63, s66, v75
    v_cvt_pk_bf16_f32 v0, v68, v69
    v_cvt_pk_bf16_f32 v1, v70, v71
    v_cvt_pk_bf16_f32 v2, v72, v73
    v_cvt_pk_bf16_f32 v3, v74, v75
    v_lshlrev_b32 v68, 16, v0
    v_and_b32 v69, 0xffff0000, v0
    v_lshlrev_b32 v76, 16, v64
    v_and_b32 v77, 0xffff0000, v64
    v_lshlrev_b32 v70, 16, v1
    v_and_b32 v71, 0xffff0000, v1
    v_lshlrev_b32 v78, 16, v65
    v_and_b32 v79, 0xffff0000, v65
    v_lshlrev_b32 v72, 16, v2
    v_and_b32 v73, 0xffff0000, v2
    v_lshlrev_b32 v80, 16, v66
    v_and_b32 v81, 0xffff0000, v66
    v_lshlrev_b32 v74, 16, v3
    v_and_b32 v75, 0xffff0000, v3
    v_lshlrev_b32 v82, 16, v67
    v_and_b32 v83, 0xffff0000, v67
    v_pk_add_f32 v[68:69], v[68:69], v[76:77]
    v_pk_add_f32 v[70:71], v[70:71], v[78:79]
    v_pk_add_f32 v[72:73], v[72:73], v[80:81]
    v_pk_add_f32 v[74:75], v[74:75], v[82:83]
    v_cvt_pk_bf16_f32 v4, v68, v69
    v_cvt_pk_bf16_f32 v5, v70, v71
    v_cvt_pk_bf16_f32 v6, v72, v73
    v_cvt_pk_bf16_f32 v7, v74, v75
    v_lshlrev_b32 v68, 16, v4
    v_and_b32 v69, 0xffff0000, v4
    v_lshlrev_b32 v70, 16, v5
    v_and_b32 v71, 0xffff0000, v5
    v_lshlrev_b32 v72, 16, v6
    v_and_b32 v73, 0xffff0000, v6
    v_lshlrev_b32 v74, 16, v7
    v_and_b32 v75, 0xffff0000, v7
    s_add_u32 s62, s64, 0x6000000
    buffer_store_dwordx4 v[4:7], v240, s[8:11], s62 offen sc1
    v_add_f32 v84, v68, v69
    v_add_f32 v84, v84, v70
    v_add_f32 v84, v84, v71
    v_add_f32 v84, v84, v72
    v_add_f32 v84, v84, v73
    v_add_f32 v84, v84, v74
    v_add_f32 v84, v84, v75
    s_nop 1
    v_add_f32_dpp v84, v84, v84 row_ror:1 row_mask:0xf bank_mask:0xf
    s_nop 1
    v_add_f32_dpp v84, v84, v84 row_ror:2 row_mask:0xf bank_mask:0xf
    s_nop 1
    v_add_f32_dpp v84, v84, v84 row_ror:4 row_mask:0xf bank_mask:0xf
    s_nop 1
    v_add_f32_dpp v84, v84, v84 row_ror:8 row_mask:0xf bank_mask:0xf
    v_mov_b32 v85, v84
    s_nop 1
    v_permlane32_swap_b32 v85, v84
    v_add_f32 v84, v85, v84
    v_mov_b32 v85, v84
    s_nop 1
    v_permlane16_swap_b32 v85, v84
    v_add_f32 v84, v85, v84
    v_mul_f32 v84, 0x3b000000, v84
    v_cvt_pk_bf16_f32 v86, v84, v84
    v_and_b32 v86, 0xffff0000, v86
    v_sub_f32 v87, v84, v86
    v_sub_f32 v76, v68, v86
    v_sub_f32 v77, v69, v86
    v_sub_f32 v78, v70, v86
    v_sub_f32 v79, v71, v86
    v_sub_f32 v80, v72, v86
    v_sub_f32 v81, v73, v86
    v_sub_f32 v82, v74, v86
    v_sub_f32 v83, v75, v86
    v_mul_f32 v100, v76, v76
    v_fmac_f32 v100, v77, v77
    v_fmac_f32 v100, v78, v78
    v_fmac_f32 v100, v79, v79
    v_fmac_f32 v100, v80, v80
    v_fmac_f32 v100, v81, v81
    v_fmac_f32 v100, v82, v82
    v_fmac_f32 v100, v83, v83
    s_nop 1
    v_add_f32_dpp v100, v100, v100 row_ror:1 row_mask:0xf bank_mask:0xf
    s_nop 1
    v_add_f32_dpp v100, v100, v100 row_ror:2 row_mask:0xf bank_mask:0xf
    s_nop 1
    v_add_f32_dpp v100, v100, v100 row_ror:4 row_mask:0xf bank_mask:0xf
    s_nop 1
    v_add_f32_dpp v100, v100, v100 row_ror:8 row_mask:0xf bank_mask:0xf
    v_mov_b32 v85, v100
    s_nop 1
    v_permlane32_swap_b32 v85, v100
    v_add_f32 v100, v85, v100
    v_mov_b32 v85, v100
    s_nop 1
    v_permlane16_swap_b32 v85, v100
    v_add_f32 v100, v85, v100
    v_mul_f32 v85, v87, v87
    v_mul_f32 v100, 0x3b000000, v100
    v_sub_f32 v100, v100, v85
    v_max_f32 v100, 0, v100
    v_cvt_pk_bf16_f32 v100, v100, v100
    v_and_b32 v100, 0xffff0000, v100
    v_add_f32 v100, 0x3727c5ac, v100
    v_cvt_pk_bf16_f32 v100, v100, v100
    v_and_b32 v100, 0xffff0000, v100
    v_sqrt_f32 v100, v100
    s_nop 0
    v_cvt_pk_bf16_f32 v100, v100, v100
    v_and_b32 v100, 0xffff0000, v100
    v_rcp_f32 v100, v100
    v_cvt_pk_bf16_f32 v8, v76, v77
    v_cvt_pk_bf16_f32 v9, v78, v79
    v_cvt_pk_bf16_f32 v10, v80, v81
    v_cvt_pk_bf16_f32 v11, v82, v83
    v_lshlrev_b32 v76, 16, v8
    v_and_b32 v77, 0xffff0000, v8
    v_lshlrev_b32 v78, 16, v9
    v_and_b32 v79, 0xffff0000, v9
    v_lshlrev_b32 v80, 16, v10
    v_and_b32 v81, 0xffff0000, v10
    v_lshlrev_b32 v82, 16, v11
    v_and_b32 v83, 0xffff0000, v11
    v_mul_f32 v76, v100, v76
    v_mul_f32 v77, v100, v77
    v_mul_f32 v78, v100, v78
    v_mul_f32 v79, v100, v79
    v_mul_f32 v80, v100, v80
    v_mul_f32 v81, v100, v81
    v_mul_f32 v82, v100, v82
    v_mul_f32 v83, v100, v83
    v_cvt_pk_bf16_f32 v8, v76, v77
    v_cvt_pk_bf16_f32 v9, v78, v79
    v_cvt_pk_bf16_f32 v10, v80, v81
    v_cvt_pk_bf16_f32 v11, v82, v83
    v_lshlrev_b32 v76, 16, v8
    v_and_b32 v77, 0xffff0000, v8
    v_lshlrev_b32 v78, 16, v9
    v_and_b32 v79, 0xffff0000, v9
    v_lshlrev_b32 v80, 16, v10
    v_and_b32 v81, 0xffff0000, v10
    v_lshlrev_b32 v82, 16, v11
    v_and_b32 v83, 0xffff0000, v11
    s_add_u32 s62, s64, 0x6200000
    buffer_store_dwordx4 v[8:11], v240, s[8:11], s62 offen sc1
    v_pk_add_f32 v[68:69], v[68:69], v[76:77]
    v_pk_add_f32 v[70:71], v[70:71], v[78:79]
    v_pk_add_f32 v[72:73], v[72:73], v[80:81]
    v_pk_add_f32 v[74:75], v[74:75], v[82:83]
    v_cvt_pk_bf16_f32 v12, v68, v69
    v_cvt_pk_bf16_f32 v13, v70, v71
    v_cvt_pk_bf16_f32 v14, v72, v73
    v_cvt_pk_bf16_f32 v15, v74, v75
    buffer_store_dwordx4 v[12:15], v240, s[16:19], s64 offen sc1
    v_lshlrev_b32 v88, 16, v236
    v_and_b32 v89, 0xffff0000, v236
    v_lshlrev_b32 v90, 16, v237
    v_and_b32 v91, 0xffff0000, v237
    v_lshlrev_b32 v92, 16, v238
    v_and_b32 v93, 0xffff0000, v238
    v_lshlrev_b32 v94, 16, v239
    v_and_b32 v95, 0xffff0000, v239
    v_mul_f32 v84, v76, v88
    v_fmac_f32 v84, v77, v89
    v_fmac_f32 v84, v78, v90
    v_fmac_f32 v84, v79, v91
    v_fmac_f32 v84, v80, v92
    v_fmac_f32 v84, v81, v93
    v_fmac_f32 v84, v82, v94
    v_fmac_f32 v84, v83, v95
    s_nop 1
    v_add_f32_dpp v84, v84, v84 row_ror:1 row_mask:0xf bank_mask:0xf
    s_nop 1
    v_add_f32_dpp v84, v84, v84 row_ror:2 row_mask:0xf bank_mask:0xf
    s_nop 1
    v_add_f32_dpp v84, v84, v84 row_ror:4 row_mask:0xf bank_mask:0xf
    s_nop 1
    v_add_f32_dpp v84, v84, v84 row_ror:8 row_mask:0xf bank_mask:0xf
    v_mov_b32 v85, v84
    s_nop 1
    v_permlane32_swap_b32 v85, v84
    v_add_f32 v84, v85, v84
    v_mov_b32 v85, v84
    s_nop 1
    v_permlane16_swap_b32 v85, v84
    v_add_f32 v84, v85, v84
    v_cvt_pk_bf16_f32 v84, v84, v84
    v_and_b32 v84, 0xffff0000, v84
    v_ashrrev_i32 v85, 31, v84
    v_or_b32 v85, 0x80000000, v85
    v_xor_b32 v84, v84, v85
    v_and_b32 v84, 0xffff0000, v84
    s_sub_u32 s62, 0x87ff, s60
    v_or_b32 v84, s62, v84
    s_waitcnt vmcnt(0)
    s_lshl_b32 s62, s60, 2
    s_add_u32 s62, s62, 0x6000
    s_mov_b64 exec, 1
    buffer_store_dword v84, off, s[8:11], s62 sc1
    s_mov_b64 exec, -1
L_nofin_131:
    s_add_u32 s80, s80, 4
    s_add_u32 s22, s22, s23
    s_branch L_p2_seg
L_p2_end:
    s_cmp_ge_u32 s67, 56
    s_cbranch_scc1 L_exit
    s_mov_b32 s74, 0
    s_mov_b32 s75, 0
    v_mov_b32 v202, 0x7ffffff0
    v_mbcnt_lo_u32_b32 v0, -1, 0
    v_mbcnt_hi_u32_b32 v0, -1, v0
    s_lshl_b32 s96, s100, 6
    v_add_u32 v0, s96, v0
    v_lshlrev_b32 v1, 6, v0
    s_getpc_b64 s[70:71]
L_pc_132:
    s_add_u32 s70, s70, L_ffn_round-L_pc_132
    s_addc_u32 s71, s71, 0
    v_min_u32 v1, L_code_end-L_ffn_round-4, v1
    global_load_dword v3, v1, s[70:71]
    v_mov_b32 v1, 0
    s_and_b32 s71, s101, 15
    s_lshl_b32 s71, s71, 7
    s_add_u32 s71, s71, 0x1000
    s_mov_b32 s72, 61
    s_cmp_lg_u32 s100, 0
    s_cbranch_scc1 L_polls_135
    s_mov_b32 exec_lo, 0x1
    s_mov_b32 exec_hi, 0
    s_mov_b32 s96, 0
L_poll_133:
    buffer_load_dword v2, v1, s[8:11], s71 offen sc1
    s_waitcnt vmcnt(0)
    v_cmp_gt_u32 vcc, s72, v2
    s_cbranch_vccz L_polld_134
    v_readfirstlane_b32 s97, v2
    s_nop 0
    s_sub_u32 s97, s72, s97
    s_cmp_lt_i32 s97, 3
    s_cbranch_scc1 L_near_136
    s_sleep 40
    s_cmp_lt_i32 s97, 5
    s_cbranch_scc1 L_near_136
    s_sleep 100
L_near_136:
    s_sleep 16
    s_add_u32 s96, s96, 1
    s_cmp_lt_u32 s96, 0x10000
    s_cbranch_scc1 L_poll_133
L_polld_134:
    s_mov_b64 exec, -1
L_polls_135:
    s_barrier
L_ffn_round:
    v_mbcnt_lo_u32_b32 v0, -1, 0
    v_mbcnt_hi_u32_b32 v0, -1, v0
    s_lshl_b32 s96, s100, 6
    v_add_u32 v0, s96, v0
    s_cmp_lg_u32 s75, 0
    s_cbranch_scc1 L_ffn_re
    v_lshlrev_b32 v30, 5, v0
    s_mov_b32 s69, 0x6000
    v_cmp_le_u32 vcc, 240, v0
    v_mov_b32 v29, s75
    v_add_u32 v29, -1, v29
    v_cndmask_b32 v19, 0, v29, vcc
    s_mov_b32 s70, 0
L_kpoll_137:
    buffer_load_dwordx4 v[20:23], v30, s[8:11], s69 offen sc1
    buffer_load_dwordx4 v[24:27], v30, s[8:11], s69 offen offset:16 sc1
    s_waitcnt vmcnt(0)
    v_min3_u32 v28, v20, v21, v22
    v_min3_u32 v28, v28, v23, v24
    v_min3_u32 v28, v28, v25, v26
    v_min_u32 v28, v28, v27
    v_or_b32 v28, v28, v19
    v_cmp_eq_u32 vcc, 0, v28
    s_cbranch_vccz L_kpolld_138
    s_sleep 6
    s_add_u32 s70, s70, 1
    s_cmp_lt_u32 s70, 0x10000
    s_cbranch_scc1 L_kpoll_137
L_kpolld_138:
    v_bfi_b32 v20, v19, 0, v20
    v_bfi_b32 v21, v19, 0, v21
    v_bfi_b32 v22, v19, 0, v22
    v_bfi_b32 v23, v19, 0, v23
    v_bfi_b32 v24, v19, 0, v24
    v_bfi_b32 v25, v19, 0, v25
    v_bfi_b32 v26, v19, 0, v26
    v_bfi_b32 v27, v19, 0, v27
    v_lshrrev_b32 v30, 6, v0
    v_lshlrev_b32 v30, 2, v30
    v_add_u32 v30, 0x20400, v30
    v_mov_b32 v31, 0x20400
    s_waitcnt vmcnt(0)
    v_max3_u32 v28, v20, v21, v22
    v_max3_u32 v28, v28, v23, v24
    v_max3_u32 v28, v28, v25, v26
    v_max_u32 v28, v28, v27
    s_nop 1
    v_max_u32_dpp v28, v28, v28 row_ror:1 row_mask:0xf bank_mask:0xf
    s_nop 1
    v_max_u32_dpp v28, v28, v28 row_ror:2 row_mask:0xf bank_mask:0xf
    s_nop 1
    v_max_u32_dpp v28, v28, v28 row_ror:4 row_mask:0xf bank_mask:0xf
    s_nop 1
    v_max_u32_dpp v28, v28, v28 row_ror:8 row_mask:0xf bank_mask:0xf
    v_mov_b32 v29, v28
    s_nop 1
    v_permlane32_swap_b32 v29, v28
    v_max_u32 v28, v29, v28
    v_mov_b32 v29, v28
    s_nop 1
    v_permlane16_swap_b32 v29, v28
    v_max_u32 v28, v29, v28
    ds_write_b32 v30, v28
    s_waitcnt lgkmcnt(0)
    s_barrier
    ds_read_b128 v[16:19], v31
    s_waitcnt lgkmcnt(0)
    v_max3_u32 v28, v16, v17, v18
    v_max_u32 v28, v28, v19
    s_nop 0
    v_readfirstlane_b32 s69, v28
    s_nop 1
    v_cmp_ne_u32 vcc, s69, v20
    s_nop 1
    v_cndmask_b32 v20, 0, v20, vcc
    v_cmp_ne_u32 vcc, s69, v21
    s_nop 1
    v_cndmask_b32 v21, 0, v21, vcc
    v_cmp_ne_u32 vcc, s69, v22
    s_nop 1
    v_cndmask_b32 v22, 0, v22, vcc
    v_cmp_ne_u32 vcc, s69, v23
    s_nop 1
    v_cndmask_b32 v23, 0, v23, vcc
    v_cmp_ne_u32 vcc, s69, v24
    s_nop 1
    v_cndmask_b32 v24, 0, v24, vcc
    v_cmp_ne_u32 vcc, s69, v25
    s_nop 1
    v_cndmask_b32 v25, 0, v25, vcc
    v_cmp_ne_u32 vcc, s69, v26
    s_nop 1
    v_cndmask_b32 v26, 0, v26, vcc
    v_cmp_ne_u32 vcc, s69, v27
    s_nop 1
    v_cndmask_b32 v27, 0, v27, vcc
    v_max3_u32 v28, v20, v21, v22
    v_max3_u32 v28, v28, v23, v24
    v_max3_u32 v28, v28, v25, v26
    v_max_u32 v28, v28, v27
    s_nop 1
    v_max_u32_dpp v28, v28, v28 row_ror:1 row_mask:0xf bank_mask:0xf
    s_nop 1
    v_max_u32_dpp v28, v28, v28 row_ror:2 row_mask:0xf bank_mask:0xf
    s_nop 1
    v_max_u32_dpp v28, v28, v28 row_ror:4 row_mask:0xf bank_mask:0xf
    s_nop 1
    v_max_u32_dpp v28, v28, v28 row_ror:8 row_mask:0xf bank_mask:0xf
    v_mov_b32 v29, v28
    s_nop 1
    v_permlane32_swap_b32 v29, v28
    v_max_u32 v28, v29, v28
    v_mov_b32 v29, v28
    s_nop 1
    v_permlane16_swap_b32 v29, v28
    v_max_u32 v28, v29, v28
    ds_write_b32 v30, v28 offset:16
    s_waitcnt lgkmcnt(0)
    s_barrier
    ds_read_b128 v[16:19], v31 offset:16
    s_waitcnt lgkmcnt(0)
    v_max3_u32 v28, v16, v17, v18
    v_max_u32 v28, v28, v19
    s_nop 0
    v_readfirstlane_b32 s70, v28
    s_barrier
    s_branch L_ffn_sel
L_ffn_re:
    v_and_b32 v24, 63, v0
    v_lshlrev_b32 v24, 3, v24
    s_mov_b32 s71, 0x7e00
    s_mov_b32 s72, 0
L_rsel_139:
    buffer_load_dwordx2 v[20:21], v24, s[8:11], s71 offen sc1
    s_waitcnt vmcnt(0)
    v_min_u32 v22, v20, v21
    v_cmp_eq_u32 vcc, 0, v22
    s_cbranch_vccz L_rseld_140
    s_sleep 3
    s_add_u32 s72, s72, 1
    s_cmp_lt_u32 s72, 0x10000
    s_cbranch_scc1 L_rsel_139
L_rseld_140:
    v_max_u32 v22, v20, v21
    v_cmp_lt_u32 vcc, s70, v22
    s_cbranch_vccz L_rsele_141
    v_max_u32_dpp v22, v22, v22 row_ror:1 row_mask:0xf bank_mask:0xf
    s_nop 1
    v_max_u32_dpp v22, v22, v22 row_ror:2 row_mask:0xf bank_mask:0xf
    s_nop 1
    v_max_u32_dpp v22, v22, v22 row_ror:4 row_mask:0xf bank_mask:0xf
    s_nop 1
    v_max_u32_dpp v22, v22, v22 row_ror:8 row_mask:0xf bank_mask:0xf
    v_mov_b32 v23, v22
    s_nop 1
    v_permlane32_swap_b32 v23, v22
    v_max_u32 v22, v23, v22
    v_mov_b32 v23, v22
    s_nop 1
    v_permlane16_swap_b32 v23, v22
    v_max_u32 v22, v23, v22
    s_nop 0
    v_readfirstlane_b32 s71, v22
    s_nop 1
    v_cmp_ne_u32 vcc, s71, v20
    s_nop 1
    v_cndmask_b32 v20, 0, v20, vcc
    v_cmp_ne_u32 vcc, s71, v21
    s_nop 1
    v_cndmask_b32 v21, 0, v21, vcc
    v_max_u32 v22, v20, v21
    s_nop 1
    v_max_u32_dpp v22, v22, v22 row_ror:1 row_mask:0xf bank_mask:0xf
    s_nop 1
    v_max_u32_dpp v22, v22, v22 row_ror:2 row_mask:0xf bank_mask:0xf
    s_nop 1
    v_max_u32_dpp v22, v22, v22 row_ror:4 row_mask:0xf bank_mask:0xf
    s_nop 1
    v_max_u32_dpp v22, v22, v22 row_ror:8 row_mask:0xf bank_mask:0xf
    v_mov_b32 v23, v22
    s_nop 1
    v_permlane32_swap_b32 v23, v22
    v_max_u32 v22, v23, v22
    v_mov_b32 v23, v22
    s_nop 1
    v_permlane16_swap_b32 v23, v22
    v_max_u32 v22, v23, v22
    s_nop 0
    v_readfirstlane_b32 s72, v22
    s_nop 0
    s_max_u32 s70, s70, s72
    s_min_u32 s72, s71, s69
    s_max_u32 s70, s70, s72
    s_max_u32 s69, s69, s71
L_rsele_141:
L_ffn_sel:
    s_and_b32 s71, s69, 2047
    s_lshl_b32 s71, s71, 11
    s_and_b32 s72, s70, 2047
    s_or_b32 s71, s71, s72
    s_add_u32 s71, s71, 1
    s_cmp_eq_u32 s71, s74
    s_cbranch_scc1 L_ffn_same
    s_mov_b32 s74, s71
    v_and_b32 v1, 63, v0
    v_lshrrev_b32 v2, 4, v1
    v_and_b32 v3, 15, v1
    v_lshrrev_b32 v6, 2, v3
    s_and_b32 s71, s69, 2047
    s_sub_u32 s71, 2047, s71
    s_and_b32 s72, s70, 2047
    s_sub_u32 s72, 2047, s72
    v_and_b32 v4, 1, v3
    v_cmp_eq_u32 vcc, 0, v4
    v_mov_b32 v4, s71
    v_mov_b32 v5, s72
    v_cndmask_b32 v4, v5, v4, vcc
    v_lshlrev_b32 v4, 10, v4
    v_lshl_add_u32 v4, v2, 4, v4
    s_mov_b32 s71, 0x6200000
    buffer_load_dwordx4 v[32:35], v4, s[8:11], s71 offen
    buffer_load_dwordx4 v[36:39], v4, s[8:11], s71 offen offset:64
    buffer_load_dwordx4 v[40:43], v4, s[8:11], s71 offen offset:128
    buffer_load_dwordx4 v[44:47], v4, s[8:11], s71 offen offset:192
    buffer_load_dwordx4 v[48:51], v4, s[8:11], s71 offen offset:256
    buffer_load_dwordx4 v[52:55], v4, s[8:11], s71 offen offset:320
    buffer_load_dwordx4 v[56:59], v4, s[8:11], s71 offen offset:384
    buffer_load_dwordx4 v[60:63], v4, s[8:11], s71 offen offset:448
    buffer_load_dwordx4 v[64:67], v4, s[8:11], s71 offen offset:512
    buffer_load_dwordx4 v[68:71], v4, s[8:11], s71 offen offset:576
    buffer_load_dwordx4 v[72:75], v4, s[8:11], s71 offen offset:640
    buffer_load_dwordx4 v[76:79], v4, s[8:11], s71 offen offset:704
    buffer_load_dwordx4 v[80:83], v4, s[8:11], s71 offen offset:768
    buffer_load_dwordx4 v[84:87], v4, s[8:11], s71 offen offset:832
    buffer_load_dwordx4 v[88:91], v4, s[8:11], s71 offen offset:896
    buffer_load_dwordx4 v[92:95], v4, s[8:11], s71 offen offset:960
    v_lshl_add_u32 v4, v2, 3, v6
    v_lshlrev_b32 v4, 6, v4
    v_and_b32 v5, 3, v3
    v_lshl_add_u32 v4, v5, 3, v4
    s_lshr_b32 s71, s68, 1
    s_lshl_b32 s71, s71, 15
    s_and_b32 s72, s68, 1
    s_lshl_b32 s72, s72, 5
    s_add_u32 s71, s71, s72
    s_add_u32 s71, s71, 0x8000
    v_add_u32 v7, s71, v4
    ds_read_b64_tr_b16 v[96:97], v7
    ds_read_b64_tr_b16 v[98:99], v7 offset:256
    ds_read_b64_tr_b16 v[100:101], v7 offset:2048
    ds_read_b64_tr_b16 v[102:103], v7 offset:2304
    ds_read_b64_tr_b16 v[104:105], v7 offset:4096
    ds_read_b64_tr_b16 v[106:107], v7 offset:4352
    ds_read_b64_tr_b16 v[108:109], v7 offset:6144
    ds_read_b64_tr_b16 v[110:111], v7 offset:6400
    s_waitcnt lgkmcnt(0)
    ds_read_b64_tr_b16 v[112:113], v7 offset:8192
    ds_read_b64_tr_b16 v[114:115], v7 offset:8448
    ds_read_b64_tr_b16 v[116:117], v7 offset:10240
    ds_read_b64_tr_b16 v[118:119], v7 offset:10496
    ds_read_b64_tr_b16 v[120:121], v7 offset:12288
    ds_read_b64_tr_b16 v[122:123], v7 offset:12544
    ds_read_b64_tr_b16 v[124:125], v7 offset:14336
    ds_read_b64_tr_b16 v[126:127], v7 offset:14592
    s_waitcnt lgkmcnt(0)
    ds_read_b64_tr_b16 v[128:129], v7 offset:16384
    ds_read_b64_tr_b16 v[130:131], v7 offset:16640
    ds_read_b64_tr_b16 v[132:133], v7 offset:18432
    ds_read_b64_tr_b16 v[134:135], v7 offset:18688
    ds_read_b64_tr_b16 v[136:137], v7 offset:20480
    ds_read_b64_tr_b16 v[138:139], v7 offset:20736
    ds_read_b64_tr_b16 v[140:141], v7 offset:22528
    ds_read_b64_tr_b16 v[142:143], v7 offset:22784
    s_waitcnt lgkmcnt(0)
    ds_read_b64_tr_b16 v[144:145], v7 offset:24576
    ds_read_b64_tr_b16 v[146:147], v7 offset:24832
    ds_read_b64_tr_b16 v[148:149], v7 offset:26624
    ds_read_b64_tr_b16 v[150:151], v7 offset:26880
    ds_read_b64_tr_b16 v[152:153], v7 offset:28672
    ds_read_b64_tr_b16 v[154:155], v7 offset:28928
    ds_read_b64_tr_b16 v[156:157], v7 offset:30720
    ds_read_b64_tr_b16 v[158:159], v7 offset:30976
    s_waitcnt lgkmcnt(0)
    s_waitcnt vmcnt(0)
    v_mfma_f32_16x16x32_bf16 v[8:11], v[32:35], v[96:99], 0
    v_mfma_f32_16x16x32_bf16 v[8:11], v[36:39], v[100:103], v[8:11]
    v_mfma_f32_16x16x32_bf16 v[8:11], v[40:43], v[104:107], v[8:11]
    v_mfma_f32_16x16x32_bf16 v[8:11], v[44:47], v[108:111], v[8:11]
    v_mfma_f32_16x16x32_bf16 v[8:11], v[48:51], v[112:115], v[8:11]
    v_mfma_f32_16x16x32_bf16 v[8:11], v[52:55], v[116:119], v[8:11]
    v_mfma_f32_16x16x32_bf16 v[8:11], v[56:59], v[120:123], v[8:11]
    v_mfma_f32_16x16x32_bf16 v[8:11], v[60:63], v[124:127], v[8:11]
    v_mfma_f32_16x16x32_bf16 v[8:11], v[64:67], v[128:131], v[8:11]
    v_mfma_f32_16x16x32_bf16 v[8:11], v[68:71], v[132:135], v[8:11]
    v_mfma_f32_16x16x32_bf16 v[8:11], v[72:75], v[136:139], v[8:11]
    v_mfma_f32_16x16x32_bf16 v[8:11], v[76:79], v[140:143], v[8:11]
    v_mfma_f32_16x16x32_bf16 v[8:11], v[80:83], v[144:147], v[8:11]
    v_mfma_f32_16x16x32_bf16 v[8:11], v[84:87], v[148:151], v[8:11]
    v_mfma_f32_16x16x32_bf16 v[8:11], v[88:91], v[152:155], v[8:11]
    v_mfma_f32_16x16x32_bf16 v[8:11], v[92:95], v[156:159], v[8:11]
    s_nop 7
    v_cvt_pk_bf16_f32 v8, v8, v8
    v_and_b32 v8, 0xffff0000, v8
    v_cvt_pk_bf16_f32 v9, v9, v9
    v_and_b32 v9, 0xffff0000, v9
    s_cmp_ge_u32 s68, 2
    s_cbranch_scc1 L_ffn_up_142
    v_mul_f32 v13, 0xbfb8aa3b, v8
    v_exp_f32 v13, v13
    s_nop 0
    v_add_f32 v13, 1.0, v13
    v_rcp_f32 v12, v13
    s_nop 0
    v_mul_f32 v8, v12, v8
    v_cvt_pk_bf16_f32 v8, v8, v8
    v_and_b32 v8, 0xffff0000, v8
    v_mul_f32 v13, 0xbfb8aa3b, v9
    v_exp_f32 v13, v13
    s_nop 0
    v_add_f32 v13, 1.0, v13
    v_rcp_f32 v12, v13
    s_nop 0
    v_mul_f32 v9, v12, v9
    v_cvt_pk_bf16_f32 v9, v9, v9
    v_and_b32 v9, 0xffff0000, v9
    s_nop 4
L_ffn_up_142:
    s_lshr_b32 s71, s68, 1
    s_lshl_b32 s71, s71, 8
    s_and_b32 s72, s68, 1
    s_lshl_b32 s72, s72, 6
    s_add_u32 s71, s71, s72
    s_add_u32 s71, s71, 0x20000
    v_lshlrev_b32 v4, 2, v3
    v_add_u32 v4, s71, v4
    ds_write_b32 v4, v8
    ds_write_b32 v4, v9 offset:128
    s_waitcnt lgkmcnt(0)
    s_barrier
    v_and_b32 v4, 1, v3
    v_lshlrev_b32 v4, 7, v4
    v_lshl_add_u32 v4, v2, 5, v4
    v_add_u32 v4, 0x20000, v4
    ds_read_b128 v[32:35], v4
    ds_read_b128 v[36:39], v4 offset:16
    ds_read_b128 v[40:43], v4 offset:256
    ds_read_b128 v[44:47], v4 offset:272
    v_lshl_add_u32 v5, v2, 3, v6
    v_lshlrev_b32 v5, 10, v5
    v_and_b32 v7, 3, v3
    v_lshl_add_u32 v5, v7, 3, v5
    s_lshl_b32 s71, s68, 8
    s_add_u32 s71, s71, 0x18000
    v_add_u32 v7, s71, v5
    s_waitcnt lgkmcnt(0)
    ds_read_b64_tr_b16 v[96:97], v7
    ds_read_b64_tr_b16 v[98:99], v7 offset:4096
    ds_read_b64_tr_b16 v[100:101], v7 offset:32
    ds_read_b64_tr_b16 v[102:103], v7 offset:4128
    ds_read_b64_tr_b16 v[104:105], v7 offset:64
    ds_read_b64_tr_b16 v[106:107], v7 offset:4160
    ds_read_b64_tr_b16 v[108:109], v7 offset:96
    ds_read_b64_tr_b16 v[110:111], v7 offset:4192
    s_waitcnt lgkmcnt(0)
    ds_read_b64_tr_b16 v[112:113], v7 offset:128
    ds_read_b64_tr_b16 v[114:115], v7 offset:4224
    ds_read_b64_tr_b16 v[116:117], v7 offset:160
    ds_read_b64_tr_b16 v[118:119], v7 offset:4256
    ds_read_b64_tr_b16 v[120:121], v7 offset:192
    ds_read_b64_tr_b16 v[122:123], v7 offset:4288
    ds_read_b64_tr_b16 v[124:125], v7 offset:224
    ds_read_b64_tr_b16 v[126:127], v7 offset:4320
    v_mul_f32 v32, v32, v40
    v_mul_f32 v33, v33, v41
    v_mul_f32 v34, v34, v42
    v_mul_f32 v35, v35, v43
    v_mul_f32 v36, v36, v44
    v_mul_f32 v37, v37, v45
    v_mul_f32 v38, v38, v46
    v_mul_f32 v39, v39, v47
    v_cvt_pk_bf16_f32 v48, v32, v33
    v_cvt_pk_bf16_f32 v49, v34, v35
    v_cvt_pk_bf16_f32 v50, v36, v37
    v_cvt_pk_bf16_f32 v51, v38, v39
    s_waitcnt lgkmcnt(0)
    s_nop 0
    v_mfma_f32_16x16x32_bf16 v[56:59], v[48:51], v[96:99], 0
    v_mfma_f32_16x16x32_bf16 v[60:63], v[48:51], v[100:103], 0
    v_mfma_f32_16x16x32_bf16 v[64:67], v[48:51], v[104:107], 0
    v_mfma_f32_16x16x32_bf16 v[68:71], v[48:51], v[108:111], 0
    v_mfma_f32_16x16x32_bf16 v[72:75], v[48:51], v[112:115], 0
    v_mfma_f32_16x16x32_bf16 v[76:79], v[48:51], v[116:119], 0
    v_mfma_f32_16x16x32_bf16 v[80:83], v[48:51], v[120:123], 0
    v_mfma_f32_16x16x32_bf16 v[84:87], v[48:51], v[124:127], 0
    v_cmp_eq_u32 vcc, 0, v2
    v_lshlrev_b32 v4, 11, v2
    v_lshl_add_u32 v4, v3, 2, v4
    s_lshl_b32 s71, s67, 12
    s_lshl_b32 s72, s68, 9
    s_add_u32 s71, s71, s72
    s_add_u32 s71, s71, 0x6410000
    v_cndmask_b32 v56, v57, v56, vcc
    v_cndmask_b32 v60, v61, v60, vcc
    v_cndmask_b32 v64, v65, v64, vcc
    v_cndmask_b32 v68, v69, v68, vcc
    v_cndmask_b32 v72, v73, v72, vcc
    v_cndmask_b32 v76, v77, v76, vcc
    v_cndmask_b32 v80, v81, v80, vcc
    v_cndmask_b32 v84, v85, v84, vcc
    s_mov_b32 exec_hi, 0
    buffer_store_dword v56, v4, s[8:11], s71 offen sc1
    buffer_store_dword v60, v4, s[8:11], s71 offen offset:64 sc1
    buffer_store_dword v64, v4, s[8:11], s71 offen offset:128 sc1
    buffer_store_dword v68, v4, s[8:11], s71 offen offset:192 sc1
    buffer_store_dword v72, v4, s[8:11], s71 offen offset:256 sc1
    buffer_store_dword v76, v4, s[8:11], s71 offen offset:320 sc1
    buffer_store_dword v80, v4, s[8:11], s71 offen offset:384 sc1
    buffer_store_dword v84, v4, s[8:11], s71 offen offset:448 sc1
    s_mov_b64 exec, -1
    s_waitcnt vmcnt(0)
    s_barrier
    s_lshl_b32 s71, s67, 2
    s_lshl_b32 s72, s75, 8
    s_add_u32 s71, s71, s72
    s_add_u32 s71, s71, 0x8000
    s_cmp_lg_u32 s100, 0
    s_cbranch_scc1 L_flag_143
    v_mov_b32 v2, s74
    s_mov_b64 exec, 1
    buffer_store_dword v2, off, s[8:11], s71 sc1
    s_mov_b64 exec, -1
L_flag_143:
    s_cmp_ge_u32 s67, 8
    s_cbranch_scc1 L_ffn_same
    s_load_dwordx2 s[16:17], s[0:1], 96
    s_waitcnt lgkmcnt(0)
    s_and_b32 s17, s17, 0xffff
    s_mov_b32 s18, 0x200000
    s_mov_b32 s19, 0x20000
    v_and_b32 v3, 63, v0
    s_cmp_lt_u32 s100, 2
    s_cselect_b32 s71, s69, s70
    v_mov_b32 v5, s71
    s_and_b32 s71, s71, 2047
    s_sub_u32 s71, 2047, s71
    s_lshl_b32 s71, s71, 10
    s_lshl_b32 s72, s67, 1
    s_and_b32 s96, s100, 1
    s_add_u32 s72, s72, s96
    s_lshl_b32 s96, s72, 6
    s_add_u32 s71, s71, s96
    v_and_b32 v4, 7, v3
    v_lshlrev_b32 v6, 3, v4
    v_add_u32 v6, s71, v6
    v_lshrrev_b32 v7, 3, v3
    v_lshlrev_b32 v7, 12, v7
    v_lshl_add_u32 v7, v4, 4, v7
    s_lshl_b32 s72, s72, 7
    s_lshr_b32 s96, s100, 1
    s_lshl_b32 s96, s96, 11
    s_add_u32 s72, s72, s96
    v_add_u32 v7, s72, v7
    s_mov_b32 s71, 0x6000000
    s_mov_b32 s72, 0x6200000
    buffer_load_dwordx2 v[8:9], v6, s[8:11], s71 offen sc1
    buffer_load_dwordx2 v[10:11], v6, s[8:11], s72 offen sc1
    v_and_b32 v5, 0xffff0000, v5
    v_ashrrev_i32 v4, 31, v5
    v_not_b32 v4, v4
    v_or_b32 v4, 0x80000000, v4
    v_xor_b32 v5, v5, v4
    v_and_b32 v5, 0xffff0000, v5
    v_mul_f32 v23, 0xbfb8aa3b, v5
    v_exp_f32 v23, v23
    s_nop 0
    v_add_f32 v23, 1.0, v23
    v_rcp_f32 v22, v23
    s_nop 0
    v_cvt_pk_bf16_f32 v22, v22, v22
    v_and_b32 v22, 0xffff0000, v22
    v_lshlrev_b32 v1, 2, v0
    s_lshl_b32 s71, s75, 8
    s_add_u32 s71, s71, 0x8000
    s_cmp_lg_u32 s100, 0
    s_cbranch_scc1 L_polls_146
    s_mov_b32 exec_hi, 0xffffff
    s_mov_b32 s96, 0
L_poll_144:
    buffer_load_dword v2, v1, s[8:11], s71 offen sc1
    s_waitcnt vmcnt(0)
    v_cmp_ne_u32 vcc, s74, v2
    s_cbranch_vccz L_polld_145
    s_sleep 2
    s_add_u32 s96, s96, 1
    s_cmp_lt_u32 s96, 0x10000
    s_cbranch_scc1 L_poll_144
L_polld_145:
    s_mov_b64 exec, -1
L_polls_146:
    s_barrier
    s_mov_b32 s71, 0x6410000
    buffer_load_dwordx4 v[32:35], v7, s[8:11], s71 offen sc1
    s_add_u32 s71, s71, 32768
    buffer_load_dwordx4 v[36:39], v7, s[8:11], s71 offen sc1
    s_add_u32 s71, s71, 32768
    buffer_load_dwordx4 v[40:43], v7, s[8:11], s71 offen sc1
    s_add_u32 s71, s71, 32768
    buffer_load_dwordx4 v[44:47], v7, s[8:11], s71 offen sc1
    s_add_u32 s71, s71, 32768
    buffer_load_dwordx4 v[48:51], v7, s[8:11], s71 offen sc1
    s_add_u32 s71, s71, 32768
    buffer_load_dwordx4 v[52:55], v7, s[8:11], s71 offen sc1
    s_add_u32 s71, s71, 32768
    buffer_load_dwordx4 v[56:59], v7, s[8:11], s71 offen sc1
    s_add_u32 s71, s71, 32768
    s_waitcnt vmcnt(7)
    v_lshlrev_b32 v12, 16, v8
    v_and_b32 v13, 0xffff0000, v8
    v_lshlrev_b32 v16, 16, v10
    v_and_b32 v17, 0xffff0000, v10
    v_lshlrev_b32 v14, 16, v9
    v_and_b32 v15, 0xffff0000, v9
    v_lshlrev_b32 v18, 16, v11
    v_and_b32 v19, 0xffff0000, v11
    s_waitcnt vmcnt(0)
    v_pk_add_f32 v[32:33], v[32:33], v[36:37]
    v_pk_add_f32 v[34:35], v[34:35], v[38:39]
    v_pk_add_f32 v[32:33], v[32:33], v[40:41]
    v_pk_add_f32 v[34:35], v[34:35], v[42:43]
    v_pk_add_f32 v[32:33], v[32:33], v[44:45]
    v_pk_add_f32 v[34:35], v[34:35], v[46:47]
    v_pk_add_f32 v[32:33], v[32:33], v[48:49]
    v_pk_add_f32 v[34:35], v[34:35], v[50:51]
    v_pk_add_f32 v[32:33], v[32:33], v[52:53]
    v_pk_add_f32 v[34:35], v[34:35], v[54:55]
    v_pk_add_f32 v[32:33], v[32:33], v[56:57]
    v_pk_add_f32 v[34:35], v[34:35], v[58:59]
    s_nop 0
    v_add_f32_dpp v32, v32, v32 row_ror:8 row_mask:0xf bank_mask:0xf
    v_add_f32_dpp v33, v33, v33 row_ror:8 row_mask:0xf bank_mask:0xf
    v_add_f32_dpp v34, v34, v34 row_ror:8 row_mask:0xf bank_mask:0xf
    v_add_f32_dpp v35, v35, v35 row_ror:8 row_mask:0xf bank_mask:0xf
    v_mov_b32 v24, v32
    s_nop 1
    v_permlane32_swap_b32 v24, v32
    v_add_f32 v32, v24, v32
    v_mov_b32 v24, v32
    s_nop 1
    v_permlane16_swap_b32 v24, v32
    v_add_f32 v32, v24, v32
    v_mov_b32 v24, v33
    s_nop 1
    v_permlane32_swap_b32 v24, v33
    v_add_f32 v33, v24, v33
    v_mov_b32 v24, v33
    s_nop 1
    v_permlane16_swap_b32 v24, v33
    v_add_f32 v33, v24, v33
    v_mov_b32 v24, v34
    s_nop 1
    v_permlane32_swap_b32 v24, v34
    v_add_f32 v34, v24, v34
    v_mov_b32 v24, v34
    s_nop 1
    v_permlane16_swap_b32 v24, v34
    v_add_f32 v34, v24, v34
    v_mov_b32 v24, v35
    s_nop 1
    v_permlane32_swap_b32 v24, v35
    v_add_f32 v35, v24, v35
    v_mov_b32 v24, v35
    s_nop 1
    v_permlane16_swap_b32 v24, v35
    v_add_f32 v35, v24, v35
    v_cvt_pk_bf16_f32 v32, v32, v32
    v_and_b32 v32, 0xffff0000, v32
    v_mul_f32 v32, v22, v32
    v_cvt_pk_bf16_f32 v32, v32, v32
    v_and_b32 v32, 0xffff0000, v32
    v_add_f32 v32, v16, v32
    v_cvt_pk_bf16_f32 v32, v32, v32
    v_and_b32 v32, 0xffff0000, v32
    v_add_f32 v32, v12, v32
    v_cvt_pk_bf16_f32 v33, v33, v33
    v_and_b32 v33, 0xffff0000, v33
    v_mul_f32 v33, v22, v33
    v_cvt_pk_bf16_f32 v33, v33, v33
    v_and_b32 v33, 0xffff0000, v33
    v_add_f32 v33, v17, v33
    v_cvt_pk_bf16_f32 v33, v33, v33
    v_and_b32 v33, 0xffff0000, v33
    v_add_f32 v33, v13, v33
    v_cvt_pk_bf16_f32 v34, v34, v34
    v_and_b32 v34, 0xffff0000, v34
    v_mul_f32 v34, v22, v34
    v_cvt_pk_bf16_f32 v34, v34, v34
    v_and_b32 v34, 0xffff0000, v34
    v_add_f32 v34, v18, v34
    v_cvt_pk_bf16_f32 v34, v34, v34
    v_and_b32 v34, 0xffff0000, v34
    v_add_f32 v34, v14, v34
    v_cvt_pk_bf16_f32 v35, v35, v35
    v_and_b32 v35, 0xffff0000, v35
    v_mul_f32 v35, v22, v35
    v_cvt_pk_bf16_f32 v35, v35, v35
    v_and_b32 v35, 0xffff0000, v35
    v_add_f32 v35, v19, v35
    v_cvt_pk_bf16_f32 v35, v35, v35
    v_and_b32 v35, 0xffff0000, v35
    v_add_f32 v35, v15, v35
    v_cvt_pk_bf16_f32 v200, v32, v33
    v_cvt_pk_bf16_f32 v201, v34, v35
    v_mov_b32 v202, v6
L_ffn_same:
    s_add_u32 s75, s75, 1
    s_cmp_lt_u32 s75, 2
    s_cbranch_scc1 L_ffn_round
    s_cmp_ge_u32 s67, 8
    s_cbranch_scc1 L_exit
    s_mov_b32 exec_lo, 0xff
    s_mov_b32 exec_hi, 0
    buffer_store_dwordx2 v[200:201], v202, s[16:19], 0 offen
    s_mov_b64 exec, -1
    s_waitcnt vmcnt(0)
L_exit:
    s_endpgm
L_code_end:
.section .rodata,"a"
.p2align 6
.amdhsa_kernel sequential_preLN__memory_aug_recurrent_mem_tr__moe_arch_mod__prompt_kernel
  .amdhsa_next_free_vgpr 512
  .amdhsa_next_free_sgpr 102
  .amdhsa_accum_offset 256
  .amdhsa_group_segment_fixed_size 0
  .amdhsa_kernarg_size 120
  .amdhsa_user_sgpr_count 2
  .amdhsa_user_sgpr_kernarg_segment_ptr 1
  .amdhsa_system_sgpr_workgroup_id_x 1
  .amdhsa_float_denorm_mode_32 3
.end_amdhsa_kernel
```

```asm
; @launch grid=(256,1,1) block=(256,1,1) lds=163840
.amdgcn_target "amdgcn-amd-amdhsa--gfx950"
.text
.globl sequential_preLN__memory_aug_recurrent_mem_tr__moe_arch_mod__prompt_kernel
.p2align 8
.type sequential_preLN__memory_aug_recurrent_mem_tr__moe_arch_mod__prompt_kernel,@function
sequential_preLN__memory_aug_recurrent_mem_tr__moe_arch_mod__prompt_kernel:
    s_cmp_ge_u32 s2, 256
    s_cbranch_scc1 L_exit
    s_load_dwordx2 s[8:9], s[0:1], 112
    s_load_dwordx2 s[92:93], s[0:1], 104
    s_load_dwordx8 s[60:67], s[0:1], 16
    s_load_dwordx2 s[12:13], s[0:1], 0
    v_lshrrev_b32 v1, 6, v0
    s_nop 0
    v_readfirstlane_b32 s100, v1
    s_getreg_b32 s84, hwreg(HW_REG_XCC_ID)
    s_and_b32 s84, s84, 7
    s_lshr_b32 s85, s2, 3
    s_mov_b32 s86, s100
    s_cmp_eq_u32 s2, 7
    s_cbranch_scc1 L_zero
L_noz:
    s_cmp_lg_u32 s84, 0
    s_cbranch_scc1 L_other
    s_xor_b32 s20, s85, 0
    v_lshrrev_b32 v4, 6, v0
    s_nop 0
    v_readfirstlane_b32 s21, v4
    v_and_b32 v1, 63, v0
    v_lshrrev_b32 v2, 4, v1
    v_and_b32 v3, 15, v1
    v_lshrrev_b32 v6, 2, v3
    v_lshlrev_b32 v117, 4, v1
    s_lshl_b32 s51, s21, 10
    s_lshl_b32 s52, s21, 11
    s_mov_b32 s14, 0x400000
    s_mov_b32 s15, 0x20000
    s_lshl_b32 s41, s20, 8
    s_lshl_b32 s42, s20, 17
    s_lshr_b32 s43, s21, 1
    s_lshl_b32 s43, s43, 2
    v_or_b32 v5, s43, v2
    v_lshlrev_b32 v5, 1, v5
    v_xor_b32 v5, v5, v3
    v_lshrrev_b32 v14, 2, v5
    v_and_b32 v14, 2, v14
    v_lshlrev_b32 v5, 4, v5
    s_lshl_b32 s43, s21, 4
    v_add_u32 v4, s43, v2
    v_lshl_add_u32 v8, v4, 13, v5
    s_cmp_lg_u32 s20, 0
    s_cbranch_scc1 L_nocc_1
    v_lshlrev_b32 v25, 3, v117
    s_lshl_b32 s43, s21, 13
    s_getpc_b64 s[4:5]
L_pc_2:
    s_add_u32 s4, s4, L_nocc_1-L_pc_2
    s_addc_u32 s5, s5, 0
    v_add_u32 v25, s43, v25
    v_min_u32 v25, L_code_end-L_nocc_1-4, v25
    global_load_dword v29, v25, s[4:5]
L_nocc_1:
    v_mul_u32_u24 v22, 57, v0
    v_lshrrev_b32 v22, 11, v22
    v_mul_u32_u24 v23, 36, v22
    v_sub_u32 v23, v0, v23
    v_and_b32 v25, 3, v23
    v_and_or_b32 v23, v23, 60, 1
    v_min_u32 v23, 31, v23
    v_lshl_add_u32 v23, v23, 2, v25
    v_lshlrev_b32 v31, 6, v23
    s_add_u32 s43, s20, 2
    s_lshr_b32 s43, s43, 2
    s_sub_u32 s43, s20, s43
    s_mul_i32 s43, s43, 7
    v_add_u32 v22, s43, v22
    s_waitcnt lgkmcnt(0)
    s_mov_b32 s4, s60
    s_and_b32 s5, s61, 0xffff
    s_lshr_b32 s6, 0x5ddddddd, s20
    s_and_b32 s6, s6, 1
    s_lshl_b32 s6, s6, 22
    s_mov_b32 s7, 0x20000
    v_add_u32 v23, 0, v22
    v_and_b32 v25, 448, v23
    v_add_u32 v23, v23, v25
    v_lshl_add_u32 v23, v23, 13, v31
    s_mov_b32 s43, 0x80000
    buffer_load_dword v30, v23, s[4:7], s43 offen
    s_mov_b32 s4, s60
    s_and_b32 s5, s61, 0xffff
    s_lshr_b32 s6, 0x5ddddddd, s20
    s_and_b32 s6, s6, 1
    s_lshl_b32 s6, s6, 22
    s_mov_b32 s7, 0x20000
    v_add_u32 v23, 161, v22
    v_and_b32 v25, 448, v23
    v_add_u32 v23, v23, v25
    v_lshl_add_u32 v23, v23, 13, v31
    s_mov_b32 s43, 0x80000
    buffer_load_dword v30, v23, s[4:7], s43 offen
    s_and_b32 s9, s9, 0xffff
    s_mov_b32 s10, 0x10000000
    s_mov_b32 s11, 0x20000
    s_and_b32 s93, s93, 0xffff
    s_mov_b32 s94, 0x100
    s_mov_b32 s95, 0x20000
    s_mov_b32 s87, 0
    s_cmp_lg_u32 s86, 0
    s_cbranch_scc1 L_reg_3
    s_lshl_b32 s97, s84, 4
    s_lshl_b32 s96, 1, s85
    v_mov_b32 v250, s96
    v_mov_b32 v251, 256
    s_mov_b64 exec, 1
    buffer_atomic_add_x2 v[250:251], off, s[92:95], s97 offset:64
    s_mov_b64 exec, -1
    s_mov_b32 s86, 1
L_reg_3:
    s_mov_b32 s16, s92
    s_mov_b32 s17, s93
    s_mov_b32 s18, s94
    s_mov_b32 s19, s95
    s_mov_b32 s88, s20
    s_mov_b32 s12, s60
    s_and_b32 s13, s61, 0xffff
    v_xor_b32 v15, 0, v14
    v_lshl_add_u32 v15, v15, 15, v8
    s_add_u32 s43, s41, 0x0
    s_add_u32 m0, s51, 0x8000
    s_nop 0
    buffer_load_dwordx4 v15, s[12:15], s43 offen lds
    s_add_u32 s43, s41, 0x8000
    s_add_u32 m0, s51, 0x9000
    s_nop 0
    buffer_load_dwordx4 v15, s[12:15], s43 offen lds
    s_add_u32 s43, s41, 0x100000
    s_add_u32 m0, s51, 0xa000
    s_nop 0
    buffer_load_dwordx4 v15, s[12:15], s43 offen lds
    s_add_u32 s43, s41, 0x108000
    s_add_u32 m0, s51, 0xb000
    s_nop 0
    buffer_load_dwordx4 v15, s[12:15], s43 offen lds
    s_add_u32 s43, s41, 0x200000
    s_add_u32 m0, s51, 0xc000
    s_nop 0
    buffer_load_dwordx4 v15, s[12:15], s43 offen lds
    s_add_u32 s43, s41, 0x208000
    s_add_u32 m0, s51, 0xd000
    s_nop 0
    buffer_load_dwordx4 v15, s[12:15], s43 offen lds
    s_add_u32 s43, s41, 0x300000
    s_add_u32 m0, s51, 0xe000
    s_nop 0
    buffer_load_dwordx4 v15, s[12:15], s43 offen lds
    s_add_u32 s43, s41, 0x308000
    s_add_u32 m0, s51, 0xf000
    s_nop 0
    buffer_load_dwordx4 v15, s[12:15], s43 offen lds
    v_xor_b32 v15, 2, v14
    v_lshl_add_u32 v15, v15, 15, v8
    s_add_u32 s43, s41, 0x0
    s_add_u32 m0, s51, 0x10000
    s_nop 0
    buffer_load_dwordx4 v15, s[12:15], s43 offen lds
    s_add_u32 s43, s41, 0x8000
    s_add_u32 m0, s51, 0x11000
    s_nop 0
    buffer_load_dwordx4 v15, s[12:15], s43 offen lds
    s_add_u32 s43, s41, 0x100000
    s_add_u32 m0, s51, 0x12000
    s_nop 0
    buffer_load_dwordx4 v15, s[12:15], s43 offen lds
    s_add_u32 s43, s41, 0x108000
    s_add_u32 m0, s51, 0x13000
    s_nop 0
    buffer_load_dwordx4 v15, s[12:15], s43 offen lds
    s_add_u32 s43, s41, 0x200000
    s_add_u32 m0, s51, 0x14000
    s_nop 0
    buffer_load_dwordx4 v15, s[12:15], s43 offen lds
    s_add_u32 s43, s41, 0x208000
    s_add_u32 m0, s51, 0x15000
    s_nop 0
    buffer_load_dwordx4 v15, s[12:15], s43 offen lds
    s_add_u32 s43, s41, 0x300000
    s_add_u32 m0, s51, 0x16000
    s_nop 0
    buffer_load_dwordx4 v15, s[12:15], s43 offen lds
    s_add_u32 s43, s41, 0x308000
    s_add_u32 m0, s51, 0x17000
    s_nop 0
    buffer_load_dwordx4 v15, s[12:15], s43 offen lds
    v_xor_b32 v15, 0, v14
    v_lshl_add_u32 v15, v15, 15, v8
    s_add_u32 s43, s41, 0x80000
    s_add_u32 m0, s51, 0x18000
    s_nop 0
    buffer_load_dwordx4 v15, s[12:15], s43 offen lds
    s_add_u32 s43, s41, 0x88000
    s_add_u32 m0, s51, 0x19000
    s_nop 0
    buffer_load_dwordx4 v15, s[12:15], s43 offen lds
    s_add_u32 s43, s41, 0x180000
    s_add_u32 m0, s51, 0x1a000
    s_nop 0
    buffer_load_dwordx4 v15, s[12:15], s43 offen lds
    s_add_u32 s43, s41, 0x188000
    s_add_u32 m0, s51, 0x1b000
    s_nop 0
    buffer_load_dwordx4 v15, s[12:15], s43 offen lds
    v_and_b32 v4, 2, v3
    v_cmp_ne_u32 vcc, 0, v4
    v_mov_b32 v4, 0x4444
    v_mov_b32 v5, 0xeeee
    v_cndmask_b32 v116, v4, v5, vcc
    v_lshrrev_b32 v5, 1, v2
    v_lshl_add_u32 v4, v6, 3, v5
    s_lshl_b32 s43, s21, 1
    v_add_u32 v4, s43, v4
    v_add_u32 v5, s20, v4
    v_and_b32 v5, 31, v5
    v_lshl_add_u32 v4, v4, 6, v5
    v_and_b32 v5, 1, v2
    v_lshl_add_u32 v4, v4, 1, v5
    v_and_b32 v5, 3, v3
    v_lshl_add_u32 v4, v4, 2, v5
    v_lshlrev_b32 v118, 4, v4
    v_and_b32 v4, 1, v2
    v_lshlrev_b32 v4, 2, v4
    v_and_b32 v7, 2, v2
    v_add_u32 v4, v4, v7
    v_and_b32 v7, 1, v6
    v_add_u32 v4, v4, v7
    v_lshl_add_u32 v4, v4, 2, v5
    v_lshlrev_b32 v4, 2, v4
    s_and_b32 s43, s21, 1
    s_lshl_b32 s43, s43, 12
    s_lshl_b32 s40, s20, 7
    s_add_u32 s43, s43, s40
    v_add_u32 v119, s43, v4
    v_sub_u32 v7, 0, v2
    v_and_b32 v7, 3, v7
    v_xor_b32 v7, v7, v6
    v_lshl_add_u32 v4, v2, 4, v7
    v_and_b32 v5, 3, v3
    v_lshl_add_u32 v4, v4, 2, v5
    s_add_u32 s43, s51, 16384
    v_lshl_add_u32 v120, v4, 2, s43
    v_sub_u32 v7, 0, v6
    v_and_b32 v7, 3, v7
    v_xor_b32 v7, v7, v2
    v_lshl_add_u32 v4, v3, 2, v7
    v_lshlrev_b32 v121, 4, v4
    v_and_b32 v5, 1, v3
    v_lshl_add_u32 v4, v6, 1, v5
    v_lshl_add_u32 v4, v2, 3, v4
    v_lshlrev_b32 v127, 4, v4
    v_and_or_b32 v122, v116, 8, v127
    s_lshl_b32 s43, s21, 13
    s_add_u32 s43, s43, 32768
    v_add_u32 v123, s43, v117
    v_add_u32 v124, 0x10000, v123
    s_mov_b32 s36, 0xcccccccc
    s_mov_b32 s37, 0xcccccccc
    s_mov_b32 s38, 0x00ff00ff
    s_mov_b32 s39, 0x00ff00ff
    s_mov_b32 s34, 0x3e0293ee
    s_mov_b32 s35, 0x49800000
    s_mov_b32 s50, 0x3f803f80
    v_and_b32 v5, 1, v2
    v_or_b32 v5, 0, v5
    v_xor_b32 v5, v5, v6
    v_and_b32 v7, 2, v5
    v_add_u32 v5, v5, v7
    v_lshlrev_b32 v5, 6, v5
    v_and_b32 v7, 3, v3
    v_lshl_add_u32 v7, v7, 4, v5
    s_lshl_b32 s43, s21, 2
    v_add_u32 v4, s43, v2
    v_lshl_add_u32 v10, v4, 10, v7
    v_and_b32 v5, 1, v2
    v_or_b32 v5, 2, v5
    v_xor_b32 v5, v5, v6
    v_and_b32 v7, 2, v5
    v_add_u32 v5, v5, v7
    v_lshlrev_b32 v5, 6, v5
    v_and_b32 v7, 3, v3
    v_lshl_add_u32 v7, v7, 4, v5
    s_lshl_b32 s43, s21, 2
    v_add_u32 v4, s43, v2
    v_lshl_add_u32 v9, v4, 10, v7
    v_and_b32 v5, 1, v2
    v_lshl_add_u32 v4, v5, 3, v6
    v_lshrrev_b32 v7, 1, v2
    v_lshl_add_u32 v4, v7, 5, v4
    v_lshlrev_b32 v4, 8, v4
    v_lshl_or_b32 v5, v5, 2, v6
    v_lshlrev_b32 v5, 5, v5
    s_lshl_b32 s43, s21, 6
    v_xor_b32 v5, s43, v5
    v_add_u32 v4, v4, v5
    v_and_b32 v5, 3, v3
    v_lshl_add_u32 v4, v5, 3, v4
    v_add_u32 v11, 32768, v4
    s_and_b32 s43, s21, 1
    s_lshl_b32 s43, s43, 12
    v_add_u32 v11, s43, v11
    v_and_b32 v5, 1, v2
    v_lshlrev_b32 v4, 4, v5
    v_lshl_add_u32 v4, v7, 2, v4
    v_and_b32 v7, 1, v6
    v_add_u32 v4, v4, v7
    s_lshl_b32 s43, s21, 5
    v_add_u32 v4, s43, v4
    v_lshlrev_b32 v4, 8, v4
    v_lshl_or_b32 v5, v5, 1, v7
    s_lshl_b32 s43, s21, 1
    s_and_b32 s43, s43, 3
    v_xor_b32 v5, s43, v5
    v_lshl_add_u32 v4, v5, 6, v4
    v_lshrrev_b32 v5, 1, v6
    v_lshl_add_u32 v4, v5, 5, v4
    v_and_b32 v5, 3, v3
    v_lshl_add_u32 v4, v5, 3, v4
    v_add_u32 v12, 32768, v4
    v_lshlrev_b32 v4, 18, v2
    v_lshl_add_u32 v4, v3, 7, v4
    s_lshl_b32 s43, s20, 13
    s_add_u32 s43, s43, s52
    s_add_u32 s43, s43, 0xf0000
    v_add_u32 v4, s43, v4
    v_and_b32 v5, 3, v3
    v_lshl_add_u32 v5, v5, 13, v119
    v_cmp_gt_u32 vcc, 2, v2
    s_nop 1
    v_cndmask_b32 v7, v5, v4, vcc
    v_mov_b32 v16, -1
    v_mov_b32 v17, -1
    v_mov_b32 v18, -1
    v_mov_b32 v19, -1
    s_lshl_b32 s43, s20, 13
    s_add_u32 s43, s43, 0x100000
    s_and_b32 s40, s21, 1
    s_lshl_b32 s40, s40, 12
    s_add_u32 s29, s43, s40
    s_add_u32 s43, s43, s52
    s_xor_b32 s40, s43, 0x40000
    buffer_store_dwordx4 v[16:19], v117, s[8:11], s43 offen
    buffer_store_dwordx4 v[16:19], v117, s[8:11], s43 offen offset:1024
    buffer_store_dwordx4 v[16:19], v117, s[8:11], s40 offen
    buffer_store_dwordx4 v[16:19], v117, s[8:11], s40 offen offset:1024
    s_mov_b32 s43, 0x12000
    buffer_store_dword v16, v119, s[8:11], s43 offen
    s_mov_b32 s43, 0x14000
    buffer_store_dword v16, v119, s[8:11], s43 offen
    s_mov_b32 s43, 0x16000
    buffer_store_dword v16, v119, s[8:11], s43 offen
    s_load_dwordx2 s[4:5], s[0:1], 8
    s_waitcnt lgkmcnt(0)
    s_and_b32 s5, s5, 0xffff
    s_mov_b32 s6, 8192
    s_mov_b32 s7, 0x20000
    v_and_b32 v20, 1, v2
    v_and_b32 v21, 1, v6
    v_lshl_add_u32 v20, v20, 1, v21
    v_lshlrev_b32 v20, 9, v20
    v_and_b32 v21, 3, v3
    v_lshl_add_u32 v20, v21, 4, v20
    v_and_b32 v21, 2, v2
    v_add_u32 v20, v20, v21
    s_and_b32 s43, s20, 1
    s_lshl_b32 s43, s43, 11
    s_bfe_u32 s40, s20, 0x20001
    s_lshl_b32 s40, s40, 7
    s_add_u32 s43, s43, s40
    s_and_b32 s40, s21, 1
    s_lshl_b32 s40, s40, 6
    s_add_u32 s43, s43, s40
    s_lshr_b32 s40, s20, 3
    s_lshl_b32 s40, s40, 2
    s_add_u32 s43, s43, s40
    v_add_u32 v20, s43, v20
    v_lshlrev_b32 v20, 1, v20
    buffer_load_dword v21, v20, s[4:7], 0 offen
    s_mov_b32 s57, 0
    s_lshl_b32 s43, s20, 13
    s_add_u32 s43, s43, s52
    s_add_u32 s30, s43, 0x1000000
    s_add_u32 s31, s43, 0x2000000
    s_lshr_b32 s43, s43, 1
    s_add_u32 s32, s43, 0x220000
    s_waitcnt vmcnt(20)
    s_barrier
    v_xor_b32 v13, 0x0, v11
    v_add_u32 v13, 0x0, v13
    ds_read_b64_tr_b16 v[32:33], v13
    ds_read_b64_tr_b16 v[34:35], v13 offset:1024
    ds_read_b64_tr_b16 v[36:37], v13 offset:16384
    ds_read_b64_tr_b16 v[38:39], v13 offset:17408
    v_xor_b32 v13, 0x20, v11
    v_add_u32 v13, 0x0, v13
    ds_read_b64_tr_b16 v[40:41], v13
    ds_read_b64_tr_b16 v[42:43], v13 offset:1024
    ds_read_b64_tr_b16 v[44:45], v13 offset:16384
    ds_read_b64_tr_b16 v[46:47], v13 offset:17408
    v_xor_b32 v13, 0x1000, v11
    v_add_u32 v13, 0x0, v13
    ds_read_b64_tr_b16 a[0:1], v13
    ds_read_b64_tr_b16 a[2:3], v13 offset:1024
    ds_read_b64_tr_b16 a[4:5], v13 offset:16384
    ds_read_b64_tr_b16 a[6:7], v13 offset:17408
    v_xor_b32 v13, 0x1020, v11
    v_add_u32 v13, 0x0, v13
    ds_read_b64_tr_b16 a[8:9], v13
    ds_read_b64_tr_b16 a[10:11], v13 offset:1024
    ds_read_b64_tr_b16 a[12:13], v13 offset:16384
    ds_read_b64_tr_b16 a[14:15], v13 offset:17408
    s_waitcnt lgkmcnt(0)
    s_barrier
    s_mov_b32 s4, s62
    s_and_b32 s5, s63, 0xffff
    s_lshr_b32 s6, 0x5ddddddd, s20
    s_and_b32 s6, s6, 1
    s_lshl_b32 s6, s6, 22
    s_mov_b32 s7, 0x20000
    v_add_u32 v23, 0, v22
    v_and_b32 v25, 448, v23
    v_add_u32 v23, v23, v25
    v_lshl_add_u32 v23, v23, 13, v31
    s_mov_b32 s43, 0x0
    buffer_load_dword v30, v23, s[4:7], s43 offen
    s_add_u32 s43, s41, 0x280000
    s_add_u32 m0, s51, 0x1c000
    s_nop 0
    buffer_load_dwordx4 v15, s[12:15], s43 offen lds
    s_add_u32 s43, s41, 0x288000
    s_add_u32 m0, s51, 0x1d000
    s_nop 0
    buffer_load_dwordx4 v15, s[12:15], s43 offen lds
    s_add_u32 s43, s41, 0x380000
    s_add_u32 m0, s51, 0x1e000
    s_nop 0
    buffer_load_dwordx4 v15, s[12:15], s43 offen lds
    s_add_u32 s43, s41, 0x388000
    s_add_u32 m0, s51, 0x1f000
    s_nop 0
    buffer_load_dwordx4 v15, s[12:15], s43 offen lds
    v_xor_b32 v15, 2, v14
    v_lshl_add_u32 v15, v15, 15, v8
    s_add_u32 s43, s41, 0x80000
    s_add_u32 m0, s51, 0x20000
    s_nop 0
    buffer_load_dwordx4 v15, s[12:15], s43 offen lds
    s_add_u32 s43, s41, 0x88000
    s_add_u32 m0, s51, 0x21000
    s_nop 0
    buffer_load_dwordx4 v15, s[12:15], s43 offen lds
    s_add_u32 s43, s41, 0x180000
    s_add_u32 m0, s51, 0x22000
    s_nop 0
    buffer_load_dwordx4 v15, s[12:15], s43 offen lds
    s_add_u32 s43, s41, 0x188000
    s_add_u32 m0, s51, 0x23000
    s_nop 0
    buffer_load_dwordx4 v15, s[12:15], s43 offen lds
    s_waitcnt vmcnt(21)
    s_barrier
    v_xor_b32 v13, 0x0, v11
    v_add_u32 v13, 0x8000, v13
    ds_read_b64_tr_b16 a[32:33], v13
    ds_read_b64_tr_b16 a[34:35], v13 offset:1024
    ds_read_b64_tr_b16 a[36:37], v13 offset:16384
    ds_read_b64_tr_b16 a[38:39], v13 offset:17408
    v_xor_b32 v13, 0x20, v11
    v_add_u32 v13, 0x8000, v13
    ds_read_b64_tr_b16 a[40:41], v13
    ds_read_b64_tr_b16 a[42:43], v13 offset:1024
    ds_read_b64_tr_b16 a[44:45], v13 offset:16384
    ds_read_b64_tr_b16 a[46:47], v13 offset:17408
    v_xor_b32 v13, 0x1000, v11
    v_add_u32 v13, 0x8000, v13
    ds_read_b64_tr_b16 a[64:65], v13
    ds_read_b64_tr_b16 a[66:67], v13 offset:1024
    ds_read_b64_tr_b16 a[68:69], v13 offset:16384
    ds_read_b64_tr_b16 a[70:71], v13 offset:17408
    v_xor_b32 v13, 0x1020, v11
    v_add_u32 v13, 0x8000, v13
    ds_read_b64_tr_b16 a[72:73], v13
    ds_read_b64_tr_b16 a[74:75], v13 offset:1024
    ds_read_b64_tr_b16 a[76:77], v13 offset:16384
    ds_read_b64_tr_b16 a[78:79], v13 offset:17408
    s_waitcnt lgkmcnt(0)
    s_barrier
    s_add_u32 s43, s41, 0x280000
    s_add_u32 m0, s51, 0x24000
    s_nop 0
    buffer_load_dwordx4 v15, s[12:15], s43 offen lds
    s_add_u32 s43, s41, 0x288000
    s_add_u32 m0, s51, 0x25000
    s_nop 0
    buffer_load_dwordx4 v15, s[12:15], s43 offen lds
    s_add_u32 s43, s41, 0x380000
    s_add_u32 m0, s51, 0x26000
    s_nop 0
    buffer_load_dwordx4 v15, s[12:15], s43 offen lds
    s_add_u32 s43, s41, 0x388000
    s_add_u32 m0, s51, 0x27000
    s_nop 0
    buffer_load_dwordx4 v15, s[12:15], s43 offen lds
    s_mov_b32 s12, s62
    s_and_b32 s13, s63, 0xffff
    v_xor_b32 v15, 0, v14
    v_lshl_add_u32 v15, v15, 15, v8
    s_add_u32 s43, s41, 0x0
    s_add_u32 m0, s51, 0x8000
    s_nop 0
    buffer_load_dwordx4 v15, s[12:15], s43 offen lds
    s_add_u32 s43, s41, 0x8000
    s_add_u32 m0, s51, 0x9000
    s_nop 0
    buffer_load_dwordx4 v15, s[12:15], s43 offen lds
    s_add_u32 s43, s41, 0x100000
    s_add_u32 m0, s51, 0xa000
    s_nop 0
    buffer_load_dwordx4 v15, s[12:15], s43 offen lds
    s_add_u32 s43, s41, 0x108000
    s_add_u32 m0, s51, 0xb000
    s_nop 0
    buffer_load_dwordx4 v15, s[12:15], s43 offen lds
    s_waitcnt vmcnt(12)
    s_barrier
    v_xor_b32 v13, 0x0, v11
    v_add_u32 v13, 0x10000, v13
    ds_read_b64_tr_b16 v[48:49], v13
    ds_read_b64_tr_b16 v[50:51], v13 offset:1024
    ds_read_b64_tr_b16 v[52:53], v13 offset:16384
    ds_read_b64_tr_b16 v[54:55], v13 offset:17408
    v_xor_b32 v13, 0x20, v11
    v_add_u32 v13, 0x10000, v13
    ds_read_b64_tr_b16 v[56:57], v13
    ds_read_b64_tr_b16 v[58:59], v13 offset:1024
    ds_read_b64_tr_b16 v[60:61], v13 offset:16384
    ds_read_b64_tr_b16 v[62:63], v13 offset:17408
    v_xor_b32 v13, 0x1000, v11
    v_add_u32 v13, 0x10000, v13
    ds_read_b64_tr_b16 a[16:17], v13
    ds_read_b64_tr_b16 a[18:19], v13 offset:1024
    ds_read_b64_tr_b16 a[20:21], v13 offset:16384
    ds_read_b64_tr_b16 a[22:23], v13 offset:17408
    v_xor_b32 v13, 0x1020, v11
    v_add_u32 v13, 0x10000, v13
    ds_read_b64_tr_b16 a[24:25], v13
    ds_read_b64_tr_b16 a[26:27], v13 offset:1024
    ds_read_b64_tr_b16 a[28:29], v13 offset:16384
    ds_read_b64_tr_b16 a[30:31], v13 offset:17408
    s_waitcnt lgkmcnt(0)
    s_barrier
    s_add_u32 s43, s41, 0x200000
    s_add_u32 m0, s51, 0xc000
    s_nop 0
    buffer_load_dwordx4 v15, s[12:15], s43 offen lds
    s_add_u32 s43, s41, 0x208000
    s_add_u32 m0, s51, 0xd000
    s_nop 0
    buffer_load_dwordx4 v15, s[12:15], s43 offen lds
    s_add_u32 s43, s41, 0x300000
    s_add_u32 m0, s51, 0xe000
    s_nop 0
    buffer_load_dwordx4 v15, s[12:15], s43 offen lds
    s_add_u32 s43, s41, 0x308000
    s_add_u32 m0, s51, 0xf000
    s_nop 0
    buffer_load_dwordx4 v15, s[12:15], s43 offen lds
    v_xor_b32 v15, 2, v14
    v_lshl_add_u32 v15, v15, 15, v8
    s_add_u32 s43, s41, 0x0
    s_add_u32 m0, s51, 0x10000
    s_nop 0
    buffer_load_dwordx4 v15, s[12:15], s43 offen lds
    s_add_u32 s43, s41, 0x8000
    s_add_u32 m0, s51, 0x11000
    s_nop 0
    buffer_load_dwordx4 v15, s[12:15], s43 offen lds
    s_add_u32 s43, s41, 0x100000
    s_add_u32 m0, s51, 0x12000
    s_nop 0
    buffer_load_dwordx4 v15, s[12:15], s43 offen lds
    s_add_u32 s43, s41, 0x108000
    s_add_u32 m0, s51, 0x13000
    s_nop 0
    buffer_load_dwordx4 v15, s[12:15], s43 offen lds
    s_waitcnt vmcnt(12)
    s_barrier
    v_xor_b32 v13, 0x0, v11
    v_add_u32 v13, 0x18000, v13
    ds_read_b64_tr_b16 a[48:49], v13
    ds_read_b64_tr_b16 a[50:51], v13 offset:1024
    ds_read_b64_tr_b16 a[52:53], v13 offset:16384
    ds_read_b64_tr_b16 a[54:55], v13 offset:17408
    v_xor_b32 v13, 0x20, v11
    v_add_u32 v13, 0x18000, v13
    ds_read_b64_tr_b16 a[56:57], v13
    ds_read_b64_tr_b16 a[58:59], v13 offset:1024
    ds_read_b64_tr_b16 a[60:61], v13 offset:16384
    ds_read_b64_tr_b16 a[62:63], v13 offset:17408
    v_xor_b32 v13, 0x1000, v11
    v_add_u32 v13, 0x18000, v13
    ds_read_b64_tr_b16 a[80:81], v13
    ds_read_b64_tr_b16 a[82:83], v13 offset:1024
    ds_read_b64_tr_b16 a[84:85], v13 offset:16384
    ds_read_b64_tr_b16 a[86:87], v13 offset:17408
    v_xor_b32 v13, 0x1020, v11
    v_add_u32 v13, 0x18000, v13
    ds_read_b64_tr_b16 a[88:89], v13
    ds_read_b64_tr_b16 a[90:91], v13 offset:1024
    ds_read_b64_tr_b16 a[92:93], v13 offset:16384
    ds_read_b64_tr_b16 a[94:95], v13 offset:17408
    s_waitcnt lgkmcnt(0)
    s_barrier
    s_add_u32 s43, s41, 0x200000
    s_add_u32 m0, s51, 0x14000
    s_nop 0
    buffer_load_dwordx4 v15, s[12:15], s43 offen lds
    s_add_u32 s43, s41, 0x208000
    s_add_u32 m0, s51, 0x15000
    s_nop 0
    buffer_load_dwordx4 v15, s[12:15], s43 offen lds
    s_add_u32 s43, s41, 0x300000
    s_add_u32 m0, s51, 0x16000
    s_nop 0
    buffer_load_dwordx4 v15, s[12:15], s43 offen lds
    s_add_u32 s43, s41, 0x308000
    s_add_u32 m0, s51, 0x17000
    s_nop 0
    buffer_load_dwordx4 v15, s[12:15], s43 offen lds
    v_xor_b32 v15, 0, v14
    v_lshl_add_u32 v15, v15, 15, v8
    s_add_u32 s43, s41, 0x80000
    s_add_u32 m0, s51, 0x18000
    s_nop 0
    buffer_load_dwordx4 v15, s[12:15], s43 offen lds
    s_add_u32 s43, s41, 0x88000
    s_add_u32 m0, s51, 0x19000
    s_nop 0
    buffer_load_dwordx4 v15, s[12:15], s43 offen lds
    s_add_u32 s43, s41, 0x180000
    s_add_u32 m0, s51, 0x1a000
    s_nop 0
    buffer_load_dwordx4 v15, s[12:15], s43 offen lds
    s_add_u32 s43, s41, 0x188000
    s_add_u32 m0, s51, 0x1b000
    s_nop 0
    buffer_load_dwordx4 v15, s[12:15], s43 offen lds
    s_waitcnt vmcnt(12)
    v_min_u32 v21, 0xfffffffe, v21
    s_mov_b32 s43, 0x10000
    s_mov_b64 exec, s[38:39]
    buffer_store_dword v21, v119, s[8:11], s43 offen
    s_mov_b64 exec, -1
    s_barrier
    v_xor_b32 v13, 0x0, v11
    v_add_u32 v13, 0x0, v13
    ds_read_b64_tr_b16 v[64:65], v13
    ds_read_b64_tr_b16 v[66:67], v13 offset:1024
    ds_read_b64_tr_b16 v[68:69], v13 offset:16384
    ds_read_b64_tr_b16 v[70:71], v13 offset:17408
    v_xor_b32 v13, 0x20, v11
    v_add_u32 v13, 0x0, v13
    ds_read_b64_tr_b16 v[72:73], v13
    ds_read_b64_tr_b16 v[74:75], v13 offset:1024
    ds_read_b64_tr_b16 v[76:77], v13 offset:16384
    ds_read_b64_tr_b16 v[78:79], v13 offset:17408
    v_xor_b32 v13, 0x1000, v11
    v_add_u32 v13, 0x0, v13
    ds_read_b64_tr_b16 a[96:97], v13
    ds_read_b64_tr_b16 a[98:99], v13 offset:1024
    ds_read_b64_tr_b16 a[100:101], v13 offset:16384
    ds_read_b64_tr_b16 a[102:103], v13 offset:17408
    v_xor_b32 v13, 0x1020, v11
    v_add_u32 v13, 0x0, v13
    ds_read_b64_tr_b16 a[104:105], v13
    ds_read_b64_tr_b16 a[106:107], v13 offset:1024
    ds_read_b64_tr_b16 a[108:109], v13 offset:16384
    ds_read_b64_tr_b16 a[110:111], v13 offset:17408
    s_waitcnt lgkmcnt(0)
    s_barrier
    s_add_u32 s43, s41, 0x280000
    s_add_u32 m0, s51, 0x1c000
    s_nop 0
    buffer_load_dwordx4 v15, s[12:15], s43 offen lds
    s_add_u32 s43, s41, 0x288000
    s_add_u32 m0, s51, 0x1d000
    s_nop 0
    buffer_load_dwordx4 v15, s[12:15], s43 offen lds
    s_add_u32 s43, s41, 0x380000
    s_add_u32 m0, s51, 0x1e000
    s_nop 0
    buffer_load_dwordx4 v15, s[12:15], s43 offen lds
    s_add_u32 s43, s41, 0x388000
    s_add_u32 m0, s51, 0x1f000
    s_nop 0
    buffer_load_dwordx4 v15, s[12:15], s43 offen lds
    v_xor_b32 v15, 2, v14
    v_lshl_add_u32 v15, v15, 15, v8
    s_add_u32 s43, s41, 0x80000
    s_add_u32 m0, s51, 0x20000
    s_nop 0
    buffer_load_dwordx4 v15, s[12:15], s43 offen lds
    s_add_u32 s43, s41, 0x88000
    s_add_u32 m0, s51, 0x21000
    s_nop 0
    buffer_load_dwordx4 v15, s[12:15], s43 offen lds
    s_add_u32 s43, s41, 0x180000
    s_add_u32 m0, s51, 0x22000
    s_nop 0
    buffer_load_dwordx4 v15, s[12:15], s43 offen lds
    s_add_u32 s43, s41, 0x188000
    s_add_u32 m0, s51, 0x23000
    s_nop 0
    buffer_load_dwordx4 v15, s[12:15], s43 offen lds
    s_waitcnt vmcnt(12)
    s_barrier
    v_xor_b32 v13, 0x0, v11
    v_add_u32 v13, 0x8000, v13
    ds_read_b64_tr_b16 a[128:129], v13
    ds_read_b64_tr_b16 a[130:131], v13 offset:1024
    ds_read_b64_tr_b16 a[132:133], v13 offset:16384
    ds_read_b64_tr_b16 a[134:135], v13 offset:17408
    v_xor_b32 v13, 0x20, v11
    v_add_u32 v13, 0x8000, v13
    ds_read_b64_tr_b16 a[136:137], v13
    ds_read_b64_tr_b16 a[138:139], v13 offset:1024
    ds_read_b64_tr_b16 a[140:141], v13 offset:16384
    ds_read_b64_tr_b16 a[142:143], v13 offset:17408
    v_xor_b32 v13, 0x1000, v11
    v_add_u32 v13, 0x8000, v13
    ds_read_b64_tr_b16 a[160:161], v13
    ds_read_b64_tr_b16 a[162:163], v13 offset:1024
    ds_read_b64_tr_b16 a[164:165], v13 offset:16384
    ds_read_b64_tr_b16 a[166:167], v13 offset:17408
    v_xor_b32 v13, 0x1020, v11
    v_add_u32 v13, 0x8000, v13
    ds_read_b64_tr_b16 a[168:169], v13
    ds_read_b64_tr_b16 a[170:171], v13 offset:1024
    ds_read_b64_tr_b16 a[172:173], v13 offset:16384
    ds_read_b64_tr_b16 a[174:175], v13 offset:17408
    s_waitcnt lgkmcnt(0)
    s_barrier
    buffer_load_dwordx2 v[26:27], off, s[16:19], 0 offset:36 sc1
    s_add_u32 s43, s41, 0x280000
    s_add_u32 m0, s51, 0x24000
    s_nop 0
    buffer_load_dwordx4 v15, s[12:15], s43 offen lds
    s_add_u32 s43, s41, 0x288000
    s_add_u32 m0, s51, 0x25000
    s_nop 0
    buffer_load_dwordx4 v15, s[12:15], s43 offen lds
    s_add_u32 s43, s41, 0x380000
    s_add_u32 m0, s51, 0x26000
    s_nop 0
    buffer_load_dwordx4 v15, s[12:15], s43 offen lds
    s_add_u32 s43, s41, 0x388000
    s_add_u32 m0, s51, 0x27000
    s_nop 0
    buffer_load_dwordx4 v15, s[12:15], s43 offen lds
    s_mov_b32 s12, s64
    s_and_b32 s13, s65, 0xffff
    v_xor_b32 v15, 0, v14
    v_lshl_add_u32 v15, v15, 15, v8
    s_add_u32 s43, s41, 0x0
    s_add_u32 m0, s51, 0x8000
    s_nop 0
    buffer_load_dwordx4 v15, s[12:15], s43 offen lds
    s_add_u32 s43, s41, 0x8000
    s_add_u32 m0, s51, 0x9000
    s_nop 0
    buffer_load_dwordx4 v15, s[12:15], s43 offen lds
    s_add_u32 s43, s41, 0x100000
    s_add_u32 m0, s51, 0xa000
    s_nop 0
    buffer_load_dwordx4 v15, s[12:15], s43 offen lds
    s_add_u32 s43, s41, 0x108000
    s_add_u32 m0, s51, 0xb000
    s_nop 0
    buffer_load_dwordx4 v15, s[12:15], s43 offen lds
    s_waitcnt vmcnt(13)
    s_barrier
    v_xor_b32 v13, 0x0, v11
    v_add_u32 v13, 0x10000, v13
    ds_read_b64_tr_b16 v[80:81], v13
    ds_read_b64_tr_b16 v[82:83], v13 offset:1024
    ds_read_b64_tr_b16 v[84:85], v13 offset:16384
    ds_read_b64_tr_b16 v[86:87], v13 offset:17408
    v_xor_b32 v13, 0x20, v11
    v_add_u32 v13, 0x10000, v13
    ds_read_b64_tr_b16 v[88:89], v13
    ds_read_b64_tr_b16 v[90:91], v13 offset:1024
    ds_read_b64_tr_b16 v[92:93], v13 offset:16384
    ds_read_b64_tr_b16 v[94:95], v13 offset:17408
    v_xor_b32 v13, 0x1000, v11
    v_add_u32 v13, 0x10000, v13
    ds_read_b64_tr_b16 a[112:113], v13
    ds_read_b64_tr_b16 a[114:115], v13 offset:1024
    ds_read_b64_tr_b16 a[116:117], v13 offset:16384
    ds_read_b64_tr_b16 a[118:119], v13 offset:17408
    v_xor_b32 v13, 0x1020, v11
    v_add_u32 v13, 0x10000, v13
    ds_read_b64_tr_b16 a[120:121], v13
    ds_read_b64_tr_b16 a[122:123], v13 offset:1024
    ds_read_b64_tr_b16 a[124:125], v13 offset:16384
    ds_read_b64_tr_b16 a[126:127], v13 offset:17408
    s_waitcnt lgkmcnt(0)
    s_barrier
    s_add_u32 s43, s41, 0x200000
    s_add_u32 m0, s51, 0xc000
    s_nop 0
    buffer_load_dwordx4 v15, s[12:15], s43 offen lds
    s_add_u32 s43, s41, 0x208000
    s_add_u32 m0, s51, 0xd000
    s_nop 0
    buffer_load_dwordx4 v15, s[12:15], s43 offen lds
    s_add_u32 s43, s41, 0x300000
    s_add_u32 m0, s51, 0xe000
    s_nop 0
    buffer_load_dwordx4 v15, s[12:15], s43 offen lds
    s_add_u32 s43, s41, 0x308000
    s_add_u32 m0, s51, 0xf000
    s_nop 0
    buffer_load_dwordx4 v15, s[12:15], s43 offen lds
    v_xor_b32 v15, 2, v14
    v_lshl_add_u32 v15, v15, 15, v8
    s_add_u32 s43, s41, 0x0
    s_add_u32 m0, s51, 0x10000
    s_nop 0
    buffer_load_dwordx4 v15, s[12:15], s43 offen lds
    s_add_u32 s43, s41, 0x8000
    s_add_u32 m0, s51, 0x11000
    s_nop 0
    buffer_load_dwordx4 v15, s[12:15], s43 offen lds
    s_add_u32 s43, s41, 0x100000
    s_add_u32 m0, s51, 0x12000
    s_nop 0
    buffer_load_dwordx4 v15, s[12:15], s43 offen lds
    s_add_u32 s43, s41, 0x108000
    s_add_u32 m0, s51, 0x13000
    s_nop 0
    buffer_load_dwordx4 v15, s[12:15], s43 offen lds
    s_waitcnt vmcnt(12)
    s_barrier
    v_xor_b32 v13, 0x0, v11
    v_add_u32 v13, 0x18000, v13
    ds_read_b64_tr_b16 a[144:145], v13
    ds_read_b64_tr_b16 a[146:147], v13 offset:1024
    ds_read_b64_tr_b16 a[148:149], v13 offset:16384
    ds_read_b64_tr_b16 a[150:151], v13 offset:17408
    v_xor_b32 v13, 0x20, v11
    v_add_u32 v13, 0x18000, v13
    ds_read_b64_tr_b16 a[152:153], v13
    ds_read_b64_tr_b16 a[154:155], v13 offset:1024
    ds_read_b64_tr_b16 a[156:157], v13 offset:16384
    ds_read_b64_tr_b16 a[158:159], v13 offset:17408
    v_xor_b32 v13, 0x1000, v11
    v_add_u32 v13, 0x18000, v13
    ds_read_b64_tr_b16 a[176:177], v13
    ds_read_b64_tr_b16 a[178:179], v13 offset:1024
    ds_read_b64_tr_b16 a[180:181], v13 offset:16384
    ds_read_b64_tr_b16 a[182:183], v13 offset:17408
    v_xor_b32 v13, 0x1020, v11
    v_add_u32 v13, 0x18000, v13
    ds_read_b64_tr_b16 a[184:185], v13
    ds_read_b64_tr_b16 a[186:187], v13 offset:1024
    ds_read_b64_tr_b16 a[188:189], v13 offset:16384
    ds_read_b64_tr_b16 a[190:191], v13 offset:17408
    s_waitcnt lgkmcnt(0)
    s_barrier
    s_add_u32 s43, s41, 0x200000
    s_add_u32 m0, s51, 0x14000
    s_nop 0
    buffer_load_dwordx4 v15, s[12:15], s43 offen lds
    s_add_u32 s43, s41, 0x208000
    s_add_u32 m0, s51, 0x15000
    s_nop 0
    buffer_load_dwordx4 v15, s[12:15], s43 offen lds
    s_add_u32 s43, s41, 0x300000
    s_add_u32 m0, s51, 0x16000
    s_nop 0
    buffer_load_dwordx4 v15, s[12:15], s43 offen lds
    s_add_u32 s43, s41, 0x308000
    s_add_u32 m0, s51, 0x17000
    s_nop 0
    buffer_load_dwordx4 v15, s[12:15], s43 offen lds
    s_mov_b32 s12, s66
    s_and_b32 s13, s67, 0xffff
    s_add_u32 s43, s42, 0x0
    s_add_u32 m0, s51, 0x18000
    s_nop 0
    buffer_load_dwordx4 v10, s[12:15], s43 offen lds
    s_add_u32 s43, s42, 0x4000
    s_add_u32 m0, s51, 0x19000
    s_nop 0
    buffer_load_dwordx4 v9, s[12:15], s43 offen lds
    s_add_u32 s43, s42, 0x8000
    s_add_u32 m0, s51, 0x1a000
    s_nop 0
    buffer_load_dwordx4 v10, s[12:15], s43 offen lds
    s_add_u32 s43, s42, 0xc000
    s_add_u32 m0, s51, 0x1b000
    s_nop 0
    buffer_load_dwordx4 v9, s[12:15], s43 offen lds
    s_waitcnt vmcnt(12)
    s_barrier
    v_xor_b32 v13, 0x0, v11
    v_add_u32 v13, 0x0, v13
    ds_read_b64_tr_b16 a[192:193], v13
    ds_read_b64_tr_b16 a[194:195], v13 offset:1024
    ds_read_b64_tr_b16 a[196:197], v13 offset:16384
    ds_read_b64_tr_b16 a[198:199], v13 offset:17408
    v_xor_b32 v13, 0x20, v11
    v_add_u32 v13, 0x0, v13
    ds_read_b64_tr_b16 a[200:201], v13
    ds_read_b64_tr_b16 a[202:203], v13 offset:1024
    ds_read_b64_tr_b16 a[204:205], v13 offset:16384
    ds_read_b64_tr_b16 a[206:207], v13 offset:17408
    v_xor_b32 v13, 0x1000, v11
    v_add_u32 v13, 0x0, v13
    ds_read_b64_tr_b16 a[224:225], v13
    ds_read_b64_tr_b16 a[226:227], v13 offset:1024
    ds_read_b64_tr_b16 a[228:229], v13 offset:16384
    ds_read_b64_tr_b16 a[230:231], v13 offset:17408
    v_xor_b32 v13, 0x1020, v11
    v_add_u32 v13, 0x0, v13
    ds_read_b64_tr_b16 a[232:233], v13
    ds_read_b64_tr_b16 a[234:235], v13 offset:1024
    ds_read_b64_tr_b16 a[236:237], v13 offset:16384
    ds_read_b64_tr_b16 a[238:239], v13 offset:17408
    s_waitcnt lgkmcnt(0)
    s_barrier
    s_add_u32 s43, s42, 0x10200
    s_add_u32 m0, s51, 0x1c000
    s_nop 0
    buffer_load_dwordx4 v10, s[12:15], s43 offen lds
    s_add_u32 s43, s42, 0x14200
    s_add_u32 m0, s51, 0x1d000
    s_nop 0
    buffer_load_dwordx4 v9, s[12:15], s43 offen lds
    s_add_u32 s43, s42, 0x18200
    s_add_u32 m0, s51, 0x1e000
    s_nop 0
    buffer_load_dwordx4 v10, s[12:15], s43 offen lds
    s_add_u32 s43, s42, 0x1c200
    s_add_u32 m0, s51, 0x1f000
    s_nop 0
    buffer_load_dwordx4 v9, s[12:15], s43 offen lds
    s_add_u32 s43, s42, 0x10000
    s_add_u32 m0, s51, 0x20000
    s_nop 0
    buffer_load_dwordx4 v10, s[12:15], s43 offen lds
    s_add_u32 s43, s42, 0x14000
    s_add_u32 m0, s51, 0x21000
    s_nop 0
    buffer_load_dwordx4 v9, s[12:15], s43 offen lds
    s_add_u32 s43, s42, 0x18000
    s_add_u32 m0, s51, 0x22000
    s_nop 0
    buffer_load_dwordx4 v10, s[12:15], s43 offen lds
    s_add_u32 s43, s42, 0x1c000
    s_add_u32 m0, s51, 0x23000
    s_nop 0
    buffer_load_dwordx4 v9, s[12:15], s43 offen lds
    s_waitcnt vmcnt(12)
    v_readfirstlane_b32 s57, v26
    v_readfirstlane_b32 s43, v27
    s_nop 0
    s_cmp_lg_u32 s43, 0
    s_cselect_b32 s57, s57, 0
    s_barrier
    s_cmp_lg_u32 s21, 0
    s_cbranch_scc1 L_arr_4
    v_mov_b32 v23, 1
    s_mov_b64 exec, 1
    buffer_atomic_add v23, off, s[16:19], 0 offset:4
    s_mov_b64 exec, -1
L_arr_4:
    v_xor_b32 v13, 0x0, v11
    v_add_u32 v13, 0x8000, v13
    ds_read_b64_tr_b16 v[128:129], v13
    ds_read_b64_tr_b16 v[130:131], v13 offset:1024
    ds_read_b64_tr_b16 v[132:133], v13 offset:16384
    ds_read_b64_tr_b16 v[134:135], v13 offset:17408
    v_xor_b32 v13, 0x20, v11
    v_add_u32 v13, 0x8000, v13
    ds_read_b64_tr_b16 v[136:137], v13
    ds_read_b64_tr_b16 v[138:139], v13 offset:1024
    ds_read_b64_tr_b16 v[140:141], v13 offset:16384
    ds_read_b64_tr_b16 v[142:143], v13 offset:17408
    v_xor_b32 v13, 0x1000, v11
    v_add_u32 v13, 0x8000, v13
    ds_read_b64_tr_b16 v[160:161], v13
    ds_read_b64_tr_b16 v[162:163], v13 offset:1024
    ds_read_b64_tr_b16 v[164:165], v13 offset:16384
    ds_read_b64_tr_b16 v[166:167], v13 offset:17408
    v_xor_b32 v13, 0x1020, v11
    v_add_u32 v13, 0x8000, v13
    ds_read_b64_tr_b16 v[168:169], v13
    ds_read_b64_tr_b16 v[170:171], v13 offset:1024
    ds_read_b64_tr_b16 v[172:173], v13 offset:16384
    ds_read_b64_tr_b16 v[174:175], v13 offset:17408
    s_waitcnt lgkmcnt(0)
    s_barrier
    s_add_u32 s43, s42, 0x200
    s_add_u32 m0, s51, 0x24000
    s_nop 0
    buffer_load_dwordx4 v10, s[12:15], s43 offen lds
    s_add_u32 s43, s42, 0x4200
    s_add_u32 m0, s51, 0x25000
    s_nop 0
    buffer_load_dwordx4 v9, s[12:15], s43 offen lds
    s_add_u32 s43, s42, 0x8200
    s_add_u32 m0, s51, 0x26000
    s_nop 0
    buffer_load_dwordx4 v10, s[12:15], s43 offen lds
    s_add_u32 s43, s42, 0xc200
    s_add_u32 m0, s51, 0x27000
    s_nop 0
    buffer_load_dwordx4 v9, s[12:15], s43 offen lds
    s_mov_b32 s12, s64
    s_and_b32 s13, s65, 0xffff
    v_xor_b32 v15, 0, v14
    v_lshl_add_u32 v15, v15, 15, v8
    s_add_u32 s43, s41, 0x80000
    s_add_u32 m0, s51, 0x8000
    s_nop 0
    buffer_load_dwordx4 v15, s[12:15], s43 offen lds
    s_add_u32 s43, s41, 0x88000
    s_add_u32 m0, s51, 0x9000
    s_nop 0
    buffer_load_dwordx4 v15, s[12:15], s43 offen lds
    s_add_u32 s43, s41, 0x180000
    s_add_u32 m0, s51, 0xa000
    s_nop 0
    buffer_load_dwordx4 v15, s[12:15], s43 offen lds
    s_add_u32 s43, s41, 0x188000
    s_add_u32 m0, s51, 0xb000
    s_nop 0
    buffer_load_dwordx4 v15, s[12:15], s43 offen lds
    s_waitcnt vmcnt(12)
    s_barrier
    v_xor_b32 v13, 0x0, v12
    v_add_u32 v13, 0x10000, v13
    ds_read_b64_tr_b16 v[192:193], v13
    ds_read_b64_tr_b16 v[194:195], v13 offset:512
    ds_read_b64_tr_b16 v[196:197], v13 offset:2048
    ds_read_b64_tr_b16 v[198:199], v13 offset:2560
    v_xor_b32 v13, 0x2000, v12
    v_add_u32 v13, 0x10000, v13
    ds_read_b64_tr_b16 v[200:201], v13
    ds_read_b64_tr_b16 v[202:203], v13 offset:512
    ds_read_b64_tr_b16 v[204:205], v13 offset:2048
    ds_read_b64_tr_b16 v[206:207], v13 offset:2560
    v_xor_b32 v13, 0x40, v12
    v_add_u32 v13, 0x10000, v13
    ds_read_b64_tr_b16 v[224:225], v13
    ds_read_b64_tr_b16 v[226:227], v13 offset:512
    ds_read_b64_tr_b16 v[228:229], v13 offset:2048
    ds_read_b64_tr_b16 v[230:231], v13 offset:2560
    v_xor_b32 v13, 0x2040, v12
    v_add_u32 v13, 0x10000, v13
    ds_read_b64_tr_b16 v[232:233], v13
    ds_read_b64_tr_b16 v[234:235], v13 offset:512
    ds_read_b64_tr_b16 v[236:237], v13 offset:2048
    ds_read_b64_tr_b16 v[238:239], v13 offset:2560
    s_waitcnt lgkmcnt(0)
    s_barrier
    s_add_u32 s43, s41, 0x280000
    s_add_u32 m0, s51, 0xc000
    s_nop 0
    buffer_load_dwordx4 v15, s[12:15], s43 offen lds
    s_add_u32 s43, s41, 0x288000
    s_add_u32 m0, s51, 0xd000
    s_nop 0
    buffer_load_dwordx4 v15, s[12:15], s43 offen lds
    s_add_u32 s43, s41, 0x380000
    s_add_u32 m0, s51, 0xe000
    s_nop 0
    buffer_load_dwordx4 v15, s[12:15], s43 offen lds
    s_add_u32 s43, s41, 0x388000
    s_add_u32 m0, s51, 0xf000
    s_nop 0
    buffer_load_dwordx4 v15, s[12:15], s43 offen lds
    v_xor_b32 v15, 2, v14
    v_lshl_add_u32 v15, v15, 15, v8
    s_add_u32 s43, s41, 0x80000
    s_add_u32 m0, s51, 0x10000
    s_nop 0
    buffer_load_dwordx4 v15, s[12:15], s43 offen lds
    s_add_u32 s43, s41, 0x88000
    s_add_u32 m0, s51, 0x11000
    s_nop 0
    buffer_load_dwordx4 v15, s[12:15], s43 offen lds
    s_add_u32 s43, s41, 0x180000
    s_add_u32 m0, s51, 0x12000
    s_nop 0
    buffer_load_dwordx4 v15, s[12:15], s43 offen lds
    s_add_u32 s43, s41, 0x188000
    s_add_u32 m0, s51, 0x13000
    s_nop 0
    buffer_load_dwordx4 v15, s[12:15], s43 offen lds
    s_waitcnt vmcnt(12)
    s_barrier
    v_xor_b32 v13, 0x0, v12
    v_add_u32 v13, 0x18000, v13
    ds_read_b64_tr_b16 v[208:209], v13
    ds_read_b64_tr_b16 v[210:211], v13 offset:512
    ds_read_b64_tr_b16 v[212:213], v13 offset:2048
    ds_read_b64_tr_b16 v[214:215], v13 offset:2560
    v_xor_b32 v13, 0x2000, v12
    v_add_u32 v13, 0x18000, v13
    ds_read_b64_tr_b16 v[216:217], v13
    ds_read_b64_tr_b16 v[218:219], v13 offset:512
    ds_read_b64_tr_b16 v[220:221], v13 offset:2048
    ds_read_b64_tr_b16 v[222:223], v13 offset:2560
    v_xor_b32 v13, 0x40, v12
    v_add_u32 v13, 0x18000, v13
    ds_read_b64_tr_b16 v[240:241], v13
    ds_read_b64_tr_b16 v[242:243], v13 offset:512
    ds_read_b64_tr_b16 v[244:245], v13 offset:2048
    ds_read_b64_tr_b16 v[246:247], v13 offset:2560
    v_xor_b32 v13, 0x2040, v12
    v_add_u32 v13, 0x18000, v13
    ds_read_b64_tr_b16 v[248:249], v13
    ds_read_b64_tr_b16 v[250:251], v13 offset:512
    ds_read_b64_tr_b16 v[252:253], v13 offset:2048
    ds_read_b64_tr_b16 v[254:255], v13 offset:2560
    s_waitcnt lgkmcnt(0)
    s_barrier
    s_add_u32 s43, s41, 0x280000
    s_add_u32 m0, s51, 0x14000
    s_nop 0
    buffer_load_dwordx4 v15, s[12:15], s43 offen lds
    s_add_u32 s43, s41, 0x288000
    s_add_u32 m0, s51, 0x15000
    s_nop 0
    buffer_load_dwordx4 v15, s[12:15], s43 offen lds
    s_add_u32 s43, s41, 0x380000
    s_add_u32 m0, s51, 0x16000
    s_nop 0
    buffer_load_dwordx4 v15, s[12:15], s43 offen lds
    s_add_u32 s43, s41, 0x388000
    s_add_u32 m0, s51, 0x17000
    s_nop 0
    buffer_load_dwordx4 v15, s[12:15], s43 offen lds
    s_mov_b32 s12, s66
    s_and_b32 s13, s67, 0xffff
    s_add_u32 s43, s42, 0x80
    s_add_u32 m0, s51, 0x18000
    s_nop 0
    buffer_load_dwordx4 v10, s[12:15], s43 offen lds
    s_add_u32 s43, s42, 0x4080
    s_add_u32 m0, s51, 0x19000
    s_nop 0
    buffer_load_dwordx4 v9, s[12:15], s43 offen lds
    s_add_u32 s43, s42, 0x8080
    s_add_u32 m0, s51, 0x1a000
    s_nop 0
    buffer_load_dwordx4 v10, s[12:15], s43 offen lds
    s_add_u32 s43, s42, 0xc080
    s_add_u32 m0, s51, 0x1b000
    s_nop 0
    buffer_load_dwordx4 v9, s[12:15], s43 offen lds
    s_waitcnt vmcnt(12)
    s_barrier
    v_xor_b32 v13, 0x0, v11
    v_add_u32 v13, 0x0, v13
    ds_read_b64_tr_b16 a[208:209], v13
    ds_read_b64_tr_b16 a[210:211], v13 offset:1024
    ds_read_b64_tr_b16 a[212:213], v13 offset:16384
    ds_read_b64_tr_b16 a[214:215], v13 offset:17408
    v_xor_b32 v13, 0x20, v11
    v_add_u32 v13, 0x0, v13
    ds_read_b64_tr_b16 a[216:217], v13
    ds_read_b64_tr_b16 a[218:219], v13 offset:1024
    ds_read_b64_tr_b16 a[220:221], v13 offset:16384
    ds_read_b64_tr_b16 a[222:223], v13 offset:17408
    v_xor_b32 v13, 0x1000, v11
    v_add_u32 v13, 0x0, v13
    ds_read_b64_tr_b16 a[240:241], v13
    ds_read_b64_tr_b16 a[242:243], v13 offset:1024
    ds_read_b64_tr_b16 a[244:245], v13 offset:16384
    ds_read_b64_tr_b16 a[246:247], v13 offset:17408
    v_xor_b32 v13, 0x1020, v11
    v_add_u32 v13, 0x0, v13
    ds_read_b64_tr_b16 a[248:249], v13
    ds_read_b64_tr_b16 a[250:251], v13 offset:1024
    ds_read_b64_tr_b16 a[252:253], v13 offset:16384
    ds_read_b64_tr_b16 a[254:255], v13 offset:17408
    s_waitcnt lgkmcnt(0)
    s_barrier
    s_cmp_lg_u32 s20, 2
    s_cbranch_scc1 L_nocc_5
    v_lshlrev_b32 v25, 2, v117
    s_lshl_b32 s43, s21, 12
    s_getpc_b64 s[4:5]
L_pc_6:
    s_add_u32 s4, s4, L_nocc_5-L_pc_6
    s_addc_u32 s5, s5, 0
    v_add_u32 v25, s43, v25
    v_min_u32 v25, L_code_end-L_nocc_5-4, v25
    global_load_dword v29, v25, s[4:5]
L_nocc_5:
L_chain_warm:
    s_add_u32 s43, s42, 0x10280
    s_add_u32 m0, s51, 0x1c000
    s_nop 0
    buffer_load_dwordx4 v10, s[12:15], s43 offen lds
    s_add_u32 s43, s42, 0x14280
    s_add_u32 m0, s51, 0x1d000
    s_nop 0
    buffer_load_dwordx4 v9, s[12:15], s43 offen lds
    s_add_u32 s43, s42, 0x18280
    s_add_u32 m0, s51, 0x1e000
    s_nop 0
    buffer_load_dwordx4 v10, s[12:15], s43 offen lds
    s_add_u32 s43, s42, 0x1c280
    s_add_u32 m0, s51, 0x1f000
    s_nop 0
    buffer_load_dwordx4 v9, s[12:15], s43 offen lds
    s_add_u32 s43, s42, 0x10080
    s_add_u32 m0, s51, 0x20000
    s_nop 0
    buffer_load_dwordx4 v10, s[12:15], s43 offen lds
    s_add_u32 s43, s42, 0x14080
    s_add_u32 m0, s51, 0x21000
    s_nop 0
    buffer_load_dwordx4 v9, s[12:15], s43 offen lds
    s_add_u32 s43, s42, 0x18080
    s_add_u32 m0, s51, 0x22000
    s_nop 0
    buffer_load_dwordx4 v10, s[12:15], s43 offen lds
    s_add_u32 s43, s42, 0x1c080
    s_add_u32 m0, s51, 0x23000
    s_nop 0
    buffer_load_dwordx4 v9, s[12:15], s43 offen lds
    ds_write_b128 v123, v[32:35]
    ds_write_b128 v123, v[36:39] offset:1024
    ds_write_b128 v123, v[40:43] offset:2048
    ds_write_b128 v123, v[44:47] offset:3072
    ds_write_b128 v123, v[48:51] offset:4096
    ds_write_b128 v123, v[52:55] offset:5120
    ds_write_b128 v123, v[56:59] offset:6144
    ds_write_b128 v123, v[60:63] offset:7168
    s_waitcnt vmcnt(12)
    s_barrier
    v_xor_b32 v13, 0x0, v11
    v_add_u32 v13, 0x8000, v13
    ds_read_b64_tr_b16 v[144:145], v13
    ds_read_b64_tr_b16 v[146:147], v13 offset:1024
    ds_read_b64_tr_b16 v[148:149], v13 offset:16384
    ds_read_b64_tr_b16 v[150:151], v13 offset:17408
    v_xor_b32 v13, 0x20, v11
    v_add_u32 v13, 0x8000, v13
    ds_read_b64_tr_b16 v[152:153], v13
    ds_read_b64_tr_b16 v[154:155], v13 offset:1024
    ds_read_b64_tr_b16 v[156:157], v13 offset:16384
    ds_read_b64_tr_b16 v[158:159], v13 offset:17408
    v_xor_b32 v13, 0x1000, v11
    v_add_u32 v13, 0x8000, v13
    ds_read_b64_tr_b16 v[176:177], v13
    ds_read_b64_tr_b16 v[178:179], v13 offset:1024
    ds_read_b64_tr_b16 v[180:181], v13 offset:16384
    ds_read_b64_tr_b16 v[182:183], v13 offset:17408
    v_xor_b32 v13, 0x1020, v11
    v_add_u32 v13, 0x8000, v13
    ds_read_b64_tr_b16 v[184:185], v13
    ds_read_b64_tr_b16 v[186:187], v13 offset:1024
    ds_read_b64_tr_b16 v[188:189], v13 offset:16384
    ds_read_b64_tr_b16 v[190:191], v13 offset:17408
    s_waitcnt lgkmcnt(0)
    s_barrier
    s_mov_b32 s43, 0x10000
    buffer_load_dword v30, v7, s[8:11], s43 offen sc1
    s_add_u32 s43, s42, 0x280
    s_add_u32 m0, s51, 0x24000
    s_nop 0
    buffer_load_dwordx4 v10, s[12:15], s43 offen lds
    s_add_u32 s43, s42, 0x4280
    s_add_u32 m0, s51, 0x25000
    s_nop 0
    buffer_load_dwordx4 v9, s[12:15], s43 offen lds
    s_add_u32 s43, s42, 0x8280
    s_add_u32 m0, s51, 0x26000
    s_nop 0
    buffer_load_dwordx4 v10, s[12:15], s43 offen lds
    s_add_u32 s43, s42, 0xc280
    s_add_u32 m0, s51, 0x27000
    s_nop 0
    buffer_load_dwordx4 v9, s[12:15], s43 offen lds
    v_lshlrev_b32 v26, 3, v117
    v_and_b32 v26, 2048, v26
    s_lshl_b32 s43, s20, 6
    s_add_u32 s43, s43, 0x2000
    buffer_load_dword v26, v26, s[8:11], s43 offen sc1
    buffer_load_dword v27, off, s[16:19], 0 offset:4 sc1
    ds_write_b128 v123, v[64:67] offset:32768
    ds_write_b128 v123, v[68:71] offset:33792
    ds_write_b128 v123, v[72:75] offset:34816
    ds_write_b128 v123, v[76:79] offset:35840
    ds_write_b128 v123, v[80:83] offset:36864
    ds_write_b128 v123, v[84:87] offset:37888
    ds_write_b128 v123, v[88:91] offset:38912
    ds_write_b128 v123, v[92:95] offset:39936
    s_waitcnt vmcnt(0)
    v_readlane_b32 s43, v26, 0
    v_readlane_b32 s40, v26, 16
    s_nop 0
    s_min_u32 s43, s43, s40
    s_cmp_lg_u32 s43, 0
    s_cselect_b32 s57, s57, 0
    v_readfirstlane_b32 s43, v27
    s_nop 0
    s_cmp_ge_u32 s43, 32
    s_cselect_b32 s57, s57, 0
    s_cmp_lg_u32 s57, 1
    s_cbranch_scc1 L_nokv_7
    s_add_u32 m0, s52, 8192
    s_nop 0
    buffer_load_dwordx4 v117, s[8:11], s30 offen lds
    buffer_load_dwordx4 v117, s[8:11], s30 offen offset:1024 lds
    s_add_u32 m0, s52, 0x6000
    s_nop 0
    buffer_load_dwordx4 v117, s[8:11], s31 offen lds
    buffer_load_dwordx4 v117, s[8:11], s31 offen offset:1024 lds
L_nokv_7:
    v_min_u32 v21, 0xfffffffe, v21
    s_mov_b32 s43, 0x10000
    s_mov_b64 exec, s[38:39]
    buffer_store_dword v21, v119, s[8:11], s43 offen
    s_mov_b64 exec, -1
    v_mov_b32 v16, -1
    v_mov_b32 v17, -1
    v_mov_b32 v18, -1
    v_mov_b32 v19, -1
    s_lshl_b32 s43, s20, 13
    s_add_u32 s43, s43, 0x100000
    s_and_b32 s40, s21, 1
    s_lshl_b32 s40, s40, 12
    s_add_u32 s29, s43, s40
    s_add_u32 s43, s43, s52
    s_xor_b32 s40, s43, 0x40000
    buffer_store_dwordx4 v[16:19], v117, s[8:11], s40 offen
    buffer_store_dwordx4 v[16:19], v117, s[8:11], s40 offen offset:1024
    s_mov_b32 s43, 0x12000
    buffer_store_dword v16, v119, s[8:11], s43 offen
    s_mov_b32 s43, 0x14000
    buffer_store_dword v16, v119, s[8:11], s43 offen
    s_mov_b32 s43, 0x16000
    buffer_store_dword v16, v119, s[8:11], s43 offen
    s_barrier
    v_xor_b32 v13, 0x0, v12
    v_add_u32 v13, 0x10000, v13
    ds_read_b64_tr_b16 v[32:33], v13
    ds_read_b64_tr_b16 v[34:35], v13 offset:512
    ds_read_b64_tr_b16 v[36:37], v13 offset:2048
    ds_read_b64_tr_b16 v[38:39], v13 offset:2560
    v_xor_b32 v13, 0x2000, v12
    v_add_u32 v13, 0x10000, v13
    ds_read_b64_tr_b16 v[40:41], v13
    ds_read_b64_tr_b16 v[42:43], v13 offset:512
    ds_read_b64_tr_b16 v[44:45], v13 offset:2048
    ds_read_b64_tr_b16 v[46:47], v13 offset:2560
    v_xor_b32 v13, 0x40, v12
    v_add_u32 v13, 0x10000, v13
    ds_read_b64_tr_b16 v[64:65], v13
    ds_read_b64_tr_b16 v[66:67], v13 offset:512
    ds_read_b64_tr_b16 v[68:69], v13 offset:2048
    ds_read_b64_tr_b16 v[70:71], v13 offset:2560
    v_xor_b32 v13, 0x2040, v12
    v_add_u32 v13, 0x10000, v13
    ds_read_b64_tr_b16 v[72:73], v13
    ds_read_b64_tr_b16 v[74:75], v13 offset:512
    ds_read_b64_tr_b16 v[76:77], v13 offset:2048
    ds_read_b64_tr_b16 v[78:79], v13 offset:2560
    v_xor_b32 v13, 0x0, v12
    v_add_u32 v13, 0x18000, v13
    ds_read_b64_tr_b16 v[48:49], v13
    ds_read_b64_tr_b16 v[50:51], v13 offset:512
    ds_read_b64_tr_b16 v[52:53], v13 offset:2048
    ds_read_b64_tr_b16 v[54:55], v13 offset:2560
    v_xor_b32 v13, 0x2000, v12
    v_add_u32 v13, 0x18000, v13
    ds_read_b64_tr_b16 v[56:57], v13
    ds_read_b64_tr_b16 v[58:59], v13 offset:512
    ds_read_b64_tr_b16 v[60:61], v13 offset:2048
    ds_read_b64_tr_b16 v[62:63], v13 offset:2560
    v_xor_b32 v13, 0x40, v12
    v_add_u32 v13, 0x18000, v13
    ds_read_b64_tr_b16 v[80:81], v13
    ds_read_b64_tr_b16 v[82:83], v13 offset:512
    ds_read_b64_tr_b16 v[84:85], v13 offset:2048
    ds_read_b64_tr_b16 v[86:87], v13 offset:2560
    v_xor_b32 v13, 0x2040, v12
    v_add_u32 v13, 0x18000, v13
    ds_read_b64_tr_b16 v[88:89], v13
    ds_read_b64_tr_b16 v[90:91], v13 offset:512
    ds_read_b64_tr_b16 v[92:93], v13 offset:2048
    ds_read_b64_tr_b16 v[94:95], v13 offset:2560
    s_waitcnt lgkmcnt(0)
    s_barrier
    ds_write_b128 v124, v[32:35]
    ds_write_b128 v124, v[36:39] offset:1024
    ds_write_b128 v124, v[40:43] offset:2048
    ds_write_b128 v124, v[44:47] offset:3072
    ds_write_b128 v124, v[48:51] offset:4096
    ds_write_b128 v124, v[52:55] offset:5120
    ds_write_b128 v124, v[56:59] offset:6144
    ds_write_b128 v124, v[60:63] offset:7168
    ds_write_b128 v124, v[64:67] offset:32768
    ds_write_b128 v124, v[68:71] offset:33792
    ds_write_b128 v124, v[72:75] offset:34816
    ds_write_b128 v124, v[76:79] offset:35840
    ds_write_b128 v124, v[80:83] offset:36864
    ds_write_b128 v124, v[84:87] offset:37888
    ds_write_b128 v124, v[88:91] offset:38912
    ds_write_b128 v124, v[92:95] offset:39936
    s_waitcnt lgkmcnt(0)
    s_cmp_eq_u32 s57, 1
    s_cbranch_scc1 L_started_8
    s_mov_b32 s96, 0
L_mode_9:
    buffer_load_dwordx2 v[2:3], off, s[92:95], 0 offset:36 sc1
    s_waitcnt vmcnt(0)
    v_readfirstlane_b32 s87, v2
    v_readfirstlane_b32 s97, v3
    s_nop 0
    s_min_u32 s97, s97, s87
    s_cmp_lg_u32 s97, 0
    s_cbranch_scc1 L_moded_10
    s_sleep 4
    s_add_u32 s96, s96, 1
    s_cmp_lg_u32 s96, 0x100
    s_cbranch_scc1 L_modef_11
    v_mov_b32 v2, 2
    v_mov_b32 v3, 0
    s_mov_b64 exec, 1
    buffer_atomic_cmpswap v[2:3], off, s[92:95], 0 offset:36
    s_mov_b64 exec, -1
L_modef_11:
    s_cmp_lt_u32 s96, 0x10000
    s_cbranch_scc1 L_mode_9
L_moded_10:
    s_cmp_lg_u32 s87, 1
    s_cbranch_scc1 L_fallback
    v_lshrrev_b32 v1, 4, v117
    v_and_b32 v2, 15, v1
    v_lshrrev_b32 v1, 4, v1
    v_lshlrev_b32 v1, 11, v1
    v_lshl_add_u32 v1, v2, 2, v1
    s_lshl_b32 s43, s20, 6
    s_add_u32 s43, s43, 0x2000
    s_mov_b32 exec_lo, 0x10001
    s_mov_b32 exec_hi, 0
    s_mov_b32 s96, 0
L_poll_12:
    buffer_load_dword v2, v1, s[8:11], s43 offen sc1
    s_waitcnt vmcnt(0)
    v_cmp_gt_u32 vcc, 1, v2
    s_cbranch_vccz L_polld_13
    s_sleep 8
    s_add_u32 s96, s96, 1
    s_cmp_lt_u32 s96, 0x10000
    s_cbranch_scc1 L_poll_12
L_polld_13:
    s_mov_b64 exec, -1
    s_add_u32 m0, s52, 8192
    s_nop 0
    buffer_load_dwordx4 v117, s[8:11], s30 offen lds
    buffer_load_dwordx4 v117, s[8:11], s30 offen offset:1024 lds
    s_add_u32 m0, s52, 0x6000
    s_nop 0
    buffer_load_dwordx4 v117, s[8:11], s31 offen lds
    buffer_load_dwordx4 v117, s[8:11], s31 offen offset:1024 lds
    s_mov_b32 s49, 0
L_cb_poll_15:
    buffer_load_dword v3, off, s[16:19], 0 offset:4 sc1
    s_waitcnt vmcnt(0)
    v_readfirstlane_b32 s43, v3
    s_nop 0
    s_cmp_ge_u32 s43, 32
    s_cbranch_scc1 L_started_8
    s_sleep 8
    s_add_u32 s49, s49, 1
    s_cmp_lt_u32 s49, 0x40000
    s_cbranch_scc1 L_cb_poll_15
L_started_8:
    s_lshr_b32 s43, s20, 1
    s_lshl_b32 s43, s43, 7
    s_and_b32 s40, s20, 1
    s_lshl_b32 s40, s40, 4
    s_add_u32 s43, s43, s40
    s_add_u32 s44, s43, 0x1000
    s_cmp_eq_u32 s21, 0
    s_cselect_b32 s44, s44, 0x7ff00000
    s_mov_b32 s22, 0
    s_mov_b32 s33, 0
    s_xor_b32 s53, s29, 1024
    s_add_u32 s23, s51, 0x10000
    s_add_u32 s48, s23, 4096
    s_mov_b32 s24, 0x12000
    s_add_u32 s55, s24, 16384
    s_mov_b32 s25, 0x100000
    s_mov_b32 s26, 0x101000
    v_mov_b32 v112, 0
    v_mov_b32 v113, 0
    v_mov_b32 v114, 0
    v_mov_b32 v115, 0
    s_add_u32 m0, s51, 4096
    ds_write_b128 v117, v[112:115] offset:22528
    ds_write_b128 v117, v[112:115] offset:23552
    s_cmp_lg_u32 s21, 0
    s_cselect_b32 s40, -1, 0
    v_mov_b32 v126, s40
    v_bfe_u32 v1, v117, 4, 1
    v_lshlrev_b32 v1, 4, v1
    s_movk_i32 s43, 0x3f80
    v_lshlrev_b32 v125, v1, s43
    v_bfe_u32 v1, v117, 5, 3
    v_cmp_eq_u32 s[68:69], 0, v1
    v_cmp_eq_u32 s[70:71], 1, v1
    v_cmp_eq_u32 s[72:73], 2, v1
    v_cmp_eq_u32 s[74:75], 3, v1
    v_lshrrev_b32 v1, 2, v117
    s_cmp_lt_u32 s21, 2
    s_cselect_b64 vcc, -1, 0
    v_cndmask_b32 v119, v119, v1, vcc
    v_mov_b32 v32, 0
    v_mov_b32 v33, 0
    v_mov_b32 v34, 0
    v_mov_b32 v35, 0
    v_mov_b32 v36, 0
    v_mov_b32 v37, 0
    v_mov_b32 v38, 0
    v_mov_b32 v39, 0
    v_mov_b32 v40, 0
    v_mov_b32 v41, 0
    v_mov_b32 v42, 0
    v_mov_b32 v43, 0
    v_mov_b32 v44, 0
    v_mov_b32 v45, 0
    v_mov_b32 v46, 0
    v_mov_b32 v47, 0
    v_mov_b32 v48, 0
    v_mov_b32 v49, 0
    v_mov_b32 v50, 0
    v_mov_b32 v51, 0
    v_mov_b32 v52, 0
    v_mov_b32 v53, 0
    v_mov_b32 v54, 0
    v_mov_b32 v55, 0
    s_add_u32 s30, s30, 0x40000
    s_add_u32 s31, s31, 0x40000
    s_mov_b32 s45, 0
    s_mov_b32 s46, 0
    s_mov_b32 s47, 0
    s_mov_b32 s76, 0
    s_and_b32 s43, s21, 1
    s_lshl_b32 s43, s43, 5
    s_add_u32 s43, s43, s20
    s_lshl_b32 s43, s43, 6
    s_add_u32 s28, s43, 0x2000
    s_mov_b32 s59, 0
    ds_read_b128 v[80:83], v123
    ds_read_b128 v[84:87], v123 offset:1024
    ds_read_b128 v[56:59], v123 offset:2048
    ds_read_b128 v[60:63], v123 offset:3072
    ds_read_b128 v[64:67], v123 offset:32768
    ds_read_b128 v[68:71], v123 offset:33792
    ds_read_b128 v[72:75], v123 offset:34816
    ds_read_b128 v[76:79], v123 offset:35840
    ds_read_b128 v[88:91], v123 offset:4096
    ds_read_b128 v[92:95], v123 offset:5120
    ds_read_b128 v[96:99], v123 offset:6144
    ds_read_b128 v[100:103], v123 offset:7168
    ds_read_b128 v[104:107], v123 offset:36864
    ds_read_b128 v[108:111], v123 offset:37888
    ds_read_b128 v[24:27], v123 offset:38912
    ds_read_b128 v[28:31], v123 offset:39936
    s_mov_b32 s49, 0
    s_waitcnt vmcnt(0) lgkmcnt(0)
    s_barrier
    s_waitcnt vmcnt(0) lgkmcnt(0)
    s_cmp_eq_u32 s21, 1
    s_cbranch_scc1 L_chain_top1_f
    s_cmp_eq_u32 s21, 2
    s_cbranch_scc1 L_chain_top2_f
    s_cmp_eq_u32 s21, 3
    s_cbranch_scc1 L_chain_top3_f
.p2align 6
L_chain_top0_f:
    buffer_load_dwordx4 v[0:3], v117, s[8:11], s23 offen nt
    v_mov_b32 v15, 0
    v_mov_b32 v15, 0
    v_mov_b32 v15, 0
    v_mov_b32 v15, 0
    v_mov_b32 v15, 0
    v_mov_b32 v15, 0
    v_mov_b32 v15, 0
    v_mov_b32 v15, 0
    v_mov_b32 v15, 0
    v_mov_b32 v15, 0
    v_mov_b32 v15, 0
    v_mov_b32 v15, 0
    v_mov_b32 v15, 0
    v_mov_b32 v15, 0
    v_mov_b32 v15, 0
    v_mov_b32 v15, 0
    buffer_load_dwordx4 v[0:3], v117, s[8:11], s23 offen sc1
    v_mov_b32 v15, 0
    v_mov_b32 v15, 0
    v_mov_b32 v15, 0
    v_mov_b32 v15, 0
    v_mov_b32 v15, 0
    v_mov_b32 v15, 0
    v_mov_b32 v15, 0
    v_mov_b32 v15, 0
    v_mov_b32 v15, 0
    v_mov_b32 v15, 0
    v_mov_b32 v15, 0
    v_mov_b32 v15, 0
    v_mov_b32 v15, 0
    v_mov_b32 v15, 0
    v_mov_b32 v15, 0
    v_mov_b32 v15, 0
L_mret_17:
    buffer_load_dwordx4 v[0:3], v117, s[8:11], s23 offen sc1
    s_add_u32 s45, s45, 1
    s_cmp_lt_u32 s45, 0x10000
    s_cselect_b32 s56, -2, -1
    s_nop 3
    v_mov_b32 v32, 0
    v_mov_b32 v33, 0
    v_mov_b32 v34, 0
    v_mov_b32 v35, 0
    s_waitcnt vmcnt(2)
    v_max3_u32 v15, v0, v1, v2
    v_max_u32 v15, v15, v3
    v_cmp_lt_u32 vcc, s56, v15
    v_smfmac_f32_16x16x64_bf16 v[32:35], v[0:3], v[80:87], v116
    s_cbranch_vccnz L_mret_17
    ds_write_b128 v117, v[0:3]
    v_smfmac_f32_16x16x64_bf16 v[36:39], v[0:3], v[56:63], v116
    buffer_load_dwordx4 v[4:7], v117, s[8:11], s48 offen nt
    v_smfmac_f32_16x16x64_bf16 v[40:43], v[0:3], v[64:71], v116
    buffer_load_dwordx4 v117, s[8:11], s48 offen nt lds
    s_mov_b32 m0, 8192
    v_smfmac_f32_16x16x64_bf16 v[44:47], v[0:3], v[72:79], v116
    s_waitcnt lgkmcnt(0)
    s_barrier
    ds_read_b128 v[8:11], v117 offset:1024
    v_smfmac_f32_16x16x64_bf16 v[48:51], v[0:3], a[192:199], v116
    ds_read_b128 v[16:19], v117 offset:2048
    ds_read_b128 v[20:23], v117 offset:3072
    v_smfmac_f32_16x16x64_bf16 v[52:55], v[0:3], a[200:207], v116
    ds_read_b128 v[80:83], v117 offset:14336
    s_waitcnt lgkmcnt(3)
    v_smfmac_f32_16x16x64_bf16 v[32:35], v[8:11], a[0:7], v116
    ds_read_b128 v[84:87], v117 offset:15360
    v_smfmac_f32_16x16x64_bf16 v[36:39], v[8:11], a[8:15], v116
    buffer_store_dwordx4 v[112:115], v117, s[8:11], s32 offen sc1
    s_waitcnt lgkmcnt(3)
    v_smfmac_f32_16x16x64_bf16 v[32:35], v[16:19], a[32:39], v116
    ds_read_b128 v[56:59], v117 offset:8192
    v_smfmac_f32_16x16x64_bf16 v[36:39], v[16:19], a[40:47], v116
    ds_read_b128 v[60:63], v117 offset:9216
    s_waitcnt lgkmcnt(4)
    v_smfmac_f32_16x16x64_bf16 v[32:35], v[20:23], a[64:71], v116
    ds_read_b128 v[64:67], v117 offset:10240
    v_smfmac_f32_16x16x64_bf16 v[36:39], v[20:23], a[72:79], v116
    ds_read_b128 v[68:71], v117 offset:11264
    v_smfmac_f32_16x16x64_bf16 v[40:43], v[8:11], a[96:103], v116
    ds_read_b128 v[72:75], v117 offset:12288
    v_smfmac_f32_16x16x64_bf16 v[40:43], v[16:19], a[128:135], v116
    ds_read_b128 v[76:79], v117 offset:13312
    v_smfmac_f32_16x16x64_bf16 v[40:43], v[20:23], a[160:167], v116
    s_waitcnt vmcnt(2)
    v_max3_u32 v15, v4, v5, v6
    v_smfmac_f32_16x16x64_bf16 v[44:47], v[8:11], a[104:111], v116
    v_max_u32 v15, v15, v7
    v_smfmac_f32_16x16x64_bf16 v[44:47], v[16:19], a[136:143], v116
    s_waitcnt vmcnt(1) lgkmcnt(0)
    v_cmp_lt_u32 vcc, s56, v15
    v_smfmac_f32_16x16x64_bf16 v[44:47], v[20:23], a[168:175], v116
    s_cbranch_vccnz L_mret_18
L_mgo_19:
    v_smfmac_f32_16x16x64_bf16 v[44:47], v[4:7], v[24:31], v116
    s_barrier
    ds_read_b128 v[12:15], v117 offset:5120
    v_smfmac_f32_16x16x64_bf16 v[32:35], v[4:7], v[88:95], v116
    ds_read_b128 v[24:27], v117 offset:6144
    v_smfmac_f32_16x16x64_bf16 v[36:39], v[4:7], v[96:103], v116
    ds_read_b128 v[28:31], v117 offset:7168
    v_smfmac_f32_16x16x64_bf16 v[40:43], v[4:7], v[104:111], v116
    ds_read_b128 v[88:91], v117 offset:24576
    s_waitcnt lgkmcnt(3)
    v_smfmac_f32_16x16x64_bf16 v[32:35], v[12:15], a[16:23], v116
    ds_read_b128 v[92:95], v117 offset:25600
    s_waitcnt lgkmcnt(3)
    v_smfmac_f32_16x16x64_bf16 v[32:35], v[24:27], a[48:55], v116
    buffer_load_dwordx4 v117, s[8:11], s30 offen lds
    s_waitcnt lgkmcnt(2)
    v_smfmac_f32_16x16x64_bf16 v[32:35], v[28:31], a[80:87], v116
    ds_read_b128 v[96:99], v117 offset:23552
    v_smfmac_f32_16x16x64_bf16 v[36:39], v[12:15], a[24:31], v116
    ds_read_b128 v[100:103], v117 offset:23552
    v_smfmac_f32_16x16x64_bf16 v[36:39], v[24:27], a[56:63], v116
    buffer_load_dwordx4 v117, s[8:11], s30 offen offset:1024 lds
    s_add_u32 m0, s52, 0x6000
    v_add_f32 v32, v32, v34
    v_smfmac_f32_16x16x64_bf16 v[36:39], v[28:31], a[88:95], v116
    ds_read_b128 v[104:107], v117 offset:23552
    v_add_f32 v33, v33, v35
    v_smfmac_f32_16x16x64_bf16 v[40:43], v[12:15], a[112:119], v116
    ds_read_b128 v[108:111], v117 offset:23552
    v_mul_f32 v32, s34, v32
    v_smfmac_f32_16x16x64_bf16 v[40:43], v[24:27], a[144:151], v116
    buffer_load_dword v125, v119, s[8:11], s28 offen sc1
    v_mul_f32 v33, s34, v33
    v_smfmac_f32_16x16x64_bf16 v[40:43], v[28:31], a[176:183], v116
    ds_read_b128 v[0:3], v124
    v_add_f32 v36, v36, v38
    v_smfmac_f32_16x16x64_bf16 v[48:51], v[4:7], a[208:215], v116
    v_add_f32 v37, v37, v39
    v_smfmac_f32_16x16x64_bf16 v[52:55], v[4:7], a[216:223], v116
    s_waitcnt lgkmcnt(5)
    buffer_load_dwordx4 v117, s[8:11], s31 offen lds
    v_mul_f32 v36, s34, v36
    v_smfmac_f32_16x16x64_bf16 v[44:47], v[12:15], a[120:127], v116
    ds_read_b128 v[4:7], v124 offset:1024
    v_mul_f32 v37, s34, v37
    v_smfmac_f32_16x16x64_bf16 v[44:47], v[24:27], a[152:159], v116
    v_cvt_pk_bf16_f32 v34, v32, v36
    v_smfmac_f32_16x16x64_bf16 v[44:47], v[28:31], a[184:191], v116
    buffer_load_dwordx4 v117, s[8:11], s31 offen offset:1024 lds
    s_mov_b32 m0, 4096
    v_cvt_pk_bf16_f32 v35, v33, v37
    v_add_f32 v40, v40, v42
    v_smfmac_f32_16x16x64_bf16 v[48:51], v[8:11], a[224:231], v116
    ds_write2_b32 v120, v34, v35 offset0:32 offset1:48
    v_add_f32 v41, v41, v43
    v_smfmac_f32_16x16x64_bf16 v[52:55], v[8:11], a[232:239], v116
    v_add_f32 v44, v44, v46
    v_add_f32 v45, v45, v47
    v_cvt_pk_bf16_f32 v113, v40, v44
    v_cvt_pk_bf16_f32 v115, v41, v45
    v_smfmac_f32_16x16x64_bf16 v[48:51], v[12:15], a[240:247], v116
    ds_write2_b32 v120, v113, v115 offset0:0 offset1:16
    v_smfmac_f32_16x16x64_bf16 v[52:55], v[12:15], a[248:255], v116
    s_cmp_eq_u32 s22, 63
    s_cbranch_scc1 L_chain_last_f
    buffer_store_dword v126, off, s[8:11], s44 sc1
    v_smfmac_f32_16x16x64_bf16 v[48:51], v[16:19], v[128:135], v116
    v_smfmac_f32_16x16x64_bf16 v[48:51], v[20:23], v[160:167], v116
    v_smfmac_f32_16x16x64_bf16 v[48:51], v[24:27], v[144:151], v116
    s_waitcnt lgkmcnt(0)
    s_barrier
    v_smfmac_f32_16x16x64_bf16 v[48:51], v[28:31], v[176:183], v116
    ds_read_b128 v[32:35], v121 offset:16384
    ds_read_b128 v[36:39], v121 offset:17408
    v_smfmac_f32_16x16x64_bf16 v[52:55], v[16:19], v[136:143], v116
    ds_read_b128 v[40:43], v121 offset:18432
    ds_read_b128 v[44:47], v121 offset:19456
    v_smfmac_f32_16x16x64_bf16 v[52:55], v[20:23], v[168:175], v116
    ds_read_b128 v[8:11], v124 offset:32768
    v_add_f32 v48, v48, v50
    v_smfmac_f32_16x16x64_bf16 v[52:55], v[24:27], v[152:159], v116
    ds_read_b128 v[12:15], v124 offset:33792
    v_add_f32 v49, v49, v51
    v_smfmac_f32_16x16x64_bf16 v[52:55], v[28:31], v[184:191], v116
    s_waitcnt lgkmcnt(5)
    v_cvt_pk_bf16_f32 v112, v48, v49
    v_mfma_f32_16x16x32_bf16 v[56:59], v[56:59], v[32:35], 0
    s_waitcnt lgkmcnt(4)
    v_mov_b32 v48, s50
    v_mov_b32 v49, s50
    v_mfma_f32_16x16x32_bf16 v[56:59], v[60:63], v[36:39], v[56:59]
    ds_read_b128 v[16:19], v124 offset:2048
    s_waitcnt lgkmcnt(4)
    v_mov_b32 v50, s50
    v_mov_b32 v51, s50
    v_mfma_f32_16x16x32_bf16 v[56:59], v[64:67], v[40:43], v[56:59]
    ds_read_b128 v[20:23], v124 offset:3072
    s_waitcnt lgkmcnt(4)
    v_add_f32 v52, v52, v54
    v_mfma_f32_16x16x32_bf16 v[56:59], v[68:71], v[44:47], v[56:59]
    ds_read_b128 v[24:27], v124 offset:4096
    v_add_f32 v53, v53, v55
    v_mfma_f32_16x16x32_bf16 v[60:63], v[72:75], v[32:35], 0
    ds_read_b128 v[28:31], v124 offset:5120
    v_cvt_pk_bf16_f32 v114, v52, v53
    v_mov_b32 v53, 0
    v_mfma_f32_16x16x32_bf16 v[60:63], v[76:79], v[36:39], v[60:63]
    v_exp_f32 v56, v56
    v_mfma_f32_16x16x32_bf16 v[60:63], v[80:83], v[40:43], v[60:63]
    v_exp_f32 v57, v57
    v_mfma_f32_16x16x32_bf16 v[60:63], v[84:87], v[44:47], v[60:63]
    v_exp_f32 v58, v58
    v_mfma_f32_16x16x32_bf16 v[64:67], v[32:35], v[32:35], 0
    v_exp_f32 v59, v59
    v_cvt_pk_bf16_f32 v68, v56, v57
    v_mfma_f32_16x16x32_bf16 v[64:67], v[36:39], v[36:39], v[64:67]
    v_exp_f32 v60, v60
    v_cvt_pk_bf16_f32 v69, v58, v59
    v_mfma_f32_16x16x32_bf16 v[64:67], v[40:43], v[40:43], v[64:67]
    v_exp_f32 v61, v61
    v_mfma_f32_16x16x32_bf16 v[64:67], v[44:47], v[44:47], v[64:67]
    v_exp_f32 v62, v62
    v_exp_f32 v63, v63
    v_cvt_pk_bf16_f32 v70, v60, v61
    v_cvt_pk_bf16_f32 v71, v62, v63
    s_nop 1
    v_mfma_f32_16x16x32_bf16 v[72:75], v[88:91], v[68:71], 0
    s_nop 0
    v_exp_f32 v64, v64
    v_mfma_f32_16x16x32_bf16 v[76:79], v[92:95], v[68:71], 0
    v_exp_f32 v65, v65
    v_mfma_f32_16x16x32_bf16 v[80:83], v[48:51], v[68:71], 0
    v_cvt_pk_bf16_f32 v52, v64, v65
    s_nop 1
    v_mfma_f32_16x16x16_bf16 v[72:75], v[112:113], v[52:53], v[72:75]
    ds_read_b128 v[32:35], v124 offset:6144
    v_mfma_f32_16x16x16_bf16 v[76:79], v[114:115], v[52:53], v[76:79]
    ds_read_b128 v[36:39], v124 offset:7168
    v_mfma_f32_16x16x16_bf16 v[80:83], v[48:49], v[52:53], v[80:83]
L_norm_20:
    s_mov_b64 vcc, s[36:37]
    v_mov_b32 v122, v122
    v_mov_b32 v122, v122
    v_mov_b32 v122, v122
    v_cndmask_b32_dpp v76, v72, v76, vcc quad_perm:[2,3,2,3] row_mask:0xf bank_mask:0xf
    v_cndmask_b32_dpp v77, v73, v77, vcc quad_perm:[2,3,2,3] row_mask:0xf bank_mask:0xf
    v_cndmask_b32_dpp v78, v74, v78, vcc quad_perm:[2,3,2,3] row_mask:0xf bank_mask:0xf
    v_cndmask_b32_dpp v79, v75, v79, vcc quad_perm:[2,3,2,3] row_mask:0xf bank_mask:0xf
    v_rcp_f32_dpp v84, v80 quad_perm:[2,3,2,3] row_mask:0xf bank_mask:0xf
    s_nop 0
    v_pk_mul_f32 v[76:77], v[76:77], v[84:85] op_sel_hi:[1,0]
    v_pk_mul_f32 v[78:79], v[78:79], v[84:85] op_sel_hi:[1,0]
    v_cvt_pk_bf16_f32 v72, v76, v77
    v_cvt_pk_bf16_f32 v73, v78, v79
    ds_write_b64 v122, v[72:73] offset:20480
    v_max_f32_dpp v86, v80, v84 quad_perm:[2,3,2,3] row_mask:0xf bank_mask:0xf
    v_mov_b32_dpp v60, v72 quad_perm:[0,1,0,1] row_mask:0xf bank_mask:0xf
    v_mov_b32_dpp v61, v73 quad_perm:[0,1,0,1] row_mask:0xf bank_mask:0xf
    v_cmp_lt_f32 vcc, s35, v86
    v_mov_b32_dpp v62, v72 quad_perm:[2,3,2,3] row_mask:0xf bank_mask:0xf
    v_mov_b32_dpp v63, v73 quad_perm:[2,3,2,3] row_mask:0xf bank_mask:0xf
    s_nop 1
    v_smfmac_f32_16x16x64_bf16 v[96:99], v[60:63], v[192:199], v116
    s_cbranch_vccnz L_smax_21
    v_smfmac_f32_16x16x64_bf16 v[100:103], v[60:63], v[224:231], v116
    s_waitcnt lgkmcnt(0)
    s_barrier
    ds_read_b128 v[92:95], v127 offset:20992
    ds_read_b128 v[80:83], v127 offset:21504
    ds_read_b128 v[84:87], v127 offset:22016
    v_smfmac_f32_16x16x64_bf16 v[104:107], v[60:63], v[0:7], v116
    ds_read_b128 v[40:43], v124 offset:34816
    v_smfmac_f32_16x16x64_bf16 v[108:111], v[60:63], v[8:15], v116
    ds_read_b128 v[56:59], v124 offset:36864
    s_waitcnt lgkmcnt(4)
    v_smfmac_f32_16x16x64_bf16 v[96:99], v[92:95], v[200:207], v116
    s_waitcnt lgkmcnt(3)
    v_smfmac_f32_16x16x64_bf16 v[96:99], v[80:83], v[208:215], v116
    ds_read_b128 v[44:47], v124 offset:35840
    s_waitcnt lgkmcnt(3)
    v_smfmac_f32_16x16x64_bf16 v[96:99], v[84:87], v[216:223], v116
    ds_read_b128 v[68:71], v124 offset:39936
    v_smfmac_f32_16x16x64_bf16 v[100:103], v[92:95], v[232:239], v116
    ds_read_b128 v[64:67], v124 offset:38912
    v_smfmac_f32_16x16x64_bf16 v[100:103], v[80:83], v[240:247], v116
    ds_read_b128 v[60:63], v124 offset:37888
    v_cvt_pk_bf16_f32 v72, v96, v98
    v_smfmac_f32_16x16x64_bf16 v[100:103], v[84:87], v[248:255], v116
    v_and_or_b32 v72, v72, -2, s33
    v_smfmac_f32_16x16x64_bf16 v[104:107], v[92:95], v[16:23], v116
    v_cvt_pk_bf16_f32 v74, v97, v99
    v_smfmac_f32_16x16x64_bf16 v[104:107], v[80:83], v[24:31], v116
    v_cvt_pk_bf16_f32 v73, v100, v102
    v_cvt_pk_bf16_f32 v75, v101, v103
    v_smfmac_f32_16x16x64_bf16 v[104:107], v[84:87], v[32:39], v116
    buffer_store_dwordx4 v[72:75], v118, s[8:11], s25 offen
    s_waitcnt lgkmcnt(3)
    v_smfmac_f32_16x16x64_bf16 v[108:111], v[92:95], v[40:47], v116
    s_waitcnt lgkmcnt(0)
    v_smfmac_f32_16x16x64_bf16 v[108:111], v[80:83], v[56:63], v116
    v_cvt_pk_bf16_f32 v76, v104, v106
    v_smfmac_f32_16x16x64_bf16 v[108:111], v[84:87], v[64:71], v116
    v_and_or_b32 v76, v76, -2, s33
    v_cvt_pk_bf16_f32 v78, v105, v107
    v_mov_b32 v122, v122
    v_mov_b32 v122, v122
    v_mov_b32 v122, v122
    v_mov_b32 v122, v122
    v_mov_b32 v122, v122
    v_mov_b32 v122, v122
    v_cvt_pk_bf16_f32 v77, v108, v110
    v_cvt_pk_bf16_f32 v79, v109, v111
    buffer_store_dwordx4 v[76:79], v118, s[8:11], s26 offen
    s_add_u32 s30, s30, 0x40000
    s_add_u32 s31, s31, 0x40000
    s_add_u32 s32, s32, 0x20000
    s_add_u32 s23, s24, 0
    s_add_u32 s48, s23, 4096
    s_xor_b32 s25, s25, 0x40000
    s_xor_b32 s26, s26, 0x40000
    s_mov_b32 s35, 0x49800000
    v_mov_b32 v126, s22
    s_add_u32 s22, s22, 1
    v_mov_b32 v32, 0
    v_mov_b32 v33, 0
    v_mov_b32 v34, 0
    v_mov_b32 v35, 0
    v_mov_b32 v36, 0
    v_mov_b32 v37, 0
    v_mov_b32 v38, 0
    v_mov_b32 v39, 0
    v_mov_b32 v40, 0
    v_mov_b32 v41, 0
    v_mov_b32 v42, 0
    v_mov_b32 v43, 0
    v_mov_b32 v44, 0
    v_mov_b32 v45, 0
    v_mov_b32 v46, 0
    v_mov_b32 v47, 0
    v_mov_b32 v48, 0
    v_mov_b32 v49, 0
    v_mov_b32 v50, 0
    v_mov_b32 v51, 0
    v_mov_b32 v52, 0
    v_mov_b32 v53, 0
    v_mov_b32 v54, 0
    v_mov_b32 v55, 0
    ds_read_b128 v[80:83], v123
    ds_read_b128 v[84:87], v123 offset:1024
    ds_read_b128 v[56:59], v123 offset:2048
    ds_read_b128 v[60:63], v123 offset:3072
    ds_read_b128 v[64:67], v123 offset:32768
    ds_read_b128 v[68:71], v123 offset:33792
    ds_read_b128 v[72:75], v123 offset:34816
    ds_read_b128 v[76:79], v123 offset:35840
    ds_read_b128 v[88:91], v123 offset:4096
    ds_read_b128 v[92:95], v123 offset:5120
    ds_read_b128 v[96:99], v123 offset:6144
    ds_read_b128 v[100:103], v123 offset:7168
    ds_read_b128 v[104:107], v123 offset:36864
    ds_read_b128 v[108:111], v123 offset:37888
    ds_read_b128 v[24:27], v123 offset:38912
    ds_read_b128 v[28:31], v123 offset:39936
    s_add_u32 s24, s24, 8192
    s_bitset0_b32 s24, 15
    s_xor_b32 s55, s24, 16384
    s_xor_b32 s29, s29, 0x40000
    s_xor_b32 s53, s29, 1024
    s_bfe_u32 s33, s22, 0x10001
    s_add_u32 s40, s22, 5
    s_lshr_b32 s40, s40, 2
    s_min_u32 s40, s40, 16
    s_bfm_b32 s58, s40, 0
    s_waitcnt vmcnt(5)
    v_cmp_eq_u32 vcc, 0, v125
    s_nop 0
    s_and_b64 vcc, vcc, s[58:59]
    s_cbranch_scc1 L_kvw_22
L_kvb_23:
    v_mov_b32 v15, 0
    s_nop 2
    v_mov_b32 v15, 0
    s_nop 2
    v_mov_b32 v15, 0
    s_nop 2
    v_mov_b32 v15, 0
    s_nop 2
    v_mov_b32 v15, 0
    s_nop 2
    v_mov_b32 v15, 0
    s_nop 2
    v_mov_b32 v15, 0
    s_nop 2
    v_mov_b32 v15, 0
    s_nop 2
    v_mov_b32 v15, 0
    s_nop 2
    v_mov_b32 v15, 0
    s_nop 2
    v_mov_b32 v15, 0
    s_nop 2
    v_mov_b32 v15, 0
    s_nop 2
    v_mov_b32 v15, 0
    s_nop 2
    v_mov_b32 v15, 0
    s_nop 2
    v_mov_b32 v15, 0
    s_nop 2
    v_mov_b32 v15, 0
    s_nop 2
    v_mov_b32 v15, 0
    s_nop 2
    v_mov_b32 v15, 0
    s_nop 2
    v_mov_b32 v15, 0
    s_nop 2
    v_mov_b32 v15, 0
    s_nop 2
    v_mov_b32 v15, 0
    s_nop 2
    v_mov_b32 v15, 0
    s_nop 2
    v_mov_b32 v15, 0
    s_nop 2
    v_mov_b32 v15, 0
    s_nop 2
    v_mov_b32 v15, 0
    s_nop 2
    v_mov_b32 v15, 0
    s_nop 2
    v_mov_b32 v15, 0
    s_nop 2
    v_mov_b32 v15, 0
    s_nop 2
    v_mov_b32 v15, 0
    s_nop 2
    v_mov_b32 v15, 0
    s_nop 2
    v_mov_b32 v15, 0
    s_nop 2
    s_waitcnt lgkmcnt(0)
    s_branch L_chain_top0_f
.p2align 6
L_chain_top1_f:
    buffer_load_dwordx4 v[0:3], v117, s[8:11], s23 offen nt
    v_mov_b32 v15, 0
    v_mov_b32 v15, 0
    v_mov_b32 v15, 0
    v_mov_b32 v15, 0
    v_mov_b32 v15, 0
    v_mov_b32 v15, 0
    v_mov_b32 v15, 0
    v_mov_b32 v15, 0
    v_mov_b32 v15, 0
    v_mov_b32 v15, 0
    v_mov_b32 v15, 0
    v_mov_b32 v15, 0
    v_mov_b32 v15, 0
    v_mov_b32 v15, 0
    v_mov_b32 v15, 0
    v_mov_b32 v15, 0
    buffer_load_dwordx4 v[0:3], v117, s[8:11], s23 offen sc1
    v_mov_b32 v15, 0
    v_mov_b32 v15, 0
    v_mov_b32 v15, 0
    v_mov_b32 v15, 0
    v_mov_b32 v15, 0
    v_mov_b32 v15, 0
    v_mov_b32 v15, 0
    v_mov_b32 v15, 0
    v_mov_b32 v15, 0
    v_mov_b32 v15, 0
    v_mov_b32 v15, 0
    v_mov_b32 v15, 0
    v_mov_b32 v15, 0
    v_mov_b32 v15, 0
    v_mov_b32 v15, 0
    v_mov_b32 v15, 0
L_mret_24:
    buffer_load_dwordx4 v[0:3], v117, s[8:11], s23 offen sc1
    s_add_u32 s45, s45, 1
    s_cmp_lt_u32 s45, 0x10000
    s_cselect_b32 s56, -2, -1
    s_nop 3
    v_mov_b32 v32, 0
    v_mov_b32 v33, 0
    v_mov_b32 v34, 0
    v_mov_b32 v35, 0
    s_waitcnt vmcnt(2)
    v_max3_u32 v15, v0, v1, v2
    v_max_u32 v15, v15, v3
    v_cmp_lt_u32 vcc, s56, v15
    v_smfmac_f32_16x16x64_bf16 v[32:35], v[0:3], v[80:87], v116
    s_cbranch_vccnz L_mret_24
    ds_write_b128 v117, v[0:3] offset:1024
    v_smfmac_f32_16x16x64_bf16 v[36:39], v[0:3], v[56:63], v116
    buffer_load_dwordx4 v[4:7], v117, s[8:11], s48 offen nt
    v_smfmac_f32_16x16x64_bf16 v[40:43], v[0:3], v[64:71], v116
    buffer_load_dwordx4 v117, s[8:11], s48 offen nt lds
    s_mov_b32 m0, 10240
    v_smfmac_f32_16x16x64_bf16 v[44:47], v[0:3], v[72:79], v116
    s_waitcnt lgkmcnt(0)
    s_barrier
    ds_read_b128 v[8:11], v117
    v_smfmac_f32_16x16x64_bf16 v[48:51], v[0:3], a[192:199], v116
    ds_read_b128 v[16:19], v117 offset:3072
    ds_read_b128 v[20:23], v117 offset:2048
    v_smfmac_f32_16x16x64_bf16 v[52:55], v[0:3], a[200:207], v116
    ds_read_b128 v[80:83], v117 offset:14336
    s_waitcnt lgkmcnt(3)
    v_smfmac_f32_16x16x64_bf16 v[32:35], v[8:11], a[0:7], v116
    ds_read_b128 v[84:87], v117 offset:15360
    v_smfmac_f32_16x16x64_bf16 v[36:39], v[8:11], a[8:15], v116
    ds_read_b128 v[56:59], v117 offset:8192
    s_waitcnt lgkmcnt(4)
    v_smfmac_f32_16x16x64_bf16 v[32:35], v[16:19], a[32:39], v116
    ds_read_b128 v[60:63], v117 offset:9216
    v_smfmac_f32_16x16x64_bf16 v[36:39], v[16:19], a[40:47], v116
    buffer_store_dwordx4 v[112:115], v117, s[8:11], s32 offen sc1
    s_waitcnt lgkmcnt(4)
    v_smfmac_f32_16x16x64_bf16 v[32:35], v[20:23], a[64:71], v116
    ds_read_b128 v[64:67], v117 offset:10240
    v_smfmac_f32_16x16x64_bf16 v[36:39], v[20:23], a[72:79], v116
    ds_read_b128 v[68:71], v117 offset:11264
    v_smfmac_f32_16x16x64_bf16 v[40:43], v[8:11], a[96:103], v116
    ds_read_b128 v[72:75], v117 offset:12288
    v_smfmac_f32_16x16x64_bf16 v[40:43], v[16:19], a[128:135], v116
    ds_read_b128 v[76:79], v117 offset:13312
    v_smfmac_f32_16x16x64_bf16 v[40:43], v[20:23], a[160:167], v116
    s_waitcnt vmcnt(2)
    v_max3_u32 v15, v4, v5, v6
    v_smfmac_f32_16x16x64_bf16 v[44:47], v[8:11], a[104:111], v116
    v_max_u32 v15, v15, v7
    v_smfmac_f32_16x16x64_bf16 v[44:47], v[16:19], a[136:143], v116
    s_waitcnt vmcnt(1) lgkmcnt(0)
    v_cmp_lt_u32 vcc, s56, v15
    v_smfmac_f32_16x16x64_bf16 v[44:47], v[20:23], a[168:175], v116
    s_cbranch_vccnz L_mret_25
L_mgo_26:
    v_smfmac_f32_16x16x64_bf16 v[44:47], v[4:7], v[24:31], v116
    s_barrier
    ds_read_b128 v[12:15], v117 offset:4096
    v_smfmac_f32_16x16x64_bf16 v[32:35], v[4:7], v[88:95], v116
    ds_read_b128 v[24:27], v117 offset:7168
    v_smfmac_f32_16x16x64_bf16 v[36:39], v[4:7], v[96:103], v116
    ds_read_b128 v[28:31], v117 offset:6144
    v_smfmac_f32_16x16x64_bf16 v[40:43], v[4:7], v[104:111], v116
    ds_read_b128 v[88:91], v117 offset:26624
    s_waitcnt lgkmcnt(3)
    v_smfmac_f32_16x16x64_bf16 v[32:35], v[12:15], a[16:23], v116
    ds_read_b128 v[92:95], v117 offset:27648
    s_waitcnt lgkmcnt(3)
    v_smfmac_f32_16x16x64_bf16 v[32:35], v[24:27], a[48:55], v116
    buffer_load_dwordx4 v117, s[8:11], s30 offen lds
    s_waitcnt lgkmcnt(2)
    v_smfmac_f32_16x16x64_bf16 v[32:35], v[28:31], a[80:87], v116
    ds_read_b128 v[96:99], v117 offset:23552
    v_smfmac_f32_16x16x64_bf16 v[36:39], v[12:15], a[24:31], v116
    ds_read_b128 v[100:103], v117 offset:23552
    v_smfmac_f32_16x16x64_bf16 v[36:39], v[24:27], a[56:63], v116
    buffer_load_dwordx4 v117, s[8:11], s30 offen offset:1024 lds
    s_add_u32 m0, s52, 0x6000
    v_add_f32 v32, v32, v34
    v_smfmac_f32_16x16x64_bf16 v[36:39], v[28:31], a[88:95], v116
    ds_read_b128 v[104:107], v117 offset:23552
    v_add_f32 v33, v33, v35
    v_smfmac_f32_16x16x64_bf16 v[40:43], v[12:15], a[112:119], v116
    ds_read_b128 v[108:111], v117 offset:23552
    v_mul_f32 v32, s34, v32
    v_smfmac_f32_16x16x64_bf16 v[40:43], v[24:27], a[144:151], v116
    buffer_load_dword v125, v119, s[8:11], s28 offen sc1
    v_mul_f32 v33, s34, v33
    v_smfmac_f32_16x16x64_bf16 v[40:43], v[28:31], a[176:183], v116
    ds_read_b128 v[0:3], v124
    v_add_f32 v36, v36, v38
    v_smfmac_f32_16x16x64_bf16 v[48:51], v[4:7], a[208:215], v116
    v_add_f32 v37, v37, v39
    v_smfmac_f32_16x16x64_bf16 v[52:55], v[4:7], a[216:223], v116
    s_waitcnt lgkmcnt(5)
    buffer_load_dwordx4 v117, s[8:11], s31 offen lds
    v_mul_f32 v36, s34, v36
    v_smfmac_f32_16x16x64_bf16 v[44:47], v[12:15], a[120:127], v116
    ds_read_b128 v[4:7], v124 offset:1024
    v_mul_f32 v37, s34, v37
    v_smfmac_f32_16x16x64_bf16 v[44:47], v[24:27], a[152:159], v116
    v_cvt_pk_bf16_f32 v34, v32, v36
    v_smfmac_f32_16x16x64_bf16 v[44:47], v[28:31], a[184:191], v116
    buffer_load_dwordx4 v117, s[8:11], s31 offen offset:1024 lds
    s_mov_b32 m0, 5120
    v_cvt_pk_bf16_f32 v35, v33, v37
    v_add_f32 v40, v40, v42
    v_smfmac_f32_16x16x64_bf16 v[48:51], v[8:11], a[224:231], v116
    ds_write2_b32 v120, v34, v35 offset0:32 offset1:48
    v_add_f32 v41, v41, v43
    v_smfmac_f32_16x16x64_bf16 v[52:55], v[8:11], a[232:239], v116
    v_add_f32 v44, v44, v46
    v_add_f32 v45, v45, v47
    v_cvt_pk_bf16_f32 v113, v40, v44
    v_cvt_pk_bf16_f32 v115, v41, v45
    v_smfmac_f32_16x16x64_bf16 v[48:51], v[12:15], a[240:247], v116
    ds_write2_b32 v120, v113, v115 offset0:0 offset1:16
    v_smfmac_f32_16x16x64_bf16 v[52:55], v[12:15], a[248:255], v116
    s_cmp_eq_u32 s22, 63
    s_cbranch_scc1 L_chain_last_f
    v_smfmac_f32_16x16x64_bf16 v[48:51], v[16:19], v[128:135], v116
    v_smfmac_f32_16x16x64_bf16 v[48:51], v[20:23], v[160:167], v116
    v_smfmac_f32_16x16x64_bf16 v[48:51], v[24:27], v[144:151], v116
    s_waitcnt lgkmcnt(0)
    s_barrier
    v_smfmac_f32_16x16x64_bf16 v[48:51], v[28:31], v[176:183], v116
    ds_read_b128 v[32:35], v121 offset:16384
    ds_read_b128 v[36:39], v121 offset:17408
    v_smfmac_f32_16x16x64_bf16 v[52:55], v[16:19], v[136:143], v116
    ds_read_b128 v[40:43], v121 offset:18432
    ds_read_b128 v[44:47], v121 offset:19456
    v_smfmac_f32_16x16x64_bf16 v[52:55], v[20:23], v[168:175], v116
    ds_read_b128 v[8:11], v124 offset:32768
    v_add_f32 v48, v48, v50
    v_smfmac_f32_16x16x64_bf16 v[52:55], v[24:27], v[152:159], v116
    ds_read_b128 v[12:15], v124 offset:33792
    v_add_f32 v49, v49, v51
    v_smfmac_f32_16x16x64_bf16 v[52:55], v[28:31], v[184:191], v116
    s_waitcnt lgkmcnt(5)
    v_cvt_pk_bf16_f32 v112, v48, v49
    v_mfma_f32_16x16x32_bf16 v[56:59], v[56:59], v[32:35], 0
    s_waitcnt lgkmcnt(4)
    v_mov_b32 v48, s50
    v_mov_b32 v49, s50
    v_mfma_f32_16x16x32_bf16 v[56:59], v[60:63], v[36:39], v[56:59]
    ds_read_b128 v[16:19], v124 offset:2048
    s_waitcnt lgkmcnt(4)
    v_mov_b32 v50, s50
    v_mov_b32 v51, s50
    v_mfma_f32_16x16x32_bf16 v[56:59], v[64:67], v[40:43], v[56:59]
    ds_read_b128 v[20:23], v124 offset:3072
    s_waitcnt lgkmcnt(4)
    v_add_f32 v52, v52, v54
    v_mfma_f32_16x16x32_bf16 v[56:59], v[68:71], v[44:47], v[56:59]
    ds_read_b128 v[24:27], v124 offset:4096
    v_add_f32 v53, v53, v55
    v_mfma_f32_16x16x32_bf16 v[60:63], v[72:75], v[32:35], 0
    ds_read_b128 v[28:31], v124 offset:5120
    v_cvt_pk_bf16_f32 v114, v52, v53
    v_mov_b32 v53, 0
    v_mfma_f32_16x16x32_bf16 v[60:63], v[76:79], v[36:39], v[60:63]
    v_exp_f32 v56, v56
    v_mfma_f32_16x16x32_bf16 v[60:63], v[80:83], v[40:43], v[60:63]
    v_exp_f32 v57, v57
    v_mfma_f32_16x16x32_bf16 v[60:63], v[84:87], v[44:47], v[60:63]
    v_exp_f32 v58, v58
    v_mfma_f32_16x16x32_bf16 v[64:67], v[32:35], v[32:35], 0
    v_exp_f32 v59, v59
    v_cvt_pk_bf16_f32 v68, v56, v57
    v_mfma_f32_16x16x32_bf16 v[64:67], v[36:39], v[36:39], v[64:67]
    v_exp_f32 v60, v60
    v_cvt_pk_bf16_f32 v69, v58, v59
    v_mfma_f32_16x16x32_bf16 v[64:67], v[40:43], v[40:43], v[64:67]
    v_exp_f32 v61, v61
    v_mfma_f32_16x16x32_bf16 v[64:67], v[44:47], v[44:47], v[64:67]
    v_exp_f32 v62, v62
    v_exp_f32 v63, v63
    v_cvt_pk_bf16_f32 v70, v60, v61
    v_cvt_pk_bf16_f32 v71, v62, v63
    s_nop 1
    v_mfma_f32_16x16x32_bf16 v[72:75], v[88:91], v[68:71], 0
    s_nop 0
    v_exp_f32 v64, v64
    v_mfma_f32_16x16x32_bf16 v[76:79], v[92:95], v[68:71], 0
    v_exp_f32 v65, v65
    v_mfma_f32_16x16x32_bf16 v[80:83], v[48:51], v[68:71], 0
    v_cvt_pk_bf16_f32 v52, v64, v65
    s_nop 1
    v_mfma_f32_16x16x16_bf16 v[72:75], v[112:113], v[52:53], v[72:75]
    ds_read_b128 v[32:35], v124 offset:6144
    v_mfma_f32_16x16x16_bf16 v[76:79], v[114:115], v[52:53], v[76:79]
    ds_read_b128 v[36:39], v124 offset:7168
    v_mfma_f32_16x16x16_bf16 v[80:83], v[48:49], v[52:53], v[80:83]
L_norm_27:
    s_mov_b64 vcc, s[36:37]
    v_mov_b32 v122, v122
    v_mov_b32 v122, v122
    v_mov_b32 v122, v122
    v_cndmask_b32_dpp v76, v72, v76, vcc quad_perm:[2,3,2,3] row_mask:0xf bank_mask:0xf
    v_cndmask_b32_dpp v77, v73, v77, vcc quad_perm:[2,3,2,3] row_mask:0xf bank_mask:0xf
    v_cndmask_b32_dpp v78, v74, v78, vcc quad_perm:[2,3,2,3] row_mask:0xf bank_mask:0xf
    v_cndmask_b32_dpp v79, v75, v79, vcc quad_perm:[2,3,2,3] row_mask:0xf bank_mask:0xf
    v_rcp_f32_dpp v84, v80 quad_perm:[2,3,2,3] row_mask:0xf bank_mask:0xf
    s_nop 0
    v_pk_mul_f32 v[76:77], v[76:77], v[84:85] op_sel_hi:[1,0]
    v_pk_mul_f32 v[78:79], v[78:79], v[84:85] op_sel_hi:[1,0]
    v_cvt_pk_bf16_f32 v72, v76, v77
    v_cvt_pk_bf16_f32 v73, v78, v79
    ds_write_b64 v122, v[72:73] offset:20992
    v_max_f32_dpp v86, v80, v84 quad_perm:[2,3,2,3] row_mask:0xf bank_mask:0xf
    v_mov_b32_dpp v60, v72 quad_perm:[0,1,0,1] row_mask:0xf bank_mask:0xf
    v_mov_b32_dpp v61, v73 quad_perm:[0,1,0,1] row_mask:0xf bank_mask:0xf
    v_cmp_lt_f32 vcc, s35, v86
    v_mov_b32_dpp v62, v72 quad_perm:[2,3,2,3] row_mask:0xf bank_mask:0xf
    v_mov_b32_dpp v63, v73 quad_perm:[2,3,2,3] row_mask:0xf bank_mask:0xf
    s_nop 1
    v_smfmac_f32_16x16x64_bf16 v[96:99], v[60:63], v[192:199], v116
    s_cbranch_vccnz L_smax_28
    v_smfmac_f32_16x16x64_bf16 v[100:103], v[60:63], v[224:231], v116
    s_waitcnt lgkmcnt(0)
    s_barrier
    ds_read_b128 v[92:95], v127 offset:20480
    ds_read_b128 v[80:83], v127 offset:22016
    ds_read_b128 v[84:87], v127 offset:21504
    v_smfmac_f32_16x16x64_bf16 v[104:107], v[60:63], v[0:7], v116
    ds_read_b128 v[40:43], v124 offset:34816
    v_smfmac_f32_16x16x64_bf16 v[108:111], v[60:63], v[8:15], v116
    ds_read_b128 v[56:59], v124 offset:36864
    s_waitcnt lgkmcnt(4)
    v_smfmac_f32_16x16x64_bf16 v[96:99], v[92:95], v[200:207], v116
    s_waitcnt lgkmcnt(3)
    v_smfmac_f32_16x16x64_bf16 v[96:99], v[80:83], v[208:215], v116
    ds_read_b128 v[44:47], v124 offset:35840
    s_waitcnt lgkmcnt(3)
    v_smfmac_f32_16x16x64_bf16 v[96:99], v[84:87], v[216:223], v116
    ds_read_b128 v[68:71], v124 offset:39936
    v_smfmac_f32_16x16x64_bf16 v[100:103], v[92:95], v[232:239], v116
    ds_read_b128 v[64:67], v124 offset:38912
    v_smfmac_f32_16x16x64_bf16 v[100:103], v[80:83], v[240:247], v116
    ds_read_b128 v[60:63], v124 offset:37888
    v_cvt_pk_bf16_f32 v72, v96, v98
    v_smfmac_f32_16x16x64_bf16 v[100:103], v[84:87], v[248:255], v116
    v_and_or_b32 v72, v72, -2, s33
    v_smfmac_f32_16x16x64_bf16 v[104:107], v[92:95], v[16:23], v116
    v_cvt_pk_bf16_f32 v74, v97, v99
    v_smfmac_f32_16x16x64_bf16 v[104:107], v[80:83], v[24:31], v116
    v_cvt_pk_bf16_f32 v73, v100, v102
    v_cvt_pk_bf16_f32 v75, v101, v103
    v_smfmac_f32_16x16x64_bf16 v[104:107], v[84:87], v[32:39], v116
    buffer_store_dwordx4 v[72:75], v118, s[8:11], s25 offen
    s_waitcnt lgkmcnt(3)
    v_smfmac_f32_16x16x64_bf16 v[108:111], v[92:95], v[40:47], v116
    s_waitcnt lgkmcnt(0)
    v_smfmac_f32_16x16x64_bf16 v[108:111], v[80:83], v[56:63], v116
    v_cvt_pk_bf16_f32 v76, v104, v106
    v_smfmac_f32_16x16x64_bf16 v[108:111], v[84:87], v[64:71], v116
    v_and_or_b32 v76, v76, -2, s33
    v_cvt_pk_bf16_f32 v78, v105, v107
    v_mov_b32 v122, v122
    v_mov_b32 v122, v122
    v_mov_b32 v122, v122
    v_mov_b32 v122, v122
    v_mov_b32 v122, v122
    v_mov_b32 v122, v122
    v_cvt_pk_bf16_f32 v77, v108, v110
    v_cvt_pk_bf16_f32 v79, v109, v111
    buffer_store_dwordx4 v[76:79], v118, s[8:11], s26 offen
    s_add_u32 s30, s30, 0x40000
    s_add_u32 s31, s31, 0x40000
    s_add_u32 s32, s32, 0x20000
    s_add_u32 s23, s24, 1024
    s_add_u32 s48, s23, 4096
    s_xor_b32 s25, s25, 0x40000
    s_xor_b32 s26, s26, 0x40000
    s_mov_b32 s35, 0x49800000
    s_add_u32 s22, s22, 1
    v_mov_b32 v32, 0
    v_mov_b32 v33, 0
    v_mov_b32 v34, 0
    v_mov_b32 v35, 0
    v_mov_b32 v36, 0
    v_mov_b32 v37, 0
    v_mov_b32 v38, 0
    v_mov_b32 v39, 0
    v_mov_b32 v40, 0
    v_mov_b32 v41, 0
    v_mov_b32 v42, 0
    v_mov_b32 v43, 0
    v_mov_b32 v44, 0
    v_mov_b32 v45, 0
    v_mov_b32 v46, 0
    v_mov_b32 v47, 0
    v_mov_b32 v48, 0
    v_mov_b32 v49, 0
    v_mov_b32 v50, 0
    v_mov_b32 v51, 0
    v_mov_b32 v52, 0
    v_mov_b32 v53, 0
    v_mov_b32 v54, 0
    v_mov_b32 v55, 0
    ds_read_b128 v[80:83], v123
    ds_read_b128 v[84:87], v123 offset:1024
    ds_read_b128 v[56:59], v123 offset:2048
    ds_read_b128 v[60:63], v123 offset:3072
    ds_read_b128 v[64:67], v123 offset:32768
    ds_read_b128 v[68:71], v123 offset:33792
    ds_read_b128 v[72:75], v123 offset:34816
    ds_read_b128 v[76:79], v123 offset:35840
    ds_read_b128 v[88:91], v123 offset:4096
    ds_read_b128 v[92:95], v123 offset:5120
    ds_read_b128 v[96:99], v123 offset:6144
    ds_read_b128 v[100:103], v123 offset:7168
    ds_read_b128 v[104:107], v123 offset:36864
    ds_read_b128 v[108:111], v123 offset:37888
    ds_read_b128 v[24:27], v123 offset:38912
    ds_read_b128 v[28:31], v123 offset:39936
    s_add_u32 s24, s24, 8192
    s_bitset0_b32 s24, 15
    s_xor_b32 s55, s24, 16384
    s_xor_b32 s29, s29, 0x40000
    s_xor_b32 s53, s29, 1024
    s_bfe_u32 s33, s22, 0x10001
    s_add_u32 s40, s22, 5
    s_lshr_b32 s40, s40, 2
    s_min_u32 s40, s40, 16
    s_bfm_b32 s58, s40, 0
    s_waitcnt vmcnt(4)
    v_cmp_eq_u32 vcc, 0, v125
    s_nop 0
    s_and_b64 vcc, vcc, s[58:59]
    s_cbranch_scc1 L_kvw_29
L_kvb_30:
    v_mov_b32 v15, 0
    s_nop 2
    v_mov_b32 v15, 0
    s_nop 2
    v_mov_b32 v15, 0
    s_nop 2
    v_mov_b32 v15, 0
    s_nop 2
    v_mov_b32 v15, 0
    s_nop 2
    v_mov_b32 v15, 0
    s_nop 2
    v_mov_b32 v15, 0
    s_nop 2
    v_mov_b32 v15, 0
    s_nop 2
    v_mov_b32 v15, 0
    s_nop 2
    v_mov_b32 v15, 0
    s_nop 2
    v_mov_b32 v15, 0
    s_nop 2
    v_mov_b32 v15, 0
    s_nop 2
    v_mov_b32 v15, 0
    s_nop 2
    v_mov_b32 v15, 0
    s_nop 2
    v_mov_b32 v15, 0
    s_nop 2
    v_mov_b32 v15, 0
    s_nop 2
    v_mov_b32 v15, 0
    s_nop 2
    v_mov_b32 v15, 0
    s_nop 2
    v_mov_b32 v15, 0
    s_nop 2
    v_mov_b32 v15, 0
    s_nop 2
    v_mov_b32 v15, 0
    s_nop 2
    v_mov_b32 v15, 0
    s_nop 2
    v_mov_b32 v15, 0
    s_nop 2
    v_mov_b32 v15, 0
    s_nop 2
    v_mov_b32 v15, 0
    s_nop 2
    v_mov_b32 v15, 0
    s_nop 2
    v_mov_b32 v15, 0
    s_nop 2
    v_mov_b32 v15, 0
    s_nop 2
    v_mov_b32 v15, 0
    s_nop 2
    v_mov_b32 v15, 0
    s_nop 2
    v_mov_b32 v15, 0
    s_nop 2
    s_waitcnt lgkmcnt(0)
    s_branch L_chain_top1_f
.p2align 6
L_chain_top2_f:
    buffer_load_dwordx4 v[0:3], v117, s[8:11], s23 offen nt
    v_mov_b32 v48, 0
    v_mov_b32 v49, 0
    v_mov_b32 v50, 0
    v_mov_b32 v51, 0
    v_mov_b32 v52, 0
    v_mov_b32 v53, 0
    v_mov_b32 v15, 0
    v_mov_b32 v15, 0
    v_mov_b32 v15, 0
    v_mov_b32 v15, 0
    v_mov_b32 v15, 0
    v_mov_b32 v15, 0
    v_mov_b32 v15, 0
    v_mov_b32 v15, 0
    v_mov_b32 v15, 0
    v_mov_b32 v15, 0
    buffer_load_dwordx4 v[0:3], v117, s[8:11], s23 offen sc1
    s_waitcnt vmcnt(3)
    v_mov_b32 v36, 0
    v_mov_b32 v37, 0
    v_mov_b32 v38, 0
    v_mov_b32 v39, 0
    v_mov_b32 v40, 0
    v_mov_b32 v41, 0
    v_mov_b32 v42, 0
    v_mov_b32 v43, 0
    v_mov_b32 v44, 0
    v_mov_b32 v45, 0
    v_mov_b32 v46, 0
    v_mov_b32 v47, 0
    v_mov_b32 v15, 0
    v_mov_b32 v15, 0
    v_mov_b32 v15, 0
    v_mov_b32 v15, 0
L_mret_31:
    buffer_load_dwordx4 v[0:3], v117, s[8:11], s23 offen sc1
    s_add_u32 s45, s45, 1
    s_cmp_lt_u32 s45, 0x10000
    s_cselect_b32 s56, -2, -1
    s_nop 3
    v_mov_b32 v32, 0
    v_mov_b32 v33, 0
    v_mov_b32 v34, 0
    v_mov_b32 v35, 0
    s_waitcnt vmcnt(2)
    v_max3_u32 v15, v0, v1, v2
    v_max_u32 v15, v15, v3
    v_cmp_lt_u32 vcc, s56, v15
    v_smfmac_f32_16x16x64_bf16 v[32:35], v[0:3], v[80:87], v116
    s_cbranch_vccnz L_mret_31
    ds_write_b128 v117, v[0:3] offset:2048
    v_smfmac_f32_16x16x64_bf16 v[36:39], v[0:3], v[56:63], v116
    buffer_load_dwordx4 v[4:7], v117, s[8:11], s48 offen nt
    v_smfmac_f32_16x16x64_bf16 v[40:43], v[0:3], v[64:71], v116
    buffer_load_dwordx4 v117, s[8:11], s48 offen nt lds
    s_mov_b32 m0, 12288
    v_smfmac_f32_16x16x64_bf16 v[44:47], v[0:3], v[72:79], v116
    s_waitcnt lgkmcnt(0)
    s_barrier
    ds_read_b128 v[8:11], v117 offset:3072
    v_smfmac_f32_16x16x64_bf16 v[48:51], v[0:3], a[192:199], v116
    ds_read_b128 v[16:19], v117
    ds_read_b128 v[20:23], v117 offset:1024
    v_smfmac_f32_16x16x64_bf16 v[52:55], v[0:3], a[200:207], v116
    ds_read_b128 v[80:83], v117 offset:14336
    s_waitcnt lgkmcnt(3)
    v_smfmac_f32_16x16x64_bf16 v[32:35], v[8:11], a[0:7], v116
    ds_read_b128 v[84:87], v117 offset:15360
    v_smfmac_f32_16x16x64_bf16 v[36:39], v[8:11], a[8:15], v116
    ds_read_b128 v[56:59], v117 offset:8192
    s_waitcnt lgkmcnt(4)
    v_smfmac_f32_16x16x64_bf16 v[32:35], v[16:19], a[32:39], v116
    ds_read_b128 v[60:63], v117 offset:9216
    v_smfmac_f32_16x16x64_bf16 v[36:39], v[16:19], a[40:47], v116
    ds_read_b128 v[64:67], v117 offset:10240
    s_waitcnt lgkmcnt(5)
    v_smfmac_f32_16x16x64_bf16 v[32:35], v[20:23], a[64:71], v116
    ds_read_b128 v[68:71], v117 offset:11264
    v_smfmac_f32_16x16x64_bf16 v[36:39], v[20:23], a[72:79], v116
    buffer_store_dwordx4 v[112:115], v117, s[8:11], s32 offen sc1
    v_smfmac_f32_16x16x64_bf16 v[40:43], v[8:11], a[96:103], v116
    ds_read_b128 v[72:75], v117 offset:12288
    v_smfmac_f32_16x16x64_bf16 v[40:43], v[16:19], a[128:135], v116
    ds_read_b128 v[76:79], v117 offset:13312
    v_smfmac_f32_16x16x64_bf16 v[40:43], v[20:23], a[160:167], v116
    s_waitcnt vmcnt(2)
    v_max3_u32 v15, v4, v5, v6
    v_smfmac_f32_16x16x64_bf16 v[44:47], v[8:11], a[104:111], v116
    v_max_u32 v15, v15, v7
    v_smfmac_f32_16x16x64_bf16 v[44:47], v[16:19], a[136:143], v116
    s_waitcnt vmcnt(1) lgkmcnt(0)
    v_cmp_lt_u32 vcc, s56, v15
    v_smfmac_f32_16x16x64_bf16 v[44:47], v[20:23], a[168:175], v116
    s_cbranch_vccnz L_mret_32
L_mgo_33:
    v_smfmac_f32_16x16x64_bf16 v[44:47], v[4:7], v[24:31], v116
    s_barrier
    ds_read_b128 v[12:15], v117 offset:7168
    v_smfmac_f32_16x16x64_bf16 v[32:35], v[4:7], v[88:95], v116
    ds_read_b128 v[24:27], v117 offset:4096
    v_smfmac_f32_16x16x64_bf16 v[36:39], v[4:7], v[96:103], v116
    ds_read_b128 v[28:31], v117 offset:5120
    v_smfmac_f32_16x16x64_bf16 v[40:43], v[4:7], v[104:111], v116
    ds_read_b128 v[88:91], v117 offset:28672
    s_waitcnt lgkmcnt(3)
    v_smfmac_f32_16x16x64_bf16 v[32:35], v[12:15], a[16:23], v116
    ds_read_b128 v[92:95], v117 offset:29696
    s_waitcnt lgkmcnt(3)
    v_smfmac_f32_16x16x64_bf16 v[32:35], v[24:27], a[48:55], v116
    buffer_load_dwordx4 v117, s[8:11], s30 offen lds
    s_waitcnt lgkmcnt(2)
    v_smfmac_f32_16x16x64_bf16 v[32:35], v[28:31], a[80:87], v116
    ds_read_b128 v[96:99], v117 offset:23552
    v_smfmac_f32_16x16x64_bf16 v[36:39], v[12:15], a[24:31], v116
    ds_read_b128 v[100:103], v117 offset:23552
    v_smfmac_f32_16x16x64_bf16 v[36:39], v[24:27], a[56:63], v116
    buffer_load_dwordx4 v117, s[8:11], s30 offen offset:1024 lds
    s_add_u32 m0, s52, 0x6000
    v_add_f32 v32, v32, v34
    v_smfmac_f32_16x16x64_bf16 v[36:39], v[28:31], a[88:95], v116
    ds_read_b128 v[104:107], v117 offset:23552
    v_add_f32 v33, v33, v35
    v_smfmac_f32_16x16x64_bf16 v[40:43], v[12:15], a[112:119], v116
    ds_read_b128 v[108:111], v117 offset:23552
    v_mul_f32 v32, s34, v32
    v_smfmac_f32_16x16x64_bf16 v[40:43], v[24:27], a[144:151], v116
    s_waitcnt lgkmcnt(4)
    buffer_load_dwordx4 v117, s[8:11], s31 offen lds
    v_mul_f32 v33, s34, v33
    v_smfmac_f32_16x16x64_bf16 v[40:43], v[28:31], a[176:183], v116
    ds_read_b128 v[0:3], v124
    v_add_f32 v36, v36, v38
    v_smfmac_f32_16x16x64_bf16 v[48:51], v[4:7], a[208:215], v116
    v_add_f32 v37, v37, v39
    v_smfmac_f32_16x16x64_bf16 v[52:55], v[4:7], a[216:223], v116
    buffer_load_dwordx4 v117, s[8:11], s31 offen offset:1024 lds
    s_mov_b32 m0, 6144
    v_mul_f32 v36, s34, v36
    v_smfmac_f32_16x16x64_bf16 v[44:47], v[12:15], a[120:127], v116
    ds_read_b128 v[4:7], v124 offset:1024
    v_mul_f32 v37, s34, v37
    v_smfmac_f32_16x16x64_bf16 v[44:47], v[24:27], a[152:159], v116
    v_cvt_pk_bf16_f32 v34, v32, v36
    v_smfmac_f32_16x16x64_bf16 v[44:47], v[28:31], a[184:191], v116
    v_cvt_pk_bf16_f32 v35, v33, v37
    v_add_f32 v40, v40, v42
    v_smfmac_f32_16x16x64_bf16 v[48:51], v[8:11], a[224:231], v116
    ds_write2_b32 v120, v34, v35 offset0:32 offset1:48
    v_add_f32 v41, v41, v43
    v_smfmac_f32_16x16x64_bf16 v[52:55], v[8:11], a[232:239], v116
    v_add_f32 v44, v44, v46
    v_add_f32 v45, v45, v47
    v_cvt_pk_bf16_f32 v113, v40, v44
    v_cvt_pk_bf16_f32 v115, v41, v45
    v_smfmac_f32_16x16x64_bf16 v[48:51], v[12:15], a[240:247], v116
    ds_write2_b32 v120, v113, v115 offset0:0 offset1:16
    v_smfmac_f32_16x16x64_bf16 v[52:55], v[12:15], a[248:255], v116
    s_cmp_eq_u32 s22, 63
    s_cbranch_scc1 L_chain_last_f
    v_smfmac_f32_16x16x64_bf16 v[48:51], v[16:19], v[128:135], v116
    buffer_store_dword v126, v119, s[8:11], s55 offen
    v_smfmac_f32_16x16x64_bf16 v[48:51], v[20:23], v[160:167], v116
    v_smfmac_f32_16x16x64_bf16 v[48:51], v[24:27], v[144:151], v116
    s_waitcnt lgkmcnt(0)
    s_barrier
    v_smfmac_f32_16x16x64_bf16 v[48:51], v[28:31], v[176:183], v116
    ds_read_b128 v[32:35], v121 offset:16384
    ds_read_b128 v[36:39], v121 offset:17408
    v_smfmac_f32_16x16x64_bf16 v[52:55], v[16:19], v[136:143], v116
    ds_read_b128 v[40:43], v121 offset:18432
    ds_read_b128 v[44:47], v121 offset:19456
    v_smfmac_f32_16x16x64_bf16 v[52:55], v[20:23], v[168:175], v116
    ds_read_b128 v[8:11], v124 offset:32768
    v_add_f32 v48, v48, v50
    v_smfmac_f32_16x16x64_bf16 v[52:55], v[24:27], v[152:159], v116
    ds_read_b128 v[12:15], v124 offset:33792
    v_add_f32 v49, v49, v51
    v_smfmac_f32_16x16x64_bf16 v[52:55], v[28:31], v[184:191], v116
    s_waitcnt lgkmcnt(5)
    v_cvt_pk_bf16_f32 v112, v48, v49
    v_mfma_f32_16x16x32_bf16 v[56:59], v[56:59], v[32:35], 0
    s_waitcnt lgkmcnt(4)
    v_mov_b32 v48, s50
    v_mov_b32 v49, s50
    v_mfma_f32_16x16x32_bf16 v[56:59], v[60:63], v[36:39], v[56:59]
    ds_read_b128 v[16:19], v124 offset:2048
    s_waitcnt lgkmcnt(4)
    v_mov_b32 v50, s50
    v_mov_b32 v51, s50
    v_mfma_f32_16x16x32_bf16 v[56:59], v[64:67], v[40:43], v[56:59]
    ds_read_b128 v[20:23], v124 offset:3072
    s_waitcnt lgkmcnt(4)
    v_add_f32 v52, v52, v54
    v_mfma_f32_16x16x32_bf16 v[56:59], v[68:71], v[44:47], v[56:59]
    ds_read_b128 v[24:27], v124 offset:4096
    v_add_f32 v53, v53, v55
    v_mfma_f32_16x16x32_bf16 v[60:63], v[72:75], v[32:35], 0
    ds_read_b128 v[28:31], v124 offset:5120
    v_cvt_pk_bf16_f32 v114, v52, v53
    v_mov_b32 v53, 0
    v_mfma_f32_16x16x32_bf16 v[60:63], v[76:79], v[36:39], v[60:63]
    v_exp_f32 v56, v56
    v_mfma_f32_16x16x32_bf16 v[60:63], v[80:83], v[40:43], v[60:63]
    v_exp_f32 v57, v57
    v_mfma_f32_16x16x32_bf16 v[60:63], v[84:87], v[44:47], v[60:63]
    v_exp_f32 v58, v58
    v_mfma_f32_16x16x32_bf16 v[64:67], v[32:35], v[32:35], 0
    v_exp_f32 v59, v59
    v_cvt_pk_bf16_f32 v68, v56, v57
    v_mfma_f32_16x16x32_bf16 v[64:67], v[36:39], v[36:39], v[64:67]
    v_exp_f32 v60, v60
    v_cvt_pk_bf16_f32 v69, v58, v59
    v_mfma_f32_16x16x32_bf16 v[64:67], v[40:43], v[40:43], v[64:67]
    v_exp_f32 v61, v61
    v_mfma_f32_16x16x32_bf16 v[64:67], v[44:47], v[44:47], v[64:67]
    v_exp_f32 v62, v62
    v_exp_f32 v63, v63
    v_cvt_pk_bf16_f32 v70, v60, v61
    v_cvt_pk_bf16_f32 v71, v62, v63
    s_nop 1
    v_mfma_f32_16x16x32_bf16 v[72:75], v[88:91], v[68:71], 0
    s_nop 0
    v_exp_f32 v64, v64
    v_mfma_f32_16x16x32_bf16 v[76:79], v[92:95], v[68:71], 0
    v_exp_f32 v65, v65
    v_mfma_f32_16x16x32_bf16 v[80:83], v[48:51], v[68:71], 0
    v_cvt_pk_bf16_f32 v52, v64, v65
    s_nop 1
    v_mfma_f32_16x16x16_bf16 v[72:75], v[112:113], v[52:53], v[72:75]
    ds_read_b128 v[32:35], v124 offset:6144
    v_mfma_f32_16x16x16_bf16 v[76:79], v[114:115], v[52:53], v[76:79]
    ds_read_b128 v[36:39], v124 offset:7168
    v_mfma_f32_16x16x16_bf16 v[80:83], v[48:49], v[52:53], v[80:83]
L_norm_34:
    s_mov_b64 vcc, s[36:37]
    v_mov_b32 v122, v122
    v_mov_b32 v122, v122
    v_mov_b32 v122, v122
    v_cndmask_b32_dpp v76, v72, v76, vcc quad_perm:[2,3,2,3] row_mask:0xf bank_mask:0xf
    v_cndmask_b32_dpp v77, v73, v77, vcc quad_perm:[2,3,2,3] row_mask:0xf bank_mask:0xf
    v_cndmask_b32_dpp v78, v74, v78, vcc quad_perm:[2,3,2,3] row_mask:0xf bank_mask:0xf
    v_cndmask_b32_dpp v79, v75, v79, vcc quad_perm:[2,3,2,3] row_mask:0xf bank_mask:0xf
    v_rcp_f32_dpp v84, v80 quad_perm:[2,3,2,3] row_mask:0xf bank_mask:0xf
    s_nop 0
    v_pk_mul_f32 v[76:77], v[76:77], v[84:85] op_sel_hi:[1,0]
    v_pk_mul_f32 v[78:79], v[78:79], v[84:85] op_sel_hi:[1,0]
    v_cvt_pk_bf16_f32 v72, v76, v77
    v_cvt_pk_bf16_f32 v73, v78, v79
    ds_write_b64 v122, v[72:73] offset:21504
    v_max_f32_dpp v86, v80, v84 quad_perm:[2,3,2,3] row_mask:0xf bank_mask:0xf
    v_mov_b32_dpp v60, v72 quad_perm:[0,1,0,1] row_mask:0xf bank_mask:0xf
    v_mov_b32_dpp v61, v73 quad_perm:[0,1,0,1] row_mask:0xf bank_mask:0xf
    v_cmp_lt_f32 vcc, s35, v86
    v_mov_b32_dpp v62, v72 quad_perm:[2,3,2,3] row_mask:0xf bank_mask:0xf
    v_mov_b32_dpp v63, v73 quad_perm:[2,3,2,3] row_mask:0xf bank_mask:0xf
    s_nop 1
    v_smfmac_f32_16x16x64_bf16 v[96:99], v[60:63], v[192:199], v116
    s_cbranch_vccnz L_smax_35
    v_smfmac_f32_16x16x64_bf16 v[100:103], v[60:63], v[224:231], v116
    s_waitcnt lgkmcnt(0)
    s_barrier
    ds_read_b128 v[92:95], v127 offset:22016
    ds_read_b128 v[80:83], v127 offset:20480
    ds_read_b128 v[84:87], v127 offset:20992
    v_smfmac_f32_16x16x64_bf16 v[104:107], v[60:63], v[0:7], v116
    ds_read_b128 v[40:43], v124 offset:34816
    v_smfmac_f32_16x16x64_bf16 v[108:111], v[60:63], v[8:15], v116
    ds_read_b128 v[56:59], v124 offset:36864
    s_waitcnt lgkmcnt(4)
    v_smfmac_f32_16x16x64_bf16 v[96:99], v[92:95], v[200:207], v116
    s_waitcnt lgkmcnt(3)
    v_smfmac_f32_16x16x64_bf16 v[96:99], v[80:83], v[208:215], v116
    ds_read_b128 v[44:47], v124 offset:35840
    s_waitcnt lgkmcnt(3)
    v_smfmac_f32_16x16x64_bf16 v[96:99], v[84:87], v[216:223], v116
    ds_read_b128 v[68:71], v124 offset:39936
    v_smfmac_f32_16x16x64_bf16 v[100:103], v[92:95], v[232:239], v116
    ds_read_b128 v[64:67], v124 offset:38912
    v_smfmac_f32_16x16x64_bf16 v[100:103], v[80:83], v[240:247], v116
    ds_read_b128 v[60:63], v124 offset:37888
    v_cvt_pk_bf16_f32 v72, v96, v98
    v_smfmac_f32_16x16x64_bf16 v[100:103], v[84:87], v[248:255], v116
    v_and_or_b32 v72, v72, -2, s33
    v_smfmac_f32_16x16x64_bf16 v[104:107], v[92:95], v[16:23], v116
    v_cvt_pk_bf16_f32 v74, v97, v99
    v_smfmac_f32_16x16x64_bf16 v[104:107], v[80:83], v[24:31], v116
    v_cvt_pk_bf16_f32 v73, v100, v102
    v_cvt_pk_bf16_f32 v75, v101, v103
    v_smfmac_f32_16x16x64_bf16 v[104:107], v[84:87], v[32:39], v116
    buffer_store_dwordx4 v[72:75], v118, s[8:11], s25 offen
    s_waitcnt lgkmcnt(3)
    v_smfmac_f32_16x16x64_bf16 v[108:111], v[92:95], v[40:47], v116
    s_waitcnt lgkmcnt(0)
    v_smfmac_f32_16x16x64_bf16 v[108:111], v[80:83], v[56:63], v116
    v_cvt_pk_bf16_f32 v76, v104, v106
    v_smfmac_f32_16x16x64_bf16 v[108:111], v[84:87], v[64:71], v116
    v_and_or_b32 v76, v76, -2, s33
    v_cvt_pk_bf16_f32 v78, v105, v107
    v_mov_b32 v122, v122
    v_mov_b32 v122, v122
    v_mov_b32 v122, v122
    v_mov_b32 v122, v122
    v_mov_b32 v122, v122
    v_mov_b32 v122, v122
    v_cvt_pk_bf16_f32 v77, v108, v110
    v_cvt_pk_bf16_f32 v79, v109, v111
    buffer_store_dwordx4 v[76:79], v118, s[8:11], s26 offen
    ds_read_b128 v[80:83], v123
    ds_read_b128 v[84:87], v123 offset:1024
    ds_read_b128 v[56:59], v123 offset:2048
    ds_read_b128 v[60:63], v123 offset:3072
    ds_read_b128 v[64:67], v123 offset:32768
    ds_read_b128 v[68:71], v123 offset:33792
    ds_read_b128 v[72:75], v123 offset:34816
    ds_read_b128 v[76:79], v123 offset:35840
    ds_read_b128 v[88:91], v123 offset:4096
    ds_read_b128 v[92:95], v123 offset:5120
    ds_read_b128 v[96:99], v123 offset:6144
    ds_read_b128 v[100:103], v123 offset:7168
    ds_read_b128 v[104:107], v123 offset:36864
    ds_read_b128 v[108:111], v123 offset:37888
    ds_read_b128 v[24:27], v123 offset:38912
    ds_read_b128 v[28:31], v123 offset:39936
    s_add_u32 s30, s30, 0x40000
    s_add_u32 s31, s31, 0x40000
    s_add_u32 s32, s32, 0x20000
    s_add_u32 s23, s24, 2048
    s_add_u32 s48, s23, 4096
    s_xor_b32 s25, s25, 0x40000
    s_xor_b32 s26, s26, 0x40000
    s_mov_b32 s35, 0x49800000
    s_add_u32 s22, s22, 1
    v_cndmask_b32 v12, 0, v125, s[68:69]
    v_cndmask_b32 v13, 0, v125, s[70:71]
    v_cndmask_b32 v14, 0, v125, s[72:73]
    v_cndmask_b32 v15, 0, v125, s[74:75]
    v_mov_b32 v54, 0
    v_mov_b32 v55, 0
    v_mov_b32 v52, 0
    v_mov_b32 v52, 0
    v_mov_b32 v52, 0
    v_mov_b32 v52, 0
    v_mov_b32 v52, 0
    v_mov_b32 v52, 0
    v_mov_b32 v52, 0
    v_mov_b32 v52, 0
    v_mov_b32 v52, 0
    v_mov_b32 v52, 0
    v_mov_b32 v52, 0
    v_mov_b32 v52, 0
    v_mov_b32 v52, 0
    v_mov_b32 v52, 0
    v_mov_b32 v52, 0
    v_mov_b32 v52, 0
    v_mov_b32 v52, 0
    v_mov_b32 v52, 0
    v_mov_b32 v52, 0
    buffer_load_dwordx4 v[4:7], v117, s[8:11], s29 offen nt
    buffer_load_dwordx4 v[8:11], v117, s[8:11], s53 offen nt
    buffer_load_dwordx4 v[16:19], v117, s[8:11], s29 offen offset:2048 nt
    buffer_load_dwordx4 v[20:23], v117, s[8:11], s53 offen offset:2048 nt
    v_mov_b32 v52, 0
    v_mov_b32 v52, 0
    v_mov_b32 v52, 0
    v_mov_b32 v52, 0
    v_mov_b32 v52, 0
    v_mov_b32 v52, 0
    v_mov_b32 v52, 0
    v_mov_b32 v52, 0
    v_mov_b32 v52, 0
    v_mov_b32 v52, 0
    v_mov_b32 v52, 0
    v_mov_b32 v52, 0
    v_mov_b32 v52, 0
    v_mov_b32 v52, 0
    v_mov_b32 v52, 0
    v_mov_b32 v52, 0
    v_mov_b32 v52, 0
    v_mov_b32 v52, 0
    v_mov_b32 v52, 0
    v_mov_b32 v52, 0
    v_mov_b32 v52, 0
    v_mov_b32 v52, 0
    v_mov_b32 v52, 0
    v_mov_b32 v52, 0
    v_mov_b32 v52, 0
    v_mov_b32 v52, 0
    v_mov_b32 v52, 0
    v_mov_b32 v52, 0
    v_mov_b32 v52, 0
    v_mov_b32 v52, 0
    v_mov_b32 v52, 0
    v_mov_b32 v52, 0
    v_mov_b32 v52, 0
    v_mov_b32 v52, 0
    v_mov_b32 v52, 0
    v_mov_b32 v52, 0
    v_mov_b32 v52, 0
    v_mov_b32 v52, 0
    v_mov_b32 v52, 0
    v_mov_b32 v52, 0
    buffer_load_dwordx4 v[32:35], v117, s[8:11], s29 offen sc1
    buffer_load_dwordx4 v[36:39], v117, s[8:11], s53 offen sc1
    buffer_load_dwordx4 v[40:43], v117, s[8:11], s29 offen offset:2048 sc1
    buffer_load_dwordx4 v[44:47], v117, s[8:11], s53 offen offset:2048 sc1
    v_mov_b32 v52, 0
L_rl_36:
    s_waitcnt vmcnt(7)
    v_mfma_f32_16x16x32_bf16 v[48:51], v[4:7], v[12:15], 0
    v_xor_b32 v52, s33, v4
    s_waitcnt vmcnt(6)
    v_mfma_f32_16x16x32_bf16 v[48:51], v[8:11], v[12:15], v[48:51]
    v_xor_b32 v53, s33, v8
    v_or_b32 v52, v52, v53
    s_waitcnt vmcnt(5)
    v_mfma_f32_16x16x32_bf16 v[48:51], v[16:19], v[12:15], v[48:51]
    v_xor_b32 v53, s33, v16
    v_or_b32 v52, v52, v53
    s_waitcnt vmcnt(4)
    v_mfma_f32_16x16x32_bf16 v[48:51], v[20:23], v[12:15], v[48:51]
    v_xor_b32 v53, s33, v20
    v_or_b32 v52, v52, v53
    v_and_b32 v52, 1, v52
    v_cmp_ne_u32 vcc, 0, v52
    s_cbranch_vccnz L_rslow_37
L_rgo_38:
    s_nop 2
    v_permlane32_swap_b32 v48, v50
    v_permlane32_swap_b32 v49, v51
    v_pk_add_f32 v[48:49], v[48:49], v[50:51]
    s_mov_b64 exec, s[38:39]
    v_cvt_pk_bf16_f32 v12, v48, v49
    v_min_u32 v12, 0xfffffffe, v12
    buffer_store_dword v12, v119, s[8:11], s24 offen
    s_mov_b64 exec, -1
    s_add_u32 s24, s24, 8192
    s_bitset0_b32 s24, 15
    s_xor_b32 s55, s24, 16384
    s_xor_b32 s29, s29, 0x40000
    s_xor_b32 s53, s29, 1024
    s_bfe_u32 s33, s22, 0x10001
    s_waitcnt lgkmcnt(0)
    s_branch L_chain_top2_f
.p2align 6
L_chain_top3_f:
    buffer_load_dwordx4 v[0:3], v117, s[8:11], s23 offen nt
    v_mov_b32 v48, 0
    v_mov_b32 v49, 0
    v_mov_b32 v50, 0
    v_mov_b32 v51, 0
    v_mov_b32 v52, 0
    v_mov_b32 v53, 0
    v_mov_b32 v15, 0
    v_mov_b32 v15, 0
    v_mov_b32 v15, 0
    v_mov_b32 v15, 0
    v_mov_b32 v15, 0
    v_mov_b32 v15, 0
    v_mov_b32 v15, 0
    v_mov_b32 v15, 0
    v_mov_b32 v15, 0
    v_mov_b32 v15, 0
    buffer_load_dwordx4 v[0:3], v117, s[8:11], s23 offen sc1
    s_waitcnt vmcnt(3)
    v_mov_b32 v36, 0
    v_mov_b32 v37, 0
    v_mov_b32 v38, 0
    v_mov_b32 v39, 0
    v_mov_b32 v40, 0
    v_mov_b32 v41, 0
    v_mov_b32 v42, 0
    v_mov_b32 v43, 0
    v_mov_b32 v44, 0
    v_mov_b32 v45, 0
    v_mov_b32 v46, 0
    v_mov_b32 v47, 0
    v_mov_b32 v15, 0
    v_mov_b32 v15, 0
    v_mov_b32 v15, 0
    v_mov_b32 v15, 0
L_mret_39:
    buffer_load_dwordx4 v[0:3], v117, s[8:11], s23 offen sc1
    s_add_u32 s45, s45, 1
    s_cmp_lt_u32 s45, 0x10000
    s_cselect_b32 s56, -2, -1
    s_nop 3
    v_mov_b32 v32, 0
    v_mov_b32 v33, 0
    v_mov_b32 v34, 0
    v_mov_b32 v35, 0
    s_waitcnt vmcnt(2)
    v_max3_u32 v15, v0, v1, v2
    v_max_u32 v15, v15, v3
    v_cmp_lt_u32 vcc, s56, v15
    v_smfmac_f32_16x16x64_bf16 v[32:35], v[0:3], v[80:87], v116
    s_cbranch_vccnz L_mret_39
    ds_write_b128 v117, v[0:3] offset:3072
    v_smfmac_f32_16x16x64_bf16 v[36:39], v[0:3], v[56:63], v116
    buffer_load_dwordx4 v[4:7], v117, s[8:11], s48 offen nt
    v_smfmac_f32_16x16x64_bf16 v[40:43], v[0:3], v[64:71], v116
    buffer_load_dwordx4 v117, s[8:11], s48 offen nt lds
    s_mov_b32 m0, 14336
    v_smfmac_f32_16x16x64_bf16 v[44:47], v[0:3], v[72:79], v116
    s_waitcnt lgkmcnt(0)
    s_barrier
    ds_read_b128 v[8:11], v117 offset:2048
    v_smfmac_f32_16x16x64_bf16 v[48:51], v[0:3], a[192:199], v116
    ds_read_b128 v[16:19], v117 offset:1024
    ds_read_b128 v[20:23], v117
    v_smfmac_f32_16x16x64_bf16 v[52:55], v[0:3], a[200:207], v116
    ds_read_b128 v[80:83], v117 offset:14336
    s_waitcnt lgkmcnt(3)
    v_smfmac_f32_16x16x64_bf16 v[32:35], v[8:11], a[0:7], v116
    ds_read_b128 v[84:87], v117 offset:15360
    v_smfmac_f32_16x16x64_bf16 v[36:39], v[8:11], a[8:15], v116
    ds_read_b128 v[56:59], v117 offset:8192
    s_waitcnt lgkmcnt(4)
    v_smfmac_f32_16x16x64_bf16 v[32:35], v[16:19], a[32:39], v116
    ds_read_b128 v[60:63], v117 offset:9216
    v_smfmac_f32_16x16x64_bf16 v[36:39], v[16:19], a[40:47], v116
    ds_read_b128 v[64:67], v117 offset:10240
    s_waitcnt lgkmcnt(5)
    v_smfmac_f32_16x16x64_bf16 v[32:35], v[20:23], a[64:71], v116
    ds_read_b128 v[68:71], v117 offset:11264
    v_smfmac_f32_16x16x64_bf16 v[36:39], v[20:23], a[72:79], v116
    ds_read_b128 v[72:75], v117 offset:12288
    v_smfmac_f32_16x16x64_bf16 v[40:43], v[8:11], a[96:103], v116
    ds_read_b128 v[76:79], v117 offset:13312
    v_smfmac_f32_16x16x64_bf16 v[40:43], v[16:19], a[128:135], v116
    buffer_store_dwordx4 v[112:115], v117, s[8:11], s32 offen sc1
    v_smfmac_f32_16x16x64_bf16 v[40:43], v[20:23], a[160:167], v116
    s_waitcnt vmcnt(2)
    v_max3_u32 v15, v4, v5, v6
    v_smfmac_f32_16x16x64_bf16 v[44:47], v[8:11], a[104:111], v116
    v_max_u32 v15, v15, v7
    v_smfmac_f32_16x16x64_bf16 v[44:47], v[16:19], a[136:143], v116
    s_waitcnt vmcnt(1) lgkmcnt(0)
    v_cmp_lt_u32 vcc, s56, v15
    v_smfmac_f32_16x16x64_bf16 v[44:47], v[20:23], a[168:175], v116
    s_cbranch_vccnz L_mret_40
L_mgo_41:
    v_smfmac_f32_16x16x64_bf16 v[44:47], v[4:7], v[24:31], v116
    s_barrier
    ds_read_b128 v[12:15], v117 offset:6144
    v_smfmac_f32_16x16x64_bf16 v[32:35], v[4:7], v[88:95], v116
    ds_read_b128 v[24:27], v117 offset:5120
    v_smfmac_f32_16x16x64_bf16 v[36:39], v[4:7], v[96:103], v116
    ds_read_b128 v[28:31], v117 offset:4096
    v_smfmac_f32_16x16x64_bf16 v[40:43], v[4:7], v[104:111], v116
    ds_read_b128 v[88:91], v117 offset:30720
    s_waitcnt lgkmcnt(3)
    v_smfmac_f32_16x16x64_bf16 v[32:35], v[12:15], a[16:23], v116
    ds_read_b128 v[92:95], v117 offset:31744
    s_waitcnt lgkmcnt(3)
    v_smfmac_f32_16x16x64_bf16 v[32:35], v[24:27], a[48:55], v116
    ds_read_b128 v[96:99], v117 offset:23552
    s_waitcnt lgkmcnt(3)
    v_smfmac_f32_16x16x64_bf16 v[32:35], v[28:31], a[80:87], v116
    buffer_load_dwordx4 v117, s[8:11], s30 offen lds
    v_smfmac_f32_16x16x64_bf16 v[36:39], v[12:15], a[24:31], v116
    ds_read_b128 v[100:103], v117 offset:23552
    v_smfmac_f32_16x16x64_bf16 v[36:39], v[24:27], a[56:63], v116
    ds_read_b128 v[104:107], v117 offset:23552
    v_add_f32 v32, v32, v34
    v_smfmac_f32_16x16x64_bf16 v[36:39], v[28:31], a[88:95], v116
    buffer_load_dwordx4 v117, s[8:11], s30 offen offset:1024 lds
    s_add_u32 m0, s52, 0x6000
    v_add_f32 v33, v33, v35
    v_smfmac_f32_16x16x64_bf16 v[40:43], v[12:15], a[112:119], v116
    ds_read_b128 v[108:111], v117 offset:23552
    v_mul_f32 v32, s34, v32
    v_smfmac_f32_16x16x64_bf16 v[40:43], v[24:27], a[144:151], v116
    ds_read_b128 v[0:3], v124
    v_mul_f32 v33, s34, v33
    v_smfmac_f32_16x16x64_bf16 v[40:43], v[28:31], a[176:183], v116
    s_waitcnt lgkmcnt(5)
    buffer_load_dwordx4 v117, s[8:11], s31 offen lds
    v_add_f32 v36, v36, v38
    v_smfmac_f32_16x16x64_bf16 v[48:51], v[4:7], a[208:215], v116
    v_add_f32 v37, v37, v39
    v_smfmac_f32_16x16x64_bf16 v[52:55], v[4:7], a[216:223], v116
    ds_read_b128 v[4:7], v124 offset:1024
    v_mul_f32 v36, s34, v36
    v_smfmac_f32_16x16x64_bf16 v[44:47], v[12:15], a[120:127], v116
    buffer_load_dwordx4 v117, s[8:11], s31 offen offset:1024 lds
    s_mov_b32 m0, 7168
    v_mul_f32 v37, s34, v37
    v_smfmac_f32_16x16x64_bf16 v[44:47], v[24:27], a[152:159], v116
    v_cvt_pk_bf16_f32 v34, v32, v36
    v_smfmac_f32_16x16x64_bf16 v[44:47], v[28:31], a[184:191], v116
    v_cvt_pk_bf16_f32 v35, v33, v37
    v_add_f32 v40, v40, v42
    v_smfmac_f32_16x16x64_bf16 v[48:51], v[8:11], a[224:231], v116
    ds_write2_b32 v120, v34, v35 offset0:32 offset1:48
    v_add_f32 v41, v41, v43
    v_smfmac_f32_16x16x64_bf16 v[52:55], v[8:11], a[232:239], v116
    v_add_f32 v44, v44, v46
    v_add_f32 v45, v45, v47
    v_cvt_pk_bf16_f32 v113, v40, v44
    v_cvt_pk_bf16_f32 v115, v41, v45
    v_smfmac_f32_16x16x64_bf16 v[48:51], v[12:15], a[240:247], v116
    ds_write2_b32 v120, v113, v115 offset0:0 offset1:16
    v_smfmac_f32_16x16x64_bf16 v[52:55], v[12:15], a[248:255], v116
    s_cmp_eq_u32 s22, 63
    s_cbranch_scc1 L_chain_last_f
    v_smfmac_f32_16x16x64_bf16 v[48:51], v[16:19], v[128:135], v116
    v_smfmac_f32_16x16x64_bf16 v[48:51], v[20:23], v[160:167], v116
    buffer_store_dword v126, v119, s[8:11], s55 offen
    v_smfmac_f32_16x16x64_bf16 v[48:51], v[24:27], v[144:151], v116
    s_waitcnt lgkmcnt(0)
    s_barrier
    v_smfmac_f32_16x16x64_bf16 v[48:51], v[28:31], v[176:183], v116
    ds_read_b128 v[32:35], v121 offset:16384
    ds_read_b128 v[36:39], v121 offset:17408
    v_smfmac_f32_16x16x64_bf16 v[52:55], v[16:19], v[136:143], v116
    ds_read_b128 v[40:43], v121 offset:18432
    ds_read_b128 v[44:47], v121 offset:19456
    v_smfmac_f32_16x16x64_bf16 v[52:55], v[20:23], v[168:175], v116
    ds_read_b128 v[8:11], v124 offset:32768
    v_add_f32 v48, v48, v50
    v_smfmac_f32_16x16x64_bf16 v[52:55], v[24:27], v[152:159], v116
    ds_read_b128 v[12:15], v124 offset:33792
    v_add_f32 v49, v49, v51
    v_smfmac_f32_16x16x64_bf16 v[52:55], v[28:31], v[184:191], v116
    s_waitcnt lgkmcnt(5)
    v_cvt_pk_bf16_f32 v112, v48, v49
    v_mfma_f32_16x16x32_bf16 v[56:59], v[56:59], v[32:35], 0
    s_waitcnt lgkmcnt(4)
    v_mov_b32 v48, s50
    v_mov_b32 v49, s50
    v_mfma_f32_16x16x32_bf16 v[56:59], v[60:63], v[36:39], v[56:59]
    ds_read_b128 v[16:19], v124 offset:2048
    s_waitcnt lgkmcnt(4)
    v_mov_b32 v50, s50
    v_mov_b32 v51, s50
    v_mfma_f32_16x16x32_bf16 v[56:59], v[64:67], v[40:43], v[56:59]
    ds_read_b128 v[20:23], v124 offset:3072
    s_waitcnt lgkmcnt(4)
    v_add_f32 v52, v52, v54
    v_mfma_f32_16x16x32_bf16 v[56:59], v[68:71], v[44:47], v[56:59]
    ds_read_b128 v[24:27], v124 offset:4096
    v_add_f32 v53, v53, v55
    v_mfma_f32_16x16x32_bf16 v[60:63], v[72:75], v[32:35], 0
    ds_read_b128 v[28:31], v124 offset:5120
    v_cvt_pk_bf16_f32 v114, v52, v53
    v_mov_b32 v53, 0
    v_mfma_f32_16x16x32_bf16 v[60:63], v[76:79], v[36:39], v[60:63]
    v_exp_f32 v56, v56
    v_mfma_f32_16x16x32_bf16 v[60:63], v[80:83], v[40:43], v[60:63]
    v_exp_f32 v57, v57
    v_mfma_f32_16x16x32_bf16 v[60:63], v[84:87], v[44:47], v[60:63]
    v_exp_f32 v58, v58
    v_mfma_f32_16x16x32_bf16 v[64:67], v[32:35], v[32:35], 0
    v_exp_f32 v59, v59
    v_cvt_pk_bf16_f32 v68, v56, v57
    v_mfma_f32_16x16x32_bf16 v[64:67], v[36:39], v[36:39], v[64:67]
    v_exp_f32 v60, v60
    v_cvt_pk_bf16_f32 v69, v58, v59
    v_mfma_f32_16x16x32_bf16 v[64:67], v[40:43], v[40:43], v[64:67]
    v_exp_f32 v61, v61
    v_mfma_f32_16x16x32_bf16 v[64:67], v[44:47], v[44:47], v[64:67]
    v_exp_f32 v62, v62
    v_exp_f32 v63, v63
    v_cvt_pk_bf16_f32 v70, v60, v61
    v_cvt_pk_bf16_f32 v71, v62, v63
    s_nop 1
    v_mfma_f32_16x16x32_bf16 v[72:75], v[88:91], v[68:71], 0
    s_nop 0
    v_exp_f32 v64, v64
    v_mfma_f32_16x16x32_bf16 v[76:79], v[92:95], v[68:71], 0
    v_exp_f32 v65, v65
    v_mfma_f32_16x16x32_bf16 v[80:83], v[48:51], v[68:71], 0
    v_cvt_pk_bf16_f32 v52, v64, v65
    s_nop 1
    v_mfma_f32_16x16x16_bf16 v[72:75], v[112:113], v[52:53], v[72:75]
    ds_read_b128 v[32:35], v124 offset:6144
    v_mfma_f32_16x16x16_bf16 v[76:79], v[114:115], v[52:53], v[76:79]
    ds_read_b128 v[36:39], v124 offset:7168
    v_mfma_f32_16x16x16_bf16 v[80:83], v[48:49], v[52:53], v[80:83]
L_norm_42:
    s_mov_b64 vcc, s[36:37]
    v_mov_b32 v122, v122
    v_mov_b32 v122, v122
    v_mov_b32 v122, v122
    v_cndmask_b32_dpp v76, v72, v76, vcc quad_perm:[2,3,2,3] row_mask:0xf bank_mask:0xf
    v_cndmask_b32_dpp v77, v73, v77, vcc quad_perm:[2,3,2,3] row_mask:0xf bank_mask:0xf
    v_cndmask_b32_dpp v78, v74, v78, vcc quad_perm:[2,3,2,3] row_mask:0xf bank_mask:0xf
    v_cndmask_b32_dpp v79, v75, v79, vcc quad_perm:[2,3,2,3] row_mask:0xf bank_mask:0xf
    v_rcp_f32_dpp v84, v80 quad_perm:[2,3,2,3] row_mask:0xf bank_mask:0xf
    s_nop 0
    v_pk_mul_f32 v[76:77], v[76:77], v[84:85] op_sel_hi:[1,0]
    v_pk_mul_f32 v[78:79], v[78:79], v[84:85] op_sel_hi:[1,0]
    v_cvt_pk_bf16_f32 v72, v76, v77
    v_cvt_pk_bf16_f32 v73, v78, v79
    ds_write_b64 v122, v[72:73] offset:22016
    v_max_f32_dpp v86, v80, v84 quad_perm:[2,3,2,3] row_mask:0xf bank_mask:0xf
    v_mov_b32_dpp v60, v72 quad_perm:[0,1,0,1] row_mask:0xf bank_mask:0xf
    v_mov_b32_dpp v61, v73 quad_perm:[0,1,0,1] row_mask:0xf bank_mask:0xf
    v_cmp_lt_f32 vcc, s35, v86
    v_mov_b32_dpp v62, v72 quad_perm:[2,3,2,3] row_mask:0xf bank_mask:0xf
    v_mov_b32_dpp v63, v73 quad_perm:[2,3,2,3] row_mask:0xf bank_mask:0xf
    s_nop 1
    v_smfmac_f32_16x16x64_bf16 v[96:99], v[60:63], v[192:199], v116
    s_cbranch_vccnz L_smax_43
    v_smfmac_f32_16x16x64_bf16 v[100:103], v[60:63], v[224:231], v116
    s_waitcnt lgkmcnt(0)
    s_barrier
    ds_read_b128 v[92:95], v127 offset:21504
    ds_read_b128 v[80:83], v127 offset:20992
    ds_read_b128 v[84:87], v127 offset:20480
    v_smfmac_f32_16x16x64_bf16 v[104:107], v[60:63], v[0:7], v116
    ds_read_b128 v[40:43], v124 offset:34816
    v_smfmac_f32_16x16x64_bf16 v[108:111], v[60:63], v[8:15], v116
    ds_read_b128 v[56:59], v124 offset:36864
    s_waitcnt lgkmcnt(4)
    v_smfmac_f32_16x16x64_bf16 v[96:99], v[92:95], v[200:207], v116
    s_waitcnt lgkmcnt(3)
    v_smfmac_f32_16x16x64_bf16 v[96:99], v[80:83], v[208:215], v116
    ds_read_b128 v[44:47], v124 offset:35840
    s_waitcnt lgkmcnt(3)
    v_smfmac_f32_16x16x64_bf16 v[96:99], v[84:87], v[216:223], v116
    ds_read_b128 v[68:71], v124 offset:39936
    v_smfmac_f32_16x16x64_bf16 v[100:103], v[92:95], v[232:239], v116
    ds_read_b128 v[64:67], v124 offset:38912
    v_smfmac_f32_16x16x64_bf16 v[100:103], v[80:83], v[240:247], v116
    ds_read_b128 v[60:63], v124 offset:37888
    v_cvt_pk_bf16_f32 v72, v96, v98
    v_smfmac_f32_16x16x64_bf16 v[100:103], v[84:87], v[248:255], v116
    v_and_or_b32 v72, v72, -2, s33
    v_smfmac_f32_16x16x64_bf16 v[104:107], v[92:95], v[16:23], v116
    v_cvt_pk_bf16_f32 v74, v97, v99
    v_smfmac_f32_16x16x64_bf16 v[104:107], v[80:83], v[24:31], v116
    v_cvt_pk_bf16_f32 v73, v100, v102
    v_cvt_pk_bf16_f32 v75, v101, v103
    v_smfmac_f32_16x16x64_bf16 v[104:107], v[84:87], v[32:39], v116
    buffer_store_dwordx4 v[72:75], v118, s[8:11], s25 offen
    s_waitcnt lgkmcnt(3)
    v_smfmac_f32_16x16x64_bf16 v[108:111], v[92:95], v[40:47], v116
    s_waitcnt lgkmcnt(0)
    v_smfmac_f32_16x16x64_bf16 v[108:111], v[80:83], v[56:63], v116
    v_cvt_pk_bf16_f32 v76, v104, v106
    v_smfmac_f32_16x16x64_bf16 v[108:111], v[84:87], v[64:71], v116
    v_and_or_b32 v76, v76, -2, s33
    v_cvt_pk_bf16_f32 v78, v105, v107
    v_mov_b32 v122, v122
    v_mov_b32 v122, v122
    v_mov_b32 v122, v122
    v_mov_b32 v122, v122
    v_mov_b32 v122, v122
    v_mov_b32 v122, v122
    v_cvt_pk_bf16_f32 v77, v108, v110
    v_cvt_pk_bf16_f32 v79, v109, v111
    buffer_store_dwordx4 v[76:79], v118, s[8:11], s26 offen
    ds_read_b128 v[80:83], v123
    ds_read_b128 v[84:87], v123 offset:1024
    ds_read_b128 v[56:59], v123 offset:2048
    ds_read_b128 v[60:63], v123 offset:3072
    ds_read_b128 v[64:67], v123 offset:32768
    ds_read_b128 v[68:71], v123 offset:33792
    ds_read_b128 v[72:75], v123 offset:34816
    ds_read_b128 v[76:79], v123 offset:35840
    ds_read_b128 v[88:91], v123 offset:4096
    ds_read_b128 v[92:95], v123 offset:5120
    ds_read_b128 v[96:99], v123 offset:6144
    ds_read_b128 v[100:103], v123 offset:7168
    ds_read_b128 v[104:107], v123 offset:36864
    ds_read_b128 v[108:111], v123 offset:37888
    ds_read_b128 v[24:27], v123 offset:38912
    ds_read_b128 v[28:31], v123 offset:39936
    s_add_u32 s30, s30, 0x40000
    s_add_u32 s31, s31, 0x40000
    s_add_u32 s32, s32, 0x20000
    s_add_u32 s23, s24, 3072
    s_add_u32 s48, s23, 4096
    s_xor_b32 s25, s25, 0x40000
    s_xor_b32 s26, s26, 0x40000
    s_mov_b32 s35, 0x49800000
    s_add_u32 s22, s22, 1
    v_cndmask_b32 v12, 0, v125, s[68:69]
    v_cndmask_b32 v13, 0, v125, s[70:71]
    v_cndmask_b32 v14, 0, v125, s[72:73]
    v_cndmask_b32 v15, 0, v125, s[74:75]
    v_mov_b32 v54, 0
    v_mov_b32 v55, 0
    v_mov_b32 v52, 0
    v_mov_b32 v52, 0
    v_mov_b32 v52, 0
    v_mov_b32 v52, 0
    v_mov_b32 v52, 0
    v_mov_b32 v52, 0
    v_mov_b32 v52, 0
    v_mov_b32 v52, 0
    v_mov_b32 v52, 0
    v_mov_b32 v52, 0
    v_mov_b32 v52, 0
    v_mov_b32 v52, 0
    v_mov_b32 v52, 0
    v_mov_b32 v52, 0
    v_mov_b32 v52, 0
    v_mov_b32 v52, 0
    v_mov_b32 v52, 0
    v_mov_b32 v52, 0
    v_mov_b32 v52, 0
    v_mov_b32 v52, 0
    v_mov_b32 v52, 0
    v_mov_b32 v52, 0
    v_mov_b32 v52, 0
    v_mov_b32 v52, 0
    v_mov_b32 v52, 0
    v_mov_b32 v52, 0
    v_mov_b32 v52, 0
    v_mov_b32 v52, 0
    v_mov_b32 v52, 0
    v_mov_b32 v52, 0
    v_mov_b32 v52, 0
    v_mov_b32 v52, 0
    v_mov_b32 v52, 0
    v_mov_b32 v52, 0
    v_mov_b32 v52, 0
    v_mov_b32 v52, 0
    v_mov_b32 v52, 0
    v_mov_b32 v52, 0
    v_mov_b32 v52, 0
    v_mov_b32 v52, 0
    v_mov_b32 v52, 0
    v_mov_b32 v52, 0
    v_mov_b32 v52, 0
    v_mov_b32 v52, 0
    v_mov_b32 v52, 0
    v_mov_b32 v52, 0
    v_mov_b32 v52, 0
    v_mov_b32 v52, 0
    v_mov_b32 v52, 0
    buffer_load_dwordx4 v[4:7], v117, s[8:11], s29 offen nt
    buffer_load_dwordx4 v[8:11], v117, s[8:11], s53 offen nt
    buffer_load_dwordx4 v[16:19], v117, s[8:11], s29 offen offset:2048 nt
    buffer_load_dwordx4 v[20:23], v117, s[8:11], s53 offen offset:2048 nt
    v_mov_b32 v52, 0
    v_mov_b32 v52, 0
    v_mov_b32 v52, 0
    v_mov_b32 v52, 0
    v_mov_b32 v52, 0
    v_mov_b32 v52, 0
    v_mov_b32 v52, 0
    v_mov_b32 v52, 0
    v_mov_b32 v52, 0
    v_mov_b32 v52, 0
    v_mov_b32 v52, 0
    v_mov_b32 v52, 0
    v_mov_b32 v52, 0
    v_mov_b32 v52, 0
    v_mov_b32 v52, 0
    v_mov_b32 v52, 0
    v_mov_b32 v52, 0
    v_mov_b32 v52, 0
    v_mov_b32 v52, 0
    v_mov_b32 v52, 0
    v_mov_b32 v52, 0
    v_mov_b32 v52, 0
    v_mov_b32 v52, 0
    v_mov_b32 v52, 0
    v_mov_b32 v52, 0
    v_mov_b32 v52, 0
    v_mov_b32 v52, 0
    v_mov_b32 v52, 0
    v_mov_b32 v52, 0
    v_mov_b32 v52, 0
    buffer_load_dwordx4 v[32:35], v117, s[8:11], s29 offen sc1
    buffer_load_dwordx4 v[36:39], v117, s[8:11], s53 offen sc1
    buffer_load_dwordx4 v[40:43], v117, s[8:11], s29 offen offset:2048 sc1
    buffer_load_dwordx4 v[44:47], v117, s[8:11], s53 offen offset:2048 sc1
    v_mov_b32 v52, 0
L_rl_44:
    s_waitcnt vmcnt(7)
    v_mfma_f32_16x16x32_bf16 v[48:51], v[4:7], v[12:15], 0
    v_xor_b32 v52, s33, v4
    s_waitcnt vmcnt(6)
    v_mfma_f32_16x16x32_bf16 v[48:51], v[8:11], v[12:15], v[48:51]
    v_xor_b32 v53, s33, v8
    v_or_b32 v52, v52, v53
    s_waitcnt vmcnt(5)
    v_mfma_f32_16x16x32_bf16 v[48:51], v[16:19], v[12:15], v[48:51]
    v_xor_b32 v53, s33, v16
    v_or_b32 v52, v52, v53
    s_waitcnt vmcnt(4)
    v_mfma_f32_16x16x32_bf16 v[48:51], v[20:23], v[12:15], v[48:51]
    v_xor_b32 v53, s33, v20
    v_or_b32 v52, v52, v53
    v_and_b32 v52, 1, v52
    v_cmp_ne_u32 vcc, 0, v52
    s_cbranch_vccnz L_rslow_45
L_rgo_46:
    s_nop 2
    v_permlane32_swap_b32 v48, v50
    v_permlane32_swap_b32 v49, v51
    v_pk_add_f32 v[48:49], v[48:49], v[50:51]
    s_mov_b64 exec, s[38:39]
    v_cvt_pk_bf16_f32 v12, v48, v49
    v_min_u32 v12, 0xfffffffe, v12
    buffer_store_dword v12, v119, s[8:11], s24 offen
    s_mov_b64 exec, -1
    s_add_u32 s24, s24, 8192
    s_bitset0_b32 s24, 15
    s_xor_b32 s55, s24, 16384
    s_xor_b32 s29, s29, 0x40000
    s_xor_b32 s53, s29, 1024
    s_bfe_u32 s33, s22, 0x10001
    s_waitcnt lgkmcnt(0)
    s_branch L_chain_top3_f
L_chain_last_f:
    s_nop 1
    v_smfmac_f32_16x16x64_bf16 v[48:51], v[16:19], v[128:135], v116
    v_smfmac_f32_16x16x64_bf16 v[48:51], v[20:23], v[160:167], v116
    v_smfmac_f32_16x16x64_bf16 v[48:51], v[24:27], v[144:151], v116
    v_smfmac_f32_16x16x64_bf16 v[48:51], v[28:31], v[176:183], v116
    v_smfmac_f32_16x16x64_bf16 v[52:55], v[16:19], v[136:143], v116
    v_smfmac_f32_16x16x64_bf16 v[52:55], v[20:23], v[168:175], v116
    v_smfmac_f32_16x16x64_bf16 v[52:55], v[24:27], v[152:159], v116
    v_smfmac_f32_16x16x64_bf16 v[52:55], v[28:31], v[184:191], v116
    v_add_f32 v48, v48, v50
    v_add_f32 v49, v49, v51
    v_cvt_pk_bf16_f32 v112, v48, v49
    s_nop 4
    v_add_f32 v52, v52, v54
    v_add_f32 v53, v53, v55
    v_cvt_pk_bf16_f32 v114, v52, v53
    s_add_u32 s32, s32, 0x20000
    buffer_store_dwordx4 v[112:115], v117, s[8:11], s32 offen sc1
    v_mov_b32 v94, 64
    s_waitcnt vmcnt(0) lgkmcnt(0)
    s_barrier
    s_mov_b64 exec, 1
    buffer_store_dword v94, off, s[8:11], s44 sc1
    s_mov_b64 exec, -1
    s_endpgm
L_mret_18:
    s_mov_b32 s43, m0
    s_mov_b32 m0, 4096
    buffer_load_dwordx4 v[4:7], v117, s[8:11], s48 offen sc1
    buffer_load_dwordx4 v117, s[8:11], s48 offen sc1 lds
    s_mov_b32 m0, 8192
    s_mov_b32 m0, s43
    s_waitcnt vmcnt(0)
    v_max3_u32 v15, v4, v5, v6
    v_max_u32 v15, v15, v7
    v_cmp_lt_u32 vcc, s56, v15
    s_add_u32 s47, s47, 1
    s_add_u32 s49, s49, 1
    s_cmp_ge_u32 s49, 0x10000
    s_cbranch_scc1 L_mgo_19
    s_cbranch_vccnz L_mret_18
    s_branch L_mgo_19
L_smax_21:
    s_add_u32 s47, s47, 1
    s_mov_b32 s35, 0x7f800000
    s_waitcnt lgkmcnt(0)
    s_sub_u32 s43, s30, 0x40000
    s_add_u32 s40, s43, 4096
    s_nop 7
    buffer_load_dwordx4 v[56:59], v117, s[8:11], s43 offen
    buffer_load_dwordx4 v[60:63], v117, s[8:11], s43 offen offset:1024
    buffer_load_dwordx4 v[64:67], v117, s[8:11], s43 offen offset:2048
    buffer_load_dwordx4 v[68:71], v117, s[8:11], s43 offen offset:3072
    buffer_load_dwordx4 v[72:75], v117, s[8:11], s40 offen
    buffer_load_dwordx4 v[76:79], v117, s[8:11], s40 offen offset:1024
    buffer_load_dwordx4 v[80:83], v117, s[8:11], s40 offen offset:2048
    buffer_load_dwordx4 v[84:87], v117, s[8:11], s40 offen offset:3072
    ds_read_b128 v[32:35], v121 offset:16384
    ds_read_b128 v[36:39], v121 offset:17408
    ds_read_b128 v[40:43], v121 offset:18432
    ds_read_b128 v[44:47], v121 offset:19456
    v_mov_b32 v96, 0
    v_mov_b32 v97, 0
    v_mov_b32 v98, 0
    v_mov_b32 v99, 0
    v_mov_b32 v100, 0
    v_mov_b32 v101, 0
    v_mov_b32 v102, 0
    v_mov_b32 v103, 0
    v_mov_b32 v104, 0
    v_mov_b32 v105, 0
    v_mov_b32 v106, 0
    v_mov_b32 v107, 0
    v_mov_b32 v108, 0
    v_mov_b32 v109, 0
    v_mov_b32 v110, 0
    v_mov_b32 v111, 0
    s_waitcnt vmcnt(0) lgkmcnt(0)
    v_mfma_f32_16x16x32_bf16 v[56:59], v[56:59], v[32:35], 0
    v_mfma_f32_16x16x32_bf16 v[56:59], v[60:63], v[36:39], v[56:59]
    v_mfma_f32_16x16x32_bf16 v[56:59], v[64:67], v[40:43], v[56:59]
    v_mfma_f32_16x16x32_bf16 v[56:59], v[68:71], v[44:47], v[56:59]
    v_mfma_f32_16x16x32_bf16 v[60:63], v[72:75], v[32:35], 0
    v_mfma_f32_16x16x32_bf16 v[60:63], v[76:79], v[36:39], v[60:63]
    v_mfma_f32_16x16x32_bf16 v[60:63], v[80:83], v[40:43], v[60:63]
    v_mfma_f32_16x16x32_bf16 v[60:63], v[84:87], v[44:47], v[60:63]
    v_mfma_f32_16x16x32_bf16 v[64:67], v[32:35], v[32:35], 0
    v_mfma_f32_16x16x32_bf16 v[64:67], v[36:39], v[36:39], v[64:67]
    v_mfma_f32_16x16x32_bf16 v[64:67], v[40:43], v[40:43], v[64:67]
    v_mfma_f32_16x16x32_bf16 v[64:67], v[44:47], v[44:47], v[64:67]
    v_max3_f32 v84, v56, v57, v58
    v_max3_f32 v84, v84, v59, v60
    v_max3_f32 v84, v84, v61, v62
    s_nop 4
    v_max3_f32 v84, v84, v63, v64
    v_max_f32 v84, v84, v65
    v_mov_b32 v85, v84
    s_nop 1
    v_permlane32_swap_b32 v85, v84
    v_max_f32 v84, v85, v84
    v_mov_b32 v85, v84
    s_nop 1
    v_permlane16_swap_b32 v85, v84
    v_max_f32 v84, v85, v84
    v_sub_f32 v56, v56, v84
    v_sub_f32 v57, v57, v84
    v_sub_f32 v58, v58, v84
    v_sub_f32 v59, v59, v84
    v_sub_f32 v60, v60, v84
    v_sub_f32 v61, v61, v84
    v_sub_f32 v62, v62, v84
    v_sub_f32 v63, v63, v84
    v_sub_f32 v64, v64, v84
    v_sub_f32 v65, v65, v84
    v_exp_f32 v56, v56
    v_exp_f32 v57, v57
    v_exp_f32 v58, v58
    v_exp_f32 v59, v59
    v_exp_f32 v60, v60
    v_exp_f32 v61, v61
    v_exp_f32 v62, v62
    v_exp_f32 v63, v63
    v_exp_f32 v64, v64
    v_exp_f32 v65, v65
    v_cvt_pk_bf16_f32 v68, v56, v57
    v_cvt_pk_bf16_f32 v69, v58, v59
    v_cvt_pk_bf16_f32 v70, v60, v61
    v_cvt_pk_bf16_f32 v71, v62, v63
    v_cvt_pk_bf16_f32 v52, v64, v65
    s_nop 0
    v_mfma_f32_16x16x32_bf16 v[72:75], v[88:91], v[68:71], 0
    v_mfma_f32_16x16x32_bf16 v[76:79], v[92:95], v[68:71], 0
    v_mfma_f32_16x16x32_bf16 v[80:83], v[48:51], v[68:71], 0
    v_mfma_f32_16x16x16_bf16 v[72:75], v[112:113], v[52:53], v[72:75]
    v_mfma_f32_16x16x16_bf16 v[76:79], v[114:115], v[52:53], v[76:79]
    v_mfma_f32_16x16x16_bf16 v[80:83], v[48:49], v[52:53], v[80:83]
    ds_read_b128 v[32:35], v124 offset:6144
    ds_read_b128 v[36:39], v124 offset:7168
    ds_read_b128 v[40:43], v124 offset:34816
    ds_read_b128 v[44:47], v124 offset:35840
    ds_read_b128 v[56:59], v124 offset:36864
    ds_read_b128 v[64:67], v124 offset:38912
    ds_read_b128 v[68:71], v124 offset:39936
    s_waitcnt lgkmcnt(0)
    s_branch L_norm_20
L_kvw_22:
    s_add_u32 s47, s47, 1
    s_add_u32 s49, s49, 1
    s_cmp_ge_u32 s49, 0x10000
    s_cbranch_scc1 L_kvb_23
    s_sleep 4
    buffer_load_dword v125, v119, s[8:11], s28 offen sc1
    s_waitcnt vmcnt(0)
    v_cmp_eq_u32 vcc, 0, v125
    s_nop 0
    s_and_b64 vcc, vcc, s[58:59]
    s_cbranch_scc1 L_kvw_22
    s_branch L_kvb_23
L_mret_25:
    s_mov_b32 s43, m0
    s_mov_b32 m0, 5120
    buffer_load_dwordx4 v[4:7], v117, s[8:11], s48 offen sc1
    buffer_load_dwordx4 v117, s[8:11], s48 offen sc1 lds
    s_mov_b32 m0, 10240
    s_mov_b32 m0, s43
    s_waitcnt vmcnt(0)
    v_max3_u32 v15, v4, v5, v6
    v_max_u32 v15, v15, v7
    v_cmp_lt_u32 vcc, s56, v15
    s_add_u32 s47, s47, 1
    s_add_u32 s49, s49, 1
    s_cmp_ge_u32 s49, 0x10000
    s_cbranch_scc1 L_mgo_26
    s_cbranch_vccnz L_mret_25
    s_branch L_mgo_26
L_smax_28:
    s_add_u32 s47, s47, 1
    s_mov_b32 s35, 0x7f800000
    s_waitcnt lgkmcnt(0)
    s_sub_u32 s43, s30, 0x40800
    s_add_u32 s40, s43, 4096
    s_nop 7
    buffer_load_dwordx4 v[56:59], v117, s[8:11], s43 offen
    buffer_load_dwordx4 v[60:63], v117, s[8:11], s43 offen offset:1024
    buffer_load_dwordx4 v[64:67], v117, s[8:11], s43 offen offset:2048
    buffer_load_dwordx4 v[68:71], v117, s[8:11], s43 offen offset:3072
    buffer_load_dwordx4 v[72:75], v117, s[8:11], s40 offen
    buffer_load_dwordx4 v[76:79], v117, s[8:11], s40 offen offset:1024
    buffer_load_dwordx4 v[80:83], v117, s[8:11], s40 offen offset:2048
    buffer_load_dwordx4 v[84:87], v117, s[8:11], s40 offen offset:3072
    ds_read_b128 v[32:35], v121 offset:16384
    ds_read_b128 v[36:39], v121 offset:17408
    ds_read_b128 v[40:43], v121 offset:18432
    ds_read_b128 v[44:47], v121 offset:19456
    v_mov_b32 v96, 0
    v_mov_b32 v97, 0
    v_mov_b32 v98, 0
    v_mov_b32 v99, 0
    v_mov_b32 v100, 0
    v_mov_b32 v101, 0
    v_mov_b32 v102, 0
    v_mov_b32 v103, 0
    v_mov_b32 v104, 0
    v_mov_b32 v105, 0
    v_mov_b32 v106, 0
    v_mov_b32 v107, 0
    v_mov_b32 v108, 0
    v_mov_b32 v109, 0
    v_mov_b32 v110, 0
    v_mov_b32 v111, 0
    s_waitcnt vmcnt(0) lgkmcnt(0)
    v_mfma_f32_16x16x32_bf16 v[56:59], v[56:59], v[32:35], 0
    v_mfma_f32_16x16x32_bf16 v[56:59], v[60:63], v[36:39], v[56:59]
    v_mfma_f32_16x16x32_bf16 v[56:59], v[64:67], v[40:43], v[56:59]
    v_mfma_f32_16x16x32_bf16 v[56:59], v[68:71], v[44:47], v[56:59]
    v_mfma_f32_16x16x32_bf16 v[60:63], v[72:75], v[32:35], 0
    v_mfma_f32_16x16x32_bf16 v[60:63], v[76:79], v[36:39], v[60:63]
    v_mfma_f32_16x16x32_bf16 v[60:63], v[80:83], v[40:43], v[60:63]
    v_mfma_f32_16x16x32_bf16 v[60:63], v[84:87], v[44:47], v[60:63]
    v_mfma_f32_16x16x32_bf16 v[64:67], v[32:35], v[32:35], 0
    v_mfma_f32_16x16x32_bf16 v[64:67], v[36:39], v[36:39], v[64:67]
    v_mfma_f32_16x16x32_bf16 v[64:67], v[40:43], v[40:43], v[64:67]
    v_mfma_f32_16x16x32_bf16 v[64:67], v[44:47], v[44:47], v[64:67]
    v_max3_f32 v84, v56, v57, v58
    v_max3_f32 v84, v84, v59, v60
    v_max3_f32 v84, v84, v61, v62
    s_nop 4
    v_max3_f32 v84, v84, v63, v64
    v_max_f32 v84, v84, v65
    v_mov_b32 v85, v84
    s_nop 1
    v_permlane32_swap_b32 v85, v84
    v_max_f32 v84, v85, v84
    v_mov_b32 v85, v84
    s_nop 1
    v_permlane16_swap_b32 v85, v84
    v_max_f32 v84, v85, v84
    v_sub_f32 v56, v56, v84
    v_sub_f32 v57, v57, v84
    v_sub_f32 v58, v58, v84
    v_sub_f32 v59, v59, v84
    v_sub_f32 v60, v60, v84
    v_sub_f32 v61, v61, v84
    v_sub_f32 v62, v62, v84
    v_sub_f32 v63, v63, v84
    v_sub_f32 v64, v64, v84
    v_sub_f32 v65, v65, v84
    v_exp_f32 v56, v56
    v_exp_f32 v57, v57
    v_exp_f32 v58, v58
    v_exp_f32 v59, v59
    v_exp_f32 v60, v60
    v_exp_f32 v61, v61
    v_exp_f32 v62, v62
    v_exp_f32 v63, v63
    v_exp_f32 v64, v64
    v_exp_f32 v65, v65
    v_cvt_pk_bf16_f32 v68, v56, v57
    v_cvt_pk_bf16_f32 v69, v58, v59
    v_cvt_pk_bf16_f32 v70, v60, v61
    v_cvt_pk_bf16_f32 v71, v62, v63
    v_cvt_pk_bf16_f32 v52, v64, v65
    s_nop 0
    v_mfma_f32_16x16x32_bf16 v[72:75], v[88:91], v[68:71], 0
    v_mfma_f32_16x16x32_bf16 v[76:79], v[92:95], v[68:71], 0
    v_mfma_f32_16x16x32_bf16 v[80:83], v[48:51], v[68:71], 0
    v_mfma_f32_16x16x16_bf16 v[72:75], v[112:113], v[52:53], v[72:75]
    v_mfma_f32_16x16x16_bf16 v[76:79], v[114:115], v[52:53], v[76:79]
    v_mfma_f32_16x16x16_bf16 v[80:83], v[48:49], v[52:53], v[80:83]
    ds_read_b128 v[32:35], v124 offset:6144
    ds_read_b128 v[36:39], v124 offset:7168
    ds_read_b128 v[40:43], v124 offset:34816
    ds_read_b128 v[44:47], v124 offset:35840
    ds_read_b128 v[56:59], v124 offset:36864
    ds_read_b128 v[64:67], v124 offset:38912
    ds_read_b128 v[68:71], v124 offset:39936
    s_waitcnt lgkmcnt(0)
    s_branch L_norm_27
L_kvw_29:
    s_add_u32 s47, s47, 1
    s_add_u32 s49, s49, 1
    s_cmp_ge_u32 s49, 0x10000
    s_cbranch_scc1 L_kvb_30
    s_sleep 4
    buffer_load_dword v125, v119, s[8:11], s28 offen sc1
    s_waitcnt vmcnt(0)
    v_cmp_eq_u32 vcc, 0, v125
    s_nop 0
    s_and_b64 vcc, vcc, s[58:59]
    s_cbranch_scc1 L_kvw_29
    s_branch L_kvb_30
L_mret_32:
    s_mov_b32 s43, m0
    s_mov_b32 m0, 6144
    buffer_load_dwordx4 v[4:7], v117, s[8:11], s48 offen sc1
    buffer_load_dwordx4 v117, s[8:11], s48 offen sc1 lds
    s_mov_b32 m0, 12288
    s_mov_b32 m0, s43
    s_waitcnt vmcnt(0)
    v_max3_u32 v15, v4, v5, v6
    v_max_u32 v15, v15, v7
    v_cmp_lt_u32 vcc, s56, v15
    s_add_u32 s47, s47, 1
    s_add_u32 s49, s49, 1
    s_cmp_ge_u32 s49, 0x10000
    s_cbranch_scc1 L_mgo_33
    s_cbranch_vccnz L_mret_32
    s_branch L_mgo_33
L_smax_35:
    s_add_u32 s47, s47, 1
    s_mov_b32 s35, 0x7f800000
    s_waitcnt lgkmcnt(0)
    s_sub_u32 s43, s30, 0x41000
    s_add_u32 s40, s43, 4096
    s_nop 7
    buffer_load_dwordx4 v[56:59], v117, s[8:11], s43 offen
    buffer_load_dwordx4 v[60:63], v117, s[8:11], s43 offen offset:1024
    buffer_load_dwordx4 v[64:67], v117, s[8:11], s43 offen offset:2048
    buffer_load_dwordx4 v[68:71], v117, s[8:11], s43 offen offset:3072
    buffer_load_dwordx4 v[72:75], v117, s[8:11], s40 offen
    buffer_load_dwordx4 v[76:79], v117, s[8:11], s40 offen offset:1024
    buffer_load_dwordx4 v[80:83], v117, s[8:11], s40 offen offset:2048
    buffer_load_dwordx4 v[84:87], v117, s[8:11], s40 offen offset:3072
    ds_read_b128 v[32:35], v121 offset:16384
    ds_read_b128 v[36:39], v121 offset:17408
    ds_read_b128 v[40:43], v121 offset:18432
    ds_read_b128 v[44:47], v121 offset:19456
    v_mov_b32 v96, 0
    v_mov_b32 v97, 0
    v_mov_b32 v98, 0
    v_mov_b32 v99, 0
    v_mov_b32 v100, 0
    v_mov_b32 v101, 0
    v_mov_b32 v102, 0
    v_mov_b32 v103, 0
    v_mov_b32 v104, 0
    v_mov_b32 v105, 0
    v_mov_b32 v106, 0
    v_mov_b32 v107, 0
    v_mov_b32 v108, 0
    v_mov_b32 v109, 0
    v_mov_b32 v110, 0
    v_mov_b32 v111, 0
    s_waitcnt vmcnt(0) lgkmcnt(0)
    v_mfma_f32_16x16x32_bf16 v[56:59], v[56:59], v[32:35], 0
    v_mfma_f32_16x16x32_bf16 v[56:59], v[60:63], v[36:39], v[56:59]
    v_mfma_f32_16x16x32_bf16 v[56:59], v[64:67], v[40:43], v[56:59]
    v_mfma_f32_16x16x32_bf16 v[56:59], v[68:71], v[44:47], v[56:59]
    v_mfma_f32_16x16x32_bf16 v[60:63], v[72:75], v[32:35], 0
    v_mfma_f32_16x16x32_bf16 v[60:63], v[76:79], v[36:39], v[60:63]
    v_mfma_f32_16x16x32_bf16 v[60:63], v[80:83], v[40:43], v[60:63]
    v_mfma_f32_16x16x32_bf16 v[60:63], v[84:87], v[44:47], v[60:63]
    v_mfma_f32_16x16x32_bf16 v[64:67], v[32:35], v[32:35], 0
    v_mfma_f32_16x16x32_bf16 v[64:67], v[36:39], v[36:39], v[64:67]
    v_mfma_f32_16x16x32_bf16 v[64:67], v[40:43], v[40:43], v[64:67]
    v_mfma_f32_16x16x32_bf16 v[64:67], v[44:47], v[44:47], v[64:67]
    v_max3_f32 v84, v56, v57, v58
    v_max3_f32 v84, v84, v59, v60
    v_max3_f32 v84, v84, v61, v62
    s_nop 4
    v_max3_f32 v84, v84, v63, v64
    v_max_f32 v84, v84, v65
    v_mov_b32 v85, v84
    s_nop 1
    v_permlane32_swap_b32 v85, v84
    v_max_f32 v84, v85, v84
    v_mov_b32 v85, v84
    s_nop 1
    v_permlane16_swap_b32 v85, v84
    v_max_f32 v84, v85, v84
    v_sub_f32 v56, v56, v84
    v_sub_f32 v57, v57, v84
    v_sub_f32 v58, v58, v84
    v_sub_f32 v59, v59, v84
    v_sub_f32 v60, v60, v84
    v_sub_f32 v61, v61, v84
    v_sub_f32 v62, v62, v84
    v_sub_f32 v63, v63, v84
    v_sub_f32 v64, v64, v84
    v_sub_f32 v65, v65, v84
    v_exp_f32 v56, v56
    v_exp_f32 v57, v57
    v_exp_f32 v58, v58
    v_exp_f32 v59, v59
    v_exp_f32 v60, v60
    v_exp_f32 v61, v61
    v_exp_f32 v62, v62
    v_exp_f32 v63, v63
    v_exp_f32 v64, v64
    v_exp_f32 v65, v65
    v_cvt_pk_bf16_f32 v68, v56, v57
    v_cvt_pk_bf16_f32 v69, v58, v59
    v_cvt_pk_bf16_f32 v70, v60, v61
    v_cvt_pk_bf16_f32 v71, v62, v63
    v_cvt_pk_bf16_f32 v52, v64, v65
    s_nop 0
    v_mfma_f32_16x16x32_bf16 v[72:75], v[88:91], v[68:71], 0
    v_mfma_f32_16x16x32_bf16 v[76:79], v[92:95], v[68:71], 0
    v_mfma_f32_16x16x32_bf16 v[80:83], v[48:51], v[68:71], 0
    v_mfma_f32_16x16x16_bf16 v[72:75], v[112:113], v[52:53], v[72:75]
    v_mfma_f32_16x16x16_bf16 v[76:79], v[114:115], v[52:53], v[76:79]
    v_mfma_f32_16x16x16_bf16 v[80:83], v[48:49], v[52:53], v[80:83]
    ds_read_b128 v[32:35], v124 offset:6144
    ds_read_b128 v[36:39], v124 offset:7168
    ds_read_b128 v[40:43], v124 offset:34816
    ds_read_b128 v[44:47], v124 offset:35840
    ds_read_b128 v[56:59], v124 offset:36864
    ds_read_b128 v[64:67], v124 offset:38912
    ds_read_b128 v[68:71], v124 offset:39936
    s_waitcnt lgkmcnt(0)
    s_branch L_norm_34
L_rslow_37:
    buffer_load_dwordx4 v[4:7], v117, s[8:11], s29 offen sc1
    buffer_load_dwordx4 v[8:11], v117, s[8:11], s53 offen sc1
    buffer_load_dwordx4 v[16:19], v117, s[8:11], s29 offen offset:2048 sc1
    buffer_load_dwordx4 v[20:23], v117, s[8:11], s53 offen offset:2048 sc1
    s_add_u32 s46, s46, 1
    s_add_u32 s49, s49, 1
    s_cmp_ge_u32 s49, 0x10000
    s_cbranch_scc1 L_rgo_38
    s_waitcnt vmcnt(7)
    v_mfma_f32_16x16x32_bf16 v[48:51], v[32:35], v[12:15], 0
    v_xor_b32 v52, s33, v32
    s_waitcnt vmcnt(6)
    v_mfma_f32_16x16x32_bf16 v[48:51], v[36:39], v[12:15], v[48:51]
    v_xor_b32 v53, s33, v36
    v_or_b32 v52, v52, v53
    s_waitcnt vmcnt(5)
    v_mfma_f32_16x16x32_bf16 v[48:51], v[40:43], v[12:15], v[48:51]
    v_xor_b32 v53, s33, v40
    v_or_b32 v52, v52, v53
    s_waitcnt vmcnt(4)
    v_mfma_f32_16x16x32_bf16 v[48:51], v[44:47], v[12:15], v[48:51]
    v_xor_b32 v53, s33, v44
    v_or_b32 v52, v52, v53
    v_and_b32 v52, 1, v52
    v_cmp_ne_u32 vcc, 0, v52
    s_cbranch_vccz L_rgo_38
    buffer_load_dwordx4 v[32:35], v117, s[8:11], s29 offen sc1
    buffer_load_dwordx4 v[36:39], v117, s[8:11], s53 offen sc1
    buffer_load_dwordx4 v[40:43], v117, s[8:11], s29 offen offset:2048 sc1
    buffer_load_dwordx4 v[44:47], v117, s[8:11], s53 offen offset:2048 sc1
    s_add_u32 s46, s46, 1
    s_branch L_rl_36
L_mret_40:
    s_mov_b32 s43, m0
    s_mov_b32 m0, 7168
    buffer_load_dwordx4 v[4:7], v117, s[8:11], s48 offen sc1
    buffer_load_dwordx4 v117, s[8:11], s48 offen sc1 lds
    s_mov_b32 m0, 14336
    s_mov_b32 m0, s43
    s_waitcnt vmcnt(0)
    v_max3_u32 v15, v4, v5, v6
    v_max_u32 v15, v15, v7
    v_cmp_lt_u32 vcc, s56, v15
    s_add_u32 s47, s47, 1
    s_add_u32 s49, s49, 1
    s_cmp_ge_u32 s49, 0x10000
    s_cbranch_scc1 L_mgo_41
    s_cbranch_vccnz L_mret_40
    s_branch L_mgo_41
L_smax_43:
    s_add_u32 s47, s47, 1
    s_mov_b32 s35, 0x7f800000
    s_waitcnt lgkmcnt(0)
    s_sub_u32 s43, s30, 0x41800
    s_add_u32 s40, s43, 4096
    s_nop 7
    buffer_load_dwordx4 v[56:59], v117, s[8:11], s43 offen
    buffer_load_dwordx4 v[60:63], v117, s[8:11], s43 offen offset:1024
    buffer_load_dwordx4 v[64:67], v117, s[8:11], s43 offen offset:2048
    buffer_load_dwordx4 v[68:71], v117, s[8:11], s43 offen offset:3072
    buffer_load_dwordx4 v[72:75], v117, s[8:11], s40 offen
    buffer_load_dwordx4 v[76:79], v117, s[8:11], s40 offen offset:1024
    buffer_load_dwordx4 v[80:83], v117, s[8:11], s40 offen offset:2048
    buffer_load_dwordx4 v[84:87], v117, s[8:11], s40 offen offset:3072
    ds_read_b128 v[32:35], v121 offset:16384
    ds_read_b128 v[36:39], v121 offset:17408
    ds_read_b128 v[40:43], v121 offset:18432
    ds_read_b128 v[44:47], v121 offset:19456
    v_mov_b32 v96, 0
    v_mov_b32 v97, 0
    v_mov_b32 v98, 0
    v_mov_b32 v99, 0
    v_mov_b32 v100, 0
    v_mov_b32 v101, 0
    v_mov_b32 v102, 0
    v_mov_b32 v103, 0
    v_mov_b32 v104, 0
    v_mov_b32 v105, 0
    v_mov_b32 v106, 0
    v_mov_b32 v107, 0
    v_mov_b32 v108, 0
    v_mov_b32 v109, 0
    v_mov_b32 v110, 0
    v_mov_b32 v111, 0
    s_waitcnt vmcnt(0) lgkmcnt(0)
    v_mfma_f32_16x16x32_bf16 v[56:59], v[56:59], v[32:35], 0
    v_mfma_f32_16x16x32_bf16 v[56:59], v[60:63], v[36:39], v[56:59]
    v_mfma_f32_16x16x32_bf16 v[56:59], v[64:67], v[40:43], v[56:59]
    v_mfma_f32_16x16x32_bf16 v[56:59], v[68:71], v[44:47], v[56:59]
    v_mfma_f32_16x16x32_bf16 v[60:63], v[72:75], v[32:35], 0
    v_mfma_f32_16x16x32_bf16 v[60:63], v[76:79], v[36:39], v[60:63]
    v_mfma_f32_16x16x32_bf16 v[60:63], v[80:83], v[40:43], v[60:63]
    v_mfma_f32_16x16x32_bf16 v[60:63], v[84:87], v[44:47], v[60:63]
    v_mfma_f32_16x16x32_bf16 v[64:67], v[32:35], v[32:35], 0
    v_mfma_f32_16x16x32_bf16 v[64:67], v[36:39], v[36:39], v[64:67]
    v_mfma_f32_16x16x32_bf16 v[64:67], v[40:43], v[40:43], v[64:67]
    v_mfma_f32_16x16x32_bf16 v[64:67], v[44:47], v[44:47], v[64:67]
    v_max3_f32 v84, v56, v57, v58
    v_max3_f32 v84, v84, v59, v60
    v_max3_f32 v84, v84, v61, v62
    s_nop 4
    v_max3_f32 v84, v84, v63, v64
    v_max_f32 v84, v84, v65
    v_mov_b32 v85, v84
    s_nop 1
    v_permlane32_swap_b32 v85, v84
    v_max_f32 v84, v85, v84
    v_mov_b32 v85, v84
    s_nop 1
    v_permlane16_swap_b32 v85, v84
    v_max_f32 v84, v85, v84
    v_sub_f32 v56, v56, v84
    v_sub_f32 v57, v57, v84
    v_sub_f32 v58, v58, v84
    v_sub_f32 v59, v59, v84
    v_sub_f32 v60, v60, v84
    v_sub_f32 v61, v61, v84
    v_sub_f32 v62, v62, v84
    v_sub_f32 v63, v63, v84
    v_sub_f32 v64, v64, v84
    v_sub_f32 v65, v65, v84
    v_exp_f32 v56, v56
    v_exp_f32 v57, v57
    v_exp_f32 v58, v58
    v_exp_f32 v59, v59
    v_exp_f32 v60, v60
    v_exp_f32 v61, v61
    v_exp_f32 v62, v62
    v_exp_f32 v63, v63
    v_exp_f32 v64, v64
    v_exp_f32 v65, v65
    v_cvt_pk_bf16_f32 v68, v56, v57
    v_cvt_pk_bf16_f32 v69, v58, v59
    v_cvt_pk_bf16_f32 v70, v60, v61
    v_cvt_pk_bf16_f32 v71, v62, v63
    v_cvt_pk_bf16_f32 v52, v64, v65
    s_nop 0
    v_mfma_f32_16x16x32_bf16 v[72:75], v[88:91], v[68:71], 0
    v_mfma_f32_16x16x32_bf16 v[76:79], v[92:95], v[68:71], 0
    v_mfma_f32_16x16x32_bf16 v[80:83], v[48:51], v[68:71], 0
    v_mfma_f32_16x16x16_bf16 v[72:75], v[112:113], v[52:53], v[72:75]
    v_mfma_f32_16x16x16_bf16 v[76:79], v[114:115], v[52:53], v[76:79]
    v_mfma_f32_16x16x16_bf16 v[80:83], v[48:49], v[52:53], v[80:83]
    ds_read_b128 v[32:35], v124 offset:6144
    ds_read_b128 v[36:39], v124 offset:7168
    ds_read_b128 v[40:43], v124 offset:34816
    ds_read_b128 v[44:47], v124 offset:35840
    ds_read_b128 v[56:59], v124 offset:36864
    ds_read_b128 v[64:67], v124 offset:38912
    ds_read_b128 v[68:71], v124 offset:39936
    s_waitcnt lgkmcnt(0)
    s_branch L_norm_42
L_rslow_45:
    buffer_load_dwordx4 v[4:7], v117, s[8:11], s29 offen sc1
    buffer_load_dwordx4 v[8:11], v117, s[8:11], s53 offen sc1
    buffer_load_dwordx4 v[16:19], v117, s[8:11], s29 offen offset:2048 sc1
    buffer_load_dwordx4 v[20:23], v117, s[8:11], s53 offen offset:2048 sc1
    s_add_u32 s46, s46, 1
    s_add_u32 s49, s49, 1
    s_cmp_ge_u32 s49, 0x10000
    s_cbranch_scc1 L_rgo_46
    s_waitcnt vmcnt(7)
    v_mfma_f32_16x16x32_bf16 v[48:51], v[32:35], v[12:15], 0
    v_xor_b32 v52, s33, v32
    s_waitcnt vmcnt(6)
    v_mfma_f32_16x16x32_bf16 v[48:51], v[36:39], v[12:15], v[48:51]
    v_xor_b32 v53, s33, v36
    v_or_b32 v52, v52, v53
    s_waitcnt vmcnt(5)
    v_mfma_f32_16x16x32_bf16 v[48:51], v[40:43], v[12:15], v[48:51]
    v_xor_b32 v53, s33, v40
    v_or_b32 v52, v52, v53
    s_waitcnt vmcnt(4)
    v_mfma_f32_16x16x32_bf16 v[48:51], v[44:47], v[12:15], v[48:51]
    v_xor_b32 v53, s33, v44
    v_or_b32 v52, v52, v53
    v_and_b32 v52, 1, v52
    v_cmp_ne_u32 vcc, 0, v52
    s_cbranch_vccz L_rgo_46
    buffer_load_dwordx4 v[32:35], v117, s[8:11], s29 offen sc1
    buffer_load_dwordx4 v[36:39], v117, s[8:11], s53 offen sc1
    buffer_load_dwordx4 v[40:43], v117, s[8:11], s29 offen offset:2048 sc1
    buffer_load_dwordx4 v[44:47], v117, s[8:11], s53 offen offset:2048 sc1
    s_add_u32 s46, s46, 1
    s_branch L_rl_44
L_zero:
    s_waitcnt lgkmcnt(0)
    s_and_b32 s9, s9, 0xffff
    s_mov_b32 s10, 0x10000000
    s_mov_b32 s11, 0x20000
    s_and_b32 s93, s93, 0xffff
    s_mov_b32 s94, 0x100
    s_mov_b32 s95, 0x20000
    s_mov_b32 s87, 0
    s_cmp_lg_u32 s86, 0
    s_cbranch_scc1 L_reg_47
    s_lshl_b32 s97, s84, 4
    s_lshl_b32 s96, 1, s85
    v_mov_b32 v250, s96
    v_mov_b32 v251, 256
    s_mov_b64 exec, 1
    buffer_atomic_add_x2 v[250:251], off, s[92:95], s97 offset:64
    s_mov_b64 exec, -1
    s_mov_b32 s86, 1
L_reg_47:
    v_mov_b32 v4, 0
    v_mov_b32 v5, 0
    v_mov_b32 v6, 0
    v_mov_b32 v7, 0
    v_lshlrev_b32 v1, 4, v0
    s_mov_b32 s97, 0x0
    buffer_store_dwordx4 v[4:7], v1, s[8:11], s97 offen sc1
    s_mov_b32 s97, 0x1000
    buffer_store_dwordx4 v[4:7], v1, s[8:11], s97 offen sc1
    s_mov_b32 s97, 0x2000
    buffer_store_dwordx4 v[4:7], v1, s[8:11], s97 offen sc1
    s_mov_b32 s97, 0x3000
    buffer_store_dwordx4 v[4:7], v1, s[8:11], s97 offen sc1
    s_mov_b32 s97, 0x4000
    buffer_store_dwordx4 v[4:7], v1, s[8:11], s97 offen sc1
    s_mov_b32 s97, 0x5000
    buffer_store_dwordx4 v[4:7], v1, s[8:11], s97 offen sc1
    s_mov_b32 s97, 0x6000
    buffer_store_dwordx4 v[4:7], v1, s[8:11], s97 offen sc1
    s_mov_b32 s97, 0x7000
    buffer_store_dwordx4 v[4:7], v1, s[8:11], s97 offen sc1
    s_mov_b32 s97, 0x8000
    buffer_store_dwordx4 v[4:7], v1, s[8:11], s97 offen sc1
    s_waitcnt vmcnt(0)
    s_barrier
    s_cmp_lg_u32 s100, 0
    s_cbranch_scc1 L_flag_48
    v_mov_b32 v2, 1
    s_mov_b64 exec, 1
    buffer_store_dword v2, off, s[92:95], 40 sc1
    s_mov_b64 exec, -1
L_flag_48:
    s_cmp_lg_u32 s100, 0
    s_cbranch_scc1 L_noz
    s_mov_b64 exec, 0xff
    s_mov_b32 s96, 0
L_count:
    buffer_load_dwordx2 v[2:3], v1, s[92:95], 0 offen offset:64 sc1
    s_waitcnt vmcnt(0)
    v_cmp_le_u32 vcc, 8192, v3
    v_add_u32 v2, 1, v2
    v_xor_b32 v3, 8192, v3
    v_or_b32 v2, v2, v3
    s_mov_b32 s4, vcc_lo
    v_cmp_eq_u32 vcc, 0, v2
    v_mov_b32 v2, 1
    s_nop 1
    s_cmp_eq_u32 vcc_lo, 0xff
    s_cbranch_scc1 L_propose
    v_mov_b32 v2, 2
    s_andn2_b32 s4, s4, vcc_lo
    s_cbranch_scc1 L_propose
    s_sleep 2
    s_add_u32 s96, s96, 1
    s_cmp_lt_u32 s96, 0x100
    s_cbranch_scc1 L_count
L_propose:
    v_mov_b32 v3, 0
    s_mov_b64 exec, 1
    buffer_atomic_cmpswap v[2:3], off, s[92:95], 0 offset:36
    s_mov_b64 exec, -1
    s_branch L_noz
L_fallback:
    s_waitcnt vmcnt(0) lgkmcnt(0)
    s_barrier
    v_mbcnt_lo_u32_b32 v0, -1, 0
    v_mbcnt_hi_u32_b32 v0, -1, v0
    s_lshl_b32 s96, s100, 6
    v_add_u32 v0, s96, v0
    s_mov_b32 s97, 44
    s_cmp_lg_u32 s100, 0
    s_cbranch_scc1 L_at_49
    s_mov_b64 exec, 1
    v_mov_b32 v2, 1
    buffer_atomic_add v2, off, s[92:95], s97 sc0
    s_mov_b64 exec, -1
L_at_49:
    s_cmp_lg_u32 s100, 0
    s_cbranch_scc1 L_at2_50
    s_mov_b64 exec, 1
    v_mov_b32 v1, 8
    s_waitcnt vmcnt(0)
    ds_write_b32 v1, v2
    s_waitcnt lgkmcnt(0)
    s_mov_b64 exec, -1
L_at2_50:
    s_barrier
    v_mov_b32 v1, 8
    ds_read_b32 v2, v1
    s_waitcnt lgkmcnt(0)
    v_readfirstlane_b32 s85, v2
    s_barrier
    s_sub_u32 s101, s85, 32
    s_cmp_ge_u32 s85, 32
    s_cbranch_scc1 L_bulk
    s_mov_b32 s20, s85
    v_lshrrev_b32 v4, 6, v0
    s_nop 0
    v_readfirstlane_b32 s21, v4
    v_and_b32 v1, 63, v0
    v_lshrrev_b32 v2, 4, v1
    v_and_b32 v3, 15, v1
    v_lshrrev_b32 v6, 2, v3
    v_lshlrev_b32 v117, 4, v1
    s_lshl_b32 s51, s21, 10
    s_lshl_b32 s52, s21, 11
    s_load_dwordx8 s[60:67], s[0:1], 16
    s_mov_b32 s14, 0x400000
    s_mov_b32 s15, 0x20000
    s_lshl_b32 s41, s20, 8
    s_lshl_b32 s42, s20, 17
    s_lshr_b32 s43, s21, 1
    s_lshl_b32 s43, s43, 2
    v_or_b32 v5, s43, v2
    v_lshlrev_b32 v5, 1, v5
    v_xor_b32 v5, v5, v3
    v_lshrrev_b32 v14, 2, v5
    v_and_b32 v14, 2, v14
    v_lshlrev_b32 v5, 4, v5
    s_lshl_b32 s43, s21, 4
    v_add_u32 v4, s43, v2
    v_lshl_add_u32 v8, v4, 13, v5
    s_waitcnt lgkmcnt(0)
    s_mov_b32 s16, s92
    s_mov_b32 s17, s93
    s_mov_b32 s18, s94
    s_mov_b32 s19, s95
    s_mov_b32 s88, s20
    s_mov_b32 s12, s60
    s_and_b32 s13, s61, 0xffff
    v_xor_b32 v15, 0, v14
    v_lshl_add_u32 v15, v15, 15, v8
    s_add_u32 s43, s41, 0x0
    s_add_u32 m0, s51, 0x8000
    s_nop 0
    buffer_load_dwordx4 v15, s[12:15], s43 offen lds
    s_add_u32 s43, s41, 0x8000
    s_add_u32 m0, s51, 0x9000
    s_nop 0
    buffer_load_dwordx4 v15, s[12:15], s43 offen lds
    s_add_u32 s43, s41, 0x100000
    s_add_u32 m0, s51, 0xa000
    s_nop 0
    buffer_load_dwordx4 v15, s[12:15], s43 offen lds
    s_add_u32 s43, s41, 0x108000
    s_add_u32 m0, s51, 0xb000
    s_nop 0
    buffer_load_dwordx4 v15, s[12:15], s43 offen lds
    s_add_u32 s43, s41, 0x200000
    s_add_u32 m0, s51, 0xc000
    s_nop 0
    buffer_load_dwordx4 v15, s[12:15], s43 offen lds
    s_add_u32 s43, s41, 0x208000
    s_add_u32 m0, s51, 0xd000
    s_nop 0
    buffer_load_dwordx4 v15, s[12:15], s43 offen lds
    s_add_u32 s43, s41, 0x300000
    s_add_u32 m0, s51, 0xe000
    s_nop 0
    buffer_load_dwordx4 v15, s[12:15], s43 offen lds
    s_add_u32 s43, s41, 0x308000
    s_add_u32 m0, s51, 0xf000
    s_nop 0
    buffer_load_dwordx4 v15, s[12:15], s43 offen lds
    v_xor_b32 v15, 2, v14
    v_lshl_add_u32 v15, v15, 15, v8
    s_add_u32 s43, s41, 0x0
    s_add_u32 m0, s51, 0x10000
    s_nop 0
    buffer_load_dwordx4 v15, s[12:15], s43 offen lds
    s_add_u32 s43, s41, 0x8000
    s_add_u32 m0, s51, 0x11000
    s_nop 0
    buffer_load_dwordx4 v15, s[12:15], s43 offen lds
    s_add_u32 s43, s41, 0x100000
    s_add_u32 m0, s51, 0x12000
    s_nop 0
    buffer_load_dwordx4 v15, s[12:15], s43 offen lds
    s_add_u32 s43, s41, 0x108000
    s_add_u32 m0, s51, 0x13000
    s_nop 0
    buffer_load_dwordx4 v15, s[12:15], s43 offen lds
    s_add_u32 s43, s41, 0x200000
    s_add_u32 m0, s51, 0x14000
    s_nop 0
    buffer_load_dwordx4 v15, s[12:15], s43 offen lds
    s_add_u32 s43, s41, 0x208000
    s_add_u32 m0, s51, 0x15000
    s_nop 0
    buffer_load_dwordx4 v15, s[12:15], s43 offen lds
    s_add_u32 s43, s41, 0x300000
    s_add_u32 m0, s51, 0x16000
    s_nop 0
    buffer_load_dwordx4 v15, s[12:15], s43 offen lds
    s_add_u32 s43, s41, 0x308000
    s_add_u32 m0, s51, 0x17000
    s_nop 0
    buffer_load_dwordx4 v15, s[12:15], s43 offen lds
    v_xor_b32 v15, 0, v14
    v_lshl_add_u32 v15, v15, 15, v8
    s_add_u32 s43, s41, 0x80000
    s_add_u32 m0, s51, 0x18000
    s_nop 0
    buffer_load_dwordx4 v15, s[12:15], s43 offen lds
    s_add_u32 s43, s41, 0x88000
    s_add_u32 m0, s51, 0x19000
    s_nop 0
    buffer_load_dwordx4 v15, s[12:15], s43 offen lds
    s_add_u32 s43, s41, 0x180000
    s_add_u32 m0, s51, 0x1a000
    s_nop 0
    buffer_load_dwordx4 v15, s[12:15], s43 offen lds
    s_add_u32 s43, s41, 0x188000
    s_add_u32 m0, s51, 0x1b000
    s_nop 0
    buffer_load_dwordx4 v15, s[12:15], s43 offen lds
    v_and_b32 v4, 2, v3
    v_cmp_ne_u32 vcc, 0, v4
    v_mov_b32 v4, 0x4444
    v_mov_b32 v5, 0xeeee
    v_cndmask_b32 v116, v4, v5, vcc
    v_lshrrev_b32 v5, 1, v2
    v_lshl_add_u32 v4, v6, 3, v5
    s_lshl_b32 s43, s21, 1
    v_add_u32 v4, s43, v4
    v_add_u32 v5, s20, v4
    v_and_b32 v5, 31, v5
    v_lshl_add_u32 v4, v4, 6, v5
    v_and_b32 v5, 1, v2
    v_lshl_add_u32 v4, v4, 1, v5
    v_and_b32 v5, 3, v3
    v_lshl_add_u32 v4, v4, 2, v5
    v_lshlrev_b32 v118, 4, v4
    v_and_b32 v4, 1, v2
    v_lshlrev_b32 v4, 2, v4
    v_and_b32 v7, 2, v2
    v_add_u32 v4, v4, v7
    v_and_b32 v7, 1, v6
    v_add_u32 v4, v4, v7
    v_lshl_add_u32 v4, v4, 2, v5
    v_lshlrev_b32 v4, 2, v4
    s_and_b32 s43, s21, 1
    s_lshl_b32 s43, s43, 12
    s_lshl_b32 s40, s20, 7
    s_add_u32 s43, s43, s40
    v_add_u32 v119, s43, v4
    v_sub_u32 v7, 0, v2
    v_and_b32 v7, 3, v7
    v_xor_b32 v7, v7, v6
    v_lshl_add_u32 v4, v2, 4, v7
    v_and_b32 v5, 3, v3
    v_lshl_add_u32 v4, v4, 2, v5
    s_add_u32 s43, s51, 16384
    v_lshl_add_u32 v120, v4, 2, s43
    v_sub_u32 v7, 0, v6
    v_and_b32 v7, 3, v7
    v_xor_b32 v7, v7, v2
    v_lshl_add_u32 v4, v3, 2, v7
    v_lshlrev_b32 v121, 4, v4
    v_and_b32 v5, 1, v3
    v_lshl_add_u32 v4, v6, 1, v5
    v_lshl_add_u32 v4, v2, 3, v4
    v_lshlrev_b32 v127, 4, v4
    v_and_or_b32 v122, v116, 8, v127
    s_lshl_b32 s43, s21, 13
    s_add_u32 s43, s43, 32768
    v_add_u32 v123, s43, v117
    v_add_u32 v124, 0x10000, v123
    s_mov_b32 s36, 0xcccccccc
    s_mov_b32 s37, 0xcccccccc
    s_mov_b32 s38, 0x00ff00ff
    s_mov_b32 s39, 0x00ff00ff
    s_mov_b32 s34, 0x3e0293ee
    s_mov_b32 s35, 0x49800000
    s_mov_b32 s50, 0x3f803f80
    v_and_b32 v5, 1, v2
    v_or_b32 v5, 0, v5
    v_xor_b32 v5, v5, v6
    v_and_b32 v7, 2, v5
    v_add_u32 v5, v5, v7
    v_lshlrev_b32 v5, 6, v5
    v_and_b32 v7, 3, v3
    v_lshl_add_u32 v7, v7, 4, v5
    s_lshl_b32 s43, s21, 2
    v_add_u32 v4, s43, v2
    v_lshl_add_u32 v10, v4, 10, v7
    v_and_b32 v5, 1, v2
    v_or_b32 v5, 2, v5
    v_xor_b32 v5, v5, v6
    v_and_b32 v7, 2, v5
    v_add_u32 v5, v5, v7
    v_lshlrev_b32 v5, 6, v5
    v_and_b32 v7, 3, v3
    v_lshl_add_u32 v7, v7, 4, v5
    s_lshl_b32 s43, s21, 2
    v_add_u32 v4, s43, v2
    v_lshl_add_u32 v9, v4, 10, v7
    v_and_b32 v5, 1, v2
    v_lshl_add_u32 v4, v5, 3, v6
    v_lshrrev_b32 v7, 1, v2
    v_lshl_add_u32 v4, v7, 5, v4
    v_lshlrev_b32 v4, 8, v4
    v_lshl_or_b32 v5, v5, 2, v6
    v_lshlrev_b32 v5, 5, v5
    s_lshl_b32 s43, s21, 6
    v_xor_b32 v5, s43, v5
    v_add_u32 v4, v4, v5
    v_and_b32 v5, 3, v3
    v_lshl_add_u32 v4, v5, 3, v4
    v_add_u32 v11, 32768, v4
    s_and_b32 s43, s21, 1
    s_lshl_b32 s43, s43, 12
    v_add_u32 v11, s43, v11
    v_and_b32 v5, 1, v2
    v_lshlrev_b32 v4, 4, v5
    v_lshl_add_u32 v4, v7, 2, v4
    v_and_b32 v7, 1, v6
    v_add_u32 v4, v4, v7
    s_lshl_b32 s43, s21, 5
    v_add_u32 v4, s43, v4
    v_lshlrev_b32 v4, 8, v4
    v_lshl_or_b32 v5, v5, 1, v7
    s_lshl_b32 s43, s21, 1
    s_and_b32 s43, s43, 3
    v_xor_b32 v5, s43, v5
    v_lshl_add_u32 v4, v5, 6, v4
    v_lshrrev_b32 v5, 1, v6
    v_lshl_add_u32 v4, v5, 5, v4
    v_and_b32 v5, 3, v3
    v_lshl_add_u32 v4, v5, 3, v4
    v_add_u32 v12, 32768, v4
    v_mov_b32 v16, -1
    v_mov_b32 v17, -1
    v_mov_b32 v18, -1
    v_mov_b32 v19, -1
    s_lshl_b32 s43, s20, 13
    s_add_u32 s43, s43, 0x7100000
    s_and_b32 s40, s21, 1
    s_lshl_b32 s40, s40, 12
    s_add_u32 s29, s43, s40
    s_add_u32 s43, s43, s52
    s_xor_b32 s40, s43, 0x40000
    buffer_store_dwordx4 v[16:19], v117, s[8:11], s43 offen sc1
    buffer_store_dwordx4 v[16:19], v117, s[8:11], s43 offen offset:1024 sc1
    buffer_store_dwordx4 v[16:19], v117, s[8:11], s40 offen sc1
    buffer_store_dwordx4 v[16:19], v117, s[8:11], s40 offen offset:1024 sc1
    s_mov_b32 s43, 0x7012000
    buffer_store_dword v16, v119, s[8:11], s43 offen sc1
    s_mov_b32 s43, 0x7014000
    buffer_store_dword v16, v119, s[8:11], s43 offen sc1
    s_mov_b32 s43, 0x7016000
    buffer_store_dword v16, v119, s[8:11], s43 offen sc1
    s_load_dwordx2 s[4:5], s[0:1], 8
    s_waitcnt lgkmcnt(0)
    s_and_b32 s5, s5, 0xffff
    s_mov_b32 s6, 8192
    s_mov_b32 s7, 0x20000
    v_and_b32 v20, 1, v2
    v_and_b32 v21, 1, v6
    v_lshl_add_u32 v20, v20, 1, v21
    v_lshlrev_b32 v20, 9, v20
    v_and_b32 v21, 3, v3
    v_lshl_add_u32 v20, v21, 4, v20
    v_and_b32 v21, 2, v2
    v_add_u32 v20, v20, v21
    s_and_b32 s43, s20, 1
    s_lshl_b32 s43, s43, 11
    s_bfe_u32 s40, s20, 0x20001
    s_lshl_b32 s40, s40, 7
    s_add_u32 s43, s43, s40
    s_and_b32 s40, s21, 1
    s_lshl_b32 s40, s40, 6
    s_add_u32 s43, s43, s40
    s_lshr_b32 s40, s20, 3
    s_lshl_b32 s40, s40, 2
    s_add_u32 s43, s43, s40
    v_add_u32 v20, s43, v20
    v_lshlrev_b32 v20, 1, v20
    buffer_load_dword v21, v20, s[4:7], 0 offen
    s_mov_b32 s57, 0
    s_lshl_b32 s43, s20, 13
    s_add_u32 s43, s43, s52
    s_add_u32 s30, s43, 0x1000000
    s_add_u32 s31, s43, 0x2000000
    s_lshr_b32 s43, s43, 1
    s_add_u32 s32, s43, 0x220000
    s_waitcnt vmcnt(20)
    s_barrier
    v_xor_b32 v13, 0x0, v11
    v_add_u32 v13, 0x0, v13
    ds_read_b64_tr_b16 v[32:33], v13
    ds_read_b64_tr_b16 v[34:35], v13 offset:1024
    ds_read_b64_tr_b16 v[36:37], v13 offset:16384
    ds_read_b64_tr_b16 v[38:39], v13 offset:17408
    v_xor_b32 v13, 0x20, v11
    v_add_u32 v13, 0x0, v13
    ds_read_b64_tr_b16 v[40:41], v13
    ds_read_b64_tr_b16 v[42:43], v13 offset:1024
    ds_read_b64_tr_b16 v[44:45], v13 offset:16384
    ds_read_b64_tr_b16 v[46:47], v13 offset:17408
    v_xor_b32 v13, 0x1000, v11
    v_add_u32 v13, 0x0, v13
    ds_read_b64_tr_b16 a[0:1], v13
    ds_read_b64_tr_b16 a[2:3], v13 offset:1024
    ds_read_b64_tr_b16 a[4:5], v13 offset:16384
    ds_read_b64_tr_b16 a[6:7], v13 offset:17408
    v_xor_b32 v13, 0x1020, v11
    v_add_u32 v13, 0x0, v13
    ds_read_b64_tr_b16 a[8:9], v13
    ds_read_b64_tr_b16 a[10:11], v13 offset:1024
    ds_read_b64_tr_b16 a[12:13], v13 offset:16384
    ds_read_b64_tr_b16 a[14:15], v13 offset:17408
    s_waitcnt lgkmcnt(0)
    s_barrier
    s_add_u32 s43, s41, 0x280000
    s_add_u32 m0, s51, 0x1c000
    s_nop 0
    buffer_load_dwordx4 v15, s[12:15], s43 offen lds
    s_add_u32 s43, s41, 0x288000
    s_add_u32 m0, s51, 0x1d000
    s_nop 0
    buffer_load_dwordx4 v15, s[12:15], s43 offen lds
    s_add_u32 s43, s41, 0x380000
    s_add_u32 m0, s51, 0x1e000
    s_nop 0
    buffer_load_dwordx4 v15, s[12:15], s43 offen lds
    s_add_u32 s43, s41, 0x388000
    s_add_u32 m0, s51, 0x1f000
    s_nop 0
    buffer_load_dwordx4 v15, s[12:15], s43 offen lds
    v_xor_b32 v15, 2, v14
    v_lshl_add_u32 v15, v15, 15, v8
    s_add_u32 s43, s41, 0x80000
    s_add_u32 m0, s51, 0x20000
    s_nop 0
    buffer_load_dwordx4 v15, s[12:15], s43 offen lds
    s_add_u32 s43, s41, 0x88000
    s_add_u32 m0, s51, 0x21000
    s_nop 0
    buffer_load_dwordx4 v15, s[12:15], s43 offen lds
    s_add_u32 s43, s41, 0x180000
    s_add_u32 m0, s51, 0x22000
    s_nop 0
    buffer_load_dwordx4 v15, s[12:15], s43 offen lds
    s_add_u32 s43, s41, 0x188000
    s_add_u32 m0, s51, 0x23000
    s_nop 0
    buffer_load_dwordx4 v15, s[12:15], s43 offen lds
    s_waitcnt vmcnt(20)
    s_barrier
    v_xor_b32 v13, 0x0, v11
    v_add_u32 v13, 0x8000, v13
    ds_read_b64_tr_b16 a[32:33], v13
    ds_read_b64_tr_b16 a[34:35], v13 offset:1024
    ds_read_b64_tr_b16 a[36:37], v13 offset:16384
    ds_read_b64_tr_b16 a[38:39], v13 offset:17408
    v_xor_b32 v13, 0x20, v11
    v_add_u32 v13, 0x8000, v13
    ds_read_b64_tr_b16 a[40:41], v13
    ds_read_b64_tr_b16 a[42:43], v13 offset:1024
    ds_read_b64_tr_b16 a[44:45], v13 offset:16384
    ds_read_b64_tr_b16 a[46:47], v13 offset:17408
    v_xor_b32 v13, 0x1000, v11
    v_add_u32 v13, 0x8000, v13
    ds_read_b64_tr_b16 a[64:65], v13
    ds_read_b64_tr_b16 a[66:67], v13 offset:1024
    ds_read_b64_tr_b16 a[68:69], v13 offset:16384
    ds_read_b64_tr_b16 a[70:71], v13 offset:17408
    v_xor_b32 v13, 0x1020, v11
    v_add_u32 v13, 0x8000, v13
    ds_read_b64_tr_b16 a[72:73], v13
    ds_read_b64_tr_b16 a[74:75], v13 offset:1024
    ds_read_b64_tr_b16 a[76:77], v13 offset:16384
    ds_read_b64_tr_b16 a[78:79], v13 offset:17408
    s_waitcnt lgkmcnt(0)
    s_barrier
    s_add_u32 s43, s41, 0x280000
    s_add_u32 m0, s51, 0x24000
    s_nop 0
    buffer_load_dwordx4 v15, s[12:15], s43 offen lds
    s_add_u32 s43, s41, 0x288000
    s_add_u32 m0, s51, 0x25000
    s_nop 0
    buffer_load_dwordx4 v15, s[12:15], s43 offen lds
    s_add_u32 s43, s41, 0x380000
    s_add_u32 m0, s51, 0x26000
    s_nop 0
    buffer_load_dwordx4 v15, s[12:15], s43 offen lds
    s_add_u32 s43, s41, 0x388000
    s_add_u32 m0, s51, 0x27000
    s_nop 0
    buffer_load_dwordx4 v15, s[12:15], s43 offen lds
    s_mov_b32 s12, s62
    s_and_b32 s13, s63, 0xffff
    v_xor_b32 v15, 0, v14
    v_lshl_add_u32 v15, v15, 15, v8
    s_add_u32 s43, s41, 0x0
    s_add_u32 m0, s51, 0x8000
    s_nop 0
    buffer_load_dwordx4 v15, s[12:15], s43 offen lds
    s_add_u32 s43, s41, 0x8000
    s_add_u32 m0, s51, 0x9000
    s_nop 0
    buffer_load_dwordx4 v15, s[12:15], s43 offen lds
    s_add_u32 s43, s41, 0x100000
    s_add_u32 m0, s51, 0xa000
    s_nop 0
    buffer_load_dwordx4 v15, s[12:15], s43 offen lds
    s_add_u32 s43, s41, 0x108000
    s_add_u32 m0, s51, 0xb000
    s_nop 0
    buffer_load_dwordx4 v15, s[12:15], s43 offen lds
    s_waitcnt vmcnt(12)
    s_barrier
    v_xor_b32 v13, 0x0, v11
    v_add_u32 v13, 0x10000, v13
    ds_read_b64_tr_b16 v[48:49], v13
    ds_read_b64_tr_b16 v[50:51], v13 offset:1024
    ds_read_b64_tr_b16 v[52:53], v13 offset:16384
    ds_read_b64_tr_b16 v[54:55], v13 offset:17408
    v_xor_b32 v13, 0x20, v11
    v_add_u32 v13, 0x10000, v13
    ds_read_b64_tr_b16 v[56:57], v13
    ds_read_b64_tr_b16 v[58:59], v13 offset:1024
    ds_read_b64_tr_b16 v[60:61], v13 offset:16384
    ds_read_b64_tr_b16 v[62:63], v13 offset:17408
    v_xor_b32 v13, 0x1000, v11
    v_add_u32 v13, 0x10000, v13
    ds_read_b64_tr_b16 a[16:17], v13
    ds_read_b64_tr_b16 a[18:19], v13 offset:1024
    ds_read_b64_tr_b16 a[20:21], v13 offset:16384
    ds_read_b64_tr_b16 a[22:23], v13 offset:17408
    v_xor_b32 v13, 0x1020, v11
    v_add_u32 v13, 0x10000, v13
    ds_read_b64_tr_b16 a[24:25], v13
    ds_read_b64_tr_b16 a[26:27], v13 offset:1024
    ds_read_b64_tr_b16 a[28:29], v13 offset:16384
    ds_read_b64_tr_b16 a[30:31], v13 offset:17408
    s_waitcnt lgkmcnt(0)
    s_barrier
    s_add_u32 s43, s41, 0x200000
    s_add_u32 m0, s51, 0xc000
    s_nop 0
    buffer_load_dwordx4 v15, s[12:15], s43 offen lds
    s_add_u32 s43, s41, 0x208000
    s_add_u32 m0, s51, 0xd000
    s_nop 0
    buffer_load_dwordx4 v15, s[12:15], s43 offen lds
    s_add_u32 s43, s41, 0x300000
    s_add_u32 m0, s51, 0xe000
    s_nop 0
    buffer_load_dwordx4 v15, s[12:15], s43 offen lds
    s_add_u32 s43, s41, 0x308000
    s_add_u32 m0, s51, 0xf000
    s_nop 0
    buffer_load_dwordx4 v15, s[12:15], s43 offen lds
    v_xor_b32 v15, 2, v14
    v_lshl_add_u32 v15, v15, 15, v8
    s_add_u32 s43, s41, 0x0
    s_add_u32 m0, s51, 0x10000
    s_nop 0
    buffer_load_dwordx4 v15, s[12:15], s43 offen lds
    s_add_u32 s43, s41, 0x8000
    s_add_u32 m0, s51, 0x11000
    s_nop 0
    buffer_load_dwordx4 v15, s[12:15], s43 offen lds
    s_add_u32 s43, s41, 0x100000
    s_add_u32 m0, s51, 0x12000
    s_nop 0
    buffer_load_dwordx4 v15, s[12:15], s43 offen lds
    s_add_u32 s43, s41, 0x108000
    s_add_u32 m0, s51, 0x13000
    s_nop 0
    buffer_load_dwordx4 v15, s[12:15], s43 offen lds
    s_waitcnt vmcnt(12)
    s_barrier
    v_xor_b32 v13, 0x0, v11
    v_add_u32 v13, 0x18000, v13
    ds_read_b64_tr_b16 a[48:49], v13
    ds_read_b64_tr_b16 a[50:51], v13 offset:1024
    ds_read_b64_tr_b16 a[52:53], v13 offset:16384
    ds_read_b64_tr_b16 a[54:55], v13 offset:17408
    v_xor_b32 v13, 0x20, v11
    v_add_u32 v13, 0x18000, v13
    ds_read_b64_tr_b16 a[56:57], v13
    ds_read_b64_tr_b16 a[58:59], v13 offset:1024
    ds_read_b64_tr_b16 a[60:61], v13 offset:16384
    ds_read_b64_tr_b16 a[62:63], v13 offset:17408
    v_xor_b32 v13, 0x1000, v11
    v_add_u32 v13, 0x18000, v13
    ds_read_b64_tr_b16 a[80:81], v13
    ds_read_b64_tr_b16 a[82:83], v13 offset:1024
    ds_read_b64_tr_b16 a[84:85], v13 offset:16384
    ds_read_b64_tr_b16 a[86:87], v13 offset:17408
    v_xor_b32 v13, 0x1020, v11
    v_add_u32 v13, 0x18000, v13
    ds_read_b64_tr_b16 a[88:89], v13
    ds_read_b64_tr_b16 a[90:91], v13 offset:1024
    ds_read_b64_tr_b16 a[92:93], v13 offset:16384
    ds_read_b64_tr_b16 a[94:95], v13 offset:17408
    s_waitcnt lgkmcnt(0)
    s_barrier
    s_add_u32 s43, s41, 0x200000
    s_add_u32 m0, s51, 0x14000
    s_nop 0
    buffer_load_dwordx4 v15, s[12:15], s43 offen lds
    s_add_u32 s43, s41, 0x208000
    s_add_u32 m0, s51, 0x15000
    s_nop 0
    buffer_load_dwordx4 v15, s[12:15], s43 offen lds
    s_add_u32 s43, s41, 0x300000
    s_add_u32 m0, s51, 0x16000
    s_nop 0
    buffer_load_dwordx4 v15, s[12:15], s43 offen lds
    s_add_u32 s43, s41, 0x308000
    s_add_u32 m0, s51, 0x17000
    s_nop 0
    buffer_load_dwordx4 v15, s[12:15], s43 offen lds
    v_xor_b32 v15, 0, v14
    v_lshl_add_u32 v15, v15, 15, v8
    s_add_u32 s43, s41, 0x80000
    s_add_u32 m0, s51, 0x18000
    s_nop 0
    buffer_load_dwordx4 v15, s[12:15], s43 offen lds
    s_add_u32 s43, s41, 0x88000
    s_add_u32 m0, s51, 0x19000
    s_nop 0
    buffer_load_dwordx4 v15, s[12:15], s43 offen lds
    s_add_u32 s43, s41, 0x180000
    s_add_u32 m0, s51, 0x1a000
    s_nop 0
    buffer_load_dwordx4 v15, s[12:15], s43 offen lds
    s_add_u32 s43, s41, 0x188000
    s_add_u32 m0, s51, 0x1b000
    s_nop 0
    buffer_load_dwordx4 v15, s[12:15], s43 offen lds
    s_waitcnt vmcnt(12)
    v_min_u32 v21, 0xfffffffe, v21
    s_mov_b32 s43, 0x7010000
    s_mov_b64 exec, s[38:39]
    buffer_store_dword v21, v119, s[8:11], s43 offen sc1
    s_mov_b64 exec, -1
    s_barrier
    v_xor_b32 v13, 0x0, v11
    v_add_u32 v13, 0x0, v13
    ds_read_b64_tr_b16 v[64:65], v13
    ds_read_b64_tr_b16 v[66:67], v13 offset:1024
    ds_read_b64_tr_b16 v[68:69], v13 offset:16384
    ds_read_b64_tr_b16 v[70:71], v13 offset:17408
    v_xor_b32 v13, 0x20, v11
    v_add_u32 v13, 0x0, v13
    ds_read_b64_tr_b16 v[72:73], v13
    ds_read_b64_tr_b16 v[74:75], v13 offset:1024
    ds_read_b64_tr_b16 v[76:77], v13 offset:16384
    ds_read_b64_tr_b16 v[78:79], v13 offset:17408
    v_xor_b32 v13, 0x1000, v11
    v_add_u32 v13, 0x0, v13
    ds_read_b64_tr_b16 a[96:97], v13
    ds_read_b64_tr_b16 a[98:99], v13 offset:1024
    ds_read_b64_tr_b16 a[100:101], v13 offset:16384
    ds_read_b64_tr_b16 a[102:103], v13 offset:17408
    v_xor_b32 v13, 0x1020, v11
    v_add_u32 v13, 0x0, v13
    ds_read_b64_tr_b16 a[104:105], v13
    ds_read_b64_tr_b16 a[106:107], v13 offset:1024
    ds_read_b64_tr_b16 a[108:109], v13 offset:16384
    ds_read_b64_tr_b16 a[110:111], v13 offset:17408
    s_waitcnt lgkmcnt(0)
    s_barrier
    s_add_u32 s43, s41, 0x280000
    s_add_u32 m0, s51, 0x1c000
    s_nop 0
    buffer_load_dwordx4 v15, s[12:15], s43 offen lds
    s_add_u32 s43, s41, 0x288000
    s_add_u32 m0, s51, 0x1d000
    s_nop 0
    buffer_load_dwordx4 v15, s[12:15], s43 offen lds
    s_add_u32 s43, s41, 0x380000
    s_add_u32 m0, s51, 0x1e000
    s_nop 0
    buffer_load_dwordx4 v15, s[12:15], s43 offen lds
    s_add_u32 s43, s41, 0x388000
    s_add_u32 m0, s51, 0x1f000
    s_nop 0
    buffer_load_dwordx4 v15, s[12:15], s43 offen lds
    v_xor_b32 v15, 2, v14
    v_lshl_add_u32 v15, v15, 15, v8
    s_add_u32 s43, s41, 0x80000
    s_add_u32 m0, s51, 0x20000
    s_nop 0
    buffer_load_dwordx4 v15, s[12:15], s43 offen lds
    s_add_u32 s43, s41, 0x88000
    s_add_u32 m0, s51, 0x21000
    s_nop 0
    buffer_load_dwordx4 v15, s[12:15], s43 offen lds
    s_add_u32 s43, s41, 0x180000
    s_add_u32 m0, s51, 0x22000
    s_nop 0
    buffer_load_dwordx4 v15, s[12:15], s43 offen lds
    s_add_u32 s43, s41, 0x188000
    s_add_u32 m0, s51, 0x23000
    s_nop 0
    buffer_load_dwordx4 v15, s[12:15], s43 offen lds
    s_waitcnt vmcnt(12)
    s_barrier
    v_xor_b32 v13, 0x0, v11
    v_add_u32 v13, 0x8000, v13
    ds_read_b64_tr_b16 a[128:129], v13
    ds_read_b64_tr_b16 a[130:131], v13 offset:1024
    ds_read_b64_tr_b16 a[132:133], v13 offset:16384
    ds_read_b64_tr_b16 a[134:135], v13 offset:17408
    v_xor_b32 v13, 0x20, v11
    v_add_u32 v13, 0x8000, v13
    ds_read_b64_tr_b16 a[136:137], v13
    ds_read_b64_tr_b16 a[138:139], v13 offset:1024
    ds_read_b64_tr_b16 a[140:141], v13 offset:16384
    ds_read_b64_tr_b16 a[142:143], v13 offset:17408
    v_xor_b32 v13, 0x1000, v11
    v_add_u32 v13, 0x8000, v13
    ds_read_b64_tr_b16 a[160:161], v13
    ds_read_b64_tr_b16 a[162:163], v13 offset:1024
    ds_read_b64_tr_b16 a[164:165], v13 offset:16384
    ds_read_b64_tr_b16 a[166:167], v13 offset:17408
    v_xor_b32 v13, 0x1020, v11
    v_add_u32 v13, 0x8000, v13
    ds_read_b64_tr_b16 a[168:169], v13
    ds_read_b64_tr_b16 a[170:171], v13 offset:1024
    ds_read_b64_tr_b16 a[172:173], v13 offset:16384
    ds_read_b64_tr_b16 a[174:175], v13 offset:17408
    s_waitcnt lgkmcnt(0)
    s_barrier
    s_add_u32 s43, s41, 0x280000
    s_add_u32 m0, s51, 0x24000
    s_nop 0
    buffer_load_dwordx4 v15, s[12:15], s43 offen lds
    s_add_u32 s43, s41, 0x288000
    s_add_u32 m0, s51, 0x25000
    s_nop 0
    buffer_load_dwordx4 v15, s[12:15], s43 offen lds
    s_add_u32 s43, s41, 0x380000
    s_add_u32 m0, s51, 0x26000
    s_nop 0
    buffer_load_dwordx4 v15, s[12:15], s43 offen lds
    s_add_u32 s43, s41, 0x388000
    s_add_u32 m0, s51, 0x27000
    s_nop 0
    buffer_load_dwordx4 v15, s[12:15], s43 offen lds
    s_mov_b32 s12, s64
    s_and_b32 s13, s65, 0xffff
    v_xor_b32 v15, 0, v14
    v_lshl_add_u32 v15, v15, 15, v8
    s_add_u32 s43, s41, 0x0
    s_add_u32 m0, s51, 0x8000
    s_nop 0
    buffer_load_dwordx4 v15, s[12:15], s43 offen lds
    s_add_u32 s43, s41, 0x8000
    s_add_u32 m0, s51, 0x9000
    s_nop 0
    buffer_load_dwordx4 v15, s[12:15], s43 offen lds
    s_add_u32 s43, s41, 0x100000
    s_add_u32 m0, s51, 0xa000
    s_nop 0
    buffer_load_dwordx4 v15, s[12:15], s43 offen lds
    s_add_u32 s43, s41, 0x108000
    s_add_u32 m0, s51, 0xb000
    s_nop 0
    buffer_load_dwordx4 v15, s[12:15], s43 offen lds
    s_waitcnt vmcnt(12)
    s_barrier
    v_xor_b32 v13, 0x0, v11
    v_add_u32 v13, 0x10000, v13
    ds_read_b64_tr_b16 v[80:81], v13
    ds_read_b64_tr_b16 v[82:83], v13 offset:1024
    ds_read_b64_tr_b16 v[84:85], v13 offset:16384
    ds_read_b64_tr_b16 v[86:87], v13 offset:17408
    v_xor_b32 v13, 0x20, v11
    v_add_u32 v13, 0x10000, v13
    ds_read_b64_tr_b16 v[88:89], v13
    ds_read_b64_tr_b16 v[90:91], v13 offset:1024
    ds_read_b64_tr_b16 v[92:93], v13 offset:16384
    ds_read_b64_tr_b16 v[94:95], v13 offset:17408
    v_xor_b32 v13, 0x1000, v11
    v_add_u32 v13, 0x10000, v13
    ds_read_b64_tr_b16 a[112:113], v13
    ds_read_b64_tr_b16 a[114:115], v13 offset:1024
    ds_read_b64_tr_b16 a[116:117], v13 offset:16384
    ds_read_b64_tr_b16 a[118:119], v13 offset:17408
    v_xor_b32 v13, 0x1020, v11
    v_add_u32 v13, 0x10000, v13
    ds_read_b64_tr_b16 a[120:121], v13
    ds_read_b64_tr_b16 a[122:123], v13 offset:1024
    ds_read_b64_tr_b16 a[124:125], v13 offset:16384
    ds_read_b64_tr_b16 a[126:127], v13 offset:17408
    s_waitcnt lgkmcnt(0)
    s_barrier
    s_add_u32 s43, s41, 0x200000
    s_add_u32 m0, s51, 0xc000
    s_nop 0
    buffer_load_dwordx4 v15, s[12:15], s43 offen lds
    s_add_u32 s43, s41, 0x208000
    s_add_u32 m0, s51, 0xd000
    s_nop 0
    buffer_load_dwordx4 v15, s[12:15], s43 offen lds
    s_add_u32 s43, s41, 0x300000
    s_add_u32 m0, s51, 0xe000
    s_nop 0
    buffer_load_dwordx4 v15, s[12:15], s43 offen lds
    s_add_u32 s43, s41, 0x308000
    s_add_u32 m0, s51, 0xf000
    s_nop 0
    buffer_load_dwordx4 v15, s[12:15], s43 offen lds
    v_xor_b32 v15, 2, v14
    v_lshl_add_u32 v15, v15, 15, v8
    s_add_u32 s43, s41, 0x0
    s_add_u32 m0, s51, 0x10000
    s_nop 0
    buffer_load_dwordx4 v15, s[12:15], s43 offen lds
    s_add_u32 s43, s41, 0x8000
    s_add_u32 m0, s51, 0x11000
    s_nop 0
    buffer_load_dwordx4 v15, s[12:15], s43 offen lds
    s_add_u32 s43, s41, 0x100000
    s_add_u32 m0, s51, 0x12000
    s_nop 0
    buffer_load_dwordx4 v15, s[12:15], s43 offen lds
    s_add_u32 s43, s41, 0x108000
    s_add_u32 m0, s51, 0x13000
    s_nop 0
    buffer_load_dwordx4 v15, s[12:15], s43 offen lds
    s_waitcnt vmcnt(12)
    s_barrier
    v_xor_b32 v13, 0x0, v11
    v_add_u32 v13, 0x18000, v13
    ds_read_b64_tr_b16 a[144:145], v13
    ds_read_b64_tr_b16 a[146:147], v13 offset:1024
    ds_read_b64_tr_b16 a[148:149], v13 offset:16384
    ds_read_b64_tr_b16 a[150:151], v13 offset:17408
    v_xor_b32 v13, 0x20, v11
    v_add_u32 v13, 0x18000, v13
    ds_read_b64_tr_b16 a[152:153], v13
    ds_read_b64_tr_b16 a[154:155], v13 offset:1024
    ds_read_b64_tr_b16 a[156:157], v13 offset:16384
    ds_read_b64_tr_b16 a[158:159], v13 offset:17408
    v_xor_b32 v13, 0x1000, v11
    v_add_u32 v13, 0x18000, v13
    ds_read_b64_tr_b16 a[176:177], v13
    ds_read_b64_tr_b16 a[178:179], v13 offset:1024
    ds_read_b64_tr_b16 a[180:181], v13 offset:16384
    ds_read_b64_tr_b16 a[182:183], v13 offset:17408
    v_xor_b32 v13, 0x1020, v11
    v_add_u32 v13, 0x18000, v13
    ds_read_b64_tr_b16 a[184:185], v13
    ds_read_b64_tr_b16 a[186:187], v13 offset:1024
    ds_read_b64_tr_b16 a[188:189], v13 offset:16384
    ds_read_b64_tr_b16 a[190:191], v13 offset:17408
    s_waitcnt lgkmcnt(0)
    s_barrier
    s_add_u32 s43, s41, 0x200000
    s_add_u32 m0, s51, 0x14000
    s_nop 0
    buffer_load_dwordx4 v15, s[12:15], s43 offen lds
    s_add_u32 s43, s41, 0x208000
    s_add_u32 m0, s51, 0x15000
    s_nop 0
    buffer_load_dwordx4 v15, s[12:15], s43 offen lds
    s_add_u32 s43, s41, 0x300000
    s_add_u32 m0, s51, 0x16000
    s_nop 0
    buffer_load_dwordx4 v15, s[12:15], s43 offen lds
    s_add_u32 s43, s41, 0x308000
    s_add_u32 m0, s51, 0x17000
    s_nop 0
    buffer_load_dwordx4 v15, s[12:15], s43 offen lds
    s_mov_b32 s12, s66
    s_and_b32 s13, s67, 0xffff
    s_add_u32 s43, s42, 0x0
    s_add_u32 m0, s51, 0x18000
    s_nop 0
    buffer_load_dwordx4 v10, s[12:15], s43 offen lds
    s_add_u32 s43, s42, 0x4000
    s_add_u32 m0, s51, 0x19000
    s_nop 0
    buffer_load_dwordx4 v9, s[12:15], s43 offen lds
    s_add_u32 s43, s42, 0x8000
    s_add_u32 m0, s51, 0x1a000
    s_nop 0
    buffer_load_dwordx4 v10, s[12:15], s43 offen lds
    s_add_u32 s43, s42, 0xc000
    s_add_u32 m0, s51, 0x1b000
    s_nop 0
    buffer_load_dwordx4 v9, s[12:15], s43 offen lds
    s_waitcnt vmcnt(12)
    s_barrier
    v_xor_b32 v13, 0x0, v11
    v_add_u32 v13, 0x0, v13
    ds_read_b64_tr_b16 a[192:193], v13
    ds_read_b64_tr_b16 a[194:195], v13 offset:1024
    ds_read_b64_tr_b16 a[196:197], v13 offset:16384
    ds_read_b64_tr_b16 a[198:199], v13 offset:17408
    v_xor_b32 v13, 0x20, v11
    v_add_u32 v13, 0x0, v13
    ds_read_b64_tr_b16 a[200:201], v13
    ds_read_b64_tr_b16 a[202:203], v13 offset:1024
    ds_read_b64_tr_b16 a[204:205], v13 offset:16384
    ds_read_b64_tr_b16 a[206:207], v13 offset:17408
    v_xor_b32 v13, 0x1000, v11
    v_add_u32 v13, 0x0, v13
    ds_read_b64_tr_b16 a[224:225], v13
    ds_read_b64_tr_b16 a[226:227], v13 offset:1024
    ds_read_b64_tr_b16 a[228:229], v13 offset:16384
    ds_read_b64_tr_b16 a[230:231], v13 offset:17408
    v_xor_b32 v13, 0x1020, v11
    v_add_u32 v13, 0x0, v13
    ds_read_b64_tr_b16 a[232:233], v13
    ds_read_b64_tr_b16 a[234:235], v13 offset:1024
    ds_read_b64_tr_b16 a[236:237], v13 offset:16384
    ds_read_b64_tr_b16 a[238:239], v13 offset:17408
    s_waitcnt lgkmcnt(0)
    s_barrier
    s_add_u32 s43, s42, 0x10200
    s_add_u32 m0, s51, 0x1c000
    s_nop 0
    buffer_load_dwordx4 v10, s[12:15], s43 offen lds
    s_add_u32 s43, s42, 0x14200
    s_add_u32 m0, s51, 0x1d000
    s_nop 0
    buffer_load_dwordx4 v9, s[12:15], s43 offen lds
    s_add_u32 s43, s42, 0x18200
    s_add_u32 m0, s51, 0x1e000
    s_nop 0
    buffer_load_dwordx4 v10, s[12:15], s43 offen lds
    s_add_u32 s43, s42, 0x1c200
    s_add_u32 m0, s51, 0x1f000
    s_nop 0
    buffer_load_dwordx4 v9, s[12:15], s43 offen lds
    s_add_u32 s43, s42, 0x10000
    s_add_u32 m0, s51, 0x20000
    s_nop 0
    buffer_load_dwordx4 v10, s[12:15], s43 offen lds
    s_add_u32 s43, s42, 0x14000
    s_add_u32 m0, s51, 0x21000
    s_nop 0
    buffer_load_dwordx4 v9, s[12:15], s43 offen lds
    s_add_u32 s43, s42, 0x18000
    s_add_u32 m0, s51, 0x22000
    s_nop 0
    buffer_load_dwordx4 v10, s[12:15], s43 offen lds
    s_add_u32 s43, s42, 0x1c000
    s_add_u32 m0, s51, 0x23000
    s_nop 0
    buffer_load_dwordx4 v9, s[12:15], s43 offen lds
    s_waitcnt vmcnt(12)
    s_barrier
    s_cmp_lg_u32 s21, 0
    s_cbranch_scc1 L_arr_51
    v_mov_b32 v23, 1
    s_mov_b64 exec, 1
    buffer_atomic_add v23, off, s[16:19], 0 offset:8
    s_mov_b64 exec, -1
L_arr_51:
    v_xor_b32 v13, 0x0, v11
    v_add_u32 v13, 0x8000, v13
    ds_read_b64_tr_b16 v[128:129], v13
    ds_read_b64_tr_b16 v[130:131], v13 offset:1024
    ds_read_b64_tr_b16 v[132:133], v13 offset:16384
    ds_read_b64_tr_b16 v[134:135], v13 offset:17408
    v_xor_b32 v13, 0x20, v11
    v_add_u32 v13, 0x8000, v13
    ds_read_b64_tr_b16 v[136:137], v13
    ds_read_b64_tr_b16 v[138:139], v13 offset:1024
    ds_read_b64_tr_b16 v[140:141], v13 offset:16384
    ds_read_b64_tr_b16 v[142:143], v13 offset:17408
    v_xor_b32 v13, 0x1000, v11
    v_add_u32 v13, 0x8000, v13
    ds_read_b64_tr_b16 v[160:161], v13
    ds_read_b64_tr_b16 v[162:163], v13 offset:1024
    ds_read_b64_tr_b16 v[164:165], v13 offset:16384
    ds_read_b64_tr_b16 v[166:167], v13 offset:17408
    v_xor_b32 v13, 0x1020, v11
    v_add_u32 v13, 0x8000, v13
    ds_read_b64_tr_b16 v[168:169], v13
    ds_read_b64_tr_b16 v[170:171], v13 offset:1024
    ds_read_b64_tr_b16 v[172:173], v13 offset:16384
    ds_read_b64_tr_b16 v[174:175], v13 offset:17408
    s_waitcnt lgkmcnt(0)
    s_barrier
    s_add_u32 s43, s42, 0x200
    s_add_u32 m0, s51, 0x24000
    s_nop 0
    buffer_load_dwordx4 v10, s[12:15], s43 offen lds
    s_add_u32 s43, s42, 0x4200
    s_add_u32 m0, s51, 0x25000
    s_nop 0
    buffer_load_dwordx4 v9, s[12:15], s43 offen lds
    s_add_u32 s43, s42, 0x8200
    s_add_u32 m0, s51, 0x26000
    s_nop 0
    buffer_load_dwordx4 v10, s[12:15], s43 offen lds
    s_add_u32 s43, s42, 0xc200
    s_add_u32 m0, s51, 0x27000
    s_nop 0
    buffer_load_dwordx4 v9, s[12:15], s43 offen lds
    s_mov_b32 s12, s64
    s_and_b32 s13, s65, 0xffff
    v_xor_b32 v15, 0, v14
    v_lshl_add_u32 v15, v15, 15, v8
    s_add_u32 s43, s41, 0x80000
    s_add_u32 m0, s51, 0x8000
    s_nop 0
    buffer_load_dwordx4 v15, s[12:15], s43 offen lds
    s_add_u32 s43, s41, 0x88000
    s_add_u32 m0, s51, 0x9000
    s_nop 0
    buffer_load_dwordx4 v15, s[12:15], s43 offen lds
    s_add_u32 s43, s41, 0x180000
    s_add_u32 m0, s51, 0xa000
    s_nop 0
    buffer_load_dwordx4 v15, s[12:15], s43 offen lds
    s_add_u32 s43, s41, 0x188000
    s_add_u32 m0, s51, 0xb000
    s_nop 0
    buffer_load_dwordx4 v15, s[12:15], s43 offen lds
    s_waitcnt vmcnt(12)
    s_barrier
    v_xor_b32 v13, 0x0, v12
    v_add_u32 v13, 0x10000, v13
    ds_read_b64_tr_b16 v[192:193], v13
    ds_read_b64_tr_b16 v[194:195], v13 offset:512
    ds_read_b64_tr_b16 v[196:197], v13 offset:2048
    ds_read_b64_tr_b16 v[198:199], v13 offset:2560
    v_xor_b32 v13, 0x2000, v12
    v_add_u32 v13, 0x10000, v13
    ds_read_b64_tr_b16 v[200:201], v13
    ds_read_b64_tr_b16 v[202:203], v13 offset:512
    ds_read_b64_tr_b16 v[204:205], v13 offset:2048
    ds_read_b64_tr_b16 v[206:207], v13 offset:2560
    v_xor_b32 v13, 0x40, v12
    v_add_u32 v13, 0x10000, v13
    ds_read_b64_tr_b16 v[224:225], v13
    ds_read_b64_tr_b16 v[226:227], v13 offset:512
    ds_read_b64_tr_b16 v[228:229], v13 offset:2048
    ds_read_b64_tr_b16 v[230:231], v13 offset:2560
    v_xor_b32 v13, 0x2040, v12
    v_add_u32 v13, 0x10000, v13
    ds_read_b64_tr_b16 v[232:233], v13
    ds_read_b64_tr_b16 v[234:235], v13 offset:512
    ds_read_b64_tr_b16 v[236:237], v13 offset:2048
    ds_read_b64_tr_b16 v[238:239], v13 offset:2560
    s_waitcnt lgkmcnt(0)
    s_barrier
    s_add_u32 s43, s41, 0x280000
    s_add_u32 m0, s51, 0xc000
    s_nop 0
    buffer_load_dwordx4 v15, s[12:15], s43 offen lds
    s_add_u32 s43, s41, 0x288000
    s_add_u32 m0, s51, 0xd000
    s_nop 0
    buffer_load_dwordx4 v15, s[12:15], s43 offen lds
    s_add_u32 s43, s41, 0x380000
    s_add_u32 m0, s51, 0xe000
    s_nop 0
    buffer_load_dwordx4 v15, s[12:15], s43 offen lds
    s_add_u32 s43, s41, 0x388000
    s_add_u32 m0, s51, 0xf000
    s_nop 0
    buffer_load_dwordx4 v15, s[12:15], s43 offen lds
    v_xor_b32 v15, 2, v14
    v_lshl_add_u32 v15, v15, 15, v8
    s_add_u32 s43, s41, 0x80000
    s_add_u32 m0, s51, 0x10000
    s_nop 0
    buffer_load_dwordx4 v15, s[12:15], s43 offen lds
    s_add_u32 s43, s41, 0x88000
    s_add_u32 m0, s51, 0x11000
    s_nop 0
    buffer_load_dwordx4 v15, s[12:15], s43 offen lds
    s_add_u32 s43, s41, 0x180000
    s_add_u32 m0, s51, 0x12000
    s_nop 0
    buffer_load_dwordx4 v15, s[12:15], s43 offen lds
    s_add_u32 s43, s41, 0x188000
    s_add_u32 m0, s51, 0x13000
    s_nop 0
    buffer_load_dwordx4 v15, s[12:15], s43 offen lds
    s_waitcnt vmcnt(12)
    s_barrier
    v_xor_b32 v13, 0x0, v12
    v_add_u32 v13, 0x18000, v13
    ds_read_b64_tr_b16 v[208:209], v13
    ds_read_b64_tr_b16 v[210:211], v13 offset:512
    ds_read_b64_tr_b16 v[212:213], v13 offset:2048
    ds_read_b64_tr_b16 v[214:215], v13 offset:2560
    v_xor_b32 v13, 0x2000, v12
    v_add_u32 v13, 0x18000, v13
    ds_read_b64_tr_b16 v[216:217], v13
    ds_read_b64_tr_b16 v[218:219], v13 offset:512
    ds_read_b64_tr_b16 v[220:221], v13 offset:2048
    ds_read_b64_tr_b16 v[222:223], v13 offset:2560
    v_xor_b32 v13, 0x40, v12
    v_add_u32 v13, 0x18000, v13
    ds_read_b64_tr_b16 v[240:241], v13
    ds_read_b64_tr_b16 v[242:243], v13 offset:512
    ds_read_b64_tr_b16 v[244:245], v13 offset:2048
    ds_read_b64_tr_b16 v[246:247], v13 offset:2560
    v_xor_b32 v13, 0x2040, v12
    v_add_u32 v13, 0x18000, v13
    ds_read_b64_tr_b16 v[248:249], v13
    ds_read_b64_tr_b16 v[250:251], v13 offset:512
    ds_read_b64_tr_b16 v[252:253], v13 offset:2048
    ds_read_b64_tr_b16 v[254:255], v13 offset:2560
    s_waitcnt lgkmcnt(0)
    s_barrier
    s_add_u32 s43, s41, 0x280000
    s_add_u32 m0, s51, 0x14000
    s_nop 0
    buffer_load_dwordx4 v15, s[12:15], s43 offen lds
    s_add_u32 s43, s41, 0x288000
    s_add_u32 m0, s51, 0x15000
    s_nop 0
    buffer_load_dwordx4 v15, s[12:15], s43 offen lds
    s_add_u32 s43, s41, 0x380000
    s_add_u32 m0, s51, 0x16000
    s_nop 0
    buffer_load_dwordx4 v15, s[12:15], s43 offen lds
    s_add_u32 s43, s41, 0x388000
    s_add_u32 m0, s51, 0x17000
    s_nop 0
    buffer_load_dwordx4 v15, s[12:15], s43 offen lds
    s_mov_b32 s12, s66
    s_and_b32 s13, s67, 0xffff
    s_add_u32 s43, s42, 0x80
    s_add_u32 m0, s51, 0x18000
    s_nop 0
    buffer_load_dwordx4 v10, s[12:15], s43 offen lds
    s_add_u32 s43, s42, 0x4080
    s_add_u32 m0, s51, 0x19000
    s_nop 0
    buffer_load_dwordx4 v9, s[12:15], s43 offen lds
    s_add_u32 s43, s42, 0x8080
    s_add_u32 m0, s51, 0x1a000
    s_nop 0
    buffer_load_dwordx4 v10, s[12:15], s43 offen lds
    s_add_u32 s43, s42, 0xc080
    s_add_u32 m0, s51, 0x1b000
    s_nop 0
    buffer_load_dwordx4 v9, s[12:15], s43 offen lds
    s_waitcnt vmcnt(12)
    s_barrier
    v_xor_b32 v13, 0x0, v11
    v_add_u32 v13, 0x0, v13
    ds_read_b64_tr_b16 a[208:209], v13
    ds_read_b64_tr_b16 a[210:211], v13 offset:1024
    ds_read_b64_tr_b16 a[212:213], v13 offset:16384
    ds_read_b64_tr_b16 a[214:215], v13 offset:17408
    v_xor_b32 v13, 0x20, v11
    v_add_u32 v13, 0x0, v13
    ds_read_b64_tr_b16 a[216:217], v13
    ds_read_b64_tr_b16 a[218:219], v13 offset:1024
    ds_read_b64_tr_b16 a[220:221], v13 offset:16384
    ds_read_b64_tr_b16 a[222:223], v13 offset:17408
    v_xor_b32 v13, 0x1000, v11
    v_add_u32 v13, 0x0, v13
    ds_read_b64_tr_b16 a[240:241], v13
    ds_read_b64_tr_b16 a[242:243], v13 offset:1024
    ds_read_b64_tr_b16 a[244:245], v13 offset:16384
    ds_read_b64_tr_b16 a[246:247], v13 offset:17408
    v_xor_b32 v13, 0x1020, v11
    v_add_u32 v13, 0x0, v13
    ds_read_b64_tr_b16 a[248:249], v13
    ds_read_b64_tr_b16 a[250:251], v13 offset:1024
    ds_read_b64_tr_b16 a[252:253], v13 offset:16384
    ds_read_b64_tr_b16 a[254:255], v13 offset:17408
    s_waitcnt lgkmcnt(0)
    s_barrier
    s_add_u32 s43, s42, 0x10280
    s_add_u32 m0, s51, 0x1c000
    s_nop 0
    buffer_load_dwordx4 v10, s[12:15], s43 offen lds
    s_add_u32 s43, s42, 0x14280
    s_add_u32 m0, s51, 0x1d000
    s_nop 0
    buffer_load_dwordx4 v9, s[12:15], s43 offen lds
    s_add_u32 s43, s42, 0x18280
    s_add_u32 m0, s51, 0x1e000
    s_nop 0
    buffer_load_dwordx4 v10, s[12:15], s43 offen lds
    s_add_u32 s43, s42, 0x1c280
    s_add_u32 m0, s51, 0x1f000
    s_nop 0
    buffer_load_dwordx4 v9, s[12:15], s43 offen lds
    s_add_u32 s43, s42, 0x10080
    s_add_u32 m0, s51, 0x20000
    s_nop 0
    buffer_load_dwordx4 v10, s[12:15], s43 offen lds
    s_add_u32 s43, s42, 0x14080
    s_add_u32 m0, s51, 0x21000
    s_nop 0
    buffer_load_dwordx4 v9, s[12:15], s43 offen lds
    s_add_u32 s43, s42, 0x18080
    s_add_u32 m0, s51, 0x22000
    s_nop 0
    buffer_load_dwordx4 v10, s[12:15], s43 offen lds
    s_add_u32 s43, s42, 0x1c080
    s_add_u32 m0, s51, 0x23000
    s_nop 0
    buffer_load_dwordx4 v9, s[12:15], s43 offen lds
    ds_write_b128 v123, v[32:35]
    ds_write_b128 v123, v[36:39] offset:1024
    ds_write_b128 v123, v[40:43] offset:2048
    ds_write_b128 v123, v[44:47] offset:3072
    ds_write_b128 v123, v[48:51] offset:4096
    ds_write_b128 v123, v[52:55] offset:5120
    ds_write_b128 v123, v[56:59] offset:6144
    ds_write_b128 v123, v[60:63] offset:7168
    s_waitcnt vmcnt(12)
    s_barrier
    v_xor_b32 v13, 0x0, v11
    v_add_u32 v13, 0x8000, v13
    ds_read_b64_tr_b16 v[144:145], v13
    ds_read_b64_tr_b16 v[146:147], v13 offset:1024
    ds_read_b64_tr_b16 v[148:149], v13 offset:16384
    ds_read_b64_tr_b16 v[150:151], v13 offset:17408
    v_xor_b32 v13, 0x20, v11
    v_add_u32 v13, 0x8000, v13
    ds_read_b64_tr_b16 v[152:153], v13
    ds_read_b64_tr_b16 v[154:155], v13 offset:1024
    ds_read_b64_tr_b16 v[156:157], v13 offset:16384
    ds_read_b64_tr_b16 v[158:159], v13 offset:17408
    v_xor_b32 v13, 0x1000, v11
    v_add_u32 v13, 0x8000, v13
    ds_read_b64_tr_b16 v[176:177], v13
    ds_read_b64_tr_b16 v[178:179], v13 offset:1024
    ds_read_b64_tr_b16 v[180:181], v13 offset:16384
    ds_read_b64_tr_b16 v[182:183], v13 offset:17408
    v_xor_b32 v13, 0x1020, v11
    v_add_u32 v13, 0x8000, v13
    ds_read_b64_tr_b16 v[184:185], v13
    ds_read_b64_tr_b16 v[186:187], v13 offset:1024
    ds_read_b64_tr_b16 v[188:189], v13 offset:16384
    ds_read_b64_tr_b16 v[190:191], v13 offset:17408
    s_waitcnt lgkmcnt(0)
    s_barrier
    s_add_u32 s43, s42, 0x280
    s_add_u32 m0, s51, 0x24000
    s_nop 0
    buffer_load_dwordx4 v10, s[12:15], s43 offen lds
    s_add_u32 s43, s42, 0x4280
    s_add_u32 m0, s51, 0x25000
    s_nop 0
    buffer_load_dwordx4 v9, s[12:15], s43 offen lds
    s_add_u32 s43, s42, 0x8280
    s_add_u32 m0, s51, 0x26000
    s_nop 0
    buffer_load_dwordx4 v10, s[12:15], s43 offen lds
    s_add_u32 s43, s42, 0xc280
    s_add_u32 m0, s51, 0x27000
    s_nop 0
    buffer_load_dwordx4 v9, s[12:15], s43 offen lds
    ds_write_b128 v123, v[64:67] offset:32768
    ds_write_b128 v123, v[68:71] offset:33792
    ds_write_b128 v123, v[72:75] offset:34816
    ds_write_b128 v123, v[76:79] offset:35840
    ds_write_b128 v123, v[80:83] offset:36864
    ds_write_b128 v123, v[84:87] offset:37888
    ds_write_b128 v123, v[88:91] offset:38912
    ds_write_b128 v123, v[92:95] offset:39936
    s_waitcnt vmcnt(8)
    s_barrier
    v_xor_b32 v13, 0x0, v12
    v_add_u32 v13, 0x10000, v13
    ds_read_b64_tr_b16 v[32:33], v13
    ds_read_b64_tr_b16 v[34:35], v13 offset:512
    ds_read_b64_tr_b16 v[36:37], v13 offset:2048
    ds_read_b64_tr_b16 v[38:39], v13 offset:2560
    v_xor_b32 v13, 0x2000, v12
    v_add_u32 v13, 0x10000, v13
    ds_read_b64_tr_b16 v[40:41], v13
    ds_read_b64_tr_b16 v[42:43], v13 offset:512
    ds_read_b64_tr_b16 v[44:45], v13 offset:2048
    ds_read_b64_tr_b16 v[46:47], v13 offset:2560
    v_xor_b32 v13, 0x40, v12
    v_add_u32 v13, 0x10000, v13
    ds_read_b64_tr_b16 v[64:65], v13
    ds_read_b64_tr_b16 v[66:67], v13 offset:512
    ds_read_b64_tr_b16 v[68:69], v13 offset:2048
    ds_read_b64_tr_b16 v[70:71], v13 offset:2560
    v_xor_b32 v13, 0x2040, v12
    v_add_u32 v13, 0x10000, v13
    ds_read_b64_tr_b16 v[72:73], v13
    ds_read_b64_tr_b16 v[74:75], v13 offset:512
    ds_read_b64_tr_b16 v[76:77], v13 offset:2048
    ds_read_b64_tr_b16 v[78:79], v13 offset:2560
    s_waitcnt vmcnt(0)
    s_barrier
    v_xor_b32 v13, 0x0, v12
    v_add_u32 v13, 0x18000, v13
    ds_read_b64_tr_b16 v[48:49], v13
    ds_read_b64_tr_b16 v[50:51], v13 offset:512
    ds_read_b64_tr_b16 v[52:53], v13 offset:2048
    ds_read_b64_tr_b16 v[54:55], v13 offset:2560
    v_xor_b32 v13, 0x2000, v12
    v_add_u32 v13, 0x18000, v13
    ds_read_b64_tr_b16 v[56:57], v13
    ds_read_b64_tr_b16 v[58:59], v13 offset:512
    ds_read_b64_tr_b16 v[60:61], v13 offset:2048
    ds_read_b64_tr_b16 v[62:63], v13 offset:2560
    v_xor_b32 v13, 0x40, v12
    v_add_u32 v13, 0x18000, v13
    ds_read_b64_tr_b16 v[80:81], v13
    ds_read_b64_tr_b16 v[82:83], v13 offset:512
    ds_read_b64_tr_b16 v[84:85], v13 offset:2048
    ds_read_b64_tr_b16 v[86:87], v13 offset:2560
    v_xor_b32 v13, 0x2040, v12
    v_add_u32 v13, 0x18000, v13
    ds_read_b64_tr_b16 v[88:89], v13
    ds_read_b64_tr_b16 v[90:91], v13 offset:512
    ds_read_b64_tr_b16 v[92:93], v13 offset:2048
    ds_read_b64_tr_b16 v[94:95], v13 offset:2560
    s_waitcnt lgkmcnt(0)
    s_barrier
    ds_write_b128 v124, v[32:35]
    ds_write_b128 v124, v[36:39] offset:1024
    ds_write_b128 v124, v[40:43] offset:2048
    ds_write_b128 v124, v[44:47] offset:3072
    ds_write_b128 v124, v[48:51] offset:4096
    ds_write_b128 v124, v[52:55] offset:5120
    ds_write_b128 v124, v[56:59] offset:6144
    ds_write_b128 v124, v[60:63] offset:7168
    ds_write_b128 v124, v[64:67] offset:32768
    ds_write_b128 v124, v[68:71] offset:33792
    ds_write_b128 v124, v[72:75] offset:34816
    ds_write_b128 v124, v[76:79] offset:35840
    ds_write_b128 v124, v[80:83] offset:36864
    ds_write_b128 v124, v[84:87] offset:37888
    ds_write_b128 v124, v[88:91] offset:38912
    ds_write_b128 v124, v[92:95] offset:39936
    s_waitcnt lgkmcnt(0)
    s_cmp_eq_u32 s57, 1
    s_cbranch_scc1 L_started_52
    v_lshrrev_b32 v1, 4, v117
    v_and_b32 v2, 15, v1
    v_lshrrev_b32 v1, 4, v1
    v_lshlrev_b32 v1, 11, v1
    v_lshl_add_u32 v1, v2, 2, v1
    s_lshl_b32 s43, s20, 6
    s_add_u32 s43, s43, 0x2000
    s_mov_b32 exec_lo, 0x10001
    s_mov_b32 exec_hi, 0
    s_mov_b32 s96, 0
L_poll_53:
    buffer_load_dword v2, v1, s[8:11], s43 offen sc1
    s_waitcnt vmcnt(0)
    v_cmp_gt_u32 vcc, 1, v2
    s_cbranch_vccz L_polld_54
    s_sleep 8
    s_add_u32 s96, s96, 1
    s_cmp_lt_u32 s96, 0x10000
    s_cbranch_scc1 L_poll_53
L_polld_54:
    s_mov_b64 exec, -1
    s_add_u32 m0, s52, 8192
    s_nop 0
    buffer_load_dwordx4 v117, s[8:11], s30 offen lds
    buffer_load_dwordx4 v117, s[8:11], s30 offen offset:1024 lds
    s_add_u32 m0, s52, 0x6000
    s_nop 0
    buffer_load_dwordx4 v117, s[8:11], s31 offen lds
    buffer_load_dwordx4 v117, s[8:11], s31 offen offset:1024 lds
    s_mov_b32 s49, 0
L_cb_poll_56:
    buffer_load_dword v3, off, s[16:19], 0 offset:8 sc1
    s_waitcnt vmcnt(0)
    v_readfirstlane_b32 s43, v3
    s_nop 0
    s_cmp_ge_u32 s43, 32
    s_cbranch_scc1 L_started_52
    s_sleep 8
    s_add_u32 s49, s49, 1
    s_cmp_lt_u32 s49, 0x40000
    s_cbranch_scc1 L_cb_poll_56
L_started_52:
    s_lshr_b32 s43, s20, 1
    s_lshl_b32 s43, s43, 7
    s_and_b32 s40, s20, 1
    s_lshl_b32 s40, s40, 4
    s_add_u32 s43, s43, s40
    s_add_u32 s44, s43, 0x1000
    s_cmp_eq_u32 s21, 0
    s_cselect_b32 s44, s44, 0x7ff00000
    s_mov_b32 s22, 0
    s_mov_b32 s33, 0
    s_xor_b32 s53, s29, 1024
    s_add_u32 s23, s51, 0x7010000
    s_add_u32 s48, s23, 4096
    s_mov_b32 s24, 0x7012000
    s_add_u32 s55, s24, 16384
    s_mov_b32 s25, 0x7100000
    s_mov_b32 s26, 0x7101000
    v_mov_b32 v112, 0
    v_mov_b32 v113, 0
    v_mov_b32 v114, 0
    v_mov_b32 v115, 0
    s_add_u32 m0, s51, 4096
    ds_write_b128 v117, v[112:115] offset:22528
    ds_write_b128 v117, v[112:115] offset:23552
    s_cmp_lg_u32 s21, 0
    s_cselect_b32 s40, -1, 0
    v_mov_b32 v126, s40
    v_bfe_u32 v1, v117, 4, 1
    v_lshlrev_b32 v1, 4, v1
    s_movk_i32 s43, 0x3f80
    v_lshlrev_b32 v125, v1, s43
    v_bfe_u32 v1, v117, 5, 3
    v_cmp_eq_u32 s[68:69], 0, v1
    v_cmp_eq_u32 s[70:71], 1, v1
    v_cmp_eq_u32 s[72:73], 2, v1
    v_cmp_eq_u32 s[74:75], 3, v1
    v_lshrrev_b32 v1, 2, v117
    s_cmp_lt_u32 s21, 2
    s_cselect_b64 vcc, -1, 0
    v_cndmask_b32 v119, v119, v1, vcc
    v_mov_b32 v32, 0
    v_mov_b32 v33, 0
    v_mov_b32 v34, 0
    v_mov_b32 v35, 0
    v_mov_b32 v36, 0
    v_mov_b32 v37, 0
    v_mov_b32 v38, 0
    v_mov_b32 v39, 0
    v_mov_b32 v40, 0
    v_mov_b32 v41, 0
    v_mov_b32 v42, 0
    v_mov_b32 v43, 0
    v_mov_b32 v44, 0
    v_mov_b32 v45, 0
    v_mov_b32 v46, 0
    v_mov_b32 v47, 0
    v_mov_b32 v48, 0
    v_mov_b32 v49, 0
    v_mov_b32 v50, 0
    v_mov_b32 v51, 0
    v_mov_b32 v52, 0
    v_mov_b32 v53, 0
    v_mov_b32 v54, 0
    v_mov_b32 v55, 0
    s_add_u32 s30, s30, 0x40000
    s_add_u32 s31, s31, 0x40000
    s_mov_b32 s45, 0
    s_mov_b32 s46, 0
    s_mov_b32 s47, 0
    s_mov_b32 s76, 0
    s_and_b32 s43, s21, 1
    s_lshl_b32 s43, s43, 5
    s_add_u32 s43, s43, s20
    s_lshl_b32 s43, s43, 6
    s_add_u32 s28, s43, 0x2000
    s_mov_b32 s59, 0
    ds_read_b128 v[80:83], v123
    ds_read_b128 v[84:87], v123 offset:1024
    ds_read_b128 v[56:59], v123 offset:2048
    ds_read_b128 v[60:63], v123 offset:3072
    ds_read_b128 v[64:67], v123 offset:32768
    ds_read_b128 v[68:71], v123 offset:33792
    ds_read_b128 v[72:75], v123 offset:34816
    ds_read_b128 v[76:79], v123 offset:35840
    ds_read_b128 v[88:91], v123 offset:4096
    ds_read_b128 v[92:95], v123 offset:5120
    ds_read_b128 v[96:99], v123 offset:6144
    ds_read_b128 v[100:103], v123 offset:7168
    ds_read_b128 v[104:107], v123 offset:36864
    ds_read_b128 v[108:111], v123 offset:37888
    ds_read_b128 v[24:27], v123 offset:38912
    ds_read_b128 v[28:31], v123 offset:39936
    s_mov_b32 s49, 0
    s_waitcnt vmcnt(0) lgkmcnt(0)
    s_barrier
    s_waitcnt vmcnt(0) lgkmcnt(0)
    s_cmp_eq_u32 s21, 1
    s_cbranch_scc1 L_chain_top1_s
    s_cmp_eq_u32 s21, 2
    s_cbranch_scc1 L_chain_top2_s
    s_cmp_eq_u32 s21, 3
    s_cbranch_scc1 L_chain_top3_s
.p2align 6
L_chain_top0_s:
    buffer_load_dwordx4 v[0:3], v117, s[8:11], s23 offen sc1
    v_mov_b32 v15, 0
    v_mov_b32 v15, 0
    v_mov_b32 v15, 0
    v_mov_b32 v15, 0
    v_mov_b32 v15, 0
    v_mov_b32 v15, 0
    v_mov_b32 v15, 0
    v_mov_b32 v15, 0
    v_mov_b32 v15, 0
    v_mov_b32 v15, 0
    v_mov_b32 v15, 0
    v_mov_b32 v15, 0
    v_mov_b32 v15, 0
    v_mov_b32 v15, 0
    v_mov_b32 v15, 0
    v_mov_b32 v15, 0
    buffer_load_dwordx4 v[0:3], v117, s[8:11], s23 offen sc1
    v_mov_b32 v15, 0
    v_mov_b32 v15, 0
    v_mov_b32 v15, 0
    v_mov_b32 v15, 0
    v_mov_b32 v15, 0
    v_mov_b32 v15, 0
    v_mov_b32 v15, 0
    v_mov_b32 v15, 0
    v_mov_b32 v15, 0
    v_mov_b32 v15, 0
    v_mov_b32 v15, 0
    v_mov_b32 v15, 0
    v_mov_b32 v15, 0
    v_mov_b32 v15, 0
    v_mov_b32 v15, 0
    v_mov_b32 v15, 0
L_mret_58:
    buffer_load_dwordx4 v[0:3], v117, s[8:11], s23 offen sc1
    s_add_u32 s45, s45, 1
    s_cmp_lt_u32 s45, 0x10000
    s_cselect_b32 s56, -2, -1
    s_nop 3
    v_mov_b32 v32, 0
    v_mov_b32 v33, 0
    v_mov_b32 v34, 0
    v_mov_b32 v35, 0
    s_waitcnt vmcnt(2)
    v_max3_u32 v15, v0, v1, v2
    v_max_u32 v15, v15, v3
    v_cmp_lt_u32 vcc, s56, v15
    v_smfmac_f32_16x16x64_bf16 v[32:35], v[0:3], v[80:87], v116
    s_cbranch_vccnz L_mret_58
    ds_write_b128 v117, v[0:3]
    v_smfmac_f32_16x16x64_bf16 v[36:39], v[0:3], v[56:63], v116
    buffer_load_dwordx4 v[4:7], v117, s[8:11], s48 offen sc1
    v_smfmac_f32_16x16x64_bf16 v[40:43], v[0:3], v[64:71], v116
    buffer_load_dwordx4 v117, s[8:11], s48 offen sc1 lds
    s_mov_b32 m0, 8192
    v_smfmac_f32_16x16x64_bf16 v[44:47], v[0:3], v[72:79], v116
    s_waitcnt lgkmcnt(0)
    s_barrier
    ds_read_b128 v[8:11], v117 offset:1024
    v_smfmac_f32_16x16x64_bf16 v[48:51], v[0:3], a[192:199], v116
    ds_read_b128 v[16:19], v117 offset:2048
    ds_read_b128 v[20:23], v117 offset:3072
    v_smfmac_f32_16x16x64_bf16 v[52:55], v[0:3], a[200:207], v116
    ds_read_b128 v[80:83], v117 offset:14336
    s_waitcnt lgkmcnt(3)
    v_smfmac_f32_16x16x64_bf16 v[32:35], v[8:11], a[0:7], v116
    ds_read_b128 v[84:87], v117 offset:15360
    v_smfmac_f32_16x16x64_bf16 v[36:39], v[8:11], a[8:15], v116
    buffer_store_dwordx4 v[112:115], v117, s[8:11], s32 offen sc1
    s_waitcnt lgkmcnt(3)
    v_smfmac_f32_16x16x64_bf16 v[32:35], v[16:19], a[32:39], v116
    ds_read_b128 v[56:59], v117 offset:8192
    v_smfmac_f32_16x16x64_bf16 v[36:39], v[16:19], a[40:47], v116
    ds_read_b128 v[60:63], v117 offset:9216
    s_waitcnt lgkmcnt(4)
    v_smfmac_f32_16x16x64_bf16 v[32:35], v[20:23], a[64:71], v116
    ds_read_b128 v[64:67], v117 offset:10240
    v_smfmac_f32_16x16x64_bf16 v[36:39], v[20:23], a[72:79], v116
    ds_read_b128 v[68:71], v117 offset:11264
    v_smfmac_f32_16x16x64_bf16 v[40:43], v[8:11], a[96:103], v116
    ds_read_b128 v[72:75], v117 offset:12288
    v_smfmac_f32_16x16x64_bf16 v[40:43], v[16:19], a[128:135], v116
    ds_read_b128 v[76:79], v117 offset:13312
    v_smfmac_f32_16x16x64_bf16 v[40:43], v[20:23], a[160:167], v116
    s_waitcnt vmcnt(2)
    v_max3_u32 v15, v4, v5, v6
    v_smfmac_f32_16x16x64_bf16 v[44:47], v[8:11], a[104:111], v116
    v_max_u32 v15, v15, v7
    v_smfmac_f32_16x16x64_bf16 v[44:47], v[16:19], a[136:143], v116
    s_waitcnt vmcnt(1) lgkmcnt(0)
    v_cmp_lt_u32 vcc, s56, v15
    v_smfmac_f32_16x16x64_bf16 v[44:47], v[20:23], a[168:175], v116
    s_cbranch_vccnz L_mret_59
L_mgo_60:
    v_smfmac_f32_16x16x64_bf16 v[44:47], v[4:7], v[24:31], v116
    s_barrier
    ds_read_b128 v[12:15], v117 offset:5120
    v_smfmac_f32_16x16x64_bf16 v[32:35], v[4:7], v[88:95], v116
    ds_read_b128 v[24:27], v117 offset:6144
    v_smfmac_f32_16x16x64_bf16 v[36:39], v[4:7], v[96:103], v116
    ds_read_b128 v[28:31], v117 offset:7168
    v_smfmac_f32_16x16x64_bf16 v[40:43], v[4:7], v[104:111], v116
    ds_read_b128 v[88:91], v117 offset:24576
    s_waitcnt lgkmcnt(3)
    v_smfmac_f32_16x16x64_bf16 v[32:35], v[12:15], a[16:23], v116
    ds_read_b128 v[92:95], v117 offset:25600
    s_waitcnt lgkmcnt(3)
    v_smfmac_f32_16x16x64_bf16 v[32:35], v[24:27], a[48:55], v116
    buffer_load_dwordx4 v117, s[8:11], s30 offen lds
    s_waitcnt lgkmcnt(2)
    v_smfmac_f32_16x16x64_bf16 v[32:35], v[28:31], a[80:87], v116
    ds_read_b128 v[96:99], v117 offset:23552
    v_smfmac_f32_16x16x64_bf16 v[36:39], v[12:15], a[24:31], v116
    ds_read_b128 v[100:103], v117 offset:23552
    v_smfmac_f32_16x16x64_bf16 v[36:39], v[24:27], a[56:63], v116
    buffer_load_dwordx4 v117, s[8:11], s30 offen offset:1024 lds
    s_add_u32 m0, s52, 0x6000
    v_add_f32 v32, v32, v34
    v_smfmac_f32_16x16x64_bf16 v[36:39], v[28:31], a[88:95], v116
    ds_read_b128 v[104:107], v117 offset:23552
    v_add_f32 v33, v33, v35
    v_smfmac_f32_16x16x64_bf16 v[40:43], v[12:15], a[112:119], v116
    ds_read_b128 v[108:111], v117 offset:23552
    v_mul_f32 v32, s34, v32
    v_smfmac_f32_16x16x64_bf16 v[40:43], v[24:27], a[144:151], v116
    buffer_load_dword v125, v119, s[8:11], s28 offen sc1
    v_mul_f32 v33, s34, v33
    v_smfmac_f32_16x16x64_bf16 v[40:43], v[28:31], a[176:183], v116
    ds_read_b128 v[0:3], v124
    v_add_f32 v36, v36, v38
    v_smfmac_f32_16x16x64_bf16 v[48:51], v[4:7], a[208:215], v116
    v_add_f32 v37, v37, v39
    v_smfmac_f32_16x16x64_bf16 v[52:55], v[4:7], a[216:223], v116
    s_waitcnt lgkmcnt(5)
    buffer_load_dwordx4 v117, s[8:11], s31 offen lds
    v_mul_f32 v36, s34, v36
    v_smfmac_f32_16x16x64_bf16 v[44:47], v[12:15], a[120:127], v116
    ds_read_b128 v[4:7], v124 offset:1024
    v_mul_f32 v37, s34, v37
    v_smfmac_f32_16x16x64_bf16 v[44:47], v[24:27], a[152:159], v116
    v_cvt_pk_bf16_f32 v34, v32, v36
    v_smfmac_f32_16x16x64_bf16 v[44:47], v[28:31], a[184:191], v116
    buffer_load_dwordx4 v117, s[8:11], s31 offen offset:1024 lds
    s_mov_b32 m0, 4096
    v_cvt_pk_bf16_f32 v35, v33, v37
    v_add_f32 v40, v40, v42
    v_smfmac_f32_16x16x64_bf16 v[48:51], v[8:11], a[224:231], v116
    ds_write2_b32 v120, v34, v35 offset0:32 offset1:48
    v_add_f32 v41, v41, v43
    v_smfmac_f32_16x16x64_bf16 v[52:55], v[8:11], a[232:239], v116
    v_add_f32 v44, v44, v46
    v_add_f32 v45, v45, v47
    v_cvt_pk_bf16_f32 v113, v40, v44
    v_cvt_pk_bf16_f32 v115, v41, v45
    v_smfmac_f32_16x16x64_bf16 v[48:51], v[12:15], a[240:247], v116
    ds_write2_b32 v120, v113, v115 offset0:0 offset1:16
    v_smfmac_f32_16x16x64_bf16 v[52:55], v[12:15], a[248:255], v116
    s_cmp_eq_u32 s22, 63
    s_cbranch_scc1 L_chain_last_s
    buffer_store_dword v126, off, s[8:11], s44 sc1
    v_smfmac_f32_16x16x64_bf16 v[48:51], v[16:19], v[128:135], v116
    v_smfmac_f32_16x16x64_bf16 v[48:51], v[20:23], v[160:167], v116
    v_smfmac_f32_16x16x64_bf16 v[48:51], v[24:27], v[144:151], v116
    s_waitcnt lgkmcnt(0)
    s_barrier
    v_smfmac_f32_16x16x64_bf16 v[48:51], v[28:31], v[176:183], v116
    ds_read_b128 v[32:35], v121 offset:16384
    ds_read_b128 v[36:39], v121 offset:17408
    v_smfmac_f32_16x16x64_bf16 v[52:55], v[16:19], v[136:143], v116
    ds_read_b128 v[40:43], v121 offset:18432
    ds_read_b128 v[44:47], v121 offset:19456
    v_smfmac_f32_16x16x64_bf16 v[52:55], v[20:23], v[168:175], v116
    ds_read_b128 v[8:11], v124 offset:32768
    v_add_f32 v48, v48, v50
    v_smfmac_f32_16x16x64_bf16 v[52:55], v[24:27], v[152:159], v116
    ds_read_b128 v[12:15], v124 offset:33792
    v_add_f32 v49, v49, v51
    v_smfmac_f32_16x16x64_bf16 v[52:55], v[28:31], v[184:191], v116
    s_waitcnt lgkmcnt(5)
    v_cvt_pk_bf16_f32 v112, v48, v49
    v_mfma_f32_16x16x32_bf16 v[56:59], v[56:59], v[32:35], 0
    s_waitcnt lgkmcnt(4)
    v_mov_b32 v48, s50
    v_mov_b32 v49, s50
    v_mfma_f32_16x16x32_bf16 v[56:59], v[60:63], v[36:39], v[56:59]
    ds_read_b128 v[16:19], v124 offset:2048
    s_waitcnt lgkmcnt(4)
    v_mov_b32 v50, s50
    v_mov_b32 v51, s50
    v_mfma_f32_16x16x32_bf16 v[56:59], v[64:67], v[40:43], v[56:59]
    ds_read_b128 v[20:23], v124 offset:3072
    s_waitcnt lgkmcnt(4)
    v_add_f32 v52, v52, v54
    v_mfma_f32_16x16x32_bf16 v[56:59], v[68:71], v[44:47], v[56:59]
    ds_read_b128 v[24:27], v124 offset:4096
    v_add_f32 v53, v53, v55
    v_mfma_f32_16x16x32_bf16 v[60:63], v[72:75], v[32:35], 0
    ds_read_b128 v[28:31], v124 offset:5120
    v_cvt_pk_bf16_f32 v114, v52, v53
    v_mov_b32 v53, 0
    v_mfma_f32_16x16x32_bf16 v[60:63], v[76:79], v[36:39], v[60:63]
    v_exp_f32 v56, v56
    v_mfma_f32_16x16x32_bf16 v[60:63], v[80:83], v[40:43], v[60:63]
    v_exp_f32 v57, v57
    v_mfma_f32_16x16x32_bf16 v[60:63], v[84:87], v[44:47], v[60:63]
    v_exp_f32 v58, v58
    v_mfma_f32_16x16x32_bf16 v[64:67], v[32:35], v[32:35], 0
    v_exp_f32 v59, v59
    v_cvt_pk_bf16_f32 v68, v56, v57
    v_mfma_f32_16x16x32_bf16 v[64:67], v[36:39], v[36:39], v[64:67]
    v_exp_f32 v60, v60
    v_cvt_pk_bf16_f32 v69, v58, v59
    v_mfma_f32_16x16x32_bf16 v[64:67], v[40:43], v[40:43], v[64:67]
    v_exp_f32 v61, v61
    v_mfma_f32_16x16x32_bf16 v[64:67], v[44:47], v[44:47], v[64:67]
    v_exp_f32 v62, v62
    v_exp_f32 v63, v63
    v_cvt_pk_bf16_f32 v70, v60, v61
    v_cvt_pk_bf16_f32 v71, v62, v63
    s_nop 1
    v_mfma_f32_16x16x32_bf16 v[72:75], v[88:91], v[68:71], 0
    s_nop 0
    v_exp_f32 v64, v64
    v_mfma_f32_16x16x32_bf16 v[76:79], v[92:95], v[68:71], 0
    v_exp_f32 v65, v65
    v_mfma_f32_16x16x32_bf16 v[80:83], v[48:51], v[68:71], 0
    v_cvt_pk_bf16_f32 v52, v64, v65
    s_nop 1
    v_mfma_f32_16x16x16_bf16 v[72:75], v[112:113], v[52:53], v[72:75]
    ds_read_b128 v[32:35], v124 offset:6144
    v_mfma_f32_16x16x16_bf16 v[76:79], v[114:115], v[52:53], v[76:79]
    ds_read_b128 v[36:39], v124 offset:7168
    v_mfma_f32_16x16x16_bf16 v[80:83], v[48:49], v[52:53], v[80:83]
L_norm_61:
    s_mov_b64 vcc, s[36:37]
    v_mov_b32 v122, v122
    v_mov_b32 v122, v122
    v_mov_b32 v122, v122
    v_cndmask_b32_dpp v76, v72, v76, vcc quad_perm:[2,3,2,3] row_mask:0xf bank_mask:0xf
    v_cndmask_b32_dpp v77, v73, v77, vcc quad_perm:[2,3,2,3] row_mask:0xf bank_mask:0xf
    v_cndmask_b32_dpp v78, v74, v78, vcc quad_perm:[2,3,2,3] row_mask:0xf bank_mask:0xf
    v_cndmask_b32_dpp v79, v75, v79, vcc quad_perm:[2,3,2,3] row_mask:0xf bank_mask:0xf
    v_rcp_f32_dpp v84, v80 quad_perm:[2,3,2,3] row_mask:0xf bank_mask:0xf
    s_nop 0
    v_pk_mul_f32 v[76:77], v[76:77], v[84:85] op_sel_hi:[1,0]
    v_pk_mul_f32 v[78:79], v[78:79], v[84:85] op_sel_hi:[1,0]
    v_cvt_pk_bf16_f32 v72, v76, v77
    v_cvt_pk_bf16_f32 v73, v78, v79
    ds_write_b64 v122, v[72:73] offset:20480
    v_max_f32_dpp v86, v80, v84 quad_perm:[2,3,2,3] row_mask:0xf bank_mask:0xf
    v_mov_b32_dpp v60, v72 quad_perm:[0,1,0,1] row_mask:0xf bank_mask:0xf
    v_mov_b32_dpp v61, v73 quad_perm:[0,1,0,1] row_mask:0xf bank_mask:0xf
    v_cmp_lt_f32 vcc, s35, v86
    v_mov_b32_dpp v62, v72 quad_perm:[2,3,2,3] row_mask:0xf bank_mask:0xf
    v_mov_b32_dpp v63, v73 quad_perm:[2,3,2,3] row_mask:0xf bank_mask:0xf
    s_nop 1
    v_smfmac_f32_16x16x64_bf16 v[96:99], v[60:63], v[192:199], v116
    s_cbranch_vccnz L_smax_62
    v_smfmac_f32_16x16x64_bf16 v[100:103], v[60:63], v[224:231], v116
    s_waitcnt lgkmcnt(0)
    s_barrier
    ds_read_b128 v[92:95], v127 offset:20992
    ds_read_b128 v[80:83], v127 offset:21504
    ds_read_b128 v[84:87], v127 offset:22016
    v_smfmac_f32_16x16x64_bf16 v[104:107], v[60:63], v[0:7], v116
    ds_read_b128 v[40:43], v124 offset:34816
    v_smfmac_f32_16x16x64_bf16 v[108:111], v[60:63], v[8:15], v116
    ds_read_b128 v[56:59], v124 offset:36864
    s_waitcnt lgkmcnt(4)
    v_smfmac_f32_16x16x64_bf16 v[96:99], v[92:95], v[200:207], v116
    s_waitcnt lgkmcnt(3)
    v_smfmac_f32_16x16x64_bf16 v[96:99], v[80:83], v[208:215], v116
    ds_read_b128 v[44:47], v124 offset:35840
    s_waitcnt lgkmcnt(3)
    v_smfmac_f32_16x16x64_bf16 v[96:99], v[84:87], v[216:223], v116
    ds_read_b128 v[68:71], v124 offset:39936
    v_smfmac_f32_16x16x64_bf16 v[100:103], v[92:95], v[232:239], v116
    ds_read_b128 v[64:67], v124 offset:38912
    v_smfmac_f32_16x16x64_bf16 v[100:103], v[80:83], v[240:247], v116
    ds_read_b128 v[60:63], v124 offset:37888
    v_cvt_pk_bf16_f32 v72, v96, v98
    v_smfmac_f32_16x16x64_bf16 v[100:103], v[84:87], v[248:255], v116
    v_and_or_b32 v72, v72, -2, s33
    v_smfmac_f32_16x16x64_bf16 v[104:107], v[92:95], v[16:23], v116
    v_cvt_pk_bf16_f32 v74, v97, v99
    v_smfmac_f32_16x16x64_bf16 v[104:107], v[80:83], v[24:31], v116
    v_cvt_pk_bf16_f32 v73, v100, v102
    v_cvt_pk_bf16_f32 v75, v101, v103
    v_smfmac_f32_16x16x64_bf16 v[104:107], v[84:87], v[32:39], v116
    buffer_store_dwordx4 v[72:75], v118, s[8:11], s25 offen sc1
    s_waitcnt lgkmcnt(3)
    v_smfmac_f32_16x16x64_bf16 v[108:111], v[92:95], v[40:47], v116
    s_waitcnt lgkmcnt(0)
    v_smfmac_f32_16x16x64_bf16 v[108:111], v[80:83], v[56:63], v116
    v_cvt_pk_bf16_f32 v76, v104, v106
    v_smfmac_f32_16x16x64_bf16 v[108:111], v[84:87], v[64:71], v116
    v_and_or_b32 v76, v76, -2, s33
    v_cvt_pk_bf16_f32 v78, v105, v107
    v_mov_b32 v122, v122
    v_mov_b32 v122, v122
    v_mov_b32 v122, v122
    v_mov_b32 v122, v122
    v_mov_b32 v122, v122
    v_mov_b32 v122, v122
    v_cvt_pk_bf16_f32 v77, v108, v110
    v_cvt_pk_bf16_f32 v79, v109, v111
    buffer_store_dwordx4 v[76:79], v118, s[8:11], s26 offen sc1
    s_add_u32 s30, s30, 0x40000
    s_add_u32 s31, s31, 0x40000
    s_add_u32 s32, s32, 0x20000
    s_add_u32 s23, s24, 0
    s_add_u32 s48, s23, 4096
    s_xor_b32 s25, s25, 0x40000
    s_xor_b32 s26, s26, 0x40000
    s_mov_b32 s35, 0x49800000
    v_mov_b32 v126, s22
    s_add_u32 s22, s22, 1
    v_mov_b32 v32, 0
    v_mov_b32 v33, 0
    v_mov_b32 v34, 0
    v_mov_b32 v35, 0
    v_mov_b32 v36, 0
    v_mov_b32 v37, 0
    v_mov_b32 v38, 0
    v_mov_b32 v39, 0
    v_mov_b32 v40, 0
    v_mov_b32 v41, 0
    v_mov_b32 v42, 0
    v_mov_b32 v43, 0
    v_mov_b32 v44, 0
    v_mov_b32 v45, 0
    v_mov_b32 v46, 0
    v_mov_b32 v47, 0
    v_mov_b32 v48, 0
    v_mov_b32 v49, 0
    v_mov_b32 v50, 0
    v_mov_b32 v51, 0
    v_mov_b32 v52, 0
    v_mov_b32 v53, 0
    v_mov_b32 v54, 0
    v_mov_b32 v55, 0
    ds_read_b128 v[80:83], v123
    ds_read_b128 v[84:87], v123 offset:1024
    ds_read_b128 v[56:59], v123 offset:2048
    ds_read_b128 v[60:63], v123 offset:3072
    ds_read_b128 v[64:67], v123 offset:32768
    ds_read_b128 v[68:71], v123 offset:33792
    ds_read_b128 v[72:75], v123 offset:34816
    ds_read_b128 v[76:79], v123 offset:35840
    ds_read_b128 v[88:91], v123 offset:4096
    ds_read_b128 v[92:95], v123 offset:5120
    ds_read_b128 v[96:99], v123 offset:6144
    ds_read_b128 v[100:103], v123 offset:7168
    ds_read_b128 v[104:107], v123 offset:36864
    ds_read_b128 v[108:111], v123 offset:37888
    ds_read_b128 v[24:27], v123 offset:38912
    ds_read_b128 v[28:31], v123 offset:39936
    s_add_u32 s24, s24, 8192
    s_bitset0_b32 s24, 15
    s_xor_b32 s55, s24, 16384
    s_xor_b32 s29, s29, 0x40000
    s_xor_b32 s53, s29, 1024
    s_bfe_u32 s33, s22, 0x10001
    s_add_u32 s40, s22, 5
    s_lshr_b32 s40, s40, 2
    s_min_u32 s40, s40, 16
    s_bfm_b32 s58, s40, 0
    s_waitcnt vmcnt(5)
    v_cmp_eq_u32 vcc, 0, v125
    s_nop 0
    s_and_b64 vcc, vcc, s[58:59]
    s_cbranch_scc1 L_kvw_63
L_kvb_64:
    v_mov_b32 v15, 0
    s_nop 2
    v_mov_b32 v15, 0
    s_nop 2
    v_mov_b32 v15, 0
    s_nop 2
    v_mov_b32 v15, 0
    s_nop 2
    v_mov_b32 v15, 0
    s_nop 2
    v_mov_b32 v15, 0
    s_nop 2
    v_mov_b32 v15, 0
    s_nop 2
    v_mov_b32 v15, 0
    s_nop 2
    v_mov_b32 v15, 0
    s_nop 2
    v_mov_b32 v15, 0
    s_nop 2
    v_mov_b32 v15, 0
    s_nop 2
    v_mov_b32 v15, 0
    s_nop 2
    v_mov_b32 v15, 0
    s_nop 2
    v_mov_b32 v15, 0
    s_nop 2
    v_mov_b32 v15, 0
    s_nop 2
    v_mov_b32 v15, 0
    s_nop 2
    v_mov_b32 v15, 0
    s_nop 2
    v_mov_b32 v15, 0
    s_nop 2
    v_mov_b32 v15, 0
    s_nop 2
    v_mov_b32 v15, 0
    s_nop 2
    v_mov_b32 v15, 0
    s_nop 2
    v_mov_b32 v15, 0
    s_nop 2
    v_mov_b32 v15, 0
    s_nop 2
    v_mov_b32 v15, 0
    s_nop 2
    v_mov_b32 v15, 0
    s_nop 2
    v_mov_b32 v15, 0
    s_nop 2
    v_mov_b32 v15, 0
    s_nop 2
    v_mov_b32 v15, 0
    s_nop 2
    v_mov_b32 v15, 0
    s_nop 2
    v_mov_b32 v15, 0
    s_nop 2
    v_mov_b32 v15, 0
    s_nop 2
    s_waitcnt lgkmcnt(0)
    s_branch L_chain_top0_s
.p2align 6
L_chain_top1_s:
    buffer_load_dwordx4 v[0:3], v117, s[8:11], s23 offen sc1
    v_mov_b32 v15, 0
    v_mov_b32 v15, 0
    v_mov_b32 v15, 0
    v_mov_b32 v15, 0
    v_mov_b32 v15, 0
    v_mov_b32 v15, 0
    v_mov_b32 v15, 0
    v_mov_b32 v15, 0
    v_mov_b32 v15, 0
    v_mov_b32 v15, 0
    v_mov_b32 v15, 0
    v_mov_b32 v15, 0
    v_mov_b32 v15, 0
    v_mov_b32 v15, 0
    v_mov_b32 v15, 0
    v_mov_b32 v15, 0
    buffer_load_dwordx4 v[0:3], v117, s[8:11], s23 offen sc1
    v_mov_b32 v15, 0
    v_mov_b32 v15, 0
    v_mov_b32 v15, 0
    v_mov_b32 v15, 0
    v_mov_b32 v15, 0
    v_mov_b32 v15, 0
    v_mov_b32 v15, 0
    v_mov_b32 v15, 0
    v_mov_b32 v15, 0
    v_mov_b32 v15, 0
    v_mov_b32 v15, 0
    v_mov_b32 v15, 0
    v_mov_b32 v15, 0
    v_mov_b32 v15, 0
    v_mov_b32 v15, 0
    v_mov_b32 v15, 0
L_mret_65:
    buffer_load_dwordx4 v[0:3], v117, s[8:11], s23 offen sc1
    s_add_u32 s45, s45, 1
    s_cmp_lt_u32 s45, 0x10000
    s_cselect_b32 s56, -2, -1
    s_nop 3
    v_mov_b32 v32, 0
    v_mov_b32 v33, 0
    v_mov_b32 v34, 0
    v_mov_b32 v35, 0
    s_waitcnt vmcnt(2)
    v_max3_u32 v15, v0, v1, v2
    v_max_u32 v15, v15, v3
    v_cmp_lt_u32 vcc, s56, v15
    v_smfmac_f32_16x16x64_bf16 v[32:35], v[0:3], v[80:87], v116
    s_cbranch_vccnz L_mret_65
    ds_write_b128 v117, v[0:3] offset:1024
    v_smfmac_f32_16x16x64_bf16 v[36:39], v[0:3], v[56:63], v116
    buffer_load_dwordx4 v[4:7], v117, s[8:11], s48 offen sc1
    v_smfmac_f32_16x16x64_bf16 v[40:43], v[0:3], v[64:71], v116
    buffer_load_dwordx4 v117, s[8:11], s48 offen sc1 lds
    s_mov_b32 m0, 10240
    v_smfmac_f32_16x16x64_bf16 v[44:47], v[0:3], v[72:79], v116
    s_waitcnt lgkmcnt(0)
    s_barrier
    ds_read_b128 v[8:11], v117
    v_smfmac_f32_16x16x64_bf16 v[48:51], v[0:3], a[192:199], v116
    ds_read_b128 v[16:19], v117 offset:3072
    ds_read_b128 v[20:23], v117 offset:2048
    v_smfmac_f32_16x16x64_bf16 v[52:55], v[0:3], a[200:207], v116
    ds_read_b128 v[80:83], v117 offset:14336
    s_waitcnt lgkmcnt(3)
    v_smfmac_f32_16x16x64_bf16 v[32:35], v[8:11], a[0:7], v116
    ds_read_b128 v[84:87], v117 offset:15360
    v_smfmac_f32_16x16x64_bf16 v[36:39], v[8:11], a[8:15], v116
    ds_read_b128 v[56:59], v117 offset:8192
    s_waitcnt lgkmcnt(4)
    v_smfmac_f32_16x16x64_bf16 v[32:35], v[16:19], a[32:39], v116
    ds_read_b128 v[60:63], v117 offset:9216
    v_smfmac_f32_16x16x64_bf16 v[36:39], v[16:19], a[40:47], v116
    buffer_store_dwordx4 v[112:115], v117, s[8:11], s32 offen sc1
    s_waitcnt lgkmcnt(4)
    v_smfmac_f32_16x16x64_bf16 v[32:35], v[20:23], a[64:71], v116
    ds_read_b128 v[64:67], v117 offset:10240
    v_smfmac_f32_16x16x64_bf16 v[36:39], v[20:23], a[72:79], v116
    ds_read_b128 v[68:71], v117 offset:11264
    v_smfmac_f32_16x16x64_bf16 v[40:43], v[8:11], a[96:103], v116
    ds_read_b128 v[72:75], v117 offset:12288
    v_smfmac_f32_16x16x64_bf16 v[40:43], v[16:19], a[128:135], v116
    ds_read_b128 v[76:79], v117 offset:13312
    v_smfmac_f32_16x16x64_bf16 v[40:43], v[20:23], a[160:167], v116
    s_waitcnt vmcnt(2)
    v_max3_u32 v15, v4, v5, v6
    v_smfmac_f32_16x16x64_bf16 v[44:47], v[8:11], a[104:111], v116
    v_max_u32 v15, v15, v7
    v_smfmac_f32_16x16x64_bf16 v[44:47], v[16:19], a[136:143], v116
    s_waitcnt vmcnt(1) lgkmcnt(0)
    v_cmp_lt_u32 vcc, s56, v15
    v_smfmac_f32_16x16x64_bf16 v[44:47], v[20:23], a[168:175], v116
    s_cbranch_vccnz L_mret_66
L_mgo_67:
    v_smfmac_f32_16x16x64_bf16 v[44:47], v[4:7], v[24:31], v116
    s_barrier
    ds_read_b128 v[12:15], v117 offset:4096
    v_smfmac_f32_16x16x64_bf16 v[32:35], v[4:7], v[88:95], v116
    ds_read_b128 v[24:27], v117 offset:7168
    v_smfmac_f32_16x16x64_bf16 v[36:39], v[4:7], v[96:103], v116
    ds_read_b128 v[28:31], v117 offset:6144
    v_smfmac_f32_16x16x64_bf16 v[40:43], v[4:7], v[104:111], v116
    ds_read_b128 v[88:91], v117 offset:26624
    s_waitcnt lgkmcnt(3)
    v_smfmac_f32_16x16x64_bf16 v[32:35], v[12:15], a[16:23], v116
    ds_read_b128 v[92:95], v117 offset:27648
    s_waitcnt lgkmcnt(3)
    v_smfmac_f32_16x16x64_bf16 v[32:35], v[24:27], a[48:55], v116
    buffer_load_dwordx4 v117, s[8:11], s30 offen lds
    s_waitcnt lgkmcnt(2)
    v_smfmac_f32_16x16x64_bf16 v[32:35], v[28:31], a[80:87], v116
    ds_read_b128 v[96:99], v117 offset:23552
    v_smfmac_f32_16x16x64_bf16 v[36:39], v[12:15], a[24:31], v116
    ds_read_b128 v[100:103], v117 offset:23552
    v_smfmac_f32_16x16x64_bf16 v[36:39], v[24:27], a[56:63], v116
    buffer_load_dwordx4 v117, s[8:11], s30 offen offset:1024 lds
    s_add_u32 m0, s52, 0x6000
    v_add_f32 v32, v32, v34
    v_smfmac_f32_16x16x64_bf16 v[36:39], v[28:31], a[88:95], v116
    ds_read_b128 v[104:107], v117 offset:23552
    v_add_f32 v33, v33, v35
    v_smfmac_f32_16x16x64_bf16 v[40:43], v[12:15], a[112:119], v116
    ds_read_b128 v[108:111], v117 offset:23552
    v_mul_f32 v32, s34, v32
    v_smfmac_f32_16x16x64_bf16 v[40:43], v[24:27], a[144:151], v116
    buffer_load_dword v125, v119, s[8:11], s28 offen sc1
    v_mul_f32 v33, s34, v33
    v_smfmac_f32_16x16x64_bf16 v[40:43], v[28:31], a[176:183], v116
    ds_read_b128 v[0:3], v124
    v_add_f32 v36, v36, v38
    v_smfmac_f32_16x16x64_bf16 v[48:51], v[4:7], a[208:215], v116
    v_add_f32 v37, v37, v39
    v_smfmac_f32_16x16x64_bf16 v[52:55], v[4:7], a[216:223], v116
    s_waitcnt lgkmcnt(5)
    buffer_load_dwordx4 v117, s[8:11], s31 offen lds
    v_mul_f32 v36, s34, v36
    v_smfmac_f32_16x16x64_bf16 v[44:47], v[12:15], a[120:127], v116
    ds_read_b128 v[4:7], v124 offset:1024
    v_mul_f32 v37, s34, v37
    v_smfmac_f32_16x16x64_bf16 v[44:47], v[24:27], a[152:159], v116
    v_cvt_pk_bf16_f32 v34, v32, v36
    v_smfmac_f32_16x16x64_bf16 v[44:47], v[28:31], a[184:191], v116
    buffer_load_dwordx4 v117, s[8:11], s31 offen offset:1024 lds
    s_mov_b32 m0, 5120
    v_cvt_pk_bf16_f32 v35, v33, v37
    v_add_f32 v40, v40, v42
    v_smfmac_f32_16x16x64_bf16 v[48:51], v[8:11], a[224:231], v116
    ds_write2_b32 v120, v34, v35 offset0:32 offset1:48
    v_add_f32 v41, v41, v43
    v_smfmac_f32_16x16x64_bf16 v[52:55], v[8:11], a[232:239], v116
    v_add_f32 v44, v44, v46
    v_add_f32 v45, v45, v47
    v_cvt_pk_bf16_f32 v113, v40, v44
    v_cvt_pk_bf16_f32 v115, v41, v45
    v_smfmac_f32_16x16x64_bf16 v[48:51], v[12:15], a[240:247], v116
    ds_write2_b32 v120, v113, v115 offset0:0 offset1:16
    v_smfmac_f32_16x16x64_bf16 v[52:55], v[12:15], a[248:255], v116
    s_cmp_eq_u32 s22, 63
    s_cbranch_scc1 L_chain_last_s
    v_smfmac_f32_16x16x64_bf16 v[48:51], v[16:19], v[128:135], v116
    v_smfmac_f32_16x16x64_bf16 v[48:51], v[20:23], v[160:167], v116
    v_smfmac_f32_16x16x64_bf16 v[48:51], v[24:27], v[144:151], v116
    s_waitcnt lgkmcnt(0)
    s_barrier
    v_smfmac_f32_16x16x64_bf16 v[48:51], v[28:31], v[176:183], v116
    ds_read_b128 v[32:35], v121 offset:16384
    ds_read_b128 v[36:39], v121 offset:17408
    v_smfmac_f32_16x16x64_bf16 v[52:55], v[16:19], v[136:143], v116
    ds_read_b128 v[40:43], v121 offset:18432
    ds_read_b128 v[44:47], v121 offset:19456
    v_smfmac_f32_16x16x64_bf16 v[52:55], v[20:23], v[168:175], v116
    ds_read_b128 v[8:11], v124 offset:32768
    v_add_f32 v48, v48, v50
    v_smfmac_f32_16x16x64_bf16 v[52:55], v[24:27], v[152:159], v116
    ds_read_b128 v[12:15], v124 offset:33792
    v_add_f32 v49, v49, v51
    v_smfmac_f32_16x16x64_bf16 v[52:55], v[28:31], v[184:191], v116
    s_waitcnt lgkmcnt(5)
    v_cvt_pk_bf16_f32 v112, v48, v49
    v_mfma_f32_16x16x32_bf16 v[56:59], v[56:59], v[32:35], 0
    s_waitcnt lgkmcnt(4)
    v_mov_b32 v48, s50
    v_mov_b32 v49, s50
    v_mfma_f32_16x16x32_bf16 v[56:59], v[60:63], v[36:39], v[56:59]
    ds_read_b128 v[16:19], v124 offset:2048
    s_waitcnt lgkmcnt(4)
    v_mov_b32 v50, s50
    v_mov_b32 v51, s50
    v_mfma_f32_16x16x32_bf16 v[56:59], v[64:67], v[40:43], v[56:59]
    ds_read_b128 v[20:23], v124 offset:3072
    s_waitcnt lgkmcnt(4)
    v_add_f32 v52, v52, v54
    v_mfma_f32_16x16x32_bf16 v[56:59], v[68:71], v[44:47], v[56:59]
    ds_read_b128 v[24:27], v124 offset:4096
    v_add_f32 v53, v53, v55
    v_mfma_f32_16x16x32_bf16 v[60:63], v[72:75], v[32:35], 0
    ds_read_b128 v[28:31], v124 offset:5120
    v_cvt_pk_bf16_f32 v114, v52, v53
    v_mov_b32 v53, 0
    v_mfma_f32_16x16x32_bf16 v[60:63], v[76:79], v[36:39], v[60:63]
    v_exp_f32 v56, v56
    v_mfma_f32_16x16x32_bf16 v[60:63], v[80:83], v[40:43], v[60:63]
    v_exp_f32 v57, v57
    v_mfma_f32_16x16x32_bf16 v[60:63], v[84:87], v[44:47], v[60:63]
    v_exp_f32 v58, v58
    v_mfma_f32_16x16x32_bf16 v[64:67], v[32:35], v[32:35], 0
    v_exp_f32 v59, v59
    v_cvt_pk_bf16_f32 v68, v56, v57
    v_mfma_f32_16x16x32_bf16 v[64:67], v[36:39], v[36:39], v[64:67]
    v_exp_f32 v60, v60
    v_cvt_pk_bf16_f32 v69, v58, v59
    v_mfma_f32_16x16x32_bf16 v[64:67], v[40:43], v[40:43], v[64:67]
    v_exp_f32 v61, v61
    v_mfma_f32_16x16x32_bf16 v[64:67], v[44:47], v[44:47], v[64:67]
    v_exp_f32 v62, v62
    v_exp_f32 v63, v63
    v_cvt_pk_bf16_f32 v70, v60, v61
    v_cvt_pk_bf16_f32 v71, v62, v63
    s_nop 1
    v_mfma_f32_16x16x32_bf16 v[72:75], v[88:91], v[68:71], 0
    s_nop 0
    v_exp_f32 v64, v64
    v_mfma_f32_16x16x32_bf16 v[76:79], v[92:95], v[68:71], 0
    v_exp_f32 v65, v65
    v_mfma_f32_16x16x32_bf16 v[80:83], v[48:51], v[68:71], 0
    v_cvt_pk_bf16_f32 v52, v64, v65
    s_nop 1
    v_mfma_f32_16x16x16_bf16 v[72:75], v[112:113], v[52:53], v[72:75]
    ds_read_b128 v[32:35], v124 offset:6144
    v_mfma_f32_16x16x16_bf16 v[76:79], v[114:115], v[52:53], v[76:79]
    ds_read_b128 v[36:39], v124 offset:7168
    v_mfma_f32_16x16x16_bf16 v[80:83], v[48:49], v[52:53], v[80:83]
L_norm_68:
    s_mov_b64 vcc, s[36:37]
    v_mov_b32 v122, v122
    v_mov_b32 v122, v122
    v_mov_b32 v122, v122
    v_cndmask_b32_dpp v76, v72, v76, vcc quad_perm:[2,3,2,3] row_mask:0xf bank_mask:0xf
    v_cndmask_b32_dpp v77, v73, v77, vcc quad_perm:[2,3,2,3] row_mask:0xf bank_mask:0xf
    v_cndmask_b32_dpp v78, v74, v78, vcc quad_perm:[2,3,2,3] row_mask:0xf bank_mask:0xf
    v_cndmask_b32_dpp v79, v75, v79, vcc quad_perm:[2,3,2,3] row_mask:0xf bank_mask:0xf
    v_rcp_f32_dpp v84, v80 quad_perm:[2,3,2,3] row_mask:0xf bank_mask:0xf
    s_nop 0
    v_pk_mul_f32 v[76:77], v[76:77], v[84:85] op_sel_hi:[1,0]
    v_pk_mul_f32 v[78:79], v[78:79], v[84:85] op_sel_hi:[1,0]
    v_cvt_pk_bf16_f32 v72, v76, v77
    v_cvt_pk_bf16_f32 v73, v78, v79
    ds_write_b64 v122, v[72:73] offset:20992
    v_max_f32_dpp v86, v80, v84 quad_perm:[2,3,2,3] row_mask:0xf bank_mask:0xf
    v_mov_b32_dpp v60, v72 quad_perm:[0,1,0,1] row_mask:0xf bank_mask:0xf
    v_mov_b32_dpp v61, v73 quad_perm:[0,1,0,1] row_mask:0xf bank_mask:0xf
    v_cmp_lt_f32 vcc, s35, v86
    v_mov_b32_dpp v62, v72 quad_perm:[2,3,2,3] row_mask:0xf bank_mask:0xf
    v_mov_b32_dpp v63, v73 quad_perm:[2,3,2,3] row_mask:0xf bank_mask:0xf
    s_nop 1
    v_smfmac_f32_16x16x64_bf16 v[96:99], v[60:63], v[192:199], v116
    s_cbranch_vccnz L_smax_69
    v_smfmac_f32_16x16x64_bf16 v[100:103], v[60:63], v[224:231], v116
    s_waitcnt lgkmcnt(0)
    s_barrier
    ds_read_b128 v[92:95], v127 offset:20480
    ds_read_b128 v[80:83], v127 offset:22016
    ds_read_b128 v[84:87], v127 offset:21504
    v_smfmac_f32_16x16x64_bf16 v[104:107], v[60:63], v[0:7], v116
    ds_read_b128 v[40:43], v124 offset:34816
    v_smfmac_f32_16x16x64_bf16 v[108:111], v[60:63], v[8:15], v116
    ds_read_b128 v[56:59], v124 offset:36864
    s_waitcnt lgkmcnt(4)
    v_smfmac_f32_16x16x64_bf16 v[96:99], v[92:95], v[200:207], v116
    s_waitcnt lgkmcnt(3)
    v_smfmac_f32_16x16x64_bf16 v[96:99], v[80:83], v[208:215], v116
    ds_read_b128 v[44:47], v124 offset:35840
    s_waitcnt lgkmcnt(3)
    v_smfmac_f32_16x16x64_bf16 v[96:99], v[84:87], v[216:223], v116
    ds_read_b128 v[68:71], v124 offset:39936
    v_smfmac_f32_16x16x64_bf16 v[100:103], v[92:95], v[232:239], v116
    ds_read_b128 v[64:67], v124 offset:38912
    v_smfmac_f32_16x16x64_bf16 v[100:103], v[80:83], v[240:247], v116
    ds_read_b128 v[60:63], v124 offset:37888
    v_cvt_pk_bf16_f32 v72, v96, v98
    v_smfmac_f32_16x16x64_bf16 v[100:103], v[84:87], v[248:255], v116
    v_and_or_b32 v72, v72, -2, s33
    v_smfmac_f32_16x16x64_bf16 v[104:107], v[92:95], v[16:23], v116
    v_cvt_pk_bf16_f32 v74, v97, v99
    v_smfmac_f32_16x16x64_bf16 v[104:107], v[80:83], v[24:31], v116
    v_cvt_pk_bf16_f32 v73, v100, v102
    v_cvt_pk_bf16_f32 v75, v101, v103
    v_smfmac_f32_16x16x64_bf16 v[104:107], v[84:87], v[32:39], v116
    buffer_store_dwordx4 v[72:75], v118, s[8:11], s25 offen sc1
    s_waitcnt lgkmcnt(3)
    v_smfmac_f32_16x16x64_bf16 v[108:111], v[92:95], v[40:47], v116
    s_waitcnt lgkmcnt(0)
    v_smfmac_f32_16x16x64_bf16 v[108:111], v[80:83], v[56:63], v116
    v_cvt_pk_bf16_f32 v76, v104, v106
    v_smfmac_f32_16x16x64_bf16 v[108:111], v[84:87], v[64:71], v116
    v_and_or_b32 v76, v76, -2, s33
    v_cvt_pk_bf16_f32 v78, v105, v107
    v_mov_b32 v122, v122
    v_mov_b32 v122, v122
    v_mov_b32 v122, v122
    v_mov_b32 v122, v122
    v_mov_b32 v122, v122
    v_mov_b32 v122, v122
    v_cvt_pk_bf16_f32 v77, v108, v110
    v_cvt_pk_bf16_f32 v79, v109, v111
    buffer_store_dwordx4 v[76:79], v118, s[8:11], s26 offen sc1
    s_add_u32 s30, s30, 0x40000
    s_add_u32 s31, s31, 0x40000
    s_add_u32 s32, s32, 0x20000
    s_add_u32 s23, s24, 1024
    s_add_u32 s48, s23, 4096
    s_xor_b32 s25, s25, 0x40000
    s_xor_b32 s26, s26, 0x40000
    s_mov_b32 s35, 0x49800000
    s_add_u32 s22, s22, 1
    v_mov_b32 v32, 0
    v_mov_b32 v33, 0
    v_mov_b32 v34, 0
    v_mov_b32 v35, 0
    v_mov_b32 v36, 0
    v_mov_b32 v37, 0
    v_mov_b32 v38, 0
    v_mov_b32 v39, 0
    v_mov_b32 v40, 0
    v_mov_b32 v41, 0
    v_mov_b32 v42, 0
    v_mov_b32 v43, 0
    v_mov_b32 v44, 0
    v_mov_b32 v45, 0
    v_mov_b32 v46, 0
    v_mov_b32 v47, 0
    v_mov_b32 v48, 0
    v_mov_b32 v49, 0
    v_mov_b32 v50, 0
    v_mov_b32 v51, 0
    v_mov_b32 v52, 0
    v_mov_b32 v53, 0
    v_mov_b32 v54, 0
    v_mov_b32 v55, 0
    ds_read_b128 v[80:83], v123
    ds_read_b128 v[84:87], v123 offset:1024
    ds_read_b128 v[56:59], v123 offset:2048
    ds_read_b128 v[60:63], v123 offset:3072
    ds_read_b128 v[64:67], v123 offset:32768
    ds_read_b128 v[68:71], v123 offset:33792
    ds_read_b128 v[72:75], v123 offset:34816
    ds_read_b128 v[76:79], v123 offset:35840
    ds_read_b128 v[88:91], v123 offset:4096
    ds_read_b128 v[92:95], v123 offset:5120
    ds_read_b128 v[96:99], v123 offset:6144
    ds_read_b128 v[100:103], v123 offset:7168
    ds_read_b128 v[104:107], v123 offset:36864
    ds_read_b128 v[108:111], v123 offset:37888
    ds_read_b128 v[24:27], v123 offset:38912
    ds_read_b128 v[28:31], v123 offset:39936
    s_add_u32 s24, s24, 8192
    s_bitset0_b32 s24, 15
    s_xor_b32 s55, s24, 16384
    s_xor_b32 s29, s29, 0x40000
    s_xor_b32 s53, s29, 1024
    s_bfe_u32 s33, s22, 0x10001
    s_add_u32 s40, s22, 5
    s_lshr_b32 s40, s40, 2
    s_min_u32 s40, s40, 16
    s_bfm_b32 s58, s40, 0
    s_waitcnt vmcnt(4)
    v_cmp_eq_u32 vcc, 0, v125
    s_nop 0
    s_and_b64 vcc, vcc, s[58:59]
    s_cbranch_scc1 L_kvw_70
L_kvb_71:
    v_mov_b32 v15, 0
    s_nop 2
    v_mov_b32 v15, 0
    s_nop 2
    v_mov_b32 v15, 0
    s_nop 2
    v_mov_b32 v15, 0
    s_nop 2
    v_mov_b32 v15, 0
    s_nop 2
    v_mov_b32 v15, 0
    s_nop 2
    v_mov_b32 v15, 0
    s_nop 2
    v_mov_b32 v15, 0
    s_nop 2
    v_mov_b32 v15, 0
    s_nop 2
    v_mov_b32 v15, 0
    s_nop 2
    v_mov_b32 v15, 0
    s_nop 2
    v_mov_b32 v15, 0
    s_nop 2
    v_mov_b32 v15, 0
    s_nop 2
    v_mov_b32 v15, 0
    s_nop 2
    v_mov_b32 v15, 0
    s_nop 2
    v_mov_b32 v15, 0
    s_nop 2
    v_mov_b32 v15, 0
    s_nop 2
    v_mov_b32 v15, 0
    s_nop 2
    v_mov_b32 v15, 0
    s_nop 2
    v_mov_b32 v15, 0
    s_nop 2
    v_mov_b32 v15, 0
    s_nop 2
    v_mov_b32 v15, 0
    s_nop 2
    v_mov_b32 v15, 0
    s_nop 2
    v_mov_b32 v15, 0
    s_nop 2
    v_mov_b32 v15, 0
    s_nop 2
    v_mov_b32 v15, 0
    s_nop 2
    v_mov_b32 v15, 0
    s_nop 2
    v_mov_b32 v15, 0
    s_nop 2
    v_mov_b32 v15, 0
    s_nop 2
    v_mov_b32 v15, 0
    s_nop 2
    v_mov_b32 v15, 0
    s_nop 2
    s_waitcnt lgkmcnt(0)
    s_branch L_chain_top1_s
.p2align 6
L_chain_top2_s:
    buffer_load_dwordx4 v[0:3], v117, s[8:11], s23 offen sc1
    v_mov_b32 v48, 0
    v_mov_b32 v49, 0
    v_mov_b32 v50, 0
    v_mov_b32 v51, 0
    v_mov_b32 v52, 0
    v_mov_b32 v53, 0
    v_mov_b32 v15, 0
    v_mov_b32 v15, 0
    v_mov_b32 v15, 0
    v_mov_b32 v15, 0
    v_mov_b32 v15, 0
    v_mov_b32 v15, 0
    v_mov_b32 v15, 0
    v_mov_b32 v15, 0
    v_mov_b32 v15, 0
    v_mov_b32 v15, 0
    buffer_load_dwordx4 v[0:3], v117, s[8:11], s23 offen sc1
    s_waitcnt vmcnt(3)
    v_mov_b32 v36, 0
    v_mov_b32 v37, 0
    v_mov_b32 v38, 0
    v_mov_b32 v39, 0
    v_mov_b32 v40, 0
    v_mov_b32 v41, 0
    v_mov_b32 v42, 0
    v_mov_b32 v43, 0
    v_mov_b32 v44, 0
    v_mov_b32 v45, 0
    v_mov_b32 v46, 0
    v_mov_b32 v47, 0
    v_mov_b32 v15, 0
    v_mov_b32 v15, 0
    v_mov_b32 v15, 0
    v_mov_b32 v15, 0
L_mret_72:
    buffer_load_dwordx4 v[0:3], v117, s[8:11], s23 offen sc1
    s_add_u32 s45, s45, 1
    s_cmp_lt_u32 s45, 0x10000
    s_cselect_b32 s56, -2, -1
    s_nop 3
    v_mov_b32 v32, 0
    v_mov_b32 v33, 0
    v_mov_b32 v34, 0
    v_mov_b32 v35, 0
    s_waitcnt vmcnt(2)
    v_max3_u32 v15, v0, v1, v2
    v_max_u32 v15, v15, v3
    v_cmp_lt_u32 vcc, s56, v15
    v_smfmac_f32_16x16x64_bf16 v[32:35], v[0:3], v[80:87], v116
    s_cbranch_vccnz L_mret_72
    ds_write_b128 v117, v[0:3] offset:2048
    v_smfmac_f32_16x16x64_bf16 v[36:39], v[0:3], v[56:63], v116
    buffer_load_dwordx4 v[4:7], v117, s[8:11], s48 offen sc1
    v_smfmac_f32_16x16x64_bf16 v[40:43], v[0:3], v[64:71], v116
    buffer_load_dwordx4 v117, s[8:11], s48 offen sc1 lds
    s_mov_b32 m0, 12288
    v_smfmac_f32_16x16x64_bf16 v[44:47], v[0:3], v[72:79], v116
    s_waitcnt lgkmcnt(0)
    s_barrier
    ds_read_b128 v[8:11], v117 offset:3072
    v_smfmac_f32_16x16x64_bf16 v[48:51], v[0:3], a[192:199], v116
    ds_read_b128 v[16:19], v117
    ds_read_b128 v[20:23], v117 offset:1024
    v_smfmac_f32_16x16x64_bf16 v[52:55], v[0:3], a[200:207], v116
    ds_read_b128 v[80:83], v117 offset:14336
    s_waitcnt lgkmcnt(3)
    v_smfmac_f32_16x16x64_bf16 v[32:35], v[8:11], a[0:7], v116
    ds_read_b128 v[84:87], v117 offset:15360
    v_smfmac_f32_16x16x64_bf16 v[36:39], v[8:11], a[8:15], v116
    ds_read_b128 v[56:59], v117 offset:8192
    s_waitcnt lgkmcnt(4)
    v_smfmac_f32_16x16x64_bf16 v[32:35], v[16:19], a[32:39], v116
    ds_read_b128 v[60:63], v117 offset:9216
    v_smfmac_f32_16x16x64_bf16 v[36:39], v[16:19], a[40:47], v116
    ds_read_b128 v[64:67], v117 offset:10240
    s_waitcnt lgkmcnt(5)
    v_smfmac_f32_16x16x64_bf16 v[32:35], v[20:23], a[64:71], v116
    ds_read_b128 v[68:71], v117 offset:11264
    v_smfmac_f32_16x16x64_bf16 v[36:39], v[20:23], a[72:79], v116
    buffer_store_dwordx4 v[112:115], v117, s[8:11], s32 offen sc1
    v_smfmac_f32_16x16x64_bf16 v[40:43], v[8:11], a[96:103], v116
    ds_read_b128 v[72:75], v117 offset:12288
    v_smfmac_f32_16x16x64_bf16 v[40:43], v[16:19], a[128:135], v116
    ds_read_b128 v[76:79], v117 offset:13312
    v_smfmac_f32_16x16x64_bf16 v[40:43], v[20:23], a[160:167], v116
    s_waitcnt vmcnt(2)
    v_max3_u32 v15, v4, v5, v6
    v_smfmac_f32_16x16x64_bf16 v[44:47], v[8:11], a[104:111], v116
    v_max_u32 v15, v15, v7
    v_smfmac_f32_16x16x64_bf16 v[44:47], v[16:19], a[136:143], v116
    s_waitcnt vmcnt(1) lgkmcnt(0)
    v_cmp_lt_u32 vcc, s56, v15
    v_smfmac_f32_16x16x64_bf16 v[44:47], v[20:23], a[168:175], v116
    s_cbranch_vccnz L_mret_73
L_mgo_74:
    v_smfmac_f32_16x16x64_bf16 v[44:47], v[4:7], v[24:31], v116
    s_barrier
    ds_read_b128 v[12:15], v117 offset:7168
    v_smfmac_f32_16x16x64_bf16 v[32:35], v[4:7], v[88:95], v116
    ds_read_b128 v[24:27], v117 offset:4096
    v_smfmac_f32_16x16x64_bf16 v[36:39], v[4:7], v[96:103], v116
    ds_read_b128 v[28:31], v117 offset:5120
    v_smfmac_f32_16x16x64_bf16 v[40:43], v[4:7], v[104:111], v116
    ds_read_b128 v[88:91], v117 offset:28672
    s_waitcnt lgkmcnt(3)
    v_smfmac_f32_16x16x64_bf16 v[32:35], v[12:15], a[16:23], v116
    ds_read_b128 v[92:95], v117 offset:29696
    s_waitcnt lgkmcnt(3)
    v_smfmac_f32_16x16x64_bf16 v[32:35], v[24:27], a[48:55], v116
    buffer_load_dwordx4 v117, s[8:11], s30 offen lds
    s_waitcnt lgkmcnt(2)
    v_smfmac_f32_16x16x64_bf16 v[32:35], v[28:31], a[80:87], v116
    ds_read_b128 v[96:99], v117 offset:23552
    v_smfmac_f32_16x16x64_bf16 v[36:39], v[12:15], a[24:31], v116
    ds_read_b128 v[100:103], v117 offset:23552
    v_smfmac_f32_16x16x64_bf16 v[36:39], v[24:27], a[56:63], v116
    buffer_load_dwordx4 v117, s[8:11], s30 offen offset:1024 lds
    s_add_u32 m0, s52, 0x6000
    v_add_f32 v32, v32, v34
    v_smfmac_f32_16x16x64_bf16 v[36:39], v[28:31], a[88:95], v116
    ds_read_b128 v[104:107], v117 offset:23552
    v_add_f32 v33, v33, v35
    v_smfmac_f32_16x16x64_bf16 v[40:43], v[12:15], a[112:119], v116
    ds_read_b128 v[108:111], v117 offset:23552
    v_mul_f32 v32, s34, v32
    v_smfmac_f32_16x16x64_bf16 v[40:43], v[24:27], a[144:151], v116
    s_waitcnt lgkmcnt(4)
    buffer_load_dwordx4 v117, s[8:11], s31 offen lds
    v_mul_f32 v33, s34, v33
    v_smfmac_f32_16x16x64_bf16 v[40:43], v[28:31], a[176:183], v116
    ds_read_b128 v[0:3], v124
    v_add_f32 v36, v36, v38
    v_smfmac_f32_16x16x64_bf16 v[48:51], v[4:7], a[208:215], v116
    v_add_f32 v37, v37, v39
    v_smfmac_f32_16x16x64_bf16 v[52:55], v[4:7], a[216:223], v116
    buffer_load_dwordx4 v117, s[8:11], s31 offen offset:1024 lds
    s_mov_b32 m0, 6144
    v_mul_f32 v36, s34, v36
    v_smfmac_f32_16x16x64_bf16 v[44:47], v[12:15], a[120:127], v116
    ds_read_b128 v[4:7], v124 offset:1024
    v_mul_f32 v37, s34, v37
    v_smfmac_f32_16x16x64_bf16 v[44:47], v[24:27], a[152:159], v116
    v_cvt_pk_bf16_f32 v34, v32, v36
    v_smfmac_f32_16x16x64_bf16 v[44:47], v[28:31], a[184:191], v116
    v_cvt_pk_bf16_f32 v35, v33, v37
    v_add_f32 v40, v40, v42
    v_smfmac_f32_16x16x64_bf16 v[48:51], v[8:11], a[224:231], v116
    ds_write2_b32 v120, v34, v35 offset0:32 offset1:48
    v_add_f32 v41, v41, v43
    v_smfmac_f32_16x16x64_bf16 v[52:55], v[8:11], a[232:239], v116
    v_add_f32 v44, v44, v46
    v_add_f32 v45, v45, v47
    v_cvt_pk_bf16_f32 v113, v40, v44
    v_cvt_pk_bf16_f32 v115, v41, v45
    v_smfmac_f32_16x16x64_bf16 v[48:51], v[12:15], a[240:247], v116
    ds_write2_b32 v120, v113, v115 offset0:0 offset1:16
    v_smfmac_f32_16x16x64_bf16 v[52:55], v[12:15], a[248:255], v116
    s_cmp_eq_u32 s22, 63
    s_cbranch_scc1 L_chain_last_s
    v_smfmac_f32_16x16x64_bf16 v[48:51], v[16:19], v[128:135], v116
    buffer_store_dword v126, v119, s[8:11], s55 offen sc1
    v_smfmac_f32_16x16x64_bf16 v[48:51], v[20:23], v[160:167], v116
    v_smfmac_f32_16x16x64_bf16 v[48:51], v[24:27], v[144:151], v116
    s_waitcnt lgkmcnt(0)
    s_barrier
    v_smfmac_f32_16x16x64_bf16 v[48:51], v[28:31], v[176:183], v116
    ds_read_b128 v[32:35], v121 offset:16384
    ds_read_b128 v[36:39], v121 offset:17408
    v_smfmac_f32_16x16x64_bf16 v[52:55], v[16:19], v[136:143], v116
    ds_read_b128 v[40:43], v121 offset:18432
    ds_read_b128 v[44:47], v121 offset:19456
    v_smfmac_f32_16x16x64_bf16 v[52:55], v[20:23], v[168:175], v116
    ds_read_b128 v[8:11], v124 offset:32768
    v_add_f32 v48, v48, v50
    v_smfmac_f32_16x16x64_bf16 v[52:55], v[24:27], v[152:159], v116
    ds_read_b128 v[12:15], v124 offset:33792
    v_add_f32 v49, v49, v51
    v_smfmac_f32_16x16x64_bf16 v[52:55], v[28:31], v[184:191], v116
    s_waitcnt lgkmcnt(5)
    v_cvt_pk_bf16_f32 v112, v48, v49
    v_mfma_f32_16x16x32_bf16 v[56:59], v[56:59], v[32:35], 0
    s_waitcnt lgkmcnt(4)
    v_mov_b32 v48, s50
    v_mov_b32 v49, s50
    v_mfma_f32_16x16x32_bf16 v[56:59], v[60:63], v[36:39], v[56:59]
    ds_read_b128 v[16:19], v124 offset:2048
    s_waitcnt lgkmcnt(4)
    v_mov_b32 v50, s50
    v_mov_b32 v51, s50
    v_mfma_f32_16x16x32_bf16 v[56:59], v[64:67], v[40:43], v[56:59]
    ds_read_b128 v[20:23], v124 offset:3072
    s_waitcnt lgkmcnt(4)
    v_add_f32 v52, v52, v54
    v_mfma_f32_16x16x32_bf16 v[56:59], v[68:71], v[44:47], v[56:59]
    ds_read_b128 v[24:27], v124 offset:4096
    v_add_f32 v53, v53, v55
    v_mfma_f32_16x16x32_bf16 v[60:63], v[72:75], v[32:35], 0
    ds_read_b128 v[28:31], v124 offset:5120
    v_cvt_pk_bf16_f32 v114, v52, v53
    v_mov_b32 v53, 0
    v_mfma_f32_16x16x32_bf16 v[60:63], v[76:79], v[36:39], v[60:63]
    v_exp_f32 v56, v56
    v_mfma_f32_16x16x32_bf16 v[60:63], v[80:83], v[40:43], v[60:63]
    v_exp_f32 v57, v57
    v_mfma_f32_16x16x32_bf16 v[60:63], v[84:87], v[44:47], v[60:63]
    v_exp_f32 v58, v58
    v_mfma_f32_16x16x32_bf16 v[64:67], v[32:35], v[32:35], 0
    v_exp_f32 v59, v59
    v_cvt_pk_bf16_f32 v68, v56, v57
    v_mfma_f32_16x16x32_bf16 v[64:67], v[36:39], v[36:39], v[64:67]
    v_exp_f32 v60, v60
    v_cvt_pk_bf16_f32 v69, v58, v59
    v_mfma_f32_16x16x32_bf16 v[64:67], v[40:43], v[40:43], v[64:67]
    v_exp_f32 v61, v61
    v_mfma_f32_16x16x32_bf16 v[64:67], v[44:47], v[44:47], v[64:67]
    v_exp_f32 v62, v62
    v_exp_f32 v63, v63
    v_cvt_pk_bf16_f32 v70, v60, v61
    v_cvt_pk_bf16_f32 v71, v62, v63
    s_nop 1
    v_mfma_f32_16x16x32_bf16 v[72:75], v[88:91], v[68:71], 0
    s_nop 0
    v_exp_f32 v64, v64
    v_mfma_f32_16x16x32_bf16 v[76:79], v[92:95], v[68:71], 0
    v_exp_f32 v65, v65
    v_mfma_f32_16x16x32_bf16 v[80:83], v[48:51], v[68:71], 0
    v_cvt_pk_bf16_f32 v52, v64, v65
    s_nop 1
    v_mfma_f32_16x16x16_bf16 v[72:75], v[112:113], v[52:53], v[72:75]
    ds_read_b128 v[32:35], v124 offset:6144
    v_mfma_f32_16x16x16_bf16 v[76:79], v[114:115], v[52:53], v[76:79]
    ds_read_b128 v[36:39], v124 offset:7168
    v_mfma_f32_16x16x16_bf16 v[80:83], v[48:49], v[52:53], v[80:83]
L_norm_75:
    s_mov_b64 vcc, s[36:37]
    v_mov_b32 v122, v122
    v_mov_b32 v122, v122
    v_mov_b32 v122, v122
    v_cndmask_b32_dpp v76, v72, v76, vcc quad_perm:[2,3,2,3] row_mask:0xf bank_mask:0xf
    v_cndmask_b32_dpp v77, v73, v77, vcc quad_perm:[2,3,2,3] row_mask:0xf bank_mask:0xf
    v_cndmask_b32_dpp v78, v74, v78, vcc quad_perm:[2,3,2,3] row_mask:0xf bank_mask:0xf
    v_cndmask_b32_dpp v79, v75, v79, vcc quad_perm:[2,3,2,3] row_mask:0xf bank_mask:0xf
    v_rcp_f32_dpp v84, v80 quad_perm:[2,3,2,3] row_mask:0xf bank_mask:0xf
    s_nop 0
    v_pk_mul_f32 v[76:77], v[76:77], v[84:85] op_sel_hi:[1,0]
    v_pk_mul_f32 v[78:79], v[78:79], v[84:85] op_sel_hi:[1,0]
    v_cvt_pk_bf16_f32 v72, v76, v77
    v_cvt_pk_bf16_f32 v73, v78, v79
    ds_write_b64 v122, v[72:73] offset:21504
    v_max_f32_dpp v86, v80, v84 quad_perm:[2,3,2,3] row_mask:0xf bank_mask:0xf
    v_mov_b32_dpp v60, v72 quad_perm:[0,1,0,1] row_mask:0xf bank_mask:0xf
    v_mov_b32_dpp v61, v73 quad_perm:[0,1,0,1] row_mask:0xf bank_mask:0xf
    v_cmp_lt_f32 vcc, s35, v86
    v_mov_b32_dpp v62, v72 quad_perm:[2,3,2,3] row_mask:0xf bank_mask:0xf
    v_mov_b32_dpp v63, v73 quad_perm:[2,3,2,3] row_mask:0xf bank_mask:0xf
    s_nop 1
    v_smfmac_f32_16x16x64_bf16 v[96:99], v[60:63], v[192:199], v116
    s_cbranch_vccnz L_smax_76
    v_smfmac_f32_16x16x64_bf16 v[100:103], v[60:63], v[224:231], v116
    s_waitcnt lgkmcnt(0)
    s_barrier
    ds_read_b128 v[92:95], v127 offset:22016
    ds_read_b128 v[80:83], v127 offset:20480
    ds_read_b128 v[84:87], v127 offset:20992
    v_smfmac_f32_16x16x64_bf16 v[104:107], v[60:63], v[0:7], v116
    ds_read_b128 v[40:43], v124 offset:34816
    v_smfmac_f32_16x16x64_bf16 v[108:111], v[60:63], v[8:15], v116
    ds_read_b128 v[56:59], v124 offset:36864
    s_waitcnt lgkmcnt(4)
    v_smfmac_f32_16x16x64_bf16 v[96:99], v[92:95], v[200:207], v116
    s_waitcnt lgkmcnt(3)
    v_smfmac_f32_16x16x64_bf16 v[96:99], v[80:83], v[208:215], v116
    ds_read_b128 v[44:47], v124 offset:35840
    s_waitcnt lgkmcnt(3)
    v_smfmac_f32_16x16x64_bf16 v[96:99], v[84:87], v[216:223], v116
    ds_read_b128 v[68:71], v124 offset:39936
    v_smfmac_f32_16x16x64_bf16 v[100:103], v[92:95], v[232:239], v116
    ds_read_b128 v[64:67], v124 offset:38912
    v_smfmac_f32_16x16x64_bf16 v[100:103], v[80:83], v[240:247], v116
    ds_read_b128 v[60:63], v124 offset:37888
    v_cvt_pk_bf16_f32 v72, v96, v98
    v_smfmac_f32_16x16x64_bf16 v[100:103], v[84:87], v[248:255], v116
    v_and_or_b32 v72, v72, -2, s33
    v_smfmac_f32_16x16x64_bf16 v[104:107], v[92:95], v[16:23], v116
    v_cvt_pk_bf16_f32 v74, v97, v99
    v_smfmac_f32_16x16x64_bf16 v[104:107], v[80:83], v[24:31], v116
    v_cvt_pk_bf16_f32 v73, v100, v102
    v_cvt_pk_bf16_f32 v75, v101, v103
    v_smfmac_f32_16x16x64_bf16 v[104:107], v[84:87], v[32:39], v116
    buffer_store_dwordx4 v[72:75], v118, s[8:11], s25 offen sc1
    s_waitcnt lgkmcnt(3)
    v_smfmac_f32_16x16x64_bf16 v[108:111], v[92:95], v[40:47], v116
    s_waitcnt lgkmcnt(0)
    v_smfmac_f32_16x16x64_bf16 v[108:111], v[80:83], v[56:63], v116
    v_cvt_pk_bf16_f32 v76, v104, v106
    v_smfmac_f32_16x16x64_bf16 v[108:111], v[84:87], v[64:71], v116
    v_and_or_b32 v76, v76, -2, s33
    v_cvt_pk_bf16_f32 v78, v105, v107
    v_mov_b32 v122, v122
    v_mov_b32 v122, v122
    v_mov_b32 v122, v122
    v_mov_b32 v122, v122
    v_mov_b32 v122, v122
    v_mov_b32 v122, v122
    v_cvt_pk_bf16_f32 v77, v108, v110
    v_cvt_pk_bf16_f32 v79, v109, v111
    buffer_store_dwordx4 v[76:79], v118, s[8:11], s26 offen sc1
    ds_read_b128 v[80:83], v123
    ds_read_b128 v[84:87], v123 offset:1024
    ds_read_b128 v[56:59], v123 offset:2048
    ds_read_b128 v[60:63], v123 offset:3072
    ds_read_b128 v[64:67], v123 offset:32768
    ds_read_b128 v[68:71], v123 offset:33792
    ds_read_b128 v[72:75], v123 offset:34816
    ds_read_b128 v[76:79], v123 offset:35840
    ds_read_b128 v[88:91], v123 offset:4096
    ds_read_b128 v[92:95], v123 offset:5120
    ds_read_b128 v[96:99], v123 offset:6144
    ds_read_b128 v[100:103], v123 offset:7168
    ds_read_b128 v[104:107], v123 offset:36864
    ds_read_b128 v[108:111], v123 offset:37888
    ds_read_b128 v[24:27], v123 offset:38912
    ds_read_b128 v[28:31], v123 offset:39936
    s_add_u32 s30, s30, 0x40000
    s_add_u32 s31, s31, 0x40000
    s_add_u32 s32, s32, 0x20000
    s_add_u32 s23, s24, 2048
    s_add_u32 s48, s23, 4096
    s_xor_b32 s25, s25, 0x40000
    s_xor_b32 s26, s26, 0x40000
    s_mov_b32 s35, 0x49800000
    s_add_u32 s22, s22, 1
    v_cndmask_b32 v12, 0, v125, s[68:69]
    v_cndmask_b32 v13, 0, v125, s[70:71]
    v_cndmask_b32 v14, 0, v125, s[72:73]
    v_cndmask_b32 v15, 0, v125, s[74:75]
    v_mov_b32 v54, 0
    v_mov_b32 v55, 0
    v_mov_b32 v52, 0
    v_mov_b32 v52, 0
    v_mov_b32 v52, 0
    v_mov_b32 v52, 0
    v_mov_b32 v52, 0
    v_mov_b32 v52, 0
    v_mov_b32 v52, 0
    v_mov_b32 v52, 0
    v_mov_b32 v52, 0
    v_mov_b32 v52, 0
    v_mov_b32 v52, 0
    v_mov_b32 v52, 0
    v_mov_b32 v52, 0
    v_mov_b32 v52, 0
    v_mov_b32 v52, 0
    v_mov_b32 v52, 0
    v_mov_b32 v52, 0
    v_mov_b32 v52, 0
    v_mov_b32 v52, 0
    buffer_load_dwordx4 v[4:7], v117, s[8:11], s29 offen sc1
    buffer_load_dwordx4 v[8:11], v117, s[8:11], s53 offen sc1
    buffer_load_dwordx4 v[16:19], v117, s[8:11], s29 offen offset:2048 sc1
    buffer_load_dwordx4 v[20:23], v117, s[8:11], s53 offen offset:2048 sc1
    v_mov_b32 v52, 0
    v_mov_b32 v52, 0
    v_mov_b32 v52, 0
    v_mov_b32 v52, 0
    v_mov_b32 v52, 0
    v_mov_b32 v52, 0
    v_mov_b32 v52, 0
    v_mov_b32 v52, 0
    v_mov_b32 v52, 0
    v_mov_b32 v52, 0
    v_mov_b32 v52, 0
    v_mov_b32 v52, 0
    v_mov_b32 v52, 0
    v_mov_b32 v52, 0
    v_mov_b32 v52, 0
    v_mov_b32 v52, 0
    v_mov_b32 v52, 0
    v_mov_b32 v52, 0
    v_mov_b32 v52, 0
    v_mov_b32 v52, 0
    v_mov_b32 v52, 0
    v_mov_b32 v52, 0
    v_mov_b32 v52, 0
    v_mov_b32 v52, 0
    v_mov_b32 v52, 0
    v_mov_b32 v52, 0
    v_mov_b32 v52, 0
    v_mov_b32 v52, 0
    v_mov_b32 v52, 0
    v_mov_b32 v52, 0
    v_mov_b32 v52, 0
    v_mov_b32 v52, 0
    v_mov_b32 v52, 0
    v_mov_b32 v52, 0
    v_mov_b32 v52, 0
    v_mov_b32 v52, 0
    v_mov_b32 v52, 0
    v_mov_b32 v52, 0
    v_mov_b32 v52, 0
    v_mov_b32 v52, 0
    buffer_load_dwordx4 v[32:35], v117, s[8:11], s29 offen sc1
    buffer_load_dwordx4 v[36:39], v117, s[8:11], s53 offen sc1
    buffer_load_dwordx4 v[40:43], v117, s[8:11], s29 offen offset:2048 sc1
    buffer_load_dwordx4 v[44:47], v117, s[8:11], s53 offen offset:2048 sc1
    v_mov_b32 v52, 0
L_rl_77:
    s_waitcnt vmcnt(7)
    v_mfma_f32_16x16x32_bf16 v[48:51], v[4:7], v[12:15], 0
    v_xor_b32 v52, s33, v4
    s_waitcnt vmcnt(6)
    v_mfma_f32_16x16x32_bf16 v[48:51], v[8:11], v[12:15], v[48:51]
    v_xor_b32 v53, s33, v8
    v_or_b32 v52, v52, v53
    s_waitcnt vmcnt(5)
    v_mfma_f32_16x16x32_bf16 v[48:51], v[16:19], v[12:15], v[48:51]
    v_xor_b32 v53, s33, v16
    v_or_b32 v52, v52, v53
    s_waitcnt vmcnt(4)
    v_mfma_f32_16x16x32_bf16 v[48:51], v[20:23], v[12:15], v[48:51]
    v_xor_b32 v53, s33, v20
    v_or_b32 v52, v52, v53
    v_and_b32 v52, 1, v52
    v_cmp_ne_u32 vcc, 0, v52
    s_cbranch_vccnz L_rslow_78
L_rgo_79:
    s_nop 2
    v_permlane32_swap_b32 v48, v50
    v_permlane32_swap_b32 v49, v51
    v_pk_add_f32 v[48:49], v[48:49], v[50:51]
    s_mov_b64 exec, s[38:39]
    v_cvt_pk_bf16_f32 v12, v48, v49
    v_min_u32 v12, 0xfffffffe, v12
    buffer_store_dword v12, v119, s[8:11], s24 offen sc1
    s_mov_b64 exec, -1
    s_add_u32 s24, s24, 8192
    s_bitset0_b32 s24, 15
    s_xor_b32 s55, s24, 16384
    s_xor_b32 s29, s29, 0x40000
    s_xor_b32 s53, s29, 1024
    s_bfe_u32 s33, s22, 0x10001
    s_waitcnt lgkmcnt(0)
    s_branch L_chain_top2_s
.p2align 6
L_chain_top3_s:
    buffer_load_dwordx4 v[0:3], v117, s[8:11], s23 offen sc1
    v_mov_b32 v48, 0
    v_mov_b32 v49, 0
    v_mov_b32 v50, 0
    v_mov_b32 v51, 0
    v_mov_b32 v52, 0
    v_mov_b32 v53, 0
    v_mov_b32 v15, 0
    v_mov_b32 v15, 0
    v_mov_b32 v15, 0
    v_mov_b32 v15, 0
    v_mov_b32 v15, 0
    v_mov_b32 v15, 0
    v_mov_b32 v15, 0
    v_mov_b32 v15, 0
    v_mov_b32 v15, 0
    v_mov_b32 v15, 0
    buffer_load_dwordx4 v[0:3], v117, s[8:11], s23 offen sc1
    s_waitcnt vmcnt(3)
    v_mov_b32 v36, 0
    v_mov_b32 v37, 0
    v_mov_b32 v38, 0
    v_mov_b32 v39, 0
    v_mov_b32 v40, 0
    v_mov_b32 v41, 0
    v_mov_b32 v42, 0
    v_mov_b32 v43, 0
    v_mov_b32 v44, 0
    v_mov_b32 v45, 0
    v_mov_b32 v46, 0
    v_mov_b32 v47, 0
    v_mov_b32 v15, 0
    v_mov_b32 v15, 0
    v_mov_b32 v15, 0
    v_mov_b32 v15, 0
L_mret_80:
    buffer_load_dwordx4 v[0:3], v117, s[8:11], s23 offen sc1
    s_add_u32 s45, s45, 1
    s_cmp_lt_u32 s45, 0x10000
    s_cselect_b32 s56, -2, -1
    s_nop 3
    v_mov_b32 v32, 0
    v_mov_b32 v33, 0
    v_mov_b32 v34, 0
    v_mov_b32 v35, 0
    s_waitcnt vmcnt(2)
    v_max3_u32 v15, v0, v1, v2
    v_max_u32 v15, v15, v3
    v_cmp_lt_u32 vcc, s56, v15
    v_smfmac_f32_16x16x64_bf16 v[32:35], v[0:3], v[80:87], v116
    s_cbranch_vccnz L_mret_80
    ds_write_b128 v117, v[0:3] offset:3072
    v_smfmac_f32_16x16x64_bf16 v[36:39], v[0:3], v[56:63], v116
    buffer_load_dwordx4 v[4:7], v117, s[8:11], s48 offen sc1
    v_smfmac_f32_16x16x64_bf16 v[40:43], v[0:3], v[64:71], v116
    buffer_load_dwordx4 v117, s[8:11], s48 offen sc1 lds
    s_mov_b32 m0, 14336
    v_smfmac_f32_16x16x64_bf16 v[44:47], v[0:3], v[72:79], v116
    s_waitcnt lgkmcnt(0)
    s_barrier
    ds_read_b128 v[8:11], v117 offset:2048
    v_smfmac_f32_16x16x64_bf16 v[48:51], v[0:3], a[192:199], v116
    ds_read_b128 v[16:19], v117 offset:1024
    ds_read_b128 v[20:23], v117
    v_smfmac_f32_16x16x64_bf16 v[52:55], v[0:3], a[200:207], v116
    ds_read_b128 v[80:83], v117 offset:14336
    s_waitcnt lgkmcnt(3)
    v_smfmac_f32_16x16x64_bf16 v[32:35], v[8:11], a[0:7], v116
    ds_read_b128 v[84:87], v117 offset:15360
    v_smfmac_f32_16x16x64_bf16 v[36:39], v[8:11], a[8:15], v116
    ds_read_b128 v[56:59], v117 offset:8192
    s_waitcnt lgkmcnt(4)
    v_smfmac_f32_16x16x64_bf16 v[32:35], v[16:19], a[32:39], v116
    ds_read_b128 v[60:63], v117 offset:9216
    v_smfmac_f32_16x16x64_bf16 v[36:39], v[16:19], a[40:47], v116
    ds_read_b128 v[64:67], v117 offset:10240
    s_waitcnt lgkmcnt(5)
    v_smfmac_f32_16x16x64_bf16 v[32:35], v[20:23], a[64:71], v116
    ds_read_b128 v[68:71], v117 offset:11264
    v_smfmac_f32_16x16x64_bf16 v[36:39], v[20:23], a[72:79], v116
    ds_read_b128 v[72:75], v117 offset:12288
    v_smfmac_f32_16x16x64_bf16 v[40:43], v[8:11], a[96:103], v116
    ds_read_b128 v[76:79], v117 offset:13312
    v_smfmac_f32_16x16x64_bf16 v[40:43], v[16:19], a[128:135], v116
    buffer_store_dwordx4 v[112:115], v117, s[8:11], s32 offen sc1
    v_smfmac_f32_16x16x64_bf16 v[40:43], v[20:23], a[160:167], v116
    s_waitcnt vmcnt(2)
    v_max3_u32 v15, v4, v5, v6
    v_smfmac_f32_16x16x64_bf16 v[44:47], v[8:11], a[104:111], v116
    v_max_u32 v15, v15, v7
    v_smfmac_f32_16x16x64_bf16 v[44:47], v[16:19], a[136:143], v116
    s_waitcnt vmcnt(1) lgkmcnt(0)
    v_cmp_lt_u32 vcc, s56, v15
    v_smfmac_f32_16x16x64_bf16 v[44:47], v[20:23], a[168:175], v116
    s_cbranch_vccnz L_mret_81
L_mgo_82:
    v_smfmac_f32_16x16x64_bf16 v[44:47], v[4:7], v[24:31], v116
    s_barrier
    ds_read_b128 v[12:15], v117 offset:6144
    v_smfmac_f32_16x16x64_bf16 v[32:35], v[4:7], v[88:95], v116
    ds_read_b128 v[24:27], v117 offset:5120
    v_smfmac_f32_16x16x64_bf16 v[36:39], v[4:7], v[96:103], v116
    ds_read_b128 v[28:31], v117 offset:4096
    v_smfmac_f32_16x16x64_bf16 v[40:43], v[4:7], v[104:111], v116
    ds_read_b128 v[88:91], v117 offset:30720
    s_waitcnt lgkmcnt(3)
    v_smfmac_f32_16x16x64_bf16 v[32:35], v[12:15], a[16:23], v116
    ds_read_b128 v[92:95], v117 offset:31744
    s_waitcnt lgkmcnt(3)
    v_smfmac_f32_16x16x64_bf16 v[32:35], v[24:27], a[48:55], v116
    ds_read_b128 v[96:99], v117 offset:23552
    s_waitcnt lgkmcnt(3)
    v_smfmac_f32_16x16x64_bf16 v[32:35], v[28:31], a[80:87], v116
    buffer_load_dwordx4 v117, s[8:11], s30 offen lds
    v_smfmac_f32_16x16x64_bf16 v[36:39], v[12:15], a[24:31], v116
    ds_read_b128 v[100:103], v117 offset:23552
    v_smfmac_f32_16x16x64_bf16 v[36:39], v[24:27], a[56:63], v116
    ds_read_b128 v[104:107], v117 offset:23552
    v_add_f32 v32, v32, v34
    v_smfmac_f32_16x16x64_bf16 v[36:39], v[28:31], a[88:95], v116
    buffer_load_dwordx4 v117, s[8:11], s30 offen offset:1024 lds
    s_add_u32 m0, s52, 0x6000
    v_add_f32 v33, v33, v35
    v_smfmac_f32_16x16x64_bf16 v[40:43], v[12:15], a[112:119], v116
    ds_read_b128 v[108:111], v117 offset:23552
    v_mul_f32 v32, s34, v32
    v_smfmac_f32_16x16x64_bf16 v[40:43], v[24:27], a[144:151], v116
    ds_read_b128 v[0:3], v124
    v_mul_f32 v33, s34, v33
    v_smfmac_f32_16x16x64_bf16 v[40:43], v[28:31], a[176:183], v116
    s_waitcnt lgkmcnt(5)
    buffer_load_dwordx4 v117, s[8:11], s31 offen lds
    v_add_f32 v36, v36, v38
    v_smfmac_f32_16x16x64_bf16 v[48:51], v[4:7], a[208:215], v116
    v_add_f32 v37, v37, v39
    v_smfmac_f32_16x16x64_bf16 v[52:55], v[4:7], a[216:223], v116
    ds_read_b128 v[4:7], v124 offset:1024
    v_mul_f32 v36, s34, v36
    v_smfmac_f32_16x16x64_bf16 v[44:47], v[12:15], a[120:127], v116
    buffer_load_dwordx4 v117, s[8:11], s31 offen offset:1024 lds
    s_mov_b32 m0, 7168
    v_mul_f32 v37, s34, v37
    v_smfmac_f32_16x16x64_bf16 v[44:47], v[24:27], a[152:159], v116
    v_cvt_pk_bf16_f32 v34, v32, v36
    v_smfmac_f32_16x16x64_bf16 v[44:47], v[28:31], a[184:191], v116
    v_cvt_pk_bf16_f32 v35, v33, v37
    v_add_f32 v40, v40, v42
    v_smfmac_f32_16x16x64_bf16 v[48:51], v[8:11], a[224:231], v116
    ds_write2_b32 v120, v34, v35 offset0:32 offset1:48
    v_add_f32 v41, v41, v43
    v_smfmac_f32_16x16x64_bf16 v[52:55], v[8:11], a[232:239], v116
    v_add_f32 v44, v44, v46
    v_add_f32 v45, v45, v47
    v_cvt_pk_bf16_f32 v113, v40, v44
    v_cvt_pk_bf16_f32 v115, v41, v45
    v_smfmac_f32_16x16x64_bf16 v[48:51], v[12:15], a[240:247], v116
    ds_write2_b32 v120, v113, v115 offset0:0 offset1:16
    v_smfmac_f32_16x16x64_bf16 v[52:55], v[12:15], a[248:255], v116
    s_cmp_eq_u32 s22, 63
    s_cbranch_scc1 L_chain_last_s
    v_smfmac_f32_16x16x64_bf16 v[48:51], v[16:19], v[128:135], v116
    v_smfmac_f32_16x16x64_bf16 v[48:51], v[20:23], v[160:167], v116
    buffer_store_dword v126, v119, s[8:11], s55 offen sc1
    v_smfmac_f32_16x16x64_bf16 v[48:51], v[24:27], v[144:151], v116
    s_waitcnt lgkmcnt(0)
    s_barrier
    v_smfmac_f32_16x16x64_bf16 v[48:51], v[28:31], v[176:183], v116
    ds_read_b128 v[32:35], v121 offset:16384
    ds_read_b128 v[36:39], v121 offset:17408
    v_smfmac_f32_16x16x64_bf16 v[52:55], v[16:19], v[136:143], v116
    ds_read_b128 v[40:43], v121 offset:18432
    ds_read_b128 v[44:47], v121 offset:19456
    v_smfmac_f32_16x16x64_bf16 v[52:55], v[20:23], v[168:175], v116
    ds_read_b128 v[8:11], v124 offset:32768
    v_add_f32 v48, v48, v50
    v_smfmac_f32_16x16x64_bf16 v[52:55], v[24:27], v[152:159], v116
    ds_read_b128 v[12:15], v124 offset:33792
    v_add_f32 v49, v49, v51
    v_smfmac_f32_16x16x64_bf16 v[52:55], v[28:31], v[184:191], v116
    s_waitcnt lgkmcnt(5)
    v_cvt_pk_bf16_f32 v112, v48, v49
    v_mfma_f32_16x16x32_bf16 v[56:59], v[56:59], v[32:35], 0
    s_waitcnt lgkmcnt(4)
    v_mov_b32 v48, s50
    v_mov_b32 v49, s50
    v_mfma_f32_16x16x32_bf16 v[56:59], v[60:63], v[36:39], v[56:59]
    ds_read_b128 v[16:19], v124 offset:2048
    s_waitcnt lgkmcnt(4)
    v_mov_b32 v50, s50
    v_mov_b32 v51, s50
    v_mfma_f32_16x16x32_bf16 v[56:59], v[64:67], v[40:43], v[56:59]
    ds_read_b128 v[20:23], v124 offset:3072
    s_waitcnt lgkmcnt(4)
    v_add_f32 v52, v52, v54
    v_mfma_f32_16x16x32_bf16 v[56:59], v[68:71], v[44:47], v[56:59]
    ds_read_b128 v[24:27], v124 offset:4096
    v_add_f32 v53, v53, v55
    v_mfma_f32_16x16x32_bf16 v[60:63], v[72:75], v[32:35], 0
    ds_read_b128 v[28:31], v124 offset:5120
    v_cvt_pk_bf16_f32 v114, v52, v53
    v_mov_b32 v53, 0
    v_mfma_f32_16x16x32_bf16 v[60:63], v[76:79], v[36:39], v[60:63]
    v_exp_f32 v56, v56
    v_mfma_f32_16x16x32_bf16 v[60:63], v[80:83], v[40:43], v[60:63]
    v_exp_f32 v57, v57
    v_mfma_f32_16x16x32_bf16 v[60:63], v[84:87], v[44:47], v[60:63]
    v_exp_f32 v58, v58
    v_mfma_f32_16x16x32_bf16 v[64:67], v[32:35], v[32:35], 0
    v_exp_f32 v59, v59
    v_cvt_pk_bf16_f32 v68, v56, v57
    v_mfma_f32_16x16x32_bf16 v[64:67], v[36:39], v[36:39], v[64:67]
    v_exp_f32 v60, v60
    v_cvt_pk_bf16_f32 v69, v58, v59
    v_mfma_f32_16x16x32_bf16 v[64:67], v[40:43], v[40:43], v[64:67]
    v_exp_f32 v61, v61
    v_mfma_f32_16x16x32_bf16 v[64:67], v[44:47], v[44:47], v[64:67]
    v_exp_f32 v62, v62
    v_exp_f32 v63, v63
    v_cvt_pk_bf16_f32 v70, v60, v61
    v_cvt_pk_bf16_f32 v71, v62, v63
    s_nop 1
    v_mfma_f32_16x16x32_bf16 v[72:75], v[88:91], v[68:71], 0
    s_nop 0
    v_exp_f32 v64, v64
    v_mfma_f32_16x16x32_bf16 v[76:79], v[92:95], v[68:71], 0
    v_exp_f32 v65, v65
    v_mfma_f32_16x16x32_bf16 v[80:83], v[48:51], v[68:71], 0
    v_cvt_pk_bf16_f32 v52, v64, v65
    s_nop 1
    v_mfma_f32_16x16x16_bf16 v[72:75], v[112:113], v[52:53], v[72:75]
    ds_read_b128 v[32:35], v124 offset:6144
    v_mfma_f32_16x16x16_bf16 v[76:79], v[114:115], v[52:53], v[76:79]
    ds_read_b128 v[36:39], v124 offset:7168
    v_mfma_f32_16x16x16_bf16 v[80:83], v[48:49], v[52:53], v[80:83]
L_norm_83:
    s_mov_b64 vcc, s[36:37]
    v_mov_b32 v122, v122
    v_mov_b32 v122, v122
    v_mov_b32 v122, v122
    v_cndmask_b32_dpp v76, v72, v76, vcc quad_perm:[2,3,2,3] row_mask:0xf bank_mask:0xf
    v_cndmask_b32_dpp v77, v73, v77, vcc quad_perm:[2,3,2,3] row_mask:0xf bank_mask:0xf
    v_cndmask_b32_dpp v78, v74, v78, vcc quad_perm:[2,3,2,3] row_mask:0xf bank_mask:0xf
    v_cndmask_b32_dpp v79, v75, v79, vcc quad_perm:[2,3,2,3] row_mask:0xf bank_mask:0xf
    v_rcp_f32_dpp v84, v80 quad_perm:[2,3,2,3] row_mask:0xf bank_mask:0xf
    s_nop 0
    v_pk_mul_f32 v[76:77], v[76:77], v[84:85] op_sel_hi:[1,0]
    v_pk_mul_f32 v[78:79], v[78:79], v[84:85] op_sel_hi:[1,0]
    v_cvt_pk_bf16_f32 v72, v76, v77
    v_cvt_pk_bf16_f32 v73, v78, v79
    ds_write_b64 v122, v[72:73] offset:22016
    v_max_f32_dpp v86, v80, v84 quad_perm:[2,3,2,3] row_mask:0xf bank_mask:0xf
    v_mov_b32_dpp v60, v72 quad_perm:[0,1,0,1] row_mask:0xf bank_mask:0xf
    v_mov_b32_dpp v61, v73 quad_perm:[0,1,0,1] row_mask:0xf bank_mask:0xf
    v_cmp_lt_f32 vcc, s35, v86
    v_mov_b32_dpp v62, v72 quad_perm:[2,3,2,3] row_mask:0xf bank_mask:0xf
    v_mov_b32_dpp v63, v73 quad_perm:[2,3,2,3] row_mask:0xf bank_mask:0xf
    s_nop 1
    v_smfmac_f32_16x16x64_bf16 v[96:99], v[60:63], v[192:199], v116
    s_cbranch_vccnz L_smax_84
    v_smfmac_f32_16x16x64_bf16 v[100:103], v[60:63], v[224:231], v116
    s_waitcnt lgkmcnt(0)
    s_barrier
    ds_read_b128 v[92:95], v127 offset:21504
    ds_read_b128 v[80:83], v127 offset:20992
    ds_read_b128 v[84:87], v127 offset:20480
    v_smfmac_f32_16x16x64_bf16 v[104:107], v[60:63], v[0:7], v116
    ds_read_b128 v[40:43], v124 offset:34816
    v_smfmac_f32_16x16x64_bf16 v[108:111], v[60:63], v[8:15], v116
    ds_read_b128 v[56:59], v124 offset:36864
    s_waitcnt lgkmcnt(4)
    v_smfmac_f32_16x16x64_bf16 v[96:99], v[92:95], v[200:207], v116
    s_waitcnt lgkmcnt(3)
    v_smfmac_f32_16x16x64_bf16 v[96:99], v[80:83], v[208:215], v116
    ds_read_b128 v[44:47], v124 offset:35840
    s_waitcnt lgkmcnt(3)
    v_smfmac_f32_16x16x64_bf16 v[96:99], v[84:87], v[216:223], v116
    ds_read_b128 v[68:71], v124 offset:39936
    v_smfmac_f32_16x16x64_bf16 v[100:103], v[92:95], v[232:239], v116
    ds_read_b128 v[64:67], v124 offset:38912
    v_smfmac_f32_16x16x64_bf16 v[100:103], v[80:83], v[240:247], v116
    ds_read_b128 v[60:63], v124 offset:37888
    v_cvt_pk_bf16_f32 v72, v96, v98
    v_smfmac_f32_16x16x64_bf16 v[100:103], v[84:87], v[248:255], v116
    v_and_or_b32 v72, v72, -2, s33
    v_smfmac_f32_16x16x64_bf16 v[104:107], v[92:95], v[16:23], v116
    v_cvt_pk_bf16_f32 v74, v97, v99
    v_smfmac_f32_16x16x64_bf16 v[104:107], v[80:83], v[24:31], v116
    v_cvt_pk_bf16_f32 v73, v100, v102
    v_cvt_pk_bf16_f32 v75, v101, v103
    v_smfmac_f32_16x16x64_bf16 v[104:107], v[84:87], v[32:39], v116
    buffer_store_dwordx4 v[72:75], v118, s[8:11], s25 offen sc1
    s_waitcnt lgkmcnt(3)
    v_smfmac_f32_16x16x64_bf16 v[108:111], v[92:95], v[40:47], v116
    s_waitcnt lgkmcnt(0)
    v_smfmac_f32_16x16x64_bf16 v[108:111], v[80:83], v[56:63], v116
    v_cvt_pk_bf16_f32 v76, v104, v106
    v_smfmac_f32_16x16x64_bf16 v[108:111], v[84:87], v[64:71], v116
    v_and_or_b32 v76, v76, -2, s33
    v_cvt_pk_bf16_f32 v78, v105, v107
    v_mov_b32 v122, v122
    v_mov_b32 v122, v122
    v_mov_b32 v122, v122
    v_mov_b32 v122, v122
    v_mov_b32 v122, v122
    v_mov_b32 v122, v122
    v_cvt_pk_bf16_f32 v77, v108, v110
    v_cvt_pk_bf16_f32 v79, v109, v111
    buffer_store_dwordx4 v[76:79], v118, s[8:11], s26 offen sc1
    ds_read_b128 v[80:83], v123
    ds_read_b128 v[84:87], v123 offset:1024
    ds_read_b128 v[56:59], v123 offset:2048
    ds_read_b128 v[60:63], v123 offset:3072
    ds_read_b128 v[64:67], v123 offset:32768
    ds_read_b128 v[68:71], v123 offset:33792
    ds_read_b128 v[72:75], v123 offset:34816
    ds_read_b128 v[76:79], v123 offset:35840
    ds_read_b128 v[88:91], v123 offset:4096
    ds_read_b128 v[92:95], v123 offset:5120
    ds_read_b128 v[96:99], v123 offset:6144
    ds_read_b128 v[100:103], v123 offset:7168
    ds_read_b128 v[104:107], v123 offset:36864
    ds_read_b128 v[108:111], v123 offset:37888
    ds_read_b128 v[24:27], v123 offset:38912
    ds_read_b128 v[28:31], v123 offset:39936
    s_add_u32 s30, s30, 0x40000
    s_add_u32 s31, s31, 0x40000
    s_add_u32 s32, s32, 0x20000
    s_add_u32 s23, s24, 3072
    s_add_u32 s48, s23, 4096
    s_xor_b32 s25, s25, 0x40000
    s_xor_b32 s26, s26, 0x40000
    s_mov_b32 s35, 0x49800000
    s_add_u32 s22, s22, 1
    v_cndmask_b32 v12, 0, v125, s[68:69]
    v_cndmask_b32 v13, 0, v125, s[70:71]
    v_cndmask_b32 v14, 0, v125, s[72:73]
    v_cndmask_b32 v15, 0, v125, s[74:75]
    v_mov_b32 v54, 0
    v_mov_b32 v55, 0
    v_mov_b32 v52, 0
    v_mov_b32 v52, 0
    v_mov_b32 v52, 0
    v_mov_b32 v52, 0
    v_mov_b32 v52, 0
    v_mov_b32 v52, 0
    v_mov_b32 v52, 0
    v_mov_b32 v52, 0
    v_mov_b32 v52, 0
    v_mov_b32 v52, 0
    v_mov_b32 v52, 0
    v_mov_b32 v52, 0
    v_mov_b32 v52, 0
    v_mov_b32 v52, 0
    v_mov_b32 v52, 0
    v_mov_b32 v52, 0
    v_mov_b32 v52, 0
    v_mov_b32 v52, 0
    v_mov_b32 v52, 0
    v_mov_b32 v52, 0
    v_mov_b32 v52, 0
    v_mov_b32 v52, 0
    v_mov_b32 v52, 0
    v_mov_b32 v52, 0
    v_mov_b32 v52, 0
    v_mov_b32 v52, 0
    v_mov_b32 v52, 0
    v_mov_b32 v52, 0
    v_mov_b32 v52, 0
    v_mov_b32 v52, 0
    v_mov_b32 v52, 0
    v_mov_b32 v52, 0
    v_mov_b32 v52, 0
    v_mov_b32 v52, 0
    v_mov_b32 v52, 0
    v_mov_b32 v52, 0
    v_mov_b32 v52, 0
    v_mov_b32 v52, 0
    v_mov_b32 v52, 0
    v_mov_b32 v52, 0
    v_mov_b32 v52, 0
    v_mov_b32 v52, 0
    v_mov_b32 v52, 0
    v_mov_b32 v52, 0
    v_mov_b32 v52, 0
    v_mov_b32 v52, 0
    v_mov_b32 v52, 0
    v_mov_b32 v52, 0
    v_mov_b32 v52, 0
    buffer_load_dwordx4 v[4:7], v117, s[8:11], s29 offen sc1
    buffer_load_dwordx4 v[8:11], v117, s[8:11], s53 offen sc1
    buffer_load_dwordx4 v[16:19], v117, s[8:11], s29 offen offset:2048 sc1
    buffer_load_dwordx4 v[20:23], v117, s[8:11], s53 offen offset:2048 sc1
    v_mov_b32 v52, 0
    v_mov_b32 v52, 0
    v_mov_b32 v52, 0
    v_mov_b32 v52, 0
    v_mov_b32 v52, 0
    v_mov_b32 v52, 0
    v_mov_b32 v52, 0
    v_mov_b32 v52, 0
    v_mov_b32 v52, 0
    v_mov_b32 v52, 0
    v_mov_b32 v52, 0
    v_mov_b32 v52, 0
    v_mov_b32 v52, 0
    v_mov_b32 v52, 0
    v_mov_b32 v52, 0
    v_mov_b32 v52, 0
    v_mov_b32 v52, 0
    v_mov_b32 v52, 0
    v_mov_b32 v52, 0
    v_mov_b32 v52, 0
    v_mov_b32 v52, 0
    v_mov_b32 v52, 0
    v_mov_b32 v52, 0
    v_mov_b32 v52, 0
    v_mov_b32 v52, 0
    v_mov_b32 v52, 0
    v_mov_b32 v52, 0
    v_mov_b32 v52, 0
    v_mov_b32 v52, 0
    v_mov_b32 v52, 0
    buffer_load_dwordx4 v[32:35], v117, s[8:11], s29 offen sc1
    buffer_load_dwordx4 v[36:39], v117, s[8:11], s53 offen sc1
    buffer_load_dwordx4 v[40:43], v117, s[8:11], s29 offen offset:2048 sc1
    buffer_load_dwordx4 v[44:47], v117, s[8:11], s53 offen offset:2048 sc1
    v_mov_b32 v52, 0
L_rl_85:
    s_waitcnt vmcnt(7)
    v_mfma_f32_16x16x32_bf16 v[48:51], v[4:7], v[12:15], 0
    v_xor_b32 v52, s33, v4
    s_waitcnt vmcnt(6)
    v_mfma_f32_16x16x32_bf16 v[48:51], v[8:11], v[12:15], v[48:51]
    v_xor_b32 v53, s33, v8
    v_or_b32 v52, v52, v53
    s_waitcnt vmcnt(5)
    v_mfma_f32_16x16x32_bf16 v[48:51], v[16:19], v[12:15], v[48:51]
    v_xor_b32 v53, s33, v16
    v_or_b32 v52, v52, v53
    s_waitcnt vmcnt(4)
    v_mfma_f32_16x16x32_bf16 v[48:51], v[20:23], v[12:15], v[48:51]
    v_xor_b32 v53, s33, v20
    v_or_b32 v52, v52, v53
    v_and_b32 v52, 1, v52
    v_cmp_ne_u32 vcc, 0, v52
    s_cbranch_vccnz L_rslow_86
L_rgo_87:
    s_nop 2
    v_permlane32_swap_b32 v48, v50
    v_permlane32_swap_b32 v49, v51
    v_pk_add_f32 v[48:49], v[48:49], v[50:51]
    s_mov_b64 exec, s[38:39]
    v_cvt_pk_bf16_f32 v12, v48, v49
    v_min_u32 v12, 0xfffffffe, v12
    buffer_store_dword v12, v119, s[8:11], s24 offen sc1
    s_mov_b64 exec, -1
    s_add_u32 s24, s24, 8192
    s_bitset0_b32 s24, 15
    s_xor_b32 s55, s24, 16384
    s_xor_b32 s29, s29, 0x40000
    s_xor_b32 s53, s29, 1024
    s_bfe_u32 s33, s22, 0x10001
    s_waitcnt lgkmcnt(0)
    s_branch L_chain_top3_s
L_chain_last_s:
    s_nop 1
    v_smfmac_f32_16x16x64_bf16 v[48:51], v[16:19], v[128:135], v116
    v_smfmac_f32_16x16x64_bf16 v[48:51], v[20:23], v[160:167], v116
    v_smfmac_f32_16x16x64_bf16 v[48:51], v[24:27], v[144:151], v116
    v_smfmac_f32_16x16x64_bf16 v[48:51], v[28:31], v[176:183], v116
    v_smfmac_f32_16x16x64_bf16 v[52:55], v[16:19], v[136:143], v116
    v_smfmac_f32_16x16x64_bf16 v[52:55], v[20:23], v[168:175], v116
    v_smfmac_f32_16x16x64_bf16 v[52:55], v[24:27], v[152:159], v116
    v_smfmac_f32_16x16x64_bf16 v[52:55], v[28:31], v[184:191], v116
    v_add_f32 v48, v48, v50
    v_add_f32 v49, v49, v51
    v_cvt_pk_bf16_f32 v112, v48, v49
    s_nop 4
    v_add_f32 v52, v52, v54
    v_add_f32 v53, v53, v55
    v_cvt_pk_bf16_f32 v114, v52, v53
    s_add_u32 s32, s32, 0x20000
    buffer_store_dwordx4 v[112:115], v117, s[8:11], s32 offen sc1
    v_mov_b32 v94, 64
    s_waitcnt vmcnt(0) lgkmcnt(0)
    s_barrier
    s_mov_b64 exec, 1
    buffer_store_dword v94, off, s[8:11], s44 sc1
    s_mov_b64 exec, -1
    s_endpgm
L_mret_59:
    s_mov_b32 s43, m0
    s_mov_b32 m0, 4096
    buffer_load_dwordx4 v[4:7], v117, s[8:11], s48 offen sc1
    buffer_load_dwordx4 v117, s[8:11], s48 offen sc1 lds
    s_mov_b32 m0, 8192
    s_mov_b32 m0, s43
    s_waitcnt vmcnt(0)
    v_max3_u32 v15, v4, v5, v6
    v_max_u32 v15, v15, v7
    v_cmp_lt_u32 vcc, s56, v15
    s_add_u32 s47, s47, 1
    s_add_u32 s49, s49, 1
    s_cmp_ge_u32 s49, 0x10000
    s_cbranch_scc1 L_mgo_60
    s_cbranch_vccnz L_mret_59
    s_branch L_mgo_60
L_smax_62:
    s_add_u32 s47, s47, 1
    s_mov_b32 s35, 0x7f800000
    s_waitcnt lgkmcnt(0)
    s_sub_u32 s43, s30, 0x40000
    s_add_u32 s40, s43, 4096
    s_nop 7
    buffer_load_dwordx4 v[56:59], v117, s[8:11], s43 offen
    buffer_load_dwordx4 v[60:63], v117, s[8:11], s43 offen offset:1024
    buffer_load_dwordx4 v[64:67], v117, s[8:11], s43 offen offset:2048
    buffer_load_dwordx4 v[68:71], v117, s[8:11], s43 offen offset:3072
    buffer_load_dwordx4 v[72:75], v117, s[8:11], s40 offen
    buffer_load_dwordx4 v[76:79], v117, s[8:11], s40 offen offset:1024
    buffer_load_dwordx4 v[80:83], v117, s[8:11], s40 offen offset:2048
    buffer_load_dwordx4 v[84:87], v117, s[8:11], s40 offen offset:3072
    ds_read_b128 v[32:35], v121 offset:16384
    ds_read_b128 v[36:39], v121 offset:17408
    ds_read_b128 v[40:43], v121 offset:18432
    ds_read_b128 v[44:47], v121 offset:19456
    v_mov_b32 v96, 0
    v_mov_b32 v97, 0
    v_mov_b32 v98, 0
    v_mov_b32 v99, 0
    v_mov_b32 v100, 0
    v_mov_b32 v101, 0
    v_mov_b32 v102, 0
    v_mov_b32 v103, 0
    v_mov_b32 v104, 0
    v_mov_b32 v105, 0
    v_mov_b32 v106, 0
    v_mov_b32 v107, 0
    v_mov_b32 v108, 0
    v_mov_b32 v109, 0
    v_mov_b32 v110, 0
    v_mov_b32 v111, 0
    s_waitcnt vmcnt(0) lgkmcnt(0)
    v_mfma_f32_16x16x32_bf16 v[56:59], v[56:59], v[32:35], 0
    v_mfma_f32_16x16x32_bf16 v[56:59], v[60:63], v[36:39], v[56:59]
    v_mfma_f32_16x16x32_bf16 v[56:59], v[64:67], v[40:43], v[56:59]
    v_mfma_f32_16x16x32_bf16 v[56:59], v[68:71], v[44:47], v[56:59]
    v_mfma_f32_16x16x32_bf16 v[60:63], v[72:75], v[32:35], 0
    v_mfma_f32_16x16x32_bf16 v[60:63], v[76:79], v[36:39], v[60:63]
    v_mfma_f32_16x16x32_bf16 v[60:63], v[80:83], v[40:43], v[60:63]
    v_mfma_f32_16x16x32_bf16 v[60:63], v[84:87], v[44:47], v[60:63]
    v_mfma_f32_16x16x32_bf16 v[64:67], v[32:35], v[32:35], 0
    v_mfma_f32_16x16x32_bf16 v[64:67], v[36:39], v[36:39], v[64:67]
    v_mfma_f32_16x16x32_bf16 v[64:67], v[40:43], v[40:43], v[64:67]
    v_mfma_f32_16x16x32_bf16 v[64:67], v[44:47], v[44:47], v[64:67]
    v_max3_f32 v84, v56, v57, v58
    v_max3_f32 v84, v84, v59, v60
    v_max3_f32 v84, v84, v61, v62
    s_nop 4
    v_max3_f32 v84, v84, v63, v64
    v_max_f32 v84, v84, v65
    v_mov_b32 v85, v84
    s_nop 1
    v_permlane32_swap_b32 v85, v84
    v_max_f32 v84, v85, v84
    v_mov_b32 v85, v84
    s_nop 1
    v_permlane16_swap_b32 v85, v84
    v_max_f32 v84, v85, v84
    v_sub_f32 v56, v56, v84
    v_sub_f32 v57, v57, v84
    v_sub_f32 v58, v58, v84
    v_sub_f32 v59, v59, v84
    v_sub_f32 v60, v60, v84
    v_sub_f32 v61, v61, v84
    v_sub_f32 v62, v62, v84
    v_sub_f32 v63, v63, v84
    v_sub_f32 v64, v64, v84
    v_sub_f32 v65, v65, v84
    v_exp_f32 v56, v56
    v_exp_f32 v57, v57
    v_exp_f32 v58, v58
    v_exp_f32 v59, v59
    v_exp_f32 v60, v60
    v_exp_f32 v61, v61
    v_exp_f32 v62, v62
    v_exp_f32 v63, v63
    v_exp_f32 v64, v64
    v_exp_f32 v65, v65
    v_cvt_pk_bf16_f32 v68, v56, v57
    v_cvt_pk_bf16_f32 v69, v58, v59
    v_cvt_pk_bf16_f32 v70, v60, v61
    v_cvt_pk_bf16_f32 v71, v62, v63
    v_cvt_pk_bf16_f32 v52, v64, v65
    s_nop 0
    v_mfma_f32_16x16x32_bf16 v[72:75], v[88:91], v[68:71], 0
    v_mfma_f32_16x16x32_bf16 v[76:79], v[92:95], v[68:71], 0
    v_mfma_f32_16x16x32_bf16 v[80:83], v[48:51], v[68:71], 0
    v_mfma_f32_16x16x16_bf16 v[72:75], v[112:113], v[52:53], v[72:75]
    v_mfma_f32_16x16x16_bf16 v[76:79], v[114:115], v[52:53], v[76:79]
    v_mfma_f32_16x16x16_bf16 v[80:83], v[48:49], v[52:53], v[80:83]
    ds_read_b128 v[32:35], v124 offset:6144
    ds_read_b128 v[36:39], v124 offset:7168
    ds_read_b128 v[40:43], v124 offset:34816
    ds_read_b128 v[44:47], v124 offset:35840
    ds_read_b128 v[56:59], v124 offset:36864
    ds_read_b128 v[64:67], v124 offset:38912
    ds_read_b128 v[68:71], v124 offset:39936
    s_waitcnt lgkmcnt(0)
    s_branch L_norm_61
L_kvw_63:
    s_add_u32 s47, s47, 1
    s_add_u32 s49, s49, 1
    s_cmp_ge_u32 s49, 0x10000
    s_cbranch_scc1 L_kvb_64
    s_sleep 4
    buffer_load_dword v125, v119, s[8:11], s28 offen sc1
    s_waitcnt vmcnt(0)
    v_cmp_eq_u32 vcc, 0, v125
    s_nop 0
    s_and_b64 vcc, vcc, s[58:59]
    s_cbranch_scc1 L_kvw_63
    s_branch L_kvb_64
L_mret_66:
    s_mov_b32 s43, m0
    s_mov_b32 m0, 5120
    buffer_load_dwordx4 v[4:7], v117, s[8:11], s48 offen sc1
    buffer_load_dwordx4 v117, s[8:11], s48 offen sc1 lds
    s_mov_b32 m0, 10240
    s_mov_b32 m0, s43
    s_waitcnt vmcnt(0)
    v_max3_u32 v15, v4, v5, v6
    v_max_u32 v15, v15, v7
    v_cmp_lt_u32 vcc, s56, v15
    s_add_u32 s47, s47, 1
    s_add_u32 s49, s49, 1
    s_cmp_ge_u32 s49, 0x10000
    s_cbranch_scc1 L_mgo_67
    s_cbranch_vccnz L_mret_66
    s_branch L_mgo_67
L_smax_69:
    s_add_u32 s47, s47, 1
    s_mov_b32 s35, 0x7f800000
    s_waitcnt lgkmcnt(0)
    s_sub_u32 s43, s30, 0x40800
    s_add_u32 s40, s43, 4096
    s_nop 7
    buffer_load_dwordx4 v[56:59], v117, s[8:11], s43 offen
    buffer_load_dwordx4 v[60:63], v117, s[8:11], s43 offen offset:1024
    buffer_load_dwordx4 v[64:67], v117, s[8:11], s43 offen offset:2048
    buffer_load_dwordx4 v[68:71], v117, s[8:11], s43 offen offset:3072
    buffer_load_dwordx4 v[72:75], v117, s[8:11], s40 offen
    buffer_load_dwordx4 v[76:79], v117, s[8:11], s40 offen offset:1024
    buffer_load_dwordx4 v[80:83], v117, s[8:11], s40 offen offset:2048
    buffer_load_dwordx4 v[84:87], v117, s[8:11], s40 offen offset:3072
    ds_read_b128 v[32:35], v121 offset:16384
    ds_read_b128 v[36:39], v121 offset:17408
    ds_read_b128 v[40:43], v121 offset:18432
    ds_read_b128 v[44:47], v121 offset:19456
    v_mov_b32 v96, 0
    v_mov_b32 v97, 0
    v_mov_b32 v98, 0
    v_mov_b32 v99, 0
    v_mov_b32 v100, 0
    v_mov_b32 v101, 0
    v_mov_b32 v102, 0
    v_mov_b32 v103, 0
    v_mov_b32 v104, 0
    v_mov_b32 v105, 0
    v_mov_b32 v106, 0
    v_mov_b32 v107, 0
    v_mov_b32 v108, 0
    v_mov_b32 v109, 0
    v_mov_b32 v110, 0
    v_mov_b32 v111, 0
    s_waitcnt vmcnt(0) lgkmcnt(0)
    v_mfma_f32_16x16x32_bf16 v[56:59], v[56:59], v[32:35], 0
    v_mfma_f32_16x16x32_bf16 v[56:59], v[60:63], v[36:39], v[56:59]
    v_mfma_f32_16x16x32_bf16 v[56:59], v[64:67], v[40:43], v[56:59]
    v_mfma_f32_16x16x32_bf16 v[56:59], v[68:71], v[44:47], v[56:59]
    v_mfma_f32_16x16x32_bf16 v[60:63], v[72:75], v[32:35], 0
    v_mfma_f32_16x16x32_bf16 v[60:63], v[76:79], v[36:39], v[60:63]
    v_mfma_f32_16x16x32_bf16 v[60:63], v[80:83], v[40:43], v[60:63]
    v_mfma_f32_16x16x32_bf16 v[60:63], v[84:87], v[44:47], v[60:63]
    v_mfma_f32_16x16x32_bf16 v[64:67], v[32:35], v[32:35], 0
    v_mfma_f32_16x16x32_bf16 v[64:67], v[36:39], v[36:39], v[64:67]
    v_mfma_f32_16x16x32_bf16 v[64:67], v[40:43], v[40:43], v[64:67]
    v_mfma_f32_16x16x32_bf16 v[64:67], v[44:47], v[44:47], v[64:67]
    v_max3_f32 v84, v56, v57, v58
    v_max3_f32 v84, v84, v59, v60
    v_max3_f32 v84, v84, v61, v62
    s_nop 4
    v_max3_f32 v84, v84, v63, v64
    v_max_f32 v84, v84, v65
    v_mov_b32 v85, v84
    s_nop 1
    v_permlane32_swap_b32 v85, v84
    v_max_f32 v84, v85, v84
    v_mov_b32 v85, v84
    s_nop 1
    v_permlane16_swap_b32 v85, v84
    v_max_f32 v84, v85, v84
    v_sub_f32 v56, v56, v84
    v_sub_f32 v57, v57, v84
    v_sub_f32 v58, v58, v84
    v_sub_f32 v59, v59, v84
    v_sub_f32 v60, v60, v84
    v_sub_f32 v61, v61, v84
    v_sub_f32 v62, v62, v84
    v_sub_f32 v63, v63, v84
    v_sub_f32 v64, v64, v84
    v_sub_f32 v65, v65, v84
    v_exp_f32 v56, v56
    v_exp_f32 v57, v57
    v_exp_f32 v58, v58
    v_exp_f32 v59, v59
    v_exp_f32 v60, v60
    v_exp_f32 v61, v61
    v_exp_f32 v62, v62
    v_exp_f32 v63, v63
    v_exp_f32 v64, v64
    v_exp_f32 v65, v65
    v_cvt_pk_bf16_f32 v68, v56, v57
    v_cvt_pk_bf16_f32 v69, v58, v59
    v_cvt_pk_bf16_f32 v70, v60, v61
    v_cvt_pk_bf16_f32 v71, v62, v63
    v_cvt_pk_bf16_f32 v52, v64, v65
    s_nop 0
    v_mfma_f32_16x16x32_bf16 v[72:75], v[88:91], v[68:71], 0
    v_mfma_f32_16x16x32_bf16 v[76:79], v[92:95], v[68:71], 0
    v_mfma_f32_16x16x32_bf16 v[80:83], v[48:51], v[68:71], 0
    v_mfma_f32_16x16x16_bf16 v[72:75], v[112:113], v[52:53], v[72:75]
    v_mfma_f32_16x16x16_bf16 v[76:79], v[114:115], v[52:53], v[76:79]
    v_mfma_f32_16x16x16_bf16 v[80:83], v[48:49], v[52:53], v[80:83]
    ds_read_b128 v[32:35], v124 offset:6144
    ds_read_b128 v[36:39], v124 offset:7168
    ds_read_b128 v[40:43], v124 offset:34816
    ds_read_b128 v[44:47], v124 offset:35840
    ds_read_b128 v[56:59], v124 offset:36864
    ds_read_b128 v[64:67], v124 offset:38912
    ds_read_b128 v[68:71], v124 offset:39936
    s_waitcnt lgkmcnt(0)
    s_branch L_norm_68
L_kvw_70:
    s_add_u32 s47, s47, 1
    s_add_u32 s49, s49, 1
    s_cmp_ge_u32 s49, 0x10000
    s_cbranch_scc1 L_kvb_71
    s_sleep 4
    buffer_load_dword v125, v119, s[8:11], s28 offen sc1
    s_waitcnt vmcnt(0)
    v_cmp_eq_u32 vcc, 0, v125
    s_nop 0
    s_and_b64 vcc, vcc, s[58:59]
    s_cbranch_scc1 L_kvw_70
    s_branch L_kvb_71
L_mret_73:
    s_mov_b32 s43, m0
    s_mov_b32 m0, 6144
    buffer_load_dwordx4 v[4:7], v117, s[8:11], s48 offen sc1
    buffer_load_dwordx4 v117, s[8:11], s48 offen sc1 lds
    s_mov_b32 m0, 12288
    s_mov_b32 m0, s43
    s_waitcnt vmcnt(0)
    v_max3_u32 v15, v4, v5, v6
    v_max_u32 v15, v15, v7
    v_cmp_lt_u32 vcc, s56, v15
    s_add_u32 s47, s47, 1
    s_add_u32 s49, s49, 1
    s_cmp_ge_u32 s49, 0x10000
    s_cbranch_scc1 L_mgo_74
    s_cbranch_vccnz L_mret_73
    s_branch L_mgo_74
L_smax_76:
    s_add_u32 s47, s47, 1
    s_mov_b32 s35, 0x7f800000
    s_waitcnt lgkmcnt(0)
    s_sub_u32 s43, s30, 0x41000
    s_add_u32 s40, s43, 4096
    s_nop 7
    buffer_load_dwordx4 v[56:59], v117, s[8:11], s43 offen
    buffer_load_dwordx4 v[60:63], v117, s[8:11], s43 offen offset:1024
    buffer_load_dwordx4 v[64:67], v117, s[8:11], s43 offen offset:2048
    buffer_load_dwordx4 v[68:71], v117, s[8:11], s43 offen offset:3072
    buffer_load_dwordx4 v[72:75], v117, s[8:11], s40 offen
    buffer_load_dwordx4 v[76:79], v117, s[8:11], s40 offen offset:1024
    buffer_load_dwordx4 v[80:83], v117, s[8:11], s40 offen offset:2048
    buffer_load_dwordx4 v[84:87], v117, s[8:11], s40 offen offset:3072
    ds_read_b128 v[32:35], v121 offset:16384
    ds_read_b128 v[36:39], v121 offset:17408
    ds_read_b128 v[40:43], v121 offset:18432
    ds_read_b128 v[44:47], v121 offset:19456
    v_mov_b32 v96, 0
    v_mov_b32 v97, 0
    v_mov_b32 v98, 0
    v_mov_b32 v99, 0
    v_mov_b32 v100, 0
    v_mov_b32 v101, 0
    v_mov_b32 v102, 0
    v_mov_b32 v103, 0
    v_mov_b32 v104, 0
    v_mov_b32 v105, 0
    v_mov_b32 v106, 0
    v_mov_b32 v107, 0
    v_mov_b32 v108, 0
    v_mov_b32 v109, 0
    v_mov_b32 v110, 0
    v_mov_b32 v111, 0
    s_waitcnt vmcnt(0) lgkmcnt(0)
    v_mfma_f32_16x16x32_bf16 v[56:59], v[56:59], v[32:35], 0
    v_mfma_f32_16x16x32_bf16 v[56:59], v[60:63], v[36:39], v[56:59]
    v_mfma_f32_16x16x32_bf16 v[56:59], v[64:67], v[40:43], v[56:59]
    v_mfma_f32_16x16x32_bf16 v[56:59], v[68:71], v[44:47], v[56:59]
    v_mfma_f32_16x16x32_bf16 v[60:63], v[72:75], v[32:35], 0
    v_mfma_f32_16x16x32_bf16 v[60:63], v[76:79], v[36:39], v[60:63]
    v_mfma_f32_16x16x32_bf16 v[60:63], v[80:83], v[40:43], v[60:63]
    v_mfma_f32_16x16x32_bf16 v[60:63], v[84:87], v[44:47], v[60:63]
    v_mfma_f32_16x16x32_bf16 v[64:67], v[32:35], v[32:35], 0
    v_mfma_f32_16x16x32_bf16 v[64:67], v[36:39], v[36:39], v[64:67]
    v_mfma_f32_16x16x32_bf16 v[64:67], v[40:43], v[40:43], v[64:67]
    v_mfma_f32_16x16x32_bf16 v[64:67], v[44:47], v[44:47], v[64:67]
    v_max3_f32 v84, v56, v57, v58
    v_max3_f32 v84, v84, v59, v60
    v_max3_f32 v84, v84, v61, v62
    s_nop 4
    v_max3_f32 v84, v84, v63, v64
    v_max_f32 v84, v84, v65
    v_mov_b32 v85, v84
    s_nop 1
    v_permlane32_swap_b32 v85, v84
    v_max_f32 v84, v85, v84
    v_mov_b32 v85, v84
    s_nop 1
    v_permlane16_swap_b32 v85, v84
    v_max_f32 v84, v85, v84
    v_sub_f32 v56, v56, v84
    v_sub_f32 v57, v57, v84
    v_sub_f32 v58, v58, v84
    v_sub_f32 v59, v59, v84
    v_sub_f32 v60, v60, v84
    v_sub_f32 v61, v61, v84
    v_sub_f32 v62, v62, v84
    v_sub_f32 v63, v63, v84
    v_sub_f32 v64, v64, v84
    v_sub_f32 v65, v65, v84
    v_exp_f32 v56, v56
    v_exp_f32 v57, v57
    v_exp_f32 v58, v58
    v_exp_f32 v59, v59
    v_exp_f32 v60, v60
    v_exp_f32 v61, v61
    v_exp_f32 v62, v62
    v_exp_f32 v63, v63
    v_exp_f32 v64, v64
    v_exp_f32 v65, v65
    v_cvt_pk_bf16_f32 v68, v56, v57
    v_cvt_pk_bf16_f32 v69, v58, v59
    v_cvt_pk_bf16_f32 v70, v60, v61
    v_cvt_pk_bf16_f32 v71, v62, v63
    v_cvt_pk_bf16_f32 v52, v64, v65
    s_nop 0
    v_mfma_f32_16x16x32_bf16 v[72:75], v[88:91], v[68:71], 0
    v_mfma_f32_16x16x32_bf16 v[76:79], v[92:95], v[68:71], 0
    v_mfma_f32_16x16x32_bf16 v[80:83], v[48:51], v[68:71], 0
    v_mfma_f32_16x16x16_bf16 v[72:75], v[112:113], v[52:53], v[72:75]
    v_mfma_f32_16x16x16_bf16 v[76:79], v[114:115], v[52:53], v[76:79]
    v_mfma_f32_16x16x16_bf16 v[80:83], v[48:49], v[52:53], v[80:83]
    ds_read_b128 v[32:35], v124 offset:6144
    ds_read_b128 v[36:39], v124 offset:7168
    ds_read_b128 v[40:43], v124 offset:34816
    ds_read_b128 v[44:47], v124 offset:35840
    ds_read_b128 v[56:59], v124 offset:36864
    ds_read_b128 v[64:67], v124 offset:38912
    ds_read_b128 v[68:71], v124 offset:39936
    s_waitcnt lgkmcnt(0)
    s_branch L_norm_75
L_rslow_78:
    buffer_load_dwordx4 v[4:7], v117, s[8:11], s29 offen sc1
    buffer_load_dwordx4 v[8:11], v117, s[8:11], s53 offen sc1
    buffer_load_dwordx4 v[16:19], v117, s[8:11], s29 offen offset:2048 sc1
    buffer_load_dwordx4 v[20:23], v117, s[8:11], s53 offen offset:2048 sc1
    s_add_u32 s46, s46, 1
    s_add_u32 s49, s49, 1
    s_cmp_ge_u32 s49, 0x10000
    s_cbranch_scc1 L_rgo_79
    s_waitcnt vmcnt(7)
    v_mfma_f32_16x16x32_bf16 v[48:51], v[32:35], v[12:15], 0
    v_xor_b32 v52, s33, v32
    s_waitcnt vmcnt(6)
    v_mfma_f32_16x16x32_bf16 v[48:51], v[36:39], v[12:15], v[48:51]
    v_xor_b32 v53, s33, v36
    v_or_b32 v52, v52, v53
    s_waitcnt vmcnt(5)
    v_mfma_f32_16x16x32_bf16 v[48:51], v[40:43], v[12:15], v[48:51]
    v_xor_b32 v53, s33, v40
    v_or_b32 v52, v52, v53
    s_waitcnt vmcnt(4)
    v_mfma_f32_16x16x32_bf16 v[48:51], v[44:47], v[12:15], v[48:51]
    v_xor_b32 v53, s33, v44
    v_or_b32 v52, v52, v53
    v_and_b32 v52, 1, v52
    v_cmp_ne_u32 vcc, 0, v52
    s_cbranch_vccz L_rgo_79
    buffer_load_dwordx4 v[32:35], v117, s[8:11], s29 offen sc1
    buffer_load_dwordx4 v[36:39], v117, s[8:11], s53 offen sc1
    buffer_load_dwordx4 v[40:43], v117, s[8:11], s29 offen offset:2048 sc1
    buffer_load_dwordx4 v[44:47], v117, s[8:11], s53 offen offset:2048 sc1
    s_add_u32 s46, s46, 1
    s_branch L_rl_77
L_mret_81:
    s_mov_b32 s43, m0
    s_mov_b32 m0, 7168
    buffer_load_dwordx4 v[4:7], v117, s[8:11], s48 offen sc1
    buffer_load_dwordx4 v117, s[8:11], s48 offen sc1 lds
    s_mov_b32 m0, 14336
    s_mov_b32 m0, s43
    s_waitcnt vmcnt(0)
    v_max3_u32 v15, v4, v5, v6
    v_max_u32 v15, v15, v7
    v_cmp_lt_u32 vcc, s56, v15
    s_add_u32 s47, s47, 1
    s_add_u32 s49, s49, 1
    s_cmp_ge_u32 s49, 0x10000
    s_cbranch_scc1 L_mgo_82
    s_cbranch_vccnz L_mret_81
    s_branch L_mgo_82
L_smax_84:
    s_add_u32 s47, s47, 1
    s_mov_b32 s35, 0x7f800000
    s_waitcnt lgkmcnt(0)
    s_sub_u32 s43, s30, 0x41800
    s_add_u32 s40, s43, 4096
    s_nop 7
    buffer_load_dwordx4 v[56:59], v117, s[8:11], s43 offen
    buffer_load_dwordx4 v[60:63], v117, s[8:11], s43 offen offset:1024
    buffer_load_dwordx4 v[64:67], v117, s[8:11], s43 offen offset:2048
    buffer_load_dwordx4 v[68:71], v117, s[8:11], s43 offen offset:3072
    buffer_load_dwordx4 v[72:75], v117, s[8:11], s40 offen
    buffer_load_dwordx4 v[76:79], v117, s[8:11], s40 offen offset:1024
    buffer_load_dwordx4 v[80:83], v117, s[8:11], s40 offen offset:2048
    buffer_load_dwordx4 v[84:87], v117, s[8:11], s40 offen offset:3072
    ds_read_b128 v[32:35], v121 offset:16384
    ds_read_b128 v[36:39], v121 offset:17408
    ds_read_b128 v[40:43], v121 offset:18432
    ds_read_b128 v[44:47], v121 offset:19456
    v_mov_b32 v96, 0
    v_mov_b32 v97, 0
    v_mov_b32 v98, 0
    v_mov_b32 v99, 0
    v_mov_b32 v100, 0
    v_mov_b32 v101, 0
    v_mov_b32 v102, 0
    v_mov_b32 v103, 0
    v_mov_b32 v104, 0
    v_mov_b32 v105, 0
    v_mov_b32 v106, 0
    v_mov_b32 v107, 0
    v_mov_b32 v108, 0
    v_mov_b32 v109, 0
    v_mov_b32 v110, 0
    v_mov_b32 v111, 0
    s_waitcnt vmcnt(0) lgkmcnt(0)
    v_mfma_f32_16x16x32_bf16 v[56:59], v[56:59], v[32:35], 0
    v_mfma_f32_16x16x32_bf16 v[56:59], v[60:63], v[36:39], v[56:59]
    v_mfma_f32_16x16x32_bf16 v[56:59], v[64:67], v[40:43], v[56:59]
    v_mfma_f32_16x16x32_bf16 v[56:59], v[68:71], v[44:47], v[56:59]
    v_mfma_f32_16x16x32_bf16 v[60:63], v[72:75], v[32:35], 0
    v_mfma_f32_16x16x32_bf16 v[60:63], v[76:79], v[36:39], v[60:63]
    v_mfma_f32_16x16x32_bf16 v[60:63], v[80:83], v[40:43], v[60:63]
    v_mfma_f32_16x16x32_bf16 v[60:63], v[84:87], v[44:47], v[60:63]
    v_mfma_f32_16x16x32_bf16 v[64:67], v[32:35], v[32:35], 0
    v_mfma_f32_16x16x32_bf16 v[64:67], v[36:39], v[36:39], v[64:67]
    v_mfma_f32_16x16x32_bf16 v[64:67], v[40:43], v[40:43], v[64:67]
    v_mfma_f32_16x16x32_bf16 v[64:67], v[44:47], v[44:47], v[64:67]
    v_max3_f32 v84, v56, v57, v58
    v_max3_f32 v84, v84, v59, v60
    v_max3_f32 v84, v84, v61, v62
    s_nop 4
    v_max3_f32 v84, v84, v63, v64
    v_max_f32 v84, v84, v65
    v_mov_b32 v85, v84
    s_nop 1
    v_permlane32_swap_b32 v85, v84
    v_max_f32 v84, v85, v84
    v_mov_b32 v85, v84
    s_nop 1
    v_permlane16_swap_b32 v85, v84
    v_max_f32 v84, v85, v84
    v_sub_f32 v56, v56, v84
    v_sub_f32 v57, v57, v84
    v_sub_f32 v58, v58, v84
    v_sub_f32 v59, v59, v84
    v_sub_f32 v60, v60, v84
    v_sub_f32 v61, v61, v84
    v_sub_f32 v62, v62, v84
    v_sub_f32 v63, v63, v84
    v_sub_f32 v64, v64, v84
    v_sub_f32 v65, v65, v84
    v_exp_f32 v56, v56
    v_exp_f32 v57, v57
    v_exp_f32 v58, v58
    v_exp_f32 v59, v59
    v_exp_f32 v60, v60
    v_exp_f32 v61, v61
    v_exp_f32 v62, v62
    v_exp_f32 v63, v63
    v_exp_f32 v64, v64
    v_exp_f32 v65, v65
    v_cvt_pk_bf16_f32 v68, v56, v57
    v_cvt_pk_bf16_f32 v69, v58, v59
    v_cvt_pk_bf16_f32 v70, v60, v61
    v_cvt_pk_bf16_f32 v71, v62, v63
    v_cvt_pk_bf16_f32 v52, v64, v65
    s_nop 0
    v_mfma_f32_16x16x32_bf16 v[72:75], v[88:91], v[68:71], 0
    v_mfma_f32_16x16x32_bf16 v[76:79], v[92:95], v[68:71], 0
    v_mfma_f32_16x16x32_bf16 v[80:83], v[48:51], v[68:71], 0
    v_mfma_f32_16x16x16_bf16 v[72:75], v[112:113], v[52:53], v[72:75]
    v_mfma_f32_16x16x16_bf16 v[76:79], v[114:115], v[52:53], v[76:79]
    v_mfma_f32_16x16x16_bf16 v[80:83], v[48:49], v[52:53], v[80:83]
    ds_read_b128 v[32:35], v124 offset:6144
    ds_read_b128 v[36:39], v124 offset:7168
    ds_read_b128 v[40:43], v124 offset:34816
    ds_read_b128 v[44:47], v124 offset:35840
    ds_read_b128 v[56:59], v124 offset:36864
    ds_read_b128 v[64:67], v124 offset:38912
    ds_read_b128 v[68:71], v124 offset:39936
    s_waitcnt lgkmcnt(0)
    s_branch L_norm_83
L_rslow_86:
    buffer_load_dwordx4 v[4:7], v117, s[8:11], s29 offen sc1
    buffer_load_dwordx4 v[8:11], v117, s[8:11], s53 offen sc1
    buffer_load_dwordx4 v[16:19], v117, s[8:11], s29 offen offset:2048 sc1
    buffer_load_dwordx4 v[20:23], v117, s[8:11], s53 offen offset:2048 sc1
    s_add_u32 s46, s46, 1
    s_add_u32 s49, s49, 1
    s_cmp_ge_u32 s49, 0x10000
    s_cbranch_scc1 L_rgo_87
    s_waitcnt vmcnt(7)
    v_mfma_f32_16x16x32_bf16 v[48:51], v[32:35], v[12:15], 0
    v_xor_b32 v52, s33, v32
    s_waitcnt vmcnt(6)
    v_mfma_f32_16x16x32_bf16 v[48:51], v[36:39], v[12:15], v[48:51]
    v_xor_b32 v53, s33, v36
    v_or_b32 v52, v52, v53
    s_waitcnt vmcnt(5)
    v_mfma_f32_16x16x32_bf16 v[48:51], v[40:43], v[12:15], v[48:51]
    v_xor_b32 v53, s33, v40
    v_or_b32 v52, v52, v53
    s_waitcnt vmcnt(4)
    v_mfma_f32_16x16x32_bf16 v[48:51], v[44:47], v[12:15], v[48:51]
    v_xor_b32 v53, s33, v44
    v_or_b32 v52, v52, v53
    v_and_b32 v52, 1, v52
    v_cmp_ne_u32 vcc, 0, v52
    s_cbranch_vccz L_rgo_87
    buffer_load_dwordx4 v[32:35], v117, s[8:11], s29 offen sc1
    buffer_load_dwordx4 v[36:39], v117, s[8:11], s53 offen sc1
    buffer_load_dwordx4 v[40:43], v117, s[8:11], s29 offen offset:2048 sc1
    buffer_load_dwordx4 v[44:47], v117, s[8:11], s53 offen offset:2048 sc1
    s_add_u32 s46, s46, 1
    s_branch L_rl_85
L_bulk:
    s_load_dwordx8 s[60:67], s[0:1], 16
    s_load_dwordx2 s[12:13], s[0:1], 0
    s_waitcnt lgkmcnt(0)
    s_branch L_bulk2
.p2align 7
L_other:
    s_sub_u32 s101, s84, 1
    s_lshl_b32 s101, s101, 5
    s_add_u32 s101, s101, s85
    s_cmp_ge_u32 s85, 2
    s_cbranch_scc1 L_nobc
    v_lshlrev_b32 v1, 6, v0
    s_lshl_b32 s96, s85, 14
    s_getpc_b64 s[4:5]
L_pc_88:
    s_add_u32 s4, s4, L_bulk2-L_pc_88
    s_addc_u32 s5, s5, 0
    v_add_u32 v1, s96, v1
    v_min_u32 v1, L_code_end-L_bulk2-4, v1
    global_load_dword v255, v1, s[4:5]
L_nobc:
    s_waitcnt lgkmcnt(0)
    s_and_b32 s9, s9, 0xffff
    s_mov_b32 s10, 0x10000000
    s_mov_b32 s11, 0x20000
    s_and_b32 s93, s93, 0xffff
    s_mov_b32 s94, 0x100
    s_mov_b32 s95, 0x20000
    s_mov_b32 s87, 0
    s_cmp_lg_u32 s86, 0
    s_cbranch_scc1 L_reg_89
    s_lshl_b32 s97, s84, 4
    s_lshl_b32 s96, 1, s85
    v_mov_b32 v250, s96
    v_mov_b32 v251, 256
    s_mov_b64 exec, 1
    buffer_atomic_add_x2 v[250:251], off, s[92:95], s97 offset:64
    s_mov_b64 exec, -1
    s_mov_b32 s86, 1
L_reg_89:
L_bulk2:
    s_add_u32 s88, s101, 32
    s_mov_b32 s41, 0
    s_lshr_b32 s20, s101, 6
    s_and_b32 s22, s101, 63
    s_cmp_ge_u32 s101, 192
    s_cselect_b32 s37, 32, 1000
L_p1go:
    s_mov_b32 s40, 0
    s_mov_b32 s80, 0
    s_mov_b32 s23, 0
L_p1_pass:
    v_mbcnt_lo_u32_b32 v0, -1, 0
    v_mbcnt_hi_u32_b32 v0, -1, v0
    s_lshl_b32 s96, s100, 6
    v_add_u32 v0, s96, v0
    s_and_b32 s13, s13, 0xffff
    s_mov_b32 s14, 0x200000
    s_mov_b32 s15, 0x20000
    v_lshrrev_b32 v147, 6, v0
    s_nop 0
    v_readfirstlane_b32 s21, v147
    v_and_b32 v144, 63, v0
    v_lshrrev_b32 v145, 4, v144
    v_and_b32 v146, 15, v144
    v_lshrrev_b32 v149, 2, v146
    v_lshlrev_b32 v137, 4, v144
    s_lshl_b32 s29, s21, 10
    s_lshl_b32 s26, s20, 7
    s_lshl_b32 s27, s21, 5
    s_add_u32 s26, s26, s27
    v_add_u32 v147, s26, v146
    v_lshlrev_b32 v147, 10, v147
    v_lshl_add_u32 v139, v145, 4, v147
    s_mov_b32 s26, 0x0
    buffer_load_dwordx4 v[0:3], v139, s[12:15], s26 offen
    buffer_load_dwordx4 v[4:7], v139, s[12:15], s26 offen offset:64
    buffer_load_dwordx4 v[8:11], v139, s[12:15], s26 offen offset:128
    buffer_load_dwordx4 v[12:15], v139, s[12:15], s26 offen offset:192
    buffer_load_dwordx4 v[16:19], v139, s[12:15], s26 offen offset:256
    buffer_load_dwordx4 v[20:23], v139, s[12:15], s26 offen offset:320
    buffer_load_dwordx4 v[24:27], v139, s[12:15], s26 offen offset:384
    buffer_load_dwordx4 v[28:31], v139, s[12:15], s26 offen offset:448
    buffer_load_dwordx4 v[32:35], v139, s[12:15], s26 offen offset:512
    buffer_load_dwordx4 v[36:39], v139, s[12:15], s26 offen offset:576
    buffer_load_dwordx4 v[40:43], v139, s[12:15], s26 offen offset:640
    buffer_load_dwordx4 v[44:47], v139, s[12:15], s26 offen offset:704
    buffer_load_dwordx4 v[48:51], v139, s[12:15], s26 offen offset:768
    buffer_load_dwordx4 v[52:55], v139, s[12:15], s26 offen offset:832
    buffer_load_dwordx4 v[56:59], v139, s[12:15], s26 offen offset:896
    buffer_load_dwordx4 v[60:63], v139, s[12:15], s26 offen offset:960
    s_mov_b32 s26, 0x4000
    buffer_load_dwordx4 v[64:67], v139, s[12:15], s26 offen
    buffer_load_dwordx4 v[68:71], v139, s[12:15], s26 offen offset:64
    buffer_load_dwordx4 v[72:75], v139, s[12:15], s26 offen offset:128
    buffer_load_dwordx4 v[76:79], v139, s[12:15], s26 offen offset:192
    buffer_load_dwordx4 v[80:83], v139, s[12:15], s26 offen offset:256
    buffer_load_dwordx4 v[84:87], v139, s[12:15], s26 offen offset:320
    buffer_load_dwordx4 v[88:91], v139, s[12:15], s26 offen offset:384
    buffer_load_dwordx4 v[92:95], v139, s[12:15], s26 offen offset:448
    buffer_load_dwordx4 v[96:99], v139, s[12:15], s26 offen offset:512
    buffer_load_dwordx4 v[100:103], v139, s[12:15], s26 offen offset:576
    buffer_load_dwordx4 v[104:107], v139, s[12:15], s26 offen offset:640
    buffer_load_dwordx4 v[108:111], v139, s[12:15], s26 offen offset:704
    buffer_load_dwordx4 v[112:115], v139, s[12:15], s26 offen offset:768
    buffer_load_dwordx4 v[116:119], v139, s[12:15], s26 offen offset:832
    buffer_load_dwordx4 v[120:123], v139, s[12:15], s26 offen offset:896
    buffer_load_dwordx4 v[124:127], v139, s[12:15], s26 offen offset:960
    s_lshr_b32 s26, s21, 1
    s_lshl_b32 s26, s26, 2
    v_or_b32 v148, s26, v145
    v_lshlrev_b32 v148, 1, v148
    v_xor_b32 v148, v148, v146
    v_lshlrev_b32 v148, 4, v148
    s_lshl_b32 s26, s21, 2
    v_add_u32 v147, s26, v145
    v_lshl_add_u32 v136, v147, 13, v148
    v_lshl_add_u32 v147, v145, 3, v149
    v_lshlrev_b32 v147, 8, v147
    v_and_b32 v148, 1, v145
    v_lshl_or_b32 v148, v148, 2, v149
    v_lshl_add_u32 v147, v148, 5, v147
    v_and_b32 v148, 3, v146
    v_lshl_add_u32 v128, v148, 3, v147
    v_xor_b32 v129, 32, v128
    v_xor_b32 v130, 64, v128
    v_xor_b32 v131, 96, v128
    v_xor_b32 v132, 128, v128
    v_xor_b32 v133, 160, v128
    v_xor_b32 v134, 192, v128
    v_xor_b32 v135, 224, v128
    s_mov_b32 s19, 0x20000
    s_mov_b32 s38, s22
    s_mov_b32 s39, s22
    v_mov_b32 v158, 0x3f803f80
    s_lshr_b32 s26, s39, 5
    s_cmp_eq_u32 s26, 0
    s_cselect_b64 s[16:17], s[62:63], s[60:61]
    s_cmp_eq_u32 s26, 1
    s_cselect_b64 s[16:17], s[64:65], s[16:17]
    s_and_b32 s17, s17, 0xffff
    s_cmp_lt_u32 s39, 96
    s_cselect_b32 s18, 0x400000, 0
    s_and_b32 s24, s39, 31
    s_lshl_b32 s24, s24, 8
    s_waitcnt vmcnt(16)
    v_pk_mov_b32 v[150:151], 0, 0
    v_pk_mov_b32 v[152:153], 0, 0
    v_dot2_f32_bf16 v150, v0, v158, v150
    v_dot2_f32_bf16 v152, v0, v0, v152
    v_dot2_f32_bf16 v151, v1, v158, v151
    v_dot2_f32_bf16 v153, v1, v1, v153
    v_dot2_f32_bf16 v150, v2, v158, v150
    v_dot2_f32_bf16 v152, v2, v2, v152
    v_dot2_f32_bf16 v151, v3, v158, v151
    v_dot2_f32_bf16 v153, v3, v3, v153
    v_dot2_f32_bf16 v150, v4, v158, v150
    v_dot2_f32_bf16 v152, v4, v4, v152
    v_dot2_f32_bf16 v151, v5, v158, v151
    v_dot2_f32_bf16 v153, v5, v5, v153
    v_dot2_f32_bf16 v150, v6, v158, v150
    v_dot2_f32_bf16 v152, v6, v6, v152
    v_dot2_f32_bf16 v151, v7, v158, v151
    v_dot2_f32_bf16 v153, v7, v7, v153
    v_dot2_f32_bf16 v150, v8, v158, v150
    v_dot2_f32_bf16 v152, v8, v8, v152
    v_dot2_f32_bf16 v151, v9, v158, v151
    v_dot2_f32_bf16 v153, v9, v9, v153
    v_dot2_f32_bf16 v150, v10, v158, v150
    v_dot2_f32_bf16 v152, v10, v10, v152
    v_dot2_f32_bf16 v151, v11, v158, v151
    v_dot2_f32_bf16 v153, v11, v11, v153
    v_dot2_f32_bf16 v150, v12, v158, v150
    v_dot2_f32_bf16 v152, v12, v12, v152
    v_dot2_f32_bf16 v151, v13, v158, v151
    v_dot2_f32_bf16 v153, v13, v13, v153
    v_dot2_f32_bf16 v150, v14, v158, v150
    v_dot2_f32_bf16 v152, v14, v14, v152
    v_dot2_f32_bf16 v151, v15, v158, v151
    v_dot2_f32_bf16 v153, v15, v15, v153
    v_dot2_f32_bf16 v150, v16, v158, v150
    v_dot2_f32_bf16 v152, v16, v16, v152
    v_dot2_f32_bf16 v151, v17, v158, v151
    v_dot2_f32_bf16 v153, v17, v17, v153
    v_dot2_f32_bf16 v150, v18, v158, v150
    v_dot2_f32_bf16 v152, v18, v18, v152
    v_dot2_f32_bf16 v151, v19, v158, v151
    v_dot2_f32_bf16 v153, v19, v19, v153
    v_dot2_f32_bf16 v150, v20, v158, v150
    v_dot2_f32_bf16 v152, v20, v20, v152
    v_dot2_f32_bf16 v151, v21, v158, v151
    v_dot2_f32_bf16 v153, v21, v21, v153
    v_dot2_f32_bf16 v150, v22, v158, v150
    v_dot2_f32_bf16 v152, v22, v22, v152
    v_dot2_f32_bf16 v151, v23, v158, v151
    v_dot2_f32_bf16 v153, v23, v23, v153
    v_dot2_f32_bf16 v150, v24, v158, v150
    v_dot2_f32_bf16 v152, v24, v24, v152
    v_dot2_f32_bf16 v151, v25, v158, v151
    v_dot2_f32_bf16 v153, v25, v25, v153
    v_dot2_f32_bf16 v150, v26, v158, v150
    v_dot2_f32_bf16 v152, v26, v26, v152
    v_dot2_f32_bf16 v151, v27, v158, v151
    v_dot2_f32_bf16 v153, v27, v27, v153
    v_dot2_f32_bf16 v150, v28, v158, v150
    v_dot2_f32_bf16 v152, v28, v28, v152
    v_dot2_f32_bf16 v151, v29, v158, v151
    v_dot2_f32_bf16 v153, v29, v29, v153
    v_dot2_f32_bf16 v150, v30, v158, v150
    v_dot2_f32_bf16 v152, v30, v30, v152
    v_dot2_f32_bf16 v151, v31, v158, v151
    v_dot2_f32_bf16 v153, v31, v31, v153
    v_dot2_f32_bf16 v150, v32, v158, v150
    v_dot2_f32_bf16 v152, v32, v32, v152
    v_dot2_f32_bf16 v151, v33, v158, v151
    v_dot2_f32_bf16 v153, v33, v33, v153
    v_dot2_f32_bf16 v150, v34, v158, v150
    v_dot2_f32_bf16 v152, v34, v34, v152
    v_dot2_f32_bf16 v151, v35, v158, v151
    v_dot2_f32_bf16 v153, v35, v35, v153
    v_dot2_f32_bf16 v150, v36, v158, v150
    v_dot2_f32_bf16 v152, v36, v36, v152
    v_dot2_f32_bf16 v151, v37, v158, v151
    v_dot2_f32_bf16 v153, v37, v37, v153
    v_dot2_f32_bf16 v150, v38, v158, v150
    v_dot2_f32_bf16 v152, v38, v38, v152
    v_dot2_f32_bf16 v151, v39, v158, v151
    v_dot2_f32_bf16 v153, v39, v39, v153
    v_dot2_f32_bf16 v150, v40, v158, v150
    v_dot2_f32_bf16 v152, v40, v40, v152
    v_dot2_f32_bf16 v151, v41, v158, v151
    v_dot2_f32_bf16 v153, v41, v41, v153
    v_dot2_f32_bf16 v150, v42, v158, v150
    v_dot2_f32_bf16 v152, v42, v42, v152
    v_dot2_f32_bf16 v151, v43, v158, v151
    v_dot2_f32_bf16 v153, v43, v43, v153
    v_dot2_f32_bf16 v150, v44, v158, v150
    v_dot2_f32_bf16 v152, v44, v44, v152
    v_dot2_f32_bf16 v151, v45, v158, v151
    v_dot2_f32_bf16 v153, v45, v45, v153
    v_dot2_f32_bf16 v150, v46, v158, v150
    v_dot2_f32_bf16 v152, v46, v46, v152
    v_dot2_f32_bf16 v151, v47, v158, v151
    v_dot2_f32_bf16 v153, v47, v47, v153
    v_dot2_f32_bf16 v150, v48, v158, v150
    v_dot2_f32_bf16 v152, v48, v48, v152
    v_dot2_f32_bf16 v151, v49, v158, v151
    v_dot2_f32_bf16 v153, v49, v49, v153
    s_add_u32 s26, s24, 0x0
    s_add_u32 m0, s29, 0x0
    s_nop 0
    buffer_load_dwordx4 v136, s[16:19], s26 offen lds
    v_dot2_f32_bf16 v150, v50, v158, v150
    v_dot2_f32_bf16 v152, v50, v50, v152
    v_dot2_f32_bf16 v151, v51, v158, v151
    v_dot2_f32_bf16 v153, v51, v51, v153
    v_dot2_f32_bf16 v150, v52, v158, v150
    v_dot2_f32_bf16 v152, v52, v52, v152
    v_dot2_f32_bf16 v151, v53, v158, v151
    v_dot2_f32_bf16 v153, v53, v53, v153
    v_dot2_f32_bf16 v150, v54, v158, v150
    v_dot2_f32_bf16 v152, v54, v54, v152
    v_dot2_f32_bf16 v151, v55, v158, v151
    v_dot2_f32_bf16 v153, v55, v55, v153
    v_dot2_f32_bf16 v150, v56, v158, v150
    v_dot2_f32_bf16 v152, v56, v56, v152
    v_dot2_f32_bf16 v151, v57, v158, v151
    v_dot2_f32_bf16 v153, v57, v57, v153
    v_dot2_f32_bf16 v150, v58, v158, v150
    v_dot2_f32_bf16 v152, v58, v58, v152
    v_dot2_f32_bf16 v151, v59, v158, v151
    v_dot2_f32_bf16 v153, v59, v59, v153
    v_dot2_f32_bf16 v150, v60, v158, v150
    v_dot2_f32_bf16 v152, v60, v60, v152
    v_dot2_f32_bf16 v151, v61, v158, v151
    v_dot2_f32_bf16 v153, v61, v61, v153
    v_dot2_f32_bf16 v150, v62, v158, v150
    v_dot2_f32_bf16 v152, v62, v62, v152
    v_dot2_f32_bf16 v151, v63, v158, v151
    v_dot2_f32_bf16 v153, v63, v63, v153
    s_nop 1
    v_add_f32 v150, v150, v151
    v_add_f32 v152, v152, v153
    v_mov_b32 v157, v150
    s_nop 1
    v_permlane32_swap_b32 v157, v150
    v_add_f32 v150, v157, v150
    v_mov_b32 v157, v150
    s_nop 1
    v_permlane16_swap_b32 v157, v150
    v_add_f32 v150, v157, v150
    v_mov_b32 v157, v152
    s_nop 1
    v_permlane32_swap_b32 v157, v152
    v_add_f32 v152, v157, v152
    v_mov_b32 v157, v152
    s_nop 1
    v_permlane16_swap_b32 v157, v152
    v_add_f32 v152, v157, v152
    v_mul_f32 v150, 0x3b000000, v150
    v_cvt_pk_bf16_f32 v154, v150, v150
    v_and_b32 v154, 0xffff0000, v154
    v_sub_f32 v156, v150, v154
    v_mul_f32 v157, v150, v150
    v_mul_f32 v152, 0x3b000000, v152
    v_sub_f32 v152, v152, v157
    v_max_f32 v152, 0, v152
    v_cvt_pk_bf16_f32 v152, v152, v152
    v_and_b32 v152, 0xffff0000, v152
    v_add_f32 v152, 0x3727c5ac, v152
    v_cvt_pk_bf16_f32 v152, v152, v152
    v_and_b32 v152, 0xffff0000, v152
    v_sqrt_f32 v152, v152
    s_nop 0
    v_cvt_pk_bf16_f32 v152, v152, v152
    v_and_b32 v152, 0xffff0000, v152
    v_rcp_f32 v152, v152
    v_lshlrev_b32 v160, 16, v0
    v_and_b32 v161, 0xffff0000, v0
    v_lshlrev_b32 v162, 16, v1
    v_and_b32 v163, 0xffff0000, v1
    v_lshlrev_b32 v164, 16, v2
    v_and_b32 v165, 0xffff0000, v2
    v_lshlrev_b32 v166, 16, v3
    v_and_b32 v167, 0xffff0000, v3
    v_lshlrev_b32 v168, 16, v4
    v_and_b32 v169, 0xffff0000, v4
    v_lshlrev_b32 v170, 16, v5
    v_and_b32 v171, 0xffff0000, v5
    v_lshlrev_b32 v172, 16, v6
    v_and_b32 v173, 0xffff0000, v6
    v_lshlrev_b32 v174, 16, v7
    v_and_b32 v175, 0xffff0000, v7
    v_pk_add_f32 v[160:161], v[160:161], v[154:155] op_sel_hi:[1,0] neg_lo:[0,1] neg_hi:[0,1]
    v_pk_add_f32 v[162:163], v[162:163], v[154:155] op_sel_hi:[1,0] neg_lo:[0,1] neg_hi:[0,1]
    v_pk_add_f32 v[164:165], v[164:165], v[154:155] op_sel_hi:[1,0] neg_lo:[0,1] neg_hi:[0,1]
    v_pk_add_f32 v[166:167], v[166:167], v[154:155] op_sel_hi:[1,0] neg_lo:[0,1] neg_hi:[0,1]
    v_pk_add_f32 v[168:169], v[168:169], v[154:155] op_sel_hi:[1,0] neg_lo:[0,1] neg_hi:[0,1]
    v_pk_add_f32 v[170:171], v[170:171], v[154:155] op_sel_hi:[1,0] neg_lo:[0,1] neg_hi:[0,1]
    s_add_u32 s26, s24, 0x20000
    s_add_u32 m0, s29, 0x1000
    s_nop 0
    buffer_load_dwordx4 v136, s[16:19], s26 offen lds
    v_pk_add_f32 v[172:173], v[172:173], v[154:155] op_sel_hi:[1,0] neg_lo:[0,1] neg_hi:[0,1]
    v_pk_add_f32 v[174:175], v[174:175], v[154:155] op_sel_hi:[1,0] neg_lo:[0,1] neg_hi:[0,1]
    v_cvt_pk_bf16_f32 v0, v160, v161
    v_cvt_pk_bf16_f32 v1, v162, v163
    v_cvt_pk_bf16_f32 v2, v164, v165
    v_cvt_pk_bf16_f32 v3, v166, v167
    v_cvt_pk_bf16_f32 v4, v168, v169
    v_cvt_pk_bf16_f32 v5, v170, v171
    v_cvt_pk_bf16_f32 v6, v172, v173
    v_cvt_pk_bf16_f32 v7, v174, v175
    v_lshlrev_b32 v160, 16, v0
    v_and_b32 v161, 0xffff0000, v0
    v_lshlrev_b32 v162, 16, v1
    v_and_b32 v163, 0xffff0000, v1
    v_lshlrev_b32 v164, 16, v2
    v_and_b32 v165, 0xffff0000, v2
    v_lshlrev_b32 v166, 16, v3
    v_and_b32 v167, 0xffff0000, v3
    v_lshlrev_b32 v168, 16, v4
    v_and_b32 v169, 0xffff0000, v4
    v_lshlrev_b32 v170, 16, v5
    v_and_b32 v171, 0xffff0000, v5
    v_lshlrev_b32 v172, 16, v6
    v_and_b32 v173, 0xffff0000, v6
    v_lshlrev_b32 v174, 16, v7
    v_and_b32 v175, 0xffff0000, v7
    v_pk_mul_f32 v[160:161], v[160:161], v[152:153] op_sel_hi:[1,0]
    v_pk_mul_f32 v[162:163], v[162:163], v[152:153] op_sel_hi:[1,0]
    v_pk_mul_f32 v[164:165], v[164:165], v[152:153] op_sel_hi:[1,0]
    v_pk_mul_f32 v[166:167], v[166:167], v[152:153] op_sel_hi:[1,0]
    v_pk_mul_f32 v[168:169], v[168:169], v[152:153] op_sel_hi:[1,0]
    v_pk_mul_f32 v[170:171], v[170:171], v[152:153] op_sel_hi:[1,0]
    v_pk_mul_f32 v[172:173], v[172:173], v[152:153] op_sel_hi:[1,0]
    v_pk_mul_f32 v[174:175], v[174:175], v[152:153] op_sel_hi:[1,0]
    v_cvt_pk_bf16_f32 v160, v160, v161
    v_cvt_pk_bf16_f32 v162, v162, v163
    v_cvt_pk_bf16_f32 v164, v164, v165
    v_cvt_pk_bf16_f32 v166, v166, v167
    v_cvt_pk_bf16_f32 v168, v168, v169
    v_cvt_pk_bf16_f32 v170, v170, v171
    v_cvt_pk_bf16_f32 v172, v172, v173
    v_cvt_pk_bf16_f32 v174, v174, v175
    v_accvgpr_write_b32 a0, v160
    v_accvgpr_write_b32 a1, v162
    v_accvgpr_write_b32 a2, v164
    v_accvgpr_write_b32 a3, v166
    v_accvgpr_write_b32 a4, v168
    v_accvgpr_write_b32 a5, v170
    v_accvgpr_write_b32 a6, v172
    v_accvgpr_write_b32 a7, v174
    s_add_u32 s26, s24, 0x40000
    s_add_u32 m0, s29, 0x2000
    s_nop 0
    buffer_load_dwordx4 v136, s[16:19], s26 offen lds
    v_lshlrev_b32 v160, 16, v8
    v_and_b32 v161, 0xffff0000, v8
    v_lshlrev_b32 v162, 16, v9
    v_and_b32 v163, 0xffff0000, v9
    v_lshlrev_b32 v164, 16, v10
    v_and_b32 v165, 0xffff0000, v10
    v_lshlrev_b32 v166, 16, v11
    v_and_b32 v167, 0xffff0000, v11
    v_lshlrev_b32 v168, 16, v12
    v_and_b32 v169, 0xffff0000, v12
    v_lshlrev_b32 v170, 16, v13
    v_and_b32 v171, 0xffff0000, v13
    v_lshlrev_b32 v172, 16, v14
    v_and_b32 v173, 0xffff0000, v14
    v_lshlrev_b32 v174, 16, v15
    v_and_b32 v175, 0xffff0000, v15
    v_pk_add_f32 v[160:161], v[160:161], v[154:155] op_sel_hi:[1,0] neg_lo:[0,1] neg_hi:[0,1]
    v_pk_add_f32 v[162:163], v[162:163], v[154:155] op_sel_hi:[1,0] neg_lo:[0,1] neg_hi:[0,1]
    v_pk_add_f32 v[164:165], v[164:165], v[154:155] op_sel_hi:[1,0] neg_lo:[0,1] neg_hi:[0,1]
    v_pk_add_f32 v[166:167], v[166:167], v[154:155] op_sel_hi:[1,0] neg_lo:[0,1] neg_hi:[0,1]
    v_pk_add_f32 v[168:169], v[168:169], v[154:155] op_sel_hi:[1,0] neg_lo:[0,1] neg_hi:[0,1]
    v_pk_add_f32 v[170:171], v[170:171], v[154:155] op_sel_hi:[1,0] neg_lo:[0,1] neg_hi:[0,1]
    v_pk_add_f32 v[172:173], v[172:173], v[154:155] op_sel_hi:[1,0] neg_lo:[0,1] neg_hi:[0,1]
    v_pk_add_f32 v[174:175], v[174:175], v[154:155] op_sel_hi:[1,0] neg_lo:[0,1] neg_hi:[0,1]
    v_cvt_pk_bf16_f32 v8, v160, v161
    v_cvt_pk_bf16_f32 v9, v162, v163
    v_cvt_pk_bf16_f32 v10, v164, v165
    v_cvt_pk_bf16_f32 v11, v166, v167
    v_cvt_pk_bf16_f32 v12, v168, v169
    v_cvt_pk_bf16_f32 v13, v170, v171
    v_cvt_pk_bf16_f32 v14, v172, v173
    v_cvt_pk_bf16_f32 v15, v174, v175
    v_lshlrev_b32 v160, 16, v8
    v_and_b32 v161, 0xffff0000, v8
    v_lshlrev_b32 v162, 16, v9
    v_and_b32 v163, 0xffff0000, v9
    v_lshlrev_b32 v164, 16, v10
    v_and_b32 v165, 0xffff0000, v10
    v_lshlrev_b32 v166, 16, v11
    v_and_b32 v167, 0xffff0000, v11
    v_lshlrev_b32 v168, 16, v12
    v_and_b32 v169, 0xffff0000, v12
    v_lshlrev_b32 v170, 16, v13
    v_and_b32 v171, 0xffff0000, v13
    v_lshlrev_b32 v172, 16, v14
    v_and_b32 v173, 0xffff0000, v14
    v_lshlrev_b32 v174, 16, v15
    v_and_b32 v175, 0xffff0000, v15
    v_pk_mul_f32 v[160:161], v[160:161], v[152:153] op_sel_hi:[1,0]
    v_pk_mul_f32 v[162:163], v[162:163], v[152:153] op_sel_hi:[1,0]
    s_add_u32 s26, s24, 0x60000
    s_add_u32 m0, s29, 0x3000
    s_nop 0
    buffer_load_dwordx4 v136, s[16:19], s26 offen lds
    v_pk_mul_f32 v[164:165], v[164:165], v[152:153] op_sel_hi:[1,0]
    v_pk_mul_f32 v[166:167], v[166:167], v[152:153] op_sel_hi:[1,0]
    v_pk_mul_f32 v[168:169], v[168:169], v[152:153] op_sel_hi:[1,0]
    v_pk_mul_f32 v[170:171], v[170:171], v[152:153] op_sel_hi:[1,0]
    v_pk_mul_f32 v[172:173], v[172:173], v[152:153] op_sel_hi:[1,0]
    v_pk_mul_f32 v[174:175], v[174:175], v[152:153] op_sel_hi:[1,0]
    v_cvt_pk_bf16_f32 v160, v160, v161
    v_cvt_pk_bf16_f32 v162, v162, v163
    v_cvt_pk_bf16_f32 v164, v164, v165
    v_cvt_pk_bf16_f32 v166, v166, v167
    v_cvt_pk_bf16_f32 v168, v168, v169
    v_cvt_pk_bf16_f32 v170, v170, v171
    v_cvt_pk_bf16_f32 v172, v172, v173
    v_cvt_pk_bf16_f32 v174, v174, v175
    v_accvgpr_write_b32 a8, v160
    v_accvgpr_write_b32 a9, v162
    v_accvgpr_write_b32 a10, v164
    v_accvgpr_write_b32 a11, v166
    v_accvgpr_write_b32 a12, v168
    v_accvgpr_write_b32 a13, v170
    v_accvgpr_write_b32 a14, v172
    v_accvgpr_write_b32 a15, v174
    v_lshlrev_b32 v160, 16, v16
    v_and_b32 v161, 0xffff0000, v16
    v_lshlrev_b32 v162, 16, v17
    v_and_b32 v163, 0xffff0000, v17
    v_lshlrev_b32 v164, 16, v18
    v_and_b32 v165, 0xffff0000, v18
    v_lshlrev_b32 v166, 16, v19
    v_and_b32 v167, 0xffff0000, v19
    v_lshlrev_b32 v168, 16, v20
    v_and_b32 v169, 0xffff0000, v20
    v_lshlrev_b32 v170, 16, v21
    v_and_b32 v171, 0xffff0000, v21
    v_lshlrev_b32 v172, 16, v22
    v_and_b32 v173, 0xffff0000, v22
    v_lshlrev_b32 v174, 16, v23
    v_and_b32 v175, 0xffff0000, v23
    v_pk_add_f32 v[160:161], v[160:161], v[154:155] op_sel_hi:[1,0] neg_lo:[0,1] neg_hi:[0,1]
    v_pk_add_f32 v[162:163], v[162:163], v[154:155] op_sel_hi:[1,0] neg_lo:[0,1] neg_hi:[0,1]
    v_pk_add_f32 v[164:165], v[164:165], v[154:155] op_sel_hi:[1,0] neg_lo:[0,1] neg_hi:[0,1]
    v_pk_add_f32 v[166:167], v[166:167], v[154:155] op_sel_hi:[1,0] neg_lo:[0,1] neg_hi:[0,1]
    v_pk_add_f32 v[168:169], v[168:169], v[154:155] op_sel_hi:[1,0] neg_lo:[0,1] neg_hi:[0,1]
    v_pk_add_f32 v[170:171], v[170:171], v[154:155] op_sel_hi:[1,0] neg_lo:[0,1] neg_hi:[0,1]
    v_pk_add_f32 v[172:173], v[172:173], v[154:155] op_sel_hi:[1,0] neg_lo:[0,1] neg_hi:[0,1]
    v_pk_add_f32 v[174:175], v[174:175], v[154:155] op_sel_hi:[1,0] neg_lo:[0,1] neg_hi:[0,1]
    v_cvt_pk_bf16_f32 v16, v160, v161
    v_cvt_pk_bf16_f32 v17, v162, v163
    v_cvt_pk_bf16_f32 v18, v164, v165
    v_cvt_pk_bf16_f32 v19, v166, v167
    s_add_u32 s26, s24, 0x80000
    s_add_u32 m0, s29, 0x4000
    s_nop 0
    buffer_load_dwordx4 v136, s[16:19], s26 offen lds
    v_cvt_pk_bf16_f32 v20, v168, v169
    v_cvt_pk_bf16_f32 v21, v170, v171
    v_cvt_pk_bf16_f32 v22, v172, v173
    v_cvt_pk_bf16_f32 v23, v174, v175
    v_lshlrev_b32 v160, 16, v16
    v_and_b32 v161, 0xffff0000, v16
    v_lshlrev_b32 v162, 16, v17
    v_and_b32 v163, 0xffff0000, v17
    v_lshlrev_b32 v164, 16, v18
    v_and_b32 v165, 0xffff0000, v18
    v_lshlrev_b32 v166, 16, v19
    v_and_b32 v167, 0xffff0000, v19
    v_lshlrev_b32 v168, 16, v20
    v_and_b32 v169, 0xffff0000, v20
    v_lshlrev_b32 v170, 16, v21
    v_and_b32 v171, 0xffff0000, v21
    v_lshlrev_b32 v172, 16, v22
    v_and_b32 v173, 0xffff0000, v22
    v_lshlrev_b32 v174, 16, v23
    v_and_b32 v175, 0xffff0000, v23
    v_pk_mul_f32 v[160:161], v[160:161], v[152:153] op_sel_hi:[1,0]
    v_pk_mul_f32 v[162:163], v[162:163], v[152:153] op_sel_hi:[1,0]
    v_pk_mul_f32 v[164:165], v[164:165], v[152:153] op_sel_hi:[1,0]
    v_pk_mul_f32 v[166:167], v[166:167], v[152:153] op_sel_hi:[1,0]
    v_pk_mul_f32 v[168:169], v[168:169], v[152:153] op_sel_hi:[1,0]
    v_pk_mul_f32 v[170:171], v[170:171], v[152:153] op_sel_hi:[1,0]
    v_pk_mul_f32 v[172:173], v[172:173], v[152:153] op_sel_hi:[1,0]
    v_pk_mul_f32 v[174:175], v[174:175], v[152:153] op_sel_hi:[1,0]
    v_cvt_pk_bf16_f32 v160, v160, v161
    v_cvt_pk_bf16_f32 v162, v162, v163
    v_cvt_pk_bf16_f32 v164, v164, v165
    v_cvt_pk_bf16_f32 v166, v166, v167
    v_cvt_pk_bf16_f32 v168, v168, v169
    v_cvt_pk_bf16_f32 v170, v170, v171
    v_cvt_pk_bf16_f32 v172, v172, v173
    v_cvt_pk_bf16_f32 v174, v174, v175
    v_accvgpr_write_b32 a16, v160
    v_accvgpr_write_b32 a17, v162
    v_accvgpr_write_b32 a18, v164
    v_accvgpr_write_b32 a19, v166
    v_accvgpr_write_b32 a20, v168
    v_accvgpr_write_b32 a21, v170
    v_accvgpr_write_b32 a22, v172
    v_accvgpr_write_b32 a23, v174
    v_lshlrev_b32 v160, 16, v24
    v_and_b32 v161, 0xffff0000, v24
    v_lshlrev_b32 v162, 16, v25
    v_and_b32 v163, 0xffff0000, v25
    v_lshlrev_b32 v164, 16, v26
    v_and_b32 v165, 0xffff0000, v26
    s_add_u32 s26, s24, 0xa0000
    s_add_u32 m0, s29, 0x5000
    s_nop 0
    buffer_load_dwordx4 v136, s[16:19], s26 offen lds
    v_lshlrev_b32 v166, 16, v27
    v_and_b32 v167, 0xffff0000, v27
    v_lshlrev_b32 v168, 16, v28
    v_and_b32 v169, 0xffff0000, v28
    v_lshlrev_b32 v170, 16, v29
    v_and_b32 v171, 0xffff0000, v29
    v_lshlrev_b32 v172, 16, v30
    v_and_b32 v173, 0xffff0000, v30
    v_lshlrev_b32 v174, 16, v31
    v_and_b32 v175, 0xffff0000, v31
    v_pk_add_f32 v[160:161], v[160:161], v[154:155] op_sel_hi:[1,0] neg_lo:[0,1] neg_hi:[0,1]
    v_pk_add_f32 v[162:163], v[162:163], v[154:155] op_sel_hi:[1,0] neg_lo:[0,1] neg_hi:[0,1]
    v_pk_add_f32 v[164:165], v[164:165], v[154:155] op_sel_hi:[1,0] neg_lo:[0,1] neg_hi:[0,1]
    v_pk_add_f32 v[166:167], v[166:167], v[154:155] op_sel_hi:[1,0] neg_lo:[0,1] neg_hi:[0,1]
    v_pk_add_f32 v[168:169], v[168:169], v[154:155] op_sel_hi:[1,0] neg_lo:[0,1] neg_hi:[0,1]
    v_pk_add_f32 v[170:171], v[170:171], v[154:155] op_sel_hi:[1,0] neg_lo:[0,1] neg_hi:[0,1]
    v_pk_add_f32 v[172:173], v[172:173], v[154:155] op_sel_hi:[1,0] neg_lo:[0,1] neg_hi:[0,1]
    v_pk_add_f32 v[174:175], v[174:175], v[154:155] op_sel_hi:[1,0] neg_lo:[0,1] neg_hi:[0,1]
    v_cvt_pk_bf16_f32 v24, v160, v161
    v_cvt_pk_bf16_f32 v25, v162, v163
    v_cvt_pk_bf16_f32 v26, v164, v165
    v_cvt_pk_bf16_f32 v27, v166, v167
    v_cvt_pk_bf16_f32 v28, v168, v169
    v_cvt_pk_bf16_f32 v29, v170, v171
    v_cvt_pk_bf16_f32 v30, v172, v173
    v_cvt_pk_bf16_f32 v31, v174, v175
    v_lshlrev_b32 v160, 16, v24
    v_and_b32 v161, 0xffff0000, v24
    v_lshlrev_b32 v162, 16, v25
    v_and_b32 v163, 0xffff0000, v25
    v_lshlrev_b32 v164, 16, v26
    v_and_b32 v165, 0xffff0000, v26
    v_lshlrev_b32 v166, 16, v27
    v_and_b32 v167, 0xffff0000, v27
    v_lshlrev_b32 v168, 16, v28
    v_and_b32 v169, 0xffff0000, v28
    v_lshlrev_b32 v170, 16, v29
    v_and_b32 v171, 0xffff0000, v29
    v_lshlrev_b32 v172, 16, v30
    v_and_b32 v173, 0xffff0000, v30
    v_lshlrev_b32 v174, 16, v31
    v_and_b32 v175, 0xffff0000, v31
    v_pk_mul_f32 v[160:161], v[160:161], v[152:153] op_sel_hi:[1,0]
    v_pk_mul_f32 v[162:163], v[162:163], v[152:153] op_sel_hi:[1,0]
    v_pk_mul_f32 v[164:165], v[164:165], v[152:153] op_sel_hi:[1,0]
    v_pk_mul_f32 v[166:167], v[166:167], v[152:153] op_sel_hi:[1,0]
    v_pk_mul_f32 v[168:169], v[168:169], v[152:153] op_sel_hi:[1,0]
    v_pk_mul_f32 v[170:171], v[170:171], v[152:153] op_sel_hi:[1,0]
    v_pk_mul_f32 v[172:173], v[172:173], v[152:153] op_sel_hi:[1,0]
    v_pk_mul_f32 v[174:175], v[174:175], v[152:153] op_sel_hi:[1,0]
    s_add_u32 s26, s24, 0xc0000
    s_add_u32 m0, s29, 0x6000
    s_nop 0
    buffer_load_dwordx4 v136, s[16:19], s26 offen lds
    v_cvt_pk_bf16_f32 v160, v160, v161
    v_cvt_pk_bf16_f32 v162, v162, v163
    v_cvt_pk_bf16_f32 v164, v164, v165
    v_cvt_pk_bf16_f32 v166, v166, v167
    v_cvt_pk_bf16_f32 v168, v168, v169
    v_cvt_pk_bf16_f32 v170, v170, v171
    v_cvt_pk_bf16_f32 v172, v172, v173
    v_cvt_pk_bf16_f32 v174, v174, v175
    v_accvgpr_write_b32 a24, v160
    v_accvgpr_write_b32 a25, v162
    v_accvgpr_write_b32 a26, v164
    v_accvgpr_write_b32 a27, v166
    v_accvgpr_write_b32 a28, v168
    v_accvgpr_write_b32 a29, v170
    v_accvgpr_write_b32 a30, v172
    v_accvgpr_write_b32 a31, v174
    v_lshlrev_b32 v160, 16, v32
    v_and_b32 v161, 0xffff0000, v32
    v_lshlrev_b32 v162, 16, v33
    v_and_b32 v163, 0xffff0000, v33
    v_lshlrev_b32 v164, 16, v34
    v_and_b32 v165, 0xffff0000, v34
    v_lshlrev_b32 v166, 16, v35
    v_and_b32 v167, 0xffff0000, v35
    v_lshlrev_b32 v168, 16, v36
    v_and_b32 v169, 0xffff0000, v36
    v_lshlrev_b32 v170, 16, v37
    v_and_b32 v171, 0xffff0000, v37
    v_lshlrev_b32 v172, 16, v38
    v_and_b32 v173, 0xffff0000, v38
    v_lshlrev_b32 v174, 16, v39
    v_and_b32 v175, 0xffff0000, v39
    v_pk_add_f32 v[160:161], v[160:161], v[154:155] op_sel_hi:[1,0] neg_lo:[0,1] neg_hi:[0,1]
    v_pk_add_f32 v[162:163], v[162:163], v[154:155] op_sel_hi:[1,0] neg_lo:[0,1] neg_hi:[0,1]
    v_pk_add_f32 v[164:165], v[164:165], v[154:155] op_sel_hi:[1,0] neg_lo:[0,1] neg_hi:[0,1]
    v_pk_add_f32 v[166:167], v[166:167], v[154:155] op_sel_hi:[1,0] neg_lo:[0,1] neg_hi:[0,1]
    v_pk_add_f32 v[168:169], v[168:169], v[154:155] op_sel_hi:[1,0] neg_lo:[0,1] neg_hi:[0,1]
    v_pk_add_f32 v[170:171], v[170:171], v[154:155] op_sel_hi:[1,0] neg_lo:[0,1] neg_hi:[0,1]
    v_pk_add_f32 v[172:173], v[172:173], v[154:155] op_sel_hi:[1,0] neg_lo:[0,1] neg_hi:[0,1]
    v_pk_add_f32 v[174:175], v[174:175], v[154:155] op_sel_hi:[1,0] neg_lo:[0,1] neg_hi:[0,1]
    v_cvt_pk_bf16_f32 v32, v160, v161
    v_cvt_pk_bf16_f32 v33, v162, v163
    v_cvt_pk_bf16_f32 v34, v164, v165
    v_cvt_pk_bf16_f32 v35, v166, v167
    v_cvt_pk_bf16_f32 v36, v168, v169
    v_cvt_pk_bf16_f32 v37, v170, v171
    v_cvt_pk_bf16_f32 v38, v172, v173
    v_cvt_pk_bf16_f32 v39, v174, v175
    v_lshlrev_b32 v160, 16, v32
    v_and_b32 v161, 0xffff0000, v32
    s_add_u32 s26, s24, 0xe0000
    s_add_u32 m0, s29, 0x7000
    s_nop 0
    buffer_load_dwordx4 v136, s[16:19], s26 offen lds
    v_lshlrev_b32 v162, 16, v33
    v_and_b32 v163, 0xffff0000, v33
    v_lshlrev_b32 v164, 16, v34
    v_and_b32 v165, 0xffff0000, v34
    v_lshlrev_b32 v166, 16, v35
    v_and_b32 v167, 0xffff0000, v35
    v_lshlrev_b32 v168, 16, v36
    v_and_b32 v169, 0xffff0000, v36
    v_lshlrev_b32 v170, 16, v37
    v_and_b32 v171, 0xffff0000, v37
    v_lshlrev_b32 v172, 16, v38
    v_and_b32 v173, 0xffff0000, v38
    v_lshlrev_b32 v174, 16, v39
    v_and_b32 v175, 0xffff0000, v39
    v_pk_mul_f32 v[160:161], v[160:161], v[152:153] op_sel_hi:[1,0]
    v_pk_mul_f32 v[162:163], v[162:163], v[152:153] op_sel_hi:[1,0]
    v_pk_mul_f32 v[164:165], v[164:165], v[152:153] op_sel_hi:[1,0]
    v_pk_mul_f32 v[166:167], v[166:167], v[152:153] op_sel_hi:[1,0]
    v_pk_mul_f32 v[168:169], v[168:169], v[152:153] op_sel_hi:[1,0]
    v_pk_mul_f32 v[170:171], v[170:171], v[152:153] op_sel_hi:[1,0]
    v_pk_mul_f32 v[172:173], v[172:173], v[152:153] op_sel_hi:[1,0]
    v_pk_mul_f32 v[174:175], v[174:175], v[152:153] op_sel_hi:[1,0]
    v_cvt_pk_bf16_f32 v160, v160, v161
    v_cvt_pk_bf16_f32 v162, v162, v163
    v_cvt_pk_bf16_f32 v164, v164, v165
    v_cvt_pk_bf16_f32 v166, v166, v167
    v_cvt_pk_bf16_f32 v168, v168, v169
    v_cvt_pk_bf16_f32 v170, v170, v171
    v_cvt_pk_bf16_f32 v172, v172, v173
    v_cvt_pk_bf16_f32 v174, v174, v175
    v_accvgpr_write_b32 a32, v160
    v_accvgpr_write_b32 a33, v162
    v_accvgpr_write_b32 a34, v164
    v_accvgpr_write_b32 a35, v166
    v_accvgpr_write_b32 a36, v168
    v_accvgpr_write_b32 a37, v170
    v_accvgpr_write_b32 a38, v172
    v_accvgpr_write_b32 a39, v174
    v_lshlrev_b32 v160, 16, v40
    v_and_b32 v161, 0xffff0000, v40
    v_lshlrev_b32 v162, 16, v41
    v_and_b32 v163, 0xffff0000, v41
    v_lshlrev_b32 v164, 16, v42
    v_and_b32 v165, 0xffff0000, v42
    v_lshlrev_b32 v166, 16, v43
    v_and_b32 v167, 0xffff0000, v43
    v_lshlrev_b32 v168, 16, v44
    v_and_b32 v169, 0xffff0000, v44
    v_lshlrev_b32 v170, 16, v45
    v_and_b32 v171, 0xffff0000, v45
    s_add_u32 s26, s24, 0x100000
    s_add_u32 m0, s29, 0x8000
    s_nop 0
    buffer_load_dwordx4 v136, s[16:19], s26 offen lds
    v_lshlrev_b32 v172, 16, v46
    v_and_b32 v173, 0xffff0000, v46
    v_lshlrev_b32 v174, 16, v47
    v_and_b32 v175, 0xffff0000, v47
    v_pk_add_f32 v[160:161], v[160:161], v[154:155] op_sel_hi:[1,0] neg_lo:[0,1] neg_hi:[0,1]
    v_pk_add_f32 v[162:163], v[162:163], v[154:155] op_sel_hi:[1,0] neg_lo:[0,1] neg_hi:[0,1]
    v_pk_add_f32 v[164:165], v[164:165], v[154:155] op_sel_hi:[1,0] neg_lo:[0,1] neg_hi:[0,1]
    v_pk_add_f32 v[166:167], v[166:167], v[154:155] op_sel_hi:[1,0] neg_lo:[0,1] neg_hi:[0,1]
    v_pk_add_f32 v[168:169], v[168:169], v[154:155] op_sel_hi:[1,0] neg_lo:[0,1] neg_hi:[0,1]
    v_pk_add_f32 v[170:171], v[170:171], v[154:155] op_sel_hi:[1,0] neg_lo:[0,1] neg_hi:[0,1]
    v_pk_add_f32 v[172:173], v[172:173], v[154:155] op_sel_hi:[1,0] neg_lo:[0,1] neg_hi:[0,1]
    v_pk_add_f32 v[174:175], v[174:175], v[154:155] op_sel_hi:[1,0] neg_lo:[0,1] neg_hi:[0,1]
    v_cvt_pk_bf16_f32 v40, v160, v161
    v_cvt_pk_bf16_f32 v41, v162, v163
    v_cvt_pk_bf16_f32 v42, v164, v165
    v_cvt_pk_bf16_f32 v43, v166, v167
    v_cvt_pk_bf16_f32 v44, v168, v169
    v_cvt_pk_bf16_f32 v45, v170, v171
    v_cvt_pk_bf16_f32 v46, v172, v173
    v_cvt_pk_bf16_f32 v47, v174, v175
    v_lshlrev_b32 v160, 16, v40
    v_and_b32 v161, 0xffff0000, v40
    v_lshlrev_b32 v162, 16, v41
    v_and_b32 v163, 0xffff0000, v41
    v_lshlrev_b32 v164, 16, v42
    v_and_b32 v165, 0xffff0000, v42
    v_lshlrev_b32 v166, 16, v43
    v_and_b32 v167, 0xffff0000, v43
    v_lshlrev_b32 v168, 16, v44
    v_and_b32 v169, 0xffff0000, v44
    v_lshlrev_b32 v170, 16, v45
    v_and_b32 v171, 0xffff0000, v45
    v_lshlrev_b32 v172, 16, v46
    v_and_b32 v173, 0xffff0000, v46
    v_lshlrev_b32 v174, 16, v47
    v_and_b32 v175, 0xffff0000, v47
    v_pk_mul_f32 v[160:161], v[160:161], v[152:153] op_sel_hi:[1,0]
    v_pk_mul_f32 v[162:163], v[162:163], v[152:153] op_sel_hi:[1,0]
    v_pk_mul_f32 v[164:165], v[164:165], v[152:153] op_sel_hi:[1,0]
    v_pk_mul_f32 v[166:167], v[166:167], v[152:153] op_sel_hi:[1,0]
    v_pk_mul_f32 v[168:169], v[168:169], v[152:153] op_sel_hi:[1,0]
    v_pk_mul_f32 v[170:171], v[170:171], v[152:153] op_sel_hi:[1,0]
    v_pk_mul_f32 v[172:173], v[172:173], v[152:153] op_sel_hi:[1,0]
    v_pk_mul_f32 v[174:175], v[174:175], v[152:153] op_sel_hi:[1,0]
    v_cvt_pk_bf16_f32 v160, v160, v161
    v_cvt_pk_bf16_f32 v162, v162, v163
    v_cvt_pk_bf16_f32 v164, v164, v165
    v_cvt_pk_bf16_f32 v166, v166, v167
    v_cvt_pk_bf16_f32 v168, v168, v169
    v_cvt_pk_bf16_f32 v170, v170, v171
    s_add_u32 s26, s24, 0x120000
    s_add_u32 m0, s29, 0x9000
    s_nop 0
    buffer_load_dwordx4 v136, s[16:19], s26 offen lds
    v_cvt_pk_bf16_f32 v172, v172, v173
    v_cvt_pk_bf16_f32 v174, v174, v175
    v_accvgpr_write_b32 a40, v160
    v_accvgpr_write_b32 a41, v162
    v_accvgpr_write_b32 a42, v164
    v_accvgpr_write_b32 a43, v166
    v_accvgpr_write_b32 a44, v168
    v_accvgpr_write_b32 a45, v170
    v_accvgpr_write_b32 a46, v172
    v_accvgpr_write_b32 a47, v174
    v_lshlrev_b32 v160, 16, v48
    v_and_b32 v161, 0xffff0000, v48
    v_lshlrev_b32 v162, 16, v49
    v_and_b32 v163, 0xffff0000, v49
    v_lshlrev_b32 v164, 16, v50
    v_and_b32 v165, 0xffff0000, v50
    v_lshlrev_b32 v166, 16, v51
    v_and_b32 v167, 0xffff0000, v51
    v_lshlrev_b32 v168, 16, v52
    v_and_b32 v169, 0xffff0000, v52
    v_lshlrev_b32 v170, 16, v53
    v_and_b32 v171, 0xffff0000, v53
    v_lshlrev_b32 v172, 16, v54
    v_and_b32 v173, 0xffff0000, v54
    v_lshlrev_b32 v174, 16, v55
    v_and_b32 v175, 0xffff0000, v55
    v_pk_add_f32 v[160:161], v[160:161], v[154:155] op_sel_hi:[1,0] neg_lo:[0,1] neg_hi:[0,1]
    v_pk_add_f32 v[162:163], v[162:163], v[154:155] op_sel_hi:[1,0] neg_lo:[0,1] neg_hi:[0,1]
    v_pk_add_f32 v[164:165], v[164:165], v[154:155] op_sel_hi:[1,0] neg_lo:[0,1] neg_hi:[0,1]
    v_pk_add_f32 v[166:167], v[166:167], v[154:155] op_sel_hi:[1,0] neg_lo:[0,1] neg_hi:[0,1]
    v_pk_add_f32 v[168:169], v[168:169], v[154:155] op_sel_hi:[1,0] neg_lo:[0,1] neg_hi:[0,1]
    v_pk_add_f32 v[170:171], v[170:171], v[154:155] op_sel_hi:[1,0] neg_lo:[0,1] neg_hi:[0,1]
    v_pk_add_f32 v[172:173], v[172:173], v[154:155] op_sel_hi:[1,0] neg_lo:[0,1] neg_hi:[0,1]
    v_pk_add_f32 v[174:175], v[174:175], v[154:155] op_sel_hi:[1,0] neg_lo:[0,1] neg_hi:[0,1]
    v_cvt_pk_bf16_f32 v48, v160, v161
    v_cvt_pk_bf16_f32 v49, v162, v163
    v_cvt_pk_bf16_f32 v50, v164, v165
    v_cvt_pk_bf16_f32 v51, v166, v167
    v_cvt_pk_bf16_f32 v52, v168, v169
    v_cvt_pk_bf16_f32 v53, v170, v171
    v_cvt_pk_bf16_f32 v54, v172, v173
    v_cvt_pk_bf16_f32 v55, v174, v175
    v_lshlrev_b32 v160, 16, v48
    v_and_b32 v161, 0xffff0000, v48
    v_lshlrev_b32 v162, 16, v49
    v_and_b32 v163, 0xffff0000, v49
    v_lshlrev_b32 v164, 16, v50
    v_and_b32 v165, 0xffff0000, v50
    v_lshlrev_b32 v166, 16, v51
    v_and_b32 v167, 0xffff0000, v51
    s_add_u32 s26, s24, 0x140000
    s_add_u32 m0, s29, 0xa000
    s_nop 0
    buffer_load_dwordx4 v136, s[16:19], s26 offen lds
    v_lshlrev_b32 v168, 16, v52
    v_and_b32 v169, 0xffff0000, v52
    v_lshlrev_b32 v170, 16, v53
    v_and_b32 v171, 0xffff0000, v53
    v_lshlrev_b32 v172, 16, v54
    v_and_b32 v173, 0xffff0000, v54
    v_lshlrev_b32 v174, 16, v55
    v_and_b32 v175, 0xffff0000, v55
    v_pk_mul_f32 v[160:161], v[160:161], v[152:153] op_sel_hi:[1,0]
    v_pk_mul_f32 v[162:163], v[162:163], v[152:153] op_sel_hi:[1,0]
    v_pk_mul_f32 v[164:165], v[164:165], v[152:153] op_sel_hi:[1,0]
    v_pk_mul_f32 v[166:167], v[166:167], v[152:153] op_sel_hi:[1,0]
    v_pk_mul_f32 v[168:169], v[168:169], v[152:153] op_sel_hi:[1,0]
    v_pk_mul_f32 v[170:171], v[170:171], v[152:153] op_sel_hi:[1,0]
    v_pk_mul_f32 v[172:173], v[172:173], v[152:153] op_sel_hi:[1,0]
    v_pk_mul_f32 v[174:175], v[174:175], v[152:153] op_sel_hi:[1,0]
    v_cvt_pk_bf16_f32 v160, v160, v161
    v_cvt_pk_bf16_f32 v162, v162, v163
    v_cvt_pk_bf16_f32 v164, v164, v165
    v_cvt_pk_bf16_f32 v166, v166, v167
    v_cvt_pk_bf16_f32 v168, v168, v169
    v_cvt_pk_bf16_f32 v170, v170, v171
    v_cvt_pk_bf16_f32 v172, v172, v173
    v_cvt_pk_bf16_f32 v174, v174, v175
    v_accvgpr_write_b32 a48, v160
    v_accvgpr_write_b32 a49, v162
    v_accvgpr_write_b32 a50, v164
    v_accvgpr_write_b32 a51, v166
    v_accvgpr_write_b32 a52, v168
    v_accvgpr_write_b32 a53, v170
    v_accvgpr_write_b32 a54, v172
    v_accvgpr_write_b32 a55, v174
    v_lshlrev_b32 v160, 16, v56
    v_and_b32 v161, 0xffff0000, v56
    v_lshlrev_b32 v162, 16, v57
    v_and_b32 v163, 0xffff0000, v57
    v_lshlrev_b32 v164, 16, v58
    v_and_b32 v165, 0xffff0000, v58
    v_lshlrev_b32 v166, 16, v59
    v_and_b32 v167, 0xffff0000, v59
    v_lshlrev_b32 v168, 16, v60
    v_and_b32 v169, 0xffff0000, v60
    v_lshlrev_b32 v170, 16, v61
    v_and_b32 v171, 0xffff0000, v61
    v_lshlrev_b32 v172, 16, v62
    v_and_b32 v173, 0xffff0000, v62
    v_lshlrev_b32 v174, 16, v63
    v_and_b32 v175, 0xffff0000, v63
    v_pk_add_f32 v[160:161], v[160:161], v[154:155] op_sel_hi:[1,0] neg_lo:[0,1] neg_hi:[0,1]
    v_pk_add_f32 v[162:163], v[162:163], v[154:155] op_sel_hi:[1,0] neg_lo:[0,1] neg_hi:[0,1]
    s_add_u32 s26, s24, 0x160000
    s_add_u32 m0, s29, 0xb000
    s_nop 0
    buffer_load_dwordx4 v136, s[16:19], s26 offen lds
    v_pk_add_f32 v[164:165], v[164:165], v[154:155] op_sel_hi:[1,0] neg_lo:[0,1] neg_hi:[0,1]
    v_pk_add_f32 v[166:167], v[166:167], v[154:155] op_sel_hi:[1,0] neg_lo:[0,1] neg_hi:[0,1]
    v_pk_add_f32 v[168:169], v[168:169], v[154:155] op_sel_hi:[1,0] neg_lo:[0,1] neg_hi:[0,1]
    v_pk_add_f32 v[170:171], v[170:171], v[154:155] op_sel_hi:[1,0] neg_lo:[0,1] neg_hi:[0,1]
    v_pk_add_f32 v[172:173], v[172:173], v[154:155] op_sel_hi:[1,0] neg_lo:[0,1] neg_hi:[0,1]
    v_pk_add_f32 v[174:175], v[174:175], v[154:155] op_sel_hi:[1,0] neg_lo:[0,1] neg_hi:[0,1]
    v_cvt_pk_bf16_f32 v56, v160, v161
    v_cvt_pk_bf16_f32 v57, v162, v163
    v_cvt_pk_bf16_f32 v58, v164, v165
    v_cvt_pk_bf16_f32 v59, v166, v167
    v_cvt_pk_bf16_f32 v60, v168, v169
    v_cvt_pk_bf16_f32 v61, v170, v171
    v_cvt_pk_bf16_f32 v62, v172, v173
    v_cvt_pk_bf16_f32 v63, v174, v175
    v_lshlrev_b32 v160, 16, v56
    v_and_b32 v161, 0xffff0000, v56
    v_lshlrev_b32 v162, 16, v57
    v_and_b32 v163, 0xffff0000, v57
    v_lshlrev_b32 v164, 16, v58
    v_and_b32 v165, 0xffff0000, v58
    v_lshlrev_b32 v166, 16, v59
    v_and_b32 v167, 0xffff0000, v59
    v_lshlrev_b32 v168, 16, v60
    v_and_b32 v169, 0xffff0000, v60
    v_lshlrev_b32 v170, 16, v61
    v_and_b32 v171, 0xffff0000, v61
    v_lshlrev_b32 v172, 16, v62
    v_and_b32 v173, 0xffff0000, v62
    v_lshlrev_b32 v174, 16, v63
    v_and_b32 v175, 0xffff0000, v63
    v_pk_mul_f32 v[160:161], v[160:161], v[152:153] op_sel_hi:[1,0]
    v_pk_mul_f32 v[162:163], v[162:163], v[152:153] op_sel_hi:[1,0]
    v_pk_mul_f32 v[164:165], v[164:165], v[152:153] op_sel_hi:[1,0]
    v_pk_mul_f32 v[166:167], v[166:167], v[152:153] op_sel_hi:[1,0]
    v_pk_mul_f32 v[168:169], v[168:169], v[152:153] op_sel_hi:[1,0]
    v_pk_mul_f32 v[170:171], v[170:171], v[152:153] op_sel_hi:[1,0]
    v_pk_mul_f32 v[172:173], v[172:173], v[152:153] op_sel_hi:[1,0]
    v_pk_mul_f32 v[174:175], v[174:175], v[152:153] op_sel_hi:[1,0]
    v_cvt_pk_bf16_f32 v160, v160, v161
    v_cvt_pk_bf16_f32 v162, v162, v163
    v_cvt_pk_bf16_f32 v164, v164, v165
    v_cvt_pk_bf16_f32 v166, v166, v167
    v_cvt_pk_bf16_f32 v168, v168, v169
    v_cvt_pk_bf16_f32 v170, v170, v171
    v_cvt_pk_bf16_f32 v172, v172, v173
    v_cvt_pk_bf16_f32 v174, v174, v175
    v_accvgpr_write_b32 a56, v160
    v_accvgpr_write_b32 a57, v162
    v_accvgpr_write_b32 a58, v164
    v_accvgpr_write_b32 a59, v166
    s_add_u32 s26, s24, 0x180000
    s_add_u32 m0, s29, 0xc000
    s_nop 0
    buffer_load_dwordx4 v136, s[16:19], s26 offen lds
    v_accvgpr_write_b32 a60, v168
    v_accvgpr_write_b32 a61, v170
    v_accvgpr_write_b32 a62, v172
    v_accvgpr_write_b32 a63, v174
    s_waitcnt vmcnt(13)
    v_pk_mov_b32 v[150:151], 0, 0
    v_pk_mov_b32 v[152:153], 0, 0
    v_dot2_f32_bf16 v150, v64, v158, v150
    v_dot2_f32_bf16 v152, v64, v64, v152
    v_dot2_f32_bf16 v151, v65, v158, v151
    v_dot2_f32_bf16 v153, v65, v65, v153
    v_dot2_f32_bf16 v150, v66, v158, v150
    v_dot2_f32_bf16 v152, v66, v66, v152
    v_dot2_f32_bf16 v151, v67, v158, v151
    v_dot2_f32_bf16 v153, v67, v67, v153
    v_dot2_f32_bf16 v150, v68, v158, v150
    v_dot2_f32_bf16 v152, v68, v68, v152
    v_dot2_f32_bf16 v151, v69, v158, v151
    v_dot2_f32_bf16 v153, v69, v69, v153
    v_dot2_f32_bf16 v150, v70, v158, v150
    v_dot2_f32_bf16 v152, v70, v70, v152
    v_dot2_f32_bf16 v151, v71, v158, v151
    v_dot2_f32_bf16 v153, v71, v71, v153
    v_dot2_f32_bf16 v150, v72, v158, v150
    v_dot2_f32_bf16 v152, v72, v72, v152
    v_dot2_f32_bf16 v151, v73, v158, v151
    v_dot2_f32_bf16 v153, v73, v73, v153
    v_dot2_f32_bf16 v150, v74, v158, v150
    v_dot2_f32_bf16 v152, v74, v74, v152
    v_dot2_f32_bf16 v151, v75, v158, v151
    v_dot2_f32_bf16 v153, v75, v75, v153
    v_dot2_f32_bf16 v150, v76, v158, v150
    v_dot2_f32_bf16 v152, v76, v76, v152
    v_dot2_f32_bf16 v151, v77, v158, v151
    v_dot2_f32_bf16 v153, v77, v77, v153
    v_dot2_f32_bf16 v150, v78, v158, v150
    v_dot2_f32_bf16 v152, v78, v78, v152
    v_dot2_f32_bf16 v151, v79, v158, v151
    v_dot2_f32_bf16 v153, v79, v79, v153
    v_dot2_f32_bf16 v150, v80, v158, v150
    v_dot2_f32_bf16 v152, v80, v80, v152
    v_dot2_f32_bf16 v151, v81, v158, v151
    v_dot2_f32_bf16 v153, v81, v81, v153
    v_dot2_f32_bf16 v150, v82, v158, v150
    v_dot2_f32_bf16 v152, v82, v82, v152
    v_dot2_f32_bf16 v151, v83, v158, v151
    v_dot2_f32_bf16 v153, v83, v83, v153
    v_dot2_f32_bf16 v150, v84, v158, v150
    v_dot2_f32_bf16 v152, v84, v84, v152
    v_dot2_f32_bf16 v151, v85, v158, v151
    v_dot2_f32_bf16 v153, v85, v85, v153
    v_dot2_f32_bf16 v150, v86, v158, v150
    v_dot2_f32_bf16 v152, v86, v86, v152
    s_add_u32 s26, s24, 0x1a0000
    s_add_u32 m0, s29, 0xd000
    s_nop 0
    buffer_load_dwordx4 v136, s[16:19], s26 offen lds
    v_dot2_f32_bf16 v151, v87, v158, v151
    v_dot2_f32_bf16 v153, v87, v87, v153
    v_dot2_f32_bf16 v150, v88, v158, v150
    v_dot2_f32_bf16 v152, v88, v88, v152
    v_dot2_f32_bf16 v151, v89, v158, v151
    v_dot2_f32_bf16 v153, v89, v89, v153
    v_dot2_f32_bf16 v150, v90, v158, v150
    v_dot2_f32_bf16 v152, v90, v90, v152
    v_dot2_f32_bf16 v151, v91, v158, v151
    v_dot2_f32_bf16 v153, v91, v91, v153
    v_dot2_f32_bf16 v150, v92, v158, v150
    v_dot2_f32_bf16 v152, v92, v92, v152
    v_dot2_f32_bf16 v151, v93, v158, v151
    v_dot2_f32_bf16 v153, v93, v93, v153
    v_dot2_f32_bf16 v150, v94, v158, v150
    v_dot2_f32_bf16 v152, v94, v94, v152
    v_dot2_f32_bf16 v151, v95, v158, v151
    v_dot2_f32_bf16 v153, v95, v95, v153
    v_dot2_f32_bf16 v150, v96, v158, v150
    v_dot2_f32_bf16 v152, v96, v96, v152
    v_dot2_f32_bf16 v151, v97, v158, v151
    v_dot2_f32_bf16 v153, v97, v97, v153
    v_dot2_f32_bf16 v150, v98, v158, v150
    v_dot2_f32_bf16 v152, v98, v98, v152
    v_dot2_f32_bf16 v151, v99, v158, v151
    v_dot2_f32_bf16 v153, v99, v99, v153
    v_dot2_f32_bf16 v150, v100, v158, v150
    v_dot2_f32_bf16 v152, v100, v100, v152
    v_dot2_f32_bf16 v151, v101, v158, v151
    v_dot2_f32_bf16 v153, v101, v101, v153
    v_dot2_f32_bf16 v150, v102, v158, v150
    v_dot2_f32_bf16 v152, v102, v102, v152
    v_dot2_f32_bf16 v151, v103, v158, v151
    v_dot2_f32_bf16 v153, v103, v103, v153
    v_dot2_f32_bf16 v150, v104, v158, v150
    v_dot2_f32_bf16 v152, v104, v104, v152
    v_dot2_f32_bf16 v151, v105, v158, v151
    v_dot2_f32_bf16 v153, v105, v105, v153
    v_dot2_f32_bf16 v150, v106, v158, v150
    v_dot2_f32_bf16 v152, v106, v106, v152
    v_dot2_f32_bf16 v151, v107, v158, v151
    v_dot2_f32_bf16 v153, v107, v107, v153
    v_dot2_f32_bf16 v150, v108, v158, v150
    v_dot2_f32_bf16 v152, v108, v108, v152
    v_dot2_f32_bf16 v151, v109, v158, v151
    v_dot2_f32_bf16 v153, v109, v109, v153
    v_dot2_f32_bf16 v150, v110, v158, v150
    v_dot2_f32_bf16 v152, v110, v110, v152
    v_dot2_f32_bf16 v151, v111, v158, v151
    v_dot2_f32_bf16 v153, v111, v111, v153
    s_add_u32 s26, s24, 0x1c0000
    s_add_u32 m0, s29, 0xe000
    s_nop 0
    buffer_load_dwordx4 v136, s[16:19], s26 offen lds
    v_dot2_f32_bf16 v150, v112, v158, v150
    v_dot2_f32_bf16 v152, v112, v112, v152
    v_dot2_f32_bf16 v151, v113, v158, v151
    v_dot2_f32_bf16 v153, v113, v113, v153
    v_dot2_f32_bf16 v150, v114, v158, v150
    v_dot2_f32_bf16 v152, v114, v114, v152
    v_dot2_f32_bf16 v151, v115, v158, v151
    v_dot2_f32_bf16 v153, v115, v115, v153
    v_dot2_f32_bf16 v150, v116, v158, v150
    v_dot2_f32_bf16 v152, v116, v116, v152
    v_dot2_f32_bf16 v151, v117, v158, v151
    v_dot2_f32_bf16 v153, v117, v117, v153
    v_dot2_f32_bf16 v150, v118, v158, v150
    v_dot2_f32_bf16 v152, v118, v118, v152
    v_dot2_f32_bf16 v151, v119, v158, v151
    v_dot2_f32_bf16 v153, v119, v119, v153
    v_dot2_f32_bf16 v150, v120, v158, v150
    v_dot2_f32_bf16 v152, v120, v120, v152
    v_dot2_f32_bf16 v151, v121, v158, v151
    v_dot2_f32_bf16 v153, v121, v121, v153
    v_dot2_f32_bf16 v150, v122, v158, v150
    v_dot2_f32_bf16 v152, v122, v122, v152
    v_dot2_f32_bf16 v151, v123, v158, v151
    v_dot2_f32_bf16 v153, v123, v123, v153
    v_dot2_f32_bf16 v150, v124, v158, v150
    v_dot2_f32_bf16 v152, v124, v124, v152
    v_dot2_f32_bf16 v151, v125, v158, v151
    v_dot2_f32_bf16 v153, v125, v125, v153
    v_dot2_f32_bf16 v150, v126, v158, v150
    v_dot2_f32_bf16 v152, v126, v126, v152
    v_dot2_f32_bf16 v151, v127, v158, v151
    v_dot2_f32_bf16 v153, v127, v127, v153
    s_nop 1
    v_add_f32 v150, v150, v151
    v_add_f32 v152, v152, v153
    v_mov_b32 v157, v150
    s_nop 1
    v_permlane32_swap_b32 v157, v150
    v_add_f32 v150, v157, v150
    v_mov_b32 v157, v150
    s_nop 1
    v_permlane16_swap_b32 v157, v150
    v_add_f32 v150, v157, v150
    v_mov_b32 v157, v152
    s_nop 1
    v_permlane32_swap_b32 v157, v152
    v_add_f32 v152, v157, v152
    v_mov_b32 v157, v152
    s_nop 1
    v_permlane16_swap_b32 v157, v152
    v_add_f32 v152, v157, v152
    v_mul_f32 v150, 0x3b000000, v150
    v_cvt_pk_bf16_f32 v154, v150, v150
    v_and_b32 v154, 0xffff0000, v154
    v_sub_f32 v156, v150, v154
    v_mul_f32 v157, v150, v150
    v_mul_f32 v152, 0x3b000000, v152
    v_sub_f32 v152, v152, v157
    v_max_f32 v152, 0, v152
    v_cvt_pk_bf16_f32 v152, v152, v152
    v_and_b32 v152, 0xffff0000, v152
    v_add_f32 v152, 0x3727c5ac, v152
    v_cvt_pk_bf16_f32 v152, v152, v152
    v_and_b32 v152, 0xffff0000, v152
    v_sqrt_f32 v152, v152
    s_nop 0
    v_cvt_pk_bf16_f32 v152, v152, v152
    v_and_b32 v152, 0xffff0000, v152
    v_rcp_f32 v152, v152
    v_lshlrev_b32 v160, 16, v64
    v_and_b32 v161, 0xffff0000, v64
    v_lshlrev_b32 v162, 16, v65
    v_and_b32 v163, 0xffff0000, v65
    v_lshlrev_b32 v164, 16, v66
    v_and_b32 v165, 0xffff0000, v66
    v_lshlrev_b32 v166, 16, v67
    v_and_b32 v167, 0xffff0000, v67
    v_lshlrev_b32 v168, 16, v68
    v_and_b32 v169, 0xffff0000, v68
    v_lshlrev_b32 v170, 16, v69
    v_and_b32 v171, 0xffff0000, v69
    v_lshlrev_b32 v172, 16, v70
    v_and_b32 v173, 0xffff0000, v70
    v_lshlrev_b32 v174, 16, v71
    v_and_b32 v175, 0xffff0000, v71
    v_pk_add_f32 v[160:161], v[160:161], v[154:155] op_sel_hi:[1,0] neg_lo:[0,1] neg_hi:[0,1]
    v_pk_add_f32 v[162:163], v[162:163], v[154:155] op_sel_hi:[1,0] neg_lo:[0,1] neg_hi:[0,1]
    s_add_u32 s26, s24, 0x1e0000
    s_add_u32 m0, s29, 0xf000
    s_nop 0
    buffer_load_dwordx4 v136, s[16:19], s26 offen lds
    v_pk_add_f32 v[164:165], v[164:165], v[154:155] op_sel_hi:[1,0] neg_lo:[0,1] neg_hi:[0,1]
    v_pk_add_f32 v[166:167], v[166:167], v[154:155] op_sel_hi:[1,0] neg_lo:[0,1] neg_hi:[0,1]
    v_pk_add_f32 v[168:169], v[168:169], v[154:155] op_sel_hi:[1,0] neg_lo:[0,1] neg_hi:[0,1]
    v_pk_add_f32 v[170:171], v[170:171], v[154:155] op_sel_hi:[1,0] neg_lo:[0,1] neg_hi:[0,1]
    v_pk_add_f32 v[172:173], v[172:173], v[154:155] op_sel_hi:[1,0] neg_lo:[0,1] neg_hi:[0,1]
    v_pk_add_f32 v[174:175], v[174:175], v[154:155] op_sel_hi:[1,0] neg_lo:[0,1] neg_hi:[0,1]
    v_cvt_pk_bf16_f32 v64, v160, v161
    v_cvt_pk_bf16_f32 v65, v162, v163
    v_cvt_pk_bf16_f32 v66, v164, v165
    v_cvt_pk_bf16_f32 v67, v166, v167
    v_cvt_pk_bf16_f32 v68, v168, v169
    v_cvt_pk_bf16_f32 v69, v170, v171
    v_cvt_pk_bf16_f32 v70, v172, v173
    v_cvt_pk_bf16_f32 v71, v174, v175
    v_lshlrev_b32 v160, 16, v64
    v_and_b32 v161, 0xffff0000, v64
    v_lshlrev_b32 v162, 16, v65
    v_and_b32 v163, 0xffff0000, v65
    v_lshlrev_b32 v164, 16, v66
    v_and_b32 v165, 0xffff0000, v66
    v_lshlrev_b32 v166, 16, v67
    v_and_b32 v167, 0xffff0000, v67
    v_lshlrev_b32 v168, 16, v68
    v_and_b32 v169, 0xffff0000, v68
    v_lshlrev_b32 v170, 16, v69
    v_and_b32 v171, 0xffff0000, v69
    v_lshlrev_b32 v172, 16, v70
    v_and_b32 v173, 0xffff0000, v70
    v_lshlrev_b32 v174, 16, v71
    v_and_b32 v175, 0xffff0000, v71
    v_pk_mul_f32 v[160:161], v[160:161], v[152:153] op_sel_hi:[1,0]
    v_pk_mul_f32 v[162:163], v[162:163], v[152:153] op_sel_hi:[1,0]
    v_pk_mul_f32 v[164:165], v[164:165], v[152:153] op_sel_hi:[1,0]
    v_pk_mul_f32 v[166:167], v[166:167], v[152:153] op_sel_hi:[1,0]
    v_pk_mul_f32 v[168:169], v[168:169], v[152:153] op_sel_hi:[1,0]
    v_pk_mul_f32 v[170:171], v[170:171], v[152:153] op_sel_hi:[1,0]
    v_pk_mul_f32 v[172:173], v[172:173], v[152:153] op_sel_hi:[1,0]
    v_pk_mul_f32 v[174:175], v[174:175], v[152:153] op_sel_hi:[1,0]
    v_cvt_pk_bf16_f32 v160, v160, v161
    v_cvt_pk_bf16_f32 v162, v162, v163
    v_cvt_pk_bf16_f32 v164, v164, v165
    v_cvt_pk_bf16_f32 v166, v166, v167
    v_cvt_pk_bf16_f32 v168, v168, v169
    v_cvt_pk_bf16_f32 v170, v170, v171
    v_cvt_pk_bf16_f32 v172, v172, v173
    v_cvt_pk_bf16_f32 v174, v174, v175
    v_accvgpr_write_b32 a64, v160
    v_accvgpr_write_b32 a65, v162
    v_accvgpr_write_b32 a66, v164
    v_accvgpr_write_b32 a67, v166
    s_add_u32 s26, s24, 0x200000
    s_add_u32 m0, s29, 0x10000
    s_nop 0
    buffer_load_dwordx4 v136, s[16:19], s26 offen lds
    v_accvgpr_write_b32 a68, v168
    v_accvgpr_write_b32 a69, v170
    v_accvgpr_write_b32 a70, v172
    v_accvgpr_write_b32 a71, v174
    v_lshlrev_b32 v160, 16, v72
    v_and_b32 v161, 0xffff0000, v72
    v_lshlrev_b32 v162, 16, v73
    v_and_b32 v163, 0xffff0000, v73
    v_lshlrev_b32 v164, 16, v74
    v_and_b32 v165, 0xffff0000, v74
    v_lshlrev_b32 v166, 16, v75
    v_and_b32 v167, 0xffff0000, v75
    v_lshlrev_b32 v168, 16, v76
    v_and_b32 v169, 0xffff0000, v76
    v_lshlrev_b32 v170, 16, v77
    v_and_b32 v171, 0xffff0000, v77
    v_lshlrev_b32 v172, 16, v78
    v_and_b32 v173, 0xffff0000, v78
    v_lshlrev_b32 v174, 16, v79
    v_and_b32 v175, 0xffff0000, v79
    v_pk_add_f32 v[160:161], v[160:161], v[154:155] op_sel_hi:[1,0] neg_lo:[0,1] neg_hi:[0,1]
    v_pk_add_f32 v[162:163], v[162:163], v[154:155] op_sel_hi:[1,0] neg_lo:[0,1] neg_hi:[0,1]
    v_pk_add_f32 v[164:165], v[164:165], v[154:155] op_sel_hi:[1,0] neg_lo:[0,1] neg_hi:[0,1]
    v_pk_add_f32 v[166:167], v[166:167], v[154:155] op_sel_hi:[1,0] neg_lo:[0,1] neg_hi:[0,1]
    v_pk_add_f32 v[168:169], v[168:169], v[154:155] op_sel_hi:[1,0] neg_lo:[0,1] neg_hi:[0,1]
    v_pk_add_f32 v[170:171], v[170:171], v[154:155] op_sel_hi:[1,0] neg_lo:[0,1] neg_hi:[0,1]
    v_pk_add_f32 v[172:173], v[172:173], v[154:155] op_sel_hi:[1,0] neg_lo:[0,1] neg_hi:[0,1]
    v_pk_add_f32 v[174:175], v[174:175], v[154:155] op_sel_hi:[1,0] neg_lo:[0,1] neg_hi:[0,1]
    v_cvt_pk_bf16_f32 v72, v160, v161
    v_cvt_pk_bf16_f32 v73, v162, v163
    v_cvt_pk_bf16_f32 v74, v164, v165
    v_cvt_pk_bf16_f32 v75, v166, v167
    v_cvt_pk_bf16_f32 v76, v168, v169
    v_cvt_pk_bf16_f32 v77, v170, v171
    v_cvt_pk_bf16_f32 v78, v172, v173
    v_cvt_pk_bf16_f32 v79, v174, v175
    v_lshlrev_b32 v160, 16, v72
    v_and_b32 v161, 0xffff0000, v72
    v_lshlrev_b32 v162, 16, v73
    v_and_b32 v163, 0xffff0000, v73
    v_lshlrev_b32 v164, 16, v74
    v_and_b32 v165, 0xffff0000, v74
    v_lshlrev_b32 v166, 16, v75
    v_and_b32 v167, 0xffff0000, v75
    v_lshlrev_b32 v168, 16, v76
    v_and_b32 v169, 0xffff0000, v76
    v_lshlrev_b32 v170, 16, v77
    v_and_b32 v171, 0xffff0000, v77
    v_lshlrev_b32 v172, 16, v78
    v_and_b32 v173, 0xffff0000, v78
    s_add_u32 s26, s24, 0x220000
    s_add_u32 m0, s29, 0x11000
    s_nop 0
    buffer_load_dwordx4 v136, s[16:19], s26 offen lds
    v_lshlrev_b32 v174, 16, v79
    v_and_b32 v175, 0xffff0000, v79
    v_pk_mul_f32 v[160:161], v[160:161], v[152:153] op_sel_hi:[1,0]
    v_pk_mul_f32 v[162:163], v[162:163], v[152:153] op_sel_hi:[1,0]
    v_pk_mul_f32 v[164:165], v[164:165], v[152:153] op_sel_hi:[1,0]
    v_pk_mul_f32 v[166:167], v[166:167], v[152:153] op_sel_hi:[1,0]
    v_pk_mul_f32 v[168:169], v[168:169], v[152:153] op_sel_hi:[1,0]
    v_pk_mul_f32 v[170:171], v[170:171], v[152:153] op_sel_hi:[1,0]
    v_pk_mul_f32 v[172:173], v[172:173], v[152:153] op_sel_hi:[1,0]
    v_pk_mul_f32 v[174:175], v[174:175], v[152:153] op_sel_hi:[1,0]
    v_cvt_pk_bf16_f32 v160, v160, v161
    v_cvt_pk_bf16_f32 v162, v162, v163
    v_cvt_pk_bf16_f32 v164, v164, v165
    v_cvt_pk_bf16_f32 v166, v166, v167
    v_cvt_pk_bf16_f32 v168, v168, v169
    v_cvt_pk_bf16_f32 v170, v170, v171
    v_cvt_pk_bf16_f32 v172, v172, v173
    v_cvt_pk_bf16_f32 v174, v174, v175
    v_accvgpr_write_b32 a72, v160
    v_accvgpr_write_b32 a73, v162
    v_accvgpr_write_b32 a74, v164
    v_accvgpr_write_b32 a75, v166
    v_accvgpr_write_b32 a76, v168
    v_accvgpr_write_b32 a77, v170
    v_accvgpr_write_b32 a78, v172
    v_accvgpr_write_b32 a79, v174
    v_lshlrev_b32 v160, 16, v80
    v_and_b32 v161, 0xffff0000, v80
    v_lshlrev_b32 v162, 16, v81
    v_and_b32 v163, 0xffff0000, v81
    v_lshlrev_b32 v164, 16, v82
    v_and_b32 v165, 0xffff0000, v82
    v_lshlrev_b32 v166, 16, v83
    v_and_b32 v167, 0xffff0000, v83
    v_lshlrev_b32 v168, 16, v84
    v_and_b32 v169, 0xffff0000, v84
    v_lshlrev_b32 v170, 16, v85
    v_and_b32 v171, 0xffff0000, v85
    v_lshlrev_b32 v172, 16, v86
    v_and_b32 v173, 0xffff0000, v86
    v_lshlrev_b32 v174, 16, v87
    v_and_b32 v175, 0xffff0000, v87
    v_pk_add_f32 v[160:161], v[160:161], v[154:155] op_sel_hi:[1,0] neg_lo:[0,1] neg_hi:[0,1]
    v_pk_add_f32 v[162:163], v[162:163], v[154:155] op_sel_hi:[1,0] neg_lo:[0,1] neg_hi:[0,1]
    v_pk_add_f32 v[164:165], v[164:165], v[154:155] op_sel_hi:[1,0] neg_lo:[0,1] neg_hi:[0,1]
    v_pk_add_f32 v[166:167], v[166:167], v[154:155] op_sel_hi:[1,0] neg_lo:[0,1] neg_hi:[0,1]
    v_pk_add_f32 v[168:169], v[168:169], v[154:155] op_sel_hi:[1,0] neg_lo:[0,1] neg_hi:[0,1]
    v_pk_add_f32 v[170:171], v[170:171], v[154:155] op_sel_hi:[1,0] neg_lo:[0,1] neg_hi:[0,1]
    v_pk_add_f32 v[172:173], v[172:173], v[154:155] op_sel_hi:[1,0] neg_lo:[0,1] neg_hi:[0,1]
    v_pk_add_f32 v[174:175], v[174:175], v[154:155] op_sel_hi:[1,0] neg_lo:[0,1] neg_hi:[0,1]
    s_add_u32 s26, s24, 0x240000
    s_add_u32 m0, s29, 0x12000
    s_nop 0
    buffer_load_dwordx4 v136, s[16:19], s26 offen lds
    v_cvt_pk_bf16_f32 v80, v160, v161
    v_cvt_pk_bf16_f32 v81, v162, v163
    v_cvt_pk_bf16_f32 v82, v164, v165
    v_cvt_pk_bf16_f32 v83, v166, v167
    v_cvt_pk_bf16_f32 v84, v168, v169
    v_cvt_pk_bf16_f32 v85, v170, v171
    v_cvt_pk_bf16_f32 v86, v172, v173
    v_cvt_pk_bf16_f32 v87, v174, v175
    v_lshlrev_b32 v160, 16, v80
    v_and_b32 v161, 0xffff0000, v80
    v_lshlrev_b32 v162, 16, v81
    v_and_b32 v163, 0xffff0000, v81
    v_lshlrev_b32 v164, 16, v82
    v_and_b32 v165, 0xffff0000, v82
    v_lshlrev_b32 v166, 16, v83
    v_and_b32 v167, 0xffff0000, v83
    v_lshlrev_b32 v168, 16, v84
    v_and_b32 v169, 0xffff0000, v84
    v_lshlrev_b32 v170, 16, v85
    v_and_b32 v171, 0xffff0000, v85
    v_lshlrev_b32 v172, 16, v86
    v_and_b32 v173, 0xffff0000, v86
    v_lshlrev_b32 v174, 16, v87
    v_and_b32 v175, 0xffff0000, v87
    v_pk_mul_f32 v[160:161], v[160:161], v[152:153] op_sel_hi:[1,0]
    v_pk_mul_f32 v[162:163], v[162:163], v[152:153] op_sel_hi:[1,0]
    v_pk_mul_f32 v[164:165], v[164:165], v[152:153] op_sel_hi:[1,0]
    v_pk_mul_f32 v[166:167], v[166:167], v[152:153] op_sel_hi:[1,0]
    v_pk_mul_f32 v[168:169], v[168:169], v[152:153] op_sel_hi:[1,0]
    v_pk_mul_f32 v[170:171], v[170:171], v[152:153] op_sel_hi:[1,0]
    v_pk_mul_f32 v[172:173], v[172:173], v[152:153] op_sel_hi:[1,0]
    v_pk_mul_f32 v[174:175], v[174:175], v[152:153] op_sel_hi:[1,0]
    v_cvt_pk_bf16_f32 v160, v160, v161
    v_cvt_pk_bf16_f32 v162, v162, v163
    v_cvt_pk_bf16_f32 v164, v164, v165
    v_cvt_pk_bf16_f32 v166, v166, v167
    v_cvt_pk_bf16_f32 v168, v168, v169
    v_cvt_pk_bf16_f32 v170, v170, v171
    v_cvt_pk_bf16_f32 v172, v172, v173
    v_cvt_pk_bf16_f32 v174, v174, v175
    v_accvgpr_write_b32 a80, v160
    v_accvgpr_write_b32 a81, v162
    v_accvgpr_write_b32 a82, v164
    v_accvgpr_write_b32 a83, v166
    v_accvgpr_write_b32 a84, v168
    v_accvgpr_write_b32 a85, v170
    v_accvgpr_write_b32 a86, v172
    v_accvgpr_write_b32 a87, v174
    v_lshlrev_b32 v160, 16, v88
    v_and_b32 v161, 0xffff0000, v88
    s_add_u32 s26, s24, 0x260000
    s_add_u32 m0, s29, 0x13000
    s_nop 0
    buffer_load_dwordx4 v136, s[16:19], s26 offen lds
    v_lshlrev_b32 v162, 16, v89
    v_and_b32 v163, 0xffff0000, v89
    v_lshlrev_b32 v164, 16, v90
    v_and_b32 v165, 0xffff0000, v90
    v_lshlrev_b32 v166, 16, v91
    v_and_b32 v167, 0xffff0000, v91
    v_lshlrev_b32 v168, 16, v92
    v_and_b32 v169, 0xffff0000, v92
    v_lshlrev_b32 v170, 16, v93
    v_and_b32 v171, 0xffff0000, v93
    v_lshlrev_b32 v172, 16, v94
    v_and_b32 v173, 0xffff0000, v94
    v_lshlrev_b32 v174, 16, v95
    v_and_b32 v175, 0xffff0000, v95
    v_pk_add_f32 v[160:161], v[160:161], v[154:155] op_sel_hi:[1,0] neg_lo:[0,1] neg_hi:[0,1]
    v_pk_add_f32 v[162:163], v[162:163], v[154:155] op_sel_hi:[1,0] neg_lo:[0,1] neg_hi:[0,1]
    v_pk_add_f32 v[164:165], v[164:165], v[154:155] op_sel_hi:[1,0] neg_lo:[0,1] neg_hi:[0,1]
    v_pk_add_f32 v[166:167], v[166:167], v[154:155] op_sel_hi:[1,0] neg_lo:[0,1] neg_hi:[0,1]
    v_pk_add_f32 v[168:169], v[168:169], v[154:155] op_sel_hi:[1,0] neg_lo:[0,1] neg_hi:[0,1]
    v_pk_add_f32 v[170:171], v[170:171], v[154:155] op_sel_hi:[1,0] neg_lo:[0,1] neg_hi:[0,1]
    v_pk_add_f32 v[172:173], v[172:173], v[154:155] op_sel_hi:[1,0] neg_lo:[0,1] neg_hi:[0,1]
    v_pk_add_f32 v[174:175], v[174:175], v[154:155] op_sel_hi:[1,0] neg_lo:[0,1] neg_hi:[0,1]
    v_cvt_pk_bf16_f32 v88, v160, v161
    v_cvt_pk_bf16_f32 v89, v162, v163
    v_cvt_pk_bf16_f32 v90, v164, v165
    v_cvt_pk_bf16_f32 v91, v166, v167
    v_cvt_pk_bf16_f32 v92, v168, v169
    v_cvt_pk_bf16_f32 v93, v170, v171
    v_cvt_pk_bf16_f32 v94, v172, v173
    v_cvt_pk_bf16_f32 v95, v174, v175
    v_lshlrev_b32 v160, 16, v88
    v_and_b32 v161, 0xffff0000, v88
    v_lshlrev_b32 v162, 16, v89
    v_and_b32 v163, 0xffff0000, v89
    v_lshlrev_b32 v164, 16, v90
    v_and_b32 v165, 0xffff0000, v90
    v_lshlrev_b32 v166, 16, v91
    v_and_b32 v167, 0xffff0000, v91
    v_lshlrev_b32 v168, 16, v92
    v_and_b32 v169, 0xffff0000, v92
    v_lshlrev_b32 v170, 16, v93
    v_and_b32 v171, 0xffff0000, v93
    v_lshlrev_b32 v172, 16, v94
    v_and_b32 v173, 0xffff0000, v94
    v_lshlrev_b32 v174, 16, v95
    v_and_b32 v175, 0xffff0000, v95
    v_pk_mul_f32 v[160:161], v[160:161], v[152:153] op_sel_hi:[1,0]
    v_pk_mul_f32 v[162:163], v[162:163], v[152:153] op_sel_hi:[1,0]
    v_pk_mul_f32 v[164:165], v[164:165], v[152:153] op_sel_hi:[1,0]
    v_pk_mul_f32 v[166:167], v[166:167], v[152:153] op_sel_hi:[1,0]
    s_add_u32 s26, s24, 0x280000
    s_add_u32 m0, s29, 0x14000
    s_nop 0
    buffer_load_dwordx4 v136, s[16:19], s26 offen lds
    v_pk_mul_f32 v[168:169], v[168:169], v[152:153] op_sel_hi:[1,0]
    v_pk_mul_f32 v[170:171], v[170:171], v[152:153] op_sel_hi:[1,0]
    v_pk_mul_f32 v[172:173], v[172:173], v[152:153] op_sel_hi:[1,0]
    v_pk_mul_f32 v[174:175], v[174:175], v[152:153] op_sel_hi:[1,0]
    v_cvt_pk_bf16_f32 v160, v160, v161
    v_cvt_pk_bf16_f32 v162, v162, v163
    v_cvt_pk_bf16_f32 v164, v164, v165
    v_cvt_pk_bf16_f32 v166, v166, v167
    v_cvt_pk_bf16_f32 v168, v168, v169
    v_cvt_pk_bf16_f32 v170, v170, v171
    v_cvt_pk_bf16_f32 v172, v172, v173
    v_cvt_pk_bf16_f32 v174, v174, v175
    v_accvgpr_write_b32 a88, v160
    v_accvgpr_write_b32 a89, v162
    v_accvgpr_write_b32 a90, v164
    v_accvgpr_write_b32 a91, v166
    v_accvgpr_write_b32 a92, v168
    v_accvgpr_write_b32 a93, v170
    v_accvgpr_write_b32 a94, v172
    v_accvgpr_write_b32 a95, v174
    v_lshlrev_b32 v160, 16, v96
    v_and_b32 v161, 0xffff0000, v96
    v_lshlrev_b32 v162, 16, v97
    v_and_b32 v163, 0xffff0000, v97
    v_lshlrev_b32 v164, 16, v98
    v_and_b32 v165, 0xffff0000, v98
    v_lshlrev_b32 v166, 16, v99
    v_and_b32 v167, 0xffff0000, v99
    v_lshlrev_b32 v168, 16, v100
    v_and_b32 v169, 0xffff0000, v100
    v_lshlrev_b32 v170, 16, v101
    v_and_b32 v171, 0xffff0000, v101
    v_lshlrev_b32 v172, 16, v102
    v_and_b32 v173, 0xffff0000, v102
    v_lshlrev_b32 v174, 16, v103
    v_and_b32 v175, 0xffff0000, v103
    v_pk_add_f32 v[160:161], v[160:161], v[154:155] op_sel_hi:[1,0] neg_lo:[0,1] neg_hi:[0,1]
    v_pk_add_f32 v[162:163], v[162:163], v[154:155] op_sel_hi:[1,0] neg_lo:[0,1] neg_hi:[0,1]
    v_pk_add_f32 v[164:165], v[164:165], v[154:155] op_sel_hi:[1,0] neg_lo:[0,1] neg_hi:[0,1]
    v_pk_add_f32 v[166:167], v[166:167], v[154:155] op_sel_hi:[1,0] neg_lo:[0,1] neg_hi:[0,1]
    v_pk_add_f32 v[168:169], v[168:169], v[154:155] op_sel_hi:[1,0] neg_lo:[0,1] neg_hi:[0,1]
    v_pk_add_f32 v[170:171], v[170:171], v[154:155] op_sel_hi:[1,0] neg_lo:[0,1] neg_hi:[0,1]
    v_pk_add_f32 v[172:173], v[172:173], v[154:155] op_sel_hi:[1,0] neg_lo:[0,1] neg_hi:[0,1]
    v_pk_add_f32 v[174:175], v[174:175], v[154:155] op_sel_hi:[1,0] neg_lo:[0,1] neg_hi:[0,1]
    v_cvt_pk_bf16_f32 v96, v160, v161
    v_cvt_pk_bf16_f32 v97, v162, v163
    v_cvt_pk_bf16_f32 v98, v164, v165
    v_cvt_pk_bf16_f32 v99, v166, v167
    v_cvt_pk_bf16_f32 v100, v168, v169
    v_cvt_pk_bf16_f32 v101, v170, v171
    s_add_u32 s26, s24, 0x2a0000
    s_add_u32 m0, s29, 0x15000
    s_nop 0
    buffer_load_dwordx4 v136, s[16:19], s26 offen lds
    v_cvt_pk_bf16_f32 v102, v172, v173
    v_cvt_pk_bf16_f32 v103, v174, v175
    v_lshlrev_b32 v160, 16, v96
    v_and_b32 v161, 0xffff0000, v96
    v_lshlrev_b32 v162, 16, v97
    v_and_b32 v163, 0xffff0000, v97
    v_lshlrev_b32 v164, 16, v98
    v_and_b32 v165, 0xffff0000, v98
    v_lshlrev_b32 v166, 16, v99
    v_and_b32 v167, 0xffff0000, v99
    v_lshlrev_b32 v168, 16, v100
    v_and_b32 v169, 0xffff0000, v100
    v_lshlrev_b32 v170, 16, v101
    v_and_b32 v171, 0xffff0000, v101
    v_lshlrev_b32 v172, 16, v102
    v_and_b32 v173, 0xffff0000, v102
    v_lshlrev_b32 v174, 16, v103
    v_and_b32 v175, 0xffff0000, v103
    v_pk_mul_f32 v[160:161], v[160:161], v[152:153] op_sel_hi:[1,0]
    v_pk_mul_f32 v[162:163], v[162:163], v[152:153] op_sel_hi:[1,0]
    v_pk_mul_f32 v[164:165], v[164:165], v[152:153] op_sel_hi:[1,0]
    v_pk_mul_f32 v[166:167], v[166:167], v[152:153] op_sel_hi:[1,0]
    v_pk_mul_f32 v[168:169], v[168:169], v[152:153] op_sel_hi:[1,0]
    v_pk_mul_f32 v[170:171], v[170:171], v[152:153] op_sel_hi:[1,0]
    v_pk_mul_f32 v[172:173], v[172:173], v[152:153] op_sel_hi:[1,0]
    v_pk_mul_f32 v[174:175], v[174:175], v[152:153] op_sel_hi:[1,0]
    v_cvt_pk_bf16_f32 v160, v160, v161
    v_cvt_pk_bf16_f32 v162, v162, v163
    v_cvt_pk_bf16_f32 v164, v164, v165
    v_cvt_pk_bf16_f32 v166, v166, v167
    v_cvt_pk_bf16_f32 v168, v168, v169
    v_cvt_pk_bf16_f32 v170, v170, v171
    v_cvt_pk_bf16_f32 v172, v172, v173
    v_cvt_pk_bf16_f32 v174, v174, v175
    v_accvgpr_write_b32 a96, v160
    v_accvgpr_write_b32 a97, v162
    v_accvgpr_write_b32 a98, v164
    v_accvgpr_write_b32 a99, v166
    v_accvgpr_write_b32 a100, v168
    v_accvgpr_write_b32 a101, v170
    v_accvgpr_write_b32 a102, v172
    v_accvgpr_write_b32 a103, v174
    v_lshlrev_b32 v160, 16, v104
    v_and_b32 v161, 0xffff0000, v104
    v_lshlrev_b32 v162, 16, v105
    v_and_b32 v163, 0xffff0000, v105
    v_lshlrev_b32 v164, 16, v106
    v_and_b32 v165, 0xffff0000, v106
    v_lshlrev_b32 v166, 16, v107
    v_and_b32 v167, 0xffff0000, v107
    s_add_u32 s26, s24, 0x2c0000
    s_add_u32 m0, s29, 0x16000
    s_nop 0
    buffer_load_dwordx4 v136, s[16:19], s26 offen lds
    v_lshlrev_b32 v168, 16, v108
    v_and_b32 v169, 0xffff0000, v108
    v_lshlrev_b32 v170, 16, v109
    v_and_b32 v171, 0xffff0000, v109
    v_lshlrev_b32 v172, 16, v110
    v_and_b32 v173, 0xffff0000, v110
    v_lshlrev_b32 v174, 16, v111
    v_and_b32 v175, 0xffff0000, v111
    v_pk_add_f32 v[160:161], v[160:161], v[154:155] op_sel_hi:[1,0] neg_lo:[0,1] neg_hi:[0,1]
    v_pk_add_f32 v[162:163], v[162:163], v[154:155] op_sel_hi:[1,0] neg_lo:[0,1] neg_hi:[0,1]
    v_pk_add_f32 v[164:165], v[164:165], v[154:155] op_sel_hi:[1,0] neg_lo:[0,1] neg_hi:[0,1]
    v_pk_add_f32 v[166:167], v[166:167], v[154:155] op_sel_hi:[1,0] neg_lo:[0,1] neg_hi:[0,1]
    v_pk_add_f32 v[168:169], v[168:169], v[154:155] op_sel_hi:[1,0] neg_lo:[0,1] neg_hi:[0,1]
    v_pk_add_f32 v[170:171], v[170:171], v[154:155] op_sel_hi:[1,0] neg_lo:[0,1] neg_hi:[0,1]
    v_pk_add_f32 v[172:173], v[172:173], v[154:155] op_sel_hi:[1,0] neg_lo:[0,1] neg_hi:[0,1]
    v_pk_add_f32 v[174:175], v[174:175], v[154:155] op_sel_hi:[1,0] neg_lo:[0,1] neg_hi:[0,1]
    v_cvt_pk_bf16_f32 v104, v160, v161
    v_cvt_pk_bf16_f32 v105, v162, v163
    v_cvt_pk_bf16_f32 v106, v164, v165
    v_cvt_pk_bf16_f32 v107, v166, v167
    v_cvt_pk_bf16_f32 v108, v168, v169
    v_cvt_pk_bf16_f32 v109, v170, v171
    v_cvt_pk_bf16_f32 v110, v172, v173
    v_cvt_pk_bf16_f32 v111, v174, v175
    v_lshlrev_b32 v160, 16, v104
    v_and_b32 v161, 0xffff0000, v104
    v_lshlrev_b32 v162, 16, v105
    v_and_b32 v163, 0xffff0000, v105
    v_lshlrev_b32 v164, 16, v106
    v_and_b32 v165, 0xffff0000, v106
    v_lshlrev_b32 v166, 16, v107
    v_and_b32 v167, 0xffff0000, v107
    v_lshlrev_b32 v168, 16, v108
    v_and_b32 v169, 0xffff0000, v108
    v_lshlrev_b32 v170, 16, v109
    v_and_b32 v171, 0xffff0000, v109
    v_lshlrev_b32 v172, 16, v110
    v_and_b32 v173, 0xffff0000, v110
    v_lshlrev_b32 v174, 16, v111
    v_and_b32 v175, 0xffff0000, v111
    v_pk_mul_f32 v[160:161], v[160:161], v[152:153] op_sel_hi:[1,0]
    v_pk_mul_f32 v[162:163], v[162:163], v[152:153] op_sel_hi:[1,0]
    v_pk_mul_f32 v[164:165], v[164:165], v[152:153] op_sel_hi:[1,0]
    v_pk_mul_f32 v[166:167], v[166:167], v[152:153] op_sel_hi:[1,0]
    v_pk_mul_f32 v[168:169], v[168:169], v[152:153] op_sel_hi:[1,0]
    v_pk_mul_f32 v[170:171], v[170:171], v[152:153] op_sel_hi:[1,0]
    v_pk_mul_f32 v[172:173], v[172:173], v[152:153] op_sel_hi:[1,0]
    v_pk_mul_f32 v[174:175], v[174:175], v[152:153] op_sel_hi:[1,0]
    v_cvt_pk_bf16_f32 v160, v160, v161
    v_cvt_pk_bf16_f32 v162, v162, v163
    s_add_u32 s26, s24, 0x2e0000
    s_add_u32 m0, s29, 0x17000
    s_nop 0
    buffer_load_dwordx4 v136, s[16:19], s26 offen lds
    v_cvt_pk_bf16_f32 v164, v164, v165
    v_cvt_pk_bf16_f32 v166, v166, v167
    v_cvt_pk_bf16_f32 v168, v168, v169
    v_cvt_pk_bf16_f32 v170, v170, v171
    v_cvt_pk_bf16_f32 v172, v172, v173
    v_cvt_pk_bf16_f32 v174, v174, v175
    v_accvgpr_write_b32 a104, v160
    v_accvgpr_write_b32 a105, v162
    v_accvgpr_write_b32 a106, v164
    v_accvgpr_write_b32 a107, v166
    v_accvgpr_write_b32 a108, v168
    v_accvgpr_write_b32 a109, v170
    v_accvgpr_write_b32 a110, v172
    v_accvgpr_write_b32 a111, v174
    v_lshlrev_b32 v160, 16, v112
    v_and_b32 v161, 0xffff0000, v112
    v_lshlrev_b32 v162, 16, v113
    v_and_b32 v163, 0xffff0000, v113
    v_lshlrev_b32 v164, 16, v114
    v_and_b32 v165, 0xffff0000, v114
    v_lshlrev_b32 v166, 16, v115
    v_and_b32 v167, 0xffff0000, v115
    v_lshlrev_b32 v168, 16, v116
    v_and_b32 v169, 0xffff0000, v116
    v_lshlrev_b32 v170, 16, v117
    v_and_b32 v171, 0xffff0000, v117
    v_lshlrev_b32 v172, 16, v118
    v_and_b32 v173, 0xffff0000, v118
    v_lshlrev_b32 v174, 16, v119
    v_and_b32 v175, 0xffff0000, v119
    v_pk_add_f32 v[160:161], v[160:161], v[154:155] op_sel_hi:[1,0] neg_lo:[0,1] neg_hi:[0,1]
    v_pk_add_f32 v[162:163], v[162:163], v[154:155] op_sel_hi:[1,0] neg_lo:[0,1] neg_hi:[0,1]
    v_pk_add_f32 v[164:165], v[164:165], v[154:155] op_sel_hi:[1,0] neg_lo:[0,1] neg_hi:[0,1]
    v_pk_add_f32 v[166:167], v[166:167], v[154:155] op_sel_hi:[1,0] neg_lo:[0,1] neg_hi:[0,1]
    v_pk_add_f32 v[168:169], v[168:169], v[154:155] op_sel_hi:[1,0] neg_lo:[0,1] neg_hi:[0,1]
    v_pk_add_f32 v[170:171], v[170:171], v[154:155] op_sel_hi:[1,0] neg_lo:[0,1] neg_hi:[0,1]
    v_pk_add_f32 v[172:173], v[172:173], v[154:155] op_sel_hi:[1,0] neg_lo:[0,1] neg_hi:[0,1]
    v_pk_add_f32 v[174:175], v[174:175], v[154:155] op_sel_hi:[1,0] neg_lo:[0,1] neg_hi:[0,1]
    v_cvt_pk_bf16_f32 v112, v160, v161
    v_cvt_pk_bf16_f32 v113, v162, v163
    v_cvt_pk_bf16_f32 v114, v164, v165
    v_cvt_pk_bf16_f32 v115, v166, v167
    v_cvt_pk_bf16_f32 v116, v168, v169
    v_cvt_pk_bf16_f32 v117, v170, v171
    v_cvt_pk_bf16_f32 v118, v172, v173
    v_cvt_pk_bf16_f32 v119, v174, v175
    v_lshlrev_b32 v160, 16, v112
    v_and_b32 v161, 0xffff0000, v112
    v_lshlrev_b32 v162, 16, v113
    v_and_b32 v163, 0xffff0000, v113
    v_lshlrev_b32 v138, 2, v137
    v_lshlrev_b32 v138, 3, v137
    s_sub_u32 s26, s101, 96
    s_lshl_b32 s26, s26, 2
    s_add_u32 s26, s26, s21
    s_min_u32 s26, s26, 512
    s_lshl_b32 s26, s26, 13
    s_cmp_eq_u32 s41, 0
    s_cselect_b32 s6, 0x400000, 0
    s_mov_b32 s7, 0x20000
    s_mov_b32 s4, s66
    s_and_b32 s5, s67, 0xffff
    buffer_load_dword v143, v138, s[4:7], s26 offen
    v_lshlrev_b32 v164, 16, v114
    v_and_b32 v165, 0xffff0000, v114
    v_lshlrev_b32 v166, 16, v115
    v_and_b32 v167, 0xffff0000, v115
    v_lshlrev_b32 v168, 16, v116
    v_and_b32 v169, 0xffff0000, v116
    v_lshlrev_b32 v170, 16, v117
    v_and_b32 v171, 0xffff0000, v117
    v_lshlrev_b32 v172, 16, v118
    v_and_b32 v173, 0xffff0000, v118
    v_lshlrev_b32 v174, 16, v119
    v_and_b32 v175, 0xffff0000, v119
    v_pk_mul_f32 v[160:161], v[160:161], v[152:153] op_sel_hi:[1,0]
    v_pk_mul_f32 v[162:163], v[162:163], v[152:153] op_sel_hi:[1,0]
    v_pk_mul_f32 v[164:165], v[164:165], v[152:153] op_sel_hi:[1,0]
    v_pk_mul_f32 v[166:167], v[166:167], v[152:153] op_sel_hi:[1,0]
    v_pk_mul_f32 v[168:169], v[168:169], v[152:153] op_sel_hi:[1,0]
    v_pk_mul_f32 v[170:171], v[170:171], v[152:153] op_sel_hi:[1,0]
    v_pk_mul_f32 v[172:173], v[172:173], v[152:153] op_sel_hi:[1,0]
    v_pk_mul_f32 v[174:175], v[174:175], v[152:153] op_sel_hi:[1,0]
    v_cvt_pk_bf16_f32 v160, v160, v161
    v_cvt_pk_bf16_f32 v162, v162, v163
    v_cvt_pk_bf16_f32 v164, v164, v165
    v_cvt_pk_bf16_f32 v166, v166, v167
    v_cvt_pk_bf16_f32 v168, v168, v169
    v_cvt_pk_bf16_f32 v170, v170, v171
    v_cvt_pk_bf16_f32 v172, v172, v173
    v_cvt_pk_bf16_f32 v174, v174, v175
    v_accvgpr_write_b32 a112, v160
    v_accvgpr_write_b32 a113, v162
    v_accvgpr_write_b32 a114, v164
    v_accvgpr_write_b32 a115, v166
    v_accvgpr_write_b32 a116, v168
    v_accvgpr_write_b32 a117, v170
    v_accvgpr_write_b32 a118, v172
    v_accvgpr_write_b32 a119, v174
    v_lshlrev_b32 v160, 16, v120
    v_and_b32 v161, 0xffff0000, v120
    v_lshlrev_b32 v162, 16, v121
    v_and_b32 v163, 0xffff0000, v121
    v_lshlrev_b32 v164, 16, v122
    v_and_b32 v165, 0xffff0000, v122
    v_lshlrev_b32 v166, 16, v123
    v_and_b32 v167, 0xffff0000, v123
    v_lshlrev_b32 v168, 16, v124
    v_and_b32 v169, 0xffff0000, v124
    v_lshlrev_b32 v170, 16, v125
    v_and_b32 v171, 0xffff0000, v125
    v_lshlrev_b32 v172, 16, v126
    v_and_b32 v173, 0xffff0000, v126
    v_lshlrev_b32 v174, 16, v127
    v_and_b32 v175, 0xffff0000, v127
    v_pk_add_f32 v[160:161], v[160:161], v[154:155] op_sel_hi:[1,0] neg_lo:[0,1] neg_hi:[0,1]
    v_pk_add_f32 v[162:163], v[162:163], v[154:155] op_sel_hi:[1,0] neg_lo:[0,1] neg_hi:[0,1]
    v_pk_add_f32 v[164:165], v[164:165], v[154:155] op_sel_hi:[1,0] neg_lo:[0,1] neg_hi:[0,1]
    v_pk_add_f32 v[166:167], v[166:167], v[154:155] op_sel_hi:[1,0] neg_lo:[0,1] neg_hi:[0,1]
    v_pk_add_f32 v[168:169], v[168:169], v[154:155] op_sel_hi:[1,0] neg_lo:[0,1] neg_hi:[0,1]
    v_pk_add_f32 v[170:171], v[170:171], v[154:155] op_sel_hi:[1,0] neg_lo:[0,1] neg_hi:[0,1]
    v_pk_add_f32 v[172:173], v[172:173], v[154:155] op_sel_hi:[1,0] neg_lo:[0,1] neg_hi:[0,1]
    v_pk_add_f32 v[174:175], v[174:175], v[154:155] op_sel_hi:[1,0] neg_lo:[0,1] neg_hi:[0,1]
    v_cvt_pk_bf16_f32 v120, v160, v161
    v_cvt_pk_bf16_f32 v121, v162, v163
    v_cvt_pk_bf16_f32 v122, v164, v165
    v_cvt_pk_bf16_f32 v123, v166, v167
    v_cvt_pk_bf16_f32 v124, v168, v169
    v_cvt_pk_bf16_f32 v125, v170, v171
    v_cvt_pk_bf16_f32 v126, v172, v173
    v_cvt_pk_bf16_f32 v127, v174, v175
    v_lshlrev_b32 v160, 16, v120
    v_and_b32 v161, 0xffff0000, v120
    v_lshlrev_b32 v162, 16, v121
    v_and_b32 v163, 0xffff0000, v121
    v_lshlrev_b32 v164, 16, v122
    v_and_b32 v165, 0xffff0000, v122
    v_lshlrev_b32 v166, 16, v123
    v_and_b32 v167, 0xffff0000, v123
    v_lshlrev_b32 v168, 16, v124
    v_and_b32 v169, 0xffff0000, v124
    v_lshlrev_b32 v170, 16, v125
    v_and_b32 v171, 0xffff0000, v125
    v_lshlrev_b32 v172, 16, v126
    v_and_b32 v173, 0xffff0000, v126
    v_lshlrev_b32 v174, 16, v127
    v_and_b32 v175, 0xffff0000, v127
    v_pk_mul_f32 v[160:161], v[160:161], v[152:153] op_sel_hi:[1,0]
    v_pk_mul_f32 v[162:163], v[162:163], v[152:153] op_sel_hi:[1,0]
    v_pk_mul_f32 v[164:165], v[164:165], v[152:153] op_sel_hi:[1,0]
    v_pk_mul_f32 v[166:167], v[166:167], v[152:153] op_sel_hi:[1,0]
    v_pk_mul_f32 v[168:169], v[168:169], v[152:153] op_sel_hi:[1,0]
    v_pk_mul_f32 v[170:171], v[170:171], v[152:153] op_sel_hi:[1,0]
    v_pk_mul_f32 v[172:173], v[172:173], v[152:153] op_sel_hi:[1,0]
    v_pk_mul_f32 v[174:175], v[174:175], v[152:153] op_sel_hi:[1,0]
    v_cvt_pk_bf16_f32 v160, v160, v161
    v_cvt_pk_bf16_f32 v162, v162, v163
    v_cvt_pk_bf16_f32 v164, v164, v165
    v_cvt_pk_bf16_f32 v166, v166, v167
    v_cvt_pk_bf16_f32 v168, v168, v169
    v_cvt_pk_bf16_f32 v170, v170, v171
    v_cvt_pk_bf16_f32 v172, v172, v173
    v_cvt_pk_bf16_f32 v174, v174, v175
    v_accvgpr_write_b32 a120, v160
    v_accvgpr_write_b32 a121, v162
    v_accvgpr_write_b32 a122, v164
    v_accvgpr_write_b32 a123, v166
    v_accvgpr_write_b32 a124, v168
    v_accvgpr_write_b32 a125, v170
    v_accvgpr_write_b32 a126, v172
    v_accvgpr_write_b32 a127, v174
    buffer_load_dwordx2 v[140:141], off, s[92:95], 0 offset:36 sc1
    s_nop 3
L_p1_unit:
    s_cmp_ge_u32 s38, 96
    s_cbranch_scc1 L_p1_end
    s_lshr_b32 s26, s38, 5
    s_add_u32 s27, s26, 1
    s_lshl_b32 s25, s27, 24
    s_lshl_b32 s27, s20, 2
    s_add_u32 s27, s27, s21
    s_lshl_b32 s27, s27, 5
    s_and_b32 s28, s38, 31
    s_add_u32 s27, s27, s28
    s_lshl_b32 s27, s27, 13
    s_add_u32 s25, s25, s27
    s_lshr_b32 s26, s38, 5
    s_cmp_eq_u32 s26, 1
    s_cbranch_scc1 L_p1_v
    s_waitcnt vmcnt(16)
    s_barrier
    ds_read_b64_tr_b16 v[64:65], v128
    ds_read_b64_tr_b16 v[66:67], v128 offset:1024
    ds_read_b64_tr_b16 v[68:69], v129
    ds_read_b64_tr_b16 v[70:71], v129 offset:1024
    ds_read_b64_tr_b16 v[72:73], v130
    ds_read_b64_tr_b16 v[74:75], v130 offset:1024
    ds_read_b64_tr_b16 v[76:77], v131
    ds_read_b64_tr_b16 v[78:79], v131 offset:1024
    ds_read_b64_tr_b16 v[80:81], v132
    ds_read_b64_tr_b16 v[82:83], v132 offset:1024
    ds_read_b64_tr_b16 v[84:85], v133
    ds_read_b64_tr_b16 v[86:87], v133 offset:1024
    ds_read_b64_tr_b16 v[88:89], v134
    ds_read_b64_tr_b16 v[90:91], v134 offset:1024
    s_waitcnt lgkmcnt(12)
    v_mfma_f32_16x16x32_bf16 v[0:3], v[64:67], a[0:3], 0
    ds_read_b64_tr_b16 v[92:93], v135
    v_mfma_f32_16x16x32_bf16 v[4:7], v[64:67], a[64:67], 0
    ds_read_b64_tr_b16 v[94:95], v135 offset:1024
    s_add_u32 s26, s24, 0x300000
    s_add_u32 m0, s29, 0x18000
    s_nop 0
    buffer_load_dwordx4 v136, s[16:19], s26 offen lds
    s_waitcnt lgkmcnt(12)
    v_mfma_f32_16x16x32_bf16 v[8:11], v[68:71], a[0:3], 0
    ds_read_b64_tr_b16 v[96:97], v128 offset:8192
    v_mfma_f32_16x16x32_bf16 v[12:15], v[68:71], a[64:67], 0
    ds_read_b64_tr_b16 v[98:99], v128 offset:9216
    s_add_u32 s26, s24, 0x320000
    s_add_u32 m0, s29, 0x19000
    s_nop 0
    buffer_load_dwordx4 v136, s[16:19], s26 offen lds
    s_waitcnt lgkmcnt(12)
    v_mfma_f32_16x16x32_bf16 v[16:19], v[72:75], a[0:3], 0
    ds_read_b64_tr_b16 v[100:101], v129 offset:8192
    v_mfma_f32_16x16x32_bf16 v[20:23], v[72:75], a[64:67], 0
    ds_read_b64_tr_b16 v[102:103], v129 offset:9216
    s_add_u32 s26, s24, 0x340000
    s_add_u32 m0, s29, 0x1a000
    s_nop 0
    buffer_load_dwordx4 v136, s[16:19], s26 offen lds
    s_waitcnt lgkmcnt(12)
    v_mfma_f32_16x16x32_bf16 v[24:27], v[76:79], a[0:3], 0
    ds_read_b64_tr_b16 v[104:105], v130 offset:8192
    v_mfma_f32_16x16x32_bf16 v[28:31], v[76:79], a[64:67], 0
    ds_read_b64_tr_b16 v[106:107], v130 offset:9216
    s_add_u32 s26, s24, 0x360000
    s_add_u32 m0, s29, 0x1b000
    s_nop 0
    buffer_load_dwordx4 v136, s[16:19], s26 offen lds
    s_waitcnt lgkmcnt(12)
    v_mfma_f32_16x16x32_bf16 v[32:35], v[80:83], a[0:3], 0
    ds_read_b64_tr_b16 v[108:109], v131 offset:8192
    v_mfma_f32_16x16x32_bf16 v[36:39], v[80:83], a[64:67], 0
    ds_read_b64_tr_b16 v[110:111], v131 offset:9216
    s_add_u32 s26, s24, 0x380000
    s_add_u32 m0, s29, 0x1c000
    s_nop 0
    buffer_load_dwordx4 v136, s[16:19], s26 offen lds
    s_waitcnt lgkmcnt(12)
    v_mfma_f32_16x16x32_bf16 v[40:43], v[84:87], a[0:3], 0
    ds_read_b64_tr_b16 v[112:113], v132 offset:8192
    v_mfma_f32_16x16x32_bf16 v[44:47], v[84:87], a[64:67], 0
    ds_read_b64_tr_b16 v[114:115], v132 offset:9216
    s_add_u32 s26, s24, 0x3a0000
    s_add_u32 m0, s29, 0x1d000
    s_nop 0
    buffer_load_dwordx4 v136, s[16:19], s26 offen lds
    s_waitcnt lgkmcnt(12)
    v_mfma_f32_16x16x32_bf16 v[48:51], v[88:91], a[0:3], 0
    ds_read_b64_tr_b16 v[116:117], v133 offset:8192
    v_mfma_f32_16x16x32_bf16 v[52:55], v[88:91], a[64:67], 0
    ds_read_b64_tr_b16 v[118:119], v133 offset:9216
    s_add_u32 s26, s24, 0x3c0000
    s_add_u32 m0, s29, 0x1e000
    s_nop 0
    buffer_load_dwordx4 v136, s[16:19], s26 offen lds
    s_waitcnt lgkmcnt(12)
    v_mfma_f32_16x16x32_bf16 v[56:59], v[92:95], a[0:3], 0
    ds_read_b64_tr_b16 v[120:121], v134 offset:8192
    v_mfma_f32_16x16x32_bf16 v[60:63], v[92:95], a[64:67], 0
    ds_read_b64_tr_b16 v[122:123], v134 offset:9216
    s_add_u32 s26, s24, 0x3e0000
    s_add_u32 m0, s29, 0x1f000
    s_nop 0
    buffer_load_dwordx4 v136, s[16:19], s26 offen lds
    s_waitcnt lgkmcnt(12)
    v_mfma_f32_16x16x32_bf16 v[0:3], v[96:99], a[4:7], v[0:3]
    ds_read_b64_tr_b16 v[124:125], v135 offset:8192
    v_mfma_f32_16x16x32_bf16 v[4:7], v[96:99], a[68:71], v[4:7]
    ds_read_b64_tr_b16 v[126:127], v135 offset:9216
    s_waitcnt lgkmcnt(12)
    v_mfma_f32_16x16x32_bf16 v[8:11], v[100:103], a[4:7], v[8:11]
    ds_read_b64_tr_b16 v[64:65], v128 offset:16384
    v_mfma_f32_16x16x32_bf16 v[12:15], v[100:103], a[68:71], v[12:15]
    ds_read_b64_tr_b16 v[66:67], v128 offset:17408
    s_waitcnt lgkmcnt(12)
    v_mfma_f32_16x16x32_bf16 v[16:19], v[104:107], a[4:7], v[16:19]
    ds_read_b64_tr_b16 v[68:69], v129 offset:16384
    v_mfma_f32_16x16x32_bf16 v[20:23], v[104:107], a[68:71], v[20:23]
    ds_read_b64_tr_b16 v[70:71], v129 offset:17408
    s_waitcnt lgkmcnt(12)
    v_mfma_f32_16x16x32_bf16 v[24:27], v[108:111], a[4:7], v[24:27]
    ds_read_b64_tr_b16 v[72:73], v130 offset:16384
    v_mfma_f32_16x16x32_bf16 v[28:31], v[108:111], a[68:71], v[28:31]
    ds_read_b64_tr_b16 v[74:75], v130 offset:17408
    s_waitcnt lgkmcnt(12)
    v_mfma_f32_16x16x32_bf16 v[32:35], v[112:115], a[4:7], v[32:35]
    ds_read_b64_tr_b16 v[76:77], v131 offset:16384
    v_mfma_f32_16x16x32_bf16 v[36:39], v[112:115], a[68:71], v[36:39]
    ds_read_b64_tr_b16 v[78:79], v131 offset:17408
    s_waitcnt lgkmcnt(12)
    v_mfma_f32_16x16x32_bf16 v[40:43], v[116:119], a[4:7], v[40:43]
    ds_read_b64_tr_b16 v[80:81], v132 offset:16384
    v_mfma_f32_16x16x32_bf16 v[44:47], v[116:119], a[68:71], v[44:47]
    ds_read_b64_tr_b16 v[82:83], v132 offset:17408
    s_waitcnt lgkmcnt(12)
    v_mfma_f32_16x16x32_bf16 v[48:51], v[120:123], a[4:7], v[48:51]
    ds_read_b64_tr_b16 v[84:85], v133 offset:16384
    v_mfma_f32_16x16x32_bf16 v[52:55], v[120:123], a[68:71], v[52:55]
    ds_read_b64_tr_b16 v[86:87], v133 offset:17408
    s_waitcnt lgkmcnt(12)
    v_mfma_f32_16x16x32_bf16 v[56:59], v[124:127], a[4:7], v[56:59]
    ds_read_b64_tr_b16 v[88:89], v134 offset:16384
    v_mfma_f32_16x16x32_bf16 v[60:63], v[124:127], a[68:71], v[60:63]
    ds_read_b64_tr_b16 v[90:91], v134 offset:17408
    s_waitcnt lgkmcnt(12)
    v_mfma_f32_16x16x32_bf16 v[0:3], v[64:67], a[8:11], v[0:3]
    ds_read_b64_tr_b16 v[92:93], v135 offset:16384
    v_mfma_f32_16x16x32_bf16 v[4:7], v[64:67], a[72:75], v[4:7]
    ds_read_b64_tr_b16 v[94:95], v135 offset:17408
    s_waitcnt lgkmcnt(12)
    v_mfma_f32_16x16x32_bf16 v[8:11], v[68:71], a[8:11], v[8:11]
    ds_read_b64_tr_b16 v[96:97], v128 offset:24576
    v_mfma_f32_16x16x32_bf16 v[12:15], v[68:71], a[72:75], v[12:15]
    ds_read_b64_tr_b16 v[98:99], v128 offset:25600
    s_waitcnt lgkmcnt(12)
    v_mfma_f32_16x16x32_bf16 v[16:19], v[72:75], a[8:11], v[16:19]
    ds_read_b64_tr_b16 v[100:101], v129 offset:24576
    v_mfma_f32_16x16x32_bf16 v[20:23], v[72:75], a[72:75], v[20:23]
    ds_read_b64_tr_b16 v[102:103], v129 offset:25600
    s_waitcnt lgkmcnt(12)
    v_mfma_f32_16x16x32_bf16 v[24:27], v[76:79], a[8:11], v[24:27]
    ds_read_b64_tr_b16 v[104:105], v130 offset:24576
    v_mfma_f32_16x16x32_bf16 v[28:31], v[76:79], a[72:75], v[28:31]
    ds_read_b64_tr_b16 v[106:107], v130 offset:25600
    s_waitcnt lgkmcnt(12)
    v_mfma_f32_16x16x32_bf16 v[32:35], v[80:83], a[8:11], v[32:35]
    ds_read_b64_tr_b16 v[108:109], v131 offset:24576
    v_mfma_f32_16x16x32_bf16 v[36:39], v[80:83], a[72:75], v[36:39]
    ds_read_b64_tr_b16 v[110:111], v131 offset:25600
    s_waitcnt lgkmcnt(12)
    v_mfma_f32_16x16x32_bf16 v[40:43], v[84:87], a[8:11], v[40:43]
    ds_read_b64_tr_b16 v[112:113], v132 offset:24576
    v_mfma_f32_16x16x32_bf16 v[44:47], v[84:87], a[72:75], v[44:47]
    ds_read_b64_tr_b16 v[114:115], v132 offset:25600
    s_waitcnt lgkmcnt(12)
    v_mfma_f32_16x16x32_bf16 v[48:51], v[88:91], a[8:11], v[48:51]
    ds_read_b64_tr_b16 v[116:117], v133 offset:24576
    v_mfma_f32_16x16x32_bf16 v[52:55], v[88:91], a[72:75], v[52:55]
    ds_read_b64_tr_b16 v[118:119], v133 offset:25600
    s_waitcnt lgkmcnt(12)
    v_mfma_f32_16x16x32_bf16 v[56:59], v[92:95], a[8:11], v[56:59]
    ds_read_b64_tr_b16 v[120:121], v134 offset:24576
    v_mfma_f32_16x16x32_bf16 v[60:63], v[92:95], a[72:75], v[60:63]
    ds_read_b64_tr_b16 v[122:123], v134 offset:25600
    s_waitcnt lgkmcnt(12)
    v_mfma_f32_16x16x32_bf16 v[0:3], v[96:99], a[12:15], v[0:3]
    ds_read_b64_tr_b16 v[124:125], v135 offset:24576
    v_mfma_f32_16x16x32_bf16 v[4:7], v[96:99], a[76:79], v[4:7]
    ds_read_b64_tr_b16 v[126:127], v135 offset:25600
    s_waitcnt lgkmcnt(12)
    v_mfma_f32_16x16x32_bf16 v[8:11], v[100:103], a[12:15], v[8:11]
    v_mfma_f32_16x16x32_bf16 v[12:15], v[100:103], a[76:79], v[12:15]
    s_waitcnt lgkmcnt(10)
    v_mfma_f32_16x16x32_bf16 v[16:19], v[104:107], a[12:15], v[16:19]
    v_mfma_f32_16x16x32_bf16 v[20:23], v[104:107], a[76:79], v[20:23]
    s_waitcnt lgkmcnt(8)
    v_mfma_f32_16x16x32_bf16 v[24:27], v[108:111], a[12:15], v[24:27]
    v_mfma_f32_16x16x32_bf16 v[28:31], v[108:111], a[76:79], v[28:31]
    s_waitcnt lgkmcnt(6)
    v_mfma_f32_16x16x32_bf16 v[32:35], v[112:115], a[12:15], v[32:35]
    v_mfma_f32_16x16x32_bf16 v[36:39], v[112:115], a[76:79], v[36:39]
    s_waitcnt lgkmcnt(4)
    v_mfma_f32_16x16x32_bf16 v[40:43], v[116:119], a[12:15], v[40:43]
    v_mfma_f32_16x16x32_bf16 v[44:47], v[116:119], a[76:79], v[44:47]
    s_waitcnt lgkmcnt(2)
    v_mfma_f32_16x16x32_bf16 v[48:51], v[120:123], a[12:15], v[48:51]
    v_mfma_f32_16x16x32_bf16 v[52:55], v[120:123], a[76:79], v[52:55]
    s_waitcnt lgkmcnt(0)
    v_mfma_f32_16x16x32_bf16 v[56:59], v[124:127], a[12:15], v[56:59]
    v_mfma_f32_16x16x32_bf16 v[60:63], v[124:127], a[76:79], v[60:63]
    s_waitcnt vmcnt(16)
    s_barrier
    ds_read_b64_tr_b16 v[64:65], v128 offset:32768
    ds_read_b64_tr_b16 v[66:67], v128 offset:33792
    ds_read_b64_tr_b16 v[68:69], v129 offset:32768
    ds_read_b64_tr_b16 v[70:71], v129 offset:33792
    ds_read_b64_tr_b16 v[72:73], v130 offset:32768
    ds_read_b64_tr_b16 v[74:75], v130 offset:33792
    ds_read_b64_tr_b16 v[76:77], v131 offset:32768
    ds_read_b64_tr_b16 v[78:79], v131 offset:33792
    ds_read_b64_tr_b16 v[80:81], v132 offset:32768
    ds_read_b64_tr_b16 v[82:83], v132 offset:33792
    ds_read_b64_tr_b16 v[84:85], v133 offset:32768
    ds_read_b64_tr_b16 v[86:87], v133 offset:33792
    ds_read_b64_tr_b16 v[88:89], v134 offset:32768
    ds_read_b64_tr_b16 v[90:91], v134 offset:33792
    s_add_u32 s39, s39, s37
    s_lshr_b32 s26, s39, 5
    s_cmp_eq_u32 s26, 0
    s_cselect_b64 s[16:17], s[62:63], s[60:61]
    s_cmp_eq_u32 s26, 1
    s_cselect_b64 s[16:17], s[64:65], s[16:17]
    s_and_b32 s17, s17, 0xffff
    s_cmp_lt_u32 s39, 96
    s_cselect_b32 s18, 0x400000, 0
    s_and_b32 s24, s39, 31
    s_lshl_b32 s24, s24, 8
    s_waitcnt lgkmcnt(12)
    v_mfma_f32_16x16x32_bf16 v[0:3], v[64:67], a[16:19], v[0:3]
    ds_read_b64_tr_b16 v[92:93], v135 offset:32768
    v_mfma_f32_16x16x32_bf16 v[4:7], v[64:67], a[80:83], v[4:7]
    ds_read_b64_tr_b16 v[94:95], v135 offset:33792
    s_add_u32 s26, s24, 0x0
    s_add_u32 m0, s29, 0x0
    s_nop 0
    buffer_load_dwordx4 v136, s[16:19], s26 offen lds
    s_waitcnt lgkmcnt(12)
    v_mfma_f32_16x16x32_bf16 v[8:11], v[68:71], a[16:19], v[8:11]
    ds_read_b64_tr_b16 v[96:97], v128 offset:40960
    v_mfma_f32_16x16x32_bf16 v[12:15], v[68:71], a[80:83], v[12:15]
    ds_read_b64_tr_b16 v[98:99], v128 offset:41984
    s_add_u32 s26, s24, 0x20000
    s_add_u32 m0, s29, 0x1000
    s_nop 0
    buffer_load_dwordx4 v136, s[16:19], s26 offen lds
    s_waitcnt lgkmcnt(12)
    v_mfma_f32_16x16x32_bf16 v[16:19], v[72:75], a[16:19], v[16:19]
    ds_read_b64_tr_b16 v[100:101], v129 offset:40960
    v_mfma_f32_16x16x32_bf16 v[20:23], v[72:75], a[80:83], v[20:23]
    ds_read_b64_tr_b16 v[102:103], v129 offset:41984
    s_add_u32 s26, s24, 0x40000
    s_add_u32 m0, s29, 0x2000
    s_nop 0
    buffer_load_dwordx4 v136, s[16:19], s26 offen lds
    s_waitcnt lgkmcnt(12)
    v_mfma_f32_16x16x32_bf16 v[24:27], v[76:79], a[16:19], v[24:27]
    ds_read_b64_tr_b16 v[104:105], v130 offset:40960
    v_mfma_f32_16x16x32_bf16 v[28:31], v[76:79], a[80:83], v[28:31]
    ds_read_b64_tr_b16 v[106:107], v130 offset:41984
    s_add_u32 s26, s24, 0x60000
    s_add_u32 m0, s29, 0x3000
    s_nop 0
    buffer_load_dwordx4 v136, s[16:19], s26 offen lds
    s_waitcnt lgkmcnt(12)
    v_mfma_f32_16x16x32_bf16 v[32:35], v[80:83], a[16:19], v[32:35]
    ds_read_b64_tr_b16 v[108:109], v131 offset:40960
    v_mfma_f32_16x16x32_bf16 v[36:39], v[80:83], a[80:83], v[36:39]
    ds_read_b64_tr_b16 v[110:111], v131 offset:41984
    s_add_u32 s26, s24, 0x80000
    s_add_u32 m0, s29, 0x4000
    s_nop 0
    buffer_load_dwordx4 v136, s[16:19], s26 offen lds
    s_waitcnt lgkmcnt(12)
    v_mfma_f32_16x16x32_bf16 v[40:43], v[84:87], a[16:19], v[40:43]
    ds_read_b64_tr_b16 v[112:113], v132 offset:40960
    v_mfma_f32_16x16x32_bf16 v[44:47], v[84:87], a[80:83], v[44:47]
    ds_read_b64_tr_b16 v[114:115], v132 offset:41984
    s_add_u32 s26, s24, 0xa0000
    s_add_u32 m0, s29, 0x5000
    s_nop 0
    buffer_load_dwordx4 v136, s[16:19], s26 offen lds
    s_waitcnt lgkmcnt(12)
    v_mfma_f32_16x16x32_bf16 v[48:51], v[88:91], a[16:19], v[48:51]
    ds_read_b64_tr_b16 v[116:117], v133 offset:40960
    v_mfma_f32_16x16x32_bf16 v[52:55], v[88:91], a[80:83], v[52:55]
    ds_read_b64_tr_b16 v[118:119], v133 offset:41984
    s_add_u32 s26, s24, 0xc0000
    s_add_u32 m0, s29, 0x6000
    s_nop 0
    buffer_load_dwordx4 v136, s[16:19], s26 offen lds
    s_waitcnt lgkmcnt(12)
    v_mfma_f32_16x16x32_bf16 v[56:59], v[92:95], a[16:19], v[56:59]
    ds_read_b64_tr_b16 v[120:121], v134 offset:40960
    v_mfma_f32_16x16x32_bf16 v[60:63], v[92:95], a[80:83], v[60:63]
    ds_read_b64_tr_b16 v[122:123], v134 offset:41984
    s_add_u32 s26, s24, 0xe0000
    s_add_u32 m0, s29, 0x7000
    s_nop 0
    buffer_load_dwordx4 v136, s[16:19], s26 offen lds
    s_waitcnt lgkmcnt(12)
    v_mfma_f32_16x16x32_bf16 v[0:3], v[96:99], a[20:23], v[0:3]
    ds_read_b64_tr_b16 v[124:125], v135 offset:40960
    v_mfma_f32_16x16x32_bf16 v[4:7], v[96:99], a[84:87], v[4:7]
    ds_read_b64_tr_b16 v[126:127], v135 offset:41984
    s_waitcnt lgkmcnt(12)
    v_mfma_f32_16x16x32_bf16 v[8:11], v[100:103], a[20:23], v[8:11]
    ds_read_b64_tr_b16 v[64:65], v128 offset:49152
    v_mfma_f32_16x16x32_bf16 v[12:15], v[100:103], a[84:87], v[12:15]
    ds_read_b64_tr_b16 v[66:67], v128 offset:50176
    s_waitcnt lgkmcnt(12)
    v_mfma_f32_16x16x32_bf16 v[16:19], v[104:107], a[20:23], v[16:19]
    ds_read_b64_tr_b16 v[68:69], v129 offset:49152
    v_mfma_f32_16x16x32_bf16 v[20:23], v[104:107], a[84:87], v[20:23]
    ds_read_b64_tr_b16 v[70:71], v129 offset:50176
    s_waitcnt lgkmcnt(12)
    v_mfma_f32_16x16x32_bf16 v[24:27], v[108:111], a[20:23], v[24:27]
    ds_read_b64_tr_b16 v[72:73], v130 offset:49152
    v_mfma_f32_16x16x32_bf16 v[28:31], v[108:111], a[84:87], v[28:31]
    ds_read_b64_tr_b16 v[74:75], v130 offset:50176
    s_waitcnt lgkmcnt(12)
    v_mfma_f32_16x16x32_bf16 v[32:35], v[112:115], a[20:23], v[32:35]
    ds_read_b64_tr_b16 v[76:77], v131 offset:49152
    v_mfma_f32_16x16x32_bf16 v[36:39], v[112:115], a[84:87], v[36:39]
    ds_read_b64_tr_b16 v[78:79], v131 offset:50176
    s_waitcnt lgkmcnt(12)
    v_mfma_f32_16x16x32_bf16 v[40:43], v[116:119], a[20:23], v[40:43]
    ds_read_b64_tr_b16 v[80:81], v132 offset:49152
    v_mfma_f32_16x16x32_bf16 v[44:47], v[116:119], a[84:87], v[44:47]
    ds_read_b64_tr_b16 v[82:83], v132 offset:50176
    s_waitcnt lgkmcnt(12)
    v_mfma_f32_16x16x32_bf16 v[48:51], v[120:123], a[20:23], v[48:51]
    ds_read_b64_tr_b16 v[84:85], v133 offset:49152
    v_mfma_f32_16x16x32_bf16 v[52:55], v[120:123], a[84:87], v[52:55]
    ds_read_b64_tr_b16 v[86:87], v133 offset:50176
    s_waitcnt lgkmcnt(12)
    v_mfma_f32_16x16x32_bf16 v[56:59], v[124:127], a[20:23], v[56:59]
    ds_read_b64_tr_b16 v[88:89], v134 offset:49152
    v_mfma_f32_16x16x32_bf16 v[60:63], v[124:127], a[84:87], v[60:63]
    ds_read_b64_tr_b16 v[90:91], v134 offset:50176
    s_waitcnt lgkmcnt(12)
    v_mfma_f32_16x16x32_bf16 v[0:3], v[64:67], a[24:27], v[0:3]
    ds_read_b64_tr_b16 v[92:93], v135 offset:49152
    v_mfma_f32_16x16x32_bf16 v[4:7], v[64:67], a[88:91], v[4:7]
    ds_read_b64_tr_b16 v[94:95], v135 offset:50176
    s_waitcnt lgkmcnt(12)
    v_mfma_f32_16x16x32_bf16 v[8:11], v[68:71], a[24:27], v[8:11]
    ds_read_b64_tr_b16 v[96:97], v128 offset:57344
    v_mfma_f32_16x16x32_bf16 v[12:15], v[68:71], a[88:91], v[12:15]
    ds_read_b64_tr_b16 v[98:99], v128 offset:58368
    s_waitcnt lgkmcnt(12)
    v_mfma_f32_16x16x32_bf16 v[16:19], v[72:75], a[24:27], v[16:19]
    ds_read_b64_tr_b16 v[100:101], v129 offset:57344
    v_mfma_f32_16x16x32_bf16 v[20:23], v[72:75], a[88:91], v[20:23]
    ds_read_b64_tr_b16 v[102:103], v129 offset:58368
    s_waitcnt lgkmcnt(12)
    v_mfma_f32_16x16x32_bf16 v[24:27], v[76:79], a[24:27], v[24:27]
    ds_read_b64_tr_b16 v[104:105], v130 offset:57344
    v_mfma_f32_16x16x32_bf16 v[28:31], v[76:79], a[88:91], v[28:31]
    ds_read_b64_tr_b16 v[106:107], v130 offset:58368
    s_waitcnt lgkmcnt(12)
    v_mfma_f32_16x16x32_bf16 v[32:35], v[80:83], a[24:27], v[32:35]
    ds_read_b64_tr_b16 v[108:109], v131 offset:57344
    v_mfma_f32_16x16x32_bf16 v[36:39], v[80:83], a[88:91], v[36:39]
    ds_read_b64_tr_b16 v[110:111], v131 offset:58368
    s_waitcnt lgkmcnt(12)
    v_mfma_f32_16x16x32_bf16 v[40:43], v[84:87], a[24:27], v[40:43]
    ds_read_b64_tr_b16 v[112:113], v132 offset:57344
    v_mfma_f32_16x16x32_bf16 v[44:47], v[84:87], a[88:91], v[44:47]
    ds_read_b64_tr_b16 v[114:115], v132 offset:58368
    s_waitcnt lgkmcnt(12)
    v_mfma_f32_16x16x32_bf16 v[48:51], v[88:91], a[24:27], v[48:51]
    ds_read_b64_tr_b16 v[116:117], v133 offset:57344
    v_mfma_f32_16x16x32_bf16 v[52:55], v[88:91], a[88:91], v[52:55]
    ds_read_b64_tr_b16 v[118:119], v133 offset:58368
    s_waitcnt lgkmcnt(12)
    v_mfma_f32_16x16x32_bf16 v[56:59], v[92:95], a[24:27], v[56:59]
    ds_read_b64_tr_b16 v[120:121], v134 offset:57344
    v_mfma_f32_16x16x32_bf16 v[60:63], v[92:95], a[88:91], v[60:63]
    ds_read_b64_tr_b16 v[122:123], v134 offset:58368
    s_waitcnt lgkmcnt(12)
    v_mfma_f32_16x16x32_bf16 v[0:3], v[96:99], a[28:31], v[0:3]
    ds_read_b64_tr_b16 v[124:125], v135 offset:57344
    v_mfma_f32_16x16x32_bf16 v[4:7], v[96:99], a[92:95], v[4:7]
    ds_read_b64_tr_b16 v[126:127], v135 offset:58368
    s_waitcnt lgkmcnt(12)
    v_mfma_f32_16x16x32_bf16 v[8:11], v[100:103], a[28:31], v[8:11]
    v_mfma_f32_16x16x32_bf16 v[12:15], v[100:103], a[92:95], v[12:15]
    s_waitcnt lgkmcnt(10)
    v_mfma_f32_16x16x32_bf16 v[16:19], v[104:107], a[28:31], v[16:19]
    v_mfma_f32_16x16x32_bf16 v[20:23], v[104:107], a[92:95], v[20:23]
    s_waitcnt lgkmcnt(8)
    v_mfma_f32_16x16x32_bf16 v[24:27], v[108:111], a[28:31], v[24:27]
    v_mfma_f32_16x16x32_bf16 v[28:31], v[108:111], a[92:95], v[28:31]
    s_waitcnt lgkmcnt(6)
    v_mfma_f32_16x16x32_bf16 v[32:35], v[112:115], a[28:31], v[32:35]
    v_mfma_f32_16x16x32_bf16 v[36:39], v[112:115], a[92:95], v[36:39]
    s_waitcnt lgkmcnt(4)
    v_mfma_f32_16x16x32_bf16 v[40:43], v[116:119], a[28:31], v[40:43]
    v_mfma_f32_16x16x32_bf16 v[44:47], v[116:119], a[92:95], v[44:47]
    s_waitcnt lgkmcnt(2)
    v_mfma_f32_16x16x32_bf16 v[48:51], v[120:123], a[28:31], v[48:51]
    v_mfma_f32_16x16x32_bf16 v[52:55], v[120:123], a[92:95], v[52:55]
    s_waitcnt lgkmcnt(0)
    v_mfma_f32_16x16x32_bf16 v[56:59], v[124:127], a[28:31], v[56:59]
    v_mfma_f32_16x16x32_bf16 v[60:63], v[124:127], a[92:95], v[60:63]
    v_xor_b32 v128, 0x10000, v128
    v_xor_b32 v129, 0x10000, v129
    v_xor_b32 v130, 0x10000, v130
    v_xor_b32 v131, 0x10000, v131
    v_xor_b32 v132, 0x10000, v132
    v_xor_b32 v133, 0x10000, v133
    v_xor_b32 v134, 0x10000, v134
    v_xor_b32 v135, 0x10000, v135
    s_waitcnt vmcnt(16)
    s_barrier
    ds_read_b64_tr_b16 v[64:65], v128
    ds_read_b64_tr_b16 v[66:67], v128 offset:1024
    ds_read_b64_tr_b16 v[68:69], v129
    ds_read_b64_tr_b16 v[70:71], v129 offset:1024
    ds_read_b64_tr_b16 v[72:73], v130
    ds_read_b64_tr_b16 v[74:75], v130 offset:1024
    ds_read_b64_tr_b16 v[76:77], v131
    ds_read_b64_tr_b16 v[78:79], v131 offset:1024
    ds_read_b64_tr_b16 v[80:81], v132
    ds_read_b64_tr_b16 v[82:83], v132 offset:1024
    ds_read_b64_tr_b16 v[84:85], v133
    ds_read_b64_tr_b16 v[86:87], v133 offset:1024
    ds_read_b64_tr_b16 v[88:89], v134
    ds_read_b64_tr_b16 v[90:91], v134 offset:1024
    s_cmp_eq_u32 s40, 0
    s_cbranch_scc1 L_nopf_90
    s_cmp_lg_u32 s87, 0
    s_cbranch_scc1 L_modeok_91
    v_readfirstlane_b32 s96, v140
    v_readfirstlane_b32 s97, v141
    s_nop 0
    s_cmp_lg_u32 s97, 0
    s_cselect_b32 s87, s96, 0
    s_cmp_eq_u32 s87, 1
    s_cbranch_scc1 L_modeok_91
    s_mov_b32 s96, 0
L_mode_92:
    buffer_load_dwordx2 v[140:141], off, s[92:95], 0 offset:36 sc1
    s_waitcnt vmcnt(0)
    v_readfirstlane_b32 s87, v140
    v_readfirstlane_b32 s97, v141
    s_nop 0
    s_min_u32 s97, s97, s87
    s_cmp_lg_u32 s97, 0
    s_cbranch_scc1 L_moded_93
    s_sleep 4
    s_add_u32 s96, s96, 1
    s_cmp_lg_u32 s96, 0x100
    s_cbranch_scc1 L_modef_94
    v_mov_b32 v140, 2
    v_mov_b32 v141, 0
    s_mov_b64 exec, 1
    buffer_atomic_cmpswap v[140:141], off, s[92:95], 0 offset:36
    s_mov_b64 exec, -1
L_modef_94:
    s_cmp_lt_u32 s96, 0x10000
    s_cbranch_scc1 L_mode_92
L_moded_93:
    s_cmp_lg_u32 s87, 1
    s_cbranch_scc1 L_fallback
L_modeok_91:
    s_cmp_lg_u32 s100, 0
    s_cbranch_scc1 L_flag_95
    v_mov_b32 v138, 1
    s_mov_b64 exec, 1
    buffer_store_dword v138, off, s[8:11], s40 sc1
    s_mov_b64 exec, -1
L_flag_95:
    s_mov_b32 s40, 0
L_nopf_90:
    s_waitcnt lgkmcnt(12)
    v_mfma_f32_16x16x32_bf16 v[0:3], v[64:67], a[32:35], v[0:3]
    ds_read_b64_tr_b16 v[92:93], v135
    v_mfma_f32_16x16x32_bf16 v[4:7], v[64:67], a[96:99], v[4:7]
    ds_read_b64_tr_b16 v[94:95], v135 offset:1024
    s_add_u32 s26, s24, 0x100000
    s_add_u32 m0, s29, 0x8000
    s_nop 0
    buffer_load_dwordx4 v136, s[16:19], s26 offen lds
    s_waitcnt lgkmcnt(12)
    v_mfma_f32_16x16x32_bf16 v[8:11], v[68:71], a[32:35], v[8:11]
    ds_read_b64_tr_b16 v[96:97], v128 offset:8192
    v_mfma_f32_16x16x32_bf16 v[12:15], v[68:71], a[96:99], v[12:15]
    ds_read_b64_tr_b16 v[98:99], v128 offset:9216
    s_add_u32 s26, s24, 0x120000
    s_add_u32 m0, s29, 0x9000
    s_nop 0
    buffer_load_dwordx4 v136, s[16:19], s26 offen lds
    s_waitcnt lgkmcnt(12)
    v_mfma_f32_16x16x32_bf16 v[16:19], v[72:75], a[32:35], v[16:19]
    ds_read_b64_tr_b16 v[100:101], v129 offset:8192
    v_mfma_f32_16x16x32_bf16 v[20:23], v[72:75], a[96:99], v[20:23]
    ds_read_b64_tr_b16 v[102:103], v129 offset:9216
    s_add_u32 s26, s24, 0x140000
    s_add_u32 m0, s29, 0xa000
    s_nop 0
    buffer_load_dwordx4 v136, s[16:19], s26 offen lds
    s_waitcnt lgkmcnt(12)
    v_mfma_f32_16x16x32_bf16 v[24:27], v[76:79], a[32:35], v[24:27]
    ds_read_b64_tr_b16 v[104:105], v130 offset:8192
    v_mfma_f32_16x16x32_bf16 v[28:31], v[76:79], a[96:99], v[28:31]
    ds_read_b64_tr_b16 v[106:107], v130 offset:9216
    s_add_u32 s26, s24, 0x160000
    s_add_u32 m0, s29, 0xb000
    s_nop 0
    buffer_load_dwordx4 v136, s[16:19], s26 offen lds
    s_waitcnt lgkmcnt(12)
    v_mfma_f32_16x16x32_bf16 v[32:35], v[80:83], a[32:35], v[32:35]
    ds_read_b64_tr_b16 v[108:109], v131 offset:8192
    v_mfma_f32_16x16x32_bf16 v[36:39], v[80:83], a[96:99], v[36:39]
    ds_read_b64_tr_b16 v[110:111], v131 offset:9216
    s_add_u32 s26, s24, 0x180000
    s_add_u32 m0, s29, 0xc000
    s_nop 0
    buffer_load_dwordx4 v136, s[16:19], s26 offen lds
    s_waitcnt lgkmcnt(12)
    v_mfma_f32_16x16x32_bf16 v[40:43], v[84:87], a[32:35], v[40:43]
    ds_read_b64_tr_b16 v[112:113], v132 offset:8192
    v_mfma_f32_16x16x32_bf16 v[44:47], v[84:87], a[96:99], v[44:47]
    ds_read_b64_tr_b16 v[114:115], v132 offset:9216
    s_add_u32 s26, s24, 0x1a0000
    s_add_u32 m0, s29, 0xd000
    s_nop 0
    buffer_load_dwordx4 v136, s[16:19], s26 offen lds
    s_waitcnt lgkmcnt(12)
    v_mfma_f32_16x16x32_bf16 v[48:51], v[88:91], a[32:35], v[48:51]
    ds_read_b64_tr_b16 v[116:117], v133 offset:8192
    v_mfma_f32_16x16x32_bf16 v[52:55], v[88:91], a[96:99], v[52:55]
    ds_read_b64_tr_b16 v[118:119], v133 offset:9216
    s_add_u32 s26, s24, 0x1c0000
    s_add_u32 m0, s29, 0xe000
    s_nop 0
    buffer_load_dwordx4 v136, s[16:19], s26 offen lds
    s_waitcnt lgkmcnt(12)
    v_mfma_f32_16x16x32_bf16 v[56:59], v[92:95], a[32:35], v[56:59]
    ds_read_b64_tr_b16 v[120:121], v134 offset:8192
    v_mfma_f32_16x16x32_bf16 v[60:63], v[92:95], a[96:99], v[60:63]
    ds_read_b64_tr_b16 v[122:123], v134 offset:9216
    s_add_u32 s26, s24, 0x1e0000
    s_add_u32 m0, s29, 0xf000
    s_nop 0
    buffer_load_dwordx4 v136, s[16:19], s26 offen lds
    s_waitcnt lgkmcnt(12)
    v_mfma_f32_16x16x32_bf16 v[0:3], v[96:99], a[36:39], v[0:3]
    ds_read_b64_tr_b16 v[124:125], v135 offset:8192
    v_mfma_f32_16x16x32_bf16 v[4:7], v[96:99], a[100:103], v[4:7]
    ds_read_b64_tr_b16 v[126:127], v135 offset:9216
    s_waitcnt lgkmcnt(12)
    v_mfma_f32_16x16x32_bf16 v[8:11], v[100:103], a[36:39], v[8:11]
    ds_read_b64_tr_b16 v[64:65], v128 offset:16384
    v_mfma_f32_16x16x32_bf16 v[12:15], v[100:103], a[100:103], v[12:15]
    ds_read_b64_tr_b16 v[66:67], v128 offset:17408
    s_waitcnt lgkmcnt(12)
    v_mfma_f32_16x16x32_bf16 v[16:19], v[104:107], a[36:39], v[16:19]
    ds_read_b64_tr_b16 v[68:69], v129 offset:16384
    v_mfma_f32_16x16x32_bf16 v[20:23], v[104:107], a[100:103], v[20:23]
    ds_read_b64_tr_b16 v[70:71], v129 offset:17408
    s_waitcnt lgkmcnt(12)
    v_mfma_f32_16x16x32_bf16 v[24:27], v[108:111], a[36:39], v[24:27]
    ds_read_b64_tr_b16 v[72:73], v130 offset:16384
    v_mfma_f32_16x16x32_bf16 v[28:31], v[108:111], a[100:103], v[28:31]
    ds_read_b64_tr_b16 v[74:75], v130 offset:17408
    s_waitcnt lgkmcnt(12)
    v_mfma_f32_16x16x32_bf16 v[32:35], v[112:115], a[36:39], v[32:35]
    ds_read_b64_tr_b16 v[76:77], v131 offset:16384
    v_mfma_f32_16x16x32_bf16 v[36:39], v[112:115], a[100:103], v[36:39]
    ds_read_b64_tr_b16 v[78:79], v131 offset:17408
    s_waitcnt lgkmcnt(12)
    v_mfma_f32_16x16x32_bf16 v[40:43], v[116:119], a[36:39], v[40:43]
    ds_read_b64_tr_b16 v[80:81], v132 offset:16384
    v_mfma_f32_16x16x32_bf16 v[44:47], v[116:119], a[100:103], v[44:47]
    ds_read_b64_tr_b16 v[82:83], v132 offset:17408
    s_waitcnt lgkmcnt(12)
    v_mfma_f32_16x16x32_bf16 v[48:51], v[120:123], a[36:39], v[48:51]
    ds_read_b64_tr_b16 v[84:85], v133 offset:16384
    v_mfma_f32_16x16x32_bf16 v[52:55], v[120:123], a[100:103], v[52:55]
    ds_read_b64_tr_b16 v[86:87], v133 offset:17408
    s_waitcnt lgkmcnt(12)
    v_mfma_f32_16x16x32_bf16 v[56:59], v[124:127], a[36:39], v[56:59]
    ds_read_b64_tr_b16 v[88:89], v134 offset:16384
    v_mfma_f32_16x16x32_bf16 v[60:63], v[124:127], a[100:103], v[60:63]
    ds_read_b64_tr_b16 v[90:91], v134 offset:17408
    s_waitcnt lgkmcnt(12)
    v_mfma_f32_16x16x32_bf16 v[0:3], v[64:67], a[40:43], v[0:3]
    ds_read_b64_tr_b16 v[92:93], v135 offset:16384
    v_mfma_f32_16x16x32_bf16 v[4:7], v[64:67], a[104:107], v[4:7]
    ds_read_b64_tr_b16 v[94:95], v135 offset:17408
    s_waitcnt lgkmcnt(12)
    v_mfma_f32_16x16x32_bf16 v[8:11], v[68:71], a[40:43], v[8:11]
    ds_read_b64_tr_b16 v[96:97], v128 offset:24576
    v_mfma_f32_16x16x32_bf16 v[12:15], v[68:71], a[104:107], v[12:15]
    ds_read_b64_tr_b16 v[98:99], v128 offset:25600
    s_waitcnt lgkmcnt(12)
    v_mfma_f32_16x16x32_bf16 v[16:19], v[72:75], a[40:43], v[16:19]
    ds_read_b64_tr_b16 v[100:101], v129 offset:24576
    v_mfma_f32_16x16x32_bf16 v[20:23], v[72:75], a[104:107], v[20:23]
    ds_read_b64_tr_b16 v[102:103], v129 offset:25600
    s_waitcnt lgkmcnt(12)
    v_mfma_f32_16x16x32_bf16 v[24:27], v[76:79], a[40:43], v[24:27]
    ds_read_b64_tr_b16 v[104:105], v130 offset:24576
    v_mfma_f32_16x16x32_bf16 v[28:31], v[76:79], a[104:107], v[28:31]
    ds_read_b64_tr_b16 v[106:107], v130 offset:25600
    s_waitcnt lgkmcnt(12)
    v_mfma_f32_16x16x32_bf16 v[32:35], v[80:83], a[40:43], v[32:35]
    ds_read_b64_tr_b16 v[108:109], v131 offset:24576
    v_mfma_f32_16x16x32_bf16 v[36:39], v[80:83], a[104:107], v[36:39]
    ds_read_b64_tr_b16 v[110:111], v131 offset:25600
    s_waitcnt lgkmcnt(12)
    v_mfma_f32_16x16x32_bf16 v[40:43], v[84:87], a[40:43], v[40:43]
    ds_read_b64_tr_b16 v[112:113], v132 offset:24576
    v_mfma_f32_16x16x32_bf16 v[44:47], v[84:87], a[104:107], v[44:47]
    ds_read_b64_tr_b16 v[114:115], v132 offset:25600
    s_waitcnt lgkmcnt(12)
    v_mfma_f32_16x16x32_bf16 v[48:51], v[88:91], a[40:43], v[48:51]
    ds_read_b64_tr_b16 v[116:117], v133 offset:24576
    v_mfma_f32_16x16x32_bf16 v[52:55], v[88:91], a[104:107], v[52:55]
    ds_read_b64_tr_b16 v[118:119], v133 offset:25600
    s_waitcnt lgkmcnt(12)
    v_mfma_f32_16x16x32_bf16 v[56:59], v[92:95], a[40:43], v[56:59]
    ds_read_b64_tr_b16 v[120:121], v134 offset:24576
    v_mfma_f32_16x16x32_bf16 v[60:63], v[92:95], a[104:107], v[60:63]
    ds_read_b64_tr_b16 v[122:123], v134 offset:25600
    s_waitcnt lgkmcnt(12)
    v_mfma_f32_16x16x32_bf16 v[0:3], v[96:99], a[44:47], v[0:3]
    ds_read_b64_tr_b16 v[124:125], v135 offset:24576
    v_mfma_f32_16x16x32_bf16 v[4:7], v[96:99], a[108:111], v[4:7]
    ds_read_b64_tr_b16 v[126:127], v135 offset:25600
    s_waitcnt lgkmcnt(12)
    v_mfma_f32_16x16x32_bf16 v[8:11], v[100:103], a[44:47], v[8:11]
    v_mfma_f32_16x16x32_bf16 v[12:15], v[100:103], a[108:111], v[12:15]
    s_waitcnt lgkmcnt(10)
    v_mfma_f32_16x16x32_bf16 v[16:19], v[104:107], a[44:47], v[16:19]
    v_mfma_f32_16x16x32_bf16 v[20:23], v[104:107], a[108:111], v[20:23]
    s_waitcnt lgkmcnt(8)
    v_mfma_f32_16x16x32_bf16 v[24:27], v[108:111], a[44:47], v[24:27]
    v_mfma_f32_16x16x32_bf16 v[28:31], v[108:111], a[108:111], v[28:31]
    s_waitcnt lgkmcnt(6)
    v_mfma_f32_16x16x32_bf16 v[32:35], v[112:115], a[44:47], v[32:35]
    v_mfma_f32_16x16x32_bf16 v[36:39], v[112:115], a[108:111], v[36:39]
    s_waitcnt lgkmcnt(4)
    v_mfma_f32_16x16x32_bf16 v[40:43], v[116:119], a[44:47], v[40:43]
    v_mfma_f32_16x16x32_bf16 v[44:47], v[116:119], a[108:111], v[44:47]
    s_waitcnt lgkmcnt(2)
    v_mfma_f32_16x16x32_bf16 v[48:51], v[120:123], a[44:47], v[48:51]
    v_mfma_f32_16x16x32_bf16 v[52:55], v[120:123], a[108:111], v[52:55]
    s_waitcnt lgkmcnt(0)
    v_mfma_f32_16x16x32_bf16 v[56:59], v[124:127], a[44:47], v[56:59]
    v_mfma_f32_16x16x32_bf16 v[60:63], v[124:127], a[108:111], v[60:63]
    s_waitcnt vmcnt(16)
    s_barrier
    ds_read_b64_tr_b16 v[64:65], v128 offset:32768
    ds_read_b64_tr_b16 v[66:67], v128 offset:33792
    ds_read_b64_tr_b16 v[68:69], v129 offset:32768
    ds_read_b64_tr_b16 v[70:71], v129 offset:33792
    ds_read_b64_tr_b16 v[72:73], v130 offset:32768
    ds_read_b64_tr_b16 v[74:75], v130 offset:33792
    ds_read_b64_tr_b16 v[76:77], v131 offset:32768
    ds_read_b64_tr_b16 v[78:79], v131 offset:33792
    ds_read_b64_tr_b16 v[80:81], v132 offset:32768
    ds_read_b64_tr_b16 v[82:83], v132 offset:33792
    ds_read_b64_tr_b16 v[84:85], v133 offset:32768
    ds_read_b64_tr_b16 v[86:87], v133 offset:33792
    ds_read_b64_tr_b16 v[88:89], v134 offset:32768
    ds_read_b64_tr_b16 v[90:91], v134 offset:33792
    s_waitcnt lgkmcnt(12)
    v_mfma_f32_16x16x32_bf16 v[0:3], v[64:67], a[48:51], v[0:3]
    ds_read_b64_tr_b16 v[92:93], v135 offset:32768
    v_mfma_f32_16x16x32_bf16 v[4:7], v[64:67], a[112:115], v[4:7]
    ds_read_b64_tr_b16 v[94:95], v135 offset:33792
    s_add_u32 s26, s24, 0x200000
    s_add_u32 m0, s29, 0x10000
    s_nop 0
    buffer_load_dwordx4 v136, s[16:19], s26 offen lds
    s_waitcnt lgkmcnt(12)
    v_mfma_f32_16x16x32_bf16 v[8:11], v[68:71], a[48:51], v[8:11]
    ds_read_b64_tr_b16 v[96:97], v128 offset:40960
    v_mfma_f32_16x16x32_bf16 v[12:15], v[68:71], a[112:115], v[12:15]
    ds_read_b64_tr_b16 v[98:99], v128 offset:41984
    s_add_u32 s26, s24, 0x220000
    s_add_u32 m0, s29, 0x11000
    s_nop 0
    buffer_load_dwordx4 v136, s[16:19], s26 offen lds
    s_waitcnt lgkmcnt(12)
    v_mfma_f32_16x16x32_bf16 v[16:19], v[72:75], a[48:51], v[16:19]
    ds_read_b64_tr_b16 v[100:101], v129 offset:40960
    v_mfma_f32_16x16x32_bf16 v[20:23], v[72:75], a[112:115], v[20:23]
    ds_read_b64_tr_b16 v[102:103], v129 offset:41984
    s_add_u32 s26, s24, 0x240000
    s_add_u32 m0, s29, 0x12000
    s_nop 0
    buffer_load_dwordx4 v136, s[16:19], s26 offen lds
    s_waitcnt lgkmcnt(12)
    v_mfma_f32_16x16x32_bf16 v[24:27], v[76:79], a[48:51], v[24:27]
    ds_read_b64_tr_b16 v[104:105], v130 offset:40960
    v_mfma_f32_16x16x32_bf16 v[28:31], v[76:79], a[112:115], v[28:31]
    ds_read_b64_tr_b16 v[106:107], v130 offset:41984
    s_add_u32 s26, s24, 0x260000
    s_add_u32 m0, s29, 0x13000
    s_nop 0
    buffer_load_dwordx4 v136, s[16:19], s26 offen lds
    s_waitcnt lgkmcnt(12)
    v_mfma_f32_16x16x32_bf16 v[32:35], v[80:83], a[48:51], v[32:35]
    ds_read_b64_tr_b16 v[108:109], v131 offset:40960
    v_mfma_f32_16x16x32_bf16 v[36:39], v[80:83], a[112:115], v[36:39]
    ds_read_b64_tr_b16 v[110:111], v131 offset:41984
    s_add_u32 s26, s24, 0x280000
    s_add_u32 m0, s29, 0x14000
    s_nop 0
    buffer_load_dwordx4 v136, s[16:19], s26 offen lds
    s_waitcnt lgkmcnt(12)
    v_mfma_f32_16x16x32_bf16 v[40:43], v[84:87], a[48:51], v[40:43]
    ds_read_b64_tr_b16 v[112:113], v132 offset:40960
    v_mfma_f32_16x16x32_bf16 v[44:47], v[84:87], a[112:115], v[44:47]
    ds_read_b64_tr_b16 v[114:115], v132 offset:41984
    s_add_u32 s26, s24, 0x2a0000
    s_add_u32 m0, s29, 0x15000
    s_nop 0
    buffer_load_dwordx4 v136, s[16:19], s26 offen lds
    s_waitcnt lgkmcnt(12)
    v_mfma_f32_16x16x32_bf16 v[48:51], v[88:91], a[48:51], v[48:51]
    ds_read_b64_tr_b16 v[116:117], v133 offset:40960
    v_mfma_f32_16x16x32_bf16 v[52:55], v[88:91], a[112:115], v[52:55]
    ds_read_b64_tr_b16 v[118:119], v133 offset:41984
    s_add_u32 s26, s24, 0x2c0000
    s_add_u32 m0, s29, 0x16000
    s_nop 0
    buffer_load_dwordx4 v136, s[16:19], s26 offen lds
    s_waitcnt lgkmcnt(12)
    v_mfma_f32_16x16x32_bf16 v[56:59], v[92:95], a[48:51], v[56:59]
    ds_read_b64_tr_b16 v[120:121], v134 offset:40960
    v_mfma_f32_16x16x32_bf16 v[60:63], v[92:95], a[112:115], v[60:63]
    ds_read_b64_tr_b16 v[122:123], v134 offset:41984
    s_add_u32 s26, s24, 0x2e0000
    s_add_u32 m0, s29, 0x17000
    s_nop 0
    buffer_load_dwordx4 v136, s[16:19], s26 offen lds
    s_waitcnt lgkmcnt(12)
    v_mfma_f32_16x16x32_bf16 v[0:3], v[96:99], a[52:55], v[0:3]
    ds_read_b64_tr_b16 v[124:125], v135 offset:40960
    v_mfma_f32_16x16x32_bf16 v[4:7], v[96:99], a[116:119], v[4:7]
    ds_read_b64_tr_b16 v[126:127], v135 offset:41984
    s_waitcnt lgkmcnt(12)
    v_mfma_f32_16x16x32_bf16 v[8:11], v[100:103], a[52:55], v[8:11]
    ds_read_b64_tr_b16 v[64:65], v128 offset:49152
    v_mfma_f32_16x16x32_bf16 v[12:15], v[100:103], a[116:119], v[12:15]
    ds_read_b64_tr_b16 v[66:67], v128 offset:50176
    s_waitcnt lgkmcnt(12)
    v_mfma_f32_16x16x32_bf16 v[16:19], v[104:107], a[52:55], v[16:19]
    ds_read_b64_tr_b16 v[68:69], v129 offset:49152
    v_mfma_f32_16x16x32_bf16 v[20:23], v[104:107], a[116:119], v[20:23]
    ds_read_b64_tr_b16 v[70:71], v129 offset:50176
    s_waitcnt lgkmcnt(12)
    v_mfma_f32_16x16x32_bf16 v[24:27], v[108:111], a[52:55], v[24:27]
    ds_read_b64_tr_b16 v[72:73], v130 offset:49152
    v_mfma_f32_16x16x32_bf16 v[28:31], v[108:111], a[116:119], v[28:31]
    ds_read_b64_tr_b16 v[74:75], v130 offset:50176
    s_waitcnt lgkmcnt(12)
    v_mfma_f32_16x16x32_bf16 v[32:35], v[112:115], a[52:55], v[32:35]
    ds_read_b64_tr_b16 v[76:77], v131 offset:49152
    v_mfma_f32_16x16x32_bf16 v[36:39], v[112:115], a[116:119], v[36:39]
    ds_read_b64_tr_b16 v[78:79], v131 offset:50176
    s_waitcnt lgkmcnt(12)
    v_mfma_f32_16x16x32_bf16 v[40:43], v[116:119], a[52:55], v[40:43]
    ds_read_b64_tr_b16 v[80:81], v132 offset:49152
    v_mfma_f32_16x16x32_bf16 v[44:47], v[116:119], a[116:119], v[44:47]
    ds_read_b64_tr_b16 v[82:83], v132 offset:50176
    s_waitcnt lgkmcnt(12)
    v_mfma_f32_16x16x32_bf16 v[48:51], v[120:123], a[52:55], v[48:51]
    ds_read_b64_tr_b16 v[84:85], v133 offset:49152
    v_mfma_f32_16x16x32_bf16 v[52:55], v[120:123], a[116:119], v[52:55]
    ds_read_b64_tr_b16 v[86:87], v133 offset:50176
    s_waitcnt lgkmcnt(12)
    v_mfma_f32_16x16x32_bf16 v[56:59], v[124:127], a[52:55], v[56:59]
    ds_read_b64_tr_b16 v[88:89], v134 offset:49152
    v_mfma_f32_16x16x32_bf16 v[60:63], v[124:127], a[116:119], v[60:63]
    ds_read_b64_tr_b16 v[90:91], v134 offset:50176
    s_waitcnt lgkmcnt(12)
    v_mfma_f32_16x16x32_bf16 v[0:3], v[64:67], a[56:59], v[0:3]
    ds_read_b64_tr_b16 v[92:93], v135 offset:49152
    v_mfma_f32_16x16x32_bf16 v[4:7], v[64:67], a[120:123], v[4:7]
    ds_read_b64_tr_b16 v[94:95], v135 offset:50176
    s_waitcnt lgkmcnt(12)
    v_mfma_f32_16x16x32_bf16 v[8:11], v[68:71], a[56:59], v[8:11]
    ds_read_b64_tr_b16 v[96:97], v128 offset:57344
    v_mfma_f32_16x16x32_bf16 v[12:15], v[68:71], a[120:123], v[12:15]
    ds_read_b64_tr_b16 v[98:99], v128 offset:58368
    s_waitcnt lgkmcnt(12)
    v_mfma_f32_16x16x32_bf16 v[16:19], v[72:75], a[56:59], v[16:19]
    ds_read_b64_tr_b16 v[100:101], v129 offset:57344
    v_mfma_f32_16x16x32_bf16 v[20:23], v[72:75], a[120:123], v[20:23]
    ds_read_b64_tr_b16 v[102:103], v129 offset:58368
    s_waitcnt lgkmcnt(12)
    v_mfma_f32_16x16x32_bf16 v[24:27], v[76:79], a[56:59], v[24:27]
    ds_read_b64_tr_b16 v[104:105], v130 offset:57344
    v_mfma_f32_16x16x32_bf16 v[28:31], v[76:79], a[120:123], v[28:31]
    ds_read_b64_tr_b16 v[106:107], v130 offset:58368
    s_waitcnt lgkmcnt(12)
    v_mfma_f32_16x16x32_bf16 v[32:35], v[80:83], a[56:59], v[32:35]
    ds_read_b64_tr_b16 v[108:109], v131 offset:57344
    v_mfma_f32_16x16x32_bf16 v[36:39], v[80:83], a[120:123], v[36:39]
    ds_read_b64_tr_b16 v[110:111], v131 offset:58368
    s_waitcnt lgkmcnt(12)
    v_mfma_f32_16x16x32_bf16 v[40:43], v[84:87], a[56:59], v[40:43]
    ds_read_b64_tr_b16 v[112:113], v132 offset:57344
    v_mfma_f32_16x16x32_bf16 v[44:47], v[84:87], a[120:123], v[44:47]
    ds_read_b64_tr_b16 v[114:115], v132 offset:58368
    s_waitcnt lgkmcnt(12)
    v_mfma_f32_16x16x32_bf16 v[48:51], v[88:91], a[56:59], v[48:51]
    ds_read_b64_tr_b16 v[116:117], v133 offset:57344
    v_mfma_f32_16x16x32_bf16 v[52:55], v[88:91], a[120:123], v[52:55]
    ds_read_b64_tr_b16 v[118:119], v133 offset:58368
    s_waitcnt lgkmcnt(12)
    v_mfma_f32_16x16x32_bf16 v[56:59], v[92:95], a[56:59], v[56:59]
    ds_read_b64_tr_b16 v[120:121], v134 offset:57344
    v_mfma_f32_16x16x32_bf16 v[60:63], v[92:95], a[120:123], v[60:63]
    ds_read_b64_tr_b16 v[122:123], v134 offset:58368
    s_waitcnt lgkmcnt(12)
    v_mfma_f32_16x16x32_bf16 v[0:3], v[96:99], a[60:63], v[0:3]
    ds_read_b64_tr_b16 v[124:125], v135 offset:57344
    v_mfma_f32_16x16x32_bf16 v[4:7], v[96:99], a[124:127], v[4:7]
    ds_read_b64_tr_b16 v[126:127], v135 offset:58368
    s_waitcnt lgkmcnt(12)
    v_mfma_f32_16x16x32_bf16 v[8:11], v[100:103], a[60:63], v[8:11]
    v_mfma_f32_16x16x32_bf16 v[12:15], v[100:103], a[124:127], v[12:15]
    s_waitcnt lgkmcnt(10)
    v_mfma_f32_16x16x32_bf16 v[16:19], v[104:107], a[60:63], v[16:19]
    v_mfma_f32_16x16x32_bf16 v[20:23], v[104:107], a[124:127], v[20:23]
    s_waitcnt lgkmcnt(8)
    v_mfma_f32_16x16x32_bf16 v[24:27], v[108:111], a[60:63], v[24:27]
    v_mfma_f32_16x16x32_bf16 v[28:31], v[108:111], a[124:127], v[28:31]
    s_waitcnt lgkmcnt(6)
    v_mfma_f32_16x16x32_bf16 v[32:35], v[112:115], a[60:63], v[32:35]
    v_mfma_f32_16x16x32_bf16 v[36:39], v[112:115], a[124:127], v[36:39]
    s_waitcnt lgkmcnt(4)
    v_mfma_f32_16x16x32_bf16 v[40:43], v[116:119], a[60:63], v[40:43]
    v_mfma_f32_16x16x32_bf16 v[44:47], v[116:119], a[124:127], v[44:47]
    s_waitcnt lgkmcnt(2)
    v_mfma_f32_16x16x32_bf16 v[48:51], v[120:123], a[60:63], v[48:51]
    v_mfma_f32_16x16x32_bf16 v[52:55], v[120:123], a[124:127], v[52:55]
    s_waitcnt lgkmcnt(0)
    v_mfma_f32_16x16x32_bf16 v[56:59], v[124:127], a[60:63], v[56:59]
    v_mfma_f32_16x16x32_bf16 v[60:63], v[124:127], a[124:127], v[60:63]
    v_xor_b32 v128, 0x10000, v128
    v_xor_b32 v129, 0x10000, v129
    v_xor_b32 v130, 0x10000, v130
    v_xor_b32 v131, 0x10000, v131
    v_xor_b32 v132, 0x10000, v132
    v_xor_b32 v133, 0x10000, v133
    v_xor_b32 v134, 0x10000, v134
    v_xor_b32 v135, 0x10000, v135
    v_cvt_pk_bf16_f32 v144, v0, v8
    v_cvt_pk_bf16_f32 v145, v1, v9
    v_cvt_pk_bf16_f32 v146, v2, v10
    v_cvt_pk_bf16_f32 v147, v3, v11
    buffer_store_dwordx4 v[144:147], v137, s[8:11], s25 offen sc1
    v_cvt_pk_bf16_f32 v148, v16, v24
    v_cvt_pk_bf16_f32 v149, v17, v25
    v_cvt_pk_bf16_f32 v150, v18, v26
    v_cvt_pk_bf16_f32 v151, v19, v27
    buffer_store_dwordx4 v[148:151], v137, s[8:11], s25 offen offset:1024 sc1
    v_cvt_pk_bf16_f32 v152, v32, v40
    v_cvt_pk_bf16_f32 v153, v33, v41
    v_cvt_pk_bf16_f32 v154, v34, v42
    v_cvt_pk_bf16_f32 v155, v35, v43
    buffer_store_dwordx4 v[152:155], v137, s[8:11], s25 offen offset:2048 sc1
    v_cvt_pk_bf16_f32 v156, v48, v56
    v_cvt_pk_bf16_f32 v157, v49, v57
    v_cvt_pk_bf16_f32 v158, v50, v58
    v_cvt_pk_bf16_f32 v159, v51, v59
    buffer_store_dwordx4 v[156:159], v137, s[8:11], s25 offen offset:3072 sc1
    v_cvt_pk_bf16_f32 v144, v4, v12
    v_cvt_pk_bf16_f32 v145, v5, v13
    v_cvt_pk_bf16_f32 v146, v6, v14
    v_cvt_pk_bf16_f32 v147, v7, v15
    s_add_u32 s25, s25, 4096
    buffer_store_dwordx4 v[144:147], v137, s[8:11], s25 offen sc1
    v_cvt_pk_bf16_f32 v148, v20, v28
    v_cvt_pk_bf16_f32 v149, v21, v29
    v_cvt_pk_bf16_f32 v150, v22, v30
    v_cvt_pk_bf16_f32 v151, v23, v31
    buffer_store_dwordx4 v[148:151], v137, s[8:11], s25 offen offset:1024 sc1
    v_cvt_pk_bf16_f32 v152, v36, v44
    v_cvt_pk_bf16_f32 v153, v37, v45
    v_cvt_pk_bf16_f32 v154, v38, v46
    v_cvt_pk_bf16_f32 v155, v39, v47
    buffer_store_dwordx4 v[152:155], v137, s[8:11], s25 offen offset:2048 sc1
    v_cvt_pk_bf16_f32 v156, v52, v60
    v_cvt_pk_bf16_f32 v157, v53, v61
    v_cvt_pk_bf16_f32 v158, v54, v62
    v_cvt_pk_bf16_f32 v159, v55, v63
    buffer_store_dwordx4 v[156:159], v137, s[8:11], s25 offen offset:3072 sc1
    s_branch L_p1_next
L_p1_v:
    s_waitcnt vmcnt(16)
    s_barrier
    ds_read_b64_tr_b16 v[64:65], v128
    ds_read_b64_tr_b16 v[66:67], v128 offset:1024
    ds_read_b64_tr_b16 v[68:69], v129
    ds_read_b64_tr_b16 v[70:71], v129 offset:1024
    ds_read_b64_tr_b16 v[72:73], v130
    ds_read_b64_tr_b16 v[74:75], v130 offset:1024
    ds_read_b64_tr_b16 v[76:77], v131
    ds_read_b64_tr_b16 v[78:79], v131 offset:1024
    ds_read_b64_tr_b16 v[80:81], v132
    ds_read_b64_tr_b16 v[82:83], v132 offset:1024
    ds_read_b64_tr_b16 v[84:85], v133
    ds_read_b64_tr_b16 v[86:87], v133 offset:1024
    ds_read_b64_tr_b16 v[88:89], v134
    ds_read_b64_tr_b16 v[90:91], v134 offset:1024
    s_waitcnt lgkmcnt(12)
    v_mfma_f32_16x16x32_bf16 v[0:3], a[0:3], v[64:67], 0
    ds_read_b64_tr_b16 v[92:93], v135
    v_mfma_f32_16x16x32_bf16 v[4:7], a[64:67], v[64:67], 0
    ds_read_b64_tr_b16 v[94:95], v135 offset:1024
    s_add_u32 s26, s24, 0x300000
    s_add_u32 m0, s29, 0x18000
    s_nop 0
    buffer_load_dwordx4 v136, s[16:19], s26 offen lds
    s_waitcnt lgkmcnt(12)
    v_mfma_f32_16x16x32_bf16 v[8:11], a[0:3], v[68:71], 0
    ds_read_b64_tr_b16 v[96:97], v128 offset:8192
    v_mfma_f32_16x16x32_bf16 v[12:15], a[64:67], v[68:71], 0
    ds_read_b64_tr_b16 v[98:99], v128 offset:9216
    s_add_u32 s26, s24, 0x320000
    s_add_u32 m0, s29, 0x19000
    s_nop 0
    buffer_load_dwordx4 v136, s[16:19], s26 offen lds
    s_waitcnt lgkmcnt(12)
    v_mfma_f32_16x16x32_bf16 v[16:19], a[0:3], v[72:75], 0
    ds_read_b64_tr_b16 v[100:101], v129 offset:8192
    v_mfma_f32_16x16x32_bf16 v[20:23], a[64:67], v[72:75], 0
    ds_read_b64_tr_b16 v[102:103], v129 offset:9216
    s_add_u32 s26, s24, 0x340000
    s_add_u32 m0, s29, 0x1a000
    s_nop 0
    buffer_load_dwordx4 v136, s[16:19], s26 offen lds
    s_waitcnt lgkmcnt(12)
    v_mfma_f32_16x16x32_bf16 v[24:27], a[0:3], v[76:79], 0
    ds_read_b64_tr_b16 v[104:105], v130 offset:8192
    v_mfma_f32_16x16x32_bf16 v[28:31], a[64:67], v[76:79], 0
    ds_read_b64_tr_b16 v[106:107], v130 offset:9216
    s_add_u32 s26, s24, 0x360000
    s_add_u32 m0, s29, 0x1b000
    s_nop 0
    buffer_load_dwordx4 v136, s[16:19], s26 offen lds
    s_waitcnt lgkmcnt(12)
    v_mfma_f32_16x16x32_bf16 v[32:35], a[0:3], v[80:83], 0
    ds_read_b64_tr_b16 v[108:109], v131 offset:8192
    v_mfma_f32_16x16x32_bf16 v[36:39], a[64:67], v[80:83], 0
    ds_read_b64_tr_b16 v[110:111], v131 offset:9216
    s_add_u32 s26, s24, 0x380000
    s_add_u32 m0, s29, 0x1c000
    s_nop 0
    buffer_load_dwordx4 v136, s[16:19], s26 offen lds
    s_waitcnt lgkmcnt(12)
    v_mfma_f32_16x16x32_bf16 v[40:43], a[0:3], v[84:87], 0
    ds_read_b64_tr_b16 v[112:113], v132 offset:8192
    v_mfma_f32_16x16x32_bf16 v[44:47], a[64:67], v[84:87], 0
    ds_read_b64_tr_b16 v[114:115], v132 offset:9216
    s_add_u32 s26, s24, 0x3a0000
    s_add_u32 m0, s29, 0x1d000
    s_nop 0
    buffer_load_dwordx4 v136, s[16:19], s26 offen lds
    s_waitcnt lgkmcnt(12)
    v_mfma_f32_16x16x32_bf16 v[48:51], a[0:3], v[88:91], 0
    ds_read_b64_tr_b16 v[116:117], v133 offset:8192
    v_mfma_f32_16x16x32_bf16 v[52:55], a[64:67], v[88:91], 0
    ds_read_b64_tr_b16 v[118:119], v133 offset:9216
    s_add_u32 s26, s24, 0x3c0000
    s_add_u32 m0, s29, 0x1e000
    s_nop 0
    buffer_load_dwordx4 v136, s[16:19], s26 offen lds
    s_waitcnt lgkmcnt(12)
    v_mfma_f32_16x16x32_bf16 v[56:59], a[0:3], v[92:95], 0
    ds_read_b64_tr_b16 v[120:121], v134 offset:8192
    v_mfma_f32_16x16x32_bf16 v[60:63], a[64:67], v[92:95], 0
    ds_read_b64_tr_b16 v[122:123], v134 offset:9216
    s_add_u32 s26, s24, 0x3e0000
    s_add_u32 m0, s29, 0x1f000
    s_nop 0
    buffer_load_dwordx4 v136, s[16:19], s26 offen lds
    s_waitcnt lgkmcnt(12)
    v_mfma_f32_16x16x32_bf16 v[0:3], a[4:7], v[96:99], v[0:3]
    ds_read_b64_tr_b16 v[124:125], v135 offset:8192
    v_mfma_f32_16x16x32_bf16 v[4:7], a[68:71], v[96:99], v[4:7]
    ds_read_b64_tr_b16 v[126:127], v135 offset:9216
    s_waitcnt lgkmcnt(12)
    v_mfma_f32_16x16x32_bf16 v[8:11], a[4:7], v[100:103], v[8:11]
    ds_read_b64_tr_b16 v[64:65], v128 offset:16384
    v_mfma_f32_16x16x32_bf16 v[12:15], a[68:71], v[100:103], v[12:15]
    ds_read_b64_tr_b16 v[66:67], v128 offset:17408
    s_waitcnt lgkmcnt(12)
    v_mfma_f32_16x16x32_bf16 v[16:19], a[4:7], v[104:107], v[16:19]
    ds_read_b64_tr_b16 v[68:69], v129 offset:16384
    v_mfma_f32_16x16x32_bf16 v[20:23], a[68:71], v[104:107], v[20:23]
    ds_read_b64_tr_b16 v[70:71], v129 offset:17408
    s_waitcnt lgkmcnt(12)
    v_mfma_f32_16x16x32_bf16 v[24:27], a[4:7], v[108:111], v[24:27]
    ds_read_b64_tr_b16 v[72:73], v130 offset:16384
    v_mfma_f32_16x16x32_bf16 v[28:31], a[68:71], v[108:111], v[28:31]
    ds_read_b64_tr_b16 v[74:75], v130 offset:17408
    s_waitcnt lgkmcnt(12)
    v_mfma_f32_16x16x32_bf16 v[32:35], a[4:7], v[112:115], v[32:35]
    ds_read_b64_tr_b16 v[76:77], v131 offset:16384
    v_mfma_f32_16x16x32_bf16 v[36:39], a[68:71], v[112:115], v[36:39]
    ds_read_b64_tr_b16 v[78:79], v131 offset:17408
    s_waitcnt lgkmcnt(12)
    v_mfma_f32_16x16x32_bf16 v[40:43], a[4:7], v[116:119], v[40:43]
    ds_read_b64_tr_b16 v[80:81], v132 offset:16384
    v_mfma_f32_16x16x32_bf16 v[44:47], a[68:71], v[116:119], v[44:47]
    ds_read_b64_tr_b16 v[82:83], v132 offset:17408
    s_waitcnt lgkmcnt(12)
    v_mfma_f32_16x16x32_bf16 v[48:51], a[4:7], v[120:123], v[48:51]
    ds_read_b64_tr_b16 v[84:85], v133 offset:16384
    v_mfma_f32_16x16x32_bf16 v[52:55], a[68:71], v[120:123], v[52:55]
    ds_read_b64_tr_b16 v[86:87], v133 offset:17408
    s_waitcnt lgkmcnt(12)
    v_mfma_f32_16x16x32_bf16 v[56:59], a[4:7], v[124:127], v[56:59]
    ds_read_b64_tr_b16 v[88:89], v134 offset:16384
    v_mfma_f32_16x16x32_bf16 v[60:63], a[68:71], v[124:127], v[60:63]
    ds_read_b64_tr_b16 v[90:91], v134 offset:17408
    s_waitcnt lgkmcnt(12)
    v_mfma_f32_16x16x32_bf16 v[0:3], a[8:11], v[64:67], v[0:3]
    ds_read_b64_tr_b16 v[92:93], v135 offset:16384
    v_mfma_f32_16x16x32_bf16 v[4:7], a[72:75], v[64:67], v[4:7]
    ds_read_b64_tr_b16 v[94:95], v135 offset:17408
    s_waitcnt lgkmcnt(12)
    v_mfma_f32_16x16x32_bf16 v[8:11], a[8:11], v[68:71], v[8:11]
    ds_read_b64_tr_b16 v[96:97], v128 offset:24576
    v_mfma_f32_16x16x32_bf16 v[12:15], a[72:75], v[68:71], v[12:15]
    ds_read_b64_tr_b16 v[98:99], v128 offset:25600
    s_waitcnt lgkmcnt(12)
    v_mfma_f32_16x16x32_bf16 v[16:19], a[8:11], v[72:75], v[16:19]
    ds_read_b64_tr_b16 v[100:101], v129 offset:24576
    v_mfma_f32_16x16x32_bf16 v[20:23], a[72:75], v[72:75], v[20:23]
    ds_read_b64_tr_b16 v[102:103], v129 offset:25600
    s_waitcnt lgkmcnt(12)
    v_mfma_f32_16x16x32_bf16 v[24:27], a[8:11], v[76:79], v[24:27]
    ds_read_b64_tr_b16 v[104:105], v130 offset:24576
    v_mfma_f32_16x16x32_bf16 v[28:31], a[72:75], v[76:79], v[28:31]
    ds_read_b64_tr_b16 v[106:107], v130 offset:25600
    s_waitcnt lgkmcnt(12)
    v_mfma_f32_16x16x32_bf16 v[32:35], a[8:11], v[80:83], v[32:35]
    ds_read_b64_tr_b16 v[108:109], v131 offset:24576
    v_mfma_f32_16x16x32_bf16 v[36:39], a[72:75], v[80:83], v[36:39]
    ds_read_b64_tr_b16 v[110:111], v131 offset:25600
    s_waitcnt lgkmcnt(12)
    v_mfma_f32_16x16x32_bf16 v[40:43], a[8:11], v[84:87], v[40:43]
    ds_read_b64_tr_b16 v[112:113], v132 offset:24576
    v_mfma_f32_16x16x32_bf16 v[44:47], a[72:75], v[84:87], v[44:47]
    ds_read_b64_tr_b16 v[114:115], v132 offset:25600
    s_waitcnt lgkmcnt(12)
    v_mfma_f32_16x16x32_bf16 v[48:51], a[8:11], v[88:91], v[48:51]
    ds_read_b64_tr_b16 v[116:117], v133 offset:24576
    v_mfma_f32_16x16x32_bf16 v[52:55], a[72:75], v[88:91], v[52:55]
    ds_read_b64_tr_b16 v[118:119], v133 offset:25600
    s_waitcnt lgkmcnt(12)
    v_mfma_f32_16x16x32_bf16 v[56:59], a[8:11], v[92:95], v[56:59]
    ds_read_b64_tr_b16 v[120:121], v134 offset:24576
    v_mfma_f32_16x16x32_bf16 v[60:63], a[72:75], v[92:95], v[60:63]
    ds_read_b64_tr_b16 v[122:123], v134 offset:25600
    s_waitcnt lgkmcnt(12)
    v_mfma_f32_16x16x32_bf16 v[0:3], a[12:15], v[96:99], v[0:3]
    ds_read_b64_tr_b16 v[124:125], v135 offset:24576
    v_mfma_f32_16x16x32_bf16 v[4:7], a[76:79], v[96:99], v[4:7]
    ds_read_b64_tr_b16 v[126:127], v135 offset:25600
    s_waitcnt lgkmcnt(12)
    v_mfma_f32_16x16x32_bf16 v[8:11], a[12:15], v[100:103], v[8:11]
    v_mfma_f32_16x16x32_bf16 v[12:15], a[76:79], v[100:103], v[12:15]
    s_waitcnt lgkmcnt(10)
    v_mfma_f32_16x16x32_bf16 v[16:19], a[12:15], v[104:107], v[16:19]
    v_mfma_f32_16x16x32_bf16 v[20:23], a[76:79], v[104:107], v[20:23]
    s_waitcnt lgkmcnt(8)
    v_mfma_f32_16x16x32_bf16 v[24:27], a[12:15], v[108:111], v[24:27]
    v_mfma_f32_16x16x32_bf16 v[28:31], a[76:79], v[108:111], v[28:31]
    s_waitcnt lgkmcnt(6)
    v_mfma_f32_16x16x32_bf16 v[32:35], a[12:15], v[112:115], v[32:35]
    v_mfma_f32_16x16x32_bf16 v[36:39], a[76:79], v[112:115], v[36:39]
    s_waitcnt lgkmcnt(4)
    v_mfma_f32_16x16x32_bf16 v[40:43], a[12:15], v[116:119], v[40:43]
    v_mfma_f32_16x16x32_bf16 v[44:47], a[76:79], v[116:119], v[44:47]
    s_waitcnt lgkmcnt(2)
    v_mfma_f32_16x16x32_bf16 v[48:51], a[12:15], v[120:123], v[48:51]
    v_mfma_f32_16x16x32_bf16 v[52:55], a[76:79], v[120:123], v[52:55]
    s_waitcnt lgkmcnt(0)
    v_mfma_f32_16x16x32_bf16 v[56:59], a[12:15], v[124:127], v[56:59]
    v_mfma_f32_16x16x32_bf16 v[60:63], a[76:79], v[124:127], v[60:63]
    s_waitcnt vmcnt(16)
    s_barrier
    ds_read_b64_tr_b16 v[64:65], v128 offset:32768
    ds_read_b64_tr_b16 v[66:67], v128 offset:33792
    ds_read_b64_tr_b16 v[68:69], v129 offset:32768
    ds_read_b64_tr_b16 v[70:71], v129 offset:33792
    ds_read_b64_tr_b16 v[72:73], v130 offset:32768
    ds_read_b64_tr_b16 v[74:75], v130 offset:33792
    ds_read_b64_tr_b16 v[76:77], v131 offset:32768
    ds_read_b64_tr_b16 v[78:79], v131 offset:33792
    ds_read_b64_tr_b16 v[80:81], v132 offset:32768
    ds_read_b64_tr_b16 v[82:83], v132 offset:33792
    ds_read_b64_tr_b16 v[84:85], v133 offset:32768
    ds_read_b64_tr_b16 v[86:87], v133 offset:33792
    ds_read_b64_tr_b16 v[88:89], v134 offset:32768
    ds_read_b64_tr_b16 v[90:91], v134 offset:33792
    s_add_u32 s39, s39, s37
    s_lshr_b32 s26, s39, 5
    s_cmp_eq_u32 s26, 0
    s_cselect_b64 s[16:17], s[62:63], s[60:61]
    s_cmp_eq_u32 s26, 1
    s_cselect_b64 s[16:17], s[64:65], s[16:17]
    s_and_b32 s17, s17, 0xffff
    s_cmp_lt_u32 s39, 96
    s_cselect_b32 s18, 0x400000, 0
    s_and_b32 s24, s39, 31
    s_lshl_b32 s24, s24, 8
    s_waitcnt lgkmcnt(12)
    v_mfma_f32_16x16x32_bf16 v[0:3], a[16:19], v[64:67], v[0:3]
    ds_read_b64_tr_b16 v[92:93], v135 offset:32768
    v_mfma_f32_16x16x32_bf16 v[4:7], a[80:83], v[64:67], v[4:7]
    ds_read_b64_tr_b16 v[94:95], v135 offset:33792
    s_add_u32 s26, s24, 0x0
    s_add_u32 m0, s29, 0x0
    s_nop 0
    buffer_load_dwordx4 v136, s[16:19], s26 offen lds
    s_waitcnt lgkmcnt(12)
    v_mfma_f32_16x16x32_bf16 v[8:11], a[16:19], v[68:71], v[8:11]
    ds_read_b64_tr_b16 v[96:97], v128 offset:40960
    v_mfma_f32_16x16x32_bf16 v[12:15], a[80:83], v[68:71], v[12:15]
    ds_read_b64_tr_b16 v[98:99], v128 offset:41984
    s_add_u32 s26, s24, 0x20000
    s_add_u32 m0, s29, 0x1000
    s_nop 0
    buffer_load_dwordx4 v136, s[16:19], s26 offen lds
    s_waitcnt lgkmcnt(12)
    v_mfma_f32_16x16x32_bf16 v[16:19], a[16:19], v[72:75], v[16:19]
    ds_read_b64_tr_b16 v[100:101], v129 offset:40960
    v_mfma_f32_16x16x32_bf16 v[20:23], a[80:83], v[72:75], v[20:23]
    ds_read_b64_tr_b16 v[102:103], v129 offset:41984
    s_add_u32 s26, s24, 0x40000
    s_add_u32 m0, s29, 0x2000
    s_nop 0
    buffer_load_dwordx4 v136, s[16:19], s26 offen lds
    s_waitcnt lgkmcnt(12)
    v_mfma_f32_16x16x32_bf16 v[24:27], a[16:19], v[76:79], v[24:27]
    ds_read_b64_tr_b16 v[104:105], v130 offset:40960
    v_mfma_f32_16x16x32_bf16 v[28:31], a[80:83], v[76:79], v[28:31]
    ds_read_b64_tr_b16 v[106:107], v130 offset:41984
    s_add_u32 s26, s24, 0x60000
    s_add_u32 m0, s29, 0x3000
    s_nop 0
    buffer_load_dwordx4 v136, s[16:19], s26 offen lds
    s_waitcnt lgkmcnt(12)
    v_mfma_f32_16x16x32_bf16 v[32:35], a[16:19], v[80:83], v[32:35]
    ds_read_b64_tr_b16 v[108:109], v131 offset:40960
    v_mfma_f32_16x16x32_bf16 v[36:39], a[80:83], v[80:83], v[36:39]
    ds_read_b64_tr_b16 v[110:111], v131 offset:41984
    s_add_u32 s26, s24, 0x80000
    s_add_u32 m0, s29, 0x4000
    s_nop 0
    buffer_load_dwordx4 v136, s[16:19], s26 offen lds
    s_waitcnt lgkmcnt(12)
    v_mfma_f32_16x16x32_bf16 v[40:43], a[16:19], v[84:87], v[40:43]
    ds_read_b64_tr_b16 v[112:113], v132 offset:40960
    v_mfma_f32_16x16x32_bf16 v[44:47], a[80:83], v[84:87], v[44:47]
    ds_read_b64_tr_b16 v[114:115], v132 offset:41984
    s_add_u32 s26, s24, 0xa0000
    s_add_u32 m0, s29, 0x5000
    s_nop 0
    buffer_load_dwordx4 v136, s[16:19], s26 offen lds
    s_waitcnt lgkmcnt(12)
    v_mfma_f32_16x16x32_bf16 v[48:51], a[16:19], v[88:91], v[48:51]
    ds_read_b64_tr_b16 v[116:117], v133 offset:40960
    v_mfma_f32_16x16x32_bf16 v[52:55], a[80:83], v[88:91], v[52:55]
    ds_read_b64_tr_b16 v[118:119], v133 offset:41984
    s_add_u32 s26, s24, 0xc0000
    s_add_u32 m0, s29, 0x6000
    s_nop 0
    buffer_load_dwordx4 v136, s[16:19], s26 offen lds
    s_waitcnt lgkmcnt(12)
    v_mfma_f32_16x16x32_bf16 v[56:59], a[16:19], v[92:95], v[56:59]
    ds_read_b64_tr_b16 v[120:121], v134 offset:40960
    v_mfma_f32_16x16x32_bf16 v[60:63], a[80:83], v[92:95], v[60:63]
    ds_read_b64_tr_b16 v[122:123], v134 offset:41984
    s_add_u32 s26, s24, 0xe0000
    s_add_u32 m0, s29, 0x7000
    s_nop 0
    buffer_load_dwordx4 v136, s[16:19], s26 offen lds
    s_waitcnt lgkmcnt(12)
    v_mfma_f32_16x16x32_bf16 v[0:3], a[20:23], v[96:99], v[0:3]
    ds_read_b64_tr_b16 v[124:125], v135 offset:40960
    v_mfma_f32_16x16x32_bf16 v[4:7], a[84:87], v[96:99], v[4:7]
    ds_read_b64_tr_b16 v[126:127], v135 offset:41984
    s_waitcnt lgkmcnt(12)
    v_mfma_f32_16x16x32_bf16 v[8:11], a[20:23], v[100:103], v[8:11]
    ds_read_b64_tr_b16 v[64:65], v128 offset:49152
    v_mfma_f32_16x16x32_bf16 v[12:15], a[84:87], v[100:103], v[12:15]
    ds_read_b64_tr_b16 v[66:67], v128 offset:50176
    s_waitcnt lgkmcnt(12)
    v_mfma_f32_16x16x32_bf16 v[16:19], a[20:23], v[104:107], v[16:19]
    ds_read_b64_tr_b16 v[68:69], v129 offset:49152
    v_mfma_f32_16x16x32_bf16 v[20:23], a[84:87], v[104:107], v[20:23]
    ds_read_b64_tr_b16 v[70:71], v129 offset:50176
    s_waitcnt lgkmcnt(12)
    v_mfma_f32_16x16x32_bf16 v[24:27], a[20:23], v[108:111], v[24:27]
    ds_read_b64_tr_b16 v[72:73], v130 offset:49152
    v_mfma_f32_16x16x32_bf16 v[28:31], a[84:87], v[108:111], v[28:31]
    ds_read_b64_tr_b16 v[74:75], v130 offset:50176
    s_waitcnt lgkmcnt(12)
    v_mfma_f32_16x16x32_bf16 v[32:35], a[20:23], v[112:115], v[32:35]
    ds_read_b64_tr_b16 v[76:77], v131 offset:49152
    v_mfma_f32_16x16x32_bf16 v[36:39], a[84:87], v[112:115], v[36:39]
    ds_read_b64_tr_b16 v[78:79], v131 offset:50176
    s_waitcnt lgkmcnt(12)
    v_mfma_f32_16x16x32_bf16 v[40:43], a[20:23], v[116:119], v[40:43]
    ds_read_b64_tr_b16 v[80:81], v132 offset:49152
    v_mfma_f32_16x16x32_bf16 v[44:47], a[84:87], v[116:119], v[44:47]
    ds_read_b64_tr_b16 v[82:83], v132 offset:50176
    s_waitcnt lgkmcnt(12)
    v_mfma_f32_16x16x32_bf16 v[48:51], a[20:23], v[120:123], v[48:51]
    ds_read_b64_tr_b16 v[84:85], v133 offset:49152
    v_mfma_f32_16x16x32_bf16 v[52:55], a[84:87], v[120:123], v[52:55]
    ds_read_b64_tr_b16 v[86:87], v133 offset:50176
    s_waitcnt lgkmcnt(12)
    v_mfma_f32_16x16x32_bf16 v[56:59], a[20:23], v[124:127], v[56:59]
    ds_read_b64_tr_b16 v[88:89], v134 offset:49152
    v_mfma_f32_16x16x32_bf16 v[60:63], a[84:87], v[124:127], v[60:63]
    ds_read_b64_tr_b16 v[90:91], v134 offset:50176
    s_waitcnt lgkmcnt(12)
    v_mfma_f32_16x16x32_bf16 v[0:3], a[24:27], v[64:67], v[0:3]
    ds_read_b64_tr_b16 v[92:93], v135 offset:49152
    v_mfma_f32_16x16x32_bf16 v[4:7], a[88:91], v[64:67], v[4:7]
    ds_read_b64_tr_b16 v[94:95], v135 offset:50176
    s_waitcnt lgkmcnt(12)
    v_mfma_f32_16x16x32_bf16 v[8:11], a[24:27], v[68:71], v[8:11]
    ds_read_b64_tr_b16 v[96:97], v128 offset:57344
    v_mfma_f32_16x16x32_bf16 v[12:15], a[88:91], v[68:71], v[12:15]
    ds_read_b64_tr_b16 v[98:99], v128 offset:58368
    s_waitcnt lgkmcnt(12)
    v_mfma_f32_16x16x32_bf16 v[16:19], a[24:27], v[72:75], v[16:19]
    ds_read_b64_tr_b16 v[100:101], v129 offset:57344
    v_mfma_f32_16x16x32_bf16 v[20:23], a[88:91], v[72:75], v[20:23]
    ds_read_b64_tr_b16 v[102:103], v129 offset:58368
    s_waitcnt lgkmcnt(12)
    v_mfma_f32_16x16x32_bf16 v[24:27], a[24:27], v[76:79], v[24:27]
    ds_read_b64_tr_b16 v[104:105], v130 offset:57344
    v_mfma_f32_16x16x32_bf16 v[28:31], a[88:91], v[76:79], v[28:31]
    ds_read_b64_tr_b16 v[106:107], v130 offset:58368
    s_waitcnt lgkmcnt(12)
    v_mfma_f32_16x16x32_bf16 v[32:35], a[24:27], v[80:83], v[32:35]
    ds_read_b64_tr_b16 v[108:109], v131 offset:57344
    v_mfma_f32_16x16x32_bf16 v[36:39], a[88:91], v[80:83], v[36:39]
    ds_read_b64_tr_b16 v[110:111], v131 offset:58368
    s_waitcnt lgkmcnt(12)
    v_mfma_f32_16x16x32_bf16 v[40:43], a[24:27], v[84:87], v[40:43]
    ds_read_b64_tr_b16 v[112:113], v132 offset:57344
    v_mfma_f32_16x16x32_bf16 v[44:47], a[88:91], v[84:87], v[44:47]
    ds_read_b64_tr_b16 v[114:115], v132 offset:58368
    s_waitcnt lgkmcnt(12)
    v_mfma_f32_16x16x32_bf16 v[48:51], a[24:27], v[88:91], v[48:51]
    ds_read_b64_tr_b16 v[116:117], v133 offset:57344
    v_mfma_f32_16x16x32_bf16 v[52:55], a[88:91], v[88:91], v[52:55]
    ds_read_b64_tr_b16 v[118:119], v133 offset:58368
    s_waitcnt lgkmcnt(12)
    v_mfma_f32_16x16x32_bf16 v[56:59], a[24:27], v[92:95], v[56:59]
    ds_read_b64_tr_b16 v[120:121], v134 offset:57344
    v_mfma_f32_16x16x32_bf16 v[60:63], a[88:91], v[92:95], v[60:63]
    ds_read_b64_tr_b16 v[122:123], v134 offset:58368
    s_waitcnt lgkmcnt(12)
    v_mfma_f32_16x16x32_bf16 v[0:3], a[28:31], v[96:99], v[0:3]
    ds_read_b64_tr_b16 v[124:125], v135 offset:57344
    v_mfma_f32_16x16x32_bf16 v[4:7], a[92:95], v[96:99], v[4:7]
    ds_read_b64_tr_b16 v[126:127], v135 offset:58368
    s_waitcnt lgkmcnt(12)
    v_mfma_f32_16x16x32_bf16 v[8:11], a[28:31], v[100:103], v[8:11]
    v_mfma_f32_16x16x32_bf16 v[12:15], a[92:95], v[100:103], v[12:15]
    s_waitcnt lgkmcnt(10)
    v_mfma_f32_16x16x32_bf16 v[16:19], a[28:31], v[104:107], v[16:19]
    v_mfma_f32_16x16x32_bf16 v[20:23], a[92:95], v[104:107], v[20:23]
    s_waitcnt lgkmcnt(8)
    v_mfma_f32_16x16x32_bf16 v[24:27], a[28:31], v[108:111], v[24:27]
    v_mfma_f32_16x16x32_bf16 v[28:31], a[92:95], v[108:111], v[28:31]
    s_waitcnt lgkmcnt(6)
    v_mfma_f32_16x16x32_bf16 v[32:35], a[28:31], v[112:115], v[32:35]
    v_mfma_f32_16x16x32_bf16 v[36:39], a[92:95], v[112:115], v[36:39]
    s_waitcnt lgkmcnt(4)
    v_mfma_f32_16x16x32_bf16 v[40:43], a[28:31], v[116:119], v[40:43]
    v_mfma_f32_16x16x32_bf16 v[44:47], a[92:95], v[116:119], v[44:47]
    s_waitcnt lgkmcnt(2)
    v_mfma_f32_16x16x32_bf16 v[48:51], a[28:31], v[120:123], v[48:51]
    v_mfma_f32_16x16x32_bf16 v[52:55], a[92:95], v[120:123], v[52:55]
    s_waitcnt lgkmcnt(0)
    v_mfma_f32_16x16x32_bf16 v[56:59], a[28:31], v[124:127], v[56:59]
    v_mfma_f32_16x16x32_bf16 v[60:63], a[92:95], v[124:127], v[60:63]
    v_xor_b32 v128, 0x10000, v128
    v_xor_b32 v129, 0x10000, v129
    v_xor_b32 v130, 0x10000, v130
    v_xor_b32 v131, 0x10000, v131
    v_xor_b32 v132, 0x10000, v132
    v_xor_b32 v133, 0x10000, v133
    v_xor_b32 v134, 0x10000, v134
    v_xor_b32 v135, 0x10000, v135
    s_waitcnt vmcnt(16)
    s_barrier
    ds_read_b64_tr_b16 v[64:65], v128
    ds_read_b64_tr_b16 v[66:67], v128 offset:1024
    ds_read_b64_tr_b16 v[68:69], v129
    ds_read_b64_tr_b16 v[70:71], v129 offset:1024
    ds_read_b64_tr_b16 v[72:73], v130
    ds_read_b64_tr_b16 v[74:75], v130 offset:1024
    ds_read_b64_tr_b16 v[76:77], v131
    ds_read_b64_tr_b16 v[78:79], v131 offset:1024
    ds_read_b64_tr_b16 v[80:81], v132
    ds_read_b64_tr_b16 v[82:83], v132 offset:1024
    ds_read_b64_tr_b16 v[84:85], v133
    ds_read_b64_tr_b16 v[86:87], v133 offset:1024
    ds_read_b64_tr_b16 v[88:89], v134
    ds_read_b64_tr_b16 v[90:91], v134 offset:1024
    s_cmp_eq_u32 s40, 0
    s_cbranch_scc1 L_nopf_96
    s_cmp_lg_u32 s87, 0
    s_cbranch_scc1 L_modeok_97
    v_readfirstlane_b32 s96, v140
    v_readfirstlane_b32 s97, v141
    s_nop 0
    s_cmp_lg_u32 s97, 0
    s_cselect_b32 s87, s96, 0
    s_cmp_eq_u32 s87, 1
    s_cbranch_scc1 L_modeok_97
    s_mov_b32 s96, 0
L_mode_98:
    buffer_load_dwordx2 v[140:141], off, s[92:95], 0 offset:36 sc1
    s_waitcnt vmcnt(0)
    v_readfirstlane_b32 s87, v140
    v_readfirstlane_b32 s97, v141
    s_nop 0
    s_min_u32 s97, s97, s87
    s_cmp_lg_u32 s97, 0
    s_cbranch_scc1 L_moded_99
    s_sleep 4
    s_add_u32 s96, s96, 1
    s_cmp_lg_u32 s96, 0x100
    s_cbranch_scc1 L_modef_100
    v_mov_b32 v140, 2
    v_mov_b32 v141, 0
    s_mov_b64 exec, 1
    buffer_atomic_cmpswap v[140:141], off, s[92:95], 0 offset:36
    s_mov_b64 exec, -1
L_modef_100:
    s_cmp_lt_u32 s96, 0x10000
    s_cbranch_scc1 L_mode_98
L_moded_99:
    s_cmp_lg_u32 s87, 1
    s_cbranch_scc1 L_fallback
L_modeok_97:
    s_cmp_lg_u32 s100, 0
    s_cbranch_scc1 L_flag_101
    v_mov_b32 v138, 1
    s_mov_b64 exec, 1
    buffer_store_dword v138, off, s[8:11], s40 sc1
    s_mov_b64 exec, -1
L_flag_101:
    s_mov_b32 s40, 0
L_nopf_96:
    s_waitcnt lgkmcnt(12)
    v_mfma_f32_16x16x32_bf16 v[0:3], a[32:35], v[64:67], v[0:3]
    ds_read_b64_tr_b16 v[92:93], v135
    v_mfma_f32_16x16x32_bf16 v[4:7], a[96:99], v[64:67], v[4:7]
    ds_read_b64_tr_b16 v[94:95], v135 offset:1024
    s_add_u32 s26, s24, 0x100000
    s_add_u32 m0, s29, 0x8000
    s_nop 0
    buffer_load_dwordx4 v136, s[16:19], s26 offen lds
    s_waitcnt lgkmcnt(12)
    v_mfma_f32_16x16x32_bf16 v[8:11], a[32:35], v[68:71], v[8:11]
    ds_read_b64_tr_b16 v[96:97], v128 offset:8192
    v_mfma_f32_16x16x32_bf16 v[12:15], a[96:99], v[68:71], v[12:15]
    ds_read_b64_tr_b16 v[98:99], v128 offset:9216
    s_add_u32 s26, s24, 0x120000
    s_add_u32 m0, s29, 0x9000
    s_nop 0
    buffer_load_dwordx4 v136, s[16:19], s26 offen lds
    s_waitcnt lgkmcnt(12)
    v_mfma_f32_16x16x32_bf16 v[16:19], a[32:35], v[72:75], v[16:19]
    ds_read_b64_tr_b16 v[100:101], v129 offset:8192
    v_mfma_f32_16x16x32_bf16 v[20:23], a[96:99], v[72:75], v[20:23]
    ds_read_b64_tr_b16 v[102:103], v129 offset:9216
    s_add_u32 s26, s24, 0x140000
    s_add_u32 m0, s29, 0xa000
    s_nop 0
    buffer_load_dwordx4 v136, s[16:19], s26 offen lds
    s_waitcnt lgkmcnt(12)
    v_mfma_f32_16x16x32_bf16 v[24:27], a[32:35], v[76:79], v[24:27]
    ds_read_b64_tr_b16 v[104:105], v130 offset:8192
    v_mfma_f32_16x16x32_bf16 v[28:31], a[96:99], v[76:79], v[28:31]
    ds_read_b64_tr_b16 v[106:107], v130 offset:9216
    s_add_u32 s26, s24, 0x160000
    s_add_u32 m0, s29, 0xb000
    s_nop 0
    buffer_load_dwordx4 v136, s[16:19], s26 offen lds
    s_waitcnt lgkmcnt(12)
    v_mfma_f32_16x16x32_bf16 v[32:35], a[32:35], v[80:83], v[32:35]
    ds_read_b64_tr_b16 v[108:109], v131 offset:8192
    v_mfma_f32_16x16x32_bf16 v[36:39], a[96:99], v[80:83], v[36:39]
    ds_read_b64_tr_b16 v[110:111], v131 offset:9216
    s_add_u32 s26, s24, 0x180000
    s_add_u32 m0, s29, 0xc000
    s_nop 0
    buffer_load_dwordx4 v136, s[16:19], s26 offen lds
    s_waitcnt lgkmcnt(12)
    v_mfma_f32_16x16x32_bf16 v[40:43], a[32:35], v[84:87], v[40:43]
    ds_read_b64_tr_b16 v[112:113], v132 offset:8192
    v_mfma_f32_16x16x32_bf16 v[44:47], a[96:99], v[84:87], v[44:47]
    ds_read_b64_tr_b16 v[114:115], v132 offset:9216
    s_add_u32 s26, s24, 0x1a0000
    s_add_u32 m0, s29, 0xd000
    s_nop 0
    buffer_load_dwordx4 v136, s[16:19], s26 offen lds
    s_waitcnt lgkmcnt(12)
    v_mfma_f32_16x16x32_bf16 v[48:51], a[32:35], v[88:91], v[48:51]
    ds_read_b64_tr_b16 v[116:117], v133 offset:8192
    v_mfma_f32_16x16x32_bf16 v[52:55], a[96:99], v[88:91], v[52:55]
    ds_read_b64_tr_b16 v[118:119], v133 offset:9216
    s_add_u32 s26, s24, 0x1c0000
    s_add_u32 m0, s29, 0xe000
    s_nop 0
    buffer_load_dwordx4 v136, s[16:19], s26 offen lds
    s_waitcnt lgkmcnt(12)
    v_mfma_f32_16x16x32_bf16 v[56:59], a[32:35], v[92:95], v[56:59]
    ds_read_b64_tr_b16 v[120:121], v134 offset:8192
    v_mfma_f32_16x16x32_bf16 v[60:63], a[96:99], v[92:95], v[60:63]
    ds_read_b64_tr_b16 v[122:123], v134 offset:9216
    s_add_u32 s26, s24, 0x1e0000
    s_add_u32 m0, s29, 0xf000
    s_nop 0
    buffer_load_dwordx4 v136, s[16:19], s26 offen lds
    s_waitcnt lgkmcnt(12)
    v_mfma_f32_16x16x32_bf16 v[0:3], a[36:39], v[96:99], v[0:3]
    ds_read_b64_tr_b16 v[124:125], v135 offset:8192
    v_mfma_f32_16x16x32_bf16 v[4:7], a[100:103], v[96:99], v[4:7]
    ds_read_b64_tr_b16 v[126:127], v135 offset:9216
    s_waitcnt lgkmcnt(12)
    v_mfma_f32_16x16x32_bf16 v[8:11], a[36:39], v[100:103], v[8:11]
    ds_read_b64_tr_b16 v[64:65], v128 offset:16384
    v_mfma_f32_16x16x32_bf16 v[12:15], a[100:103], v[100:103], v[12:15]
    ds_read_b64_tr_b16 v[66:67], v128 offset:17408
    s_waitcnt lgkmcnt(12)
    v_mfma_f32_16x16x32_bf16 v[16:19], a[36:39], v[104:107], v[16:19]
    ds_read_b64_tr_b16 v[68:69], v129 offset:16384
    v_mfma_f32_16x16x32_bf16 v[20:23], a[100:103], v[104:107], v[20:23]
    ds_read_b64_tr_b16 v[70:71], v129 offset:17408
    s_waitcnt lgkmcnt(12)
    v_mfma_f32_16x16x32_bf16 v[24:27], a[36:39], v[108:111], v[24:27]
    ds_read_b64_tr_b16 v[72:73], v130 offset:16384
    v_mfma_f32_16x16x32_bf16 v[28:31], a[100:103], v[108:111], v[28:31]
    ds_read_b64_tr_b16 v[74:75], v130 offset:17408
    s_waitcnt lgkmcnt(12)
    v_mfma_f32_16x16x32_bf16 v[32:35], a[36:39], v[112:115], v[32:35]
    ds_read_b64_tr_b16 v[76:77], v131 offset:16384
    v_mfma_f32_16x16x32_bf16 v[36:39], a[100:103], v[112:115], v[36:39]
    ds_read_b64_tr_b16 v[78:79], v131 offset:17408
    s_waitcnt lgkmcnt(12)
    v_mfma_f32_16x16x32_bf16 v[40:43], a[36:39], v[116:119], v[40:43]
    ds_read_b64_tr_b16 v[80:81], v132 offset:16384
    v_mfma_f32_16x16x32_bf16 v[44:47], a[100:103], v[116:119], v[44:47]
    ds_read_b64_tr_b16 v[82:83], v132 offset:17408
    s_waitcnt lgkmcnt(12)
    v_mfma_f32_16x16x32_bf16 v[48:51], a[36:39], v[120:123], v[48:51]
    ds_read_b64_tr_b16 v[84:85], v133 offset:16384
    v_mfma_f32_16x16x32_bf16 v[52:55], a[100:103], v[120:123], v[52:55]
    ds_read_b64_tr_b16 v[86:87], v133 offset:17408
    s_waitcnt lgkmcnt(12)
    v_mfma_f32_16x16x32_bf16 v[56:59], a[36:39], v[124:127], v[56:59]
    ds_read_b64_tr_b16 v[88:89], v134 offset:16384
    v_mfma_f32_16x16x32_bf16 v[60:63], a[100:103], v[124:127], v[60:63]
    ds_read_b64_tr_b16 v[90:91], v134 offset:17408
    s_waitcnt lgkmcnt(12)
    v_mfma_f32_16x16x32_bf16 v[0:3], a[40:43], v[64:67], v[0:3]
    ds_read_b64_tr_b16 v[92:93], v135 offset:16384
    v_mfma_f32_16x16x32_bf16 v[4:7], a[104:107], v[64:67], v[4:7]
    ds_read_b64_tr_b16 v[94:95], v135 offset:17408
    s_waitcnt lgkmcnt(12)
    v_mfma_f32_16x16x32_bf16 v[8:11], a[40:43], v[68:71], v[8:11]
    ds_read_b64_tr_b16 v[96:97], v128 offset:24576
    v_mfma_f32_16x16x32_bf16 v[12:15], a[104:107], v[68:71], v[12:15]
    ds_read_b64_tr_b16 v[98:99], v128 offset:25600
    s_waitcnt lgkmcnt(12)
    v_mfma_f32_16x16x32_bf16 v[16:19], a[40:43], v[72:75], v[16:19]
    ds_read_b64_tr_b16 v[100:101], v129 offset:24576
    v_mfma_f32_16x16x32_bf16 v[20:23], a[104:107], v[72:75], v[20:23]
    ds_read_b64_tr_b16 v[102:103], v129 offset:25600
    s_waitcnt lgkmcnt(12)
    v_mfma_f32_16x16x32_bf16 v[24:27], a[40:43], v[76:79], v[24:27]
    ds_read_b64_tr_b16 v[104:105], v130 offset:24576
    v_mfma_f32_16x16x32_bf16 v[28:31], a[104:107], v[76:79], v[28:31]
    ds_read_b64_tr_b16 v[106:107], v130 offset:25600
    s_waitcnt lgkmcnt(12)
    v_mfma_f32_16x16x32_bf16 v[32:35], a[40:43], v[80:83], v[32:35]
    ds_read_b64_tr_b16 v[108:109], v131 offset:24576
    v_mfma_f32_16x16x32_bf16 v[36:39], a[104:107], v[80:83], v[36:39]
    ds_read_b64_tr_b16 v[110:111], v131 offset:25600
    s_waitcnt lgkmcnt(12)
    v_mfma_f32_16x16x32_bf16 v[40:43], a[40:43], v[84:87], v[40:43]
    ds_read_b64_tr_b16 v[112:113], v132 offset:24576
    v_mfma_f32_16x16x32_bf16 v[44:47], a[104:107], v[84:87], v[44:47]
    ds_read_b64_tr_b16 v[114:115], v132 offset:25600
    s_waitcnt lgkmcnt(12)
    v_mfma_f32_16x16x32_bf16 v[48:51], a[40:43], v[88:91], v[48:51]
    ds_read_b64_tr_b16 v[116:117], v133 offset:24576
    v_mfma_f32_16x16x32_bf16 v[52:55], a[104:107], v[88:91], v[52:55]
    ds_read_b64_tr_b16 v[118:119], v133 offset:25600
    s_waitcnt lgkmcnt(12)
    v_mfma_f32_16x16x32_bf16 v[56:59], a[40:43], v[92:95], v[56:59]
    ds_read_b64_tr_b16 v[120:121], v134 offset:24576
    v_mfma_f32_16x16x32_bf16 v[60:63], a[104:107], v[92:95], v[60:63]
    ds_read_b64_tr_b16 v[122:123], v134 offset:25600
    s_waitcnt lgkmcnt(12)
    v_mfma_f32_16x16x32_bf16 v[0:3], a[44:47], v[96:99], v[0:3]
    ds_read_b64_tr_b16 v[124:125], v135 offset:24576
    v_mfma_f32_16x16x32_bf16 v[4:7], a[108:111], v[96:99], v[4:7]
    ds_read_b64_tr_b16 v[126:127], v135 offset:25600
    s_waitcnt lgkmcnt(12)
    v_mfma_f32_16x16x32_bf16 v[8:11], a[44:47], v[100:103], v[8:11]
    v_mfma_f32_16x16x32_bf16 v[12:15], a[108:111], v[100:103], v[12:15]
    s_waitcnt lgkmcnt(10)
    v_mfma_f32_16x16x32_bf16 v[16:19], a[44:47], v[104:107], v[16:19]
    v_mfma_f32_16x16x32_bf16 v[20:23], a[108:111], v[104:107], v[20:23]
    s_waitcnt lgkmcnt(8)
    v_mfma_f32_16x16x32_bf16 v[24:27], a[44:47], v[108:111], v[24:27]
    v_mfma_f32_16x16x32_bf16 v[28:31], a[108:111], v[108:111], v[28:31]
    s_waitcnt lgkmcnt(6)
    v_mfma_f32_16x16x32_bf16 v[32:35], a[44:47], v[112:115], v[32:35]
    v_mfma_f32_16x16x32_bf16 v[36:39], a[108:111], v[112:115], v[36:39]
    s_waitcnt lgkmcnt(4)
    v_mfma_f32_16x16x32_bf16 v[40:43], a[44:47], v[116:119], v[40:43]
    v_mfma_f32_16x16x32_bf16 v[44:47], a[108:111], v[116:119], v[44:47]
    s_waitcnt lgkmcnt(2)
    v_mfma_f32_16x16x32_bf16 v[48:51], a[44:47], v[120:123], v[48:51]
    v_mfma_f32_16x16x32_bf16 v[52:55], a[108:111], v[120:123], v[52:55]
    s_waitcnt lgkmcnt(0)
    v_mfma_f32_16x16x32_bf16 v[56:59], a[44:47], v[124:127], v[56:59]
    v_mfma_f32_16x16x32_bf16 v[60:63], a[108:111], v[124:127], v[60:63]
    s_waitcnt vmcnt(16)
    s_barrier
    ds_read_b64_tr_b16 v[64:65], v128 offset:32768
    ds_read_b64_tr_b16 v[66:67], v128 offset:33792
    ds_read_b64_tr_b16 v[68:69], v129 offset:32768
    ds_read_b64_tr_b16 v[70:71], v129 offset:33792
    ds_read_b64_tr_b16 v[72:73], v130 offset:32768
    ds_read_b64_tr_b16 v[74:75], v130 offset:33792
    ds_read_b64_tr_b16 v[76:77], v131 offset:32768
    ds_read_b64_tr_b16 v[78:79], v131 offset:33792
    ds_read_b64_tr_b16 v[80:81], v132 offset:32768
    ds_read_b64_tr_b16 v[82:83], v132 offset:33792
    ds_read_b64_tr_b16 v[84:85], v133 offset:32768
    ds_read_b64_tr_b16 v[86:87], v133 offset:33792
    ds_read_b64_tr_b16 v[88:89], v134 offset:32768
    ds_read_b64_tr_b16 v[90:91], v134 offset:33792
    s_waitcnt lgkmcnt(12)
    v_mfma_f32_16x16x32_bf16 v[0:3], a[48:51], v[64:67], v[0:3]
    ds_read_b64_tr_b16 v[92:93], v135 offset:32768
    v_mfma_f32_16x16x32_bf16 v[4:7], a[112:115], v[64:67], v[4:7]
    ds_read_b64_tr_b16 v[94:95], v135 offset:33792
    s_add_u32 s26, s24, 0x200000
    s_add_u32 m0, s29, 0x10000
    s_nop 0
    buffer_load_dwordx4 v136, s[16:19], s26 offen lds
    s_waitcnt lgkmcnt(12)
    v_mfma_f32_16x16x32_bf16 v[8:11], a[48:51], v[68:71], v[8:11]
    ds_read_b64_tr_b16 v[96:97], v128 offset:40960
    v_mfma_f32_16x16x32_bf16 v[12:15], a[112:115], v[68:71], v[12:15]
    ds_read_b64_tr_b16 v[98:99], v128 offset:41984
    s_add_u32 s26, s24, 0x220000
    s_add_u32 m0, s29, 0x11000
    s_nop 0
    buffer_load_dwordx4 v136, s[16:19], s26 offen lds
    s_waitcnt lgkmcnt(12)
    v_mfma_f32_16x16x32_bf16 v[16:19], a[48:51], v[72:75], v[16:19]
    ds_read_b64_tr_b16 v[100:101], v129 offset:40960
    v_mfma_f32_16x16x32_bf16 v[20:23], a[112:115], v[72:75], v[20:23]
    ds_read_b64_tr_b16 v[102:103], v129 offset:41984
    s_add_u32 s26, s24, 0x240000
    s_add_u32 m0, s29, 0x12000
    s_nop 0
    buffer_load_dwordx4 v136, s[16:19], s26 offen lds
    s_waitcnt lgkmcnt(12)
    v_mfma_f32_16x16x32_bf16 v[24:27], a[48:51], v[76:79], v[24:27]
    ds_read_b64_tr_b16 v[104:105], v130 offset:40960
    v_mfma_f32_16x16x32_bf16 v[28:31], a[112:115], v[76:79], v[28:31]
    ds_read_b64_tr_b16 v[106:107], v130 offset:41984
    s_add_u32 s26, s24, 0x260000
    s_add_u32 m0, s29, 0x13000
    s_nop 0
    buffer_load_dwordx4 v136, s[16:19], s26 offen lds
    s_waitcnt lgkmcnt(12)
    v_mfma_f32_16x16x32_bf16 v[32:35], a[48:51], v[80:83], v[32:35]
    ds_read_b64_tr_b16 v[108:109], v131 offset:40960
    v_mfma_f32_16x16x32_bf16 v[36:39], a[112:115], v[80:83], v[36:39]
    ds_read_b64_tr_b16 v[110:111], v131 offset:41984
    s_add_u32 s26, s24, 0x280000
    s_add_u32 m0, s29, 0x14000
    s_nop 0
    buffer_load_dwordx4 v136, s[16:19], s26 offen lds
    s_waitcnt lgkmcnt(12)
    v_mfma_f32_16x16x32_bf16 v[40:43], a[48:51], v[84:87], v[40:43]
    ds_read_b64_tr_b16 v[112:113], v132 offset:40960
    v_mfma_f32_16x16x32_bf16 v[44:47], a[112:115], v[84:87], v[44:47]
    ds_read_b64_tr_b16 v[114:115], v132 offset:41984
    s_add_u32 s26, s24, 0x2a0000
    s_add_u32 m0, s29, 0x15000
    s_nop 0
    buffer_load_dwordx4 v136, s[16:19], s26 offen lds
    s_waitcnt lgkmcnt(12)
    v_mfma_f32_16x16x32_bf16 v[48:51], a[48:51], v[88:91], v[48:51]
    ds_read_b64_tr_b16 v[116:117], v133 offset:40960
    v_mfma_f32_16x16x32_bf16 v[52:55], a[112:115], v[88:91], v[52:55]
    ds_read_b64_tr_b16 v[118:119], v133 offset:41984
    s_add_u32 s26, s24, 0x2c0000
    s_add_u32 m0, s29, 0x16000
    s_nop 0
    buffer_load_dwordx4 v136, s[16:19], s26 offen lds
    s_waitcnt lgkmcnt(12)
    v_mfma_f32_16x16x32_bf16 v[56:59], a[48:51], v[92:95], v[56:59]
    ds_read_b64_tr_b16 v[120:121], v134 offset:40960
    v_mfma_f32_16x16x32_bf16 v[60:63], a[112:115], v[92:95], v[60:63]
    ds_read_b64_tr_b16 v[122:123], v134 offset:41984
    s_add_u32 s26, s24, 0x2e0000
    s_add_u32 m0, s29, 0x17000
    s_nop 0
    buffer_load_dwordx4 v136, s[16:19], s26 offen lds
    s_waitcnt lgkmcnt(12)
    v_mfma_f32_16x16x32_bf16 v[0:3], a[52:55], v[96:99], v[0:3]
    ds_read_b64_tr_b16 v[124:125], v135 offset:40960
    v_mfma_f32_16x16x32_bf16 v[4:7], a[116:119], v[96:99], v[4:7]
    ds_read_b64_tr_b16 v[126:127], v135 offset:41984
    s_waitcnt lgkmcnt(12)
    v_mfma_f32_16x16x32_bf16 v[8:11], a[52:55], v[100:103], v[8:11]
    ds_read_b64_tr_b16 v[64:65], v128 offset:49152
    v_mfma_f32_16x16x32_bf16 v[12:15], a[116:119], v[100:103], v[12:15]
    ds_read_b64_tr_b16 v[66:67], v128 offset:50176
    s_waitcnt lgkmcnt(12)
    v_mfma_f32_16x16x32_bf16 v[16:19], a[52:55], v[104:107], v[16:19]
    ds_read_b64_tr_b16 v[68:69], v129 offset:49152
    v_mfma_f32_16x16x32_bf16 v[20:23], a[116:119], v[104:107], v[20:23]
    ds_read_b64_tr_b16 v[70:71], v129 offset:50176
    s_waitcnt lgkmcnt(12)
    v_mfma_f32_16x16x32_bf16 v[24:27], a[52:55], v[108:111], v[24:27]
    ds_read_b64_tr_b16 v[72:73], v130 offset:49152
    v_mfma_f32_16x16x32_bf16 v[28:31], a[116:119], v[108:111], v[28:31]
    ds_read_b64_tr_b16 v[74:75], v130 offset:50176
    s_waitcnt lgkmcnt(12)
    v_mfma_f32_16x16x32_bf16 v[32:35], a[52:55], v[112:115], v[32:35]
    ds_read_b64_tr_b16 v[76:77], v131 offset:49152
    v_mfma_f32_16x16x32_bf16 v[36:39], a[116:119], v[112:115], v[36:39]
    ds_read_b64_tr_b16 v[78:79], v131 offset:50176
    s_waitcnt lgkmcnt(12)
    v_mfma_f32_16x16x32_bf16 v[40:43], a[52:55], v[116:119], v[40:43]
    ds_read_b64_tr_b16 v[80:81], v132 offset:49152
    v_mfma_f32_16x16x32_bf16 v[44:47], a[116:119], v[116:119], v[44:47]
    ds_read_b64_tr_b16 v[82:83], v132 offset:50176
    s_waitcnt lgkmcnt(12)
    v_mfma_f32_16x16x32_bf16 v[48:51], a[52:55], v[120:123], v[48:51]
    ds_read_b64_tr_b16 v[84:85], v133 offset:49152
    v_mfma_f32_16x16x32_bf16 v[52:55], a[116:119], v[120:123], v[52:55]
    ds_read_b64_tr_b16 v[86:87], v133 offset:50176
    s_waitcnt lgkmcnt(12)
    v_mfma_f32_16x16x32_bf16 v[56:59], a[52:55], v[124:127], v[56:59]
    ds_read_b64_tr_b16 v[88:89], v134 offset:49152
    v_mfma_f32_16x16x32_bf16 v[60:63], a[116:119], v[124:127], v[60:63]
    ds_read_b64_tr_b16 v[90:91], v134 offset:50176
    s_waitcnt lgkmcnt(12)
    v_mfma_f32_16x16x32_bf16 v[0:3], a[56:59], v[64:67], v[0:3]
    ds_read_b64_tr_b16 v[92:93], v135 offset:49152
    v_mfma_f32_16x16x32_bf16 v[4:7], a[120:123], v[64:67], v[4:7]
    ds_read_b64_tr_b16 v[94:95], v135 offset:50176
    s_waitcnt lgkmcnt(12)
    v_mfma_f32_16x16x32_bf16 v[8:11], a[56:59], v[68:71], v[8:11]
    ds_read_b64_tr_b16 v[96:97], v128 offset:57344
    v_mfma_f32_16x16x32_bf16 v[12:15], a[120:123], v[68:71], v[12:15]
    ds_read_b64_tr_b16 v[98:99], v128 offset:58368
    s_waitcnt lgkmcnt(12)
    v_mfma_f32_16x16x32_bf16 v[16:19], a[56:59], v[72:75], v[16:19]
    ds_read_b64_tr_b16 v[100:101], v129 offset:57344
    v_mfma_f32_16x16x32_bf16 v[20:23], a[120:123], v[72:75], v[20:23]
    ds_read_b64_tr_b16 v[102:103], v129 offset:58368
    s_waitcnt lgkmcnt(12)
    v_mfma_f32_16x16x32_bf16 v[24:27], a[56:59], v[76:79], v[24:27]
    ds_read_b64_tr_b16 v[104:105], v130 offset:57344
    v_mfma_f32_16x16x32_bf16 v[28:31], a[120:123], v[76:79], v[28:31]
    ds_read_b64_tr_b16 v[106:107], v130 offset:58368
    s_waitcnt lgkmcnt(12)
    v_mfma_f32_16x16x32_bf16 v[32:35], a[56:59], v[80:83], v[32:35]
    ds_read_b64_tr_b16 v[108:109], v131 offset:57344
    v_mfma_f32_16x16x32_bf16 v[36:39], a[120:123], v[80:83], v[36:39]
    ds_read_b64_tr_b16 v[110:111], v131 offset:58368
    s_waitcnt lgkmcnt(12)
    v_mfma_f32_16x16x32_bf16 v[40:43], a[56:59], v[84:87], v[40:43]
    ds_read_b64_tr_b16 v[112:113], v132 offset:57344
    v_mfma_f32_16x16x32_bf16 v[44:47], a[120:123], v[84:87], v[44:47]
    ds_read_b64_tr_b16 v[114:115], v132 offset:58368
    s_waitcnt lgkmcnt(12)
    v_mfma_f32_16x16x32_bf16 v[48:51], a[56:59], v[88:91], v[48:51]
    ds_read_b64_tr_b16 v[116:117], v133 offset:57344
    v_mfma_f32_16x16x32_bf16 v[52:55], a[120:123], v[88:91], v[52:55]
    ds_read_b64_tr_b16 v[118:119], v133 offset:58368
    s_waitcnt lgkmcnt(12)
    v_mfma_f32_16x16x32_bf16 v[56:59], a[56:59], v[92:95], v[56:59]
    ds_read_b64_tr_b16 v[120:121], v134 offset:57344
    v_mfma_f32_16x16x32_bf16 v[60:63], a[120:123], v[92:95], v[60:63]
    ds_read_b64_tr_b16 v[122:123], v134 offset:58368
    s_waitcnt lgkmcnt(12)
    v_mfma_f32_16x16x32_bf16 v[0:3], a[60:63], v[96:99], v[0:3]
    ds_read_b64_tr_b16 v[124:125], v135 offset:57344
    v_mfma_f32_16x16x32_bf16 v[4:7], a[124:127], v[96:99], v[4:7]
    ds_read_b64_tr_b16 v[126:127], v135 offset:58368
    s_waitcnt lgkmcnt(12)
    v_mfma_f32_16x16x32_bf16 v[8:11], a[60:63], v[100:103], v[8:11]
    v_mfma_f32_16x16x32_bf16 v[12:15], a[124:127], v[100:103], v[12:15]
    s_waitcnt lgkmcnt(10)
    v_mfma_f32_16x16x32_bf16 v[16:19], a[60:63], v[104:107], v[16:19]
    v_mfma_f32_16x16x32_bf16 v[20:23], a[124:127], v[104:107], v[20:23]
    s_waitcnt lgkmcnt(8)
    v_mfma_f32_16x16x32_bf16 v[24:27], a[60:63], v[108:111], v[24:27]
    v_mfma_f32_16x16x32_bf16 v[28:31], a[124:127], v[108:111], v[28:31]
    s_waitcnt lgkmcnt(6)
    v_mfma_f32_16x16x32_bf16 v[32:35], a[60:63], v[112:115], v[32:35]
    v_mfma_f32_16x16x32_bf16 v[36:39], a[124:127], v[112:115], v[36:39]
    s_waitcnt lgkmcnt(4)
    v_mfma_f32_16x16x32_bf16 v[40:43], a[60:63], v[116:119], v[40:43]
    v_mfma_f32_16x16x32_bf16 v[44:47], a[124:127], v[116:119], v[44:47]
    s_waitcnt lgkmcnt(2)
    v_mfma_f32_16x16x32_bf16 v[48:51], a[60:63], v[120:123], v[48:51]
    v_mfma_f32_16x16x32_bf16 v[52:55], a[124:127], v[120:123], v[52:55]
    s_waitcnt lgkmcnt(0)
    v_mfma_f32_16x16x32_bf16 v[56:59], a[60:63], v[124:127], v[56:59]
    v_mfma_f32_16x16x32_bf16 v[60:63], a[124:127], v[124:127], v[60:63]
    v_xor_b32 v128, 0x10000, v128
    v_xor_b32 v129, 0x10000, v129
    v_xor_b32 v130, 0x10000, v130
    v_xor_b32 v131, 0x10000, v131
    v_xor_b32 v132, 0x10000, v132
    v_xor_b32 v133, 0x10000, v133
    v_xor_b32 v134, 0x10000, v134
    v_xor_b32 v135, 0x10000, v135
    v_cvt_pk_bf16_f32 v144, v0, v1
    v_cvt_pk_bf16_f32 v145, v2, v3
    v_cvt_pk_bf16_f32 v146, v4, v5
    v_cvt_pk_bf16_f32 v147, v6, v7
    buffer_store_dwordx4 v[144:147], v137, s[8:11], s25 offen sc1
    v_cvt_pk_bf16_f32 v148, v8, v9
    v_cvt_pk_bf16_f32 v149, v10, v11
    v_cvt_pk_bf16_f32 v150, v12, v13
    v_cvt_pk_bf16_f32 v151, v14, v15
    buffer_store_dwordx4 v[148:151], v137, s[8:11], s25 offen offset:1024 sc1
    v_cvt_pk_bf16_f32 v152, v16, v17
    v_cvt_pk_bf16_f32 v153, v18, v19
    v_cvt_pk_bf16_f32 v154, v20, v21
    v_cvt_pk_bf16_f32 v155, v22, v23
    buffer_store_dwordx4 v[152:155], v137, s[8:11], s25 offen offset:2048 sc1
    v_cvt_pk_bf16_f32 v156, v24, v25
    v_cvt_pk_bf16_f32 v157, v26, v27
    v_cvt_pk_bf16_f32 v158, v28, v29
    v_cvt_pk_bf16_f32 v159, v30, v31
    buffer_store_dwordx4 v[156:159], v137, s[8:11], s25 offen offset:3072 sc1
    v_cvt_pk_bf16_f32 v144, v32, v33
    v_cvt_pk_bf16_f32 v145, v34, v35
    v_cvt_pk_bf16_f32 v146, v36, v37
    v_cvt_pk_bf16_f32 v147, v38, v39
    s_add_u32 s25, s25, 4096
    buffer_store_dwordx4 v[144:147], v137, s[8:11], s25 offen sc1
    v_cvt_pk_bf16_f32 v148, v40, v41
    v_cvt_pk_bf16_f32 v149, v42, v43
    v_cvt_pk_bf16_f32 v150, v44, v45
    v_cvt_pk_bf16_f32 v151, v46, v47
    buffer_store_dwordx4 v[148:151], v137, s[8:11], s25 offen offset:1024 sc1
    v_cvt_pk_bf16_f32 v152, v48, v49
    v_cvt_pk_bf16_f32 v153, v50, v51
    v_cvt_pk_bf16_f32 v154, v52, v53
    v_cvt_pk_bf16_f32 v155, v54, v55
    buffer_store_dwordx4 v[152:155], v137, s[8:11], s25 offen offset:2048 sc1
    v_cvt_pk_bf16_f32 v156, v56, v57
    v_cvt_pk_bf16_f32 v157, v58, v59
    v_cvt_pk_bf16_f32 v158, v60, v61
    v_cvt_pk_bf16_f32 v159, v62, v63
    buffer_store_dwordx4 v[156:159], v137, s[8:11], s25 offen offset:3072 sc1
L_p1_next:
    s_add_u32 s80, s80, 1
    s_lshl_b32 s40, s38, 4
    s_add_u32 s40, s40, s20
    s_lshl_b32 s40, s40, 2
    s_add_u32 s40, s40, 0x2000
    s_sub_u32 s44, s25, 4095
    s_add_u32 s38, s38, s37
    s_branch L_p1_unit
L_p1_end:
    s_waitcnt vmcnt(0)
    s_barrier
    s_cmp_eq_u32 s40, 0
    s_cbranch_scc1 L_nopf_102
    s_cmp_lg_u32 s87, 0
    s_cbranch_scc1 L_modeok_103
    v_readfirstlane_b32 s96, v140
    v_readfirstlane_b32 s97, v141
    s_nop 0
    s_cmp_lg_u32 s97, 0
    s_cselect_b32 s87, s96, 0
    s_cmp_eq_u32 s87, 1
    s_cbranch_scc1 L_modeok_103
    s_mov_b32 s96, 0
L_mode_104:
    buffer_load_dwordx2 v[140:141], off, s[92:95], 0 offset:36 sc1
    s_waitcnt vmcnt(0)
    v_readfirstlane_b32 s87, v140
    v_readfirstlane_b32 s97, v141
    s_nop 0
    s_min_u32 s97, s97, s87
    s_cmp_lg_u32 s97, 0
    s_cbranch_scc1 L_moded_105
    s_sleep 4
    s_add_u32 s96, s96, 1
    s_cmp_lg_u32 s96, 0x100
    s_cbranch_scc1 L_modef_106
    v_mov_b32 v140, 2
    v_mov_b32 v141, 0
    s_mov_b64 exec, 1
    buffer_atomic_cmpswap v[140:141], off, s[92:95], 0 offset:36
    s_mov_b64 exec, -1
L_modef_106:
    s_cmp_lt_u32 s96, 0x10000
    s_cbranch_scc1 L_mode_104
L_moded_105:
    s_cmp_lg_u32 s87, 1
    s_cbranch_scc1 L_fallback
L_modeok_103:
    s_cmp_lg_u32 s100, 0
    s_cbranch_scc1 L_flag_107
    v_mov_b32 v138, 1
    s_mov_b64 exec, 1
    buffer_store_dword v138, off, s[8:11], s40 sc1
    s_mov_b64 exec, -1
L_flag_107:
    s_mov_b32 s40, 0
L_nopf_102:
    s_cmp_lg_u32 s41, 0
    s_cbranch_scc1 L_p1done
    s_mov_b32 s41, 1
    s_mul_i32 s22, s101, 171
    s_lshr_b32 s22, s22, 11
    s_mul_i32 s26, s22, 12
    s_sub_u32 s20, s101, s26
    s_add_u32 s20, s20, 4
    s_mul_i32 s27, s101, 683
    s_lshr_b32 s27, s27, 11
    s_mul_i32 s26, s27, 3
    s_sub_u32 s26, s101, s26
    s_cmp_eq_u32 s26, 2
    s_cselect_b32 s28, 10, 11
    s_cmp_ge_u32 s101, 192
    s_cselect_b32 s20, s26, s20
    s_cselect_b32 s22, s27, s22
    s_cselect_b32 s37, s28, 16
    s_branch L_p1_pass
L_p1done:
    v_mbcnt_lo_u32_b32 v0, -1, 0
    v_mbcnt_hi_u32_b32 v0, -1, v0
    s_lshl_b32 s96, s100, 6
    v_add_u32 v0, s96, v0
    s_and_b32 s20, s101, 15
    s_lshr_b32 s22, s101, 4
    s_mov_b32 s23, 14
    v_mov_b32 v1, 0
    s_lshl_b32 s24, s20, 7
    s_add_u32 s24, s24, 0x1000
    s_mul_i32 s25, s22, 14
    s_lshr_b32 s25, s25, 4
    s_add_u32 s25, s25, 12
    s_cmp_lg_u32 s100, 0
    s_cbranch_scc1 L_polls_110
    s_mov_b32 exec_lo, 0x1
    s_mov_b32 exec_hi, 0
    s_mov_b32 s96, 0
L_poll_108:
    buffer_load_dword v2, v1, s[8:11], s24 offen sc1
    s_waitcnt vmcnt(0)
    v_cmp_gt_u32 vcc, s25, v2
    s_cbranch_vccz L_polld_109
    v_readfirstlane_b32 s97, v2
    s_nop 0
    s_sub_u32 s97, s25, s97
    s_cmp_lt_i32 s97, 3
    s_cbranch_scc1 L_near_111
    s_sleep 40
    s_cmp_lt_i32 s97, 5
    s_cbranch_scc1 L_near_111
    s_sleep 100
L_near_111:
    s_sleep 8
    s_add_u32 s96, s96, 1
    s_cmp_lt_u32 s96, 0x10000
    s_cbranch_scc1 L_poll_108
L_polld_109:
    s_mov_b64 exec, -1
L_polls_110:
    s_barrier
    s_load_dwordx2 s[12:13], s[0:1], 40
    s_waitcnt lgkmcnt(0)
    s_and_b32 s13, s13, 0xffff
    s_mov_b32 s14, 0x400000
    s_mov_b32 s15, 0x20000
    v_lshrrev_b32 v4, 6, v0
    s_nop 0
    v_readfirstlane_b32 s21, v4
    v_and_b32 v1, 63, v0
    v_lshrrev_b32 v2, 4, v1
    v_and_b32 v3, 15, v1
    v_lshrrev_b32 v6, 2, v3
    v_lshlrev_b32 v240, 4, v1
    v_lshlrev_b32 v241, 3, v1
    s_lshl_b32 s27, s21, 10
    s_lshl_b32 s24, s21, 5
    v_xor_b32 v4, s24, v240
    v_add_u32 v8, s27, v4
    v_xor_b32 v9, 128, v8
    v_lshl_add_u32 v4, v2, 2, v6
    v_and_b32 v5, 7, v4
    v_lshlrev_b32 v4, 10, v4
    v_lshl_add_u32 v4, v5, 5, v4
    v_and_b32 v5, 3, v3
    v_lshlrev_b32 v5, 4, v5
    v_xor_b32 v4, v5, v4
    s_lshl_b32 s24, s21, 8
    v_add_u32 v10, s24, v4
    s_lshl_b32 s25, s20, 18
    s_add_u32 s24, s25, 0x0
    s_add_u32 m0, s27, 0x0
    s_nop 0
    buffer_load_dwordx4 v8, s[12:15], s24 offen lds
    s_add_u32 s24, s25, 0x1000
    s_add_u32 m0, s27, 0x1000
    s_nop 0
    buffer_load_dwordx4 v9, s[12:15], s24 offen lds
    s_add_u32 s24, s25, 0x2000
    s_add_u32 m0, s27, 0x2000
    s_nop 0
    buffer_load_dwordx4 v8, s[12:15], s24 offen lds
    s_add_u32 s24, s25, 0x3000
    s_add_u32 m0, s27, 0x3000
    s_nop 0
    buffer_load_dwordx4 v9, s[12:15], s24 offen lds
    s_add_u32 s24, s25, 0x4000
    s_add_u32 m0, s27, 0x4000
    s_nop 0
    buffer_load_dwordx4 v8, s[12:15], s24 offen lds
    s_add_u32 s24, s25, 0x5000
    s_add_u32 m0, s27, 0x5000
    s_nop 0
    buffer_load_dwordx4 v9, s[12:15], s24 offen lds
    s_add_u32 s24, s25, 0x6000
    s_add_u32 m0, s27, 0x6000
    s_nop 0
    buffer_load_dwordx4 v8, s[12:15], s24 offen lds
    s_add_u32 s24, s25, 0x7000
    s_add_u32 m0, s27, 0x7000
    s_nop 0
    buffer_load_dwordx4 v9, s[12:15], s24 offen lds
    s_add_u32 s24, s25, 0x8000
    s_add_u32 m0, s27, 0x8000
    s_nop 0
    buffer_load_dwordx4 v8, s[12:15], s24 offen lds
    s_add_u32 s24, s25, 0x9000
    s_add_u32 m0, s27, 0x9000
    s_nop 0
    buffer_load_dwordx4 v9, s[12:15], s24 offen lds
    s_add_u32 s24, s25, 0xa000
    s_add_u32 m0, s27, 0xa000
    s_nop 0
    buffer_load_dwordx4 v8, s[12:15], s24 offen lds
    s_add_u32 s24, s25, 0xb000
    s_add_u32 m0, s27, 0xb000
    s_nop 0
    buffer_load_dwordx4 v9, s[12:15], s24 offen lds
    s_add_u32 s24, s25, 0xc000
    s_add_u32 m0, s27, 0xc000
    s_nop 0
    buffer_load_dwordx4 v8, s[12:15], s24 offen lds
    s_add_u32 s24, s25, 0xd000
    s_add_u32 m0, s27, 0xd000
    s_nop 0
    buffer_load_dwordx4 v9, s[12:15], s24 offen lds
    s_add_u32 s24, s25, 0xe000
    s_add_u32 m0, s27, 0xe000
    s_nop 0
    buffer_load_dwordx4 v8, s[12:15], s24 offen lds
    s_add_u32 s24, s25, 0xf000
    s_add_u32 m0, s27, 0xf000
    s_nop 0
    buffer_load_dwordx4 v9, s[12:15], s24 offen lds
    s_add_u32 s24, s25, 0x10000
    s_add_u32 m0, s27, 0x10000
    s_nop 0
    buffer_load_dwordx4 v8, s[12:15], s24 offen lds
    s_add_u32 s24, s25, 0x11000
    s_add_u32 m0, s27, 0x11000
    s_nop 0
    buffer_load_dwordx4 v9, s[12:15], s24 offen lds
    s_add_u32 s24, s25, 0x12000
    s_add_u32 m0, s27, 0x12000
    s_nop 0
    buffer_load_dwordx4 v8, s[12:15], s24 offen lds
    s_add_u32 s24, s25, 0x13000
    s_add_u32 m0, s27, 0x13000
    s_nop 0
    buffer_load_dwordx4 v9, s[12:15], s24 offen lds
    s_add_u32 s24, s25, 0x14000
    s_add_u32 m0, s27, 0x14000
    s_nop 0
    buffer_load_dwordx4 v8, s[12:15], s24 offen lds
    s_add_u32 s24, s25, 0x15000
    s_add_u32 m0, s27, 0x15000
    s_nop 0
    buffer_load_dwordx4 v9, s[12:15], s24 offen lds
    s_add_u32 s24, s25, 0x16000
    s_add_u32 m0, s27, 0x16000
    s_nop 0
    buffer_load_dwordx4 v8, s[12:15], s24 offen lds
    s_add_u32 s24, s25, 0x17000
    s_add_u32 m0, s27, 0x17000
    s_nop 0
    buffer_load_dwordx4 v9, s[12:15], s24 offen lds
    s_add_u32 s24, s25, 0x18000
    s_add_u32 m0, s27, 0x18000
    s_nop 0
    buffer_load_dwordx4 v8, s[12:15], s24 offen lds
    s_add_u32 s24, s25, 0x19000
    s_add_u32 m0, s27, 0x19000
    s_nop 0
    buffer_load_dwordx4 v9, s[12:15], s24 offen lds
    s_add_u32 s24, s25, 0x1a000
    s_add_u32 m0, s27, 0x1a000
    s_nop 0
    buffer_load_dwordx4 v8, s[12:15], s24 offen lds
    s_add_u32 s24, s25, 0x1b000
    s_add_u32 m0, s27, 0x1b000
    s_nop 0
    buffer_load_dwordx4 v9, s[12:15], s24 offen lds
    s_add_u32 s24, s25, 0x1c000
    s_add_u32 m0, s27, 0x1c000
    s_nop 0
    buffer_load_dwordx4 v8, s[12:15], s24 offen lds
    s_add_u32 s24, s25, 0x1d000
    s_add_u32 m0, s27, 0x1d000
    s_nop 0
    buffer_load_dwordx4 v9, s[12:15], s24 offen lds
    s_add_u32 s24, s25, 0x1e000
    s_add_u32 m0, s27, 0x1e000
    s_nop 0
    buffer_load_dwordx4 v8, s[12:15], s24 offen lds
    s_add_u32 s24, s25, 0x1f000
    s_add_u32 m0, s27, 0x1f000
    s_nop 0
    buffer_load_dwordx4 v9, s[12:15], s24 offen lds
    s_waitcnt vmcnt(0)
    s_barrier
    v_xor_b32 v11, 0x0, v10
    ds_read_b64_tr_b16 a[0:1], v11
    ds_read_b64_tr_b16 a[2:3], v11 offset:16384
    ds_read_b64_tr_b16 a[32:33], v11 offset:32768
    ds_read_b64_tr_b16 a[34:35], v11 offset:49152
    v_xor_b32 v11, 0x8, v10
    ds_read_b64_tr_b16 a[4:5], v11
    ds_read_b64_tr_b16 a[6:7], v11 offset:16384
    ds_read_b64_tr_b16 a[36:37], v11 offset:32768
    ds_read_b64_tr_b16 a[38:39], v11 offset:49152
    s_waitcnt lgkmcnt(0)
    v_xor_b32 v11, 0x40, v10
    ds_read_b64_tr_b16 a[8:9], v11
    ds_read_b64_tr_b16 a[10:11], v11 offset:16384
    ds_read_b64_tr_b16 a[40:41], v11 offset:32768
    ds_read_b64_tr_b16 a[42:43], v11 offset:49152
    v_xor_b32 v11, 0x48, v10
    ds_read_b64_tr_b16 a[12:13], v11
    ds_read_b64_tr_b16 a[14:15], v11 offset:16384
    ds_read_b64_tr_b16 a[44:45], v11 offset:32768
    ds_read_b64_tr_b16 a[46:47], v11 offset:49152
    s_waitcnt lgkmcnt(0)
    v_xor_b32 v11, 0x80, v10
    ds_read_b64_tr_b16 a[16:17], v11
    ds_read_b64_tr_b16 a[18:19], v11 offset:16384
    ds_read_b64_tr_b16 a[48:49], v11 offset:32768
    ds_read_b64_tr_b16 a[50:51], v11 offset:49152
    v_xor_b32 v11, 0x88, v10
    ds_read_b64_tr_b16 a[20:21], v11
    ds_read_b64_tr_b16 a[22:23], v11 offset:16384
    ds_read_b64_tr_b16 a[52:53], v11 offset:32768
    ds_read_b64_tr_b16 a[54:55], v11 offset:49152
    s_waitcnt lgkmcnt(0)
    v_xor_b32 v11, 0xc0, v10
    ds_read_b64_tr_b16 a[24:25], v11
    ds_read_b64_tr_b16 a[26:27], v11 offset:16384
    ds_read_b64_tr_b16 a[56:57], v11 offset:32768
    ds_read_b64_tr_b16 a[58:59], v11 offset:49152
    v_xor_b32 v11, 0xc8, v10
    ds_read_b64_tr_b16 a[28:29], v11
    ds_read_b64_tr_b16 a[30:31], v11 offset:16384
    ds_read_b64_tr_b16 a[60:61], v11 offset:32768
    ds_read_b64_tr_b16 a[62:63], v11 offset:49152
    s_waitcnt lgkmcnt(0)
    v_xor_b32 v11, 0x10000, v10
    ds_read_b64_tr_b16 a[64:65], v11
    ds_read_b64_tr_b16 a[66:67], v11 offset:16384
    ds_read_b64_tr_b16 a[96:97], v11 offset:32768
    ds_read_b64_tr_b16 a[98:99], v11 offset:49152
    v_xor_b32 v11, 0x10008, v10
    ds_read_b64_tr_b16 a[68:69], v11
    ds_read_b64_tr_b16 a[70:71], v11 offset:16384
    ds_read_b64_tr_b16 a[100:101], v11 offset:32768
    ds_read_b64_tr_b16 a[102:103], v11 offset:49152
    s_waitcnt lgkmcnt(0)
    v_xor_b32 v11, 0x10040, v10
    ds_read_b64_tr_b16 a[72:73], v11
    ds_read_b64_tr_b16 a[74:75], v11 offset:16384
    ds_read_b64_tr_b16 a[104:105], v11 offset:32768
    ds_read_b64_tr_b16 a[106:107], v11 offset:49152
    v_xor_b32 v11, 0x10048, v10
    ds_read_b64_tr_b16 a[76:77], v11
    ds_read_b64_tr_b16 a[78:79], v11 offset:16384
    ds_read_b64_tr_b16 a[108:109], v11 offset:32768
    ds_read_b64_tr_b16 a[110:111], v11 offset:49152
    s_waitcnt lgkmcnt(0)
    v_xor_b32 v11, 0x10080, v10
    ds_read_b64_tr_b16 a[80:81], v11
    ds_read_b64_tr_b16 a[82:83], v11 offset:16384
    ds_read_b64_tr_b16 a[112:113], v11 offset:32768
    ds_read_b64_tr_b16 a[114:115], v11 offset:49152
    v_xor_b32 v11, 0x10088, v10
    ds_read_b64_tr_b16 a[84:85], v11
    ds_read_b64_tr_b16 a[86:87], v11 offset:16384
    ds_read_b64_tr_b16 a[116:117], v11 offset:32768
    ds_read_b64_tr_b16 a[118:119], v11 offset:49152
    s_waitcnt lgkmcnt(0)
    v_xor_b32 v11, 0x100c0, v10
    ds_read_b64_tr_b16 a[88:89], v11
    ds_read_b64_tr_b16 a[90:91], v11 offset:16384
    ds_read_b64_tr_b16 a[120:121], v11 offset:32768
    ds_read_b64_tr_b16 a[122:123], v11 offset:49152
    v_xor_b32 v11, 0x100c8, v10
    ds_read_b64_tr_b16 a[92:93], v11
    ds_read_b64_tr_b16 a[94:95], v11 offset:16384
    ds_read_b64_tr_b16 a[124:125], v11 offset:32768
    ds_read_b64_tr_b16 a[126:127], v11 offset:49152
    s_waitcnt lgkmcnt(0)
    s_barrier
    s_lshl_b32 s25, s20, 18
    s_add_u32 s24, s25, 0x20000
    s_add_u32 m0, s27, 0x0
    s_nop 0
    buffer_load_dwordx4 v8, s[12:15], s24 offen lds
    s_add_u32 s24, s25, 0x21000
    s_add_u32 m0, s27, 0x1000
    s_nop 0
    buffer_load_dwordx4 v9, s[12:15], s24 offen lds
    s_add_u32 s24, s25, 0x22000
    s_add_u32 m0, s27, 0x2000
    s_nop 0
    buffer_load_dwordx4 v8, s[12:15], s24 offen lds
    s_add_u32 s24, s25, 0x23000
    s_add_u32 m0, s27, 0x3000
    s_nop 0
    buffer_load_dwordx4 v9, s[12:15], s24 offen lds
    s_add_u32 s24, s25, 0x24000
    s_add_u32 m0, s27, 0x4000
    s_nop 0
    buffer_load_dwordx4 v8, s[12:15], s24 offen lds
    s_add_u32 s24, s25, 0x25000
    s_add_u32 m0, s27, 0x5000
    s_nop 0
    buffer_load_dwordx4 v9, s[12:15], s24 offen lds
    s_add_u32 s24, s25, 0x26000
    s_add_u32 m0, s27, 0x6000
    s_nop 0
    buffer_load_dwordx4 v8, s[12:15], s24 offen lds
    s_add_u32 s24, s25, 0x27000
    s_add_u32 m0, s27, 0x7000
    s_nop 0
    buffer_load_dwordx4 v9, s[12:15], s24 offen lds
    s_add_u32 s24, s25, 0x28000
    s_add_u32 m0, s27, 0x8000
    s_nop 0
    buffer_load_dwordx4 v8, s[12:15], s24 offen lds
    s_add_u32 s24, s25, 0x29000
    s_add_u32 m0, s27, 0x9000
    s_nop 0
    buffer_load_dwordx4 v9, s[12:15], s24 offen lds
    s_add_u32 s24, s25, 0x2a000
    s_add_u32 m0, s27, 0xa000
    s_nop 0
    buffer_load_dwordx4 v8, s[12:15], s24 offen lds
    s_add_u32 s24, s25, 0x2b000
    s_add_u32 m0, s27, 0xb000
    s_nop 0
    buffer_load_dwordx4 v9, s[12:15], s24 offen lds
    s_add_u32 s24, s25, 0x2c000
    s_add_u32 m0, s27, 0xc000
    s_nop 0
    buffer_load_dwordx4 v8, s[12:15], s24 offen lds
    s_add_u32 s24, s25, 0x2d000
    s_add_u32 m0, s27, 0xd000
    s_nop 0
    buffer_load_dwordx4 v9, s[12:15], s24 offen lds
    s_add_u32 s24, s25, 0x2e000
    s_add_u32 m0, s27, 0xe000
    s_nop 0
    buffer_load_dwordx4 v8, s[12:15], s24 offen lds
    s_add_u32 s24, s25, 0x2f000
    s_add_u32 m0, s27, 0xf000
    s_nop 0
    buffer_load_dwordx4 v9, s[12:15], s24 offen lds
    s_add_u32 s24, s25, 0x30000
    s_add_u32 m0, s27, 0x10000
    s_nop 0
    buffer_load_dwordx4 v8, s[12:15], s24 offen lds
    s_add_u32 s24, s25, 0x31000
    s_add_u32 m0, s27, 0x11000
    s_nop 0
    buffer_load_dwordx4 v9, s[12:15], s24 offen lds
    s_add_u32 s24, s25, 0x32000
    s_add_u32 m0, s27, 0x12000
    s_nop 0
    buffer_load_dwordx4 v8, s[12:15], s24 offen lds
    s_add_u32 s24, s25, 0x33000
    s_add_u32 m0, s27, 0x13000
    s_nop 0
    buffer_load_dwordx4 v9, s[12:15], s24 offen lds
    s_add_u32 s24, s25, 0x34000
    s_add_u32 m0, s27, 0x14000
    s_nop 0
    buffer_load_dwordx4 v8, s[12:15], s24 offen lds
    s_add_u32 s24, s25, 0x35000
    s_add_u32 m0, s27, 0x15000
    s_nop 0
    buffer_load_dwordx4 v9, s[12:15], s24 offen lds
    s_add_u32 s24, s25, 0x36000
    s_add_u32 m0, s27, 0x16000
    s_nop 0
    buffer_load_dwordx4 v8, s[12:15], s24 offen lds
    s_add_u32 s24, s25, 0x37000
    s_add_u32 m0, s27, 0x17000
    s_nop 0
    buffer_load_dwordx4 v9, s[12:15], s24 offen lds
    s_add_u32 s24, s25, 0x38000
    s_add_u32 m0, s27, 0x18000
    s_nop 0
    buffer_load_dwordx4 v8, s[12:15], s24 offen lds
    s_add_u32 s24, s25, 0x39000
    s_add_u32 m0, s27, 0x19000
    s_nop 0
    buffer_load_dwordx4 v9, s[12:15], s24 offen lds
    s_add_u32 s24, s25, 0x3a000
    s_add_u32 m0, s27, 0x1a000
    s_nop 0
    buffer_load_dwordx4 v8, s[12:15], s24 offen lds
    s_add_u32 s24, s25, 0x3b000
    s_add_u32 m0, s27, 0x1b000
    s_nop 0
    buffer_load_dwordx4 v9, s[12:15], s24 offen lds
    s_add_u32 s24, s25, 0x3c000
    s_add_u32 m0, s27, 0x1c000
    s_nop 0
    buffer_load_dwordx4 v8, s[12:15], s24 offen lds
    s_add_u32 s24, s25, 0x3d000
    s_add_u32 m0, s27, 0x1d000
    s_nop 0
    buffer_load_dwordx4 v9, s[12:15], s24 offen lds
    s_add_u32 s24, s25, 0x3e000
    s_add_u32 m0, s27, 0x1e000
    s_nop 0
    buffer_load_dwordx4 v8, s[12:15], s24 offen lds
    s_add_u32 s24, s25, 0x3f000
    s_add_u32 m0, s27, 0x1f000
    s_nop 0
    buffer_load_dwordx4 v9, s[12:15], s24 offen lds
    s_waitcnt vmcnt(0)
    s_barrier
    v_xor_b32 v11, 0x0, v10
    ds_read_b64_tr_b16 a[128:129], v11
    ds_read_b64_tr_b16 a[130:131], v11 offset:16384
    ds_read_b64_tr_b16 a[160:161], v11 offset:32768
    ds_read_b64_tr_b16 a[162:163], v11 offset:49152
    v_xor_b32 v11, 0x8, v10
    ds_read_b64_tr_b16 a[132:133], v11
    ds_read_b64_tr_b16 a[134:135], v11 offset:16384
    ds_read_b64_tr_b16 a[164:165], v11 offset:32768
    ds_read_b64_tr_b16 a[166:167], v11 offset:49152
    s_waitcnt lgkmcnt(0)
    v_xor_b32 v11, 0x40, v10
    ds_read_b64_tr_b16 a[136:137], v11
    ds_read_b64_tr_b16 a[138:139], v11 offset:16384
    ds_read_b64_tr_b16 a[168:169], v11 offset:32768
    ds_read_b64_tr_b16 a[170:171], v11 offset:49152
    v_xor_b32 v11, 0x48, v10
    ds_read_b64_tr_b16 a[140:141], v11
    ds_read_b64_tr_b16 a[142:143], v11 offset:16384
    ds_read_b64_tr_b16 a[172:173], v11 offset:32768
    ds_read_b64_tr_b16 a[174:175], v11 offset:49152
    s_waitcnt lgkmcnt(0)
    v_xor_b32 v11, 0x80, v10
    ds_read_b64_tr_b16 a[144:145], v11
    ds_read_b64_tr_b16 a[146:147], v11 offset:16384
    ds_read_b64_tr_b16 a[176:177], v11 offset:32768
    ds_read_b64_tr_b16 a[178:179], v11 offset:49152
    v_xor_b32 v11, 0x88, v10
    ds_read_b64_tr_b16 a[148:149], v11
    ds_read_b64_tr_b16 a[150:151], v11 offset:16384
    ds_read_b64_tr_b16 a[180:181], v11 offset:32768
    ds_read_b64_tr_b16 a[182:183], v11 offset:49152
    s_waitcnt lgkmcnt(0)
    v_xor_b32 v11, 0xc0, v10
    ds_read_b64_tr_b16 a[152:153], v11
    ds_read_b64_tr_b16 a[154:155], v11 offset:16384
    ds_read_b64_tr_b16 a[184:185], v11 offset:32768
    ds_read_b64_tr_b16 a[186:187], v11 offset:49152
    v_xor_b32 v11, 0xc8, v10
    ds_read_b64_tr_b16 a[156:157], v11
    ds_read_b64_tr_b16 a[158:159], v11 offset:16384
    ds_read_b64_tr_b16 a[188:189], v11 offset:32768
    ds_read_b64_tr_b16 a[190:191], v11 offset:49152
    s_waitcnt lgkmcnt(0)
    v_xor_b32 v11, 0x10000, v10
    ds_read_b64_tr_b16 a[192:193], v11
    ds_read_b64_tr_b16 a[194:195], v11 offset:16384
    ds_read_b64_tr_b16 a[224:225], v11 offset:32768
    ds_read_b64_tr_b16 a[226:227], v11 offset:49152
    v_xor_b32 v11, 0x10008, v10
    ds_read_b64_tr_b16 a[196:197], v11
    ds_read_b64_tr_b16 a[198:199], v11 offset:16384
    ds_read_b64_tr_b16 a[228:229], v11 offset:32768
    ds_read_b64_tr_b16 a[230:231], v11 offset:49152
    s_waitcnt lgkmcnt(0)
    v_xor_b32 v11, 0x10040, v10
    ds_read_b64_tr_b16 a[200:201], v11
    ds_read_b64_tr_b16 a[202:203], v11 offset:16384
    ds_read_b64_tr_b16 a[232:233], v11 offset:32768
    ds_read_b64_tr_b16 a[234:235], v11 offset:49152
    v_xor_b32 v11, 0x10048, v10
    ds_read_b64_tr_b16 a[204:205], v11
    ds_read_b64_tr_b16 a[206:207], v11 offset:16384
    ds_read_b64_tr_b16 a[236:237], v11 offset:32768
    ds_read_b64_tr_b16 a[238:239], v11 offset:49152
    s_waitcnt lgkmcnt(0)
    v_xor_b32 v11, 0x10080, v10
    ds_read_b64_tr_b16 a[208:209], v11
    ds_read_b64_tr_b16 a[210:211], v11 offset:16384
    ds_read_b64_tr_b16 a[240:241], v11 offset:32768
    ds_read_b64_tr_b16 a[242:243], v11 offset:49152
    v_xor_b32 v11, 0x10088, v10
    ds_read_b64_tr_b16 a[212:213], v11
    ds_read_b64_tr_b16 a[214:215], v11 offset:16384
    ds_read_b64_tr_b16 a[244:245], v11 offset:32768
    ds_read_b64_tr_b16 a[246:247], v11 offset:49152
    s_waitcnt lgkmcnt(0)
    v_xor_b32 v11, 0x100c0, v10
    ds_read_b64_tr_b16 a[216:217], v11
    ds_read_b64_tr_b16 a[218:219], v11 offset:16384
    ds_read_b64_tr_b16 a[248:249], v11 offset:32768
    ds_read_b64_tr_b16 a[250:251], v11 offset:49152
    v_xor_b32 v11, 0x100c8, v10
    ds_read_b64_tr_b16 a[220:221], v11
    ds_read_b64_tr_b16 a[222:223], v11 offset:16384
    ds_read_b64_tr_b16 a[252:253], v11 offset:32768
    ds_read_b64_tr_b16 a[254:255], v11 offset:49152
    s_waitcnt lgkmcnt(0)
    s_barrier
    s_and_b32 s24, s21, 1
    s_lshl_b32 s24, s24, 4
    v_add_u32 v4, s24, v3
    v_lshlrev_b32 v5, 2, v2
    v_sub_u32 v4, v4, v5
    v_cmp_le_i32 s[30:31], 0, v4
    v_cmp_le_i32 s[32:33], 1, v4
    v_cmp_le_i32 s[34:35], 2, v4
    v_cmp_le_i32 s[36:37], 3, v4
    v_cmp_le_i32 s[38:39], 16, v4
    v_cmp_le_i32 s[40:41], 17, v4
    v_cmp_le_i32 s[42:43], 18, v4
    v_cmp_le_i32 s[44:45], 19, v4
    s_mov_b32 s28, 0x3e0293ee
    s_mov_b32 s29, 0x3e0293ee
    s_mov_b32 s53, 0xff000000
    v_mov_b32 v136, 0x3f803f80
    v_mov_b32 v137, 0x3f803f80
    v_mov_b32 v138, 0x3f803f80
    v_mov_b32 v139, 0x3f803f80
    v_lshlrev_b32 v4, 10, v3
    v_lshl_add_u32 v4, v2, 4, v4
    s_lshl_b32 s24, s21, 8
    v_add_u32 v242, s24, v4
    s_lshl_b32 s24, s21, 12
    v_add_u32 v243, s24, v240
    v_mov_b32 v244, v240
    s_add_u32 s24, s24, 0x22000
    v_xor_b32 v7, v2, v6
    v_lshl_add_u32 v4, v2, 4, v7
    v_and_b32 v5, 3, v3
    v_lshl_add_u32 v4, v4, 2, v5
    v_lshl_add_u32 v253, v4, 2, s24
    v_lshl_add_u32 v4, v3, 2, v7
    v_lshl_add_u32 v254, v4, 4, s24
    s_load_dwordx2 s[12:13], s[0:1], 0
    s_waitcnt lgkmcnt(0)
    s_and_b32 s13, s13, 0xffff
    s_mov_b32 s14, 0x200000
    s_mov_b32 s15, 0x20000
    s_load_dwordx2 s[16:17], s[0:1], 96
    s_waitcnt lgkmcnt(0)
    s_and_b32 s17, s17, 0xffff
    s_mov_b32 s18, 0x200000
    s_mov_b32 s19, 0x20000
    s_load_dwordx2 s[56:57], s[0:1], 64
    s_waitcnt lgkmcnt(0)
    s_and_b32 s57, s57, 0xffff
    s_mov_b32 s58, 0x400
    s_mov_b32 s59, 0x20000
    v_and_b32 v100, 63, v0
    v_lshlrev_b32 v240, 4, v100
    buffer_load_dwordx4 v[236:239], v240, s[56:59], 0 offen
    s_mov_b32 s65, 0x3f80
    s_mov_b32 s66, 0x3f800000
    s_waitcnt vmcnt(0)
    s_sub_u32 s67, s101, 128
    s_cmp_ge_u32 s67, 56
    s_cbranch_scc1 L_nostage_112
L_nostage_112:
    v_lshrrev_b32 v246, 2, v240
    s_lshl_b32 s24, s20, 7
    s_add_u32 s24, s24, 0x2000
    s_cmp_lg_u32 s100, 0
    s_cbranch_scc1 L_polls_115
    s_mov_b32 exec_lo, 0xffffffff
    s_mov_b32 exec_hi, 0
    s_mov_b32 s96, 0
L_poll_113:
    buffer_load_dword v247, v246, s[8:11], s24 offen sc1
    s_waitcnt vmcnt(0)
    v_cmp_gt_u32 vcc, 1, v247
    s_cbranch_vccz L_polld_114
    s_sleep 32
    s_add_u32 s96, s96, 1
    s_cmp_lt_u32 s96, 0x10000
    s_cbranch_scc1 L_poll_113
L_polld_114:
    s_mov_b64 exec, -1
L_polls_115:
    s_barrier
    s_lshl_b32 s24, s20, 7
    s_add_u32 s24, s24, 0x2800
    s_cmp_lg_u32 s100, 0
    s_cbranch_scc1 L_polls_118
    s_mov_b32 exec_lo, 0xffffffff
    s_mov_b32 exec_hi, 0
    s_mov_b32 s96, 0
L_poll_116:
    buffer_load_dword v247, v246, s[8:11], s24 offen sc1
    s_waitcnt vmcnt(0)
    v_cmp_gt_u32 vcc, 1, v247
    s_cbranch_vccz L_polld_117
    s_sleep 32
    s_add_u32 s96, s96, 1
    s_cmp_lt_u32 s96, 0x10000
    s_cbranch_scc1 L_poll_116
L_polld_117:
    s_mov_b64 exec, -1
L_polls_118:
    s_barrier
    s_lshl_b32 s24, s20, 7
    s_add_u32 s24, s24, 0x3000
    s_cmp_lg_u32 s100, 0
    s_cbranch_scc1 L_polls_121
    s_mov_b32 exec_lo, 0xffffffff
    s_mov_b32 exec_hi, 0
    s_mov_b32 s96, 0
L_poll_119:
    buffer_load_dword v247, v246, s[8:11], s24 offen sc1
    s_waitcnt vmcnt(0)
    v_cmp_gt_u32 vcc, 1, v247
    s_cbranch_vccz L_polld_120
    s_sleep 32
    s_add_u32 s96, s96, 1
    s_cmp_lt_u32 s96, 0x10000
    s_cbranch_scc1 L_poll_119
L_polld_120:
    s_mov_b64 exec, -1
L_polls_121:
    s_barrier
    s_mov_b32 s80, 0
L_p2_seg:
    s_cmp_ge_u32 s22, 64
    s_cbranch_scc1 L_p2_end
    v_lshrrev_b32 v246, 2, v240
    s_lshl_b32 s24, s20, 7
    s_add_u32 s24, s24, 0x1000
    s_mul_i32 s25, s22, 10
    s_lshr_b32 s25, s25, 4
    s_add_u32 s25, s25, 17
    s_cmp_lg_u32 s100, 0
    s_cbranch_scc1 L_polls_124
    s_mov_b32 exec_lo, 0x1
    s_mov_b32 exec_hi, 0
    s_mov_b32 s96, 0
L_poll_122:
    buffer_load_dword v247, v246, s[8:11], s24 offen sc1
    s_waitcnt vmcnt(0)
    v_cmp_gt_u32 vcc, s25, v247
    s_cbranch_vccz L_polld_123
    v_readfirstlane_b32 s97, v247
    s_nop 0
    s_sub_u32 s97, s25, s97
    s_cmp_lt_i32 s97, 3
    s_cbranch_scc1 L_near_125
    s_sleep 40
    s_cmp_lt_i32 s97, 5
    s_cbranch_scc1 L_near_125
    s_sleep 100
L_near_125:
    s_sleep 8
    s_add_u32 s96, s96, 1
    s_cmp_lt_u32 s96, 0x10000
    s_cbranch_scc1 L_poll_122
L_polld_123:
    s_mov_b64 exec, -1
L_polls_124:
    s_barrier
    s_cmp_ge_u32 s67, 56
    s_cbranch_scc1 L_nostage_126
    v_mbcnt_lo_u32_b32 v0, -1, 0
    v_mbcnt_hi_u32_b32 v0, -1, v0
    s_lshl_b32 s96, s100, 6
    v_add_u32 v0, s96, v0
    v_lshrrev_b32 v2, 6, v0
    s_nop 0
    v_readfirstlane_b32 s68, v2
    v_and_b32 v1, 63, v0
    s_lshl_b32 s73, s68, 10
    v_lshrrev_b32 v2, 2, v1
    s_lshl_b32 s71, s68, 4
    v_add_u32 v2, s71, v2
    s_movk_i32 s71, 3584
    v_mul_lo_u32 v2, v2, s71
    v_and_b32 v3, 3, v1
    v_lshl_add_u32 v4, v3, 4, v2
    s_cmp_lg_u32 s80, 0
    s_cbranch_scc1 L_part_127
    s_load_dwordx2 s[76:77], s[0:1], 72
    s_waitcnt lgkmcnt(0)
    s_and_b32 s77, s77, 0xffff
    s_mov_b32 s78, 0x1c0000
    s_mov_b32 s79, 0x20000
    s_lshl_b32 s71, s67, 6
    s_add_u32 s71, s71, 0x0
    s_add_u32 m0, s73, 0x8000
    s_nop 0
    buffer_load_dwordx4 v4, s[76:79], s71 offen lds
    s_lshl_b32 s71, s67, 6
    s_add_u32 s71, s71, 0x38000
    s_add_u32 m0, s73, 0x9000
    s_nop 0
    buffer_load_dwordx4 v4, s[76:79], s71 offen lds
    s_lshl_b32 s71, s67, 6
    s_add_u32 s71, s71, 0x70000
    s_add_u32 m0, s73, 0xa000
    s_nop 0
    buffer_load_dwordx4 v4, s[76:79], s71 offen lds
    s_lshl_b32 s71, s67, 6
    s_add_u32 s71, s71, 0xa8000
    s_add_u32 m0, s73, 0xb000
    s_nop 0
    buffer_load_dwordx4 v4, s[76:79], s71 offen lds
    s_lshl_b32 s71, s67, 6
    s_add_u32 s71, s71, 0xe0000
    s_add_u32 m0, s73, 0xc000
    s_nop 0
    buffer_load_dwordx4 v4, s[76:79], s71 offen lds
    s_lshl_b32 s71, s67, 6
    s_add_u32 s71, s71, 0x118000
    s_add_u32 m0, s73, 0xd000
    s_nop 0
    buffer_load_dwordx4 v4, s[76:79], s71 offen lds
    s_lshl_b32 s71, s67, 6
    s_add_u32 s71, s71, 0x150000
    s_add_u32 m0, s73, 0xe000
    s_nop 0
    buffer_load_dwordx4 v4, s[76:79], s71 offen lds
    s_lshl_b32 s71, s67, 6
    s_add_u32 s71, s71, 0x188000
    s_add_u32 m0, s73, 0xf000
    s_nop 0
    buffer_load_dwordx4 v4, s[76:79], s71 offen lds
L_part_127:
    s_cmp_lg_u32 s80, 4
    s_cbranch_scc1 L_part_128
    s_load_dwordx2 s[76:77], s[0:1], 80
    s_waitcnt lgkmcnt(0)
    s_and_b32 s77, s77, 0xffff
    s_mov_b32 s78, 0x1c0000
    s_mov_b32 s79, 0x20000
    s_lshl_b32 s71, s67, 6
    s_add_u32 s71, s71, 0x0
    s_add_u32 m0, s73, 0x10000
    s_nop 0
    buffer_load_dwordx4 v4, s[76:79], s71 offen lds
    s_lshl_b32 s71, s67, 6
    s_add_u32 s71, s71, 0x38000
    s_add_u32 m0, s73, 0x11000
    s_nop 0
    buffer_load_dwordx4 v4, s[76:79], s71 offen lds
    s_lshl_b32 s71, s67, 6
    s_add_u32 s71, s71, 0x70000
    s_add_u32 m0, s73, 0x12000
    s_nop 0
    buffer_load_dwordx4 v4, s[76:79], s71 offen lds
    s_lshl_b32 s71, s67, 6
    s_add_u32 s71, s71, 0xa8000
    s_add_u32 m0, s73, 0x13000
    s_nop 0
    buffer_load_dwordx4 v4, s[76:79], s71 offen lds
    s_lshl_b32 s71, s67, 6
    s_add_u32 s71, s71, 0xe0000
    s_add_u32 m0, s73, 0x14000
    s_nop 0
    buffer_load_dwordx4 v4, s[76:79], s71 offen lds
    s_lshl_b32 s71, s67, 6
    s_add_u32 s71, s71, 0x118000
    s_add_u32 m0, s73, 0x15000
    s_nop 0
    buffer_load_dwordx4 v4, s[76:79], s71 offen lds
    s_lshl_b32 s71, s67, 6
    s_add_u32 s71, s71, 0x150000
    s_add_u32 m0, s73, 0x16000
    s_nop 0
    buffer_load_dwordx4 v4, s[76:79], s71 offen lds
    s_lshl_b32 s71, s67, 6
    s_add_u32 s71, s71, 0x188000
    s_add_u32 m0, s73, 0x17000
    s_nop 0
    buffer_load_dwordx4 v4, s[76:79], s71 offen lds
L_part_128:
    s_cmp_lg_u32 s80, 8
    s_cbranch_scc1 L_part_129
    s_load_dwordx2 s[76:77], s[0:1], 88
    s_waitcnt lgkmcnt(0)
    s_and_b32 s77, s77, 0xffff
    s_mov_b32 s78, 0x1c0000
    s_mov_b32 s79, 0x20000
    v_lshlrev_b32 v5, 4, v1
    v_add_u32 v5, s73, v5
    s_lshl_b32 s71, s67, 15
    s_add_u32 s71, s71, 0
    s_add_u32 m0, s73, 0x18000
    s_nop 0
    buffer_load_dwordx4 v5, s[76:79], s71 offen lds
    s_lshl_b32 s71, s67, 15
    s_add_u32 s71, s71, 4096
    s_add_u32 m0, s73, 0x19000
    s_nop 0
    buffer_load_dwordx4 v5, s[76:79], s71 offen lds
    s_lshl_b32 s71, s67, 15
    s_add_u32 s71, s71, 8192
    s_add_u32 m0, s73, 0x1a000
    s_nop 0
    buffer_load_dwordx4 v5, s[76:79], s71 offen lds
    s_lshl_b32 s71, s67, 15
    s_add_u32 s71, s71, 12288
    s_add_u32 m0, s73, 0x1b000
    s_nop 0
    buffer_load_dwordx4 v5, s[76:79], s71 offen lds
    s_lshl_b32 s71, s67, 15
    s_add_u32 s71, s71, 16384
    s_add_u32 m0, s73, 0x1c000
    s_nop 0
    buffer_load_dwordx4 v5, s[76:79], s71 offen lds
    s_lshl_b32 s71, s67, 15
    s_add_u32 s71, s71, 20480
    s_add_u32 m0, s73, 0x1d000
    s_nop 0
    buffer_load_dwordx4 v5, s[76:79], s71 offen lds
    s_lshl_b32 s71, s67, 15
    s_add_u32 s71, s71, 24576
    s_add_u32 m0, s73, 0x1e000
    s_nop 0
    buffer_load_dwordx4 v5, s[76:79], s71 offen lds
    s_lshl_b32 s71, s67, 15
    s_add_u32 s71, s71, 28672
    s_add_u32 m0, s73, 0x1f000
    s_nop 0
    buffer_load_dwordx4 v5, s[76:79], s71 offen lds
L_part_129:
L_nostage_126:
    s_lshl_b32 s24, s22, 5
    s_lshl_b32 s25, s20, 1
    s_add_u32 s24, s24, s25
    s_lshr_b32 s25, s21, 1
    s_add_u32 s24, s24, s25
    s_lshl_b32 s25, s24, 13
    s_add_u32 s47, s25, 0x1000000
    s_add_u32 s54, s47, 4096
    s_add_u32 s48, s25, 0x2000000
    s_add_u32 s55, s48, 4096
    s_and_b32 s26, s21, 1
    s_lshl_b32 s26, s26, 12
    s_add_u32 s46, s25, s26
    s_add_u32 s46, s46, 0x3000000
    s_lshl_b32 s25, s24, 12
    s_add_u32 s49, s25, 0x240000
    s_lshl_b32 s24, s22, 4
    s_add_u32 s24, s24, s20
    s_lshl_b32 s24, s24, 15
    s_add_u32 s51, s24, 0x4000000
    buffer_load_dwordx4 v[0:3], v240, s[8:11], s46 offen
    buffer_load_dwordx4 v[4:7], v240, s[8:11], s46 offen offset:1024
    buffer_load_dwordx4 v[8:11], v240, s[8:11], s46 offen offset:2048
    buffer_load_dwordx4 v[12:15], v240, s[8:11], s46 offen offset:3072
    buffer_load_dwordx4 v[16:19], v240, s[8:11], s47 offen
    buffer_load_dwordx4 v[20:23], v240, s[8:11], s47 offen offset:1024
    buffer_load_dwordx4 v[24:27], v240, s[8:11], s47 offen offset:2048
    buffer_load_dwordx4 v[28:31], v240, s[8:11], s47 offen offset:3072
    buffer_load_dwordx4 v[32:35], v240, s[8:11], s54 offen
    buffer_load_dwordx4 v[36:39], v240, s[8:11], s54 offen offset:1024
    buffer_load_dwordx4 v[40:43], v240, s[8:11], s54 offen offset:2048
    buffer_load_dwordx4 v[44:47], v240, s[8:11], s54 offen offset:3072
    buffer_load_dwordx4 v[64:67], v240, s[8:11], s48 offen
    buffer_load_dwordx4 v[68:71], v240, s[8:11], s48 offen offset:1024
    buffer_load_dwordx4 v[72:75], v240, s[8:11], s48 offen offset:2048
    buffer_load_dwordx4 v[76:79], v240, s[8:11], s48 offen offset:3072
    buffer_load_dwordx4 v[80:83], v240, s[8:11], s55 offen
    buffer_load_dwordx4 v[84:87], v240, s[8:11], s55 offen offset:1024
    buffer_load_dwordx4 v[88:91], v240, s[8:11], s55 offen offset:2048
    buffer_load_dwordx4 v[92:95], v240, s[8:11], s55 offen offset:3072
    s_waitcnt vmcnt(8)
    v_mfma_f32_16x16x32_bf16 v[116:119], v[16:19], v[0:3], 0
    v_mfma_f32_16x16x32_bf16 v[116:119], v[20:23], v[4:7], v[116:119]
    v_mfma_f32_16x16x32_bf16 v[116:119], v[24:27], v[8:11], v[116:119]
    v_mfma_f32_16x16x32_bf16 v[116:119], v[28:31], v[12:15], v[116:119]
    v_mfma_f32_16x16x32_bf16 v[120:123], v[32:35], v[0:3], 0
    v_mfma_f32_16x16x32_bf16 v[120:123], v[36:39], v[4:7], v[120:123]
    v_mfma_f32_16x16x32_bf16 v[120:123], v[40:43], v[8:11], v[120:123]
    v_mfma_f32_16x16x32_bf16 v[120:123], v[44:47], v[12:15], v[120:123]
    v_mov_b32 v247, s53
    v_cndmask_b32 v116, v247, v116, s[30:31]
    v_cndmask_b32 v117, v247, v117, s[32:33]
    v_cndmask_b32 v118, v247, v118, s[34:35]
    v_cndmask_b32 v119, v247, v119, s[36:37]
    s_nop 2
    v_cndmask_b32 v120, v247, v120, s[38:39]
    v_cndmask_b32 v121, v247, v121, s[40:41]
    v_cndmask_b32 v122, v247, v122, s[42:43]
    v_cndmask_b32 v123, v247, v123, s[44:45]
    v_max3_f32 v251, v116, v117, v118
    v_max3_f32 v251, v251, v119, v120
    v_max3_f32 v251, v251, v121, v122
    v_lshrrev_b32 v246, 2, v240
    s_lshl_b32 s24, s20, 7
    s_add_u32 s24, s24, 0x1000
    s_add_u32 s25, s22, 1
    s_nop 1
    s_cmp_lg_u32 s100, 0
    s_cbranch_scc1 L_polls_132
    s_mov_b32 exec_lo, 0x11
    s_mov_b32 exec_hi, 0
    s_mov_b32 s96, 0
L_poll_130:
    buffer_load_dword v247, v246, s[8:11], s24 offen sc1
    s_waitcnt vmcnt(0)
    v_cmp_gt_u32 vcc, s25, v247
    s_cbranch_vccz L_polld_131
    v_readfirstlane_b32 s97, v247
    s_nop 0
    s_sub_u32 s97, s25, s97
    s_cmp_lt_i32 s97, 3
    s_cbranch_scc1 L_near_133
    s_sleep 40
    s_cmp_lt_i32 s97, 5
    s_cbranch_scc1 L_near_133
    s_sleep 100
L_near_133:
    s_sleep 8
    s_add_u32 s96, s96, 1
    s_cmp_lt_u32 s96, 0x10000
    s_cbranch_scc1 L_poll_130
L_polld_131:
    s_mov_b64 exec, -1
L_polls_132:
    s_barrier
    buffer_load_dwordx4 v[172:175], v240, s[8:11], s49 offen
    buffer_load_dwordx4 v[176:179], v240, s[8:11], s49 offen offset:1024
    buffer_load_dwordx4 v[180:183], v240, s[8:11], s49 offen offset:2048
    buffer_load_dwordx4 v[184:187], v240, s[8:11], s49 offen offset:3072
    s_waitcnt vmcnt(0)
    ds_write_b32 v253, v173
    ds_write_b32 v253, v175 offset:64
    ds_write_b32 v253, v177 offset:1024
    ds_write_b32 v253, v179 offset:1088
    ds_write_b32 v253, v181 offset:2048
    ds_write_b32 v253, v183 offset:2112
    ds_write_b32 v253, v185 offset:3072
    ds_write_b32 v253, v187 offset:3136
    ds_read_b128 v[48:51], v254
    ds_read_b128 v[52:55], v254 offset:1024
    ds_read_b128 v[56:59], v254 offset:2048
    ds_read_b128 v[60:63], v254 offset:3072
    s_waitcnt lgkmcnt(0)
    v_mfma_f32_16x16x32_bf16 v[112:115], v[48:51], v[0:3], 0
    v_mfma_f32_16x16x32_bf16 v[112:115], v[52:55], v[4:7], v[112:115]
    v_mfma_f32_16x16x32_bf16 v[112:115], v[56:59], v[8:11], v[112:115]
    v_mfma_f32_16x16x32_bf16 v[112:115], v[60:63], v[12:15], v[112:115]
    v_mov_b32 v246, v251
    s_nop 6
    v_max3_f32 v246, v246, v123, v112
    v_max_f32 v246, v246, v113
    v_mov_b32 v247, v246
    s_nop 1
    v_permlane32_swap_b32 v247, v246
    v_max_f32 v246, v247, v246
    v_mov_b32 v247, v246
    s_nop 1
    v_permlane16_swap_b32 v247, v246
    v_max_f32 v246, v247, v246
    v_mul_f32 v248, s28, v246
    v_pk_fma_f32 v[116:117], v[116:117], s[28:29], v[248:249] op_sel_hi:[1,1,0] neg_lo:[0,0,1] neg_hi:[0,0,1]
    v_pk_fma_f32 v[118:119], v[118:119], s[28:29], v[248:249] op_sel_hi:[1,1,0] neg_lo:[0,0,1] neg_hi:[0,0,1]
    v_pk_fma_f32 v[120:121], v[120:121], s[28:29], v[248:249] op_sel_hi:[1,1,0] neg_lo:[0,0,1] neg_hi:[0,0,1]
    v_pk_fma_f32 v[122:123], v[122:123], s[28:29], v[248:249] op_sel_hi:[1,1,0] neg_lo:[0,0,1] neg_hi:[0,0,1]
    v_pk_fma_f32 v[112:113], v[112:113], s[28:29], v[248:249] op_sel_hi:[1,1,0] neg_lo:[0,0,1] neg_hi:[0,0,1]
    v_exp_f32 v116, v116
    v_exp_f32 v117, v117
    v_exp_f32 v118, v118
    v_exp_f32 v119, v119
    v_exp_f32 v120, v120
    v_exp_f32 v121, v121
    v_exp_f32 v122, v122
    v_exp_f32 v123, v123
    v_exp_f32 v112, v112
    v_exp_f32 v113, v113
    v_cvt_pk_bf16_f32 v124, v116, v117
    v_cvt_pk_bf16_f32 v125, v118, v119
    v_cvt_pk_bf16_f32 v126, v120, v121
    v_cvt_pk_bf16_f32 v127, v122, v123
    v_cvt_pk_bf16_f32 v128, v112, v113
    v_mov_b32 v129, 0
    v_mfma_f32_16x16x32_bf16 v[132:135], v[136:139], v[124:127], 0
    v_mfma_f32_16x16x32_bf16 v[140:143], v[64:67], v[124:127], 0
    v_mfma_f32_16x16x32_bf16 v[144:147], v[68:71], v[124:127], 0
    v_mfma_f32_16x16x32_bf16 v[148:151], v[72:75], v[124:127], 0
    v_mfma_f32_16x16x32_bf16 v[152:155], v[76:79], v[124:127], 0
    v_mfma_f32_16x16x32_bf16 v[156:159], v[80:83], v[124:127], 0
    v_mfma_f32_16x16x32_bf16 v[160:163], v[84:87], v[124:127], 0
    v_mfma_f32_16x16x32_bf16 v[164:167], v[88:91], v[124:127], 0
    v_mfma_f32_16x16x32_bf16 v[168:171], v[92:95], v[124:127], 0
    v_mfma_f32_16x16x16_bf16 v[132:135], v[136:137], v[128:129], v[132:135]
    v_mfma_f32_16x16x16_bf16 v[140:143], v[172:173], v[128:129], v[140:143]
    v_mfma_f32_16x16x16_bf16 v[144:147], v[174:175], v[128:129], v[144:147]
    v_mfma_f32_16x16x16_bf16 v[148:151], v[176:177], v[128:129], v[148:151]
    v_mfma_f32_16x16x16_bf16 v[152:155], v[178:179], v[128:129], v[152:155]
    v_mfma_f32_16x16x16_bf16 v[156:159], v[180:181], v[128:129], v[156:159]
    v_mfma_f32_16x16x16_bf16 v[160:163], v[182:183], v[128:129], v[160:163]
    v_mfma_f32_16x16x16_bf16 v[164:167], v[184:185], v[128:129], v[164:167]
    v_mfma_f32_16x16x16_bf16 v[168:171], v[186:187], v[128:129], v[168:171]
    v_rcp_f32 v250, v132
    s_nop 0
    v_pk_mul_f32 v[140:141], v[140:141], v[250:251] op_sel_hi:[1,0]
    v_pk_mul_f32 v[142:143], v[142:143], v[250:251] op_sel_hi:[1,0]
    v_pk_mul_f32 v[144:145], v[144:145], v[250:251] op_sel_hi:[1,0]
    v_pk_mul_f32 v[146:147], v[146:147], v[250:251] op_sel_hi:[1,0]
    v_pk_mul_f32 v[148:149], v[148:149], v[250:251] op_sel_hi:[1,0]
    v_pk_mul_f32 v[150:151], v[150:151], v[250:251] op_sel_hi:[1,0]
    v_pk_mul_f32 v[152:153], v[152:153], v[250:251] op_sel_hi:[1,0]
    v_pk_mul_f32 v[154:155], v[154:155], v[250:251] op_sel_hi:[1,0]
    v_pk_mul_f32 v[156:157], v[156:157], v[250:251] op_sel_hi:[1,0]
    v_pk_mul_f32 v[158:159], v[158:159], v[250:251] op_sel_hi:[1,0]
    v_pk_mul_f32 v[160:161], v[160:161], v[250:251] op_sel_hi:[1,0]
    v_pk_mul_f32 v[162:163], v[162:163], v[250:251] op_sel_hi:[1,0]
    v_pk_mul_f32 v[164:165], v[164:165], v[250:251] op_sel_hi:[1,0]
    v_pk_mul_f32 v[166:167], v[166:167], v[250:251] op_sel_hi:[1,0]
    v_pk_mul_f32 v[168:169], v[168:169], v[250:251] op_sel_hi:[1,0]
    v_pk_mul_f32 v[170:171], v[170:171], v[250:251] op_sel_hi:[1,0]
    v_cvt_pk_bf16_f32 v140, v140, v141
    v_cvt_pk_bf16_f32 v141, v142, v143
    v_cvt_pk_bf16_f32 v142, v144, v145
    v_cvt_pk_bf16_f32 v143, v146, v147
    v_cvt_pk_bf16_f32 v144, v148, v149
    v_cvt_pk_bf16_f32 v145, v150, v151
    v_cvt_pk_bf16_f32 v146, v152, v153
    v_cvt_pk_bf16_f32 v147, v154, v155
    v_cvt_pk_bf16_f32 v148, v156, v157
    v_cvt_pk_bf16_f32 v149, v158, v159
    v_cvt_pk_bf16_f32 v150, v160, v161
    v_cvt_pk_bf16_f32 v151, v162, v163
    v_cvt_pk_bf16_f32 v152, v164, v165
    v_cvt_pk_bf16_f32 v153, v166, v167
    v_cvt_pk_bf16_f32 v154, v168, v169
    v_cvt_pk_bf16_f32 v155, v170, v171
    ds_write_b128 v243, v[140:143]
    ds_write_b128 v243, v[144:147] offset:1024
    ds_write_b128 v243, v[148:151] offset:2048
    ds_write_b128 v243, v[152:155] offset:3072
    s_waitcnt lgkmcnt(0)
    s_barrier
    ds_read_b128 v[0:3], v244
    ds_read_b128 v[4:7], v244 offset:1024
    ds_read_b128 v[8:11], v244 offset:2048
    ds_read_b128 v[12:15], v244 offset:3072
    ds_read_b128 v[16:19], v244 offset:4096
    ds_read_b128 v[20:23], v244 offset:5120
    ds_read_b128 v[24:27], v244 offset:6144
    ds_read_b128 v[28:31], v244 offset:7168
    s_waitcnt lgkmcnt(4)
    ds_read_b128 v[32:35], v244 offset:8192
    ds_read_b128 v[36:39], v244 offset:9216
    ds_read_b128 v[40:43], v244 offset:10240
    ds_read_b128 v[44:47], v244 offset:11264
    ds_read_b128 v[48:51], v244 offset:12288
    ds_read_b128 v[52:55], v244 offset:13312
    ds_read_b128 v[56:59], v244 offset:14336
    ds_read_b128 v[60:63], v244 offset:15360
    v_xor_b32 v243, 0x4000, v243
    v_xor_b32 v244, 0x4000, v244
    s_waitcnt lgkmcnt(0)
    v_mfma_f32_16x16x32_bf16 v[172:175], a[0:3], v[0:3], 0
    v_mfma_f32_16x16x32_bf16 v[176:179], a[4:7], v[0:3], 0
    v_mfma_f32_16x16x32_bf16 v[180:183], a[8:11], v[0:3], 0
    v_mfma_f32_16x16x32_bf16 v[184:187], a[12:15], v[0:3], 0
    v_mfma_f32_16x16x32_bf16 v[188:191], a[16:19], v[0:3], 0
    v_mfma_f32_16x16x32_bf16 v[192:195], a[20:23], v[0:3], 0
    v_mfma_f32_16x16x32_bf16 v[196:199], a[24:27], v[0:3], 0
    v_mfma_f32_16x16x32_bf16 v[200:203], a[28:31], v[0:3], 0
    v_mfma_f32_16x16x32_bf16 v[172:175], a[32:35], v[4:7], v[172:175]
    v_mfma_f32_16x16x32_bf16 v[176:179], a[36:39], v[4:7], v[176:179]
    v_mfma_f32_16x16x32_bf16 v[180:183], a[40:43], v[4:7], v[180:183]
    v_mfma_f32_16x16x32_bf16 v[184:187], a[44:47], v[4:7], v[184:187]
    v_mfma_f32_16x16x32_bf16 v[188:191], a[48:51], v[4:7], v[188:191]
    v_mfma_f32_16x16x32_bf16 v[192:195], a[52:55], v[4:7], v[192:195]
    v_mfma_f32_16x16x32_bf16 v[196:199], a[56:59], v[4:7], v[196:199]
    v_mfma_f32_16x16x32_bf16 v[200:203], a[60:63], v[4:7], v[200:203]
    v_mfma_f32_16x16x32_bf16 v[172:175], a[64:67], v[8:11], v[172:175]
    v_mfma_f32_16x16x32_bf16 v[176:179], a[68:71], v[8:11], v[176:179]
    v_mfma_f32_16x16x32_bf16 v[180:183], a[72:75], v[8:11], v[180:183]
    v_mfma_f32_16x16x32_bf16 v[184:187], a[76:79], v[8:11], v[184:187]
    v_mfma_f32_16x16x32_bf16 v[188:191], a[80:83], v[8:11], v[188:191]
    v_mfma_f32_16x16x32_bf16 v[192:195], a[84:87], v[8:11], v[192:195]
    v_mfma_f32_16x16x32_bf16 v[196:199], a[88:91], v[8:11], v[196:199]
    v_mfma_f32_16x16x32_bf16 v[200:203], a[92:95], v[8:11], v[200:203]
    v_mfma_f32_16x16x32_bf16 v[172:175], a[96:99], v[12:15], v[172:175]
    v_mfma_f32_16x16x32_bf16 v[176:179], a[100:103], v[12:15], v[176:179]
    v_mfma_f32_16x16x32_bf16 v[180:183], a[104:107], v[12:15], v[180:183]
    v_mfma_f32_16x16x32_bf16 v[184:187], a[108:111], v[12:15], v[184:187]
    v_mfma_f32_16x16x32_bf16 v[188:191], a[112:115], v[12:15], v[188:191]
    v_mfma_f32_16x16x32_bf16 v[192:195], a[116:119], v[12:15], v[192:195]
    v_mfma_f32_16x16x32_bf16 v[196:199], a[120:123], v[12:15], v[196:199]
    v_mfma_f32_16x16x32_bf16 v[200:203], a[124:127], v[12:15], v[200:203]
    v_mfma_f32_16x16x32_bf16 v[172:175], a[128:131], v[32:35], v[172:175]
    v_mfma_f32_16x16x32_bf16 v[176:179], a[132:135], v[32:35], v[176:179]
    v_mfma_f32_16x16x32_bf16 v[180:183], a[136:139], v[32:35], v[180:183]
    v_mfma_f32_16x16x32_bf16 v[184:187], a[140:143], v[32:35], v[184:187]
    v_mfma_f32_16x16x32_bf16 v[188:191], a[144:147], v[32:35], v[188:191]
    v_mfma_f32_16x16x32_bf16 v[192:195], a[148:151], v[32:35], v[192:195]
    v_mfma_f32_16x16x32_bf16 v[196:199], a[152:155], v[32:35], v[196:199]
    v_mfma_f32_16x16x32_bf16 v[200:203], a[156:159], v[32:35], v[200:203]
    v_mfma_f32_16x16x32_bf16 v[172:175], a[160:163], v[36:39], v[172:175]
    v_mfma_f32_16x16x32_bf16 v[176:179], a[164:167], v[36:39], v[176:179]
    v_mfma_f32_16x16x32_bf16 v[180:183], a[168:171], v[36:39], v[180:183]
    v_mfma_f32_16x16x32_bf16 v[184:187], a[172:175], v[36:39], v[184:187]
    v_mfma_f32_16x16x32_bf16 v[188:191], a[176:179], v[36:39], v[188:191]
    v_mfma_f32_16x16x32_bf16 v[192:195], a[180:183], v[36:39], v[192:195]
    v_mfma_f32_16x16x32_bf16 v[196:199], a[184:187], v[36:39], v[196:199]
    v_mfma_f32_16x16x32_bf16 v[200:203], a[188:191], v[36:39], v[200:203]
    v_mfma_f32_16x16x32_bf16 v[172:175], a[192:195], v[40:43], v[172:175]
    v_mfma_f32_16x16x32_bf16 v[176:179], a[196:199], v[40:43], v[176:179]
    v_mfma_f32_16x16x32_bf16 v[180:183], a[200:203], v[40:43], v[180:183]
    v_mfma_f32_16x16x32_bf16 v[184:187], a[204:207], v[40:43], v[184:187]
    v_mfma_f32_16x16x32_bf16 v[188:191], a[208:211], v[40:43], v[188:191]
    v_mfma_f32_16x16x32_bf16 v[192:195], a[212:215], v[40:43], v[192:195]
    v_mfma_f32_16x16x32_bf16 v[196:199], a[216:219], v[40:43], v[196:199]
    v_mfma_f32_16x16x32_bf16 v[200:203], a[220:223], v[40:43], v[200:203]
    v_mfma_f32_16x16x32_bf16 v[172:175], a[224:227], v[44:47], v[172:175]
    v_mfma_f32_16x16x32_bf16 v[176:179], a[228:231], v[44:47], v[176:179]
    v_mfma_f32_16x16x32_bf16 v[180:183], a[232:235], v[44:47], v[180:183]
    v_mfma_f32_16x16x32_bf16 v[184:187], a[236:239], v[44:47], v[184:187]
    v_mfma_f32_16x16x32_bf16 v[188:191], a[240:243], v[44:47], v[188:191]
    v_mfma_f32_16x16x32_bf16 v[192:195], a[244:247], v[44:47], v[192:195]
    v_mfma_f32_16x16x32_bf16 v[196:199], a[248:251], v[44:47], v[196:199]
    v_mfma_f32_16x16x32_bf16 v[200:203], a[252:255], v[44:47], v[200:203]
    v_mfma_f32_16x16x32_bf16 v[204:207], a[0:3], v[16:19], 0
    v_mfma_f32_16x16x32_bf16 v[208:211], a[4:7], v[16:19], 0
    v_mfma_f32_16x16x32_bf16 v[212:215], a[8:11], v[16:19], 0
    v_mfma_f32_16x16x32_bf16 v[216:219], a[12:15], v[16:19], 0
    v_mfma_f32_16x16x32_bf16 v[220:223], a[16:19], v[16:19], 0
    v_mfma_f32_16x16x32_bf16 v[224:227], a[20:23], v[16:19], 0
    v_mfma_f32_16x16x32_bf16 v[228:231], a[24:27], v[16:19], 0
    v_mfma_f32_16x16x32_bf16 v[232:235], a[28:31], v[16:19], 0
    v_cvt_pk_bf16_f32 v140, v172, v173
    v_cvt_pk_bf16_f32 v141, v174, v175
    v_cvt_pk_bf16_f32 v142, v176, v177
    v_cvt_pk_bf16_f32 v143, v178, v179
    s_add_u32 s24, s51, 0
    buffer_store_dwordx4 v[140:143], v242, s[8:11], s24 offen sc1
    v_mfma_f32_16x16x32_bf16 v[204:207], a[32:35], v[20:23], v[204:207]
    v_mfma_f32_16x16x32_bf16 v[208:211], a[36:39], v[20:23], v[208:211]
    v_mfma_f32_16x16x32_bf16 v[212:215], a[40:43], v[20:23], v[212:215]
    v_mfma_f32_16x16x32_bf16 v[216:219], a[44:47], v[20:23], v[216:219]
    v_mfma_f32_16x16x32_bf16 v[220:223], a[48:51], v[20:23], v[220:223]
    v_mfma_f32_16x16x32_bf16 v[224:227], a[52:55], v[20:23], v[224:227]
    v_mfma_f32_16x16x32_bf16 v[228:231], a[56:59], v[20:23], v[228:231]
    v_mfma_f32_16x16x32_bf16 v[232:235], a[60:63], v[20:23], v[232:235]
    v_cvt_pk_bf16_f32 v144, v180, v181
    v_cvt_pk_bf16_f32 v145, v182, v183
    v_cvt_pk_bf16_f32 v146, v184, v185
    v_cvt_pk_bf16_f32 v147, v186, v187
    buffer_store_dwordx4 v[144:147], v242, s[8:11], s24 offen offset:64 sc1
    v_mfma_f32_16x16x32_bf16 v[204:207], a[64:67], v[24:27], v[204:207]
    v_mfma_f32_16x16x32_bf16 v[208:211], a[68:71], v[24:27], v[208:211]
    v_mfma_f32_16x16x32_bf16 v[212:215], a[72:75], v[24:27], v[212:215]
    v_mfma_f32_16x16x32_bf16 v[216:219], a[76:79], v[24:27], v[216:219]
    v_mfma_f32_16x16x32_bf16 v[220:223], a[80:83], v[24:27], v[220:223]
    v_mfma_f32_16x16x32_bf16 v[224:227], a[84:87], v[24:27], v[224:227]
    v_mfma_f32_16x16x32_bf16 v[228:231], a[88:91], v[24:27], v[228:231]
    v_mfma_f32_16x16x32_bf16 v[232:235], a[92:95], v[24:27], v[232:235]
    v_cvt_pk_bf16_f32 v148, v188, v189
    v_cvt_pk_bf16_f32 v149, v190, v191
    v_cvt_pk_bf16_f32 v150, v192, v193
    v_cvt_pk_bf16_f32 v151, v194, v195
    buffer_store_dwordx4 v[148:151], v242, s[8:11], s24 offen offset:128 sc1
    v_mfma_f32_16x16x32_bf16 v[204:207], a[96:99], v[28:31], v[204:207]
    v_mfma_f32_16x16x32_bf16 v[208:211], a[100:103], v[28:31], v[208:211]
    v_mfma_f32_16x16x32_bf16 v[212:215], a[104:107], v[28:31], v[212:215]
    v_mfma_f32_16x16x32_bf16 v[216:219], a[108:111], v[28:31], v[216:219]
    v_mfma_f32_16x16x32_bf16 v[220:223], a[112:115], v[28:31], v[220:223]
    v_mfma_f32_16x16x32_bf16 v[224:227], a[116:119], v[28:31], v[224:227]
    v_mfma_f32_16x16x32_bf16 v[228:231], a[120:123], v[28:31], v[228:231]
    v_mfma_f32_16x16x32_bf16 v[232:235], a[124:127], v[28:31], v[232:235]
    v_cvt_pk_bf16_f32 v152, v196, v197
    v_cvt_pk_bf16_f32 v153, v198, v199
    v_cvt_pk_bf16_f32 v154, v200, v201
    v_cvt_pk_bf16_f32 v155, v202, v203
    buffer_store_dwordx4 v[152:155], v242, s[8:11], s24 offen offset:192 sc1
    v_mfma_f32_16x16x32_bf16 v[204:207], a[128:131], v[48:51], v[204:207]
    v_mfma_f32_16x16x32_bf16 v[208:211], a[132:135], v[48:51], v[208:211]
    v_mfma_f32_16x16x32_bf16 v[212:215], a[136:139], v[48:51], v[212:215]
    v_mfma_f32_16x16x32_bf16 v[216:219], a[140:143], v[48:51], v[216:219]
    v_mfma_f32_16x16x32_bf16 v[220:223], a[144:147], v[48:51], v[220:223]
    v_mfma_f32_16x16x32_bf16 v[224:227], a[148:151], v[48:51], v[224:227]
    v_mfma_f32_16x16x32_bf16 v[228:231], a[152:155], v[48:51], v[228:231]
    v_mfma_f32_16x16x32_bf16 v[232:235], a[156:159], v[48:51], v[232:235]
    v_mfma_f32_16x16x32_bf16 v[204:207], a[160:163], v[52:55], v[204:207]
    v_mfma_f32_16x16x32_bf16 v[208:211], a[164:167], v[52:55], v[208:211]
    v_mfma_f32_16x16x32_bf16 v[212:215], a[168:171], v[52:55], v[212:215]
    v_mfma_f32_16x16x32_bf16 v[216:219], a[172:175], v[52:55], v[216:219]
    v_mfma_f32_16x16x32_bf16 v[220:223], a[176:179], v[52:55], v[220:223]
    v_mfma_f32_16x16x32_bf16 v[224:227], a[180:183], v[52:55], v[224:227]
    v_mfma_f32_16x16x32_bf16 v[228:231], a[184:187], v[52:55], v[228:231]
    v_mfma_f32_16x16x32_bf16 v[232:235], a[188:191], v[52:55], v[232:235]
    v_mfma_f32_16x16x32_bf16 v[204:207], a[192:195], v[56:59], v[204:207]
    v_mfma_f32_16x16x32_bf16 v[208:211], a[196:199], v[56:59], v[208:211]
    v_mfma_f32_16x16x32_bf16 v[212:215], a[200:203], v[56:59], v[212:215]
    v_mfma_f32_16x16x32_bf16 v[216:219], a[204:207], v[56:59], v[216:219]
    v_mfma_f32_16x16x32_bf16 v[220:223], a[208:211], v[56:59], v[220:223]
    v_mfma_f32_16x16x32_bf16 v[224:227], a[212:215], v[56:59], v[224:227]
    v_mfma_f32_16x16x32_bf16 v[228:231], a[216:219], v[56:59], v[228:231]
    v_mfma_f32_16x16x32_bf16 v[232:235], a[220:223], v[56:59], v[232:235]
    v_mfma_f32_16x16x32_bf16 v[204:207], a[224:227], v[60:63], v[204:207]
    v_mfma_f32_16x16x32_bf16 v[208:211], a[228:231], v[60:63], v[208:211]
    v_mfma_f32_16x16x32_bf16 v[212:215], a[232:235], v[60:63], v[212:215]
    v_mfma_f32_16x16x32_bf16 v[216:219], a[236:239], v[60:63], v[216:219]
    v_mfma_f32_16x16x32_bf16 v[220:223], a[240:243], v[60:63], v[220:223]
    v_mfma_f32_16x16x32_bf16 v[224:227], a[244:247], v[60:63], v[224:227]
    v_mfma_f32_16x16x32_bf16 v[228:231], a[248:251], v[60:63], v[228:231]
    v_mfma_f32_16x16x32_bf16 v[232:235], a[252:255], v[60:63], v[232:235]
    v_cvt_pk_bf16_f32 v140, v204, v205
    v_cvt_pk_bf16_f32 v141, v206, v207
    v_cvt_pk_bf16_f32 v142, v208, v209
    v_cvt_pk_bf16_f32 v143, v210, v211
    s_add_u32 s24, s51, 16384
    buffer_store_dwordx4 v[140:143], v242, s[8:11], s24 offen sc1
    v_cvt_pk_bf16_f32 v144, v212, v213
    v_cvt_pk_bf16_f32 v145, v214, v215
    v_cvt_pk_bf16_f32 v146, v216, v217
    v_cvt_pk_bf16_f32 v147, v218, v219
    buffer_store_dwordx4 v[144:147], v242, s[8:11], s24 offen offset:64 sc1
    v_cvt_pk_bf16_f32 v148, v220, v221
    v_cvt_pk_bf16_f32 v149, v222, v223
    v_cvt_pk_bf16_f32 v150, v224, v225
    v_cvt_pk_bf16_f32 v151, v226, v227
    buffer_store_dwordx4 v[148:151], v242, s[8:11], s24 offen offset:128 sc1
    v_cvt_pk_bf16_f32 v152, v228, v229
    v_cvt_pk_bf16_f32 v153, v230, v231
    v_cvt_pk_bf16_f32 v154, v232, v233
    v_cvt_pk_bf16_f32 v155, v234, v235
    buffer_store_dwordx4 v[152:155], v242, s[8:11], s24 offen offset:192 sc1
    s_waitcnt vmcnt(0)
    s_barrier
    s_lshl_b32 s25, s22, 6
    s_add_u32 s25, s25, 0x4000
    s_lshl_b32 s24, s20, 2
    s_add_u32 s24, s24, s25
    s_cmp_lg_u32 s100, 0
    s_cbranch_scc1 L_flag_134
    v_mov_b32 v246, 1
    s_mov_b64 exec, 1
    buffer_store_dword v246, off, s[8:11], s24 sc1
    s_mov_b64 exec, -1
L_flag_134:
    v_lshrrev_b32 v246, 2, v240
    s_cmp_lg_u32 s100, 0
    s_cbranch_scc1 L_polls_137
    s_mov_b32 exec_lo, 0xffff
    s_mov_b32 exec_hi, 0
    s_mov_b32 s96, 0
L_poll_135:
    buffer_load_dword v247, v246, s[8:11], s25 offen sc1
    s_waitcnt vmcnt(0)
    v_cmp_gt_u32 vcc, 1, v247
    s_cbranch_vccz L_polld_136
    s_sleep 2
    s_add_u32 s96, s96, 1
    s_cmp_lt_u32 s96, 0x10000
    s_cbranch_scc1 L_poll_135
L_polld_136:
    s_mov_b64 exec, -1
L_polls_137:
    s_barrier
    s_cmp_ge_u32 s100, 2
    s_cbranch_scc1 L_nofin_138
    s_lshl_b32 s60, s22, 5
    s_lshl_b32 s24, s20, 1
    s_add_u32 s60, s60, s24
    s_add_u32 s60, s60, s100
    s_lshr_b32 s62, s60, 5
    s_lshl_b32 s62, s62, 19
    s_and_b32 s63, s60, 31
    s_lshl_b32 s63, s63, 10
    s_add_u32 s62, s62, s63
    s_add_u32 s62, s62, 0x4000000
    s_lshl_b32 s64, s60, 10
    buffer_load_dwordx4 v[64:67], v240, s[12:15], s64 offen
    buffer_load_dwordx4 v[0:3], v240, s[8:11], s62 offen
    s_add_u32 s62, s62, 32768
    buffer_load_dwordx4 v[4:7], v240, s[8:11], s62 offen
    s_add_u32 s62, s62, 32768
    buffer_load_dwordx4 v[8:11], v240, s[8:11], s62 offen
    s_add_u32 s62, s62, 32768
    buffer_load_dwordx4 v[12:15], v240, s[8:11], s62 offen
    s_add_u32 s62, s62, 32768
    buffer_load_dwordx4 v[16:19], v240, s[8:11], s62 offen
    s_add_u32 s62, s62, 32768
    buffer_load_dwordx4 v[20:23], v240, s[8:11], s62 offen
    s_add_u32 s62, s62, 32768
    buffer_load_dwordx4 v[24:27], v240, s[8:11], s62 offen
    s_add_u32 s62, s62, 32768
    buffer_load_dwordx4 v[28:31], v240, s[8:11], s62 offen
    s_add_u32 s62, s62, 32768
    buffer_load_dwordx4 v[32:35], v240, s[8:11], s62 offen
    s_add_u32 s62, s62, 32768
    buffer_load_dwordx4 v[36:39], v240, s[8:11], s62 offen
    s_add_u32 s62, s62, 32768
    buffer_load_dwordx4 v[40:43], v240, s[8:11], s62 offen
    s_add_u32 s62, s62, 32768
    buffer_load_dwordx4 v[44:47], v240, s[8:11], s62 offen
    s_add_u32 s62, s62, 32768
    buffer_load_dwordx4 v[48:51], v240, s[8:11], s62 offen
    s_add_u32 s62, s62, 32768
    buffer_load_dwordx4 v[52:55], v240, s[8:11], s62 offen
    s_add_u32 s62, s62, 32768
    buffer_load_dwordx4 v[56:59], v240, s[8:11], s62 offen
    s_add_u32 s62, s62, 32768
    buffer_load_dwordx4 v[60:63], v240, s[8:11], s62 offen
    v_mov_b32 v68, 0
    v_mov_b32 v69, 0
    v_mov_b32 v70, 0
    v_mov_b32 v71, 0
    v_mov_b32 v72, 0
    v_mov_b32 v73, 0
    v_mov_b32 v74, 0
    v_mov_b32 v75, 0
    s_waitcnt vmcnt(15)
    v_dot2_f32_bf16 v68, v0, s65, v68
    v_dot2_f32_bf16 v69, v0, s66, v69
    v_dot2_f32_bf16 v70, v1, s65, v70
    v_dot2_f32_bf16 v71, v1, s66, v71
    v_dot2_f32_bf16 v72, v2, s65, v72
    v_dot2_f32_bf16 v73, v2, s66, v73
    v_dot2_f32_bf16 v74, v3, s65, v74
    v_dot2_f32_bf16 v75, v3, s66, v75
    s_waitcnt vmcnt(14)
    v_dot2_f32_bf16 v68, v4, s65, v68
    v_dot2_f32_bf16 v69, v4, s66, v69
    v_dot2_f32_bf16 v70, v5, s65, v70
    v_dot2_f32_bf16 v71, v5, s66, v71
    v_dot2_f32_bf16 v72, v6, s65, v72
    v_dot2_f32_bf16 v73, v6, s66, v73
    v_dot2_f32_bf16 v74, v7, s65, v74
    v_dot2_f32_bf16 v75, v7, s66, v75
    s_waitcnt vmcnt(13)
    v_dot2_f32_bf16 v68, v8, s65, v68
    v_dot2_f32_bf16 v69, v8, s66, v69
    v_dot2_f32_bf16 v70, v9, s65, v70
    v_dot2_f32_bf16 v71, v9, s66, v71
    v_dot2_f32_bf16 v72, v10, s65, v72
    v_dot2_f32_bf16 v73, v10, s66, v73
    v_dot2_f32_bf16 v74, v11, s65, v74
    v_dot2_f32_bf16 v75, v11, s66, v75
    s_waitcnt vmcnt(12)
    v_dot2_f32_bf16 v68, v12, s65, v68
    v_dot2_f32_bf16 v69, v12, s66, v69
    v_dot2_f32_bf16 v70, v13, s65, v70
    v_dot2_f32_bf16 v71, v13, s66, v71
    v_dot2_f32_bf16 v72, v14, s65, v72
    v_dot2_f32_bf16 v73, v14, s66, v73
    v_dot2_f32_bf16 v74, v15, s65, v74
    v_dot2_f32_bf16 v75, v15, s66, v75
    s_waitcnt vmcnt(11)
    v_dot2_f32_bf16 v68, v16, s65, v68
    v_dot2_f32_bf16 v69, v16, s66, v69
    v_dot2_f32_bf16 v70, v17, s65, v70
    v_dot2_f32_bf16 v71, v17, s66, v71
    v_dot2_f32_bf16 v72, v18, s65, v72
    v_dot2_f32_bf16 v73, v18, s66, v73
    v_dot2_f32_bf16 v74, v19, s65, v74
    v_dot2_f32_bf16 v75, v19, s66, v75
    s_waitcnt vmcnt(10)
    v_dot2_f32_bf16 v68, v20, s65, v68
    v_dot2_f32_bf16 v69, v20, s66, v69
    v_dot2_f32_bf16 v70, v21, s65, v70
    v_dot2_f32_bf16 v71, v21, s66, v71
    v_dot2_f32_bf16 v72, v22, s65, v72
    v_dot2_f32_bf16 v73, v22, s66, v73
    v_dot2_f32_bf16 v74, v23, s65, v74
    v_dot2_f32_bf16 v75, v23, s66, v75
    s_waitcnt vmcnt(9)
    v_dot2_f32_bf16 v68, v24, s65, v68
    v_dot2_f32_bf16 v69, v24, s66, v69
    v_dot2_f32_bf16 v70, v25, s65, v70
    v_dot2_f32_bf16 v71, v25, s66, v71
    v_dot2_f32_bf16 v72, v26, s65, v72
    v_dot2_f32_bf16 v73, v26, s66, v73
    v_dot2_f32_bf16 v74, v27, s65, v74
    v_dot2_f32_bf16 v75, v27, s66, v75
    s_waitcnt vmcnt(8)
    v_dot2_f32_bf16 v68, v28, s65, v68
    v_dot2_f32_bf16 v69, v28, s66, v69
    v_dot2_f32_bf16 v70, v29, s65, v70
    v_dot2_f32_bf16 v71, v29, s66, v71
    v_dot2_f32_bf16 v72, v30, s65, v72
    v_dot2_f32_bf16 v73, v30, s66, v73
    v_dot2_f32_bf16 v74, v31, s65, v74
    v_dot2_f32_bf16 v75, v31, s66, v75
    s_waitcnt vmcnt(7)
    v_dot2_f32_bf16 v68, v32, s65, v68
    v_dot2_f32_bf16 v69, v32, s66, v69
    v_dot2_f32_bf16 v70, v33, s65, v70
    v_dot2_f32_bf16 v71, v33, s66, v71
    v_dot2_f32_bf16 v72, v34, s65, v72
    v_dot2_f32_bf16 v73, v34, s66, v73
    v_dot2_f32_bf16 v74, v35, s65, v74
    v_dot2_f32_bf16 v75, v35, s66, v75
    s_waitcnt vmcnt(6)
    v_dot2_f32_bf16 v68, v36, s65, v68
    v_dot2_f32_bf16 v69, v36, s66, v69
    v_dot2_f32_bf16 v70, v37, s65, v70
    v_dot2_f32_bf16 v71, v37, s66, v71
    v_dot2_f32_bf16 v72, v38, s65, v72
    v_dot2_f32_bf16 v73, v38, s66, v73
    v_dot2_f32_bf16 v74, v39, s65, v74
    v_dot2_f32_bf16 v75, v39, s66, v75
    s_waitcnt vmcnt(5)
    v_dot2_f32_bf16 v68, v40, s65, v68
    v_dot2_f32_bf16 v69, v40, s66, v69
    v_dot2_f32_bf16 v70, v41, s65, v70
    v_dot2_f32_bf16 v71, v41, s66, v71
    v_dot2_f32_bf16 v72, v42, s65, v72
    v_dot2_f32_bf16 v73, v42, s66, v73
    v_dot2_f32_bf16 v74, v43, s65, v74
    v_dot2_f32_bf16 v75, v43, s66, v75
    s_waitcnt vmcnt(4)
    v_dot2_f32_bf16 v68, v44, s65, v68
    v_dot2_f32_bf16 v69, v44, s66, v69
    v_dot2_f32_bf16 v70, v45, s65, v70
    v_dot2_f32_bf16 v71, v45, s66, v71
    v_dot2_f32_bf16 v72, v46, s65, v72
    v_dot2_f32_bf16 v73, v46, s66, v73
    v_dot2_f32_bf16 v74, v47, s65, v74
    v_dot2_f32_bf16 v75, v47, s66, v75
    s_waitcnt vmcnt(3)
    v_dot2_f32_bf16 v68, v48, s65, v68
    v_dot2_f32_bf16 v69, v48, s66, v69
    v_dot2_f32_bf16 v70, v49, s65, v70
    v_dot2_f32_bf16 v71, v49, s66, v71
    v_dot2_f32_bf16 v72, v50, s65, v72
    v_dot2_f32_bf16 v73, v50, s66, v73
    v_dot2_f32_bf16 v74, v51, s65, v74
    v_dot2_f32_bf16 v75, v51, s66, v75
    s_waitcnt vmcnt(2)
    v_dot2_f32_bf16 v68, v52, s65, v68
    v_dot2_f32_bf16 v69, v52, s66, v69
    v_dot2_f32_bf16 v70, v53, s65, v70
    v_dot2_f32_bf16 v71, v53, s66, v71
    v_dot2_f32_bf16 v72, v54, s65, v72
    v_dot2_f32_bf16 v73, v54, s66, v73
    v_dot2_f32_bf16 v74, v55, s65, v74
    v_dot2_f32_bf16 v75, v55, s66, v75
    s_waitcnt vmcnt(1)
    v_dot2_f32_bf16 v68, v56, s65, v68
    v_dot2_f32_bf16 v69, v56, s66, v69
    v_dot2_f32_bf16 v70, v57, s65, v70
    v_dot2_f32_bf16 v71, v57, s66, v71
    v_dot2_f32_bf16 v72, v58, s65, v72
    v_dot2_f32_bf16 v73, v58, s66, v73
    v_dot2_f32_bf16 v74, v59, s65, v74
    v_dot2_f32_bf16 v75, v59, s66, v75
    s_waitcnt vmcnt(0)
    v_dot2_f32_bf16 v68, v60, s65, v68
    v_dot2_f32_bf16 v69, v60, s66, v69
    v_dot2_f32_bf16 v70, v61, s65, v70
    v_dot2_f32_bf16 v71, v61, s66, v71
    v_dot2_f32_bf16 v72, v62, s65, v72
    v_dot2_f32_bf16 v73, v62, s66, v73
    v_dot2_f32_bf16 v74, v63, s65, v74
    v_dot2_f32_bf16 v75, v63, s66, v75
    v_cvt_pk_bf16_f32 v0, v68, v69
    v_cvt_pk_bf16_f32 v1, v70, v71
    v_cvt_pk_bf16_f32 v2, v72, v73
    v_cvt_pk_bf16_f32 v3, v74, v75
    v_lshlrev_b32 v68, 16, v0
    v_and_b32 v69, 0xffff0000, v0
    v_lshlrev_b32 v76, 16, v64
    v_and_b32 v77, 0xffff0000, v64
    v_lshlrev_b32 v70, 16, v1
    v_and_b32 v71, 0xffff0000, v1
    v_lshlrev_b32 v78, 16, v65
    v_and_b32 v79, 0xffff0000, v65
    v_lshlrev_b32 v72, 16, v2
    v_and_b32 v73, 0xffff0000, v2
    v_lshlrev_b32 v80, 16, v66
    v_and_b32 v81, 0xffff0000, v66
    v_lshlrev_b32 v74, 16, v3
    v_and_b32 v75, 0xffff0000, v3
    v_lshlrev_b32 v82, 16, v67
    v_and_b32 v83, 0xffff0000, v67
    v_pk_add_f32 v[68:69], v[68:69], v[76:77]
    v_pk_add_f32 v[70:71], v[70:71], v[78:79]
    v_pk_add_f32 v[72:73], v[72:73], v[80:81]
    v_pk_add_f32 v[74:75], v[74:75], v[82:83]
    v_cvt_pk_bf16_f32 v4, v68, v69
    v_cvt_pk_bf16_f32 v5, v70, v71
    v_cvt_pk_bf16_f32 v6, v72, v73
    v_cvt_pk_bf16_f32 v7, v74, v75
    v_lshlrev_b32 v68, 16, v4
    v_and_b32 v69, 0xffff0000, v4
    v_lshlrev_b32 v70, 16, v5
    v_and_b32 v71, 0xffff0000, v5
    v_lshlrev_b32 v72, 16, v6
    v_and_b32 v73, 0xffff0000, v6
    v_lshlrev_b32 v74, 16, v7
    v_and_b32 v75, 0xffff0000, v7
    s_add_u32 s62, s64, 0x6000000
    buffer_store_dwordx4 v[4:7], v240, s[8:11], s62 offen sc1
    v_add_f32 v84, v68, v69
    v_add_f32 v84, v84, v70
    v_add_f32 v84, v84, v71
    v_add_f32 v84, v84, v72
    v_add_f32 v84, v84, v73
    v_add_f32 v84, v84, v74
    v_add_f32 v84, v84, v75
    s_nop 1
    v_add_f32_dpp v84, v84, v84 row_ror:1 row_mask:0xf bank_mask:0xf
    s_nop 1
    v_add_f32_dpp v84, v84, v84 row_ror:2 row_mask:0xf bank_mask:0xf
    s_nop 1
    v_add_f32_dpp v84, v84, v84 row_ror:4 row_mask:0xf bank_mask:0xf
    s_nop 1
    v_add_f32_dpp v84, v84, v84 row_ror:8 row_mask:0xf bank_mask:0xf
    v_mov_b32 v85, v84
    s_nop 1
    v_permlane32_swap_b32 v85, v84
    v_add_f32 v84, v85, v84
    v_mov_b32 v85, v84
    s_nop 1
    v_permlane16_swap_b32 v85, v84
    v_add_f32 v84, v85, v84
    v_mul_f32 v84, 0x3b000000, v84
    v_cvt_pk_bf16_f32 v86, v84, v84
    v_and_b32 v86, 0xffff0000, v86
    v_sub_f32 v87, v84, v86
    v_sub_f32 v76, v68, v86
    v_sub_f32 v77, v69, v86
    v_sub_f32 v78, v70, v86
    v_sub_f32 v79, v71, v86
    v_sub_f32 v80, v72, v86
    v_sub_f32 v81, v73, v86
    v_sub_f32 v82, v74, v86
    v_sub_f32 v83, v75, v86
    v_mul_f32 v100, v76, v76
    v_fmac_f32 v100, v77, v77
    v_fmac_f32 v100, v78, v78
    v_fmac_f32 v100, v79, v79
    v_fmac_f32 v100, v80, v80
    v_fmac_f32 v100, v81, v81
    v_fmac_f32 v100, v82, v82
    v_fmac_f32 v100, v83, v83
    s_nop 1
    v_add_f32_dpp v100, v100, v100 row_ror:1 row_mask:0xf bank_mask:0xf
    s_nop 1
    v_add_f32_dpp v100, v100, v100 row_ror:2 row_mask:0xf bank_mask:0xf
    s_nop 1
    v_add_f32_dpp v100, v100, v100 row_ror:4 row_mask:0xf bank_mask:0xf
    s_nop 1
    v_add_f32_dpp v100, v100, v100 row_ror:8 row_mask:0xf bank_mask:0xf
    v_mov_b32 v85, v100
    s_nop 1
    v_permlane32_swap_b32 v85, v100
    v_add_f32 v100, v85, v100
    v_mov_b32 v85, v100
    s_nop 1
    v_permlane16_swap_b32 v85, v100
    v_add_f32 v100, v85, v100
    v_mul_f32 v85, v87, v87
    v_mul_f32 v100, 0x3b000000, v100
    v_sub_f32 v100, v100, v85
    v_max_f32 v100, 0, v100
    v_cvt_pk_bf16_f32 v100, v100, v100
    v_and_b32 v100, 0xffff0000, v100
    v_add_f32 v100, 0x3727c5ac, v100
    v_cvt_pk_bf16_f32 v100, v100, v100
    v_and_b32 v100, 0xffff0000, v100
    v_sqrt_f32 v100, v100
    s_nop 0
    v_cvt_pk_bf16_f32 v100, v100, v100
    v_and_b32 v100, 0xffff0000, v100
    v_rcp_f32 v100, v100
    v_cvt_pk_bf16_f32 v8, v76, v77
    v_cvt_pk_bf16_f32 v9, v78, v79
    v_cvt_pk_bf16_f32 v10, v80, v81
    v_cvt_pk_bf16_f32 v11, v82, v83
    v_lshlrev_b32 v76, 16, v8
    v_and_b32 v77, 0xffff0000, v8
    v_lshlrev_b32 v78, 16, v9
    v_and_b32 v79, 0xffff0000, v9
    v_lshlrev_b32 v80, 16, v10
    v_and_b32 v81, 0xffff0000, v10
    v_lshlrev_b32 v82, 16, v11
    v_and_b32 v83, 0xffff0000, v11
    v_mul_f32 v76, v100, v76
    v_mul_f32 v77, v100, v77
    v_mul_f32 v78, v100, v78
    v_mul_f32 v79, v100, v79
    v_mul_f32 v80, v100, v80
    v_mul_f32 v81, v100, v81
    v_mul_f32 v82, v100, v82
    v_mul_f32 v83, v100, v83
    v_cvt_pk_bf16_f32 v8, v76, v77
    v_cvt_pk_bf16_f32 v9, v78, v79
    v_cvt_pk_bf16_f32 v10, v80, v81
    v_cvt_pk_bf16_f32 v11, v82, v83
    v_lshlrev_b32 v76, 16, v8
    v_and_b32 v77, 0xffff0000, v8
    v_lshlrev_b32 v78, 16, v9
    v_and_b32 v79, 0xffff0000, v9
    v_lshlrev_b32 v80, 16, v10
    v_and_b32 v81, 0xffff0000, v10
    v_lshlrev_b32 v82, 16, v11
    v_and_b32 v83, 0xffff0000, v11
    s_add_u32 s62, s64, 0x6200000
    buffer_store_dwordx4 v[8:11], v240, s[8:11], s62 offen sc1
    v_pk_add_f32 v[68:69], v[68:69], v[76:77]
    v_pk_add_f32 v[70:71], v[70:71], v[78:79]
    v_pk_add_f32 v[72:73], v[72:73], v[80:81]
    v_pk_add_f32 v[74:75], v[74:75], v[82:83]
    v_cvt_pk_bf16_f32 v12, v68, v69
    v_cvt_pk_bf16_f32 v13, v70, v71
    v_cvt_pk_bf16_f32 v14, v72, v73
    v_cvt_pk_bf16_f32 v15, v74, v75
    buffer_store_dwordx4 v[12:15], v240, s[16:19], s64 offen sc1
    v_lshlrev_b32 v88, 16, v236
    v_and_b32 v89, 0xffff0000, v236
    v_lshlrev_b32 v90, 16, v237
    v_and_b32 v91, 0xffff0000, v237
    v_lshlrev_b32 v92, 16, v238
    v_and_b32 v93, 0xffff0000, v238
    v_lshlrev_b32 v94, 16, v239
    v_and_b32 v95, 0xffff0000, v239
    v_mul_f32 v84, v76, v88
    v_fmac_f32 v84, v77, v89
    v_fmac_f32 v84, v78, v90
    v_fmac_f32 v84, v79, v91
    v_fmac_f32 v84, v80, v92
    v_fmac_f32 v84, v81, v93
    v_fmac_f32 v84, v82, v94
    v_fmac_f32 v84, v83, v95
    s_nop 1
    v_add_f32_dpp v84, v84, v84 row_ror:1 row_mask:0xf bank_mask:0xf
    s_nop 1
    v_add_f32_dpp v84, v84, v84 row_ror:2 row_mask:0xf bank_mask:0xf
    s_nop 1
    v_add_f32_dpp v84, v84, v84 row_ror:4 row_mask:0xf bank_mask:0xf
    s_nop 1
    v_add_f32_dpp v84, v84, v84 row_ror:8 row_mask:0xf bank_mask:0xf
    v_mov_b32 v85, v84
    s_nop 1
    v_permlane32_swap_b32 v85, v84
    v_add_f32 v84, v85, v84
    v_mov_b32 v85, v84
    s_nop 1
    v_permlane16_swap_b32 v85, v84
    v_add_f32 v84, v85, v84
    v_cvt_pk_bf16_f32 v84, v84, v84
    v_and_b32 v84, 0xffff0000, v84
    v_ashrrev_i32 v85, 31, v84
    v_or_b32 v85, 0x80000000, v85
    v_xor_b32 v84, v84, v85
    v_and_b32 v84, 0xffff0000, v84
    s_sub_u32 s62, 0x87ff, s60
    v_or_b32 v84, s62, v84
    s_waitcnt vmcnt(0)
    s_lshl_b32 s62, s60, 2
    s_add_u32 s62, s62, 0x6000
    s_mov_b64 exec, 1
    buffer_store_dword v84, off, s[8:11], s62 sc1
    s_mov_b64 exec, -1
L_nofin_138:
    s_add_u32 s80, s80, 4
    s_add_u32 s22, s22, s23
    s_branch L_p2_seg
L_p2_end:
    s_cmp_ge_u32 s67, 56
    s_cbranch_scc1 L_exit
    s_mov_b32 s74, 0
    s_mov_b32 s75, 0
    v_mov_b32 v202, 0x7ffffff0
    v_mbcnt_lo_u32_b32 v0, -1, 0
    v_mbcnt_hi_u32_b32 v0, -1, v0
    s_lshl_b32 s96, s100, 6
    v_add_u32 v0, s96, v0
    v_lshlrev_b32 v1, 6, v0
    s_getpc_b64 s[70:71]
L_pc_139:
    s_add_u32 s70, s70, L_ffn_round-L_pc_139
    s_addc_u32 s71, s71, 0
    v_min_u32 v1, L_code_end-L_ffn_round-4, v1
    global_load_dword v3, v1, s[70:71]
    v_mov_b32 v1, 0
    s_and_b32 s71, s101, 15
    s_lshl_b32 s71, s71, 7
    s_add_u32 s71, s71, 0x1000
    s_mov_b32 s72, 61
    s_cmp_lg_u32 s100, 0
    s_cbranch_scc1 L_polls_142
    s_mov_b32 exec_lo, 0x1
    s_mov_b32 exec_hi, 0
    s_mov_b32 s96, 0
L_poll_140:
    buffer_load_dword v2, v1, s[8:11], s71 offen sc1
    s_waitcnt vmcnt(0)
    v_cmp_gt_u32 vcc, s72, v2
    s_cbranch_vccz L_polld_141
    v_readfirstlane_b32 s97, v2
    s_nop 0
    s_sub_u32 s97, s72, s97
    s_cmp_lt_i32 s97, 3
    s_cbranch_scc1 L_near_143
    s_sleep 40
    s_cmp_lt_i32 s97, 5
    s_cbranch_scc1 L_near_143
    s_sleep 100
L_near_143:
    s_sleep 16
    s_add_u32 s96, s96, 1
    s_cmp_lt_u32 s96, 0x10000
    s_cbranch_scc1 L_poll_140
L_polld_141:
    s_mov_b64 exec, -1
L_polls_142:
    s_barrier
L_ffn_round:
    v_mbcnt_lo_u32_b32 v0, -1, 0
    v_mbcnt_hi_u32_b32 v0, -1, v0
    s_lshl_b32 s96, s100, 6
    v_add_u32 v0, s96, v0
    s_cmp_lg_u32 s75, 0
    s_cbranch_scc1 L_ffn_re
    v_lshlrev_b32 v30, 5, v0
    s_mov_b32 s69, 0x6000
    v_cmp_le_u32 vcc, 240, v0
    v_mov_b32 v29, s75
    v_add_u32 v29, -1, v29
    v_cndmask_b32 v19, 0, v29, vcc
    s_mov_b32 s70, 0
L_kpoll_144:
    buffer_load_dwordx4 v[20:23], v30, s[8:11], s69 offen sc1
    buffer_load_dwordx4 v[24:27], v30, s[8:11], s69 offen offset:16 sc1
    s_waitcnt vmcnt(0)
    v_min3_u32 v28, v20, v21, v22
    v_min3_u32 v28, v28, v23, v24
    v_min3_u32 v28, v28, v25, v26
    v_min_u32 v28, v28, v27
    v_or_b32 v28, v28, v19
    v_cmp_eq_u32 vcc, 0, v28
    s_cbranch_vccz L_kpolld_145
    s_sleep 6
    s_add_u32 s70, s70, 1
    s_cmp_lt_u32 s70, 0x10000
    s_cbranch_scc1 L_kpoll_144
L_kpolld_145:
    v_bfi_b32 v20, v19, 0, v20
    v_bfi_b32 v21, v19, 0, v21
    v_bfi_b32 v22, v19, 0, v22
    v_bfi_b32 v23, v19, 0, v23
    v_bfi_b32 v24, v19, 0, v24
    v_bfi_b32 v25, v19, 0, v25
    v_bfi_b32 v26, v19, 0, v26
    v_bfi_b32 v27, v19, 0, v27
    v_lshrrev_b32 v30, 6, v0
    v_lshlrev_b32 v30, 2, v30
    v_add_u32 v30, 0x20400, v30
    v_mov_b32 v31, 0x20400
    s_waitcnt vmcnt(0)
    v_max3_u32 v28, v20, v21, v22
    v_max3_u32 v28, v28, v23, v24
    v_max3_u32 v28, v28, v25, v26
    v_max_u32 v28, v28, v27
    s_nop 1
    v_max_u32_dpp v28, v28, v28 row_ror:1 row_mask:0xf bank_mask:0xf
    s_nop 1
    v_max_u32_dpp v28, v28, v28 row_ror:2 row_mask:0xf bank_mask:0xf
    s_nop 1
    v_max_u32_dpp v28, v28, v28 row_ror:4 row_mask:0xf bank_mask:0xf
    s_nop 1
    v_max_u32_dpp v28, v28, v28 row_ror:8 row_mask:0xf bank_mask:0xf
    v_mov_b32 v29, v28
    s_nop 1
    v_permlane32_swap_b32 v29, v28
    v_max_u32 v28, v29, v28
    v_mov_b32 v29, v28
    s_nop 1
    v_permlane16_swap_b32 v29, v28
    v_max_u32 v28, v29, v28
    ds_write_b32 v30, v28
    s_waitcnt lgkmcnt(0)
    s_barrier
    ds_read_b128 v[16:19], v31
    s_waitcnt lgkmcnt(0)
    v_max3_u32 v28, v16, v17, v18
    v_max_u32 v28, v28, v19
    s_nop 0
    v_readfirstlane_b32 s69, v28
    s_nop 1
    v_cmp_ne_u32 vcc, s69, v20
    s_nop 1
    v_cndmask_b32 v20, 0, v20, vcc
    v_cmp_ne_u32 vcc, s69, v21
    s_nop 1
    v_cndmask_b32 v21, 0, v21, vcc
    v_cmp_ne_u32 vcc, s69, v22
    s_nop 1
    v_cndmask_b32 v22, 0, v22, vcc
    v_cmp_ne_u32 vcc, s69, v23
    s_nop 1
    v_cndmask_b32 v23, 0, v23, vcc
    v_cmp_ne_u32 vcc, s69, v24
    s_nop 1
    v_cndmask_b32 v24, 0, v24, vcc
    v_cmp_ne_u32 vcc, s69, v25
    s_nop 1
    v_cndmask_b32 v25, 0, v25, vcc
    v_cmp_ne_u32 vcc, s69, v26
    s_nop 1
    v_cndmask_b32 v26, 0, v26, vcc
    v_cmp_ne_u32 vcc, s69, v27
    s_nop 1
    v_cndmask_b32 v27, 0, v27, vcc
    v_max3_u32 v28, v20, v21, v22
    v_max3_u32 v28, v28, v23, v24
    v_max3_u32 v28, v28, v25, v26
    v_max_u32 v28, v28, v27
    s_nop 1
    v_max_u32_dpp v28, v28, v28 row_ror:1 row_mask:0xf bank_mask:0xf
    s_nop 1
    v_max_u32_dpp v28, v28, v28 row_ror:2 row_mask:0xf bank_mask:0xf
    s_nop 1
    v_max_u32_dpp v28, v28, v28 row_ror:4 row_mask:0xf bank_mask:0xf
    s_nop 1
    v_max_u32_dpp v28, v28, v28 row_ror:8 row_mask:0xf bank_mask:0xf
    v_mov_b32 v29, v28
    s_nop 1
    v_permlane32_swap_b32 v29, v28
    v_max_u32 v28, v29, v28
    v_mov_b32 v29, v28
    s_nop 1
    v_permlane16_swap_b32 v29, v28
    v_max_u32 v28, v29, v28
    ds_write_b32 v30, v28 offset:16
    s_waitcnt lgkmcnt(0)
    s_barrier
    ds_read_b128 v[16:19], v31 offset:16
    s_waitcnt lgkmcnt(0)
    v_max3_u32 v28, v16, v17, v18
    v_max_u32 v28, v28, v19
    s_nop 0
    v_readfirstlane_b32 s70, v28
    s_barrier
    s_branch L_ffn_sel
L_ffn_re:
    v_and_b32 v24, 63, v0
    v_lshlrev_b32 v24, 3, v24
    s_mov_b32 s71, 0x7e00
    s_mov_b32 s72, 0
L_rsel_146:
    buffer_load_dwordx2 v[20:21], v24, s[8:11], s71 offen sc1
    s_waitcnt vmcnt(0)
    v_min_u32 v22, v20, v21
    v_cmp_eq_u32 vcc, 0, v22
    s_cbranch_vccz L_rseld_147
    s_sleep 3
    s_add_u32 s72, s72, 1
    s_cmp_lt_u32 s72, 0x10000
    s_cbranch_scc1 L_rsel_146
L_rseld_147:
    v_max_u32 v22, v20, v21
    v_cmp_lt_u32 vcc, s70, v22
    s_cbranch_vccz L_rsele_148
    v_max_u32_dpp v22, v22, v22 row_ror:1 row_mask:0xf bank_mask:0xf
    s_nop 1
    v_max_u32_dpp v22, v22, v22 row_ror:2 row_mask:0xf bank_mask:0xf
    s_nop 1
    v_max_u32_dpp v22, v22, v22 row_ror:4 row_mask:0xf bank_mask:0xf
    s_nop 1
    v_max_u32_dpp v22, v22, v22 row_ror:8 row_mask:0xf bank_mask:0xf
    v_mov_b32 v23, v22
    s_nop 1
    v_permlane32_swap_b32 v23, v22
    v_max_u32 v22, v23, v22
    v_mov_b32 v23, v22
    s_nop 1
    v_permlane16_swap_b32 v23, v22
    v_max_u32 v22, v23, v22
    s_nop 0
    v_readfirstlane_b32 s71, v22
    s_nop 1
    v_cmp_ne_u32 vcc, s71, v20
    s_nop 1
    v_cndmask_b32 v20, 0, v20, vcc
    v_cmp_ne_u32 vcc, s71, v21
    s_nop 1
    v_cndmask_b32 v21, 0, v21, vcc
    v_max_u32 v22, v20, v21
    s_nop 1
    v_max_u32_dpp v22, v22, v22 row_ror:1 row_mask:0xf bank_mask:0xf
    s_nop 1
    v_max_u32_dpp v22, v22, v22 row_ror:2 row_mask:0xf bank_mask:0xf
    s_nop 1
    v_max_u32_dpp v22, v22, v22 row_ror:4 row_mask:0xf bank_mask:0xf
    s_nop 1
    v_max_u32_dpp v22, v22, v22 row_ror:8 row_mask:0xf bank_mask:0xf
    v_mov_b32 v23, v22
    s_nop 1
    v_permlane32_swap_b32 v23, v22
    v_max_u32 v22, v23, v22
    v_mov_b32 v23, v22
    s_nop 1
    v_permlane16_swap_b32 v23, v22
    v_max_u32 v22, v23, v22
    s_nop 0
    v_readfirstlane_b32 s72, v22
    s_nop 0
    s_max_u32 s70, s70, s72
    s_min_u32 s72, s71, s69
    s_max_u32 s70, s70, s72
    s_max_u32 s69, s69, s71
L_rsele_148:
L_ffn_sel:
    s_and_b32 s71, s69, 2047
    s_lshl_b32 s71, s71, 11
    s_and_b32 s72, s70, 2047
    s_or_b32 s71, s71, s72
    s_add_u32 s71, s71, 1
    s_cmp_eq_u32 s71, s74
    s_cbranch_scc1 L_ffn_same
    s_mov_b32 s74, s71
    v_and_b32 v1, 63, v0
    v_lshrrev_b32 v2, 4, v1
    v_and_b32 v3, 15, v1
    v_lshrrev_b32 v6, 2, v3
    s_and_b32 s71, s69, 2047
    s_sub_u32 s71, 2047, s71
    s_and_b32 s72, s70, 2047
    s_sub_u32 s72, 2047, s72
    v_and_b32 v4, 1, v3
    v_cmp_eq_u32 vcc, 0, v4
    v_mov_b32 v4, s71
    v_mov_b32 v5, s72
    v_cndmask_b32 v4, v5, v4, vcc
    v_lshlrev_b32 v4, 10, v4
    v_lshl_add_u32 v4, v2, 4, v4
    s_mov_b32 s71, 0x6200000
    buffer_load_dwordx4 v[32:35], v4, s[8:11], s71 offen
    buffer_load_dwordx4 v[36:39], v4, s[8:11], s71 offen offset:64
    buffer_load_dwordx4 v[40:43], v4, s[8:11], s71 offen offset:128
    buffer_load_dwordx4 v[44:47], v4, s[8:11], s71 offen offset:192
    buffer_load_dwordx4 v[48:51], v4, s[8:11], s71 offen offset:256
    buffer_load_dwordx4 v[52:55], v4, s[8:11], s71 offen offset:320
    buffer_load_dwordx4 v[56:59], v4, s[8:11], s71 offen offset:384
    buffer_load_dwordx4 v[60:63], v4, s[8:11], s71 offen offset:448
    buffer_load_dwordx4 v[64:67], v4, s[8:11], s71 offen offset:512
    buffer_load_dwordx4 v[68:71], v4, s[8:11], s71 offen offset:576
    buffer_load_dwordx4 v[72:75], v4, s[8:11], s71 offen offset:640
    buffer_load_dwordx4 v[76:79], v4, s[8:11], s71 offen offset:704
    buffer_load_dwordx4 v[80:83], v4, s[8:11], s71 offen offset:768
    buffer_load_dwordx4 v[84:87], v4, s[8:11], s71 offen offset:832
    buffer_load_dwordx4 v[88:91], v4, s[8:11], s71 offen offset:896
    buffer_load_dwordx4 v[92:95], v4, s[8:11], s71 offen offset:960
    v_lshl_add_u32 v4, v2, 3, v6
    v_lshlrev_b32 v4, 6, v4
    v_and_b32 v5, 3, v3
    v_lshl_add_u32 v4, v5, 3, v4
    s_lshr_b32 s71, s68, 1
    s_lshl_b32 s71, s71, 15
    s_and_b32 s72, s68, 1
    s_lshl_b32 s72, s72, 5
    s_add_u32 s71, s71, s72
    s_add_u32 s71, s71, 0x8000
    v_add_u32 v7, s71, v4
    ds_read_b64_tr_b16 v[96:97], v7
    ds_read_b64_tr_b16 v[98:99], v7 offset:256
    ds_read_b64_tr_b16 v[100:101], v7 offset:2048
    ds_read_b64_tr_b16 v[102:103], v7 offset:2304
    ds_read_b64_tr_b16 v[104:105], v7 offset:4096
    ds_read_b64_tr_b16 v[106:107], v7 offset:4352
    ds_read_b64_tr_b16 v[108:109], v7 offset:6144
    ds_read_b64_tr_b16 v[110:111], v7 offset:6400
    s_waitcnt lgkmcnt(0)
    ds_read_b64_tr_b16 v[112:113], v7 offset:8192
    ds_read_b64_tr_b16 v[114:115], v7 offset:8448
    ds_read_b64_tr_b16 v[116:117], v7 offset:10240
    ds_read_b64_tr_b16 v[118:119], v7 offset:10496
    ds_read_b64_tr_b16 v[120:121], v7 offset:12288
    ds_read_b64_tr_b16 v[122:123], v7 offset:12544
    ds_read_b64_tr_b16 v[124:125], v7 offset:14336
    ds_read_b64_tr_b16 v[126:127], v7 offset:14592
    s_waitcnt lgkmcnt(0)
    ds_read_b64_tr_b16 v[128:129], v7 offset:16384
    ds_read_b64_tr_b16 v[130:131], v7 offset:16640
    ds_read_b64_tr_b16 v[132:133], v7 offset:18432
    ds_read_b64_tr_b16 v[134:135], v7 offset:18688
    ds_read_b64_tr_b16 v[136:137], v7 offset:20480
    ds_read_b64_tr_b16 v[138:139], v7 offset:20736
    ds_read_b64_tr_b16 v[140:141], v7 offset:22528
    ds_read_b64_tr_b16 v[142:143], v7 offset:22784
    s_waitcnt lgkmcnt(0)
    ds_read_b64_tr_b16 v[144:145], v7 offset:24576
    ds_read_b64_tr_b16 v[146:147], v7 offset:24832
    ds_read_b64_tr_b16 v[148:149], v7 offset:26624
    ds_read_b64_tr_b16 v[150:151], v7 offset:26880
    ds_read_b64_tr_b16 v[152:153], v7 offset:28672
    ds_read_b64_tr_b16 v[154:155], v7 offset:28928
    ds_read_b64_tr_b16 v[156:157], v7 offset:30720
    ds_read_b64_tr_b16 v[158:159], v7 offset:30976
    s_waitcnt lgkmcnt(0)
    s_waitcnt vmcnt(0)
    v_mfma_f32_16x16x32_bf16 v[8:11], v[32:35], v[96:99], 0
    v_mfma_f32_16x16x32_bf16 v[8:11], v[36:39], v[100:103], v[8:11]
    v_mfma_f32_16x16x32_bf16 v[8:11], v[40:43], v[104:107], v[8:11]
    v_mfma_f32_16x16x32_bf16 v[8:11], v[44:47], v[108:111], v[8:11]
    v_mfma_f32_16x16x32_bf16 v[8:11], v[48:51], v[112:115], v[8:11]
    v_mfma_f32_16x16x32_bf16 v[8:11], v[52:55], v[116:119], v[8:11]
    v_mfma_f32_16x16x32_bf16 v[8:11], v[56:59], v[120:123], v[8:11]
    v_mfma_f32_16x16x32_bf16 v[8:11], v[60:63], v[124:127], v[8:11]
    v_mfma_f32_16x16x32_bf16 v[8:11], v[64:67], v[128:131], v[8:11]
    v_mfma_f32_16x16x32_bf16 v[8:11], v[68:71], v[132:135], v[8:11]
    v_mfma_f32_16x16x32_bf16 v[8:11], v[72:75], v[136:139], v[8:11]
    v_mfma_f32_16x16x32_bf16 v[8:11], v[76:79], v[140:143], v[8:11]
    v_mfma_f32_16x16x32_bf16 v[8:11], v[80:83], v[144:147], v[8:11]
    v_mfma_f32_16x16x32_bf16 v[8:11], v[84:87], v[148:151], v[8:11]
    v_mfma_f32_16x16x32_bf16 v[8:11], v[88:91], v[152:155], v[8:11]
    v_mfma_f32_16x16x32_bf16 v[8:11], v[92:95], v[156:159], v[8:11]
    s_nop 7
    v_cvt_pk_bf16_f32 v8, v8, v8
    v_and_b32 v8, 0xffff0000, v8
    v_cvt_pk_bf16_f32 v9, v9, v9
    v_and_b32 v9, 0xffff0000, v9
    s_cmp_ge_u32 s68, 2
    s_cbranch_scc1 L_ffn_up_149
    v_mul_f32 v13, 0xbfb8aa3b, v8
    v_exp_f32 v13, v13
    s_nop 0
    v_add_f32 v13, 1.0, v13
    v_rcp_f32 v12, v13
    s_nop 0
    v_mul_f32 v8, v12, v8
    v_cvt_pk_bf16_f32 v8, v8, v8
    v_and_b32 v8, 0xffff0000, v8
    v_mul_f32 v13, 0xbfb8aa3b, v9
    v_exp_f32 v13, v13
    s_nop 0
    v_add_f32 v13, 1.0, v13
    v_rcp_f32 v12, v13
    s_nop 0
    v_mul_f32 v9, v12, v9
    v_cvt_pk_bf16_f32 v9, v9, v9
    v_and_b32 v9, 0xffff0000, v9
    s_nop 4
L_ffn_up_149:
    s_lshr_b32 s71, s68, 1
    s_lshl_b32 s71, s71, 8
    s_and_b32 s72, s68, 1
    s_lshl_b32 s72, s72, 6
    s_add_u32 s71, s71, s72
    s_add_u32 s71, s71, 0x20000
    v_lshlrev_b32 v4, 2, v3
    v_add_u32 v4, s71, v4
    ds_write_b32 v4, v8
    ds_write_b32 v4, v9 offset:128
    s_waitcnt lgkmcnt(0)
    s_barrier
    v_and_b32 v4, 1, v3
    v_lshlrev_b32 v4, 7, v4
    v_lshl_add_u32 v4, v2, 5, v4
    v_add_u32 v4, 0x20000, v4
    ds_read_b128 v[32:35], v4
    ds_read_b128 v[36:39], v4 offset:16
    ds_read_b128 v[40:43], v4 offset:256
    ds_read_b128 v[44:47], v4 offset:272
    v_lshl_add_u32 v5, v2, 3, v6
    v_lshlrev_b32 v5, 10, v5
    v_and_b32 v7, 3, v3
    v_lshl_add_u32 v5, v7, 3, v5
    s_lshl_b32 s71, s68, 8
    s_add_u32 s71, s71, 0x18000
    v_add_u32 v7, s71, v5
    s_waitcnt lgkmcnt(0)
    ds_read_b64_tr_b16 v[96:97], v7
    ds_read_b64_tr_b16 v[98:99], v7 offset:4096
    ds_read_b64_tr_b16 v[100:101], v7 offset:32
    ds_read_b64_tr_b16 v[102:103], v7 offset:4128
    ds_read_b64_tr_b16 v[104:105], v7 offset:64
    ds_read_b64_tr_b16 v[106:107], v7 offset:4160
    ds_read_b64_tr_b16 v[108:109], v7 offset:96
    ds_read_b64_tr_b16 v[110:111], v7 offset:4192
    s_waitcnt lgkmcnt(0)
    ds_read_b64_tr_b16 v[112:113], v7 offset:128
    ds_read_b64_tr_b16 v[114:115], v7 offset:4224
    ds_read_b64_tr_b16 v[116:117], v7 offset:160
    ds_read_b64_tr_b16 v[118:119], v7 offset:4256
    ds_read_b64_tr_b16 v[120:121], v7 offset:192
    ds_read_b64_tr_b16 v[122:123], v7 offset:4288
    ds_read_b64_tr_b16 v[124:125], v7 offset:224
    ds_read_b64_tr_b16 v[126:127], v7 offset:4320
    v_mul_f32 v32, v32, v40
    v_mul_f32 v33, v33, v41
    v_mul_f32 v34, v34, v42
    v_mul_f32 v35, v35, v43
    v_mul_f32 v36, v36, v44
    v_mul_f32 v37, v37, v45
    v_mul_f32 v38, v38, v46
    v_mul_f32 v39, v39, v47
    v_cvt_pk_bf16_f32 v48, v32, v33
    v_cvt_pk_bf16_f32 v49, v34, v35
    v_cvt_pk_bf16_f32 v50, v36, v37
    v_cvt_pk_bf16_f32 v51, v38, v39
    s_waitcnt lgkmcnt(0)
    s_nop 0
    v_mfma_f32_16x16x32_bf16 v[56:59], v[48:51], v[96:99], 0
    v_mfma_f32_16x16x32_bf16 v[60:63], v[48:51], v[100:103], 0
    v_mfma_f32_16x16x32_bf16 v[64:67], v[48:51], v[104:107], 0
    v_mfma_f32_16x16x32_bf16 v[68:71], v[48:51], v[108:111], 0
    v_mfma_f32_16x16x32_bf16 v[72:75], v[48:51], v[112:115], 0
    v_mfma_f32_16x16x32_bf16 v[76:79], v[48:51], v[116:119], 0
    v_mfma_f32_16x16x32_bf16 v[80:83], v[48:51], v[120:123], 0
    v_mfma_f32_16x16x32_bf16 v[84:87], v[48:51], v[124:127], 0
    v_cmp_eq_u32 vcc, 0, v2
    v_lshlrev_b32 v4, 11, v2
    v_lshl_add_u32 v4, v3, 2, v4
    s_lshl_b32 s71, s67, 12
    s_lshl_b32 s72, s68, 9
    s_add_u32 s71, s71, s72
    s_add_u32 s71, s71, 0x6410000
    v_cndmask_b32 v56, v57, v56, vcc
    v_cndmask_b32 v60, v61, v60, vcc
    v_cndmask_b32 v64, v65, v64, vcc
    v_cndmask_b32 v68, v69, v68, vcc
    v_cndmask_b32 v72, v73, v72, vcc
    v_cndmask_b32 v76, v77, v76, vcc
    v_cndmask_b32 v80, v81, v80, vcc
    v_cndmask_b32 v84, v85, v84, vcc
    s_mov_b32 exec_hi, 0
    buffer_store_dword v56, v4, s[8:11], s71 offen sc1
    buffer_store_dword v60, v4, s[8:11], s71 offen offset:64 sc1
    buffer_store_dword v64, v4, s[8:11], s71 offen offset:128 sc1
    buffer_store_dword v68, v4, s[8:11], s71 offen offset:192 sc1
    buffer_store_dword v72, v4, s[8:11], s71 offen offset:256 sc1
    buffer_store_dword v76, v4, s[8:11], s71 offen offset:320 sc1
    buffer_store_dword v80, v4, s[8:11], s71 offen offset:384 sc1
    buffer_store_dword v84, v4, s[8:11], s71 offen offset:448 sc1
    s_mov_b64 exec, -1
    s_waitcnt vmcnt(0)
    s_barrier
    s_lshl_b32 s71, s67, 2
    s_lshl_b32 s72, s75, 8
    s_add_u32 s71, s71, s72
    s_add_u32 s71, s71, 0x8000
    s_cmp_lg_u32 s100, 0
    s_cbranch_scc1 L_flag_150
    v_mov_b32 v2, s74
    s_mov_b64 exec, 1
    buffer_store_dword v2, off, s[8:11], s71 sc1
    s_mov_b64 exec, -1
L_flag_150:
    s_cmp_ge_u32 s67, 8
    s_cbranch_scc1 L_ffn_same
    s_load_dwordx2 s[16:17], s[0:1], 96
    s_waitcnt lgkmcnt(0)
    s_and_b32 s17, s17, 0xffff
    s_mov_b32 s18, 0x200000
    s_mov_b32 s19, 0x20000
    v_and_b32 v3, 63, v0
    s_cmp_lt_u32 s100, 2
    s_cselect_b32 s71, s69, s70
    v_mov_b32 v5, s71
    s_and_b32 s71, s71, 2047
    s_sub_u32 s71, 2047, s71
    s_lshl_b32 s71, s71, 10
    s_lshl_b32 s72, s67, 1
    s_and_b32 s96, s100, 1
    s_add_u32 s72, s72, s96
    s_lshl_b32 s96, s72, 6
    s_add_u32 s71, s71, s96
    v_and_b32 v4, 7, v3
    v_lshlrev_b32 v6, 3, v4
    v_add_u32 v6, s71, v6
    v_lshrrev_b32 v7, 3, v3
    v_lshlrev_b32 v7, 12, v7
    v_lshl_add_u32 v7, v4, 4, v7
    s_lshl_b32 s72, s72, 7
    s_lshr_b32 s96, s100, 1
    s_lshl_b32 s96, s96, 11
    s_add_u32 s72, s72, s96
    v_add_u32 v7, s72, v7
    s_mov_b32 s71, 0x6000000
    s_mov_b32 s72, 0x6200000
    buffer_load_dwordx2 v[8:9], v6, s[8:11], s71 offen sc1
    buffer_load_dwordx2 v[10:11], v6, s[8:11], s72 offen sc1
    v_and_b32 v5, 0xffff0000, v5
    v_ashrrev_i32 v4, 31, v5
    v_not_b32 v4, v4
    v_or_b32 v4, 0x80000000, v4
    v_xor_b32 v5, v5, v4
    v_and_b32 v5, 0xffff0000, v5
    v_mul_f32 v23, 0xbfb8aa3b, v5
    v_exp_f32 v23, v23
    s_nop 0
    v_add_f32 v23, 1.0, v23
    v_rcp_f32 v22, v23
    s_nop 0
    v_cvt_pk_bf16_f32 v22, v22, v22
    v_and_b32 v22, 0xffff0000, v22
    v_lshlrev_b32 v1, 2, v0
    s_lshl_b32 s71, s75, 8
    s_add_u32 s71, s71, 0x8000
    s_cmp_lg_u32 s100, 0
    s_cbranch_scc1 L_polls_153
    s_mov_b32 exec_hi, 0xffffff
    s_mov_b32 s96, 0
L_poll_151:
    buffer_load_dword v2, v1, s[8:11], s71 offen sc1
    s_waitcnt vmcnt(0)
    v_cmp_ne_u32 vcc, s74, v2
    s_cbranch_vccz L_polld_152
    s_sleep 2
    s_add_u32 s96, s96, 1
    s_cmp_lt_u32 s96, 0x10000
    s_cbranch_scc1 L_poll_151
L_polld_152:
    s_mov_b64 exec, -1
L_polls_153:
    s_barrier
    s_mov_b32 s71, 0x6410000
    buffer_load_dwordx4 v[32:35], v7, s[8:11], s71 offen sc1
    s_add_u32 s71, s71, 32768
    buffer_load_dwordx4 v[36:39], v7, s[8:11], s71 offen sc1
    s_add_u32 s71, s71, 32768
    buffer_load_dwordx4 v[40:43], v7, s[8:11], s71 offen sc1
    s_add_u32 s71, s71, 32768
    buffer_load_dwordx4 v[44:47], v7, s[8:11], s71 offen sc1
    s_add_u32 s71, s71, 32768
    buffer_load_dwordx4 v[48:51], v7, s[8:11], s71 offen sc1
    s_add_u32 s71, s71, 32768
    buffer_load_dwordx4 v[52:55], v7, s[8:11], s71 offen sc1
    s_add_u32 s71, s71, 32768
    buffer_load_dwordx4 v[56:59], v7, s[8:11], s71 offen sc1
    s_add_u32 s71, s71, 32768
    s_waitcnt vmcnt(7)
    v_lshlrev_b32 v12, 16, v8
    v_and_b32 v13, 0xffff0000, v8
    v_lshlrev_b32 v16, 16, v10
    v_and_b32 v17, 0xffff0000, v10
    v_lshlrev_b32 v14, 16, v9
    v_and_b32 v15, 0xffff0000, v9
    v_lshlrev_b32 v18, 16, v11
    v_and_b32 v19, 0xffff0000, v11
    s_waitcnt vmcnt(0)
    v_pk_add_f32 v[32:33], v[32:33], v[36:37]
    v_pk_add_f32 v[34:35], v[34:35], v[38:39]
    v_pk_add_f32 v[32:33], v[32:33], v[40:41]
    v_pk_add_f32 v[34:35], v[34:35], v[42:43]
    v_pk_add_f32 v[32:33], v[32:33], v[44:45]
    v_pk_add_f32 v[34:35], v[34:35], v[46:47]
    v_pk_add_f32 v[32:33], v[32:33], v[48:49]
    v_pk_add_f32 v[34:35], v[34:35], v[50:51]
    v_pk_add_f32 v[32:33], v[32:33], v[52:53]
    v_pk_add_f32 v[34:35], v[34:35], v[54:55]
    v_pk_add_f32 v[32:33], v[32:33], v[56:57]
    v_pk_add_f32 v[34:35], v[34:35], v[58:59]
    s_nop 0
    v_add_f32_dpp v32, v32, v32 row_ror:8 row_mask:0xf bank_mask:0xf
    v_add_f32_dpp v33, v33, v33 row_ror:8 row_mask:0xf bank_mask:0xf
    v_add_f32_dpp v34, v34, v34 row_ror:8 row_mask:0xf bank_mask:0xf
    v_add_f32_dpp v35, v35, v35 row_ror:8 row_mask:0xf bank_mask:0xf
    v_mov_b32 v24, v32
    s_nop 1
    v_permlane32_swap_b32 v24, v32
    v_add_f32 v32, v24, v32
    v_mov_b32 v24, v32
    s_nop 1
    v_permlane16_swap_b32 v24, v32
    v_add_f32 v32, v24, v32
    v_mov_b32 v24, v33
    s_nop 1
    v_permlane32_swap_b32 v24, v33
    v_add_f32 v33, v24, v33
    v_mov_b32 v24, v33
    s_nop 1
    v_permlane16_swap_b32 v24, v33
    v_add_f32 v33, v24, v33
    v_mov_b32 v24, v34
    s_nop 1
    v_permlane32_swap_b32 v24, v34
    v_add_f32 v34, v24, v34
    v_mov_b32 v24, v34
    s_nop 1
    v_permlane16_swap_b32 v24, v34
    v_add_f32 v34, v24, v34
    v_mov_b32 v24, v35
    s_nop 1
    v_permlane32_swap_b32 v24, v35
    v_add_f32 v35, v24, v35
    v_mov_b32 v24, v35
    s_nop 1
    v_permlane16_swap_b32 v24, v35
    v_add_f32 v35, v24, v35
    v_cvt_pk_bf16_f32 v32, v32, v32
    v_and_b32 v32, 0xffff0000, v32
    v_mul_f32 v32, v22, v32
    v_cvt_pk_bf16_f32 v32, v32, v32
    v_and_b32 v32, 0xffff0000, v32
    v_add_f32 v32, v16, v32
    v_cvt_pk_bf16_f32 v32, v32, v32
    v_and_b32 v32, 0xffff0000, v32
    v_add_f32 v32, v12, v32
    v_cvt_pk_bf16_f32 v33, v33, v33
    v_and_b32 v33, 0xffff0000, v33
    v_mul_f32 v33, v22, v33
    v_cvt_pk_bf16_f32 v33, v33, v33
    v_and_b32 v33, 0xffff0000, v33
    v_add_f32 v33, v17, v33
    v_cvt_pk_bf16_f32 v33, v33, v33
    v_and_b32 v33, 0xffff0000, v33
    v_add_f32 v33, v13, v33
    v_cvt_pk_bf16_f32 v34, v34, v34
    v_and_b32 v34, 0xffff0000, v34
    v_mul_f32 v34, v22, v34
    v_cvt_pk_bf16_f32 v34, v34, v34
    v_and_b32 v34, 0xffff0000, v34
    v_add_f32 v34, v18, v34
    v_cvt_pk_bf16_f32 v34, v34, v34
    v_and_b32 v34, 0xffff0000, v34
    v_add_f32 v34, v14, v34
    v_cvt_pk_bf16_f32 v35, v35, v35
    v_and_b32 v35, 0xffff0000, v35
    v_mul_f32 v35, v22, v35
    v_cvt_pk_bf16_f32 v35, v35, v35
    v_and_b32 v35, 0xffff0000, v35
    v_add_f32 v35, v19, v35
    v_cvt_pk_bf16_f32 v35, v35, v35
    v_and_b32 v35, 0xffff0000, v35
    v_add_f32 v35, v15, v35
    v_cvt_pk_bf16_f32 v200, v32, v33
    v_cvt_pk_bf16_f32 v201, v34, v35
    v_mov_b32 v202, v6
L_ffn_same:
    s_add_u32 s75, s75, 1
    s_cmp_lt_u32 s75, 2
    s_cbranch_scc1 L_ffn_round
    s_cmp_ge_u32 s67, 8
    s_cbranch_scc1 L_exit
    s_mov_b32 exec_lo, 0xff
    s_mov_b32 exec_hi, 0
    buffer_store_dwordx2 v[200:201], v202, s[16:19], 0 offen
    s_mov_b64 exec, -1
    s_waitcnt vmcnt(0)
L_exit:
    s_endpgm
L_code_end:
.section .rodata,"a"
.p2align 6
.amdhsa_kernel sequential_preLN__memory_aug_recurrent_mem_tr__moe_arch_mod__prompt_kernel
  .amdhsa_next_free_vgpr 512
  .amdhsa_next_free_sgpr 102
  .amdhsa_accum_offset 256
  .amdhsa_group_segment_fixed_size 0
  .amdhsa_kernarg_size 120
  .amdhsa_user_sgpr_count 2
  .amdhsa_user_sgpr_kernarg_segment_ptr 1
  .amdhsa_system_sgpr_workgroup_id_x 1
  .amdhsa_float_denorm_mode_32 3
.end_amdhsa_kernel
```

```asm
; @launch grid=(256,1,1) block=(256,1,1) lds=163840
.amdgcn_target "amdgcn-amd-amdhsa--gfx950"
.text
.globl sequential_preLN__memory_aug_recurrent_mem_tr__moe_arch_mod__prompt_kernel
.p2align 8
.type sequential_preLN__memory_aug_recurrent_mem_tr__moe_arch_mod__prompt_kernel,@function
sequential_preLN__memory_aug_recurrent_mem_tr__moe_arch_mod__prompt_kernel:
    s_cmp_ge_u32 s2, 256
    s_cbranch_scc1 L_exit
    s_load_dwordx2 s[8:9], s[0:1], 112
    s_load_dwordx2 s[92:93], s[0:1], 104
    s_load_dwordx8 s[60:67], s[0:1], 16
    s_load_dwordx2 s[12:13], s[0:1], 0
    v_lshrrev_b32 v1, 6, v0
    s_nop 0
    v_readfirstlane_b32 s100, v1
    s_getreg_b32 s84, hwreg(HW_REG_XCC_ID)
    s_and_b32 s84, s84, 7
    s_lshr_b32 s85, s2, 3
    s_mov_b32 s86, s100
    s_cmp_eq_u32 s2, 7
    s_cbranch_scc1 L_zero
L_noz:
    s_cmp_lg_u32 s84, 0
    s_cbranch_scc1 L_other
    s_xor_b32 s20, s85, 0
    v_lshrrev_b32 v4, 6, v0
    s_nop 0
    v_readfirstlane_b32 s21, v4
    v_and_b32 v1, 63, v0
    v_lshrrev_b32 v2, 4, v1
    v_and_b32 v3, 15, v1
    v_lshrrev_b32 v6, 2, v3
    v_lshlrev_b32 v117, 4, v1
    s_lshl_b32 s51, s21, 10
    s_lshl_b32 s52, s21, 11
    s_mov_b32 s14, 0x400000
    s_mov_b32 s15, 0x20000
    s_lshl_b32 s41, s20, 8
    s_lshl_b32 s42, s20, 17
    s_lshr_b32 s43, s21, 1
    s_lshl_b32 s43, s43, 2
    v_or_b32 v5, s43, v2
    v_lshlrev_b32 v5, 1, v5
    v_xor_b32 v5, v5, v3
    v_lshrrev_b32 v14, 2, v5
    v_and_b32 v14, 2, v14
    v_lshlrev_b32 v5, 4, v5
    s_lshl_b32 s43, s21, 4
    v_add_u32 v4, s43, v2
    v_lshl_add_u32 v8, v4, 13, v5
    s_cmp_lg_u32 s20, 0
    s_cbranch_scc1 L_nocc_1
    v_lshlrev_b32 v25, 3, v117
    s_lshl_b32 s43, s21, 13
    s_getpc_b64 s[4:5]
L_pc_2:
    s_add_u32 s4, s4, L_nocc_1-L_pc_2
    s_addc_u32 s5, s5, 0
    v_add_u32 v25, s43, v25
    v_min_u32 v25, L_code_end-L_nocc_1-4, v25
    global_load_dword v29, v25, s[4:5]
L_nocc_1:
    v_mul_u32_u24 v22, 57, v0
    v_lshrrev_b32 v22, 11, v22
    v_mul_u32_u24 v23, 36, v22
    v_sub_u32 v23, v0, v23
    v_and_b32 v25, 3, v23
    v_and_or_b32 v23, v23, 60, 1
    v_min_u32 v23, 31, v23
    v_lshl_add_u32 v23, v23, 2, v25
    v_lshlrev_b32 v31, 6, v23
    s_add_u32 s43, s20, 2
    s_lshr_b32 s43, s43, 2
    s_sub_u32 s43, s20, s43
    s_mul_i32 s43, s43, 7
    v_add_u32 v22, s43, v22
    s_waitcnt lgkmcnt(0)
    s_mov_b32 s4, s60
    s_and_b32 s5, s61, 0xffff
    s_lshr_b32 s6, 0x5ddddddd, s20
    s_and_b32 s6, s6, 1
    s_lshl_b32 s6, s6, 22
    s_mov_b32 s7, 0x20000
    v_add_u32 v23, 0, v22
    v_and_b32 v25, 448, v23
    v_add_u32 v23, v23, v25
    v_lshl_add_u32 v23, v23, 13, v31
    s_mov_b32 s43, 0x80000
    buffer_load_dword v30, v23, s[4:7], s43 offen
    s_mov_b32 s4, s60
    s_and_b32 s5, s61, 0xffff
    s_lshr_b32 s6, 0x5ddddddd, s20
    s_and_b32 s6, s6, 1
    s_lshl_b32 s6, s6, 22
    s_mov_b32 s7, 0x20000
    v_add_u32 v23, 161, v22
    v_and_b32 v25, 448, v23
    v_add_u32 v23, v23, v25
    v_lshl_add_u32 v23, v23, 13, v31
    s_mov_b32 s43, 0x80000
    buffer_load_dword v30, v23, s[4:7], s43 offen
    s_and_b32 s9, s9, 0xffff
    s_mov_b32 s10, 0x10000000
    s_mov_b32 s11, 0x20000
    s_and_b32 s93, s93, 0xffff
    s_mov_b32 s94, 0x100
    s_mov_b32 s95, 0x20000
    s_mov_b32 s87, 0
    s_cmp_lg_u32 s86, 0
    s_cbranch_scc1 L_reg_3
    s_lshl_b32 s97, s84, 4
    s_lshl_b32 s96, 1, s85
    v_mov_b32 v250, s96
    v_mov_b32 v251, 256
    s_mov_b64 exec, 1
    buffer_atomic_add_x2 v[250:251], off, s[92:95], s97 offset:64
    s_mov_b64 exec, -1
    s_mov_b32 s86, 1
L_reg_3:
    s_mov_b32 s16, s92
    s_mov_b32 s17, s93
    s_mov_b32 s18, s94
    s_mov_b32 s19, s95
    s_mov_b32 s88, s20
    s_mov_b32 s12, s60
    s_and_b32 s13, s61, 0xffff
    v_xor_b32 v15, 0, v14
    v_lshl_add_u32 v15, v15, 15, v8
    s_add_u32 s43, s41, 0x0
    s_add_u32 m0, s51, 0x8000
    s_nop 0
    buffer_load_dwordx4 v15, s[12:15], s43 offen lds
    s_add_u32 s43, s41, 0x8000
    s_add_u32 m0, s51, 0x9000
    s_nop 0
    buffer_load_dwordx4 v15, s[12:15], s43 offen lds
    s_add_u32 s43, s41, 0x100000
    s_add_u32 m0, s51, 0xa000
    s_nop 0
    buffer_load_dwordx4 v15, s[12:15], s43 offen lds
    s_add_u32 s43, s41, 0x108000
    s_add_u32 m0, s51, 0xb000
    s_nop 0
    buffer_load_dwordx4 v15, s[12:15], s43 offen lds
    s_add_u32 s43, s41, 0x200000
    s_add_u32 m0, s51, 0xc000
    s_nop 0
    buffer_load_dwordx4 v15, s[12:15], s43 offen lds
    s_add_u32 s43, s41, 0x208000
    s_add_u32 m0, s51, 0xd000
    s_nop 0
    buffer_load_dwordx4 v15, s[12:15], s43 offen lds
    s_add_u32 s43, s41, 0x300000
    s_add_u32 m0, s51, 0xe000
    s_nop 0
    buffer_load_dwordx4 v15, s[12:15], s43 offen lds
    s_add_u32 s43, s41, 0x308000
    s_add_u32 m0, s51, 0xf000
    s_nop 0
    buffer_load_dwordx4 v15, s[12:15], s43 offen lds
    v_xor_b32 v15, 2, v14
    v_lshl_add_u32 v15, v15, 15, v8
    s_add_u32 s43, s41, 0x0
    s_add_u32 m0, s51, 0x10000
    s_nop 0
    buffer_load_dwordx4 v15, s[12:15], s43 offen lds
    s_add_u32 s43, s41, 0x8000
    s_add_u32 m0, s51, 0x11000
    s_nop 0
    buffer_load_dwordx4 v15, s[12:15], s43 offen lds
    s_add_u32 s43, s41, 0x100000
    s_add_u32 m0, s51, 0x12000
    s_nop 0
    buffer_load_dwordx4 v15, s[12:15], s43 offen lds
    s_add_u32 s43, s41, 0x108000
    s_add_u32 m0, s51, 0x13000
    s_nop 0
    buffer_load_dwordx4 v15, s[12:15], s43 offen lds
    s_add_u32 s43, s41, 0x200000
    s_add_u32 m0, s51, 0x14000
    s_nop 0
    buffer_load_dwordx4 v15, s[12:15], s43 offen lds
    s_add_u32 s43, s41, 0x208000
    s_add_u32 m0, s51, 0x15000
    s_nop 0
    buffer_load_dwordx4 v15, s[12:15], s43 offen lds
    s_add_u32 s43, s41, 0x300000
    s_add_u32 m0, s51, 0x16000
    s_nop 0
    buffer_load_dwordx4 v15, s[12:15], s43 offen lds
    s_add_u32 s43, s41, 0x308000
    s_add_u32 m0, s51, 0x17000
    s_nop 0
    buffer_load_dwordx4 v15, s[12:15], s43 offen lds
    v_xor_b32 v15, 0, v14
    v_lshl_add_u32 v15, v15, 15, v8
    s_add_u32 s43, s41, 0x80000
    s_add_u32 m0, s51, 0x18000
    s_nop 0
    buffer_load_dwordx4 v15, s[12:15], s43 offen lds
    s_add_u32 s43, s41, 0x88000
    s_add_u32 m0, s51, 0x19000
    s_nop 0
    buffer_load_dwordx4 v15, s[12:15], s43 offen lds
    s_add_u32 s43, s41, 0x180000
    s_add_u32 m0, s51, 0x1a000
    s_nop 0
    buffer_load_dwordx4 v15, s[12:15], s43 offen lds
    s_add_u32 s43, s41, 0x188000
    s_add_u32 m0, s51, 0x1b000
    s_nop 0
    buffer_load_dwordx4 v15, s[12:15], s43 offen lds
    v_and_b32 v4, 2, v3
    v_cmp_ne_u32 vcc, 0, v4
    v_mov_b32 v4, 0x4444
    v_mov_b32 v5, 0xeeee
    v_cndmask_b32 v116, v4, v5, vcc
    v_lshrrev_b32 v5, 1, v2
    v_lshl_add_u32 v4, v6, 3, v5
    s_lshl_b32 s43, s21, 1
    v_add_u32 v4, s43, v4
    v_add_u32 v5, s20, v4
    v_and_b32 v5, 31, v5
    v_lshl_add_u32 v4, v4, 6, v5
    v_and_b32 v5, 1, v2
    v_lshl_add_u32 v4, v4, 1, v5
    v_and_b32 v5, 3, v3
    v_lshl_add_u32 v4, v4, 2, v5
    v_lshlrev_b32 v118, 4, v4
    v_and_b32 v4, 1, v2
    v_lshlrev_b32 v4, 2, v4
    v_and_b32 v7, 2, v2
    v_add_u32 v4, v4, v7
    v_and_b32 v7, 1, v6
    v_add_u32 v4, v4, v7
    v_lshl_add_u32 v4, v4, 2, v5
    v_lshlrev_b32 v4, 2, v4
    s_and_b32 s43, s21, 1
    s_lshl_b32 s43, s43, 12
    s_lshl_b32 s40, s20, 7
    s_add_u32 s43, s43, s40
    v_add_u32 v119, s43, v4
    v_sub_u32 v7, 0, v2
    v_and_b32 v7, 3, v7
    v_xor_b32 v7, v7, v6
    v_lshl_add_u32 v4, v2, 4, v7
    v_and_b32 v5, 3, v3
    v_lshl_add_u32 v4, v4, 2, v5
    s_add_u32 s43, s51, 16384
    v_lshl_add_u32 v120, v4, 2, s43
    v_sub_u32 v7, 0, v6
    v_and_b32 v7, 3, v7
    v_xor_b32 v7, v7, v2
    v_lshl_add_u32 v4, v3, 2, v7
    v_lshlrev_b32 v121, 4, v4
    v_and_b32 v5, 1, v3
    v_lshl_add_u32 v4, v6, 1, v5
    v_lshl_add_u32 v4, v2, 3, v4
    v_lshlrev_b32 v127, 4, v4
    v_and_or_b32 v122, v116, 8, v127
    s_lshl_b32 s43, s21, 13
    s_add_u32 s43, s43, 32768
    v_add_u32 v123, s43, v117
    v_add_u32 v124, 0x10000, v123
    s_mov_b32 s36, 0xcccccccc
    s_mov_b32 s37, 0xcccccccc
    s_mov_b32 s38, 0x00ff00ff
    s_mov_b32 s39, 0x00ff00ff
    s_mov_b32 s34, 0x3e0293ee
    s_mov_b32 s35, 0x49800000
    s_mov_b32 s50, 0x3f803f80
    v_and_b32 v5, 1, v2
    v_or_b32 v5, 0, v5
    v_xor_b32 v5, v5, v6
    v_and_b32 v7, 2, v5
    v_add_u32 v5, v5, v7
    v_lshlrev_b32 v5, 6, v5
    v_and_b32 v7, 3, v3
    v_lshl_add_u32 v7, v7, 4, v5
    s_lshl_b32 s43, s21, 2
    v_add_u32 v4, s43, v2
    v_lshl_add_u32 v10, v4, 10, v7
    v_and_b32 v5, 1, v2
    v_or_b32 v5, 2, v5
    v_xor_b32 v5, v5, v6
    v_and_b32 v7, 2, v5
    v_add_u32 v5, v5, v7
    v_lshlrev_b32 v5, 6, v5
    v_and_b32 v7, 3, v3
    v_lshl_add_u32 v7, v7, 4, v5
    s_lshl_b32 s43, s21, 2
    v_add_u32 v4, s43, v2
    v_lshl_add_u32 v9, v4, 10, v7
    v_and_b32 v5, 1, v2
    v_lshl_add_u32 v4, v5, 3, v6
    v_lshrrev_b32 v7, 1, v2
    v_lshl_add_u32 v4, v7, 5, v4
    v_lshlrev_b32 v4, 8, v4
    v_lshl_or_b32 v5, v5, 2, v6
    v_lshlrev_b32 v5, 5, v5
    s_lshl_b32 s43, s21, 6
    v_xor_b32 v5, s43, v5
    v_add_u32 v4, v4, v5
    v_and_b32 v5, 3, v3
    v_lshl_add_u32 v4, v5, 3, v4
    v_add_u32 v11, 32768, v4
    s_and_b32 s43, s21, 1
    s_lshl_b32 s43, s43, 12
    v_add_u32 v11, s43, v11
    v_and_b32 v5, 1, v2
    v_lshlrev_b32 v4, 4, v5
    v_lshl_add_u32 v4, v7, 2, v4
    v_and_b32 v7, 1, v6
    v_add_u32 v4, v4, v7
    s_lshl_b32 s43, s21, 5
    v_add_u32 v4, s43, v4
    v_lshlrev_b32 v4, 8, v4
    v_lshl_or_b32 v5, v5, 1, v7
    s_lshl_b32 s43, s21, 1
    s_and_b32 s43, s43, 3
    v_xor_b32 v5, s43, v5
    v_lshl_add_u32 v4, v5, 6, v4
    v_lshrrev_b32 v5, 1, v6
    v_lshl_add_u32 v4, v5, 5, v4
    v_and_b32 v5, 3, v3
    v_lshl_add_u32 v4, v5, 3, v4
    v_add_u32 v12, 32768, v4
    v_lshlrev_b32 v4, 18, v2
    v_lshl_add_u32 v4, v3, 7, v4
    s_lshl_b32 s43, s20, 13
    s_add_u32 s43, s43, s52
    s_add_u32 s43, s43, 0xf0000
    v_add_u32 v4, s43, v4
    v_and_b32 v5, 3, v3
    v_lshl_add_u32 v5, v5, 13, v119
    v_cmp_gt_u32 vcc, 2, v2
    s_nop 1
    v_cndmask_b32 v7, v5, v4, vcc
    v_mov_b32 v16, -1
    v_mov_b32 v17, -1
    v_mov_b32 v18, -1
    v_mov_b32 v19, -1
    s_lshl_b32 s43, s20, 13
    s_add_u32 s43, s43, 0x100000
    s_and_b32 s40, s21, 1
    s_lshl_b32 s40, s40, 12
    s_add_u32 s29, s43, s40
    s_add_u32 s43, s43, s52
    s_xor_b32 s40, s43, 0x40000
    buffer_store_dwordx4 v[16:19], v117, s[8:11], s43 offen
    buffer_store_dwordx4 v[16:19], v117, s[8:11], s43 offen offset:1024
    buffer_store_dwordx4 v[16:19], v117, s[8:11], s40 offen
    buffer_store_dwordx4 v[16:19], v117, s[8:11], s40 offen offset:1024
    s_mov_b32 s43, 0x12000
    buffer_store_dword v16, v119, s[8:11], s43 offen
    s_mov_b32 s43, 0x14000
    buffer_store_dword v16, v119, s[8:11], s43 offen
    s_mov_b32 s43, 0x16000
    buffer_store_dword v16, v119, s[8:11], s43 offen
    s_load_dwordx2 s[4:5], s[0:1], 8
    s_waitcnt lgkmcnt(0)
    s_and_b32 s5, s5, 0xffff
    s_mov_b32 s6, 8192
    s_mov_b32 s7, 0x20000
    v_and_b32 v20, 1, v2
    v_and_b32 v21, 1, v6
    v_lshl_add_u32 v20, v20, 1, v21
    v_lshlrev_b32 v20, 9, v20
    v_and_b32 v21, 3, v3
    v_lshl_add_u32 v20, v21, 4, v20
    v_and_b32 v21, 2, v2
    v_add_u32 v20, v20, v21
    s_and_b32 s43, s20, 1
    s_lshl_b32 s43, s43, 11
    s_bfe_u32 s40, s20, 0x20001
    s_lshl_b32 s40, s40, 7
    s_add_u32 s43, s43, s40
    s_and_b32 s40, s21, 1
    s_lshl_b32 s40, s40, 6
    s_add_u32 s43, s43, s40
    s_lshr_b32 s40, s20, 3
    s_lshl_b32 s40, s40, 2
    s_add_u32 s43, s43, s40
    v_add_u32 v20, s43, v20
    v_lshlrev_b32 v20, 1, v20
    buffer_load_dword v21, v20, s[4:7], 0 offen
    s_mov_b32 s57, 0
    s_lshl_b32 s43, s20, 13
    s_add_u32 s43, s43, s52
    s_add_u32 s30, s43, 0x1000000
    s_add_u32 s31, s43, 0x2000000
    s_lshr_b32 s43, s43, 1
    s_add_u32 s32, s43, 0x220000
    s_waitcnt vmcnt(20)
    s_barrier
    v_xor_b32 v13, 0x0, v11
    v_add_u32 v13, 0x0, v13
    ds_read_b64_tr_b16 v[32:33], v13
    ds_read_b64_tr_b16 v[34:35], v13 offset:1024
    ds_read_b64_tr_b16 v[36:37], v13 offset:16384
    ds_read_b64_tr_b16 v[38:39], v13 offset:17408
    v_xor_b32 v13, 0x20, v11
    v_add_u32 v13, 0x0, v13
    ds_read_b64_tr_b16 v[40:41], v13
    ds_read_b64_tr_b16 v[42:43], v13 offset:1024
    ds_read_b64_tr_b16 v[44:45], v13 offset:16384
    ds_read_b64_tr_b16 v[46:47], v13 offset:17408
    v_xor_b32 v13, 0x1000, v11
    v_add_u32 v13, 0x0, v13
    ds_read_b64_tr_b16 a[0:1], v13
    ds_read_b64_tr_b16 a[2:3], v13 offset:1024
    ds_read_b64_tr_b16 a[4:5], v13 offset:16384
    ds_read_b64_tr_b16 a[6:7], v13 offset:17408
    v_xor_b32 v13, 0x1020, v11
    v_add_u32 v13, 0x0, v13
    ds_read_b64_tr_b16 a[8:9], v13
    ds_read_b64_tr_b16 a[10:11], v13 offset:1024
    ds_read_b64_tr_b16 a[12:13], v13 offset:16384
    ds_read_b64_tr_b16 a[14:15], v13 offset:17408
    s_waitcnt lgkmcnt(0)
    s_barrier
    s_mov_b32 s4, s62
    s_and_b32 s5, s63, 0xffff
    s_lshr_b32 s6, 0x5ddddddd, s20
    s_and_b32 s6, s6, 1
    s_lshl_b32 s6, s6, 22
    s_mov_b32 s7, 0x20000
    v_add_u32 v23, 0, v22
    v_and_b32 v25, 448, v23
    v_add_u32 v23, v23, v25
    v_lshl_add_u32 v23, v23, 13, v31
    s_mov_b32 s43, 0x0
    buffer_load_dword v30, v23, s[4:7], s43 offen
    s_add_u32 s43, s41, 0x280000
    s_add_u32 m0, s51, 0x1c000
    s_nop 0
    buffer_load_dwordx4 v15, s[12:15], s43 offen lds
    s_add_u32 s43, s41, 0x288000
    s_add_u32 m0, s51, 0x1d000
    s_nop 0
    buffer_load_dwordx4 v15, s[12:15], s43 offen lds
    s_add_u32 s43, s41, 0x380000
    s_add_u32 m0, s51, 0x1e000
    s_nop 0
    buffer_load_dwordx4 v15, s[12:15], s43 offen lds
    s_add_u32 s43, s41, 0x388000
    s_add_u32 m0, s51, 0x1f000
    s_nop 0
    buffer_load_dwordx4 v15, s[12:15], s43 offen lds
    v_xor_b32 v15, 2, v14
    v_lshl_add_u32 v15, v15, 15, v8
    s_add_u32 s43, s41, 0x80000
    s_add_u32 m0, s51, 0x20000
    s_nop 0
    buffer_load_dwordx4 v15, s[12:15], s43 offen lds
    s_add_u32 s43, s41, 0x88000
    s_add_u32 m0, s51, 0x21000
    s_nop 0
    buffer_load_dwordx4 v15, s[12:15], s43 offen lds
    s_add_u32 s43, s41, 0x180000
    s_add_u32 m0, s51, 0x22000
    s_nop 0
    buffer_load_dwordx4 v15, s[12:15], s43 offen lds
    s_add_u32 s43, s41, 0x188000
    s_add_u32 m0, s51, 0x23000
    s_nop 0
    buffer_load_dwordx4 v15, s[12:15], s43 offen lds
    s_waitcnt vmcnt(21)
    s_barrier
    v_xor_b32 v13, 0x0, v11
    v_add_u32 v13, 0x8000, v13
    ds_read_b64_tr_b16 a[32:33], v13
    ds_read_b64_tr_b16 a[34:35], v13 offset:1024
    ds_read_b64_tr_b16 a[36:37], v13 offset:16384
    ds_read_b64_tr_b16 a[38:39], v13 offset:17408
    v_xor_b32 v13, 0x20, v11
    v_add_u32 v13, 0x8000, v13
    ds_read_b64_tr_b16 a[40:41], v13
    ds_read_b64_tr_b16 a[42:43], v13 offset:1024
    ds_read_b64_tr_b16 a[44:45], v13 offset:16384
    ds_read_b64_tr_b16 a[46:47], v13 offset:17408
    v_xor_b32 v13, 0x1000, v11
    v_add_u32 v13, 0x8000, v13
    ds_read_b64_tr_b16 a[64:65], v13
    ds_read_b64_tr_b16 a[66:67], v13 offset:1024
    ds_read_b64_tr_b16 a[68:69], v13 offset:16384
    ds_read_b64_tr_b16 a[70:71], v13 offset:17408
    v_xor_b32 v13, 0x1020, v11
    v_add_u32 v13, 0x8000, v13
    ds_read_b64_tr_b16 a[72:73], v13
    ds_read_b64_tr_b16 a[74:75], v13 offset:1024
    ds_read_b64_tr_b16 a[76:77], v13 offset:16384
    ds_read_b64_tr_b16 a[78:79], v13 offset:17408
    s_waitcnt lgkmcnt(0)
    s_barrier
    s_add_u32 s43, s41, 0x280000
    s_add_u32 m0, s51, 0x24000
    s_nop 0
    buffer_load_dwordx4 v15, s[12:15], s43 offen lds
    s_add_u32 s43, s41, 0x288000
    s_add_u32 m0, s51, 0x25000
    s_nop 0
    buffer_load_dwordx4 v15, s[12:15], s43 offen lds
    s_add_u32 s43, s41, 0x380000
    s_add_u32 m0, s51, 0x26000
    s_nop 0
    buffer_load_dwordx4 v15, s[12:15], s43 offen lds
    s_add_u32 s43, s41, 0x388000
    s_add_u32 m0, s51, 0x27000
    s_nop 0
    buffer_load_dwordx4 v15, s[12:15], s43 offen lds
    s_mov_b32 s12, s62
    s_and_b32 s13, s63, 0xffff
    v_xor_b32 v15, 0, v14
    v_lshl_add_u32 v15, v15, 15, v8
    s_add_u32 s43, s41, 0x0
    s_add_u32 m0, s51, 0x8000
    s_nop 0
    buffer_load_dwordx4 v15, s[12:15], s43 offen lds
    s_add_u32 s43, s41, 0x8000
    s_add_u32 m0, s51, 0x9000
    s_nop 0
    buffer_load_dwordx4 v15, s[12:15], s43 offen lds
    s_add_u32 s43, s41, 0x100000
    s_add_u32 m0, s51, 0xa000
    s_nop 0
    buffer_load_dwordx4 v15, s[12:15], s43 offen lds
    s_add_u32 s43, s41, 0x108000
    s_add_u32 m0, s51, 0xb000
    s_nop 0
    buffer_load_dwordx4 v15, s[12:15], s43 offen lds
    s_waitcnt vmcnt(12)
    s_barrier
    v_xor_b32 v13, 0x0, v11
    v_add_u32 v13, 0x10000, v13
    ds_read_b64_tr_b16 v[48:49], v13
    ds_read_b64_tr_b16 v[50:51], v13 offset:1024
    ds_read_b64_tr_b16 v[52:53], v13 offset:16384
    ds_read_b64_tr_b16 v[54:55], v13 offset:17408
    v_xor_b32 v13, 0x20, v11
    v_add_u32 v13, 0x10000, v13
    ds_read_b64_tr_b16 v[56:57], v13
    ds_read_b64_tr_b16 v[58:59], v13 offset:1024
    ds_read_b64_tr_b16 v[60:61], v13 offset:16384
    ds_read_b64_tr_b16 v[62:63], v13 offset:17408
    v_xor_b32 v13, 0x1000, v11
    v_add_u32 v13, 0x10000, v13
    ds_read_b64_tr_b16 a[16:17], v13
    ds_read_b64_tr_b16 a[18:19], v13 offset:1024
    ds_read_b64_tr_b16 a[20:21], v13 offset:16384
    ds_read_b64_tr_b16 a[22:23], v13 offset:17408
    v_xor_b32 v13, 0x1020, v11
    v_add_u32 v13, 0x10000, v13
    ds_read_b64_tr_b16 a[24:25], v13
    ds_read_b64_tr_b16 a[26:27], v13 offset:1024
    ds_read_b64_tr_b16 a[28:29], v13 offset:16384
    ds_read_b64_tr_b16 a[30:31], v13 offset:17408
    s_waitcnt lgkmcnt(0)
    s_barrier
    s_add_u32 s43, s41, 0x200000
    s_add_u32 m0, s51, 0xc000
    s_nop 0
    buffer_load_dwordx4 v15, s[12:15], s43 offen lds
    s_add_u32 s43, s41, 0x208000
    s_add_u32 m0, s51, 0xd000
    s_nop 0
    buffer_load_dwordx4 v15, s[12:15], s43 offen lds
    s_add_u32 s43, s41, 0x300000
    s_add_u32 m0, s51, 0xe000
    s_nop 0
    buffer_load_dwordx4 v15, s[12:15], s43 offen lds
    s_add_u32 s43, s41, 0x308000
    s_add_u32 m0, s51, 0xf000
    s_nop 0
    buffer_load_dwordx4 v15, s[12:15], s43 offen lds
    v_xor_b32 v15, 2, v14
    v_lshl_add_u32 v15, v15, 15, v8
    s_add_u32 s43, s41, 0x0
    s_add_u32 m0, s51, 0x10000
    s_nop 0
    buffer_load_dwordx4 v15, s[12:15], s43 offen lds
    s_add_u32 s43, s41, 0x8000
    s_add_u32 m0, s51, 0x11000
    s_nop 0
    buffer_load_dwordx4 v15, s[12:15], s43 offen lds
    s_add_u32 s43, s41, 0x100000
    s_add_u32 m0, s51, 0x12000
    s_nop 0
    buffer_load_dwordx4 v15, s[12:15], s43 offen lds
    s_add_u32 s43, s41, 0x108000
    s_add_u32 m0, s51, 0x13000
    s_nop 0
    buffer_load_dwordx4 v15, s[12:15], s43 offen lds
    s_waitcnt vmcnt(12)
    s_barrier
    v_xor_b32 v13, 0x0, v11
    v_add_u32 v13, 0x18000, v13
    ds_read_b64_tr_b16 a[48:49], v13
    ds_read_b64_tr_b16 a[50:51], v13 offset:1024
    ds_read_b64_tr_b16 a[52:53], v13 offset:16384
    ds_read_b64_tr_b16 a[54:55], v13 offset:17408
    v_xor_b32 v13, 0x20, v11
    v_add_u32 v13, 0x18000, v13
    ds_read_b64_tr_b16 a[56:57], v13
    ds_read_b64_tr_b16 a[58:59], v13 offset:1024
    ds_read_b64_tr_b16 a[60:61], v13 offset:16384
    ds_read_b64_tr_b16 a[62:63], v13 offset:17408
    v_xor_b32 v13, 0x1000, v11
    v_add_u32 v13, 0x18000, v13
    ds_read_b64_tr_b16 a[80:81], v13
    ds_read_b64_tr_b16 a[82:83], v13 offset:1024
    ds_read_b64_tr_b16 a[84:85], v13 offset:16384
    ds_read_b64_tr_b16 a[86:87], v13 offset:17408
    v_xor_b32 v13, 0x1020, v11
    v_add_u32 v13, 0x18000, v13
    ds_read_b64_tr_b16 a[88:89], v13
    ds_read_b64_tr_b16 a[90:91], v13 offset:1024
    ds_read_b64_tr_b16 a[92:93], v13 offset:16384
    ds_read_b64_tr_b16 a[94:95], v13 offset:17408
    s_waitcnt lgkmcnt(0)
    s_barrier
    s_add_u32 s43, s41, 0x200000
    s_add_u32 m0, s51, 0x14000
    s_nop 0
    buffer_load_dwordx4 v15, s[12:15], s43 offen lds
    s_add_u32 s43, s41, 0x208000
    s_add_u32 m0, s51, 0x15000
    s_nop 0
    buffer_load_dwordx4 v15, s[12:15], s43 offen lds
    s_add_u32 s43, s41, 0x300000
    s_add_u32 m0, s51, 0x16000
    s_nop 0
    buffer_load_dwordx4 v15, s[12:15], s43 offen lds
    s_add_u32 s43, s41, 0x308000
    s_add_u32 m0, s51, 0x17000
    s_nop 0
    buffer_load_dwordx4 v15, s[12:15], s43 offen lds
    v_xor_b32 v15, 0, v14
    v_lshl_add_u32 v15, v15, 15, v8
    s_add_u32 s43, s41, 0x80000
    s_add_u32 m0, s51, 0x18000
    s_nop 0
    buffer_load_dwordx4 v15, s[12:15], s43 offen lds
    s_add_u32 s43, s41, 0x88000
    s_add_u32 m0, s51, 0x19000
    s_nop 0
    buffer_load_dwordx4 v15, s[12:15], s43 offen lds
    s_add_u32 s43, s41, 0x180000
    s_add_u32 m0, s51, 0x1a000
    s_nop 0
    buffer_load_dwordx4 v15, s[12:15], s43 offen lds
    s_add_u32 s43, s41, 0x188000
    s_add_u32 m0, s51, 0x1b000
    s_nop 0
    buffer_load_dwordx4 v15, s[12:15], s43 offen lds
    s_waitcnt vmcnt(12)
    v_min_u32 v21, 0xfffffffe, v21
    s_mov_b32 s43, 0x10000
    s_mov_b64 exec, s[38:39]
    buffer_store_dword v21, v119, s[8:11], s43 offen
    s_mov_b64 exec, -1
    s_barrier
    v_xor_b32 v13, 0x0, v11
    v_add_u32 v13, 0x0, v13
    ds_read_b64_tr_b16 v[64:65], v13
    ds_read_b64_tr_b16 v[66:67], v13 offset:1024
    ds_read_b64_tr_b16 v[68:69], v13 offset:16384
    ds_read_b64_tr_b16 v[70:71], v13 offset:17408
    v_xor_b32 v13, 0x20, v11
    v_add_u32 v13, 0x0, v13
    ds_read_b64_tr_b16 v[72:73], v13
    ds_read_b64_tr_b16 v[74:75], v13 offset:1024
    ds_read_b64_tr_b16 v[76:77], v13 offset:16384
    ds_read_b64_tr_b16 v[78:79], v13 offset:17408
    v_xor_b32 v13, 0x1000, v11
    v_add_u32 v13, 0x0, v13
    ds_read_b64_tr_b16 a[96:97], v13
    ds_read_b64_tr_b16 a[98:99], v13 offset:1024
    ds_read_b64_tr_b16 a[100:101], v13 offset:16384
    ds_read_b64_tr_b16 a[102:103], v13 offset:17408
    v_xor_b32 v13, 0x1020, v11
    v_add_u32 v13, 0x0, v13
    ds_read_b64_tr_b16 a[104:105], v13
    ds_read_b64_tr_b16 a[106:107], v13 offset:1024
    ds_read_b64_tr_b16 a[108:109], v13 offset:16384
    ds_read_b64_tr_b16 a[110:111], v13 offset:17408
    s_waitcnt lgkmcnt(0)
    s_barrier
    s_add_u32 s43, s41, 0x280000
    s_add_u32 m0, s51, 0x1c000
    s_nop 0
    buffer_load_dwordx4 v15, s[12:15], s43 offen lds
    s_add_u32 s43, s41, 0x288000
    s_add_u32 m0, s51, 0x1d000
    s_nop 0
    buffer_load_dwordx4 v15, s[12:15], s43 offen lds
    s_add_u32 s43, s41, 0x380000
    s_add_u32 m0, s51, 0x1e000
    s_nop 0
    buffer_load_dwordx4 v15, s[12:15], s43 offen lds
    s_add_u32 s43, s41, 0x388000
    s_add_u32 m0, s51, 0x1f000
    s_nop 0
    buffer_load_dwordx4 v15, s[12:15], s43 offen lds
    v_xor_b32 v15, 2, v14
    v_lshl_add_u32 v15, v15, 15, v8
    s_add_u32 s43, s41, 0x80000
    s_add_u32 m0, s51, 0x20000
    s_nop 0
    buffer_load_dwordx4 v15, s[12:15], s43 offen lds
    s_add_u32 s43, s41, 0x88000
    s_add_u32 m0, s51, 0x21000
    s_nop 0
    buffer_load_dwordx4 v15, s[12:15], s43 offen lds
    s_add_u32 s43, s41, 0x180000
    s_add_u32 m0, s51, 0x22000
    s_nop 0
    buffer_load_dwordx4 v15, s[12:15], s43 offen lds
    s_add_u32 s43, s41, 0x188000
    s_add_u32 m0, s51, 0x23000
    s_nop 0
    buffer_load_dwordx4 v15, s[12:15], s43 offen lds
    s_waitcnt vmcnt(12)
    s_barrier
    v_xor_b32 v13, 0x0, v11
    v_add_u32 v13, 0x8000, v13
    ds_read_b64_tr_b16 a[128:129], v13
    ds_read_b64_tr_b16 a[130:131], v13 offset:1024
    ds_read_b64_tr_b16 a[132:133], v13 offset:16384
    ds_read_b64_tr_b16 a[134:135], v13 offset:17408
    v_xor_b32 v13, 0x20, v11
    v_add_u32 v13, 0x8000, v13
    ds_read_b64_tr_b16 a[136:137], v13
    ds_read_b64_tr_b16 a[138:139], v13 offset:1024
    ds_read_b64_tr_b16 a[140:141], v13 offset:16384
    ds_read_b64_tr_b16 a[142:143], v13 offset:17408
    v_xor_b32 v13, 0x1000, v11
    v_add_u32 v13, 0x8000, v13
    ds_read_b64_tr_b16 a[160:161], v13
    ds_read_b64_tr_b16 a[162:163], v13 offset:1024
    ds_read_b64_tr_b16 a[164:165], v13 offset:16384
    ds_read_b64_tr_b16 a[166:167], v13 offset:17408
    v_xor_b32 v13, 0x1020, v11
    v_add_u32 v13, 0x8000, v13
    ds_read_b64_tr_b16 a[168:169], v13
    ds_read_b64_tr_b16 a[170:171], v13 offset:1024
    ds_read_b64_tr_b16 a[172:173], v13 offset:16384
    ds_read_b64_tr_b16 a[174:175], v13 offset:17408
    s_waitcnt lgkmcnt(0)
    s_barrier
    buffer_load_dwordx2 v[26:27], off, s[16:19], 0 offset:36 sc1
    s_add_u32 s43, s41, 0x280000
    s_add_u32 m0, s51, 0x24000
    s_nop 0
    buffer_load_dwordx4 v15, s[12:15], s43 offen lds
    s_add_u32 s43, s41, 0x288000
    s_add_u32 m0, s51, 0x25000
    s_nop 0
    buffer_load_dwordx4 v15, s[12:15], s43 offen lds
    s_add_u32 s43, s41, 0x380000
    s_add_u32 m0, s51, 0x26000
    s_nop 0
    buffer_load_dwordx4 v15, s[12:15], s43 offen lds
    s_add_u32 s43, s41, 0x388000
    s_add_u32 m0, s51, 0x27000
    s_nop 0
    buffer_load_dwordx4 v15, s[12:15], s43 offen lds
    s_mov_b32 s12, s64
    s_and_b32 s13, s65, 0xffff
    v_xor_b32 v15, 0, v14
    v_lshl_add_u32 v15, v15, 15, v8
    s_add_u32 s43, s41, 0x0
    s_add_u32 m0, s51, 0x8000
    s_nop 0
    buffer_load_dwordx4 v15, s[12:15], s43 offen lds
    s_add_u32 s43, s41, 0x8000
    s_add_u32 m0, s51, 0x9000
    s_nop 0
    buffer_load_dwordx4 v15, s[12:15], s43 offen lds
    s_add_u32 s43, s41, 0x100000
    s_add_u32 m0, s51, 0xa000
    s_nop 0
    buffer_load_dwordx4 v15, s[12:15], s43 offen lds
    s_add_u32 s43, s41, 0x108000
    s_add_u32 m0, s51, 0xb000
    s_nop 0
    buffer_load_dwordx4 v15, s[12:15], s43 offen lds
    s_waitcnt vmcnt(13)
    s_barrier
    v_xor_b32 v13, 0x0, v11
    v_add_u32 v13, 0x10000, v13
    ds_read_b64_tr_b16 v[80:81], v13
    ds_read_b64_tr_b16 v[82:83], v13 offset:1024
    ds_read_b64_tr_b16 v[84:85], v13 offset:16384
    ds_read_b64_tr_b16 v[86:87], v13 offset:17408
    v_xor_b32 v13, 0x20, v11
    v_add_u32 v13, 0x10000, v13
    ds_read_b64_tr_b16 v[88:89], v13
    ds_read_b64_tr_b16 v[90:91], v13 offset:1024
    ds_read_b64_tr_b16 v[92:93], v13 offset:16384
    ds_read_b64_tr_b16 v[94:95], v13 offset:17408
    v_xor_b32 v13, 0x1000, v11
    v_add_u32 v13, 0x10000, v13
    ds_read_b64_tr_b16 a[112:113], v13
    ds_read_b64_tr_b16 a[114:115], v13 offset:1024
    ds_read_b64_tr_b16 a[116:117], v13 offset:16384
    ds_read_b64_tr_b16 a[118:119], v13 offset:17408
    v_xor_b32 v13, 0x1020, v11
    v_add_u32 v13, 0x10000, v13
    ds_read_b64_tr_b16 a[120:121], v13
    ds_read_b64_tr_b16 a[122:123], v13 offset:1024
    ds_read_b64_tr_b16 a[124:125], v13 offset:16384
    ds_read_b64_tr_b16 a[126:127], v13 offset:17408
    s_waitcnt lgkmcnt(0)
    s_barrier
    s_add_u32 s43, s41, 0x200000
    s_add_u32 m0, s51, 0xc000
    s_nop 0
    buffer_load_dwordx4 v15, s[12:15], s43 offen lds
    s_add_u32 s43, s41, 0x208000
    s_add_u32 m0, s51, 0xd000
    s_nop 0
    buffer_load_dwordx4 v15, s[12:15], s43 offen lds
    s_add_u32 s43, s41, 0x300000
    s_add_u32 m0, s51, 0xe000
    s_nop 0
    buffer_load_dwordx4 v15, s[12:15], s43 offen lds
    s_add_u32 s43, s41, 0x308000
    s_add_u32 m0, s51, 0xf000
    s_nop 0
    buffer_load_dwordx4 v15, s[12:15], s43 offen lds
    v_xor_b32 v15, 2, v14
    v_lshl_add_u32 v15, v15, 15, v8
    s_add_u32 s43, s41, 0x0
    s_add_u32 m0, s51, 0x10000
    s_nop 0
    buffer_load_dwordx4 v15, s[12:15], s43 offen lds
    s_add_u32 s43, s41, 0x8000
    s_add_u32 m0, s51, 0x11000
    s_nop 0
    buffer_load_dwordx4 v15, s[12:15], s43 offen lds
    s_add_u32 s43, s41, 0x100000
    s_add_u32 m0, s51, 0x12000
    s_nop 0
    buffer_load_dwordx4 v15, s[12:15], s43 offen lds
    s_add_u32 s43, s41, 0x108000
    s_add_u32 m0, s51, 0x13000
    s_nop 0
    buffer_load_dwordx4 v15, s[12:15], s43 offen lds
    s_waitcnt vmcnt(12)
    s_barrier
    v_xor_b32 v13, 0x0, v11
    v_add_u32 v13, 0x18000, v13
    ds_read_b64_tr_b16 a[144:145], v13
    ds_read_b64_tr_b16 a[146:147], v13 offset:1024
    ds_read_b64_tr_b16 a[148:149], v13 offset:16384
    ds_read_b64_tr_b16 a[150:151], v13 offset:17408
    v_xor_b32 v13, 0x20, v11
    v_add_u32 v13, 0x18000, v13
    ds_read_b64_tr_b16 a[152:153], v13
    ds_read_b64_tr_b16 a[154:155], v13 offset:1024
    ds_read_b64_tr_b16 a[156:157], v13 offset:16384
    ds_read_b64_tr_b16 a[158:159], v13 offset:17408
    v_xor_b32 v13, 0x1000, v11
    v_add_u32 v13, 0x18000, v13
    ds_read_b64_tr_b16 a[176:177], v13
    ds_read_b64_tr_b16 a[178:179], v13 offset:1024
    ds_read_b64_tr_b16 a[180:181], v13 offset:16384
    ds_read_b64_tr_b16 a[182:183], v13 offset:17408
    v_xor_b32 v13, 0x1020, v11
    v_add_u32 v13, 0x18000, v13
    ds_read_b64_tr_b16 a[184:185], v13
    ds_read_b64_tr_b16 a[186:187], v13 offset:1024
    ds_read_b64_tr_b16 a[188:189], v13 offset:16384
    ds_read_b64_tr_b16 a[190:191], v13 offset:17408
    s_waitcnt lgkmcnt(0)
    s_barrier
    s_add_u32 s43, s41, 0x200000
    s_add_u32 m0, s51, 0x14000
    s_nop 0
    buffer_load_dwordx4 v15, s[12:15], s43 offen lds
    s_add_u32 s43, s41, 0x208000
    s_add_u32 m0, s51, 0x15000
    s_nop 0
    buffer_load_dwordx4 v15, s[12:15], s43 offen lds
    s_add_u32 s43, s41, 0x300000
    s_add_u32 m0, s51, 0x16000
    s_nop 0
    buffer_load_dwordx4 v15, s[12:15], s43 offen lds
    s_add_u32 s43, s41, 0x308000
    s_add_u32 m0, s51, 0x17000
    s_nop 0
    buffer_load_dwordx4 v15, s[12:15], s43 offen lds
    s_mov_b32 s12, s66
    s_and_b32 s13, s67, 0xffff
    s_add_u32 s43, s42, 0x0
    s_add_u32 m0, s51, 0x18000
    s_nop 0
    buffer_load_dwordx4 v10, s[12:15], s43 offen lds
    s_add_u32 s43, s42, 0x4000
    s_add_u32 m0, s51, 0x19000
    s_nop 0
    buffer_load_dwordx4 v9, s[12:15], s43 offen lds
    s_add_u32 s43, s42, 0x8000
    s_add_u32 m0, s51, 0x1a000
    s_nop 0
    buffer_load_dwordx4 v10, s[12:15], s43 offen lds
    s_add_u32 s43, s42, 0xc000
    s_add_u32 m0, s51, 0x1b000
    s_nop 0
    buffer_load_dwordx4 v9, s[12:15], s43 offen lds
    s_waitcnt vmcnt(12)
    s_barrier
    v_xor_b32 v13, 0x0, v11
    v_add_u32 v13, 0x0, v13
    ds_read_b64_tr_b16 a[192:193], v13
    ds_read_b64_tr_b16 a[194:195], v13 offset:1024
    ds_read_b64_tr_b16 a[196:197], v13 offset:16384
    ds_read_b64_tr_b16 a[198:199], v13 offset:17408
    v_xor_b32 v13, 0x20, v11
    v_add_u32 v13, 0x0, v13
    ds_read_b64_tr_b16 a[200:201], v13
    ds_read_b64_tr_b16 a[202:203], v13 offset:1024
    ds_read_b64_tr_b16 a[204:205], v13 offset:16384
    ds_read_b64_tr_b16 a[206:207], v13 offset:17408
    v_xor_b32 v13, 0x1000, v11
    v_add_u32 v13, 0x0, v13
    ds_read_b64_tr_b16 a[224:225], v13
    ds_read_b64_tr_b16 a[226:227], v13 offset:1024
    ds_read_b64_tr_b16 a[228:229], v13 offset:16384
    ds_read_b64_tr_b16 a[230:231], v13 offset:17408
    v_xor_b32 v13, 0x1020, v11
    v_add_u32 v13, 0x0, v13
    ds_read_b64_tr_b16 a[232:233], v13
    ds_read_b64_tr_b16 a[234:235], v13 offset:1024
    ds_read_b64_tr_b16 a[236:237], v13 offset:16384
    ds_read_b64_tr_b16 a[238:239], v13 offset:17408
    s_waitcnt lgkmcnt(0)
    s_barrier
    s_add_u32 s43, s42, 0x10200
    s_add_u32 m0, s51, 0x1c000
    s_nop 0
    buffer_load_dwordx4 v10, s[12:15], s43 offen lds
    s_add_u32 s43, s42, 0x14200
    s_add_u32 m0, s51, 0x1d000
    s_nop 0
    buffer_load_dwordx4 v9, s[12:15], s43 offen lds
    s_add_u32 s43, s42, 0x18200
    s_add_u32 m0, s51, 0x1e000
    s_nop 0
    buffer_load_dwordx4 v10, s[12:15], s43 offen lds
    s_add_u32 s43, s42, 0x1c200
    s_add_u32 m0, s51, 0x1f000
    s_nop 0
    buffer_load_dwordx4 v9, s[12:15], s43 offen lds
    s_add_u32 s43, s42, 0x10000
    s_add_u32 m0, s51, 0x20000
    s_nop 0
    buffer_load_dwordx4 v10, s[12:15], s43 offen lds
    s_add_u32 s43, s42, 0x14000
    s_add_u32 m0, s51, 0x21000
    s_nop 0
    buffer_load_dwordx4 v9, s[12:15], s43 offen lds
    s_add_u32 s43, s42, 0x18000
    s_add_u32 m0, s51, 0x22000
    s_nop 0
    buffer_load_dwordx4 v10, s[12:15], s43 offen lds
    s_add_u32 s43, s42, 0x1c000
    s_add_u32 m0, s51, 0x23000
    s_nop 0
    buffer_load_dwordx4 v9, s[12:15], s43 offen lds
    s_waitcnt vmcnt(12)
    v_readfirstlane_b32 s57, v26
    v_readfirstlane_b32 s43, v27
    s_nop 0
    s_cmp_lg_u32 s43, 0
    s_cselect_b32 s57, s57, 0
    s_barrier
    s_cmp_lg_u32 s21, 0
    s_cbranch_scc1 L_arr_4
    v_mov_b32 v23, 1
    s_mov_b64 exec, 1
    buffer_atomic_add v23, off, s[16:19], 0 offset:4
    s_mov_b64 exec, -1
L_arr_4:
    v_xor_b32 v13, 0x0, v11
    v_add_u32 v13, 0x8000, v13
    ds_read_b64_tr_b16 v[128:129], v13
    ds_read_b64_tr_b16 v[130:131], v13 offset:1024
    ds_read_b64_tr_b16 v[132:133], v13 offset:16384
    ds_read_b64_tr_b16 v[134:135], v13 offset:17408
    v_xor_b32 v13, 0x20, v11
    v_add_u32 v13, 0x8000, v13
    ds_read_b64_tr_b16 v[136:137], v13
    ds_read_b64_tr_b16 v[138:139], v13 offset:1024
    ds_read_b64_tr_b16 v[140:141], v13 offset:16384
    ds_read_b64_tr_b16 v[142:143], v13 offset:17408
    v_xor_b32 v13, 0x1000, v11
    v_add_u32 v13, 0x8000, v13
    ds_read_b64_tr_b16 v[160:161], v13
    ds_read_b64_tr_b16 v[162:163], v13 offset:1024
    ds_read_b64_tr_b16 v[164:165], v13 offset:16384
    ds_read_b64_tr_b16 v[166:167], v13 offset:17408
    v_xor_b32 v13, 0x1020, v11
    v_add_u32 v13, 0x8000, v13
    ds_read_b64_tr_b16 v[168:169], v13
    ds_read_b64_tr_b16 v[170:171], v13 offset:1024
    ds_read_b64_tr_b16 v[172:173], v13 offset:16384
    ds_read_b64_tr_b16 v[174:175], v13 offset:17408
    s_waitcnt lgkmcnt(0)
    s_barrier
    s_add_u32 s43, s42, 0x200
    s_add_u32 m0, s51, 0x24000
    s_nop 0
    buffer_load_dwordx4 v10, s[12:15], s43 offen lds
    s_add_u32 s43, s42, 0x4200
    s_add_u32 m0, s51, 0x25000
    s_nop 0
    buffer_load_dwordx4 v9, s[12:15], s43 offen lds
    s_add_u32 s43, s42, 0x8200
    s_add_u32 m0, s51, 0x26000
    s_nop 0
    buffer_load_dwordx4 v10, s[12:15], s43 offen lds
    s_add_u32 s43, s42, 0xc200
    s_add_u32 m0, s51, 0x27000
    s_nop 0
    buffer_load_dwordx4 v9, s[12:15], s43 offen lds
    s_mov_b32 s12, s64
    s_and_b32 s13, s65, 0xffff
    v_xor_b32 v15, 0, v14
    v_lshl_add_u32 v15, v15, 15, v8
    s_add_u32 s43, s41, 0x80000
    s_add_u32 m0, s51, 0x8000
    s_nop 0
    buffer_load_dwordx4 v15, s[12:15], s43 offen lds
    s_add_u32 s43, s41, 0x88000
    s_add_u32 m0, s51, 0x9000
    s_nop 0
    buffer_load_dwordx4 v15, s[12:15], s43 offen lds
    s_add_u32 s43, s41, 0x180000
    s_add_u32 m0, s51, 0xa000
    s_nop 0
    buffer_load_dwordx4 v15, s[12:15], s43 offen lds
    s_add_u32 s43, s41, 0x188000
    s_add_u32 m0, s51, 0xb000
    s_nop 0
    buffer_load_dwordx4 v15, s[12:15], s43 offen lds
    s_waitcnt vmcnt(12)
    s_barrier
    v_xor_b32 v13, 0x0, v12
    v_add_u32 v13, 0x10000, v13
    ds_read_b64_tr_b16 v[192:193], v13
    ds_read_b64_tr_b16 v[194:195], v13 offset:512
    ds_read_b64_tr_b16 v[196:197], v13 offset:2048
    ds_read_b64_tr_b16 v[198:199], v13 offset:2560
    v_xor_b32 v13, 0x2000, v12
    v_add_u32 v13, 0x10000, v13
    ds_read_b64_tr_b16 v[200:201], v13
    ds_read_b64_tr_b16 v[202:203], v13 offset:512
    ds_read_b64_tr_b16 v[204:205], v13 offset:2048
    ds_read_b64_tr_b16 v[206:207], v13 offset:2560
    v_xor_b32 v13, 0x40, v12
    v_add_u32 v13, 0x10000, v13
    ds_read_b64_tr_b16 v[224:225], v13
    ds_read_b64_tr_b16 v[226:227], v13 offset:512
    ds_read_b64_tr_b16 v[228:229], v13 offset:2048
    ds_read_b64_tr_b16 v[230:231], v13 offset:2560
    v_xor_b32 v13, 0x2040, v12
    v_add_u32 v13, 0x10000, v13
    ds_read_b64_tr_b16 v[232:233], v13
    ds_read_b64_tr_b16 v[234:235], v13 offset:512
    ds_read_b64_tr_b16 v[236:237], v13 offset:2048
    ds_read_b64_tr_b16 v[238:239], v13 offset:2560
    s_waitcnt lgkmcnt(0)
    s_barrier
    s_add_u32 s43, s41, 0x280000
    s_add_u32 m0, s51, 0xc000
    s_nop 0
    buffer_load_dwordx4 v15, s[12:15], s43 offen lds
    s_add_u32 s43, s41, 0x288000
    s_add_u32 m0, s51, 0xd000
    s_nop 0
    buffer_load_dwordx4 v15, s[12:15], s43 offen lds
    s_add_u32 s43, s41, 0x380000
    s_add_u32 m0, s51, 0xe000
    s_nop 0
    buffer_load_dwordx4 v15, s[12:15], s43 offen lds
    s_add_u32 s43, s41, 0x388000
    s_add_u32 m0, s51, 0xf000
    s_nop 0
    buffer_load_dwordx4 v15, s[12:15], s43 offen lds
    v_xor_b32 v15, 2, v14
    v_lshl_add_u32 v15, v15, 15, v8
    s_add_u32 s43, s41, 0x80000
    s_add_u32 m0, s51, 0x10000
    s_nop 0
    buffer_load_dwordx4 v15, s[12:15], s43 offen lds
    s_add_u32 s43, s41, 0x88000
    s_add_u32 m0, s51, 0x11000
    s_nop 0
    buffer_load_dwordx4 v15, s[12:15], s43 offen lds
    s_add_u32 s43, s41, 0x180000
    s_add_u32 m0, s51, 0x12000
    s_nop 0
    buffer_load_dwordx4 v15, s[12:15], s43 offen lds
    s_add_u32 s43, s41, 0x188000
    s_add_u32 m0, s51, 0x13000
    s_nop 0
    buffer_load_dwordx4 v15, s[12:15], s43 offen lds
    s_waitcnt vmcnt(12)
    s_barrier
    v_xor_b32 v13, 0x0, v12
    v_add_u32 v13, 0x18000, v13
    ds_read_b64_tr_b16 v[208:209], v13
    ds_read_b64_tr_b16 v[210:211], v13 offset:512
    ds_read_b64_tr_b16 v[212:213], v13 offset:2048
    ds_read_b64_tr_b16 v[214:215], v13 offset:2560
    v_xor_b32 v13, 0x2000, v12
    v_add_u32 v13, 0x18000, v13
    ds_read_b64_tr_b16 v[216:217], v13
    ds_read_b64_tr_b16 v[218:219], v13 offset:512
    ds_read_b64_tr_b16 v[220:221], v13 offset:2048
    ds_read_b64_tr_b16 v[222:223], v13 offset:2560
    v_xor_b32 v13, 0x40, v12
    v_add_u32 v13, 0x18000, v13
    ds_read_b64_tr_b16 v[240:241], v13
    ds_read_b64_tr_b16 v[242:243], v13 offset:512
    ds_read_b64_tr_b16 v[244:245], v13 offset:2048
    ds_read_b64_tr_b16 v[246:247], v13 offset:2560
    v_xor_b32 v13, 0x2040, v12
    v_add_u32 v13, 0x18000, v13
    ds_read_b64_tr_b16 v[248:249], v13
    ds_read_b64_tr_b16 v[250:251], v13 offset:512
    ds_read_b64_tr_b16 v[252:253], v13 offset:2048
    ds_read_b64_tr_b16 v[254:255], v13 offset:2560
    s_waitcnt lgkmcnt(0)
    s_barrier
    s_add_u32 s43, s41, 0x280000
    s_add_u32 m0, s51, 0x14000
    s_nop 0
    buffer_load_dwordx4 v15, s[12:15], s43 offen lds
    s_add_u32 s43, s41, 0x288000
    s_add_u32 m0, s51, 0x15000
    s_nop 0
    buffer_load_dwordx4 v15, s[12:15], s43 offen lds
    s_add_u32 s43, s41, 0x380000
    s_add_u32 m0, s51, 0x16000
    s_nop 0
    buffer_load_dwordx4 v15, s[12:15], s43 offen lds
    s_add_u32 s43, s41, 0x388000
    s_add_u32 m0, s51, 0x17000
    s_nop 0
    buffer_load_dwordx4 v15, s[12:15], s43 offen lds
    s_mov_b32 s12, s66
    s_and_b32 s13, s67, 0xffff
    s_add_u32 s43, s42, 0x80
    s_add_u32 m0, s51, 0x18000
    s_nop 0
    buffer_load_dwordx4 v10, s[12:15], s43 offen lds
    s_add_u32 s43, s42, 0x4080
    s_add_u32 m0, s51, 0x19000
    s_nop 0
    buffer_load_dwordx4 v9, s[12:15], s43 offen lds
    s_add_u32 s43, s42, 0x8080
    s_add_u32 m0, s51, 0x1a000
    s_nop 0
    buffer_load_dwordx4 v10, s[12:15], s43 offen lds
    s_add_u32 s43, s42, 0xc080
    s_add_u32 m0, s51, 0x1b000
    s_nop 0
    buffer_load_dwordx4 v9, s[12:15], s43 offen lds
    s_waitcnt vmcnt(12)
    s_barrier
    v_xor_b32 v13, 0x0, v11
    v_add_u32 v13, 0x0, v13
    ds_read_b64_tr_b16 a[208:209], v13
    ds_read_b64_tr_b16 a[210:211], v13 offset:1024
    ds_read_b64_tr_b16 a[212:213], v13 offset:16384
    ds_read_b64_tr_b16 a[214:215], v13 offset:17408
    v_xor_b32 v13, 0x20, v11
    v_add_u32 v13, 0x0, v13
    ds_read_b64_tr_b16 a[216:217], v13
    ds_read_b64_tr_b16 a[218:219], v13 offset:1024
    ds_read_b64_tr_b16 a[220:221], v13 offset:16384
    ds_read_b64_tr_b16 a[222:223], v13 offset:17408
    v_xor_b32 v13, 0x1000, v11
    v_add_u32 v13, 0x0, v13
    ds_read_b64_tr_b16 a[240:241], v13
    ds_read_b64_tr_b16 a[242:243], v13 offset:1024
    ds_read_b64_tr_b16 a[244:245], v13 offset:16384
    ds_read_b64_tr_b16 a[246:247], v13 offset:17408
    v_xor_b32 v13, 0x1020, v11
    v_add_u32 v13, 0x0, v13
    ds_read_b64_tr_b16 a[248:249], v13
    ds_read_b64_tr_b16 a[250:251], v13 offset:1024
    ds_read_b64_tr_b16 a[252:253], v13 offset:16384
    ds_read_b64_tr_b16 a[254:255], v13 offset:17408
    s_waitcnt lgkmcnt(0)
    s_barrier
    s_cmp_lg_u32 s20, 2
    s_cbranch_scc1 L_nocc_5
    v_lshlrev_b32 v25, 2, v117
    s_lshl_b32 s43, s21, 12
    s_getpc_b64 s[4:5]
L_pc_6:
    s_add_u32 s4, s4, L_nocc_5-L_pc_6
    s_addc_u32 s5, s5, 0
    v_add_u32 v25, s43, v25
    v_min_u32 v25, L_code_end-L_nocc_5-4, v25
    global_load_dword v29, v25, s[4:5]
L_nocc_5:
L_chain_warm:
    s_add_u32 s43, s42, 0x10280
    s_add_u32 m0, s51, 0x1c000
    s_nop 0
    buffer_load_dwordx4 v10, s[12:15], s43 offen lds
    s_add_u32 s43, s42, 0x14280
    s_add_u32 m0, s51, 0x1d000
    s_nop 0
    buffer_load_dwordx4 v9, s[12:15], s43 offen lds
    s_add_u32 s43, s42, 0x18280
    s_add_u32 m0, s51, 0x1e000
    s_nop 0
    buffer_load_dwordx4 v10, s[12:15], s43 offen lds
    s_add_u32 s43, s42, 0x1c280
    s_add_u32 m0, s51, 0x1f000
    s_nop 0
    buffer_load_dwordx4 v9, s[12:15], s43 offen lds
    s_add_u32 s43, s42, 0x10080
    s_add_u32 m0, s51, 0x20000
    s_nop 0
    buffer_load_dwordx4 v10, s[12:15], s43 offen lds
    s_add_u32 s43, s42, 0x14080
    s_add_u32 m0, s51, 0x21000
    s_nop 0
    buffer_load_dwordx4 v9, s[12:15], s43 offen lds
    s_add_u32 s43, s42, 0x18080
    s_add_u32 m0, s51, 0x22000
    s_nop 0
    buffer_load_dwordx4 v10, s[12:15], s43 offen lds
    s_add_u32 s43, s42, 0x1c080
    s_add_u32 m0, s51, 0x23000
    s_nop 0
    buffer_load_dwordx4 v9, s[12:15], s43 offen lds
    ds_write_b128 v123, v[32:35]
    ds_write_b128 v123, v[36:39] offset:1024
    ds_write_b128 v123, v[40:43] offset:2048
    ds_write_b128 v123, v[44:47] offset:3072
    ds_write_b128 v123, v[48:51] offset:4096
    ds_write_b128 v123, v[52:55] offset:5120
    ds_write_b128 v123, v[56:59] offset:6144
    ds_write_b128 v123, v[60:63] offset:7168
    s_waitcnt vmcnt(12)
    s_barrier
    v_xor_b32 v13, 0x0, v11
    v_add_u32 v13, 0x8000, v13
    ds_read_b64_tr_b16 v[144:145], v13
    ds_read_b64_tr_b16 v[146:147], v13 offset:1024
    ds_read_b64_tr_b16 v[148:149], v13 offset:16384
    ds_read_b64_tr_b16 v[150:151], v13 offset:17408
    v_xor_b32 v13, 0x20, v11
    v_add_u32 v13, 0x8000, v13
    ds_read_b64_tr_b16 v[152:153], v13
    ds_read_b64_tr_b16 v[154:155], v13 offset:1024
    ds_read_b64_tr_b16 v[156:157], v13 offset:16384
    ds_read_b64_tr_b16 v[158:159], v13 offset:17408
    v_xor_b32 v13, 0x1000, v11
    v_add_u32 v13, 0x8000, v13
    ds_read_b64_tr_b16 v[176:177], v13
    ds_read_b64_tr_b16 v[178:179], v13 offset:1024
    ds_read_b64_tr_b16 v[180:181], v13 offset:16384
    ds_read_b64_tr_b16 v[182:183], v13 offset:17408
    v_xor_b32 v13, 0x1020, v11
    v_add_u32 v13, 0x8000, v13
    ds_read_b64_tr_b16 v[184:185], v13
    ds_read_b64_tr_b16 v[186:187], v13 offset:1024
    ds_read_b64_tr_b16 v[188:189], v13 offset:16384
    ds_read_b64_tr_b16 v[190:191], v13 offset:17408
    s_waitcnt lgkmcnt(0)
    s_barrier
    s_mov_b32 s43, 0x10000
    buffer_load_dword v30, v7, s[8:11], s43 offen sc1
    s_add_u32 s43, s42, 0x280
    s_add_u32 m0, s51, 0x24000
    s_nop 0
    buffer_load_dwordx4 v10, s[12:15], s43 offen lds
    s_add_u32 s43, s42, 0x4280
    s_add_u32 m0, s51, 0x25000
    s_nop 0
    buffer_load_dwordx4 v9, s[12:15], s43 offen lds
    s_add_u32 s43, s42, 0x8280
    s_add_u32 m0, s51, 0x26000
    s_nop 0
    buffer_load_dwordx4 v10, s[12:15], s43 offen lds
    s_add_u32 s43, s42, 0xc280
    s_add_u32 m0, s51, 0x27000
    s_nop 0
    buffer_load_dwordx4 v9, s[12:15], s43 offen lds
    v_lshlrev_b32 v26, 3, v117
    v_and_b32 v26, 2048, v26
    s_lshl_b32 s43, s20, 6
    s_add_u32 s43, s43, 0x2000
    buffer_load_dword v26, v26, s[8:11], s43 offen sc1
    buffer_load_dword v27, off, s[16:19], 0 offset:4 sc1
    ds_write_b128 v123, v[64:67] offset:32768
    ds_write_b128 v123, v[68:71] offset:33792
    ds_write_b128 v123, v[72:75] offset:34816
    ds_write_b128 v123, v[76:79] offset:35840
    ds_write_b128 v123, v[80:83] offset:36864
    ds_write_b128 v123, v[84:87] offset:37888
    ds_write_b128 v123, v[88:91] offset:38912
    ds_write_b128 v123, v[92:95] offset:39936
    s_waitcnt vmcnt(0)
    v_readlane_b32 s43, v26, 0
    v_readlane_b32 s40, v26, 16
    s_nop 0
    s_min_u32 s43, s43, s40
    s_cmp_lg_u32 s43, 0
    s_cselect_b32 s57, s57, 0
    v_readfirstlane_b32 s43, v27
    s_nop 0
    s_cmp_ge_u32 s43, 32
    s_cselect_b32 s57, s57, 0
    s_cmp_lg_u32 s57, 1
    s_cbranch_scc1 L_nokv_7
    s_add_u32 m0, s52, 8192
    s_nop 0
    buffer_load_dwordx4 v117, s[8:11], s30 offen lds
    buffer_load_dwordx4 v117, s[8:11], s30 offen offset:1024 lds
    s_add_u32 m0, s52, 0x6000
    s_nop 0
    buffer_load_dwordx4 v117, s[8:11], s31 offen lds
    buffer_load_dwordx4 v117, s[8:11], s31 offen offset:1024 lds
L_nokv_7:
    v_min_u32 v21, 0xfffffffe, v21
    s_mov_b32 s43, 0x10000
    s_mov_b64 exec, s[38:39]
    buffer_store_dword v21, v119, s[8:11], s43 offen
    s_mov_b64 exec, -1
    v_mov_b32 v16, -1
    v_mov_b32 v17, -1
    v_mov_b32 v18, -1
    v_mov_b32 v19, -1
    s_lshl_b32 s43, s20, 13
    s_add_u32 s43, s43, 0x100000
    s_and_b32 s40, s21, 1
    s_lshl_b32 s40, s40, 12
    s_add_u32 s29, s43, s40
    s_add_u32 s43, s43, s52
    s_xor_b32 s40, s43, 0x40000
    buffer_store_dwordx4 v[16:19], v117, s[8:11], s40 offen
    buffer_store_dwordx4 v[16:19], v117, s[8:11], s40 offen offset:1024
    s_mov_b32 s43, 0x12000
    buffer_store_dword v16, v119, s[8:11], s43 offen
    s_mov_b32 s43, 0x14000
    buffer_store_dword v16, v119, s[8:11], s43 offen
    s_mov_b32 s43, 0x16000
    buffer_store_dword v16, v119, s[8:11], s43 offen
    s_barrier
    v_xor_b32 v13, 0x0, v12
    v_add_u32 v13, 0x10000, v13
    ds_read_b64_tr_b16 v[32:33], v13
    ds_read_b64_tr_b16 v[34:35], v13 offset:512
    ds_read_b64_tr_b16 v[36:37], v13 offset:2048
    ds_read_b64_tr_b16 v[38:39], v13 offset:2560
    v_xor_b32 v13, 0x2000, v12
    v_add_u32 v13, 0x10000, v13
    ds_read_b64_tr_b16 v[40:41], v13
    ds_read_b64_tr_b16 v[42:43], v13 offset:512
    ds_read_b64_tr_b16 v[44:45], v13 offset:2048
    ds_read_b64_tr_b16 v[46:47], v13 offset:2560
    v_xor_b32 v13, 0x40, v12
    v_add_u32 v13, 0x10000, v13
    ds_read_b64_tr_b16 v[64:65], v13
    ds_read_b64_tr_b16 v[66:67], v13 offset:512
    ds_read_b64_tr_b16 v[68:69], v13 offset:2048
    ds_read_b64_tr_b16 v[70:71], v13 offset:2560
    v_xor_b32 v13, 0x2040, v12
    v_add_u32 v13, 0x10000, v13
    ds_read_b64_tr_b16 v[72:73], v13
    ds_read_b64_tr_b16 v[74:75], v13 offset:512
    ds_read_b64_tr_b16 v[76:77], v13 offset:2048
    ds_read_b64_tr_b16 v[78:79], v13 offset:2560
    v_xor_b32 v13, 0x0, v12
    v_add_u32 v13, 0x18000, v13
    ds_read_b64_tr_b16 v[48:49], v13
    ds_read_b64_tr_b16 v[50:51], v13 offset:512
    ds_read_b64_tr_b16 v[52:53], v13 offset:2048
    ds_read_b64_tr_b16 v[54:55], v13 offset:2560
    v_xor_b32 v13, 0x2000, v12
    v_add_u32 v13, 0x18000, v13
    ds_read_b64_tr_b16 v[56:57], v13
    ds_read_b64_tr_b16 v[58:59], v13 offset:512
    ds_read_b64_tr_b16 v[60:61], v13 offset:2048
    ds_read_b64_tr_b16 v[62:63], v13 offset:2560
    v_xor_b32 v13, 0x40, v12
    v_add_u32 v13, 0x18000, v13
    ds_read_b64_tr_b16 v[80:81], v13
    ds_read_b64_tr_b16 v[82:83], v13 offset:512
    ds_read_b64_tr_b16 v[84:85], v13 offset:2048
    ds_read_b64_tr_b16 v[86:87], v13 offset:2560
    v_xor_b32 v13, 0x2040, v12
    v_add_u32 v13, 0x18000, v13
    ds_read_b64_tr_b16 v[88:89], v13
    ds_read_b64_tr_b16 v[90:91], v13 offset:512
    ds_read_b64_tr_b16 v[92:93], v13 offset:2048
    ds_read_b64_tr_b16 v[94:95], v13 offset:2560
    s_waitcnt lgkmcnt(0)
    s_barrier
    ds_write_b128 v124, v[32:35]
    ds_write_b128 v124, v[36:39] offset:1024
    ds_write_b128 v124, v[40:43] offset:2048
    ds_write_b128 v124, v[44:47] offset:3072
    ds_write_b128 v124, v[48:51] offset:4096
    ds_write_b128 v124, v[52:55] offset:5120
    ds_write_b128 v124, v[56:59] offset:6144
    ds_write_b128 v124, v[60:63] offset:7168
    ds_write_b128 v124, v[64:67] offset:32768
    ds_write_b128 v124, v[68:71] offset:33792
    ds_write_b128 v124, v[72:75] offset:34816
    ds_write_b128 v124, v[76:79] offset:35840
    ds_write_b128 v124, v[80:83] offset:36864
    ds_write_b128 v124, v[84:87] offset:37888
    ds_write_b128 v124, v[88:91] offset:38912
    ds_write_b128 v124, v[92:95] offset:39936
    s_waitcnt lgkmcnt(0)
    s_cmp_eq_u32 s57, 1
    s_cbranch_scc1 L_started_8
    s_mov_b32 s96, 0
L_mode_9:
    buffer_load_dwordx2 v[2:3], off, s[92:95], 0 offset:36 sc1
    s_waitcnt vmcnt(0)
    v_readfirstlane_b32 s87, v2
    v_readfirstlane_b32 s97, v3
    s_nop 0
    s_min_u32 s97, s97, s87
    s_cmp_lg_u32 s97, 0
    s_cbranch_scc1 L_moded_10
    s_sleep 4
    s_add_u32 s96, s96, 1
    s_cmp_lg_u32 s96, 0x100
    s_cbranch_scc1 L_modef_11
    v_mov_b32 v2, 2
    v_mov_b32 v3, 0
    s_mov_b64 exec, 1
    buffer_atomic_cmpswap v[2:3], off, s[92:95], 0 offset:36
    s_mov_b64 exec, -1
L_modef_11:
    s_cmp_lt_u32 s96, 0x10000
    s_cbranch_scc1 L_mode_9
L_moded_10:
    s_cmp_lg_u32 s87, 1
    s_cbranch_scc1 L_fallback
    v_lshrrev_b32 v1, 4, v117
    v_and_b32 v2, 15, v1
    v_lshrrev_b32 v1, 4, v1
    v_lshlrev_b32 v1, 11, v1
    v_lshl_add_u32 v1, v2, 2, v1
    s_lshl_b32 s43, s20, 6
    s_add_u32 s43, s43, 0x2000
    s_mov_b32 exec_lo, 0x10001
    s_mov_b32 exec_hi, 0
    s_mov_b32 s96, 0
L_poll_12:
    buffer_load_dword v2, v1, s[8:11], s43 offen sc1
    s_waitcnt vmcnt(0)
    v_cmp_gt_u32 vcc, 1, v2
    s_cbranch_vccz L_polld_13
    s_sleep 8
    s_add_u32 s96, s96, 1
    s_cmp_lt_u32 s96, 0x10000
    s_cbranch_scc1 L_poll_12
L_polld_13:
    s_mov_b64 exec, -1
    s_add_u32 m0, s52, 8192
    s_nop 0
    buffer_load_dwordx4 v117, s[8:11], s30 offen lds
    buffer_load_dwordx4 v117, s[8:11], s30 offen offset:1024 lds
    s_add_u32 m0, s52, 0x6000
    s_nop 0
    buffer_load_dwordx4 v117, s[8:11], s31 offen lds
    buffer_load_dwordx4 v117, s[8:11], s31 offen offset:1024 lds
    s_mov_b32 s49, 0
L_cb_poll_15:
    buffer_load_dword v3, off, s[16:19], 0 offset:4 sc1
    s_waitcnt vmcnt(0)
    v_readfirstlane_b32 s43, v3
    s_nop 0
    s_cmp_ge_u32 s43, 32
    s_cbranch_scc1 L_started_8
    s_sleep 8
    s_add_u32 s49, s49, 1
    s_cmp_lt_u32 s49, 0x40000
    s_cbranch_scc1 L_cb_poll_15
L_started_8:
    s_lshr_b32 s43, s20, 1
    s_lshl_b32 s43, s43, 7
    s_and_b32 s40, s20, 1
    s_lshl_b32 s40, s40, 4
    s_add_u32 s43, s43, s40
    s_add_u32 s44, s43, 0x1000
    s_cmp_eq_u32 s21, 0
    s_cselect_b32 s44, s44, 0x7ff00000
    s_mov_b32 s22, 0
    s_mov_b32 s33, 0
    s_xor_b32 s53, s29, 1024
    s_add_u32 s23, s51, 0x10000
    s_add_u32 s48, s23, 4096
    s_mov_b32 s24, 0x12000
    s_add_u32 s55, s24, 16384
    s_mov_b32 s25, 0x100000
    s_mov_b32 s26, 0x101000
    v_mov_b32 v112, 0
    v_mov_b32 v113, 0
    v_mov_b32 v114, 0
    v_mov_b32 v115, 0
    s_add_u32 m0, s51, 4096
    ds_write_b128 v117, v[112:115] offset:22528
    ds_write_b128 v117, v[112:115] offset:23552
    s_cmp_lg_u32 s21, 0
    s_cselect_b32 s40, -1, 0
    v_mov_b32 v126, s40
    v_bfe_u32 v1, v117, 4, 1
    v_lshlrev_b32 v1, 4, v1
    s_movk_i32 s43, 0x3f80
    v_lshlrev_b32 v125, v1, s43
    v_bfe_u32 v1, v117, 5, 3
    v_cmp_eq_u32 s[68:69], 0, v1
    v_cmp_eq_u32 s[70:71], 1, v1
    v_cmp_eq_u32 s[72:73], 2, v1
    v_cmp_eq_u32 s[74:75], 3, v1
    v_lshrrev_b32 v1, 2, v117
    s_cmp_lt_u32 s21, 2
    s_cselect_b64 vcc, -1, 0
    v_cndmask_b32 v119, v119, v1, vcc
    v_mov_b32 v32, 0
    v_mov_b32 v33, 0
    v_mov_b32 v34, 0
    v_mov_b32 v35, 0
    v_mov_b32 v36, 0
    v_mov_b32 v37, 0
    v_mov_b32 v38, 0
    v_mov_b32 v39, 0
    v_mov_b32 v40, 0
    v_mov_b32 v41, 0
    v_mov_b32 v42, 0
    v_mov_b32 v43, 0
    v_mov_b32 v44, 0
    v_mov_b32 v45, 0
    v_mov_b32 v46, 0
    v_mov_b32 v47, 0
    v_mov_b32 v48, 0
    v_mov_b32 v49, 0
    v_mov_b32 v50, 0
    v_mov_b32 v51, 0
    v_mov_b32 v52, 0
    v_mov_b32 v53, 0
    v_mov_b32 v54, 0
    v_mov_b32 v55, 0
    s_add_u32 s30, s30, 0x40000
    s_add_u32 s31, s31, 0x40000
    s_mov_b32 s45, 0
    s_mov_b32 s46, 0
    s_mov_b32 s47, 0
    s_mov_b32 s76, 0
    s_and_b32 s43, s21, 1
    s_lshl_b32 s43, s43, 5
    s_add_u32 s43, s43, s20
    s_lshl_b32 s43, s43, 6
    s_add_u32 s28, s43, 0x2000
    s_mov_b32 s59, 0
    ds_read_b128 v[80:83], v123
    ds_read_b128 v[84:87], v123 offset:1024
    ds_read_b128 v[56:59], v123 offset:2048
    ds_read_b128 v[60:63], v123 offset:3072
    ds_read_b128 v[64:67], v123 offset:32768
    ds_read_b128 v[68:71], v123 offset:33792
    ds_read_b128 v[72:75], v123 offset:34816
    ds_read_b128 v[76:79], v123 offset:35840
    ds_read_b128 v[88:91], v123 offset:4096
    ds_read_b128 v[92:95], v123 offset:5120
    ds_read_b128 v[96:99], v123 offset:6144
    ds_read_b128 v[100:103], v123 offset:7168
    ds_read_b128 v[104:107], v123 offset:36864
    ds_read_b128 v[108:111], v123 offset:37888
    ds_read_b128 v[24:27], v123 offset:38912
    ds_read_b128 v[28:31], v123 offset:39936
    s_mov_b32 s49, 0
    s_waitcnt vmcnt(0) lgkmcnt(0)
    s_barrier
    s_waitcnt vmcnt(0) lgkmcnt(0)
    s_cmp_eq_u32 s21, 1
    s_cbranch_scc1 L_chain_top1_f
    s_cmp_eq_u32 s21, 2
    s_cbranch_scc1 L_chain_top2_f
    s_cmp_eq_u32 s21, 3
    s_cbranch_scc1 L_chain_top3_f
.p2align 6
L_chain_top0_f:
    buffer_load_dwordx4 v[0:3], v117, s[8:11], s23 offen nt
    v_mov_b32 v15, 0
    v_mov_b32 v15, 0
    v_mov_b32 v15, 0
    v_mov_b32 v15, 0
    v_mov_b32 v15, 0
    v_mov_b32 v15, 0
    v_mov_b32 v15, 0
    v_mov_b32 v15, 0
    v_mov_b32 v15, 0
    v_mov_b32 v15, 0
    v_mov_b32 v15, 0
    v_mov_b32 v15, 0
    v_mov_b32 v15, 0
    v_mov_b32 v15, 0
    v_mov_b32 v15, 0
    v_mov_b32 v15, 0
    buffer_load_dwordx4 v[0:3], v117, s[8:11], s23 offen sc1
    v_mov_b32 v15, 0
    v_mov_b32 v15, 0
    v_mov_b32 v15, 0
    v_mov_b32 v15, 0
    v_mov_b32 v15, 0
    v_mov_b32 v15, 0
    v_mov_b32 v15, 0
    v_mov_b32 v15, 0
    v_mov_b32 v15, 0
    v_mov_b32 v15, 0
    v_mov_b32 v15, 0
    v_mov_b32 v15, 0
    v_mov_b32 v15, 0
    v_mov_b32 v15, 0
    v_mov_b32 v15, 0
    v_mov_b32 v15, 0
L_mret_17:
    buffer_load_dwordx4 v[0:3], v117, s[8:11], s23 offen sc1
    s_add_u32 s45, s45, 1
    s_cmp_lt_u32 s45, 0x10000
    s_cselect_b32 s56, -2, -1
    s_nop 3
    v_mov_b32 v32, 0
    v_mov_b32 v33, 0
    v_mov_b32 v34, 0
    v_mov_b32 v35, 0
    s_waitcnt vmcnt(2)
    v_max3_u32 v15, v0, v1, v2
    v_max_u32 v15, v15, v3
    v_cmp_lt_u32 vcc, s56, v15
    v_smfmac_f32_16x16x64_bf16 v[32:35], v[0:3], v[80:87], v116
    s_cbranch_vccnz L_mret_17
    ds_write_b128 v117, v[0:3]
    v_smfmac_f32_16x16x64_bf16 v[36:39], v[0:3], v[56:63], v116
    buffer_load_dwordx4 v[4:7], v117, s[8:11], s48 offen nt
    v_smfmac_f32_16x16x64_bf16 v[40:43], v[0:3], v[64:71], v116
    buffer_load_dwordx4 v117, s[8:11], s48 offen nt lds
    s_mov_b32 m0, 8192
    v_smfmac_f32_16x16x64_bf16 v[44:47], v[0:3], v[72:79], v116
    s_waitcnt lgkmcnt(0)
    s_barrier
    ds_read_b128 v[8:11], v117 offset:1024
    v_smfmac_f32_16x16x64_bf16 v[48:51], v[0:3], a[192:199], v116
    ds_read_b128 v[16:19], v117 offset:2048
    ds_read_b128 v[20:23], v117 offset:3072
    v_smfmac_f32_16x16x64_bf16 v[52:55], v[0:3], a[200:207], v116
    ds_read_b128 v[80:83], v117 offset:14336
    s_waitcnt lgkmcnt(3)
    v_smfmac_f32_16x16x64_bf16 v[32:35], v[8:11], a[0:7], v116
    ds_read_b128 v[84:87], v117 offset:15360
    v_smfmac_f32_16x16x64_bf16 v[36:39], v[8:11], a[8:15], v116
    buffer_store_dwordx4 v[112:115], v117, s[8:11], s32 offen sc1
    s_waitcnt lgkmcnt(3)
    v_smfmac_f32_16x16x64_bf16 v[32:35], v[16:19], a[32:39], v116
    ds_read_b128 v[56:59], v117 offset:8192
    v_smfmac_f32_16x16x64_bf16 v[36:39], v[16:19], a[40:47], v116
    ds_read_b128 v[60:63], v117 offset:9216
    s_waitcnt lgkmcnt(4)
    v_smfmac_f32_16x16x64_bf16 v[32:35], v[20:23], a[64:71], v116
    ds_read_b128 v[64:67], v117 offset:10240
    v_smfmac_f32_16x16x64_bf16 v[36:39], v[20:23], a[72:79], v116
    ds_read_b128 v[68:71], v117 offset:11264
    v_smfmac_f32_16x16x64_bf16 v[40:43], v[8:11], a[96:103], v116
    ds_read_b128 v[72:75], v117 offset:12288
    v_smfmac_f32_16x16x64_bf16 v[40:43], v[16:19], a[128:135], v116
    ds_read_b128 v[76:79], v117 offset:13312
    v_smfmac_f32_16x16x64_bf16 v[40:43], v[20:23], a[160:167], v116
    s_waitcnt vmcnt(2)
    v_max3_u32 v15, v4, v5, v6
    v_smfmac_f32_16x16x64_bf16 v[44:47], v[8:11], a[104:111], v116
    v_max_u32 v15, v15, v7
    v_smfmac_f32_16x16x64_bf16 v[44:47], v[16:19], a[136:143], v116
    s_waitcnt vmcnt(1) lgkmcnt(0)
    v_cmp_lt_u32 vcc, s56, v15
    v_smfmac_f32_16x16x64_bf16 v[44:47], v[20:23], a[168:175], v116
    s_cbranch_vccnz L_mret_18
L_mgo_19:
    v_smfmac_f32_16x16x64_bf16 v[44:47], v[4:7], v[24:31], v116
    s_barrier
    ds_read_b128 v[12:15], v117 offset:5120
    v_smfmac_f32_16x16x64_bf16 v[32:35], v[4:7], v[88:95], v116
    ds_read_b128 v[24:27], v117 offset:6144
    v_smfmac_f32_16x16x64_bf16 v[36:39], v[4:7], v[96:103], v116
    ds_read_b128 v[28:31], v117 offset:7168
    v_smfmac_f32_16x16x64_bf16 v[40:43], v[4:7], v[104:111], v116
    ds_read_b128 v[88:91], v117 offset:24576
    s_waitcnt lgkmcnt(3)
    v_smfmac_f32_16x16x64_bf16 v[32:35], v[12:15], a[16:23], v116
    ds_read_b128 v[92:95], v117 offset:25600
    s_waitcnt lgkmcnt(3)
    v_smfmac_f32_16x16x64_bf16 v[32:35], v[24:27], a[48:55], v116
    buffer_load_dwordx4 v117, s[8:11], s30 offen lds
    s_waitcnt lgkmcnt(2)
    v_smfmac_f32_16x16x64_bf16 v[32:35], v[28:31], a[80:87], v116
    ds_read_b128 v[96:99], v117 offset:23552
    v_smfmac_f32_16x16x64_bf16 v[36:39], v[12:15], a[24:31], v116
    ds_read_b128 v[100:103], v117 offset:23552
    v_smfmac_f32_16x16x64_bf16 v[36:39], v[24:27], a[56:63], v116
    buffer_load_dwordx4 v117, s[8:11], s30 offen offset:1024 lds
    s_add_u32 m0, s52, 0x6000
    v_add_f32 v32, v32, v34
    v_smfmac_f32_16x16x64_bf16 v[36:39], v[28:31], a[88:95], v116
    ds_read_b128 v[104:107], v117 offset:23552
    v_add_f32 v33, v33, v35
    v_smfmac_f32_16x16x64_bf16 v[40:43], v[12:15], a[112:119], v116
    ds_read_b128 v[108:111], v117 offset:23552
    v_mul_f32 v32, s34, v32
    v_smfmac_f32_16x16x64_bf16 v[40:43], v[24:27], a[144:151], v116
    buffer_load_dword v125, v119, s[8:11], s28 offen sc1
    v_mul_f32 v33, s34, v33
    v_smfmac_f32_16x16x64_bf16 v[40:43], v[28:31], a[176:183], v116
    ds_read_b128 v[0:3], v124
    v_add_f32 v36, v36, v38
    v_smfmac_f32_16x16x64_bf16 v[48:51], v[4:7], a[208:215], v116
    v_add_f32 v37, v37, v39
    v_smfmac_f32_16x16x64_bf16 v[52:55], v[4:7], a[216:223], v116
    s_waitcnt lgkmcnt(5)
    buffer_load_dwordx4 v117, s[8:11], s31 offen lds
    v_mul_f32 v36, s34, v36
    v_smfmac_f32_16x16x64_bf16 v[44:47], v[12:15], a[120:127], v116
    ds_read_b128 v[4:7], v124 offset:1024
    v_mul_f32 v37, s34, v37
    v_smfmac_f32_16x16x64_bf16 v[44:47], v[24:27], a[152:159], v116
    v_cvt_pk_bf16_f32 v34, v32, v36
    v_smfmac_f32_16x16x64_bf16 v[44:47], v[28:31], a[184:191], v116
    buffer_load_dwordx4 v117, s[8:11], s31 offen offset:1024 lds
    s_mov_b32 m0, 4096
    v_cvt_pk_bf16_f32 v35, v33, v37
    v_add_f32 v40, v40, v42
    v_smfmac_f32_16x16x64_bf16 v[48:51], v[8:11], a[224:231], v116
    ds_write2_b32 v120, v34, v35 offset0:32 offset1:48
    v_add_f32 v41, v41, v43
    v_smfmac_f32_16x16x64_bf16 v[52:55], v[8:11], a[232:239], v116
    v_add_f32 v44, v44, v46
    v_add_f32 v45, v45, v47
    v_cvt_pk_bf16_f32 v113, v40, v44
    v_cvt_pk_bf16_f32 v115, v41, v45
    v_smfmac_f32_16x16x64_bf16 v[48:51], v[12:15], a[240:247], v116
    ds_write2_b32 v120, v113, v115 offset0:0 offset1:16
    v_smfmac_f32_16x16x64_bf16 v[52:55], v[12:15], a[248:255], v116
    s_cmp_eq_u32 s22, 63
    s_cbranch_scc1 L_chain_last_f
    buffer_store_dword v126, off, s[8:11], s44 sc1
    v_smfmac_f32_16x16x64_bf16 v[48:51], v[16:19], v[128:135], v116
    v_smfmac_f32_16x16x64_bf16 v[48:51], v[20:23], v[160:167], v116
    v_smfmac_f32_16x16x64_bf16 v[48:51], v[24:27], v[144:151], v116
    s_waitcnt lgkmcnt(0)
    s_barrier
    v_smfmac_f32_16x16x64_bf16 v[48:51], v[28:31], v[176:183], v116
    ds_read_b128 v[32:35], v121 offset:16384
    ds_read_b128 v[36:39], v121 offset:17408
    v_smfmac_f32_16x16x64_bf16 v[52:55], v[16:19], v[136:143], v116
    ds_read_b128 v[40:43], v121 offset:18432
    ds_read_b128 v[44:47], v121 offset:19456
    v_smfmac_f32_16x16x64_bf16 v[52:55], v[20:23], v[168:175], v116
    ds_read_b128 v[8:11], v124 offset:32768
    v_add_f32 v48, v48, v50
    v_smfmac_f32_16x16x64_bf16 v[52:55], v[24:27], v[152:159], v116
    ds_read_b128 v[12:15], v124 offset:33792
    v_add_f32 v49, v49, v51
    v_smfmac_f32_16x16x64_bf16 v[52:55], v[28:31], v[184:191], v116
    s_waitcnt lgkmcnt(5)
    v_cvt_pk_bf16_f32 v112, v48, v49
    v_mfma_f32_16x16x32_bf16 v[56:59], v[56:59], v[32:35], 0
    s_waitcnt lgkmcnt(4)
    v_mov_b32 v48, s50
    v_mov_b32 v49, s50
    v_mfma_f32_16x16x32_bf16 v[56:59], v[60:63], v[36:39], v[56:59]
    ds_read_b128 v[16:19], v124 offset:2048
    s_waitcnt lgkmcnt(4)
    v_mov_b32 v50, s50
    v_mov_b32 v51, s50
    v_mfma_f32_16x16x32_bf16 v[56:59], v[64:67], v[40:43], v[56:59]
    ds_read_b128 v[20:23], v124 offset:3072
    s_waitcnt lgkmcnt(4)
    v_add_f32 v52, v52, v54
    v_mfma_f32_16x16x32_bf16 v[56:59], v[68:71], v[44:47], v[56:59]
    ds_read_b128 v[24:27], v124 offset:4096
    v_add_f32 v53, v53, v55
    v_mfma_f32_16x16x32_bf16 v[60:63], v[72:75], v[32:35], 0
    ds_read_b128 v[28:31], v124 offset:5120
    v_cvt_pk_bf16_f32 v114, v52, v53
    v_mov_b32 v53, 0
    v_mfma_f32_16x16x32_bf16 v[60:63], v[76:79], v[36:39], v[60:63]
    v_exp_f32 v56, v56
    v_mfma_f32_16x16x32_bf16 v[60:63], v[80:83], v[40:43], v[60:63]
    v_exp_f32 v57, v57
    v_mfma_f32_16x16x32_bf16 v[60:63], v[84:87], v[44:47], v[60:63]
    v_exp_f32 v58, v58
    v_mfma_f32_16x16x32_bf16 v[64:67], v[32:35], v[32:35], 0
    v_exp_f32 v59, v59
    v_cvt_pk_bf16_f32 v68, v56, v57
    v_mfma_f32_16x16x32_bf16 v[64:67], v[36:39], v[36:39], v[64:67]
    v_exp_f32 v60, v60
    v_cvt_pk_bf16_f32 v69, v58, v59
    v_mfma_f32_16x16x32_bf16 v[64:67], v[40:43], v[40:43], v[64:67]
    v_exp_f32 v61, v61
    v_mfma_f32_16x16x32_bf16 v[64:67], v[44:47], v[44:47], v[64:67]
    v_exp_f32 v62, v62
    v_exp_f32 v63, v63
    v_cvt_pk_bf16_f32 v70, v60, v61
    v_cvt_pk_bf16_f32 v71, v62, v63
    s_nop 1
    v_mfma_f32_16x16x32_bf16 v[72:75], v[88:91], v[68:71], 0
    s_nop 0
    v_exp_f32 v64, v64
    v_mfma_f32_16x16x32_bf16 v[76:79], v[92:95], v[68:71], 0
    v_exp_f32 v65, v65
    v_mfma_f32_16x16x32_bf16 v[80:83], v[48:51], v[68:71], 0
    v_cvt_pk_bf16_f32 v52, v64, v65
    s_nop 1
    v_mfma_f32_16x16x16_bf16 v[72:75], v[112:113], v[52:53], v[72:75]
    ds_read_b128 v[32:35], v124 offset:6144
    v_mfma_f32_16x16x16_bf16 v[76:79], v[114:115], v[52:53], v[76:79]
    ds_read_b128 v[36:39], v124 offset:7168
    v_mfma_f32_16x16x16_bf16 v[80:83], v[48:49], v[52:53], v[80:83]
L_norm_20:
    s_mov_b64 vcc, s[36:37]
    v_mov_b32 v122, v122
    v_mov_b32 v122, v122
    v_mov_b32 v122, v122
    v_cndmask_b32_dpp v76, v72, v76, vcc quad_perm:[2,3,2,3] row_mask:0xf bank_mask:0xf
    v_cndmask_b32_dpp v77, v73, v77, vcc quad_perm:[2,3,2,3] row_mask:0xf bank_mask:0xf
    v_cndmask_b32_dpp v78, v74, v78, vcc quad_perm:[2,3,2,3] row_mask:0xf bank_mask:0xf
    v_cndmask_b32_dpp v79, v75, v79, vcc quad_perm:[2,3,2,3] row_mask:0xf bank_mask:0xf
    v_rcp_f32_dpp v84, v80 quad_perm:[2,3,2,3] row_mask:0xf bank_mask:0xf
    s_nop 0
    v_pk_mul_f32 v[76:77], v[76:77], v[84:85] op_sel_hi:[1,0]
    v_pk_mul_f32 v[78:79], v[78:79], v[84:85] op_sel_hi:[1,0]
    v_cvt_pk_bf16_f32 v72, v76, v77
    v_cvt_pk_bf16_f32 v73, v78, v79
    ds_write_b64 v122, v[72:73] offset:20480
    v_max_f32_dpp v86, v80, v84 quad_perm:[2,3,2,3] row_mask:0xf bank_mask:0xf
    v_mov_b32_dpp v60, v72 quad_perm:[0,1,0,1] row_mask:0xf bank_mask:0xf
    v_mov_b32_dpp v61, v73 quad_perm:[0,1,0,1] row_mask:0xf bank_mask:0xf
    v_cmp_lt_f32 vcc, s35, v86
    v_mov_b32_dpp v62, v72 quad_perm:[2,3,2,3] row_mask:0xf bank_mask:0xf
    v_mov_b32_dpp v63, v73 quad_perm:[2,3,2,3] row_mask:0xf bank_mask:0xf
    s_nop 1
    v_smfmac_f32_16x16x64_bf16 v[96:99], v[60:63], v[192:199], v116
    s_cbranch_vccnz L_smax_21
    v_smfmac_f32_16x16x64_bf16 v[100:103], v[60:63], v[224:231], v116
    s_waitcnt lgkmcnt(0)
    s_barrier
    ds_read_b128 v[92:95], v127 offset:20992
    ds_read_b128 v[80:83], v127 offset:21504
    ds_read_b128 v[84:87], v127 offset:22016
    v_smfmac_f32_16x16x64_bf16 v[104:107], v[60:63], v[0:7], v116
    ds_read_b128 v[40:43], v124 offset:34816
    v_smfmac_f32_16x16x64_bf16 v[108:111], v[60:63], v[8:15], v116
    ds_read_b128 v[56:59], v124 offset:36864
    s_waitcnt lgkmcnt(4)
    v_smfmac_f32_16x16x64_bf16 v[96:99], v[92:95], v[200:207], v116
    s_waitcnt lgkmcnt(3)
    v_smfmac_f32_16x16x64_bf16 v[96:99], v[80:83], v[208:215], v116
    ds_read_b128 v[44:47], v124 offset:35840
    s_waitcnt lgkmcnt(3)
    v_smfmac_f32_16x16x64_bf16 v[96:99], v[84:87], v[216:223], v116
    ds_read_b128 v[68:71], v124 offset:39936
    v_smfmac_f32_16x16x64_bf16 v[100:103], v[92:95], v[232:239], v116
    ds_read_b128 v[64:67], v124 offset:38912
    v_smfmac_f32_16x16x64_bf16 v[100:103], v[80:83], v[240:247], v116
    ds_read_b128 v[60:63], v124 offset:37888
    v_cvt_pk_bf16_f32 v72, v96, v98
    v_smfmac_f32_16x16x64_bf16 v[100:103], v[84:87], v[248:255], v116
    v_and_or_b32 v72, v72, -2, s33
    v_smfmac_f32_16x16x64_bf16 v[104:107], v[92:95], v[16:23], v116
    v_cvt_pk_bf16_f32 v74, v97, v99
    v_smfmac_f32_16x16x64_bf16 v[104:107], v[80:83], v[24:31], v116
    v_cvt_pk_bf16_f32 v73, v100, v102
    v_cvt_pk_bf16_f32 v75, v101, v103
    v_smfmac_f32_16x16x64_bf16 v[104:107], v[84:87], v[32:39], v116
    buffer_store_dwordx4 v[72:75], v118, s[8:11], s25 offen
    s_waitcnt lgkmcnt(3)
    v_smfmac_f32_16x16x64_bf16 v[108:111], v[92:95], v[40:47], v116
    s_waitcnt lgkmcnt(0)
    v_smfmac_f32_16x16x64_bf16 v[108:111], v[80:83], v[56:63], v116
    v_cvt_pk_bf16_f32 v76, v104, v106
    v_smfmac_f32_16x16x64_bf16 v[108:111], v[84:87], v[64:71], v116
    v_and_or_b32 v76, v76, -2, s33
    v_cvt_pk_bf16_f32 v78, v105, v107
    v_mov_b32 v122, v122
    v_mov_b32 v122, v122
    v_mov_b32 v122, v122
    v_mov_b32 v122, v122
    v_mov_b32 v122, v122
    v_mov_b32 v122, v122
    v_cvt_pk_bf16_f32 v77, v108, v110
    v_cvt_pk_bf16_f32 v79, v109, v111
    buffer_store_dwordx4 v[76:79], v118, s[8:11], s26 offen
    s_add_u32 s30, s30, 0x40000
    s_add_u32 s31, s31, 0x40000
    s_add_u32 s32, s32, 0x20000
    s_add_u32 s23, s24, 0
    s_add_u32 s48, s23, 4096
    s_xor_b32 s25, s25, 0x40000
    s_xor_b32 s26, s26, 0x40000
    s_mov_b32 s35, 0x49800000
    v_mov_b32 v126, s22
    s_add_u32 s22, s22, 1
    v_mov_b32 v32, 0
    v_mov_b32 v33, 0
    v_mov_b32 v34, 0
    v_mov_b32 v35, 0
    v_mov_b32 v36, 0
    v_mov_b32 v37, 0
    v_mov_b32 v38, 0
    v_mov_b32 v39, 0
    v_mov_b32 v40, 0
    v_mov_b32 v41, 0
    v_mov_b32 v42, 0
    v_mov_b32 v43, 0
    v_mov_b32 v44, 0
    v_mov_b32 v45, 0
    v_mov_b32 v46, 0
    v_mov_b32 v47, 0
    v_mov_b32 v48, 0
    v_mov_b32 v49, 0
    v_mov_b32 v50, 0
    v_mov_b32 v51, 0
    v_mov_b32 v52, 0
    v_mov_b32 v53, 0
    v_mov_b32 v54, 0
    v_mov_b32 v55, 0
    ds_read_b128 v[80:83], v123
    ds_read_b128 v[84:87], v123 offset:1024
    ds_read_b128 v[56:59], v123 offset:2048
    ds_read_b128 v[60:63], v123 offset:3072
    ds_read_b128 v[64:67], v123 offset:32768
    ds_read_b128 v[68:71], v123 offset:33792
    ds_read_b128 v[72:75], v123 offset:34816
    ds_read_b128 v[76:79], v123 offset:35840
    ds_read_b128 v[88:91], v123 offset:4096
    ds_read_b128 v[92:95], v123 offset:5120
    ds_read_b128 v[96:99], v123 offset:6144
    ds_read_b128 v[100:103], v123 offset:7168
    ds_read_b128 v[104:107], v123 offset:36864
    ds_read_b128 v[108:111], v123 offset:37888
    ds_read_b128 v[24:27], v123 offset:38912
    ds_read_b128 v[28:31], v123 offset:39936
    s_add_u32 s24, s24, 8192
    s_bitset0_b32 s24, 15
    s_xor_b32 s55, s24, 16384
    s_xor_b32 s29, s29, 0x40000
    s_xor_b32 s53, s29, 1024
    s_bfe_u32 s33, s22, 0x10001
    s_add_u32 s40, s22, 5
    s_lshr_b32 s40, s40, 2
    s_min_u32 s40, s40, 16
    s_bfm_b32 s58, s40, 0
    s_waitcnt vmcnt(5)
    v_cmp_eq_u32 vcc, 0, v125
    s_nop 0
    s_and_b64 vcc, vcc, s[58:59]
    s_cbranch_scc1 L_kvw_22
L_kvb_23:
    v_mov_b32 v15, 0
    s_nop 2
    v_mov_b32 v15, 0
    s_nop 2
    v_mov_b32 v15, 0
    s_nop 2
    v_mov_b32 v15, 0
    s_nop 2
    v_mov_b32 v15, 0
    s_nop 2
    v_mov_b32 v15, 0
    s_nop 2
    v_mov_b32 v15, 0
    s_nop 2
    v_mov_b32 v15, 0
    s_nop 2
    v_mov_b32 v15, 0
    s_nop 2
    v_mov_b32 v15, 0
    s_nop 2
    v_mov_b32 v15, 0
    s_nop 2
    v_mov_b32 v15, 0
    s_nop 2
    v_mov_b32 v15, 0
    s_nop 2
    v_mov_b32 v15, 0
    s_nop 2
    v_mov_b32 v15, 0
    s_nop 2
    v_mov_b32 v15, 0
    s_nop 2
    v_mov_b32 v15, 0
    s_nop 2
    v_mov_b32 v15, 0
    s_nop 2
    v_mov_b32 v15, 0
    s_nop 2
    v_mov_b32 v15, 0
    s_nop 2
    v_mov_b32 v15, 0
    s_nop 2
    v_mov_b32 v15, 0
    s_nop 2
    v_mov_b32 v15, 0
    s_nop 2
    v_mov_b32 v15, 0
    s_nop 2
    v_mov_b32 v15, 0
    s_nop 2
    v_mov_b32 v15, 0
    s_nop 2
    v_mov_b32 v15, 0
    s_nop 2
    v_mov_b32 v15, 0
    s_nop 2
    v_mov_b32 v15, 0
    s_nop 2
    v_mov_b32 v15, 0
    s_nop 2
    v_mov_b32 v15, 0
    s_nop 2
    s_waitcnt lgkmcnt(0)
    s_branch L_chain_top0_f
.p2align 6
L_chain_top1_f:
    buffer_load_dwordx4 v[0:3], v117, s[8:11], s23 offen nt
    v_mov_b32 v15, 0
    v_mov_b32 v15, 0
    v_mov_b32 v15, 0
    v_mov_b32 v15, 0
    v_mov_b32 v15, 0
    v_mov_b32 v15, 0
    v_mov_b32 v15, 0
    v_mov_b32 v15, 0
    v_mov_b32 v15, 0
    v_mov_b32 v15, 0
    v_mov_b32 v15, 0
    v_mov_b32 v15, 0
    v_mov_b32 v15, 0
    v_mov_b32 v15, 0
    v_mov_b32 v15, 0
    v_mov_b32 v15, 0
    buffer_load_dwordx4 v[0:3], v117, s[8:11], s23 offen sc1
    v_mov_b32 v15, 0
    v_mov_b32 v15, 0
    v_mov_b32 v15, 0
    v_mov_b32 v15, 0
    v_mov_b32 v15, 0
    v_mov_b32 v15, 0
    v_mov_b32 v15, 0
    v_mov_b32 v15, 0
    v_mov_b32 v15, 0
    v_mov_b32 v15, 0
    v_mov_b32 v15, 0
    v_mov_b32 v15, 0
    v_mov_b32 v15, 0
    v_mov_b32 v15, 0
    v_mov_b32 v15, 0
    v_mov_b32 v15, 0
L_mret_24:
    buffer_load_dwordx4 v[0:3], v117, s[8:11], s23 offen sc1
    s_add_u32 s45, s45, 1
    s_cmp_lt_u32 s45, 0x10000
    s_cselect_b32 s56, -2, -1
    s_nop 3
    v_mov_b32 v32, 0
    v_mov_b32 v33, 0
    v_mov_b32 v34, 0
    v_mov_b32 v35, 0
    s_waitcnt vmcnt(2)
    v_max3_u32 v15, v0, v1, v2
    v_max_u32 v15, v15, v3
    v_cmp_lt_u32 vcc, s56, v15
    v_smfmac_f32_16x16x64_bf16 v[32:35], v[0:3], v[80:87], v116
    s_cbranch_vccnz L_mret_24
    ds_write_b128 v117, v[0:3] offset:1024
    v_smfmac_f32_16x16x64_bf16 v[36:39], v[0:3], v[56:63], v116
    buffer_load_dwordx4 v[4:7], v117, s[8:11], s48 offen nt
    v_smfmac_f32_16x16x64_bf16 v[40:43], v[0:3], v[64:71], v116
    buffer_load_dwordx4 v117, s[8:11], s48 offen nt lds
    s_mov_b32 m0, 10240
    v_smfmac_f32_16x16x64_bf16 v[44:47], v[0:3], v[72:79], v116
    s_waitcnt lgkmcnt(0)
    s_barrier
    ds_read_b128 v[8:11], v117
    v_smfmac_f32_16x16x64_bf16 v[48:51], v[0:3], a[192:199], v116
    ds_read_b128 v[16:19], v117 offset:3072
    ds_read_b128 v[20:23], v117 offset:2048
    v_smfmac_f32_16x16x64_bf16 v[52:55], v[0:3], a[200:207], v116
    ds_read_b128 v[80:83], v117 offset:14336
    s_waitcnt lgkmcnt(3)
    v_smfmac_f32_16x16x64_bf16 v[32:35], v[8:11], a[0:7], v116
    ds_read_b128 v[84:87], v117 offset:15360
    v_smfmac_f32_16x16x64_bf16 v[36:39], v[8:11], a[8:15], v116
    ds_read_b128 v[56:59], v117 offset:8192
    s_waitcnt lgkmcnt(4)
    v_smfmac_f32_16x16x64_bf16 v[32:35], v[16:19], a[32:39], v116
    ds_read_b128 v[60:63], v117 offset:9216
    v_smfmac_f32_16x16x64_bf16 v[36:39], v[16:19], a[40:47], v116
    buffer_store_dwordx4 v[112:115], v117, s[8:11], s32 offen sc1
    s_waitcnt lgkmcnt(4)
    v_smfmac_f32_16x16x64_bf16 v[32:35], v[20:23], a[64:71], v116
    ds_read_b128 v[64:67], v117 offset:10240
    v_smfmac_f32_16x16x64_bf16 v[36:39], v[20:23], a[72:79], v116
    ds_read_b128 v[68:71], v117 offset:11264
    v_smfmac_f32_16x16x64_bf16 v[40:43], v[8:11], a[96:103], v116
    ds_read_b128 v[72:75], v117 offset:12288
    v_smfmac_f32_16x16x64_bf16 v[40:43], v[16:19], a[128:135], v116
    ds_read_b128 v[76:79], v117 offset:13312
    v_smfmac_f32_16x16x64_bf16 v[40:43], v[20:23], a[160:167], v116
    s_waitcnt vmcnt(2)
    v_max3_u32 v15, v4, v5, v6
    v_smfmac_f32_16x16x64_bf16 v[44:47], v[8:11], a[104:111], v116
    v_max_u32 v15, v15, v7
    v_smfmac_f32_16x16x64_bf16 v[44:47], v[16:19], a[136:143], v116
    s_waitcnt vmcnt(1) lgkmcnt(0)
    v_cmp_lt_u32 vcc, s56, v15
    v_smfmac_f32_16x16x64_bf16 v[44:47], v[20:23], a[168:175], v116
    s_cbranch_vccnz L_mret_25
L_mgo_26:
    v_smfmac_f32_16x16x64_bf16 v[44:47], v[4:7], v[24:31], v116
    s_barrier
    ds_read_b128 v[12:15], v117 offset:4096
    v_smfmac_f32_16x16x64_bf16 v[32:35], v[4:7], v[88:95], v116
    ds_read_b128 v[24:27], v117 offset:7168
    v_smfmac_f32_16x16x64_bf16 v[36:39], v[4:7], v[96:103], v116
    ds_read_b128 v[28:31], v117 offset:6144
    v_smfmac_f32_16x16x64_bf16 v[40:43], v[4:7], v[104:111], v116
    ds_read_b128 v[88:91], v117 offset:26624
    s_waitcnt lgkmcnt(3)
    v_smfmac_f32_16x16x64_bf16 v[32:35], v[12:15], a[16:23], v116
    ds_read_b128 v[92:95], v117 offset:27648
    s_waitcnt lgkmcnt(3)
    v_smfmac_f32_16x16x64_bf16 v[32:35], v[24:27], a[48:55], v116
    buffer_load_dwordx4 v117, s[8:11], s30 offen lds
    s_waitcnt lgkmcnt(2)
    v_smfmac_f32_16x16x64_bf16 v[32:35], v[28:31], a[80:87], v116
    ds_read_b128 v[96:99], v117 offset:23552
    v_smfmac_f32_16x16x64_bf16 v[36:39], v[12:15], a[24:31], v116
    ds_read_b128 v[100:103], v117 offset:23552
    v_smfmac_f32_16x16x64_bf16 v[36:39], v[24:27], a[56:63], v116
    buffer_load_dwordx4 v117, s[8:11], s30 offen offset:1024 lds
    s_add_u32 m0, s52, 0x6000
    v_add_f32 v32, v32, v34
    v_smfmac_f32_16x16x64_bf16 v[36:39], v[28:31], a[88:95], v116
    ds_read_b128 v[104:107], v117 offset:23552
    v_add_f32 v33, v33, v35
    v_smfmac_f32_16x16x64_bf16 v[40:43], v[12:15], a[112:119], v116
    ds_read_b128 v[108:111], v117 offset:23552
    v_mul_f32 v32, s34, v32
    v_smfmac_f32_16x16x64_bf16 v[40:43], v[24:27], a[144:151], v116
    buffer_load_dword v125, v119, s[8:11], s28 offen sc1
    v_mul_f32 v33, s34, v33
    v_smfmac_f32_16x16x64_bf16 v[40:43], v[28:31], a[176:183], v116
    ds_read_b128 v[0:3], v124
    v_add_f32 v36, v36, v38
    v_smfmac_f32_16x16x64_bf16 v[48:51], v[4:7], a[208:215], v116
    v_add_f32 v37, v37, v39
    v_smfmac_f32_16x16x64_bf16 v[52:55], v[4:7], a[216:223], v116
    s_waitcnt lgkmcnt(5)
    buffer_load_dwordx4 v117, s[8:11], s31 offen lds
    v_mul_f32 v36, s34, v36
    v_smfmac_f32_16x16x64_bf16 v[44:47], v[12:15], a[120:127], v116
    ds_read_b128 v[4:7], v124 offset:1024
    v_mul_f32 v37, s34, v37
    v_smfmac_f32_16x16x64_bf16 v[44:47], v[24:27], a[152:159], v116
    v_cvt_pk_bf16_f32 v34, v32, v36
    v_smfmac_f32_16x16x64_bf16 v[44:47], v[28:31], a[184:191], v116
    buffer_load_dwordx4 v117, s[8:11], s31 offen offset:1024 lds
    s_mov_b32 m0, 5120
    v_cvt_pk_bf16_f32 v35, v33, v37
    v_add_f32 v40, v40, v42
    v_smfmac_f32_16x16x64_bf16 v[48:51], v[8:11], a[224:231], v116
    ds_write2_b32 v120, v34, v35 offset0:32 offset1:48
    v_add_f32 v41, v41, v43
    v_smfmac_f32_16x16x64_bf16 v[52:55], v[8:11], a[232:239], v116
    v_add_f32 v44, v44, v46
    v_add_f32 v45, v45, v47
    v_cvt_pk_bf16_f32 v113, v40, v44
    v_cvt_pk_bf16_f32 v115, v41, v45
    v_smfmac_f32_16x16x64_bf16 v[48:51], v[12:15], a[240:247], v116
    ds_write2_b32 v120, v113, v115 offset0:0 offset1:16
    v_smfmac_f32_16x16x64_bf16 v[52:55], v[12:15], a[248:255], v116
    s_cmp_eq_u32 s22, 63
    s_cbranch_scc1 L_chain_last_f
    v_smfmac_f32_16x16x64_bf16 v[48:51], v[16:19], v[128:135], v116
    v_smfmac_f32_16x16x64_bf16 v[48:51], v[20:23], v[160:167], v116
    v_smfmac_f32_16x16x64_bf16 v[48:51], v[24:27], v[144:151], v116
    s_waitcnt lgkmcnt(0)
    s_barrier
    v_smfmac_f32_16x16x64_bf16 v[48:51], v[28:31], v[176:183], v116
    ds_read_b128 v[32:35], v121 offset:16384
    ds_read_b128 v[36:39], v121 offset:17408
    v_smfmac_f32_16x16x64_bf16 v[52:55], v[16:19], v[136:143], v116
    ds_read_b128 v[40:43], v121 offset:18432
    ds_read_b128 v[44:47], v121 offset:19456
    v_smfmac_f32_16x16x64_bf16 v[52:55], v[20:23], v[168:175], v116
    ds_read_b128 v[8:11], v124 offset:32768
    v_add_f32 v48, v48, v50
    v_smfmac_f32_16x16x64_bf16 v[52:55], v[24:27], v[152:159], v116
    ds_read_b128 v[12:15], v124 offset:33792
    v_add_f32 v49, v49, v51
    v_smfmac_f32_16x16x64_bf16 v[52:55], v[28:31], v[184:191], v116
    s_waitcnt lgkmcnt(5)
    v_cvt_pk_bf16_f32 v112, v48, v49
    v_mfma_f32_16x16x32_bf16 v[56:59], v[56:59], v[32:35], 0
    s_waitcnt lgkmcnt(4)
    v_mov_b32 v48, s50
    v_mov_b32 v49, s50
    v_mfma_f32_16x16x32_bf16 v[56:59], v[60:63], v[36:39], v[56:59]
    ds_read_b128 v[16:19], v124 offset:2048
    s_waitcnt lgkmcnt(4)
    v_mov_b32 v50, s50
    v_mov_b32 v51, s50
    v_mfma_f32_16x16x32_bf16 v[56:59], v[64:67], v[40:43], v[56:59]
    ds_read_b128 v[20:23], v124 offset:3072
    s_waitcnt lgkmcnt(4)
    v_add_f32 v52, v52, v54
    v_mfma_f32_16x16x32_bf16 v[56:59], v[68:71], v[44:47], v[56:59]
    ds_read_b128 v[24:27], v124 offset:4096
    v_add_f32 v53, v53, v55
    v_mfma_f32_16x16x32_bf16 v[60:63], v[72:75], v[32:35], 0
    ds_read_b128 v[28:31], v124 offset:5120
    v_cvt_pk_bf16_f32 v114, v52, v53
    v_mov_b32 v53, 0
    v_mfma_f32_16x16x32_bf16 v[60:63], v[76:79], v[36:39], v[60:63]
    v_exp_f32 v56, v56
    v_mfma_f32_16x16x32_bf16 v[60:63], v[80:83], v[40:43], v[60:63]
    v_exp_f32 v57, v57
    v_mfma_f32_16x16x32_bf16 v[60:63], v[84:87], v[44:47], v[60:63]
    v_exp_f32 v58, v58
    v_mfma_f32_16x16x32_bf16 v[64:67], v[32:35], v[32:35], 0
    v_exp_f32 v59, v59
    v_cvt_pk_bf16_f32 v68, v56, v57
    v_mfma_f32_16x16x32_bf16 v[64:67], v[36:39], v[36:39], v[64:67]
    v_exp_f32 v60, v60
    v_cvt_pk_bf16_f32 v69, v58, v59
    v_mfma_f32_16x16x32_bf16 v[64:67], v[40:43], v[40:43], v[64:67]
    v_exp_f32 v61, v61
    v_mfma_f32_16x16x32_bf16 v[64:67], v[44:47], v[44:47], v[64:67]
    v_exp_f32 v62, v62
    v_exp_f32 v63, v63
    v_cvt_pk_bf16_f32 v70, v60, v61
    v_cvt_pk_bf16_f32 v71, v62, v63
    s_nop 1
    v_mfma_f32_16x16x32_bf16 v[72:75], v[88:91], v[68:71], 0
    s_nop 0
    v_exp_f32 v64, v64
    v_mfma_f32_16x16x32_bf16 v[76:79], v[92:95], v[68:71], 0
    v_exp_f32 v65, v65
    v_mfma_f32_16x16x32_bf16 v[80:83], v[48:51], v[68:71], 0
    v_cvt_pk_bf16_f32 v52, v64, v65
    s_nop 1
    v_mfma_f32_16x16x16_bf16 v[72:75], v[112:113], v[52:53], v[72:75]
    ds_read_b128 v[32:35], v124 offset:6144
    v_mfma_f32_16x16x16_bf16 v[76:79], v[114:115], v[52:53], v[76:79]
    ds_read_b128 v[36:39], v124 offset:7168
    v_mfma_f32_16x16x16_bf16 v[80:83], v[48:49], v[52:53], v[80:83]
L_norm_27:
    s_mov_b64 vcc, s[36:37]
    v_mov_b32 v122, v122
    v_mov_b32 v122, v122
    v_mov_b32 v122, v122
    v_cndmask_b32_dpp v76, v72, v76, vcc quad_perm:[2,3,2,3] row_mask:0xf bank_mask:0xf
    v_cndmask_b32_dpp v77, v73, v77, vcc quad_perm:[2,3,2,3] row_mask:0xf bank_mask:0xf
    v_cndmask_b32_dpp v78, v74, v78, vcc quad_perm:[2,3,2,3] row_mask:0xf bank_mask:0xf
    v_cndmask_b32_dpp v79, v75, v79, vcc quad_perm:[2,3,2,3] row_mask:0xf bank_mask:0xf
    v_rcp_f32_dpp v84, v80 quad_perm:[2,3,2,3] row_mask:0xf bank_mask:0xf
    s_nop 0
    v_pk_mul_f32 v[76:77], v[76:77], v[84:85] op_sel_hi:[1,0]
    v_pk_mul_f32 v[78:79], v[78:79], v[84:85] op_sel_hi:[1,0]
    v_cvt_pk_bf16_f32 v72, v76, v77
    v_cvt_pk_bf16_f32 v73, v78, v79
    ds_write_b64 v122, v[72:73] offset:20992
    v_max_f32_dpp v86, v80, v84 quad_perm:[2,3,2,3] row_mask:0xf bank_mask:0xf
    v_mov_b32_dpp v60, v72 quad_perm:[0,1,0,1] row_mask:0xf bank_mask:0xf
    v_mov_b32_dpp v61, v73 quad_perm:[0,1,0,1] row_mask:0xf bank_mask:0xf
    v_cmp_lt_f32 vcc, s35, v86
    v_mov_b32_dpp v62, v72 quad_perm:[2,3,2,3] row_mask:0xf bank_mask:0xf
    v_mov_b32_dpp v63, v73 quad_perm:[2,3,2,3] row_mask:0xf bank_mask:0xf
    s_nop 1
    v_smfmac_f32_16x16x64_bf16 v[96:99], v[60:63], v[192:199], v116
    s_cbranch_vccnz L_smax_28
    v_smfmac_f32_16x16x64_bf16 v[100:103], v[60:63], v[224:231], v116
    s_waitcnt lgkmcnt(0)
    s_barrier
    ds_read_b128 v[92:95], v127 offset:20480
    ds_read_b128 v[80:83], v127 offset:22016
    ds_read_b128 v[84:87], v127 offset:21504
    v_smfmac_f32_16x16x64_bf16 v[104:107], v[60:63], v[0:7], v116
    ds_read_b128 v[40:43], v124 offset:34816
    v_smfmac_f32_16x16x64_bf16 v[108:111], v[60:63], v[8:15], v116
    ds_read_b128 v[56:59], v124 offset:36864
    s_waitcnt lgkmcnt(4)
    v_smfmac_f32_16x16x64_bf16 v[96:99], v[92:95], v[200:207], v116
    s_waitcnt lgkmcnt(3)
    v_smfmac_f32_16x16x64_bf16 v[96:99], v[80:83], v[208:215], v116
    ds_read_b128 v[44:47], v124 offset:35840
    s_waitcnt lgkmcnt(3)
    v_smfmac_f32_16x16x64_bf16 v[96:99], v[84:87], v[216:223], v116
    ds_read_b128 v[68:71], v124 offset:39936
    v_smfmac_f32_16x16x64_bf16 v[100:103], v[92:95], v[232:239], v116
    ds_read_b128 v[64:67], v124 offset:38912
    v_smfmac_f32_16x16x64_bf16 v[100:103], v[80:83], v[240:247], v116
    ds_read_b128 v[60:63], v124 offset:37888
    v_cvt_pk_bf16_f32 v72, v96, v98
    v_smfmac_f32_16x16x64_bf16 v[100:103], v[84:87], v[248:255], v116
    v_and_or_b32 v72, v72, -2, s33
    v_smfmac_f32_16x16x64_bf16 v[104:107], v[92:95], v[16:23], v116
    v_cvt_pk_bf16_f32 v74, v97, v99
    v_smfmac_f32_16x16x64_bf16 v[104:107], v[80:83], v[24:31], v116
    v_cvt_pk_bf16_f32 v73, v100, v102
    v_cvt_pk_bf16_f32 v75, v101, v103
    v_smfmac_f32_16x16x64_bf16 v[104:107], v[84:87], v[32:39], v116
    buffer_store_dwordx4 v[72:75], v118, s[8:11], s25 offen
    s_waitcnt lgkmcnt(3)
    v_smfmac_f32_16x16x64_bf16 v[108:111], v[92:95], v[40:47], v116
    s_waitcnt lgkmcnt(0)
    v_smfmac_f32_16x16x64_bf16 v[108:111], v[80:83], v[56:63], v116
    v_cvt_pk_bf16_f32 v76, v104, v106
    v_smfmac_f32_16x16x64_bf16 v[108:111], v[84:87], v[64:71], v116
    v_and_or_b32 v76, v76, -2, s33
    v_cvt_pk_bf16_f32 v78, v105, v107
    v_mov_b32 v122, v122
    v_mov_b32 v122, v122
    v_mov_b32 v122, v122
    v_mov_b32 v122, v122
    v_mov_b32 v122, v122
    v_mov_b32 v122, v122
    v_cvt_pk_bf16_f32 v77, v108, v110
    v_cvt_pk_bf16_f32 v79, v109, v111
    buffer_store_dwordx4 v[76:79], v118, s[8:11], s26 offen
    s_add_u32 s30, s30, 0x40000
    s_add_u32 s31, s31, 0x40000
    s_add_u32 s32, s32, 0x20000
    s_add_u32 s23, s24, 1024
    s_add_u32 s48, s23, 4096
    s_xor_b32 s25, s25, 0x40000
    s_xor_b32 s26, s26, 0x40000
    s_mov_b32 s35, 0x49800000
    s_add_u32 s22, s22, 1
    v_mov_b32 v32, 0
    v_mov_b32 v33, 0
    v_mov_b32 v34, 0
    v_mov_b32 v35, 0
    v_mov_b32 v36, 0
    v_mov_b32 v37, 0
    v_mov_b32 v38, 0
    v_mov_b32 v39, 0
    v_mov_b32 v40, 0
    v_mov_b32 v41, 0
    v_mov_b32 v42, 0
    v_mov_b32 v43, 0
    v_mov_b32 v44, 0
    v_mov_b32 v45, 0
    v_mov_b32 v46, 0
    v_mov_b32 v47, 0
    v_mov_b32 v48, 0
    v_mov_b32 v49, 0
    v_mov_b32 v50, 0
    v_mov_b32 v51, 0
    v_mov_b32 v52, 0
    v_mov_b32 v53, 0
    v_mov_b32 v54, 0
    v_mov_b32 v55, 0
    ds_read_b128 v[80:83], v123
    ds_read_b128 v[84:87], v123 offset:1024
    ds_read_b128 v[56:59], v123 offset:2048
    ds_read_b128 v[60:63], v123 offset:3072
    ds_read_b128 v[64:67], v123 offset:32768
    ds_read_b128 v[68:71], v123 offset:33792
    ds_read_b128 v[72:75], v123 offset:34816
    ds_read_b128 v[76:79], v123 offset:35840
    ds_read_b128 v[88:91], v123 offset:4096
    ds_read_b128 v[92:95], v123 offset:5120
    ds_read_b128 v[96:99], v123 offset:6144
    ds_read_b128 v[100:103], v123 offset:7168
    ds_read_b128 v[104:107], v123 offset:36864
    ds_read_b128 v[108:111], v123 offset:37888
    ds_read_b128 v[24:27], v123 offset:38912
    ds_read_b128 v[28:31], v123 offset:39936
    s_add_u32 s24, s24, 8192
    s_bitset0_b32 s24, 15
    s_xor_b32 s55, s24, 16384
    s_xor_b32 s29, s29, 0x40000
    s_xor_b32 s53, s29, 1024
    s_bfe_u32 s33, s22, 0x10001
    s_add_u32 s40, s22, 5
    s_lshr_b32 s40, s40, 2
    s_min_u32 s40, s40, 16
    s_bfm_b32 s58, s40, 0
    s_waitcnt vmcnt(4)
    v_cmp_eq_u32 vcc, 0, v125
    s_nop 0
    s_and_b64 vcc, vcc, s[58:59]
    s_cbranch_scc1 L_kvw_29
L_kvb_30:
    v_mov_b32 v15, 0
    s_nop 2
    v_mov_b32 v15, 0
    s_nop 2
    v_mov_b32 v15, 0
    s_nop 2
    v_mov_b32 v15, 0
    s_nop 2
    v_mov_b32 v15, 0
    s_nop 2
    v_mov_b32 v15, 0
    s_nop 2
    v_mov_b32 v15, 0
    s_nop 2
    v_mov_b32 v15, 0
    s_nop 2
    v_mov_b32 v15, 0
    s_nop 2
    v_mov_b32 v15, 0
    s_nop 2
    v_mov_b32 v15, 0
    s_nop 2
    v_mov_b32 v15, 0
    s_nop 2
    v_mov_b32 v15, 0
    s_nop 2
    v_mov_b32 v15, 0
    s_nop 2
    v_mov_b32 v15, 0
    s_nop 2
    v_mov_b32 v15, 0
    s_nop 2
    v_mov_b32 v15, 0
    s_nop 2
    v_mov_b32 v15, 0
    s_nop 2
    v_mov_b32 v15, 0
    s_nop 2
    v_mov_b32 v15, 0
    s_nop 2
    v_mov_b32 v15, 0
    s_nop 2
    v_mov_b32 v15, 0
    s_nop 2
    v_mov_b32 v15, 0
    s_nop 2
    v_mov_b32 v15, 0
    s_nop 2
    v_mov_b32 v15, 0
    s_nop 2
    v_mov_b32 v15, 0
    s_nop 2
    v_mov_b32 v15, 0
    s_nop 2
    v_mov_b32 v15, 0
    s_nop 2
    v_mov_b32 v15, 0
    s_nop 2
    v_mov_b32 v15, 0
    s_nop 2
    v_mov_b32 v15, 0
    s_nop 2
    s_waitcnt lgkmcnt(0)
    s_branch L_chain_top1_f
.p2align 6
L_chain_top2_f:
    buffer_load_dwordx4 v[0:3], v117, s[8:11], s23 offen nt
    v_mov_b32 v48, 0
    v_mov_b32 v49, 0
    v_mov_b32 v50, 0
    v_mov_b32 v51, 0
    v_mov_b32 v52, 0
    v_mov_b32 v53, 0
    v_mov_b32 v15, 0
    v_mov_b32 v15, 0
    v_mov_b32 v15, 0
    v_mov_b32 v15, 0
    v_mov_b32 v15, 0
    v_mov_b32 v15, 0
    v_mov_b32 v15, 0
    v_mov_b32 v15, 0
    v_mov_b32 v15, 0
    v_mov_b32 v15, 0
    buffer_load_dwordx4 v[0:3], v117, s[8:11], s23 offen sc1
    s_waitcnt vmcnt(3)
    v_mov_b32 v36, 0
    v_mov_b32 v37, 0
    v_mov_b32 v38, 0
    v_mov_b32 v39, 0
    v_mov_b32 v40, 0
    v_mov_b32 v41, 0
    v_mov_b32 v42, 0
    v_mov_b32 v43, 0
    v_mov_b32 v44, 0
    v_mov_b32 v45, 0
    v_mov_b32 v46, 0
    v_mov_b32 v47, 0
    v_mov_b32 v15, 0
    v_mov_b32 v15, 0
    v_mov_b32 v15, 0
    v_mov_b32 v15, 0
L_mret_31:
    buffer_load_dwordx4 v[0:3], v117, s[8:11], s23 offen sc1
    s_add_u32 s45, s45, 1
    s_cmp_lt_u32 s45, 0x10000
    s_cselect_b32 s56, -2, -1
    s_nop 3
    v_mov_b32 v32, 0
    v_mov_b32 v33, 0
    v_mov_b32 v34, 0
    v_mov_b32 v35, 0
    s_waitcnt vmcnt(2)
    v_max3_u32 v15, v0, v1, v2
    v_max_u32 v15, v15, v3
    v_cmp_lt_u32 vcc, s56, v15
    v_smfmac_f32_16x16x64_bf16 v[32:35], v[0:3], v[80:87], v116
    s_cbranch_vccnz L_mret_31
    ds_write_b128 v117, v[0:3] offset:2048
    v_smfmac_f32_16x16x64_bf16 v[36:39], v[0:3], v[56:63], v116
    buffer_load_dwordx4 v[4:7], v117, s[8:11], s48 offen nt
    v_smfmac_f32_16x16x64_bf16 v[40:43], v[0:3], v[64:71], v116
    buffer_load_dwordx4 v117, s[8:11], s48 offen nt lds
    s_mov_b32 m0, 12288
    v_smfmac_f32_16x16x64_bf16 v[44:47], v[0:3], v[72:79], v116
    s_waitcnt lgkmcnt(0)
    s_barrier
    ds_read_b128 v[8:11], v117 offset:3072
    v_smfmac_f32_16x16x64_bf16 v[48:51], v[0:3], a[192:199], v116
    ds_read_b128 v[16:19], v117
    ds_read_b128 v[20:23], v117 offset:1024
    v_smfmac_f32_16x16x64_bf16 v[52:55], v[0:3], a[200:207], v116
    ds_read_b128 v[80:83], v117 offset:14336
    s_waitcnt lgkmcnt(3)
    v_smfmac_f32_16x16x64_bf16 v[32:35], v[8:11], a[0:7], v116
    ds_read_b128 v[84:87], v117 offset:15360
    v_smfmac_f32_16x16x64_bf16 v[36:39], v[8:11], a[8:15], v116
    ds_read_b128 v[56:59], v117 offset:8192
    s_waitcnt lgkmcnt(4)
    v_smfmac_f32_16x16x64_bf16 v[32:35], v[16:19], a[32:39], v116
    ds_read_b128 v[60:63], v117 offset:9216
    v_smfmac_f32_16x16x64_bf16 v[36:39], v[16:19], a[40:47], v116
    ds_read_b128 v[64:67], v117 offset:10240
    s_waitcnt lgkmcnt(5)
    v_smfmac_f32_16x16x64_bf16 v[32:35], v[20:23], a[64:71], v116
    ds_read_b128 v[68:71], v117 offset:11264
    v_smfmac_f32_16x16x64_bf16 v[36:39], v[20:23], a[72:79], v116
    buffer_store_dwordx4 v[112:115], v117, s[8:11], s32 offen sc1
    v_smfmac_f32_16x16x64_bf16 v[40:43], v[8:11], a[96:103], v116
    ds_read_b128 v[72:75], v117 offset:12288
    v_smfmac_f32_16x16x64_bf16 v[40:43], v[16:19], a[128:135], v116
    ds_read_b128 v[76:79], v117 offset:13312
    v_smfmac_f32_16x16x64_bf16 v[40:43], v[20:23], a[160:167], v116
    s_waitcnt vmcnt(2)
    v_max3_u32 v15, v4, v5, v6
    v_smfmac_f32_16x16x64_bf16 v[44:47], v[8:11], a[104:111], v116
    v_max_u32 v15, v15, v7
    v_smfmac_f32_16x16x64_bf16 v[44:47], v[16:19], a[136:143], v116
    s_waitcnt vmcnt(1) lgkmcnt(0)
    v_cmp_lt_u32 vcc, s56, v15
    v_smfmac_f32_16x16x64_bf16 v[44:47], v[20:23], a[168:175], v116
    s_cbranch_vccnz L_mret_32
L_mgo_33:
    v_smfmac_f32_16x16x64_bf16 v[44:47], v[4:7], v[24:31], v116
    s_barrier
    ds_read_b128 v[12:15], v117 offset:7168
    v_smfmac_f32_16x16x64_bf16 v[32:35], v[4:7], v[88:95], v116
    ds_read_b128 v[24:27], v117 offset:4096
    v_smfmac_f32_16x16x64_bf16 v[36:39], v[4:7], v[96:103], v116
    ds_read_b128 v[28:31], v117 offset:5120
    v_smfmac_f32_16x16x64_bf16 v[40:43], v[4:7], v[104:111], v116
    ds_read_b128 v[88:91], v117 offset:28672
    s_waitcnt lgkmcnt(3)
    v_smfmac_f32_16x16x64_bf16 v[32:35], v[12:15], a[16:23], v116
    ds_read_b128 v[92:95], v117 offset:29696
    s_waitcnt lgkmcnt(3)
    v_smfmac_f32_16x16x64_bf16 v[32:35], v[24:27], a[48:55], v116
    buffer_load_dwordx4 v117, s[8:11], s30 offen lds
    s_waitcnt lgkmcnt(2)
    v_smfmac_f32_16x16x64_bf16 v[32:35], v[28:31], a[80:87], v116
    ds_read_b128 v[96:99], v117 offset:23552
    v_smfmac_f32_16x16x64_bf16 v[36:39], v[12:15], a[24:31], v116
    ds_read_b128 v[100:103], v117 offset:23552
    v_smfmac_f32_16x16x64_bf16 v[36:39], v[24:27], a[56:63], v116
    buffer_load_dwordx4 v117, s[8:11], s30 offen offset:1024 lds
    s_add_u32 m0, s52, 0x6000
    v_add_f32 v32, v32, v34
    v_smfmac_f32_16x16x64_bf16 v[36:39], v[28:31], a[88:95], v116
    ds_read_b128 v[104:107], v117 offset:23552
    v_add_f32 v33, v33, v35
    v_smfmac_f32_16x16x64_bf16 v[40:43], v[12:15], a[112:119], v116
    ds_read_b128 v[108:111], v117 offset:23552
    v_mul_f32 v32, s34, v32
    v_smfmac_f32_16x16x64_bf16 v[40:43], v[24:27], a[144:151], v116
    s_waitcnt lgkmcnt(4)
    buffer_load_dwordx4 v117, s[8:11], s31 offen lds
    v_mul_f32 v33, s34, v33
    v_smfmac_f32_16x16x64_bf16 v[40:43], v[28:31], a[176:183], v116
    ds_read_b128 v[0:3], v124
    v_add_f32 v36, v36, v38
    v_smfmac_f32_16x16x64_bf16 v[48:51], v[4:7], a[208:215], v116
    v_add_f32 v37, v37, v39
    v_smfmac_f32_16x16x64_bf16 v[52:55], v[4:7], a[216:223], v116
    buffer_load_dwordx4 v117, s[8:11], s31 offen offset:1024 lds
    s_mov_b32 m0, 6144
    v_mul_f32 v36, s34, v36
    v_smfmac_f32_16x16x64_bf16 v[44:47], v[12:15], a[120:127], v116
    ds_read_b128 v[4:7], v124 offset:1024
    v_mul_f32 v37, s34, v37
    v_smfmac_f32_16x16x64_bf16 v[44:47], v[24:27], a[152:159], v116
    v_cvt_pk_bf16_f32 v34, v32, v36
    v_smfmac_f32_16x16x64_bf16 v[44:47], v[28:31], a[184:191], v116
    v_cvt_pk_bf16_f32 v35, v33, v37
    v_add_f32 v40, v40, v42
    v_smfmac_f32_16x16x64_bf16 v[48:51], v[8:11], a[224:231], v116
    ds_write2_b32 v120, v34, v35 offset0:32 offset1:48
    v_add_f32 v41, v41, v43
    v_smfmac_f32_16x16x64_bf16 v[52:55], v[8:11], a[232:239], v116
    v_add_f32 v44, v44, v46
    v_add_f32 v45, v45, v47
    v_cvt_pk_bf16_f32 v113, v40, v44
    v_cvt_pk_bf16_f32 v115, v41, v45
    v_smfmac_f32_16x16x64_bf16 v[48:51], v[12:15], a[240:247], v116
    ds_write2_b32 v120, v113, v115 offset0:0 offset1:16
    v_smfmac_f32_16x16x64_bf16 v[52:55], v[12:15], a[248:255], v116
    s_cmp_eq_u32 s22, 63
    s_cbranch_scc1 L_chain_last_f
    v_smfmac_f32_16x16x64_bf16 v[48:51], v[16:19], v[128:135], v116
    buffer_store_dword v126, v119, s[8:11], s55 offen
    v_smfmac_f32_16x16x64_bf16 v[48:51], v[20:23], v[160:167], v116
    v_smfmac_f32_16x16x64_bf16 v[48:51], v[24:27], v[144:151], v116
    s_waitcnt lgkmcnt(0)
    s_barrier
    v_smfmac_f32_16x16x64_bf16 v[48:51], v[28:31], v[176:183], v116
    ds_read_b128 v[32:35], v121 offset:16384
    ds_read_b128 v[36:39], v121 offset:17408
    v_smfmac_f32_16x16x64_bf16 v[52:55], v[16:19], v[136:143], v116
    ds_read_b128 v[40:43], v121 offset:18432
    ds_read_b128 v[44:47], v121 offset:19456
    v_smfmac_f32_16x16x64_bf16 v[52:55], v[20:23], v[168:175], v116
    ds_read_b128 v[8:11], v124 offset:32768
    v_add_f32 v48, v48, v50
    v_smfmac_f32_16x16x64_bf16 v[52:55], v[24:27], v[152:159], v116
    ds_read_b128 v[12:15], v124 offset:33792
    v_add_f32 v49, v49, v51
    v_smfmac_f32_16x16x64_bf16 v[52:55], v[28:31], v[184:191], v116
    s_waitcnt lgkmcnt(5)
    v_cvt_pk_bf16_f32 v112, v48, v49
    v_mfma_f32_16x16x32_bf16 v[56:59], v[56:59], v[32:35], 0
    s_waitcnt lgkmcnt(4)
    v_mov_b32 v48, s50
    v_mov_b32 v49, s50
    v_mfma_f32_16x16x32_bf16 v[56:59], v[60:63], v[36:39], v[56:59]
    ds_read_b128 v[16:19], v124 offset:2048
    s_waitcnt lgkmcnt(4)
    v_mov_b32 v50, s50
    v_mov_b32 v51, s50
    v_mfma_f32_16x16x32_bf16 v[56:59], v[64:67], v[40:43], v[56:59]
    ds_read_b128 v[20:23], v124 offset:3072
    s_waitcnt lgkmcnt(4)
    v_add_f32 v52, v52, v54
    v_mfma_f32_16x16x32_bf16 v[56:59], v[68:71], v[44:47], v[56:59]
    ds_read_b128 v[24:27], v124 offset:4096
    v_add_f32 v53, v53, v55
    v_mfma_f32_16x16x32_bf16 v[60:63], v[72:75], v[32:35], 0
    ds_read_b128 v[28:31], v124 offset:5120
    v_cvt_pk_bf16_f32 v114, v52, v53
    v_mov_b32 v53, 0
    v_mfma_f32_16x16x32_bf16 v[60:63], v[76:79], v[36:39], v[60:63]
    v_exp_f32 v56, v56
    v_mfma_f32_16x16x32_bf16 v[60:63], v[80:83], v[40:43], v[60:63]
    v_exp_f32 v57, v57
    v_mfma_f32_16x16x32_bf16 v[60:63], v[84:87], v[44:47], v[60:63]
    v_exp_f32 v58, v58
    v_mfma_f32_16x16x32_bf16 v[64:67], v[32:35], v[32:35], 0
    v_exp_f32 v59, v59
    v_cvt_pk_bf16_f32 v68, v56, v57
    v_mfma_f32_16x16x32_bf16 v[64:67], v[36:39], v[36:39], v[64:67]
    v_exp_f32 v60, v60
    v_cvt_pk_bf16_f32 v69, v58, v59
    v_mfma_f32_16x16x32_bf16 v[64:67], v[40:43], v[40:43], v[64:67]
    v_exp_f32 v61, v61
    v_mfma_f32_16x16x32_bf16 v[64:67], v[44:47], v[44:47], v[64:67]
    v_exp_f32 v62, v62
    v_exp_f32 v63, v63
    v_cvt_pk_bf16_f32 v70, v60, v61
    v_cvt_pk_bf16_f32 v71, v62, v63
    s_nop 1
    v_mfma_f32_16x16x32_bf16 v[72:75], v[88:91], v[68:71], 0
    s_nop 0
    v_exp_f32 v64, v64
    v_mfma_f32_16x16x32_bf16 v[76:79], v[92:95], v[68:71], 0
    v_exp_f32 v65, v65
    v_mfma_f32_16x16x32_bf16 v[80:83], v[48:51], v[68:71], 0
    v_cvt_pk_bf16_f32 v52, v64, v65
    s_nop 1
    v_mfma_f32_16x16x16_bf16 v[72:75], v[112:113], v[52:53], v[72:75]
    ds_read_b128 v[32:35], v124 offset:6144
    v_mfma_f32_16x16x16_bf16 v[76:79], v[114:115], v[52:53], v[76:79]
    ds_read_b128 v[36:39], v124 offset:7168
    v_mfma_f32_16x16x16_bf16 v[80:83], v[48:49], v[52:53], v[80:83]
L_norm_34:
    s_mov_b64 vcc, s[36:37]
    v_mov_b32 v122, v122
    v_mov_b32 v122, v122
    v_mov_b32 v122, v122
    v_cndmask_b32_dpp v76, v72, v76, vcc quad_perm:[2,3,2,3] row_mask:0xf bank_mask:0xf
    v_cndmask_b32_dpp v77, v73, v77, vcc quad_perm:[2,3,2,3] row_mask:0xf bank_mask:0xf
    v_cndmask_b32_dpp v78, v74, v78, vcc quad_perm:[2,3,2,3] row_mask:0xf bank_mask:0xf
    v_cndmask_b32_dpp v79, v75, v79, vcc quad_perm:[2,3,2,3] row_mask:0xf bank_mask:0xf
    v_rcp_f32_dpp v84, v80 quad_perm:[2,3,2,3] row_mask:0xf bank_mask:0xf
    s_nop 0
    v_pk_mul_f32 v[76:77], v[76:77], v[84:85] op_sel_hi:[1,0]
    v_pk_mul_f32 v[78:79], v[78:79], v[84:85] op_sel_hi:[1,0]
    v_cvt_pk_bf16_f32 v72, v76, v77
    v_cvt_pk_bf16_f32 v73, v78, v79
    ds_write_b64 v122, v[72:73] offset:21504
    v_max_f32_dpp v86, v80, v84 quad_perm:[2,3,2,3] row_mask:0xf bank_mask:0xf
    v_mov_b32_dpp v60, v72 quad_perm:[0,1,0,1] row_mask:0xf bank_mask:0xf
    v_mov_b32_dpp v61, v73 quad_perm:[0,1,0,1] row_mask:0xf bank_mask:0xf
    v_cmp_lt_f32 vcc, s35, v86
    v_mov_b32_dpp v62, v72 quad_perm:[2,3,2,3] row_mask:0xf bank_mask:0xf
    v_mov_b32_dpp v63, v73 quad_perm:[2,3,2,3] row_mask:0xf bank_mask:0xf
    s_nop 1
    v_smfmac_f32_16x16x64_bf16 v[96:99], v[60:63], v[192:199], v116
    s_cbranch_vccnz L_smax_35
    v_smfmac_f32_16x16x64_bf16 v[100:103], v[60:63], v[224:231], v116
    s_waitcnt lgkmcnt(0)
    s_barrier
    ds_read_b128 v[92:95], v127 offset:22016
    ds_read_b128 v[80:83], v127 offset:20480
    ds_read_b128 v[84:87], v127 offset:20992
    v_smfmac_f32_16x16x64_bf16 v[104:107], v[60:63], v[0:7], v116
    ds_read_b128 v[40:43], v124 offset:34816
    v_smfmac_f32_16x16x64_bf16 v[108:111], v[60:63], v[8:15], v116
    ds_read_b128 v[56:59], v124 offset:36864
    s_waitcnt lgkmcnt(4)
    v_smfmac_f32_16x16x64_bf16 v[96:99], v[92:95], v[200:207], v116
    s_waitcnt lgkmcnt(3)
    v_smfmac_f32_16x16x64_bf16 v[96:99], v[80:83], v[208:215], v116
    ds_read_b128 v[44:47], v124 offset:35840
    s_waitcnt lgkmcnt(3)
    v_smfmac_f32_16x16x64_bf16 v[96:99], v[84:87], v[216:223], v116
    ds_read_b128 v[68:71], v124 offset:39936
    v_smfmac_f32_16x16x64_bf16 v[100:103], v[92:95], v[232:239], v116
    ds_read_b128 v[64:67], v124 offset:38912
    v_smfmac_f32_16x16x64_bf16 v[100:103], v[80:83], v[240:247], v116
    ds_read_b128 v[60:63], v124 offset:37888
    v_cvt_pk_bf16_f32 v72, v96, v98
    v_smfmac_f32_16x16x64_bf16 v[100:103], v[84:87], v[248:255], v116
    v_and_or_b32 v72, v72, -2, s33
    v_smfmac_f32_16x16x64_bf16 v[104:107], v[92:95], v[16:23], v116
    v_cvt_pk_bf16_f32 v74, v97, v99
    v_smfmac_f32_16x16x64_bf16 v[104:107], v[80:83], v[24:31], v116
    v_cvt_pk_bf16_f32 v73, v100, v102
    v_cvt_pk_bf16_f32 v75, v101, v103
    v_smfmac_f32_16x16x64_bf16 v[104:107], v[84:87], v[32:39], v116
    buffer_store_dwordx4 v[72:75], v118, s[8:11], s25 offen
    s_waitcnt lgkmcnt(3)
    v_smfmac_f32_16x16x64_bf16 v[108:111], v[92:95], v[40:47], v116
    s_waitcnt lgkmcnt(0)
    v_smfmac_f32_16x16x64_bf16 v[108:111], v[80:83], v[56:63], v116
    v_cvt_pk_bf16_f32 v76, v104, v106
    v_smfmac_f32_16x16x64_bf16 v[108:111], v[84:87], v[64:71], v116
    v_and_or_b32 v76, v76, -2, s33
    v_cvt_pk_bf16_f32 v78, v105, v107
    v_mov_b32 v122, v122
    v_mov_b32 v122, v122
    v_mov_b32 v122, v122
    v_mov_b32 v122, v122
    v_mov_b32 v122, v122
    v_mov_b32 v122, v122
    v_cvt_pk_bf16_f32 v77, v108, v110
    v_cvt_pk_bf16_f32 v79, v109, v111
    buffer_store_dwordx4 v[76:79], v118, s[8:11], s26 offen
    ds_read_b128 v[80:83], v123
    ds_read_b128 v[84:87], v123 offset:1024
    ds_read_b128 v[56:59], v123 offset:2048
    ds_read_b128 v[60:63], v123 offset:3072
    ds_read_b128 v[64:67], v123 offset:32768
    ds_read_b128 v[68:71], v123 offset:33792
    ds_read_b128 v[72:75], v123 offset:34816
    ds_read_b128 v[76:79], v123 offset:35840
    ds_read_b128 v[88:91], v123 offset:4096
    ds_read_b128 v[92:95], v123 offset:5120
    ds_read_b128 v[96:99], v123 offset:6144
    ds_read_b128 v[100:103], v123 offset:7168
    ds_read_b128 v[104:107], v123 offset:36864
    ds_read_b128 v[108:111], v123 offset:37888
    ds_read_b128 v[24:27], v123 offset:38912
    ds_read_b128 v[28:31], v123 offset:39936
    s_add_u32 s30, s30, 0x40000
    s_add_u32 s31, s31, 0x40000
    s_add_u32 s32, s32, 0x20000
    s_add_u32 s23, s24, 2048
    s_add_u32 s48, s23, 4096
    s_xor_b32 s25, s25, 0x40000
    s_xor_b32 s26, s26, 0x40000
    s_mov_b32 s35, 0x49800000
    s_add_u32 s22, s22, 1
    v_cndmask_b32 v12, 0, v125, s[68:69]
    v_cndmask_b32 v13, 0, v125, s[70:71]
    v_cndmask_b32 v14, 0, v125, s[72:73]
    v_cndmask_b32 v15, 0, v125, s[74:75]
    v_mov_b32 v54, 0
    v_mov_b32 v55, 0
    v_mov_b32 v52, 0
    v_mov_b32 v52, 0
    v_mov_b32 v52, 0
    v_mov_b32 v52, 0
    v_mov_b32 v52, 0
    v_mov_b32 v52, 0
    v_mov_b32 v52, 0
    v_mov_b32 v52, 0
    v_mov_b32 v52, 0
    v_mov_b32 v52, 0
    v_mov_b32 v52, 0
    v_mov_b32 v52, 0
    v_mov_b32 v52, 0
    v_mov_b32 v52, 0
    v_mov_b32 v52, 0
    v_mov_b32 v52, 0
    v_mov_b32 v52, 0
    v_mov_b32 v52, 0
    v_mov_b32 v52, 0
    buffer_load_dwordx4 v[4:7], v117, s[8:11], s29 offen nt
    buffer_load_dwordx4 v[8:11], v117, s[8:11], s53 offen nt
    buffer_load_dwordx4 v[16:19], v117, s[8:11], s29 offen offset:2048 nt
    buffer_load_dwordx4 v[20:23], v117, s[8:11], s53 offen offset:2048 nt
    v_mov_b32 v52, 0
    v_mov_b32 v52, 0
    v_mov_b32 v52, 0
    v_mov_b32 v52, 0
    v_mov_b32 v52, 0
    v_mov_b32 v52, 0
    v_mov_b32 v52, 0
    v_mov_b32 v52, 0
    v_mov_b32 v52, 0
    v_mov_b32 v52, 0
    v_mov_b32 v52, 0
    v_mov_b32 v52, 0
    v_mov_b32 v52, 0
    v_mov_b32 v52, 0
    v_mov_b32 v52, 0
    v_mov_b32 v52, 0
    v_mov_b32 v52, 0
    v_mov_b32 v52, 0
    v_mov_b32 v52, 0
    v_mov_b32 v52, 0
    v_mov_b32 v52, 0
    v_mov_b32 v52, 0
    v_mov_b32 v52, 0
    v_mov_b32 v52, 0
    v_mov_b32 v52, 0
    v_mov_b32 v52, 0
    v_mov_b32 v52, 0
    v_mov_b32 v52, 0
    v_mov_b32 v52, 0
    v_mov_b32 v52, 0
    v_mov_b32 v52, 0
    v_mov_b32 v52, 0
    v_mov_b32 v52, 0
    v_mov_b32 v52, 0
    v_mov_b32 v52, 0
    v_mov_b32 v52, 0
    v_mov_b32 v52, 0
    v_mov_b32 v52, 0
    v_mov_b32 v52, 0
    v_mov_b32 v52, 0
    buffer_load_dwordx4 v[32:35], v117, s[8:11], s29 offen sc1
    buffer_load_dwordx4 v[36:39], v117, s[8:11], s53 offen sc1
    buffer_load_dwordx4 v[40:43], v117, s[8:11], s29 offen offset:2048 sc1
    buffer_load_dwordx4 v[44:47], v117, s[8:11], s53 offen offset:2048 sc1
    v_mov_b32 v52, 0
L_rl_36:
    s_waitcnt vmcnt(7)
    v_mfma_f32_16x16x32_bf16 v[48:51], v[4:7], v[12:15], 0
    v_xor_b32 v52, s33, v4
    s_waitcnt vmcnt(6)
    v_mfma_f32_16x16x32_bf16 v[48:51], v[8:11], v[12:15], v[48:51]
    v_xor_b32 v53, s33, v8
    v_or_b32 v52, v52, v53
    s_waitcnt vmcnt(5)
    v_mfma_f32_16x16x32_bf16 v[48:51], v[16:19], v[12:15], v[48:51]
    v_xor_b32 v53, s33, v16
    v_or_b32 v52, v52, v53
    s_waitcnt vmcnt(4)
    v_mfma_f32_16x16x32_bf16 v[48:51], v[20:23], v[12:15], v[48:51]
    v_xor_b32 v53, s33, v20
    v_or_b32 v52, v52, v53
    v_and_b32 v52, 1, v52
    v_cmp_ne_u32 vcc, 0, v52
    s_cbranch_vccnz L_rslow_37
L_rgo_38:
    s_nop 2
    v_permlane32_swap_b32 v48, v50
    v_permlane32_swap_b32 v49, v51
    v_pk_add_f32 v[48:49], v[48:49], v[50:51]
    s_mov_b64 exec, s[38:39]
    v_cvt_pk_bf16_f32 v12, v48, v49
    v_min_u32 v12, 0xfffffffe, v12
    buffer_store_dword v12, v119, s[8:11], s24 offen
    s_mov_b64 exec, -1
    s_add_u32 s24, s24, 8192
    s_bitset0_b32 s24, 15
    s_xor_b32 s55, s24, 16384
    s_xor_b32 s29, s29, 0x40000
    s_xor_b32 s53, s29, 1024
    s_bfe_u32 s33, s22, 0x10001
    s_waitcnt lgkmcnt(0)
    s_branch L_chain_top2_f
.p2align 6
L_chain_top3_f:
    buffer_load_dwordx4 v[0:3], v117, s[8:11], s23 offen nt
    v_mov_b32 v48, 0
    v_mov_b32 v49, 0
    v_mov_b32 v50, 0
    v_mov_b32 v51, 0
    v_mov_b32 v52, 0
    v_mov_b32 v53, 0
    v_mov_b32 v15, 0
    v_mov_b32 v15, 0
    v_mov_b32 v15, 0
    v_mov_b32 v15, 0
    v_mov_b32 v15, 0
    v_mov_b32 v15, 0
    v_mov_b32 v15, 0
    v_mov_b32 v15, 0
    v_mov_b32 v15, 0
    v_mov_b32 v15, 0
    buffer_load_dwordx4 v[0:3], v117, s[8:11], s23 offen sc1
    s_waitcnt vmcnt(3)
    v_mov_b32 v36, 0
    v_mov_b32 v37, 0
    v_mov_b32 v38, 0
    v_mov_b32 v39, 0
    v_mov_b32 v40, 0
    v_mov_b32 v41, 0
    v_mov_b32 v42, 0
    v_mov_b32 v43, 0
    v_mov_b32 v44, 0
    v_mov_b32 v45, 0
    v_mov_b32 v46, 0
    v_mov_b32 v47, 0
    v_mov_b32 v15, 0
    v_mov_b32 v15, 0
    v_mov_b32 v15, 0
    v_mov_b32 v15, 0
L_mret_39:
    buffer_load_dwordx4 v[0:3], v117, s[8:11], s23 offen sc1
    s_add_u32 s45, s45, 1
    s_cmp_lt_u32 s45, 0x10000
    s_cselect_b32 s56, -2, -1
    s_nop 3
    v_mov_b32 v32, 0
    v_mov_b32 v33, 0
    v_mov_b32 v34, 0
    v_mov_b32 v35, 0
    s_waitcnt vmcnt(2)
    v_max3_u32 v15, v0, v1, v2
    v_max_u32 v15, v15, v3
    v_cmp_lt_u32 vcc, s56, v15
    v_smfmac_f32_16x16x64_bf16 v[32:35], v[0:3], v[80:87], v116
    s_cbranch_vccnz L_mret_39
    ds_write_b128 v117, v[0:3] offset:3072
    v_smfmac_f32_16x16x64_bf16 v[36:39], v[0:3], v[56:63], v116
    buffer_load_dwordx4 v[4:7], v117, s[8:11], s48 offen nt
    v_smfmac_f32_16x16x64_bf16 v[40:43], v[0:3], v[64:71], v116
    buffer_load_dwordx4 v117, s[8:11], s48 offen nt lds
    s_mov_b32 m0, 14336
    v_smfmac_f32_16x16x64_bf16 v[44:47], v[0:3], v[72:79], v116
    s_waitcnt lgkmcnt(0)
    s_barrier
    ds_read_b128 v[8:11], v117 offset:2048
    v_smfmac_f32_16x16x64_bf16 v[48:51], v[0:3], a[192:199], v116
    ds_read_b128 v[16:19], v117 offset:1024
    ds_read_b128 v[20:23], v117
    v_smfmac_f32_16x16x64_bf16 v[52:55], v[0:3], a[200:207], v116
    ds_read_b128 v[80:83], v117 offset:14336
    s_waitcnt lgkmcnt(3)
    v_smfmac_f32_16x16x64_bf16 v[32:35], v[8:11], a[0:7], v116
    ds_read_b128 v[84:87], v117 offset:15360
    v_smfmac_f32_16x16x64_bf16 v[36:39], v[8:11], a[8:15], v116
    ds_read_b128 v[56:59], v117 offset:8192
    s_waitcnt lgkmcnt(4)
    v_smfmac_f32_16x16x64_bf16 v[32:35], v[16:19], a[32:39], v116
    ds_read_b128 v[60:63], v117 offset:9216
    v_smfmac_f32_16x16x64_bf16 v[36:39], v[16:19], a[40:47], v116
    ds_read_b128 v[64:67], v117 offset:10240
    s_waitcnt lgkmcnt(5)
    v_smfmac_f32_16x16x64_bf16 v[32:35], v[20:23], a[64:71], v116
    ds_read_b128 v[68:71], v117 offset:11264
    v_smfmac_f32_16x16x64_bf16 v[36:39], v[20:23], a[72:79], v116
    ds_read_b128 v[72:75], v117 offset:12288
    v_smfmac_f32_16x16x64_bf16 v[40:43], v[8:11], a[96:103], v116
    ds_read_b128 v[76:79], v117 offset:13312
    v_smfmac_f32_16x16x64_bf16 v[40:43], v[16:19], a[128:135], v116
    buffer_store_dwordx4 v[112:115], v117, s[8:11], s32 offen sc1
    v_smfmac_f32_16x16x64_bf16 v[40:43], v[20:23], a[160:167], v116
    s_waitcnt vmcnt(2)
    v_max3_u32 v15, v4, v5, v6
    v_smfmac_f32_16x16x64_bf16 v[44:47], v[8:11], a[104:111], v116
    v_max_u32 v15, v15, v7
    v_smfmac_f32_16x16x64_bf16 v[44:47], v[16:19], a[136:143], v116
    s_waitcnt vmcnt(1) lgkmcnt(0)
    v_cmp_lt_u32 vcc, s56, v15
    v_smfmac_f32_16x16x64_bf16 v[44:47], v[20:23], a[168:175], v116
    s_cbranch_vccnz L_mret_40
L_mgo_41:
    v_smfmac_f32_16x16x64_bf16 v[44:47], v[4:7], v[24:31], v116
    s_barrier
    ds_read_b128 v[12:15], v117 offset:6144
    v_smfmac_f32_16x16x64_bf16 v[32:35], v[4:7], v[88:95], v116
    ds_read_b128 v[24:27], v117 offset:5120
    v_smfmac_f32_16x16x64_bf16 v[36:39], v[4:7], v[96:103], v116
    ds_read_b128 v[28:31], v117 offset:4096
    v_smfmac_f32_16x16x64_bf16 v[40:43], v[4:7], v[104:111], v116
    ds_read_b128 v[88:91], v117 offset:30720
    s_waitcnt lgkmcnt(3)
    v_smfmac_f32_16x16x64_bf16 v[32:35], v[12:15], a[16:23], v116
    ds_read_b128 v[92:95], v117 offset:31744
    s_waitcnt lgkmcnt(3)
    v_smfmac_f32_16x16x64_bf16 v[32:35], v[24:27], a[48:55], v116
    ds_read_b128 v[96:99], v117 offset:23552
    s_waitcnt lgkmcnt(3)
    v_smfmac_f32_16x16x64_bf16 v[32:35], v[28:31], a[80:87], v116
    buffer_load_dwordx4 v117, s[8:11], s30 offen lds
    v_smfmac_f32_16x16x64_bf16 v[36:39], v[12:15], a[24:31], v116
    ds_read_b128 v[100:103], v117 offset:23552
    v_smfmac_f32_16x16x64_bf16 v[36:39], v[24:27], a[56:63], v116
    ds_read_b128 v[104:107], v117 offset:23552
    v_add_f32 v32, v32, v34
    v_smfmac_f32_16x16x64_bf16 v[36:39], v[28:31], a[88:95], v116
    buffer_load_dwordx4 v117, s[8:11], s30 offen offset:1024 lds
    s_add_u32 m0, s52, 0x6000
    v_add_f32 v33, v33, v35
    v_smfmac_f32_16x16x64_bf16 v[40:43], v[12:15], a[112:119], v116
    ds_read_b128 v[108:111], v117 offset:23552
    v_mul_f32 v32, s34, v32
    v_smfmac_f32_16x16x64_bf16 v[40:43], v[24:27], a[144:151], v116
    ds_read_b128 v[0:3], v124
    v_mul_f32 v33, s34, v33
    v_smfmac_f32_16x16x64_bf16 v[40:43], v[28:31], a[176:183], v116
    s_waitcnt lgkmcnt(5)
    buffer_load_dwordx4 v117, s[8:11], s31 offen lds
    v_add_f32 v36, v36, v38
    v_smfmac_f32_16x16x64_bf16 v[48:51], v[4:7], a[208:215], v116
    v_add_f32 v37, v37, v39
    v_smfmac_f32_16x16x64_bf16 v[52:55], v[4:7], a[216:223], v116
    ds_read_b128 v[4:7], v124 offset:1024
    v_mul_f32 v36, s34, v36
    v_smfmac_f32_16x16x64_bf16 v[44:47], v[12:15], a[120:127], v116
    buffer_load_dwordx4 v117, s[8:11], s31 offen offset:1024 lds
    s_mov_b32 m0, 7168
    v_mul_f32 v37, s34, v37
    v_smfmac_f32_16x16x64_bf16 v[44:47], v[24:27], a[152:159], v116
    v_cvt_pk_bf16_f32 v34, v32, v36
    v_smfmac_f32_16x16x64_bf16 v[44:47], v[28:31], a[184:191], v116
    v_cvt_pk_bf16_f32 v35, v33, v37
    v_add_f32 v40, v40, v42
    v_smfmac_f32_16x16x64_bf16 v[48:51], v[8:11], a[224:231], v116
    ds_write2_b32 v120, v34, v35 offset0:32 offset1:48
    v_add_f32 v41, v41, v43
    v_smfmac_f32_16x16x64_bf16 v[52:55], v[8:11], a[232:239], v116
    v_add_f32 v44, v44, v46
    v_add_f32 v45, v45, v47
    v_cvt_pk_bf16_f32 v113, v40, v44
    v_cvt_pk_bf16_f32 v115, v41, v45
    v_smfmac_f32_16x16x64_bf16 v[48:51], v[12:15], a[240:247], v116
    ds_write2_b32 v120, v113, v115 offset0:0 offset1:16
    v_smfmac_f32_16x16x64_bf16 v[52:55], v[12:15], a[248:255], v116
    s_cmp_eq_u32 s22, 63
    s_cbranch_scc1 L_chain_last_f
    v_smfmac_f32_16x16x64_bf16 v[48:51], v[16:19], v[128:135], v116
    v_smfmac_f32_16x16x64_bf16 v[48:51], v[20:23], v[160:167], v116
    buffer_store_dword v126, v119, s[8:11], s55 offen
    v_smfmac_f32_16x16x64_bf16 v[48:51], v[24:27], v[144:151], v116
    s_waitcnt lgkmcnt(0)
    s_barrier
    v_smfmac_f32_16x16x64_bf16 v[48:51], v[28:31], v[176:183], v116
    ds_read_b128 v[32:35], v121 offset:16384
    ds_read_b128 v[36:39], v121 offset:17408
    v_smfmac_f32_16x16x64_bf16 v[52:55], v[16:19], v[136:143], v116
    ds_read_b128 v[40:43], v121 offset:18432
    ds_read_b128 v[44:47], v121 offset:19456
    v_smfmac_f32_16x16x64_bf16 v[52:55], v[20:23], v[168:175], v116
    ds_read_b128 v[8:11], v124 offset:32768
    v_add_f32 v48, v48, v50
    v_smfmac_f32_16x16x64_bf16 v[52:55], v[24:27], v[152:159], v116
    ds_read_b128 v[12:15], v124 offset:33792
    v_add_f32 v49, v49, v51
    v_smfmac_f32_16x16x64_bf16 v[52:55], v[28:31], v[184:191], v116
    s_waitcnt lgkmcnt(5)
    v_cvt_pk_bf16_f32 v112, v48, v49
    v_mfma_f32_16x16x32_bf16 v[56:59], v[56:59], v[32:35], 0
    s_waitcnt lgkmcnt(4)
    v_mov_b32 v48, s50
    v_mov_b32 v49, s50
    v_mfma_f32_16x16x32_bf16 v[56:59], v[60:63], v[36:39], v[56:59]
    ds_read_b128 v[16:19], v124 offset:2048
    s_waitcnt lgkmcnt(4)
    v_mov_b32 v50, s50
    v_mov_b32 v51, s50
    v_mfma_f32_16x16x32_bf16 v[56:59], v[64:67], v[40:43], v[56:59]
    ds_read_b128 v[20:23], v124 offset:3072
    s_waitcnt lgkmcnt(4)
    v_add_f32 v52, v52, v54
    v_mfma_f32_16x16x32_bf16 v[56:59], v[68:71], v[44:47], v[56:59]
    ds_read_b128 v[24:27], v124 offset:4096
    v_add_f32 v53, v53, v55
    v_mfma_f32_16x16x32_bf16 v[60:63], v[72:75], v[32:35], 0
    ds_read_b128 v[28:31], v124 offset:5120
    v_cvt_pk_bf16_f32 v114, v52, v53
    v_mov_b32 v53, 0
    v_mfma_f32_16x16x32_bf16 v[60:63], v[76:79], v[36:39], v[60:63]
    v_exp_f32 v56, v56
    v_mfma_f32_16x16x32_bf16 v[60:63], v[80:83], v[40:43], v[60:63]
    v_exp_f32 v57, v57
    v_mfma_f32_16x16x32_bf16 v[60:63], v[84:87], v[44:47], v[60:63]
    v_exp_f32 v58, v58
    v_mfma_f32_16x16x32_bf16 v[64:67], v[32:35], v[32:35], 0
    v_exp_f32 v59, v59
    v_cvt_pk_bf16_f32 v68, v56, v57
    v_mfma_f32_16x16x32_bf16 v[64:67], v[36:39], v[36:39], v[64:67]
    v_exp_f32 v60, v60
    v_cvt_pk_bf16_f32 v69, v58, v59
    v_mfma_f32_16x16x32_bf16 v[64:67], v[40:43], v[40:43], v[64:67]
    v_exp_f32 v61, v61
    v_mfma_f32_16x16x32_bf16 v[64:67], v[44:47], v[44:47], v[64:67]
    v_exp_f32 v62, v62
    v_exp_f32 v63, v63
    v_cvt_pk_bf16_f32 v70, v60, v61
    v_cvt_pk_bf16_f32 v71, v62, v63
    s_nop 1
    v_mfma_f32_16x16x32_bf16 v[72:75], v[88:91], v[68:71], 0
    s_nop 0
    v_exp_f32 v64, v64
    v_mfma_f32_16x16x32_bf16 v[76:79], v[92:95], v[68:71], 0
    v_exp_f32 v65, v65
    v_mfma_f32_16x16x32_bf16 v[80:83], v[48:51], v[68:71], 0
    v_cvt_pk_bf16_f32 v52, v64, v65
    s_nop 1
    v_mfma_f32_16x16x16_bf16 v[72:75], v[112:113], v[52:53], v[72:75]
    ds_read_b128 v[32:35], v124 offset:6144
    v_mfma_f32_16x16x16_bf16 v[76:79], v[114:115], v[52:53], v[76:79]
    ds_read_b128 v[36:39], v124 offset:7168
    v_mfma_f32_16x16x16_bf16 v[80:83], v[48:49], v[52:53], v[80:83]
L_norm_42:
    s_mov_b64 vcc, s[36:37]
    v_mov_b32 v122, v122
    v_mov_b32 v122, v122
    v_mov_b32 v122, v122
    v_cndmask_b32_dpp v76, v72, v76, vcc quad_perm:[2,3,2,3] row_mask:0xf bank_mask:0xf
    v_cndmask_b32_dpp v77, v73, v77, vcc quad_perm:[2,3,2,3] row_mask:0xf bank_mask:0xf
    v_cndmask_b32_dpp v78, v74, v78, vcc quad_perm:[2,3,2,3] row_mask:0xf bank_mask:0xf
    v_cndmask_b32_dpp v79, v75, v79, vcc quad_perm:[2,3,2,3] row_mask:0xf bank_mask:0xf
    v_rcp_f32_dpp v84, v80 quad_perm:[2,3,2,3] row_mask:0xf bank_mask:0xf
    s_nop 0
    v_pk_mul_f32 v[76:77], v[76:77], v[84:85] op_sel_hi:[1,0]
    v_pk_mul_f32 v[78:79], v[78:79], v[84:85] op_sel_hi:[1,0]
    v_cvt_pk_bf16_f32 v72, v76, v77
    v_cvt_pk_bf16_f32 v73, v78, v79
    ds_write_b64 v122, v[72:73] offset:22016
    v_max_f32_dpp v86, v80, v84 quad_perm:[2,3,2,3] row_mask:0xf bank_mask:0xf
    v_mov_b32_dpp v60, v72 quad_perm:[0,1,0,1] row_mask:0xf bank_mask:0xf
    v_mov_b32_dpp v61, v73 quad_perm:[0,1,0,1] row_mask:0xf bank_mask:0xf
    v_cmp_lt_f32 vcc, s35, v86
    v_mov_b32_dpp v62, v72 quad_perm:[2,3,2,3] row_mask:0xf bank_mask:0xf
    v_mov_b32_dpp v63, v73 quad_perm:[2,3,2,3] row_mask:0xf bank_mask:0xf
    s_nop 1
    v_smfmac_f32_16x16x64_bf16 v[96:99], v[60:63], v[192:199], v116
    s_cbranch_vccnz L_smax_43
    v_smfmac_f32_16x16x64_bf16 v[100:103], v[60:63], v[224:231], v116
    s_waitcnt lgkmcnt(0)
    s_barrier
    ds_read_b128 v[92:95], v127 offset:21504
    ds_read_b128 v[80:83], v127 offset:20992
    ds_read_b128 v[84:87], v127 offset:20480
    v_smfmac_f32_16x16x64_bf16 v[104:107], v[60:63], v[0:7], v116
    ds_read_b128 v[40:43], v124 offset:34816
    v_smfmac_f32_16x16x64_bf16 v[108:111], v[60:63], v[8:15], v116
    ds_read_b128 v[56:59], v124 offset:36864
    s_waitcnt lgkmcnt(4)
    v_smfmac_f32_16x16x64_bf16 v[96:99], v[92:95], v[200:207], v116
    s_waitcnt lgkmcnt(3)
    v_smfmac_f32_16x16x64_bf16 v[96:99], v[80:83], v[208:215], v116
    ds_read_b128 v[44:47], v124 offset:35840
    s_waitcnt lgkmcnt(3)
    v_smfmac_f32_16x16x64_bf16 v[96:99], v[84:87], v[216:223], v116
    ds_read_b128 v[68:71], v124 offset:39936
    v_smfmac_f32_16x16x64_bf16 v[100:103], v[92:95], v[232:239], v116
    ds_read_b128 v[64:67], v124 offset:38912
    v_smfmac_f32_16x16x64_bf16 v[100:103], v[80:83], v[240:247], v116
    ds_read_b128 v[60:63], v124 offset:37888
    v_cvt_pk_bf16_f32 v72, v96, v98
    v_smfmac_f32_16x16x64_bf16 v[100:103], v[84:87], v[248:255], v116
    v_and_or_b32 v72, v72, -2, s33
    v_smfmac_f32_16x16x64_bf16 v[104:107], v[92:95], v[16:23], v116
    v_cvt_pk_bf16_f32 v74, v97, v99
    v_smfmac_f32_16x16x64_bf16 v[104:107], v[80:83], v[24:31], v116
    v_cvt_pk_bf16_f32 v73, v100, v102
    v_cvt_pk_bf16_f32 v75, v101, v103
    v_smfmac_f32_16x16x64_bf16 v[104:107], v[84:87], v[32:39], v116
    buffer_store_dwordx4 v[72:75], v118, s[8:11], s25 offen
    s_waitcnt lgkmcnt(3)
    v_smfmac_f32_16x16x64_bf16 v[108:111], v[92:95], v[40:47], v116
    s_waitcnt lgkmcnt(0)
    v_smfmac_f32_16x16x64_bf16 v[108:111], v[80:83], v[56:63], v116
    v_cvt_pk_bf16_f32 v76, v104, v106
    v_smfmac_f32_16x16x64_bf16 v[108:111], v[84:87], v[64:71], v116
    v_and_or_b32 v76, v76, -2, s33
    v_cvt_pk_bf16_f32 v78, v105, v107
    v_mov_b32 v122, v122
    v_mov_b32 v122, v122
    v_mov_b32 v122, v122
    v_mov_b32 v122, v122
    v_mov_b32 v122, v122
    v_mov_b32 v122, v122
    v_cvt_pk_bf16_f32 v77, v108, v110
    v_cvt_pk_bf16_f32 v79, v109, v111
    buffer_store_dwordx4 v[76:79], v118, s[8:11], s26 offen
    ds_read_b128 v[80:83], v123
    ds_read_b128 v[84:87], v123 offset:1024
    ds_read_b128 v[56:59], v123 offset:2048
    ds_read_b128 v[60:63], v123 offset:3072
    ds_read_b128 v[64:67], v123 offset:32768
    ds_read_b128 v[68:71], v123 offset:33792
    ds_read_b128 v[72:75], v123 offset:34816
    ds_read_b128 v[76:79], v123 offset:35840
    ds_read_b128 v[88:91], v123 offset:4096
    ds_read_b128 v[92:95], v123 offset:5120
    ds_read_b128 v[96:99], v123 offset:6144
    ds_read_b128 v[100:103], v123 offset:7168
    ds_read_b128 v[104:107], v123 offset:36864
    ds_read_b128 v[108:111], v123 offset:37888
    ds_read_b128 v[24:27], v123 offset:38912
    ds_read_b128 v[28:31], v123 offset:39936
    s_add_u32 s30, s30, 0x40000
    s_add_u32 s31, s31, 0x40000
    s_add_u32 s32, s32, 0x20000
    s_add_u32 s23, s24, 3072
    s_add_u32 s48, s23, 4096
    s_xor_b32 s25, s25, 0x40000
    s_xor_b32 s26, s26, 0x40000
    s_mov_b32 s35, 0x49800000
    s_add_u32 s22, s22, 1
    v_cndmask_b32 v12, 0, v125, s[68:69]
    v_cndmask_b32 v13, 0, v125, s[70:71]
    v_cndmask_b32 v14, 0, v125, s[72:73]
    v_cndmask_b32 v15, 0, v125, s[74:75]
    v_mov_b32 v54, 0
    v_mov_b32 v55, 0
    v_mov_b32 v52, 0
    v_mov_b32 v52, 0
    v_mov_b32 v52, 0
    v_mov_b32 v52, 0
    v_mov_b32 v52, 0
    v_mov_b32 v52, 0
    v_mov_b32 v52, 0
    v_mov_b32 v52, 0
    v_mov_b32 v52, 0
    v_mov_b32 v52, 0
    v_mov_b32 v52, 0
    v_mov_b32 v52, 0
    v_mov_b32 v52, 0
    v_mov_b32 v52, 0
    v_mov_b32 v52, 0
    v_mov_b32 v52, 0
    v_mov_b32 v52, 0
    v_mov_b32 v52, 0
    v_mov_b32 v52, 0
    v_mov_b32 v52, 0
    v_mov_b32 v52, 0
    v_mov_b32 v52, 0
    v_mov_b32 v52, 0
    v_mov_b32 v52, 0
    v_mov_b32 v52, 0
    v_mov_b32 v52, 0
    v_mov_b32 v52, 0
    v_mov_b32 v52, 0
    v_mov_b32 v52, 0
    v_mov_b32 v52, 0
    v_mov_b32 v52, 0
    v_mov_b32 v52, 0
    v_mov_b32 v52, 0
    v_mov_b32 v52, 0
    v_mov_b32 v52, 0
    v_mov_b32 v52, 0
    v_mov_b32 v52, 0
    v_mov_b32 v52, 0
    v_mov_b32 v52, 0
    v_mov_b32 v52, 0
    v_mov_b32 v52, 0
    v_mov_b32 v52, 0
    v_mov_b32 v52, 0
    v_mov_b32 v52, 0
    v_mov_b32 v52, 0
    v_mov_b32 v52, 0
    v_mov_b32 v52, 0
    v_mov_b32 v52, 0
    v_mov_b32 v52, 0
    buffer_load_dwordx4 v[4:7], v117, s[8:11], s29 offen nt
    buffer_load_dwordx4 v[8:11], v117, s[8:11], s53 offen nt
    buffer_load_dwordx4 v[16:19], v117, s[8:11], s29 offen offset:2048 nt
    buffer_load_dwordx4 v[20:23], v117, s[8:11], s53 offen offset:2048 nt
    v_mov_b32 v52, 0
    v_mov_b32 v52, 0
    v_mov_b32 v52, 0
    v_mov_b32 v52, 0
    v_mov_b32 v52, 0
    v_mov_b32 v52, 0
    v_mov_b32 v52, 0
    v_mov_b32 v52, 0
    v_mov_b32 v52, 0
    v_mov_b32 v52, 0
    v_mov_b32 v52, 0
    v_mov_b32 v52, 0
    v_mov_b32 v52, 0
    v_mov_b32 v52, 0
    v_mov_b32 v52, 0
    v_mov_b32 v52, 0
    v_mov_b32 v52, 0
    v_mov_b32 v52, 0
    v_mov_b32 v52, 0
    v_mov_b32 v52, 0
    v_mov_b32 v52, 0
    v_mov_b32 v52, 0
    v_mov_b32 v52, 0
    v_mov_b32 v52, 0
    v_mov_b32 v52, 0
    v_mov_b32 v52, 0
    v_mov_b32 v52, 0
    v_mov_b32 v52, 0
    v_mov_b32 v52, 0
    v_mov_b32 v52, 0
    buffer_load_dwordx4 v[32:35], v117, s[8:11], s29 offen sc1
    buffer_load_dwordx4 v[36:39], v117, s[8:11], s53 offen sc1
    buffer_load_dwordx4 v[40:43], v117, s[8:11], s29 offen offset:2048 sc1
    buffer_load_dwordx4 v[44:47], v117, s[8:11], s53 offen offset:2048 sc1
    v_mov_b32 v52, 0
L_rl_44:
    s_waitcnt vmcnt(7)
    v_mfma_f32_16x16x32_bf16 v[48:51], v[4:7], v[12:15], 0
    v_xor_b32 v52, s33, v4
    s_waitcnt vmcnt(6)
    v_mfma_f32_16x16x32_bf16 v[48:51], v[8:11], v[12:15], v[48:51]
    v_xor_b32 v53, s33, v8
    v_or_b32 v52, v52, v53
    s_waitcnt vmcnt(5)
    v_mfma_f32_16x16x32_bf16 v[48:51], v[16:19], v[12:15], v[48:51]
    v_xor_b32 v53, s33, v16
    v_or_b32 v52, v52, v53
    s_waitcnt vmcnt(4)
    v_mfma_f32_16x16x32_bf16 v[48:51], v[20:23], v[12:15], v[48:51]
    v_xor_b32 v53, s33, v20
    v_or_b32 v52, v52, v53
    v_and_b32 v52, 1, v52
    v_cmp_ne_u32 vcc, 0, v52
    s_cbranch_vccnz L_rslow_45
L_rgo_46:
    s_nop 2
    v_permlane32_swap_b32 v48, v50
    v_permlane32_swap_b32 v49, v51
    v_pk_add_f32 v[48:49], v[48:49], v[50:51]
    s_mov_b64 exec, s[38:39]
    v_cvt_pk_bf16_f32 v12, v48, v49
    v_min_u32 v12, 0xfffffffe, v12
    buffer_store_dword v12, v119, s[8:11], s24 offen
    s_mov_b64 exec, -1
    s_add_u32 s24, s24, 8192
    s_bitset0_b32 s24, 15
    s_xor_b32 s55, s24, 16384
    s_xor_b32 s29, s29, 0x40000
    s_xor_b32 s53, s29, 1024
    s_bfe_u32 s33, s22, 0x10001
    s_waitcnt lgkmcnt(0)
    s_branch L_chain_top3_f
L_chain_last_f:
    s_nop 1
    v_smfmac_f32_16x16x64_bf16 v[48:51], v[16:19], v[128:135], v116
    v_smfmac_f32_16x16x64_bf16 v[48:51], v[20:23], v[160:167], v116
    v_smfmac_f32_16x16x64_bf16 v[48:51], v[24:27], v[144:151], v116
    v_smfmac_f32_16x16x64_bf16 v[48:51], v[28:31], v[176:183], v116
    v_smfmac_f32_16x16x64_bf16 v[52:55], v[16:19], v[136:143], v116
    v_smfmac_f32_16x16x64_bf16 v[52:55], v[20:23], v[168:175], v116
    v_smfmac_f32_16x16x64_bf16 v[52:55], v[24:27], v[152:159], v116
    v_smfmac_f32_16x16x64_bf16 v[52:55], v[28:31], v[184:191], v116
    v_add_f32 v48, v48, v50
    v_add_f32 v49, v49, v51
    v_cvt_pk_bf16_f32 v112, v48, v49
    s_nop 4
    v_add_f32 v52, v52, v54
    v_add_f32 v53, v53, v55
    v_cvt_pk_bf16_f32 v114, v52, v53
    s_add_u32 s32, s32, 0x20000
    buffer_store_dwordx4 v[112:115], v117, s[8:11], s32 offen sc1
    v_mov_b32 v94, 64
    s_waitcnt vmcnt(0) lgkmcnt(0)
    s_barrier
    s_mov_b64 exec, 1
    buffer_store_dword v94, off, s[8:11], s44 sc1
    s_mov_b64 exec, -1
    s_endpgm
L_mret_18:
    s_mov_b32 s43, m0
    s_mov_b32 m0, 4096
    buffer_load_dwordx4 v[4:7], v117, s[8:11], s48 offen sc1
    buffer_load_dwordx4 v117, s[8:11], s48 offen sc1 lds
    s_mov_b32 m0, 8192
    s_mov_b32 m0, s43
    s_waitcnt vmcnt(0)
    v_max3_u32 v15, v4, v5, v6
    v_max_u32 v15, v15, v7
    v_cmp_lt_u32 vcc, s56, v15
    s_add_u32 s47, s47, 1
    s_add_u32 s49, s49, 1
    s_cmp_ge_u32 s49, 0x10000
    s_cbranch_scc1 L_mgo_19
    s_cbranch_vccnz L_mret_18
    s_branch L_mgo_19
L_smax_21:
    s_add_u32 s47, s47, 1
    s_mov_b32 s35, 0x7f800000
    s_waitcnt lgkmcnt(0)
    s_sub_u32 s43, s30, 0x40000
    s_add_u32 s40, s43, 4096
    s_nop 7
    buffer_load_dwordx4 v[56:59], v117, s[8:11], s43 offen
    buffer_load_dwordx4 v[60:63], v117, s[8:11], s43 offen offset:1024
    buffer_load_dwordx4 v[64:67], v117, s[8:11], s43 offen offset:2048
    buffer_load_dwordx4 v[68:71], v117, s[8:11], s43 offen offset:3072
    buffer_load_dwordx4 v[72:75], v117, s[8:11], s40 offen
    buffer_load_dwordx4 v[76:79], v117, s[8:11], s40 offen offset:1024
    buffer_load_dwordx4 v[80:83], v117, s[8:11], s40 offen offset:2048
    buffer_load_dwordx4 v[84:87], v117, s[8:11], s40 offen offset:3072
    ds_read_b128 v[32:35], v121 offset:16384
    ds_read_b128 v[36:39], v121 offset:17408
    ds_read_b128 v[40:43], v121 offset:18432
    ds_read_b128 v[44:47], v121 offset:19456
    v_mov_b32 v96, 0
    v_mov_b32 v97, 0
    v_mov_b32 v98, 0
    v_mov_b32 v99, 0
    v_mov_b32 v100, 0
    v_mov_b32 v101, 0
    v_mov_b32 v102, 0
    v_mov_b32 v103, 0
    v_mov_b32 v104, 0
    v_mov_b32 v105, 0
    v_mov_b32 v106, 0
    v_mov_b32 v107, 0
    v_mov_b32 v108, 0
    v_mov_b32 v109, 0
    v_mov_b32 v110, 0
    v_mov_b32 v111, 0
    s_waitcnt vmcnt(0) lgkmcnt(0)
    v_mfma_f32_16x16x32_bf16 v[56:59], v[56:59], v[32:35], 0
    v_mfma_f32_16x16x32_bf16 v[56:59], v[60:63], v[36:39], v[56:59]
    v_mfma_f32_16x16x32_bf16 v[56:59], v[64:67], v[40:43], v[56:59]
    v_mfma_f32_16x16x32_bf16 v[56:59], v[68:71], v[44:47], v[56:59]
    v_mfma_f32_16x16x32_bf16 v[60:63], v[72:75], v[32:35], 0
    v_mfma_f32_16x16x32_bf16 v[60:63], v[76:79], v[36:39], v[60:63]
    v_mfma_f32_16x16x32_bf16 v[60:63], v[80:83], v[40:43], v[60:63]
    v_mfma_f32_16x16x32_bf16 v[60:63], v[84:87], v[44:47], v[60:63]
    v_mfma_f32_16x16x32_bf16 v[64:67], v[32:35], v[32:35], 0
    v_mfma_f32_16x16x32_bf16 v[64:67], v[36:39], v[36:39], v[64:67]
    v_mfma_f32_16x16x32_bf16 v[64:67], v[40:43], v[40:43], v[64:67]
    v_mfma_f32_16x16x32_bf16 v[64:67], v[44:47], v[44:47], v[64:67]
    v_max3_f32 v84, v56, v57, v58
    v_max3_f32 v84, v84, v59, v60
    v_max3_f32 v84, v84, v61, v62
    s_nop 4
    v_max3_f32 v84, v84, v63, v64
    v_max_f32 v84, v84, v65
    v_mov_b32 v85, v84
    s_nop 1
    v_permlane32_swap_b32 v85, v84
    v_max_f32 v84, v85, v84
    v_mov_b32 v85, v84
    s_nop 1
    v_permlane16_swap_b32 v85, v84
    v_max_f32 v84, v85, v84
    v_sub_f32 v56, v56, v84
    v_sub_f32 v57, v57, v84
    v_sub_f32 v58, v58, v84
    v_sub_f32 v59, v59, v84
    v_sub_f32 v60, v60, v84
    v_sub_f32 v61, v61, v84
    v_sub_f32 v62, v62, v84
    v_sub_f32 v63, v63, v84
    v_sub_f32 v64, v64, v84
    v_sub_f32 v65, v65, v84
    v_exp_f32 v56, v56
    v_exp_f32 v57, v57
    v_exp_f32 v58, v58
    v_exp_f32 v59, v59
    v_exp_f32 v60, v60
    v_exp_f32 v61, v61
    v_exp_f32 v62, v62
    v_exp_f32 v63, v63
    v_exp_f32 v64, v64
    v_exp_f32 v65, v65
    v_cvt_pk_bf16_f32 v68, v56, v57
    v_cvt_pk_bf16_f32 v69, v58, v59
    v_cvt_pk_bf16_f32 v70, v60, v61
    v_cvt_pk_bf16_f32 v71, v62, v63
    v_cvt_pk_bf16_f32 v52, v64, v65
    s_nop 0
    v_mfma_f32_16x16x32_bf16 v[72:75], v[88:91], v[68:71], 0
    v_mfma_f32_16x16x32_bf16 v[76:79], v[92:95], v[68:71], 0
    v_mfma_f32_16x16x32_bf16 v[80:83], v[48:51], v[68:71], 0
    v_mfma_f32_16x16x16_bf16 v[72:75], v[112:113], v[52:53], v[72:75]
    v_mfma_f32_16x16x16_bf16 v[76:79], v[114:115], v[52:53], v[76:79]
    v_mfma_f32_16x16x16_bf16 v[80:83], v[48:49], v[52:53], v[80:83]
    ds_read_b128 v[32:35], v124 offset:6144
    ds_read_b128 v[36:39], v124 offset:7168
    ds_read_b128 v[40:43], v124 offset:34816
    ds_read_b128 v[44:47], v124 offset:35840
    ds_read_b128 v[56:59], v124 offset:36864
    ds_read_b128 v[64:67], v124 offset:38912
    ds_read_b128 v[68:71], v124 offset:39936
    s_waitcnt lgkmcnt(0)
    s_branch L_norm_20
L_kvw_22:
    s_add_u32 s47, s47, 1
    s_add_u32 s49, s49, 1
    s_cmp_ge_u32 s49, 0x10000
    s_cbranch_scc1 L_kvb_23
    s_sleep 4
    buffer_load_dword v125, v119, s[8:11], s28 offen sc1
    s_waitcnt vmcnt(0)
    v_cmp_eq_u32 vcc, 0, v125
    s_nop 0
    s_and_b64 vcc, vcc, s[58:59]
    s_cbranch_scc1 L_kvw_22
    s_branch L_kvb_23
L_mret_25:
    s_mov_b32 s43, m0
    s_mov_b32 m0, 5120
    buffer_load_dwordx4 v[4:7], v117, s[8:11], s48 offen sc1
    buffer_load_dwordx4 v117, s[8:11], s48 offen sc1 lds
    s_mov_b32 m0, 10240
    s_mov_b32 m0, s43
    s_waitcnt vmcnt(0)
    v_max3_u32 v15, v4, v5, v6
    v_max_u32 v15, v15, v7
    v_cmp_lt_u32 vcc, s56, v15
    s_add_u32 s47, s47, 1
    s_add_u32 s49, s49, 1
    s_cmp_ge_u32 s49, 0x10000
    s_cbranch_scc1 L_mgo_26
    s_cbranch_vccnz L_mret_25
    s_branch L_mgo_26
L_smax_28:
    s_add_u32 s47, s47, 1
    s_mov_b32 s35, 0x7f800000
    s_waitcnt lgkmcnt(0)
    s_sub_u32 s43, s30, 0x40800
    s_add_u32 s40, s43, 4096
    s_nop 7
    buffer_load_dwordx4 v[56:59], v117, s[8:11], s43 offen
    buffer_load_dwordx4 v[60:63], v117, s[8:11], s43 offen offset:1024
    buffer_load_dwordx4 v[64:67], v117, s[8:11], s43 offen offset:2048
    buffer_load_dwordx4 v[68:71], v117, s[8:11], s43 offen offset:3072
    buffer_load_dwordx4 v[72:75], v117, s[8:11], s40 offen
    buffer_load_dwordx4 v[76:79], v117, s[8:11], s40 offen offset:1024
    buffer_load_dwordx4 v[80:83], v117, s[8:11], s40 offen offset:2048
    buffer_load_dwordx4 v[84:87], v117, s[8:11], s40 offen offset:3072
    ds_read_b128 v[32:35], v121 offset:16384
    ds_read_b128 v[36:39], v121 offset:17408
    ds_read_b128 v[40:43], v121 offset:18432
    ds_read_b128 v[44:47], v121 offset:19456
    v_mov_b32 v96, 0
    v_mov_b32 v97, 0
    v_mov_b32 v98, 0
    v_mov_b32 v99, 0
    v_mov_b32 v100, 0
    v_mov_b32 v101, 0
    v_mov_b32 v102, 0
    v_mov_b32 v103, 0
    v_mov_b32 v104, 0
    v_mov_b32 v105, 0
    v_mov_b32 v106, 0
    v_mov_b32 v107, 0
    v_mov_b32 v108, 0
    v_mov_b32 v109, 0
    v_mov_b32 v110, 0
    v_mov_b32 v111, 0
    s_waitcnt vmcnt(0) lgkmcnt(0)
    v_mfma_f32_16x16x32_bf16 v[56:59], v[56:59], v[32:35], 0
    v_mfma_f32_16x16x32_bf16 v[56:59], v[60:63], v[36:39], v[56:59]
    v_mfma_f32_16x16x32_bf16 v[56:59], v[64:67], v[40:43], v[56:59]
    v_mfma_f32_16x16x32_bf16 v[56:59], v[68:71], v[44:47], v[56:59]
    v_mfma_f32_16x16x32_bf16 v[60:63], v[72:75], v[32:35], 0
    v_mfma_f32_16x16x32_bf16 v[60:63], v[76:79], v[36:39], v[60:63]
    v_mfma_f32_16x16x32_bf16 v[60:63], v[80:83], v[40:43], v[60:63]
    v_mfma_f32_16x16x32_bf16 v[60:63], v[84:87], v[44:47], v[60:63]
    v_mfma_f32_16x16x32_bf16 v[64:67], v[32:35], v[32:35], 0
    v_mfma_f32_16x16x32_bf16 v[64:67], v[36:39], v[36:39], v[64:67]
    v_mfma_f32_16x16x32_bf16 v[64:67], v[40:43], v[40:43], v[64:67]
    v_mfma_f32_16x16x32_bf16 v[64:67], v[44:47], v[44:47], v[64:67]
    v_max3_f32 v84, v56, v57, v58
    v_max3_f32 v84, v84, v59, v60
    v_max3_f32 v84, v84, v61, v62
    s_nop 4
    v_max3_f32 v84, v84, v63, v64
    v_max_f32 v84, v84, v65
    v_mov_b32 v85, v84
    s_nop 1
    v_permlane32_swap_b32 v85, v84
    v_max_f32 v84, v85, v84
    v_mov_b32 v85, v84
    s_nop 1
    v_permlane16_swap_b32 v85, v84
    v_max_f32 v84, v85, v84
    v_sub_f32 v56, v56, v84
    v_sub_f32 v57, v57, v84
    v_sub_f32 v58, v58, v84
    v_sub_f32 v59, v59, v84
    v_sub_f32 v60, v60, v84
    v_sub_f32 v61, v61, v84
    v_sub_f32 v62, v62, v84
    v_sub_f32 v63, v63, v84
    v_sub_f32 v64, v64, v84
    v_sub_f32 v65, v65, v84
    v_exp_f32 v56, v56
    v_exp_f32 v57, v57
    v_exp_f32 v58, v58
    v_exp_f32 v59, v59
    v_exp_f32 v60, v60
    v_exp_f32 v61, v61
    v_exp_f32 v62, v62
    v_exp_f32 v63, v63
    v_exp_f32 v64, v64
    v_exp_f32 v65, v65
    v_cvt_pk_bf16_f32 v68, v56, v57
    v_cvt_pk_bf16_f32 v69, v58, v59
    v_cvt_pk_bf16_f32 v70, v60, v61
    v_cvt_pk_bf16_f32 v71, v62, v63
    v_cvt_pk_bf16_f32 v52, v64, v65
    s_nop 0
    v_mfma_f32_16x16x32_bf16 v[72:75], v[88:91], v[68:71], 0
    v_mfma_f32_16x16x32_bf16 v[76:79], v[92:95], v[68:71], 0
    v_mfma_f32_16x16x32_bf16 v[80:83], v[48:51], v[68:71], 0
    v_mfma_f32_16x16x16_bf16 v[72:75], v[112:113], v[52:53], v[72:75]
    v_mfma_f32_16x16x16_bf16 v[76:79], v[114:115], v[52:53], v[76:79]
    v_mfma_f32_16x16x16_bf16 v[80:83], v[48:49], v[52:53], v[80:83]
    ds_read_b128 v[32:35], v124 offset:6144
    ds_read_b128 v[36:39], v124 offset:7168
    ds_read_b128 v[40:43], v124 offset:34816
    ds_read_b128 v[44:47], v124 offset:35840
    ds_read_b128 v[56:59], v124 offset:36864
    ds_read_b128 v[64:67], v124 offset:38912
    ds_read_b128 v[68:71], v124 offset:39936
    s_waitcnt lgkmcnt(0)
    s_branch L_norm_27
L_kvw_29:
    s_add_u32 s47, s47, 1
    s_add_u32 s49, s49, 1
    s_cmp_ge_u32 s49, 0x10000
    s_cbranch_scc1 L_kvb_30
    s_sleep 4
    buffer_load_dword v125, v119, s[8:11], s28 offen sc1
    s_waitcnt vmcnt(0)
    v_cmp_eq_u32 vcc, 0, v125
    s_nop 0
    s_and_b64 vcc, vcc, s[58:59]
    s_cbranch_scc1 L_kvw_29
    s_branch L_kvb_30
L_mret_32:
    s_mov_b32 s43, m0
    s_mov_b32 m0, 6144
    buffer_load_dwordx4 v[4:7], v117, s[8:11], s48 offen sc1
    buffer_load_dwordx4 v117, s[8:11], s48 offen sc1 lds
    s_mov_b32 m0, 12288
    s_mov_b32 m0, s43
    s_waitcnt vmcnt(0)
    v_max3_u32 v15, v4, v5, v6
    v_max_u32 v15, v15, v7
    v_cmp_lt_u32 vcc, s56, v15
    s_add_u32 s47, s47, 1
    s_add_u32 s49, s49, 1
    s_cmp_ge_u32 s49, 0x10000
    s_cbranch_scc1 L_mgo_33
    s_cbranch_vccnz L_mret_32
    s_branch L_mgo_33
L_smax_35:
    s_add_u32 s47, s47, 1
    s_mov_b32 s35, 0x7f800000
    s_waitcnt lgkmcnt(0)
    s_sub_u32 s43, s30, 0x41000
    s_add_u32 s40, s43, 4096
    s_nop 7
    buffer_load_dwordx4 v[56:59], v117, s[8:11], s43 offen
    buffer_load_dwordx4 v[60:63], v117, s[8:11], s43 offen offset:1024
    buffer_load_dwordx4 v[64:67], v117, s[8:11], s43 offen offset:2048
    buffer_load_dwordx4 v[68:71], v117, s[8:11], s43 offen offset:3072
    buffer_load_dwordx4 v[72:75], v117, s[8:11], s40 offen
    buffer_load_dwordx4 v[76:79], v117, s[8:11], s40 offen offset:1024
    buffer_load_dwordx4 v[80:83], v117, s[8:11], s40 offen offset:2048
    buffer_load_dwordx4 v[84:87], v117, s[8:11], s40 offen offset:3072
    ds_read_b128 v[32:35], v121 offset:16384
    ds_read_b128 v[36:39], v121 offset:17408
    ds_read_b128 v[40:43], v121 offset:18432
    ds_read_b128 v[44:47], v121 offset:19456
    v_mov_b32 v96, 0
    v_mov_b32 v97, 0
    v_mov_b32 v98, 0
    v_mov_b32 v99, 0
    v_mov_b32 v100, 0
    v_mov_b32 v101, 0
    v_mov_b32 v102, 0
    v_mov_b32 v103, 0
    v_mov_b32 v104, 0
    v_mov_b32 v105, 0
    v_mov_b32 v106, 0
    v_mov_b32 v107, 0
    v_mov_b32 v108, 0
    v_mov_b32 v109, 0
    v_mov_b32 v110, 0
    v_mov_b32 v111, 0
    s_waitcnt vmcnt(0) lgkmcnt(0)
    v_mfma_f32_16x16x32_bf16 v[56:59], v[56:59], v[32:35], 0
    v_mfma_f32_16x16x32_bf16 v[56:59], v[60:63], v[36:39], v[56:59]
    v_mfma_f32_16x16x32_bf16 v[56:59], v[64:67], v[40:43], v[56:59]
    v_mfma_f32_16x16x32_bf16 v[56:59], v[68:71], v[44:47], v[56:59]
    v_mfma_f32_16x16x32_bf16 v[60:63], v[72:75], v[32:35], 0
    v_mfma_f32_16x16x32_bf16 v[60:63], v[76:79], v[36:39], v[60:63]
    v_mfma_f32_16x16x32_bf16 v[60:63], v[80:83], v[40:43], v[60:63]
    v_mfma_f32_16x16x32_bf16 v[60:63], v[84:87], v[44:47], v[60:63]
    v_mfma_f32_16x16x32_bf16 v[64:67], v[32:35], v[32:35], 0
    v_mfma_f32_16x16x32_bf16 v[64:67], v[36:39], v[36:39], v[64:67]
    v_mfma_f32_16x16x32_bf16 v[64:67], v[40:43], v[40:43], v[64:67]
    v_mfma_f32_16x16x32_bf16 v[64:67], v[44:47], v[44:47], v[64:67]
    v_max3_f32 v84, v56, v57, v58
    v_max3_f32 v84, v84, v59, v60
    v_max3_f32 v84, v84, v61, v62
    s_nop 4
    v_max3_f32 v84, v84, v63, v64
    v_max_f32 v84, v84, v65
    v_mov_b32 v85, v84
    s_nop 1
    v_permlane32_swap_b32 v85, v84
    v_max_f32 v84, v85, v84
    v_mov_b32 v85, v84
    s_nop 1
    v_permlane16_swap_b32 v85, v84
    v_max_f32 v84, v85, v84
    v_sub_f32 v56, v56, v84
    v_sub_f32 v57, v57, v84
    v_sub_f32 v58, v58, v84
    v_sub_f32 v59, v59, v84
    v_sub_f32 v60, v60, v84
    v_sub_f32 v61, v61, v84
    v_sub_f32 v62, v62, v84
    v_sub_f32 v63, v63, v84
    v_sub_f32 v64, v64, v84
    v_sub_f32 v65, v65, v84
    v_exp_f32 v56, v56
    v_exp_f32 v57, v57
    v_exp_f32 v58, v58
    v_exp_f32 v59, v59
    v_exp_f32 v60, v60
    v_exp_f32 v61, v61
    v_exp_f32 v62, v62
    v_exp_f32 v63, v63
    v_exp_f32 v64, v64
    v_exp_f32 v65, v65
    v_cvt_pk_bf16_f32 v68, v56, v57
    v_cvt_pk_bf16_f32 v69, v58, v59
    v_cvt_pk_bf16_f32 v70, v60, v61
    v_cvt_pk_bf16_f32 v71, v62, v63
    v_cvt_pk_bf16_f32 v52, v64, v65
    s_nop 0
    v_mfma_f32_16x16x32_bf16 v[72:75], v[88:91], v[68:71], 0
    v_mfma_f32_16x16x32_bf16 v[76:79], v[92:95], v[68:71], 0
    v_mfma_f32_16x16x32_bf16 v[80:83], v[48:51], v[68:71], 0
    v_mfma_f32_16x16x16_bf16 v[72:75], v[112:113], v[52:53], v[72:75]
    v_mfma_f32_16x16x16_bf16 v[76:79], v[114:115], v[52:53], v[76:79]
    v_mfma_f32_16x16x16_bf16 v[80:83], v[48:49], v[52:53], v[80:83]
    ds_read_b128 v[32:35], v124 offset:6144
    ds_read_b128 v[36:39], v124 offset:7168
    ds_read_b128 v[40:43], v124 offset:34816
    ds_read_b128 v[44:47], v124 offset:35840
    ds_read_b128 v[56:59], v124 offset:36864
    ds_read_b128 v[64:67], v124 offset:38912
    ds_read_b128 v[68:71], v124 offset:39936
    s_waitcnt lgkmcnt(0)
    s_branch L_norm_34
L_rslow_37:
    buffer_load_dwordx4 v[4:7], v117, s[8:11], s29 offen sc1
    buffer_load_dwordx4 v[8:11], v117, s[8:11], s53 offen sc1
    buffer_load_dwordx4 v[16:19], v117, s[8:11], s29 offen offset:2048 sc1
    buffer_load_dwordx4 v[20:23], v117, s[8:11], s53 offen offset:2048 sc1
    s_add_u32 s46, s46, 1
    s_add_u32 s49, s49, 1
    s_cmp_ge_u32 s49, 0x10000
    s_cbranch_scc1 L_rgo_38
    s_waitcnt vmcnt(7)
    v_mfma_f32_16x16x32_bf16 v[48:51], v[32:35], v[12:15], 0
    v_xor_b32 v52, s33, v32
    s_waitcnt vmcnt(6)
    v_mfma_f32_16x16x32_bf16 v[48:51], v[36:39], v[12:15], v[48:51]
    v_xor_b32 v53, s33, v36
    v_or_b32 v52, v52, v53
    s_waitcnt vmcnt(5)
    v_mfma_f32_16x16x32_bf16 v[48:51], v[40:43], v[12:15], v[48:51]
    v_xor_b32 v53, s33, v40
    v_or_b32 v52, v52, v53
    s_waitcnt vmcnt(4)
    v_mfma_f32_16x16x32_bf16 v[48:51], v[44:47], v[12:15], v[48:51]
    v_xor_b32 v53, s33, v44
    v_or_b32 v52, v52, v53
    v_and_b32 v52, 1, v52
    v_cmp_ne_u32 vcc, 0, v52
    s_cbranch_vccz L_rgo_38
    buffer_load_dwordx4 v[32:35], v117, s[8:11], s29 offen sc1
    buffer_load_dwordx4 v[36:39], v117, s[8:11], s53 offen sc1
    buffer_load_dwordx4 v[40:43], v117, s[8:11], s29 offen offset:2048 sc1
    buffer_load_dwordx4 v[44:47], v117, s[8:11], s53 offen offset:2048 sc1
    s_add_u32 s46, s46, 1
    s_branch L_rl_36
L_mret_40:
    s_mov_b32 s43, m0
    s_mov_b32 m0, 7168
    buffer_load_dwordx4 v[4:7], v117, s[8:11], s48 offen sc1
    buffer_load_dwordx4 v117, s[8:11], s48 offen sc1 lds
    s_mov_b32 m0, 14336
    s_mov_b32 m0, s43
    s_waitcnt vmcnt(0)
    v_max3_u32 v15, v4, v5, v6
    v_max_u32 v15, v15, v7
    v_cmp_lt_u32 vcc, s56, v15
    s_add_u32 s47, s47, 1
    s_add_u32 s49, s49, 1
    s_cmp_ge_u32 s49, 0x10000
    s_cbranch_scc1 L_mgo_41
    s_cbranch_vccnz L_mret_40
    s_branch L_mgo_41
L_smax_43:
    s_add_u32 s47, s47, 1
    s_mov_b32 s35, 0x7f800000
    s_waitcnt lgkmcnt(0)
    s_sub_u32 s43, s30, 0x41800
    s_add_u32 s40, s43, 4096
    s_nop 7
    buffer_load_dwordx4 v[56:59], v117, s[8:11], s43 offen
    buffer_load_dwordx4 v[60:63], v117, s[8:11], s43 offen offset:1024
    buffer_load_dwordx4 v[64:67], v117, s[8:11], s43 offen offset:2048
    buffer_load_dwordx4 v[68:71], v117, s[8:11], s43 offen offset:3072
    buffer_load_dwordx4 v[72:75], v117, s[8:11], s40 offen
    buffer_load_dwordx4 v[76:79], v117, s[8:11], s40 offen offset:1024
    buffer_load_dwordx4 v[80:83], v117, s[8:11], s40 offen offset:2048
    buffer_load_dwordx4 v[84:87], v117, s[8:11], s40 offen offset:3072
    ds_read_b128 v[32:35], v121 offset:16384
    ds_read_b128 v[36:39], v121 offset:17408
    ds_read_b128 v[40:43], v121 offset:18432
    ds_read_b128 v[44:47], v121 offset:19456
    v_mov_b32 v96, 0
    v_mov_b32 v97, 0
    v_mov_b32 v98, 0
    v_mov_b32 v99, 0
    v_mov_b32 v100, 0
    v_mov_b32 v101, 0
    v_mov_b32 v102, 0
    v_mov_b32 v103, 0
    v_mov_b32 v104, 0
    v_mov_b32 v105, 0
    v_mov_b32 v106, 0
    v_mov_b32 v107, 0
    v_mov_b32 v108, 0
    v_mov_b32 v109, 0
    v_mov_b32 v110, 0
    v_mov_b32 v111, 0
    s_waitcnt vmcnt(0) lgkmcnt(0)
    v_mfma_f32_16x16x32_bf16 v[56:59], v[56:59], v[32:35], 0
    v_mfma_f32_16x16x32_bf16 v[56:59], v[60:63], v[36:39], v[56:59]
    v_mfma_f32_16x16x32_bf16 v[56:59], v[64:67], v[40:43], v[56:59]
    v_mfma_f32_16x16x32_bf16 v[56:59], v[68:71], v[44:47], v[56:59]
    v_mfma_f32_16x16x32_bf16 v[60:63], v[72:75], v[32:35], 0
    v_mfma_f32_16x16x32_bf16 v[60:63], v[76:79], v[36:39], v[60:63]
    v_mfma_f32_16x16x32_bf16 v[60:63], v[80:83], v[40:43], v[60:63]
    v_mfma_f32_16x16x32_bf16 v[60:63], v[84:87], v[44:47], v[60:63]
    v_mfma_f32_16x16x32_bf16 v[64:67], v[32:35], v[32:35], 0
    v_mfma_f32_16x16x32_bf16 v[64:67], v[36:39], v[36:39], v[64:67]
    v_mfma_f32_16x16x32_bf16 v[64:67], v[40:43], v[40:43], v[64:67]
    v_mfma_f32_16x16x32_bf16 v[64:67], v[44:47], v[44:47], v[64:67]
    v_max3_f32 v84, v56, v57, v58
    v_max3_f32 v84, v84, v59, v60
    v_max3_f32 v84, v84, v61, v62
    s_nop 4
    v_max3_f32 v84, v84, v63, v64
    v_max_f32 v84, v84, v65
    v_mov_b32 v85, v84
    s_nop 1
    v_permlane32_swap_b32 v85, v84
    v_max_f32 v84, v85, v84
    v_mov_b32 v85, v84
    s_nop 1
    v_permlane16_swap_b32 v85, v84
    v_max_f32 v84, v85, v84
    v_sub_f32 v56, v56, v84
    v_sub_f32 v57, v57, v84
    v_sub_f32 v58, v58, v84
    v_sub_f32 v59, v59, v84
    v_sub_f32 v60, v60, v84
    v_sub_f32 v61, v61, v84
    v_sub_f32 v62, v62, v84
    v_sub_f32 v63, v63, v84
    v_sub_f32 v64, v64, v84
    v_sub_f32 v65, v65, v84
    v_exp_f32 v56, v56
    v_exp_f32 v57, v57
    v_exp_f32 v58, v58
    v_exp_f32 v59, v59
    v_exp_f32 v60, v60
    v_exp_f32 v61, v61
    v_exp_f32 v62, v62
    v_exp_f32 v63, v63
    v_exp_f32 v64, v64
    v_exp_f32 v65, v65
    v_cvt_pk_bf16_f32 v68, v56, v57
    v_cvt_pk_bf16_f32 v69, v58, v59
    v_cvt_pk_bf16_f32 v70, v60, v61
    v_cvt_pk_bf16_f32 v71, v62, v63
    v_cvt_pk_bf16_f32 v52, v64, v65
    s_nop 0
    v_mfma_f32_16x16x32_bf16 v[72:75], v[88:91], v[68:71], 0
    v_mfma_f32_16x16x32_bf16 v[76:79], v[92:95], v[68:71], 0
    v_mfma_f32_16x16x32_bf16 v[80:83], v[48:51], v[68:71], 0
    v_mfma_f32_16x16x16_bf16 v[72:75], v[112:113], v[52:53], v[72:75]
    v_mfma_f32_16x16x16_bf16 v[76:79], v[114:115], v[52:53], v[76:79]
    v_mfma_f32_16x16x16_bf16 v[80:83], v[48:49], v[52:53], v[80:83]
    ds_read_b128 v[32:35], v124 offset:6144
    ds_read_b128 v[36:39], v124 offset:7168
    ds_read_b128 v[40:43], v124 offset:34816
    ds_read_b128 v[44:47], v124 offset:35840
    ds_read_b128 v[56:59], v124 offset:36864
    ds_read_b128 v[64:67], v124 offset:38912
    ds_read_b128 v[68:71], v124 offset:39936
    s_waitcnt lgkmcnt(0)
    s_branch L_norm_42
L_rslow_45:
    buffer_load_dwordx4 v[4:7], v117, s[8:11], s29 offen sc1
    buffer_load_dwordx4 v[8:11], v117, s[8:11], s53 offen sc1
    buffer_load_dwordx4 v[16:19], v117, s[8:11], s29 offen offset:2048 sc1
    buffer_load_dwordx4 v[20:23], v117, s[8:11], s53 offen offset:2048 sc1
    s_add_u32 s46, s46, 1
    s_add_u32 s49, s49, 1
    s_cmp_ge_u32 s49, 0x10000
    s_cbranch_scc1 L_rgo_46
    s_waitcnt vmcnt(7)
    v_mfma_f32_16x16x32_bf16 v[48:51], v[32:35], v[12:15], 0
    v_xor_b32 v52, s33, v32
    s_waitcnt vmcnt(6)
    v_mfma_f32_16x16x32_bf16 v[48:51], v[36:39], v[12:15], v[48:51]
    v_xor_b32 v53, s33, v36
    v_or_b32 v52, v52, v53
    s_waitcnt vmcnt(5)
    v_mfma_f32_16x16x32_bf16 v[48:51], v[40:43], v[12:15], v[48:51]
    v_xor_b32 v53, s33, v40
    v_or_b32 v52, v52, v53
    s_waitcnt vmcnt(4)
    v_mfma_f32_16x16x32_bf16 v[48:51], v[44:47], v[12:15], v[48:51]
    v_xor_b32 v53, s33, v44
    v_or_b32 v52, v52, v53
    v_and_b32 v52, 1, v52
    v_cmp_ne_u32 vcc, 0, v52
    s_cbranch_vccz L_rgo_46
    buffer_load_dwordx4 v[32:35], v117, s[8:11], s29 offen sc1
    buffer_load_dwordx4 v[36:39], v117, s[8:11], s53 offen sc1
    buffer_load_dwordx4 v[40:43], v117, s[8:11], s29 offen offset:2048 sc1
    buffer_load_dwordx4 v[44:47], v117, s[8:11], s53 offen offset:2048 sc1
    s_add_u32 s46, s46, 1
    s_branch L_rl_44
L_zero:
    s_waitcnt lgkmcnt(0)
    s_and_b32 s9, s9, 0xffff
    s_mov_b32 s10, 0x10000000
    s_mov_b32 s11, 0x20000
    s_and_b32 s93, s93, 0xffff
    s_mov_b32 s94, 0x100
    s_mov_b32 s95, 0x20000
    s_mov_b32 s87, 0
    s_cmp_lg_u32 s86, 0
    s_cbranch_scc1 L_reg_47
    s_lshl_b32 s97, s84, 4
    s_lshl_b32 s96, 1, s85
    v_mov_b32 v250, s96
    v_mov_b32 v251, 256
    s_mov_b64 exec, 1
    buffer_atomic_add_x2 v[250:251], off, s[92:95], s97 offset:64
    s_mov_b64 exec, -1
    s_mov_b32 s86, 1
L_reg_47:
    v_mov_b32 v4, 0
    v_mov_b32 v5, 0
    v_mov_b32 v6, 0
    v_mov_b32 v7, 0
    v_lshlrev_b32 v1, 4, v0
    s_mov_b32 s97, 0x0
    buffer_store_dwordx4 v[4:7], v1, s[8:11], s97 offen sc1
    s_mov_b32 s97, 0x1000
    buffer_store_dwordx4 v[4:7], v1, s[8:11], s97 offen sc1
    s_mov_b32 s97, 0x2000
    buffer_store_dwordx4 v[4:7], v1, s[8:11], s97 offen sc1
    s_mov_b32 s97, 0x3000
    buffer_store_dwordx4 v[4:7], v1, s[8:11], s97 offen sc1
    s_mov_b32 s97, 0x4000
    buffer_store_dwordx4 v[4:7], v1, s[8:11], s97 offen sc1
    s_mov_b32 s97, 0x5000
    buffer_store_dwordx4 v[4:7], v1, s[8:11], s97 offen sc1
    s_mov_b32 s97, 0x6000
    buffer_store_dwordx4 v[4:7], v1, s[8:11], s97 offen sc1
    s_mov_b32 s97, 0x7000
    buffer_store_dwordx4 v[4:7], v1, s[8:11], s97 offen sc1
    s_mov_b32 s97, 0x8000
    buffer_store_dwordx4 v[4:7], v1, s[8:11], s97 offen sc1
    s_waitcnt vmcnt(0)
    s_barrier
    s_cmp_lg_u32 s100, 0
    s_cbranch_scc1 L_flag_48
    v_mov_b32 v2, 1
    s_mov_b64 exec, 1
    buffer_store_dword v2, off, s[92:95], 40 sc1
    s_mov_b64 exec, -1
L_flag_48:
    s_cmp_lg_u32 s100, 0
    s_cbranch_scc1 L_noz
    s_mov_b64 exec, 0xff
    s_mov_b32 s96, 0
L_count:
    buffer_load_dwordx2 v[2:3], v1, s[92:95], 0 offen offset:64 sc1
    s_waitcnt vmcnt(0)
    v_cmp_le_u32 vcc, 8192, v3
    v_add_u32 v2, 1, v2
    v_xor_b32 v3, 8192, v3
    v_or_b32 v2, v2, v3
    s_mov_b32 s4, vcc_lo
    v_cmp_eq_u32 vcc, 0, v2
    v_mov_b32 v2, 1
    s_nop 1
    s_cmp_eq_u32 vcc_lo, 0xff
    s_cbranch_scc1 L_propose
    v_mov_b32 v2, 2
    s_andn2_b32 s4, s4, vcc_lo
    s_cbranch_scc1 L_propose
    s_sleep 2
    s_add_u32 s96, s96, 1
    s_cmp_lt_u32 s96, 0x100
    s_cbranch_scc1 L_count
L_propose:
    v_mov_b32 v3, 0
    s_mov_b64 exec, 1
    buffer_atomic_cmpswap v[2:3], off, s[92:95], 0 offset:36
    s_mov_b64 exec, -1
    s_branch L_noz
L_fallback:
    s_mov_b32 s87, 2
    s_waitcnt vmcnt(0) lgkmcnt(0)
    s_barrier
    v_mbcnt_lo_u32_b32 v0, -1, 0
    v_mbcnt_hi_u32_b32 v0, -1, v0
    s_lshl_b32 s96, s100, 6
    v_add_u32 v0, s96, v0
    s_mov_b32 s97, 44
    s_cmp_lg_u32 s100, 0
    s_cbranch_scc1 L_at_49
    s_mov_b64 exec, 1
    v_mov_b32 v2, 1
    buffer_atomic_add v2, off, s[92:95], s97 sc0
    s_mov_b64 exec, -1
L_at_49:
    s_cmp_lg_u32 s100, 0
    s_cbranch_scc1 L_at2_50
    s_mov_b64 exec, 1
    v_mov_b32 v1, 8
    s_waitcnt vmcnt(0)
    ds_write_b32 v1, v2
    s_waitcnt lgkmcnt(0)
    s_mov_b64 exec, -1
L_at2_50:
    s_barrier
    v_mov_b32 v1, 8
    ds_read_b32 v2, v1
    s_waitcnt lgkmcnt(0)
    v_readfirstlane_b32 s85, v2
    s_barrier
    s_sub_u32 s101, s85, 32
    s_cmp_ge_u32 s85, 32
    s_cbranch_scc1 L_bulk
    s_mov_b32 s20, s85
    v_lshrrev_b32 v4, 6, v0
    s_nop 0
    v_readfirstlane_b32 s21, v4
    v_and_b32 v1, 63, v0
    v_lshrrev_b32 v2, 4, v1
    v_and_b32 v3, 15, v1
    v_lshrrev_b32 v6, 2, v3
    v_lshlrev_b32 v117, 4, v1
    s_lshl_b32 s51, s21, 10
    s_lshl_b32 s52, s21, 11
    s_load_dwordx8 s[60:67], s[0:1], 16
    s_mov_b32 s14, 0x400000
    s_mov_b32 s15, 0x20000
    s_lshl_b32 s41, s20, 8
    s_lshl_b32 s42, s20, 17
    s_lshr_b32 s43, s21, 1
    s_lshl_b32 s43, s43, 2
    v_or_b32 v5, s43, v2
    v_lshlrev_b32 v5, 1, v5
    v_xor_b32 v5, v5, v3
    v_lshrrev_b32 v14, 2, v5
    v_and_b32 v14, 2, v14
    v_lshlrev_b32 v5, 4, v5
    s_lshl_b32 s43, s21, 4
    v_add_u32 v4, s43, v2
    v_lshl_add_u32 v8, v4, 13, v5
    s_waitcnt lgkmcnt(0)
    s_mov_b32 s16, s92
    s_mov_b32 s17, s93
    s_mov_b32 s18, s94
    s_mov_b32 s19, s95
    s_mov_b32 s88, s20
    s_mov_b32 s12, s60
    s_and_b32 s13, s61, 0xffff
    v_xor_b32 v15, 0, v14
    v_lshl_add_u32 v15, v15, 15, v8
    s_add_u32 s43, s41, 0x0
    s_add_u32 m0, s51, 0x8000
    s_nop 0
    buffer_load_dwordx4 v15, s[12:15], s43 offen lds
    s_add_u32 s43, s41, 0x8000
    s_add_u32 m0, s51, 0x9000
    s_nop 0
    buffer_load_dwordx4 v15, s[12:15], s43 offen lds
    s_add_u32 s43, s41, 0x100000
    s_add_u32 m0, s51, 0xa000
    s_nop 0
    buffer_load_dwordx4 v15, s[12:15], s43 offen lds
    s_add_u32 s43, s41, 0x108000
    s_add_u32 m0, s51, 0xb000
    s_nop 0
    buffer_load_dwordx4 v15, s[12:15], s43 offen lds
    s_add_u32 s43, s41, 0x200000
    s_add_u32 m0, s51, 0xc000
    s_nop 0
    buffer_load_dwordx4 v15, s[12:15], s43 offen lds
    s_add_u32 s43, s41, 0x208000
    s_add_u32 m0, s51, 0xd000
    s_nop 0
    buffer_load_dwordx4 v15, s[12:15], s43 offen lds
    s_add_u32 s43, s41, 0x300000
    s_add_u32 m0, s51, 0xe000
    s_nop 0
    buffer_load_dwordx4 v15, s[12:15], s43 offen lds
    s_add_u32 s43, s41, 0x308000
    s_add_u32 m0, s51, 0xf000
    s_nop 0
    buffer_load_dwordx4 v15, s[12:15], s43 offen lds
    v_xor_b32 v15, 2, v14
    v_lshl_add_u32 v15, v15, 15, v8
    s_add_u32 s43, s41, 0x0
    s_add_u32 m0, s51, 0x10000
    s_nop 0
    buffer_load_dwordx4 v15, s[12:15], s43 offen lds
    s_add_u32 s43, s41, 0x8000
    s_add_u32 m0, s51, 0x11000
    s_nop 0
    buffer_load_dwordx4 v15, s[12:15], s43 offen lds
    s_add_u32 s43, s41, 0x100000
    s_add_u32 m0, s51, 0x12000
    s_nop 0
    buffer_load_dwordx4 v15, s[12:15], s43 offen lds
    s_add_u32 s43, s41, 0x108000
    s_add_u32 m0, s51, 0x13000
    s_nop 0
    buffer_load_dwordx4 v15, s[12:15], s43 offen lds
    s_add_u32 s43, s41, 0x200000
    s_add_u32 m0, s51, 0x14000
    s_nop 0
    buffer_load_dwordx4 v15, s[12:15], s43 offen lds
    s_add_u32 s43, s41, 0x208000
    s_add_u32 m0, s51, 0x15000
    s_nop 0
    buffer_load_dwordx4 v15, s[12:15], s43 offen lds
    s_add_u32 s43, s41, 0x300000
    s_add_u32 m0, s51, 0x16000
    s_nop 0
    buffer_load_dwordx4 v15, s[12:15], s43 offen lds
    s_add_u32 s43, s41, 0x308000
    s_add_u32 m0, s51, 0x17000
    s_nop 0
    buffer_load_dwordx4 v15, s[12:15], s43 offen lds
    v_xor_b32 v15, 0, v14
    v_lshl_add_u32 v15, v15, 15, v8
    s_add_u32 s43, s41, 0x80000
    s_add_u32 m0, s51, 0x18000
    s_nop 0
    buffer_load_dwordx4 v15, s[12:15], s43 offen lds
    s_add_u32 s43, s41, 0x88000
    s_add_u32 m0, s51, 0x19000
    s_nop 0
    buffer_load_dwordx4 v15, s[12:15], s43 offen lds
    s_add_u32 s43, s41, 0x180000
    s_add_u32 m0, s51, 0x1a000
    s_nop 0
    buffer_load_dwordx4 v15, s[12:15], s43 offen lds
    s_add_u32 s43, s41, 0x188000
    s_add_u32 m0, s51, 0x1b000
    s_nop 0
    buffer_load_dwordx4 v15, s[12:15], s43 offen lds
    v_and_b32 v4, 2, v3
    v_cmp_ne_u32 vcc, 0, v4
    v_mov_b32 v4, 0x4444
    v_mov_b32 v5, 0xeeee
    v_cndmask_b32 v116, v4, v5, vcc
    v_lshrrev_b32 v5, 1, v2
    v_lshl_add_u32 v4, v6, 3, v5
    s_lshl_b32 s43, s21, 1
    v_add_u32 v4, s43, v4
    v_add_u32 v5, s20, v4
    v_and_b32 v5, 31, v5
    v_lshl_add_u32 v4, v4, 6, v5
    v_and_b32 v5, 1, v2
    v_lshl_add_u32 v4, v4, 1, v5
    v_and_b32 v5, 3, v3
    v_lshl_add_u32 v4, v4, 2, v5
    v_lshlrev_b32 v118, 4, v4
    v_and_b32 v4, 1, v2
    v_lshlrev_b32 v4, 2, v4
    v_and_b32 v7, 2, v2
    v_add_u32 v4, v4, v7
    v_and_b32 v7, 1, v6
    v_add_u32 v4, v4, v7
    v_lshl_add_u32 v4, v4, 2, v5
    v_lshlrev_b32 v4, 2, v4
    s_and_b32 s43, s21, 1
    s_lshl_b32 s43, s43, 12
    s_lshl_b32 s40, s20, 7
    s_add_u32 s43, s43, s40
    v_add_u32 v119, s43, v4
    v_sub_u32 v7, 0, v2
    v_and_b32 v7, 3, v7
    v_xor_b32 v7, v7, v6
    v_lshl_add_u32 v4, v2, 4, v7
    v_and_b32 v5, 3, v3
    v_lshl_add_u32 v4, v4, 2, v5
    s_add_u32 s43, s51, 16384
    v_lshl_add_u32 v120, v4, 2, s43
    v_sub_u32 v7, 0, v6
    v_and_b32 v7, 3, v7
    v_xor_b32 v7, v7, v2
    v_lshl_add_u32 v4, v3, 2, v7
    v_lshlrev_b32 v121, 4, v4
    v_and_b32 v5, 1, v3
    v_lshl_add_u32 v4, v6, 1, v5
    v_lshl_add_u32 v4, v2, 3, v4
    v_lshlrev_b32 v127, 4, v4
    v_and_or_b32 v122, v116, 8, v127
    s_lshl_b32 s43, s21, 13
    s_add_u32 s43, s43, 32768
    v_add_u32 v123, s43, v117
    v_add_u32 v124, 0x10000, v123
    s_mov_b32 s36, 0xcccccccc
    s_mov_b32 s37, 0xcccccccc
    s_mov_b32 s38, 0x00ff00ff
    s_mov_b32 s39, 0x00ff00ff
    s_mov_b32 s34, 0x3e0293ee
    s_mov_b32 s35, 0x49800000
    s_mov_b32 s50, 0x3f803f80
    v_and_b32 v5, 1, v2
    v_or_b32 v5, 0, v5
    v_xor_b32 v5, v5, v6
    v_and_b32 v7, 2, v5
    v_add_u32 v5, v5, v7
    v_lshlrev_b32 v5, 6, v5
    v_and_b32 v7, 3, v3
    v_lshl_add_u32 v7, v7, 4, v5
    s_lshl_b32 s43, s21, 2
    v_add_u32 v4, s43, v2
    v_lshl_add_u32 v10, v4, 10, v7
    v_and_b32 v5, 1, v2
    v_or_b32 v5, 2, v5
    v_xor_b32 v5, v5, v6
    v_and_b32 v7, 2, v5
    v_add_u32 v5, v5, v7
    v_lshlrev_b32 v5, 6, v5
    v_and_b32 v7, 3, v3
    v_lshl_add_u32 v7, v7, 4, v5
    s_lshl_b32 s43, s21, 2
    v_add_u32 v4, s43, v2
    v_lshl_add_u32 v9, v4, 10, v7
    v_and_b32 v5, 1, v2
    v_lshl_add_u32 v4, v5, 3, v6
    v_lshrrev_b32 v7, 1, v2
    v_lshl_add_u32 v4, v7, 5, v4
    v_lshlrev_b32 v4, 8, v4
    v_lshl_or_b32 v5, v5, 2, v6
    v_lshlrev_b32 v5, 5, v5
    s_lshl_b32 s43, s21, 6
    v_xor_b32 v5, s43, v5
    v_add_u32 v4, v4, v5
    v_and_b32 v5, 3, v3
    v_lshl_add_u32 v4, v5, 3, v4
    v_add_u32 v11, 32768, v4
    s_and_b32 s43, s21, 1
    s_lshl_b32 s43, s43, 12
    v_add_u32 v11, s43, v11
    v_and_b32 v5, 1, v2
    v_lshlrev_b32 v4, 4, v5
    v_lshl_add_u32 v4, v7, 2, v4
    v_and_b32 v7, 1, v6
    v_add_u32 v4, v4, v7
    s_lshl_b32 s43, s21, 5
    v_add_u32 v4, s43, v4
    v_lshlrev_b32 v4, 8, v4
    v_lshl_or_b32 v5, v5, 1, v7
    s_lshl_b32 s43, s21, 1
    s_and_b32 s43, s43, 3
    v_xor_b32 v5, s43, v5
    v_lshl_add_u32 v4, v5, 6, v4
    v_lshrrev_b32 v5, 1, v6
    v_lshl_add_u32 v4, v5, 5, v4
    v_and_b32 v5, 3, v3
    v_lshl_add_u32 v4, v5, 3, v4
    v_add_u32 v12, 32768, v4
    v_mov_b32 v16, -1
    v_mov_b32 v17, -1
    v_mov_b32 v18, -1
    v_mov_b32 v19, -1
    s_lshl_b32 s43, s20, 13
    s_add_u32 s43, s43, 0x7100000
    s_and_b32 s40, s21, 1
    s_lshl_b32 s40, s40, 12
    s_add_u32 s29, s43, s40
    s_add_u32 s43, s43, s52
    s_xor_b32 s40, s43, 0x40000
    buffer_store_dwordx4 v[16:19], v117, s[8:11], s43 offen sc1
    buffer_store_dwordx4 v[16:19], v117, s[8:11], s43 offen offset:1024 sc1
    buffer_store_dwordx4 v[16:19], v117, s[8:11], s40 offen sc1
    buffer_store_dwordx4 v[16:19], v117, s[8:11], s40 offen offset:1024 sc1
    s_mov_b32 s43, 0x7012000
    buffer_store_dword v16, v119, s[8:11], s43 offen sc1
    s_mov_b32 s43, 0x7014000
    buffer_store_dword v16, v119, s[8:11], s43 offen sc1
    s_mov_b32 s43, 0x7016000
    buffer_store_dword v16, v119, s[8:11], s43 offen sc1
    s_load_dwordx2 s[4:5], s[0:1], 8
    s_waitcnt lgkmcnt(0)
    s_and_b32 s5, s5, 0xffff
    s_mov_b32 s6, 8192
    s_mov_b32 s7, 0x20000
    v_and_b32 v20, 1, v2
    v_and_b32 v21, 1, v6
    v_lshl_add_u32 v20, v20, 1, v21
    v_lshlrev_b32 v20, 9, v20
    v_and_b32 v21, 3, v3
    v_lshl_add_u32 v20, v21, 4, v20
    v_and_b32 v21, 2, v2
    v_add_u32 v20, v20, v21
    s_and_b32 s43, s20, 1
    s_lshl_b32 s43, s43, 11
    s_bfe_u32 s40, s20, 0x20001
    s_lshl_b32 s40, s40, 7
    s_add_u32 s43, s43, s40
    s_and_b32 s40, s21, 1
    s_lshl_b32 s40, s40, 6
    s_add_u32 s43, s43, s40
    s_lshr_b32 s40, s20, 3
    s_lshl_b32 s40, s40, 2
    s_add_u32 s43, s43, s40
    v_add_u32 v20, s43, v20
    v_lshlrev_b32 v20, 1, v20
    buffer_load_dword v21, v20, s[4:7], 0 offen
    s_mov_b32 s57, 0
    s_lshl_b32 s43, s20, 13
    s_add_u32 s43, s43, s52
    s_add_u32 s30, s43, 0x1000000
    s_add_u32 s31, s43, 0x2000000
    s_lshr_b32 s43, s43, 1
    s_add_u32 s32, s43, 0x220000
    s_waitcnt vmcnt(20)
    s_barrier
    v_xor_b32 v13, 0x0, v11
    v_add_u32 v13, 0x0, v13
    ds_read_b64_tr_b16 v[32:33], v13
    ds_read_b64_tr_b16 v[34:35], v13 offset:1024
    ds_read_b64_tr_b16 v[36:37], v13 offset:16384
    ds_read_b64_tr_b16 v[38:39], v13 offset:17408
    v_xor_b32 v13, 0x20, v11
    v_add_u32 v13, 0x0, v13
    ds_read_b64_tr_b16 v[40:41], v13
    ds_read_b64_tr_b16 v[42:43], v13 offset:1024
    ds_read_b64_tr_b16 v[44:45], v13 offset:16384
    ds_read_b64_tr_b16 v[46:47], v13 offset:17408
    v_xor_b32 v13, 0x1000, v11
    v_add_u32 v13, 0x0, v13
    ds_read_b64_tr_b16 a[0:1], v13
    ds_read_b64_tr_b16 a[2:3], v13 offset:1024
    ds_read_b64_tr_b16 a[4:5], v13 offset:16384
    ds_read_b64_tr_b16 a[6:7], v13 offset:17408
    v_xor_b32 v13, 0x1020, v11
    v_add_u32 v13, 0x0, v13
    ds_read_b64_tr_b16 a[8:9], v13
    ds_read_b64_tr_b16 a[10:11], v13 offset:1024
    ds_read_b64_tr_b16 a[12:13], v13 offset:16384
    ds_read_b64_tr_b16 a[14:15], v13 offset:17408
    s_waitcnt lgkmcnt(0)
    s_barrier
    s_add_u32 s43, s41, 0x280000
    s_add_u32 m0, s51, 0x1c000
    s_nop 0
    buffer_load_dwordx4 v15, s[12:15], s43 offen lds
    s_add_u32 s43, s41, 0x288000
    s_add_u32 m0, s51, 0x1d000
    s_nop 0
    buffer_load_dwordx4 v15, s[12:15], s43 offen lds
    s_add_u32 s43, s41, 0x380000
    s_add_u32 m0, s51, 0x1e000
    s_nop 0
    buffer_load_dwordx4 v15, s[12:15], s43 offen lds
    s_add_u32 s43, s41, 0x388000
    s_add_u32 m0, s51, 0x1f000
    s_nop 0
    buffer_load_dwordx4 v15, s[12:15], s43 offen lds
    v_xor_b32 v15, 2, v14
    v_lshl_add_u32 v15, v15, 15, v8
    s_add_u32 s43, s41, 0x80000
    s_add_u32 m0, s51, 0x20000
    s_nop 0
    buffer_load_dwordx4 v15, s[12:15], s43 offen lds
    s_add_u32 s43, s41, 0x88000
    s_add_u32 m0, s51, 0x21000
    s_nop 0
    buffer_load_dwordx4 v15, s[12:15], s43 offen lds
    s_add_u32 s43, s41, 0x180000
    s_add_u32 m0, s51, 0x22000
    s_nop 0
    buffer_load_dwordx4 v15, s[12:15], s43 offen lds
    s_add_u32 s43, s41, 0x188000
    s_add_u32 m0, s51, 0x23000
    s_nop 0
    buffer_load_dwordx4 v15, s[12:15], s43 offen lds
    s_waitcnt vmcnt(20)
    s_barrier
    v_xor_b32 v13, 0x0, v11
    v_add_u32 v13, 0x8000, v13
    ds_read_b64_tr_b16 a[32:33], v13
    ds_read_b64_tr_b16 a[34:35], v13 offset:1024
    ds_read_b64_tr_b16 a[36:37], v13 offset:16384
    ds_read_b64_tr_b16 a[38:39], v13 offset:17408
    v_xor_b32 v13, 0x20, v11
    v_add_u32 v13, 0x8000, v13
    ds_read_b64_tr_b16 a[40:41], v13
    ds_read_b64_tr_b16 a[42:43], v13 offset:1024
    ds_read_b64_tr_b16 a[44:45], v13 offset:16384
    ds_read_b64_tr_b16 a[46:47], v13 offset:17408
    v_xor_b32 v13, 0x1000, v11
    v_add_u32 v13, 0x8000, v13
    ds_read_b64_tr_b16 a[64:65], v13
    ds_read_b64_tr_b16 a[66:67], v13 offset:1024
    ds_read_b64_tr_b16 a[68:69], v13 offset:16384
    ds_read_b64_tr_b16 a[70:71], v13 offset:17408
    v_xor_b32 v13, 0x1020, v11
    v_add_u32 v13, 0x8000, v13
    ds_read_b64_tr_b16 a[72:73], v13
    ds_read_b64_tr_b16 a[74:75], v13 offset:1024
    ds_read_b64_tr_b16 a[76:77], v13 offset:16384
    ds_read_b64_tr_b16 a[78:79], v13 offset:17408
    s_waitcnt lgkmcnt(0)
    s_barrier
    s_add_u32 s43, s41, 0x280000
    s_add_u32 m0, s51, 0x24000
    s_nop 0
    buffer_load_dwordx4 v15, s[12:15], s43 offen lds
    s_add_u32 s43, s41, 0x288000
    s_add_u32 m0, s51, 0x25000
    s_nop 0
    buffer_load_dwordx4 v15, s[12:15], s43 offen lds
    s_add_u32 s43, s41, 0x380000
    s_add_u32 m0, s51, 0x26000
    s_nop 0
    buffer_load_dwordx4 v15, s[12:15], s43 offen lds
    s_add_u32 s43, s41, 0x388000
    s_add_u32 m0, s51, 0x27000
    s_nop 0
    buffer_load_dwordx4 v15, s[12:15], s43 offen lds
    s_mov_b32 s12, s62
    s_and_b32 s13, s63, 0xffff
    v_xor_b32 v15, 0, v14
    v_lshl_add_u32 v15, v15, 15, v8
    s_add_u32 s43, s41, 0x0
    s_add_u32 m0, s51, 0x8000
    s_nop 0
    buffer_load_dwordx4 v15, s[12:15], s43 offen lds
    s_add_u32 s43, s41, 0x8000
    s_add_u32 m0, s51, 0x9000
    s_nop 0
    buffer_load_dwordx4 v15, s[12:15], s43 offen lds
    s_add_u32 s43, s41, 0x100000
    s_add_u32 m0, s51, 0xa000
    s_nop 0
    buffer_load_dwordx4 v15, s[12:15], s43 offen lds
    s_add_u32 s43, s41, 0x108000
    s_add_u32 m0, s51, 0xb000
    s_nop 0
    buffer_load_dwordx4 v15, s[12:15], s43 offen lds
    s_waitcnt vmcnt(12)
    s_barrier
    v_xor_b32 v13, 0x0, v11
    v_add_u32 v13, 0x10000, v13
    ds_read_b64_tr_b16 v[48:49], v13
    ds_read_b64_tr_b16 v[50:51], v13 offset:1024
    ds_read_b64_tr_b16 v[52:53], v13 offset:16384
    ds_read_b64_tr_b16 v[54:55], v13 offset:17408
    v_xor_b32 v13, 0x20, v11
    v_add_u32 v13, 0x10000, v13
    ds_read_b64_tr_b16 v[56:57], v13
    ds_read_b64_tr_b16 v[58:59], v13 offset:1024
    ds_read_b64_tr_b16 v[60:61], v13 offset:16384
    ds_read_b64_tr_b16 v[62:63], v13 offset:17408
    v_xor_b32 v13, 0x1000, v11
    v_add_u32 v13, 0x10000, v13
    ds_read_b64_tr_b16 a[16:17], v13
    ds_read_b64_tr_b16 a[18:19], v13 offset:1024
    ds_read_b64_tr_b16 a[20:21], v13 offset:16384
    ds_read_b64_tr_b16 a[22:23], v13 offset:17408
    v_xor_b32 v13, 0x1020, v11
    v_add_u32 v13, 0x10000, v13
    ds_read_b64_tr_b16 a[24:25], v13
    ds_read_b64_tr_b16 a[26:27], v13 offset:1024
    ds_read_b64_tr_b16 a[28:29], v13 offset:16384
    ds_read_b64_tr_b16 a[30:31], v13 offset:17408
    s_waitcnt lgkmcnt(0)
    s_barrier
    s_add_u32 s43, s41, 0x200000
    s_add_u32 m0, s51, 0xc000
    s_nop 0
    buffer_load_dwordx4 v15, s[12:15], s43 offen lds
    s_add_u32 s43, s41, 0x208000
    s_add_u32 m0, s51, 0xd000
    s_nop 0
    buffer_load_dwordx4 v15, s[12:15], s43 offen lds
    s_add_u32 s43, s41, 0x300000
    s_add_u32 m0, s51, 0xe000
    s_nop 0
    buffer_load_dwordx4 v15, s[12:15], s43 offen lds
    s_add_u32 s43, s41, 0x308000
    s_add_u32 m0, s51, 0xf000
    s_nop 0
    buffer_load_dwordx4 v15, s[12:15], s43 offen lds
    v_xor_b32 v15, 2, v14
    v_lshl_add_u32 v15, v15, 15, v8
    s_add_u32 s43, s41, 0x0
    s_add_u32 m0, s51, 0x10000
    s_nop 0
    buffer_load_dwordx4 v15, s[12:15], s43 offen lds
    s_add_u32 s43, s41, 0x8000
    s_add_u32 m0, s51, 0x11000
    s_nop 0
    buffer_load_dwordx4 v15, s[12:15], s43 offen lds
    s_add_u32 s43, s41, 0x100000
    s_add_u32 m0, s51, 0x12000
    s_nop 0
    buffer_load_dwordx4 v15, s[12:15], s43 offen lds
    s_add_u32 s43, s41, 0x108000
    s_add_u32 m0, s51, 0x13000
    s_nop 0
    buffer_load_dwordx4 v15, s[12:15], s43 offen lds
    s_waitcnt vmcnt(12)
    s_barrier
    v_xor_b32 v13, 0x0, v11
    v_add_u32 v13, 0x18000, v13
    ds_read_b64_tr_b16 a[48:49], v13
    ds_read_b64_tr_b16 a[50:51], v13 offset:1024
    ds_read_b64_tr_b16 a[52:53], v13 offset:16384
    ds_read_b64_tr_b16 a[54:55], v13 offset:17408
    v_xor_b32 v13, 0x20, v11
    v_add_u32 v13, 0x18000, v13
    ds_read_b64_tr_b16 a[56:57], v13
    ds_read_b64_tr_b16 a[58:59], v13 offset:1024
    ds_read_b64_tr_b16 a[60:61], v13 offset:16384
    ds_read_b64_tr_b16 a[62:63], v13 offset:17408
    v_xor_b32 v13, 0x1000, v11
    v_add_u32 v13, 0x18000, v13
    ds_read_b64_tr_b16 a[80:81], v13
    ds_read_b64_tr_b16 a[82:83], v13 offset:1024
    ds_read_b64_tr_b16 a[84:85], v13 offset:16384
    ds_read_b64_tr_b16 a[86:87], v13 offset:17408
    v_xor_b32 v13, 0x1020, v11
    v_add_u32 v13, 0x18000, v13
    ds_read_b64_tr_b16 a[88:89], v13
    ds_read_b64_tr_b16 a[90:91], v13 offset:1024
    ds_read_b64_tr_b16 a[92:93], v13 offset:16384
    ds_read_b64_tr_b16 a[94:95], v13 offset:17408
    s_waitcnt lgkmcnt(0)
    s_barrier
    s_add_u32 s43, s41, 0x200000
    s_add_u32 m0, s51, 0x14000
    s_nop 0
    buffer_load_dwordx4 v15, s[12:15], s43 offen lds
    s_add_u32 s43, s41, 0x208000
    s_add_u32 m0, s51, 0x15000
    s_nop 0
    buffer_load_dwordx4 v15, s[12:15], s43 offen lds
    s_add_u32 s43, s41, 0x300000
    s_add_u32 m0, s51, 0x16000
    s_nop 0
    buffer_load_dwordx4 v15, s[12:15], s43 offen lds
    s_add_u32 s43, s41, 0x308000
    s_add_u32 m0, s51, 0x17000
    s_nop 0
    buffer_load_dwordx4 v15, s[12:15], s43 offen lds
    v_xor_b32 v15, 0, v14
    v_lshl_add_u32 v15, v15, 15, v8
    s_add_u32 s43, s41, 0x80000
    s_add_u32 m0, s51, 0x18000
    s_nop 0
    buffer_load_dwordx4 v15, s[12:15], s43 offen lds
    s_add_u32 s43, s41, 0x88000
    s_add_u32 m0, s51, 0x19000
    s_nop 0
    buffer_load_dwordx4 v15, s[12:15], s43 offen lds
    s_add_u32 s43, s41, 0x180000
    s_add_u32 m0, s51, 0x1a000
    s_nop 0
    buffer_load_dwordx4 v15, s[12:15], s43 offen lds
    s_add_u32 s43, s41, 0x188000
    s_add_u32 m0, s51, 0x1b000
    s_nop 0
    buffer_load_dwordx4 v15, s[12:15], s43 offen lds
    s_waitcnt vmcnt(12)
    v_min_u32 v21, 0xfffffffe, v21
    s_mov_b32 s43, 0x7010000
    s_mov_b64 exec, s[38:39]
    buffer_store_dword v21, v119, s[8:11], s43 offen sc1
    s_mov_b64 exec, -1
    s_barrier
    v_xor_b32 v13, 0x0, v11
    v_add_u32 v13, 0x0, v13
    ds_read_b64_tr_b16 v[64:65], v13
    ds_read_b64_tr_b16 v[66:67], v13 offset:1024
    ds_read_b64_tr_b16 v[68:69], v13 offset:16384
    ds_read_b64_tr_b16 v[70:71], v13 offset:17408
    v_xor_b32 v13, 0x20, v11
    v_add_u32 v13, 0x0, v13
    ds_read_b64_tr_b16 v[72:73], v13
    ds_read_b64_tr_b16 v[74:75], v13 offset:1024
    ds_read_b64_tr_b16 v[76:77], v13 offset:16384
    ds_read_b64_tr_b16 v[78:79], v13 offset:17408
    v_xor_b32 v13, 0x1000, v11
    v_add_u32 v13, 0x0, v13
    ds_read_b64_tr_b16 a[96:97], v13
    ds_read_b64_tr_b16 a[98:99], v13 offset:1024
    ds_read_b64_tr_b16 a[100:101], v13 offset:16384
    ds_read_b64_tr_b16 a[102:103], v13 offset:17408
    v_xor_b32 v13, 0x1020, v11
    v_add_u32 v13, 0x0, v13
    ds_read_b64_tr_b16 a[104:105], v13
    ds_read_b64_tr_b16 a[106:107], v13 offset:1024
    ds_read_b64_tr_b16 a[108:109], v13 offset:16384
    ds_read_b64_tr_b16 a[110:111], v13 offset:17408
    s_waitcnt lgkmcnt(0)
    s_barrier
    s_add_u32 s43, s41, 0x280000
    s_add_u32 m0, s51, 0x1c000
    s_nop 0
    buffer_load_dwordx4 v15, s[12:15], s43 offen lds
    s_add_u32 s43, s41, 0x288000
    s_add_u32 m0, s51, 0x1d000
    s_nop 0
    buffer_load_dwordx4 v15, s[12:15], s43 offen lds
    s_add_u32 s43, s41, 0x380000
    s_add_u32 m0, s51, 0x1e000
    s_nop 0
    buffer_load_dwordx4 v15, s[12:15], s43 offen lds
    s_add_u32 s43, s41, 0x388000
    s_add_u32 m0, s51, 0x1f000
    s_nop 0
    buffer_load_dwordx4 v15, s[12:15], s43 offen lds
    v_xor_b32 v15, 2, v14
    v_lshl_add_u32 v15, v15, 15, v8
    s_add_u32 s43, s41, 0x80000
    s_add_u32 m0, s51, 0x20000
    s_nop 0
    buffer_load_dwordx4 v15, s[12:15], s43 offen lds
    s_add_u32 s43, s41, 0x88000
    s_add_u32 m0, s51, 0x21000
    s_nop 0
    buffer_load_dwordx4 v15, s[12:15], s43 offen lds
    s_add_u32 s43, s41, 0x180000
    s_add_u32 m0, s51, 0x22000
    s_nop 0
    buffer_load_dwordx4 v15, s[12:15], s43 offen lds
    s_add_u32 s43, s41, 0x188000
    s_add_u32 m0, s51, 0x23000
    s_nop 0
    buffer_load_dwordx4 v15, s[12:15], s43 offen lds
    s_waitcnt vmcnt(12)
    s_barrier
    v_xor_b32 v13, 0x0, v11
    v_add_u32 v13, 0x8000, v13
    ds_read_b64_tr_b16 a[128:129], v13
    ds_read_b64_tr_b16 a[130:131], v13 offset:1024
    ds_read_b64_tr_b16 a[132:133], v13 offset:16384
    ds_read_b64_tr_b16 a[134:135], v13 offset:17408
    v_xor_b32 v13, 0x20, v11
    v_add_u32 v13, 0x8000, v13
    ds_read_b64_tr_b16 a[136:137], v13
    ds_read_b64_tr_b16 a[138:139], v13 offset:1024
    ds_read_b64_tr_b16 a[140:141], v13 offset:16384
    ds_read_b64_tr_b16 a[142:143], v13 offset:17408
    v_xor_b32 v13, 0x1000, v11
    v_add_u32 v13, 0x8000, v13
    ds_read_b64_tr_b16 a[160:161], v13
    ds_read_b64_tr_b16 a[162:163], v13 offset:1024
    ds_read_b64_tr_b16 a[164:165], v13 offset:16384
    ds_read_b64_tr_b16 a[166:167], v13 offset:17408
    v_xor_b32 v13, 0x1020, v11
    v_add_u32 v13, 0x8000, v13
    ds_read_b64_tr_b16 a[168:169], v13
    ds_read_b64_tr_b16 a[170:171], v13 offset:1024
    ds_read_b64_tr_b16 a[172:173], v13 offset:16384
    ds_read_b64_tr_b16 a[174:175], v13 offset:17408
    s_waitcnt lgkmcnt(0)
    s_barrier
    s_add_u32 s43, s41, 0x280000
    s_add_u32 m0, s51, 0x24000
    s_nop 0
    buffer_load_dwordx4 v15, s[12:15], s43 offen lds
    s_add_u32 s43, s41, 0x288000
    s_add_u32 m0, s51, 0x25000
    s_nop 0
    buffer_load_dwordx4 v15, s[12:15], s43 offen lds
    s_add_u32 s43, s41, 0x380000
    s_add_u32 m0, s51, 0x26000
    s_nop 0
    buffer_load_dwordx4 v15, s[12:15], s43 offen lds
    s_add_u32 s43, s41, 0x388000
    s_add_u32 m0, s51, 0x27000
    s_nop 0
    buffer_load_dwordx4 v15, s[12:15], s43 offen lds
    s_mov_b32 s12, s64
    s_and_b32 s13, s65, 0xffff
    v_xor_b32 v15, 0, v14
    v_lshl_add_u32 v15, v15, 15, v8
    s_add_u32 s43, s41, 0x0
    s_add_u32 m0, s51, 0x8000
    s_nop 0
    buffer_load_dwordx4 v15, s[12:15], s43 offen lds
    s_add_u32 s43, s41, 0x8000
    s_add_u32 m0, s51, 0x9000
    s_nop 0
    buffer_load_dwordx4 v15, s[12:15], s43 offen lds
    s_add_u32 s43, s41, 0x100000
    s_add_u32 m0, s51, 0xa000
    s_nop 0
    buffer_load_dwordx4 v15, s[12:15], s43 offen lds
    s_add_u32 s43, s41, 0x108000
    s_add_u32 m0, s51, 0xb000
    s_nop 0
    buffer_load_dwordx4 v15, s[12:15], s43 offen lds
    s_waitcnt vmcnt(12)
    s_barrier
    v_xor_b32 v13, 0x0, v11
    v_add_u32 v13, 0x10000, v13
    ds_read_b64_tr_b16 v[80:81], v13
    ds_read_b64_tr_b16 v[82:83], v13 offset:1024
    ds_read_b64_tr_b16 v[84:85], v13 offset:16384
    ds_read_b64_tr_b16 v[86:87], v13 offset:17408
    v_xor_b32 v13, 0x20, v11
    v_add_u32 v13, 0x10000, v13
    ds_read_b64_tr_b16 v[88:89], v13
    ds_read_b64_tr_b16 v[90:91], v13 offset:1024
    ds_read_b64_tr_b16 v[92:93], v13 offset:16384
    ds_read_b64_tr_b16 v[94:95], v13 offset:17408
    v_xor_b32 v13, 0x1000, v11
    v_add_u32 v13, 0x10000, v13
    ds_read_b64_tr_b16 a[112:113], v13
    ds_read_b64_tr_b16 a[114:115], v13 offset:1024
    ds_read_b64_tr_b16 a[116:117], v13 offset:16384
    ds_read_b64_tr_b16 a[118:119], v13 offset:17408
    v_xor_b32 v13, 0x1020, v11
    v_add_u32 v13, 0x10000, v13
    ds_read_b64_tr_b16 a[120:121], v13
    ds_read_b64_tr_b16 a[122:123], v13 offset:1024
    ds_read_b64_tr_b16 a[124:125], v13 offset:16384
    ds_read_b64_tr_b16 a[126:127], v13 offset:17408
    s_waitcnt lgkmcnt(0)
    s_barrier
    s_add_u32 s43, s41, 0x200000
    s_add_u32 m0, s51, 0xc000
    s_nop 0
    buffer_load_dwordx4 v15, s[12:15], s43 offen lds
    s_add_u32 s43, s41, 0x208000
    s_add_u32 m0, s51, 0xd000
    s_nop 0
    buffer_load_dwordx4 v15, s[12:15], s43 offen lds
    s_add_u32 s43, s41, 0x300000
    s_add_u32 m0, s51, 0xe000
    s_nop 0
    buffer_load_dwordx4 v15, s[12:15], s43 offen lds
    s_add_u32 s43, s41, 0x308000
    s_add_u32 m0, s51, 0xf000
    s_nop 0
    buffer_load_dwordx4 v15, s[12:15], s43 offen lds
    v_xor_b32 v15, 2, v14
    v_lshl_add_u32 v15, v15, 15, v8
    s_add_u32 s43, s41, 0x0
    s_add_u32 m0, s51, 0x10000
    s_nop 0
    buffer_load_dwordx4 v15, s[12:15], s43 offen lds
    s_add_u32 s43, s41, 0x8000
    s_add_u32 m0, s51, 0x11000
    s_nop 0
    buffer_load_dwordx4 v15, s[12:15], s43 offen lds
    s_add_u32 s43, s41, 0x100000
    s_add_u32 m0, s51, 0x12000
    s_nop 0
    buffer_load_dwordx4 v15, s[12:15], s43 offen lds
    s_add_u32 s43, s41, 0x108000
    s_add_u32 m0, s51, 0x13000
    s_nop 0
    buffer_load_dwordx4 v15, s[12:15], s43 offen lds
    s_waitcnt vmcnt(12)
    s_barrier
    v_xor_b32 v13, 0x0, v11
    v_add_u32 v13, 0x18000, v13
    ds_read_b64_tr_b16 a[144:145], v13
    ds_read_b64_tr_b16 a[146:147], v13 offset:1024
    ds_read_b64_tr_b16 a[148:149], v13 offset:16384
    ds_read_b64_tr_b16 a[150:151], v13 offset:17408
    v_xor_b32 v13, 0x20, v11
    v_add_u32 v13, 0x18000, v13
    ds_read_b64_tr_b16 a[152:153], v13
    ds_read_b64_tr_b16 a[154:155], v13 offset:1024
    ds_read_b64_tr_b16 a[156:157], v13 offset:16384
    ds_read_b64_tr_b16 a[158:159], v13 offset:17408
    v_xor_b32 v13, 0x1000, v11
    v_add_u32 v13, 0x18000, v13
    ds_read_b64_tr_b16 a[176:177], v13
    ds_read_b64_tr_b16 a[178:179], v13 offset:1024
    ds_read_b64_tr_b16 a[180:181], v13 offset:16384
    ds_read_b64_tr_b16 a[182:183], v13 offset:17408
    v_xor_b32 v13, 0x1020, v11
    v_add_u32 v13, 0x18000, v13
    ds_read_b64_tr_b16 a[184:185], v13
    ds_read_b64_tr_b16 a[186:187], v13 offset:1024
    ds_read_b64_tr_b16 a[188:189], v13 offset:16384
    ds_read_b64_tr_b16 a[190:191], v13 offset:17408
    s_waitcnt lgkmcnt(0)
    s_barrier
    s_add_u32 s43, s41, 0x200000
    s_add_u32 m0, s51, 0x14000
    s_nop 0
    buffer_load_dwordx4 v15, s[12:15], s43 offen lds
    s_add_u32 s43, s41, 0x208000
    s_add_u32 m0, s51, 0x15000
    s_nop 0
    buffer_load_dwordx4 v15, s[12:15], s43 offen lds
    s_add_u32 s43, s41, 0x300000
    s_add_u32 m0, s51, 0x16000
    s_nop 0
    buffer_load_dwordx4 v15, s[12:15], s43 offen lds
    s_add_u32 s43, s41, 0x308000
    s_add_u32 m0, s51, 0x17000
    s_nop 0
    buffer_load_dwordx4 v15, s[12:15], s43 offen lds
    s_mov_b32 s12, s66
    s_and_b32 s13, s67, 0xffff
    s_add_u32 s43, s42, 0x0
    s_add_u32 m0, s51, 0x18000
    s_nop 0
    buffer_load_dwordx4 v10, s[12:15], s43 offen lds
    s_add_u32 s43, s42, 0x4000
    s_add_u32 m0, s51, 0x19000
    s_nop 0
    buffer_load_dwordx4 v9, s[12:15], s43 offen lds
    s_add_u32 s43, s42, 0x8000
    s_add_u32 m0, s51, 0x1a000
    s_nop 0
    buffer_load_dwordx4 v10, s[12:15], s43 offen lds
    s_add_u32 s43, s42, 0xc000
    s_add_u32 m0, s51, 0x1b000
    s_nop 0
    buffer_load_dwordx4 v9, s[12:15], s43 offen lds
    s_waitcnt vmcnt(12)
    s_barrier
    v_xor_b32 v13, 0x0, v11
    v_add_u32 v13, 0x0, v13
    ds_read_b64_tr_b16 a[192:193], v13
    ds_read_b64_tr_b16 a[194:195], v13 offset:1024
    ds_read_b64_tr_b16 a[196:197], v13 offset:16384
    ds_read_b64_tr_b16 a[198:199], v13 offset:17408
    v_xor_b32 v13, 0x20, v11
    v_add_u32 v13, 0x0, v13
    ds_read_b64_tr_b16 a[200:201], v13
    ds_read_b64_tr_b16 a[202:203], v13 offset:1024
    ds_read_b64_tr_b16 a[204:205], v13 offset:16384
    ds_read_b64_tr_b16 a[206:207], v13 offset:17408
    v_xor_b32 v13, 0x1000, v11
    v_add_u32 v13, 0x0, v13
    ds_read_b64_tr_b16 a[224:225], v13
    ds_read_b64_tr_b16 a[226:227], v13 offset:1024
    ds_read_b64_tr_b16 a[228:229], v13 offset:16384
    ds_read_b64_tr_b16 a[230:231], v13 offset:17408
    v_xor_b32 v13, 0x1020, v11
    v_add_u32 v13, 0x0, v13
    ds_read_b64_tr_b16 a[232:233], v13
    ds_read_b64_tr_b16 a[234:235], v13 offset:1024
    ds_read_b64_tr_b16 a[236:237], v13 offset:16384
    ds_read_b64_tr_b16 a[238:239], v13 offset:17408
    s_waitcnt lgkmcnt(0)
    s_barrier
    s_add_u32 s43, s42, 0x10200
    s_add_u32 m0, s51, 0x1c000
    s_nop 0
    buffer_load_dwordx4 v10, s[12:15], s43 offen lds
    s_add_u32 s43, s42, 0x14200
    s_add_u32 m0, s51, 0x1d000
    s_nop 0
    buffer_load_dwordx4 v9, s[12:15], s43 offen lds
    s_add_u32 s43, s42, 0x18200
    s_add_u32 m0, s51, 0x1e000
    s_nop 0
    buffer_load_dwordx4 v10, s[12:15], s43 offen lds
    s_add_u32 s43, s42, 0x1c200
    s_add_u32 m0, s51, 0x1f000
    s_nop 0
    buffer_load_dwordx4 v9, s[12:15], s43 offen lds
    s_add_u32 s43, s42, 0x10000
    s_add_u32 m0, s51, 0x20000
    s_nop 0
    buffer_load_dwordx4 v10, s[12:15], s43 offen lds
    s_add_u32 s43, s42, 0x14000
    s_add_u32 m0, s51, 0x21000
    s_nop 0
    buffer_load_dwordx4 v9, s[12:15], s43 offen lds
    s_add_u32 s43, s42, 0x18000
    s_add_u32 m0, s51, 0x22000
    s_nop 0
    buffer_load_dwordx4 v10, s[12:15], s43 offen lds
    s_add_u32 s43, s42, 0x1c000
    s_add_u32 m0, s51, 0x23000
    s_nop 0
    buffer_load_dwordx4 v9, s[12:15], s43 offen lds
    s_waitcnt vmcnt(12)
    s_barrier
    s_cmp_lg_u32 s21, 0
    s_cbranch_scc1 L_arr_51
    v_mov_b32 v23, 1
    s_mov_b64 exec, 1
    buffer_atomic_add v23, off, s[16:19], 0 offset:8
    s_mov_b64 exec, -1
L_arr_51:
    v_xor_b32 v13, 0x0, v11
    v_add_u32 v13, 0x8000, v13
    ds_read_b64_tr_b16 v[128:129], v13
    ds_read_b64_tr_b16 v[130:131], v13 offset:1024
    ds_read_b64_tr_b16 v[132:133], v13 offset:16384
    ds_read_b64_tr_b16 v[134:135], v13 offset:17408
    v_xor_b32 v13, 0x20, v11
    v_add_u32 v13, 0x8000, v13
    ds_read_b64_tr_b16 v[136:137], v13
    ds_read_b64_tr_b16 v[138:139], v13 offset:1024
    ds_read_b64_tr_b16 v[140:141], v13 offset:16384
    ds_read_b64_tr_b16 v[142:143], v13 offset:17408
    v_xor_b32 v13, 0x1000, v11
    v_add_u32 v13, 0x8000, v13
    ds_read_b64_tr_b16 v[160:161], v13
    ds_read_b64_tr_b16 v[162:163], v13 offset:1024
    ds_read_b64_tr_b16 v[164:165], v13 offset:16384
    ds_read_b64_tr_b16 v[166:167], v13 offset:17408
    v_xor_b32 v13, 0x1020, v11
    v_add_u32 v13, 0x8000, v13
    ds_read_b64_tr_b16 v[168:169], v13
    ds_read_b64_tr_b16 v[170:171], v13 offset:1024
    ds_read_b64_tr_b16 v[172:173], v13 offset:16384
    ds_read_b64_tr_b16 v[174:175], v13 offset:17408
    s_waitcnt lgkmcnt(0)
    s_barrier
    s_add_u32 s43, s42, 0x200
    s_add_u32 m0, s51, 0x24000
    s_nop 0
    buffer_load_dwordx4 v10, s[12:15], s43 offen lds
    s_add_u32 s43, s42, 0x4200
    s_add_u32 m0, s51, 0x25000
    s_nop 0
    buffer_load_dwordx4 v9, s[12:15], s43 offen lds
    s_add_u32 s43, s42, 0x8200
    s_add_u32 m0, s51, 0x26000
    s_nop 0
    buffer_load_dwordx4 v10, s[12:15], s43 offen lds
    s_add_u32 s43, s42, 0xc200
    s_add_u32 m0, s51, 0x27000
    s_nop 0
    buffer_load_dwordx4 v9, s[12:15], s43 offen lds
    s_mov_b32 s12, s64
    s_and_b32 s13, s65, 0xffff
    v_xor_b32 v15, 0, v14
    v_lshl_add_u32 v15, v15, 15, v8
    s_add_u32 s43, s41, 0x80000
    s_add_u32 m0, s51, 0x8000
    s_nop 0
    buffer_load_dwordx4 v15, s[12:15], s43 offen lds
    s_add_u32 s43, s41, 0x88000
    s_add_u32 m0, s51, 0x9000
    s_nop 0
    buffer_load_dwordx4 v15, s[12:15], s43 offen lds
    s_add_u32 s43, s41, 0x180000
    s_add_u32 m0, s51, 0xa000
    s_nop 0
    buffer_load_dwordx4 v15, s[12:15], s43 offen lds
    s_add_u32 s43, s41, 0x188000
    s_add_u32 m0, s51, 0xb000
    s_nop 0
    buffer_load_dwordx4 v15, s[12:15], s43 offen lds
    s_waitcnt vmcnt(12)
    s_barrier
    v_xor_b32 v13, 0x0, v12
    v_add_u32 v13, 0x10000, v13
    ds_read_b64_tr_b16 v[192:193], v13
    ds_read_b64_tr_b16 v[194:195], v13 offset:512
    ds_read_b64_tr_b16 v[196:197], v13 offset:2048
    ds_read_b64_tr_b16 v[198:199], v13 offset:2560
    v_xor_b32 v13, 0x2000, v12
    v_add_u32 v13, 0x10000, v13
    ds_read_b64_tr_b16 v[200:201], v13
    ds_read_b64_tr_b16 v[202:203], v13 offset:512
    ds_read_b64_tr_b16 v[204:205], v13 offset:2048
    ds_read_b64_tr_b16 v[206:207], v13 offset:2560
    v_xor_b32 v13, 0x40, v12
    v_add_u32 v13, 0x10000, v13
    ds_read_b64_tr_b16 v[224:225], v13
    ds_read_b64_tr_b16 v[226:227], v13 offset:512
    ds_read_b64_tr_b16 v[228:229], v13 offset:2048
    ds_read_b64_tr_b16 v[230:231], v13 offset:2560
    v_xor_b32 v13, 0x2040, v12
    v_add_u32 v13, 0x10000, v13
    ds_read_b64_tr_b16 v[232:233], v13
    ds_read_b64_tr_b16 v[234:235], v13 offset:512
    ds_read_b64_tr_b16 v[236:237], v13 offset:2048
    ds_read_b64_tr_b16 v[238:239], v13 offset:2560
    s_waitcnt lgkmcnt(0)
    s_barrier
    s_add_u32 s43, s41, 0x280000
    s_add_u32 m0, s51, 0xc000
    s_nop 0
    buffer_load_dwordx4 v15, s[12:15], s43 offen lds
    s_add_u32 s43, s41, 0x288000
    s_add_u32 m0, s51, 0xd000
    s_nop 0
    buffer_load_dwordx4 v15, s[12:15], s43 offen lds
    s_add_u32 s43, s41, 0x380000
    s_add_u32 m0, s51, 0xe000
    s_nop 0
    buffer_load_dwordx4 v15, s[12:15], s43 offen lds
    s_add_u32 s43, s41, 0x388000
    s_add_u32 m0, s51, 0xf000
    s_nop 0
    buffer_load_dwordx4 v15, s[12:15], s43 offen lds
    v_xor_b32 v15, 2, v14
    v_lshl_add_u32 v15, v15, 15, v8
    s_add_u32 s43, s41, 0x80000
    s_add_u32 m0, s51, 0x10000
    s_nop 0
    buffer_load_dwordx4 v15, s[12:15], s43 offen lds
    s_add_u32 s43, s41, 0x88000
    s_add_u32 m0, s51, 0x11000
    s_nop 0
    buffer_load_dwordx4 v15, s[12:15], s43 offen lds
    s_add_u32 s43, s41, 0x180000
    s_add_u32 m0, s51, 0x12000
    s_nop 0
    buffer_load_dwordx4 v15, s[12:15], s43 offen lds
    s_add_u32 s43, s41, 0x188000
    s_add_u32 m0, s51, 0x13000
    s_nop 0
    buffer_load_dwordx4 v15, s[12:15], s43 offen lds
    s_waitcnt vmcnt(12)
    s_barrier
    v_xor_b32 v13, 0x0, v12
    v_add_u32 v13, 0x18000, v13
    ds_read_b64_tr_b16 v[208:209], v13
    ds_read_b64_tr_b16 v[210:211], v13 offset:512
    ds_read_b64_tr_b16 v[212:213], v13 offset:2048
    ds_read_b64_tr_b16 v[214:215], v13 offset:2560
    v_xor_b32 v13, 0x2000, v12
    v_add_u32 v13, 0x18000, v13
    ds_read_b64_tr_b16 v[216:217], v13
    ds_read_b64_tr_b16 v[218:219], v13 offset:512
    ds_read_b64_tr_b16 v[220:221], v13 offset:2048
    ds_read_b64_tr_b16 v[222:223], v13 offset:2560
    v_xor_b32 v13, 0x40, v12
    v_add_u32 v13, 0x18000, v13
    ds_read_b64_tr_b16 v[240:241], v13
    ds_read_b64_tr_b16 v[242:243], v13 offset:512
    ds_read_b64_tr_b16 v[244:245], v13 offset:2048
    ds_read_b64_tr_b16 v[246:247], v13 offset:2560
    v_xor_b32 v13, 0x2040, v12
    v_add_u32 v13, 0x18000, v13
    ds_read_b64_tr_b16 v[248:249], v13
    ds_read_b64_tr_b16 v[250:251], v13 offset:512
    ds_read_b64_tr_b16 v[252:253], v13 offset:2048
    ds_read_b64_tr_b16 v[254:255], v13 offset:2560
    s_waitcnt lgkmcnt(0)
    s_barrier
    s_add_u32 s43, s41, 0x280000
    s_add_u32 m0, s51, 0x14000
    s_nop 0
    buffer_load_dwordx4 v15, s[12:15], s43 offen lds
    s_add_u32 s43, s41, 0x288000
    s_add_u32 m0, s51, 0x15000
    s_nop 0
    buffer_load_dwordx4 v15, s[12:15], s43 offen lds
    s_add_u32 s43, s41, 0x380000
    s_add_u32 m0, s51, 0x16000
    s_nop 0
    buffer_load_dwordx4 v15, s[12:15], s43 offen lds
    s_add_u32 s43, s41, 0x388000
    s_add_u32 m0, s51, 0x17000
    s_nop 0
    buffer_load_dwordx4 v15, s[12:15], s43 offen lds
    s_mov_b32 s12, s66
    s_and_b32 s13, s67, 0xffff
    s_add_u32 s43, s42, 0x80
    s_add_u32 m0, s51, 0x18000
    s_nop 0
    buffer_load_dwordx4 v10, s[12:15], s43 offen lds
    s_add_u32 s43, s42, 0x4080
    s_add_u32 m0, s51, 0x19000
    s_nop 0
    buffer_load_dwordx4 v9, s[12:15], s43 offen lds
    s_add_u32 s43, s42, 0x8080
    s_add_u32 m0, s51, 0x1a000
    s_nop 0
    buffer_load_dwordx4 v10, s[12:15], s43 offen lds
    s_add_u32 s43, s42, 0xc080
    s_add_u32 m0, s51, 0x1b000
    s_nop 0
    buffer_load_dwordx4 v9, s[12:15], s43 offen lds
    s_waitcnt vmcnt(12)
    s_barrier
    v_xor_b32 v13, 0x0, v11
    v_add_u32 v13, 0x0, v13
    ds_read_b64_tr_b16 a[208:209], v13
    ds_read_b64_tr_b16 a[210:211], v13 offset:1024
    ds_read_b64_tr_b16 a[212:213], v13 offset:16384
    ds_read_b64_tr_b16 a[214:215], v13 offset:17408
    v_xor_b32 v13, 0x20, v11
    v_add_u32 v13, 0x0, v13
    ds_read_b64_tr_b16 a[216:217], v13
    ds_read_b64_tr_b16 a[218:219], v13 offset:1024
    ds_read_b64_tr_b16 a[220:221], v13 offset:16384
    ds_read_b64_tr_b16 a[222:223], v13 offset:17408
    v_xor_b32 v13, 0x1000, v11
    v_add_u32 v13, 0x0, v13
    ds_read_b64_tr_b16 a[240:241], v13
    ds_read_b64_tr_b16 a[242:243], v13 offset:1024
    ds_read_b64_tr_b16 a[244:245], v13 offset:16384
    ds_read_b64_tr_b16 a[246:247], v13 offset:17408
    v_xor_b32 v13, 0x1020, v11
    v_add_u32 v13, 0x0, v13
    ds_read_b64_tr_b16 a[248:249], v13
    ds_read_b64_tr_b16 a[250:251], v13 offset:1024
    ds_read_b64_tr_b16 a[252:253], v13 offset:16384
    ds_read_b64_tr_b16 a[254:255], v13 offset:17408
    s_waitcnt lgkmcnt(0)
    s_barrier
    s_add_u32 s43, s42, 0x10280
    s_add_u32 m0, s51, 0x1c000
    s_nop 0
    buffer_load_dwordx4 v10, s[12:15], s43 offen lds
    s_add_u32 s43, s42, 0x14280
    s_add_u32 m0, s51, 0x1d000
    s_nop 0
    buffer_load_dwordx4 v9, s[12:15], s43 offen lds
    s_add_u32 s43, s42, 0x18280
    s_add_u32 m0, s51, 0x1e000
    s_nop 0
    buffer_load_dwordx4 v10, s[12:15], s43 offen lds
    s_add_u32 s43, s42, 0x1c280
    s_add_u32 m0, s51, 0x1f000
    s_nop 0
    buffer_load_dwordx4 v9, s[12:15], s43 offen lds
    s_add_u32 s43, s42, 0x10080
    s_add_u32 m0, s51, 0x20000
    s_nop 0
    buffer_load_dwordx4 v10, s[12:15], s43 offen lds
    s_add_u32 s43, s42, 0x14080
    s_add_u32 m0, s51, 0x21000
    s_nop 0
    buffer_load_dwordx4 v9, s[12:15], s43 offen lds
    s_add_u32 s43, s42, 0x18080
    s_add_u32 m0, s51, 0x22000
    s_nop 0
    buffer_load_dwordx4 v10, s[12:15], s43 offen lds
    s_add_u32 s43, s42, 0x1c080
    s_add_u32 m0, s51, 0x23000
    s_nop 0
    buffer_load_dwordx4 v9, s[12:15], s43 offen lds
    ds_write_b128 v123, v[32:35]
    ds_write_b128 v123, v[36:39] offset:1024
    ds_write_b128 v123, v[40:43] offset:2048
    ds_write_b128 v123, v[44:47] offset:3072
    ds_write_b128 v123, v[48:51] offset:4096
    ds_write_b128 v123, v[52:55] offset:5120
    ds_write_b128 v123, v[56:59] offset:6144
    ds_write_b128 v123, v[60:63] offset:7168
    s_waitcnt vmcnt(12)
    s_barrier
    v_xor_b32 v13, 0x0, v11
    v_add_u32 v13, 0x8000, v13
    ds_read_b64_tr_b16 v[144:145], v13
    ds_read_b64_tr_b16 v[146:147], v13 offset:1024
    ds_read_b64_tr_b16 v[148:149], v13 offset:16384
    ds_read_b64_tr_b16 v[150:151], v13 offset:17408
    v_xor_b32 v13, 0x20, v11
    v_add_u32 v13, 0x8000, v13
    ds_read_b64_tr_b16 v[152:153], v13
    ds_read_b64_tr_b16 v[154:155], v13 offset:1024
    ds_read_b64_tr_b16 v[156:157], v13 offset:16384
    ds_read_b64_tr_b16 v[158:159], v13 offset:17408
    v_xor_b32 v13, 0x1000, v11
    v_add_u32 v13, 0x8000, v13
    ds_read_b64_tr_b16 v[176:177], v13
    ds_read_b64_tr_b16 v[178:179], v13 offset:1024
    ds_read_b64_tr_b16 v[180:181], v13 offset:16384
    ds_read_b64_tr_b16 v[182:183], v13 offset:17408
    v_xor_b32 v13, 0x1020, v11
    v_add_u32 v13, 0x8000, v13
    ds_read_b64_tr_b16 v[184:185], v13
    ds_read_b64_tr_b16 v[186:187], v13 offset:1024
    ds_read_b64_tr_b16 v[188:189], v13 offset:16384
    ds_read_b64_tr_b16 v[190:191], v13 offset:17408
    s_waitcnt lgkmcnt(0)
    s_barrier
    s_add_u32 s43, s42, 0x280
    s_add_u32 m0, s51, 0x24000
    s_nop 0
    buffer_load_dwordx4 v10, s[12:15], s43 offen lds
    s_add_u32 s43, s42, 0x4280
    s_add_u32 m0, s51, 0x25000
    s_nop 0
    buffer_load_dwordx4 v9, s[12:15], s43 offen lds
    s_add_u32 s43, s42, 0x8280
    s_add_u32 m0, s51, 0x26000
    s_nop 0
    buffer_load_dwordx4 v10, s[12:15], s43 offen lds
    s_add_u32 s43, s42, 0xc280
    s_add_u32 m0, s51, 0x27000
    s_nop 0
    buffer_load_dwordx4 v9, s[12:15], s43 offen lds
    ds_write_b128 v123, v[64:67] offset:32768
    ds_write_b128 v123, v[68:71] offset:33792
    ds_write_b128 v123, v[72:75] offset:34816
    ds_write_b128 v123, v[76:79] offset:35840
    ds_write_b128 v123, v[80:83] offset:36864
    ds_write_b128 v123, v[84:87] offset:37888
    ds_write_b128 v123, v[88:91] offset:38912
    ds_write_b128 v123, v[92:95] offset:39936
    s_waitcnt vmcnt(8)
    s_barrier
    v_xor_b32 v13, 0x0, v12
    v_add_u32 v13, 0x10000, v13
    ds_read_b64_tr_b16 v[32:33], v13
    ds_read_b64_tr_b16 v[34:35], v13 offset:512
    ds_read_b64_tr_b16 v[36:37], v13 offset:2048
    ds_read_b64_tr_b16 v[38:39], v13 offset:2560
    v_xor_b32 v13, 0x2000, v12
    v_add_u32 v13, 0x10000, v13
    ds_read_b64_tr_b16 v[40:41], v13
    ds_read_b64_tr_b16 v[42:43], v13 offset:512
    ds_read_b64_tr_b16 v[44:45], v13 offset:2048
    ds_read_b64_tr_b16 v[46:47], v13 offset:2560
    v_xor_b32 v13, 0x40, v12
    v_add_u32 v13, 0x10000, v13
    ds_read_b64_tr_b16 v[64:65], v13
    ds_read_b64_tr_b16 v[66:67], v13 offset:512
    ds_read_b64_tr_b16 v[68:69], v13 offset:2048
    ds_read_b64_tr_b16 v[70:71], v13 offset:2560
    v_xor_b32 v13, 0x2040, v12
    v_add_u32 v13, 0x10000, v13
    ds_read_b64_tr_b16 v[72:73], v13
    ds_read_b64_tr_b16 v[74:75], v13 offset:512
    ds_read_b64_tr_b16 v[76:77], v13 offset:2048
    ds_read_b64_tr_b16 v[78:79], v13 offset:2560
    s_waitcnt vmcnt(0)
    s_barrier
    v_xor_b32 v13, 0x0, v12
    v_add_u32 v13, 0x18000, v13
    ds_read_b64_tr_b16 v[48:49], v13
    ds_read_b64_tr_b16 v[50:51], v13 offset:512
    ds_read_b64_tr_b16 v[52:53], v13 offset:2048
    ds_read_b64_tr_b16 v[54:55], v13 offset:2560
    v_xor_b32 v13, 0x2000, v12
    v_add_u32 v13, 0x18000, v13
    ds_read_b64_tr_b16 v[56:57], v13
    ds_read_b64_tr_b16 v[58:59], v13 offset:512
    ds_read_b64_tr_b16 v[60:61], v13 offset:2048
    ds_read_b64_tr_b16 v[62:63], v13 offset:2560
    v_xor_b32 v13, 0x40, v12
    v_add_u32 v13, 0x18000, v13
    ds_read_b64_tr_b16 v[80:81], v13
    ds_read_b64_tr_b16 v[82:83], v13 offset:512
    ds_read_b64_tr_b16 v[84:85], v13 offset:2048
    ds_read_b64_tr_b16 v[86:87], v13 offset:2560
    v_xor_b32 v13, 0x2040, v12
    v_add_u32 v13, 0x18000, v13
    ds_read_b64_tr_b16 v[88:89], v13
    ds_read_b64_tr_b16 v[90:91], v13 offset:512
    ds_read_b64_tr_b16 v[92:93], v13 offset:2048
    ds_read_b64_tr_b16 v[94:95], v13 offset:2560
    s_waitcnt lgkmcnt(0)
    s_barrier
    ds_write_b128 v124, v[32:35]
    ds_write_b128 v124, v[36:39] offset:1024
    ds_write_b128 v124, v[40:43] offset:2048
    ds_write_b128 v124, v[44:47] offset:3072
    ds_write_b128 v124, v[48:51] offset:4096
    ds_write_b128 v124, v[52:55] offset:5120
    ds_write_b128 v124, v[56:59] offset:6144
    ds_write_b128 v124, v[60:63] offset:7168
    ds_write_b128 v124, v[64:67] offset:32768
    ds_write_b128 v124, v[68:71] offset:33792
    ds_write_b128 v124, v[72:75] offset:34816
    ds_write_b128 v124, v[76:79] offset:35840
    ds_write_b128 v124, v[80:83] offset:36864
    ds_write_b128 v124, v[84:87] offset:37888
    ds_write_b128 v124, v[88:91] offset:38912
    ds_write_b128 v124, v[92:95] offset:39936
    s_waitcnt lgkmcnt(0)
    s_cmp_eq_u32 s57, 1
    s_cbranch_scc1 L_started_52
    v_lshrrev_b32 v1, 4, v117
    v_and_b32 v2, 15, v1
    v_lshrrev_b32 v1, 4, v1
    v_lshlrev_b32 v1, 11, v1
    v_lshl_add_u32 v1, v2, 2, v1
    s_lshl_b32 s43, s20, 6
    s_add_u32 s43, s43, 0x2000
    s_mov_b32 exec_lo, 0x10001
    s_mov_b32 exec_hi, 0
    s_mov_b32 s96, 0
L_poll_53:
    buffer_load_dword v2, v1, s[8:11], s43 offen sc1
    s_waitcnt vmcnt(0)
    v_cmp_gt_u32 vcc, 1, v2
    s_cbranch_vccz L_polld_54
    s_sleep 8
    s_add_u32 s96, s96, 1
    s_cmp_lt_u32 s96, 0x10000
    s_cbranch_scc1 L_poll_53
L_polld_54:
    s_mov_b64 exec, -1
    s_add_u32 m0, s52, 8192
    s_nop 0
    buffer_load_dwordx4 v117, s[8:11], s30 offen lds
    buffer_load_dwordx4 v117, s[8:11], s30 offen offset:1024 lds
    s_add_u32 m0, s52, 0x6000
    s_nop 0
    buffer_load_dwordx4 v117, s[8:11], s31 offen lds
    buffer_load_dwordx4 v117, s[8:11], s31 offen offset:1024 lds
    s_mov_b32 s49, 0
L_cb_poll_56:
    buffer_load_dword v3, off, s[16:19], 0 offset:8 sc1
    s_waitcnt vmcnt(0)
    v_readfirstlane_b32 s43, v3
    s_nop 0
    s_cmp_ge_u32 s43, 32
    s_cbranch_scc1 L_started_52
    s_sleep 8
    s_add_u32 s49, s49, 1
    s_cmp_lt_u32 s49, 0x40000
    s_cbranch_scc1 L_cb_poll_56
L_started_52:
    s_lshr_b32 s43, s20, 1
    s_lshl_b32 s43, s43, 7
    s_and_b32 s40, s20, 1
    s_lshl_b32 s40, s40, 4
    s_add_u32 s43, s43, s40
    s_add_u32 s44, s43, 0x1000
    s_cmp_eq_u32 s21, 0
    s_cselect_b32 s44, s44, 0x7ff00000
    s_mov_b32 s22, 0
    s_mov_b32 s33, 0
    s_xor_b32 s53, s29, 1024
    s_add_u32 s23, s51, 0x7010000
    s_add_u32 s48, s23, 4096
    s_mov_b32 s24, 0x7012000
    s_add_u32 s55, s24, 16384
    s_mov_b32 s25, 0x7100000
    s_mov_b32 s26, 0x7101000
    v_mov_b32 v112, 0
    v_mov_b32 v113, 0
    v_mov_b32 v114, 0
    v_mov_b32 v115, 0
    s_add_u32 m0, s51, 4096
    ds_write_b128 v117, v[112:115] offset:22528
    ds_write_b128 v117, v[112:115] offset:23552
    s_cmp_lg_u32 s21, 0
    s_cselect_b32 s40, -1, 0
    v_mov_b32 v126, s40
    v_bfe_u32 v1, v117, 4, 1
    v_lshlrev_b32 v1, 4, v1
    s_movk_i32 s43, 0x3f80
    v_lshlrev_b32 v125, v1, s43
    v_bfe_u32 v1, v117, 5, 3
    v_cmp_eq_u32 s[68:69], 0, v1
    v_cmp_eq_u32 s[70:71], 1, v1
    v_cmp_eq_u32 s[72:73], 2, v1
    v_cmp_eq_u32 s[74:75], 3, v1
    v_lshrrev_b32 v1, 2, v117
    s_cmp_lt_u32 s21, 2
    s_cselect_b64 vcc, -1, 0
    v_cndmask_b32 v119, v119, v1, vcc
    v_mov_b32 v32, 0
    v_mov_b32 v33, 0
    v_mov_b32 v34, 0
    v_mov_b32 v35, 0
    v_mov_b32 v36, 0
    v_mov_b32 v37, 0
    v_mov_b32 v38, 0
    v_mov_b32 v39, 0
    v_mov_b32 v40, 0
    v_mov_b32 v41, 0
    v_mov_b32 v42, 0
    v_mov_b32 v43, 0
    v_mov_b32 v44, 0
    v_mov_b32 v45, 0
    v_mov_b32 v46, 0
    v_mov_b32 v47, 0
    v_mov_b32 v48, 0
    v_mov_b32 v49, 0
    v_mov_b32 v50, 0
    v_mov_b32 v51, 0
    v_mov_b32 v52, 0
    v_mov_b32 v53, 0
    v_mov_b32 v54, 0
    v_mov_b32 v55, 0
    s_add_u32 s30, s30, 0x40000
    s_add_u32 s31, s31, 0x40000
    s_mov_b32 s45, 0
    s_mov_b32 s46, 0
    s_mov_b32 s47, 0
    s_mov_b32 s76, 0
    s_and_b32 s43, s21, 1
    s_lshl_b32 s43, s43, 5
    s_add_u32 s43, s43, s20
    s_lshl_b32 s43, s43, 6
    s_add_u32 s28, s43, 0x2000
    s_mov_b32 s59, 0
    ds_read_b128 v[80:83], v123
    ds_read_b128 v[84:87], v123 offset:1024
    ds_read_b128 v[56:59], v123 offset:2048
    ds_read_b128 v[60:63], v123 offset:3072
    ds_read_b128 v[64:67], v123 offset:32768
    ds_read_b128 v[68:71], v123 offset:33792
    ds_read_b128 v[72:75], v123 offset:34816
    ds_read_b128 v[76:79], v123 offset:35840
    ds_read_b128 v[88:91], v123 offset:4096
    ds_read_b128 v[92:95], v123 offset:5120
    ds_read_b128 v[96:99], v123 offset:6144
    ds_read_b128 v[100:103], v123 offset:7168
    ds_read_b128 v[104:107], v123 offset:36864
    ds_read_b128 v[108:111], v123 offset:37888
    ds_read_b128 v[24:27], v123 offset:38912
    ds_read_b128 v[28:31], v123 offset:39936
    s_mov_b32 s49, 0
    s_waitcnt vmcnt(0) lgkmcnt(0)
    s_barrier
    s_waitcnt vmcnt(0) lgkmcnt(0)
    s_cmp_eq_u32 s21, 1
    s_cbranch_scc1 L_chain_top1_s
    s_cmp_eq_u32 s21, 2
    s_cbranch_scc1 L_chain_top2_s
    s_cmp_eq_u32 s21, 3
    s_cbranch_scc1 L_chain_top3_s
.p2align 6
L_chain_top0_s:
    buffer_load_dwordx4 v[0:3], v117, s[8:11], s23 offen sc1
    v_mov_b32 v15, 0
    v_mov_b32 v15, 0
    v_mov_b32 v15, 0
    v_mov_b32 v15, 0
    v_mov_b32 v15, 0
    v_mov_b32 v15, 0
    v_mov_b32 v15, 0
    v_mov_b32 v15, 0
    v_mov_b32 v15, 0
    v_mov_b32 v15, 0
    v_mov_b32 v15, 0
    v_mov_b32 v15, 0
    v_mov_b32 v15, 0
    v_mov_b32 v15, 0
    v_mov_b32 v15, 0
    v_mov_b32 v15, 0
    buffer_load_dwordx4 v[0:3], v117, s[8:11], s23 offen sc1
    v_mov_b32 v15, 0
    v_mov_b32 v15, 0
    v_mov_b32 v15, 0
    v_mov_b32 v15, 0
    v_mov_b32 v15, 0
    v_mov_b32 v15, 0
    v_mov_b32 v15, 0
    v_mov_b32 v15, 0
    v_mov_b32 v15, 0
    v_mov_b32 v15, 0
    v_mov_b32 v15, 0
    v_mov_b32 v15, 0
    v_mov_b32 v15, 0
    v_mov_b32 v15, 0
    v_mov_b32 v15, 0
    v_mov_b32 v15, 0
L_mret_58:
    buffer_load_dwordx4 v[0:3], v117, s[8:11], s23 offen sc1
    s_add_u32 s45, s45, 1
    s_cmp_lt_u32 s45, 0x10000
    s_cselect_b32 s56, -2, -1
    s_nop 3
    v_mov_b32 v32, 0
    v_mov_b32 v33, 0
    v_mov_b32 v34, 0
    v_mov_b32 v35, 0
    s_waitcnt vmcnt(2)
    v_max3_u32 v15, v0, v1, v2
    v_max_u32 v15, v15, v3
    v_cmp_lt_u32 vcc, s56, v15
    v_smfmac_f32_16x16x64_bf16 v[32:35], v[0:3], v[80:87], v116
    s_cbranch_vccnz L_mret_58
    ds_write_b128 v117, v[0:3]
    v_smfmac_f32_16x16x64_bf16 v[36:39], v[0:3], v[56:63], v116
    buffer_load_dwordx4 v[4:7], v117, s[8:11], s48 offen sc1
    v_smfmac_f32_16x16x64_bf16 v[40:43], v[0:3], v[64:71], v116
    buffer_load_dwordx4 v117, s[8:11], s48 offen sc1 lds
    s_mov_b32 m0, 8192
    v_smfmac_f32_16x16x64_bf16 v[44:47], v[0:3], v[72:79], v116
    s_waitcnt lgkmcnt(0)
    s_barrier
    ds_read_b128 v[8:11], v117 offset:1024
    v_smfmac_f32_16x16x64_bf16 v[48:51], v[0:3], a[192:199], v116
    ds_read_b128 v[16:19], v117 offset:2048
    ds_read_b128 v[20:23], v117 offset:3072
    v_smfmac_f32_16x16x64_bf16 v[52:55], v[0:3], a[200:207], v116
    ds_read_b128 v[80:83], v117 offset:14336
    s_waitcnt lgkmcnt(3)
    v_smfmac_f32_16x16x64_bf16 v[32:35], v[8:11], a[0:7], v116
    ds_read_b128 v[84:87], v117 offset:15360
    v_smfmac_f32_16x16x64_bf16 v[36:39], v[8:11], a[8:15], v116
    buffer_store_dwordx4 v[112:115], v117, s[8:11], s32 offen sc1
    s_waitcnt lgkmcnt(3)
    v_smfmac_f32_16x16x64_bf16 v[32:35], v[16:19], a[32:39], v116
    ds_read_b128 v[56:59], v117 offset:8192
    v_smfmac_f32_16x16x64_bf16 v[36:39], v[16:19], a[40:47], v116
    ds_read_b128 v[60:63], v117 offset:9216
    s_waitcnt lgkmcnt(4)
    v_smfmac_f32_16x16x64_bf16 v[32:35], v[20:23], a[64:71], v116
    ds_read_b128 v[64:67], v117 offset:10240
    v_smfmac_f32_16x16x64_bf16 v[36:39], v[20:23], a[72:79], v116
    ds_read_b128 v[68:71], v117 offset:11264
    v_smfmac_f32_16x16x64_bf16 v[40:43], v[8:11], a[96:103], v116
    ds_read_b128 v[72:75], v117 offset:12288
    v_smfmac_f32_16x16x64_bf16 v[40:43], v[16:19], a[128:135], v116
    ds_read_b128 v[76:79], v117 offset:13312
    v_smfmac_f32_16x16x64_bf16 v[40:43], v[20:23], a[160:167], v116
    s_waitcnt vmcnt(2)
    v_max3_u32 v15, v4, v5, v6
    v_smfmac_f32_16x16x64_bf16 v[44:47], v[8:11], a[104:111], v116
    v_max_u32 v15, v15, v7
    v_smfmac_f32_16x16x64_bf16 v[44:47], v[16:19], a[136:143], v116
    s_waitcnt vmcnt(1) lgkmcnt(0)
    v_cmp_lt_u32 vcc, s56, v15
    v_smfmac_f32_16x16x64_bf16 v[44:47], v[20:23], a[168:175], v116
    s_cbranch_vccnz L_mret_59
L_mgo_60:
    v_smfmac_f32_16x16x64_bf16 v[44:47], v[4:7], v[24:31], v116
    s_barrier
    ds_read_b128 v[12:15], v117 offset:5120
    v_smfmac_f32_16x16x64_bf16 v[32:35], v[4:7], v[88:95], v116
    ds_read_b128 v[24:27], v117 offset:6144
    v_smfmac_f32_16x16x64_bf16 v[36:39], v[4:7], v[96:103], v116
    ds_read_b128 v[28:31], v117 offset:7168
    v_smfmac_f32_16x16x64_bf16 v[40:43], v[4:7], v[104:111], v116
    ds_read_b128 v[88:91], v117 offset:24576
    s_waitcnt lgkmcnt(3)
    v_smfmac_f32_16x16x64_bf16 v[32:35], v[12:15], a[16:23], v116
    ds_read_b128 v[92:95], v117 offset:25600
    s_waitcnt lgkmcnt(3)
    v_smfmac_f32_16x16x64_bf16 v[32:35], v[24:27], a[48:55], v116
    buffer_load_dwordx4 v117, s[8:11], s30 offen lds
    s_waitcnt lgkmcnt(2)
    v_smfmac_f32_16x16x64_bf16 v[32:35], v[28:31], a[80:87], v116
    ds_read_b128 v[96:99], v117 offset:23552
    v_smfmac_f32_16x16x64_bf16 v[36:39], v[12:15], a[24:31], v116
    ds_read_b128 v[100:103], v117 offset:23552
    v_smfmac_f32_16x16x64_bf16 v[36:39], v[24:27], a[56:63], v116
    buffer_load_dwordx4 v117, s[8:11], s30 offen offset:1024 lds
    s_add_u32 m0, s52, 0x6000
    v_add_f32 v32, v32, v34
    v_smfmac_f32_16x16x64_bf16 v[36:39], v[28:31], a[88:95], v116
    ds_read_b128 v[104:107], v117 offset:23552
    v_add_f32 v33, v33, v35
    v_smfmac_f32_16x16x64_bf16 v[40:43], v[12:15], a[112:119], v116
    ds_read_b128 v[108:111], v117 offset:23552
    v_mul_f32 v32, s34, v32
    v_smfmac_f32_16x16x64_bf16 v[40:43], v[24:27], a[144:151], v116
    buffer_load_dword v125, v119, s[8:11], s28 offen sc1
    v_mul_f32 v33, s34, v33
    v_smfmac_f32_16x16x64_bf16 v[40:43], v[28:31], a[176:183], v116
    ds_read_b128 v[0:3], v124
    v_add_f32 v36, v36, v38
    v_smfmac_f32_16x16x64_bf16 v[48:51], v[4:7], a[208:215], v116
    v_add_f32 v37, v37, v39
    v_smfmac_f32_16x16x64_bf16 v[52:55], v[4:7], a[216:223], v116
    s_waitcnt lgkmcnt(5)
    buffer_load_dwordx4 v117, s[8:11], s31 offen lds
    v_mul_f32 v36, s34, v36
    v_smfmac_f32_16x16x64_bf16 v[44:47], v[12:15], a[120:127], v116
    ds_read_b128 v[4:7], v124 offset:1024
    v_mul_f32 v37, s34, v37
    v_smfmac_f32_16x16x64_bf16 v[44:47], v[24:27], a[152:159], v116
    v_cvt_pk_bf16_f32 v34, v32, v36
    v_smfmac_f32_16x16x64_bf16 v[44:47], v[28:31], a[184:191], v116
    buffer_load_dwordx4 v117, s[8:11], s31 offen offset:1024 lds
    s_mov_b32 m0, 4096
    v_cvt_pk_bf16_f32 v35, v33, v37
    v_add_f32 v40, v40, v42
    v_smfmac_f32_16x16x64_bf16 v[48:51], v[8:11], a[224:231], v116
    ds_write2_b32 v120, v34, v35 offset0:32 offset1:48
    v_add_f32 v41, v41, v43
    v_smfmac_f32_16x16x64_bf16 v[52:55], v[8:11], a[232:239], v116
    v_add_f32 v44, v44, v46
    v_add_f32 v45, v45, v47
    v_cvt_pk_bf16_f32 v113, v40, v44
    v_cvt_pk_bf16_f32 v115, v41, v45
    v_smfmac_f32_16x16x64_bf16 v[48:51], v[12:15], a[240:247], v116
    ds_write2_b32 v120, v113, v115 offset0:0 offset1:16
    v_smfmac_f32_16x16x64_bf16 v[52:55], v[12:15], a[248:255], v116
    s_cmp_eq_u32 s22, 63
    s_cbranch_scc1 L_chain_last_s
    buffer_store_dword v126, off, s[8:11], s44 sc1
    v_smfmac_f32_16x16x64_bf16 v[48:51], v[16:19], v[128:135], v116
    v_smfmac_f32_16x16x64_bf16 v[48:51], v[20:23], v[160:167], v116
    v_smfmac_f32_16x16x64_bf16 v[48:51], v[24:27], v[144:151], v116
    s_waitcnt lgkmcnt(0)
    s_barrier
    v_smfmac_f32_16x16x64_bf16 v[48:51], v[28:31], v[176:183], v116
    ds_read_b128 v[32:35], v121 offset:16384
    ds_read_b128 v[36:39], v121 offset:17408
    v_smfmac_f32_16x16x64_bf16 v[52:55], v[16:19], v[136:143], v116
    ds_read_b128 v[40:43], v121 offset:18432
    ds_read_b128 v[44:47], v121 offset:19456
    v_smfmac_f32_16x16x64_bf16 v[52:55], v[20:23], v[168:175], v116
    ds_read_b128 v[8:11], v124 offset:32768
    v_add_f32 v48, v48, v50
    v_smfmac_f32_16x16x64_bf16 v[52:55], v[24:27], v[152:159], v116
    ds_read_b128 v[12:15], v124 offset:33792
    v_add_f32 v49, v49, v51
    v_smfmac_f32_16x16x64_bf16 v[52:55], v[28:31], v[184:191], v116
    s_waitcnt lgkmcnt(5)
    v_cvt_pk_bf16_f32 v112, v48, v49
    v_mfma_f32_16x16x32_bf16 v[56:59], v[56:59], v[32:35], 0
    s_waitcnt lgkmcnt(4)
    v_mov_b32 v48, s50
    v_mov_b32 v49, s50
    v_mfma_f32_16x16x32_bf16 v[56:59], v[60:63], v[36:39], v[56:59]
    ds_read_b128 v[16:19], v124 offset:2048
    s_waitcnt lgkmcnt(4)
    v_mov_b32 v50, s50
    v_mov_b32 v51, s50
    v_mfma_f32_16x16x32_bf16 v[56:59], v[64:67], v[40:43], v[56:59]
    ds_read_b128 v[20:23], v124 offset:3072
    s_waitcnt lgkmcnt(4)
    v_add_f32 v52, v52, v54
    v_mfma_f32_16x16x32_bf16 v[56:59], v[68:71], v[44:47], v[56:59]
    ds_read_b128 v[24:27], v124 offset:4096
    v_add_f32 v53, v53, v55
    v_mfma_f32_16x16x32_bf16 v[60:63], v[72:75], v[32:35], 0
    ds_read_b128 v[28:31], v124 offset:5120
    v_cvt_pk_bf16_f32 v114, v52, v53
    v_mov_b32 v53, 0
    v_mfma_f32_16x16x32_bf16 v[60:63], v[76:79], v[36:39], v[60:63]
    v_exp_f32 v56, v56
    v_mfma_f32_16x16x32_bf16 v[60:63], v[80:83], v[40:43], v[60:63]
    v_exp_f32 v57, v57
    v_mfma_f32_16x16x32_bf16 v[60:63], v[84:87], v[44:47], v[60:63]
    v_exp_f32 v58, v58
    v_mfma_f32_16x16x32_bf16 v[64:67], v[32:35], v[32:35], 0
    v_exp_f32 v59, v59
    v_cvt_pk_bf16_f32 v68, v56, v57
    v_mfma_f32_16x16x32_bf16 v[64:67], v[36:39], v[36:39], v[64:67]
    v_exp_f32 v60, v60
    v_cvt_pk_bf16_f32 v69, v58, v59
    v_mfma_f32_16x16x32_bf16 v[64:67], v[40:43], v[40:43], v[64:67]
    v_exp_f32 v61, v61
    v_mfma_f32_16x16x32_bf16 v[64:67], v[44:47], v[44:47], v[64:67]
    v_exp_f32 v62, v62
    v_exp_f32 v63, v63
    v_cvt_pk_bf16_f32 v70, v60, v61
    v_cvt_pk_bf16_f32 v71, v62, v63
    s_nop 1
    v_mfma_f32_16x16x32_bf16 v[72:75], v[88:91], v[68:71], 0
    s_nop 0
    v_exp_f32 v64, v64
    v_mfma_f32_16x16x32_bf16 v[76:79], v[92:95], v[68:71], 0
    v_exp_f32 v65, v65
    v_mfma_f32_16x16x32_bf16 v[80:83], v[48:51], v[68:71], 0
    v_cvt_pk_bf16_f32 v52, v64, v65
    s_nop 1
    v_mfma_f32_16x16x16_bf16 v[72:75], v[112:113], v[52:53], v[72:75]
    ds_read_b128 v[32:35], v124 offset:6144
    v_mfma_f32_16x16x16_bf16 v[76:79], v[114:115], v[52:53], v[76:79]
    ds_read_b128 v[36:39], v124 offset:7168
    v_mfma_f32_16x16x16_bf16 v[80:83], v[48:49], v[52:53], v[80:83]
L_norm_61:
    s_mov_b64 vcc, s[36:37]
    v_mov_b32 v122, v122
    v_mov_b32 v122, v122
    v_mov_b32 v122, v122
    v_cndmask_b32_dpp v76, v72, v76, vcc quad_perm:[2,3,2,3] row_mask:0xf bank_mask:0xf
    v_cndmask_b32_dpp v77, v73, v77, vcc quad_perm:[2,3,2,3] row_mask:0xf bank_mask:0xf
    v_cndmask_b32_dpp v78, v74, v78, vcc quad_perm:[2,3,2,3] row_mask:0xf bank_mask:0xf
    v_cndmask_b32_dpp v79, v75, v79, vcc quad_perm:[2,3,2,3] row_mask:0xf bank_mask:0xf
    v_rcp_f32_dpp v84, v80 quad_perm:[2,3,2,3] row_mask:0xf bank_mask:0xf
    s_nop 0
    v_pk_mul_f32 v[76:77], v[76:77], v[84:85] op_sel_hi:[1,0]
    v_pk_mul_f32 v[78:79], v[78:79], v[84:85] op_sel_hi:[1,0]
    v_cvt_pk_bf16_f32 v72, v76, v77
    v_cvt_pk_bf16_f32 v73, v78, v79
    ds_write_b64 v122, v[72:73] offset:20480
    v_max_f32_dpp v86, v80, v84 quad_perm:[2,3,2,3] row_mask:0xf bank_mask:0xf
    v_mov_b32_dpp v60, v72 quad_perm:[0,1,0,1] row_mask:0xf bank_mask:0xf
    v_mov_b32_dpp v61, v73 quad_perm:[0,1,0,1] row_mask:0xf bank_mask:0xf
    v_cmp_lt_f32 vcc, s35, v86
    v_mov_b32_dpp v62, v72 quad_perm:[2,3,2,3] row_mask:0xf bank_mask:0xf
    v_mov_b32_dpp v63, v73 quad_perm:[2,3,2,3] row_mask:0xf bank_mask:0xf
    s_nop 1
    v_smfmac_f32_16x16x64_bf16 v[96:99], v[60:63], v[192:199], v116
    s_cbranch_vccnz L_smax_62
    v_smfmac_f32_16x16x64_bf16 v[100:103], v[60:63], v[224:231], v116
    s_waitcnt lgkmcnt(0)
    s_barrier
    ds_read_b128 v[92:95], v127 offset:20992
    ds_read_b128 v[80:83], v127 offset:21504
    ds_read_b128 v[84:87], v127 offset:22016
    v_smfmac_f32_16x16x64_bf16 v[104:107], v[60:63], v[0:7], v116
    ds_read_b128 v[40:43], v124 offset:34816
    v_smfmac_f32_16x16x64_bf16 v[108:111], v[60:63], v[8:15], v116
    ds_read_b128 v[56:59], v124 offset:36864
    s_waitcnt lgkmcnt(4)
    v_smfmac_f32_16x16x64_bf16 v[96:99], v[92:95], v[200:207], v116
    s_waitcnt lgkmcnt(3)
    v_smfmac_f32_16x16x64_bf16 v[96:99], v[80:83], v[208:215], v116
    ds_read_b128 v[44:47], v124 offset:35840
    s_waitcnt lgkmcnt(3)
    v_smfmac_f32_16x16x64_bf16 v[96:99], v[84:87], v[216:223], v116
    ds_read_b128 v[68:71], v124 offset:39936
    v_smfmac_f32_16x16x64_bf16 v[100:103], v[92:95], v[232:239], v116
    ds_read_b128 v[64:67], v124 offset:38912
    v_smfmac_f32_16x16x64_bf16 v[100:103], v[80:83], v[240:247], v116
    ds_read_b128 v[60:63], v124 offset:37888
    v_cvt_pk_bf16_f32 v72, v96, v98
    v_smfmac_f32_16x16x64_bf16 v[100:103], v[84:87], v[248:255], v116
    v_and_or_b32 v72, v72, -2, s33
    v_smfmac_f32_16x16x64_bf16 v[104:107], v[92:95], v[16:23], v116
    v_cvt_pk_bf16_f32 v74, v97, v99
    v_smfmac_f32_16x16x64_bf16 v[104:107], v[80:83], v[24:31], v116
    v_cvt_pk_bf16_f32 v73, v100, v102
    v_cvt_pk_bf16_f32 v75, v101, v103
    v_smfmac_f32_16x16x64_bf16 v[104:107], v[84:87], v[32:39], v116
    buffer_store_dwordx4 v[72:75], v118, s[8:11], s25 offen sc1
    s_waitcnt lgkmcnt(3)
    v_smfmac_f32_16x16x64_bf16 v[108:111], v[92:95], v[40:47], v116
    s_waitcnt lgkmcnt(0)
    v_smfmac_f32_16x16x64_bf16 v[108:111], v[80:83], v[56:63], v116
    v_cvt_pk_bf16_f32 v76, v104, v106
    v_smfmac_f32_16x16x64_bf16 v[108:111], v[84:87], v[64:71], v116
    v_and_or_b32 v76, v76, -2, s33
    v_cvt_pk_bf16_f32 v78, v105, v107
    v_mov_b32 v122, v122
    v_mov_b32 v122, v122
    v_mov_b32 v122, v122
    v_mov_b32 v122, v122
    v_mov_b32 v122, v122
    v_mov_b32 v122, v122
    v_cvt_pk_bf16_f32 v77, v108, v110
    v_cvt_pk_bf16_f32 v79, v109, v111
    buffer_store_dwordx4 v[76:79], v118, s[8:11], s26 offen sc1
    s_add_u32 s30, s30, 0x40000
    s_add_u32 s31, s31, 0x40000
    s_add_u32 s32, s32, 0x20000
    s_add_u32 s23, s24, 0
    s_add_u32 s48, s23, 4096
    s_xor_b32 s25, s25, 0x40000
    s_xor_b32 s26, s26, 0x40000
    s_mov_b32 s35, 0x49800000
    v_mov_b32 v126, s22
    s_add_u32 s22, s22, 1
    v_mov_b32 v32, 0
    v_mov_b32 v33, 0
    v_mov_b32 v34, 0
    v_mov_b32 v35, 0
    v_mov_b32 v36, 0
    v_mov_b32 v37, 0
    v_mov_b32 v38, 0
    v_mov_b32 v39, 0
    v_mov_b32 v40, 0
    v_mov_b32 v41, 0
    v_mov_b32 v42, 0
    v_mov_b32 v43, 0
    v_mov_b32 v44, 0
    v_mov_b32 v45, 0
    v_mov_b32 v46, 0
    v_mov_b32 v47, 0
    v_mov_b32 v48, 0
    v_mov_b32 v49, 0
    v_mov_b32 v50, 0
    v_mov_b32 v51, 0
    v_mov_b32 v52, 0
    v_mov_b32 v53, 0
    v_mov_b32 v54, 0
    v_mov_b32 v55, 0
    ds_read_b128 v[80:83], v123
    ds_read_b128 v[84:87], v123 offset:1024
    ds_read_b128 v[56:59], v123 offset:2048
    ds_read_b128 v[60:63], v123 offset:3072
    ds_read_b128 v[64:67], v123 offset:32768
    ds_read_b128 v[68:71], v123 offset:33792
    ds_read_b128 v[72:75], v123 offset:34816
    ds_read_b128 v[76:79], v123 offset:35840
    ds_read_b128 v[88:91], v123 offset:4096
    ds_read_b128 v[92:95], v123 offset:5120
    ds_read_b128 v[96:99], v123 offset:6144
    ds_read_b128 v[100:103], v123 offset:7168
    ds_read_b128 v[104:107], v123 offset:36864
    ds_read_b128 v[108:111], v123 offset:37888
    ds_read_b128 v[24:27], v123 offset:38912
    ds_read_b128 v[28:31], v123 offset:39936
    s_add_u32 s24, s24, 8192
    s_bitset0_b32 s24, 15
    s_xor_b32 s55, s24, 16384
    s_xor_b32 s29, s29, 0x40000
    s_xor_b32 s53, s29, 1024
    s_bfe_u32 s33, s22, 0x10001
    s_add_u32 s40, s22, 5
    s_lshr_b32 s40, s40, 2
    s_min_u32 s40, s40, 16
    s_bfm_b32 s58, s40, 0
    s_waitcnt vmcnt(5)
    v_cmp_eq_u32 vcc, 0, v125
    s_nop 0
    s_and_b64 vcc, vcc, s[58:59]
    s_cbranch_scc1 L_kvw_63
L_kvb_64:
    v_mov_b32 v15, 0
    s_nop 2
    v_mov_b32 v15, 0
    s_nop 2
    v_mov_b32 v15, 0
    s_nop 2
    v_mov_b32 v15, 0
    s_nop 2
    v_mov_b32 v15, 0
    s_nop 2
    v_mov_b32 v15, 0
    s_nop 2
    v_mov_b32 v15, 0
    s_nop 2
    v_mov_b32 v15, 0
    s_nop 2
    v_mov_b32 v15, 0
    s_nop 2
    v_mov_b32 v15, 0
    s_nop 2
    v_mov_b32 v15, 0
    s_nop 2
    v_mov_b32 v15, 0
    s_nop 2
    v_mov_b32 v15, 0
    s_nop 2
    v_mov_b32 v15, 0
    s_nop 2
    v_mov_b32 v15, 0
    s_nop 2
    v_mov_b32 v15, 0
    s_nop 2
    v_mov_b32 v15, 0
    s_nop 2
    v_mov_b32 v15, 0
    s_nop 2
    v_mov_b32 v15, 0
    s_nop 2
    v_mov_b32 v15, 0
    s_nop 2
    v_mov_b32 v15, 0
    s_nop 2
    v_mov_b32 v15, 0
    s_nop 2
    v_mov_b32 v15, 0
    s_nop 2
    v_mov_b32 v15, 0
    s_nop 2
    v_mov_b32 v15, 0
    s_nop 2
    v_mov_b32 v15, 0
    s_nop 2
    v_mov_b32 v15, 0
    s_nop 2
    v_mov_b32 v15, 0
    s_nop 2
    v_mov_b32 v15, 0
    s_nop 2
    v_mov_b32 v15, 0
    s_nop 2
    v_mov_b32 v15, 0
    s_nop 2
    s_waitcnt lgkmcnt(0)
    s_branch L_chain_top0_s
.p2align 6
L_chain_top1_s:
    buffer_load_dwordx4 v[0:3], v117, s[8:11], s23 offen sc1
    v_mov_b32 v15, 0
    v_mov_b32 v15, 0
    v_mov_b32 v15, 0
    v_mov_b32 v15, 0
    v_mov_b32 v15, 0
    v_mov_b32 v15, 0
    v_mov_b32 v15, 0
    v_mov_b32 v15, 0
    v_mov_b32 v15, 0
    v_mov_b32 v15, 0
    v_mov_b32 v15, 0
    v_mov_b32 v15, 0
    v_mov_b32 v15, 0
    v_mov_b32 v15, 0
    v_mov_b32 v15, 0
    v_mov_b32 v15, 0
    buffer_load_dwordx4 v[0:3], v117, s[8:11], s23 offen sc1
    v_mov_b32 v15, 0
    v_mov_b32 v15, 0
    v_mov_b32 v15, 0
    v_mov_b32 v15, 0
    v_mov_b32 v15, 0
    v_mov_b32 v15, 0
    v_mov_b32 v15, 0
    v_mov_b32 v15, 0
    v_mov_b32 v15, 0
    v_mov_b32 v15, 0
    v_mov_b32 v15, 0
    v_mov_b32 v15, 0
    v_mov_b32 v15, 0
    v_mov_b32 v15, 0
    v_mov_b32 v15, 0
    v_mov_b32 v15, 0
L_mret_65:
    buffer_load_dwordx4 v[0:3], v117, s[8:11], s23 offen sc1
    s_add_u32 s45, s45, 1
    s_cmp_lt_u32 s45, 0x10000
    s_cselect_b32 s56, -2, -1
    s_nop 3
    v_mov_b32 v32, 0
    v_mov_b32 v33, 0
    v_mov_b32 v34, 0
    v_mov_b32 v35, 0
    s_waitcnt vmcnt(2)
    v_max3_u32 v15, v0, v1, v2
    v_max_u32 v15, v15, v3
    v_cmp_lt_u32 vcc, s56, v15
    v_smfmac_f32_16x16x64_bf16 v[32:35], v[0:3], v[80:87], v116
    s_cbranch_vccnz L_mret_65
    ds_write_b128 v117, v[0:3] offset:1024
    v_smfmac_f32_16x16x64_bf16 v[36:39], v[0:3], v[56:63], v116
    buffer_load_dwordx4 v[4:7], v117, s[8:11], s48 offen sc1
    v_smfmac_f32_16x16x64_bf16 v[40:43], v[0:3], v[64:71], v116
    buffer_load_dwordx4 v117, s[8:11], s48 offen sc1 lds
    s_mov_b32 m0, 10240
    v_smfmac_f32_16x16x64_bf16 v[44:47], v[0:3], v[72:79], v116
    s_waitcnt lgkmcnt(0)
    s_barrier
    ds_read_b128 v[8:11], v117
    v_smfmac_f32_16x16x64_bf16 v[48:51], v[0:3], a[192:199], v116
    ds_read_b128 v[16:19], v117 offset:3072
    ds_read_b128 v[20:23], v117 offset:2048
    v_smfmac_f32_16x16x64_bf16 v[52:55], v[0:3], a[200:207], v116
    ds_read_b128 v[80:83], v117 offset:14336
    s_waitcnt lgkmcnt(3)
    v_smfmac_f32_16x16x64_bf16 v[32:35], v[8:11], a[0:7], v116
    ds_read_b128 v[84:87], v117 offset:15360
    v_smfmac_f32_16x16x64_bf16 v[36:39], v[8:11], a[8:15], v116
    ds_read_b128 v[56:59], v117 offset:8192
    s_waitcnt lgkmcnt(4)
    v_smfmac_f32_16x16x64_bf16 v[32:35], v[16:19], a[32:39], v116
    ds_read_b128 v[60:63], v117 offset:9216
    v_smfmac_f32_16x16x64_bf16 v[36:39], v[16:19], a[40:47], v116
    buffer_store_dwordx4 v[112:115], v117, s[8:11], s32 offen sc1
    s_waitcnt lgkmcnt(4)
    v_smfmac_f32_16x16x64_bf16 v[32:35], v[20:23], a[64:71], v116
    ds_read_b128 v[64:67], v117 offset:10240
    v_smfmac_f32_16x16x64_bf16 v[36:39], v[20:23], a[72:79], v116
    ds_read_b128 v[68:71], v117 offset:11264
    v_smfmac_f32_16x16x64_bf16 v[40:43], v[8:11], a[96:103], v116
    ds_read_b128 v[72:75], v117 offset:12288
    v_smfmac_f32_16x16x64_bf16 v[40:43], v[16:19], a[128:135], v116
    ds_read_b128 v[76:79], v117 offset:13312
    v_smfmac_f32_16x16x64_bf16 v[40:43], v[20:23], a[160:167], v116
    s_waitcnt vmcnt(2)
    v_max3_u32 v15, v4, v5, v6
    v_smfmac_f32_16x16x64_bf16 v[44:47], v[8:11], a[104:111], v116
    v_max_u32 v15, v15, v7
    v_smfmac_f32_16x16x64_bf16 v[44:47], v[16:19], a[136:143], v116
    s_waitcnt vmcnt(1) lgkmcnt(0)
    v_cmp_lt_u32 vcc, s56, v15
    v_smfmac_f32_16x16x64_bf16 v[44:47], v[20:23], a[168:175], v116
    s_cbranch_vccnz L_mret_66
L_mgo_67:
    v_smfmac_f32_16x16x64_bf16 v[44:47], v[4:7], v[24:31], v116
    s_barrier
    ds_read_b128 v[12:15], v117 offset:4096
    v_smfmac_f32_16x16x64_bf16 v[32:35], v[4:7], v[88:95], v116
    ds_read_b128 v[24:27], v117 offset:7168
    v_smfmac_f32_16x16x64_bf16 v[36:39], v[4:7], v[96:103], v116
    ds_read_b128 v[28:31], v117 offset:6144
    v_smfmac_f32_16x16x64_bf16 v[40:43], v[4:7], v[104:111], v116
    ds_read_b128 v[88:91], v117 offset:26624
    s_waitcnt lgkmcnt(3)
    v_smfmac_f32_16x16x64_bf16 v[32:35], v[12:15], a[16:23], v116
    ds_read_b128 v[92:95], v117 offset:27648
    s_waitcnt lgkmcnt(3)
    v_smfmac_f32_16x16x64_bf16 v[32:35], v[24:27], a[48:55], v116
    buffer_load_dwordx4 v117, s[8:11], s30 offen lds
    s_waitcnt lgkmcnt(2)
    v_smfmac_f32_16x16x64_bf16 v[32:35], v[28:31], a[80:87], v116
    ds_read_b128 v[96:99], v117 offset:23552
    v_smfmac_f32_16x16x64_bf16 v[36:39], v[12:15], a[24:31], v116
    ds_read_b128 v[100:103], v117 offset:23552
    v_smfmac_f32_16x16x64_bf16 v[36:39], v[24:27], a[56:63], v116
    buffer_load_dwordx4 v117, s[8:11], s30 offen offset:1024 lds
    s_add_u32 m0, s52, 0x6000
    v_add_f32 v32, v32, v34
    v_smfmac_f32_16x16x64_bf16 v[36:39], v[28:31], a[88:95], v116
    ds_read_b128 v[104:107], v117 offset:23552
    v_add_f32 v33, v33, v35
    v_smfmac_f32_16x16x64_bf16 v[40:43], v[12:15], a[112:119], v116
    ds_read_b128 v[108:111], v117 offset:23552
    v_mul_f32 v32, s34, v32
    v_smfmac_f32_16x16x64_bf16 v[40:43], v[24:27], a[144:151], v116
    buffer_load_dword v125, v119, s[8:11], s28 offen sc1
    v_mul_f32 v33, s34, v33
    v_smfmac_f32_16x16x64_bf16 v[40:43], v[28:31], a[176:183], v116
    ds_read_b128 v[0:3], v124
    v_add_f32 v36, v36, v38
    v_smfmac_f32_16x16x64_bf16 v[48:51], v[4:7], a[208:215], v116
    v_add_f32 v37, v37, v39
    v_smfmac_f32_16x16x64_bf16 v[52:55], v[4:7], a[216:223], v116
    s_waitcnt lgkmcnt(5)
    buffer_load_dwordx4 v117, s[8:11], s31 offen lds
    v_mul_f32 v36, s34, v36
    v_smfmac_f32_16x16x64_bf16 v[44:47], v[12:15], a[120:127], v116
    ds_read_b128 v[4:7], v124 offset:1024
    v_mul_f32 v37, s34, v37
    v_smfmac_f32_16x16x64_bf16 v[44:47], v[24:27], a[152:159], v116
    v_cvt_pk_bf16_f32 v34, v32, v36
    v_smfmac_f32_16x16x64_bf16 v[44:47], v[28:31], a[184:191], v116
    buffer_load_dwordx4 v117, s[8:11], s31 offen offset:1024 lds
    s_mov_b32 m0, 5120
    v_cvt_pk_bf16_f32 v35, v33, v37
    v_add_f32 v40, v40, v42
    v_smfmac_f32_16x16x64_bf16 v[48:51], v[8:11], a[224:231], v116
    ds_write2_b32 v120, v34, v35 offset0:32 offset1:48
    v_add_f32 v41, v41, v43
    v_smfmac_f32_16x16x64_bf16 v[52:55], v[8:11], a[232:239], v116
    v_add_f32 v44, v44, v46
    v_add_f32 v45, v45, v47
    v_cvt_pk_bf16_f32 v113, v40, v44
    v_cvt_pk_bf16_f32 v115, v41, v45
    v_smfmac_f32_16x16x64_bf16 v[48:51], v[12:15], a[240:247], v116
    ds_write2_b32 v120, v113, v115 offset0:0 offset1:16
    v_smfmac_f32_16x16x64_bf16 v[52:55], v[12:15], a[248:255], v116
    s_cmp_eq_u32 s22, 63
    s_cbranch_scc1 L_chain_last_s
    v_smfmac_f32_16x16x64_bf16 v[48:51], v[16:19], v[128:135], v116
    v_smfmac_f32_16x16x64_bf16 v[48:51], v[20:23], v[160:167], v116
    v_smfmac_f32_16x16x64_bf16 v[48:51], v[24:27], v[144:151], v116
    s_waitcnt lgkmcnt(0)
    s_barrier
    v_smfmac_f32_16x16x64_bf16 v[48:51], v[28:31], v[176:183], v116
    ds_read_b128 v[32:35], v121 offset:16384
    ds_read_b128 v[36:39], v121 offset:17408
    v_smfmac_f32_16x16x64_bf16 v[52:55], v[16:19], v[136:143], v116
    ds_read_b128 v[40:43], v121 offset:18432
    ds_read_b128 v[44:47], v121 offset:19456
    v_smfmac_f32_16x16x64_bf16 v[52:55], v[20:23], v[168:175], v116
    ds_read_b128 v[8:11], v124 offset:32768
    v_add_f32 v48, v48, v50
    v_smfmac_f32_16x16x64_bf16 v[52:55], v[24:27], v[152:159], v116
    ds_read_b128 v[12:15], v124 offset:33792
    v_add_f32 v49, v49, v51
    v_smfmac_f32_16x16x64_bf16 v[52:55], v[28:31], v[184:191], v116
    s_waitcnt lgkmcnt(5)
    v_cvt_pk_bf16_f32 v112, v48, v49
    v_mfma_f32_16x16x32_bf16 v[56:59], v[56:59], v[32:35], 0
    s_waitcnt lgkmcnt(4)
    v_mov_b32 v48, s50
    v_mov_b32 v49, s50
    v_mfma_f32_16x16x32_bf16 v[56:59], v[60:63], v[36:39], v[56:59]
    ds_read_b128 v[16:19], v124 offset:2048
    s_waitcnt lgkmcnt(4)
    v_mov_b32 v50, s50
    v_mov_b32 v51, s50
    v_mfma_f32_16x16x32_bf16 v[56:59], v[64:67], v[40:43], v[56:59]
    ds_read_b128 v[20:23], v124 offset:3072
    s_waitcnt lgkmcnt(4)
    v_add_f32 v52, v52, v54
    v_mfma_f32_16x16x32_bf16 v[56:59], v[68:71], v[44:47], v[56:59]
    ds_read_b128 v[24:27], v124 offset:4096
    v_add_f32 v53, v53, v55
    v_mfma_f32_16x16x32_bf16 v[60:63], v[72:75], v[32:35], 0
    ds_read_b128 v[28:31], v124 offset:5120
    v_cvt_pk_bf16_f32 v114, v52, v53
    v_mov_b32 v53, 0
    v_mfma_f32_16x16x32_bf16 v[60:63], v[76:79], v[36:39], v[60:63]
    v_exp_f32 v56, v56
    v_mfma_f32_16x16x32_bf16 v[60:63], v[80:83], v[40:43], v[60:63]
    v_exp_f32 v57, v57
    v_mfma_f32_16x16x32_bf16 v[60:63], v[84:87], v[44:47], v[60:63]
    v_exp_f32 v58, v58
    v_mfma_f32_16x16x32_bf16 v[64:67], v[32:35], v[32:35], 0
    v_exp_f32 v59, v59
    v_cvt_pk_bf16_f32 v68, v56, v57
    v_mfma_f32_16x16x32_bf16 v[64:67], v[36:39], v[36:39], v[64:67]
    v_exp_f32 v60, v60
    v_cvt_pk_bf16_f32 v69, v58, v59
    v_mfma_f32_16x16x32_bf16 v[64:67], v[40:43], v[40:43], v[64:67]
    v_exp_f32 v61, v61
    v_mfma_f32_16x16x32_bf16 v[64:67], v[44:47], v[44:47], v[64:67]
    v_exp_f32 v62, v62
    v_exp_f32 v63, v63
    v_cvt_pk_bf16_f32 v70, v60, v61
    v_cvt_pk_bf16_f32 v71, v62, v63
    s_nop 1
    v_mfma_f32_16x16x32_bf16 v[72:75], v[88:91], v[68:71], 0
    s_nop 0
    v_exp_f32 v64, v64
    v_mfma_f32_16x16x32_bf16 v[76:79], v[92:95], v[68:71], 0
    v_exp_f32 v65, v65
    v_mfma_f32_16x16x32_bf16 v[80:83], v[48:51], v[68:71], 0
    v_cvt_pk_bf16_f32 v52, v64, v65
    s_nop 1
    v_mfma_f32_16x16x16_bf16 v[72:75], v[112:113], v[52:53], v[72:75]
    ds_read_b128 v[32:35], v124 offset:6144
    v_mfma_f32_16x16x16_bf16 v[76:79], v[114:115], v[52:53], v[76:79]
    ds_read_b128 v[36:39], v124 offset:7168
    v_mfma_f32_16x16x16_bf16 v[80:83], v[48:49], v[52:53], v[80:83]
L_norm_68:
    s_mov_b64 vcc, s[36:37]
    v_mov_b32 v122, v122
    v_mov_b32 v122, v122
    v_mov_b32 v122, v122
    v_cndmask_b32_dpp v76, v72, v76, vcc quad_perm:[2,3,2,3] row_mask:0xf bank_mask:0xf
    v_cndmask_b32_dpp v77, v73, v77, vcc quad_perm:[2,3,2,3] row_mask:0xf bank_mask:0xf
    v_cndmask_b32_dpp v78, v74, v78, vcc quad_perm:[2,3,2,3] row_mask:0xf bank_mask:0xf
    v_cndmask_b32_dpp v79, v75, v79, vcc quad_perm:[2,3,2,3] row_mask:0xf bank_mask:0xf
    v_rcp_f32_dpp v84, v80 quad_perm:[2,3,2,3] row_mask:0xf bank_mask:0xf
    s_nop 0
    v_pk_mul_f32 v[76:77], v[76:77], v[84:85] op_sel_hi:[1,0]
    v_pk_mul_f32 v[78:79], v[78:79], v[84:85] op_sel_hi:[1,0]
    v_cvt_pk_bf16_f32 v72, v76, v77
    v_cvt_pk_bf16_f32 v73, v78, v79
    ds_write_b64 v122, v[72:73] offset:20992
    v_max_f32_dpp v86, v80, v84 quad_perm:[2,3,2,3] row_mask:0xf bank_mask:0xf
    v_mov_b32_dpp v60, v72 quad_perm:[0,1,0,1] row_mask:0xf bank_mask:0xf
    v_mov_b32_dpp v61, v73 quad_perm:[0,1,0,1] row_mask:0xf bank_mask:0xf
    v_cmp_lt_f32 vcc, s35, v86
    v_mov_b32_dpp v62, v72 quad_perm:[2,3,2,3] row_mask:0xf bank_mask:0xf
    v_mov_b32_dpp v63, v73 quad_perm:[2,3,2,3] row_mask:0xf bank_mask:0xf
    s_nop 1
    v_smfmac_f32_16x16x64_bf16 v[96:99], v[60:63], v[192:199], v116
    s_cbranch_vccnz L_smax_69
    v_smfmac_f32_16x16x64_bf16 v[100:103], v[60:63], v[224:231], v116
    s_waitcnt lgkmcnt(0)
    s_barrier
    ds_read_b128 v[92:95], v127 offset:20480
    ds_read_b128 v[80:83], v127 offset:22016
    ds_read_b128 v[84:87], v127 offset:21504
    v_smfmac_f32_16x16x64_bf16 v[104:107], v[60:63], v[0:7], v116
    ds_read_b128 v[40:43], v124 offset:34816
    v_smfmac_f32_16x16x64_bf16 v[108:111], v[60:63], v[8:15], v116
    ds_read_b128 v[56:59], v124 offset:36864
    s_waitcnt lgkmcnt(4)
    v_smfmac_f32_16x16x64_bf16 v[96:99], v[92:95], v[200:207], v116
    s_waitcnt lgkmcnt(3)
    v_smfmac_f32_16x16x64_bf16 v[96:99], v[80:83], v[208:215], v116
    ds_read_b128 v[44:47], v124 offset:35840
    s_waitcnt lgkmcnt(3)
    v_smfmac_f32_16x16x64_bf16 v[96:99], v[84:87], v[216:223], v116
    ds_read_b128 v[68:71], v124 offset:39936
    v_smfmac_f32_16x16x64_bf16 v[100:103], v[92:95], v[232:239], v116
    ds_read_b128 v[64:67], v124 offset:38912
    v_smfmac_f32_16x16x64_bf16 v[100:103], v[80:83], v[240:247], v116
    ds_read_b128 v[60:63], v124 offset:37888
    v_cvt_pk_bf16_f32 v72, v96, v98
    v_smfmac_f32_16x16x64_bf16 v[100:103], v[84:87], v[248:255], v116
    v_and_or_b32 v72, v72, -2, s33
    v_smfmac_f32_16x16x64_bf16 v[104:107], v[92:95], v[16:23], v116
    v_cvt_pk_bf16_f32 v74, v97, v99
    v_smfmac_f32_16x16x64_bf16 v[104:107], v[80:83], v[24:31], v116
    v_cvt_pk_bf16_f32 v73, v100, v102
    v_cvt_pk_bf16_f32 v75, v101, v103
    v_smfmac_f32_16x16x64_bf16 v[104:107], v[84:87], v[32:39], v116
    buffer_store_dwordx4 v[72:75], v118, s[8:11], s25 offen sc1
    s_waitcnt lgkmcnt(3)
    v_smfmac_f32_16x16x64_bf16 v[108:111], v[92:95], v[40:47], v116
    s_waitcnt lgkmcnt(0)
    v_smfmac_f32_16x16x64_bf16 v[108:111], v[80:83], v[56:63], v116
    v_cvt_pk_bf16_f32 v76, v104, v106
    v_smfmac_f32_16x16x64_bf16 v[108:111], v[84:87], v[64:71], v116
    v_and_or_b32 v76, v76, -2, s33
    v_cvt_pk_bf16_f32 v78, v105, v107
    v_mov_b32 v122, v122
    v_mov_b32 v122, v122
    v_mov_b32 v122, v122
    v_mov_b32 v122, v122
    v_mov_b32 v122, v122
    v_mov_b32 v122, v122
    v_cvt_pk_bf16_f32 v77, v108, v110
    v_cvt_pk_bf16_f32 v79, v109, v111
    buffer_store_dwordx4 v[76:79], v118, s[8:11], s26 offen sc1
    s_add_u32 s30, s30, 0x40000
    s_add_u32 s31, s31, 0x40000
    s_add_u32 s32, s32, 0x20000
    s_add_u32 s23, s24, 1024
    s_add_u32 s48, s23, 4096
    s_xor_b32 s25, s25, 0x40000
    s_xor_b32 s26, s26, 0x40000
    s_mov_b32 s35, 0x49800000
    s_add_u32 s22, s22, 1
    v_mov_b32 v32, 0
    v_mov_b32 v33, 0
    v_mov_b32 v34, 0
    v_mov_b32 v35, 0
    v_mov_b32 v36, 0
    v_mov_b32 v37, 0
    v_mov_b32 v38, 0
    v_mov_b32 v39, 0
    v_mov_b32 v40, 0
    v_mov_b32 v41, 0
    v_mov_b32 v42, 0
    v_mov_b32 v43, 0
    v_mov_b32 v44, 0
    v_mov_b32 v45, 0
    v_mov_b32 v46, 0
    v_mov_b32 v47, 0
    v_mov_b32 v48, 0
    v_mov_b32 v49, 0
    v_mov_b32 v50, 0
    v_mov_b32 v51, 0
    v_mov_b32 v52, 0
    v_mov_b32 v53, 0
    v_mov_b32 v54, 0
    v_mov_b32 v55, 0
    ds_read_b128 v[80:83], v123
    ds_read_b128 v[84:87], v123 offset:1024
    ds_read_b128 v[56:59], v123 offset:2048
    ds_read_b128 v[60:63], v123 offset:3072
    ds_read_b128 v[64:67], v123 offset:32768
    ds_read_b128 v[68:71], v123 offset:33792
    ds_read_b128 v[72:75], v123 offset:34816
    ds_read_b128 v[76:79], v123 offset:35840
    ds_read_b128 v[88:91], v123 offset:4096
    ds_read_b128 v[92:95], v123 offset:5120
    ds_read_b128 v[96:99], v123 offset:6144
    ds_read_b128 v[100:103], v123 offset:7168
    ds_read_b128 v[104:107], v123 offset:36864
    ds_read_b128 v[108:111], v123 offset:37888
    ds_read_b128 v[24:27], v123 offset:38912
    ds_read_b128 v[28:31], v123 offset:39936
    s_add_u32 s24, s24, 8192
    s_bitset0_b32 s24, 15
    s_xor_b32 s55, s24, 16384
    s_xor_b32 s29, s29, 0x40000
    s_xor_b32 s53, s29, 1024
    s_bfe_u32 s33, s22, 0x10001
    s_add_u32 s40, s22, 5
    s_lshr_b32 s40, s40, 2
    s_min_u32 s40, s40, 16
    s_bfm_b32 s58, s40, 0
    s_waitcnt vmcnt(4)
    v_cmp_eq_u32 vcc, 0, v125
    s_nop 0
    s_and_b64 vcc, vcc, s[58:59]
    s_cbranch_scc1 L_kvw_70
L_kvb_71:
    v_mov_b32 v15, 0
    s_nop 2
    v_mov_b32 v15, 0
    s_nop 2
    v_mov_b32 v15, 0
    s_nop 2
    v_mov_b32 v15, 0
    s_nop 2
    v_mov_b32 v15, 0
    s_nop 2
    v_mov_b32 v15, 0
    s_nop 2
    v_mov_b32 v15, 0
    s_nop 2
    v_mov_b32 v15, 0
    s_nop 2
    v_mov_b32 v15, 0
    s_nop 2
    v_mov_b32 v15, 0
    s_nop 2
    v_mov_b32 v15, 0
    s_nop 2
    v_mov_b32 v15, 0
    s_nop 2
    v_mov_b32 v15, 0
    s_nop 2
    v_mov_b32 v15, 0
    s_nop 2
    v_mov_b32 v15, 0
    s_nop 2
    v_mov_b32 v15, 0
    s_nop 2
    v_mov_b32 v15, 0
    s_nop 2
    v_mov_b32 v15, 0
    s_nop 2
    v_mov_b32 v15, 0
    s_nop 2
    v_mov_b32 v15, 0
    s_nop 2
    v_mov_b32 v15, 0
    s_nop 2
    v_mov_b32 v15, 0
    s_nop 2
    v_mov_b32 v15, 0
    s_nop 2
    v_mov_b32 v15, 0
    s_nop 2
    v_mov_b32 v15, 0
    s_nop 2
    v_mov_b32 v15, 0
    s_nop 2
    v_mov_b32 v15, 0
    s_nop 2
    v_mov_b32 v15, 0
    s_nop 2
    v_mov_b32 v15, 0
    s_nop 2
    v_mov_b32 v15, 0
    s_nop 2
    v_mov_b32 v15, 0
    s_nop 2
    s_waitcnt lgkmcnt(0)
    s_branch L_chain_top1_s
.p2align 6
L_chain_top2_s:
    buffer_load_dwordx4 v[0:3], v117, s[8:11], s23 offen sc1
    v_mov_b32 v48, 0
    v_mov_b32 v49, 0
    v_mov_b32 v50, 0
    v_mov_b32 v51, 0
    v_mov_b32 v52, 0
    v_mov_b32 v53, 0
    v_mov_b32 v15, 0
    v_mov_b32 v15, 0
    v_mov_b32 v15, 0
    v_mov_b32 v15, 0
    v_mov_b32 v15, 0
    v_mov_b32 v15, 0
    v_mov_b32 v15, 0
    v_mov_b32 v15, 0
    v_mov_b32 v15, 0
    v_mov_b32 v15, 0
    buffer_load_dwordx4 v[0:3], v117, s[8:11], s23 offen sc1
    s_waitcnt vmcnt(3)
    v_mov_b32 v36, 0
    v_mov_b32 v37, 0
    v_mov_b32 v38, 0
    v_mov_b32 v39, 0
    v_mov_b32 v40, 0
    v_mov_b32 v41, 0
    v_mov_b32 v42, 0
    v_mov_b32 v43, 0
    v_mov_b32 v44, 0
    v_mov_b32 v45, 0
    v_mov_b32 v46, 0
    v_mov_b32 v47, 0
    v_mov_b32 v15, 0
    v_mov_b32 v15, 0
    v_mov_b32 v15, 0
    v_mov_b32 v15, 0
L_mret_72:
    buffer_load_dwordx4 v[0:3], v117, s[8:11], s23 offen sc1
    s_add_u32 s45, s45, 1
    s_cmp_lt_u32 s45, 0x10000
    s_cselect_b32 s56, -2, -1
    s_nop 3
    v_mov_b32 v32, 0
    v_mov_b32 v33, 0
    v_mov_b32 v34, 0
    v_mov_b32 v35, 0
    s_waitcnt vmcnt(2)
    v_max3_u32 v15, v0, v1, v2
    v_max_u32 v15, v15, v3
    v_cmp_lt_u32 vcc, s56, v15
    v_smfmac_f32_16x16x64_bf16 v[32:35], v[0:3], v[80:87], v116
    s_cbranch_vccnz L_mret_72
    ds_write_b128 v117, v[0:3] offset:2048
    v_smfmac_f32_16x16x64_bf16 v[36:39], v[0:3], v[56:63], v116
    buffer_load_dwordx4 v[4:7], v117, s[8:11], s48 offen sc1
    v_smfmac_f32_16x16x64_bf16 v[40:43], v[0:3], v[64:71], v116
    buffer_load_dwordx4 v117, s[8:11], s48 offen sc1 lds
    s_mov_b32 m0, 12288
    v_smfmac_f32_16x16x64_bf16 v[44:47], v[0:3], v[72:79], v116
    s_waitcnt lgkmcnt(0)
    s_barrier
    ds_read_b128 v[8:11], v117 offset:3072
    v_smfmac_f32_16x16x64_bf16 v[48:51], v[0:3], a[192:199], v116
    ds_read_b128 v[16:19], v117
    ds_read_b128 v[20:23], v117 offset:1024
    v_smfmac_f32_16x16x64_bf16 v[52:55], v[0:3], a[200:207], v116
    ds_read_b128 v[80:83], v117 offset:14336
    s_waitcnt lgkmcnt(3)
    v_smfmac_f32_16x16x64_bf16 v[32:35], v[8:11], a[0:7], v116
    ds_read_b128 v[84:87], v117 offset:15360
    v_smfmac_f32_16x16x64_bf16 v[36:39], v[8:11], a[8:15], v116
    ds_read_b128 v[56:59], v117 offset:8192
    s_waitcnt lgkmcnt(4)
    v_smfmac_f32_16x16x64_bf16 v[32:35], v[16:19], a[32:39], v116
    ds_read_b128 v[60:63], v117 offset:9216
    v_smfmac_f32_16x16x64_bf16 v[36:39], v[16:19], a[40:47], v116
    ds_read_b128 v[64:67], v117 offset:10240
    s_waitcnt lgkmcnt(5)
    v_smfmac_f32_16x16x64_bf16 v[32:35], v[20:23], a[64:71], v116
    ds_read_b128 v[68:71], v117 offset:11264
    v_smfmac_f32_16x16x64_bf16 v[36:39], v[20:23], a[72:79], v116
    buffer_store_dwordx4 v[112:115], v117, s[8:11], s32 offen sc1
    v_smfmac_f32_16x16x64_bf16 v[40:43], v[8:11], a[96:103], v116
    ds_read_b128 v[72:75], v117 offset:12288
    v_smfmac_f32_16x16x64_bf16 v[40:43], v[16:19], a[128:135], v116
    ds_read_b128 v[76:79], v117 offset:13312
    v_smfmac_f32_16x16x64_bf16 v[40:43], v[20:23], a[160:167], v116
    s_waitcnt vmcnt(2)
    v_max3_u32 v15, v4, v5, v6
    v_smfmac_f32_16x16x64_bf16 v[44:47], v[8:11], a[104:111], v116
    v_max_u32 v15, v15, v7
    v_smfmac_f32_16x16x64_bf16 v[44:47], v[16:19], a[136:143], v116
    s_waitcnt vmcnt(1) lgkmcnt(0)
    v_cmp_lt_u32 vcc, s56, v15
    v_smfmac_f32_16x16x64_bf16 v[44:47], v[20:23], a[168:175], v116
    s_cbranch_vccnz L_mret_73
L_mgo_74:
    v_smfmac_f32_16x16x64_bf16 v[44:47], v[4:7], v[24:31], v116
    s_barrier
    ds_read_b128 v[12:15], v117 offset:7168
    v_smfmac_f32_16x16x64_bf16 v[32:35], v[4:7], v[88:95], v116
    ds_read_b128 v[24:27], v117 offset:4096
    v_smfmac_f32_16x16x64_bf16 v[36:39], v[4:7], v[96:103], v116
    ds_read_b128 v[28:31], v117 offset:5120
    v_smfmac_f32_16x16x64_bf16 v[40:43], v[4:7], v[104:111], v116
    ds_read_b128 v[88:91], v117 offset:28672
    s_waitcnt lgkmcnt(3)
    v_smfmac_f32_16x16x64_bf16 v[32:35], v[12:15], a[16:23], v116
    ds_read_b128 v[92:95], v117 offset:29696
    s_waitcnt lgkmcnt(3)
    v_smfmac_f32_16x16x64_bf16 v[32:35], v[24:27], a[48:55], v116
    buffer_load_dwordx4 v117, s[8:11], s30 offen lds
    s_waitcnt lgkmcnt(2)
    v_smfmac_f32_16x16x64_bf16 v[32:35], v[28:31], a[80:87], v116
    ds_read_b128 v[96:99], v117 offset:23552
    v_smfmac_f32_16x16x64_bf16 v[36:39], v[12:15], a[24:31], v116
    ds_read_b128 v[100:103], v117 offset:23552
    v_smfmac_f32_16x16x64_bf16 v[36:39], v[24:27], a[56:63], v116
    buffer_load_dwordx4 v117, s[8:11], s30 offen offset:1024 lds
    s_add_u32 m0, s52, 0x6000
    v_add_f32 v32, v32, v34
    v_smfmac_f32_16x16x64_bf16 v[36:39], v[28:31], a[88:95], v116
    ds_read_b128 v[104:107], v117 offset:23552
    v_add_f32 v33, v33, v35
    v_smfmac_f32_16x16x64_bf16 v[40:43], v[12:15], a[112:119], v116
    ds_read_b128 v[108:111], v117 offset:23552
    v_mul_f32 v32, s34, v32
    v_smfmac_f32_16x16x64_bf16 v[40:43], v[24:27], a[144:151], v116
    s_waitcnt lgkmcnt(4)
    buffer_load_dwordx4 v117, s[8:11], s31 offen lds
    v_mul_f32 v33, s34, v33
    v_smfmac_f32_16x16x64_bf16 v[40:43], v[28:31], a[176:183], v116
    ds_read_b128 v[0:3], v124
    v_add_f32 v36, v36, v38
    v_smfmac_f32_16x16x64_bf16 v[48:51], v[4:7], a[208:215], v116
    v_add_f32 v37, v37, v39
    v_smfmac_f32_16x16x64_bf16 v[52:55], v[4:7], a[216:223], v116
    buffer_load_dwordx4 v117, s[8:11], s31 offen offset:1024 lds
    s_mov_b32 m0, 6144
    v_mul_f32 v36, s34, v36
    v_smfmac_f32_16x16x64_bf16 v[44:47], v[12:15], a[120:127], v116
    ds_read_b128 v[4:7], v124 offset:1024
    v_mul_f32 v37, s34, v37
    v_smfmac_f32_16x16x64_bf16 v[44:47], v[24:27], a[152:159], v116
    v_cvt_pk_bf16_f32 v34, v32, v36
    v_smfmac_f32_16x16x64_bf16 v[44:47], v[28:31], a[184:191], v116
    v_cvt_pk_bf16_f32 v35, v33, v37
    v_add_f32 v40, v40, v42
    v_smfmac_f32_16x16x64_bf16 v[48:51], v[8:11], a[224:231], v116
    ds_write2_b32 v120, v34, v35 offset0:32 offset1:48
    v_add_f32 v41, v41, v43
    v_smfmac_f32_16x16x64_bf16 v[52:55], v[8:11], a[232:239], v116
    v_add_f32 v44, v44, v46
    v_add_f32 v45, v45, v47
    v_cvt_pk_bf16_f32 v113, v40, v44
    v_cvt_pk_bf16_f32 v115, v41, v45
    v_smfmac_f32_16x16x64_bf16 v[48:51], v[12:15], a[240:247], v116
    ds_write2_b32 v120, v113, v115 offset0:0 offset1:16
    v_smfmac_f32_16x16x64_bf16 v[52:55], v[12:15], a[248:255], v116
    s_cmp_eq_u32 s22, 63
    s_cbranch_scc1 L_chain_last_s
    v_smfmac_f32_16x16x64_bf16 v[48:51], v[16:19], v[128:135], v116
    buffer_store_dword v126, v119, s[8:11], s55 offen sc1
    v_smfmac_f32_16x16x64_bf16 v[48:51], v[20:23], v[160:167], v116
    v_smfmac_f32_16x16x64_bf16 v[48:51], v[24:27], v[144:151], v116
    s_waitcnt lgkmcnt(0)
    s_barrier
    v_smfmac_f32_16x16x64_bf16 v[48:51], v[28:31], v[176:183], v116
    ds_read_b128 v[32:35], v121 offset:16384
    ds_read_b128 v[36:39], v121 offset:17408
    v_smfmac_f32_16x16x64_bf16 v[52:55], v[16:19], v[136:143], v116
    ds_read_b128 v[40:43], v121 offset:18432
    ds_read_b128 v[44:47], v121 offset:19456
    v_smfmac_f32_16x16x64_bf16 v[52:55], v[20:23], v[168:175], v116
    ds_read_b128 v[8:11], v124 offset:32768
    v_add_f32 v48, v48, v50
    v_smfmac_f32_16x16x64_bf16 v[52:55], v[24:27], v[152:159], v116
    ds_read_b128 v[12:15], v124 offset:33792
    v_add_f32 v49, v49, v51
    v_smfmac_f32_16x16x64_bf16 v[52:55], v[28:31], v[184:191], v116
    s_waitcnt lgkmcnt(5)
    v_cvt_pk_bf16_f32 v112, v48, v49
    v_mfma_f32_16x16x32_bf16 v[56:59], v[56:59], v[32:35], 0
    s_waitcnt lgkmcnt(4)
    v_mov_b32 v48, s50
    v_mov_b32 v49, s50
    v_mfma_f32_16x16x32_bf16 v[56:59], v[60:63], v[36:39], v[56:59]
    ds_read_b128 v[16:19], v124 offset:2048
    s_waitcnt lgkmcnt(4)
    v_mov_b32 v50, s50
    v_mov_b32 v51, s50
    v_mfma_f32_16x16x32_bf16 v[56:59], v[64:67], v[40:43], v[56:59]
    ds_read_b128 v[20:23], v124 offset:3072
    s_waitcnt lgkmcnt(4)
    v_add_f32 v52, v52, v54
    v_mfma_f32_16x16x32_bf16 v[56:59], v[68:71], v[44:47], v[56:59]
    ds_read_b128 v[24:27], v124 offset:4096
    v_add_f32 v53, v53, v55
    v_mfma_f32_16x16x32_bf16 v[60:63], v[72:75], v[32:35], 0
    ds_read_b128 v[28:31], v124 offset:5120
    v_cvt_pk_bf16_f32 v114, v52, v53
    v_mov_b32 v53, 0
    v_mfma_f32_16x16x32_bf16 v[60:63], v[76:79], v[36:39], v[60:63]
    v_exp_f32 v56, v56
    v_mfma_f32_16x16x32_bf16 v[60:63], v[80:83], v[40:43], v[60:63]
    v_exp_f32 v57, v57
    v_mfma_f32_16x16x32_bf16 v[60:63], v[84:87], v[44:47], v[60:63]
    v_exp_f32 v58, v58
    v_mfma_f32_16x16x32_bf16 v[64:67], v[32:35], v[32:35], 0
    v_exp_f32 v59, v59
    v_cvt_pk_bf16_f32 v68, v56, v57
    v_mfma_f32_16x16x32_bf16 v[64:67], v[36:39], v[36:39], v[64:67]
    v_exp_f32 v60, v60
    v_cvt_pk_bf16_f32 v69, v58, v59
    v_mfma_f32_16x16x32_bf16 v[64:67], v[40:43], v[40:43], v[64:67]
    v_exp_f32 v61, v61
    v_mfma_f32_16x16x32_bf16 v[64:67], v[44:47], v[44:47], v[64:67]
    v_exp_f32 v62, v62
    v_exp_f32 v63, v63
    v_cvt_pk_bf16_f32 v70, v60, v61
    v_cvt_pk_bf16_f32 v71, v62, v63
    s_nop 1
    v_mfma_f32_16x16x32_bf16 v[72:75], v[88:91], v[68:71], 0
    s_nop 0
    v_exp_f32 v64, v64
    v_mfma_f32_16x16x32_bf16 v[76:79], v[92:95], v[68:71], 0
    v_exp_f32 v65, v65
    v_mfma_f32_16x16x32_bf16 v[80:83], v[48:51], v[68:71], 0
    v_cvt_pk_bf16_f32 v52, v64, v65
    s_nop 1
    v_mfma_f32_16x16x16_bf16 v[72:75], v[112:113], v[52:53], v[72:75]
    ds_read_b128 v[32:35], v124 offset:6144
    v_mfma_f32_16x16x16_bf16 v[76:79], v[114:115], v[52:53], v[76:79]
    ds_read_b128 v[36:39], v124 offset:7168
    v_mfma_f32_16x16x16_bf16 v[80:83], v[48:49], v[52:53], v[80:83]
L_norm_75:
    s_mov_b64 vcc, s[36:37]
    v_mov_b32 v122, v122
    v_mov_b32 v122, v122
    v_mov_b32 v122, v122
    v_cndmask_b32_dpp v76, v72, v76, vcc quad_perm:[2,3,2,3] row_mask:0xf bank_mask:0xf
    v_cndmask_b32_dpp v77, v73, v77, vcc quad_perm:[2,3,2,3] row_mask:0xf bank_mask:0xf
    v_cndmask_b32_dpp v78, v74, v78, vcc quad_perm:[2,3,2,3] row_mask:0xf bank_mask:0xf
    v_cndmask_b32_dpp v79, v75, v79, vcc quad_perm:[2,3,2,3] row_mask:0xf bank_mask:0xf
    v_rcp_f32_dpp v84, v80 quad_perm:[2,3,2,3] row_mask:0xf bank_mask:0xf
    s_nop 0
    v_pk_mul_f32 v[76:77], v[76:77], v[84:85] op_sel_hi:[1,0]
    v_pk_mul_f32 v[78:79], v[78:79], v[84:85] op_sel_hi:[1,0]
    v_cvt_pk_bf16_f32 v72, v76, v77
    v_cvt_pk_bf16_f32 v73, v78, v79
    ds_write_b64 v122, v[72:73] offset:21504
    v_max_f32_dpp v86, v80, v84 quad_perm:[2,3,2,3] row_mask:0xf bank_mask:0xf
    v_mov_b32_dpp v60, v72 quad_perm:[0,1,0,1] row_mask:0xf bank_mask:0xf
    v_mov_b32_dpp v61, v73 quad_perm:[0,1,0,1] row_mask:0xf bank_mask:0xf
    v_cmp_lt_f32 vcc, s35, v86
    v_mov_b32_dpp v62, v72 quad_perm:[2,3,2,3] row_mask:0xf bank_mask:0xf
    v_mov_b32_dpp v63, v73 quad_perm:[2,3,2,3] row_mask:0xf bank_mask:0xf
    s_nop 1
    v_smfmac_f32_16x16x64_bf16 v[96:99], v[60:63], v[192:199], v116
    s_cbranch_vccnz L_smax_76
    v_smfmac_f32_16x16x64_bf16 v[100:103], v[60:63], v[224:231], v116
    s_waitcnt lgkmcnt(0)
    s_barrier
    ds_read_b128 v[92:95], v127 offset:22016
    ds_read_b128 v[80:83], v127 offset:20480
    ds_read_b128 v[84:87], v127 offset:20992
    v_smfmac_f32_16x16x64_bf16 v[104:107], v[60:63], v[0:7], v116
    ds_read_b128 v[40:43], v124 offset:34816
    v_smfmac_f32_16x16x64_bf16 v[108:111], v[60:63], v[8:15], v116
    ds_read_b128 v[56:59], v124 offset:36864
    s_waitcnt lgkmcnt(4)
    v_smfmac_f32_16x16x64_bf16 v[96:99], v[92:95], v[200:207], v116
    s_waitcnt lgkmcnt(3)
    v_smfmac_f32_16x16x64_bf16 v[96:99], v[80:83], v[208:215], v116
    ds_read_b128 v[44:47], v124 offset:35840
    s_waitcnt lgkmcnt(3)
    v_smfmac_f32_16x16x64_bf16 v[96:99], v[84:87], v[216:223], v116
    ds_read_b128 v[68:71], v124 offset:39936
    v_smfmac_f32_16x16x64_bf16 v[100:103], v[92:95], v[232:239], v116
    ds_read_b128 v[64:67], v124 offset:38912
    v_smfmac_f32_16x16x64_bf16 v[100:103], v[80:83], v[240:247], v116
    ds_read_b128 v[60:63], v124 offset:37888
    v_cvt_pk_bf16_f32 v72, v96, v98
    v_smfmac_f32_16x16x64_bf16 v[100:103], v[84:87], v[248:255], v116
    v_and_or_b32 v72, v72, -2, s33
    v_smfmac_f32_16x16x64_bf16 v[104:107], v[92:95], v[16:23], v116
    v_cvt_pk_bf16_f32 v74, v97, v99
    v_smfmac_f32_16x16x64_bf16 v[104:107], v[80:83], v[24:31], v116
    v_cvt_pk_bf16_f32 v73, v100, v102
    v_cvt_pk_bf16_f32 v75, v101, v103
    v_smfmac_f32_16x16x64_bf16 v[104:107], v[84:87], v[32:39], v116
    buffer_store_dwordx4 v[72:75], v118, s[8:11], s25 offen sc1
    s_waitcnt lgkmcnt(3)
    v_smfmac_f32_16x16x64_bf16 v[108:111], v[92:95], v[40:47], v116
    s_waitcnt lgkmcnt(0)
    v_smfmac_f32_16x16x64_bf16 v[108:111], v[80:83], v[56:63], v116
    v_cvt_pk_bf16_f32 v76, v104, v106
    v_smfmac_f32_16x16x64_bf16 v[108:111], v[84:87], v[64:71], v116
    v_and_or_b32 v76, v76, -2, s33
    v_cvt_pk_bf16_f32 v78, v105, v107
    v_mov_b32 v122, v122
    v_mov_b32 v122, v122
    v_mov_b32 v122, v122
    v_mov_b32 v122, v122
    v_mov_b32 v122, v122
    v_mov_b32 v122, v122
    v_cvt_pk_bf16_f32 v77, v108, v110
    v_cvt_pk_bf16_f32 v79, v109, v111
    buffer_store_dwordx4 v[76:79], v118, s[8:11], s26 offen sc1
    ds_read_b128 v[80:83], v123
    ds_read_b128 v[84:87], v123 offset:1024
    ds_read_b128 v[56:59], v123 offset:2048
    ds_read_b128 v[60:63], v123 offset:3072
    ds_read_b128 v[64:67], v123 offset:32768
    ds_read_b128 v[68:71], v123 offset:33792
    ds_read_b128 v[72:75], v123 offset:34816
    ds_read_b128 v[76:79], v123 offset:35840
    ds_read_b128 v[88:91], v123 offset:4096
    ds_read_b128 v[92:95], v123 offset:5120
    ds_read_b128 v[96:99], v123 offset:6144
    ds_read_b128 v[100:103], v123 offset:7168
    ds_read_b128 v[104:107], v123 offset:36864
    ds_read_b128 v[108:111], v123 offset:37888
    ds_read_b128 v[24:27], v123 offset:38912
    ds_read_b128 v[28:31], v123 offset:39936
    s_add_u32 s30, s30, 0x40000
    s_add_u32 s31, s31, 0x40000
    s_add_u32 s32, s32, 0x20000
    s_add_u32 s23, s24, 2048
    s_add_u32 s48, s23, 4096
    s_xor_b32 s25, s25, 0x40000
    s_xor_b32 s26, s26, 0x40000
    s_mov_b32 s35, 0x49800000
    s_add_u32 s22, s22, 1
    v_cndmask_b32 v12, 0, v125, s[68:69]
    v_cndmask_b32 v13, 0, v125, s[70:71]
    v_cndmask_b32 v14, 0, v125, s[72:73]
    v_cndmask_b32 v15, 0, v125, s[74:75]
    v_mov_b32 v54, 0
    v_mov_b32 v55, 0
    v_mov_b32 v52, 0
    v_mov_b32 v52, 0
    v_mov_b32 v52, 0
    v_mov_b32 v52, 0
    v_mov_b32 v52, 0
    v_mov_b32 v52, 0
    v_mov_b32 v52, 0
    v_mov_b32 v52, 0
    v_mov_b32 v52, 0
    v_mov_b32 v52, 0
    v_mov_b32 v52, 0
    v_mov_b32 v52, 0
    v_mov_b32 v52, 0
    v_mov_b32 v52, 0
    v_mov_b32 v52, 0
    v_mov_b32 v52, 0
    v_mov_b32 v52, 0
    v_mov_b32 v52, 0
    v_mov_b32 v52, 0
    buffer_load_dwordx4 v[4:7], v117, s[8:11], s29 offen sc1
    buffer_load_dwordx4 v[8:11], v117, s[8:11], s53 offen sc1
    buffer_load_dwordx4 v[16:19], v117, s[8:11], s29 offen offset:2048 sc1
    buffer_load_dwordx4 v[20:23], v117, s[8:11], s53 offen offset:2048 sc1
    v_mov_b32 v52, 0
    v_mov_b32 v52, 0
    v_mov_b32 v52, 0
    v_mov_b32 v52, 0
    v_mov_b32 v52, 0
    v_mov_b32 v52, 0
    v_mov_b32 v52, 0
    v_mov_b32 v52, 0
    v_mov_b32 v52, 0
    v_mov_b32 v52, 0
    v_mov_b32 v52, 0
    v_mov_b32 v52, 0
    v_mov_b32 v52, 0
    v_mov_b32 v52, 0
    v_mov_b32 v52, 0
    v_mov_b32 v52, 0
    v_mov_b32 v52, 0
    v_mov_b32 v52, 0
    v_mov_b32 v52, 0
    v_mov_b32 v52, 0
    v_mov_b32 v52, 0
    v_mov_b32 v52, 0
    v_mov_b32 v52, 0
    v_mov_b32 v52, 0
    v_mov_b32 v52, 0
    v_mov_b32 v52, 0
    v_mov_b32 v52, 0
    v_mov_b32 v52, 0
    v_mov_b32 v52, 0
    v_mov_b32 v52, 0
    v_mov_b32 v52, 0
    v_mov_b32 v52, 0
    v_mov_b32 v52, 0
    v_mov_b32 v52, 0
    v_mov_b32 v52, 0
    v_mov_b32 v52, 0
    v_mov_b32 v52, 0
    v_mov_b32 v52, 0
    v_mov_b32 v52, 0
    v_mov_b32 v52, 0
    buffer_load_dwordx4 v[32:35], v117, s[8:11], s29 offen sc1
    buffer_load_dwordx4 v[36:39], v117, s[8:11], s53 offen sc1
    buffer_load_dwordx4 v[40:43], v117, s[8:11], s29 offen offset:2048 sc1
    buffer_load_dwordx4 v[44:47], v117, s[8:11], s53 offen offset:2048 sc1
    v_mov_b32 v52, 0
L_rl_77:
    s_waitcnt vmcnt(7)
    v_mfma_f32_16x16x32_bf16 v[48:51], v[4:7], v[12:15], 0
    v_xor_b32 v52, s33, v4
    s_waitcnt vmcnt(6)
    v_mfma_f32_16x16x32_bf16 v[48:51], v[8:11], v[12:15], v[48:51]
    v_xor_b32 v53, s33, v8
    v_or_b32 v52, v52, v53
    s_waitcnt vmcnt(5)
    v_mfma_f32_16x16x32_bf16 v[48:51], v[16:19], v[12:15], v[48:51]
    v_xor_b32 v53, s33, v16
    v_or_b32 v52, v52, v53
    s_waitcnt vmcnt(4)
    v_mfma_f32_16x16x32_bf16 v[48:51], v[20:23], v[12:15], v[48:51]
    v_xor_b32 v53, s33, v20
    v_or_b32 v52, v52, v53
    v_and_b32 v52, 1, v52
    v_cmp_ne_u32 vcc, 0, v52
    s_cbranch_vccnz L_rslow_78
L_rgo_79:
    s_nop 2
    v_permlane32_swap_b32 v48, v50
    v_permlane32_swap_b32 v49, v51
    v_pk_add_f32 v[48:49], v[48:49], v[50:51]
    s_mov_b64 exec, s[38:39]
    v_cvt_pk_bf16_f32 v12, v48, v49
    v_min_u32 v12, 0xfffffffe, v12
    buffer_store_dword v12, v119, s[8:11], s24 offen sc1
    s_mov_b64 exec, -1
    s_add_u32 s24, s24, 8192
    s_bitset0_b32 s24, 15
    s_xor_b32 s55, s24, 16384
    s_xor_b32 s29, s29, 0x40000
    s_xor_b32 s53, s29, 1024
    s_bfe_u32 s33, s22, 0x10001
    s_waitcnt lgkmcnt(0)
    s_branch L_chain_top2_s
.p2align 6
L_chain_top3_s:
    buffer_load_dwordx4 v[0:3], v117, s[8:11], s23 offen sc1
    v_mov_b32 v48, 0
    v_mov_b32 v49, 0
    v_mov_b32 v50, 0
    v_mov_b32 v51, 0
    v_mov_b32 v52, 0
    v_mov_b32 v53, 0
    v_mov_b32 v15, 0
    v_mov_b32 v15, 0
    v_mov_b32 v15, 0
    v_mov_b32 v15, 0
    v_mov_b32 v15, 0
    v_mov_b32 v15, 0
    v_mov_b32 v15, 0
    v_mov_b32 v15, 0
    v_mov_b32 v15, 0
    v_mov_b32 v15, 0
    buffer_load_dwordx4 v[0:3], v117, s[8:11], s23 offen sc1
    s_waitcnt vmcnt(3)
    v_mov_b32 v36, 0
    v_mov_b32 v37, 0
    v_mov_b32 v38, 0
    v_mov_b32 v39, 0
    v_mov_b32 v40, 0
    v_mov_b32 v41, 0
    v_mov_b32 v42, 0
    v_mov_b32 v43, 0
    v_mov_b32 v44, 0
    v_mov_b32 v45, 0
    v_mov_b32 v46, 0
    v_mov_b32 v47, 0
    v_mov_b32 v15, 0
    v_mov_b32 v15, 0
    v_mov_b32 v15, 0
    v_mov_b32 v15, 0
L_mret_80:
    buffer_load_dwordx4 v[0:3], v117, s[8:11], s23 offen sc1
    s_add_u32 s45, s45, 1
    s_cmp_lt_u32 s45, 0x10000
    s_cselect_b32 s56, -2, -1
    s_nop 3
    v_mov_b32 v32, 0
    v_mov_b32 v33, 0
    v_mov_b32 v34, 0
    v_mov_b32 v35, 0
    s_waitcnt vmcnt(2)
    v_max3_u32 v15, v0, v1, v2
    v_max_u32 v15, v15, v3
    v_cmp_lt_u32 vcc, s56, v15
    v_smfmac_f32_16x16x64_bf16 v[32:35], v[0:3], v[80:87], v116
    s_cbranch_vccnz L_mret_80
    ds_write_b128 v117, v[0:3] offset:3072
    v_smfmac_f32_16x16x64_bf16 v[36:39], v[0:3], v[56:63], v116
    buffer_load_dwordx4 v[4:7], v117, s[8:11], s48 offen sc1
    v_smfmac_f32_16x16x64_bf16 v[40:43], v[0:3], v[64:71], v116
    buffer_load_dwordx4 v117, s[8:11], s48 offen sc1 lds
    s_mov_b32 m0, 14336
    v_smfmac_f32_16x16x64_bf16 v[44:47], v[0:3], v[72:79], v116
    s_waitcnt lgkmcnt(0)
    s_barrier
    ds_read_b128 v[8:11], v117 offset:2048
    v_smfmac_f32_16x16x64_bf16 v[48:51], v[0:3], a[192:199], v116
    ds_read_b128 v[16:19], v117 offset:1024
    ds_read_b128 v[20:23], v117
    v_smfmac_f32_16x16x64_bf16 v[52:55], v[0:3], a[200:207], v116
    ds_read_b128 v[80:83], v117 offset:14336
    s_waitcnt lgkmcnt(3)
    v_smfmac_f32_16x16x64_bf16 v[32:35], v[8:11], a[0:7], v116
    ds_read_b128 v[84:87], v117 offset:15360
    v_smfmac_f32_16x16x64_bf16 v[36:39], v[8:11], a[8:15], v116
    ds_read_b128 v[56:59], v117 offset:8192
    s_waitcnt lgkmcnt(4)
    v_smfmac_f32_16x16x64_bf16 v[32:35], v[16:19], a[32:39], v116
    ds_read_b128 v[60:63], v117 offset:9216
    v_smfmac_f32_16x16x64_bf16 v[36:39], v[16:19], a[40:47], v116
    ds_read_b128 v[64:67], v117 offset:10240
    s_waitcnt lgkmcnt(5)
    v_smfmac_f32_16x16x64_bf16 v[32:35], v[20:23], a[64:71], v116
    ds_read_b128 v[68:71], v117 offset:11264
    v_smfmac_f32_16x16x64_bf16 v[36:39], v[20:23], a[72:79], v116
    ds_read_b128 v[72:75], v117 offset:12288
    v_smfmac_f32_16x16x64_bf16 v[40:43], v[8:11], a[96:103], v116
    ds_read_b128 v[76:79], v117 offset:13312
    v_smfmac_f32_16x16x64_bf16 v[40:43], v[16:19], a[128:135], v116
    buffer_store_dwordx4 v[112:115], v117, s[8:11], s32 offen sc1
    v_smfmac_f32_16x16x64_bf16 v[40:43], v[20:23], a[160:167], v116
    s_waitcnt vmcnt(2)
    v_max3_u32 v15, v4, v5, v6
    v_smfmac_f32_16x16x64_bf16 v[44:47], v[8:11], a[104:111], v116
    v_max_u32 v15, v15, v7
    v_smfmac_f32_16x16x64_bf16 v[44:47], v[16:19], a[136:143], v116
    s_waitcnt vmcnt(1) lgkmcnt(0)
    v_cmp_lt_u32 vcc, s56, v15
    v_smfmac_f32_16x16x64_bf16 v[44:47], v[20:23], a[168:175], v116
    s_cbranch_vccnz L_mret_81
L_mgo_82:
    v_smfmac_f32_16x16x64_bf16 v[44:47], v[4:7], v[24:31], v116
    s_barrier
    ds_read_b128 v[12:15], v117 offset:6144
    v_smfmac_f32_16x16x64_bf16 v[32:35], v[4:7], v[88:95], v116
    ds_read_b128 v[24:27], v117 offset:5120
    v_smfmac_f32_16x16x64_bf16 v[36:39], v[4:7], v[96:103], v116
    ds_read_b128 v[28:31], v117 offset:4096
    v_smfmac_f32_16x16x64_bf16 v[40:43], v[4:7], v[104:111], v116
    ds_read_b128 v[88:91], v117 offset:30720
    s_waitcnt lgkmcnt(3)
    v_smfmac_f32_16x16x64_bf16 v[32:35], v[12:15], a[16:23], v116
    ds_read_b128 v[92:95], v117 offset:31744
    s_waitcnt lgkmcnt(3)
    v_smfmac_f32_16x16x64_bf16 v[32:35], v[24:27], a[48:55], v116
    ds_read_b128 v[96:99], v117 offset:23552
    s_waitcnt lgkmcnt(3)
    v_smfmac_f32_16x16x64_bf16 v[32:35], v[28:31], a[80:87], v116
    buffer_load_dwordx4 v117, s[8:11], s30 offen lds
    v_smfmac_f32_16x16x64_bf16 v[36:39], v[12:15], a[24:31], v116
    ds_read_b128 v[100:103], v117 offset:23552
    v_smfmac_f32_16x16x64_bf16 v[36:39], v[24:27], a[56:63], v116
    ds_read_b128 v[104:107], v117 offset:23552
    v_add_f32 v32, v32, v34
    v_smfmac_f32_16x16x64_bf16 v[36:39], v[28:31], a[88:95], v116
    buffer_load_dwordx4 v117, s[8:11], s30 offen offset:1024 lds
    s_add_u32 m0, s52, 0x6000
    v_add_f32 v33, v33, v35
    v_smfmac_f32_16x16x64_bf16 v[40:43], v[12:15], a[112:119], v116
    ds_read_b128 v[108:111], v117 offset:23552
    v_mul_f32 v32, s34, v32
    v_smfmac_f32_16x16x64_bf16 v[40:43], v[24:27], a[144:151], v116
    ds_read_b128 v[0:3], v124
    v_mul_f32 v33, s34, v33
    v_smfmac_f32_16x16x64_bf16 v[40:43], v[28:31], a[176:183], v116
    s_waitcnt lgkmcnt(5)
    buffer_load_dwordx4 v117, s[8:11], s31 offen lds
    v_add_f32 v36, v36, v38
    v_smfmac_f32_16x16x64_bf16 v[48:51], v[4:7], a[208:215], v116
    v_add_f32 v37, v37, v39
    v_smfmac_f32_16x16x64_bf16 v[52:55], v[4:7], a[216:223], v116
    ds_read_b128 v[4:7], v124 offset:1024
    v_mul_f32 v36, s34, v36
    v_smfmac_f32_16x16x64_bf16 v[44:47], v[12:15], a[120:127], v116
    buffer_load_dwordx4 v117, s[8:11], s31 offen offset:1024 lds
    s_mov_b32 m0, 7168
    v_mul_f32 v37, s34, v37
    v_smfmac_f32_16x16x64_bf16 v[44:47], v[24:27], a[152:159], v116
    v_cvt_pk_bf16_f32 v34, v32, v36
    v_smfmac_f32_16x16x64_bf16 v[44:47], v[28:31], a[184:191], v116
    v_cvt_pk_bf16_f32 v35, v33, v37
    v_add_f32 v40, v40, v42
    v_smfmac_f32_16x16x64_bf16 v[48:51], v[8:11], a[224:231], v116
    ds_write2_b32 v120, v34, v35 offset0:32 offset1:48
    v_add_f32 v41, v41, v43
    v_smfmac_f32_16x16x64_bf16 v[52:55], v[8:11], a[232:239], v116
    v_add_f32 v44, v44, v46
    v_add_f32 v45, v45, v47
    v_cvt_pk_bf16_f32 v113, v40, v44
    v_cvt_pk_bf16_f32 v115, v41, v45
    v_smfmac_f32_16x16x64_bf16 v[48:51], v[12:15], a[240:247], v116
    ds_write2_b32 v120, v113, v115 offset0:0 offset1:16
    v_smfmac_f32_16x16x64_bf16 v[52:55], v[12:15], a[248:255], v116
    s_cmp_eq_u32 s22, 63
    s_cbranch_scc1 L_chain_last_s
    v_smfmac_f32_16x16x64_bf16 v[48:51], v[16:19], v[128:135], v116
    v_smfmac_f32_16x16x64_bf16 v[48:51], v[20:23], v[160:167], v116
    buffer_store_dword v126, v119, s[8:11], s55 offen sc1
    v_smfmac_f32_16x16x64_bf16 v[48:51], v[24:27], v[144:151], v116
    s_waitcnt lgkmcnt(0)
    s_barrier
    v_smfmac_f32_16x16x64_bf16 v[48:51], v[28:31], v[176:183], v116
    ds_read_b128 v[32:35], v121 offset:16384
    ds_read_b128 v[36:39], v121 offset:17408
    v_smfmac_f32_16x16x64_bf16 v[52:55], v[16:19], v[136:143], v116
    ds_read_b128 v[40:43], v121 offset:18432
    ds_read_b128 v[44:47], v121 offset:19456
    v_smfmac_f32_16x16x64_bf16 v[52:55], v[20:23], v[168:175], v116
    ds_read_b128 v[8:11], v124 offset:32768
    v_add_f32 v48, v48, v50
    v_smfmac_f32_16x16x64_bf16 v[52:55], v[24:27], v[152:159], v116
    ds_read_b128 v[12:15], v124 offset:33792
    v_add_f32 v49, v49, v51
    v_smfmac_f32_16x16x64_bf16 v[52:55], v[28:31], v[184:191], v116
    s_waitcnt lgkmcnt(5)
    v_cvt_pk_bf16_f32 v112, v48, v49
    v_mfma_f32_16x16x32_bf16 v[56:59], v[56:59], v[32:35], 0
    s_waitcnt lgkmcnt(4)
    v_mov_b32 v48, s50
    v_mov_b32 v49, s50
    v_mfma_f32_16x16x32_bf16 v[56:59], v[60:63], v[36:39], v[56:59]
    ds_read_b128 v[16:19], v124 offset:2048
    s_waitcnt lgkmcnt(4)
    v_mov_b32 v50, s50
    v_mov_b32 v51, s50
    v_mfma_f32_16x16x32_bf16 v[56:59], v[64:67], v[40:43], v[56:59]
    ds_read_b128 v[20:23], v124 offset:3072
    s_waitcnt lgkmcnt(4)
    v_add_f32 v52, v52, v54
    v_mfma_f32_16x16x32_bf16 v[56:59], v[68:71], v[44:47], v[56:59]
    ds_read_b128 v[24:27], v124 offset:4096
    v_add_f32 v53, v53, v55
    v_mfma_f32_16x16x32_bf16 v[60:63], v[72:75], v[32:35], 0
    ds_read_b128 v[28:31], v124 offset:5120
    v_cvt_pk_bf16_f32 v114, v52, v53
    v_mov_b32 v53, 0
    v_mfma_f32_16x16x32_bf16 v[60:63], v[76:79], v[36:39], v[60:63]
    v_exp_f32 v56, v56
    v_mfma_f32_16x16x32_bf16 v[60:63], v[80:83], v[40:43], v[60:63]
    v_exp_f32 v57, v57
    v_mfma_f32_16x16x32_bf16 v[60:63], v[84:87], v[44:47], v[60:63]
    v_exp_f32 v58, v58
    v_mfma_f32_16x16x32_bf16 v[64:67], v[32:35], v[32:35], 0
    v_exp_f32 v59, v59
    v_cvt_pk_bf16_f32 v68, v56, v57
    v_mfma_f32_16x16x32_bf16 v[64:67], v[36:39], v[36:39], v[64:67]
    v_exp_f32 v60, v60
    v_cvt_pk_bf16_f32 v69, v58, v59
    v_mfma_f32_16x16x32_bf16 v[64:67], v[40:43], v[40:43], v[64:67]
    v_exp_f32 v61, v61
    v_mfma_f32_16x16x32_bf16 v[64:67], v[44:47], v[44:47], v[64:67]
    v_exp_f32 v62, v62
    v_exp_f32 v63, v63
    v_cvt_pk_bf16_f32 v70, v60, v61
    v_cvt_pk_bf16_f32 v71, v62, v63
    s_nop 1
    v_mfma_f32_16x16x32_bf16 v[72:75], v[88:91], v[68:71], 0
    s_nop 0
    v_exp_f32 v64, v64
    v_mfma_f32_16x16x32_bf16 v[76:79], v[92:95], v[68:71], 0
    v_exp_f32 v65, v65
    v_mfma_f32_16x16x32_bf16 v[80:83], v[48:51], v[68:71], 0
    v_cvt_pk_bf16_f32 v52, v64, v65
    s_nop 1
    v_mfma_f32_16x16x16_bf16 v[72:75], v[112:113], v[52:53], v[72:75]
    ds_read_b128 v[32:35], v124 offset:6144
    v_mfma_f32_16x16x16_bf16 v[76:79], v[114:115], v[52:53], v[76:79]
    ds_read_b128 v[36:39], v124 offset:7168
    v_mfma_f32_16x16x16_bf16 v[80:83], v[48:49], v[52:53], v[80:83]
L_norm_83:
    s_mov_b64 vcc, s[36:37]
    v_mov_b32 v122, v122
    v_mov_b32 v122, v122
    v_mov_b32 v122, v122
    v_cndmask_b32_dpp v76, v72, v76, vcc quad_perm:[2,3,2,3] row_mask:0xf bank_mask:0xf
    v_cndmask_b32_dpp v77, v73, v77, vcc quad_perm:[2,3,2,3] row_mask:0xf bank_mask:0xf
    v_cndmask_b32_dpp v78, v74, v78, vcc quad_perm:[2,3,2,3] row_mask:0xf bank_mask:0xf
    v_cndmask_b32_dpp v79, v75, v79, vcc quad_perm:[2,3,2,3] row_mask:0xf bank_mask:0xf
    v_rcp_f32_dpp v84, v80 quad_perm:[2,3,2,3] row_mask:0xf bank_mask:0xf
    s_nop 0
    v_pk_mul_f32 v[76:77], v[76:77], v[84:85] op_sel_hi:[1,0]
    v_pk_mul_f32 v[78:79], v[78:79], v[84:85] op_sel_hi:[1,0]
    v_cvt_pk_bf16_f32 v72, v76, v77
    v_cvt_pk_bf16_f32 v73, v78, v79
    ds_write_b64 v122, v[72:73] offset:22016
    v_max_f32_dpp v86, v80, v84 quad_perm:[2,3,2,3] row_mask:0xf bank_mask:0xf
    v_mov_b32_dpp v60, v72 quad_perm:[0,1,0,1] row_mask:0xf bank_mask:0xf
    v_mov_b32_dpp v61, v73 quad_perm:[0,1,0,1] row_mask:0xf bank_mask:0xf
    v_cmp_lt_f32 vcc, s35, v86
    v_mov_b32_dpp v62, v72 quad_perm:[2,3,2,3] row_mask:0xf bank_mask:0xf
    v_mov_b32_dpp v63, v73 quad_perm:[2,3,2,3] row_mask:0xf bank_mask:0xf
    s_nop 1
    v_smfmac_f32_16x16x64_bf16 v[96:99], v[60:63], v[192:199], v116
    s_cbranch_vccnz L_smax_84
    v_smfmac_f32_16x16x64_bf16 v[100:103], v[60:63], v[224:231], v116
    s_waitcnt lgkmcnt(0)
    s_barrier
    ds_read_b128 v[92:95], v127 offset:21504
    ds_read_b128 v[80:83], v127 offset:20992
    ds_read_b128 v[84:87], v127 offset:20480
    v_smfmac_f32_16x16x64_bf16 v[104:107], v[60:63], v[0:7], v116
    ds_read_b128 v[40:43], v124 offset:34816
    v_smfmac_f32_16x16x64_bf16 v[108:111], v[60:63], v[8:15], v116
    ds_read_b128 v[56:59], v124 offset:36864
    s_waitcnt lgkmcnt(4)
    v_smfmac_f32_16x16x64_bf16 v[96:99], v[92:95], v[200:207], v116
    s_waitcnt lgkmcnt(3)
    v_smfmac_f32_16x16x64_bf16 v[96:99], v[80:83], v[208:215], v116
    ds_read_b128 v[44:47], v124 offset:35840
    s_waitcnt lgkmcnt(3)
    v_smfmac_f32_16x16x64_bf16 v[96:99], v[84:87], v[216:223], v116
    ds_read_b128 v[68:71], v124 offset:39936
    v_smfmac_f32_16x16x64_bf16 v[100:103], v[92:95], v[232:239], v116
    ds_read_b128 v[64:67], v124 offset:38912
    v_smfmac_f32_16x16x64_bf16 v[100:103], v[80:83], v[240:247], v116
    ds_read_b128 v[60:63], v124 offset:37888
    v_cvt_pk_bf16_f32 v72, v96, v98
    v_smfmac_f32_16x16x64_bf16 v[100:103], v[84:87], v[248:255], v116
    v_and_or_b32 v72, v72, -2, s33
    v_smfmac_f32_16x16x64_bf16 v[104:107], v[92:95], v[16:23], v116
    v_cvt_pk_bf16_f32 v74, v97, v99
    v_smfmac_f32_16x16x64_bf16 v[104:107], v[80:83], v[24:31], v116
    v_cvt_pk_bf16_f32 v73, v100, v102
    v_cvt_pk_bf16_f32 v75, v101, v103
    v_smfmac_f32_16x16x64_bf16 v[104:107], v[84:87], v[32:39], v116
    buffer_store_dwordx4 v[72:75], v118, s[8:11], s25 offen sc1
    s_waitcnt lgkmcnt(3)
    v_smfmac_f32_16x16x64_bf16 v[108:111], v[92:95], v[40:47], v116
    s_waitcnt lgkmcnt(0)
    v_smfmac_f32_16x16x64_bf16 v[108:111], v[80:83], v[56:63], v116
    v_cvt_pk_bf16_f32 v76, v104, v106
    v_smfmac_f32_16x16x64_bf16 v[108:111], v[84:87], v[64:71], v116
    v_and_or_b32 v76, v76, -2, s33
    v_cvt_pk_bf16_f32 v78, v105, v107
    v_mov_b32 v122, v122
    v_mov_b32 v122, v122
    v_mov_b32 v122, v122
    v_mov_b32 v122, v122
    v_mov_b32 v122, v122
    v_mov_b32 v122, v122
    v_cvt_pk_bf16_f32 v77, v108, v110
    v_cvt_pk_bf16_f32 v79, v109, v111
    buffer_store_dwordx4 v[76:79], v118, s[8:11], s26 offen sc1
    ds_read_b128 v[80:83], v123
    ds_read_b128 v[84:87], v123 offset:1024
    ds_read_b128 v[56:59], v123 offset:2048
    ds_read_b128 v[60:63], v123 offset:3072
    ds_read_b128 v[64:67], v123 offset:32768
    ds_read_b128 v[68:71], v123 offset:33792
    ds_read_b128 v[72:75], v123 offset:34816
    ds_read_b128 v[76:79], v123 offset:35840
    ds_read_b128 v[88:91], v123 offset:4096
    ds_read_b128 v[92:95], v123 offset:5120
    ds_read_b128 v[96:99], v123 offset:6144
    ds_read_b128 v[100:103], v123 offset:7168
    ds_read_b128 v[104:107], v123 offset:36864
    ds_read_b128 v[108:111], v123 offset:37888
    ds_read_b128 v[24:27], v123 offset:38912
    ds_read_b128 v[28:31], v123 offset:39936
    s_add_u32 s30, s30, 0x40000
    s_add_u32 s31, s31, 0x40000
    s_add_u32 s32, s32, 0x20000
    s_add_u32 s23, s24, 3072
    s_add_u32 s48, s23, 4096
    s_xor_b32 s25, s25, 0x40000
    s_xor_b32 s26, s26, 0x40000
    s_mov_b32 s35, 0x49800000
    s_add_u32 s22, s22, 1
    v_cndmask_b32 v12, 0, v125, s[68:69]
    v_cndmask_b32 v13, 0, v125, s[70:71]
    v_cndmask_b32 v14, 0, v125, s[72:73]
    v_cndmask_b32 v15, 0, v125, s[74:75]
    v_mov_b32 v54, 0
    v_mov_b32 v55, 0
    v_mov_b32 v52, 0
    v_mov_b32 v52, 0
    v_mov_b32 v52, 0
    v_mov_b32 v52, 0
    v_mov_b32 v52, 0
    v_mov_b32 v52, 0
    v_mov_b32 v52, 0
    v_mov_b32 v52, 0
    v_mov_b32 v52, 0
    v_mov_b32 v52, 0
    v_mov_b32 v52, 0
    v_mov_b32 v52, 0
    v_mov_b32 v52, 0
    v_mov_b32 v52, 0
    v_mov_b32 v52, 0
    v_mov_b32 v52, 0
    v_mov_b32 v52, 0
    v_mov_b32 v52, 0
    v_mov_b32 v52, 0
    v_mov_b32 v52, 0
    v_mov_b32 v52, 0
    v_mov_b32 v52, 0
    v_mov_b32 v52, 0
    v_mov_b32 v52, 0
    v_mov_b32 v52, 0
    v_mov_b32 v52, 0
    v_mov_b32 v52, 0
    v_mov_b32 v52, 0
    v_mov_b32 v52, 0
    v_mov_b32 v52, 0
    v_mov_b32 v52, 0
    v_mov_b32 v52, 0
    v_mov_b32 v52, 0
    v_mov_b32 v52, 0
    v_mov_b32 v52, 0
    v_mov_b32 v52, 0
    v_mov_b32 v52, 0
    v_mov_b32 v52, 0
    v_mov_b32 v52, 0
    v_mov_b32 v52, 0
    v_mov_b32 v52, 0
    v_mov_b32 v52, 0
    v_mov_b32 v52, 0
    v_mov_b32 v52, 0
    v_mov_b32 v52, 0
    v_mov_b32 v52, 0
    v_mov_b32 v52, 0
    v_mov_b32 v52, 0
    v_mov_b32 v52, 0
    buffer_load_dwordx4 v[4:7], v117, s[8:11], s29 offen sc1
    buffer_load_dwordx4 v[8:11], v117, s[8:11], s53 offen sc1
    buffer_load_dwordx4 v[16:19], v117, s[8:11], s29 offen offset:2048 sc1
    buffer_load_dwordx4 v[20:23], v117, s[8:11], s53 offen offset:2048 sc1
    v_mov_b32 v52, 0
    v_mov_b32 v52, 0
    v_mov_b32 v52, 0
    v_mov_b32 v52, 0
    v_mov_b32 v52, 0
    v_mov_b32 v52, 0
    v_mov_b32 v52, 0
    v_mov_b32 v52, 0
    v_mov_b32 v52, 0
    v_mov_b32 v52, 0
    v_mov_b32 v52, 0
    v_mov_b32 v52, 0
    v_mov_b32 v52, 0
    v_mov_b32 v52, 0
    v_mov_b32 v52, 0
    v_mov_b32 v52, 0
    v_mov_b32 v52, 0
    v_mov_b32 v52, 0
    v_mov_b32 v52, 0
    v_mov_b32 v52, 0
    v_mov_b32 v52, 0
    v_mov_b32 v52, 0
    v_mov_b32 v52, 0
    v_mov_b32 v52, 0
    v_mov_b32 v52, 0
    v_mov_b32 v52, 0
    v_mov_b32 v52, 0
    v_mov_b32 v52, 0
    v_mov_b32 v52, 0
    v_mov_b32 v52, 0
    buffer_load_dwordx4 v[32:35], v117, s[8:11], s29 offen sc1
    buffer_load_dwordx4 v[36:39], v117, s[8:11], s53 offen sc1
    buffer_load_dwordx4 v[40:43], v117, s[8:11], s29 offen offset:2048 sc1
    buffer_load_dwordx4 v[44:47], v117, s[8:11], s53 offen offset:2048 sc1
    v_mov_b32 v52, 0
L_rl_85:
    s_waitcnt vmcnt(7)
    v_mfma_f32_16x16x32_bf16 v[48:51], v[4:7], v[12:15], 0
    v_xor_b32 v52, s33, v4
    s_waitcnt vmcnt(6)
    v_mfma_f32_16x16x32_bf16 v[48:51], v[8:11], v[12:15], v[48:51]
    v_xor_b32 v53, s33, v8
    v_or_b32 v52, v52, v53
    s_waitcnt vmcnt(5)
    v_mfma_f32_16x16x32_bf16 v[48:51], v[16:19], v[12:15], v[48:51]
    v_xor_b32 v53, s33, v16
    v_or_b32 v52, v52, v53
    s_waitcnt vmcnt(4)
    v_mfma_f32_16x16x32_bf16 v[48:51], v[20:23], v[12:15], v[48:51]
    v_xor_b32 v53, s33, v20
    v_or_b32 v52, v52, v53
    v_and_b32 v52, 1, v52
    v_cmp_ne_u32 vcc, 0, v52
    s_cbranch_vccnz L_rslow_86
L_rgo_87:
    s_nop 2
    v_permlane32_swap_b32 v48, v50
    v_permlane32_swap_b32 v49, v51
    v_pk_add_f32 v[48:49], v[48:49], v[50:51]
    s_mov_b64 exec, s[38:39]
    v_cvt_pk_bf16_f32 v12, v48, v49
    v_min_u32 v12, 0xfffffffe, v12
    buffer_store_dword v12, v119, s[8:11], s24 offen sc1
    s_mov_b64 exec, -1
    s_add_u32 s24, s24, 8192
    s_bitset0_b32 s24, 15
    s_xor_b32 s55, s24, 16384
    s_xor_b32 s29, s29, 0x40000
    s_xor_b32 s53, s29, 1024
    s_bfe_u32 s33, s22, 0x10001
    s_waitcnt lgkmcnt(0)
    s_branch L_chain_top3_s
L_chain_last_s:
    s_nop 1
    v_smfmac_f32_16x16x64_bf16 v[48:51], v[16:19], v[128:135], v116
    v_smfmac_f32_16x16x64_bf16 v[48:51], v[20:23], v[160:167], v116
    v_smfmac_f32_16x16x64_bf16 v[48:51], v[24:27], v[144:151], v116
    v_smfmac_f32_16x16x64_bf16 v[48:51], v[28:31], v[176:183], v116
    v_smfmac_f32_16x16x64_bf16 v[52:55], v[16:19], v[136:143], v116
    v_smfmac_f32_16x16x64_bf16 v[52:55], v[20:23], v[168:175], v116
    v_smfmac_f32_16x16x64_bf16 v[52:55], v[24:27], v[152:159], v116
    v_smfmac_f32_16x16x64_bf16 v[52:55], v[28:31], v[184:191], v116
    v_add_f32 v48, v48, v50
    v_add_f32 v49, v49, v51
    v_cvt_pk_bf16_f32 v112, v48, v49
    s_nop 4
    v_add_f32 v52, v52, v54
    v_add_f32 v53, v53, v55
    v_cvt_pk_bf16_f32 v114, v52, v53
    s_add_u32 s32, s32, 0x20000
    buffer_store_dwordx4 v[112:115], v117, s[8:11], s32 offen sc1
    v_mov_b32 v94, 64
    s_waitcnt vmcnt(0) lgkmcnt(0)
    s_barrier
    s_mov_b64 exec, 1
    buffer_store_dword v94, off, s[8:11], s44 sc1
    s_mov_b64 exec, -1
    s_endpgm
L_mret_59:
    s_mov_b32 s43, m0
    s_mov_b32 m0, 4096
    buffer_load_dwordx4 v[4:7], v117, s[8:11], s48 offen sc1
    buffer_load_dwordx4 v117, s[8:11], s48 offen sc1 lds
    s_mov_b32 m0, 8192
    s_mov_b32 m0, s43
    s_waitcnt vmcnt(0)
    v_max3_u32 v15, v4, v5, v6
    v_max_u32 v15, v15, v7
    v_cmp_lt_u32 vcc, s56, v15
    s_add_u32 s47, s47, 1
    s_add_u32 s49, s49, 1
    s_cmp_ge_u32 s49, 0x10000
    s_cbranch_scc1 L_mgo_60
    s_cbranch_vccnz L_mret_59
    s_branch L_mgo_60
L_smax_62:
    s_add_u32 s47, s47, 1
    s_mov_b32 s35, 0x7f800000
    s_waitcnt lgkmcnt(0)
    s_sub_u32 s43, s30, 0x40000
    s_add_u32 s40, s43, 4096
    s_nop 7
    buffer_load_dwordx4 v[56:59], v117, s[8:11], s43 offen
    buffer_load_dwordx4 v[60:63], v117, s[8:11], s43 offen offset:1024
    buffer_load_dwordx4 v[64:67], v117, s[8:11], s43 offen offset:2048
    buffer_load_dwordx4 v[68:71], v117, s[8:11], s43 offen offset:3072
    buffer_load_dwordx4 v[72:75], v117, s[8:11], s40 offen
    buffer_load_dwordx4 v[76:79], v117, s[8:11], s40 offen offset:1024
    buffer_load_dwordx4 v[80:83], v117, s[8:11], s40 offen offset:2048
    buffer_load_dwordx4 v[84:87], v117, s[8:11], s40 offen offset:3072
    ds_read_b128 v[32:35], v121 offset:16384
    ds_read_b128 v[36:39], v121 offset:17408
    ds_read_b128 v[40:43], v121 offset:18432
    ds_read_b128 v[44:47], v121 offset:19456
    v_mov_b32 v96, 0
    v_mov_b32 v97, 0
    v_mov_b32 v98, 0
    v_mov_b32 v99, 0
    v_mov_b32 v100, 0
    v_mov_b32 v101, 0
    v_mov_b32 v102, 0
    v_mov_b32 v103, 0
    v_mov_b32 v104, 0
    v_mov_b32 v105, 0
    v_mov_b32 v106, 0
    v_mov_b32 v107, 0
    v_mov_b32 v108, 0
    v_mov_b32 v109, 0
    v_mov_b32 v110, 0
    v_mov_b32 v111, 0
    s_waitcnt vmcnt(0) lgkmcnt(0)
    v_mfma_f32_16x16x32_bf16 v[56:59], v[56:59], v[32:35], 0
    v_mfma_f32_16x16x32_bf16 v[56:59], v[60:63], v[36:39], v[56:59]
    v_mfma_f32_16x16x32_bf16 v[56:59], v[64:67], v[40:43], v[56:59]
    v_mfma_f32_16x16x32_bf16 v[56:59], v[68:71], v[44:47], v[56:59]
    v_mfma_f32_16x16x32_bf16 v[60:63], v[72:75], v[32:35], 0
    v_mfma_f32_16x16x32_bf16 v[60:63], v[76:79], v[36:39], v[60:63]
    v_mfma_f32_16x16x32_bf16 v[60:63], v[80:83], v[40:43], v[60:63]
    v_mfma_f32_16x16x32_bf16 v[60:63], v[84:87], v[44:47], v[60:63]
    v_mfma_f32_16x16x32_bf16 v[64:67], v[32:35], v[32:35], 0
    v_mfma_f32_16x16x32_bf16 v[64:67], v[36:39], v[36:39], v[64:67]
    v_mfma_f32_16x16x32_bf16 v[64:67], v[40:43], v[40:43], v[64:67]
    v_mfma_f32_16x16x32_bf16 v[64:67], v[44:47], v[44:47], v[64:67]
    v_max3_f32 v84, v56, v57, v58
    v_max3_f32 v84, v84, v59, v60
    v_max3_f32 v84, v84, v61, v62
    s_nop 4
    v_max3_f32 v84, v84, v63, v64
    v_max_f32 v84, v84, v65
    v_mov_b32 v85, v84
    s_nop 1
    v_permlane32_swap_b32 v85, v84
    v_max_f32 v84, v85, v84
    v_mov_b32 v85, v84
    s_nop 1
    v_permlane16_swap_b32 v85, v84
    v_max_f32 v84, v85, v84
    v_sub_f32 v56, v56, v84
    v_sub_f32 v57, v57, v84
    v_sub_f32 v58, v58, v84
    v_sub_f32 v59, v59, v84
    v_sub_f32 v60, v60, v84
    v_sub_f32 v61, v61, v84
    v_sub_f32 v62, v62, v84
    v_sub_f32 v63, v63, v84
    v_sub_f32 v64, v64, v84
    v_sub_f32 v65, v65, v84
    v_exp_f32 v56, v56
    v_exp_f32 v57, v57
    v_exp_f32 v58, v58
    v_exp_f32 v59, v59
    v_exp_f32 v60, v60
    v_exp_f32 v61, v61
    v_exp_f32 v62, v62
    v_exp_f32 v63, v63
    v_exp_f32 v64, v64
    v_exp_f32 v65, v65
    v_cvt_pk_bf16_f32 v68, v56, v57
    v_cvt_pk_bf16_f32 v69, v58, v59
    v_cvt_pk_bf16_f32 v70, v60, v61
    v_cvt_pk_bf16_f32 v71, v62, v63
    v_cvt_pk_bf16_f32 v52, v64, v65
    s_nop 0
    v_mfma_f32_16x16x32_bf16 v[72:75], v[88:91], v[68:71], 0
    v_mfma_f32_16x16x32_bf16 v[76:79], v[92:95], v[68:71], 0
    v_mfma_f32_16x16x32_bf16 v[80:83], v[48:51], v[68:71], 0
    v_mfma_f32_16x16x16_bf16 v[72:75], v[112:113], v[52:53], v[72:75]
    v_mfma_f32_16x16x16_bf16 v[76:79], v[114:115], v[52:53], v[76:79]
    v_mfma_f32_16x16x16_bf16 v[80:83], v[48:49], v[52:53], v[80:83]
    ds_read_b128 v[32:35], v124 offset:6144
    ds_read_b128 v[36:39], v124 offset:7168
    ds_read_b128 v[40:43], v124 offset:34816
    ds_read_b128 v[44:47], v124 offset:35840
    ds_read_b128 v[56:59], v124 offset:36864
    ds_read_b128 v[64:67], v124 offset:38912
    ds_read_b128 v[68:71], v124 offset:39936
    s_waitcnt lgkmcnt(0)
    s_branch L_norm_61
L_kvw_63:
    s_add_u32 s47, s47, 1
    s_add_u32 s49, s49, 1
    s_cmp_ge_u32 s49, 0x10000
    s_cbranch_scc1 L_kvb_64
    s_sleep 4
    buffer_load_dword v125, v119, s[8:11], s28 offen sc1
    s_waitcnt vmcnt(0)
    v_cmp_eq_u32 vcc, 0, v125
    s_nop 0
    s_and_b64 vcc, vcc, s[58:59]
    s_cbranch_scc1 L_kvw_63
    s_branch L_kvb_64
L_mret_66:
    s_mov_b32 s43, m0
    s_mov_b32 m0, 5120
    buffer_load_dwordx4 v[4:7], v117, s[8:11], s48 offen sc1
    buffer_load_dwordx4 v117, s[8:11], s48 offen sc1 lds
    s_mov_b32 m0, 10240
    s_mov_b32 m0, s43
    s_waitcnt vmcnt(0)
    v_max3_u32 v15, v4, v5, v6
    v_max_u32 v15, v15, v7
    v_cmp_lt_u32 vcc, s56, v15
    s_add_u32 s47, s47, 1
    s_add_u32 s49, s49, 1
    s_cmp_ge_u32 s49, 0x10000
    s_cbranch_scc1 L_mgo_67
    s_cbranch_vccnz L_mret_66
    s_branch L_mgo_67
L_smax_69:
    s_add_u32 s47, s47, 1
    s_mov_b32 s35, 0x7f800000
    s_waitcnt lgkmcnt(0)
    s_sub_u32 s43, s30, 0x40800
    s_add_u32 s40, s43, 4096
    s_nop 7
    buffer_load_dwordx4 v[56:59], v117, s[8:11], s43 offen
    buffer_load_dwordx4 v[60:63], v117, s[8:11], s43 offen offset:1024
    buffer_load_dwordx4 v[64:67], v117, s[8:11], s43 offen offset:2048
    buffer_load_dwordx4 v[68:71], v117, s[8:11], s43 offen offset:3072
    buffer_load_dwordx4 v[72:75], v117, s[8:11], s40 offen
    buffer_load_dwordx4 v[76:79], v117, s[8:11], s40 offen offset:1024
    buffer_load_dwordx4 v[80:83], v117, s[8:11], s40 offen offset:2048
    buffer_load_dwordx4 v[84:87], v117, s[8:11], s40 offen offset:3072
    ds_read_b128 v[32:35], v121 offset:16384
    ds_read_b128 v[36:39], v121 offset:17408
    ds_read_b128 v[40:43], v121 offset:18432
    ds_read_b128 v[44:47], v121 offset:19456
    v_mov_b32 v96, 0
    v_mov_b32 v97, 0
    v_mov_b32 v98, 0
    v_mov_b32 v99, 0
    v_mov_b32 v100, 0
    v_mov_b32 v101, 0
    v_mov_b32 v102, 0
    v_mov_b32 v103, 0
    v_mov_b32 v104, 0
    v_mov_b32 v105, 0
    v_mov_b32 v106, 0
    v_mov_b32 v107, 0
    v_mov_b32 v108, 0
    v_mov_b32 v109, 0
    v_mov_b32 v110, 0
    v_mov_b32 v111, 0
    s_waitcnt vmcnt(0) lgkmcnt(0)
    v_mfma_f32_16x16x32_bf16 v[56:59], v[56:59], v[32:35], 0
    v_mfma_f32_16x16x32_bf16 v[56:59], v[60:63], v[36:39], v[56:59]
    v_mfma_f32_16x16x32_bf16 v[56:59], v[64:67], v[40:43], v[56:59]
    v_mfma_f32_16x16x32_bf16 v[56:59], v[68:71], v[44:47], v[56:59]
    v_mfma_f32_16x16x32_bf16 v[60:63], v[72:75], v[32:35], 0
    v_mfma_f32_16x16x32_bf16 v[60:63], v[76:79], v[36:39], v[60:63]
    v_mfma_f32_16x16x32_bf16 v[60:63], v[80:83], v[40:43], v[60:63]
    v_mfma_f32_16x16x32_bf16 v[60:63], v[84:87], v[44:47], v[60:63]
    v_mfma_f32_16x16x32_bf16 v[64:67], v[32:35], v[32:35], 0
    v_mfma_f32_16x16x32_bf16 v[64:67], v[36:39], v[36:39], v[64:67]
    v_mfma_f32_16x16x32_bf16 v[64:67], v[40:43], v[40:43], v[64:67]
    v_mfma_f32_16x16x32_bf16 v[64:67], v[44:47], v[44:47], v[64:67]
    v_max3_f32 v84, v56, v57, v58
    v_max3_f32 v84, v84, v59, v60
    v_max3_f32 v84, v84, v61, v62
    s_nop 4
    v_max3_f32 v84, v84, v63, v64
    v_max_f32 v84, v84, v65
    v_mov_b32 v85, v84
    s_nop 1
    v_permlane32_swap_b32 v85, v84
    v_max_f32 v84, v85, v84
    v_mov_b32 v85, v84
    s_nop 1
    v_permlane16_swap_b32 v85, v84
    v_max_f32 v84, v85, v84
    v_sub_f32 v56, v56, v84
    v_sub_f32 v57, v57, v84
    v_sub_f32 v58, v58, v84
    v_sub_f32 v59, v59, v84
    v_sub_f32 v60, v60, v84
    v_sub_f32 v61, v61, v84
    v_sub_f32 v62, v62, v84
    v_sub_f32 v63, v63, v84
    v_sub_f32 v64, v64, v84
    v_sub_f32 v65, v65, v84
    v_exp_f32 v56, v56
    v_exp_f32 v57, v57
    v_exp_f32 v58, v58
    v_exp_f32 v59, v59
    v_exp_f32 v60, v60
    v_exp_f32 v61, v61
    v_exp_f32 v62, v62
    v_exp_f32 v63, v63
    v_exp_f32 v64, v64
    v_exp_f32 v65, v65
    v_cvt_pk_bf16_f32 v68, v56, v57
    v_cvt_pk_bf16_f32 v69, v58, v59
    v_cvt_pk_bf16_f32 v70, v60, v61
    v_cvt_pk_bf16_f32 v71, v62, v63
    v_cvt_pk_bf16_f32 v52, v64, v65
    s_nop 0
    v_mfma_f32_16x16x32_bf16 v[72:75], v[88:91], v[68:71], 0
    v_mfma_f32_16x16x32_bf16 v[76:79], v[92:95], v[68:71], 0
    v_mfma_f32_16x16x32_bf16 v[80:83], v[48:51], v[68:71], 0
    v_mfma_f32_16x16x16_bf16 v[72:75], v[112:113], v[52:53], v[72:75]
    v_mfma_f32_16x16x16_bf16 v[76:79], v[114:115], v[52:53], v[76:79]
    v_mfma_f32_16x16x16_bf16 v[80:83], v[48:49], v[52:53], v[80:83]
    ds_read_b128 v[32:35], v124 offset:6144
    ds_read_b128 v[36:39], v124 offset:7168
    ds_read_b128 v[40:43], v124 offset:34816
    ds_read_b128 v[44:47], v124 offset:35840
    ds_read_b128 v[56:59], v124 offset:36864
    ds_read_b128 v[64:67], v124 offset:38912
    ds_read_b128 v[68:71], v124 offset:39936
    s_waitcnt lgkmcnt(0)
    s_branch L_norm_68
L_kvw_70:
    s_add_u32 s47, s47, 1
    s_add_u32 s49, s49, 1
    s_cmp_ge_u32 s49, 0x10000
    s_cbranch_scc1 L_kvb_71
    s_sleep 4
    buffer_load_dword v125, v119, s[8:11], s28 offen sc1
    s_waitcnt vmcnt(0)
    v_cmp_eq_u32 vcc, 0, v125
    s_nop 0
    s_and_b64 vcc, vcc, s[58:59]
    s_cbranch_scc1 L_kvw_70
    s_branch L_kvb_71
L_mret_73:
    s_mov_b32 s43, m0
    s_mov_b32 m0, 6144
    buffer_load_dwordx4 v[4:7], v117, s[8:11], s48 offen sc1
    buffer_load_dwordx4 v117, s[8:11], s48 offen sc1 lds
    s_mov_b32 m0, 12288
    s_mov_b32 m0, s43
    s_waitcnt vmcnt(0)
    v_max3_u32 v15, v4, v5, v6
    v_max_u32 v15, v15, v7
    v_cmp_lt_u32 vcc, s56, v15
    s_add_u32 s47, s47, 1
    s_add_u32 s49, s49, 1
    s_cmp_ge_u32 s49, 0x10000
    s_cbranch_scc1 L_mgo_74
    s_cbranch_vccnz L_mret_73
    s_branch L_mgo_74
L_smax_76:
    s_add_u32 s47, s47, 1
    s_mov_b32 s35, 0x7f800000
    s_waitcnt lgkmcnt(0)
    s_sub_u32 s43, s30, 0x41000
    s_add_u32 s40, s43, 4096
    s_nop 7
    buffer_load_dwordx4 v[56:59], v117, s[8:11], s43 offen
    buffer_load_dwordx4 v[60:63], v117, s[8:11], s43 offen offset:1024
    buffer_load_dwordx4 v[64:67], v117, s[8:11], s43 offen offset:2048
    buffer_load_dwordx4 v[68:71], v117, s[8:11], s43 offen offset:3072
    buffer_load_dwordx4 v[72:75], v117, s[8:11], s40 offen
    buffer_load_dwordx4 v[76:79], v117, s[8:11], s40 offen offset:1024
    buffer_load_dwordx4 v[80:83], v117, s[8:11], s40 offen offset:2048
    buffer_load_dwordx4 v[84:87], v117, s[8:11], s40 offen offset:3072
    ds_read_b128 v[32:35], v121 offset:16384
    ds_read_b128 v[36:39], v121 offset:17408
    ds_read_b128 v[40:43], v121 offset:18432
    ds_read_b128 v[44:47], v121 offset:19456
    v_mov_b32 v96, 0
    v_mov_b32 v97, 0
    v_mov_b32 v98, 0
    v_mov_b32 v99, 0
    v_mov_b32 v100, 0
    v_mov_b32 v101, 0
    v_mov_b32 v102, 0
    v_mov_b32 v103, 0
    v_mov_b32 v104, 0
    v_mov_b32 v105, 0
    v_mov_b32 v106, 0
    v_mov_b32 v107, 0
    v_mov_b32 v108, 0
    v_mov_b32 v109, 0
    v_mov_b32 v110, 0
    v_mov_b32 v111, 0
    s_waitcnt vmcnt(0) lgkmcnt(0)
    v_mfma_f32_16x16x32_bf16 v[56:59], v[56:59], v[32:35], 0
    v_mfma_f32_16x16x32_bf16 v[56:59], v[60:63], v[36:39], v[56:59]
    v_mfma_f32_16x16x32_bf16 v[56:59], v[64:67], v[40:43], v[56:59]
    v_mfma_f32_16x16x32_bf16 v[56:59], v[68:71], v[44:47], v[56:59]
    v_mfma_f32_16x16x32_bf16 v[60:63], v[72:75], v[32:35], 0
    v_mfma_f32_16x16x32_bf16 v[60:63], v[76:79], v[36:39], v[60:63]
    v_mfma_f32_16x16x32_bf16 v[60:63], v[80:83], v[40:43], v[60:63]
    v_mfma_f32_16x16x32_bf16 v[60:63], v[84:87], v[44:47], v[60:63]
    v_mfma_f32_16x16x32_bf16 v[64:67], v[32:35], v[32:35], 0
    v_mfma_f32_16x16x32_bf16 v[64:67], v[36:39], v[36:39], v[64:67]
    v_mfma_f32_16x16x32_bf16 v[64:67], v[40:43], v[40:43], v[64:67]
    v_mfma_f32_16x16x32_bf16 v[64:67], v[44:47], v[44:47], v[64:67]
    v_max3_f32 v84, v56, v57, v58
    v_max3_f32 v84, v84, v59, v60
    v_max3_f32 v84, v84, v61, v62
    s_nop 4
    v_max3_f32 v84, v84, v63, v64
    v_max_f32 v84, v84, v65
    v_mov_b32 v85, v84
    s_nop 1
    v_permlane32_swap_b32 v85, v84
    v_max_f32 v84, v85, v84
    v_mov_b32 v85, v84
    s_nop 1
    v_permlane16_swap_b32 v85, v84
    v_max_f32 v84, v85, v84
    v_sub_f32 v56, v56, v84
    v_sub_f32 v57, v57, v84
    v_sub_f32 v58, v58, v84
    v_sub_f32 v59, v59, v84
    v_sub_f32 v60, v60, v84
    v_sub_f32 v61, v61, v84
    v_sub_f32 v62, v62, v84
    v_sub_f32 v63, v63, v84
    v_sub_f32 v64, v64, v84
    v_sub_f32 v65, v65, v84
    v_exp_f32 v56, v56
    v_exp_f32 v57, v57
    v_exp_f32 v58, v58
    v_exp_f32 v59, v59
    v_exp_f32 v60, v60
    v_exp_f32 v61, v61
    v_exp_f32 v62, v62
    v_exp_f32 v63, v63
    v_exp_f32 v64, v64
    v_exp_f32 v65, v65
    v_cvt_pk_bf16_f32 v68, v56, v57
    v_cvt_pk_bf16_f32 v69, v58, v59
    v_cvt_pk_bf16_f32 v70, v60, v61
    v_cvt_pk_bf16_f32 v71, v62, v63
    v_cvt_pk_bf16_f32 v52, v64, v65
    s_nop 0
    v_mfma_f32_16x16x32_bf16 v[72:75], v[88:91], v[68:71], 0
    v_mfma_f32_16x16x32_bf16 v[76:79], v[92:95], v[68:71], 0
    v_mfma_f32_16x16x32_bf16 v[80:83], v[48:51], v[68:71], 0
    v_mfma_f32_16x16x16_bf16 v[72:75], v[112:113], v[52:53], v[72:75]
    v_mfma_f32_16x16x16_bf16 v[76:79], v[114:115], v[52:53], v[76:79]
    v_mfma_f32_16x16x16_bf16 v[80:83], v[48:49], v[52:53], v[80:83]
    ds_read_b128 v[32:35], v124 offset:6144
    ds_read_b128 v[36:39], v124 offset:7168
    ds_read_b128 v[40:43], v124 offset:34816
    ds_read_b128 v[44:47], v124 offset:35840
    ds_read_b128 v[56:59], v124 offset:36864
    ds_read_b128 v[64:67], v124 offset:38912
    ds_read_b128 v[68:71], v124 offset:39936
    s_waitcnt lgkmcnt(0)
    s_branch L_norm_75
L_rslow_78:
    buffer_load_dwordx4 v[4:7], v117, s[8:11], s29 offen sc1
    buffer_load_dwordx4 v[8:11], v117, s[8:11], s53 offen sc1
    buffer_load_dwordx4 v[16:19], v117, s[8:11], s29 offen offset:2048 sc1
    buffer_load_dwordx4 v[20:23], v117, s[8:11], s53 offen offset:2048 sc1
    s_add_u32 s46, s46, 1
    s_add_u32 s49, s49, 1
    s_cmp_ge_u32 s49, 0x10000
    s_cbranch_scc1 L_rgo_79
    s_waitcnt vmcnt(7)
    v_mfma_f32_16x16x32_bf16 v[48:51], v[32:35], v[12:15], 0
    v_xor_b32 v52, s33, v32
    s_waitcnt vmcnt(6)
    v_mfma_f32_16x16x32_bf16 v[48:51], v[36:39], v[12:15], v[48:51]
    v_xor_b32 v53, s33, v36
    v_or_b32 v52, v52, v53
    s_waitcnt vmcnt(5)
    v_mfma_f32_16x16x32_bf16 v[48:51], v[40:43], v[12:15], v[48:51]
    v_xor_b32 v53, s33, v40
    v_or_b32 v52, v52, v53
    s_waitcnt vmcnt(4)
    v_mfma_f32_16x16x32_bf16 v[48:51], v[44:47], v[12:15], v[48:51]
    v_xor_b32 v53, s33, v44
    v_or_b32 v52, v52, v53
    v_and_b32 v52, 1, v52
    v_cmp_ne_u32 vcc, 0, v52
    s_cbranch_vccz L_rgo_79
    buffer_load_dwordx4 v[32:35], v117, s[8:11], s29 offen sc1
    buffer_load_dwordx4 v[36:39], v117, s[8:11], s53 offen sc1
    buffer_load_dwordx4 v[40:43], v117, s[8:11], s29 offen offset:2048 sc1
    buffer_load_dwordx4 v[44:47], v117, s[8:11], s53 offen offset:2048 sc1
    s_add_u32 s46, s46, 1
    s_branch L_rl_77
L_mret_81:
    s_mov_b32 s43, m0
    s_mov_b32 m0, 7168
    buffer_load_dwordx4 v[4:7], v117, s[8:11], s48 offen sc1
    buffer_load_dwordx4 v117, s[8:11], s48 offen sc1 lds
    s_mov_b32 m0, 14336
    s_mov_b32 m0, s43
    s_waitcnt vmcnt(0)
    v_max3_u32 v15, v4, v5, v6
    v_max_u32 v15, v15, v7
    v_cmp_lt_u32 vcc, s56, v15
    s_add_u32 s47, s47, 1
    s_add_u32 s49, s49, 1
    s_cmp_ge_u32 s49, 0x10000
    s_cbranch_scc1 L_mgo_82
    s_cbranch_vccnz L_mret_81
    s_branch L_mgo_82
L_smax_84:
    s_add_u32 s47, s47, 1
    s_mov_b32 s35, 0x7f800000
    s_waitcnt lgkmcnt(0)
    s_sub_u32 s43, s30, 0x41800
    s_add_u32 s40, s43, 4096
    s_nop 7
    buffer_load_dwordx4 v[56:59], v117, s[8:11], s43 offen
    buffer_load_dwordx4 v[60:63], v117, s[8:11], s43 offen offset:1024
    buffer_load_dwordx4 v[64:67], v117, s[8:11], s43 offen offset:2048
    buffer_load_dwordx4 v[68:71], v117, s[8:11], s43 offen offset:3072
    buffer_load_dwordx4 v[72:75], v117, s[8:11], s40 offen
    buffer_load_dwordx4 v[76:79], v117, s[8:11], s40 offen offset:1024
    buffer_load_dwordx4 v[80:83], v117, s[8:11], s40 offen offset:2048
    buffer_load_dwordx4 v[84:87], v117, s[8:11], s40 offen offset:3072
    ds_read_b128 v[32:35], v121 offset:16384
    ds_read_b128 v[36:39], v121 offset:17408
    ds_read_b128 v[40:43], v121 offset:18432
    ds_read_b128 v[44:47], v121 offset:19456
    v_mov_b32 v96, 0
    v_mov_b32 v97, 0
    v_mov_b32 v98, 0
    v_mov_b32 v99, 0
    v_mov_b32 v100, 0
    v_mov_b32 v101, 0
    v_mov_b32 v102, 0
    v_mov_b32 v103, 0
    v_mov_b32 v104, 0
    v_mov_b32 v105, 0
    v_mov_b32 v106, 0
    v_mov_b32 v107, 0
    v_mov_b32 v108, 0
    v_mov_b32 v109, 0
    v_mov_b32 v110, 0
    v_mov_b32 v111, 0
    s_waitcnt vmcnt(0) lgkmcnt(0)
    v_mfma_f32_16x16x32_bf16 v[56:59], v[56:59], v[32:35], 0
    v_mfma_f32_16x16x32_bf16 v[56:59], v[60:63], v[36:39], v[56:59]
    v_mfma_f32_16x16x32_bf16 v[56:59], v[64:67], v[40:43], v[56:59]
    v_mfma_f32_16x16x32_bf16 v[56:59], v[68:71], v[44:47], v[56:59]
    v_mfma_f32_16x16x32_bf16 v[60:63], v[72:75], v[32:35], 0
    v_mfma_f32_16x16x32_bf16 v[60:63], v[76:79], v[36:39], v[60:63]
    v_mfma_f32_16x16x32_bf16 v[60:63], v[80:83], v[40:43], v[60:63]
    v_mfma_f32_16x16x32_bf16 v[60:63], v[84:87], v[44:47], v[60:63]
    v_mfma_f32_16x16x32_bf16 v[64:67], v[32:35], v[32:35], 0
    v_mfma_f32_16x16x32_bf16 v[64:67], v[36:39], v[36:39], v[64:67]
    v_mfma_f32_16x16x32_bf16 v[64:67], v[40:43], v[40:43], v[64:67]
    v_mfma_f32_16x16x32_bf16 v[64:67], v[44:47], v[44:47], v[64:67]
    v_max3_f32 v84, v56, v57, v58
    v_max3_f32 v84, v84, v59, v60
    v_max3_f32 v84, v84, v61, v62
    s_nop 4
    v_max3_f32 v84, v84, v63, v64
    v_max_f32 v84, v84, v65
    v_mov_b32 v85, v84
    s_nop 1
    v_permlane32_swap_b32 v85, v84
    v_max_f32 v84, v85, v84
    v_mov_b32 v85, v84
    s_nop 1
    v_permlane16_swap_b32 v85, v84
    v_max_f32 v84, v85, v84
    v_sub_f32 v56, v56, v84
    v_sub_f32 v57, v57, v84
    v_sub_f32 v58, v58, v84
    v_sub_f32 v59, v59, v84
    v_sub_f32 v60, v60, v84
    v_sub_f32 v61, v61, v84
    v_sub_f32 v62, v62, v84
    v_sub_f32 v63, v63, v84
    v_sub_f32 v64, v64, v84
    v_sub_f32 v65, v65, v84
    v_exp_f32 v56, v56
    v_exp_f32 v57, v57
    v_exp_f32 v58, v58
    v_exp_f32 v59, v59
    v_exp_f32 v60, v60
    v_exp_f32 v61, v61
    v_exp_f32 v62, v62
    v_exp_f32 v63, v63
    v_exp_f32 v64, v64
    v_exp_f32 v65, v65
    v_cvt_pk_bf16_f32 v68, v56, v57
    v_cvt_pk_bf16_f32 v69, v58, v59
    v_cvt_pk_bf16_f32 v70, v60, v61
    v_cvt_pk_bf16_f32 v71, v62, v63
    v_cvt_pk_bf16_f32 v52, v64, v65
    s_nop 0
    v_mfma_f32_16x16x32_bf16 v[72:75], v[88:91], v[68:71], 0
    v_mfma_f32_16x16x32_bf16 v[76:79], v[92:95], v[68:71], 0
    v_mfma_f32_16x16x32_bf16 v[80:83], v[48:51], v[68:71], 0
    v_mfma_f32_16x16x16_bf16 v[72:75], v[112:113], v[52:53], v[72:75]
    v_mfma_f32_16x16x16_bf16 v[76:79], v[114:115], v[52:53], v[76:79]
    v_mfma_f32_16x16x16_bf16 v[80:83], v[48:49], v[52:53], v[80:83]
    ds_read_b128 v[32:35], v124 offset:6144
    ds_read_b128 v[36:39], v124 offset:7168
    ds_read_b128 v[40:43], v124 offset:34816
    ds_read_b128 v[44:47], v124 offset:35840
    ds_read_b128 v[56:59], v124 offset:36864
    ds_read_b128 v[64:67], v124 offset:38912
    ds_read_b128 v[68:71], v124 offset:39936
    s_waitcnt lgkmcnt(0)
    s_branch L_norm_83
L_rslow_86:
    buffer_load_dwordx4 v[4:7], v117, s[8:11], s29 offen sc1
    buffer_load_dwordx4 v[8:11], v117, s[8:11], s53 offen sc1
    buffer_load_dwordx4 v[16:19], v117, s[8:11], s29 offen offset:2048 sc1
    buffer_load_dwordx4 v[20:23], v117, s[8:11], s53 offen offset:2048 sc1
    s_add_u32 s46, s46, 1
    s_add_u32 s49, s49, 1
    s_cmp_ge_u32 s49, 0x10000
    s_cbranch_scc1 L_rgo_87
    s_waitcnt vmcnt(7)
    v_mfma_f32_16x16x32_bf16 v[48:51], v[32:35], v[12:15], 0
    v_xor_b32 v52, s33, v32
    s_waitcnt vmcnt(6)
    v_mfma_f32_16x16x32_bf16 v[48:51], v[36:39], v[12:15], v[48:51]
    v_xor_b32 v53, s33, v36
    v_or_b32 v52, v52, v53
    s_waitcnt vmcnt(5)
    v_mfma_f32_16x16x32_bf16 v[48:51], v[40:43], v[12:15], v[48:51]
    v_xor_b32 v53, s33, v40
    v_or_b32 v52, v52, v53
    s_waitcnt vmcnt(4)
    v_mfma_f32_16x16x32_bf16 v[48:51], v[44:47], v[12:15], v[48:51]
    v_xor_b32 v53, s33, v44
    v_or_b32 v52, v52, v53
    v_and_b32 v52, 1, v52
    v_cmp_ne_u32 vcc, 0, v52
    s_cbranch_vccz L_rgo_87
    buffer_load_dwordx4 v[32:35], v117, s[8:11], s29 offen sc1
    buffer_load_dwordx4 v[36:39], v117, s[8:11], s53 offen sc1
    buffer_load_dwordx4 v[40:43], v117, s[8:11], s29 offen offset:2048 sc1
    buffer_load_dwordx4 v[44:47], v117, s[8:11], s53 offen offset:2048 sc1
    s_add_u32 s46, s46, 1
    s_branch L_rl_85
L_bulk:
    s_load_dwordx8 s[60:67], s[0:1], 16
    s_load_dwordx2 s[12:13], s[0:1], 0
    s_waitcnt lgkmcnt(0)
    s_branch L_bulk2
.p2align 7
L_other:
    s_sub_u32 s101, s84, 1
    s_lshl_b32 s101, s101, 5
    s_add_u32 s101, s101, s85
    s_cmp_ge_u32 s85, 2
    s_cbranch_scc1 L_nobc
    v_lshlrev_b32 v1, 6, v0
    s_lshl_b32 s96, s85, 14
    s_getpc_b64 s[4:5]
L_pc_88:
    s_add_u32 s4, s4, L_bulk2-L_pc_88
    s_addc_u32 s5, s5, 0
    v_add_u32 v1, s96, v1
    v_min_u32 v1, L_code_end-L_bulk2-4, v1
    global_load_dword v255, v1, s[4:5]
L_nobc:
    s_waitcnt lgkmcnt(0)
    s_and_b32 s9, s9, 0xffff
    s_mov_b32 s10, 0x10000000
    s_mov_b32 s11, 0x20000
    s_and_b32 s93, s93, 0xffff
    s_mov_b32 s94, 0x100
    s_mov_b32 s95, 0x20000
    s_mov_b32 s87, 0
    s_cmp_lg_u32 s86, 0
    s_cbranch_scc1 L_reg_89
    s_lshl_b32 s97, s84, 4
    s_lshl_b32 s96, 1, s85
    v_mov_b32 v250, s96
    v_mov_b32 v251, 256
    s_mov_b64 exec, 1
    buffer_atomic_add_x2 v[250:251], off, s[92:95], s97 offset:64
    s_mov_b64 exec, -1
    s_mov_b32 s86, 1
L_reg_89:
L_bulk2:
    s_add_u32 s88, s101, 32
    s_mov_b32 s41, 0
    s_lshr_b32 s20, s101, 6
    s_and_b32 s22, s101, 63
    s_cmp_ge_u32 s101, 192
    s_cselect_b32 s37, 32, 1000
L_p1go:
    s_mov_b32 s40, 0
    s_mov_b32 s80, 0
    s_mov_b32 s23, 0
L_p1_pass:
    v_mbcnt_lo_u32_b32 v0, -1, 0
    v_mbcnt_hi_u32_b32 v0, -1, v0
    s_lshl_b32 s96, s100, 6
    v_add_u32 v0, s96, v0
    s_and_b32 s13, s13, 0xffff
    s_mov_b32 s14, 0x200000
    s_mov_b32 s15, 0x20000
    v_lshrrev_b32 v147, 6, v0
    s_nop 0
    v_readfirstlane_b32 s21, v147
    v_and_b32 v144, 63, v0
    v_lshrrev_b32 v145, 4, v144
    v_and_b32 v146, 15, v144
    v_lshrrev_b32 v149, 2, v146
    v_lshlrev_b32 v137, 4, v144
    s_lshl_b32 s29, s21, 10
    s_lshl_b32 s26, s20, 7
    s_lshl_b32 s27, s21, 5
    s_add_u32 s26, s26, s27
    v_add_u32 v147, s26, v146
    v_lshlrev_b32 v147, 10, v147
    v_lshl_add_u32 v139, v145, 4, v147
    s_mov_b32 s26, 0x0
    buffer_load_dwordx4 v[0:3], v139, s[12:15], s26 offen
    buffer_load_dwordx4 v[4:7], v139, s[12:15], s26 offen offset:64
    buffer_load_dwordx4 v[8:11], v139, s[12:15], s26 offen offset:128
    buffer_load_dwordx4 v[12:15], v139, s[12:15], s26 offen offset:192
    buffer_load_dwordx4 v[16:19], v139, s[12:15], s26 offen offset:256
    buffer_load_dwordx4 v[20:23], v139, s[12:15], s26 offen offset:320
    buffer_load_dwordx4 v[24:27], v139, s[12:15], s26 offen offset:384
    buffer_load_dwordx4 v[28:31], v139, s[12:15], s26 offen offset:448
    buffer_load_dwordx4 v[32:35], v139, s[12:15], s26 offen offset:512
    buffer_load_dwordx4 v[36:39], v139, s[12:15], s26 offen offset:576
    buffer_load_dwordx4 v[40:43], v139, s[12:15], s26 offen offset:640
    buffer_load_dwordx4 v[44:47], v139, s[12:15], s26 offen offset:704
    buffer_load_dwordx4 v[48:51], v139, s[12:15], s26 offen offset:768
    buffer_load_dwordx4 v[52:55], v139, s[12:15], s26 offen offset:832
    buffer_load_dwordx4 v[56:59], v139, s[12:15], s26 offen offset:896
    buffer_load_dwordx4 v[60:63], v139, s[12:15], s26 offen offset:960
    s_mov_b32 s26, 0x4000
    buffer_load_dwordx4 v[64:67], v139, s[12:15], s26 offen
    buffer_load_dwordx4 v[68:71], v139, s[12:15], s26 offen offset:64
    buffer_load_dwordx4 v[72:75], v139, s[12:15], s26 offen offset:128
    buffer_load_dwordx4 v[76:79], v139, s[12:15], s26 offen offset:192
    buffer_load_dwordx4 v[80:83], v139, s[12:15], s26 offen offset:256
    buffer_load_dwordx4 v[84:87], v139, s[12:15], s26 offen offset:320
    buffer_load_dwordx4 v[88:91], v139, s[12:15], s26 offen offset:384
    buffer_load_dwordx4 v[92:95], v139, s[12:15], s26 offen offset:448
    buffer_load_dwordx4 v[96:99], v139, s[12:15], s26 offen offset:512
    buffer_load_dwordx4 v[100:103], v139, s[12:15], s26 offen offset:576
    buffer_load_dwordx4 v[104:107], v139, s[12:15], s26 offen offset:640
    buffer_load_dwordx4 v[108:111], v139, s[12:15], s26 offen offset:704
    buffer_load_dwordx4 v[112:115], v139, s[12:15], s26 offen offset:768
    buffer_load_dwordx4 v[116:119], v139, s[12:15], s26 offen offset:832
    buffer_load_dwordx4 v[120:123], v139, s[12:15], s26 offen offset:896
    buffer_load_dwordx4 v[124:127], v139, s[12:15], s26 offen offset:960
    s_lshr_b32 s26, s21, 1
    s_lshl_b32 s26, s26, 2
    v_or_b32 v148, s26, v145
    v_lshlrev_b32 v148, 1, v148
    v_xor_b32 v148, v148, v146
    v_lshlrev_b32 v148, 4, v148
    s_lshl_b32 s26, s21, 2
    v_add_u32 v147, s26, v145
    v_lshl_add_u32 v136, v147, 13, v148
    v_lshl_add_u32 v147, v145, 3, v149
    v_lshlrev_b32 v147, 8, v147
    v_and_b32 v148, 1, v145
    v_lshl_or_b32 v148, v148, 2, v149
    v_lshl_add_u32 v147, v148, 5, v147
    v_and_b32 v148, 3, v146
    v_lshl_add_u32 v128, v148, 3, v147
    v_xor_b32 v129, 32, v128
    v_xor_b32 v130, 64, v128
    v_xor_b32 v131, 96, v128
    v_xor_b32 v132, 128, v128
    v_xor_b32 v133, 160, v128
    v_xor_b32 v134, 192, v128
    v_xor_b32 v135, 224, v128
    s_mov_b32 s19, 0x20000
    s_mov_b32 s38, s22
    s_mov_b32 s39, s22
    v_mov_b32 v158, 0x3f803f80
    s_lshr_b32 s26, s39, 5
    s_cmp_eq_u32 s26, 0
    s_cselect_b64 s[16:17], s[62:63], s[60:61]
    s_cmp_eq_u32 s26, 1
    s_cselect_b64 s[16:17], s[64:65], s[16:17]
    s_and_b32 s17, s17, 0xffff
    s_cmp_lt_u32 s39, 96
    s_cselect_b32 s18, 0x400000, 0
    s_and_b32 s24, s39, 31
    s_lshl_b32 s24, s24, 8
    s_waitcnt vmcnt(16)
    v_pk_mov_b32 v[150:151], 0, 0
    v_pk_mov_b32 v[152:153], 0, 0
    v_dot2_f32_bf16 v150, v0, v158, v150
    v_dot2_f32_bf16 v152, v0, v0, v152
    v_dot2_f32_bf16 v151, v1, v158, v151
    v_dot2_f32_bf16 v153, v1, v1, v153
    v_dot2_f32_bf16 v150, v2, v158, v150
    v_dot2_f32_bf16 v152, v2, v2, v152
    v_dot2_f32_bf16 v151, v3, v158, v151
    v_dot2_f32_bf16 v153, v3, v3, v153
    v_dot2_f32_bf16 v150, v4, v158, v150
    v_dot2_f32_bf16 v152, v4, v4, v152
    v_dot2_f32_bf16 v151, v5, v158, v151
    v_dot2_f32_bf16 v153, v5, v5, v153
    v_dot2_f32_bf16 v150, v6, v158, v150
    v_dot2_f32_bf16 v152, v6, v6, v152
    v_dot2_f32_bf16 v151, v7, v158, v151
    v_dot2_f32_bf16 v153, v7, v7, v153
    v_dot2_f32_bf16 v150, v8, v158, v150
    v_dot2_f32_bf16 v152, v8, v8, v152
    v_dot2_f32_bf16 v151, v9, v158, v151
    v_dot2_f32_bf16 v153, v9, v9, v153
    v_dot2_f32_bf16 v150, v10, v158, v150
    v_dot2_f32_bf16 v152, v10, v10, v152
    v_dot2_f32_bf16 v151, v11, v158, v151
    v_dot2_f32_bf16 v153, v11, v11, v153
    v_dot2_f32_bf16 v150, v12, v158, v150
    v_dot2_f32_bf16 v152, v12, v12, v152
    v_dot2_f32_bf16 v151, v13, v158, v151
    v_dot2_f32_bf16 v153, v13, v13, v153
    v_dot2_f32_bf16 v150, v14, v158, v150
    v_dot2_f32_bf16 v152, v14, v14, v152
    v_dot2_f32_bf16 v151, v15, v158, v151
    v_dot2_f32_bf16 v153, v15, v15, v153
    v_dot2_f32_bf16 v150, v16, v158, v150
    v_dot2_f32_bf16 v152, v16, v16, v152
    v_dot2_f32_bf16 v151, v17, v158, v151
    v_dot2_f32_bf16 v153, v17, v17, v153
    v_dot2_f32_bf16 v150, v18, v158, v150
    v_dot2_f32_bf16 v152, v18, v18, v152
    v_dot2_f32_bf16 v151, v19, v158, v151
    v_dot2_f32_bf16 v153, v19, v19, v153
    v_dot2_f32_bf16 v150, v20, v158, v150
    v_dot2_f32_bf16 v152, v20, v20, v152
    v_dot2_f32_bf16 v151, v21, v158, v151
    v_dot2_f32_bf16 v153, v21, v21, v153
    v_dot2_f32_bf16 v150, v22, v158, v150
    v_dot2_f32_bf16 v152, v22, v22, v152
    v_dot2_f32_bf16 v151, v23, v158, v151
    v_dot2_f32_bf16 v153, v23, v23, v153
    v_dot2_f32_bf16 v150, v24, v158, v150
    v_dot2_f32_bf16 v152, v24, v24, v152
    v_dot2_f32_bf16 v151, v25, v158, v151
    v_dot2_f32_bf16 v153, v25, v25, v153
    v_dot2_f32_bf16 v150, v26, v158, v150
    v_dot2_f32_bf16 v152, v26, v26, v152
    v_dot2_f32_bf16 v151, v27, v158, v151
    v_dot2_f32_bf16 v153, v27, v27, v153
    v_dot2_f32_bf16 v150, v28, v158, v150
    v_dot2_f32_bf16 v152, v28, v28, v152
    v_dot2_f32_bf16 v151, v29, v158, v151
    v_dot2_f32_bf16 v153, v29, v29, v153
    v_dot2_f32_bf16 v150, v30, v158, v150
    v_dot2_f32_bf16 v152, v30, v30, v152
    v_dot2_f32_bf16 v151, v31, v158, v151
    v_dot2_f32_bf16 v153, v31, v31, v153
    v_dot2_f32_bf16 v150, v32, v158, v150
    v_dot2_f32_bf16 v152, v32, v32, v152
    v_dot2_f32_bf16 v151, v33, v158, v151
    v_dot2_f32_bf16 v153, v33, v33, v153
    v_dot2_f32_bf16 v150, v34, v158, v150
    v_dot2_f32_bf16 v152, v34, v34, v152
    v_dot2_f32_bf16 v151, v35, v158, v151
    v_dot2_f32_bf16 v153, v35, v35, v153
    v_dot2_f32_bf16 v150, v36, v158, v150
    v_dot2_f32_bf16 v152, v36, v36, v152
    v_dot2_f32_bf16 v151, v37, v158, v151
    v_dot2_f32_bf16 v153, v37, v37, v153
    v_dot2_f32_bf16 v150, v38, v158, v150
    v_dot2_f32_bf16 v152, v38, v38, v152
    v_dot2_f32_bf16 v151, v39, v158, v151
    v_dot2_f32_bf16 v153, v39, v39, v153
    v_dot2_f32_bf16 v150, v40, v158, v150
    v_dot2_f32_bf16 v152, v40, v40, v152
    v_dot2_f32_bf16 v151, v41, v158, v151
    v_dot2_f32_bf16 v153, v41, v41, v153
    v_dot2_f32_bf16 v150, v42, v158, v150
    v_dot2_f32_bf16 v152, v42, v42, v152
    v_dot2_f32_bf16 v151, v43, v158, v151
    v_dot2_f32_bf16 v153, v43, v43, v153
    v_dot2_f32_bf16 v150, v44, v158, v150
    v_dot2_f32_bf16 v152, v44, v44, v152
    v_dot2_f32_bf16 v151, v45, v158, v151
    v_dot2_f32_bf16 v153, v45, v45, v153
    v_dot2_f32_bf16 v150, v46, v158, v150
    v_dot2_f32_bf16 v152, v46, v46, v152
    v_dot2_f32_bf16 v151, v47, v158, v151
    v_dot2_f32_bf16 v153, v47, v47, v153
    v_dot2_f32_bf16 v150, v48, v158, v150
    v_dot2_f32_bf16 v152, v48, v48, v152
    v_dot2_f32_bf16 v151, v49, v158, v151
    v_dot2_f32_bf16 v153, v49, v49, v153
    s_add_u32 s26, s24, 0x0
    s_add_u32 m0, s29, 0x0
    s_nop 0
    buffer_load_dwordx4 v136, s[16:19], s26 offen lds
    v_dot2_f32_bf16 v150, v50, v158, v150
    v_dot2_f32_bf16 v152, v50, v50, v152
    v_dot2_f32_bf16 v151, v51, v158, v151
    v_dot2_f32_bf16 v153, v51, v51, v153
    v_dot2_f32_bf16 v150, v52, v158, v150
    v_dot2_f32_bf16 v152, v52, v52, v152
    v_dot2_f32_bf16 v151, v53, v158, v151
    v_dot2_f32_bf16 v153, v53, v53, v153
    v_dot2_f32_bf16 v150, v54, v158, v150
    v_dot2_f32_bf16 v152, v54, v54, v152
    v_dot2_f32_bf16 v151, v55, v158, v151
    v_dot2_f32_bf16 v153, v55, v55, v153
    v_dot2_f32_bf16 v150, v56, v158, v150
    v_dot2_f32_bf16 v152, v56, v56, v152
    v_dot2_f32_bf16 v151, v57, v158, v151
    v_dot2_f32_bf16 v153, v57, v57, v153
    v_dot2_f32_bf16 v150, v58, v158, v150
    v_dot2_f32_bf16 v152, v58, v58, v152
    v_dot2_f32_bf16 v151, v59, v158, v151
    v_dot2_f32_bf16 v153, v59, v59, v153
    v_dot2_f32_bf16 v150, v60, v158, v150
    v_dot2_f32_bf16 v152, v60, v60, v152
    v_dot2_f32_bf16 v151, v61, v158, v151
    v_dot2_f32_bf16 v153, v61, v61, v153
    v_dot2_f32_bf16 v150, v62, v158, v150
    v_dot2_f32_bf16 v152, v62, v62, v152
    v_dot2_f32_bf16 v151, v63, v158, v151
    v_dot2_f32_bf16 v153, v63, v63, v153
    s_nop 1
    v_add_f32 v150, v150, v151
    v_add_f32 v152, v152, v153
    v_mov_b32 v157, v150
    s_nop 1
    v_permlane32_swap_b32 v157, v150
    v_add_f32 v150, v157, v150
    v_mov_b32 v157, v150
    s_nop 1
    v_permlane16_swap_b32 v157, v150
    v_add_f32 v150, v157, v150
    v_mov_b32 v157, v152
    s_nop 1
    v_permlane32_swap_b32 v157, v152
    v_add_f32 v152, v157, v152
    v_mov_b32 v157, v152
    s_nop 1
    v_permlane16_swap_b32 v157, v152
    v_add_f32 v152, v157, v152
    v_mul_f32 v150, 0x3b000000, v150
    v_cvt_pk_bf16_f32 v154, v150, v150
    v_and_b32 v154, 0xffff0000, v154
    v_sub_f32 v156, v150, v154
    v_mul_f32 v157, v150, v150
    v_mul_f32 v152, 0x3b000000, v152
    v_sub_f32 v152, v152, v157
    v_max_f32 v152, 0, v152
    v_cvt_pk_bf16_f32 v152, v152, v152
    v_and_b32 v152, 0xffff0000, v152
    v_add_f32 v152, 0x3727c5ac, v152
    v_cvt_pk_bf16_f32 v152, v152, v152
    v_and_b32 v152, 0xffff0000, v152
    v_sqrt_f32 v152, v152
    s_nop 0
    v_cvt_pk_bf16_f32 v152, v152, v152
    v_and_b32 v152, 0xffff0000, v152
    v_rcp_f32 v152, v152
    v_lshlrev_b32 v160, 16, v0
    v_and_b32 v161, 0xffff0000, v0
    v_lshlrev_b32 v162, 16, v1
    v_and_b32 v163, 0xffff0000, v1
    v_lshlrev_b32 v164, 16, v2
    v_and_b32 v165, 0xffff0000, v2
    v_lshlrev_b32 v166, 16, v3
    v_and_b32 v167, 0xffff0000, v3
    v_lshlrev_b32 v168, 16, v4
    v_and_b32 v169, 0xffff0000, v4
    v_lshlrev_b32 v170, 16, v5
    v_and_b32 v171, 0xffff0000, v5
    v_lshlrev_b32 v172, 16, v6
    v_and_b32 v173, 0xffff0000, v6
    v_lshlrev_b32 v174, 16, v7
    v_and_b32 v175, 0xffff0000, v7
    v_pk_add_f32 v[160:161], v[160:161], v[154:155] op_sel_hi:[1,0] neg_lo:[0,1] neg_hi:[0,1]
    v_pk_add_f32 v[162:163], v[162:163], v[154:155] op_sel_hi:[1,0] neg_lo:[0,1] neg_hi:[0,1]
    v_pk_add_f32 v[164:165], v[164:165], v[154:155] op_sel_hi:[1,0] neg_lo:[0,1] neg_hi:[0,1]
    v_pk_add_f32 v[166:167], v[166:167], v[154:155] op_sel_hi:[1,0] neg_lo:[0,1] neg_hi:[0,1]
    v_pk_add_f32 v[168:169], v[168:169], v[154:155] op_sel_hi:[1,0] neg_lo:[0,1] neg_hi:[0,1]
    v_pk_add_f32 v[170:171], v[170:171], v[154:155] op_sel_hi:[1,0] neg_lo:[0,1] neg_hi:[0,1]
    s_add_u32 s26, s24, 0x20000
    s_add_u32 m0, s29, 0x1000
    s_nop 0
    buffer_load_dwordx4 v136, s[16:19], s26 offen lds
    v_pk_add_f32 v[172:173], v[172:173], v[154:155] op_sel_hi:[1,0] neg_lo:[0,1] neg_hi:[0,1]
    v_pk_add_f32 v[174:175], v[174:175], v[154:155] op_sel_hi:[1,0] neg_lo:[0,1] neg_hi:[0,1]
    v_cvt_pk_bf16_f32 v0, v160, v161
    v_cvt_pk_bf16_f32 v1, v162, v163
    v_cvt_pk_bf16_f32 v2, v164, v165
    v_cvt_pk_bf16_f32 v3, v166, v167
    v_cvt_pk_bf16_f32 v4, v168, v169
    v_cvt_pk_bf16_f32 v5, v170, v171
    v_cvt_pk_bf16_f32 v6, v172, v173
    v_cvt_pk_bf16_f32 v7, v174, v175
    v_lshlrev_b32 v160, 16, v0
    v_and_b32 v161, 0xffff0000, v0
    v_lshlrev_b32 v162, 16, v1
    v_and_b32 v163, 0xffff0000, v1
    v_lshlrev_b32 v164, 16, v2
    v_and_b32 v165, 0xffff0000, v2
    v_lshlrev_b32 v166, 16, v3
    v_and_b32 v167, 0xffff0000, v3
    v_lshlrev_b32 v168, 16, v4
    v_and_b32 v169, 0xffff0000, v4
    v_lshlrev_b32 v170, 16, v5
    v_and_b32 v171, 0xffff0000, v5
    v_lshlrev_b32 v172, 16, v6
    v_and_b32 v173, 0xffff0000, v6
    v_lshlrev_b32 v174, 16, v7
    v_and_b32 v175, 0xffff0000, v7
    v_pk_mul_f32 v[160:161], v[160:161], v[152:153] op_sel_hi:[1,0]
    v_pk_mul_f32 v[162:163], v[162:163], v[152:153] op_sel_hi:[1,0]
    v_pk_mul_f32 v[164:165], v[164:165], v[152:153] op_sel_hi:[1,0]
    v_pk_mul_f32 v[166:167], v[166:167], v[152:153] op_sel_hi:[1,0]
    v_pk_mul_f32 v[168:169], v[168:169], v[152:153] op_sel_hi:[1,0]
    v_pk_mul_f32 v[170:171], v[170:171], v[152:153] op_sel_hi:[1,0]
    v_pk_mul_f32 v[172:173], v[172:173], v[152:153] op_sel_hi:[1,0]
    v_pk_mul_f32 v[174:175], v[174:175], v[152:153] op_sel_hi:[1,0]
    v_cvt_pk_bf16_f32 v160, v160, v161
    v_cvt_pk_bf16_f32 v162, v162, v163
    v_cvt_pk_bf16_f32 v164, v164, v165
    v_cvt_pk_bf16_f32 v166, v166, v167
    v_cvt_pk_bf16_f32 v168, v168, v169
    v_cvt_pk_bf16_f32 v170, v170, v171
    v_cvt_pk_bf16_f32 v172, v172, v173
    v_cvt_pk_bf16_f32 v174, v174, v175
    v_accvgpr_write_b32 a0, v160
    v_accvgpr_write_b32 a1, v162
    v_accvgpr_write_b32 a2, v164
    v_accvgpr_write_b32 a3, v166
    v_accvgpr_write_b32 a4, v168
    v_accvgpr_write_b32 a5, v170
    v_accvgpr_write_b32 a6, v172
    v_accvgpr_write_b32 a7, v174
    s_add_u32 s26, s24, 0x40000
    s_add_u32 m0, s29, 0x2000
    s_nop 0
    buffer_load_dwordx4 v136, s[16:19], s26 offen lds
    v_lshlrev_b32 v160, 16, v8
    v_and_b32 v161, 0xffff0000, v8
    v_lshlrev_b32 v162, 16, v9
    v_and_b32 v163, 0xffff0000, v9
    v_lshlrev_b32 v164, 16, v10
    v_and_b32 v165, 0xffff0000, v10
    v_lshlrev_b32 v166, 16, v11
    v_and_b32 v167, 0xffff0000, v11
    v_lshlrev_b32 v168, 16, v12
    v_and_b32 v169, 0xffff0000, v12
    v_lshlrev_b32 v170, 16, v13
    v_and_b32 v171, 0xffff0000, v13
    v_lshlrev_b32 v172, 16, v14
    v_and_b32 v173, 0xffff0000, v14
    v_lshlrev_b32 v174, 16, v15
    v_and_b32 v175, 0xffff0000, v15
    v_pk_add_f32 v[160:161], v[160:161], v[154:155] op_sel_hi:[1,0] neg_lo:[0,1] neg_hi:[0,1]
    v_pk_add_f32 v[162:163], v[162:163], v[154:155] op_sel_hi:[1,0] neg_lo:[0,1] neg_hi:[0,1]
    v_pk_add_f32 v[164:165], v[164:165], v[154:155] op_sel_hi:[1,0] neg_lo:[0,1] neg_hi:[0,1]
    v_pk_add_f32 v[166:167], v[166:167], v[154:155] op_sel_hi:[1,0] neg_lo:[0,1] neg_hi:[0,1]
    v_pk_add_f32 v[168:169], v[168:169], v[154:155] op_sel_hi:[1,0] neg_lo:[0,1] neg_hi:[0,1]
    v_pk_add_f32 v[170:171], v[170:171], v[154:155] op_sel_hi:[1,0] neg_lo:[0,1] neg_hi:[0,1]
    v_pk_add_f32 v[172:173], v[172:173], v[154:155] op_sel_hi:[1,0] neg_lo:[0,1] neg_hi:[0,1]
    v_pk_add_f32 v[174:175], v[174:175], v[154:155] op_sel_hi:[1,0] neg_lo:[0,1] neg_hi:[0,1]
    v_cvt_pk_bf16_f32 v8, v160, v161
    v_cvt_pk_bf16_f32 v9, v162, v163
    v_cvt_pk_bf16_f32 v10, v164, v165
    v_cvt_pk_bf16_f32 v11, v166, v167
    v_cvt_pk_bf16_f32 v12, v168, v169
    v_cvt_pk_bf16_f32 v13, v170, v171
    v_cvt_pk_bf16_f32 v14, v172, v173
    v_cvt_pk_bf16_f32 v15, v174, v175
    v_lshlrev_b32 v160, 16, v8
    v_and_b32 v161, 0xffff0000, v8
    v_lshlrev_b32 v162, 16, v9
    v_and_b32 v163, 0xffff0000, v9
    v_lshlrev_b32 v164, 16, v10
    v_and_b32 v165, 0xffff0000, v10
    v_lshlrev_b32 v166, 16, v11
    v_and_b32 v167, 0xffff0000, v11
    v_lshlrev_b32 v168, 16, v12
    v_and_b32 v169, 0xffff0000, v12
    v_lshlrev_b32 v170, 16, v13
    v_and_b32 v171, 0xffff0000, v13
    v_lshlrev_b32 v172, 16, v14
    v_and_b32 v173, 0xffff0000, v14
    v_lshlrev_b32 v174, 16, v15
    v_and_b32 v175, 0xffff0000, v15
    v_pk_mul_f32 v[160:161], v[160:161], v[152:153] op_sel_hi:[1,0]
    v_pk_mul_f32 v[162:163], v[162:163], v[152:153] op_sel_hi:[1,0]
    s_add_u32 s26, s24, 0x60000
    s_add_u32 m0, s29, 0x3000
    s_nop 0
    buffer_load_dwordx4 v136, s[16:19], s26 offen lds
    v_pk_mul_f32 v[164:165], v[164:165], v[152:153] op_sel_hi:[1,0]
    v_pk_mul_f32 v[166:167], v[166:167], v[152:153] op_sel_hi:[1,0]
    v_pk_mul_f32 v[168:169], v[168:169], v[152:153] op_sel_hi:[1,0]
    v_pk_mul_f32 v[170:171], v[170:171], v[152:153] op_sel_hi:[1,0]
    v_pk_mul_f32 v[172:173], v[172:173], v[152:153] op_sel_hi:[1,0]
    v_pk_mul_f32 v[174:175], v[174:175], v[152:153] op_sel_hi:[1,0]
    v_cvt_pk_bf16_f32 v160, v160, v161
    v_cvt_pk_bf16_f32 v162, v162, v163
    v_cvt_pk_bf16_f32 v164, v164, v165
    v_cvt_pk_bf16_f32 v166, v166, v167
    v_cvt_pk_bf16_f32 v168, v168, v169
    v_cvt_pk_bf16_f32 v170, v170, v171
    v_cvt_pk_bf16_f32 v172, v172, v173
    v_cvt_pk_bf16_f32 v174, v174, v175
    v_accvgpr_write_b32 a8, v160
    v_accvgpr_write_b32 a9, v162
    v_accvgpr_write_b32 a10, v164
    v_accvgpr_write_b32 a11, v166
    v_accvgpr_write_b32 a12, v168
    v_accvgpr_write_b32 a13, v170
    v_accvgpr_write_b32 a14, v172
    v_accvgpr_write_b32 a15, v174
    v_lshlrev_b32 v160, 16, v16
    v_and_b32 v161, 0xffff0000, v16
    v_lshlrev_b32 v162, 16, v17
    v_and_b32 v163, 0xffff0000, v17
    v_lshlrev_b32 v164, 16, v18
    v_and_b32 v165, 0xffff0000, v18
    v_lshlrev_b32 v166, 16, v19
    v_and_b32 v167, 0xffff0000, v19
    v_lshlrev_b32 v168, 16, v20
    v_and_b32 v169, 0xffff0000, v20
    v_lshlrev_b32 v170, 16, v21
    v_and_b32 v171, 0xffff0000, v21
    v_lshlrev_b32 v172, 16, v22
    v_and_b32 v173, 0xffff0000, v22
    v_lshlrev_b32 v174, 16, v23
    v_and_b32 v175, 0xffff0000, v23
    v_pk_add_f32 v[160:161], v[160:161], v[154:155] op_sel_hi:[1,0] neg_lo:[0,1] neg_hi:[0,1]
    v_pk_add_f32 v[162:163], v[162:163], v[154:155] op_sel_hi:[1,0] neg_lo:[0,1] neg_hi:[0,1]
    v_pk_add_f32 v[164:165], v[164:165], v[154:155] op_sel_hi:[1,0] neg_lo:[0,1] neg_hi:[0,1]
    v_pk_add_f32 v[166:167], v[166:167], v[154:155] op_sel_hi:[1,0] neg_lo:[0,1] neg_hi:[0,1]
    v_pk_add_f32 v[168:169], v[168:169], v[154:155] op_sel_hi:[1,0] neg_lo:[0,1] neg_hi:[0,1]
    v_pk_add_f32 v[170:171], v[170:171], v[154:155] op_sel_hi:[1,0] neg_lo:[0,1] neg_hi:[0,1]
    v_pk_add_f32 v[172:173], v[172:173], v[154:155] op_sel_hi:[1,0] neg_lo:[0,1] neg_hi:[0,1]
    v_pk_add_f32 v[174:175], v[174:175], v[154:155] op_sel_hi:[1,0] neg_lo:[0,1] neg_hi:[0,1]
    v_cvt_pk_bf16_f32 v16, v160, v161
    v_cvt_pk_bf16_f32 v17, v162, v163
    v_cvt_pk_bf16_f32 v18, v164, v165
    v_cvt_pk_bf16_f32 v19, v166, v167
    s_add_u32 s26, s24, 0x80000
    s_add_u32 m0, s29, 0x4000
    s_nop 0
    buffer_load_dwordx4 v136, s[16:19], s26 offen lds
    v_cvt_pk_bf16_f32 v20, v168, v169
    v_cvt_pk_bf16_f32 v21, v170, v171
    v_cvt_pk_bf16_f32 v22, v172, v173
    v_cvt_pk_bf16_f32 v23, v174, v175
    v_lshlrev_b32 v160, 16, v16
    v_and_b32 v161, 0xffff0000, v16
    v_lshlrev_b32 v162, 16, v17
    v_and_b32 v163, 0xffff0000, v17
    v_lshlrev_b32 v164, 16, v18
    v_and_b32 v165, 0xffff0000, v18
    v_lshlrev_b32 v166, 16, v19
    v_and_b32 v167, 0xffff0000, v19
    v_lshlrev_b32 v168, 16, v20
    v_and_b32 v169, 0xffff0000, v20
    v_lshlrev_b32 v170, 16, v21
    v_and_b32 v171, 0xffff0000, v21
    v_lshlrev_b32 v172, 16, v22
    v_and_b32 v173, 0xffff0000, v22
    v_lshlrev_b32 v174, 16, v23
    v_and_b32 v175, 0xffff0000, v23
    v_pk_mul_f32 v[160:161], v[160:161], v[152:153] op_sel_hi:[1,0]
    v_pk_mul_f32 v[162:163], v[162:163], v[152:153] op_sel_hi:[1,0]
    v_pk_mul_f32 v[164:165], v[164:165], v[152:153] op_sel_hi:[1,0]
    v_pk_mul_f32 v[166:167], v[166:167], v[152:153] op_sel_hi:[1,0]
    v_pk_mul_f32 v[168:169], v[168:169], v[152:153] op_sel_hi:[1,0]
    v_pk_mul_f32 v[170:171], v[170:171], v[152:153] op_sel_hi:[1,0]
    v_pk_mul_f32 v[172:173], v[172:173], v[152:153] op_sel_hi:[1,0]
    v_pk_mul_f32 v[174:175], v[174:175], v[152:153] op_sel_hi:[1,0]
    v_cvt_pk_bf16_f32 v160, v160, v161
    v_cvt_pk_bf16_f32 v162, v162, v163
    v_cvt_pk_bf16_f32 v164, v164, v165
    v_cvt_pk_bf16_f32 v166, v166, v167
    v_cvt_pk_bf16_f32 v168, v168, v169
    v_cvt_pk_bf16_f32 v170, v170, v171
    v_cvt_pk_bf16_f32 v172, v172, v173
    v_cvt_pk_bf16_f32 v174, v174, v175
    v_accvgpr_write_b32 a16, v160
    v_accvgpr_write_b32 a17, v162
    v_accvgpr_write_b32 a18, v164
    v_accvgpr_write_b32 a19, v166
    v_accvgpr_write_b32 a20, v168
    v_accvgpr_write_b32 a21, v170
    v_accvgpr_write_b32 a22, v172
    v_accvgpr_write_b32 a23, v174
    v_lshlrev_b32 v160, 16, v24
    v_and_b32 v161, 0xffff0000, v24
    v_lshlrev_b32 v162, 16, v25
    v_and_b32 v163, 0xffff0000, v25
    v_lshlrev_b32 v164, 16, v26
    v_and_b32 v165, 0xffff0000, v26
    s_add_u32 s26, s24, 0xa0000
    s_add_u32 m0, s29, 0x5000
    s_nop 0
    buffer_load_dwordx4 v136, s[16:19], s26 offen lds
    v_lshlrev_b32 v166, 16, v27
    v_and_b32 v167, 0xffff0000, v27
    v_lshlrev_b32 v168, 16, v28
    v_and_b32 v169, 0xffff0000, v28
    v_lshlrev_b32 v170, 16, v29
    v_and_b32 v171, 0xffff0000, v29
    v_lshlrev_b32 v172, 16, v30
    v_and_b32 v173, 0xffff0000, v30
    v_lshlrev_b32 v174, 16, v31
    v_and_b32 v175, 0xffff0000, v31
    v_pk_add_f32 v[160:161], v[160:161], v[154:155] op_sel_hi:[1,0] neg_lo:[0,1] neg_hi:[0,1]
    v_pk_add_f32 v[162:163], v[162:163], v[154:155] op_sel_hi:[1,0] neg_lo:[0,1] neg_hi:[0,1]
    v_pk_add_f32 v[164:165], v[164:165], v[154:155] op_sel_hi:[1,0] neg_lo:[0,1] neg_hi:[0,1]
    v_pk_add_f32 v[166:167], v[166:167], v[154:155] op_sel_hi:[1,0] neg_lo:[0,1] neg_hi:[0,1]
    v_pk_add_f32 v[168:169], v[168:169], v[154:155] op_sel_hi:[1,0] neg_lo:[0,1] neg_hi:[0,1]
    v_pk_add_f32 v[170:171], v[170:171], v[154:155] op_sel_hi:[1,0] neg_lo:[0,1] neg_hi:[0,1]
    v_pk_add_f32 v[172:173], v[172:173], v[154:155] op_sel_hi:[1,0] neg_lo:[0,1] neg_hi:[0,1]
    v_pk_add_f32 v[174:175], v[174:175], v[154:155] op_sel_hi:[1,0] neg_lo:[0,1] neg_hi:[0,1]
    v_cvt_pk_bf16_f32 v24, v160, v161
    v_cvt_pk_bf16_f32 v25, v162, v163
    v_cvt_pk_bf16_f32 v26, v164, v165
    v_cvt_pk_bf16_f32 v27, v166, v167
    v_cvt_pk_bf16_f32 v28, v168, v169
    v_cvt_pk_bf16_f32 v29, v170, v171
    v_cvt_pk_bf16_f32 v30, v172, v173
    v_cvt_pk_bf16_f32 v31, v174, v175
    v_lshlrev_b32 v160, 16, v24
    v_and_b32 v161, 0xffff0000, v24
    v_lshlrev_b32 v162, 16, v25
    v_and_b32 v163, 0xffff0000, v25
    v_lshlrev_b32 v164, 16, v26
    v_and_b32 v165, 0xffff0000, v26
    v_lshlrev_b32 v166, 16, v27
    v_and_b32 v167, 0xffff0000, v27
    v_lshlrev_b32 v168, 16, v28
    v_and_b32 v169, 0xffff0000, v28
    v_lshlrev_b32 v170, 16, v29
    v_and_b32 v171, 0xffff0000, v29
    v_lshlrev_b32 v172, 16, v30
    v_and_b32 v173, 0xffff0000, v30
    v_lshlrev_b32 v174, 16, v31
    v_and_b32 v175, 0xffff0000, v31
    v_pk_mul_f32 v[160:161], v[160:161], v[152:153] op_sel_hi:[1,0]
    v_pk_mul_f32 v[162:163], v[162:163], v[152:153] op_sel_hi:[1,0]
    v_pk_mul_f32 v[164:165], v[164:165], v[152:153] op_sel_hi:[1,0]
    v_pk_mul_f32 v[166:167], v[166:167], v[152:153] op_sel_hi:[1,0]
    v_pk_mul_f32 v[168:169], v[168:169], v[152:153] op_sel_hi:[1,0]
    v_pk_mul_f32 v[170:171], v[170:171], v[152:153] op_sel_hi:[1,0]
    v_pk_mul_f32 v[172:173], v[172:173], v[152:153] op_sel_hi:[1,0]
    v_pk_mul_f32 v[174:175], v[174:175], v[152:153] op_sel_hi:[1,0]
    s_add_u32 s26, s24, 0xc0000
    s_add_u32 m0, s29, 0x6000
    s_nop 0
    buffer_load_dwordx4 v136, s[16:19], s26 offen lds
    v_cvt_pk_bf16_f32 v160, v160, v161
    v_cvt_pk_bf16_f32 v162, v162, v163
    v_cvt_pk_bf16_f32 v164, v164, v165
    v_cvt_pk_bf16_f32 v166, v166, v167
    v_cvt_pk_bf16_f32 v168, v168, v169
    v_cvt_pk_bf16_f32 v170, v170, v171
    v_cvt_pk_bf16_f32 v172, v172, v173
    v_cvt_pk_bf16_f32 v174, v174, v175
    v_accvgpr_write_b32 a24, v160
    v_accvgpr_write_b32 a25, v162
    v_accvgpr_write_b32 a26, v164
    v_accvgpr_write_b32 a27, v166
    v_accvgpr_write_b32 a28, v168
    v_accvgpr_write_b32 a29, v170
    v_accvgpr_write_b32 a30, v172
    v_accvgpr_write_b32 a31, v174
    v_lshlrev_b32 v160, 16, v32
    v_and_b32 v161, 0xffff0000, v32
    v_lshlrev_b32 v162, 16, v33
    v_and_b32 v163, 0xffff0000, v33
    v_lshlrev_b32 v164, 16, v34
    v_and_b32 v165, 0xffff0000, v34
    v_lshlrev_b32 v166, 16, v35
    v_and_b32 v167, 0xffff0000, v35
    v_lshlrev_b32 v168, 16, v36
    v_and_b32 v169, 0xffff0000, v36
    v_lshlrev_b32 v170, 16, v37
    v_and_b32 v171, 0xffff0000, v37
    v_lshlrev_b32 v172, 16, v38
    v_and_b32 v173, 0xffff0000, v38
    v_lshlrev_b32 v174, 16, v39
    v_and_b32 v175, 0xffff0000, v39
    v_pk_add_f32 v[160:161], v[160:161], v[154:155] op_sel_hi:[1,0] neg_lo:[0,1] neg_hi:[0,1]
    v_pk_add_f32 v[162:163], v[162:163], v[154:155] op_sel_hi:[1,0] neg_lo:[0,1] neg_hi:[0,1]
    v_pk_add_f32 v[164:165], v[164:165], v[154:155] op_sel_hi:[1,0] neg_lo:[0,1] neg_hi:[0,1]
    v_pk_add_f32 v[166:167], v[166:167], v[154:155] op_sel_hi:[1,0] neg_lo:[0,1] neg_hi:[0,1]
    v_pk_add_f32 v[168:169], v[168:169], v[154:155] op_sel_hi:[1,0] neg_lo:[0,1] neg_hi:[0,1]
    v_pk_add_f32 v[170:171], v[170:171], v[154:155] op_sel_hi:[1,0] neg_lo:[0,1] neg_hi:[0,1]
    v_pk_add_f32 v[172:173], v[172:173], v[154:155] op_sel_hi:[1,0] neg_lo:[0,1] neg_hi:[0,1]
    v_pk_add_f32 v[174:175], v[174:175], v[154:155] op_sel_hi:[1,0] neg_lo:[0,1] neg_hi:[0,1]
    v_cvt_pk_bf16_f32 v32, v160, v161
    v_cvt_pk_bf16_f32 v33, v162, v163
    v_cvt_pk_bf16_f32 v34, v164, v165
    v_cvt_pk_bf16_f32 v35, v166, v167
    v_cvt_pk_bf16_f32 v36, v168, v169
    v_cvt_pk_bf16_f32 v37, v170, v171
    v_cvt_pk_bf16_f32 v38, v172, v173
    v_cvt_pk_bf16_f32 v39, v174, v175
    v_lshlrev_b32 v160, 16, v32
    v_and_b32 v161, 0xffff0000, v32
    s_add_u32 s26, s24, 0xe0000
    s_add_u32 m0, s29, 0x7000
    s_nop 0
    buffer_load_dwordx4 v136, s[16:19], s26 offen lds
    v_lshlrev_b32 v162, 16, v33
    v_and_b32 v163, 0xffff0000, v33
    v_lshlrev_b32 v164, 16, v34
    v_and_b32 v165, 0xffff0000, v34
    v_lshlrev_b32 v166, 16, v35
    v_and_b32 v167, 0xffff0000, v35
    v_lshlrev_b32 v168, 16, v36
    v_and_b32 v169, 0xffff0000, v36
    v_lshlrev_b32 v170, 16, v37
    v_and_b32 v171, 0xffff0000, v37
    v_lshlrev_b32 v172, 16, v38
    v_and_b32 v173, 0xffff0000, v38
    v_lshlrev_b32 v174, 16, v39
    v_and_b32 v175, 0xffff0000, v39
    v_pk_mul_f32 v[160:161], v[160:161], v[152:153] op_sel_hi:[1,0]
    v_pk_mul_f32 v[162:163], v[162:163], v[152:153] op_sel_hi:[1,0]
    v_pk_mul_f32 v[164:165], v[164:165], v[152:153] op_sel_hi:[1,0]
    v_pk_mul_f32 v[166:167], v[166:167], v[152:153] op_sel_hi:[1,0]
    v_pk_mul_f32 v[168:169], v[168:169], v[152:153] op_sel_hi:[1,0]
    v_pk_mul_f32 v[170:171], v[170:171], v[152:153] op_sel_hi:[1,0]
    v_pk_mul_f32 v[172:173], v[172:173], v[152:153] op_sel_hi:[1,0]
    v_pk_mul_f32 v[174:175], v[174:175], v[152:153] op_sel_hi:[1,0]
    v_cvt_pk_bf16_f32 v160, v160, v161
    v_cvt_pk_bf16_f32 v162, v162, v163
    v_cvt_pk_bf16_f32 v164, v164, v165
    v_cvt_pk_bf16_f32 v166, v166, v167
    v_cvt_pk_bf16_f32 v168, v168, v169
    v_cvt_pk_bf16_f32 v170, v170, v171
    v_cvt_pk_bf16_f32 v172, v172, v173
    v_cvt_pk_bf16_f32 v174, v174, v175
    v_accvgpr_write_b32 a32, v160
    v_accvgpr_write_b32 a33, v162
    v_accvgpr_write_b32 a34, v164
    v_accvgpr_write_b32 a35, v166
    v_accvgpr_write_b32 a36, v168
    v_accvgpr_write_b32 a37, v170
    v_accvgpr_write_b32 a38, v172
    v_accvgpr_write_b32 a39, v174
    v_lshlrev_b32 v160, 16, v40
    v_and_b32 v161, 0xffff0000, v40
    v_lshlrev_b32 v162, 16, v41
    v_and_b32 v163, 0xffff0000, v41
    v_lshlrev_b32 v164, 16, v42
    v_and_b32 v165, 0xffff0000, v42
    v_lshlrev_b32 v166, 16, v43
    v_and_b32 v167, 0xffff0000, v43
    v_lshlrev_b32 v168, 16, v44
    v_and_b32 v169, 0xffff0000, v44
    v_lshlrev_b32 v170, 16, v45
    v_and_b32 v171, 0xffff0000, v45
    s_add_u32 s26, s24, 0x100000
    s_add_u32 m0, s29, 0x8000
    s_nop 0
    buffer_load_dwordx4 v136, s[16:19], s26 offen lds
    v_lshlrev_b32 v172, 16, v46
    v_and_b32 v173, 0xffff0000, v46
    v_lshlrev_b32 v174, 16, v47
    v_and_b32 v175, 0xffff0000, v47
    v_pk_add_f32 v[160:161], v[160:161], v[154:155] op_sel_hi:[1,0] neg_lo:[0,1] neg_hi:[0,1]
    v_pk_add_f32 v[162:163], v[162:163], v[154:155] op_sel_hi:[1,0] neg_lo:[0,1] neg_hi:[0,1]
    v_pk_add_f32 v[164:165], v[164:165], v[154:155] op_sel_hi:[1,0] neg_lo:[0,1] neg_hi:[0,1]
    v_pk_add_f32 v[166:167], v[166:167], v[154:155] op_sel_hi:[1,0] neg_lo:[0,1] neg_hi:[0,1]
    v_pk_add_f32 v[168:169], v[168:169], v[154:155] op_sel_hi:[1,0] neg_lo:[0,1] neg_hi:[0,1]
    v_pk_add_f32 v[170:171], v[170:171], v[154:155] op_sel_hi:[1,0] neg_lo:[0,1] neg_hi:[0,1]
    v_pk_add_f32 v[172:173], v[172:173], v[154:155] op_sel_hi:[1,0] neg_lo:[0,1] neg_hi:[0,1]
    v_pk_add_f32 v[174:175], v[174:175], v[154:155] op_sel_hi:[1,0] neg_lo:[0,1] neg_hi:[0,1]
    v_cvt_pk_bf16_f32 v40, v160, v161
    v_cvt_pk_bf16_f32 v41, v162, v163
    v_cvt_pk_bf16_f32 v42, v164, v165
    v_cvt_pk_bf16_f32 v43, v166, v167
    v_cvt_pk_bf16_f32 v44, v168, v169
    v_cvt_pk_bf16_f32 v45, v170, v171
    v_cvt_pk_bf16_f32 v46, v172, v173
    v_cvt_pk_bf16_f32 v47, v174, v175
    v_lshlrev_b32 v160, 16, v40
    v_and_b32 v161, 0xffff0000, v40
    v_lshlrev_b32 v162, 16, v41
    v_and_b32 v163, 0xffff0000, v41
    v_lshlrev_b32 v164, 16, v42
    v_and_b32 v165, 0xffff0000, v42
    v_lshlrev_b32 v166, 16, v43
    v_and_b32 v167, 0xffff0000, v43
    v_lshlrev_b32 v168, 16, v44
    v_and_b32 v169, 0xffff0000, v44
    v_lshlrev_b32 v170, 16, v45
    v_and_b32 v171, 0xffff0000, v45
    v_lshlrev_b32 v172, 16, v46
    v_and_b32 v173, 0xffff0000, v46
    v_lshlrev_b32 v174, 16, v47
    v_and_b32 v175, 0xffff0000, v47
    v_pk_mul_f32 v[160:161], v[160:161], v[152:153] op_sel_hi:[1,0]
    v_pk_mul_f32 v[162:163], v[162:163], v[152:153] op_sel_hi:[1,0]
    v_pk_mul_f32 v[164:165], v[164:165], v[152:153] op_sel_hi:[1,0]
    v_pk_mul_f32 v[166:167], v[166:167], v[152:153] op_sel_hi:[1,0]
    v_pk_mul_f32 v[168:169], v[168:169], v[152:153] op_sel_hi:[1,0]
    v_pk_mul_f32 v[170:171], v[170:171], v[152:153] op_sel_hi:[1,0]
    v_pk_mul_f32 v[172:173], v[172:173], v[152:153] op_sel_hi:[1,0]
    v_pk_mul_f32 v[174:175], v[174:175], v[152:153] op_sel_hi:[1,0]
    v_cvt_pk_bf16_f32 v160, v160, v161
    v_cvt_pk_bf16_f32 v162, v162, v163
    v_cvt_pk_bf16_f32 v164, v164, v165
    v_cvt_pk_bf16_f32 v166, v166, v167
    v_cvt_pk_bf16_f32 v168, v168, v169
    v_cvt_pk_bf16_f32 v170, v170, v171
    s_add_u32 s26, s24, 0x120000
    s_add_u32 m0, s29, 0x9000
    s_nop 0
    buffer_load_dwordx4 v136, s[16:19], s26 offen lds
    v_cvt_pk_bf16_f32 v172, v172, v173
    v_cvt_pk_bf16_f32 v174, v174, v175
    v_accvgpr_write_b32 a40, v160
    v_accvgpr_write_b32 a41, v162
    v_accvgpr_write_b32 a42, v164
    v_accvgpr_write_b32 a43, v166
    v_accvgpr_write_b32 a44, v168
    v_accvgpr_write_b32 a45, v170
    v_accvgpr_write_b32 a46, v172
    v_accvgpr_write_b32 a47, v174
    v_lshlrev_b32 v160, 16, v48
    v_and_b32 v161, 0xffff0000, v48
    v_lshlrev_b32 v162, 16, v49
    v_and_b32 v163, 0xffff0000, v49
    v_lshlrev_b32 v164, 16, v50
    v_and_b32 v165, 0xffff0000, v50
    v_lshlrev_b32 v166, 16, v51
    v_and_b32 v167, 0xffff0000, v51
    v_lshlrev_b32 v168, 16, v52
    v_and_b32 v169, 0xffff0000, v52
    v_lshlrev_b32 v170, 16, v53
    v_and_b32 v171, 0xffff0000, v53
    v_lshlrev_b32 v172, 16, v54
    v_and_b32 v173, 0xffff0000, v54
    v_lshlrev_b32 v174, 16, v55
    v_and_b32 v175, 0xffff0000, v55
    v_pk_add_f32 v[160:161], v[160:161], v[154:155] op_sel_hi:[1,0] neg_lo:[0,1] neg_hi:[0,1]
    v_pk_add_f32 v[162:163], v[162:163], v[154:155] op_sel_hi:[1,0] neg_lo:[0,1] neg_hi:[0,1]
    v_pk_add_f32 v[164:165], v[164:165], v[154:155] op_sel_hi:[1,0] neg_lo:[0,1] neg_hi:[0,1]
    v_pk_add_f32 v[166:167], v[166:167], v[154:155] op_sel_hi:[1,0] neg_lo:[0,1] neg_hi:[0,1]
    v_pk_add_f32 v[168:169], v[168:169], v[154:155] op_sel_hi:[1,0] neg_lo:[0,1] neg_hi:[0,1]
    v_pk_add_f32 v[170:171], v[170:171], v[154:155] op_sel_hi:[1,0] neg_lo:[0,1] neg_hi:[0,1]
    v_pk_add_f32 v[172:173], v[172:173], v[154:155] op_sel_hi:[1,0] neg_lo:[0,1] neg_hi:[0,1]
    v_pk_add_f32 v[174:175], v[174:175], v[154:155] op_sel_hi:[1,0] neg_lo:[0,1] neg_hi:[0,1]
    v_cvt_pk_bf16_f32 v48, v160, v161
    v_cvt_pk_bf16_f32 v49, v162, v163
    v_cvt_pk_bf16_f32 v50, v164, v165
    v_cvt_pk_bf16_f32 v51, v166, v167
    v_cvt_pk_bf16_f32 v52, v168, v169
    v_cvt_pk_bf16_f32 v53, v170, v171
    v_cvt_pk_bf16_f32 v54, v172, v173
    v_cvt_pk_bf16_f32 v55, v174, v175
    v_lshlrev_b32 v160, 16, v48
    v_and_b32 v161, 0xffff0000, v48
    v_lshlrev_b32 v162, 16, v49
    v_and_b32 v163, 0xffff0000, v49
    v_lshlrev_b32 v164, 16, v50
    v_and_b32 v165, 0xffff0000, v50
    v_lshlrev_b32 v166, 16, v51
    v_and_b32 v167, 0xffff0000, v51
    s_add_u32 s26, s24, 0x140000
    s_add_u32 m0, s29, 0xa000
    s_nop 0
    buffer_load_dwordx4 v136, s[16:19], s26 offen lds
    v_lshlrev_b32 v168, 16, v52
    v_and_b32 v169, 0xffff0000, v52
    v_lshlrev_b32 v170, 16, v53
    v_and_b32 v171, 0xffff0000, v53
    v_lshlrev_b32 v172, 16, v54
    v_and_b32 v173, 0xffff0000, v54
    v_lshlrev_b32 v174, 16, v55
    v_and_b32 v175, 0xffff0000, v55
    v_pk_mul_f32 v[160:161], v[160:161], v[152:153] op_sel_hi:[1,0]
    v_pk_mul_f32 v[162:163], v[162:163], v[152:153] op_sel_hi:[1,0]
    v_pk_mul_f32 v[164:165], v[164:165], v[152:153] op_sel_hi:[1,0]
    v_pk_mul_f32 v[166:167], v[166:167], v[152:153] op_sel_hi:[1,0]
    v_pk_mul_f32 v[168:169], v[168:169], v[152:153] op_sel_hi:[1,0]
    v_pk_mul_f32 v[170:171], v[170:171], v[152:153] op_sel_hi:[1,0]
    v_pk_mul_f32 v[172:173], v[172:173], v[152:153] op_sel_hi:[1,0]
    v_pk_mul_f32 v[174:175], v[174:175], v[152:153] op_sel_hi:[1,0]
    v_cvt_pk_bf16_f32 v160, v160, v161
    v_cvt_pk_bf16_f32 v162, v162, v163
    v_cvt_pk_bf16_f32 v164, v164, v165
    v_cvt_pk_bf16_f32 v166, v166, v167
    v_cvt_pk_bf16_f32 v168, v168, v169
    v_cvt_pk_bf16_f32 v170, v170, v171
    v_cvt_pk_bf16_f32 v172, v172, v173
    v_cvt_pk_bf16_f32 v174, v174, v175
    v_accvgpr_write_b32 a48, v160
    v_accvgpr_write_b32 a49, v162
    v_accvgpr_write_b32 a50, v164
    v_accvgpr_write_b32 a51, v166
    v_accvgpr_write_b32 a52, v168
    v_accvgpr_write_b32 a53, v170
    v_accvgpr_write_b32 a54, v172
    v_accvgpr_write_b32 a55, v174
    v_lshlrev_b32 v160, 16, v56
    v_and_b32 v161, 0xffff0000, v56
    v_lshlrev_b32 v162, 16, v57
    v_and_b32 v163, 0xffff0000, v57
    v_lshlrev_b32 v164, 16, v58
    v_and_b32 v165, 0xffff0000, v58
    v_lshlrev_b32 v166, 16, v59
    v_and_b32 v167, 0xffff0000, v59
    v_lshlrev_b32 v168, 16, v60
    v_and_b32 v169, 0xffff0000, v60
    v_lshlrev_b32 v170, 16, v61
    v_and_b32 v171, 0xffff0000, v61
    v_lshlrev_b32 v172, 16, v62
    v_and_b32 v173, 0xffff0000, v62
    v_lshlrev_b32 v174, 16, v63
    v_and_b32 v175, 0xffff0000, v63
    v_pk_add_f32 v[160:161], v[160:161], v[154:155] op_sel_hi:[1,0] neg_lo:[0,1] neg_hi:[0,1]
    v_pk_add_f32 v[162:163], v[162:163], v[154:155] op_sel_hi:[1,0] neg_lo:[0,1] neg_hi:[0,1]
    s_add_u32 s26, s24, 0x160000
    s_add_u32 m0, s29, 0xb000
    s_nop 0
    buffer_load_dwordx4 v136, s[16:19], s26 offen lds
    v_pk_add_f32 v[164:165], v[164:165], v[154:155] op_sel_hi:[1,0] neg_lo:[0,1] neg_hi:[0,1]
    v_pk_add_f32 v[166:167], v[166:167], v[154:155] op_sel_hi:[1,0] neg_lo:[0,1] neg_hi:[0,1]
    v_pk_add_f32 v[168:169], v[168:169], v[154:155] op_sel_hi:[1,0] neg_lo:[0,1] neg_hi:[0,1]
    v_pk_add_f32 v[170:171], v[170:171], v[154:155] op_sel_hi:[1,0] neg_lo:[0,1] neg_hi:[0,1]
    v_pk_add_f32 v[172:173], v[172:173], v[154:155] op_sel_hi:[1,0] neg_lo:[0,1] neg_hi:[0,1]
    v_pk_add_f32 v[174:175], v[174:175], v[154:155] op_sel_hi:[1,0] neg_lo:[0,1] neg_hi:[0,1]
    v_cvt_pk_bf16_f32 v56, v160, v161
    v_cvt_pk_bf16_f32 v57, v162, v163
    v_cvt_pk_bf16_f32 v58, v164, v165
    v_cvt_pk_bf16_f32 v59, v166, v167
    v_cvt_pk_bf16_f32 v60, v168, v169
    v_cvt_pk_bf16_f32 v61, v170, v171
    v_cvt_pk_bf16_f32 v62, v172, v173
    v_cvt_pk_bf16_f32 v63, v174, v175
    v_lshlrev_b32 v160, 16, v56
    v_and_b32 v161, 0xffff0000, v56
    v_lshlrev_b32 v162, 16, v57
    v_and_b32 v163, 0xffff0000, v57
    v_lshlrev_b32 v164, 16, v58
    v_and_b32 v165, 0xffff0000, v58
    v_lshlrev_b32 v166, 16, v59
    v_and_b32 v167, 0xffff0000, v59
    v_lshlrev_b32 v168, 16, v60
    v_and_b32 v169, 0xffff0000, v60
    v_lshlrev_b32 v170, 16, v61
    v_and_b32 v171, 0xffff0000, v61
    v_lshlrev_b32 v172, 16, v62
    v_and_b32 v173, 0xffff0000, v62
    v_lshlrev_b32 v174, 16, v63
    v_and_b32 v175, 0xffff0000, v63
    v_pk_mul_f32 v[160:161], v[160:161], v[152:153] op_sel_hi:[1,0]
    v_pk_mul_f32 v[162:163], v[162:163], v[152:153] op_sel_hi:[1,0]
    v_pk_mul_f32 v[164:165], v[164:165], v[152:153] op_sel_hi:[1,0]
    v_pk_mul_f32 v[166:167], v[166:167], v[152:153] op_sel_hi:[1,0]
    v_pk_mul_f32 v[168:169], v[168:169], v[152:153] op_sel_hi:[1,0]
    v_pk_mul_f32 v[170:171], v[170:171], v[152:153] op_sel_hi:[1,0]
    v_pk_mul_f32 v[172:173], v[172:173], v[152:153] op_sel_hi:[1,0]
    v_pk_mul_f32 v[174:175], v[174:175], v[152:153] op_sel_hi:[1,0]
    v_cvt_pk_bf16_f32 v160, v160, v161
    v_cvt_pk_bf16_f32 v162, v162, v163
    v_cvt_pk_bf16_f32 v164, v164, v165
    v_cvt_pk_bf16_f32 v166, v166, v167
    v_cvt_pk_bf16_f32 v168, v168, v169
    v_cvt_pk_bf16_f32 v170, v170, v171
    v_cvt_pk_bf16_f32 v172, v172, v173
    v_cvt_pk_bf16_f32 v174, v174, v175
    v_accvgpr_write_b32 a56, v160
    v_accvgpr_write_b32 a57, v162
    v_accvgpr_write_b32 a58, v164
    v_accvgpr_write_b32 a59, v166
    s_add_u32 s26, s24, 0x180000
    s_add_u32 m0, s29, 0xc000
    s_nop 0
    buffer_load_dwordx4 v136, s[16:19], s26 offen lds
    v_accvgpr_write_b32 a60, v168
    v_accvgpr_write_b32 a61, v170
    v_accvgpr_write_b32 a62, v172
    v_accvgpr_write_b32 a63, v174
    s_waitcnt vmcnt(13)
    v_pk_mov_b32 v[150:151], 0, 0
    v_pk_mov_b32 v[152:153], 0, 0
    v_dot2_f32_bf16 v150, v64, v158, v150
    v_dot2_f32_bf16 v152, v64, v64, v152
    v_dot2_f32_bf16 v151, v65, v158, v151
    v_dot2_f32_bf16 v153, v65, v65, v153
    v_dot2_f32_bf16 v150, v66, v158, v150
    v_dot2_f32_bf16 v152, v66, v66, v152
    v_dot2_f32_bf16 v151, v67, v158, v151
    v_dot2_f32_bf16 v153, v67, v67, v153
    v_dot2_f32_bf16 v150, v68, v158, v150
    v_dot2_f32_bf16 v152, v68, v68, v152
    v_dot2_f32_bf16 v151, v69, v158, v151
    v_dot2_f32_bf16 v153, v69, v69, v153
    v_dot2_f32_bf16 v150, v70, v158, v150
    v_dot2_f32_bf16 v152, v70, v70, v152
    v_dot2_f32_bf16 v151, v71, v158, v151
    v_dot2_f32_bf16 v153, v71, v71, v153
    v_dot2_f32_bf16 v150, v72, v158, v150
    v_dot2_f32_bf16 v152, v72, v72, v152
    v_dot2_f32_bf16 v151, v73, v158, v151
    v_dot2_f32_bf16 v153, v73, v73, v153
    v_dot2_f32_bf16 v150, v74, v158, v150
    v_dot2_f32_bf16 v152, v74, v74, v152
    v_dot2_f32_bf16 v151, v75, v158, v151
    v_dot2_f32_bf16 v153, v75, v75, v153
    v_dot2_f32_bf16 v150, v76, v158, v150
    v_dot2_f32_bf16 v152, v76, v76, v152
    v_dot2_f32_bf16 v151, v77, v158, v151
    v_dot2_f32_bf16 v153, v77, v77, v153
    v_dot2_f32_bf16 v150, v78, v158, v150
    v_dot2_f32_bf16 v152, v78, v78, v152
    v_dot2_f32_bf16 v151, v79, v158, v151
    v_dot2_f32_bf16 v153, v79, v79, v153
    v_dot2_f32_bf16 v150, v80, v158, v150
    v_dot2_f32_bf16 v152, v80, v80, v152
    v_dot2_f32_bf16 v151, v81, v158, v151
    v_dot2_f32_bf16 v153, v81, v81, v153
    v_dot2_f32_bf16 v150, v82, v158, v150
    v_dot2_f32_bf16 v152, v82, v82, v152
    v_dot2_f32_bf16 v151, v83, v158, v151
    v_dot2_f32_bf16 v153, v83, v83, v153
    v_dot2_f32_bf16 v150, v84, v158, v150
    v_dot2_f32_bf16 v152, v84, v84, v152
    v_dot2_f32_bf16 v151, v85, v158, v151
    v_dot2_f32_bf16 v153, v85, v85, v153
    v_dot2_f32_bf16 v150, v86, v158, v150
    v_dot2_f32_bf16 v152, v86, v86, v152
    s_add_u32 s26, s24, 0x1a0000
    s_add_u32 m0, s29, 0xd000
    s_nop 0
    buffer_load_dwordx4 v136, s[16:19], s26 offen lds
    v_dot2_f32_bf16 v151, v87, v158, v151
    v_dot2_f32_bf16 v153, v87, v87, v153
    v_dot2_f32_bf16 v150, v88, v158, v150
    v_dot2_f32_bf16 v152, v88, v88, v152
    v_dot2_f32_bf16 v151, v89, v158, v151
    v_dot2_f32_bf16 v153, v89, v89, v153
    v_dot2_f32_bf16 v150, v90, v158, v150
    v_dot2_f32_bf16 v152, v90, v90, v152
    v_dot2_f32_bf16 v151, v91, v158, v151
    v_dot2_f32_bf16 v153, v91, v91, v153
    v_dot2_f32_bf16 v150, v92, v158, v150
    v_dot2_f32_bf16 v152, v92, v92, v152
    v_dot2_f32_bf16 v151, v93, v158, v151
    v_dot2_f32_bf16 v153, v93, v93, v153
    v_dot2_f32_bf16 v150, v94, v158, v150
    v_dot2_f32_bf16 v152, v94, v94, v152
    v_dot2_f32_bf16 v151, v95, v158, v151
    v_dot2_f32_bf16 v153, v95, v95, v153
    v_dot2_f32_bf16 v150, v96, v158, v150
    v_dot2_f32_bf16 v152, v96, v96, v152
    v_dot2_f32_bf16 v151, v97, v158, v151
    v_dot2_f32_bf16 v153, v97, v97, v153
    v_dot2_f32_bf16 v150, v98, v158, v150
    v_dot2_f32_bf16 v152, v98, v98, v152
    v_dot2_f32_bf16 v151, v99, v158, v151
    v_dot2_f32_bf16 v153, v99, v99, v153
    v_dot2_f32_bf16 v150, v100, v158, v150
    v_dot2_f32_bf16 v152, v100, v100, v152
    v_dot2_f32_bf16 v151, v101, v158, v151
    v_dot2_f32_bf16 v153, v101, v101, v153
    v_dot2_f32_bf16 v150, v102, v158, v150
    v_dot2_f32_bf16 v152, v102, v102, v152
    v_dot2_f32_bf16 v151, v103, v158, v151
    v_dot2_f32_bf16 v153, v103, v103, v153
    v_dot2_f32_bf16 v150, v104, v158, v150
    v_dot2_f32_bf16 v152, v104, v104, v152
    v_dot2_f32_bf16 v151, v105, v158, v151
    v_dot2_f32_bf16 v153, v105, v105, v153
    v_dot2_f32_bf16 v150, v106, v158, v150
    v_dot2_f32_bf16 v152, v106, v106, v152
    v_dot2_f32_bf16 v151, v107, v158, v151
    v_dot2_f32_bf16 v153, v107, v107, v153
    v_dot2_f32_bf16 v150, v108, v158, v150
    v_dot2_f32_bf16 v152, v108, v108, v152
    v_dot2_f32_bf16 v151, v109, v158, v151
    v_dot2_f32_bf16 v153, v109, v109, v153
    v_dot2_f32_bf16 v150, v110, v158, v150
    v_dot2_f32_bf16 v152, v110, v110, v152
    v_dot2_f32_bf16 v151, v111, v158, v151
    v_dot2_f32_bf16 v153, v111, v111, v153
    s_add_u32 s26, s24, 0x1c0000
    s_add_u32 m0, s29, 0xe000
    s_nop 0
    buffer_load_dwordx4 v136, s[16:19], s26 offen lds
    v_dot2_f32_bf16 v150, v112, v158, v150
    v_dot2_f32_bf16 v152, v112, v112, v152
    v_dot2_f32_bf16 v151, v113, v158, v151
    v_dot2_f32_bf16 v153, v113, v113, v153
    v_dot2_f32_bf16 v150, v114, v158, v150
    v_dot2_f32_bf16 v152, v114, v114, v152
    v_dot2_f32_bf16 v151, v115, v158, v151
    v_dot2_f32_bf16 v153, v115, v115, v153
    v_dot2_f32_bf16 v150, v116, v158, v150
    v_dot2_f32_bf16 v152, v116, v116, v152
    v_dot2_f32_bf16 v151, v117, v158, v151
    v_dot2_f32_bf16 v153, v117, v117, v153
    v_dot2_f32_bf16 v150, v118, v158, v150
    v_dot2_f32_bf16 v152, v118, v118, v152
    v_dot2_f32_bf16 v151, v119, v158, v151
    v_dot2_f32_bf16 v153, v119, v119, v153
    v_dot2_f32_bf16 v150, v120, v158, v150
    v_dot2_f32_bf16 v152, v120, v120, v152
    v_dot2_f32_bf16 v151, v121, v158, v151
    v_dot2_f32_bf16 v153, v121, v121, v153
    v_dot2_f32_bf16 v150, v122, v158, v150
    v_dot2_f32_bf16 v152, v122, v122, v152
    v_dot2_f32_bf16 v151, v123, v158, v151
    v_dot2_f32_bf16 v153, v123, v123, v153
    v_dot2_f32_bf16 v150, v124, v158, v150
    v_dot2_f32_bf16 v152, v124, v124, v152
    v_dot2_f32_bf16 v151, v125, v158, v151
    v_dot2_f32_bf16 v153, v125, v125, v153
    v_dot2_f32_bf16 v150, v126, v158, v150
    v_dot2_f32_bf16 v152, v126, v126, v152
    v_dot2_f32_bf16 v151, v127, v158, v151
    v_dot2_f32_bf16 v153, v127, v127, v153
    s_nop 1
    v_add_f32 v150, v150, v151
    v_add_f32 v152, v152, v153
    v_mov_b32 v157, v150
    s_nop 1
    v_permlane32_swap_b32 v157, v150
    v_add_f32 v150, v157, v150
    v_mov_b32 v157, v150
    s_nop 1
    v_permlane16_swap_b32 v157, v150
    v_add_f32 v150, v157, v150
    v_mov_b32 v157, v152
    s_nop 1
    v_permlane32_swap_b32 v157, v152
    v_add_f32 v152, v157, v152
    v_mov_b32 v157, v152
    s_nop 1
    v_permlane16_swap_b32 v157, v152
    v_add_f32 v152, v157, v152
    v_mul_f32 v150, 0x3b000000, v150
    v_cvt_pk_bf16_f32 v154, v150, v150
    v_and_b32 v154, 0xffff0000, v154
    v_sub_f32 v156, v150, v154
    v_mul_f32 v157, v150, v150
    v_mul_f32 v152, 0x3b000000, v152
    v_sub_f32 v152, v152, v157
    v_max_f32 v152, 0, v152
    v_cvt_pk_bf16_f32 v152, v152, v152
    v_and_b32 v152, 0xffff0000, v152
    v_add_f32 v152, 0x3727c5ac, v152
    v_cvt_pk_bf16_f32 v152, v152, v152
    v_and_b32 v152, 0xffff0000, v152
    v_sqrt_f32 v152, v152
    s_nop 0
    v_cvt_pk_bf16_f32 v152, v152, v152
    v_and_b32 v152, 0xffff0000, v152
    v_rcp_f32 v152, v152
    v_lshlrev_b32 v160, 16, v64
    v_and_b32 v161, 0xffff0000, v64
    v_lshlrev_b32 v162, 16, v65
    v_and_b32 v163, 0xffff0000, v65
    v_lshlrev_b32 v164, 16, v66
    v_and_b32 v165, 0xffff0000, v66
    v_lshlrev_b32 v166, 16, v67
    v_and_b32 v167, 0xffff0000, v67
    v_lshlrev_b32 v168, 16, v68
    v_and_b32 v169, 0xffff0000, v68
    v_lshlrev_b32 v170, 16, v69
    v_and_b32 v171, 0xffff0000, v69
    v_lshlrev_b32 v172, 16, v70
    v_and_b32 v173, 0xffff0000, v70
    v_lshlrev_b32 v174, 16, v71
    v_and_b32 v175, 0xffff0000, v71
    v_pk_add_f32 v[160:161], v[160:161], v[154:155] op_sel_hi:[1,0] neg_lo:[0,1] neg_hi:[0,1]
    v_pk_add_f32 v[162:163], v[162:163], v[154:155] op_sel_hi:[1,0] neg_lo:[0,1] neg_hi:[0,1]
    s_add_u32 s26, s24, 0x1e0000
    s_add_u32 m0, s29, 0xf000
    s_nop 0
    buffer_load_dwordx4 v136, s[16:19], s26 offen lds
    v_pk_add_f32 v[164:165], v[164:165], v[154:155] op_sel_hi:[1,0] neg_lo:[0,1] neg_hi:[0,1]
    v_pk_add_f32 v[166:167], v[166:167], v[154:155] op_sel_hi:[1,0] neg_lo:[0,1] neg_hi:[0,1]
    v_pk_add_f32 v[168:169], v[168:169], v[154:155] op_sel_hi:[1,0] neg_lo:[0,1] neg_hi:[0,1]
    v_pk_add_f32 v[170:171], v[170:171], v[154:155] op_sel_hi:[1,0] neg_lo:[0,1] neg_hi:[0,1]
    v_pk_add_f32 v[172:173], v[172:173], v[154:155] op_sel_hi:[1,0] neg_lo:[0,1] neg_hi:[0,1]
    v_pk_add_f32 v[174:175], v[174:175], v[154:155] op_sel_hi:[1,0] neg_lo:[0,1] neg_hi:[0,1]
    v_cvt_pk_bf16_f32 v64, v160, v161
    v_cvt_pk_bf16_f32 v65, v162, v163
    v_cvt_pk_bf16_f32 v66, v164, v165
    v_cvt_pk_bf16_f32 v67, v166, v167
    v_cvt_pk_bf16_f32 v68, v168, v169
    v_cvt_pk_bf16_f32 v69, v170, v171
    v_cvt_pk_bf16_f32 v70, v172, v173
    v_cvt_pk_bf16_f32 v71, v174, v175
    v_lshlrev_b32 v160, 16, v64
    v_and_b32 v161, 0xffff0000, v64
    v_lshlrev_b32 v162, 16, v65
    v_and_b32 v163, 0xffff0000, v65
    v_lshlrev_b32 v164, 16, v66
    v_and_b32 v165, 0xffff0000, v66
    v_lshlrev_b32 v166, 16, v67
    v_and_b32 v167, 0xffff0000, v67
    v_lshlrev_b32 v168, 16, v68
    v_and_b32 v169, 0xffff0000, v68
    v_lshlrev_b32 v170, 16, v69
    v_and_b32 v171, 0xffff0000, v69
    v_lshlrev_b32 v172, 16, v70
    v_and_b32 v173, 0xffff0000, v70
    v_lshlrev_b32 v174, 16, v71
    v_and_b32 v175, 0xffff0000, v71
    v_pk_mul_f32 v[160:161], v[160:161], v[152:153] op_sel_hi:[1,0]
    v_pk_mul_f32 v[162:163], v[162:163], v[152:153] op_sel_hi:[1,0]
    v_pk_mul_f32 v[164:165], v[164:165], v[152:153] op_sel_hi:[1,0]
    v_pk_mul_f32 v[166:167], v[166:167], v[152:153] op_sel_hi:[1,0]
    v_pk_mul_f32 v[168:169], v[168:169], v[152:153] op_sel_hi:[1,0]
    v_pk_mul_f32 v[170:171], v[170:171], v[152:153] op_sel_hi:[1,0]
    v_pk_mul_f32 v[172:173], v[172:173], v[152:153] op_sel_hi:[1,0]
    v_pk_mul_f32 v[174:175], v[174:175], v[152:153] op_sel_hi:[1,0]
    v_cvt_pk_bf16_f32 v160, v160, v161
    v_cvt_pk_bf16_f32 v162, v162, v163
    v_cvt_pk_bf16_f32 v164, v164, v165
    v_cvt_pk_bf16_f32 v166, v166, v167
    v_cvt_pk_bf16_f32 v168, v168, v169
    v_cvt_pk_bf16_f32 v170, v170, v171
    v_cvt_pk_bf16_f32 v172, v172, v173
    v_cvt_pk_bf16_f32 v174, v174, v175
    v_accvgpr_write_b32 a64, v160
    v_accvgpr_write_b32 a65, v162
    v_accvgpr_write_b32 a66, v164
    v_accvgpr_write_b32 a67, v166
    s_add_u32 s26, s24, 0x200000
    s_add_u32 m0, s29, 0x10000
    s_nop 0
    buffer_load_dwordx4 v136, s[16:19], s26 offen lds
    v_accvgpr_write_b32 a68, v168
    v_accvgpr_write_b32 a69, v170
    v_accvgpr_write_b32 a70, v172
    v_accvgpr_write_b32 a71, v174
    v_lshlrev_b32 v160, 16, v72
    v_and_b32 v161, 0xffff0000, v72
    v_lshlrev_b32 v162, 16, v73
    v_and_b32 v163, 0xffff0000, v73
    v_lshlrev_b32 v164, 16, v74
    v_and_b32 v165, 0xffff0000, v74
    v_lshlrev_b32 v166, 16, v75
    v_and_b32 v167, 0xffff0000, v75
    v_lshlrev_b32 v168, 16, v76
    v_and_b32 v169, 0xffff0000, v76
    v_lshlrev_b32 v170, 16, v77
    v_and_b32 v171, 0xffff0000, v77
    v_lshlrev_b32 v172, 16, v78
    v_and_b32 v173, 0xffff0000, v78
    v_lshlrev_b32 v174, 16, v79
    v_and_b32 v175, 0xffff0000, v79
    v_pk_add_f32 v[160:161], v[160:161], v[154:155] op_sel_hi:[1,0] neg_lo:[0,1] neg_hi:[0,1]
    v_pk_add_f32 v[162:163], v[162:163], v[154:155] op_sel_hi:[1,0] neg_lo:[0,1] neg_hi:[0,1]
    v_pk_add_f32 v[164:165], v[164:165], v[154:155] op_sel_hi:[1,0] neg_lo:[0,1] neg_hi:[0,1]
    v_pk_add_f32 v[166:167], v[166:167], v[154:155] op_sel_hi:[1,0] neg_lo:[0,1] neg_hi:[0,1]
    v_pk_add_f32 v[168:169], v[168:169], v[154:155] op_sel_hi:[1,0] neg_lo:[0,1] neg_hi:[0,1]
    v_pk_add_f32 v[170:171], v[170:171], v[154:155] op_sel_hi:[1,0] neg_lo:[0,1] neg_hi:[0,1]
    v_pk_add_f32 v[172:173], v[172:173], v[154:155] op_sel_hi:[1,0] neg_lo:[0,1] neg_hi:[0,1]
    v_pk_add_f32 v[174:175], v[174:175], v[154:155] op_sel_hi:[1,0] neg_lo:[0,1] neg_hi:[0,1]
    v_cvt_pk_bf16_f32 v72, v160, v161
    v_cvt_pk_bf16_f32 v73, v162, v163
    v_cvt_pk_bf16_f32 v74, v164, v165
    v_cvt_pk_bf16_f32 v75, v166, v167
    v_cvt_pk_bf16_f32 v76, v168, v169
    v_cvt_pk_bf16_f32 v77, v170, v171
    v_cvt_pk_bf16_f32 v78, v172, v173
    v_cvt_pk_bf16_f32 v79, v174, v175
    v_lshlrev_b32 v160, 16, v72
    v_and_b32 v161, 0xffff0000, v72
    v_lshlrev_b32 v162, 16, v73
    v_and_b32 v163, 0xffff0000, v73
    v_lshlrev_b32 v164, 16, v74
    v_and_b32 v165, 0xffff0000, v74
    v_lshlrev_b32 v166, 16, v75
    v_and_b32 v167, 0xffff0000, v75
    v_lshlrev_b32 v168, 16, v76
    v_and_b32 v169, 0xffff0000, v76
    v_lshlrev_b32 v170, 16, v77
    v_and_b32 v171, 0xffff0000, v77
    v_lshlrev_b32 v172, 16, v78
    v_and_b32 v173, 0xffff0000, v78
    s_add_u32 s26, s24, 0x220000
    s_add_u32 m0, s29, 0x11000
    s_nop 0
    buffer_load_dwordx4 v136, s[16:19], s26 offen lds
    v_lshlrev_b32 v174, 16, v79
    v_and_b32 v175, 0xffff0000, v79
    v_pk_mul_f32 v[160:161], v[160:161], v[152:153] op_sel_hi:[1,0]
    v_pk_mul_f32 v[162:163], v[162:163], v[152:153] op_sel_hi:[1,0]
    v_pk_mul_f32 v[164:165], v[164:165], v[152:153] op_sel_hi:[1,0]
    v_pk_mul_f32 v[166:167], v[166:167], v[152:153] op_sel_hi:[1,0]
    v_pk_mul_f32 v[168:169], v[168:169], v[152:153] op_sel_hi:[1,0]
    v_pk_mul_f32 v[170:171], v[170:171], v[152:153] op_sel_hi:[1,0]
    v_pk_mul_f32 v[172:173], v[172:173], v[152:153] op_sel_hi:[1,0]
    v_pk_mul_f32 v[174:175], v[174:175], v[152:153] op_sel_hi:[1,0]
    v_cvt_pk_bf16_f32 v160, v160, v161
    v_cvt_pk_bf16_f32 v162, v162, v163
    v_cvt_pk_bf16_f32 v164, v164, v165
    v_cvt_pk_bf16_f32 v166, v166, v167
    v_cvt_pk_bf16_f32 v168, v168, v169
    v_cvt_pk_bf16_f32 v170, v170, v171
    v_cvt_pk_bf16_f32 v172, v172, v173
    v_cvt_pk_bf16_f32 v174, v174, v175
    v_accvgpr_write_b32 a72, v160
    v_accvgpr_write_b32 a73, v162
    v_accvgpr_write_b32 a74, v164
    v_accvgpr_write_b32 a75, v166
    v_accvgpr_write_b32 a76, v168
    v_accvgpr_write_b32 a77, v170
    v_accvgpr_write_b32 a78, v172
    v_accvgpr_write_b32 a79, v174
    v_lshlrev_b32 v160, 16, v80
    v_and_b32 v161, 0xffff0000, v80
    v_lshlrev_b32 v162, 16, v81
    v_and_b32 v163, 0xffff0000, v81
    v_lshlrev_b32 v164, 16, v82
    v_and_b32 v165, 0xffff0000, v82
    v_lshlrev_b32 v166, 16, v83
    v_and_b32 v167, 0xffff0000, v83
    v_lshlrev_b32 v168, 16, v84
    v_and_b32 v169, 0xffff0000, v84
    v_lshlrev_b32 v170, 16, v85
    v_and_b32 v171, 0xffff0000, v85
    v_lshlrev_b32 v172, 16, v86
    v_and_b32 v173, 0xffff0000, v86
    v_lshlrev_b32 v174, 16, v87
    v_and_b32 v175, 0xffff0000, v87
    v_pk_add_f32 v[160:161], v[160:161], v[154:155] op_sel_hi:[1,0] neg_lo:[0,1] neg_hi:[0,1]
    v_pk_add_f32 v[162:163], v[162:163], v[154:155] op_sel_hi:[1,0] neg_lo:[0,1] neg_hi:[0,1]
    v_pk_add_f32 v[164:165], v[164:165], v[154:155] op_sel_hi:[1,0] neg_lo:[0,1] neg_hi:[0,1]
    v_pk_add_f32 v[166:167], v[166:167], v[154:155] op_sel_hi:[1,0] neg_lo:[0,1] neg_hi:[0,1]
    v_pk_add_f32 v[168:169], v[168:169], v[154:155] op_sel_hi:[1,0] neg_lo:[0,1] neg_hi:[0,1]
    v_pk_add_f32 v[170:171], v[170:171], v[154:155] op_sel_hi:[1,0] neg_lo:[0,1] neg_hi:[0,1]
    v_pk_add_f32 v[172:173], v[172:173], v[154:155] op_sel_hi:[1,0] neg_lo:[0,1] neg_hi:[0,1]
    v_pk_add_f32 v[174:175], v[174:175], v[154:155] op_sel_hi:[1,0] neg_lo:[0,1] neg_hi:[0,1]
    s_add_u32 s26, s24, 0x240000
    s_add_u32 m0, s29, 0x12000
    s_nop 0
    buffer_load_dwordx4 v136, s[16:19], s26 offen lds
    v_cvt_pk_bf16_f32 v80, v160, v161
    v_cvt_pk_bf16_f32 v81, v162, v163
    v_cvt_pk_bf16_f32 v82, v164, v165
    v_cvt_pk_bf16_f32 v83, v166, v167
    v_cvt_pk_bf16_f32 v84, v168, v169
    v_cvt_pk_bf16_f32 v85, v170, v171
    v_cvt_pk_bf16_f32 v86, v172, v173
    v_cvt_pk_bf16_f32 v87, v174, v175
    v_lshlrev_b32 v160, 16, v80
    v_and_b32 v161, 0xffff0000, v80
    v_lshlrev_b32 v162, 16, v81
    v_and_b32 v163, 0xffff0000, v81
    v_lshlrev_b32 v164, 16, v82
    v_and_b32 v165, 0xffff0000, v82
    v_lshlrev_b32 v166, 16, v83
    v_and_b32 v167, 0xffff0000, v83
    v_lshlrev_b32 v168, 16, v84
    v_and_b32 v169, 0xffff0000, v84
    v_lshlrev_b32 v170, 16, v85
    v_and_b32 v171, 0xffff0000, v85
    v_lshlrev_b32 v172, 16, v86
    v_and_b32 v173, 0xffff0000, v86
    v_lshlrev_b32 v174, 16, v87
    v_and_b32 v175, 0xffff0000, v87
    v_pk_mul_f32 v[160:161], v[160:161], v[152:153] op_sel_hi:[1,0]
    v_pk_mul_f32 v[162:163], v[162:163], v[152:153] op_sel_hi:[1,0]
    v_pk_mul_f32 v[164:165], v[164:165], v[152:153] op_sel_hi:[1,0]
    v_pk_mul_f32 v[166:167], v[166:167], v[152:153] op_sel_hi:[1,0]
    v_pk_mul_f32 v[168:169], v[168:169], v[152:153] op_sel_hi:[1,0]
    v_pk_mul_f32 v[170:171], v[170:171], v[152:153] op_sel_hi:[1,0]
    v_pk_mul_f32 v[172:173], v[172:173], v[152:153] op_sel_hi:[1,0]
    v_pk_mul_f32 v[174:175], v[174:175], v[152:153] op_sel_hi:[1,0]
    v_cvt_pk_bf16_f32 v160, v160, v161
    v_cvt_pk_bf16_f32 v162, v162, v163
    v_cvt_pk_bf16_f32 v164, v164, v165
    v_cvt_pk_bf16_f32 v166, v166, v167
    v_cvt_pk_bf16_f32 v168, v168, v169
    v_cvt_pk_bf16_f32 v170, v170, v171
    v_cvt_pk_bf16_f32 v172, v172, v173
    v_cvt_pk_bf16_f32 v174, v174, v175
    v_accvgpr_write_b32 a80, v160
    v_accvgpr_write_b32 a81, v162
    v_accvgpr_write_b32 a82, v164
    v_accvgpr_write_b32 a83, v166
    v_accvgpr_write_b32 a84, v168
    v_accvgpr_write_b32 a85, v170
    v_accvgpr_write_b32 a86, v172
    v_accvgpr_write_b32 a87, v174
    v_lshlrev_b32 v160, 16, v88
    v_and_b32 v161, 0xffff0000, v88
    s_add_u32 s26, s24, 0x260000
    s_add_u32 m0, s29, 0x13000
    s_nop 0
    buffer_load_dwordx4 v136, s[16:19], s26 offen lds
    v_lshlrev_b32 v162, 16, v89
    v_and_b32 v163, 0xffff0000, v89
    v_lshlrev_b32 v164, 16, v90
    v_and_b32 v165, 0xffff0000, v90
    v_lshlrev_b32 v166, 16, v91
    v_and_b32 v167, 0xffff0000, v91
    v_lshlrev_b32 v168, 16, v92
    v_and_b32 v169, 0xffff0000, v92
    v_lshlrev_b32 v170, 16, v93
    v_and_b32 v171, 0xffff0000, v93
    v_lshlrev_b32 v172, 16, v94
    v_and_b32 v173, 0xffff0000, v94
    v_lshlrev_b32 v174, 16, v95
    v_and_b32 v175, 0xffff0000, v95
    v_pk_add_f32 v[160:161], v[160:161], v[154:155] op_sel_hi:[1,0] neg_lo:[0,1] neg_hi:[0,1]
    v_pk_add_f32 v[162:163], v[162:163], v[154:155] op_sel_hi:[1,0] neg_lo:[0,1] neg_hi:[0,1]
    v_pk_add_f32 v[164:165], v[164:165], v[154:155] op_sel_hi:[1,0] neg_lo:[0,1] neg_hi:[0,1]
    v_pk_add_f32 v[166:167], v[166:167], v[154:155] op_sel_hi:[1,0] neg_lo:[0,1] neg_hi:[0,1]
    v_pk_add_f32 v[168:169], v[168:169], v[154:155] op_sel_hi:[1,0] neg_lo:[0,1] neg_hi:[0,1]
    v_pk_add_f32 v[170:171], v[170:171], v[154:155] op_sel_hi:[1,0] neg_lo:[0,1] neg_hi:[0,1]
    v_pk_add_f32 v[172:173], v[172:173], v[154:155] op_sel_hi:[1,0] neg_lo:[0,1] neg_hi:[0,1]
    v_pk_add_f32 v[174:175], v[174:175], v[154:155] op_sel_hi:[1,0] neg_lo:[0,1] neg_hi:[0,1]
    v_cvt_pk_bf16_f32 v88, v160, v161
    v_cvt_pk_bf16_f32 v89, v162, v163
    v_cvt_pk_bf16_f32 v90, v164, v165
    v_cvt_pk_bf16_f32 v91, v166, v167
    v_cvt_pk_bf16_f32 v92, v168, v169
    v_cvt_pk_bf16_f32 v93, v170, v171
    v_cvt_pk_bf16_f32 v94, v172, v173
    v_cvt_pk_bf16_f32 v95, v174, v175
    v_lshlrev_b32 v160, 16, v88
    v_and_b32 v161, 0xffff0000, v88
    v_lshlrev_b32 v162, 16, v89
    v_and_b32 v163, 0xffff0000, v89
    v_lshlrev_b32 v164, 16, v90
    v_and_b32 v165, 0xffff0000, v90
    v_lshlrev_b32 v166, 16, v91
    v_and_b32 v167, 0xffff0000, v91
    v_lshlrev_b32 v168, 16, v92
    v_and_b32 v169, 0xffff0000, v92
    v_lshlrev_b32 v170, 16, v93
    v_and_b32 v171, 0xffff0000, v93
    v_lshlrev_b32 v172, 16, v94
    v_and_b32 v173, 0xffff0000, v94
    v_lshlrev_b32 v174, 16, v95
    v_and_b32 v175, 0xffff0000, v95
    v_pk_mul_f32 v[160:161], v[160:161], v[152:153] op_sel_hi:[1,0]
    v_pk_mul_f32 v[162:163], v[162:163], v[152:153] op_sel_hi:[1,0]
    v_pk_mul_f32 v[164:165], v[164:165], v[152:153] op_sel_hi:[1,0]
    v_pk_mul_f32 v[166:167], v[166:167], v[152:153] op_sel_hi:[1,0]
    s_add_u32 s26, s24, 0x280000
    s_add_u32 m0, s29, 0x14000
    s_nop 0
    buffer_load_dwordx4 v136, s[16:19], s26 offen lds
    v_pk_mul_f32 v[168:169], v[168:169], v[152:153] op_sel_hi:[1,0]
    v_pk_mul_f32 v[170:171], v[170:171], v[152:153] op_sel_hi:[1,0]
    v_pk_mul_f32 v[172:173], v[172:173], v[152:153] op_sel_hi:[1,0]
    v_pk_mul_f32 v[174:175], v[174:175], v[152:153] op_sel_hi:[1,0]
    v_cvt_pk_bf16_f32 v160, v160, v161
    v_cvt_pk_bf16_f32 v162, v162, v163
    v_cvt_pk_bf16_f32 v164, v164, v165
    v_cvt_pk_bf16_f32 v166, v166, v167
    v_cvt_pk_bf16_f32 v168, v168, v169
    v_cvt_pk_bf16_f32 v170, v170, v171
    v_cvt_pk_bf16_f32 v172, v172, v173
    v_cvt_pk_bf16_f32 v174, v174, v175
    v_accvgpr_write_b32 a88, v160
    v_accvgpr_write_b32 a89, v162
    v_accvgpr_write_b32 a90, v164
    v_accvgpr_write_b32 a91, v166
    v_accvgpr_write_b32 a92, v168
    v_accvgpr_write_b32 a93, v170
    v_accvgpr_write_b32 a94, v172
    v_accvgpr_write_b32 a95, v174
    v_lshlrev_b32 v160, 16, v96
    v_and_b32 v161, 0xffff0000, v96
    v_lshlrev_b32 v162, 16, v97
    v_and_b32 v163, 0xffff0000, v97
    v_lshlrev_b32 v164, 16, v98
    v_and_b32 v165, 0xffff0000, v98
    v_lshlrev_b32 v166, 16, v99
    v_and_b32 v167, 0xffff0000, v99
    v_lshlrev_b32 v168, 16, v100
    v_and_b32 v169, 0xffff0000, v100
    v_lshlrev_b32 v170, 16, v101
    v_and_b32 v171, 0xffff0000, v101
    v_lshlrev_b32 v172, 16, v102
    v_and_b32 v173, 0xffff0000, v102
    v_lshlrev_b32 v174, 16, v103
    v_and_b32 v175, 0xffff0000, v103
    v_pk_add_f32 v[160:161], v[160:161], v[154:155] op_sel_hi:[1,0] neg_lo:[0,1] neg_hi:[0,1]
    v_pk_add_f32 v[162:163], v[162:163], v[154:155] op_sel_hi:[1,0] neg_lo:[0,1] neg_hi:[0,1]
    v_pk_add_f32 v[164:165], v[164:165], v[154:155] op_sel_hi:[1,0] neg_lo:[0,1] neg_hi:[0,1]
    v_pk_add_f32 v[166:167], v[166:167], v[154:155] op_sel_hi:[1,0] neg_lo:[0,1] neg_hi:[0,1]
    v_pk_add_f32 v[168:169], v[168:169], v[154:155] op_sel_hi:[1,0] neg_lo:[0,1] neg_hi:[0,1]
    v_pk_add_f32 v[170:171], v[170:171], v[154:155] op_sel_hi:[1,0] neg_lo:[0,1] neg_hi:[0,1]
    v_pk_add_f32 v[172:173], v[172:173], v[154:155] op_sel_hi:[1,0] neg_lo:[0,1] neg_hi:[0,1]
    v_pk_add_f32 v[174:175], v[174:175], v[154:155] op_sel_hi:[1,0] neg_lo:[0,1] neg_hi:[0,1]
    v_cvt_pk_bf16_f32 v96, v160, v161
    v_cvt_pk_bf16_f32 v97, v162, v163
    v_cvt_pk_bf16_f32 v98, v164, v165
    v_cvt_pk_bf16_f32 v99, v166, v167
    v_cvt_pk_bf16_f32 v100, v168, v169
    v_cvt_pk_bf16_f32 v101, v170, v171
    s_add_u32 s26, s24, 0x2a0000
    s_add_u32 m0, s29, 0x15000
    s_nop 0
    buffer_load_dwordx4 v136, s[16:19], s26 offen lds
    v_cvt_pk_bf16_f32 v102, v172, v173
    v_cvt_pk_bf16_f32 v103, v174, v175
    v_lshlrev_b32 v160, 16, v96
    v_and_b32 v161, 0xffff0000, v96
    v_lshlrev_b32 v162, 16, v97
    v_and_b32 v163, 0xffff0000, v97
    v_lshlrev_b32 v164, 16, v98
    v_and_b32 v165, 0xffff0000, v98
    v_lshlrev_b32 v166, 16, v99
    v_and_b32 v167, 0xffff0000, v99
    v_lshlrev_b32 v168, 16, v100
    v_and_b32 v169, 0xffff0000, v100
    v_lshlrev_b32 v170, 16, v101
    v_and_b32 v171, 0xffff0000, v101
    v_lshlrev_b32 v172, 16, v102
    v_and_b32 v173, 0xffff0000, v102
    v_lshlrev_b32 v174, 16, v103
    v_and_b32 v175, 0xffff0000, v103
    v_pk_mul_f32 v[160:161], v[160:161], v[152:153] op_sel_hi:[1,0]
    v_pk_mul_f32 v[162:163], v[162:163], v[152:153] op_sel_hi:[1,0]
    v_pk_mul_f32 v[164:165], v[164:165], v[152:153] op_sel_hi:[1,0]
    v_pk_mul_f32 v[166:167], v[166:167], v[152:153] op_sel_hi:[1,0]
    v_pk_mul_f32 v[168:169], v[168:169], v[152:153] op_sel_hi:[1,0]
    v_pk_mul_f32 v[170:171], v[170:171], v[152:153] op_sel_hi:[1,0]
    v_pk_mul_f32 v[172:173], v[172:173], v[152:153] op_sel_hi:[1,0]
    v_pk_mul_f32 v[174:175], v[174:175], v[152:153] op_sel_hi:[1,0]
    v_cvt_pk_bf16_f32 v160, v160, v161
    v_cvt_pk_bf16_f32 v162, v162, v163
    v_cvt_pk_bf16_f32 v164, v164, v165
    v_cvt_pk_bf16_f32 v166, v166, v167
    v_cvt_pk_bf16_f32 v168, v168, v169
    v_cvt_pk_bf16_f32 v170, v170, v171
    v_cvt_pk_bf16_f32 v172, v172, v173
    v_cvt_pk_bf16_f32 v174, v174, v175
    v_accvgpr_write_b32 a96, v160
    v_accvgpr_write_b32 a97, v162
    v_accvgpr_write_b32 a98, v164
    v_accvgpr_write_b32 a99, v166
    v_accvgpr_write_b32 a100, v168
    v_accvgpr_write_b32 a101, v170
    v_accvgpr_write_b32 a102, v172
    v_accvgpr_write_b32 a103, v174
    v_lshlrev_b32 v160, 16, v104
    v_and_b32 v161, 0xffff0000, v104
    v_lshlrev_b32 v162, 16, v105
    v_and_b32 v163, 0xffff0000, v105
    v_lshlrev_b32 v164, 16, v106
    v_and_b32 v165, 0xffff0000, v106
    v_lshlrev_b32 v166, 16, v107
    v_and_b32 v167, 0xffff0000, v107
    s_add_u32 s26, s24, 0x2c0000
    s_add_u32 m0, s29, 0x16000
    s_nop 0
    buffer_load_dwordx4 v136, s[16:19], s26 offen lds
    v_lshlrev_b32 v168, 16, v108
    v_and_b32 v169, 0xffff0000, v108
    v_lshlrev_b32 v170, 16, v109
    v_and_b32 v171, 0xffff0000, v109
    v_lshlrev_b32 v172, 16, v110
    v_and_b32 v173, 0xffff0000, v110
    v_lshlrev_b32 v174, 16, v111
    v_and_b32 v175, 0xffff0000, v111
    v_pk_add_f32 v[160:161], v[160:161], v[154:155] op_sel_hi:[1,0] neg_lo:[0,1] neg_hi:[0,1]
    v_pk_add_f32 v[162:163], v[162:163], v[154:155] op_sel_hi:[1,0] neg_lo:[0,1] neg_hi:[0,1]
    v_pk_add_f32 v[164:165], v[164:165], v[154:155] op_sel_hi:[1,0] neg_lo:[0,1] neg_hi:[0,1]
    v_pk_add_f32 v[166:167], v[166:167], v[154:155] op_sel_hi:[1,0] neg_lo:[0,1] neg_hi:[0,1]
    v_pk_add_f32 v[168:169], v[168:169], v[154:155] op_sel_hi:[1,0] neg_lo:[0,1] neg_hi:[0,1]
    v_pk_add_f32 v[170:171], v[170:171], v[154:155] op_sel_hi:[1,0] neg_lo:[0,1] neg_hi:[0,1]
    v_pk_add_f32 v[172:173], v[172:173], v[154:155] op_sel_hi:[1,0] neg_lo:[0,1] neg_hi:[0,1]
    v_pk_add_f32 v[174:175], v[174:175], v[154:155] op_sel_hi:[1,0] neg_lo:[0,1] neg_hi:[0,1]
    v_cvt_pk_bf16_f32 v104, v160, v161
    v_cvt_pk_bf16_f32 v105, v162, v163
    v_cvt_pk_bf16_f32 v106, v164, v165
    v_cvt_pk_bf16_f32 v107, v166, v167
    v_cvt_pk_bf16_f32 v108, v168, v169
    v_cvt_pk_bf16_f32 v109, v170, v171
    v_cvt_pk_bf16_f32 v110, v172, v173
    v_cvt_pk_bf16_f32 v111, v174, v175
    v_lshlrev_b32 v160, 16, v104
    v_and_b32 v161, 0xffff0000, v104
    v_lshlrev_b32 v162, 16, v105
    v_and_b32 v163, 0xffff0000, v105
    v_lshlrev_b32 v164, 16, v106
    v_and_b32 v165, 0xffff0000, v106
    v_lshlrev_b32 v166, 16, v107
    v_and_b32 v167, 0xffff0000, v107
    v_lshlrev_b32 v168, 16, v108
    v_and_b32 v169, 0xffff0000, v108
    v_lshlrev_b32 v170, 16, v109
    v_and_b32 v171, 0xffff0000, v109
    v_lshlrev_b32 v172, 16, v110
    v_and_b32 v173, 0xffff0000, v110
    v_lshlrev_b32 v174, 16, v111
    v_and_b32 v175, 0xffff0000, v111
    v_pk_mul_f32 v[160:161], v[160:161], v[152:153] op_sel_hi:[1,0]
    v_pk_mul_f32 v[162:163], v[162:163], v[152:153] op_sel_hi:[1,0]
    v_pk_mul_f32 v[164:165], v[164:165], v[152:153] op_sel_hi:[1,0]
    v_pk_mul_f32 v[166:167], v[166:167], v[152:153] op_sel_hi:[1,0]
    v_pk_mul_f32 v[168:169], v[168:169], v[152:153] op_sel_hi:[1,0]
    v_pk_mul_f32 v[170:171], v[170:171], v[152:153] op_sel_hi:[1,0]
    v_pk_mul_f32 v[172:173], v[172:173], v[152:153] op_sel_hi:[1,0]
    v_pk_mul_f32 v[174:175], v[174:175], v[152:153] op_sel_hi:[1,0]
    v_cvt_pk_bf16_f32 v160, v160, v161
    v_cvt_pk_bf16_f32 v162, v162, v163
    s_add_u32 s26, s24, 0x2e0000
    s_add_u32 m0, s29, 0x17000
    s_nop 0
    buffer_load_dwordx4 v136, s[16:19], s26 offen lds
    v_cvt_pk_bf16_f32 v164, v164, v165
    v_cvt_pk_bf16_f32 v166, v166, v167
    v_cvt_pk_bf16_f32 v168, v168, v169
    v_cvt_pk_bf16_f32 v170, v170, v171
    v_cvt_pk_bf16_f32 v172, v172, v173
    v_cvt_pk_bf16_f32 v174, v174, v175
    v_accvgpr_write_b32 a104, v160
    v_accvgpr_write_b32 a105, v162
    v_accvgpr_write_b32 a106, v164
    v_accvgpr_write_b32 a107, v166
    v_accvgpr_write_b32 a108, v168
    v_accvgpr_write_b32 a109, v170
    v_accvgpr_write_b32 a110, v172
    v_accvgpr_write_b32 a111, v174
    v_lshlrev_b32 v160, 16, v112
    v_and_b32 v161, 0xffff0000, v112
    v_lshlrev_b32 v162, 16, v113
    v_and_b32 v163, 0xffff0000, v113
    v_lshlrev_b32 v164, 16, v114
    v_and_b32 v165, 0xffff0000, v114
    v_lshlrev_b32 v166, 16, v115
    v_and_b32 v167, 0xffff0000, v115
    v_lshlrev_b32 v168, 16, v116
    v_and_b32 v169, 0xffff0000, v116
    v_lshlrev_b32 v170, 16, v117
    v_and_b32 v171, 0xffff0000, v117
    v_lshlrev_b32 v172, 16, v118
    v_and_b32 v173, 0xffff0000, v118
    v_lshlrev_b32 v174, 16, v119
    v_and_b32 v175, 0xffff0000, v119
    v_pk_add_f32 v[160:161], v[160:161], v[154:155] op_sel_hi:[1,0] neg_lo:[0,1] neg_hi:[0,1]
    v_pk_add_f32 v[162:163], v[162:163], v[154:155] op_sel_hi:[1,0] neg_lo:[0,1] neg_hi:[0,1]
    v_pk_add_f32 v[164:165], v[164:165], v[154:155] op_sel_hi:[1,0] neg_lo:[0,1] neg_hi:[0,1]
    v_pk_add_f32 v[166:167], v[166:167], v[154:155] op_sel_hi:[1,0] neg_lo:[0,1] neg_hi:[0,1]
    v_pk_add_f32 v[168:169], v[168:169], v[154:155] op_sel_hi:[1,0] neg_lo:[0,1] neg_hi:[0,1]
    v_pk_add_f32 v[170:171], v[170:171], v[154:155] op_sel_hi:[1,0] neg_lo:[0,1] neg_hi:[0,1]
    v_pk_add_f32 v[172:173], v[172:173], v[154:155] op_sel_hi:[1,0] neg_lo:[0,1] neg_hi:[0,1]
    v_pk_add_f32 v[174:175], v[174:175], v[154:155] op_sel_hi:[1,0] neg_lo:[0,1] neg_hi:[0,1]
    v_cvt_pk_bf16_f32 v112, v160, v161
    v_cvt_pk_bf16_f32 v113, v162, v163
    v_cvt_pk_bf16_f32 v114, v164, v165
    v_cvt_pk_bf16_f32 v115, v166, v167
    v_cvt_pk_bf16_f32 v116, v168, v169
    v_cvt_pk_bf16_f32 v117, v170, v171
    v_cvt_pk_bf16_f32 v118, v172, v173
    v_cvt_pk_bf16_f32 v119, v174, v175
    v_lshlrev_b32 v160, 16, v112
    v_and_b32 v161, 0xffff0000, v112
    v_lshlrev_b32 v162, 16, v113
    v_and_b32 v163, 0xffff0000, v113
    v_lshlrev_b32 v138, 2, v137
    v_lshlrev_b32 v138, 3, v137
    s_sub_u32 s26, s101, 96
    s_lshl_b32 s26, s26, 2
    s_add_u32 s26, s26, s21
    s_min_u32 s26, s26, 512
    s_lshl_b32 s26, s26, 13
    s_cmp_eq_u32 s41, 0
    s_cselect_b32 s6, 0x400000, 0
    s_mov_b32 s7, 0x20000
    s_mov_b32 s4, s66
    s_and_b32 s5, s67, 0xffff
    buffer_load_dword v143, v138, s[4:7], s26 offen
    v_lshlrev_b32 v164, 16, v114
    v_and_b32 v165, 0xffff0000, v114
    v_lshlrev_b32 v166, 16, v115
    v_and_b32 v167, 0xffff0000, v115
    v_lshlrev_b32 v168, 16, v116
    v_and_b32 v169, 0xffff0000, v116
    v_lshlrev_b32 v170, 16, v117
    v_and_b32 v171, 0xffff0000, v117
    v_lshlrev_b32 v172, 16, v118
    v_and_b32 v173, 0xffff0000, v118
    v_lshlrev_b32 v174, 16, v119
    v_and_b32 v175, 0xffff0000, v119
    v_pk_mul_f32 v[160:161], v[160:161], v[152:153] op_sel_hi:[1,0]
    v_pk_mul_f32 v[162:163], v[162:163], v[152:153] op_sel_hi:[1,0]
    v_pk_mul_f32 v[164:165], v[164:165], v[152:153] op_sel_hi:[1,0]
    v_pk_mul_f32 v[166:167], v[166:167], v[152:153] op_sel_hi:[1,0]
    v_pk_mul_f32 v[168:169], v[168:169], v[152:153] op_sel_hi:[1,0]
    v_pk_mul_f32 v[170:171], v[170:171], v[152:153] op_sel_hi:[1,0]
    v_pk_mul_f32 v[172:173], v[172:173], v[152:153] op_sel_hi:[1,0]
    v_pk_mul_f32 v[174:175], v[174:175], v[152:153] op_sel_hi:[1,0]
    v_cvt_pk_bf16_f32 v160, v160, v161
    v_cvt_pk_bf16_f32 v162, v162, v163
    v_cvt_pk_bf16_f32 v164, v164, v165
    v_cvt_pk_bf16_f32 v166, v166, v167
    v_cvt_pk_bf16_f32 v168, v168, v169
    v_cvt_pk_bf16_f32 v170, v170, v171
    v_cvt_pk_bf16_f32 v172, v172, v173
    v_cvt_pk_bf16_f32 v174, v174, v175
    v_accvgpr_write_b32 a112, v160
    v_accvgpr_write_b32 a113, v162
    v_accvgpr_write_b32 a114, v164
    v_accvgpr_write_b32 a115, v166
    v_accvgpr_write_b32 a116, v168
    v_accvgpr_write_b32 a117, v170
    v_accvgpr_write_b32 a118, v172
    v_accvgpr_write_b32 a119, v174
    v_lshlrev_b32 v160, 16, v120
    v_and_b32 v161, 0xffff0000, v120
    v_lshlrev_b32 v162, 16, v121
    v_and_b32 v163, 0xffff0000, v121
    v_lshlrev_b32 v164, 16, v122
    v_and_b32 v165, 0xffff0000, v122
    v_lshlrev_b32 v166, 16, v123
    v_and_b32 v167, 0xffff0000, v123
    v_lshlrev_b32 v168, 16, v124
    v_and_b32 v169, 0xffff0000, v124
    v_lshlrev_b32 v170, 16, v125
    v_and_b32 v171, 0xffff0000, v125
    v_lshlrev_b32 v172, 16, v126
    v_and_b32 v173, 0xffff0000, v126
    v_lshlrev_b32 v174, 16, v127
    v_and_b32 v175, 0xffff0000, v127
    v_pk_add_f32 v[160:161], v[160:161], v[154:155] op_sel_hi:[1,0] neg_lo:[0,1] neg_hi:[0,1]
    v_pk_add_f32 v[162:163], v[162:163], v[154:155] op_sel_hi:[1,0] neg_lo:[0,1] neg_hi:[0,1]
    v_pk_add_f32 v[164:165], v[164:165], v[154:155] op_sel_hi:[1,0] neg_lo:[0,1] neg_hi:[0,1]
    v_pk_add_f32 v[166:167], v[166:167], v[154:155] op_sel_hi:[1,0] neg_lo:[0,1] neg_hi:[0,1]
    v_pk_add_f32 v[168:169], v[168:169], v[154:155] op_sel_hi:[1,0] neg_lo:[0,1] neg_hi:[0,1]
    v_pk_add_f32 v[170:171], v[170:171], v[154:155] op_sel_hi:[1,0] neg_lo:[0,1] neg_hi:[0,1]
    v_pk_add_f32 v[172:173], v[172:173], v[154:155] op_sel_hi:[1,0] neg_lo:[0,1] neg_hi:[0,1]
    v_pk_add_f32 v[174:175], v[174:175], v[154:155] op_sel_hi:[1,0] neg_lo:[0,1] neg_hi:[0,1]
    v_cvt_pk_bf16_f32 v120, v160, v161
    v_cvt_pk_bf16_f32 v121, v162, v163
    v_cvt_pk_bf16_f32 v122, v164, v165
    v_cvt_pk_bf16_f32 v123, v166, v167
    v_cvt_pk_bf16_f32 v124, v168, v169
    v_cvt_pk_bf16_f32 v125, v170, v171
    v_cvt_pk_bf16_f32 v126, v172, v173
    v_cvt_pk_bf16_f32 v127, v174, v175
    v_lshlrev_b32 v160, 16, v120
    v_and_b32 v161, 0xffff0000, v120
    v_lshlrev_b32 v162, 16, v121
    v_and_b32 v163, 0xffff0000, v121
    v_lshlrev_b32 v164, 16, v122
    v_and_b32 v165, 0xffff0000, v122
    v_lshlrev_b32 v166, 16, v123
    v_and_b32 v167, 0xffff0000, v123
    v_lshlrev_b32 v168, 16, v124
    v_and_b32 v169, 0xffff0000, v124
    v_lshlrev_b32 v170, 16, v125
    v_and_b32 v171, 0xffff0000, v125
    v_lshlrev_b32 v172, 16, v126
    v_and_b32 v173, 0xffff0000, v126
    v_lshlrev_b32 v174, 16, v127
    v_and_b32 v175, 0xffff0000, v127
    v_pk_mul_f32 v[160:161], v[160:161], v[152:153] op_sel_hi:[1,0]
    v_pk_mul_f32 v[162:163], v[162:163], v[152:153] op_sel_hi:[1,0]
    v_pk_mul_f32 v[164:165], v[164:165], v[152:153] op_sel_hi:[1,0]
    v_pk_mul_f32 v[166:167], v[166:167], v[152:153] op_sel_hi:[1,0]
    v_pk_mul_f32 v[168:169], v[168:169], v[152:153] op_sel_hi:[1,0]
    v_pk_mul_f32 v[170:171], v[170:171], v[152:153] op_sel_hi:[1,0]
    v_pk_mul_f32 v[172:173], v[172:173], v[152:153] op_sel_hi:[1,0]
    v_pk_mul_f32 v[174:175], v[174:175], v[152:153] op_sel_hi:[1,0]
    v_cvt_pk_bf16_f32 v160, v160, v161
    v_cvt_pk_bf16_f32 v162, v162, v163
    v_cvt_pk_bf16_f32 v164, v164, v165
    v_cvt_pk_bf16_f32 v166, v166, v167
    v_cvt_pk_bf16_f32 v168, v168, v169
    v_cvt_pk_bf16_f32 v170, v170, v171
    v_cvt_pk_bf16_f32 v172, v172, v173
    v_cvt_pk_bf16_f32 v174, v174, v175
    v_accvgpr_write_b32 a120, v160
    v_accvgpr_write_b32 a121, v162
    v_accvgpr_write_b32 a122, v164
    v_accvgpr_write_b32 a123, v166
    v_accvgpr_write_b32 a124, v168
    v_accvgpr_write_b32 a125, v170
    v_accvgpr_write_b32 a126, v172
    v_accvgpr_write_b32 a127, v174
    buffer_load_dwordx2 v[140:141], off, s[92:95], 0 offset:36 sc1
    s_nop 3
L_p1_unit:
    s_cmp_ge_u32 s38, 96
    s_cbranch_scc1 L_p1_end
    s_lshr_b32 s26, s38, 5
    s_add_u32 s27, s26, 1
    s_lshl_b32 s25, s27, 24
    s_lshl_b32 s27, s20, 2
    s_add_u32 s27, s27, s21
    s_lshl_b32 s27, s27, 5
    s_and_b32 s28, s38, 31
    s_add_u32 s27, s27, s28
    s_lshl_b32 s27, s27, 13
    s_add_u32 s25, s25, s27
    s_lshr_b32 s26, s38, 5
    s_cmp_eq_u32 s26, 1
    s_cbranch_scc1 L_p1_v
    s_waitcnt vmcnt(16)
    s_barrier
    ds_read_b64_tr_b16 v[64:65], v128
    ds_read_b64_tr_b16 v[66:67], v128 offset:1024
    ds_read_b64_tr_b16 v[68:69], v129
    ds_read_b64_tr_b16 v[70:71], v129 offset:1024
    ds_read_b64_tr_b16 v[72:73], v130
    ds_read_b64_tr_b16 v[74:75], v130 offset:1024
    ds_read_b64_tr_b16 v[76:77], v131
    ds_read_b64_tr_b16 v[78:79], v131 offset:1024
    ds_read_b64_tr_b16 v[80:81], v132
    ds_read_b64_tr_b16 v[82:83], v132 offset:1024
    ds_read_b64_tr_b16 v[84:85], v133
    ds_read_b64_tr_b16 v[86:87], v133 offset:1024
    ds_read_b64_tr_b16 v[88:89], v134
    ds_read_b64_tr_b16 v[90:91], v134 offset:1024
    s_waitcnt lgkmcnt(12)
    v_mfma_f32_16x16x32_bf16 v[0:3], v[64:67], a[0:3], 0
    ds_read_b64_tr_b16 v[92:93], v135
    v_mfma_f32_16x16x32_bf16 v[4:7], v[64:67], a[64:67], 0
    ds_read_b64_tr_b16 v[94:95], v135 offset:1024
    s_add_u32 s26, s24, 0x300000
    s_add_u32 m0, s29, 0x18000
    s_nop 0
    buffer_load_dwordx4 v136, s[16:19], s26 offen lds
    s_waitcnt lgkmcnt(12)
    v_mfma_f32_16x16x32_bf16 v[8:11], v[68:71], a[0:3], 0
    ds_read_b64_tr_b16 v[96:97], v128 offset:8192
    v_mfma_f32_16x16x32_bf16 v[12:15], v[68:71], a[64:67], 0
    ds_read_b64_tr_b16 v[98:99], v128 offset:9216
    s_add_u32 s26, s24, 0x320000
    s_add_u32 m0, s29, 0x19000
    s_nop 0
    buffer_load_dwordx4 v136, s[16:19], s26 offen lds
    s_waitcnt lgkmcnt(12)
    v_mfma_f32_16x16x32_bf16 v[16:19], v[72:75], a[0:3], 0
    ds_read_b64_tr_b16 v[100:101], v129 offset:8192
    v_mfma_f32_16x16x32_bf16 v[20:23], v[72:75], a[64:67], 0
    ds_read_b64_tr_b16 v[102:103], v129 offset:9216
    s_add_u32 s26, s24, 0x340000
    s_add_u32 m0, s29, 0x1a000
    s_nop 0
    buffer_load_dwordx4 v136, s[16:19], s26 offen lds
    s_waitcnt lgkmcnt(12)
    v_mfma_f32_16x16x32_bf16 v[24:27], v[76:79], a[0:3], 0
    ds_read_b64_tr_b16 v[104:105], v130 offset:8192
    v_mfma_f32_16x16x32_bf16 v[28:31], v[76:79], a[64:67], 0
    ds_read_b64_tr_b16 v[106:107], v130 offset:9216
    s_add_u32 s26, s24, 0x360000
    s_add_u32 m0, s29, 0x1b000
    s_nop 0
    buffer_load_dwordx4 v136, s[16:19], s26 offen lds
    s_waitcnt lgkmcnt(12)
    v_mfma_f32_16x16x32_bf16 v[32:35], v[80:83], a[0:3], 0
    ds_read_b64_tr_b16 v[108:109], v131 offset:8192
    v_mfma_f32_16x16x32_bf16 v[36:39], v[80:83], a[64:67], 0
    ds_read_b64_tr_b16 v[110:111], v131 offset:9216
    s_add_u32 s26, s24, 0x380000
    s_add_u32 m0, s29, 0x1c000
    s_nop 0
    buffer_load_dwordx4 v136, s[16:19], s26 offen lds
    s_waitcnt lgkmcnt(12)
    v_mfma_f32_16x16x32_bf16 v[40:43], v[84:87], a[0:3], 0
    ds_read_b64_tr_b16 v[112:113], v132 offset:8192
    v_mfma_f32_16x16x32_bf16 v[44:47], v[84:87], a[64:67], 0
    ds_read_b64_tr_b16 v[114:115], v132 offset:9216
    s_add_u32 s26, s24, 0x3a0000
    s_add_u32 m0, s29, 0x1d000
    s_nop 0
    buffer_load_dwordx4 v136, s[16:19], s26 offen lds
    s_waitcnt lgkmcnt(12)
    v_mfma_f32_16x16x32_bf16 v[48:51], v[88:91], a[0:3], 0
    ds_read_b64_tr_b16 v[116:117], v133 offset:8192
    v_mfma_f32_16x16x32_bf16 v[52:55], v[88:91], a[64:67], 0
    ds_read_b64_tr_b16 v[118:119], v133 offset:9216
    s_add_u32 s26, s24, 0x3c0000
    s_add_u32 m0, s29, 0x1e000
    s_nop 0
    buffer_load_dwordx4 v136, s[16:19], s26 offen lds
    s_waitcnt lgkmcnt(12)
    v_mfma_f32_16x16x32_bf16 v[56:59], v[92:95], a[0:3], 0
    ds_read_b64_tr_b16 v[120:121], v134 offset:8192
    v_mfma_f32_16x16x32_bf16 v[60:63], v[92:95], a[64:67], 0
    ds_read_b64_tr_b16 v[122:123], v134 offset:9216
    s_add_u32 s26, s24, 0x3e0000
    s_add_u32 m0, s29, 0x1f000
    s_nop 0
    buffer_load_dwordx4 v136, s[16:19], s26 offen lds
    s_waitcnt lgkmcnt(12)
    v_mfma_f32_16x16x32_bf16 v[0:3], v[96:99], a[4:7], v[0:3]
    ds_read_b64_tr_b16 v[124:125], v135 offset:8192
    v_mfma_f32_16x16x32_bf16 v[4:7], v[96:99], a[68:71], v[4:7]
    ds_read_b64_tr_b16 v[126:127], v135 offset:9216
    s_waitcnt lgkmcnt(12)
    v_mfma_f32_16x16x32_bf16 v[8:11], v[100:103], a[4:7], v[8:11]
    ds_read_b64_tr_b16 v[64:65], v128 offset:16384
    v_mfma_f32_16x16x32_bf16 v[12:15], v[100:103], a[68:71], v[12:15]
    ds_read_b64_tr_b16 v[66:67], v128 offset:17408
    s_waitcnt lgkmcnt(12)
    v_mfma_f32_16x16x32_bf16 v[16:19], v[104:107], a[4:7], v[16:19]
    ds_read_b64_tr_b16 v[68:69], v129 offset:16384
    v_mfma_f32_16x16x32_bf16 v[20:23], v[104:107], a[68:71], v[20:23]
    ds_read_b64_tr_b16 v[70:71], v129 offset:17408
    s_waitcnt lgkmcnt(12)
    v_mfma_f32_16x16x32_bf16 v[24:27], v[108:111], a[4:7], v[24:27]
    ds_read_b64_tr_b16 v[72:73], v130 offset:16384
    v_mfma_f32_16x16x32_bf16 v[28:31], v[108:111], a[68:71], v[28:31]
    ds_read_b64_tr_b16 v[74:75], v130 offset:17408
    s_waitcnt lgkmcnt(12)
    v_mfma_f32_16x16x32_bf16 v[32:35], v[112:115], a[4:7], v[32:35]
    ds_read_b64_tr_b16 v[76:77], v131 offset:16384
    v_mfma_f32_16x16x32_bf16 v[36:39], v[112:115], a[68:71], v[36:39]
    ds_read_b64_tr_b16 v[78:79], v131 offset:17408
    s_waitcnt lgkmcnt(12)
    v_mfma_f32_16x16x32_bf16 v[40:43], v[116:119], a[4:7], v[40:43]
    ds_read_b64_tr_b16 v[80:81], v132 offset:16384
    v_mfma_f32_16x16x32_bf16 v[44:47], v[116:119], a[68:71], v[44:47]
    ds_read_b64_tr_b16 v[82:83], v132 offset:17408
    s_waitcnt lgkmcnt(12)
    v_mfma_f32_16x16x32_bf16 v[48:51], v[120:123], a[4:7], v[48:51]
    ds_read_b64_tr_b16 v[84:85], v133 offset:16384
    v_mfma_f32_16x16x32_bf16 v[52:55], v[120:123], a[68:71], v[52:55]
    ds_read_b64_tr_b16 v[86:87], v133 offset:17408
    s_waitcnt lgkmcnt(12)
    v_mfma_f32_16x16x32_bf16 v[56:59], v[124:127], a[4:7], v[56:59]
    ds_read_b64_tr_b16 v[88:89], v134 offset:16384
    v_mfma_f32_16x16x32_bf16 v[60:63], v[124:127], a[68:71], v[60:63]
    ds_read_b64_tr_b16 v[90:91], v134 offset:17408
    s_waitcnt lgkmcnt(12)
    v_mfma_f32_16x16x32_bf16 v[0:3], v[64:67], a[8:11], v[0:3]
    ds_read_b64_tr_b16 v[92:93], v135 offset:16384
    v_mfma_f32_16x16x32_bf16 v[4:7], v[64:67], a[72:75], v[4:7]
    ds_read_b64_tr_b16 v[94:95], v135 offset:17408
    s_waitcnt lgkmcnt(12)
    v_mfma_f32_16x16x32_bf16 v[8:11], v[68:71], a[8:11], v[8:11]
    ds_read_b64_tr_b16 v[96:97], v128 offset:24576
    v_mfma_f32_16x16x32_bf16 v[12:15], v[68:71], a[72:75], v[12:15]
    ds_read_b64_tr_b16 v[98:99], v128 offset:25600
    s_waitcnt lgkmcnt(12)
    v_mfma_f32_16x16x32_bf16 v[16:19], v[72:75], a[8:11], v[16:19]
    ds_read_b64_tr_b16 v[100:101], v129 offset:24576
    v_mfma_f32_16x16x32_bf16 v[20:23], v[72:75], a[72:75], v[20:23]
    ds_read_b64_tr_b16 v[102:103], v129 offset:25600
    s_waitcnt lgkmcnt(12)
    v_mfma_f32_16x16x32_bf16 v[24:27], v[76:79], a[8:11], v[24:27]
    ds_read_b64_tr_b16 v[104:105], v130 offset:24576
    v_mfma_f32_16x16x32_bf16 v[28:31], v[76:79], a[72:75], v[28:31]
    ds_read_b64_tr_b16 v[106:107], v130 offset:25600
    s_waitcnt lgkmcnt(12)
    v_mfma_f32_16x16x32_bf16 v[32:35], v[80:83], a[8:11], v[32:35]
    ds_read_b64_tr_b16 v[108:109], v131 offset:24576
    v_mfma_f32_16x16x32_bf16 v[36:39], v[80:83], a[72:75], v[36:39]
    ds_read_b64_tr_b16 v[110:111], v131 offset:25600
    s_waitcnt lgkmcnt(12)
    v_mfma_f32_16x16x32_bf16 v[40:43], v[84:87], a[8:11], v[40:43]
    ds_read_b64_tr_b16 v[112:113], v132 offset:24576
    v_mfma_f32_16x16x32_bf16 v[44:47], v[84:87], a[72:75], v[44:47]
    ds_read_b64_tr_b16 v[114:115], v132 offset:25600
    s_waitcnt lgkmcnt(12)
    v_mfma_f32_16x16x32_bf16 v[48:51], v[88:91], a[8:11], v[48:51]
    ds_read_b64_tr_b16 v[116:117], v133 offset:24576
    v_mfma_f32_16x16x32_bf16 v[52:55], v[88:91], a[72:75], v[52:55]
    ds_read_b64_tr_b16 v[118:119], v133 offset:25600
    s_waitcnt lgkmcnt(12)
    v_mfma_f32_16x16x32_bf16 v[56:59], v[92:95], a[8:11], v[56:59]
    ds_read_b64_tr_b16 v[120:121], v134 offset:24576
    v_mfma_f32_16x16x32_bf16 v[60:63], v[92:95], a[72:75], v[60:63]
    ds_read_b64_tr_b16 v[122:123], v134 offset:25600
    s_waitcnt lgkmcnt(12)
    v_mfma_f32_16x16x32_bf16 v[0:3], v[96:99], a[12:15], v[0:3]
    ds_read_b64_tr_b16 v[124:125], v135 offset:24576
    v_mfma_f32_16x16x32_bf16 v[4:7], v[96:99], a[76:79], v[4:7]
    ds_read_b64_tr_b16 v[126:127], v135 offset:25600
    s_waitcnt lgkmcnt(12)
    v_mfma_f32_16x16x32_bf16 v[8:11], v[100:103], a[12:15], v[8:11]
    v_mfma_f32_16x16x32_bf16 v[12:15], v[100:103], a[76:79], v[12:15]
    s_waitcnt lgkmcnt(10)
    v_mfma_f32_16x16x32_bf16 v[16:19], v[104:107], a[12:15], v[16:19]
    v_mfma_f32_16x16x32_bf16 v[20:23], v[104:107], a[76:79], v[20:23]
    s_waitcnt lgkmcnt(8)
    v_mfma_f32_16x16x32_bf16 v[24:27], v[108:111], a[12:15], v[24:27]
    v_mfma_f32_16x16x32_bf16 v[28:31], v[108:111], a[76:79], v[28:31]
    s_waitcnt lgkmcnt(6)
    v_mfma_f32_16x16x32_bf16 v[32:35], v[112:115], a[12:15], v[32:35]
    v_mfma_f32_16x16x32_bf16 v[36:39], v[112:115], a[76:79], v[36:39]
    s_waitcnt lgkmcnt(4)
    v_mfma_f32_16x16x32_bf16 v[40:43], v[116:119], a[12:15], v[40:43]
    v_mfma_f32_16x16x32_bf16 v[44:47], v[116:119], a[76:79], v[44:47]
    s_waitcnt lgkmcnt(2)
    v_mfma_f32_16x16x32_bf16 v[48:51], v[120:123], a[12:15], v[48:51]
    v_mfma_f32_16x16x32_bf16 v[52:55], v[120:123], a[76:79], v[52:55]
    s_waitcnt lgkmcnt(0)
    v_mfma_f32_16x16x32_bf16 v[56:59], v[124:127], a[12:15], v[56:59]
    v_mfma_f32_16x16x32_bf16 v[60:63], v[124:127], a[76:79], v[60:63]
    s_waitcnt vmcnt(16)
    s_barrier
    ds_read_b64_tr_b16 v[64:65], v128 offset:32768
    ds_read_b64_tr_b16 v[66:67], v128 offset:33792
    ds_read_b64_tr_b16 v[68:69], v129 offset:32768
    ds_read_b64_tr_b16 v[70:71], v129 offset:33792
    ds_read_b64_tr_b16 v[72:73], v130 offset:32768
    ds_read_b64_tr_b16 v[74:75], v130 offset:33792
    ds_read_b64_tr_b16 v[76:77], v131 offset:32768
    ds_read_b64_tr_b16 v[78:79], v131 offset:33792
    ds_read_b64_tr_b16 v[80:81], v132 offset:32768
    ds_read_b64_tr_b16 v[82:83], v132 offset:33792
    ds_read_b64_tr_b16 v[84:85], v133 offset:32768
    ds_read_b64_tr_b16 v[86:87], v133 offset:33792
    ds_read_b64_tr_b16 v[88:89], v134 offset:32768
    ds_read_b64_tr_b16 v[90:91], v134 offset:33792
    s_add_u32 s39, s39, s37
    s_lshr_b32 s26, s39, 5
    s_cmp_eq_u32 s26, 0
    s_cselect_b64 s[16:17], s[62:63], s[60:61]
    s_cmp_eq_u32 s26, 1
    s_cselect_b64 s[16:17], s[64:65], s[16:17]
    s_and_b32 s17, s17, 0xffff
    s_cmp_lt_u32 s39, 96
    s_cselect_b32 s18, 0x400000, 0
    s_and_b32 s24, s39, 31
    s_lshl_b32 s24, s24, 8
    s_waitcnt lgkmcnt(12)
    v_mfma_f32_16x16x32_bf16 v[0:3], v[64:67], a[16:19], v[0:3]
    ds_read_b64_tr_b16 v[92:93], v135 offset:32768
    v_mfma_f32_16x16x32_bf16 v[4:7], v[64:67], a[80:83], v[4:7]
    ds_read_b64_tr_b16 v[94:95], v135 offset:33792
    s_add_u32 s26, s24, 0x0
    s_add_u32 m0, s29, 0x0
    s_nop 0
    buffer_load_dwordx4 v136, s[16:19], s26 offen lds
    s_waitcnt lgkmcnt(12)
    v_mfma_f32_16x16x32_bf16 v[8:11], v[68:71], a[16:19], v[8:11]
    ds_read_b64_tr_b16 v[96:97], v128 offset:40960
    v_mfma_f32_16x16x32_bf16 v[12:15], v[68:71], a[80:83], v[12:15]
    ds_read_b64_tr_b16 v[98:99], v128 offset:41984
    s_add_u32 s26, s24, 0x20000
    s_add_u32 m0, s29, 0x1000
    s_nop 0
    buffer_load_dwordx4 v136, s[16:19], s26 offen lds
    s_waitcnt lgkmcnt(12)
    v_mfma_f32_16x16x32_bf16 v[16:19], v[72:75], a[16:19], v[16:19]
    ds_read_b64_tr_b16 v[100:101], v129 offset:40960
    v_mfma_f32_16x16x32_bf16 v[20:23], v[72:75], a[80:83], v[20:23]
    ds_read_b64_tr_b16 v[102:103], v129 offset:41984
    s_add_u32 s26, s24, 0x40000
    s_add_u32 m0, s29, 0x2000
    s_nop 0
    buffer_load_dwordx4 v136, s[16:19], s26 offen lds
    s_waitcnt lgkmcnt(12)
    v_mfma_f32_16x16x32_bf16 v[24:27], v[76:79], a[16:19], v[24:27]
    ds_read_b64_tr_b16 v[104:105], v130 offset:40960
    v_mfma_f32_16x16x32_bf16 v[28:31], v[76:79], a[80:83], v[28:31]
    ds_read_b64_tr_b16 v[106:107], v130 offset:41984
    s_add_u32 s26, s24, 0x60000
    s_add_u32 m0, s29, 0x3000
    s_nop 0
    buffer_load_dwordx4 v136, s[16:19], s26 offen lds
    s_waitcnt lgkmcnt(12)
    v_mfma_f32_16x16x32_bf16 v[32:35], v[80:83], a[16:19], v[32:35]
    ds_read_b64_tr_b16 v[108:109], v131 offset:40960
    v_mfma_f32_16x16x32_bf16 v[36:39], v[80:83], a[80:83], v[36:39]
    ds_read_b64_tr_b16 v[110:111], v131 offset:41984
    s_add_u32 s26, s24, 0x80000
    s_add_u32 m0, s29, 0x4000
    s_nop 0
    buffer_load_dwordx4 v136, s[16:19], s26 offen lds
    s_waitcnt lgkmcnt(12)
    v_mfma_f32_16x16x32_bf16 v[40:43], v[84:87], a[16:19], v[40:43]
    ds_read_b64_tr_b16 v[112:113], v132 offset:40960
    v_mfma_f32_16x16x32_bf16 v[44:47], v[84:87], a[80:83], v[44:47]
    ds_read_b64_tr_b16 v[114:115], v132 offset:41984
    s_add_u32 s26, s24, 0xa0000
    s_add_u32 m0, s29, 0x5000
    s_nop 0
    buffer_load_dwordx4 v136, s[16:19], s26 offen lds
    s_waitcnt lgkmcnt(12)
    v_mfma_f32_16x16x32_bf16 v[48:51], v[88:91], a[16:19], v[48:51]
    ds_read_b64_tr_b16 v[116:117], v133 offset:40960
    v_mfma_f32_16x16x32_bf16 v[52:55], v[88:91], a[80:83], v[52:55]
    ds_read_b64_tr_b16 v[118:119], v133 offset:41984
    s_add_u32 s26, s24, 0xc0000
    s_add_u32 m0, s29, 0x6000
    s_nop 0
    buffer_load_dwordx4 v136, s[16:19], s26 offen lds
    s_waitcnt lgkmcnt(12)
    v_mfma_f32_16x16x32_bf16 v[56:59], v[92:95], a[16:19], v[56:59]
    ds_read_b64_tr_b16 v[120:121], v134 offset:40960
    v_mfma_f32_16x16x32_bf16 v[60:63], v[92:95], a[80:83], v[60:63]
    ds_read_b64_tr_b16 v[122:123], v134 offset:41984
    s_add_u32 s26, s24, 0xe0000
    s_add_u32 m0, s29, 0x7000
    s_nop 0
    buffer_load_dwordx4 v136, s[16:19], s26 offen lds
    s_waitcnt lgkmcnt(12)
    v_mfma_f32_16x16x32_bf16 v[0:3], v[96:99], a[20:23], v[0:3]
    ds_read_b64_tr_b16 v[124:125], v135 offset:40960
    v_mfma_f32_16x16x32_bf16 v[4:7], v[96:99], a[84:87], v[4:7]
    ds_read_b64_tr_b16 v[126:127], v135 offset:41984
    s_waitcnt lgkmcnt(12)
    v_mfma_f32_16x16x32_bf16 v[8:11], v[100:103], a[20:23], v[8:11]
    ds_read_b64_tr_b16 v[64:65], v128 offset:49152
    v_mfma_f32_16x16x32_bf16 v[12:15], v[100:103], a[84:87], v[12:15]
    ds_read_b64_tr_b16 v[66:67], v128 offset:50176
    s_waitcnt lgkmcnt(12)
    v_mfma_f32_16x16x32_bf16 v[16:19], v[104:107], a[20:23], v[16:19]
    ds_read_b64_tr_b16 v[68:69], v129 offset:49152
    v_mfma_f32_16x16x32_bf16 v[20:23], v[104:107], a[84:87], v[20:23]
    ds_read_b64_tr_b16 v[70:71], v129 offset:50176
    s_waitcnt lgkmcnt(12)
    v_mfma_f32_16x16x32_bf16 v[24:27], v[108:111], a[20:23], v[24:27]
    ds_read_b64_tr_b16 v[72:73], v130 offset:49152
    v_mfma_f32_16x16x32_bf16 v[28:31], v[108:111], a[84:87], v[28:31]
    ds_read_b64_tr_b16 v[74:75], v130 offset:50176
    s_waitcnt lgkmcnt(12)
    v_mfma_f32_16x16x32_bf16 v[32:35], v[112:115], a[20:23], v[32:35]
    ds_read_b64_tr_b16 v[76:77], v131 offset:49152
    v_mfma_f32_16x16x32_bf16 v[36:39], v[112:115], a[84:87], v[36:39]
    ds_read_b64_tr_b16 v[78:79], v131 offset:50176
    s_waitcnt lgkmcnt(12)
    v_mfma_f32_16x16x32_bf16 v[40:43], v[116:119], a[20:23], v[40:43]
    ds_read_b64_tr_b16 v[80:81], v132 offset:49152
    v_mfma_f32_16x16x32_bf16 v[44:47], v[116:119], a[84:87], v[44:47]
    ds_read_b64_tr_b16 v[82:83], v132 offset:50176
    s_waitcnt lgkmcnt(12)
    v_mfma_f32_16x16x32_bf16 v[48:51], v[120:123], a[20:23], v[48:51]
    ds_read_b64_tr_b16 v[84:85], v133 offset:49152
    v_mfma_f32_16x16x32_bf16 v[52:55], v[120:123], a[84:87], v[52:55]
    ds_read_b64_tr_b16 v[86:87], v133 offset:50176
    s_waitcnt lgkmcnt(12)
    v_mfma_f32_16x16x32_bf16 v[56:59], v[124:127], a[20:23], v[56:59]
    ds_read_b64_tr_b16 v[88:89], v134 offset:49152
    v_mfma_f32_16x16x32_bf16 v[60:63], v[124:127], a[84:87], v[60:63]
    ds_read_b64_tr_b16 v[90:91], v134 offset:50176
    s_waitcnt lgkmcnt(12)
    v_mfma_f32_16x16x32_bf16 v[0:3], v[64:67], a[24:27], v[0:3]
    ds_read_b64_tr_b16 v[92:93], v135 offset:49152
    v_mfma_f32_16x16x32_bf16 v[4:7], v[64:67], a[88:91], v[4:7]
    ds_read_b64_tr_b16 v[94:95], v135 offset:50176
    s_waitcnt lgkmcnt(12)
    v_mfma_f32_16x16x32_bf16 v[8:11], v[68:71], a[24:27], v[8:11]
    ds_read_b64_tr_b16 v[96:97], v128 offset:57344
    v_mfma_f32_16x16x32_bf16 v[12:15], v[68:71], a[88:91], v[12:15]
    ds_read_b64_tr_b16 v[98:99], v128 offset:58368
    s_waitcnt lgkmcnt(12)
    v_mfma_f32_16x16x32_bf16 v[16:19], v[72:75], a[24:27], v[16:19]
    ds_read_b64_tr_b16 v[100:101], v129 offset:57344
    v_mfma_f32_16x16x32_bf16 v[20:23], v[72:75], a[88:91], v[20:23]
    ds_read_b64_tr_b16 v[102:103], v129 offset:58368
    s_waitcnt lgkmcnt(12)
    v_mfma_f32_16x16x32_bf16 v[24:27], v[76:79], a[24:27], v[24:27]
    ds_read_b64_tr_b16 v[104:105], v130 offset:57344
    v_mfma_f32_16x16x32_bf16 v[28:31], v[76:79], a[88:91], v[28:31]
    ds_read_b64_tr_b16 v[106:107], v130 offset:58368
    s_waitcnt lgkmcnt(12)
    v_mfma_f32_16x16x32_bf16 v[32:35], v[80:83], a[24:27], v[32:35]
    ds_read_b64_tr_b16 v[108:109], v131 offset:57344
    v_mfma_f32_16x16x32_bf16 v[36:39], v[80:83], a[88:91], v[36:39]
    ds_read_b64_tr_b16 v[110:111], v131 offset:58368
    s_waitcnt lgkmcnt(12)
    v_mfma_f32_16x16x32_bf16 v[40:43], v[84:87], a[24:27], v[40:43]
    ds_read_b64_tr_b16 v[112:113], v132 offset:57344
    v_mfma_f32_16x16x32_bf16 v[44:47], v[84:87], a[88:91], v[44:47]
    ds_read_b64_tr_b16 v[114:115], v132 offset:58368
    s_waitcnt lgkmcnt(12)
    v_mfma_f32_16x16x32_bf16 v[48:51], v[88:91], a[24:27], v[48:51]
    ds_read_b64_tr_b16 v[116:117], v133 offset:57344
    v_mfma_f32_16x16x32_bf16 v[52:55], v[88:91], a[88:91], v[52:55]
    ds_read_b64_tr_b16 v[118:119], v133 offset:58368
    s_waitcnt lgkmcnt(12)
    v_mfma_f32_16x16x32_bf16 v[56:59], v[92:95], a[24:27], v[56:59]
    ds_read_b64_tr_b16 v[120:121], v134 offset:57344
    v_mfma_f32_16x16x32_bf16 v[60:63], v[92:95], a[88:91], v[60:63]
    ds_read_b64_tr_b16 v[122:123], v134 offset:58368
    s_waitcnt lgkmcnt(12)
    v_mfma_f32_16x16x32_bf16 v[0:3], v[96:99], a[28:31], v[0:3]
    ds_read_b64_tr_b16 v[124:125], v135 offset:57344
    v_mfma_f32_16x16x32_bf16 v[4:7], v[96:99], a[92:95], v[4:7]
    ds_read_b64_tr_b16 v[126:127], v135 offset:58368
    s_waitcnt lgkmcnt(12)
    v_mfma_f32_16x16x32_bf16 v[8:11], v[100:103], a[28:31], v[8:11]
    v_mfma_f32_16x16x32_bf16 v[12:15], v[100:103], a[92:95], v[12:15]
    s_waitcnt lgkmcnt(10)
    v_mfma_f32_16x16x32_bf16 v[16:19], v[104:107], a[28:31], v[16:19]
    v_mfma_f32_16x16x32_bf16 v[20:23], v[104:107], a[92:95], v[20:23]
    s_waitcnt lgkmcnt(8)
    v_mfma_f32_16x16x32_bf16 v[24:27], v[108:111], a[28:31], v[24:27]
    v_mfma_f32_16x16x32_bf16 v[28:31], v[108:111], a[92:95], v[28:31]
    s_waitcnt lgkmcnt(6)
    v_mfma_f32_16x16x32_bf16 v[32:35], v[112:115], a[28:31], v[32:35]
    v_mfma_f32_16x16x32_bf16 v[36:39], v[112:115], a[92:95], v[36:39]
    s_waitcnt lgkmcnt(4)
    v_mfma_f32_16x16x32_bf16 v[40:43], v[116:119], a[28:31], v[40:43]
    v_mfma_f32_16x16x32_bf16 v[44:47], v[116:119], a[92:95], v[44:47]
    s_waitcnt lgkmcnt(2)
    v_mfma_f32_16x16x32_bf16 v[48:51], v[120:123], a[28:31], v[48:51]
    v_mfma_f32_16x16x32_bf16 v[52:55], v[120:123], a[92:95], v[52:55]
    s_waitcnt lgkmcnt(0)
    v_mfma_f32_16x16x32_bf16 v[56:59], v[124:127], a[28:31], v[56:59]
    v_mfma_f32_16x16x32_bf16 v[60:63], v[124:127], a[92:95], v[60:63]
    v_xor_b32 v128, 0x10000, v128
    v_xor_b32 v129, 0x10000, v129
    v_xor_b32 v130, 0x10000, v130
    v_xor_b32 v131, 0x10000, v131
    v_xor_b32 v132, 0x10000, v132
    v_xor_b32 v133, 0x10000, v133
    v_xor_b32 v134, 0x10000, v134
    v_xor_b32 v135, 0x10000, v135
    s_waitcnt vmcnt(16)
    s_barrier
    ds_read_b64_tr_b16 v[64:65], v128
    ds_read_b64_tr_b16 v[66:67], v128 offset:1024
    ds_read_b64_tr_b16 v[68:69], v129
    ds_read_b64_tr_b16 v[70:71], v129 offset:1024
    ds_read_b64_tr_b16 v[72:73], v130
    ds_read_b64_tr_b16 v[74:75], v130 offset:1024
    ds_read_b64_tr_b16 v[76:77], v131
    ds_read_b64_tr_b16 v[78:79], v131 offset:1024
    ds_read_b64_tr_b16 v[80:81], v132
    ds_read_b64_tr_b16 v[82:83], v132 offset:1024
    ds_read_b64_tr_b16 v[84:85], v133
    ds_read_b64_tr_b16 v[86:87], v133 offset:1024
    ds_read_b64_tr_b16 v[88:89], v134
    ds_read_b64_tr_b16 v[90:91], v134 offset:1024
    s_cmp_eq_u32 s40, 0
    s_cbranch_scc1 L_nopf_90
    s_cmp_lg_u32 s87, 0
    s_cbranch_scc1 L_modeok_91
    v_readfirstlane_b32 s96, v140
    v_readfirstlane_b32 s97, v141
    s_nop 0
    s_cmp_lg_u32 s97, 0
    s_cselect_b32 s87, s96, 0
    s_cmp_eq_u32 s87, 1
    s_cbranch_scc1 L_modeok_91
    s_mov_b32 s96, 0
L_mode_92:
    buffer_load_dwordx2 v[140:141], off, s[92:95], 0 offset:36 sc1
    s_waitcnt vmcnt(0)
    v_readfirstlane_b32 s87, v140
    v_readfirstlane_b32 s97, v141
    s_nop 0
    s_min_u32 s97, s97, s87
    s_cmp_lg_u32 s97, 0
    s_cbranch_scc1 L_moded_93
    s_sleep 4
    s_add_u32 s96, s96, 1
    s_cmp_lg_u32 s96, 0x100
    s_cbranch_scc1 L_modef_94
    v_mov_b32 v140, 2
    v_mov_b32 v141, 0
    s_mov_b64 exec, 1
    buffer_atomic_cmpswap v[140:141], off, s[92:95], 0 offset:36
    s_mov_b64 exec, -1
L_modef_94:
    s_cmp_lt_u32 s96, 0x10000
    s_cbranch_scc1 L_mode_92
L_moded_93:
    s_cmp_lg_u32 s87, 1
    s_cbranch_scc1 L_fallback
L_modeok_91:
    s_cmp_lg_u32 s100, 0
    s_cbranch_scc1 L_flag_95
    v_mov_b32 v138, 1
    s_mov_b64 exec, 1
    buffer_store_dword v138, off, s[8:11], s40 sc1
    s_mov_b64 exec, -1
L_flag_95:
    s_mov_b32 s40, 0
L_nopf_90:
    s_waitcnt lgkmcnt(12)
    v_mfma_f32_16x16x32_bf16 v[0:3], v[64:67], a[32:35], v[0:3]
    ds_read_b64_tr_b16 v[92:93], v135
    v_mfma_f32_16x16x32_bf16 v[4:7], v[64:67], a[96:99], v[4:7]
    ds_read_b64_tr_b16 v[94:95], v135 offset:1024
    s_add_u32 s26, s24, 0x100000
    s_add_u32 m0, s29, 0x8000
    s_nop 0
    buffer_load_dwordx4 v136, s[16:19], s26 offen lds
    s_waitcnt lgkmcnt(12)
    v_mfma_f32_16x16x32_bf16 v[8:11], v[68:71], a[32:35], v[8:11]
    ds_read_b64_tr_b16 v[96:97], v128 offset:8192
    v_mfma_f32_16x16x32_bf16 v[12:15], v[68:71], a[96:99], v[12:15]
    ds_read_b64_tr_b16 v[98:99], v128 offset:9216
    s_add_u32 s26, s24, 0x120000
    s_add_u32 m0, s29, 0x9000
    s_nop 0
    buffer_load_dwordx4 v136, s[16:19], s26 offen lds
    s_waitcnt lgkmcnt(12)
    v_mfma_f32_16x16x32_bf16 v[16:19], v[72:75], a[32:35], v[16:19]
    ds_read_b64_tr_b16 v[100:101], v129 offset:8192
    v_mfma_f32_16x16x32_bf16 v[20:23], v[72:75], a[96:99], v[20:23]
    ds_read_b64_tr_b16 v[102:103], v129 offset:9216
    s_add_u32 s26, s24, 0x140000
    s_add_u32 m0, s29, 0xa000
    s_nop 0
    buffer_load_dwordx4 v136, s[16:19], s26 offen lds
    s_waitcnt lgkmcnt(12)
    v_mfma_f32_16x16x32_bf16 v[24:27], v[76:79], a[32:35], v[24:27]
    ds_read_b64_tr_b16 v[104:105], v130 offset:8192
    v_mfma_f32_16x16x32_bf16 v[28:31], v[76:79], a[96:99], v[28:31]
    ds_read_b64_tr_b16 v[106:107], v130 offset:9216
    s_add_u32 s26, s24, 0x160000
    s_add_u32 m0, s29, 0xb000
    s_nop 0
    buffer_load_dwordx4 v136, s[16:19], s26 offen lds
    s_waitcnt lgkmcnt(12)
    v_mfma_f32_16x16x32_bf16 v[32:35], v[80:83], a[32:35], v[32:35]
    ds_read_b64_tr_b16 v[108:109], v131 offset:8192
    v_mfma_f32_16x16x32_bf16 v[36:39], v[80:83], a[96:99], v[36:39]
    ds_read_b64_tr_b16 v[110:111], v131 offset:9216
    s_add_u32 s26, s24, 0x180000
    s_add_u32 m0, s29, 0xc000
    s_nop 0
    buffer_load_dwordx4 v136, s[16:19], s26 offen lds
    s_waitcnt lgkmcnt(12)
    v_mfma_f32_16x16x32_bf16 v[40:43], v[84:87], a[32:35], v[40:43]
    ds_read_b64_tr_b16 v[112:113], v132 offset:8192
    v_mfma_f32_16x16x32_bf16 v[44:47], v[84:87], a[96:99], v[44:47]
    ds_read_b64_tr_b16 v[114:115], v132 offset:9216
    s_add_u32 s26, s24, 0x1a0000
    s_add_u32 m0, s29, 0xd000
    s_nop 0
    buffer_load_dwordx4 v136, s[16:19], s26 offen lds
    s_waitcnt lgkmcnt(12)
    v_mfma_f32_16x16x32_bf16 v[48:51], v[88:91], a[32:35], v[48:51]
    ds_read_b64_tr_b16 v[116:117], v133 offset:8192
    v_mfma_f32_16x16x32_bf16 v[52:55], v[88:91], a[96:99], v[52:55]
    ds_read_b64_tr_b16 v[118:119], v133 offset:9216
    s_add_u32 s26, s24, 0x1c0000
    s_add_u32 m0, s29, 0xe000
    s_nop 0
    buffer_load_dwordx4 v136, s[16:19], s26 offen lds
    s_waitcnt lgkmcnt(12)
    v_mfma_f32_16x16x32_bf16 v[56:59], v[92:95], a[32:35], v[56:59]
    ds_read_b64_tr_b16 v[120:121], v134 offset:8192
    v_mfma_f32_16x16x32_bf16 v[60:63], v[92:95], a[96:99], v[60:63]
    ds_read_b64_tr_b16 v[122:123], v134 offset:9216
    s_add_u32 s26, s24, 0x1e0000
    s_add_u32 m0, s29, 0xf000
    s_nop 0
    buffer_load_dwordx4 v136, s[16:19], s26 offen lds
    s_waitcnt lgkmcnt(12)
    v_mfma_f32_16x16x32_bf16 v[0:3], v[96:99], a[36:39], v[0:3]
    ds_read_b64_tr_b16 v[124:125], v135 offset:8192
    v_mfma_f32_16x16x32_bf16 v[4:7], v[96:99], a[100:103], v[4:7]
    ds_read_b64_tr_b16 v[126:127], v135 offset:9216
    s_waitcnt lgkmcnt(12)
    v_mfma_f32_16x16x32_bf16 v[8:11], v[100:103], a[36:39], v[8:11]
    ds_read_b64_tr_b16 v[64:65], v128 offset:16384
    v_mfma_f32_16x16x32_bf16 v[12:15], v[100:103], a[100:103], v[12:15]
    ds_read_b64_tr_b16 v[66:67], v128 offset:17408
    s_waitcnt lgkmcnt(12)
    v_mfma_f32_16x16x32_bf16 v[16:19], v[104:107], a[36:39], v[16:19]
    ds_read_b64_tr_b16 v[68:69], v129 offset:16384
    v_mfma_f32_16x16x32_bf16 v[20:23], v[104:107], a[100:103], v[20:23]
    ds_read_b64_tr_b16 v[70:71], v129 offset:17408
    s_waitcnt lgkmcnt(12)
    v_mfma_f32_16x16x32_bf16 v[24:27], v[108:111], a[36:39], v[24:27]
    ds_read_b64_tr_b16 v[72:73], v130 offset:16384
    v_mfma_f32_16x16x32_bf16 v[28:31], v[108:111], a[100:103], v[28:31]
    ds_read_b64_tr_b16 v[74:75], v130 offset:17408
    s_waitcnt lgkmcnt(12)
    v_mfma_f32_16x16x32_bf16 v[32:35], v[112:115], a[36:39], v[32:35]
    ds_read_b64_tr_b16 v[76:77], v131 offset:16384
    v_mfma_f32_16x16x32_bf16 v[36:39], v[112:115], a[100:103], v[36:39]
    ds_read_b64_tr_b16 v[78:79], v131 offset:17408
    s_waitcnt lgkmcnt(12)
    v_mfma_f32_16x16x32_bf16 v[40:43], v[116:119], a[36:39], v[40:43]
    ds_read_b64_tr_b16 v[80:81], v132 offset:16384
    v_mfma_f32_16x16x32_bf16 v[44:47], v[116:119], a[100:103], v[44:47]
    ds_read_b64_tr_b16 v[82:83], v132 offset:17408
    s_waitcnt lgkmcnt(12)
    v_mfma_f32_16x16x32_bf16 v[48:51], v[120:123], a[36:39], v[48:51]
    ds_read_b64_tr_b16 v[84:85], v133 offset:16384
    v_mfma_f32_16x16x32_bf16 v[52:55], v[120:123], a[100:103], v[52:55]
    ds_read_b64_tr_b16 v[86:87], v133 offset:17408
    s_waitcnt lgkmcnt(12)
    v_mfma_f32_16x16x32_bf16 v[56:59], v[124:127], a[36:39], v[56:59]
    ds_read_b64_tr_b16 v[88:89], v134 offset:16384
    v_mfma_f32_16x16x32_bf16 v[60:63], v[124:127], a[100:103], v[60:63]
    ds_read_b64_tr_b16 v[90:91], v134 offset:17408
    s_waitcnt lgkmcnt(12)
    v_mfma_f32_16x16x32_bf16 v[0:3], v[64:67], a[40:43], v[0:3]
    ds_read_b64_tr_b16 v[92:93], v135 offset:16384
    v_mfma_f32_16x16x32_bf16 v[4:7], v[64:67], a[104:107], v[4:7]
    ds_read_b64_tr_b16 v[94:95], v135 offset:17408
    s_waitcnt lgkmcnt(12)
    v_mfma_f32_16x16x32_bf16 v[8:11], v[68:71], a[40:43], v[8:11]
    ds_read_b64_tr_b16 v[96:97], v128 offset:24576
    v_mfma_f32_16x16x32_bf16 v[12:15], v[68:71], a[104:107], v[12:15]
    ds_read_b64_tr_b16 v[98:99], v128 offset:25600
    s_waitcnt lgkmcnt(12)
    v_mfma_f32_16x16x32_bf16 v[16:19], v[72:75], a[40:43], v[16:19]
    ds_read_b64_tr_b16 v[100:101], v129 offset:24576
    v_mfma_f32_16x16x32_bf16 v[20:23], v[72:75], a[104:107], v[20:23]
    ds_read_b64_tr_b16 v[102:103], v129 offset:25600
    s_waitcnt lgkmcnt(12)
    v_mfma_f32_16x16x32_bf16 v[24:27], v[76:79], a[40:43], v[24:27]
    ds_read_b64_tr_b16 v[104:105], v130 offset:24576
    v_mfma_f32_16x16x32_bf16 v[28:31], v[76:79], a[104:107], v[28:31]
    ds_read_b64_tr_b16 v[106:107], v130 offset:25600
    s_waitcnt lgkmcnt(12)
    v_mfma_f32_16x16x32_bf16 v[32:35], v[80:83], a[40:43], v[32:35]
    ds_read_b64_tr_b16 v[108:109], v131 offset:24576
    v_mfma_f32_16x16x32_bf16 v[36:39], v[80:83], a[104:107], v[36:39]
    ds_read_b64_tr_b16 v[110:111], v131 offset:25600
    s_waitcnt lgkmcnt(12)
    v_mfma_f32_16x16x32_bf16 v[40:43], v[84:87], a[40:43], v[40:43]
    ds_read_b64_tr_b16 v[112:113], v132 offset:24576
    v_mfma_f32_16x16x32_bf16 v[44:47], v[84:87], a[104:107], v[44:47]
    ds_read_b64_tr_b16 v[114:115], v132 offset:25600
    s_waitcnt lgkmcnt(12)
    v_mfma_f32_16x16x32_bf16 v[48:51], v[88:91], a[40:43], v[48:51]
    ds_read_b64_tr_b16 v[116:117], v133 offset:24576
    v_mfma_f32_16x16x32_bf16 v[52:55], v[88:91], a[104:107], v[52:55]
    ds_read_b64_tr_b16 v[118:119], v133 offset:25600
    s_waitcnt lgkmcnt(12)
    v_mfma_f32_16x16x32_bf16 v[56:59], v[92:95], a[40:43], v[56:59]
    ds_read_b64_tr_b16 v[120:121], v134 offset:24576
    v_mfma_f32_16x16x32_bf16 v[60:63], v[92:95], a[104:107], v[60:63]
    ds_read_b64_tr_b16 v[122:123], v134 offset:25600
    s_waitcnt lgkmcnt(12)
    v_mfma_f32_16x16x32_bf16 v[0:3], v[96:99], a[44:47], v[0:3]
    ds_read_b64_tr_b16 v[124:125], v135 offset:24576
    v_mfma_f32_16x16x32_bf16 v[4:7], v[96:99], a[108:111], v[4:7]
    ds_read_b64_tr_b16 v[126:127], v135 offset:25600
    s_waitcnt lgkmcnt(12)
    v_mfma_f32_16x16x32_bf16 v[8:11], v[100:103], a[44:47], v[8:11]
    v_mfma_f32_16x16x32_bf16 v[12:15], v[100:103], a[108:111], v[12:15]
    s_waitcnt lgkmcnt(10)
    v_mfma_f32_16x16x32_bf16 v[16:19], v[104:107], a[44:47], v[16:19]
    v_mfma_f32_16x16x32_bf16 v[20:23], v[104:107], a[108:111], v[20:23]
    s_waitcnt lgkmcnt(8)
    v_mfma_f32_16x16x32_bf16 v[24:27], v[108:111], a[44:47], v[24:27]
    v_mfma_f32_16x16x32_bf16 v[28:31], v[108:111], a[108:111], v[28:31]
    s_waitcnt lgkmcnt(6)
    v_mfma_f32_16x16x32_bf16 v[32:35], v[112:115], a[44:47], v[32:35]
    v_mfma_f32_16x16x32_bf16 v[36:39], v[112:115], a[108:111], v[36:39]
    s_waitcnt lgkmcnt(4)
    v_mfma_f32_16x16x32_bf16 v[40:43], v[116:119], a[44:47], v[40:43]
    v_mfma_f32_16x16x32_bf16 v[44:47], v[116:119], a[108:111], v[44:47]
    s_waitcnt lgkmcnt(2)
    v_mfma_f32_16x16x32_bf16 v[48:51], v[120:123], a[44:47], v[48:51]
    v_mfma_f32_16x16x32_bf16 v[52:55], v[120:123], a[108:111], v[52:55]
    s_waitcnt lgkmcnt(0)
    v_mfma_f32_16x16x32_bf16 v[56:59], v[124:127], a[44:47], v[56:59]
    v_mfma_f32_16x16x32_bf16 v[60:63], v[124:127], a[108:111], v[60:63]
    s_waitcnt vmcnt(16)
    s_barrier
    ds_read_b64_tr_b16 v[64:65], v128 offset:32768
    ds_read_b64_tr_b16 v[66:67], v128 offset:33792
    ds_read_b64_tr_b16 v[68:69], v129 offset:32768
    ds_read_b64_tr_b16 v[70:71], v129 offset:33792
    ds_read_b64_tr_b16 v[72:73], v130 offset:32768
    ds_read_b64_tr_b16 v[74:75], v130 offset:33792
    ds_read_b64_tr_b16 v[76:77], v131 offset:32768
    ds_read_b64_tr_b16 v[78:79], v131 offset:33792
    ds_read_b64_tr_b16 v[80:81], v132 offset:32768
    ds_read_b64_tr_b16 v[82:83], v132 offset:33792
    ds_read_b64_tr_b16 v[84:85], v133 offset:32768
    ds_read_b64_tr_b16 v[86:87], v133 offset:33792
    ds_read_b64_tr_b16 v[88:89], v134 offset:32768
    ds_read_b64_tr_b16 v[90:91], v134 offset:33792
    s_waitcnt lgkmcnt(12)
    v_mfma_f32_16x16x32_bf16 v[0:3], v[64:67], a[48:51], v[0:3]
    ds_read_b64_tr_b16 v[92:93], v135 offset:32768
    v_mfma_f32_16x16x32_bf16 v[4:7], v[64:67], a[112:115], v[4:7]
    ds_read_b64_tr_b16 v[94:95], v135 offset:33792
    s_add_u32 s26, s24, 0x200000
    s_add_u32 m0, s29, 0x10000
    s_nop 0
    buffer_load_dwordx4 v136, s[16:19], s26 offen lds
    s_waitcnt lgkmcnt(12)
    v_mfma_f32_16x16x32_bf16 v[8:11], v[68:71], a[48:51], v[8:11]
    ds_read_b64_tr_b16 v[96:97], v128 offset:40960
    v_mfma_f32_16x16x32_bf16 v[12:15], v[68:71], a[112:115], v[12:15]
    ds_read_b64_tr_b16 v[98:99], v128 offset:41984
    s_add_u32 s26, s24, 0x220000
    s_add_u32 m0, s29, 0x11000
    s_nop 0
    buffer_load_dwordx4 v136, s[16:19], s26 offen lds
    s_waitcnt lgkmcnt(12)
    v_mfma_f32_16x16x32_bf16 v[16:19], v[72:75], a[48:51], v[16:19]
    ds_read_b64_tr_b16 v[100:101], v129 offset:40960
    v_mfma_f32_16x16x32_bf16 v[20:23], v[72:75], a[112:115], v[20:23]
    ds_read_b64_tr_b16 v[102:103], v129 offset:41984
    s_add_u32 s26, s24, 0x240000
    s_add_u32 m0, s29, 0x12000
    s_nop 0
    buffer_load_dwordx4 v136, s[16:19], s26 offen lds
    s_waitcnt lgkmcnt(12)
    v_mfma_f32_16x16x32_bf16 v[24:27], v[76:79], a[48:51], v[24:27]
    ds_read_b64_tr_b16 v[104:105], v130 offset:40960
    v_mfma_f32_16x16x32_bf16 v[28:31], v[76:79], a[112:115], v[28:31]
    ds_read_b64_tr_b16 v[106:107], v130 offset:41984
    s_add_u32 s26, s24, 0x260000
    s_add_u32 m0, s29, 0x13000
    s_nop 0
    buffer_load_dwordx4 v136, s[16:19], s26 offen lds
    s_waitcnt lgkmcnt(12)
    v_mfma_f32_16x16x32_bf16 v[32:35], v[80:83], a[48:51], v[32:35]
    ds_read_b64_tr_b16 v[108:109], v131 offset:40960
    v_mfma_f32_16x16x32_bf16 v[36:39], v[80:83], a[112:115], v[36:39]
    ds_read_b64_tr_b16 v[110:111], v131 offset:41984
    s_add_u32 s26, s24, 0x280000
    s_add_u32 m0, s29, 0x14000
    s_nop 0
    buffer_load_dwordx4 v136, s[16:19], s26 offen lds
    s_waitcnt lgkmcnt(12)
    v_mfma_f32_16x16x32_bf16 v[40:43], v[84:87], a[48:51], v[40:43]
    ds_read_b64_tr_b16 v[112:113], v132 offset:40960
    v_mfma_f32_16x16x32_bf16 v[44:47], v[84:87], a[112:115], v[44:47]
    ds_read_b64_tr_b16 v[114:115], v132 offset:41984
    s_add_u32 s26, s24, 0x2a0000
    s_add_u32 m0, s29, 0x15000
    s_nop 0
    buffer_load_dwordx4 v136, s[16:19], s26 offen lds
    s_waitcnt lgkmcnt(12)
    v_mfma_f32_16x16x32_bf16 v[48:51], v[88:91], a[48:51], v[48:51]
    ds_read_b64_tr_b16 v[116:117], v133 offset:40960
    v_mfma_f32_16x16x32_bf16 v[52:55], v[88:91], a[112:115], v[52:55]
    ds_read_b64_tr_b16 v[118:119], v133 offset:41984
    s_add_u32 s26, s24, 0x2c0000
    s_add_u32 m0, s29, 0x16000
    s_nop 0
    buffer_load_dwordx4 v136, s[16:19], s26 offen lds
    s_waitcnt lgkmcnt(12)
    v_mfma_f32_16x16x32_bf16 v[56:59], v[92:95], a[48:51], v[56:59]
    ds_read_b64_tr_b16 v[120:121], v134 offset:40960
    v_mfma_f32_16x16x32_bf16 v[60:63], v[92:95], a[112:115], v[60:63]
    ds_read_b64_tr_b16 v[122:123], v134 offset:41984
    s_add_u32 s26, s24, 0x2e0000
    s_add_u32 m0, s29, 0x17000
    s_nop 0
    buffer_load_dwordx4 v136, s[16:19], s26 offen lds
    s_waitcnt lgkmcnt(12)
    v_mfma_f32_16x16x32_bf16 v[0:3], v[96:99], a[52:55], v[0:3]
    ds_read_b64_tr_b16 v[124:125], v135 offset:40960
    v_mfma_f32_16x16x32_bf16 v[4:7], v[96:99], a[116:119], v[4:7]
    ds_read_b64_tr_b16 v[126:127], v135 offset:41984
    s_waitcnt lgkmcnt(12)
    v_mfma_f32_16x16x32_bf16 v[8:11], v[100:103], a[52:55], v[8:11]
    ds_read_b64_tr_b16 v[64:65], v128 offset:49152
    v_mfma_f32_16x16x32_bf16 v[12:15], v[100:103], a[116:119], v[12:15]
    ds_read_b64_tr_b16 v[66:67], v128 offset:50176
    s_waitcnt lgkmcnt(12)
    v_mfma_f32_16x16x32_bf16 v[16:19], v[104:107], a[52:55], v[16:19]
    ds_read_b64_tr_b16 v[68:69], v129 offset:49152
    v_mfma_f32_16x16x32_bf16 v[20:23], v[104:107], a[116:119], v[20:23]
    ds_read_b64_tr_b16 v[70:71], v129 offset:50176
    s_waitcnt lgkmcnt(12)
    v_mfma_f32_16x16x32_bf16 v[24:27], v[108:111], a[52:55], v[24:27]
    ds_read_b64_tr_b16 v[72:73], v130 offset:49152
    v_mfma_f32_16x16x32_bf16 v[28:31], v[108:111], a[116:119], v[28:31]
    ds_read_b64_tr_b16 v[74:75], v130 offset:50176
    s_waitcnt lgkmcnt(12)
    v_mfma_f32_16x16x32_bf16 v[32:35], v[112:115], a[52:55], v[32:35]
    ds_read_b64_tr_b16 v[76:77], v131 offset:49152
    v_mfma_f32_16x16x32_bf16 v[36:39], v[112:115], a[116:119], v[36:39]
    ds_read_b64_tr_b16 v[78:79], v131 offset:50176
    s_waitcnt lgkmcnt(12)
    v_mfma_f32_16x16x32_bf16 v[40:43], v[116:119], a[52:55], v[40:43]
    ds_read_b64_tr_b16 v[80:81], v132 offset:49152
    v_mfma_f32_16x16x32_bf16 v[44:47], v[116:119], a[116:119], v[44:47]
    ds_read_b64_tr_b16 v[82:83], v132 offset:50176
    s_waitcnt lgkmcnt(12)
    v_mfma_f32_16x16x32_bf16 v[48:51], v[120:123], a[52:55], v[48:51]
    ds_read_b64_tr_b16 v[84:85], v133 offset:49152
    v_mfma_f32_16x16x32_bf16 v[52:55], v[120:123], a[116:119], v[52:55]
    ds_read_b64_tr_b16 v[86:87], v133 offset:50176
    s_waitcnt lgkmcnt(12)
    v_mfma_f32_16x16x32_bf16 v[56:59], v[124:127], a[52:55], v[56:59]
    ds_read_b64_tr_b16 v[88:89], v134 offset:49152
    v_mfma_f32_16x16x32_bf16 v[60:63], v[124:127], a[116:119], v[60:63]
    ds_read_b64_tr_b16 v[90:91], v134 offset:50176
    s_waitcnt lgkmcnt(12)
    v_mfma_f32_16x16x32_bf16 v[0:3], v[64:67], a[56:59], v[0:3]
    ds_read_b64_tr_b16 v[92:93], v135 offset:49152
    v_mfma_f32_16x16x32_bf16 v[4:7], v[64:67], a[120:123], v[4:7]
    ds_read_b64_tr_b16 v[94:95], v135 offset:50176
    s_waitcnt lgkmcnt(12)
    v_mfma_f32_16x16x32_bf16 v[8:11], v[68:71], a[56:59], v[8:11]
    ds_read_b64_tr_b16 v[96:97], v128 offset:57344
    v_mfma_f32_16x16x32_bf16 v[12:15], v[68:71], a[120:123], v[12:15]
    ds_read_b64_tr_b16 v[98:99], v128 offset:58368
    s_waitcnt lgkmcnt(12)
    v_mfma_f32_16x16x32_bf16 v[16:19], v[72:75], a[56:59], v[16:19]
    ds_read_b64_tr_b16 v[100:101], v129 offset:57344
    v_mfma_f32_16x16x32_bf16 v[20:23], v[72:75], a[120:123], v[20:23]
    ds_read_b64_tr_b16 v[102:103], v129 offset:58368
    s_waitcnt lgkmcnt(12)
    v_mfma_f32_16x16x32_bf16 v[24:27], v[76:79], a[56:59], v[24:27]
    ds_read_b64_tr_b16 v[104:105], v130 offset:57344
    v_mfma_f32_16x16x32_bf16 v[28:31], v[76:79], a[120:123], v[28:31]
    ds_read_b64_tr_b16 v[106:107], v130 offset:58368
    s_waitcnt lgkmcnt(12)
    v_mfma_f32_16x16x32_bf16 v[32:35], v[80:83], a[56:59], v[32:35]
    ds_read_b64_tr_b16 v[108:109], v131 offset:57344
    v_mfma_f32_16x16x32_bf16 v[36:39], v[80:83], a[120:123], v[36:39]
    ds_read_b64_tr_b16 v[110:111], v131 offset:58368
    s_waitcnt lgkmcnt(12)
    v_mfma_f32_16x16x32_bf16 v[40:43], v[84:87], a[56:59], v[40:43]
    ds_read_b64_tr_b16 v[112:113], v132 offset:57344
    v_mfma_f32_16x16x32_bf16 v[44:47], v[84:87], a[120:123], v[44:47]
    ds_read_b64_tr_b16 v[114:115], v132 offset:58368
    s_waitcnt lgkmcnt(12)
    v_mfma_f32_16x16x32_bf16 v[48:51], v[88:91], a[56:59], v[48:51]
    ds_read_b64_tr_b16 v[116:117], v133 offset:57344
    v_mfma_f32_16x16x32_bf16 v[52:55], v[88:91], a[120:123], v[52:55]
    ds_read_b64_tr_b16 v[118:119], v133 offset:58368
    s_waitcnt lgkmcnt(12)
    v_mfma_f32_16x16x32_bf16 v[56:59], v[92:95], a[56:59], v[56:59]
    ds_read_b64_tr_b16 v[120:121], v134 offset:57344
    v_mfma_f32_16x16x32_bf16 v[60:63], v[92:95], a[120:123], v[60:63]
    ds_read_b64_tr_b16 v[122:123], v134 offset:58368
    s_waitcnt lgkmcnt(12)
    v_mfma_f32_16x16x32_bf16 v[0:3], v[96:99], a[60:63], v[0:3]
    ds_read_b64_tr_b16 v[124:125], v135 offset:57344
    v_mfma_f32_16x16x32_bf16 v[4:7], v[96:99], a[124:127], v[4:7]
    ds_read_b64_tr_b16 v[126:127], v135 offset:58368
    s_waitcnt lgkmcnt(12)
    v_mfma_f32_16x16x32_bf16 v[8:11], v[100:103], a[60:63], v[8:11]
    v_mfma_f32_16x16x32_bf16 v[12:15], v[100:103], a[124:127], v[12:15]
    s_waitcnt lgkmcnt(10)
    v_mfma_f32_16x16x32_bf16 v[16:19], v[104:107], a[60:63], v[16:19]
    v_mfma_f32_16x16x32_bf16 v[20:23], v[104:107], a[124:127], v[20:23]
    s_waitcnt lgkmcnt(8)
    v_mfma_f32_16x16x32_bf16 v[24:27], v[108:111], a[60:63], v[24:27]
    v_mfma_f32_16x16x32_bf16 v[28:31], v[108:111], a[124:127], v[28:31]
    s_waitcnt lgkmcnt(6)
    v_mfma_f32_16x16x32_bf16 v[32:35], v[112:115], a[60:63], v[32:35]
    v_mfma_f32_16x16x32_bf16 v[36:39], v[112:115], a[124:127], v[36:39]
    s_waitcnt lgkmcnt(4)
    v_mfma_f32_16x16x32_bf16 v[40:43], v[116:119], a[60:63], v[40:43]
    v_mfma_f32_16x16x32_bf16 v[44:47], v[116:119], a[124:127], v[44:47]
    s_waitcnt lgkmcnt(2)
    v_mfma_f32_16x16x32_bf16 v[48:51], v[120:123], a[60:63], v[48:51]
    v_mfma_f32_16x16x32_bf16 v[52:55], v[120:123], a[124:127], v[52:55]
    s_waitcnt lgkmcnt(0)
    v_mfma_f32_16x16x32_bf16 v[56:59], v[124:127], a[60:63], v[56:59]
    v_mfma_f32_16x16x32_bf16 v[60:63], v[124:127], a[124:127], v[60:63]
    v_xor_b32 v128, 0x10000, v128
    v_xor_b32 v129, 0x10000, v129
    v_xor_b32 v130, 0x10000, v130
    v_xor_b32 v131, 0x10000, v131
    v_xor_b32 v132, 0x10000, v132
    v_xor_b32 v133, 0x10000, v133
    v_xor_b32 v134, 0x10000, v134
    v_xor_b32 v135, 0x10000, v135
    v_cvt_pk_bf16_f32 v144, v0, v8
    v_cvt_pk_bf16_f32 v145, v1, v9
    v_cvt_pk_bf16_f32 v146, v2, v10
    v_cvt_pk_bf16_f32 v147, v3, v11
    buffer_store_dwordx4 v[144:147], v137, s[8:11], s25 offen sc1
    v_cvt_pk_bf16_f32 v148, v16, v24
    v_cvt_pk_bf16_f32 v149, v17, v25
    v_cvt_pk_bf16_f32 v150, v18, v26
    v_cvt_pk_bf16_f32 v151, v19, v27
    buffer_store_dwordx4 v[148:151], v137, s[8:11], s25 offen offset:1024 sc1
    v_cvt_pk_bf16_f32 v152, v32, v40
    v_cvt_pk_bf16_f32 v153, v33, v41
    v_cvt_pk_bf16_f32 v154, v34, v42
    v_cvt_pk_bf16_f32 v155, v35, v43
    buffer_store_dwordx4 v[152:155], v137, s[8:11], s25 offen offset:2048 sc1
    v_cvt_pk_bf16_f32 v156, v48, v56
    v_cvt_pk_bf16_f32 v157, v49, v57
    v_cvt_pk_bf16_f32 v158, v50, v58
    v_cvt_pk_bf16_f32 v159, v51, v59
    buffer_store_dwordx4 v[156:159], v137, s[8:11], s25 offen offset:3072 sc1
    v_cvt_pk_bf16_f32 v144, v4, v12
    v_cvt_pk_bf16_f32 v145, v5, v13
    v_cvt_pk_bf16_f32 v146, v6, v14
    v_cvt_pk_bf16_f32 v147, v7, v15
    s_add_u32 s25, s25, 4096
    buffer_store_dwordx4 v[144:147], v137, s[8:11], s25 offen sc1
    v_cvt_pk_bf16_f32 v148, v20, v28
    v_cvt_pk_bf16_f32 v149, v21, v29
    v_cvt_pk_bf16_f32 v150, v22, v30
    v_cvt_pk_bf16_f32 v151, v23, v31
    buffer_store_dwordx4 v[148:151], v137, s[8:11], s25 offen offset:1024 sc1
    v_cvt_pk_bf16_f32 v152, v36, v44
    v_cvt_pk_bf16_f32 v153, v37, v45
    v_cvt_pk_bf16_f32 v154, v38, v46
    v_cvt_pk_bf16_f32 v155, v39, v47
    buffer_store_dwordx4 v[152:155], v137, s[8:11], s25 offen offset:2048 sc1
    v_cvt_pk_bf16_f32 v156, v52, v60
    v_cvt_pk_bf16_f32 v157, v53, v61
    v_cvt_pk_bf16_f32 v158, v54, v62
    v_cvt_pk_bf16_f32 v159, v55, v63
    buffer_store_dwordx4 v[156:159], v137, s[8:11], s25 offen offset:3072 sc1
    s_branch L_p1_next
L_p1_v:
    s_waitcnt vmcnt(16)
    s_barrier
    ds_read_b64_tr_b16 v[64:65], v128
    ds_read_b64_tr_b16 v[66:67], v128 offset:1024
    ds_read_b64_tr_b16 v[68:69], v129
    ds_read_b64_tr_b16 v[70:71], v129 offset:1024
    ds_read_b64_tr_b16 v[72:73], v130
    ds_read_b64_tr_b16 v[74:75], v130 offset:1024
    ds_read_b64_tr_b16 v[76:77], v131
    ds_read_b64_tr_b16 v[78:79], v131 offset:1024
    ds_read_b64_tr_b16 v[80:81], v132
    ds_read_b64_tr_b16 v[82:83], v132 offset:1024
    ds_read_b64_tr_b16 v[84:85], v133
    ds_read_b64_tr_b16 v[86:87], v133 offset:1024
    ds_read_b64_tr_b16 v[88:89], v134
    ds_read_b64_tr_b16 v[90:91], v134 offset:1024
    s_waitcnt lgkmcnt(12)
    v_mfma_f32_16x16x32_bf16 v[0:3], a[0:3], v[64:67], 0
    ds_read_b64_tr_b16 v[92:93], v135
    v_mfma_f32_16x16x32_bf16 v[4:7], a[64:67], v[64:67], 0
    ds_read_b64_tr_b16 v[94:95], v135 offset:1024
    s_add_u32 s26, s24, 0x300000
    s_add_u32 m0, s29, 0x18000
    s_nop 0
    buffer_load_dwordx4 v136, s[16:19], s26 offen lds
    s_waitcnt lgkmcnt(12)
    v_mfma_f32_16x16x32_bf16 v[8:11], a[0:3], v[68:71], 0
    ds_read_b64_tr_b16 v[96:97], v128 offset:8192
    v_mfma_f32_16x16x32_bf16 v[12:15], a[64:67], v[68:71], 0
    ds_read_b64_tr_b16 v[98:99], v128 offset:9216
    s_add_u32 s26, s24, 0x320000
    s_add_u32 m0, s29, 0x19000
    s_nop 0
    buffer_load_dwordx4 v136, s[16:19], s26 offen lds
    s_waitcnt lgkmcnt(12)
    v_mfma_f32_16x16x32_bf16 v[16:19], a[0:3], v[72:75], 0
    ds_read_b64_tr_b16 v[100:101], v129 offset:8192
    v_mfma_f32_16x16x32_bf16 v[20:23], a[64:67], v[72:75], 0
    ds_read_b64_tr_b16 v[102:103], v129 offset:9216
    s_add_u32 s26, s24, 0x340000
    s_add_u32 m0, s29, 0x1a000
    s_nop 0
    buffer_load_dwordx4 v136, s[16:19], s26 offen lds
    s_waitcnt lgkmcnt(12)
    v_mfma_f32_16x16x32_bf16 v[24:27], a[0:3], v[76:79], 0
    ds_read_b64_tr_b16 v[104:105], v130 offset:8192
    v_mfma_f32_16x16x32_bf16 v[28:31], a[64:67], v[76:79], 0
    ds_read_b64_tr_b16 v[106:107], v130 offset:9216
    s_add_u32 s26, s24, 0x360000
    s_add_u32 m0, s29, 0x1b000
    s_nop 0
    buffer_load_dwordx4 v136, s[16:19], s26 offen lds
    s_waitcnt lgkmcnt(12)
    v_mfma_f32_16x16x32_bf16 v[32:35], a[0:3], v[80:83], 0
    ds_read_b64_tr_b16 v[108:109], v131 offset:8192
    v_mfma_f32_16x16x32_bf16 v[36:39], a[64:67], v[80:83], 0
    ds_read_b64_tr_b16 v[110:111], v131 offset:9216
    s_add_u32 s26, s24, 0x380000
    s_add_u32 m0, s29, 0x1c000
    s_nop 0
    buffer_load_dwordx4 v136, s[16:19], s26 offen lds
    s_waitcnt lgkmcnt(12)
    v_mfma_f32_16x16x32_bf16 v[40:43], a[0:3], v[84:87], 0
    ds_read_b64_tr_b16 v[112:113], v132 offset:8192
    v_mfma_f32_16x16x32_bf16 v[44:47], a[64:67], v[84:87], 0
    ds_read_b64_tr_b16 v[114:115], v132 offset:9216
    s_add_u32 s26, s24, 0x3a0000
    s_add_u32 m0, s29, 0x1d000
    s_nop 0
    buffer_load_dwordx4 v136, s[16:19], s26 offen lds
    s_waitcnt lgkmcnt(12)
    v_mfma_f32_16x16x32_bf16 v[48:51], a[0:3], v[88:91], 0
    ds_read_b64_tr_b16 v[116:117], v133 offset:8192
    v_mfma_f32_16x16x32_bf16 v[52:55], a[64:67], v[88:91], 0
    ds_read_b64_tr_b16 v[118:119], v133 offset:9216
    s_add_u32 s26, s24, 0x3c0000
    s_add_u32 m0, s29, 0x1e000
    s_nop 0
    buffer_load_dwordx4 v136, s[16:19], s26 offen lds
    s_waitcnt lgkmcnt(12)
    v_mfma_f32_16x16x32_bf16 v[56:59], a[0:3], v[92:95], 0
    ds_read_b64_tr_b16 v[120:121], v134 offset:8192
    v_mfma_f32_16x16x32_bf16 v[60:63], a[64:67], v[92:95], 0
    ds_read_b64_tr_b16 v[122:123], v134 offset:9216
    s_add_u32 s26, s24, 0x3e0000
    s_add_u32 m0, s29, 0x1f000
    s_nop 0
    buffer_load_dwordx4 v136, s[16:19], s26 offen lds
    s_waitcnt lgkmcnt(12)
    v_mfma_f32_16x16x32_bf16 v[0:3], a[4:7], v[96:99], v[0:3]
    ds_read_b64_tr_b16 v[124:125], v135 offset:8192
    v_mfma_f32_16x16x32_bf16 v[4:7], a[68:71], v[96:99], v[4:7]
    ds_read_b64_tr_b16 v[126:127], v135 offset:9216
    s_waitcnt lgkmcnt(12)
    v_mfma_f32_16x16x32_bf16 v[8:11], a[4:7], v[100:103], v[8:11]
    ds_read_b64_tr_b16 v[64:65], v128 offset:16384
    v_mfma_f32_16x16x32_bf16 v[12:15], a[68:71], v[100:103], v[12:15]
    ds_read_b64_tr_b16 v[66:67], v128 offset:17408
    s_waitcnt lgkmcnt(12)
    v_mfma_f32_16x16x32_bf16 v[16:19], a[4:7], v[104:107], v[16:19]
    ds_read_b64_tr_b16 v[68:69], v129 offset:16384
    v_mfma_f32_16x16x32_bf16 v[20:23], a[68:71], v[104:107], v[20:23]
    ds_read_b64_tr_b16 v[70:71], v129 offset:17408
    s_waitcnt lgkmcnt(12)
    v_mfma_f32_16x16x32_bf16 v[24:27], a[4:7], v[108:111], v[24:27]
    ds_read_b64_tr_b16 v[72:73], v130 offset:16384
    v_mfma_f32_16x16x32_bf16 v[28:31], a[68:71], v[108:111], v[28:31]
    ds_read_b64_tr_b16 v[74:75], v130 offset:17408
    s_waitcnt lgkmcnt(12)
    v_mfma_f32_16x16x32_bf16 v[32:35], a[4:7], v[112:115], v[32:35]
    ds_read_b64_tr_b16 v[76:77], v131 offset:16384
    v_mfma_f32_16x16x32_bf16 v[36:39], a[68:71], v[112:115], v[36:39]
    ds_read_b64_tr_b16 v[78:79], v131 offset:17408
    s_waitcnt lgkmcnt(12)
    v_mfma_f32_16x16x32_bf16 v[40:43], a[4:7], v[116:119], v[40:43]
    ds_read_b64_tr_b16 v[80:81], v132 offset:16384
    v_mfma_f32_16x16x32_bf16 v[44:47], a[68:71], v[116:119], v[44:47]
    ds_read_b64_tr_b16 v[82:83], v132 offset:17408
    s_waitcnt lgkmcnt(12)
    v_mfma_f32_16x16x32_bf16 v[48:51], a[4:7], v[120:123], v[48:51]
    ds_read_b64_tr_b16 v[84:85], v133 offset:16384
    v_mfma_f32_16x16x32_bf16 v[52:55], a[68:71], v[120:123], v[52:55]
    ds_read_b64_tr_b16 v[86:87], v133 offset:17408
    s_waitcnt lgkmcnt(12)
    v_mfma_f32_16x16x32_bf16 v[56:59], a[4:7], v[124:127], v[56:59]
    ds_read_b64_tr_b16 v[88:89], v134 offset:16384
    v_mfma_f32_16x16x32_bf16 v[60:63], a[68:71], v[124:127], v[60:63]
    ds_read_b64_tr_b16 v[90:91], v134 offset:17408
    s_waitcnt lgkmcnt(12)
    v_mfma_f32_16x16x32_bf16 v[0:3], a[8:11], v[64:67], v[0:3]
    ds_read_b64_tr_b16 v[92:93], v135 offset:16384
    v_mfma_f32_16x16x32_bf16 v[4:7], a[72:75], v[64:67], v[4:7]
    ds_read_b64_tr_b16 v[94:95], v135 offset:17408
    s_waitcnt lgkmcnt(12)
    v_mfma_f32_16x16x32_bf16 v[8:11], a[8:11], v[68:71], v[8:11]
    ds_read_b64_tr_b16 v[96:97], v128 offset:24576
    v_mfma_f32_16x16x32_bf16 v[12:15], a[72:75], v[68:71], v[12:15]
    ds_read_b64_tr_b16 v[98:99], v128 offset:25600
    s_waitcnt lgkmcnt(12)
    v_mfma_f32_16x16x32_bf16 v[16:19], a[8:11], v[72:75], v[16:19]
    ds_read_b64_tr_b16 v[100:101], v129 offset:24576
    v_mfma_f32_16x16x32_bf16 v[20:23], a[72:75], v[72:75], v[20:23]
    ds_read_b64_tr_b16 v[102:103], v129 offset:25600
    s_waitcnt lgkmcnt(12)
    v_mfma_f32_16x16x32_bf16 v[24:27], a[8:11], v[76:79], v[24:27]
    ds_read_b64_tr_b16 v[104:105], v130 offset:24576
    v_mfma_f32_16x16x32_bf16 v[28:31], a[72:75], v[76:79], v[28:31]
    ds_read_b64_tr_b16 v[106:107], v130 offset:25600
    s_waitcnt lgkmcnt(12)
    v_mfma_f32_16x16x32_bf16 v[32:35], a[8:11], v[80:83], v[32:35]
    ds_read_b64_tr_b16 v[108:109], v131 offset:24576
    v_mfma_f32_16x16x32_bf16 v[36:39], a[72:75], v[80:83], v[36:39]
    ds_read_b64_tr_b16 v[110:111], v131 offset:25600
    s_waitcnt lgkmcnt(12)
    v_mfma_f32_16x16x32_bf16 v[40:43], a[8:11], v[84:87], v[40:43]
    ds_read_b64_tr_b16 v[112:113], v132 offset:24576
    v_mfma_f32_16x16x32_bf16 v[44:47], a[72:75], v[84:87], v[44:47]
    ds_read_b64_tr_b16 v[114:115], v132 offset:25600
    s_waitcnt lgkmcnt(12)
    v_mfma_f32_16x16x32_bf16 v[48:51], a[8:11], v[88:91], v[48:51]
    ds_read_b64_tr_b16 v[116:117], v133 offset:24576
    v_mfma_f32_16x16x32_bf16 v[52:55], a[72:75], v[88:91], v[52:55]
    ds_read_b64_tr_b16 v[118:119], v133 offset:25600
    s_waitcnt lgkmcnt(12)
    v_mfma_f32_16x16x32_bf16 v[56:59], a[8:11], v[92:95], v[56:59]
    ds_read_b64_tr_b16 v[120:121], v134 offset:24576
    v_mfma_f32_16x16x32_bf16 v[60:63], a[72:75], v[92:95], v[60:63]
    ds_read_b64_tr_b16 v[122:123], v134 offset:25600
    s_waitcnt lgkmcnt(12)
    v_mfma_f32_16x16x32_bf16 v[0:3], a[12:15], v[96:99], v[0:3]
    ds_read_b64_tr_b16 v[124:125], v135 offset:24576
    v_mfma_f32_16x16x32_bf16 v[4:7], a[76:79], v[96:99], v[4:7]
    ds_read_b64_tr_b16 v[126:127], v135 offset:25600
    s_waitcnt lgkmcnt(12)
    v_mfma_f32_16x16x32_bf16 v[8:11], a[12:15], v[100:103], v[8:11]
    v_mfma_f32_16x16x32_bf16 v[12:15], a[76:79], v[100:103], v[12:15]
    s_waitcnt lgkmcnt(10)
    v_mfma_f32_16x16x32_bf16 v[16:19], a[12:15], v[104:107], v[16:19]
    v_mfma_f32_16x16x32_bf16 v[20:23], a[76:79], v[104:107], v[20:23]
    s_waitcnt lgkmcnt(8)
    v_mfma_f32_16x16x32_bf16 v[24:27], a[12:15], v[108:111], v[24:27]
    v_mfma_f32_16x16x32_bf16 v[28:31], a[76:79], v[108:111], v[28:31]
    s_waitcnt lgkmcnt(6)
    v_mfma_f32_16x16x32_bf16 v[32:35], a[12:15], v[112:115], v[32:35]
    v_mfma_f32_16x16x32_bf16 v[36:39], a[76:79], v[112:115], v[36:39]
    s_waitcnt lgkmcnt(4)
    v_mfma_f32_16x16x32_bf16 v[40:43], a[12:15], v[116:119], v[40:43]
    v_mfma_f32_16x16x32_bf16 v[44:47], a[76:79], v[116:119], v[44:47]
    s_waitcnt lgkmcnt(2)
    v_mfma_f32_16x16x32_bf16 v[48:51], a[12:15], v[120:123], v[48:51]
    v_mfma_f32_16x16x32_bf16 v[52:55], a[76:79], v[120:123], v[52:55]
    s_waitcnt lgkmcnt(0)
    v_mfma_f32_16x16x32_bf16 v[56:59], a[12:15], v[124:127], v[56:59]
    v_mfma_f32_16x16x32_bf16 v[60:63], a[76:79], v[124:127], v[60:63]
    s_waitcnt vmcnt(16)
    s_barrier
    ds_read_b64_tr_b16 v[64:65], v128 offset:32768
    ds_read_b64_tr_b16 v[66:67], v128 offset:33792
    ds_read_b64_tr_b16 v[68:69], v129 offset:32768
    ds_read_b64_tr_b16 v[70:71], v129 offset:33792
    ds_read_b64_tr_b16 v[72:73], v130 offset:32768
    ds_read_b64_tr_b16 v[74:75], v130 offset:33792
    ds_read_b64_tr_b16 v[76:77], v131 offset:32768
    ds_read_b64_tr_b16 v[78:79], v131 offset:33792
    ds_read_b64_tr_b16 v[80:81], v132 offset:32768
    ds_read_b64_tr_b16 v[82:83], v132 offset:33792
    ds_read_b64_tr_b16 v[84:85], v133 offset:32768
    ds_read_b64_tr_b16 v[86:87], v133 offset:33792
    ds_read_b64_tr_b16 v[88:89], v134 offset:32768
    ds_read_b64_tr_b16 v[90:91], v134 offset:33792
    s_add_u32 s39, s39, s37
    s_lshr_b32 s26, s39, 5
    s_cmp_eq_u32 s26, 0
    s_cselect_b64 s[16:17], s[62:63], s[60:61]
    s_cmp_eq_u32 s26, 1
    s_cselect_b64 s[16:17], s[64:65], s[16:17]
    s_and_b32 s17, s17, 0xffff
    s_cmp_lt_u32 s39, 96
    s_cselect_b32 s18, 0x400000, 0
    s_and_b32 s24, s39, 31
    s_lshl_b32 s24, s24, 8
    s_waitcnt lgkmcnt(12)
    v_mfma_f32_16x16x32_bf16 v[0:3], a[16:19], v[64:67], v[0:3]
    ds_read_b64_tr_b16 v[92:93], v135 offset:32768
    v_mfma_f32_16x16x32_bf16 v[4:7], a[80:83], v[64:67], v[4:7]
    ds_read_b64_tr_b16 v[94:95], v135 offset:33792
    s_add_u32 s26, s24, 0x0
    s_add_u32 m0, s29, 0x0
    s_nop 0
    buffer_load_dwordx4 v136, s[16:19], s26 offen lds
    s_waitcnt lgkmcnt(12)
    v_mfma_f32_16x16x32_bf16 v[8:11], a[16:19], v[68:71], v[8:11]
    ds_read_b64_tr_b16 v[96:97], v128 offset:40960
    v_mfma_f32_16x16x32_bf16 v[12:15], a[80:83], v[68:71], v[12:15]
    ds_read_b64_tr_b16 v[98:99], v128 offset:41984
    s_add_u32 s26, s24, 0x20000
    s_add_u32 m0, s29, 0x1000
    s_nop 0
    buffer_load_dwordx4 v136, s[16:19], s26 offen lds
    s_waitcnt lgkmcnt(12)
    v_mfma_f32_16x16x32_bf16 v[16:19], a[16:19], v[72:75], v[16:19]
    ds_read_b64_tr_b16 v[100:101], v129 offset:40960
    v_mfma_f32_16x16x32_bf16 v[20:23], a[80:83], v[72:75], v[20:23]
    ds_read_b64_tr_b16 v[102:103], v129 offset:41984
    s_add_u32 s26, s24, 0x40000
    s_add_u32 m0, s29, 0x2000
    s_nop 0
    buffer_load_dwordx4 v136, s[16:19], s26 offen lds
    s_waitcnt lgkmcnt(12)
    v_mfma_f32_16x16x32_bf16 v[24:27], a[16:19], v[76:79], v[24:27]
    ds_read_b64_tr_b16 v[104:105], v130 offset:40960
    v_mfma_f32_16x16x32_bf16 v[28:31], a[80:83], v[76:79], v[28:31]
    ds_read_b64_tr_b16 v[106:107], v130 offset:41984
    s_add_u32 s26, s24, 0x60000
    s_add_u32 m0, s29, 0x3000
    s_nop 0
    buffer_load_dwordx4 v136, s[16:19], s26 offen lds
    s_waitcnt lgkmcnt(12)
    v_mfma_f32_16x16x32_bf16 v[32:35], a[16:19], v[80:83], v[32:35]
    ds_read_b64_tr_b16 v[108:109], v131 offset:40960
    v_mfma_f32_16x16x32_bf16 v[36:39], a[80:83], v[80:83], v[36:39]
    ds_read_b64_tr_b16 v[110:111], v131 offset:41984
    s_add_u32 s26, s24, 0x80000
    s_add_u32 m0, s29, 0x4000
    s_nop 0
    buffer_load_dwordx4 v136, s[16:19], s26 offen lds
    s_waitcnt lgkmcnt(12)
    v_mfma_f32_16x16x32_bf16 v[40:43], a[16:19], v[84:87], v[40:43]
    ds_read_b64_tr_b16 v[112:113], v132 offset:40960
    v_mfma_f32_16x16x32_bf16 v[44:47], a[80:83], v[84:87], v[44:47]
    ds_read_b64_tr_b16 v[114:115], v132 offset:41984
    s_add_u32 s26, s24, 0xa0000
    s_add_u32 m0, s29, 0x5000
    s_nop 0
    buffer_load_dwordx4 v136, s[16:19], s26 offen lds
    s_waitcnt lgkmcnt(12)
    v_mfma_f32_16x16x32_bf16 v[48:51], a[16:19], v[88:91], v[48:51]
    ds_read_b64_tr_b16 v[116:117], v133 offset:40960
    v_mfma_f32_16x16x32_bf16 v[52:55], a[80:83], v[88:91], v[52:55]
    ds_read_b64_tr_b16 v[118:119], v133 offset:41984
    s_add_u32 s26, s24, 0xc0000
    s_add_u32 m0, s29, 0x6000
    s_nop 0
    buffer_load_dwordx4 v136, s[16:19], s26 offen lds
    s_waitcnt lgkmcnt(12)
    v_mfma_f32_16x16x32_bf16 v[56:59], a[16:19], v[92:95], v[56:59]
    ds_read_b64_tr_b16 v[120:121], v134 offset:40960
    v_mfma_f32_16x16x32_bf16 v[60:63], a[80:83], v[92:95], v[60:63]
    ds_read_b64_tr_b16 v[122:123], v134 offset:41984
    s_add_u32 s26, s24, 0xe0000
    s_add_u32 m0, s29, 0x7000
    s_nop 0
    buffer_load_dwordx4 v136, s[16:19], s26 offen lds
    s_waitcnt lgkmcnt(12)
    v_mfma_f32_16x16x32_bf16 v[0:3], a[20:23], v[96:99], v[0:3]
    ds_read_b64_tr_b16 v[124:125], v135 offset:40960
    v_mfma_f32_16x16x32_bf16 v[4:7], a[84:87], v[96:99], v[4:7]
    ds_read_b64_tr_b16 v[126:127], v135 offset:41984
    s_waitcnt lgkmcnt(12)
    v_mfma_f32_16x16x32_bf16 v[8:11], a[20:23], v[100:103], v[8:11]
    ds_read_b64_tr_b16 v[64:65], v128 offset:49152
    v_mfma_f32_16x16x32_bf16 v[12:15], a[84:87], v[100:103], v[12:15]
    ds_read_b64_tr_b16 v[66:67], v128 offset:50176
    s_waitcnt lgkmcnt(12)
    v_mfma_f32_16x16x32_bf16 v[16:19], a[20:23], v[104:107], v[16:19]
    ds_read_b64_tr_b16 v[68:69], v129 offset:49152
    v_mfma_f32_16x16x32_bf16 v[20:23], a[84:87], v[104:107], v[20:23]
    ds_read_b64_tr_b16 v[70:71], v129 offset:50176
    s_waitcnt lgkmcnt(12)
    v_mfma_f32_16x16x32_bf16 v[24:27], a[20:23], v[108:111], v[24:27]
    ds_read_b64_tr_b16 v[72:73], v130 offset:49152
    v_mfma_f32_16x16x32_bf16 v[28:31], a[84:87], v[108:111], v[28:31]
    ds_read_b64_tr_b16 v[74:75], v130 offset:50176
    s_waitcnt lgkmcnt(12)
    v_mfma_f32_16x16x32_bf16 v[32:35], a[20:23], v[112:115], v[32:35]
    ds_read_b64_tr_b16 v[76:77], v131 offset:49152
    v_mfma_f32_16x16x32_bf16 v[36:39], a[84:87], v[112:115], v[36:39]
    ds_read_b64_tr_b16 v[78:79], v131 offset:50176
    s_waitcnt lgkmcnt(12)
    v_mfma_f32_16x16x32_bf16 v[40:43], a[20:23], v[116:119], v[40:43]
    ds_read_b64_tr_b16 v[80:81], v132 offset:49152
    v_mfma_f32_16x16x32_bf16 v[44:47], a[84:87], v[116:119], v[44:47]
    ds_read_b64_tr_b16 v[82:83], v132 offset:50176
    s_waitcnt lgkmcnt(12)
    v_mfma_f32_16x16x32_bf16 v[48:51], a[20:23], v[120:123], v[48:51]
    ds_read_b64_tr_b16 v[84:85], v133 offset:49152
    v_mfma_f32_16x16x32_bf16 v[52:55], a[84:87], v[120:123], v[52:55]
    ds_read_b64_tr_b16 v[86:87], v133 offset:50176
    s_waitcnt lgkmcnt(12)
    v_mfma_f32_16x16x32_bf16 v[56:59], a[20:23], v[124:127], v[56:59]
    ds_read_b64_tr_b16 v[88:89], v134 offset:49152
    v_mfma_f32_16x16x32_bf16 v[60:63], a[84:87], v[124:127], v[60:63]
    ds_read_b64_tr_b16 v[90:91], v134 offset:50176
    s_waitcnt lgkmcnt(12)
    v_mfma_f32_16x16x32_bf16 v[0:3], a[24:27], v[64:67], v[0:3]
    ds_read_b64_tr_b16 v[92:93], v135 offset:49152
    v_mfma_f32_16x16x32_bf16 v[4:7], a[88:91], v[64:67], v[4:7]
    ds_read_b64_tr_b16 v[94:95], v135 offset:50176
    s_waitcnt lgkmcnt(12)
    v_mfma_f32_16x16x32_bf16 v[8:11], a[24:27], v[68:71], v[8:11]
    ds_read_b64_tr_b16 v[96:97], v128 offset:57344
    v_mfma_f32_16x16x32_bf16 v[12:15], a[88:91], v[68:71], v[12:15]
    ds_read_b64_tr_b16 v[98:99], v128 offset:58368
    s_waitcnt lgkmcnt(12)
    v_mfma_f32_16x16x32_bf16 v[16:19], a[24:27], v[72:75], v[16:19]
    ds_read_b64_tr_b16 v[100:101], v129 offset:57344
    v_mfma_f32_16x16x32_bf16 v[20:23], a[88:91], v[72:75], v[20:23]
    ds_read_b64_tr_b16 v[102:103], v129 offset:58368
    s_waitcnt lgkmcnt(12)
    v_mfma_f32_16x16x32_bf16 v[24:27], a[24:27], v[76:79], v[24:27]
    ds_read_b64_tr_b16 v[104:105], v130 offset:57344
    v_mfma_f32_16x16x32_bf16 v[28:31], a[88:91], v[76:79], v[28:31]
    ds_read_b64_tr_b16 v[106:107], v130 offset:58368
    s_waitcnt lgkmcnt(12)
    v_mfma_f32_16x16x32_bf16 v[32:35], a[24:27], v[80:83], v[32:35]
    ds_read_b64_tr_b16 v[108:109], v131 offset:57344
    v_mfma_f32_16x16x32_bf16 v[36:39], a[88:91], v[80:83], v[36:39]
    ds_read_b64_tr_b16 v[110:111], v131 offset:58368
    s_waitcnt lgkmcnt(12)
    v_mfma_f32_16x16x32_bf16 v[40:43], a[24:27], v[84:87], v[40:43]
    ds_read_b64_tr_b16 v[112:113], v132 offset:57344
    v_mfma_f32_16x16x32_bf16 v[44:47], a[88:91], v[84:87], v[44:47]
    ds_read_b64_tr_b16 v[114:115], v132 offset:58368
    s_waitcnt lgkmcnt(12)
    v_mfma_f32_16x16x32_bf16 v[48:51], a[24:27], v[88:91], v[48:51]
    ds_read_b64_tr_b16 v[116:117], v133 offset:57344
    v_mfma_f32_16x16x32_bf16 v[52:55], a[88:91], v[88:91], v[52:55]
    ds_read_b64_tr_b16 v[118:119], v133 offset:58368
    s_waitcnt lgkmcnt(12)
    v_mfma_f32_16x16x32_bf16 v[56:59], a[24:27], v[92:95], v[56:59]
    ds_read_b64_tr_b16 v[120:121], v134 offset:57344
    v_mfma_f32_16x16x32_bf16 v[60:63], a[88:91], v[92:95], v[60:63]
    ds_read_b64_tr_b16 v[122:123], v134 offset:58368
    s_waitcnt lgkmcnt(12)
    v_mfma_f32_16x16x32_bf16 v[0:3], a[28:31], v[96:99], v[0:3]
    ds_read_b64_tr_b16 v[124:125], v135 offset:57344
    v_mfma_f32_16x16x32_bf16 v[4:7], a[92:95], v[96:99], v[4:7]
    ds_read_b64_tr_b16 v[126:127], v135 offset:58368
    s_waitcnt lgkmcnt(12)
    v_mfma_f32_16x16x32_bf16 v[8:11], a[28:31], v[100:103], v[8:11]
    v_mfma_f32_16x16x32_bf16 v[12:15], a[92:95], v[100:103], v[12:15]
    s_waitcnt lgkmcnt(10)
    v_mfma_f32_16x16x32_bf16 v[16:19], a[28:31], v[104:107], v[16:19]
    v_mfma_f32_16x16x32_bf16 v[20:23], a[92:95], v[104:107], v[20:23]
    s_waitcnt lgkmcnt(8)
    v_mfma_f32_16x16x32_bf16 v[24:27], a[28:31], v[108:111], v[24:27]
    v_mfma_f32_16x16x32_bf16 v[28:31], a[92:95], v[108:111], v[28:31]
    s_waitcnt lgkmcnt(6)
    v_mfma_f32_16x16x32_bf16 v[32:35], a[28:31], v[112:115], v[32:35]
    v_mfma_f32_16x16x32_bf16 v[36:39], a[92:95], v[112:115], v[36:39]
    s_waitcnt lgkmcnt(4)
    v_mfma_f32_16x16x32_bf16 v[40:43], a[28:31], v[116:119], v[40:43]
    v_mfma_f32_16x16x32_bf16 v[44:47], a[92:95], v[116:119], v[44:47]
    s_waitcnt lgkmcnt(2)
    v_mfma_f32_16x16x32_bf16 v[48:51], a[28:31], v[120:123], v[48:51]
    v_mfma_f32_16x16x32_bf16 v[52:55], a[92:95], v[120:123], v[52:55]
    s_waitcnt lgkmcnt(0)
    v_mfma_f32_16x16x32_bf16 v[56:59], a[28:31], v[124:127], v[56:59]
    v_mfma_f32_16x16x32_bf16 v[60:63], a[92:95], v[124:127], v[60:63]
    v_xor_b32 v128, 0x10000, v128
    v_xor_b32 v129, 0x10000, v129
    v_xor_b32 v130, 0x10000, v130
    v_xor_b32 v131, 0x10000, v131
    v_xor_b32 v132, 0x10000, v132
    v_xor_b32 v133, 0x10000, v133
    v_xor_b32 v134, 0x10000, v134
    v_xor_b32 v135, 0x10000, v135
    s_waitcnt vmcnt(16)
    s_barrier
    ds_read_b64_tr_b16 v[64:65], v128
    ds_read_b64_tr_b16 v[66:67], v128 offset:1024
    ds_read_b64_tr_b16 v[68:69], v129
    ds_read_b64_tr_b16 v[70:71], v129 offset:1024
    ds_read_b64_tr_b16 v[72:73], v130
    ds_read_b64_tr_b16 v[74:75], v130 offset:1024
    ds_read_b64_tr_b16 v[76:77], v131
    ds_read_b64_tr_b16 v[78:79], v131 offset:1024
    ds_read_b64_tr_b16 v[80:81], v132
    ds_read_b64_tr_b16 v[82:83], v132 offset:1024
    ds_read_b64_tr_b16 v[84:85], v133
    ds_read_b64_tr_b16 v[86:87], v133 offset:1024
    ds_read_b64_tr_b16 v[88:89], v134
    ds_read_b64_tr_b16 v[90:91], v134 offset:1024
    s_cmp_eq_u32 s40, 0
    s_cbranch_scc1 L_nopf_96
    s_cmp_lg_u32 s87, 0
    s_cbranch_scc1 L_modeok_97
    v_readfirstlane_b32 s96, v140
    v_readfirstlane_b32 s97, v141
    s_nop 0
    s_cmp_lg_u32 s97, 0
    s_cselect_b32 s87, s96, 0
    s_cmp_eq_u32 s87, 1
    s_cbranch_scc1 L_modeok_97
    s_mov_b32 s96, 0
L_mode_98:
    buffer_load_dwordx2 v[140:141], off, s[92:95], 0 offset:36 sc1
    s_waitcnt vmcnt(0)
    v_readfirstlane_b32 s87, v140
    v_readfirstlane_b32 s97, v141
    s_nop 0
    s_min_u32 s97, s97, s87
    s_cmp_lg_u32 s97, 0
    s_cbranch_scc1 L_moded_99
    s_sleep 4
    s_add_u32 s96, s96, 1
    s_cmp_lg_u32 s96, 0x100
    s_cbranch_scc1 L_modef_100
    v_mov_b32 v140, 2
    v_mov_b32 v141, 0
    s_mov_b64 exec, 1
    buffer_atomic_cmpswap v[140:141], off, s[92:95], 0 offset:36
    s_mov_b64 exec, -1
L_modef_100:
    s_cmp_lt_u32 s96, 0x10000
    s_cbranch_scc1 L_mode_98
L_moded_99:
    s_cmp_lg_u32 s87, 1
    s_cbranch_scc1 L_fallback
L_modeok_97:
    s_cmp_lg_u32 s100, 0
    s_cbranch_scc1 L_flag_101
    v_mov_b32 v138, 1
    s_mov_b64 exec, 1
    buffer_store_dword v138, off, s[8:11], s40 sc1
    s_mov_b64 exec, -1
L_flag_101:
    s_mov_b32 s40, 0
L_nopf_96:
    s_waitcnt lgkmcnt(12)
    v_mfma_f32_16x16x32_bf16 v[0:3], a[32:35], v[64:67], v[0:3]
    ds_read_b64_tr_b16 v[92:93], v135
    v_mfma_f32_16x16x32_bf16 v[4:7], a[96:99], v[64:67], v[4:7]
    ds_read_b64_tr_b16 v[94:95], v135 offset:1024
    s_add_u32 s26, s24, 0x100000
    s_add_u32 m0, s29, 0x8000
    s_nop 0
    buffer_load_dwordx4 v136, s[16:19], s26 offen lds
    s_waitcnt lgkmcnt(12)
    v_mfma_f32_16x16x32_bf16 v[8:11], a[32:35], v[68:71], v[8:11]
    ds_read_b64_tr_b16 v[96:97], v128 offset:8192
    v_mfma_f32_16x16x32_bf16 v[12:15], a[96:99], v[68:71], v[12:15]
    ds_read_b64_tr_b16 v[98:99], v128 offset:9216
    s_add_u32 s26, s24, 0x120000
    s_add_u32 m0, s29, 0x9000
    s_nop 0
    buffer_load_dwordx4 v136, s[16:19], s26 offen lds
    s_waitcnt lgkmcnt(12)
    v_mfma_f32_16x16x32_bf16 v[16:19], a[32:35], v[72:75], v[16:19]
    ds_read_b64_tr_b16 v[100:101], v129 offset:8192
    v_mfma_f32_16x16x32_bf16 v[20:23], a[96:99], v[72:75], v[20:23]
    ds_read_b64_tr_b16 v[102:103], v129 offset:9216
    s_add_u32 s26, s24, 0x140000
    s_add_u32 m0, s29, 0xa000
    s_nop 0
    buffer_load_dwordx4 v136, s[16:19], s26 offen lds
    s_waitcnt lgkmcnt(12)
    v_mfma_f32_16x16x32_bf16 v[24:27], a[32:35], v[76:79], v[24:27]
    ds_read_b64_tr_b16 v[104:105], v130 offset:8192
    v_mfma_f32_16x16x32_bf16 v[28:31], a[96:99], v[76:79], v[28:31]
    ds_read_b64_tr_b16 v[106:107], v130 offset:9216
    s_add_u32 s26, s24, 0x160000
    s_add_u32 m0, s29, 0xb000
    s_nop 0
    buffer_load_dwordx4 v136, s[16:19], s26 offen lds
    s_waitcnt lgkmcnt(12)
    v_mfma_f32_16x16x32_bf16 v[32:35], a[32:35], v[80:83], v[32:35]
    ds_read_b64_tr_b16 v[108:109], v131 offset:8192
    v_mfma_f32_16x16x32_bf16 v[36:39], a[96:99], v[80:83], v[36:39]
    ds_read_b64_tr_b16 v[110:111], v131 offset:9216
    s_add_u32 s26, s24, 0x180000
    s_add_u32 m0, s29, 0xc000
    s_nop 0
    buffer_load_dwordx4 v136, s[16:19], s26 offen lds
    s_waitcnt lgkmcnt(12)
    v_mfma_f32_16x16x32_bf16 v[40:43], a[32:35], v[84:87], v[40:43]
    ds_read_b64_tr_b16 v[112:113], v132 offset:8192
    v_mfma_f32_16x16x32_bf16 v[44:47], a[96:99], v[84:87], v[44:47]
    ds_read_b64_tr_b16 v[114:115], v132 offset:9216
    s_add_u32 s26, s24, 0x1a0000
    s_add_u32 m0, s29, 0xd000
    s_nop 0
    buffer_load_dwordx4 v136, s[16:19], s26 offen lds
    s_waitcnt lgkmcnt(12)
    v_mfma_f32_16x16x32_bf16 v[48:51], a[32:35], v[88:91], v[48:51]
    ds_read_b64_tr_b16 v[116:117], v133 offset:8192
    v_mfma_f32_16x16x32_bf16 v[52:55], a[96:99], v[88:91], v[52:55]
    ds_read_b64_tr_b16 v[118:119], v133 offset:9216
    s_add_u32 s26, s24, 0x1c0000
    s_add_u32 m0, s29, 0xe000
    s_nop 0
    buffer_load_dwordx4 v136, s[16:19], s26 offen lds
    s_waitcnt lgkmcnt(12)
    v_mfma_f32_16x16x32_bf16 v[56:59], a[32:35], v[92:95], v[56:59]
    ds_read_b64_tr_b16 v[120:121], v134 offset:8192
    v_mfma_f32_16x16x32_bf16 v[60:63], a[96:99], v[92:95], v[60:63]
    ds_read_b64_tr_b16 v[122:123], v134 offset:9216
    s_add_u32 s26, s24, 0x1e0000
    s_add_u32 m0, s29, 0xf000
    s_nop 0
    buffer_load_dwordx4 v136, s[16:19], s26 offen lds
    s_waitcnt lgkmcnt(12)
    v_mfma_f32_16x16x32_bf16 v[0:3], a[36:39], v[96:99], v[0:3]
    ds_read_b64_tr_b16 v[124:125], v135 offset:8192
    v_mfma_f32_16x16x32_bf16 v[4:7], a[100:103], v[96:99], v[4:7]
    ds_read_b64_tr_b16 v[126:127], v135 offset:9216
    s_waitcnt lgkmcnt(12)
    v_mfma_f32_16x16x32_bf16 v[8:11], a[36:39], v[100:103], v[8:11]
    ds_read_b64_tr_b16 v[64:65], v128 offset:16384
    v_mfma_f32_16x16x32_bf16 v[12:15], a[100:103], v[100:103], v[12:15]
    ds_read_b64_tr_b16 v[66:67], v128 offset:17408
    s_waitcnt lgkmcnt(12)
    v_mfma_f32_16x16x32_bf16 v[16:19], a[36:39], v[104:107], v[16:19]
    ds_read_b64_tr_b16 v[68:69], v129 offset:16384
    v_mfma_f32_16x16x32_bf16 v[20:23], a[100:103], v[104:107], v[20:23]
    ds_read_b64_tr_b16 v[70:71], v129 offset:17408
    s_waitcnt lgkmcnt(12)
    v_mfma_f32_16x16x32_bf16 v[24:27], a[36:39], v[108:111], v[24:27]
    ds_read_b64_tr_b16 v[72:73], v130 offset:16384
    v_mfma_f32_16x16x32_bf16 v[28:31], a[100:103], v[108:111], v[28:31]
    ds_read_b64_tr_b16 v[74:75], v130 offset:17408
    s_waitcnt lgkmcnt(12)
    v_mfma_f32_16x16x32_bf16 v[32:35], a[36:39], v[112:115], v[32:35]
    ds_read_b64_tr_b16 v[76:77], v131 offset:16384
    v_mfma_f32_16x16x32_bf16 v[36:39], a[100:103], v[112:115], v[36:39]
    ds_read_b64_tr_b16 v[78:79], v131 offset:17408
    s_waitcnt lgkmcnt(12)
    v_mfma_f32_16x16x32_bf16 v[40:43], a[36:39], v[116:119], v[40:43]
    ds_read_b64_tr_b16 v[80:81], v132 offset:16384
    v_mfma_f32_16x16x32_bf16 v[44:47], a[100:103], v[116:119], v[44:47]
    ds_read_b64_tr_b16 v[82:83], v132 offset:17408
    s_waitcnt lgkmcnt(12)
    v_mfma_f32_16x16x32_bf16 v[48:51], a[36:39], v[120:123], v[48:51]
    ds_read_b64_tr_b16 v[84:85], v133 offset:16384
    v_mfma_f32_16x16x32_bf16 v[52:55], a[100:103], v[120:123], v[52:55]
    ds_read_b64_tr_b16 v[86:87], v133 offset:17408
    s_waitcnt lgkmcnt(12)
    v_mfma_f32_16x16x32_bf16 v[56:59], a[36:39], v[124:127], v[56:59]
    ds_read_b64_tr_b16 v[88:89], v134 offset:16384
    v_mfma_f32_16x16x32_bf16 v[60:63], a[100:103], v[124:127], v[60:63]
    ds_read_b64_tr_b16 v[90:91], v134 offset:17408
    s_waitcnt lgkmcnt(12)
    v_mfma_f32_16x16x32_bf16 v[0:3], a[40:43], v[64:67], v[0:3]
    ds_read_b64_tr_b16 v[92:93], v135 offset:16384
    v_mfma_f32_16x16x32_bf16 v[4:7], a[104:107], v[64:67], v[4:7]
    ds_read_b64_tr_b16 v[94:95], v135 offset:17408
    s_waitcnt lgkmcnt(12)
    v_mfma_f32_16x16x32_bf16 v[8:11], a[40:43], v[68:71], v[8:11]
    ds_read_b64_tr_b16 v[96:97], v128 offset:24576
    v_mfma_f32_16x16x32_bf16 v[12:15], a[104:107], v[68:71], v[12:15]
    ds_read_b64_tr_b16 v[98:99], v128 offset:25600
    s_waitcnt lgkmcnt(12)
    v_mfma_f32_16x16x32_bf16 v[16:19], a[40:43], v[72:75], v[16:19]
    ds_read_b64_tr_b16 v[100:101], v129 offset:24576
    v_mfma_f32_16x16x32_bf16 v[20:23], a[104:107], v[72:75], v[20:23]
    ds_read_b64_tr_b16 v[102:103], v129 offset:25600
    s_waitcnt lgkmcnt(12)
    v_mfma_f32_16x16x32_bf16 v[24:27], a[40:43], v[76:79], v[24:27]
    ds_read_b64_tr_b16 v[104:105], v130 offset:24576
    v_mfma_f32_16x16x32_bf16 v[28:31], a[104:107], v[76:79], v[28:31]
    ds_read_b64_tr_b16 v[106:107], v130 offset:25600
    s_waitcnt lgkmcnt(12)
    v_mfma_f32_16x16x32_bf16 v[32:35], a[40:43], v[80:83], v[32:35]
    ds_read_b64_tr_b16 v[108:109], v131 offset:24576
    v_mfma_f32_16x16x32_bf16 v[36:39], a[104:107], v[80:83], v[36:39]
    ds_read_b64_tr_b16 v[110:111], v131 offset:25600
    s_waitcnt lgkmcnt(12)
    v_mfma_f32_16x16x32_bf16 v[40:43], a[40:43], v[84:87], v[40:43]
    ds_read_b64_tr_b16 v[112:113], v132 offset:24576
    v_mfma_f32_16x16x32_bf16 v[44:47], a[104:107], v[84:87], v[44:47]
    ds_read_b64_tr_b16 v[114:115], v132 offset:25600
    s_waitcnt lgkmcnt(12)
    v_mfma_f32_16x16x32_bf16 v[48:51], a[40:43], v[88:91], v[48:51]
    ds_read_b64_tr_b16 v[116:117], v133 offset:24576
    v_mfma_f32_16x16x32_bf16 v[52:55], a[104:107], v[88:91], v[52:55]
    ds_read_b64_tr_b16 v[118:119], v133 offset:25600
    s_waitcnt lgkmcnt(12)
    v_mfma_f32_16x16x32_bf16 v[56:59], a[40:43], v[92:95], v[56:59]
    ds_read_b64_tr_b16 v[120:121], v134 offset:24576
    v_mfma_f32_16x16x32_bf16 v[60:63], a[104:107], v[92:95], v[60:63]
    ds_read_b64_tr_b16 v[122:123], v134 offset:25600
    s_waitcnt lgkmcnt(12)
    v_mfma_f32_16x16x32_bf16 v[0:3], a[44:47], v[96:99], v[0:3]
    ds_read_b64_tr_b16 v[124:125], v135 offset:24576
    v_mfma_f32_16x16x32_bf16 v[4:7], a[108:111], v[96:99], v[4:7]
    ds_read_b64_tr_b16 v[126:127], v135 offset:25600
    s_waitcnt lgkmcnt(12)
    v_mfma_f32_16x16x32_bf16 v[8:11], a[44:47], v[100:103], v[8:11]
    v_mfma_f32_16x16x32_bf16 v[12:15], a[108:111], v[100:103], v[12:15]
    s_waitcnt lgkmcnt(10)
    v_mfma_f32_16x16x32_bf16 v[16:19], a[44:47], v[104:107], v[16:19]
    v_mfma_f32_16x16x32_bf16 v[20:23], a[108:111], v[104:107], v[20:23]
    s_waitcnt lgkmcnt(8)
    v_mfma_f32_16x16x32_bf16 v[24:27], a[44:47], v[108:111], v[24:27]
    v_mfma_f32_16x16x32_bf16 v[28:31], a[108:111], v[108:111], v[28:31]
    s_waitcnt lgkmcnt(6)
    v_mfma_f32_16x16x32_bf16 v[32:35], a[44:47], v[112:115], v[32:35]
    v_mfma_f32_16x16x32_bf16 v[36:39], a[108:111], v[112:115], v[36:39]
    s_waitcnt lgkmcnt(4)
    v_mfma_f32_16x16x32_bf16 v[40:43], a[44:47], v[116:119], v[40:43]
    v_mfma_f32_16x16x32_bf16 v[44:47], a[108:111], v[116:119], v[44:47]
    s_waitcnt lgkmcnt(2)
    v_mfma_f32_16x16x32_bf16 v[48:51], a[44:47], v[120:123], v[48:51]
    v_mfma_f32_16x16x32_bf16 v[52:55], a[108:111], v[120:123], v[52:55]
    s_waitcnt lgkmcnt(0)
    v_mfma_f32_16x16x32_bf16 v[56:59], a[44:47], v[124:127], v[56:59]
    v_mfma_f32_16x16x32_bf16 v[60:63], a[108:111], v[124:127], v[60:63]
    s_waitcnt vmcnt(16)
    s_barrier
    ds_read_b64_tr_b16 v[64:65], v128 offset:32768
    ds_read_b64_tr_b16 v[66:67], v128 offset:33792
    ds_read_b64_tr_b16 v[68:69], v129 offset:32768
    ds_read_b64_tr_b16 v[70:71], v129 offset:33792
    ds_read_b64_tr_b16 v[72:73], v130 offset:32768
    ds_read_b64_tr_b16 v[74:75], v130 offset:33792
    ds_read_b64_tr_b16 v[76:77], v131 offset:32768
    ds_read_b64_tr_b16 v[78:79], v131 offset:33792
    ds_read_b64_tr_b16 v[80:81], v132 offset:32768
    ds_read_b64_tr_b16 v[82:83], v132 offset:33792
    ds_read_b64_tr_b16 v[84:85], v133 offset:32768
    ds_read_b64_tr_b16 v[86:87], v133 offset:33792
    ds_read_b64_tr_b16 v[88:89], v134 offset:32768
    ds_read_b64_tr_b16 v[90:91], v134 offset:33792
    s_waitcnt lgkmcnt(12)
    v_mfma_f32_16x16x32_bf16 v[0:3], a[48:51], v[64:67], v[0:3]
    ds_read_b64_tr_b16 v[92:93], v135 offset:32768
    v_mfma_f32_16x16x32_bf16 v[4:7], a[112:115], v[64:67], v[4:7]
    ds_read_b64_tr_b16 v[94:95], v135 offset:33792
    s_add_u32 s26, s24, 0x200000
    s_add_u32 m0, s29, 0x10000
    s_nop 0
    buffer_load_dwordx4 v136, s[16:19], s26 offen lds
    s_waitcnt lgkmcnt(12)
    v_mfma_f32_16x16x32_bf16 v[8:11], a[48:51], v[68:71], v[8:11]
    ds_read_b64_tr_b16 v[96:97], v128 offset:40960
    v_mfma_f32_16x16x32_bf16 v[12:15], a[112:115], v[68:71], v[12:15]
    ds_read_b64_tr_b16 v[98:99], v128 offset:41984
    s_add_u32 s26, s24, 0x220000
    s_add_u32 m0, s29, 0x11000
    s_nop 0
    buffer_load_dwordx4 v136, s[16:19], s26 offen lds
    s_waitcnt lgkmcnt(12)
    v_mfma_f32_16x16x32_bf16 v[16:19], a[48:51], v[72:75], v[16:19]
    ds_read_b64_tr_b16 v[100:101], v129 offset:40960
    v_mfma_f32_16x16x32_bf16 v[20:23], a[112:115], v[72:75], v[20:23]
    ds_read_b64_tr_b16 v[102:103], v129 offset:41984
    s_add_u32 s26, s24, 0x240000
    s_add_u32 m0, s29, 0x12000
    s_nop 0
    buffer_load_dwordx4 v136, s[16:19], s26 offen lds
    s_waitcnt lgkmcnt(12)
    v_mfma_f32_16x16x32_bf16 v[24:27], a[48:51], v[76:79], v[24:27]
    ds_read_b64_tr_b16 v[104:105], v130 offset:40960
    v_mfma_f32_16x16x32_bf16 v[28:31], a[112:115], v[76:79], v[28:31]
    ds_read_b64_tr_b16 v[106:107], v130 offset:41984
    s_add_u32 s26, s24, 0x260000
    s_add_u32 m0, s29, 0x13000
    s_nop 0
    buffer_load_dwordx4 v136, s[16:19], s26 offen lds
    s_waitcnt lgkmcnt(12)
    v_mfma_f32_16x16x32_bf16 v[32:35], a[48:51], v[80:83], v[32:35]
    ds_read_b64_tr_b16 v[108:109], v131 offset:40960
    v_mfma_f32_16x16x32_bf16 v[36:39], a[112:115], v[80:83], v[36:39]
    ds_read_b64_tr_b16 v[110:111], v131 offset:41984
    s_add_u32 s26, s24, 0x280000
    s_add_u32 m0, s29, 0x14000
    s_nop 0
    buffer_load_dwordx4 v136, s[16:19], s26 offen lds
    s_waitcnt lgkmcnt(12)
    v_mfma_f32_16x16x32_bf16 v[40:43], a[48:51], v[84:87], v[40:43]
    ds_read_b64_tr_b16 v[112:113], v132 offset:40960
    v_mfma_f32_16x16x32_bf16 v[44:47], a[112:115], v[84:87], v[44:47]
    ds_read_b64_tr_b16 v[114:115], v132 offset:41984
    s_add_u32 s26, s24, 0x2a0000
    s_add_u32 m0, s29, 0x15000
    s_nop 0
    buffer_load_dwordx4 v136, s[16:19], s26 offen lds
    s_waitcnt lgkmcnt(12)
    v_mfma_f32_16x16x32_bf16 v[48:51], a[48:51], v[88:91], v[48:51]
    ds_read_b64_tr_b16 v[116:117], v133 offset:40960
    v_mfma_f32_16x16x32_bf16 v[52:55], a[112:115], v[88:91], v[52:55]
    ds_read_b64_tr_b16 v[118:119], v133 offset:41984
    s_add_u32 s26, s24, 0x2c0000
    s_add_u32 m0, s29, 0x16000
    s_nop 0
    buffer_load_dwordx4 v136, s[16:19], s26 offen lds
    s_waitcnt lgkmcnt(12)
    v_mfma_f32_16x16x32_bf16 v[56:59], a[48:51], v[92:95], v[56:59]
    ds_read_b64_tr_b16 v[120:121], v134 offset:40960
    v_mfma_f32_16x16x32_bf16 v[60:63], a[112:115], v[92:95], v[60:63]
    ds_read_b64_tr_b16 v[122:123], v134 offset:41984
    s_add_u32 s26, s24, 0x2e0000
    s_add_u32 m0, s29, 0x17000
    s_nop 0
    buffer_load_dwordx4 v136, s[16:19], s26 offen lds
    s_waitcnt lgkmcnt(12)
    v_mfma_f32_16x16x32_bf16 v[0:3], a[52:55], v[96:99], v[0:3]
    ds_read_b64_tr_b16 v[124:125], v135 offset:40960
    v_mfma_f32_16x16x32_bf16 v[4:7], a[116:119], v[96:99], v[4:7]
    ds_read_b64_tr_b16 v[126:127], v135 offset:41984
    s_waitcnt lgkmcnt(12)
    v_mfma_f32_16x16x32_bf16 v[8:11], a[52:55], v[100:103], v[8:11]
    ds_read_b64_tr_b16 v[64:65], v128 offset:49152
    v_mfma_f32_16x16x32_bf16 v[12:15], a[116:119], v[100:103], v[12:15]
    ds_read_b64_tr_b16 v[66:67], v128 offset:50176
    s_waitcnt lgkmcnt(12)
    v_mfma_f32_16x16x32_bf16 v[16:19], a[52:55], v[104:107], v[16:19]
    ds_read_b64_tr_b16 v[68:69], v129 offset:49152
    v_mfma_f32_16x16x32_bf16 v[20:23], a[116:119], v[104:107], v[20:23]
    ds_read_b64_tr_b16 v[70:71], v129 offset:50176
    s_waitcnt lgkmcnt(12)
    v_mfma_f32_16x16x32_bf16 v[24:27], a[52:55], v[108:111], v[24:27]
    ds_read_b64_tr_b16 v[72:73], v130 offset:49152
    v_mfma_f32_16x16x32_bf16 v[28:31], a[116:119], v[108:111], v[28:31]
    ds_read_b64_tr_b16 v[74:75], v130 offset:50176
    s_waitcnt lgkmcnt(12)
    v_mfma_f32_16x16x32_bf16 v[32:35], a[52:55], v[112:115], v[32:35]
    ds_read_b64_tr_b16 v[76:77], v131 offset:49152
    v_mfma_f32_16x16x32_bf16 v[36:39], a[116:119], v[112:115], v[36:39]
    ds_read_b64_tr_b16 v[78:79], v131 offset:50176
    s_waitcnt lgkmcnt(12)
    v_mfma_f32_16x16x32_bf16 v[40:43], a[52:55], v[116:119], v[40:43]
    ds_read_b64_tr_b16 v[80:81], v132 offset:49152
    v_mfma_f32_16x16x32_bf16 v[44:47], a[116:119], v[116:119], v[44:47]
    ds_read_b64_tr_b16 v[82:83], v132 offset:50176
    s_waitcnt lgkmcnt(12)
    v_mfma_f32_16x16x32_bf16 v[48:51], a[52:55], v[120:123], v[48:51]
    ds_read_b64_tr_b16 v[84:85], v133 offset:49152
    v_mfma_f32_16x16x32_bf16 v[52:55], a[116:119], v[120:123], v[52:55]
    ds_read_b64_tr_b16 v[86:87], v133 offset:50176
    s_waitcnt lgkmcnt(12)
    v_mfma_f32_16x16x32_bf16 v[56:59], a[52:55], v[124:127], v[56:59]
    ds_read_b64_tr_b16 v[88:89], v134 offset:49152
    v_mfma_f32_16x16x32_bf16 v[60:63], a[116:119], v[124:127], v[60:63]
    ds_read_b64_tr_b16 v[90:91], v134 offset:50176
    s_waitcnt lgkmcnt(12)
    v_mfma_f32_16x16x32_bf16 v[0:3], a[56:59], v[64:67], v[0:3]
    ds_read_b64_tr_b16 v[92:93], v135 offset:49152
    v_mfma_f32_16x16x32_bf16 v[4:7], a[120:123], v[64:67], v[4:7]
    ds_read_b64_tr_b16 v[94:95], v135 offset:50176
    s_waitcnt lgkmcnt(12)
    v_mfma_f32_16x16x32_bf16 v[8:11], a[56:59], v[68:71], v[8:11]
    ds_read_b64_tr_b16 v[96:97], v128 offset:57344
    v_mfma_f32_16x16x32_bf16 v[12:15], a[120:123], v[68:71], v[12:15]
    ds_read_b64_tr_b16 v[98:99], v128 offset:58368
    s_waitcnt lgkmcnt(12)
    v_mfma_f32_16x16x32_bf16 v[16:19], a[56:59], v[72:75], v[16:19]
    ds_read_b64_tr_b16 v[100:101], v129 offset:57344
    v_mfma_f32_16x16x32_bf16 v[20:23], a[120:123], v[72:75], v[20:23]
    ds_read_b64_tr_b16 v[102:103], v129 offset:58368
    s_waitcnt lgkmcnt(12)
    v_mfma_f32_16x16x32_bf16 v[24:27], a[56:59], v[76:79], v[24:27]
    ds_read_b64_tr_b16 v[104:105], v130 offset:57344
    v_mfma_f32_16x16x32_bf16 v[28:31], a[120:123], v[76:79], v[28:31]
    ds_read_b64_tr_b16 v[106:107], v130 offset:58368
    s_waitcnt lgkmcnt(12)
    v_mfma_f32_16x16x32_bf16 v[32:35], a[56:59], v[80:83], v[32:35]
    ds_read_b64_tr_b16 v[108:109], v131 offset:57344
    v_mfma_f32_16x16x32_bf16 v[36:39], a[120:123], v[80:83], v[36:39]
    ds_read_b64_tr_b16 v[110:111], v131 offset:58368
    s_waitcnt lgkmcnt(12)
    v_mfma_f32_16x16x32_bf16 v[40:43], a[56:59], v[84:87], v[40:43]
    ds_read_b64_tr_b16 v[112:113], v132 offset:57344
    v_mfma_f32_16x16x32_bf16 v[44:47], a[120:123], v[84:87], v[44:47]
    ds_read_b64_tr_b16 v[114:115], v132 offset:58368
    s_waitcnt lgkmcnt(12)
    v_mfma_f32_16x16x32_bf16 v[48:51], a[56:59], v[88:91], v[48:51]
    ds_read_b64_tr_b16 v[116:117], v133 offset:57344
    v_mfma_f32_16x16x32_bf16 v[52:55], a[120:123], v[88:91], v[52:55]
    ds_read_b64_tr_b16 v[118:119], v133 offset:58368
    s_waitcnt lgkmcnt(12)
    v_mfma_f32_16x16x32_bf16 v[56:59], a[56:59], v[92:95], v[56:59]
    ds_read_b64_tr_b16 v[120:121], v134 offset:57344
    v_mfma_f32_16x16x32_bf16 v[60:63], a[120:123], v[92:95], v[60:63]
    ds_read_b64_tr_b16 v[122:123], v134 offset:58368
    s_waitcnt lgkmcnt(12)
    v_mfma_f32_16x16x32_bf16 v[0:3], a[60:63], v[96:99], v[0:3]
    ds_read_b64_tr_b16 v[124:125], v135 offset:57344
    v_mfma_f32_16x16x32_bf16 v[4:7], a[124:127], v[96:99], v[4:7]
    ds_read_b64_tr_b16 v[126:127], v135 offset:58368
    s_waitcnt lgkmcnt(12)
    v_mfma_f32_16x16x32_bf16 v[8:11], a[60:63], v[100:103], v[8:11]
    v_mfma_f32_16x16x32_bf16 v[12:15], a[124:127], v[100:103], v[12:15]
    s_waitcnt lgkmcnt(10)
    v_mfma_f32_16x16x32_bf16 v[16:19], a[60:63], v[104:107], v[16:19]
    v_mfma_f32_16x16x32_bf16 v[20:23], a[124:127], v[104:107], v[20:23]
    s_waitcnt lgkmcnt(8)
    v_mfma_f32_16x16x32_bf16 v[24:27], a[60:63], v[108:111], v[24:27]
    v_mfma_f32_16x16x32_bf16 v[28:31], a[124:127], v[108:111], v[28:31]
    s_waitcnt lgkmcnt(6)
    v_mfma_f32_16x16x32_bf16 v[32:35], a[60:63], v[112:115], v[32:35]
    v_mfma_f32_16x16x32_bf16 v[36:39], a[124:127], v[112:115], v[36:39]
    s_waitcnt lgkmcnt(4)
    v_mfma_f32_16x16x32_bf16 v[40:43], a[60:63], v[116:119], v[40:43]
    v_mfma_f32_16x16x32_bf16 v[44:47], a[124:127], v[116:119], v[44:47]
    s_waitcnt lgkmcnt(2)
    v_mfma_f32_16x16x32_bf16 v[48:51], a[60:63], v[120:123], v[48:51]
    v_mfma_f32_16x16x32_bf16 v[52:55], a[124:127], v[120:123], v[52:55]
    s_waitcnt lgkmcnt(0)
    v_mfma_f32_16x16x32_bf16 v[56:59], a[60:63], v[124:127], v[56:59]
    v_mfma_f32_16x16x32_bf16 v[60:63], a[124:127], v[124:127], v[60:63]
    v_xor_b32 v128, 0x10000, v128
    v_xor_b32 v129, 0x10000, v129
    v_xor_b32 v130, 0x10000, v130
    v_xor_b32 v131, 0x10000, v131
    v_xor_b32 v132, 0x10000, v132
    v_xor_b32 v133, 0x10000, v133
    v_xor_b32 v134, 0x10000, v134
    v_xor_b32 v135, 0x10000, v135
    v_cvt_pk_bf16_f32 v144, v0, v1
    v_cvt_pk_bf16_f32 v145, v2, v3
    v_cvt_pk_bf16_f32 v146, v4, v5
    v_cvt_pk_bf16_f32 v147, v6, v7
    buffer_store_dwordx4 v[144:147], v137, s[8:11], s25 offen sc1
    v_cvt_pk_bf16_f32 v148, v8, v9
    v_cvt_pk_bf16_f32 v149, v10, v11
    v_cvt_pk_bf16_f32 v150, v12, v13
    v_cvt_pk_bf16_f32 v151, v14, v15
    buffer_store_dwordx4 v[148:151], v137, s[8:11], s25 offen offset:1024 sc1
    v_cvt_pk_bf16_f32 v152, v16, v17
    v_cvt_pk_bf16_f32 v153, v18, v19
    v_cvt_pk_bf16_f32 v154, v20, v21
    v_cvt_pk_bf16_f32 v155, v22, v23
    buffer_store_dwordx4 v[152:155], v137, s[8:11], s25 offen offset:2048 sc1
    v_cvt_pk_bf16_f32 v156, v24, v25
    v_cvt_pk_bf16_f32 v157, v26, v27
    v_cvt_pk_bf16_f32 v158, v28, v29
    v_cvt_pk_bf16_f32 v159, v30, v31
    buffer_store_dwordx4 v[156:159], v137, s[8:11], s25 offen offset:3072 sc1
    v_cvt_pk_bf16_f32 v144, v32, v33
    v_cvt_pk_bf16_f32 v145, v34, v35
    v_cvt_pk_bf16_f32 v146, v36, v37
    v_cvt_pk_bf16_f32 v147, v38, v39
    s_add_u32 s25, s25, 4096
    buffer_store_dwordx4 v[144:147], v137, s[8:11], s25 offen sc1
    v_cvt_pk_bf16_f32 v148, v40, v41
    v_cvt_pk_bf16_f32 v149, v42, v43
    v_cvt_pk_bf16_f32 v150, v44, v45
    v_cvt_pk_bf16_f32 v151, v46, v47
    buffer_store_dwordx4 v[148:151], v137, s[8:11], s25 offen offset:1024 sc1
    v_cvt_pk_bf16_f32 v152, v48, v49
    v_cvt_pk_bf16_f32 v153, v50, v51
    v_cvt_pk_bf16_f32 v154, v52, v53
    v_cvt_pk_bf16_f32 v155, v54, v55
    buffer_store_dwordx4 v[152:155], v137, s[8:11], s25 offen offset:2048 sc1
    v_cvt_pk_bf16_f32 v156, v56, v57
    v_cvt_pk_bf16_f32 v157, v58, v59
    v_cvt_pk_bf16_f32 v158, v60, v61
    v_cvt_pk_bf16_f32 v159, v62, v63
    buffer_store_dwordx4 v[156:159], v137, s[8:11], s25 offen offset:3072 sc1
    s_cmp_lg_u32 s20, 15
    s_cbranch_scc1 L_p1_next
    v_mov_b32 v0, -1
    v_mov_b32 v1, -1
    v_mov_b32 v2, -1
    v_mov_b32 v3, -1
    s_sub_u32 s26, s25, 0x2001000
    s_lshr_b32 s26, s26, 1
    s_add_u32 s26, s26, 0x240000
    buffer_store_dwordx4 v[0:3], v137, s[8:11], s26 offen sc1
    buffer_store_dwordx4 v[0:3], v137, s[8:11], s26 offen offset:1024 sc1
    buffer_store_dwordx4 v[0:3], v137, s[8:11], s26 offen offset:2048 sc1
    buffer_store_dwordx4 v[0:3], v137, s[8:11], s26 offen offset:3072 sc1
    s_nop 1
L_p1_next:
    s_add_u32 s80, s80, 1
    s_lshl_b32 s40, s38, 4
    s_add_u32 s40, s40, s20
    s_lshl_b32 s40, s40, 2
    s_add_u32 s40, s40, 0x2000
    s_sub_u32 s44, s25, 4095
    s_add_u32 s38, s38, s37
    s_branch L_p1_unit
L_p1_end:
    s_waitcnt vmcnt(0)
    s_barrier
    s_cmp_eq_u32 s40, 0
    s_cbranch_scc1 L_nopf_102
    s_cmp_lg_u32 s87, 0
    s_cbranch_scc1 L_modeok_103
    v_readfirstlane_b32 s96, v140
    v_readfirstlane_b32 s97, v141
    s_nop 0
    s_cmp_lg_u32 s97, 0
    s_cselect_b32 s87, s96, 0
    s_cmp_eq_u32 s87, 1
    s_cbranch_scc1 L_modeok_103
    s_mov_b32 s96, 0
L_mode_104:
    buffer_load_dwordx2 v[140:141], off, s[92:95], 0 offset:36 sc1
    s_waitcnt vmcnt(0)
    v_readfirstlane_b32 s87, v140
    v_readfirstlane_b32 s97, v141
    s_nop 0
    s_min_u32 s97, s97, s87
    s_cmp_lg_u32 s97, 0
    s_cbranch_scc1 L_moded_105
    s_sleep 4
    s_add_u32 s96, s96, 1
    s_cmp_lg_u32 s96, 0x100
    s_cbranch_scc1 L_modef_106
    v_mov_b32 v140, 2
    v_mov_b32 v141, 0
    s_mov_b64 exec, 1
    buffer_atomic_cmpswap v[140:141], off, s[92:95], 0 offset:36
    s_mov_b64 exec, -1
L_modef_106:
    s_cmp_lt_u32 s96, 0x10000
    s_cbranch_scc1 L_mode_104
L_moded_105:
    s_cmp_lg_u32 s87, 1
    s_cbranch_scc1 L_fallback
L_modeok_103:
    s_cmp_lg_u32 s100, 0
    s_cbranch_scc1 L_flag_107
    v_mov_b32 v138, 1
    s_mov_b64 exec, 1
    buffer_store_dword v138, off, s[8:11], s40 sc1
    s_mov_b64 exec, -1
L_flag_107:
    s_mov_b32 s40, 0
L_nopf_102:
    s_cmp_lg_u32 s41, 0
    s_cbranch_scc1 L_p1done
    s_mov_b32 s41, 1
    s_mul_i32 s22, s101, 171
    s_lshr_b32 s22, s22, 11
    s_mul_i32 s26, s22, 12
    s_sub_u32 s20, s101, s26
    s_add_u32 s20, s20, 4
    s_mul_i32 s27, s101, 683
    s_lshr_b32 s27, s27, 11
    s_mul_i32 s26, s27, 3
    s_sub_u32 s26, s101, s26
    s_cmp_eq_u32 s26, 2
    s_cselect_b32 s28, 10, 11
    s_cmp_ge_u32 s101, 192
    s_cselect_b32 s20, s26, s20
    s_cselect_b32 s22, s27, s22
    s_cselect_b32 s37, s28, 16
    s_branch L_p1_pass
L_p1done:
    v_mbcnt_lo_u32_b32 v0, -1, 0
    v_mbcnt_hi_u32_b32 v0, -1, v0
    s_lshl_b32 s96, s100, 6
    v_add_u32 v0, s96, v0
    s_and_b32 s20, s101, 15
    s_lshr_b32 s22, s101, 4
    s_mov_b32 s23, 14
    v_mov_b32 v1, 0
    s_lshl_b32 s24, s20, 7
    s_add_u32 s24, s24, 0x1000
    s_mul_i32 s25, s22, 14
    s_lshr_b32 s25, s25, 4
    s_add_u32 s25, s25, 12
    s_cmp_lg_u32 s100, 0
    s_cbranch_scc1 L_polls_110
    s_mov_b32 exec_lo, 0x1
    s_mov_b32 exec_hi, 0
    s_mov_b32 s96, 0
L_poll_108:
    buffer_load_dword v2, v1, s[8:11], s24 offen sc1
    s_waitcnt vmcnt(0)
    v_cmp_gt_u32 vcc, s25, v2
    s_cbranch_vccz L_polld_109
    v_readfirstlane_b32 s97, v2
    s_nop 0
    s_sub_u32 s97, s25, s97
    s_cmp_lt_i32 s97, 3
    s_cbranch_scc1 L_near_111
    s_sleep 40
    s_cmp_lt_i32 s97, 5
    s_cbranch_scc1 L_near_111
    s_sleep 100
L_near_111:
    s_sleep 4
    s_add_u32 s96, s96, 1
    s_cmp_lt_u32 s96, 0x10000
    s_cbranch_scc1 L_poll_108
L_polld_109:
    s_mov_b64 exec, -1
L_polls_110:
    s_barrier
    s_load_dwordx2 s[12:13], s[0:1], 40
    s_waitcnt lgkmcnt(0)
    s_and_b32 s13, s13, 0xffff
    s_mov_b32 s14, 0x400000
    s_mov_b32 s15, 0x20000
    v_lshrrev_b32 v4, 6, v0
    s_nop 0
    v_readfirstlane_b32 s21, v4
    v_and_b32 v1, 63, v0
    v_lshrrev_b32 v2, 4, v1
    v_and_b32 v3, 15, v1
    v_lshrrev_b32 v6, 2, v3
    v_lshlrev_b32 v240, 4, v1
    v_lshlrev_b32 v241, 3, v1
    s_lshl_b32 s27, s21, 10
    s_lshl_b32 s24, s21, 5
    v_xor_b32 v4, s24, v240
    v_add_u32 v8, s27, v4
    v_xor_b32 v9, 128, v8
    v_lshl_add_u32 v4, v2, 2, v6
    v_and_b32 v5, 7, v4
    v_lshlrev_b32 v4, 10, v4
    v_lshl_add_u32 v4, v5, 5, v4
    v_and_b32 v5, 3, v3
    v_lshlrev_b32 v5, 4, v5
    v_xor_b32 v4, v5, v4
    s_lshl_b32 s24, s21, 8
    v_add_u32 v10, s24, v4
    s_lshl_b32 s25, s20, 18
    s_add_u32 s24, s25, 0x0
    s_add_u32 m0, s27, 0x0
    s_nop 0
    buffer_load_dwordx4 v8, s[12:15], s24 offen lds
    s_add_u32 s24, s25, 0x1000
    s_add_u32 m0, s27, 0x1000
    s_nop 0
    buffer_load_dwordx4 v9, s[12:15], s24 offen lds
    s_add_u32 s24, s25, 0x2000
    s_add_u32 m0, s27, 0x2000
    s_nop 0
    buffer_load_dwordx4 v8, s[12:15], s24 offen lds
    s_add_u32 s24, s25, 0x3000
    s_add_u32 m0, s27, 0x3000
    s_nop 0
    buffer_load_dwordx4 v9, s[12:15], s24 offen lds
    s_add_u32 s24, s25, 0x4000
    s_add_u32 m0, s27, 0x4000
    s_nop 0
    buffer_load_dwordx4 v8, s[12:15], s24 offen lds
    s_add_u32 s24, s25, 0x5000
    s_add_u32 m0, s27, 0x5000
    s_nop 0
    buffer_load_dwordx4 v9, s[12:15], s24 offen lds
    s_add_u32 s24, s25, 0x6000
    s_add_u32 m0, s27, 0x6000
    s_nop 0
    buffer_load_dwordx4 v8, s[12:15], s24 offen lds
    s_add_u32 s24, s25, 0x7000
    s_add_u32 m0, s27, 0x7000
    s_nop 0
    buffer_load_dwordx4 v9, s[12:15], s24 offen lds
    s_add_u32 s24, s25, 0x8000
    s_add_u32 m0, s27, 0x8000
    s_nop 0
    buffer_load_dwordx4 v8, s[12:15], s24 offen lds
    s_add_u32 s24, s25, 0x9000
    s_add_u32 m0, s27, 0x9000
    s_nop 0
    buffer_load_dwordx4 v9, s[12:15], s24 offen lds
    s_add_u32 s24, s25, 0xa000
    s_add_u32 m0, s27, 0xa000
    s_nop 0
    buffer_load_dwordx4 v8, s[12:15], s24 offen lds
    s_add_u32 s24, s25, 0xb000
    s_add_u32 m0, s27, 0xb000
    s_nop 0
    buffer_load_dwordx4 v9, s[12:15], s24 offen lds
    s_add_u32 s24, s25, 0xc000
    s_add_u32 m0, s27, 0xc000
    s_nop 0
    buffer_load_dwordx4 v8, s[12:15], s24 offen lds
    s_add_u32 s24, s25, 0xd000
    s_add_u32 m0, s27, 0xd000
    s_nop 0
    buffer_load_dwordx4 v9, s[12:15], s24 offen lds
    s_add_u32 s24, s25, 0xe000
    s_add_u32 m0, s27, 0xe000
    s_nop 0
    buffer_load_dwordx4 v8, s[12:15], s24 offen lds
    s_add_u32 s24, s25, 0xf000
    s_add_u32 m0, s27, 0xf000
    s_nop 0
    buffer_load_dwordx4 v9, s[12:15], s24 offen lds
    s_add_u32 s24, s25, 0x10000
    s_add_u32 m0, s27, 0x10000
    s_nop 0
    buffer_load_dwordx4 v8, s[12:15], s24 offen lds
    s_add_u32 s24, s25, 0x11000
    s_add_u32 m0, s27, 0x11000
    s_nop 0
    buffer_load_dwordx4 v9, s[12:15], s24 offen lds
    s_add_u32 s24, s25, 0x12000
    s_add_u32 m0, s27, 0x12000
    s_nop 0
    buffer_load_dwordx4 v8, s[12:15], s24 offen lds
    s_add_u32 s24, s25, 0x13000
    s_add_u32 m0, s27, 0x13000
    s_nop 0
    buffer_load_dwordx4 v9, s[12:15], s24 offen lds
    s_add_u32 s24, s25, 0x14000
    s_add_u32 m0, s27, 0x14000
    s_nop 0
    buffer_load_dwordx4 v8, s[12:15], s24 offen lds
    s_add_u32 s24, s25, 0x15000
    s_add_u32 m0, s27, 0x15000
    s_nop 0
    buffer_load_dwordx4 v9, s[12:15], s24 offen lds
    s_add_u32 s24, s25, 0x16000
    s_add_u32 m0, s27, 0x16000
    s_nop 0
    buffer_load_dwordx4 v8, s[12:15], s24 offen lds
    s_add_u32 s24, s25, 0x17000
    s_add_u32 m0, s27, 0x17000
    s_nop 0
    buffer_load_dwordx4 v9, s[12:15], s24 offen lds
    s_add_u32 s24, s25, 0x18000
    s_add_u32 m0, s27, 0x18000
    s_nop 0
    buffer_load_dwordx4 v8, s[12:15], s24 offen lds
    s_add_u32 s24, s25, 0x19000
    s_add_u32 m0, s27, 0x19000
    s_nop 0
    buffer_load_dwordx4 v9, s[12:15], s24 offen lds
    s_add_u32 s24, s25, 0x1a000
    s_add_u32 m0, s27, 0x1a000
    s_nop 0
    buffer_load_dwordx4 v8, s[12:15], s24 offen lds
    s_add_u32 s24, s25, 0x1b000
    s_add_u32 m0, s27, 0x1b000
    s_nop 0
    buffer_load_dwordx4 v9, s[12:15], s24 offen lds
    s_add_u32 s24, s25, 0x1c000
    s_add_u32 m0, s27, 0x1c000
    s_nop 0
    buffer_load_dwordx4 v8, s[12:15], s24 offen lds
    s_add_u32 s24, s25, 0x1d000
    s_add_u32 m0, s27, 0x1d000
    s_nop 0
    buffer_load_dwordx4 v9, s[12:15], s24 offen lds
    s_add_u32 s24, s25, 0x1e000
    s_add_u32 m0, s27, 0x1e000
    s_nop 0
    buffer_load_dwordx4 v8, s[12:15], s24 offen lds
    s_add_u32 s24, s25, 0x1f000
    s_add_u32 m0, s27, 0x1f000
    s_nop 0
    buffer_load_dwordx4 v9, s[12:15], s24 offen lds
    s_waitcnt vmcnt(0)
    s_barrier
    v_xor_b32 v11, 0x0, v10
    ds_read_b64_tr_b16 a[0:1], v11
    ds_read_b64_tr_b16 a[2:3], v11 offset:16384
    ds_read_b64_tr_b16 a[32:33], v11 offset:32768
    ds_read_b64_tr_b16 a[34:35], v11 offset:49152
    v_xor_b32 v11, 0x8, v10
    ds_read_b64_tr_b16 a[4:5], v11
    ds_read_b64_tr_b16 a[6:7], v11 offset:16384
    ds_read_b64_tr_b16 a[36:37], v11 offset:32768
    ds_read_b64_tr_b16 a[38:39], v11 offset:49152
    s_waitcnt lgkmcnt(0)
    v_xor_b32 v11, 0x40, v10
    ds_read_b64_tr_b16 a[8:9], v11
    ds_read_b64_tr_b16 a[10:11], v11 offset:16384
    ds_read_b64_tr_b16 a[40:41], v11 offset:32768
    ds_read_b64_tr_b16 a[42:43], v11 offset:49152
    v_xor_b32 v11, 0x48, v10
    ds_read_b64_tr_b16 a[12:13], v11
    ds_read_b64_tr_b16 a[14:15], v11 offset:16384
    ds_read_b64_tr_b16 a[44:45], v11 offset:32768
    ds_read_b64_tr_b16 a[46:47], v11 offset:49152
    s_waitcnt lgkmcnt(0)
    v_xor_b32 v11, 0x80, v10
    ds_read_b64_tr_b16 a[16:17], v11
    ds_read_b64_tr_b16 a[18:19], v11 offset:16384
    ds_read_b64_tr_b16 a[48:49], v11 offset:32768
    ds_read_b64_tr_b16 a[50:51], v11 offset:49152
    v_xor_b32 v11, 0x88, v10
    ds_read_b64_tr_b16 a[20:21], v11
    ds_read_b64_tr_b16 a[22:23], v11 offset:16384
    ds_read_b64_tr_b16 a[52:53], v11 offset:32768
    ds_read_b64_tr_b16 a[54:55], v11 offset:49152
    s_waitcnt lgkmcnt(0)
    v_xor_b32 v11, 0xc0, v10
    ds_read_b64_tr_b16 a[24:25], v11
    ds_read_b64_tr_b16 a[26:27], v11 offset:16384
    ds_read_b64_tr_b16 a[56:57], v11 offset:32768
    ds_read_b64_tr_b16 a[58:59], v11 offset:49152
    v_xor_b32 v11, 0xc8, v10
    ds_read_b64_tr_b16 a[28:29], v11
    ds_read_b64_tr_b16 a[30:31], v11 offset:16384
    ds_read_b64_tr_b16 a[60:61], v11 offset:32768
    ds_read_b64_tr_b16 a[62:63], v11 offset:49152
    s_waitcnt lgkmcnt(0)
    v_xor_b32 v11, 0x10000, v10
    ds_read_b64_tr_b16 a[64:65], v11
    ds_read_b64_tr_b16 a[66:67], v11 offset:16384
    ds_read_b64_tr_b16 a[96:97], v11 offset:32768
    ds_read_b64_tr_b16 a[98:99], v11 offset:49152
    v_xor_b32 v11, 0x10008, v10
    ds_read_b64_tr_b16 a[68:69], v11
    ds_read_b64_tr_b16 a[70:71], v11 offset:16384
    ds_read_b64_tr_b16 a[100:101], v11 offset:32768
    ds_read_b64_tr_b16 a[102:103], v11 offset:49152
    s_waitcnt lgkmcnt(0)
    v_xor_b32 v11, 0x10040, v10
    ds_read_b64_tr_b16 a[72:73], v11
    ds_read_b64_tr_b16 a[74:75], v11 offset:16384
    ds_read_b64_tr_b16 a[104:105], v11 offset:32768
    ds_read_b64_tr_b16 a[106:107], v11 offset:49152
    v_xor_b32 v11, 0x10048, v10
    ds_read_b64_tr_b16 a[76:77], v11
    ds_read_b64_tr_b16 a[78:79], v11 offset:16384
    ds_read_b64_tr_b16 a[108:109], v11 offset:32768
    ds_read_b64_tr_b16 a[110:111], v11 offset:49152
    s_waitcnt lgkmcnt(0)
    v_xor_b32 v11, 0x10080, v10
    ds_read_b64_tr_b16 a[80:81], v11
    ds_read_b64_tr_b16 a[82:83], v11 offset:16384
    ds_read_b64_tr_b16 a[112:113], v11 offset:32768
    ds_read_b64_tr_b16 a[114:115], v11 offset:49152
    v_xor_b32 v11, 0x10088, v10
    ds_read_b64_tr_b16 a[84:85], v11
    ds_read_b64_tr_b16 a[86:87], v11 offset:16384
    ds_read_b64_tr_b16 a[116:117], v11 offset:32768
    ds_read_b64_tr_b16 a[118:119], v11 offset:49152
    s_waitcnt lgkmcnt(0)
    v_xor_b32 v11, 0x100c0, v10
    ds_read_b64_tr_b16 a[88:89], v11
    ds_read_b64_tr_b16 a[90:91], v11 offset:16384
    ds_read_b64_tr_b16 a[120:121], v11 offset:32768
    ds_read_b64_tr_b16 a[122:123], v11 offset:49152
    v_xor_b32 v11, 0x100c8, v10
    ds_read_b64_tr_b16 a[92:93], v11
    ds_read_b64_tr_b16 a[94:95], v11 offset:16384
    ds_read_b64_tr_b16 a[124:125], v11 offset:32768
    ds_read_b64_tr_b16 a[126:127], v11 offset:49152
    s_waitcnt lgkmcnt(0)
    s_barrier
    s_lshl_b32 s25, s20, 18
    s_add_u32 s24, s25, 0x20000
    s_add_u32 m0, s27, 0x0
    s_nop 0
    buffer_load_dwordx4 v8, s[12:15], s24 offen lds
    s_add_u32 s24, s25, 0x21000
    s_add_u32 m0, s27, 0x1000
    s_nop 0
    buffer_load_dwordx4 v9, s[12:15], s24 offen lds
    s_add_u32 s24, s25, 0x22000
    s_add_u32 m0, s27, 0x2000
    s_nop 0
    buffer_load_dwordx4 v8, s[12:15], s24 offen lds
    s_add_u32 s24, s25, 0x23000
    s_add_u32 m0, s27, 0x3000
    s_nop 0
    buffer_load_dwordx4 v9, s[12:15], s24 offen lds
    s_add_u32 s24, s25, 0x24000
    s_add_u32 m0, s27, 0x4000
    s_nop 0
    buffer_load_dwordx4 v8, s[12:15], s24 offen lds
    s_add_u32 s24, s25, 0x25000
    s_add_u32 m0, s27, 0x5000
    s_nop 0
    buffer_load_dwordx4 v9, s[12:15], s24 offen lds
    s_add_u32 s24, s25, 0x26000
    s_add_u32 m0, s27, 0x6000
    s_nop 0
    buffer_load_dwordx4 v8, s[12:15], s24 offen lds
    s_add_u32 s24, s25, 0x27000
    s_add_u32 m0, s27, 0x7000
    s_nop 0
    buffer_load_dwordx4 v9, s[12:15], s24 offen lds
    s_add_u32 s24, s25, 0x28000
    s_add_u32 m0, s27, 0x8000
    s_nop 0
    buffer_load_dwordx4 v8, s[12:15], s24 offen lds
    s_add_u32 s24, s25, 0x29000
    s_add_u32 m0, s27, 0x9000
    s_nop 0
    buffer_load_dwordx4 v9, s[12:15], s24 offen lds
    s_add_u32 s24, s25, 0x2a000
    s_add_u32 m0, s27, 0xa000
    s_nop 0
    buffer_load_dwordx4 v8, s[12:15], s24 offen lds
    s_add_u32 s24, s25, 0x2b000
    s_add_u32 m0, s27, 0xb000
    s_nop 0
    buffer_load_dwordx4 v9, s[12:15], s24 offen lds
    s_add_u32 s24, s25, 0x2c000
    s_add_u32 m0, s27, 0xc000
    s_nop 0
    buffer_load_dwordx4 v8, s[12:15], s24 offen lds
    s_add_u32 s24, s25, 0x2d000
    s_add_u32 m0, s27, 0xd000
    s_nop 0
    buffer_load_dwordx4 v9, s[12:15], s24 offen lds
    s_add_u32 s24, s25, 0x2e000
    s_add_u32 m0, s27, 0xe000
    s_nop 0
    buffer_load_dwordx4 v8, s[12:15], s24 offen lds
    s_add_u32 s24, s25, 0x2f000
    s_add_u32 m0, s27, 0xf000
    s_nop 0
    buffer_load_dwordx4 v9, s[12:15], s24 offen lds
    s_add_u32 s24, s25, 0x30000
    s_add_u32 m0, s27, 0x10000
    s_nop 0
    buffer_load_dwordx4 v8, s[12:15], s24 offen lds
    s_add_u32 s24, s25, 0x31000
    s_add_u32 m0, s27, 0x11000
    s_nop 0
    buffer_load_dwordx4 v9, s[12:15], s24 offen lds
    s_add_u32 s24, s25, 0x32000
    s_add_u32 m0, s27, 0x12000
    s_nop 0
    buffer_load_dwordx4 v8, s[12:15], s24 offen lds
    s_add_u32 s24, s25, 0x33000
    s_add_u32 m0, s27, 0x13000
    s_nop 0
    buffer_load_dwordx4 v9, s[12:15], s24 offen lds
    s_add_u32 s24, s25, 0x34000
    s_add_u32 m0, s27, 0x14000
    s_nop 0
    buffer_load_dwordx4 v8, s[12:15], s24 offen lds
    s_add_u32 s24, s25, 0x35000
    s_add_u32 m0, s27, 0x15000
    s_nop 0
    buffer_load_dwordx4 v9, s[12:15], s24 offen lds
    s_add_u32 s24, s25, 0x36000
    s_add_u32 m0, s27, 0x16000
    s_nop 0
    buffer_load_dwordx4 v8, s[12:15], s24 offen lds
    s_add_u32 s24, s25, 0x37000
    s_add_u32 m0, s27, 0x17000
    s_nop 0
    buffer_load_dwordx4 v9, s[12:15], s24 offen lds
    s_add_u32 s24, s25, 0x38000
    s_add_u32 m0, s27, 0x18000
    s_nop 0
    buffer_load_dwordx4 v8, s[12:15], s24 offen lds
    s_add_u32 s24, s25, 0x39000
    s_add_u32 m0, s27, 0x19000
    s_nop 0
    buffer_load_dwordx4 v9, s[12:15], s24 offen lds
    s_add_u32 s24, s25, 0x3a000
    s_add_u32 m0, s27, 0x1a000
    s_nop 0
    buffer_load_dwordx4 v8, s[12:15], s24 offen lds
    s_add_u32 s24, s25, 0x3b000
    s_add_u32 m0, s27, 0x1b000
    s_nop 0
    buffer_load_dwordx4 v9, s[12:15], s24 offen lds
    s_add_u32 s24, s25, 0x3c000
    s_add_u32 m0, s27, 0x1c000
    s_nop 0
    buffer_load_dwordx4 v8, s[12:15], s24 offen lds
    s_add_u32 s24, s25, 0x3d000
    s_add_u32 m0, s27, 0x1d000
    s_nop 0
    buffer_load_dwordx4 v9, s[12:15], s24 offen lds
    s_add_u32 s24, s25, 0x3e000
    s_add_u32 m0, s27, 0x1e000
    s_nop 0
    buffer_load_dwordx4 v8, s[12:15], s24 offen lds
    s_add_u32 s24, s25, 0x3f000
    s_add_u32 m0, s27, 0x1f000
    s_nop 0
    buffer_load_dwordx4 v9, s[12:15], s24 offen lds
    s_waitcnt vmcnt(0)
    s_barrier
    v_xor_b32 v11, 0x0, v10
    ds_read_b64_tr_b16 a[128:129], v11
    ds_read_b64_tr_b16 a[130:131], v11 offset:16384
    ds_read_b64_tr_b16 a[160:161], v11 offset:32768
    ds_read_b64_tr_b16 a[162:163], v11 offset:49152
    v_xor_b32 v11, 0x8, v10
    ds_read_b64_tr_b16 a[132:133], v11
    ds_read_b64_tr_b16 a[134:135], v11 offset:16384
    ds_read_b64_tr_b16 a[164:165], v11 offset:32768
    ds_read_b64_tr_b16 a[166:167], v11 offset:49152
    s_waitcnt lgkmcnt(0)
    v_xor_b32 v11, 0x40, v10
    ds_read_b64_tr_b16 a[136:137], v11
    ds_read_b64_tr_b16 a[138:139], v11 offset:16384
    ds_read_b64_tr_b16 a[168:169], v11 offset:32768
    ds_read_b64_tr_b16 a[170:171], v11 offset:49152
    v_xor_b32 v11, 0x48, v10
    ds_read_b64_tr_b16 a[140:141], v11
    ds_read_b64_tr_b16 a[142:143], v11 offset:16384
    ds_read_b64_tr_b16 a[172:173], v11 offset:32768
    ds_read_b64_tr_b16 a[174:175], v11 offset:49152
    s_waitcnt lgkmcnt(0)
    v_xor_b32 v11, 0x80, v10
    ds_read_b64_tr_b16 a[144:145], v11
    ds_read_b64_tr_b16 a[146:147], v11 offset:16384
    ds_read_b64_tr_b16 a[176:177], v11 offset:32768
    ds_read_b64_tr_b16 a[178:179], v11 offset:49152
    v_xor_b32 v11, 0x88, v10
    ds_read_b64_tr_b16 a[148:149], v11
    ds_read_b64_tr_b16 a[150:151], v11 offset:16384
    ds_read_b64_tr_b16 a[180:181], v11 offset:32768
    ds_read_b64_tr_b16 a[182:183], v11 offset:49152
    s_waitcnt lgkmcnt(0)
    v_xor_b32 v11, 0xc0, v10
    ds_read_b64_tr_b16 a[152:153], v11
    ds_read_b64_tr_b16 a[154:155], v11 offset:16384
    ds_read_b64_tr_b16 a[184:185], v11 offset:32768
    ds_read_b64_tr_b16 a[186:187], v11 offset:49152
    v_xor_b32 v11, 0xc8, v10
    ds_read_b64_tr_b16 a[156:157], v11
    ds_read_b64_tr_b16 a[158:159], v11 offset:16384
    ds_read_b64_tr_b16 a[188:189], v11 offset:32768
    ds_read_b64_tr_b16 a[190:191], v11 offset:49152
    s_waitcnt lgkmcnt(0)
    v_xor_b32 v11, 0x10000, v10
    ds_read_b64_tr_b16 a[192:193], v11
    ds_read_b64_tr_b16 a[194:195], v11 offset:16384
    ds_read_b64_tr_b16 a[224:225], v11 offset:32768
    ds_read_b64_tr_b16 a[226:227], v11 offset:49152
    v_xor_b32 v11, 0x10008, v10
    ds_read_b64_tr_b16 a[196:197], v11
    ds_read_b64_tr_b16 a[198:199], v11 offset:16384
    ds_read_b64_tr_b16 a[228:229], v11 offset:32768
    ds_read_b64_tr_b16 a[230:231], v11 offset:49152
    s_waitcnt lgkmcnt(0)
    v_xor_b32 v11, 0x10040, v10
    ds_read_b64_tr_b16 a[200:201], v11
    ds_read_b64_tr_b16 a[202:203], v11 offset:16384
    ds_read_b64_tr_b16 a[232:233], v11 offset:32768
    ds_read_b64_tr_b16 a[234:235], v11 offset:49152
    v_xor_b32 v11, 0x10048, v10
    ds_read_b64_tr_b16 a[204:205], v11
    ds_read_b64_tr_b16 a[206:207], v11 offset:16384
    ds_read_b64_tr_b16 a[236:237], v11 offset:32768
    ds_read_b64_tr_b16 a[238:239], v11 offset:49152
    s_waitcnt lgkmcnt(0)
    v_xor_b32 v11, 0x10080, v10
    ds_read_b64_tr_b16 a[208:209], v11
    ds_read_b64_tr_b16 a[210:211], v11 offset:16384
    ds_read_b64_tr_b16 a[240:241], v11 offset:32768
    ds_read_b64_tr_b16 a[242:243], v11 offset:49152
    v_xor_b32 v11, 0x10088, v10
    ds_read_b64_tr_b16 a[212:213], v11
    ds_read_b64_tr_b16 a[214:215], v11 offset:16384
    ds_read_b64_tr_b16 a[244:245], v11 offset:32768
    ds_read_b64_tr_b16 a[246:247], v11 offset:49152
    s_waitcnt lgkmcnt(0)
    v_xor_b32 v11, 0x100c0, v10
    ds_read_b64_tr_b16 a[216:217], v11
    ds_read_b64_tr_b16 a[218:219], v11 offset:16384
    ds_read_b64_tr_b16 a[248:249], v11 offset:32768
    ds_read_b64_tr_b16 a[250:251], v11 offset:49152
    v_xor_b32 v11, 0x100c8, v10
    ds_read_b64_tr_b16 a[220:221], v11
    ds_read_b64_tr_b16 a[222:223], v11 offset:16384
    ds_read_b64_tr_b16 a[252:253], v11 offset:32768
    ds_read_b64_tr_b16 a[254:255], v11 offset:49152
    s_waitcnt lgkmcnt(0)
    s_barrier
    s_and_b32 s24, s21, 1
    s_lshl_b32 s24, s24, 4
    v_add_u32 v4, s24, v3
    v_lshlrev_b32 v5, 2, v2
    v_sub_u32 v4, v4, v5
    v_cmp_le_i32 s[30:31], 0, v4
    v_cmp_le_i32 s[32:33], 1, v4
    v_cmp_le_i32 s[34:35], 2, v4
    v_cmp_le_i32 s[36:37], 3, v4
    v_cmp_le_i32 s[38:39], 16, v4
    v_cmp_le_i32 s[40:41], 17, v4
    v_cmp_le_i32 s[42:43], 18, v4
    v_cmp_le_i32 s[44:45], 19, v4
    s_mov_b32 s28, 0x3e0293ee
    s_mov_b32 s29, 0x3e0293ee
    s_mov_b32 s53, 0xff000000
    v_mov_b32 v136, 0x3f803f80
    v_mov_b32 v137, 0x3f803f80
    v_mov_b32 v138, 0x3f803f80
    v_mov_b32 v139, 0x3f803f80
    v_lshlrev_b32 v4, 10, v3
    v_lshl_add_u32 v4, v2, 4, v4
    s_lshl_b32 s24, s21, 8
    v_add_u32 v242, s24, v4
    s_lshl_b32 s24, s21, 12
    v_add_u32 v243, s24, v240
    v_mov_b32 v244, v240
    s_add_u32 s24, s24, 0x22000
    v_xor_b32 v7, v2, v6
    v_lshl_add_u32 v4, v2, 4, v7
    v_and_b32 v5, 3, v3
    v_lshl_add_u32 v4, v4, 2, v5
    v_lshl_add_u32 v253, v4, 2, s24
    v_lshl_add_u32 v4, v3, 2, v7
    v_lshl_add_u32 v254, v4, 4, s24
    s_load_dwordx2 s[12:13], s[0:1], 0
    s_waitcnt lgkmcnt(0)
    s_and_b32 s13, s13, 0xffff
    s_mov_b32 s14, 0x200000
    s_mov_b32 s15, 0x20000
    s_load_dwordx2 s[16:17], s[0:1], 96
    s_waitcnt lgkmcnt(0)
    s_and_b32 s17, s17, 0xffff
    s_mov_b32 s18, 0x200000
    s_mov_b32 s19, 0x20000
    s_load_dwordx2 s[56:57], s[0:1], 64
    s_waitcnt lgkmcnt(0)
    s_and_b32 s57, s57, 0xffff
    s_mov_b32 s58, 0x400
    s_mov_b32 s59, 0x20000
    v_and_b32 v100, 63, v0
    v_lshlrev_b32 v240, 4, v100
    buffer_load_dwordx4 v[236:239], v240, s[56:59], 0 offen
    s_mov_b32 s65, 0x3f80
    s_mov_b32 s66, 0x3f800000
    s_waitcnt vmcnt(0)
    s_sub_u32 s67, s101, 128
    s_cmp_ge_u32 s67, 56
    s_cbranch_scc1 L_nostage_112
L_nostage_112:
    v_lshrrev_b32 v246, 2, v240
    s_lshl_b32 s24, s20, 7
    s_add_u32 s24, s24, 0x2000
    s_cmp_lg_u32 s100, 0
    s_cbranch_scc1 L_polls_115
    s_mov_b32 exec_lo, 0xffffffff
    s_mov_b32 exec_hi, 0
    s_mov_b32 s96, 0
L_poll_113:
    buffer_load_dword v247, v246, s[8:11], s24 offen sc1
    s_waitcnt vmcnt(0)
    v_cmp_gt_u32 vcc, 1, v247
    s_cbranch_vccz L_polld_114
    s_sleep 32
    s_add_u32 s96, s96, 1
    s_cmp_lt_u32 s96, 0x10000
    s_cbranch_scc1 L_poll_113
L_polld_114:
    s_mov_b64 exec, -1
L_polls_115:
    s_barrier
    s_lshl_b32 s24, s20, 7
    s_add_u32 s24, s24, 0x2800
    s_cmp_lg_u32 s100, 0
    s_cbranch_scc1 L_polls_118
    s_mov_b32 exec_lo, 0xffffffff
    s_mov_b32 exec_hi, 0
    s_mov_b32 s96, 0
L_poll_116:
    buffer_load_dword v247, v246, s[8:11], s24 offen sc1
    s_waitcnt vmcnt(0)
    v_cmp_gt_u32 vcc, 1, v247
    s_cbranch_vccz L_polld_117
    s_sleep 32
    s_add_u32 s96, s96, 1
    s_cmp_lt_u32 s96, 0x10000
    s_cbranch_scc1 L_poll_116
L_polld_117:
    s_mov_b64 exec, -1
L_polls_118:
    s_barrier
    s_lshl_b32 s24, s20, 7
    s_add_u32 s24, s24, 0x3000
    s_cmp_lg_u32 s100, 0
    s_cbranch_scc1 L_polls_121
    s_mov_b32 exec_lo, 0xffffffff
    s_mov_b32 exec_hi, 0
    s_mov_b32 s96, 0
L_poll_119:
    buffer_load_dword v247, v246, s[8:11], s24 offen sc1
    s_waitcnt vmcnt(0)
    v_cmp_gt_u32 vcc, 1, v247
    s_cbranch_vccz L_polld_120
    s_sleep 32
    s_add_u32 s96, s96, 1
    s_cmp_lt_u32 s96, 0x10000
    s_cbranch_scc1 L_poll_119
L_polld_120:
    s_mov_b64 exec, -1
L_polls_121:
    s_barrier
    s_mov_b32 s80, 0
    s_mov_b32 s82, 0
L_p2_seg:
    s_cmp_ge_u32 s22, 64
    s_cbranch_scc1 L_p2_end
    v_lshrrev_b32 v246, 2, v240
    s_lshl_b32 s24, s20, 7
    s_add_u32 s24, s24, 0x1000
    s_mul_i32 s25, s22, 10
    s_lshr_b32 s25, s25, 4
    s_add_u32 s25, s25, 17
    s_cmp_lg_u32 s100, 0
    s_cbranch_scc1 L_polls_124
    s_mov_b32 exec_lo, 0x1
    s_mov_b32 exec_hi, 0
    s_mov_b32 s96, 0
L_poll_122:
    buffer_load_dword v247, v246, s[8:11], s24 offen sc1
    s_waitcnt vmcnt(0)
    v_cmp_gt_u32 vcc, s25, v247
    s_cbranch_vccz L_polld_123
    v_readfirstlane_b32 s97, v247
    s_nop 0
    s_sub_u32 s97, s25, s97
    s_cmp_lt_i32 s97, 3
    s_cbranch_scc1 L_near_125
    s_sleep 40
    s_cmp_lt_i32 s97, 5
    s_cbranch_scc1 L_near_125
    s_sleep 100
L_near_125:
    s_sleep 4
    s_add_u32 s96, s96, 1
    s_cmp_lt_u32 s96, 0x10000
    s_cbranch_scc1 L_poll_122
L_polld_123:
    s_mov_b64 exec, -1
L_polls_124:
    s_barrier
    s_cmp_ge_u32 s67, 56
    s_cbranch_scc1 L_nostage_126
    v_mbcnt_lo_u32_b32 v0, -1, 0
    v_mbcnt_hi_u32_b32 v0, -1, v0
    s_lshl_b32 s96, s100, 6
    v_add_u32 v0, s96, v0
    v_lshrrev_b32 v2, 6, v0
    s_nop 0
    v_readfirstlane_b32 s68, v2
    v_and_b32 v1, 63, v0
    s_lshl_b32 s73, s68, 10
    v_lshrrev_b32 v2, 2, v1
    s_lshl_b32 s71, s68, 4
    v_add_u32 v2, s71, v2
    s_movk_i32 s71, 3584
    v_mul_lo_u32 v2, v2, s71
    v_and_b32 v3, 3, v1
    v_lshl_add_u32 v4, v3, 4, v2
    s_cmp_lg_u32 s80, 0
    s_cbranch_scc1 L_part_127
    s_load_dwordx2 s[76:77], s[0:1], 72
    s_waitcnt lgkmcnt(0)
    s_and_b32 s77, s77, 0xffff
    s_mov_b32 s78, 0x1c0000
    s_mov_b32 s79, 0x20000
    s_lshl_b32 s71, s67, 6
    s_add_u32 s71, s71, 0x0
    s_add_u32 m0, s73, 0x8000
    s_nop 0
    buffer_load_dwordx4 v4, s[76:79], s71 offen lds
    s_lshl_b32 s71, s67, 6
    s_add_u32 s71, s71, 0x38000
    s_add_u32 m0, s73, 0x9000
    s_nop 0
    buffer_load_dwordx4 v4, s[76:79], s71 offen lds
    s_lshl_b32 s71, s67, 6
    s_add_u32 s71, s71, 0x70000
    s_add_u32 m0, s73, 0xa000
    s_nop 0
    buffer_load_dwordx4 v4, s[76:79], s71 offen lds
    s_lshl_b32 s71, s67, 6
    s_add_u32 s71, s71, 0xa8000
    s_add_u32 m0, s73, 0xb000
    s_nop 0
    buffer_load_dwordx4 v4, s[76:79], s71 offen lds
    s_lshl_b32 s71, s67, 6
    s_add_u32 s71, s71, 0xe0000
    s_add_u32 m0, s73, 0xc000
    s_nop 0
    buffer_load_dwordx4 v4, s[76:79], s71 offen lds
    s_lshl_b32 s71, s67, 6
    s_add_u32 s71, s71, 0x118000
    s_add_u32 m0, s73, 0xd000
    s_nop 0
    buffer_load_dwordx4 v4, s[76:79], s71 offen lds
    s_lshl_b32 s71, s67, 6
    s_add_u32 s71, s71, 0x150000
    s_add_u32 m0, s73, 0xe000
    s_nop 0
    buffer_load_dwordx4 v4, s[76:79], s71 offen lds
    s_lshl_b32 s71, s67, 6
    s_add_u32 s71, s71, 0x188000
    s_add_u32 m0, s73, 0xf000
    s_nop 0
    buffer_load_dwordx4 v4, s[76:79], s71 offen lds
L_part_127:
    s_cmp_lg_u32 s80, 4
    s_cbranch_scc1 L_part_128
    s_load_dwordx2 s[76:77], s[0:1], 80
    s_waitcnt lgkmcnt(0)
    s_and_b32 s77, s77, 0xffff
    s_mov_b32 s78, 0x1c0000
    s_mov_b32 s79, 0x20000
    s_lshl_b32 s71, s67, 6
    s_add_u32 s71, s71, 0x0
    s_add_u32 m0, s73, 0x10000
    s_nop 0
    buffer_load_dwordx4 v4, s[76:79], s71 offen lds
    s_lshl_b32 s71, s67, 6
    s_add_u32 s71, s71, 0x38000
    s_add_u32 m0, s73, 0x11000
    s_nop 0
    buffer_load_dwordx4 v4, s[76:79], s71 offen lds
    s_lshl_b32 s71, s67, 6
    s_add_u32 s71, s71, 0x70000
    s_add_u32 m0, s73, 0x12000
    s_nop 0
    buffer_load_dwordx4 v4, s[76:79], s71 offen lds
    s_lshl_b32 s71, s67, 6
    s_add_u32 s71, s71, 0xa8000
    s_add_u32 m0, s73, 0x13000
    s_nop 0
    buffer_load_dwordx4 v4, s[76:79], s71 offen lds
    s_lshl_b32 s71, s67, 6
    s_add_u32 s71, s71, 0xe0000
    s_add_u32 m0, s73, 0x14000
    s_nop 0
    buffer_load_dwordx4 v4, s[76:79], s71 offen lds
    s_lshl_b32 s71, s67, 6
    s_add_u32 s71, s71, 0x118000
    s_add_u32 m0, s73, 0x15000
    s_nop 0
    buffer_load_dwordx4 v4, s[76:79], s71 offen lds
    s_lshl_b32 s71, s67, 6
    s_add_u32 s71, s71, 0x150000
    s_add_u32 m0, s73, 0x16000
    s_nop 0
    buffer_load_dwordx4 v4, s[76:79], s71 offen lds
    s_lshl_b32 s71, s67, 6
    s_add_u32 s71, s71, 0x188000
    s_add_u32 m0, s73, 0x17000
    s_nop 0
    buffer_load_dwordx4 v4, s[76:79], s71 offen lds
L_part_128:
    s_cmp_lg_u32 s80, 8
    s_cbranch_scc1 L_part_129
    s_load_dwordx2 s[76:77], s[0:1], 88
    s_waitcnt lgkmcnt(0)
    s_and_b32 s77, s77, 0xffff
    s_mov_b32 s78, 0x1c0000
    s_mov_b32 s79, 0x20000
    v_lshlrev_b32 v5, 4, v1
    v_add_u32 v5, s73, v5
    s_lshl_b32 s71, s67, 15
    s_add_u32 s71, s71, 0
    s_add_u32 m0, s73, 0x18000
    s_nop 0
    buffer_load_dwordx4 v5, s[76:79], s71 offen lds
    s_lshl_b32 s71, s67, 15
    s_add_u32 s71, s71, 4096
    s_add_u32 m0, s73, 0x19000
    s_nop 0
    buffer_load_dwordx4 v5, s[76:79], s71 offen lds
    s_lshl_b32 s71, s67, 15
    s_add_u32 s71, s71, 8192
    s_add_u32 m0, s73, 0x1a000
    s_nop 0
    buffer_load_dwordx4 v5, s[76:79], s71 offen lds
    s_lshl_b32 s71, s67, 15
    s_add_u32 s71, s71, 12288
    s_add_u32 m0, s73, 0x1b000
    s_nop 0
    buffer_load_dwordx4 v5, s[76:79], s71 offen lds
    s_lshl_b32 s71, s67, 15
    s_add_u32 s71, s71, 16384
    s_add_u32 m0, s73, 0x1c000
    s_nop 0
    buffer_load_dwordx4 v5, s[76:79], s71 offen lds
    s_lshl_b32 s71, s67, 15
    s_add_u32 s71, s71, 20480
    s_add_u32 m0, s73, 0x1d000
    s_nop 0
    buffer_load_dwordx4 v5, s[76:79], s71 offen lds
    s_lshl_b32 s71, s67, 15
    s_add_u32 s71, s71, 24576
    s_add_u32 m0, s73, 0x1e000
    s_nop 0
    buffer_load_dwordx4 v5, s[76:79], s71 offen lds
    s_lshl_b32 s71, s67, 15
    s_add_u32 s71, s71, 28672
    s_add_u32 m0, s73, 0x1f000
    s_nop 0
    buffer_load_dwordx4 v5, s[76:79], s71 offen lds
L_part_129:
L_nostage_126:
    s_lshl_b32 s24, s22, 5
    s_lshl_b32 s25, s20, 1
    s_add_u32 s24, s24, s25
    s_lshr_b32 s25, s21, 1
    s_add_u32 s24, s24, s25
    s_lshl_b32 s25, s24, 13
    s_add_u32 s47, s25, 0x1000000
    s_add_u32 s54, s47, 4096
    s_add_u32 s48, s25, 0x2000000
    s_add_u32 s55, s48, 4096
    s_and_b32 s26, s21, 1
    s_lshl_b32 s26, s26, 12
    s_add_u32 s46, s25, s26
    s_add_u32 s46, s46, 0x3000000
    s_lshl_b32 s25, s24, 12
    s_add_u32 s49, s25, 0x240000
    s_lshl_b32 s24, s22, 4
    s_add_u32 s24, s24, s20
    s_lshl_b32 s24, s24, 15
    s_add_u32 s51, s24, 0x4000000
    s_cmp_ge_u32 s22, 60
    s_cselect_b32 s81, 1, 0
    s_lshl_b32 s60, s20, 1
    s_and_b32 s24, s100, 1
    s_add_u32 s60, s60, s24
    s_cmp_ge_u32 s22, 62
    s_cselect_b32 s24, 1, 0
    s_max_u32 s82, s82, s24
    s_lshl_b32 s24, s82, 3
    s_and_b32 s24, s24, 16
    s_add_u32 s24, s24, s20
    s_cmp_lg_u32 s82, 0
    s_cselect_b32 s60, s24, s60
    s_lshl_b32 s24, s22, 5
    s_add_u32 s60, s60, s24
    s_lshl_b32 s64, s60, 10
    buffer_load_dwordx4 v[96:99], v240, s[12:15], s64 offen
    s_lshl_b32 s52, s22, 6
    s_add_u32 s52, s52, 0x4000
    s_lshl_b32 s24, s22, 7
    s_and_b32 s25, s82, 2
    s_lshl_b32 s25, s25, 7
    s_add_u32 s24, s24, s25
    s_add_u32 s24, s24, 0x6a00
    s_cmp_lg_u32 s81, 0
    s_cselect_b32 s52, s24, s52
    s_cmp_ge_u32 s22, 62
    s_cselect_b32 s83, s87, 0
    s_and_b32 s83, s83, 1
    s_cbranch_scc0 L_notouch_130
    buffer_load_dword v245, off, s[8:11], s52 sc1
    v_lshlrev_b32 v246, 3, v240
    s_lshl_b32 s24, s21, 13
    s_add_u32 s24, s24, s51
    buffer_load_dword v245, v246, s[8:11], s24 offen sc1
L_notouch_130:
    buffer_load_dwordx4 v[0:3], v240, s[8:11], s46 offen
    buffer_load_dwordx4 v[4:7], v240, s[8:11], s46 offen offset:1024
    buffer_load_dwordx4 v[8:11], v240, s[8:11], s46 offen offset:2048
    buffer_load_dwordx4 v[12:15], v240, s[8:11], s46 offen offset:3072
    buffer_load_dwordx4 v[16:19], v240, s[8:11], s47 offen
    buffer_load_dwordx4 v[20:23], v240, s[8:11], s47 offen offset:1024
    buffer_load_dwordx4 v[24:27], v240, s[8:11], s47 offen offset:2048
    buffer_load_dwordx4 v[28:31], v240, s[8:11], s47 offen offset:3072
    buffer_load_dwordx4 v[32:35], v240, s[8:11], s54 offen
    buffer_load_dwordx4 v[36:39], v240, s[8:11], s54 offen offset:1024
    buffer_load_dwordx4 v[40:43], v240, s[8:11], s54 offen offset:2048
    buffer_load_dwordx4 v[44:47], v240, s[8:11], s54 offen offset:3072
    buffer_load_dwordx4 v[64:67], v240, s[8:11], s48 offen
    buffer_load_dwordx4 v[68:71], v240, s[8:11], s48 offen offset:1024
    buffer_load_dwordx4 v[72:75], v240, s[8:11], s48 offen offset:2048
    buffer_load_dwordx4 v[76:79], v240, s[8:11], s48 offen offset:3072
    buffer_load_dwordx4 v[80:83], v240, s[8:11], s55 offen
    buffer_load_dwordx4 v[84:87], v240, s[8:11], s55 offen offset:1024
    buffer_load_dwordx4 v[88:91], v240, s[8:11], s55 offen offset:2048
    buffer_load_dwordx4 v[92:95], v240, s[8:11], s55 offen offset:3072
    s_waitcnt vmcnt(8)
    v_mfma_f32_16x16x32_bf16 v[116:119], v[16:19], v[0:3], 0
    v_mfma_f32_16x16x32_bf16 v[116:119], v[20:23], v[4:7], v[116:119]
    v_mfma_f32_16x16x32_bf16 v[116:119], v[24:27], v[8:11], v[116:119]
    v_mfma_f32_16x16x32_bf16 v[116:119], v[28:31], v[12:15], v[116:119]
    v_mfma_f32_16x16x32_bf16 v[120:123], v[32:35], v[0:3], 0
    v_mfma_f32_16x16x32_bf16 v[120:123], v[36:39], v[4:7], v[120:123]
    v_mfma_f32_16x16x32_bf16 v[120:123], v[40:43], v[8:11], v[120:123]
    v_mfma_f32_16x16x32_bf16 v[120:123], v[44:47], v[12:15], v[120:123]
    v_mov_b32 v247, s53
    v_cndmask_b32 v116, v247, v116, s[30:31]
    v_cndmask_b32 v117, v247, v117, s[32:33]
    v_cndmask_b32 v118, v247, v118, s[34:35]
    v_cndmask_b32 v119, v247, v119, s[36:37]
    s_nop 2
    v_cndmask_b32 v120, v247, v120, s[38:39]
    v_cndmask_b32 v121, v247, v121, s[40:41]
    v_cndmask_b32 v122, v247, v122, s[42:43]
    v_cndmask_b32 v123, v247, v123, s[44:45]
    v_max3_f32 v251, v116, v117, v118
    v_max3_f32 v251, v251, v119, v120
    v_max3_f32 v251, v251, v121, v122
    v_lshrrev_b32 v246, 2, v240
    s_lshl_b32 s24, s20, 7
    s_add_u32 s24, s24, 0x1000
    s_add_u32 s25, s22, 1
    s_sub_u32 s26, s22, 1
    s_min_u32 s26, s26, 61
    s_cmp_lg_u32 s81, 0
    s_cselect_b32 s25, s26, s25
    s_cmp_lg_u32 s100, 0
    s_cbranch_scc1 L_polls_133
    s_mov_b32 exec_lo, 0x11
    s_mov_b32 exec_hi, 0
    s_mov_b32 s96, 0
L_poll_131:
    buffer_load_dword v247, v246, s[8:11], s24 offen sc1
    s_waitcnt vmcnt(0)
    v_cmp_gt_u32 vcc, s25, v247
    s_cbranch_vccz L_polld_132
    v_readfirstlane_b32 s97, v247
    s_nop 0
    s_sub_u32 s97, s25, s97
    s_cmp_lt_i32 s97, 3
    s_cbranch_scc1 L_near_134
    s_sleep 40
    s_cmp_lt_i32 s97, 5
    s_cbranch_scc1 L_near_134
    s_sleep 100
L_near_134:
    s_sleep 4
    s_add_u32 s96, s96, 1
    s_cmp_lt_u32 s96, 0x10000
    s_cbranch_scc1 L_poll_131
L_polld_132:
    s_mov_b64 exec, -1
L_polls_133:
    s_barrier
    s_cmp_eq_u32 s81, 0
    s_cbranch_scc1 L_kmf_136
    s_lshr_b32 s26, s21, 1
    s_lshl_b32 s26, s26, 4
    s_add_u32 s24, s24, s26
    s_mov_b32 s96, 0
    buffer_load_dword v245, off, s[8:11], s24 sc1
    buffer_load_dwordx4 v[220:223], v240, s[8:11], s49 offen sc1
    buffer_load_dwordx4 v[224:227], v240, s[8:11], s49 offen offset:1024 sc1
    buffer_load_dwordx4 v[228:231], v240, s[8:11], s49 offen offset:2048 sc1
    buffer_load_dwordx4 v[232:235], v240, s[8:11], s49 offen offset:3072 sc1
    s_sleep 14
L_kmp_135:
    buffer_load_dword v245, off, s[8:11], s24 sc1
    buffer_load_dwordx4 v[220:223], v240, s[8:11], s49 offen sc1
    buffer_load_dwordx4 v[224:227], v240, s[8:11], s49 offen offset:1024 sc1
    buffer_load_dwordx4 v[228:231], v240, s[8:11], s49 offen offset:2048 sc1
    buffer_load_dwordx4 v[232:235], v240, s[8:11], s49 offen offset:3072 sc1
    s_add_u32 s96, s96, 1
    s_waitcnt vmcnt(5)
    v_max3_u32 v246, v220, v221, v222
    v_max3_u32 v246, v246, v223, v224
    v_max3_u32 v246, v246, v225, v226
    v_max3_u32 v246, v246, v227, v228
    v_max3_u32 v246, v246, v229, v230
    v_max3_u32 v246, v246, v231, v232
    v_max3_u32 v246, v246, v233, v234
    v_max_u32 v246, v246, v235
    v_cmp_eq_u32 vcc, -1, v246
    v_readfirstlane_b32 s26, v245
    s_cbranch_vccz L_kmo_137
    s_cmp_gt_u32 s26, s22
    s_cbranch_scc1 L_kmf_136
    s_cmp_lt_u32 s96, 0x10000
    s_cbranch_scc1 L_kmp_135
L_kmf_136:
    buffer_load_dwordx4 v[220:223], v240, s[8:11], s49 offen sc1
    buffer_load_dwordx4 v[224:227], v240, s[8:11], s49 offen offset:1024 sc1
    buffer_load_dwordx4 v[228:231], v240, s[8:11], s49 offen offset:2048 sc1
    buffer_load_dwordx4 v[232:235], v240, s[8:11], s49 offen offset:3072 sc1
    s_waitcnt vmcnt(0)
L_kmo_137:
    s_mov_b32 s62, 0x8f00
    buffer_load_dword v104, off, s[8:11], s62 sc1
    ds_write_b32 v253, v221
    ds_write_b32 v253, v223 offset:64
    ds_write_b32 v253, v225 offset:1024
    ds_write_b32 v253, v227 offset:1088
    ds_write_b32 v253, v229 offset:2048
    ds_write_b32 v253, v231 offset:2112
    ds_write_b32 v253, v233 offset:3072
    ds_write_b32 v253, v235 offset:3136
    ds_read_b128 v[48:51], v254
    ds_read_b128 v[52:55], v254 offset:1024
    ds_read_b128 v[56:59], v254 offset:2048
    ds_read_b128 v[60:63], v254 offset:3072
    s_waitcnt lgkmcnt(0)
    v_mfma_f32_16x16x32_bf16 v[112:115], v[48:51], v[0:3], 0
    v_mfma_f32_16x16x32_bf16 v[112:115], v[52:55], v[4:7], v[112:115]
    v_mfma_f32_16x16x32_bf16 v[112:115], v[56:59], v[8:11], v[112:115]
    v_mfma_f32_16x16x32_bf16 v[112:115], v[60:63], v[12:15], v[112:115]
    v_mov_b32 v246, v251
    s_nop 6
    v_max3_f32 v246, v246, v123, v112
    v_max_f32 v246, v246, v113
    v_mov_b32 v247, v246
    s_nop 1
    v_permlane32_swap_b32 v247, v246
    v_max_f32 v246, v247, v246
    v_mov_b32 v247, v246
    s_nop 1
    v_permlane16_swap_b32 v247, v246
    v_max_f32 v246, v247, v246
    v_mul_f32 v248, s28, v246
    v_pk_fma_f32 v[116:117], v[116:117], s[28:29], v[248:249] op_sel_hi:[1,1,0] neg_lo:[0,0,1] neg_hi:[0,0,1]
    v_pk_fma_f32 v[118:119], v[118:119], s[28:29], v[248:249] op_sel_hi:[1,1,0] neg_lo:[0,0,1] neg_hi:[0,0,1]
    v_pk_fma_f32 v[120:121], v[120:121], s[28:29], v[248:249] op_sel_hi:[1,1,0] neg_lo:[0,0,1] neg_hi:[0,0,1]
    v_pk_fma_f32 v[122:123], v[122:123], s[28:29], v[248:249] op_sel_hi:[1,1,0] neg_lo:[0,0,1] neg_hi:[0,0,1]
    v_pk_fma_f32 v[112:113], v[112:113], s[28:29], v[248:249] op_sel_hi:[1,1,0] neg_lo:[0,0,1] neg_hi:[0,0,1]
    v_exp_f32 v116, v116
    v_exp_f32 v117, v117
    v_exp_f32 v118, v118
    v_exp_f32 v119, v119
    v_exp_f32 v120, v120
    v_exp_f32 v121, v121
    v_exp_f32 v122, v122
    v_exp_f32 v123, v123
    v_exp_f32 v112, v112
    v_exp_f32 v113, v113
    v_cvt_pk_bf16_f32 v124, v116, v117
    v_cvt_pk_bf16_f32 v125, v118, v119
    v_cvt_pk_bf16_f32 v126, v120, v121
    v_cvt_pk_bf16_f32 v127, v122, v123
    v_cvt_pk_bf16_f32 v128, v112, v113
    v_mov_b32 v129, 0
    v_mfma_f32_16x16x32_bf16 v[132:135], v[136:139], v[124:127], 0
    v_mfma_f32_16x16x32_bf16 v[140:143], v[64:67], v[124:127], 0
    v_mfma_f32_16x16x32_bf16 v[144:147], v[68:71], v[124:127], 0
    v_mfma_f32_16x16x32_bf16 v[148:151], v[72:75], v[124:127], 0
    v_mfma_f32_16x16x32_bf16 v[152:155], v[76:79], v[124:127], 0
    v_mfma_f32_16x16x32_bf16 v[156:159], v[80:83], v[124:127], 0
    v_mfma_f32_16x16x32_bf16 v[160:163], v[84:87], v[124:127], 0
    v_mfma_f32_16x16x32_bf16 v[164:167], v[88:91], v[124:127], 0
    v_mfma_f32_16x16x32_bf16 v[168:171], v[92:95], v[124:127], 0
    v_mfma_f32_16x16x16_bf16 v[132:135], v[136:137], v[128:129], v[132:135]
    v_mfma_f32_16x16x16_bf16 v[140:143], v[220:221], v[128:129], v[140:143]
    v_mfma_f32_16x16x16_bf16 v[144:147], v[222:223], v[128:129], v[144:147]
    v_mfma_f32_16x16x16_bf16 v[148:151], v[224:225], v[128:129], v[148:151]
    v_mfma_f32_16x16x16_bf16 v[152:155], v[226:227], v[128:129], v[152:155]
    v_mfma_f32_16x16x16_bf16 v[156:159], v[228:229], v[128:129], v[156:159]
    v_mfma_f32_16x16x16_bf16 v[160:163], v[230:231], v[128:129], v[160:163]
    v_mfma_f32_16x16x16_bf16 v[164:167], v[232:233], v[128:129], v[164:167]
    v_mfma_f32_16x16x16_bf16 v[168:171], v[234:235], v[128:129], v[168:171]
    v_rcp_f32 v250, v132
    s_nop 0
    v_pk_mul_f32 v[140:141], v[140:141], v[250:251] op_sel_hi:[1,0]
    v_pk_mul_f32 v[142:143], v[142:143], v[250:251] op_sel_hi:[1,0]
    v_pk_mul_f32 v[144:145], v[144:145], v[250:251] op_sel_hi:[1,0]
    v_pk_mul_f32 v[146:147], v[146:147], v[250:251] op_sel_hi:[1,0]
    v_pk_mul_f32 v[148:149], v[148:149], v[250:251] op_sel_hi:[1,0]
    v_pk_mul_f32 v[150:151], v[150:151], v[250:251] op_sel_hi:[1,0]
    v_pk_mul_f32 v[152:153], v[152:153], v[250:251] op_sel_hi:[1,0]
    v_pk_mul_f32 v[154:155], v[154:155], v[250:251] op_sel_hi:[1,0]
    v_pk_mul_f32 v[156:157], v[156:157], v[250:251] op_sel_hi:[1,0]
    v_pk_mul_f32 v[158:159], v[158:159], v[250:251] op_sel_hi:[1,0]
    v_pk_mul_f32 v[160:161], v[160:161], v[250:251] op_sel_hi:[1,0]
    v_pk_mul_f32 v[162:163], v[162:163], v[250:251] op_sel_hi:[1,0]
    v_pk_mul_f32 v[164:165], v[164:165], v[250:251] op_sel_hi:[1,0]
    v_pk_mul_f32 v[166:167], v[166:167], v[250:251] op_sel_hi:[1,0]
    v_pk_mul_f32 v[168:169], v[168:169], v[250:251] op_sel_hi:[1,0]
    v_pk_mul_f32 v[170:171], v[170:171], v[250:251] op_sel_hi:[1,0]
    v_cvt_pk_bf16_f32 v140, v140, v141
    v_cvt_pk_bf16_f32 v141, v142, v143
    v_cvt_pk_bf16_f32 v142, v144, v145
    v_cvt_pk_bf16_f32 v143, v146, v147
    v_cvt_pk_bf16_f32 v144, v148, v149
    v_cvt_pk_bf16_f32 v145, v150, v151
    v_cvt_pk_bf16_f32 v146, v152, v153
    v_cvt_pk_bf16_f32 v147, v154, v155
    v_cvt_pk_bf16_f32 v148, v156, v157
    v_cvt_pk_bf16_f32 v149, v158, v159
    v_cvt_pk_bf16_f32 v150, v160, v161
    v_cvt_pk_bf16_f32 v151, v162, v163
    v_cvt_pk_bf16_f32 v152, v164, v165
    v_cvt_pk_bf16_f32 v153, v166, v167
    v_cvt_pk_bf16_f32 v154, v168, v169
    v_cvt_pk_bf16_f32 v155, v170, v171
    ds_write_b128 v243, v[140:143]
    ds_write_b128 v243, v[144:147] offset:1024
    ds_write_b128 v243, v[148:151] offset:2048
    ds_write_b128 v243, v[152:155] offset:3072
    s_waitcnt lgkmcnt(0)
    s_barrier
    s_lshr_b32 s25, s82, 1
    s_lshl_b32 s24, s25, 12
    v_add_u32 v246, s24, v244
    ds_read_b128 v[0:3], v246
    ds_read_b128 v[4:7], v246 offset:1024
    ds_read_b128 v[8:11], v246 offset:2048
    ds_read_b128 v[12:15], v246 offset:3072
    ds_read_b128 v[32:35], v246 offset:8192
    ds_read_b128 v[36:39], v246 offset:9216
    ds_read_b128 v[40:43], v246 offset:10240
    ds_read_b128 v[44:47], v246 offset:11264
    s_lshl_b32 s25, s25, 14
    s_add_u32 s51, s51, s25
    v_xor_b32 v243, 0x4000, v243
    s_waitcnt lgkmcnt(7)
    v_mfma_f32_16x16x32_bf16 v[172:175], a[0:3], v[0:3], 0
    v_mfma_f32_16x16x32_bf16 v[176:179], a[4:7], v[0:3], 0
    s_waitcnt lgkmcnt(6)
    v_mfma_f32_16x16x32_bf16 v[172:175], a[32:35], v[4:7], v[172:175]
    v_mfma_f32_16x16x32_bf16 v[176:179], a[36:39], v[4:7], v[176:179]
    s_waitcnt lgkmcnt(5)
    v_mfma_f32_16x16x32_bf16 v[172:175], a[64:67], v[8:11], v[172:175]
    v_mfma_f32_16x16x32_bf16 v[176:179], a[68:71], v[8:11], v[176:179]
    s_waitcnt lgkmcnt(4)
    v_mfma_f32_16x16x32_bf16 v[172:175], a[96:99], v[12:15], v[172:175]
    v_mfma_f32_16x16x32_bf16 v[176:179], a[100:103], v[12:15], v[176:179]
    s_waitcnt lgkmcnt(3)
    v_mfma_f32_16x16x32_bf16 v[172:175], a[128:131], v[32:35], v[172:175]
    v_mfma_f32_16x16x32_bf16 v[176:179], a[132:135], v[32:35], v[176:179]
    s_waitcnt lgkmcnt(2)
    v_mfma_f32_16x16x32_bf16 v[172:175], a[160:163], v[36:39], v[172:175]
    v_mfma_f32_16x16x32_bf16 v[176:179], a[164:167], v[36:39], v[176:179]
    s_waitcnt lgkmcnt(1)
    v_mfma_f32_16x16x32_bf16 v[172:175], a[192:195], v[40:43], v[172:175]
    v_mfma_f32_16x16x32_bf16 v[176:179], a[196:199], v[40:43], v[176:179]
    s_waitcnt lgkmcnt(0)
    v_mfma_f32_16x16x32_bf16 v[172:175], a[224:227], v[44:47], v[172:175]
    v_mfma_f32_16x16x32_bf16 v[176:179], a[228:231], v[44:47], v[176:179]
    v_mfma_f32_16x16x32_bf16 v[180:183], a[8:11], v[0:3], 0
    v_mfma_f32_16x16x32_bf16 v[184:187], a[12:15], v[0:3], 0
    ds_read_b128 v[16:19], v244 offset:4096
    v_mfma_f32_16x16x32_bf16 v[180:183], a[40:43], v[4:7], v[180:183]
    v_mfma_f32_16x16x32_bf16 v[184:187], a[44:47], v[4:7], v[184:187]
    ds_read_b128 v[20:23], v244 offset:5120
    v_cvt_pk_bf16_f32 v140, v172, v173
    v_cvt_pk_bf16_f32 v141, v174, v175
    v_cvt_pk_bf16_f32 v142, v176, v177
    v_cvt_pk_bf16_f32 v143, v178, v179
    s_add_u32 s24, s51, 0
    s_cmp_lg_u32 s83, 0
    s_cbranch_scc1 L_near_140
    buffer_store_dwordx4 v[140:143], v242, s[8:11], s24 offen sc1
    s_branch L_far_141
L_near_140:
    buffer_store_dwordx4 v[140:143], v242, s[8:11], s24 offen
L_far_141:
    v_mfma_f32_16x16x32_bf16 v[180:183], a[72:75], v[8:11], v[180:183]
    v_mfma_f32_16x16x32_bf16 v[184:187], a[76:79], v[8:11], v[184:187]
    ds_read_b128 v[24:27], v244 offset:6144
    v_mfma_f32_16x16x32_bf16 v[180:183], a[104:107], v[12:15], v[180:183]
    v_mfma_f32_16x16x32_bf16 v[184:187], a[108:111], v[12:15], v[184:187]
    ds_read_b128 v[28:31], v244 offset:7168
    v_mfma_f32_16x16x32_bf16 v[180:183], a[136:139], v[32:35], v[180:183]
    v_mfma_f32_16x16x32_bf16 v[184:187], a[140:143], v[32:35], v[184:187]
    ds_read_b128 v[48:51], v244 offset:12288
    v_mfma_f32_16x16x32_bf16 v[180:183], a[168:171], v[36:39], v[180:183]
    v_mfma_f32_16x16x32_bf16 v[184:187], a[172:175], v[36:39], v[184:187]
    ds_read_b128 v[52:55], v244 offset:13312
    v_mfma_f32_16x16x32_bf16 v[180:183], a[200:203], v[40:43], v[180:183]
    v_mfma_f32_16x16x32_bf16 v[184:187], a[204:207], v[40:43], v[184:187]
    ds_read_b128 v[56:59], v244 offset:14336
    v_mfma_f32_16x16x32_bf16 v[180:183], a[232:235], v[44:47], v[180:183]
    v_mfma_f32_16x16x32_bf16 v[184:187], a[236:239], v[44:47], v[184:187]
    ds_read_b128 v[60:63], v244 offset:15360
    v_mfma_f32_16x16x32_bf16 v[188:191], a[16:19], v[0:3], 0
    v_mfma_f32_16x16x32_bf16 v[192:195], a[20:23], v[0:3], 0
    v_mfma_f32_16x16x32_bf16 v[188:191], a[48:51], v[4:7], v[188:191]
    v_mfma_f32_16x16x32_bf16 v[192:195], a[52:55], v[4:7], v[192:195]
    v_cvt_pk_bf16_f32 v144, v180, v181
    v_cvt_pk_bf16_f32 v145, v182, v183
    v_cvt_pk_bf16_f32 v146, v184, v185
    v_cvt_pk_bf16_f32 v147, v186, v187
    s_cmp_lg_u32 s83, 0
    s_cbranch_scc1 L_near_142
    buffer_store_dwordx4 v[144:147], v242, s[8:11], s24 offen offset:64 sc1
    s_branch L_far_143
L_near_142:
    buffer_store_dwordx4 v[144:147], v242, s[8:11], s24 offen offset:64
L_far_143:
    v_mfma_f32_16x16x32_bf16 v[188:191], a[80:83], v[8:11], v[188:191]
    v_mfma_f32_16x16x32_bf16 v[192:195], a[84:87], v[8:11], v[192:195]
    v_mfma_f32_16x16x32_bf16 v[188:191], a[112:115], v[12:15], v[188:191]
    v_mfma_f32_16x16x32_bf16 v[192:195], a[116:119], v[12:15], v[192:195]
    v_mfma_f32_16x16x32_bf16 v[188:191], a[144:147], v[32:35], v[188:191]
    v_mfma_f32_16x16x32_bf16 v[192:195], a[148:151], v[32:35], v[192:195]
    v_mfma_f32_16x16x32_bf16 v[188:191], a[176:179], v[36:39], v[188:191]
    v_mfma_f32_16x16x32_bf16 v[192:195], a[180:183], v[36:39], v[192:195]
    v_mfma_f32_16x16x32_bf16 v[188:191], a[208:211], v[40:43], v[188:191]
    v_mfma_f32_16x16x32_bf16 v[192:195], a[212:215], v[40:43], v[192:195]
    v_mfma_f32_16x16x32_bf16 v[188:191], a[240:243], v[44:47], v[188:191]
    v_mfma_f32_16x16x32_bf16 v[192:195], a[244:247], v[44:47], v[192:195]
    v_mfma_f32_16x16x32_bf16 v[196:199], a[24:27], v[0:3], 0
    v_mfma_f32_16x16x32_bf16 v[200:203], a[28:31], v[0:3], 0
    v_mfma_f32_16x16x32_bf16 v[196:199], a[56:59], v[4:7], v[196:199]
    v_mfma_f32_16x16x32_bf16 v[200:203], a[60:63], v[4:7], v[200:203]
    v_cvt_pk_bf16_f32 v148, v188, v189
    v_cvt_pk_bf16_f32 v149, v190, v191
    v_cvt_pk_bf16_f32 v150, v192, v193
    v_cvt_pk_bf16_f32 v151, v194, v195
    s_cmp_lg_u32 s83, 0
    s_cbranch_scc1 L_near_144
    buffer_store_dwordx4 v[148:151], v242, s[8:11], s24 offen offset:128 sc1
    s_branch L_far_145
L_near_144:
    buffer_store_dwordx4 v[148:151], v242, s[8:11], s24 offen offset:128
L_far_145:
    v_mfma_f32_16x16x32_bf16 v[196:199], a[88:91], v[8:11], v[196:199]
    v_mfma_f32_16x16x32_bf16 v[200:203], a[92:95], v[8:11], v[200:203]
    v_mfma_f32_16x16x32_bf16 v[196:199], a[120:123], v[12:15], v[196:199]
    v_mfma_f32_16x16x32_bf16 v[200:203], a[124:127], v[12:15], v[200:203]
    v_mfma_f32_16x16x32_bf16 v[196:199], a[152:155], v[32:35], v[196:199]
    v_mfma_f32_16x16x32_bf16 v[200:203], a[156:159], v[32:35], v[200:203]
    v_mfma_f32_16x16x32_bf16 v[196:199], a[184:187], v[36:39], v[196:199]
    v_mfma_f32_16x16x32_bf16 v[200:203], a[188:191], v[36:39], v[200:203]
    v_mfma_f32_16x16x32_bf16 v[196:199], a[216:219], v[40:43], v[196:199]
    v_mfma_f32_16x16x32_bf16 v[200:203], a[220:223], v[40:43], v[200:203]
    v_mfma_f32_16x16x32_bf16 v[196:199], a[248:251], v[44:47], v[196:199]
    v_mfma_f32_16x16x32_bf16 v[200:203], a[252:255], v[44:47], v[200:203]
    v_xor_b32 v244, 0x4000, v244
    s_cmp_lg_u32 s82, 0
    s_cbranch_scc1 L_half_138
    s_waitcnt lgkmcnt(0)
    v_mfma_f32_16x16x32_bf16 v[204:207], a[0:3], v[16:19], 0
    v_mfma_f32_16x16x32_bf16 v[208:211], a[4:7], v[16:19], 0
    v_mfma_f32_16x16x32_bf16 v[204:207], a[32:35], v[20:23], v[204:207]
    v_mfma_f32_16x16x32_bf16 v[208:211], a[36:39], v[20:23], v[208:211]
    v_cvt_pk_bf16_f32 v152, v196, v197
    v_cvt_pk_bf16_f32 v153, v198, v199
    v_cvt_pk_bf16_f32 v154, v200, v201
    v_cvt_pk_bf16_f32 v155, v202, v203
    s_cmp_lg_u32 s83, 0
    s_cbranch_scc1 L_near_146
    buffer_store_dwordx4 v[152:155], v242, s[8:11], s24 offen offset:192 sc1
    s_branch L_far_147
L_near_146:
    buffer_store_dwordx4 v[152:155], v242, s[8:11], s24 offen offset:192
L_far_147:
    v_mfma_f32_16x16x32_bf16 v[204:207], a[64:67], v[24:27], v[204:207]
    v_mfma_f32_16x16x32_bf16 v[208:211], a[68:71], v[24:27], v[208:211]
    v_mfma_f32_16x16x32_bf16 v[204:207], a[96:99], v[28:31], v[204:207]
    v_mfma_f32_16x16x32_bf16 v[208:211], a[100:103], v[28:31], v[208:211]
    v_mfma_f32_16x16x32_bf16 v[204:207], a[128:131], v[48:51], v[204:207]
    v_mfma_f32_16x16x32_bf16 v[208:211], a[132:135], v[48:51], v[208:211]
    v_mfma_f32_16x16x32_bf16 v[204:207], a[160:163], v[52:55], v[204:207]
    v_mfma_f32_16x16x32_bf16 v[208:211], a[164:167], v[52:55], v[208:211]
    v_mfma_f32_16x16x32_bf16 v[204:207], a[192:195], v[56:59], v[204:207]
    v_mfma_f32_16x16x32_bf16 v[208:211], a[196:199], v[56:59], v[208:211]
    v_mfma_f32_16x16x32_bf16 v[204:207], a[224:227], v[60:63], v[204:207]
    v_mfma_f32_16x16x32_bf16 v[208:211], a[228:231], v[60:63], v[208:211]
    v_mfma_f32_16x16x32_bf16 v[212:215], a[8:11], v[16:19], 0
    v_mfma_f32_16x16x32_bf16 v[216:219], a[12:15], v[16:19], 0
    v_mfma_f32_16x16x32_bf16 v[212:215], a[40:43], v[20:23], v[212:215]
    v_mfma_f32_16x16x32_bf16 v[216:219], a[44:47], v[20:23], v[216:219]
    v_cvt_pk_bf16_f32 v140, v204, v205
    v_cvt_pk_bf16_f32 v141, v206, v207
    v_cvt_pk_bf16_f32 v142, v208, v209
    v_cvt_pk_bf16_f32 v143, v210, v211
    s_add_u32 s24, s51, 16384
    s_cmp_lg_u32 s83, 0
    s_cbranch_scc1 L_near_148
    buffer_store_dwordx4 v[140:143], v242, s[8:11], s24 offen sc1
    s_branch L_far_149
L_near_148:
    buffer_store_dwordx4 v[140:143], v242, s[8:11], s24 offen
L_far_149:
    v_mfma_f32_16x16x32_bf16 v[212:215], a[72:75], v[24:27], v[212:215]
    v_mfma_f32_16x16x32_bf16 v[216:219], a[76:79], v[24:27], v[216:219]
    v_mfma_f32_16x16x32_bf16 v[212:215], a[104:107], v[28:31], v[212:215]
    v_mfma_f32_16x16x32_bf16 v[216:219], a[108:111], v[28:31], v[216:219]
    v_mfma_f32_16x16x32_bf16 v[212:215], a[136:139], v[48:51], v[212:215]
    v_mfma_f32_16x16x32_bf16 v[216:219], a[140:143], v[48:51], v[216:219]
    v_mfma_f32_16x16x32_bf16 v[212:215], a[168:171], v[52:55], v[212:215]
    v_mfma_f32_16x16x32_bf16 v[216:219], a[172:175], v[52:55], v[216:219]
    v_mfma_f32_16x16x32_bf16 v[212:215], a[200:203], v[56:59], v[212:215]
    v_mfma_f32_16x16x32_bf16 v[216:219], a[204:207], v[56:59], v[216:219]
    v_mfma_f32_16x16x32_bf16 v[212:215], a[232:235], v[60:63], v[212:215]
    v_mfma_f32_16x16x32_bf16 v[216:219], a[236:239], v[60:63], v[216:219]
    s_waitcnt vmcnt(5)
    v_mfma_f32_16x16x32_bf16 v[220:223], a[16:19], v[16:19], 0
    v_mfma_f32_16x16x32_bf16 v[224:227], a[20:23], v[16:19], 0
    v_mfma_f32_16x16x32_bf16 v[220:223], a[48:51], v[20:23], v[220:223]
    v_mfma_f32_16x16x32_bf16 v[224:227], a[52:55], v[20:23], v[224:227]
    v_cvt_pk_bf16_f32 v144, v212, v213
    v_cvt_pk_bf16_f32 v145, v214, v215
    v_cvt_pk_bf16_f32 v146, v216, v217
    v_cvt_pk_bf16_f32 v147, v218, v219
    s_cmp_lg_u32 s83, 0
    s_cbranch_scc1 L_near_150
    buffer_store_dwordx4 v[144:147], v242, s[8:11], s24 offen offset:64 sc1
    s_branch L_far_151
L_near_150:
    buffer_store_dwordx4 v[144:147], v242, s[8:11], s24 offen offset:64
L_far_151:
    v_mfma_f32_16x16x32_bf16 v[220:223], a[80:83], v[24:27], v[220:223]
    v_mfma_f32_16x16x32_bf16 v[224:227], a[84:87], v[24:27], v[224:227]
    v_mfma_f32_16x16x32_bf16 v[220:223], a[112:115], v[28:31], v[220:223]
    v_mfma_f32_16x16x32_bf16 v[224:227], a[116:119], v[28:31], v[224:227]
    v_mfma_f32_16x16x32_bf16 v[220:223], a[144:147], v[48:51], v[220:223]
    v_mfma_f32_16x16x32_bf16 v[224:227], a[148:151], v[48:51], v[224:227]
    v_mfma_f32_16x16x32_bf16 v[220:223], a[176:179], v[52:55], v[220:223]
    v_mfma_f32_16x16x32_bf16 v[224:227], a[180:183], v[52:55], v[224:227]
    v_mfma_f32_16x16x32_bf16 v[220:223], a[208:211], v[56:59], v[220:223]
    v_mfma_f32_16x16x32_bf16 v[224:227], a[212:215], v[56:59], v[224:227]
    v_mfma_f32_16x16x32_bf16 v[220:223], a[240:243], v[60:63], v[220:223]
    v_mfma_f32_16x16x32_bf16 v[224:227], a[244:247], v[60:63], v[224:227]
    v_mfma_f32_16x16x32_bf16 v[228:231], a[24:27], v[16:19], 0
    v_mfma_f32_16x16x32_bf16 v[232:235], a[28:31], v[16:19], 0
    v_mfma_f32_16x16x32_bf16 v[228:231], a[56:59], v[20:23], v[228:231]
    v_mfma_f32_16x16x32_bf16 v[232:235], a[60:63], v[20:23], v[232:235]
    v_cvt_pk_bf16_f32 v148, v220, v221
    v_cvt_pk_bf16_f32 v149, v222, v223
    v_cvt_pk_bf16_f32 v150, v224, v225
    v_cvt_pk_bf16_f32 v151, v226, v227
    s_cmp_lg_u32 s83, 0
    s_cbranch_scc1 L_near_152
    buffer_store_dwordx4 v[148:151], v242, s[8:11], s24 offen offset:128 sc1
    s_branch L_far_153
L_near_152:
    buffer_store_dwordx4 v[148:151], v242, s[8:11], s24 offen offset:128
L_far_153:
    v_mfma_f32_16x16x32_bf16 v[228:231], a[88:91], v[24:27], v[228:231]
    v_mfma_f32_16x16x32_bf16 v[232:235], a[92:95], v[24:27], v[232:235]
    v_mfma_f32_16x16x32_bf16 v[228:231], a[120:123], v[28:31], v[228:231]
    v_mfma_f32_16x16x32_bf16 v[232:235], a[124:127], v[28:31], v[232:235]
    v_mfma_f32_16x16x32_bf16 v[228:231], a[152:155], v[48:51], v[228:231]
    v_mfma_f32_16x16x32_bf16 v[232:235], a[156:159], v[48:51], v[232:235]
    v_mfma_f32_16x16x32_bf16 v[228:231], a[184:187], v[52:55], v[228:231]
    v_mfma_f32_16x16x32_bf16 v[232:235], a[188:191], v[52:55], v[232:235]
    v_mfma_f32_16x16x32_bf16 v[228:231], a[216:219], v[56:59], v[228:231]
    v_mfma_f32_16x16x32_bf16 v[232:235], a[220:223], v[56:59], v[232:235]
    v_mfma_f32_16x16x32_bf16 v[228:231], a[248:251], v[60:63], v[228:231]
    v_mfma_f32_16x16x32_bf16 v[232:235], a[252:255], v[60:63], v[232:235]
    s_nop 3
    v_cvt_pk_bf16_f32 v152, v228, v229
    v_cvt_pk_bf16_f32 v153, v230, v231
    s_nop 1
    v_cvt_pk_bf16_f32 v154, v232, v233
    v_cvt_pk_bf16_f32 v155, v234, v235
    s_cmp_lg_u32 s83, 0
    s_cbranch_scc1 L_near_154
    buffer_store_dwordx4 v[152:155], v242, s[8:11], s24 offen offset:192 sc1
    s_branch L_far_155
L_near_154:
    buffer_store_dwordx4 v[152:155], v242, s[8:11], s24 offen offset:192
L_far_155:
    s_branch L_proj_139
L_half_138:
    s_nop 7
    v_cvt_pk_bf16_f32 v152, v196, v197
    v_cvt_pk_bf16_f32 v153, v198, v199
    v_cvt_pk_bf16_f32 v154, v200, v201
    v_cvt_pk_bf16_f32 v155, v202, v203
    s_cmp_lg_u32 s83, 0
    s_cbranch_scc1 L_near_156
    buffer_store_dwordx4 v[152:155], v242, s[8:11], s24 offen offset:192 sc1
    s_branch L_far_157
L_near_156:
    buffer_store_dwordx4 v[152:155], v242, s[8:11], s24 offen offset:192
L_far_157:
    s_waitcnt lgkmcnt(0)
L_proj_139:
    s_waitcnt vmcnt(0)
    s_barrier
    s_lshl_b32 s24, s20, 2
    s_add_u32 s24, s24, s52
    s_cmp_lg_u32 s100, 0
    s_cbranch_scc1 L_flag_158
    v_mov_b32 v246, 1
    s_mov_b64 exec, 1
    s_cmp_lg_u32 s83, 0
    s_cbranch_scc1 L_near_159
    buffer_store_dword v246, off, s[8:11], s24 sc1
    s_branch L_far_160
L_near_159:
    buffer_store_dword v246, off, s[8:11], s24
L_far_160:
    s_mov_b64 exec, -1
L_flag_158:
    v_lshrrev_b32 v246, 2, v240
    s_cmp_lg_u32 s100, 0
    s_cbranch_scc1 L_polls_163
    s_mov_b32 exec_lo, 0xffff
    s_mov_b32 exec_hi, 0
    s_mov_b32 s96, 0
L_poll_161:
    buffer_load_dword v247, v246, s[8:11], s52 offen sc1
    s_waitcnt vmcnt(0)
    v_cmp_gt_u32 vcc, 1, v247
    s_cbranch_vccz L_polld_162
    s_sleep 1
    s_add_u32 s96, s96, 1
    s_cmp_lt_u32 s96, 0x10000
    s_cbranch_scc1 L_poll_161
L_polld_162:
    s_mov_b64 exec, -1
L_polls_163:
    s_barrier
    s_cmp_lg_u32 s82, 0
    s_cselect_b32 s24, 1, 2
    s_cmp_ge_u32 s100, s24
    s_cbranch_scc1 L_nofin_164
    s_lshr_b32 s62, s60, 5
    s_lshl_b32 s62, s62, 19
    s_and_b32 s63, s60, 31
    s_lshl_b32 s63, s63, 10
    s_add_u32 s62, s62, s63
    s_add_u32 s62, s62, 0x4000000
    buffer_load_dwordx4 v[0:3], v240, s[8:11], s62 offen
    s_add_u32 s62, s62, 32768
    buffer_load_dwordx4 v[4:7], v240, s[8:11], s62 offen
    s_add_u32 s62, s62, 32768
    buffer_load_dwordx4 v[8:11], v240, s[8:11], s62 offen
    s_add_u32 s62, s62, 32768
    buffer_load_dwordx4 v[12:15], v240, s[8:11], s62 offen
    s_add_u32 s62, s62, 32768
    buffer_load_dwordx4 v[16:19], v240, s[8:11], s62 offen
    s_add_u32 s62, s62, 32768
    buffer_load_dwordx4 v[20:23], v240, s[8:11], s62 offen
    s_add_u32 s62, s62, 32768
    buffer_load_dwordx4 v[24:27], v240, s[8:11], s62 offen
    s_add_u32 s62, s62, 32768
    buffer_load_dwordx4 v[28:31], v240, s[8:11], s62 offen
    s_add_u32 s62, s62, 32768
    buffer_load_dwordx4 v[32:35], v240, s[8:11], s62 offen
    s_add_u32 s62, s62, 32768
    buffer_load_dwordx4 v[36:39], v240, s[8:11], s62 offen
    s_add_u32 s62, s62, 32768
    buffer_load_dwordx4 v[40:43], v240, s[8:11], s62 offen
    s_add_u32 s62, s62, 32768
    buffer_load_dwordx4 v[44:47], v240, s[8:11], s62 offen
    s_add_u32 s62, s62, 32768
    buffer_load_dwordx4 v[48:51], v240, s[8:11], s62 offen
    s_add_u32 s62, s62, 32768
    buffer_load_dwordx4 v[52:55], v240, s[8:11], s62 offen
    s_add_u32 s62, s62, 32768
    buffer_load_dwordx4 v[56:59], v240, s[8:11], s62 offen
    s_add_u32 s62, s62, 32768
    buffer_load_dwordx4 v[60:63], v240, s[8:11], s62 offen
    v_mov_b32 v68, 0
    v_mov_b32 v69, 0
    v_mov_b32 v70, 0
    v_mov_b32 v71, 0
    v_mov_b32 v72, 0
    v_mov_b32 v73, 0
    v_mov_b32 v74, 0
    v_mov_b32 v75, 0
    s_waitcnt vmcnt(15)
    v_dot2_f32_bf16 v68, v0, s65, v68
    v_dot2_f32_bf16 v69, v0, s66, v69
    v_dot2_f32_bf16 v70, v1, s65, v70
    v_dot2_f32_bf16 v71, v1, s66, v71
    v_dot2_f32_bf16 v72, v2, s65, v72
    v_dot2_f32_bf16 v73, v2, s66, v73
    v_dot2_f32_bf16 v74, v3, s65, v74
    v_dot2_f32_bf16 v75, v3, s66, v75
    s_waitcnt vmcnt(14)
    v_dot2_f32_bf16 v68, v4, s65, v68
    v_dot2_f32_bf16 v69, v4, s66, v69
    v_dot2_f32_bf16 v70, v5, s65, v70
    v_dot2_f32_bf16 v71, v5, s66, v71
    v_dot2_f32_bf16 v72, v6, s65, v72
    v_dot2_f32_bf16 v73, v6, s66, v73
    v_dot2_f32_bf16 v74, v7, s65, v74
    v_dot2_f32_bf16 v75, v7, s66, v75
    s_waitcnt vmcnt(13)
    v_dot2_f32_bf16 v68, v8, s65, v68
    v_dot2_f32_bf16 v69, v8, s66, v69
    v_dot2_f32_bf16 v70, v9, s65, v70
    v_dot2_f32_bf16 v71, v9, s66, v71
    v_dot2_f32_bf16 v72, v10, s65, v72
    v_dot2_f32_bf16 v73, v10, s66, v73
    v_dot2_f32_bf16 v74, v11, s65, v74
    v_dot2_f32_bf16 v75, v11, s66, v75
    s_waitcnt vmcnt(12)
    v_dot2_f32_bf16 v68, v12, s65, v68
    v_dot2_f32_bf16 v69, v12, s66, v69
    v_dot2_f32_bf16 v70, v13, s65, v70
    v_dot2_f32_bf16 v71, v13, s66, v71
    v_dot2_f32_bf16 v72, v14, s65, v72
    v_dot2_f32_bf16 v73, v14, s66, v73
    v_dot2_f32_bf16 v74, v15, s65, v74
    v_dot2_f32_bf16 v75, v15, s66, v75
    s_waitcnt vmcnt(11)
    v_dot2_f32_bf16 v68, v16, s65, v68
    v_dot2_f32_bf16 v69, v16, s66, v69
    v_dot2_f32_bf16 v70, v17, s65, v70
    v_dot2_f32_bf16 v71, v17, s66, v71
    v_dot2_f32_bf16 v72, v18, s65, v72
    v_dot2_f32_bf16 v73, v18, s66, v73
    v_dot2_f32_bf16 v74, v19, s65, v74
    v_dot2_f32_bf16 v75, v19, s66, v75
    s_waitcnt vmcnt(10)
    v_dot2_f32_bf16 v68, v20, s65, v68
    v_dot2_f32_bf16 v69, v20, s66, v69
    v_dot2_f32_bf16 v70, v21, s65, v70
    v_dot2_f32_bf16 v71, v21, s66, v71
    v_dot2_f32_bf16 v72, v22, s65, v72
    v_dot2_f32_bf16 v73, v22, s66, v73
    v_dot2_f32_bf16 v74, v23, s65, v74
    v_dot2_f32_bf16 v75, v23, s66, v75
    s_waitcnt vmcnt(9)
    v_dot2_f32_bf16 v68, v24, s65, v68
    v_dot2_f32_bf16 v69, v24, s66, v69
    v_dot2_f32_bf16 v70, v25, s65, v70
    v_dot2_f32_bf16 v71, v25, s66, v71
    v_dot2_f32_bf16 v72, v26, s65, v72
    v_dot2_f32_bf16 v73, v26, s66, v73
    v_dot2_f32_bf16 v74, v27, s65, v74
    v_dot2_f32_bf16 v75, v27, s66, v75
    s_waitcnt vmcnt(8)
    v_dot2_f32_bf16 v68, v28, s65, v68
    v_dot2_f32_bf16 v69, v28, s66, v69
    v_dot2_f32_bf16 v70, v29, s65, v70
    v_dot2_f32_bf16 v71, v29, s66, v71
    v_dot2_f32_bf16 v72, v30, s65, v72
    v_dot2_f32_bf16 v73, v30, s66, v73
    v_dot2_f32_bf16 v74, v31, s65, v74
    v_dot2_f32_bf16 v75, v31, s66, v75
    s_waitcnt vmcnt(7)
    v_dot2_f32_bf16 v68, v32, s65, v68
    v_dot2_f32_bf16 v69, v32, s66, v69
    v_dot2_f32_bf16 v70, v33, s65, v70
    v_dot2_f32_bf16 v71, v33, s66, v71
    v_dot2_f32_bf16 v72, v34, s65, v72
    v_dot2_f32_bf16 v73, v34, s66, v73
    v_dot2_f32_bf16 v74, v35, s65, v74
    v_dot2_f32_bf16 v75, v35, s66, v75
    s_waitcnt vmcnt(6)
    v_dot2_f32_bf16 v68, v36, s65, v68
    v_dot2_f32_bf16 v69, v36, s66, v69
    v_dot2_f32_bf16 v70, v37, s65, v70
    v_dot2_f32_bf16 v71, v37, s66, v71
    v_dot2_f32_bf16 v72, v38, s65, v72
    v_dot2_f32_bf16 v73, v38, s66, v73
    v_dot2_f32_bf16 v74, v39, s65, v74
    v_dot2_f32_bf16 v75, v39, s66, v75
    s_waitcnt vmcnt(5)
    v_dot2_f32_bf16 v68, v40, s65, v68
    v_dot2_f32_bf16 v69, v40, s66, v69
    v_dot2_f32_bf16 v70, v41, s65, v70
    v_dot2_f32_bf16 v71, v41, s66, v71
    v_dot2_f32_bf16 v72, v42, s65, v72
    v_dot2_f32_bf16 v73, v42, s66, v73
    v_dot2_f32_bf16 v74, v43, s65, v74
    v_dot2_f32_bf16 v75, v43, s66, v75
    s_waitcnt vmcnt(4)
    v_dot2_f32_bf16 v68, v44, s65, v68
    v_dot2_f32_bf16 v69, v44, s66, v69
    v_dot2_f32_bf16 v70, v45, s65, v70
    v_dot2_f32_bf16 v71, v45, s66, v71
    v_dot2_f32_bf16 v72, v46, s65, v72
    v_dot2_f32_bf16 v73, v46, s66, v73
    v_dot2_f32_bf16 v74, v47, s65, v74
    v_dot2_f32_bf16 v75, v47, s66, v75
    s_waitcnt vmcnt(3)
    v_dot2_f32_bf16 v68, v48, s65, v68
    v_dot2_f32_bf16 v69, v48, s66, v69
    v_dot2_f32_bf16 v70, v49, s65, v70
    v_dot2_f32_bf16 v71, v49, s66, v71
    v_dot2_f32_bf16 v72, v50, s65, v72
    v_dot2_f32_bf16 v73, v50, s66, v73
    v_dot2_f32_bf16 v74, v51, s65, v74
    v_dot2_f32_bf16 v75, v51, s66, v75
    s_waitcnt vmcnt(2)
    v_dot2_f32_bf16 v68, v52, s65, v68
    v_dot2_f32_bf16 v69, v52, s66, v69
    v_dot2_f32_bf16 v70, v53, s65, v70
    v_dot2_f32_bf16 v71, v53, s66, v71
    v_dot2_f32_bf16 v72, v54, s65, v72
    v_dot2_f32_bf16 v73, v54, s66, v73
    v_dot2_f32_bf16 v74, v55, s65, v74
    v_dot2_f32_bf16 v75, v55, s66, v75
    s_waitcnt vmcnt(1)
    v_dot2_f32_bf16 v68, v56, s65, v68
    v_dot2_f32_bf16 v69, v56, s66, v69
    v_dot2_f32_bf16 v70, v57, s65, v70
    v_dot2_f32_bf16 v71, v57, s66, v71
    v_dot2_f32_bf16 v72, v58, s65, v72
    v_dot2_f32_bf16 v73, v58, s66, v73
    v_dot2_f32_bf16 v74, v59, s65, v74
    v_dot2_f32_bf16 v75, v59, s66, v75
    s_waitcnt vmcnt(0)
    v_dot2_f32_bf16 v68, v60, s65, v68
    v_dot2_f32_bf16 v69, v60, s66, v69
    v_dot2_f32_bf16 v70, v61, s65, v70
    v_dot2_f32_bf16 v71, v61, s66, v71
    v_dot2_f32_bf16 v72, v62, s65, v72
    v_dot2_f32_bf16 v73, v62, s66, v73
    v_dot2_f32_bf16 v74, v63, s65, v74
    v_dot2_f32_bf16 v75, v63, s66, v75
    v_cvt_pk_bf16_f32 v0, v68, v69
    v_cvt_pk_bf16_f32 v1, v70, v71
    v_cvt_pk_bf16_f32 v2, v72, v73
    v_cvt_pk_bf16_f32 v3, v74, v75
    v_lshlrev_b32 v68, 16, v0
    v_and_b32 v69, 0xffff0000, v0
    v_lshlrev_b32 v76, 16, v96
    v_and_b32 v77, 0xffff0000, v96
    v_lshlrev_b32 v70, 16, v1
    v_and_b32 v71, 0xffff0000, v1
    v_lshlrev_b32 v78, 16, v97
    v_and_b32 v79, 0xffff0000, v97
    v_lshlrev_b32 v72, 16, v2
    v_and_b32 v73, 0xffff0000, v2
    v_lshlrev_b32 v80, 16, v98
    v_and_b32 v81, 0xffff0000, v98
    v_lshlrev_b32 v74, 16, v3
    v_and_b32 v75, 0xffff0000, v3
    v_lshlrev_b32 v82, 16, v99
    v_and_b32 v83, 0xffff0000, v99
    v_pk_add_f32 v[68:69], v[68:69], v[76:77]
    v_pk_add_f32 v[70:71], v[70:71], v[78:79]
    v_pk_add_f32 v[72:73], v[72:73], v[80:81]
    v_pk_add_f32 v[74:75], v[74:75], v[82:83]
    v_cvt_pk_bf16_f32 v4, v68, v69
    v_cvt_pk_bf16_f32 v5, v70, v71
    v_cvt_pk_bf16_f32 v6, v72, v73
    v_cvt_pk_bf16_f32 v7, v74, v75
    v_lshlrev_b32 v68, 16, v4
    v_and_b32 v69, 0xffff0000, v4
    v_lshlrev_b32 v70, 16, v5
    v_and_b32 v71, 0xffff0000, v5
    v_lshlrev_b32 v72, 16, v6
    v_and_b32 v73, 0xffff0000, v6
    v_lshlrev_b32 v74, 16, v7
    v_and_b32 v75, 0xffff0000, v7
    s_add_u32 s62, s64, 0x6000000
    buffer_store_dwordx4 v[4:7], v240, s[8:11], s62 offen sc1
    v_add_f32 v84, v68, v69
    v_add_f32 v84, v84, v70
    v_add_f32 v84, v84, v71
    v_add_f32 v84, v84, v72
    v_add_f32 v84, v84, v73
    v_add_f32 v84, v84, v74
    v_add_f32 v84, v84, v75
    s_nop 1
    v_add_f32_dpp v84, v84, v84 row_ror:1 row_mask:0xf bank_mask:0xf
    s_nop 1
    v_add_f32_dpp v84, v84, v84 row_ror:2 row_mask:0xf bank_mask:0xf
    s_nop 1
    v_add_f32_dpp v84, v84, v84 row_ror:4 row_mask:0xf bank_mask:0xf
    s_nop 1
    v_add_f32_dpp v84, v84, v84 row_ror:8 row_mask:0xf bank_mask:0xf
    v_mov_b32 v85, v84
    s_nop 1
    v_permlane32_swap_b32 v85, v84
    v_add_f32 v84, v85, v84
    v_mov_b32 v85, v84
    s_nop 1
    v_permlane16_swap_b32 v85, v84
    v_add_f32 v84, v85, v84
    v_mul_f32 v84, 0x3b000000, v84
    v_cvt_pk_bf16_f32 v86, v84, v84
    v_and_b32 v86, 0xffff0000, v86
    v_sub_f32 v87, v84, v86
    v_sub_f32 v76, v68, v86
    v_sub_f32 v77, v69, v86
    v_sub_f32 v78, v70, v86
    v_sub_f32 v79, v71, v86
    v_sub_f32 v80, v72, v86
    v_sub_f32 v81, v73, v86
    v_sub_f32 v82, v74, v86
    v_sub_f32 v83, v75, v86
    v_mul_f32 v100, v76, v76
    v_fmac_f32 v100, v77, v77
    v_fmac_f32 v100, v78, v78
    v_fmac_f32 v100, v79, v79
    v_fmac_f32 v100, v80, v80
    v_fmac_f32 v100, v81, v81
    v_fmac_f32 v100, v82, v82
    v_fmac_f32 v100, v83, v83
    s_nop 1
    v_add_f32_dpp v100, v100, v100 row_ror:1 row_mask:0xf bank_mask:0xf
    s_nop 1
    v_add_f32_dpp v100, v100, v100 row_ror:2 row_mask:0xf bank_mask:0xf
    s_nop 1
    v_add_f32_dpp v100, v100, v100 row_ror:4 row_mask:0xf bank_mask:0xf
    s_nop 1
    v_add_f32_dpp v100, v100, v100 row_ror:8 row_mask:0xf bank_mask:0xf
    v_mov_b32 v85, v100
    s_nop 1
    v_permlane32_swap_b32 v85, v100
    v_add_f32 v100, v85, v100
    v_mov_b32 v85, v100
    s_nop 1
    v_permlane16_swap_b32 v85, v100
    v_add_f32 v100, v85, v100
    v_mul_f32 v85, v87, v87
    v_mul_f32 v100, 0x3b000000, v100
    v_sub_f32 v100, v100, v85
    v_max_f32 v100, 0, v100
    v_cvt_pk_bf16_f32 v100, v100, v100
    v_and_b32 v100, 0xffff0000, v100
    v_add_f32 v100, 0x3727c5ac, v100
    v_cvt_pk_bf16_f32 v100, v100, v100
    v_and_b32 v100, 0xffff0000, v100
    v_sqrt_f32 v100, v100
    s_nop 0
    v_cvt_pk_bf16_f32 v100, v100, v100
    v_and_b32 v100, 0xffff0000, v100
    v_rcp_f32 v100, v100
    v_cvt_pk_bf16_f32 v8, v76, v77
    v_cvt_pk_bf16_f32 v9, v78, v79
    v_cvt_pk_bf16_f32 v10, v80, v81
    v_cvt_pk_bf16_f32 v11, v82, v83
    v_lshlrev_b32 v76, 16, v8
    v_and_b32 v77, 0xffff0000, v8
    v_lshlrev_b32 v78, 16, v9
    v_and_b32 v79, 0xffff0000, v9
    v_lshlrev_b32 v80, 16, v10
    v_and_b32 v81, 0xffff0000, v10
    v_lshlrev_b32 v82, 16, v11
    v_and_b32 v83, 0xffff0000, v11
    v_mul_f32 v76, v100, v76
    v_mul_f32 v77, v100, v77
    v_mul_f32 v78, v100, v78
    v_mul_f32 v79, v100, v79
    v_mul_f32 v80, v100, v80
    v_mul_f32 v81, v100, v81
    v_mul_f32 v82, v100, v82
    v_mul_f32 v83, v100, v83
    v_cvt_pk_bf16_f32 v8, v76, v77
    v_cvt_pk_bf16_f32 v9, v78, v79
    v_cvt_pk_bf16_f32 v10, v80, v81
    v_cvt_pk_bf16_f32 v11, v82, v83
    v_lshlrev_b32 v76, 16, v8
    v_and_b32 v77, 0xffff0000, v8
    v_lshlrev_b32 v78, 16, v9
    v_and_b32 v79, 0xffff0000, v9
    v_lshlrev_b32 v80, 16, v10
    v_and_b32 v81, 0xffff0000, v10
    v_lshlrev_b32 v82, 16, v11
    v_and_b32 v83, 0xffff0000, v11
    s_add_u32 s62, s64, 0x6200000
    buffer_store_dwordx4 v[8:11], v240, s[8:11], s62 offen sc1
    v_pk_add_f32 v[68:69], v[68:69], v[76:77]
    v_pk_add_f32 v[70:71], v[70:71], v[78:79]
    v_pk_add_f32 v[72:73], v[72:73], v[80:81]
    v_pk_add_f32 v[74:75], v[74:75], v[82:83]
    v_cvt_pk_bf16_f32 v12, v68, v69
    v_cvt_pk_bf16_f32 v13, v70, v71
    v_cvt_pk_bf16_f32 v14, v72, v73
    v_cvt_pk_bf16_f32 v15, v74, v75
    buffer_store_dwordx4 v[12:15], v240, s[16:19], s64 offen sc1
    v_lshlrev_b32 v88, 16, v236
    v_and_b32 v89, 0xffff0000, v236
    v_lshlrev_b32 v90, 16, v237
    v_and_b32 v91, 0xffff0000, v237
    v_lshlrev_b32 v92, 16, v238
    v_and_b32 v93, 0xffff0000, v238
    v_lshlrev_b32 v94, 16, v239
    v_and_b32 v95, 0xffff0000, v239
    v_mul_f32 v84, v76, v88
    v_fmac_f32 v84, v77, v89
    v_fmac_f32 v84, v78, v90
    v_fmac_f32 v84, v79, v91
    v_fmac_f32 v84, v80, v92
    v_fmac_f32 v84, v81, v93
    v_fmac_f32 v84, v82, v94
    v_fmac_f32 v84, v83, v95
    s_nop 1
    v_add_f32_dpp v84, v84, v84 row_ror:1 row_mask:0xf bank_mask:0xf
    s_nop 1
    v_add_f32_dpp v84, v84, v84 row_ror:2 row_mask:0xf bank_mask:0xf
    s_nop 1
    v_add_f32_dpp v84, v84, v84 row_ror:4 row_mask:0xf bank_mask:0xf
    s_nop 1
    v_add_f32_dpp v84, v84, v84 row_ror:8 row_mask:0xf bank_mask:0xf
    v_mov_b32 v85, v84
    s_nop 1
    v_permlane32_swap_b32 v85, v84
    v_add_f32 v84, v85, v84
    v_mov_b32 v85, v84
    s_nop 1
    v_permlane16_swap_b32 v85, v84
    v_add_f32 v84, v85, v84
    v_cvt_pk_bf16_f32 v84, v84, v84
    v_and_b32 v84, 0xffff0000, v84
    v_ashrrev_i32 v85, 31, v84
    v_or_b32 v85, 0x80000000, v85
    v_xor_b32 v84, v84, v85
    v_and_b32 v84, 0xffff0000, v84
    s_sub_u32 s62, 0x87ff, s60
    v_or_b32 v84, s62, v84
    s_lshl_b32 s62, s60, 2
    s_mov_b64 exec, 1
    s_add_u32 s63, s62, 0x6e00
    s_cmp_ge_u32 s60, 1920
    s_cselect_b32 s63, s63, 0x7ff00000
    buffer_store_dword v84, off, s[8:11], s63 sc1
    v_cmp_ge_u32 vcc, v104, v84
    s_cselect_b32 s63, 1, 0
    s_and_b32 s63, s63, vcc_lo
    s_cbranch_scc1 L_nokey_165
    s_add_u32 s62, s62, 0x6000
    s_waitcnt vmcnt(0)
    buffer_store_dword v84, off, s[8:11], s62 sc1
L_nokey_165:
    s_mov_b64 exec, -1
L_nofin_164:
    s_add_u32 s80, s80, 4
    s_add_u32 s22, s22, s23
    s_sub_u32 s24, s22, 68
    s_cmp_lt_u32 s24, 2
    s_cselect_b32 s82, 2, 0
    s_cselect_b32 s24, 6, 0
    s_sub_u32 s22, s22, s24
    s_branch L_p2_seg
L_p2_end:
    s_cmp_ge_u32 s67, 56
    s_cbranch_scc1 L_exit
    s_mov_b32 s74, 0
    s_mov_b32 s75, 0
    v_mov_b32 v202, 0x7ffffff0
    v_mbcnt_lo_u32_b32 v0, -1, 0
    v_mbcnt_hi_u32_b32 v0, -1, v0
    s_lshl_b32 s96, s100, 6
    v_add_u32 v0, s96, v0
    v_lshlrev_b32 v1, 6, v0
    s_getpc_b64 s[70:71]
L_pc_166:
    s_add_u32 s70, s70, L_ffn_round-L_pc_166
    s_addc_u32 s71, s71, 0
    v_min_u32 v1, L_code_end-L_ffn_round-4, v1
    global_load_dword v3, v1, s[70:71]
    v_mov_b32 v1, 0
    s_and_b32 s71, s101, 15
    s_lshl_b32 s71, s71, 7
    s_add_u32 s71, s71, 0x1000
    s_mov_b32 s72, 57
    s_cmp_lg_u32 s100, 0
    s_cbranch_scc1 L_polls_169
    s_mov_b32 exec_lo, 0x1
    s_mov_b32 exec_hi, 0
    s_mov_b32 s96, 0
L_poll_167:
    buffer_load_dword v2, v1, s[8:11], s71 offen sc1
    s_waitcnt vmcnt(0)
    v_cmp_gt_u32 vcc, s72, v2
    s_cbranch_vccz L_polld_168
    v_readfirstlane_b32 s97, v2
    s_nop 0
    s_sub_u32 s97, s72, s97
    s_cmp_lt_i32 s97, 3
    s_cbranch_scc1 L_near_170
    s_sleep 40
    s_cmp_lt_i32 s97, 5
    s_cbranch_scc1 L_near_170
    s_sleep 100
L_near_170:
    s_sleep 16
    s_add_u32 s96, s96, 1
    s_cmp_lt_u32 s96, 0x10000
    s_cbranch_scc1 L_poll_167
L_polld_168:
    s_mov_b64 exec, -1
L_polls_169:
    s_barrier
L_ffn_round:
    v_mbcnt_lo_u32_b32 v0, -1, 0
    v_mbcnt_hi_u32_b32 v0, -1, v0
    s_lshl_b32 s96, s100, 6
    v_add_u32 v0, s96, v0
    s_cmp_lg_u32 s75, 0
    s_cbranch_scc1 L_ffn_re
    v_lshlrev_b32 v30, 5, v0
    s_mov_b32 s69, 0x6000
    v_cmp_le_u32 vcc, 224, v0
    v_mov_b32 v29, s75
    v_add_u32 v29, -1, v29
    v_cndmask_b32 v19, 0, v29, vcc
    s_mov_b32 s70, 0
L_kpoll_171:
    buffer_load_dwordx4 v[20:23], v30, s[8:11], s69 offen sc1
    buffer_load_dwordx4 v[24:27], v30, s[8:11], s69 offen offset:16 sc1
    s_waitcnt vmcnt(0)
    v_min3_u32 v28, v20, v21, v22
    v_min3_u32 v28, v28, v23, v24
    v_min3_u32 v28, v28, v25, v26
    v_min_u32 v28, v28, v27
    v_or_b32 v28, v28, v19
    v_cmp_eq_u32 vcc, 0, v28
    s_cbranch_vccz L_kpolld_172
    s_sleep 6
    s_add_u32 s70, s70, 1
    s_cmp_lt_u32 s70, 0x10000
    s_cbranch_scc1 L_kpoll_171
L_kpolld_172:
    v_bfi_b32 v20, v19, 0, v20
    v_bfi_b32 v21, v19, 0, v21
    v_bfi_b32 v22, v19, 0, v22
    v_bfi_b32 v23, v19, 0, v23
    v_bfi_b32 v24, v19, 0, v24
    v_bfi_b32 v25, v19, 0, v25
    v_bfi_b32 v26, v19, 0, v26
    v_bfi_b32 v27, v19, 0, v27
    v_lshrrev_b32 v30, 6, v0
    v_lshlrev_b32 v30, 2, v30
    v_add_u32 v30, 0x20400, v30
    v_mov_b32 v31, 0x20400
    s_waitcnt vmcnt(0)
    v_max3_u32 v28, v20, v21, v22
    v_max3_u32 v28, v28, v23, v24
    v_max3_u32 v28, v28, v25, v26
    v_max_u32 v28, v28, v27
    s_nop 1
    v_max_u32_dpp v28, v28, v28 row_ror:1 row_mask:0xf bank_mask:0xf
    s_nop 1
    v_max_u32_dpp v28, v28, v28 row_ror:2 row_mask:0xf bank_mask:0xf
    s_nop 1
    v_max_u32_dpp v28, v28, v28 row_ror:4 row_mask:0xf bank_mask:0xf
    s_nop 1
    v_max_u32_dpp v28, v28, v28 row_ror:8 row_mask:0xf bank_mask:0xf
    v_mov_b32 v29, v28
    s_nop 1
    v_permlane32_swap_b32 v29, v28
    v_max_u32 v28, v29, v28
    v_mov_b32 v29, v28
    s_nop 1
    v_permlane16_swap_b32 v29, v28
    v_max_u32 v28, v29, v28
    ds_write_b32 v30, v28
    s_waitcnt lgkmcnt(0)
    s_barrier
    ds_read_b128 v[16:19], v31
    s_waitcnt lgkmcnt(0)
    v_max3_u32 v28, v16, v17, v18
    v_max_u32 v28, v28, v19
    s_nop 0
    v_readfirstlane_b32 s69, v28
    s_nop 1
    v_cmp_ne_u32 vcc, s69, v20
    s_nop 1
    v_cndmask_b32 v20, 0, v20, vcc
    v_cmp_ne_u32 vcc, s69, v21
    s_nop 1
    v_cndmask_b32 v21, 0, v21, vcc
    v_cmp_ne_u32 vcc, s69, v22
    s_nop 1
    v_cndmask_b32 v22, 0, v22, vcc
    v_cmp_ne_u32 vcc, s69, v23
    s_nop 1
    v_cndmask_b32 v23, 0, v23, vcc
    v_cmp_ne_u32 vcc, s69, v24
    s_nop 1
    v_cndmask_b32 v24, 0, v24, vcc
    v_cmp_ne_u32 vcc, s69, v25
    s_nop 1
    v_cndmask_b32 v25, 0, v25, vcc
    v_cmp_ne_u32 vcc, s69, v26
    s_nop 1
    v_cndmask_b32 v26, 0, v26, vcc
    v_cmp_ne_u32 vcc, s69, v27
    s_nop 1
    v_cndmask_b32 v27, 0, v27, vcc
    v_max3_u32 v28, v20, v21, v22
    v_max3_u32 v28, v28, v23, v24
    v_max3_u32 v28, v28, v25, v26
    v_max_u32 v28, v28, v27
    s_nop 1
    v_max_u32_dpp v28, v28, v28 row_ror:1 row_mask:0xf bank_mask:0xf
    s_nop 1
    v_max_u32_dpp v28, v28, v28 row_ror:2 row_mask:0xf bank_mask:0xf
    s_nop 1
    v_max_u32_dpp v28, v28, v28 row_ror:4 row_mask:0xf bank_mask:0xf
    s_nop 1
    v_max_u32_dpp v28, v28, v28 row_ror:8 row_mask:0xf bank_mask:0xf
    v_mov_b32 v29, v28
    s_nop 1
    v_permlane32_swap_b32 v29, v28
    v_max_u32 v28, v29, v28
    v_mov_b32 v29, v28
    s_nop 1
    v_permlane16_swap_b32 v29, v28
    v_max_u32 v28, v29, v28
    ds_write_b32 v30, v28 offset:16
    s_waitcnt lgkmcnt(0)
    s_barrier
    ds_read_b128 v[16:19], v31 offset:16
    s_waitcnt lgkmcnt(0)
    v_max3_u32 v28, v16, v17, v18
    v_max_u32 v28, v28, v19
    s_nop 0
    v_readfirstlane_b32 s70, v28
    s_barrier
    s_cmp_lg_u32 s67, 55
    s_cbranch_scc1 L_ffn_sel
    s_mov_b32 s71, 0x8f00
    s_cmp_lg_u32 s100, 0
    s_cbranch_scc1 L_flag_173
    v_mov_b32 v2, s70
    s_mov_b64 exec, 1
    buffer_store_dword v2, off, s[8:11], s71 sc1
    s_mov_b64 exec, -1
L_flag_173:
    s_branch L_ffn_sel
L_ffn_re:
    v_and_b32 v24, 63, v0
    v_lshlrev_b32 v24, 3, v24
    v_mov_b32 v23, 0x20400
    s_cmp_lg_u32 s100, 0
    s_cbranch_scc1 L_rselw_177
    s_mov_b32 s71, 0x7e00
    s_mov_b32 s71, 0x7c00
    s_cmp_eq_u32 s75, 1
    s_cselect_b32 s71, s71, 0x8c00
    s_mov_b32 s72, 0
L_rsel_174:
    buffer_load_dwordx2 v[20:21], v24, s[8:11], s71 offen sc1
    s_waitcnt vmcnt(0)
    v_min_u32 v22, v20, v21
    v_cmp_eq_u32 vcc, 0, v22
    s_cbranch_vccz L_rseld_175
    s_sleep 1
    s_add_u32 s72, s72, 1
    s_cmp_lt_u32 s72, 0x10000
    s_cbranch_scc1 L_rsel_174
L_rseld_175:
    v_max_u32 v22, v20, v21
    v_cmp_lt_u32 vcc, s70, v22
    s_cbranch_vccz L_rsele_176
    s_cmp_lg_u32 s71, 0x8c00
    s_cbranch_scc1 L_rackd_179
    s_mov_b32 s71, 0x7e00
L_rack_178:
    buffer_load_dwordx2 v[26:27], v24, s[8:11], s71 offen sc1
    s_add_u32 s72, s72, 1
    s_waitcnt vmcnt(0)
    v_sub_u32 v26, v20, v26
    v_sub_u32 v27, v21, v27
    v_max_u32 v26, v26, v27
    v_cmp_lt_u32 vcc, s70, v26
    s_cbranch_vccz L_rackd_179
    s_cmp_lt_u32 s72, 0x10000
    s_cbranch_scc1 L_rack_178
L_rackd_179:
    v_max_u32_dpp v22, v22, v22 row_ror:1 row_mask:0xf bank_mask:0xf
    s_nop 1
    v_max_u32_dpp v22, v22, v22 row_ror:2 row_mask:0xf bank_mask:0xf
    s_nop 1
    v_max_u32_dpp v22, v22, v22 row_ror:4 row_mask:0xf bank_mask:0xf
    s_nop 1
    v_max_u32_dpp v22, v22, v22 row_ror:8 row_mask:0xf bank_mask:0xf
    v_mov_b32 v23, v22
    s_nop 1
    v_permlane32_swap_b32 v23, v22
    v_max_u32 v22, v23, v22
    v_mov_b32 v23, v22
    s_nop 1
    v_permlane16_swap_b32 v23, v22
    v_max_u32 v22, v23, v22
    s_nop 0
    v_readfirstlane_b32 s71, v22
    s_nop 1
    v_cmp_ne_u32 vcc, s71, v20
    s_nop 1
    v_cndmask_b32 v20, 0, v20, vcc
    v_cmp_ne_u32 vcc, s71, v21
    s_nop 1
    v_cndmask_b32 v21, 0, v21, vcc
    v_max_u32 v22, v20, v21
    s_nop 1
    v_max_u32_dpp v22, v22, v22 row_ror:1 row_mask:0xf bank_mask:0xf
    s_nop 1
    v_max_u32_dpp v22, v22, v22 row_ror:2 row_mask:0xf bank_mask:0xf
    s_nop 1
    v_max_u32_dpp v22, v22, v22 row_ror:4 row_mask:0xf bank_mask:0xf
    s_nop 1
    v_max_u32_dpp v22, v22, v22 row_ror:8 row_mask:0xf bank_mask:0xf
    v_mov_b32 v23, v22
    s_nop 1
    v_permlane32_swap_b32 v23, v22
    v_max_u32 v22, v23, v22
    v_mov_b32 v23, v22
    s_nop 1
    v_permlane16_swap_b32 v23, v22
    v_max_u32 v22, v23, v22
    s_nop 0
    v_readfirstlane_b32 s72, v22
    s_nop 0
    s_max_u32 s70, s70, s72
    s_min_u32 s72, s71, s69
    s_max_u32 s70, s70, s72
    s_max_u32 s69, s69, s71
L_rsele_176:
    v_mov_b32 v23, 0x20400
    v_mov_b32 v20, s69
    v_mov_b32 v21, s70
    ds_write_b64 v23, v[20:21]
    s_waitcnt lgkmcnt(0)
L_rselw_177:
    s_barrier
    ds_read_b64 v[20:21], v23
    s_waitcnt lgkmcnt(0)
    v_readfirstlane_b32 s69, v20
    v_readfirstlane_b32 s70, v21
    s_barrier
    s_nop 3
L_ffn_sel:
    s_and_b32 s71, s69, 2047
    s_lshl_b32 s71, s71, 11
    s_and_b32 s72, s70, 2047
    s_or_b32 s71, s71, s72
    s_add_u32 s71, s71, 1
    s_cmp_eq_u32 s71, s74
    s_cbranch_scc1 L_ffn_same
    s_mov_b32 s74, s71
    v_and_b32 v1, 63, v0
    v_lshrrev_b32 v2, 4, v1
    v_and_b32 v3, 15, v1
    v_lshrrev_b32 v6, 2, v3
    s_and_b32 s71, s69, 2047
    s_sub_u32 s71, 2047, s71
    s_and_b32 s72, s70, 2047
    s_sub_u32 s72, 2047, s72
    v_and_b32 v4, 1, v3
    v_cmp_eq_u32 vcc, 0, v4
    v_mov_b32 v4, s71
    v_mov_b32 v5, s72
    v_cndmask_b32 v4, v5, v4, vcc
    v_lshlrev_b32 v4, 10, v4
    v_lshl_add_u32 v4, v2, 4, v4
    s_mov_b32 s71, 0x6200000
    buffer_load_dwordx4 v[32:35], v4, s[8:11], s71 offen
    buffer_load_dwordx4 v[36:39], v4, s[8:11], s71 offen offset:64
    buffer_load_dwordx4 v[40:43], v4, s[8:11], s71 offen offset:128
    buffer_load_dwordx4 v[44:47], v4, s[8:11], s71 offen offset:192
    buffer_load_dwordx4 v[48:51], v4, s[8:11], s71 offen offset:256
    buffer_load_dwordx4 v[52:55], v4, s[8:11], s71 offen offset:320
    buffer_load_dwordx4 v[56:59], v4, s[8:11], s71 offen offset:384
    buffer_load_dwordx4 v[60:63], v4, s[8:11], s71 offen offset:448
    buffer_load_dwordx4 v[64:67], v4, s[8:11], s71 offen offset:512
    buffer_load_dwordx4 v[68:71], v4, s[8:11], s71 offen offset:576
    buffer_load_dwordx4 v[72:75], v4, s[8:11], s71 offen offset:640
    buffer_load_dwordx4 v[76:79], v4, s[8:11], s71 offen offset:704
    buffer_load_dwordx4 v[80:83], v4, s[8:11], s71 offen offset:768
    buffer_load_dwordx4 v[84:87], v4, s[8:11], s71 offen offset:832
    buffer_load_dwordx4 v[88:91], v4, s[8:11], s71 offen offset:896
    buffer_load_dwordx4 v[92:95], v4, s[8:11], s71 offen offset:960
    v_lshl_add_u32 v4, v2, 3, v6
    v_lshlrev_b32 v4, 6, v4
    v_and_b32 v5, 3, v3
    v_lshl_add_u32 v4, v5, 3, v4
    s_lshr_b32 s71, s68, 1
    s_lshl_b32 s71, s71, 15
    s_and_b32 s72, s68, 1
    s_lshl_b32 s72, s72, 5
    s_add_u32 s71, s71, s72
    s_add_u32 s71, s71, 0x8000
    v_add_u32 v7, s71, v4
    ds_read_b64_tr_b16 v[96:97], v7
    ds_read_b64_tr_b16 v[98:99], v7 offset:256
    ds_read_b64_tr_b16 v[100:101], v7 offset:2048
    ds_read_b64_tr_b16 v[102:103], v7 offset:2304
    ds_read_b64_tr_b16 v[104:105], v7 offset:4096
    ds_read_b64_tr_b16 v[106:107], v7 offset:4352
    ds_read_b64_tr_b16 v[108:109], v7 offset:6144
    ds_read_b64_tr_b16 v[110:111], v7 offset:6400
    s_waitcnt lgkmcnt(0)
    ds_read_b64_tr_b16 v[112:113], v7 offset:8192
    ds_read_b64_tr_b16 v[114:115], v7 offset:8448
    ds_read_b64_tr_b16 v[116:117], v7 offset:10240
    ds_read_b64_tr_b16 v[118:119], v7 offset:10496
    ds_read_b64_tr_b16 v[120:121], v7 offset:12288
    ds_read_b64_tr_b16 v[122:123], v7 offset:12544
    ds_read_b64_tr_b16 v[124:125], v7 offset:14336
    ds_read_b64_tr_b16 v[126:127], v7 offset:14592
    s_waitcnt lgkmcnt(0)
    ds_read_b64_tr_b16 v[128:129], v7 offset:16384
    ds_read_b64_tr_b16 v[130:131], v7 offset:16640
    ds_read_b64_tr_b16 v[132:133], v7 offset:18432
    ds_read_b64_tr_b16 v[134:135], v7 offset:18688
    ds_read_b64_tr_b16 v[136:137], v7 offset:20480
    ds_read_b64_tr_b16 v[138:139], v7 offset:20736
    ds_read_b64_tr_b16 v[140:141], v7 offset:22528
    ds_read_b64_tr_b16 v[142:143], v7 offset:22784
    s_waitcnt lgkmcnt(0)
    ds_read_b64_tr_b16 v[144:145], v7 offset:24576
    ds_read_b64_tr_b16 v[146:147], v7 offset:24832
    ds_read_b64_tr_b16 v[148:149], v7 offset:26624
    ds_read_b64_tr_b16 v[150:151], v7 offset:26880
    ds_read_b64_tr_b16 v[152:153], v7 offset:28672
    ds_read_b64_tr_b16 v[154:155], v7 offset:28928
    ds_read_b64_tr_b16 v[156:157], v7 offset:30720
    ds_read_b64_tr_b16 v[158:159], v7 offset:30976
    s_waitcnt lgkmcnt(0)
    s_waitcnt vmcnt(0)
    v_mfma_f32_16x16x32_bf16 v[8:11], v[32:35], v[96:99], 0
    v_mfma_f32_16x16x32_bf16 v[8:11], v[36:39], v[100:103], v[8:11]
    v_mfma_f32_16x16x32_bf16 v[8:11], v[40:43], v[104:107], v[8:11]
    v_mfma_f32_16x16x32_bf16 v[8:11], v[44:47], v[108:111], v[8:11]
    v_mfma_f32_16x16x32_bf16 v[8:11], v[48:51], v[112:115], v[8:11]
    v_mfma_f32_16x16x32_bf16 v[8:11], v[52:55], v[116:119], v[8:11]
    v_mfma_f32_16x16x32_bf16 v[8:11], v[56:59], v[120:123], v[8:11]
    v_mfma_f32_16x16x32_bf16 v[8:11], v[60:63], v[124:127], v[8:11]
    v_mfma_f32_16x16x32_bf16 v[8:11], v[64:67], v[128:131], v[8:11]
    v_mfma_f32_16x16x32_bf16 v[8:11], v[68:71], v[132:135], v[8:11]
    v_mfma_f32_16x16x32_bf16 v[8:11], v[72:75], v[136:139], v[8:11]
    v_mfma_f32_16x16x32_bf16 v[8:11], v[76:79], v[140:143], v[8:11]
    v_mfma_f32_16x16x32_bf16 v[8:11], v[80:83], v[144:147], v[8:11]
    v_mfma_f32_16x16x32_bf16 v[8:11], v[84:87], v[148:151], v[8:11]
    v_mfma_f32_16x16x32_bf16 v[8:11], v[88:91], v[152:155], v[8:11]
    v_mfma_f32_16x16x32_bf16 v[8:11], v[92:95], v[156:159], v[8:11]
    s_nop 7
    v_cvt_pk_bf16_f32 v8, v8, v8
    v_and_b32 v8, 0xffff0000, v8
    v_cvt_pk_bf16_f32 v9, v9, v9
    v_and_b32 v9, 0xffff0000, v9
    s_cmp_ge_u32 s68, 2
    s_cbranch_scc1 L_ffn_up_180
    v_mul_f32 v13, 0xbfb8aa3b, v8
    v_exp_f32 v13, v13
    s_nop 0
    v_add_f32 v13, 1.0, v13
    v_rcp_f32 v12, v13
    s_nop 0
    v_mul_f32 v8, v12, v8
    v_cvt_pk_bf16_f32 v8, v8, v8
    v_and_b32 v8, 0xffff0000, v8
    v_mul_f32 v13, 0xbfb8aa3b, v9
    v_exp_f32 v13, v13
    s_nop 0
    v_add_f32 v13, 1.0, v13
    v_rcp_f32 v12, v13
    s_nop 0
    v_mul_f32 v9, v12, v9
    v_cvt_pk_bf16_f32 v9, v9, v9
    v_and_b32 v9, 0xffff0000, v9
    s_nop 4
L_ffn_up_180:
    s_lshr_b32 s71, s68, 1
    s_lshl_b32 s71, s71, 8
    s_and_b32 s72, s68, 1
    s_lshl_b32 s72, s72, 6
    s_add_u32 s71, s71, s72
    s_add_u32 s71, s71, 0x20000
    v_lshlrev_b32 v4, 2, v3
    v_add_u32 v4, s71, v4
    ds_write_b32 v4, v8
    ds_write_b32 v4, v9 offset:128
    s_waitcnt lgkmcnt(0)
    s_barrier
    v_and_b32 v4, 1, v3
    v_lshlrev_b32 v4, 7, v4
    v_lshl_add_u32 v4, v2, 5, v4
    v_add_u32 v4, 0x20000, v4
    ds_read_b128 v[32:35], v4
    ds_read_b128 v[36:39], v4 offset:16
    ds_read_b128 v[40:43], v4 offset:256
    ds_read_b128 v[44:47], v4 offset:272
    v_lshl_add_u32 v5, v2, 3, v6
    v_lshlrev_b32 v5, 10, v5
    v_and_b32 v7, 3, v3
    v_lshl_add_u32 v5, v7, 3, v5
    s_lshl_b32 s71, s68, 8
    s_add_u32 s71, s71, 0x18000
    v_add_u32 v7, s71, v5
    s_waitcnt lgkmcnt(0)
    ds_read_b64_tr_b16 v[96:97], v7
    ds_read_b64_tr_b16 v[98:99], v7 offset:4096
    ds_read_b64_tr_b16 v[100:101], v7 offset:32
    ds_read_b64_tr_b16 v[102:103], v7 offset:4128
    ds_read_b64_tr_b16 v[104:105], v7 offset:64
    ds_read_b64_tr_b16 v[106:107], v7 offset:4160
    ds_read_b64_tr_b16 v[108:109], v7 offset:96
    ds_read_b64_tr_b16 v[110:111], v7 offset:4192
    s_waitcnt lgkmcnt(0)
    ds_read_b64_tr_b16 v[112:113], v7 offset:128
    ds_read_b64_tr_b16 v[114:115], v7 offset:4224
    ds_read_b64_tr_b16 v[116:117], v7 offset:160
    ds_read_b64_tr_b16 v[118:119], v7 offset:4256
    ds_read_b64_tr_b16 v[120:121], v7 offset:192
    ds_read_b64_tr_b16 v[122:123], v7 offset:4288
    ds_read_b64_tr_b16 v[124:125], v7 offset:224
    ds_read_b64_tr_b16 v[126:127], v7 offset:4320
    v_mul_f32 v32, v32, v40
    v_mul_f32 v33, v33, v41
    v_mul_f32 v34, v34, v42
    v_mul_f32 v35, v35, v43
    v_mul_f32 v36, v36, v44
    v_mul_f32 v37, v37, v45
    v_mul_f32 v38, v38, v46
    v_mul_f32 v39, v39, v47
    v_cvt_pk_bf16_f32 v48, v32, v33
    v_cvt_pk_bf16_f32 v49, v34, v35
    v_cvt_pk_bf16_f32 v50, v36, v37
    v_cvt_pk_bf16_f32 v51, v38, v39
    s_waitcnt lgkmcnt(0)
    s_nop 0
    v_mfma_f32_16x16x32_bf16 v[56:59], v[48:51], v[96:99], 0
    v_mfma_f32_16x16x32_bf16 v[60:63], v[48:51], v[100:103], 0
    v_mfma_f32_16x16x32_bf16 v[64:67], v[48:51], v[104:107], 0
    v_mfma_f32_16x16x32_bf16 v[68:71], v[48:51], v[108:111], 0
    v_mfma_f32_16x16x32_bf16 v[72:75], v[48:51], v[112:115], 0
    v_mfma_f32_16x16x32_bf16 v[76:79], v[48:51], v[116:119], 0
    v_mfma_f32_16x16x32_bf16 v[80:83], v[48:51], v[120:123], 0
    v_mfma_f32_16x16x32_bf16 v[84:87], v[48:51], v[124:127], 0
    v_cmp_eq_u32 vcc, 0, v2
    v_lshlrev_b32 v4, 11, v2
    v_lshl_add_u32 v4, v3, 2, v4
    s_lshl_b32 s71, s67, 12
    s_lshl_b32 s72, s68, 9
    s_add_u32 s71, s71, s72
    s_add_u32 s71, s71, 0x6410000
    v_cndmask_b32 v56, v57, v56, vcc
    v_cndmask_b32 v60, v61, v60, vcc
    v_cndmask_b32 v64, v65, v64, vcc
    v_cndmask_b32 v68, v69, v68, vcc
    v_cndmask_b32 v72, v73, v72, vcc
    v_cndmask_b32 v76, v77, v76, vcc
    v_cndmask_b32 v80, v81, v80, vcc
    v_cndmask_b32 v84, v85, v84, vcc
    s_mov_b32 exec_hi, 0
    buffer_store_dword v56, v4, s[8:11], s71 offen sc1
    buffer_store_dword v60, v4, s[8:11], s71 offen offset:64 sc1
    buffer_store_dword v64, v4, s[8:11], s71 offen offset:128 sc1
    buffer_store_dword v68, v4, s[8:11], s71 offen offset:192 sc1
    buffer_store_dword v72, v4, s[8:11], s71 offen offset:256 sc1
    buffer_store_dword v76, v4, s[8:11], s71 offen offset:320 sc1
    buffer_store_dword v80, v4, s[8:11], s71 offen offset:384 sc1
    buffer_store_dword v84, v4, s[8:11], s71 offen offset:448 sc1
    s_mov_b64 exec, -1
    s_waitcnt vmcnt(0)
    s_barrier
    s_lshl_b32 s71, s67, 2
    s_lshl_b32 s72, s75, 8
    s_add_u32 s71, s71, s72
    s_add_u32 s71, s71, 0x8000
    s_cmp_lg_u32 s100, 0
    s_cbranch_scc1 L_flag_181
    v_mov_b32 v2, s74
    s_mov_b64 exec, 1
    buffer_store_dword v2, off, s[8:11], s71 sc1
    s_mov_b64 exec, -1
L_flag_181:
    s_cmp_ge_u32 s67, 8
    s_cbranch_scc1 L_ffn_same
    s_load_dwordx2 s[16:17], s[0:1], 96
    s_waitcnt lgkmcnt(0)
    s_and_b32 s17, s17, 0xffff
    s_mov_b32 s18, 0x200000
    s_mov_b32 s19, 0x20000
    v_and_b32 v3, 63, v0
    s_cmp_lt_u32 s100, 2
    s_cselect_b32 s71, s69, s70
    v_mov_b32 v5, s71
    s_and_b32 s71, s71, 2047
    s_sub_u32 s71, 2047, s71
    s_lshl_b32 s71, s71, 10
    s_lshl_b32 s72, s67, 1
    s_and_b32 s96, s100, 1
    s_add_u32 s72, s72, s96
    s_lshl_b32 s96, s72, 6
    s_add_u32 s71, s71, s96
    v_and_b32 v4, 7, v3
    v_lshlrev_b32 v6, 3, v4
    v_add_u32 v6, s71, v6
    v_lshrrev_b32 v7, 3, v3
    v_lshlrev_b32 v7, 12, v7
    v_lshl_add_u32 v7, v4, 4, v7
    s_lshl_b32 s72, s72, 7
    s_lshr_b32 s96, s100, 1
    s_lshl_b32 s96, s96, 11
    s_add_u32 s72, s72, s96
    v_add_u32 v7, s72, v7
    s_mov_b32 s71, 0x6000000
    s_mov_b32 s72, 0x6200000
    buffer_load_dwordx2 v[8:9], v6, s[8:11], s71 offen sc1
    buffer_load_dwordx2 v[10:11], v6, s[8:11], s72 offen sc1
    v_and_b32 v5, 0xffff0000, v5
    v_ashrrev_i32 v4, 31, v5
    v_not_b32 v4, v4
    v_or_b32 v4, 0x80000000, v4
    v_xor_b32 v5, v5, v4
    v_and_b32 v5, 0xffff0000, v5
    v_mul_f32 v23, 0xbfb8aa3b, v5
    v_exp_f32 v23, v23
    s_nop 0
    v_add_f32 v23, 1.0, v23
    v_rcp_f32 v22, v23
    s_nop 0
    v_cvt_pk_bf16_f32 v22, v22, v22
    v_and_b32 v22, 0xffff0000, v22
    v_lshlrev_b32 v1, 2, v0
    s_lshl_b32 s71, s75, 8
    s_add_u32 s71, s71, 0x8000
    s_cmp_lg_u32 s100, 0
    s_cbranch_scc1 L_polls_184
    s_mov_b32 exec_hi, 0xffffff
    s_mov_b32 s96, 0
L_poll_182:
    buffer_load_dword v2, v1, s[8:11], s71 offen sc1
    s_waitcnt vmcnt(0)
    v_cmp_ne_u32 vcc, s74, v2
    s_cbranch_vccz L_polld_183
    s_sleep 2
    s_add_u32 s96, s96, 1
    s_cmp_lt_u32 s96, 0x10000
    s_cbranch_scc1 L_poll_182
L_polld_183:
    s_mov_b64 exec, -1
L_polls_184:
    s_barrier
    s_mov_b32 s71, 0x6410000
    buffer_load_dwordx4 v[32:35], v7, s[8:11], s71 offen sc1
    s_add_u32 s71, s71, 32768
    buffer_load_dwordx4 v[36:39], v7, s[8:11], s71 offen sc1
    s_add_u32 s71, s71, 32768
    buffer_load_dwordx4 v[40:43], v7, s[8:11], s71 offen sc1
    s_add_u32 s71, s71, 32768
    buffer_load_dwordx4 v[44:47], v7, s[8:11], s71 offen sc1
    s_add_u32 s71, s71, 32768
    buffer_load_dwordx4 v[48:51], v7, s[8:11], s71 offen sc1
    s_add_u32 s71, s71, 32768
    buffer_load_dwordx4 v[52:55], v7, s[8:11], s71 offen sc1
    s_add_u32 s71, s71, 32768
    buffer_load_dwordx4 v[56:59], v7, s[8:11], s71 offen sc1
    s_add_u32 s71, s71, 32768
    s_waitcnt vmcnt(7)
    v_lshlrev_b32 v12, 16, v8
    v_and_b32 v13, 0xffff0000, v8
    v_lshlrev_b32 v16, 16, v10
    v_and_b32 v17, 0xffff0000, v10
    v_lshlrev_b32 v14, 16, v9
    v_and_b32 v15, 0xffff0000, v9
    v_lshlrev_b32 v18, 16, v11
    v_and_b32 v19, 0xffff0000, v11
    s_waitcnt vmcnt(0)
    v_pk_add_f32 v[32:33], v[32:33], v[36:37]
    v_pk_add_f32 v[34:35], v[34:35], v[38:39]
    v_pk_add_f32 v[32:33], v[32:33], v[40:41]
    v_pk_add_f32 v[34:35], v[34:35], v[42:43]
    v_pk_add_f32 v[32:33], v[32:33], v[44:45]
    v_pk_add_f32 v[34:35], v[34:35], v[46:47]
    v_pk_add_f32 v[32:33], v[32:33], v[48:49]
    v_pk_add_f32 v[34:35], v[34:35], v[50:51]
    v_pk_add_f32 v[32:33], v[32:33], v[52:53]
    v_pk_add_f32 v[34:35], v[34:35], v[54:55]
    v_pk_add_f32 v[32:33], v[32:33], v[56:57]
    v_pk_add_f32 v[34:35], v[34:35], v[58:59]
    s_nop 0
    v_add_f32_dpp v32, v32, v32 row_ror:8 row_mask:0xf bank_mask:0xf
    v_add_f32_dpp v33, v33, v33 row_ror:8 row_mask:0xf bank_mask:0xf
    v_add_f32_dpp v34, v34, v34 row_ror:8 row_mask:0xf bank_mask:0xf
    v_add_f32_dpp v35, v35, v35 row_ror:8 row_mask:0xf bank_mask:0xf
    v_mov_b32 v24, v32
    s_nop 1
    v_permlane32_swap_b32 v24, v32
    v_add_f32 v32, v24, v32
    v_mov_b32 v24, v32
    s_nop 1
    v_permlane16_swap_b32 v24, v32
    v_add_f32 v32, v24, v32
    v_mov_b32 v24, v33
    s_nop 1
    v_permlane32_swap_b32 v24, v33
    v_add_f32 v33, v24, v33
    v_mov_b32 v24, v33
    s_nop 1
    v_permlane16_swap_b32 v24, v33
    v_add_f32 v33, v24, v33
    v_mov_b32 v24, v34
    s_nop 1
    v_permlane32_swap_b32 v24, v34
    v_add_f32 v34, v24, v34
    v_mov_b32 v24, v34
    s_nop 1
    v_permlane16_swap_b32 v24, v34
    v_add_f32 v34, v24, v34
    v_mov_b32 v24, v35
    s_nop 1
    v_permlane32_swap_b32 v24, v35
    v_add_f32 v35, v24, v35
    v_mov_b32 v24, v35
    s_nop 1
    v_permlane16_swap_b32 v24, v35
    v_add_f32 v35, v24, v35
    v_cvt_pk_bf16_f32 v32, v32, v32
    v_and_b32 v32, 0xffff0000, v32
    v_mul_f32 v32, v22, v32
    v_cvt_pk_bf16_f32 v32, v32, v32
    v_and_b32 v32, 0xffff0000, v32
    v_add_f32 v32, v16, v32
    v_cvt_pk_bf16_f32 v32, v32, v32
    v_and_b32 v32, 0xffff0000, v32
    v_add_f32 v32, v12, v32
    v_cvt_pk_bf16_f32 v33, v33, v33
    v_and_b32 v33, 0xffff0000, v33
    v_mul_f32 v33, v22, v33
    v_cvt_pk_bf16_f32 v33, v33, v33
    v_and_b32 v33, 0xffff0000, v33
    v_add_f32 v33, v17, v33
    v_cvt_pk_bf16_f32 v33, v33, v33
    v_and_b32 v33, 0xffff0000, v33
    v_add_f32 v33, v13, v33
    v_cvt_pk_bf16_f32 v34, v34, v34
    v_and_b32 v34, 0xffff0000, v34
    v_mul_f32 v34, v22, v34
    v_cvt_pk_bf16_f32 v34, v34, v34
    v_and_b32 v34, 0xffff0000, v34
    v_add_f32 v34, v18, v34
    v_cvt_pk_bf16_f32 v34, v34, v34
    v_and_b32 v34, 0xffff0000, v34
    v_add_f32 v34, v14, v34
    v_cvt_pk_bf16_f32 v35, v35, v35
    v_and_b32 v35, 0xffff0000, v35
    v_mul_f32 v35, v22, v35
    v_cvt_pk_bf16_f32 v35, v35, v35
    v_and_b32 v35, 0xffff0000, v35
    v_add_f32 v35, v19, v35
    v_cvt_pk_bf16_f32 v35, v35, v35
    v_and_b32 v35, 0xffff0000, v35
    v_add_f32 v35, v15, v35
    v_cvt_pk_bf16_f32 v200, v32, v33
    v_cvt_pk_bf16_f32 v201, v34, v35
    v_mov_b32 v202, v6
L_ffn_same:
    s_add_u32 s75, s75, 1
    s_cmp_lt_u32 s75, 3
    s_cbranch_scc1 L_ffn_round
    s_cmp_ge_u32 s67, 8
    s_cbranch_scc1 L_exit
    s_mov_b32 exec_lo, 0xff
    s_mov_b32 exec_hi, 0
    buffer_store_dwordx2 v[200:201], v202, s[16:19], 0 offen
    s_mov_b64 exec, -1
    s_waitcnt vmcnt(0)
L_exit:
    s_endpgm
L_code_end:
.section .rodata,"a"
.p2align 6
.amdhsa_kernel sequential_preLN__memory_aug_recurrent_mem_tr__moe_arch_mod__prompt_kernel
  .amdhsa_next_free_vgpr 512
  .amdhsa_next_free_sgpr 102
  .amdhsa_accum_offset 256
  .amdhsa_group_segment_fixed_size 0
  .amdhsa_kernarg_size 120
  .amdhsa_user_sgpr_count 2
  .amdhsa_user_sgpr_kernarg_segment_ptr 1
  .amdhsa_system_sgpr_workgroup_id_x 1
  .amdhsa_float_denorm_mode_32 3
.end_amdhsa_kernel
```

```asm
; @launch grid=(256,1,1) block=(256,1,1) lds=163840
.amdgcn_target "amdgcn-amd-amdhsa--gfx950"
.text
.globl sequential_preLN__memory_aug_recurrent_mem_tr__moe_arch_mod__prompt_kernel
.p2align 8
.type sequential_preLN__memory_aug_recurrent_mem_tr__moe_arch_mod__prompt_kernel,@function
sequential_preLN__memory_aug_recurrent_mem_tr__moe_arch_mod__prompt_kernel:
    s_cmp_ge_u32 s2, 256
    s_cbranch_scc1 L_exit
    s_load_dwordx2 s[8:9], s[0:1], 112
    s_load_dwordx2 s[92:93], s[0:1], 104
    s_load_dwordx8 s[60:67], s[0:1], 16
    s_load_dwordx2 s[12:13], s[0:1], 0
    v_lshrrev_b32 v1, 6, v0
    s_nop 0
    v_readfirstlane_b32 s100, v1
    s_getreg_b32 s84, hwreg(HW_REG_XCC_ID)
    s_and_b32 s84, s84, 7
    s_lshr_b32 s85, s2, 3
    s_mov_b32 s86, s100
    s_cmp_eq_u32 s2, 7
    s_cbranch_scc1 L_zero
L_noz:
    s_cmp_lg_u32 s84, 0
    s_cbranch_scc1 L_other
    s_xor_b32 s20, s85, 0
    v_lshrrev_b32 v4, 6, v0
    s_nop 0
    v_readfirstlane_b32 s21, v4
    v_and_b32 v1, 63, v0
    v_lshrrev_b32 v2, 4, v1
    v_and_b32 v3, 15, v1
    v_lshrrev_b32 v6, 2, v3
    v_lshlrev_b32 v117, 4, v1
    s_lshl_b32 s51, s21, 10
    s_lshl_b32 s52, s21, 11
    s_mov_b32 s14, 0x400000
    s_mov_b32 s15, 0x20000
    s_lshl_b32 s41, s20, 8
    s_lshl_b32 s42, s20, 17
    s_lshr_b32 s43, s21, 1
    s_lshl_b32 s43, s43, 2
    v_or_b32 v5, s43, v2
    v_lshlrev_b32 v5, 1, v5
    v_xor_b32 v5, v5, v3
    v_lshrrev_b32 v14, 2, v5
    v_and_b32 v14, 2, v14
    v_lshlrev_b32 v5, 4, v5
    s_lshl_b32 s43, s21, 4
    v_add_u32 v4, s43, v2
    v_lshl_add_u32 v8, v4, 13, v5
    s_cmp_lg_u32 s20, 0
    s_cbranch_scc1 L_nocc_1
    v_lshlrev_b32 v25, 3, v117
    s_lshl_b32 s43, s21, 13
    s_getpc_b64 s[4:5]
L_pc_2:
    s_add_u32 s4, s4, L_nocc_1-L_pc_2
    s_addc_u32 s5, s5, 0
    v_add_u32 v25, s43, v25
    v_min_u32 v25, L_code_end-L_nocc_1-4, v25
    global_load_dword v29, v25, s[4:5]
L_nocc_1:
    v_mul_u32_u24 v22, 57, v0
    v_lshrrev_b32 v22, 11, v22
    v_mul_u32_u24 v23, 36, v22
    v_sub_u32 v23, v0, v23
    v_and_b32 v25, 3, v23
    v_and_or_b32 v23, v23, 60, 1
    v_min_u32 v23, 31, v23
    v_lshl_add_u32 v23, v23, 2, v25
    v_lshlrev_b32 v31, 6, v23
    s_add_u32 s43, s20, 2
    s_lshr_b32 s43, s43, 2
    s_sub_u32 s43, s20, s43
    s_mul_i32 s43, s43, 7
    v_add_u32 v22, s43, v22
    s_waitcnt lgkmcnt(0)
    s_mov_b32 s4, s60
    s_and_b32 s5, s61, 0xffff
    s_lshr_b32 s6, 0x5ddddddd, s20
    s_and_b32 s6, s6, 1
    s_lshl_b32 s6, s6, 22
    s_mov_b32 s7, 0x20000
    v_add_u32 v23, 0, v22
    v_and_b32 v25, 448, v23
    v_add_u32 v23, v23, v25
    v_lshl_add_u32 v23, v23, 13, v31
    s_mov_b32 s43, 0x80000
    buffer_load_dword v30, v23, s[4:7], s43 offen
    s_mov_b32 s4, s60
    s_and_b32 s5, s61, 0xffff
    s_lshr_b32 s6, 0x5ddddddd, s20
    s_and_b32 s6, s6, 1
    s_lshl_b32 s6, s6, 22
    s_mov_b32 s7, 0x20000
    v_add_u32 v23, 161, v22
    v_and_b32 v25, 448, v23
    v_add_u32 v23, v23, v25
    v_lshl_add_u32 v23, v23, 13, v31
    s_mov_b32 s43, 0x80000
    buffer_load_dword v30, v23, s[4:7], s43 offen
    s_and_b32 s9, s9, 0xffff
    s_mov_b32 s10, 0x10000000
    s_mov_b32 s11, 0x20000
    s_and_b32 s93, s93, 0xffff
    s_mov_b32 s94, 0x100
    s_mov_b32 s95, 0x20000
    s_mov_b32 s87, 0
    s_cmp_lg_u32 s86, 0
    s_cbranch_scc1 L_reg_3
    s_lshl_b32 s97, s84, 4
    s_lshl_b32 s96, 1, s85
    v_mov_b32 v250, s96
    v_mov_b32 v251, 256
    s_mov_b64 exec, 1
    buffer_atomic_add_x2 v[250:251], off, s[92:95], s97 offset:64
    s_mov_b64 exec, -1
    s_mov_b32 s86, 1
L_reg_3:
    s_mov_b32 s16, s92
    s_mov_b32 s17, s93
    s_mov_b32 s18, s94
    s_mov_b32 s19, s95
    s_mov_b32 s88, s20
    s_mov_b32 s12, s60
    s_and_b32 s13, s61, 0xffff
    v_xor_b32 v15, 0, v14
    v_lshl_add_u32 v15, v15, 15, v8
    s_add_u32 s43, s41, 0x0
    s_add_u32 m0, s51, 0x8000
    s_nop 0
    buffer_load_dwordx4 v15, s[12:15], s43 offen lds
    s_add_u32 s43, s41, 0x8000
    s_add_u32 m0, s51, 0x9000
    s_nop 0
    buffer_load_dwordx4 v15, s[12:15], s43 offen lds
    s_add_u32 s43, s41, 0x100000
    s_add_u32 m0, s51, 0xa000
    s_nop 0
    buffer_load_dwordx4 v15, s[12:15], s43 offen lds
    s_add_u32 s43, s41, 0x108000
    s_add_u32 m0, s51, 0xb000
    s_nop 0
    buffer_load_dwordx4 v15, s[12:15], s43 offen lds
    s_add_u32 s43, s41, 0x200000
    s_add_u32 m0, s51, 0xc000
    s_nop 0
    buffer_load_dwordx4 v15, s[12:15], s43 offen lds
    s_add_u32 s43, s41, 0x208000
    s_add_u32 m0, s51, 0xd000
    s_nop 0
    buffer_load_dwordx4 v15, s[12:15], s43 offen lds
    s_add_u32 s43, s41, 0x300000
    s_add_u32 m0, s51, 0xe000
    s_nop 0
    buffer_load_dwordx4 v15, s[12:15], s43 offen lds
    s_add_u32 s43, s41, 0x308000
    s_add_u32 m0, s51, 0xf000
    s_nop 0
    buffer_load_dwordx4 v15, s[12:15], s43 offen lds
    v_xor_b32 v15, 2, v14
    v_lshl_add_u32 v15, v15, 15, v8
    s_add_u32 s43, s41, 0x0
    s_add_u32 m0, s51, 0x10000
    s_nop 0
    buffer_load_dwordx4 v15, s[12:15], s43 offen lds
    s_add_u32 s43, s41, 0x8000
    s_add_u32 m0, s51, 0x11000
    s_nop 0
    buffer_load_dwordx4 v15, s[12:15], s43 offen lds
    s_add_u32 s43, s41, 0x100000
    s_add_u32 m0, s51, 0x12000
    s_nop 0
    buffer_load_dwordx4 v15, s[12:15], s43 offen lds
    s_add_u32 s43, s41, 0x108000
    s_add_u32 m0, s51, 0x13000
    s_nop 0
    buffer_load_dwordx4 v15, s[12:15], s43 offen lds
    s_add_u32 s43, s41, 0x200000
    s_add_u32 m0, s51, 0x14000
    s_nop 0
    buffer_load_dwordx4 v15, s[12:15], s43 offen lds
    s_add_u32 s43, s41, 0x208000
    s_add_u32 m0, s51, 0x15000
    s_nop 0
    buffer_load_dwordx4 v15, s[12:15], s43 offen lds
    s_add_u32 s43, s41, 0x300000
    s_add_u32 m0, s51, 0x16000
    s_nop 0
    buffer_load_dwordx4 v15, s[12:15], s43 offen lds
    s_add_u32 s43, s41, 0x308000
    s_add_u32 m0, s51, 0x17000
    s_nop 0
    buffer_load_dwordx4 v15, s[12:15], s43 offen lds
    v_xor_b32 v15, 0, v14
    v_lshl_add_u32 v15, v15, 15, v8
    s_add_u32 s43, s41, 0x80000
    s_add_u32 m0, s51, 0x18000
    s_nop 0
    buffer_load_dwordx4 v15, s[12:15], s43 offen lds
    s_add_u32 s43, s41, 0x88000
    s_add_u32 m0, s51, 0x19000
    s_nop 0
    buffer_load_dwordx4 v15, s[12:15], s43 offen lds
    s_add_u32 s43, s41, 0x180000
    s_add_u32 m0, s51, 0x1a000
    s_nop 0
    buffer_load_dwordx4 v15, s[12:15], s43 offen lds
    s_add_u32 s43, s41, 0x188000
    s_add_u32 m0, s51, 0x1b000
    s_nop 0
    buffer_load_dwordx4 v15, s[12:15], s43 offen lds
    v_and_b32 v4, 2, v3
    v_cmp_ne_u32 vcc, 0, v4
    v_mov_b32 v4, 0x4444
    v_mov_b32 v5, 0xeeee
    v_cndmask_b32 v116, v4, v5, vcc
    v_lshrrev_b32 v5, 1, v2
    v_lshl_add_u32 v4, v6, 3, v5
    s_lshl_b32 s43, s21, 1
    v_add_u32 v4, s43, v4
    v_add_u32 v5, s20, v4
    v_and_b32 v5, 31, v5
    v_lshl_add_u32 v4, v4, 6, v5
    v_and_b32 v5, 1, v2
    v_lshl_add_u32 v4, v4, 1, v5
    v_and_b32 v5, 3, v3
    v_lshl_add_u32 v4, v4, 2, v5
    v_lshlrev_b32 v118, 4, v4
    v_and_b32 v4, 1, v2
    v_lshlrev_b32 v4, 2, v4
    v_and_b32 v7, 2, v2
    v_add_u32 v4, v4, v7
    v_and_b32 v7, 1, v6
    v_add_u32 v4, v4, v7
    v_lshl_add_u32 v4, v4, 2, v5
    v_lshlrev_b32 v4, 2, v4
    s_and_b32 s43, s21, 1
    s_lshl_b32 s43, s43, 12
    s_lshl_b32 s40, s20, 7
    s_add_u32 s43, s43, s40
    v_add_u32 v119, s43, v4
    v_sub_u32 v7, 0, v2
    v_and_b32 v7, 3, v7
    v_xor_b32 v7, v7, v6
    v_lshl_add_u32 v4, v2, 4, v7
    v_and_b32 v5, 3, v3
    v_lshl_add_u32 v4, v4, 2, v5
    s_add_u32 s43, s51, 16384
    v_lshl_add_u32 v120, v4, 2, s43
    v_sub_u32 v7, 0, v6
    v_and_b32 v7, 3, v7
    v_xor_b32 v7, v7, v2
    v_lshl_add_u32 v4, v3, 2, v7
    v_lshlrev_b32 v121, 4, v4
    v_and_b32 v5, 1, v3
    v_lshl_add_u32 v4, v6, 1, v5
    v_lshl_add_u32 v4, v2, 3, v4
    v_lshlrev_b32 v127, 4, v4
    v_and_or_b32 v122, v116, 8, v127
    s_lshl_b32 s43, s21, 13
    s_add_u32 s43, s43, 32768
    v_add_u32 v123, s43, v117
    v_add_u32 v124, 0x10000, v123
    s_mov_b32 s36, 0xcccccccc
    s_mov_b32 s37, 0xcccccccc
    s_mov_b32 s38, 0x00ff00ff
    s_mov_b32 s39, 0x00ff00ff
    s_mov_b32 s34, 0x3e0293ee
    s_mov_b32 s35, 0x49800000
    s_mov_b32 s50, 0x3f803f80
    v_and_b32 v5, 1, v2
    v_or_b32 v5, 0, v5
    v_xor_b32 v5, v5, v6
    v_and_b32 v7, 2, v5
    v_add_u32 v5, v5, v7
    v_lshlrev_b32 v5, 6, v5
    v_and_b32 v7, 3, v3
    v_lshl_add_u32 v7, v7, 4, v5
    s_lshl_b32 s43, s21, 2
    v_add_u32 v4, s43, v2
    v_lshl_add_u32 v10, v4, 10, v7
    v_and_b32 v5, 1, v2
    v_or_b32 v5, 2, v5
    v_xor_b32 v5, v5, v6
    v_and_b32 v7, 2, v5
    v_add_u32 v5, v5, v7
    v_lshlrev_b32 v5, 6, v5
    v_and_b32 v7, 3, v3
    v_lshl_add_u32 v7, v7, 4, v5
    s_lshl_b32 s43, s21, 2
    v_add_u32 v4, s43, v2
    v_lshl_add_u32 v9, v4, 10, v7
    v_and_b32 v5, 1, v2
    v_lshl_add_u32 v4, v5, 3, v6
    v_lshrrev_b32 v7, 1, v2
    v_lshl_add_u32 v4, v7, 5, v4
    v_lshlrev_b32 v4, 8, v4
    v_lshl_or_b32 v5, v5, 2, v6
    v_lshlrev_b32 v5, 5, v5
    s_lshl_b32 s43, s21, 6
    v_xor_b32 v5, s43, v5
    v_add_u32 v4, v4, v5
    v_and_b32 v5, 3, v3
    v_lshl_add_u32 v4, v5, 3, v4
    v_add_u32 v11, 32768, v4
    s_and_b32 s43, s21, 1
    s_lshl_b32 s43, s43, 12
    v_add_u32 v11, s43, v11
    v_and_b32 v5, 1, v2
    v_lshlrev_b32 v4, 4, v5
    v_lshl_add_u32 v4, v7, 2, v4
    v_and_b32 v7, 1, v6
    v_add_u32 v4, v4, v7
    s_lshl_b32 s43, s21, 5
    v_add_u32 v4, s43, v4
    v_lshlrev_b32 v4, 8, v4
    v_lshl_or_b32 v5, v5, 1, v7
    s_lshl_b32 s43, s21, 1
    s_and_b32 s43, s43, 3
    v_xor_b32 v5, s43, v5
    v_lshl_add_u32 v4, v5, 6, v4
    v_lshrrev_b32 v5, 1, v6
    v_lshl_add_u32 v4, v5, 5, v4
    v_and_b32 v5, 3, v3
    v_lshl_add_u32 v4, v5, 3, v4
    v_add_u32 v12, 32768, v4
    v_lshlrev_b32 v4, 18, v2
    v_lshl_add_u32 v4, v3, 7, v4
    s_lshl_b32 s43, s20, 13
    s_add_u32 s43, s43, s52
    s_add_u32 s43, s43, 0xf0000
    v_add_u32 v4, s43, v4
    v_and_b32 v5, 3, v3
    v_lshl_add_u32 v5, v5, 13, v119
    v_cmp_gt_u32 vcc, 2, v2
    s_nop 1
    v_cndmask_b32 v7, v5, v4, vcc
    v_mov_b32 v16, -1
    v_mov_b32 v17, -1
    v_mov_b32 v18, -1
    v_mov_b32 v19, -1
    s_lshl_b32 s43, s20, 13
    s_add_u32 s43, s43, 0x100000
    s_and_b32 s40, s21, 1
    s_lshl_b32 s40, s40, 12
    s_add_u32 s29, s43, s40
    s_add_u32 s43, s43, s52
    s_xor_b32 s40, s43, 0x40000
    buffer_store_dwordx4 v[16:19], v117, s[8:11], s43 offen
    buffer_store_dwordx4 v[16:19], v117, s[8:11], s43 offen offset:1024
    buffer_store_dwordx4 v[16:19], v117, s[8:11], s40 offen
    buffer_store_dwordx4 v[16:19], v117, s[8:11], s40 offen offset:1024
    s_mov_b32 s43, 0x12000
    buffer_store_dword v16, v119, s[8:11], s43 offen
    s_mov_b32 s43, 0x14000
    buffer_store_dword v16, v119, s[8:11], s43 offen
    s_mov_b32 s43, 0x16000
    buffer_store_dword v16, v119, s[8:11], s43 offen
    s_load_dwordx2 s[4:5], s[0:1], 8
    s_waitcnt lgkmcnt(0)
    s_and_b32 s5, s5, 0xffff
    s_mov_b32 s6, 8192
    s_mov_b32 s7, 0x20000
    v_and_b32 v20, 1, v2
    v_and_b32 v21, 1, v6
    v_lshl_add_u32 v20, v20, 1, v21
    v_lshlrev_b32 v20, 9, v20
    v_and_b32 v21, 3, v3
    v_lshl_add_u32 v20, v21, 4, v20
    v_and_b32 v21, 2, v2
    v_add_u32 v20, v20, v21
    s_and_b32 s43, s20, 1
    s_lshl_b32 s43, s43, 11
    s_bfe_u32 s40, s20, 0x20001
    s_lshl_b32 s40, s40, 7
    s_add_u32 s43, s43, s40
    s_and_b32 s40, s21, 1
    s_lshl_b32 s40, s40, 6
    s_add_u32 s43, s43, s40
    s_lshr_b32 s40, s20, 3
    s_lshl_b32 s40, s40, 2
    s_add_u32 s43, s43, s40
    v_add_u32 v20, s43, v20
    v_lshlrev_b32 v20, 1, v20
    buffer_load_dword v21, v20, s[4:7], 0 offen
    s_mov_b32 s57, 0
    s_lshl_b32 s43, s20, 13
    s_add_u32 s43, s43, s52
    s_add_u32 s30, s43, 0x1000000
    s_add_u32 s31, s43, 0x2000000
    s_lshr_b32 s43, s43, 1
    s_add_u32 s32, s43, 0x220000
    s_waitcnt vmcnt(20)
    s_barrier
    v_xor_b32 v13, 0x0, v11
    v_add_u32 v13, 0x0, v13
    ds_read_b64_tr_b16 v[80:81], v13
    ds_read_b64_tr_b16 v[82:83], v13 offset:1024
    ds_read_b64_tr_b16 v[84:85], v13 offset:16384
    ds_read_b64_tr_b16 v[86:87], v13 offset:17408
    v_xor_b32 v13, 0x20, v11
    v_add_u32 v13, 0x0, v13
    ds_read_b64_tr_b16 v[56:57], v13
    ds_read_b64_tr_b16 v[58:59], v13 offset:1024
    ds_read_b64_tr_b16 v[60:61], v13 offset:16384
    ds_read_b64_tr_b16 v[62:63], v13 offset:17408
    v_xor_b32 v13, 0x1000, v11
    v_add_u32 v13, 0x0, v13
    ds_read_b64_tr_b16 a[0:1], v13
    ds_read_b64_tr_b16 a[2:3], v13 offset:1024
    ds_read_b64_tr_b16 a[4:5], v13 offset:16384
    ds_read_b64_tr_b16 a[6:7], v13 offset:17408
    v_xor_b32 v13, 0x1020, v11
    v_add_u32 v13, 0x0, v13
    ds_read_b64_tr_b16 a[8:9], v13
    ds_read_b64_tr_b16 a[10:11], v13 offset:1024
    ds_read_b64_tr_b16 a[12:13], v13 offset:16384
    ds_read_b64_tr_b16 a[14:15], v13 offset:17408
    s_waitcnt lgkmcnt(0)
    s_barrier
    s_mov_b32 s4, s62
    s_and_b32 s5, s63, 0xffff
    s_lshr_b32 s6, 0x5ddddddd, s20
    s_and_b32 s6, s6, 1
    s_lshl_b32 s6, s6, 22
    s_mov_b32 s7, 0x20000
    v_add_u32 v23, 0, v22
    v_and_b32 v25, 448, v23
    v_add_u32 v23, v23, v25
    v_lshl_add_u32 v23, v23, 13, v31
    s_mov_b32 s43, 0x0
    buffer_load_dword v30, v23, s[4:7], s43 offen
    s_add_u32 s43, s41, 0x280000
    s_add_u32 m0, s51, 0x1c000
    s_nop 0
    buffer_load_dwordx4 v15, s[12:15], s43 offen lds
    s_add_u32 s43, s41, 0x288000
    s_add_u32 m0, s51, 0x1d000
    s_nop 0
    buffer_load_dwordx4 v15, s[12:15], s43 offen lds
    s_add_u32 s43, s41, 0x380000
    s_add_u32 m0, s51, 0x1e000
    s_nop 0
    buffer_load_dwordx4 v15, s[12:15], s43 offen lds
    s_add_u32 s43, s41, 0x388000
    s_add_u32 m0, s51, 0x1f000
    s_nop 0
    buffer_load_dwordx4 v15, s[12:15], s43 offen lds
    v_xor_b32 v15, 2, v14
    v_lshl_add_u32 v15, v15, 15, v8
    s_add_u32 s43, s41, 0x80000
    s_add_u32 m0, s51, 0x20000
    s_nop 0
    buffer_load_dwordx4 v15, s[12:15], s43 offen lds
    s_add_u32 s43, s41, 0x88000
    s_add_u32 m0, s51, 0x21000
    s_nop 0
    buffer_load_dwordx4 v15, s[12:15], s43 offen lds
    s_add_u32 s43, s41, 0x180000
    s_add_u32 m0, s51, 0x22000
    s_nop 0
    buffer_load_dwordx4 v15, s[12:15], s43 offen lds
    s_add_u32 s43, s41, 0x188000
    s_add_u32 m0, s51, 0x23000
    s_nop 0
    buffer_load_dwordx4 v15, s[12:15], s43 offen lds
    s_waitcnt vmcnt(21)
    s_barrier
    v_xor_b32 v13, 0x0, v11
    v_add_u32 v13, 0x8000, v13
    ds_read_b64_tr_b16 a[32:33], v13
    ds_read_b64_tr_b16 a[34:35], v13 offset:1024
    ds_read_b64_tr_b16 a[36:37], v13 offset:16384
    ds_read_b64_tr_b16 a[38:39], v13 offset:17408
    v_xor_b32 v13, 0x20, v11
    v_add_u32 v13, 0x8000, v13
    ds_read_b64_tr_b16 a[40:41], v13
    ds_read_b64_tr_b16 a[42:43], v13 offset:1024
    ds_read_b64_tr_b16 a[44:45], v13 offset:16384
    ds_read_b64_tr_b16 a[46:47], v13 offset:17408
    v_xor_b32 v13, 0x1000, v11
    v_add_u32 v13, 0x8000, v13
    ds_read_b64_tr_b16 a[64:65], v13
    ds_read_b64_tr_b16 a[66:67], v13 offset:1024
    ds_read_b64_tr_b16 a[68:69], v13 offset:16384
    ds_read_b64_tr_b16 a[70:71], v13 offset:17408
    v_xor_b32 v13, 0x1020, v11
    v_add_u32 v13, 0x8000, v13
    ds_read_b64_tr_b16 a[72:73], v13
    ds_read_b64_tr_b16 a[74:75], v13 offset:1024
    ds_read_b64_tr_b16 a[76:77], v13 offset:16384
    ds_read_b64_tr_b16 a[78:79], v13 offset:17408
    s_waitcnt lgkmcnt(0)
    s_barrier
    s_add_u32 s43, s41, 0x280000
    s_add_u32 m0, s51, 0x24000
    s_nop 0
    buffer_load_dwordx4 v15, s[12:15], s43 offen lds
    s_add_u32 s43, s41, 0x288000
    s_add_u32 m0, s51, 0x25000
    s_nop 0
    buffer_load_dwordx4 v15, s[12:15], s43 offen lds
    s_add_u32 s43, s41, 0x380000
    s_add_u32 m0, s51, 0x26000
    s_nop 0
    buffer_load_dwordx4 v15, s[12:15], s43 offen lds
    s_add_u32 s43, s41, 0x388000
    s_add_u32 m0, s51, 0x27000
    s_nop 0
    buffer_load_dwordx4 v15, s[12:15], s43 offen lds
    s_mov_b32 s12, s62
    s_and_b32 s13, s63, 0xffff
    v_xor_b32 v15, 0, v14
    v_lshl_add_u32 v15, v15, 15, v8
    s_add_u32 s43, s41, 0x0
    s_add_u32 m0, s51, 0x8000
    s_nop 0
    buffer_load_dwordx4 v15, s[12:15], s43 offen lds
    s_add_u32 s43, s41, 0x8000
    s_add_u32 m0, s51, 0x9000
    s_nop 0
    buffer_load_dwordx4 v15, s[12:15], s43 offen lds
    s_add_u32 s43, s41, 0x100000
    s_add_u32 m0, s51, 0xa000
    s_nop 0
    buffer_load_dwordx4 v15, s[12:15], s43 offen lds
    s_add_u32 s43, s41, 0x108000
    s_add_u32 m0, s51, 0xb000
    s_nop 0
    buffer_load_dwordx4 v15, s[12:15], s43 offen lds
    s_waitcnt vmcnt(12)
    s_barrier
    v_xor_b32 v13, 0x0, v11
    v_add_u32 v13, 0x10000, v13
    ds_read_b64_tr_b16 v[88:89], v13
    ds_read_b64_tr_b16 v[90:91], v13 offset:1024
    ds_read_b64_tr_b16 v[92:93], v13 offset:16384
    ds_read_b64_tr_b16 v[94:95], v13 offset:17408
    v_xor_b32 v13, 0x20, v11
    v_add_u32 v13, 0x10000, v13
    ds_read_b64_tr_b16 v[96:97], v13
    ds_read_b64_tr_b16 v[98:99], v13 offset:1024
    ds_read_b64_tr_b16 v[100:101], v13 offset:16384
    ds_read_b64_tr_b16 v[102:103], v13 offset:17408
    v_xor_b32 v13, 0x1000, v11
    v_add_u32 v13, 0x10000, v13
    ds_read_b64_tr_b16 a[16:17], v13
    ds_read_b64_tr_b16 a[18:19], v13 offset:1024
    ds_read_b64_tr_b16 a[20:21], v13 offset:16384
    ds_read_b64_tr_b16 a[22:23], v13 offset:17408
    v_xor_b32 v13, 0x1020, v11
    v_add_u32 v13, 0x10000, v13
    ds_read_b64_tr_b16 a[24:25], v13
    ds_read_b64_tr_b16 a[26:27], v13 offset:1024
    ds_read_b64_tr_b16 a[28:29], v13 offset:16384
    ds_read_b64_tr_b16 a[30:31], v13 offset:17408
    s_waitcnt lgkmcnt(0)
    s_barrier
    s_add_u32 s43, s41, 0x200000
    s_add_u32 m0, s51, 0xc000
    s_nop 0
    buffer_load_dwordx4 v15, s[12:15], s43 offen lds
    s_add_u32 s43, s41, 0x208000
    s_add_u32 m0, s51, 0xd000
    s_nop 0
    buffer_load_dwordx4 v15, s[12:15], s43 offen lds
    s_add_u32 s43, s41, 0x300000
    s_add_u32 m0, s51, 0xe000
    s_nop 0
    buffer_load_dwordx4 v15, s[12:15], s43 offen lds
    s_add_u32 s43, s41, 0x308000
    s_add_u32 m0, s51, 0xf000
    s_nop 0
    buffer_load_dwordx4 v15, s[12:15], s43 offen lds
    v_xor_b32 v15, 2, v14
    v_lshl_add_u32 v15, v15, 15, v8
    s_add_u32 s43, s41, 0x0
    s_add_u32 m0, s51, 0x10000
    s_nop 0
    buffer_load_dwordx4 v15, s[12:15], s43 offen lds
    s_add_u32 s43, s41, 0x8000
    s_add_u32 m0, s51, 0x11000
    s_nop 0
    buffer_load_dwordx4 v15, s[12:15], s43 offen lds
    s_add_u32 s43, s41, 0x100000
    s_add_u32 m0, s51, 0x12000
    s_nop 0
    buffer_load_dwordx4 v15, s[12:15], s43 offen lds
    s_add_u32 s43, s41, 0x108000
    s_add_u32 m0, s51, 0x13000
    s_nop 0
    buffer_load_dwordx4 v15, s[12:15], s43 offen lds
    s_waitcnt vmcnt(12)
    s_barrier
    v_xor_b32 v13, 0x0, v11
    v_add_u32 v13, 0x18000, v13
    ds_read_b64_tr_b16 a[48:49], v13
    ds_read_b64_tr_b16 a[50:51], v13 offset:1024
    ds_read_b64_tr_b16 a[52:53], v13 offset:16384
    ds_read_b64_tr_b16 a[54:55], v13 offset:17408
    v_xor_b32 v13, 0x20, v11
    v_add_u32 v13, 0x18000, v13
    ds_read_b64_tr_b16 a[56:57], v13
    ds_read_b64_tr_b16 a[58:59], v13 offset:1024
    ds_read_b64_tr_b16 a[60:61], v13 offset:16384
    ds_read_b64_tr_b16 a[62:63], v13 offset:17408
    v_xor_b32 v13, 0x1000, v11
    v_add_u32 v13, 0x18000, v13
    ds_read_b64_tr_b16 a[80:81], v13
    ds_read_b64_tr_b16 a[82:83], v13 offset:1024
    ds_read_b64_tr_b16 a[84:85], v13 offset:16384
    ds_read_b64_tr_b16 a[86:87], v13 offset:17408
    v_xor_b32 v13, 0x1020, v11
    v_add_u32 v13, 0x18000, v13
    ds_read_b64_tr_b16 a[88:89], v13
    ds_read_b64_tr_b16 a[90:91], v13 offset:1024
    ds_read_b64_tr_b16 a[92:93], v13 offset:16384
    ds_read_b64_tr_b16 a[94:95], v13 offset:17408
    s_waitcnt lgkmcnt(0)
    s_barrier
    s_add_u32 s43, s41, 0x200000
    s_add_u32 m0, s51, 0x14000
    s_nop 0
    buffer_load_dwordx4 v15, s[12:15], s43 offen lds
    s_add_u32 s43, s41, 0x208000
    s_add_u32 m0, s51, 0x15000
    s_nop 0
    buffer_load_dwordx4 v15, s[12:15], s43 offen lds
    s_add_u32 s43, s41, 0x300000
    s_add_u32 m0, s51, 0x16000
    s_nop 0
    buffer_load_dwordx4 v15, s[12:15], s43 offen lds
    s_add_u32 s43, s41, 0x308000
    s_add_u32 m0, s51, 0x17000
    s_nop 0
    buffer_load_dwordx4 v15, s[12:15], s43 offen lds
    v_xor_b32 v15, 0, v14
    v_lshl_add_u32 v15, v15, 15, v8
    s_add_u32 s43, s41, 0x80000
    s_add_u32 m0, s51, 0x18000
    s_nop 0
    buffer_load_dwordx4 v15, s[12:15], s43 offen lds
    s_add_u32 s43, s41, 0x88000
    s_add_u32 m0, s51, 0x19000
    s_nop 0
    buffer_load_dwordx4 v15, s[12:15], s43 offen lds
    s_add_u32 s43, s41, 0x180000
    s_add_u32 m0, s51, 0x1a000
    s_nop 0
    buffer_load_dwordx4 v15, s[12:15], s43 offen lds
    s_add_u32 s43, s41, 0x188000
    s_add_u32 m0, s51, 0x1b000
    s_nop 0
    buffer_load_dwordx4 v15, s[12:15], s43 offen lds
    s_waitcnt vmcnt(12)
    v_min_u32 v21, 0xfffffffe, v21
    s_mov_b32 s43, 0x10000
    s_mov_b64 exec, s[38:39]
    buffer_store_dword v21, v119, s[8:11], s43 offen
    s_mov_b64 exec, -1
    s_barrier
    v_xor_b32 v13, 0x0, v11
    v_add_u32 v13, 0x0, v13
    ds_read_b64_tr_b16 v[64:65], v13
    ds_read_b64_tr_b16 v[66:67], v13 offset:1024
    ds_read_b64_tr_b16 v[68:69], v13 offset:16384
    ds_read_b64_tr_b16 v[70:71], v13 offset:17408
    v_xor_b32 v13, 0x20, v11
    v_add_u32 v13, 0x0, v13
    ds_read_b64_tr_b16 v[72:73], v13
    ds_read_b64_tr_b16 v[74:75], v13 offset:1024
    ds_read_b64_tr_b16 v[76:77], v13 offset:16384
    ds_read_b64_tr_b16 v[78:79], v13 offset:17408
    v_xor_b32 v13, 0x1000, v11
    v_add_u32 v13, 0x0, v13
    ds_read_b64_tr_b16 a[96:97], v13
    ds_read_b64_tr_b16 a[98:99], v13 offset:1024
    ds_read_b64_tr_b16 a[100:101], v13 offset:16384
    ds_read_b64_tr_b16 a[102:103], v13 offset:17408
    v_xor_b32 v13, 0x1020, v11
    v_add_u32 v13, 0x0, v13
    ds_read_b64_tr_b16 a[104:105], v13
    ds_read_b64_tr_b16 a[106:107], v13 offset:1024
    ds_read_b64_tr_b16 a[108:109], v13 offset:16384
    ds_read_b64_tr_b16 a[110:111], v13 offset:17408
    s_waitcnt lgkmcnt(0)
    s_barrier
    s_add_u32 s43, s41, 0x280000
    s_add_u32 m0, s51, 0x1c000
    s_nop 0
    buffer_load_dwordx4 v15, s[12:15], s43 offen lds
    s_add_u32 s43, s41, 0x288000
    s_add_u32 m0, s51, 0x1d000
    s_nop 0
    buffer_load_dwordx4 v15, s[12:15], s43 offen lds
    s_add_u32 s43, s41, 0x380000
    s_add_u32 m0, s51, 0x1e000
    s_nop 0
    buffer_load_dwordx4 v15, s[12:15], s43 offen lds
    s_add_u32 s43, s41, 0x388000
    s_add_u32 m0, s51, 0x1f000
    s_nop 0
    buffer_load_dwordx4 v15, s[12:15], s43 offen lds
    v_xor_b32 v15, 2, v14
    v_lshl_add_u32 v15, v15, 15, v8
    s_add_u32 s43, s41, 0x80000
    s_add_u32 m0, s51, 0x20000
    s_nop 0
    buffer_load_dwordx4 v15, s[12:15], s43 offen lds
    s_add_u32 s43, s41, 0x88000
    s_add_u32 m0, s51, 0x21000
    s_nop 0
    buffer_load_dwordx4 v15, s[12:15], s43 offen lds
    s_add_u32 s43, s41, 0x180000
    s_add_u32 m0, s51, 0x22000
    s_nop 0
    buffer_load_dwordx4 v15, s[12:15], s43 offen lds
    s_add_u32 s43, s41, 0x188000
    s_add_u32 m0, s51, 0x23000
    s_nop 0
    buffer_load_dwordx4 v15, s[12:15], s43 offen lds
    s_waitcnt vmcnt(12)
    s_barrier
    v_xor_b32 v13, 0x0, v11
    v_add_u32 v13, 0x8000, v13
    ds_read_b64_tr_b16 a[128:129], v13
    ds_read_b64_tr_b16 a[130:131], v13 offset:1024
    ds_read_b64_tr_b16 a[132:133], v13 offset:16384
    ds_read_b64_tr_b16 a[134:135], v13 offset:17408
    v_xor_b32 v13, 0x20, v11
    v_add_u32 v13, 0x8000, v13
    ds_read_b64_tr_b16 a[136:137], v13
    ds_read_b64_tr_b16 a[138:139], v13 offset:1024
    ds_read_b64_tr_b16 a[140:141], v13 offset:16384
    ds_read_b64_tr_b16 a[142:143], v13 offset:17408
    v_xor_b32 v13, 0x1000, v11
    v_add_u32 v13, 0x8000, v13
    ds_read_b64_tr_b16 a[160:161], v13
    ds_read_b64_tr_b16 a[162:163], v13 offset:1024
    ds_read_b64_tr_b16 a[164:165], v13 offset:16384
    ds_read_b64_tr_b16 a[166:167], v13 offset:17408
    v_xor_b32 v13, 0x1020, v11
    v_add_u32 v13, 0x8000, v13
    ds_read_b64_tr_b16 a[168:169], v13
    ds_read_b64_tr_b16 a[170:171], v13 offset:1024
    ds_read_b64_tr_b16 a[172:173], v13 offset:16384
    ds_read_b64_tr_b16 a[174:175], v13 offset:17408
    s_waitcnt lgkmcnt(0)
    s_barrier
    buffer_load_dwordx2 v[26:27], off, s[16:19], 0 offset:36 sc1
    s_add_u32 s43, s41, 0x280000
    s_add_u32 m0, s51, 0x24000
    s_nop 0
    buffer_load_dwordx4 v15, s[12:15], s43 offen lds
    s_add_u32 s43, s41, 0x288000
    s_add_u32 m0, s51, 0x25000
    s_nop 0
    buffer_load_dwordx4 v15, s[12:15], s43 offen lds
    s_add_u32 s43, s41, 0x380000
    s_add_u32 m0, s51, 0x26000
    s_nop 0
    buffer_load_dwordx4 v15, s[12:15], s43 offen lds
    s_add_u32 s43, s41, 0x388000
    s_add_u32 m0, s51, 0x27000
    s_nop 0
    buffer_load_dwordx4 v15, s[12:15], s43 offen lds
    s_mov_b32 s12, s64
    s_and_b32 s13, s65, 0xffff
    v_xor_b32 v15, 0, v14
    v_lshl_add_u32 v15, v15, 15, v8
    s_add_u32 s43, s41, 0x0
    s_add_u32 m0, s51, 0x8000
    s_nop 0
    buffer_load_dwordx4 v15, s[12:15], s43 offen lds
    s_add_u32 s43, s41, 0x8000
    s_add_u32 m0, s51, 0x9000
    s_nop 0
    buffer_load_dwordx4 v15, s[12:15], s43 offen lds
    s_add_u32 s43, s41, 0x100000
    s_add_u32 m0, s51, 0xa000
    s_nop 0
    buffer_load_dwordx4 v15, s[12:15], s43 offen lds
    s_add_u32 s43, s41, 0x108000
    s_add_u32 m0, s51, 0xb000
    s_nop 0
    buffer_load_dwordx4 v15, s[12:15], s43 offen lds
    s_waitcnt vmcnt(13)
    s_barrier
    v_xor_b32 v13, 0x0, v11
    v_add_u32 v13, 0x10000, v13
    ds_read_b64_tr_b16 v[104:105], v13
    ds_read_b64_tr_b16 v[106:107], v13 offset:1024
    ds_read_b64_tr_b16 v[108:109], v13 offset:16384
    ds_read_b64_tr_b16 v[110:111], v13 offset:17408
    v_xor_b32 v13, 0x20, v11
    v_add_u32 v13, 0x10000, v13
    ds_read_b64_tr_b16 v[32:33], v13
    ds_read_b64_tr_b16 v[34:35], v13 offset:1024
    ds_read_b64_tr_b16 v[36:37], v13 offset:16384
    ds_read_b64_tr_b16 v[38:39], v13 offset:17408
    v_xor_b32 v13, 0x1000, v11
    v_add_u32 v13, 0x10000, v13
    ds_read_b64_tr_b16 a[112:113], v13
    ds_read_b64_tr_b16 a[114:115], v13 offset:1024
    ds_read_b64_tr_b16 a[116:117], v13 offset:16384
    ds_read_b64_tr_b16 a[118:119], v13 offset:17408
    v_xor_b32 v13, 0x1020, v11
    v_add_u32 v13, 0x10000, v13
    ds_read_b64_tr_b16 a[120:121], v13
    ds_read_b64_tr_b16 a[122:123], v13 offset:1024
    ds_read_b64_tr_b16 a[124:125], v13 offset:16384
    ds_read_b64_tr_b16 a[126:127], v13 offset:17408
    s_waitcnt lgkmcnt(0)
    s_barrier
    s_add_u32 s43, s41, 0x200000
    s_add_u32 m0, s51, 0xc000
    s_nop 0
    buffer_load_dwordx4 v15, s[12:15], s43 offen lds
    s_add_u32 s43, s41, 0x208000
    s_add_u32 m0, s51, 0xd000
    s_nop 0
    buffer_load_dwordx4 v15, s[12:15], s43 offen lds
    s_add_u32 s43, s41, 0x300000
    s_add_u32 m0, s51, 0xe000
    s_nop 0
    buffer_load_dwordx4 v15, s[12:15], s43 offen lds
    s_add_u32 s43, s41, 0x308000
    s_add_u32 m0, s51, 0xf000
    s_nop 0
    buffer_load_dwordx4 v15, s[12:15], s43 offen lds
    v_xor_b32 v15, 2, v14
    v_lshl_add_u32 v15, v15, 15, v8
    s_add_u32 s43, s41, 0x0
    s_add_u32 m0, s51, 0x10000
    s_nop 0
    buffer_load_dwordx4 v15, s[12:15], s43 offen lds
    s_add_u32 s43, s41, 0x8000
    s_add_u32 m0, s51, 0x11000
    s_nop 0
    buffer_load_dwordx4 v15, s[12:15], s43 offen lds
    s_add_u32 s43, s41, 0x100000
    s_add_u32 m0, s51, 0x12000
    s_nop 0
    buffer_load_dwordx4 v15, s[12:15], s43 offen lds
    s_add_u32 s43, s41, 0x108000
    s_add_u32 m0, s51, 0x13000
    s_nop 0
    buffer_load_dwordx4 v15, s[12:15], s43 offen lds
    s_waitcnt vmcnt(12)
    s_barrier
    v_xor_b32 v13, 0x0, v11
    v_add_u32 v13, 0x18000, v13
    ds_read_b64_tr_b16 a[144:145], v13
    ds_read_b64_tr_b16 a[146:147], v13 offset:1024
    ds_read_b64_tr_b16 a[148:149], v13 offset:16384
    ds_read_b64_tr_b16 a[150:151], v13 offset:17408
    v_xor_b32 v13, 0x20, v11
    v_add_u32 v13, 0x18000, v13
    ds_read_b64_tr_b16 a[152:153], v13
    ds_read_b64_tr_b16 a[154:155], v13 offset:1024
    ds_read_b64_tr_b16 a[156:157], v13 offset:16384
    ds_read_b64_tr_b16 a[158:159], v13 offset:17408
    v_xor_b32 v13, 0x1000, v11
    v_add_u32 v13, 0x18000, v13
    ds_read_b64_tr_b16 a[176:177], v13
    ds_read_b64_tr_b16 a[178:179], v13 offset:1024
    ds_read_b64_tr_b16 a[180:181], v13 offset:16384
    ds_read_b64_tr_b16 a[182:183], v13 offset:17408
    v_xor_b32 v13, 0x1020, v11
    v_add_u32 v13, 0x18000, v13
    ds_read_b64_tr_b16 a[184:185], v13
    ds_read_b64_tr_b16 a[186:187], v13 offset:1024
    ds_read_b64_tr_b16 a[188:189], v13 offset:16384
    ds_read_b64_tr_b16 a[190:191], v13 offset:17408
    s_waitcnt lgkmcnt(0)
    s_barrier
    s_add_u32 s43, s41, 0x200000
    s_add_u32 m0, s51, 0x14000
    s_nop 0
    buffer_load_dwordx4 v15, s[12:15], s43 offen lds
    s_add_u32 s43, s41, 0x208000
    s_add_u32 m0, s51, 0x15000
    s_nop 0
    buffer_load_dwordx4 v15, s[12:15], s43 offen lds
    s_add_u32 s43, s41, 0x300000
    s_add_u32 m0, s51, 0x16000
    s_nop 0
    buffer_load_dwordx4 v15, s[12:15], s43 offen lds
    s_add_u32 s43, s41, 0x308000
    s_add_u32 m0, s51, 0x17000
    s_nop 0
    buffer_load_dwordx4 v15, s[12:15], s43 offen lds
    s_mov_b32 s12, s66
    s_and_b32 s13, s67, 0xffff
    s_add_u32 s43, s42, 0x80
    s_add_u32 m0, s51, 0x18000
    s_nop 0
    buffer_load_dwordx4 v10, s[12:15], s43 offen lds
    s_add_u32 s43, s42, 0x4080
    s_add_u32 m0, s51, 0x19000
    s_nop 0
    buffer_load_dwordx4 v9, s[12:15], s43 offen lds
    s_add_u32 s43, s42, 0x8080
    s_add_u32 m0, s51, 0x1a000
    s_nop 0
    buffer_load_dwordx4 v10, s[12:15], s43 offen lds
    s_add_u32 s43, s42, 0xc080
    s_add_u32 m0, s51, 0x1b000
    s_nop 0
    buffer_load_dwordx4 v9, s[12:15], s43 offen lds
    s_waitcnt vmcnt(12)
    s_barrier
    v_xor_b32 v13, 0x0, v11
    v_add_u32 v13, 0x0, v13
    ds_read_b64_tr_b16 a[192:193], v13
    ds_read_b64_tr_b16 a[194:195], v13 offset:1024
    ds_read_b64_tr_b16 a[196:197], v13 offset:16384
    ds_read_b64_tr_b16 a[198:199], v13 offset:17408
    v_xor_b32 v13, 0x20, v11
    v_add_u32 v13, 0x0, v13
    ds_read_b64_tr_b16 a[200:201], v13
    ds_read_b64_tr_b16 a[202:203], v13 offset:1024
    ds_read_b64_tr_b16 a[204:205], v13 offset:16384
    ds_read_b64_tr_b16 a[206:207], v13 offset:17408
    v_xor_b32 v13, 0x1000, v11
    v_add_u32 v13, 0x0, v13
    ds_read_b64_tr_b16 a[224:225], v13
    ds_read_b64_tr_b16 a[226:227], v13 offset:1024
    ds_read_b64_tr_b16 a[228:229], v13 offset:16384
    ds_read_b64_tr_b16 a[230:231], v13 offset:17408
    v_xor_b32 v13, 0x1020, v11
    v_add_u32 v13, 0x0, v13
    ds_read_b64_tr_b16 a[232:233], v13
    ds_read_b64_tr_b16 a[234:235], v13 offset:1024
    ds_read_b64_tr_b16 a[236:237], v13 offset:16384
    ds_read_b64_tr_b16 a[238:239], v13 offset:17408
    s_waitcnt lgkmcnt(0)
    s_barrier
    s_add_u32 s43, s42, 0x10280
    s_add_u32 m0, s51, 0x1c000
    s_nop 0
    buffer_load_dwordx4 v10, s[12:15], s43 offen lds
    s_add_u32 s43, s42, 0x14280
    s_add_u32 m0, s51, 0x1d000
    s_nop 0
    buffer_load_dwordx4 v9, s[12:15], s43 offen lds
    s_add_u32 s43, s42, 0x18280
    s_add_u32 m0, s51, 0x1e000
    s_nop 0
    buffer_load_dwordx4 v10, s[12:15], s43 offen lds
    s_add_u32 s43, s42, 0x1c280
    s_add_u32 m0, s51, 0x1f000
    s_nop 0
    buffer_load_dwordx4 v9, s[12:15], s43 offen lds
    s_add_u32 s43, s42, 0x10080
    s_add_u32 m0, s51, 0x20000
    s_nop 0
    buffer_load_dwordx4 v10, s[12:15], s43 offen lds
    s_add_u32 s43, s42, 0x14080
    s_add_u32 m0, s51, 0x21000
    s_nop 0
    buffer_load_dwordx4 v9, s[12:15], s43 offen lds
    s_add_u32 s43, s42, 0x18080
    s_add_u32 m0, s51, 0x22000
    s_nop 0
    buffer_load_dwordx4 v10, s[12:15], s43 offen lds
    s_add_u32 s43, s42, 0x1c080
    s_add_u32 m0, s51, 0x23000
    s_nop 0
    buffer_load_dwordx4 v9, s[12:15], s43 offen lds
    s_waitcnt vmcnt(12)
    v_readfirstlane_b32 s57, v26
    v_readfirstlane_b32 s43, v27
    s_nop 0
    s_cmp_lg_u32 s43, 0
    s_cselect_b32 s57, s57, 0
    s_barrier
    s_cmp_lg_u32 s21, 0
    s_cbranch_scc1 L_arr_4
    v_mov_b32 v23, 1
    s_mov_b64 exec, 1
    buffer_atomic_add v23, off, s[16:19], 0 offset:4
    s_mov_b64 exec, -1
L_arr_4:
    v_xor_b32 v13, 0x0, v11
    v_add_u32 v13, 0x8000, v13
    ds_read_b64_tr_b16 v[128:129], v13
    ds_read_b64_tr_b16 v[130:131], v13 offset:1024
    ds_read_b64_tr_b16 v[132:133], v13 offset:16384
    ds_read_b64_tr_b16 v[134:135], v13 offset:17408
    v_xor_b32 v13, 0x20, v11
    v_add_u32 v13, 0x8000, v13
    ds_read_b64_tr_b16 v[136:137], v13
    ds_read_b64_tr_b16 v[138:139], v13 offset:1024
    ds_read_b64_tr_b16 v[140:141], v13 offset:16384
    ds_read_b64_tr_b16 v[142:143], v13 offset:17408
    v_xor_b32 v13, 0x1000, v11
    v_add_u32 v13, 0x8000, v13
    ds_read_b64_tr_b16 v[160:161], v13
    ds_read_b64_tr_b16 v[162:163], v13 offset:1024
    ds_read_b64_tr_b16 v[164:165], v13 offset:16384
    ds_read_b64_tr_b16 v[166:167], v13 offset:17408
    v_xor_b32 v13, 0x1020, v11
    v_add_u32 v13, 0x8000, v13
    ds_read_b64_tr_b16 v[168:169], v13
    ds_read_b64_tr_b16 v[170:171], v13 offset:1024
    ds_read_b64_tr_b16 v[172:173], v13 offset:16384
    ds_read_b64_tr_b16 v[174:175], v13 offset:17408
    s_waitcnt lgkmcnt(0)
    s_barrier
    s_add_u32 s43, s42, 0x280
    s_add_u32 m0, s51, 0x24000
    s_nop 0
    buffer_load_dwordx4 v10, s[12:15], s43 offen lds
    s_add_u32 s43, s42, 0x4280
    s_add_u32 m0, s51, 0x25000
    s_nop 0
    buffer_load_dwordx4 v9, s[12:15], s43 offen lds
    s_add_u32 s43, s42, 0x8280
    s_add_u32 m0, s51, 0x26000
    s_nop 0
    buffer_load_dwordx4 v10, s[12:15], s43 offen lds
    s_add_u32 s43, s42, 0xc280
    s_add_u32 m0, s51, 0x27000
    s_nop 0
    buffer_load_dwordx4 v9, s[12:15], s43 offen lds
    s_mov_b32 s12, s64
    s_and_b32 s13, s65, 0xffff
    v_xor_b32 v15, 0, v14
    v_lshl_add_u32 v15, v15, 15, v8
    s_add_u32 s43, s41, 0x80000
    s_add_u32 m0, s51, 0x8000
    s_nop 0
    buffer_load_dwordx4 v15, s[12:15], s43 offen lds
    s_add_u32 s43, s41, 0x88000
    s_add_u32 m0, s51, 0x9000
    s_nop 0
    buffer_load_dwordx4 v15, s[12:15], s43 offen lds
    s_add_u32 s43, s41, 0x180000
    s_add_u32 m0, s51, 0xa000
    s_nop 0
    buffer_load_dwordx4 v15, s[12:15], s43 offen lds
    s_add_u32 s43, s41, 0x188000
    s_add_u32 m0, s51, 0xb000
    s_nop 0
    buffer_load_dwordx4 v15, s[12:15], s43 offen lds
    s_waitcnt vmcnt(12)
    s_barrier
    v_xor_b32 v13, 0x0, v12
    v_add_u32 v13, 0x10000, v13
    ds_read_b64_tr_b16 v[192:193], v13
    ds_read_b64_tr_b16 v[194:195], v13 offset:512
    ds_read_b64_tr_b16 v[196:197], v13 offset:2048
    ds_read_b64_tr_b16 v[198:199], v13 offset:2560
    v_xor_b32 v13, 0x2000, v12
    v_add_u32 v13, 0x10000, v13
    ds_read_b64_tr_b16 v[200:201], v13
    ds_read_b64_tr_b16 v[202:203], v13 offset:512
    ds_read_b64_tr_b16 v[204:205], v13 offset:2048
    ds_read_b64_tr_b16 v[206:207], v13 offset:2560
    v_xor_b32 v13, 0x40, v12
    v_add_u32 v13, 0x10000, v13
    ds_read_b64_tr_b16 v[224:225], v13
    ds_read_b64_tr_b16 v[226:227], v13 offset:512
    ds_read_b64_tr_b16 v[228:229], v13 offset:2048
    ds_read_b64_tr_b16 v[230:231], v13 offset:2560
    v_xor_b32 v13, 0x2040, v12
    v_add_u32 v13, 0x10000, v13
    ds_read_b64_tr_b16 v[232:233], v13
    ds_read_b64_tr_b16 v[234:235], v13 offset:512
    ds_read_b64_tr_b16 v[236:237], v13 offset:2048
    ds_read_b64_tr_b16 v[238:239], v13 offset:2560
    s_waitcnt lgkmcnt(0)
    s_barrier
    s_add_u32 s43, s41, 0x280000
    s_add_u32 m0, s51, 0xc000
    s_nop 0
    buffer_load_dwordx4 v15, s[12:15], s43 offen lds
    s_add_u32 s43, s41, 0x288000
    s_add_u32 m0, s51, 0xd000
    s_nop 0
    buffer_load_dwordx4 v15, s[12:15], s43 offen lds
    s_add_u32 s43, s41, 0x380000
    s_add_u32 m0, s51, 0xe000
    s_nop 0
    buffer_load_dwordx4 v15, s[12:15], s43 offen lds
    s_add_u32 s43, s41, 0x388000
    s_add_u32 m0, s51, 0xf000
    s_nop 0
    buffer_load_dwordx4 v15, s[12:15], s43 offen lds
    v_xor_b32 v15, 2, v14
    v_lshl_add_u32 v15, v15, 15, v8
    s_add_u32 s43, s41, 0x80000
    s_add_u32 m0, s51, 0x10000
    s_nop 0
    buffer_load_dwordx4 v15, s[12:15], s43 offen lds
    s_add_u32 s43, s41, 0x88000
    s_add_u32 m0, s51, 0x11000
    s_nop 0
    buffer_load_dwordx4 v15, s[12:15], s43 offen lds
    s_add_u32 s43, s41, 0x180000
    s_add_u32 m0, s51, 0x12000
    s_nop 0
    buffer_load_dwordx4 v15, s[12:15], s43 offen lds
    s_add_u32 s43, s41, 0x188000
    s_add_u32 m0, s51, 0x13000
    s_nop 0
    buffer_load_dwordx4 v15, s[12:15], s43 offen lds
    s_waitcnt vmcnt(12)
    s_barrier
    v_xor_b32 v13, 0x0, v12
    v_add_u32 v13, 0x18000, v13
    ds_read_b64_tr_b16 v[208:209], v13
    ds_read_b64_tr_b16 v[210:211], v13 offset:512
    ds_read_b64_tr_b16 v[212:213], v13 offset:2048
    ds_read_b64_tr_b16 v[214:215], v13 offset:2560
    v_xor_b32 v13, 0x2000, v12
    v_add_u32 v13, 0x18000, v13
    ds_read_b64_tr_b16 v[216:217], v13
    ds_read_b64_tr_b16 v[218:219], v13 offset:512
    ds_read_b64_tr_b16 v[220:221], v13 offset:2048
    ds_read_b64_tr_b16 v[222:223], v13 offset:2560
    v_xor_b32 v13, 0x40, v12
    v_add_u32 v13, 0x18000, v13
    ds_read_b64_tr_b16 v[240:241], v13
    ds_read_b64_tr_b16 v[242:243], v13 offset:512
    ds_read_b64_tr_b16 v[244:245], v13 offset:2048
    ds_read_b64_tr_b16 v[246:247], v13 offset:2560
    v_xor_b32 v13, 0x2040, v12
    v_add_u32 v13, 0x18000, v13
    ds_read_b64_tr_b16 v[248:249], v13
    ds_read_b64_tr_b16 v[250:251], v13 offset:512
    ds_read_b64_tr_b16 v[252:253], v13 offset:2048
    ds_read_b64_tr_b16 v[254:255], v13 offset:2560
    s_waitcnt lgkmcnt(0)
    s_barrier
    s_add_u32 s43, s41, 0x280000
    s_add_u32 m0, s51, 0x14000
    s_nop 0
    buffer_load_dwordx4 v15, s[12:15], s43 offen lds
    s_add_u32 s43, s41, 0x288000
    s_add_u32 m0, s51, 0x15000
    s_nop 0
    buffer_load_dwordx4 v15, s[12:15], s43 offen lds
    s_add_u32 s43, s41, 0x380000
    s_add_u32 m0, s51, 0x16000
    s_nop 0
    buffer_load_dwordx4 v15, s[12:15], s43 offen lds
    s_add_u32 s43, s41, 0x388000
    s_add_u32 m0, s51, 0x17000
    s_nop 0
    buffer_load_dwordx4 v15, s[12:15], s43 offen lds
    ds_write_b128 v124, v[192:195]
    ds_write_b128 v124, v[196:199] offset:1024
    ds_write_b128 v124, v[200:203] offset:2048
    ds_write_b128 v124, v[204:207] offset:3072
    ds_write_b128 v124, v[208:211] offset:4096
    ds_write_b128 v124, v[212:215] offset:5120
    ds_write_b128 v124, v[216:219] offset:6144
    ds_write_b128 v124, v[220:223] offset:7168
    ds_write_b128 v124, v[224:227] offset:32768
    ds_write_b128 v124, v[228:231] offset:33792
    ds_write_b128 v124, v[232:235] offset:34816
    ds_write_b128 v124, v[236:239] offset:35840
    ds_write_b128 v124, v[240:243] offset:36864
    ds_write_b128 v124, v[244:247] offset:37888
    ds_write_b128 v124, v[248:251] offset:38912
    ds_write_b128 v124, v[252:255] offset:39936
    s_waitcnt vmcnt(8)
    s_barrier
    v_xor_b32 v13, 0x0, v11
    v_add_u32 v13, 0x0, v13
    ds_read_b64_tr_b16 a[208:209], v13
    ds_read_b64_tr_b16 a[210:211], v13 offset:1024
    ds_read_b64_tr_b16 a[212:213], v13 offset:16384
    ds_read_b64_tr_b16 a[214:215], v13 offset:17408
    v_xor_b32 v13, 0x20, v11
    v_add_u32 v13, 0x0, v13
    ds_read_b64_tr_b16 a[216:217], v13
    ds_read_b64_tr_b16 a[218:219], v13 offset:1024
    ds_read_b64_tr_b16 a[220:221], v13 offset:16384
    ds_read_b64_tr_b16 a[222:223], v13 offset:17408
    v_xor_b32 v13, 0x1000, v11
    v_add_u32 v13, 0x0, v13
    ds_read_b64_tr_b16 a[240:241], v13
    ds_read_b64_tr_b16 a[242:243], v13 offset:1024
    ds_read_b64_tr_b16 a[244:245], v13 offset:16384
    ds_read_b64_tr_b16 a[246:247], v13 offset:17408
    v_xor_b32 v13, 0x1020, v11
    v_add_u32 v13, 0x0, v13
    ds_read_b64_tr_b16 a[248:249], v13
    ds_read_b64_tr_b16 a[250:251], v13 offset:1024
    ds_read_b64_tr_b16 a[252:253], v13 offset:16384
    ds_read_b64_tr_b16 a[254:255], v13 offset:17408
    s_waitcnt lgkmcnt(0)
    s_barrier
    s_mov_b32 s43, 0x10000
    buffer_load_dword v30, v7, s[8:11], s43 offen sc1
    s_cmp_lg_u32 s20, 2
    s_cbranch_scc1 L_nocc_5
    v_lshlrev_b32 v25, 2, v117
    s_lshl_b32 s43, s21, 12
    s_getpc_b64 s[4:5]
L_pc_6:
    s_add_u32 s4, s4, L_nocc_5-L_pc_6
    s_addc_u32 s5, s5, 0
    v_add_u32 v25, s43, v25
    v_min_u32 v25, L_code_end-L_nocc_5-4, v25
    global_load_dword v29, v25, s[4:5]
L_nocc_5:
L_chain_warm:
    s_mov_b32 s12, s66
    s_and_b32 s13, s67, 0xffff
    s_add_u32 s43, s42, 0x0
    s_add_u32 m0, s51, 0x8000
    s_nop 0
    buffer_load_dwordx4 v10, s[12:15], s43 offen lds
    s_add_u32 s43, s42, 0x4000
    s_add_u32 m0, s51, 0x9000
    s_nop 0
    buffer_load_dwordx4 v9, s[12:15], s43 offen lds
    s_add_u32 s43, s42, 0x8000
    s_add_u32 m0, s51, 0xa000
    s_nop 0
    buffer_load_dwordx4 v10, s[12:15], s43 offen lds
    s_add_u32 s43, s42, 0xc000
    s_add_u32 m0, s51, 0xb000
    s_nop 0
    buffer_load_dwordx4 v9, s[12:15], s43 offen lds
    s_add_u32 s43, s42, 0x10200
    s_add_u32 m0, s51, 0xc000
    s_nop 0
    buffer_load_dwordx4 v10, s[12:15], s43 offen lds
    s_add_u32 s43, s42, 0x14200
    s_add_u32 m0, s51, 0xd000
    s_nop 0
    buffer_load_dwordx4 v9, s[12:15], s43 offen lds
    s_add_u32 s43, s42, 0x18200
    s_add_u32 m0, s51, 0xe000
    s_nop 0
    buffer_load_dwordx4 v10, s[12:15], s43 offen lds
    s_add_u32 s43, s42, 0x1c200
    s_add_u32 m0, s51, 0xf000
    s_nop 0
    buffer_load_dwordx4 v9, s[12:15], s43 offen lds
    s_waitcnt vmcnt(9)
    s_barrier
    v_xor_b32 v13, 0x0, v11
    v_add_u32 v13, 0x8000, v13
    ds_read_b64_tr_b16 v[144:145], v13
    ds_read_b64_tr_b16 v[146:147], v13 offset:1024
    ds_read_b64_tr_b16 v[148:149], v13 offset:16384
    ds_read_b64_tr_b16 v[150:151], v13 offset:17408
    v_xor_b32 v13, 0x20, v11
    v_add_u32 v13, 0x8000, v13
    ds_read_b64_tr_b16 v[152:153], v13
    ds_read_b64_tr_b16 v[154:155], v13 offset:1024
    ds_read_b64_tr_b16 v[156:157], v13 offset:16384
    ds_read_b64_tr_b16 v[158:159], v13 offset:17408
    v_xor_b32 v13, 0x1000, v11
    v_add_u32 v13, 0x8000, v13
    ds_read_b64_tr_b16 v[176:177], v13
    ds_read_b64_tr_b16 v[178:179], v13 offset:1024
    ds_read_b64_tr_b16 v[180:181], v13 offset:16384
    ds_read_b64_tr_b16 v[182:183], v13 offset:17408
    v_xor_b32 v13, 0x1020, v11
    v_add_u32 v13, 0x8000, v13
    ds_read_b64_tr_b16 v[184:185], v13
    ds_read_b64_tr_b16 v[186:187], v13 offset:1024
    ds_read_b64_tr_b16 v[188:189], v13 offset:16384
    ds_read_b64_tr_b16 v[190:191], v13 offset:17408
    s_waitcnt lgkmcnt(0)
    s_barrier
    s_add_u32 s43, s42, 0x10000
    s_add_u32 m0, s51, 0x10000
    s_nop 0
    buffer_load_dwordx4 v10, s[12:15], s43 offen lds
    s_add_u32 s43, s42, 0x14000
    s_add_u32 m0, s51, 0x11000
    s_nop 0
    buffer_load_dwordx4 v9, s[12:15], s43 offen lds
    s_add_u32 s43, s42, 0x18000
    s_add_u32 m0, s51, 0x12000
    s_nop 0
    buffer_load_dwordx4 v10, s[12:15], s43 offen lds
    s_add_u32 s43, s42, 0x1c000
    s_add_u32 m0, s51, 0x13000
    s_nop 0
    buffer_load_dwordx4 v9, s[12:15], s43 offen lds
    s_add_u32 s43, s42, 0x200
    s_add_u32 m0, s51, 0x14000
    s_nop 0
    buffer_load_dwordx4 v10, s[12:15], s43 offen lds
    s_add_u32 s43, s42, 0x4200
    s_add_u32 m0, s51, 0x15000
    s_nop 0
    buffer_load_dwordx4 v9, s[12:15], s43 offen lds
    s_add_u32 s43, s42, 0x8200
    s_add_u32 m0, s51, 0x16000
    s_nop 0
    buffer_load_dwordx4 v10, s[12:15], s43 offen lds
    s_add_u32 s43, s42, 0xc200
    s_add_u32 m0, s51, 0x17000
    s_nop 0
    buffer_load_dwordx4 v9, s[12:15], s43 offen lds
    v_lshlrev_b32 v26, 3, v117
    v_and_b32 v26, 2048, v26
    s_lshl_b32 s43, s20, 6
    s_add_u32 s43, s43, 0x2000
    buffer_load_dword v26, v26, s[8:11], s43 offen sc1
    buffer_load_dword v27, off, s[16:19], 0 offset:4 sc1
    s_waitcnt vmcnt(10)
    v_min_u32 v21, 0xfffffffe, v21
    s_mov_b32 s43, 0x10000
    s_mov_b64 exec, s[38:39]
    buffer_store_dword v21, v119, s[8:11], s43 offen
    s_mov_b64 exec, -1
    v_mov_b32 v16, -1
    v_mov_b32 v17, -1
    v_mov_b32 v18, -1
    v_mov_b32 v19, -1
    s_lshl_b32 s43, s20, 13
    s_add_u32 s43, s43, 0x100000
    s_and_b32 s40, s21, 1
    s_lshl_b32 s40, s40, 12
    s_add_u32 s29, s43, s40
    s_add_u32 s43, s43, s52
    s_xor_b32 s40, s43, 0x40000
    buffer_store_dwordx4 v[16:19], v117, s[8:11], s40 offen
    buffer_store_dwordx4 v[16:19], v117, s[8:11], s40 offen offset:1024
    s_mov_b32 s43, 0x12000
    buffer_store_dword v16, v119, s[8:11], s43 offen
    s_mov_b32 s43, 0x14000
    buffer_store_dword v16, v119, s[8:11], s43 offen
    s_mov_b32 s43, 0x16000
    buffer_store_dword v16, v119, s[8:11], s43 offen
    s_barrier
    v_xor_b32 v13, 0x0, v12
    v_add_u32 v13, 0x0, v13
    ds_read_b64_tr_b16 v[192:193], v13
    ds_read_b64_tr_b16 v[194:195], v13 offset:512
    ds_read_b64_tr_b16 v[196:197], v13 offset:2048
    ds_read_b64_tr_b16 v[198:199], v13 offset:2560
    v_xor_b32 v13, 0x2000, v12
    v_add_u32 v13, 0x0, v13
    ds_read_b64_tr_b16 v[200:201], v13
    ds_read_b64_tr_b16 v[202:203], v13 offset:512
    ds_read_b64_tr_b16 v[204:205], v13 offset:2048
    ds_read_b64_tr_b16 v[206:207], v13 offset:2560
    v_xor_b32 v13, 0x40, v12
    v_add_u32 v13, 0x0, v13
    ds_read_b64_tr_b16 v[224:225], v13
    ds_read_b64_tr_b16 v[226:227], v13 offset:512
    ds_read_b64_tr_b16 v[228:229], v13 offset:2048
    ds_read_b64_tr_b16 v[230:231], v13 offset:2560
    v_xor_b32 v13, 0x2040, v12
    v_add_u32 v13, 0x0, v13
    ds_read_b64_tr_b16 v[232:233], v13
    ds_read_b64_tr_b16 v[234:235], v13 offset:512
    ds_read_b64_tr_b16 v[236:237], v13 offset:2048
    ds_read_b64_tr_b16 v[238:239], v13 offset:2560
    s_lshr_b32 s43, s20, 1
    s_lshl_b32 s43, s43, 7
    s_and_b32 s40, s20, 1
    s_lshl_b32 s40, s40, 4
    s_add_u32 s43, s43, s40
    s_add_u32 s44, s43, 0x1000
    s_cmp_eq_u32 s21, 0
    s_cselect_b32 s44, s44, 0x7ff00000
    s_mov_b32 s22, 0
    s_mov_b32 s33, 0
    s_xor_b32 s53, s29, 1024
    s_add_u32 s23, s51, 0x10000
    s_add_u32 s48, s23, 4096
    s_mov_b32 s24, 0x12000
    s_add_u32 s55, s24, 16384
    s_mov_b32 s25, 0x100000
    s_mov_b32 s26, 0x101000
    v_mov_b32 v112, 0
    v_mov_b32 v113, 0
    v_mov_b32 v114, 0
    v_mov_b32 v115, 0
    ds_write_b128 v117, v[112:115] offset:22528
    ds_write_b128 v117, v[112:115] offset:23552
    s_cmp_lg_u32 s21, 0
    s_cselect_b32 s40, -1, 0
    v_mov_b32 v126, s40
    v_bfe_u32 v1, v117, 4, 1
    v_lshlrev_b32 v1, 4, v1
    s_movk_i32 s43, 0x3f80
    v_lshlrev_b32 v125, v1, s43
    v_bfe_u32 v1, v117, 5, 3
    v_cmp_eq_u32 s[68:69], 0, v1
    v_cmp_eq_u32 s[70:71], 1, v1
    v_cmp_eq_u32 s[72:73], 2, v1
    v_cmp_eq_u32 s[74:75], 3, v1
    v_lshrrev_b32 v1, 2, v117
    s_cmp_lt_u32 s21, 2
    s_cselect_b64 vcc, -1, 0
    v_cndmask_b32 v119, v119, v1, vcc
    v_mov_b32 v40, 0
    v_mov_b32 v41, 0
    v_mov_b32 v42, 0
    v_mov_b32 v43, 0
    v_mov_b32 v44, 0
    v_mov_b32 v45, 0
    v_mov_b32 v46, 0
    v_mov_b32 v47, 0
    v_mov_b32 v48, 0
    v_mov_b32 v49, 0
    v_mov_b32 v50, 0
    v_mov_b32 v51, 0
    v_mov_b32 v52, 0
    v_mov_b32 v53, 0
    v_mov_b32 v54, 0
    v_mov_b32 v55, 0
    s_mov_b32 s45, 0
    s_mov_b32 s46, 0
    s_mov_b32 s47, 0
    s_mov_b32 s76, 0
    s_and_b32 s43, s21, 1
    s_lshl_b32 s43, s43, 5
    s_add_u32 s43, s43, s20
    s_lshl_b32 s43, s43, 6
    s_add_u32 s28, s43, 0x2000
    s_mov_b32 s59, 0
    s_waitcnt vmcnt(6) lgkmcnt(0)
    v_readlane_b32 s43, v26, 0
    v_readlane_b32 s40, v26, 16
    s_nop 0
    s_min_u32 s43, s43, s40
    s_cmp_lg_u32 s43, 0
    s_cselect_b32 s57, s57, 0
    v_readfirstlane_b32 s43, v27
    s_nop 0
    s_cmp_ge_u32 s43, 32
    s_cselect_b32 s57, s57, 0
    s_cmp_lg_u32 s57, 1
    s_cbranch_scc1 L_nokv_7
    s_add_u32 m0, s52, 8192
    s_nop 0
    buffer_load_dwordx4 v117, s[8:11], s30 offen lds
    buffer_load_dwordx4 v117, s[8:11], s30 offen offset:1024 lds
    s_add_u32 m0, s52, 0x6000
    s_nop 0
    buffer_load_dwordx4 v117, s[8:11], s31 offen lds
    buffer_load_dwordx4 v117, s[8:11], s31 offen offset:1024 lds
L_nokv_7:
    s_barrier
    v_xor_b32 v13, 0x0, v12
    v_add_u32 v13, 0x8000, v13
    ds_read_b64_tr_b16 v[208:209], v13
    ds_read_b64_tr_b16 v[210:211], v13 offset:512
    ds_read_b64_tr_b16 v[212:213], v13 offset:2048
    ds_read_b64_tr_b16 v[214:215], v13 offset:2560
    v_xor_b32 v13, 0x2000, v12
    v_add_u32 v13, 0x8000, v13
    ds_read_b64_tr_b16 v[216:217], v13
    ds_read_b64_tr_b16 v[218:219], v13 offset:512
    ds_read_b64_tr_b16 v[220:221], v13 offset:2048
    ds_read_b64_tr_b16 v[222:223], v13 offset:2560
    v_xor_b32 v13, 0x40, v12
    v_add_u32 v13, 0x8000, v13
    ds_read_b64_tr_b16 v[240:241], v13
    ds_read_b64_tr_b16 v[242:243], v13 offset:512
    ds_read_b64_tr_b16 v[244:245], v13 offset:2048
    ds_read_b64_tr_b16 v[246:247], v13 offset:2560
    v_xor_b32 v13, 0x2040, v12
    v_add_u32 v13, 0x8000, v13
    ds_read_b64_tr_b16 v[248:249], v13
    ds_read_b64_tr_b16 v[250:251], v13 offset:512
    ds_read_b64_tr_b16 v[252:253], v13 offset:2048
    ds_read_b64_tr_b16 v[254:255], v13 offset:2560
    ds_write_b128 v123, v[80:83]
    ds_write_b128 v123, v[84:87] offset:1024
    ds_write_b128 v123, v[56:59] offset:2048
    ds_write_b128 v123, v[60:63] offset:3072
    ds_write_b128 v123, v[88:91] offset:4096
    ds_write_b128 v123, v[92:95] offset:5120
    ds_write_b128 v123, v[96:99] offset:6144
    ds_write_b128 v123, v[100:103] offset:7168
    s_cmp_eq_u32 s57, 1
    s_cbranch_scc1 L_started_8
    s_mov_b32 s96, 0
L_mode_9:
    buffer_load_dwordx2 v[2:3], off, s[92:95], 0 offset:36 sc1
    s_waitcnt vmcnt(0)
    v_readfirstlane_b32 s87, v2
    v_readfirstlane_b32 s97, v3
    s_nop 0
    s_min_u32 s97, s97, s87
    s_cmp_lg_u32 s97, 0
    s_cbranch_scc1 L_moded_10
    s_sleep 4
    s_add_u32 s96, s96, 1
    s_cmp_lg_u32 s96, 0x100
    s_cbranch_scc1 L_modef_11
    v_mov_b32 v2, 2
    v_mov_b32 v3, 0
    s_mov_b64 exec, 1
    buffer_atomic_cmpswap v[2:3], off, s[92:95], 0 offset:36
    s_mov_b64 exec, -1
L_modef_11:
    s_cmp_lt_u32 s96, 0x10000
    s_cbranch_scc1 L_mode_9
L_moded_10:
    s_cmp_lg_u32 s87, 1
    s_cbranch_scc1 L_fallback
    v_lshrrev_b32 v1, 4, v117
    v_and_b32 v2, 15, v1
    v_lshrrev_b32 v1, 4, v1
    v_lshlrev_b32 v1, 11, v1
    v_lshl_add_u32 v1, v2, 2, v1
    s_lshl_b32 s43, s20, 6
    s_add_u32 s43, s43, 0x2000
    s_mov_b32 exec_lo, 0x10001
    s_mov_b32 exec_hi, 0
    s_mov_b32 s96, 0
L_poll_12:
    buffer_load_dword v2, v1, s[8:11], s43 offen sc1
    s_waitcnt vmcnt(0)
    v_cmp_gt_u32 vcc, 1, v2
    s_cbranch_vccz L_polld_13
    s_sleep 8
    s_add_u32 s96, s96, 1
    s_cmp_lt_u32 s96, 0x10000
    s_cbranch_scc1 L_poll_12
L_polld_13:
    s_mov_b64 exec, -1
    s_add_u32 m0, s52, 8192
    s_nop 0
    buffer_load_dwordx4 v117, s[8:11], s30 offen lds
    buffer_load_dwordx4 v117, s[8:11], s30 offen offset:1024 lds
    s_add_u32 m0, s52, 0x6000
    s_nop 0
    buffer_load_dwordx4 v117, s[8:11], s31 offen lds
    buffer_load_dwordx4 v117, s[8:11], s31 offen offset:1024 lds
    s_mov_b32 s49, 0
L_cb_poll_15:
    buffer_load_dword v3, off, s[16:19], 0 offset:4 sc1
    s_waitcnt vmcnt(0)
    v_readfirstlane_b32 s43, v3
    s_nop 0
    s_cmp_ge_u32 s43, 32
    s_cbranch_scc1 L_started_8
    s_sleep 8
    s_add_u32 s49, s49, 1
    s_cmp_lt_u32 s49, 0x40000
    s_cbranch_scc1 L_cb_poll_15
L_started_8:
    s_add_u32 m0, s51, 4096
    v_mov_b32 v24, v32
    v_mov_b32 v25, v33
    v_mov_b32 v26, v34
    v_mov_b32 v27, v35
    v_mov_b32 v28, v36
    v_mov_b32 v29, v37
    v_mov_b32 v30, v38
    v_mov_b32 v31, v39
    s_add_u32 s30, s30, 0x40000
    s_add_u32 s31, s31, 0x40000
    s_mov_b32 s49, 0
    s_waitcnt vmcnt(0) lgkmcnt(0)
    s_barrier
    ds_write_b128 v123, v[64:67] offset:32768
    ds_write_b128 v123, v[68:71] offset:33792
    ds_write_b128 v123, v[72:75] offset:34816
    ds_write_b128 v123, v[76:79] offset:35840
    ds_write_b128 v123, v[104:107] offset:36864
    ds_write_b128 v123, v[108:111] offset:37888
    ds_write_b128 v123, v[32:35] offset:38912
    ds_write_b128 v123, v[36:39] offset:39936
    v_mov_b32 v32, 0
    v_mov_b32 v33, 0
    v_mov_b32 v34, 0
    v_mov_b32 v35, 0
    v_mov_b32 v36, 0
    v_mov_b32 v37, 0
    v_mov_b32 v38, 0
    v_mov_b32 v39, 0
    s_nop 4
    s_cmp_eq_u32 s21, 1
    s_cbranch_scc1 L_chain_top1_f
    s_cmp_eq_u32 s21, 2
    s_cbranch_scc1 L_chain_top2_f
    s_cmp_eq_u32 s21, 3
    s_cbranch_scc1 L_chain_top3_f
.p2align 6
L_chain_top0_f:
    buffer_load_dwordx4 v[0:3], v117, s[8:11], s23 offen nt
    v_mov_b32 v15, 0
    v_mov_b32 v15, 0
    v_mov_b32 v15, 0
    v_mov_b32 v15, 0
    v_mov_b32 v15, 0
    v_mov_b32 v15, 0
    v_mov_b32 v15, 0
    v_mov_b32 v15, 0
    v_mov_b32 v15, 0
    v_mov_b32 v15, 0
    v_mov_b32 v15, 0
    v_mov_b32 v15, 0
    v_mov_b32 v15, 0
    v_mov_b32 v15, 0
    v_mov_b32 v15, 0
    v_mov_b32 v15, 0
    buffer_load_dwordx4 v[0:3], v117, s[8:11], s23 offen sc1
    v_mov_b32 v15, 0
    v_mov_b32 v15, 0
    v_mov_b32 v15, 0
    v_mov_b32 v15, 0
    v_mov_b32 v15, 0
    v_mov_b32 v15, 0
    v_mov_b32 v15, 0
    v_mov_b32 v15, 0
    v_mov_b32 v15, 0
    v_mov_b32 v15, 0
    v_mov_b32 v15, 0
    v_mov_b32 v15, 0
    v_mov_b32 v15, 0
    v_mov_b32 v15, 0
    v_mov_b32 v15, 0
    v_mov_b32 v15, 0
L_mret_17:
    buffer_load_dwordx4 v[0:3], v117, s[8:11], s23 offen sc1
    s_add_u32 s45, s45, 1
    s_cmp_lt_u32 s45, 0x10000
    s_cselect_b32 s56, -2, -1
    s_nop 3
    v_mov_b32 v32, 0
    v_mov_b32 v33, 0
    v_mov_b32 v34, 0
    v_mov_b32 v35, 0
    s_waitcnt vmcnt(2)
    v_max3_u32 v15, v0, v1, v2
    v_max_u32 v15, v15, v3
    v_cmp_lt_u32 vcc, s56, v15
    v_smfmac_f32_16x16x64_bf16 v[32:35], v[0:3], v[80:87], v116
    s_cbranch_vccnz L_mret_17
    ds_write_b128 v117, v[0:3]
    v_smfmac_f32_16x16x64_bf16 v[36:39], v[0:3], v[56:63], v116
    buffer_load_dwordx4 v[4:7], v117, s[8:11], s48 offen nt
    v_smfmac_f32_16x16x64_bf16 v[40:43], v[0:3], v[64:71], v116
    buffer_load_dwordx4 v117, s[8:11], s48 offen nt lds
    s_mov_b32 m0, 8192
    v_smfmac_f32_16x16x64_bf16 v[44:47], v[0:3], v[72:79], v116
    s_waitcnt lgkmcnt(0)
    s_barrier
    ds_read_b128 v[8:11], v117 offset:1024
    v_smfmac_f32_16x16x64_bf16 v[48:51], v[0:3], a[192:199], v116
    ds_read_b128 v[16:19], v117 offset:2048
    ds_read_b128 v[20:23], v117 offset:3072
    v_smfmac_f32_16x16x64_bf16 v[52:55], v[0:3], a[200:207], v116
    ds_read_b128 v[80:83], v117 offset:14336
    s_waitcnt lgkmcnt(3)
    v_smfmac_f32_16x16x64_bf16 v[32:35], v[8:11], a[0:7], v116
    ds_read_b128 v[84:87], v117 offset:15360
    v_smfmac_f32_16x16x64_bf16 v[36:39], v[8:11], a[8:15], v116
    buffer_store_dwordx4 v[112:115], v117, s[8:11], s32 offen sc1
    s_waitcnt lgkmcnt(3)
    v_smfmac_f32_16x16x64_bf16 v[32:35], v[16:19], a[32:39], v116
    ds_read_b128 v[56:59], v117 offset:8192
    v_smfmac_f32_16x16x64_bf16 v[36:39], v[16:19], a[40:47], v116
    ds_read_b128 v[60:63], v117 offset:9216
    s_waitcnt lgkmcnt(4)
    v_smfmac_f32_16x16x64_bf16 v[32:35], v[20:23], a[64:71], v116
    ds_read_b128 v[64:67], v117 offset:10240
    v_smfmac_f32_16x16x64_bf16 v[36:39], v[20:23], a[72:79], v116
    ds_read_b128 v[68:71], v117 offset:11264
    v_smfmac_f32_16x16x64_bf16 v[40:43], v[8:11], a[96:103], v116
    ds_read_b128 v[72:75], v117 offset:12288
    v_smfmac_f32_16x16x64_bf16 v[40:43], v[16:19], a[128:135], v116
    ds_read_b128 v[76:79], v117 offset:13312
    v_smfmac_f32_16x16x64_bf16 v[40:43], v[20:23], a[160:167], v116
    s_waitcnt vmcnt(2)
    v_max3_u32 v15, v4, v5, v6
    v_smfmac_f32_16x16x64_bf16 v[44:47], v[8:11], a[104:111], v116
    v_max_u32 v15, v15, v7
    v_smfmac_f32_16x16x64_bf16 v[44:47], v[16:19], a[136:143], v116
    s_waitcnt vmcnt(1) lgkmcnt(0)
    v_cmp_lt_u32 vcc, s56, v15
    v_smfmac_f32_16x16x64_bf16 v[44:47], v[20:23], a[168:175], v116
    s_cbranch_vccnz L_mret_18
L_mgo_19:
    v_smfmac_f32_16x16x64_bf16 v[44:47], v[4:7], v[24:31], v116
    s_barrier
    ds_read_b128 v[12:15], v117 offset:5120
    v_smfmac_f32_16x16x64_bf16 v[32:35], v[4:7], v[88:95], v116
    ds_read_b128 v[24:27], v117 offset:6144
    v_smfmac_f32_16x16x64_bf16 v[36:39], v[4:7], v[96:103], v116
    ds_read_b128 v[28:31], v117 offset:7168
    v_smfmac_f32_16x16x64_bf16 v[40:43], v[4:7], v[104:111], v116
    ds_read_b128 v[88:91], v117 offset:24576
    s_waitcnt lgkmcnt(3)
    v_smfmac_f32_16x16x64_bf16 v[32:35], v[12:15], a[16:23], v116
    ds_read_b128 v[92:95], v117 offset:25600
    s_waitcnt lgkmcnt(3)
    v_smfmac_f32_16x16x64_bf16 v[32:35], v[24:27], a[48:55], v116
    buffer_load_dwordx4 v117, s[8:11], s30 offen lds
    s_waitcnt lgkmcnt(2)
    v_smfmac_f32_16x16x64_bf16 v[32:35], v[28:31], a[80:87], v116
    ds_read_b128 v[96:99], v117 offset:23552
    v_smfmac_f32_16x16x64_bf16 v[36:39], v[12:15], a[24:31], v116
    ds_read_b128 v[100:103], v117 offset:23552
    v_smfmac_f32_16x16x64_bf16 v[36:39], v[24:27], a[56:63], v116
    buffer_load_dwordx4 v117, s[8:11], s30 offen offset:1024 lds
    s_add_u32 m0, s52, 0x6000
    v_add_f32 v32, v32, v34
    v_smfmac_f32_16x16x64_bf16 v[36:39], v[28:31], a[88:95], v116
    ds_read_b128 v[104:107], v117 offset:23552
    v_add_f32 v33, v33, v35
    v_smfmac_f32_16x16x64_bf16 v[40:43], v[12:15], a[112:119], v116
    ds_read_b128 v[108:111], v117 offset:23552
    v_mul_f32 v32, s34, v32
    v_smfmac_f32_16x16x64_bf16 v[40:43], v[24:27], a[144:151], v116
    buffer_load_dword v125, v119, s[8:11], s28 offen sc1
    v_mul_f32 v33, s34, v33
    v_smfmac_f32_16x16x64_bf16 v[40:43], v[28:31], a[176:183], v116
    ds_read_b128 v[0:3], v124
    v_add_f32 v36, v36, v38
    v_smfmac_f32_16x16x64_bf16 v[48:51], v[4:7], a[208:215], v116
    v_add_f32 v37, v37, v39
    v_smfmac_f32_16x16x64_bf16 v[52:55], v[4:7], a[216:223], v116
    s_waitcnt lgkmcnt(5)
    buffer_load_dwordx4 v117, s[8:11], s31 offen lds
    v_mul_f32 v36, s34, v36
    v_smfmac_f32_16x16x64_bf16 v[44:47], v[12:15], a[120:127], v116
    ds_read_b128 v[4:7], v124 offset:1024
    v_mul_f32 v37, s34, v37
    v_smfmac_f32_16x16x64_bf16 v[44:47], v[24:27], a[152:159], v116
    v_cvt_pk_bf16_f32 v34, v32, v36
    v_smfmac_f32_16x16x64_bf16 v[44:47], v[28:31], a[184:191], v116
    buffer_load_dwordx4 v117, s[8:11], s31 offen offset:1024 lds
    s_mov_b32 m0, 4096
    v_cvt_pk_bf16_f32 v35, v33, v37
    v_add_f32 v40, v40, v42
    v_smfmac_f32_16x16x64_bf16 v[48:51], v[8:11], a[224:231], v116
    ds_write2_b32 v120, v34, v35 offset0:32 offset1:48
    v_add_f32 v41, v41, v43
    v_smfmac_f32_16x16x64_bf16 v[52:55], v[8:11], a[232:239], v116
    v_add_f32 v44, v44, v46
    v_add_f32 v45, v45, v47
    v_cvt_pk_bf16_f32 v113, v40, v44
    v_cvt_pk_bf16_f32 v115, v41, v45
    v_smfmac_f32_16x16x64_bf16 v[48:51], v[12:15], a[240:247], v116
    ds_write2_b32 v120, v113, v115 offset0:0 offset1:16
    v_smfmac_f32_16x16x64_bf16 v[52:55], v[12:15], a[248:255], v116
    s_cmp_eq_u32 s22, 63
    s_cbranch_scc1 L_chain_last_f
    buffer_store_dword v126, off, s[8:11], s44 sc1
    v_smfmac_f32_16x16x64_bf16 v[48:51], v[16:19], v[128:135], v116
    v_smfmac_f32_16x16x64_bf16 v[48:51], v[20:23], v[160:167], v116
    v_smfmac_f32_16x16x64_bf16 v[48:51], v[24:27], v[144:151], v116
    s_waitcnt lgkmcnt(0)
    s_barrier
    v_smfmac_f32_16x16x64_bf16 v[48:51], v[28:31], v[176:183], v116
    ds_read_b128 v[32:35], v121 offset:16384
    ds_read_b128 v[36:39], v121 offset:17408
    v_smfmac_f32_16x16x64_bf16 v[52:55], v[16:19], v[136:143], v116
    ds_read_b128 v[40:43], v121 offset:18432
    ds_read_b128 v[44:47], v121 offset:19456
    v_smfmac_f32_16x16x64_bf16 v[52:55], v[20:23], v[168:175], v116
    ds_read_b128 v[8:11], v124 offset:32768
    v_add_f32 v48, v48, v50
    v_smfmac_f32_16x16x64_bf16 v[52:55], v[24:27], v[152:159], v116
    ds_read_b128 v[12:15], v124 offset:33792
    v_add_f32 v49, v49, v51
    v_smfmac_f32_16x16x64_bf16 v[52:55], v[28:31], v[184:191], v116
    s_waitcnt lgkmcnt(5)
    v_cvt_pk_bf16_f32 v112, v48, v49
    v_mfma_f32_16x16x32_bf16 v[56:59], v[56:59], v[32:35], 0
    s_waitcnt lgkmcnt(4)
    v_mov_b32 v48, s50
    v_mov_b32 v49, s50
    v_mfma_f32_16x16x32_bf16 v[56:59], v[60:63], v[36:39], v[56:59]
    ds_read_b128 v[16:19], v124 offset:2048
    s_waitcnt lgkmcnt(4)
    v_mov_b32 v50, s50
    v_mov_b32 v51, s50
    v_mfma_f32_16x16x32_bf16 v[56:59], v[64:67], v[40:43], v[56:59]
    ds_read_b128 v[20:23], v124 offset:3072
    s_waitcnt lgkmcnt(4)
    v_add_f32 v52, v52, v54
    v_mfma_f32_16x16x32_bf16 v[56:59], v[68:71], v[44:47], v[56:59]
    ds_read_b128 v[24:27], v124 offset:4096
    v_add_f32 v53, v53, v55
    v_mfma_f32_16x16x32_bf16 v[60:63], v[72:75], v[32:35], 0
    ds_read_b128 v[28:31], v124 offset:5120
    v_cvt_pk_bf16_f32 v114, v52, v53
    v_mov_b32 v53, 0
    v_mfma_f32_16x16x32_bf16 v[60:63], v[76:79], v[36:39], v[60:63]
    v_exp_f32 v56, v56
    v_mfma_f32_16x16x32_bf16 v[60:63], v[80:83], v[40:43], v[60:63]
    v_exp_f32 v57, v57
    v_mfma_f32_16x16x32_bf16 v[60:63], v[84:87], v[44:47], v[60:63]
    v_exp_f32 v58, v58
    v_mfma_f32_16x16x32_bf16 v[64:67], v[32:35], v[32:35], 0
    v_exp_f32 v59, v59
    v_cvt_pk_bf16_f32 v68, v56, v57
    v_mfma_f32_16x16x32_bf16 v[64:67], v[36:39], v[36:39], v[64:67]
    v_exp_f32 v60, v60
    v_cvt_pk_bf16_f32 v69, v58, v59
    v_mfma_f32_16x16x32_bf16 v[64:67], v[40:43], v[40:43], v[64:67]
    v_exp_f32 v61, v61
    v_mfma_f32_16x16x32_bf16 v[64:67], v[44:47], v[44:47], v[64:67]
    v_exp_f32 v62, v62
    v_exp_f32 v63, v63
    v_cvt_pk_bf16_f32 v70, v60, v61
    v_cvt_pk_bf16_f32 v71, v62, v63
    s_nop 1
    v_mfma_f32_16x16x32_bf16 v[72:75], v[88:91], v[68:71], 0
    s_nop 0
    v_exp_f32 v64, v64
    v_mfma_f32_16x16x32_bf16 v[76:79], v[92:95], v[68:71], 0
    v_exp_f32 v65, v65
    v_mfma_f32_16x16x32_bf16 v[80:83], v[48:51], v[68:71], 0
    v_cvt_pk_bf16_f32 v52, v64, v65
    s_nop 1
    v_mfma_f32_16x16x16_bf16 v[72:75], v[112:113], v[52:53], v[72:75]
    ds_read_b128 v[32:35], v124 offset:6144
    v_mfma_f32_16x16x16_bf16 v[76:79], v[114:115], v[52:53], v[76:79]
    ds_read_b128 v[36:39], v124 offset:7168
    v_mfma_f32_16x16x16_bf16 v[80:83], v[48:49], v[52:53], v[80:83]
L_norm_20:
    s_mov_b64 vcc, s[36:37]
    v_mov_b32 v122, v122
    v_mov_b32 v122, v122
    v_mov_b32 v122, v122
    v_cndmask_b32_dpp v76, v72, v76, vcc quad_perm:[2,3,2,3] row_mask:0xf bank_mask:0xf
    v_cndmask_b32_dpp v77, v73, v77, vcc quad_perm:[2,3,2,3] row_mask:0xf bank_mask:0xf
    v_cndmask_b32_dpp v78, v74, v78, vcc quad_perm:[2,3,2,3] row_mask:0xf bank_mask:0xf
    v_cndmask_b32_dpp v79, v75, v79, vcc quad_perm:[2,3,2,3] row_mask:0xf bank_mask:0xf
    v_rcp_f32_dpp v84, v80 quad_perm:[2,3,2,3] row_mask:0xf bank_mask:0xf
    s_nop 0
    v_pk_mul_f32 v[76:77], v[76:77], v[84:85] op_sel_hi:[1,0]
    v_pk_mul_f32 v[78:79], v[78:79], v[84:85] op_sel_hi:[1,0]
    v_cvt_pk_bf16_f32 v72, v76, v77
    v_cvt_pk_bf16_f32 v73, v78, v79
    ds_write_b64 v122, v[72:73] offset:20480
    v_max_f32_dpp v86, v80, v84 quad_perm:[2,3,2,3] row_mask:0xf bank_mask:0xf
    v_mov_b32_dpp v60, v72 quad_perm:[0,1,0,1] row_mask:0xf bank_mask:0xf
    v_mov_b32_dpp v61, v73 quad_perm:[0,1,0,1] row_mask:0xf bank_mask:0xf
    v_cmp_lt_f32 vcc, s35, v86
    v_mov_b32_dpp v62, v72 quad_perm:[2,3,2,3] row_mask:0xf bank_mask:0xf
    v_mov_b32_dpp v63, v73 quad_perm:[2,3,2,3] row_mask:0xf bank_mask:0xf
    s_nop 1
    v_smfmac_f32_16x16x64_bf16 v[96:99], v[60:63], v[192:199], v116
    s_cbranch_vccnz L_smax_21
    v_smfmac_f32_16x16x64_bf16 v[100:103], v[60:63], v[224:231], v116
    s_waitcnt lgkmcnt(0)
    s_barrier
    ds_read_b128 v[92:95], v127 offset:20992
    ds_read_b128 v[80:83], v127 offset:21504
    ds_read_b128 v[84:87], v127 offset:22016
    v_smfmac_f32_16x16x64_bf16 v[104:107], v[60:63], v[0:7], v116
    ds_read_b128 v[40:43], v124 offset:34816
    v_smfmac_f32_16x16x64_bf16 v[108:111], v[60:63], v[8:15], v116
    ds_read_b128 v[56:59], v124 offset:36864
    s_waitcnt lgkmcnt(4)
    v_smfmac_f32_16x16x64_bf16 v[96:99], v[92:95], v[200:207], v116
    s_waitcnt lgkmcnt(3)
    v_smfmac_f32_16x16x64_bf16 v[96:99], v[80:83], v[208:215], v116
    ds_read_b128 v[44:47], v124 offset:35840
    s_waitcnt lgkmcnt(3)
    v_smfmac_f32_16x16x64_bf16 v[96:99], v[84:87], v[216:223], v116
    ds_read_b128 v[68:71], v124 offset:39936
    v_smfmac_f32_16x16x64_bf16 v[100:103], v[92:95], v[232:239], v116
    ds_read_b128 v[64:67], v124 offset:38912
    v_smfmac_f32_16x16x64_bf16 v[100:103], v[80:83], v[240:247], v116
    ds_read_b128 v[60:63], v124 offset:37888
    v_cvt_pk_bf16_f32 v72, v96, v98
    v_smfmac_f32_16x16x64_bf16 v[100:103], v[84:87], v[248:255], v116
    v_and_or_b32 v72, v72, -2, s33
    v_smfmac_f32_16x16x64_bf16 v[104:107], v[92:95], v[16:23], v116
    v_cvt_pk_bf16_f32 v74, v97, v99
    v_smfmac_f32_16x16x64_bf16 v[104:107], v[80:83], v[24:31], v116
    v_cvt_pk_bf16_f32 v73, v100, v102
    v_cvt_pk_bf16_f32 v75, v101, v103
    v_smfmac_f32_16x16x64_bf16 v[104:107], v[84:87], v[32:39], v116
    buffer_store_dwordx4 v[72:75], v118, s[8:11], s25 offen
    s_waitcnt lgkmcnt(3)
    v_smfmac_f32_16x16x64_bf16 v[108:111], v[92:95], v[40:47], v116
    s_waitcnt lgkmcnt(0)
    v_smfmac_f32_16x16x64_bf16 v[108:111], v[80:83], v[56:63], v116
    v_cvt_pk_bf16_f32 v76, v104, v106
    v_smfmac_f32_16x16x64_bf16 v[108:111], v[84:87], v[64:71], v116
    v_and_or_b32 v76, v76, -2, s33
    v_cvt_pk_bf16_f32 v78, v105, v107
    v_mov_b32 v122, v122
    v_mov_b32 v122, v122
    v_mov_b32 v122, v122
    v_mov_b32 v122, v122
    v_mov_b32 v122, v122
    v_mov_b32 v122, v122
    v_cvt_pk_bf16_f32 v77, v108, v110
    v_cvt_pk_bf16_f32 v79, v109, v111
    buffer_store_dwordx4 v[76:79], v118, s[8:11], s26 offen
    s_add_u32 s30, s30, 0x40000
    s_add_u32 s31, s31, 0x40000
    s_add_u32 s32, s32, 0x20000
    s_add_u32 s23, s24, 0
    s_add_u32 s48, s23, 4096
    s_xor_b32 s25, s25, 0x40000
    s_xor_b32 s26, s26, 0x40000
    s_mov_b32 s35, 0x49800000
    v_mov_b32 v126, s22
    s_add_u32 s22, s22, 1
    v_mov_b32 v32, 0
    v_mov_b32 v33, 0
    v_mov_b32 v34, 0
    v_mov_b32 v35, 0
    v_mov_b32 v36, 0
    v_mov_b32 v37, 0
    v_mov_b32 v38, 0
    v_mov_b32 v39, 0
    v_mov_b32 v40, 0
    v_mov_b32 v41, 0
    v_mov_b32 v42, 0
    v_mov_b32 v43, 0
    v_mov_b32 v44, 0
    v_mov_b32 v45, 0
    v_mov_b32 v46, 0
    v_mov_b32 v47, 0
    v_mov_b32 v48, 0
    v_mov_b32 v49, 0
    v_mov_b32 v50, 0
    v_mov_b32 v51, 0
    v_mov_b32 v52, 0
    v_mov_b32 v53, 0
    v_mov_b32 v54, 0
    v_mov_b32 v55, 0
    ds_read_b128 v[80:83], v123
    ds_read_b128 v[84:87], v123 offset:1024
    ds_read_b128 v[56:59], v123 offset:2048
    ds_read_b128 v[60:63], v123 offset:3072
    ds_read_b128 v[64:67], v123 offset:32768
    ds_read_b128 v[68:71], v123 offset:33792
    ds_read_b128 v[72:75], v123 offset:34816
    ds_read_b128 v[76:79], v123 offset:35840
    ds_read_b128 v[88:91], v123 offset:4096
    ds_read_b128 v[92:95], v123 offset:5120
    ds_read_b128 v[96:99], v123 offset:6144
    ds_read_b128 v[100:103], v123 offset:7168
    ds_read_b128 v[104:107], v123 offset:36864
    ds_read_b128 v[108:111], v123 offset:37888
    ds_read_b128 v[24:27], v123 offset:38912
    ds_read_b128 v[28:31], v123 offset:39936
    s_add_u32 s24, s24, 8192
    s_bitset0_b32 s24, 15
    s_xor_b32 s55, s24, 16384
    s_xor_b32 s29, s29, 0x40000
    s_xor_b32 s53, s29, 1024
    s_bfe_u32 s33, s22, 0x10001
    s_add_u32 s40, s22, 5
    s_lshr_b32 s40, s40, 2
    s_min_u32 s40, s40, 16
    s_bfm_b32 s58, s40, 0
    s_waitcnt vmcnt(5)
    v_cmp_eq_u32 vcc, 0, v125
    s_nop 0
    s_and_b64 vcc, vcc, s[58:59]
    s_cbranch_scc1 L_kvw_22
L_kvb_23:
    v_mov_b32 v15, 0
    s_nop 2
    v_mov_b32 v15, 0
    s_nop 2
    v_mov_b32 v15, 0
    s_nop 2
    v_mov_b32 v15, 0
    s_nop 2
    v_mov_b32 v15, 0
    s_nop 2
    v_mov_b32 v15, 0
    s_nop 2
    v_mov_b32 v15, 0
    s_nop 2
    v_mov_b32 v15, 0
    s_nop 2
    v_mov_b32 v15, 0
    s_nop 2
    v_mov_b32 v15, 0
    s_nop 2
    v_mov_b32 v15, 0
    s_nop 2
    v_mov_b32 v15, 0
    s_nop 2
    v_mov_b32 v15, 0
    s_nop 2
    v_mov_b32 v15, 0
    s_nop 2
    v_mov_b32 v15, 0
    s_nop 2
    v_mov_b32 v15, 0
    s_nop 2
    v_mov_b32 v15, 0
    s_nop 2
    v_mov_b32 v15, 0
    s_nop 2
    v_mov_b32 v15, 0
    s_nop 2
    v_mov_b32 v15, 0
    s_nop 2
    v_mov_b32 v15, 0
    s_nop 2
    v_mov_b32 v15, 0
    s_nop 2
    v_mov_b32 v15, 0
    s_nop 2
    v_mov_b32 v15, 0
    s_nop 2
    v_mov_b32 v15, 0
    s_nop 2
    v_mov_b32 v15, 0
    s_nop 2
    v_mov_b32 v15, 0
    s_nop 2
    v_mov_b32 v15, 0
    s_nop 2
    v_mov_b32 v15, 0
    s_nop 2
    v_mov_b32 v15, 0
    s_nop 2
    v_mov_b32 v15, 0
    s_nop 2
    s_waitcnt lgkmcnt(0)
    s_branch L_chain_top0_f
.p2align 6
L_chain_top1_f:
    buffer_load_dwordx4 v[0:3], v117, s[8:11], s23 offen nt
    v_mov_b32 v15, 0
    v_mov_b32 v15, 0
    v_mov_b32 v15, 0
    v_mov_b32 v15, 0
    v_mov_b32 v15, 0
    v_mov_b32 v15, 0
    v_mov_b32 v15, 0
    v_mov_b32 v15, 0
    v_mov_b32 v15, 0
    v_mov_b32 v15, 0
    v_mov_b32 v15, 0
    v_mov_b32 v15, 0
    v_mov_b32 v15, 0
    v_mov_b32 v15, 0
    v_mov_b32 v15, 0
    v_mov_b32 v15, 0
    buffer_load_dwordx4 v[0:3], v117, s[8:11], s23 offen sc1
    v_mov_b32 v15, 0
    v_mov_b32 v15, 0
    v_mov_b32 v15, 0
    v_mov_b32 v15, 0
    v_mov_b32 v15, 0
    v_mov_b32 v15, 0
    v_mov_b32 v15, 0
    v_mov_b32 v15, 0
    v_mov_b32 v15, 0
    v_mov_b32 v15, 0
    v_mov_b32 v15, 0
    v_mov_b32 v15, 0
    v_mov_b32 v15, 0
    v_mov_b32 v15, 0
    v_mov_b32 v15, 0
    v_mov_b32 v15, 0
L_mret_24:
    buffer_load_dwordx4 v[0:3], v117, s[8:11], s23 offen sc1
    s_add_u32 s45, s45, 1
    s_cmp_lt_u32 s45, 0x10000
    s_cselect_b32 s56, -2, -1
    s_nop 3
    v_mov_b32 v32, 0
    v_mov_b32 v33, 0
    v_mov_b32 v34, 0
    v_mov_b32 v35, 0
    s_waitcnt vmcnt(2)
    v_max3_u32 v15, v0, v1, v2
    v_max_u32 v15, v15, v3
    v_cmp_lt_u32 vcc, s56, v15
    v_smfmac_f32_16x16x64_bf16 v[32:35], v[0:3], v[80:87], v116
    s_cbranch_vccnz L_mret_24
    ds_write_b128 v117, v[0:3] offset:1024
    v_smfmac_f32_16x16x64_bf16 v[36:39], v[0:3], v[56:63], v116
    buffer_load_dwordx4 v[4:7], v117, s[8:11], s48 offen nt
    v_smfmac_f32_16x16x64_bf16 v[40:43], v[0:3], v[64:71], v116
    buffer_load_dwordx4 v117, s[8:11], s48 offen nt lds
    s_mov_b32 m0, 10240
    v_smfmac_f32_16x16x64_bf16 v[44:47], v[0:3], v[72:79], v116
    s_waitcnt lgkmcnt(0)
    s_barrier
    ds_read_b128 v[8:11], v117
    v_smfmac_f32_16x16x64_bf16 v[48:51], v[0:3], a[192:199], v116
    ds_read_b128 v[16:19], v117 offset:3072
    ds_read_b128 v[20:23], v117 offset:2048
    v_smfmac_f32_16x16x64_bf16 v[52:55], v[0:3], a[200:207], v116
    ds_read_b128 v[80:83], v117 offset:14336
    s_waitcnt lgkmcnt(3)
    v_smfmac_f32_16x16x64_bf16 v[32:35], v[8:11], a[0:7], v116
    ds_read_b128 v[84:87], v117 offset:15360
    v_smfmac_f32_16x16x64_bf16 v[36:39], v[8:11], a[8:15], v116
    ds_read_b128 v[56:59], v117 offset:8192
    s_waitcnt lgkmcnt(4)
    v_smfmac_f32_16x16x64_bf16 v[32:35], v[16:19], a[32:39], v116
    ds_read_b128 v[60:63], v117 offset:9216
    v_smfmac_f32_16x16x64_bf16 v[36:39], v[16:19], a[40:47], v116
    buffer_store_dwordx4 v[112:115], v117, s[8:11], s32 offen sc1
    s_waitcnt lgkmcnt(4)
    v_smfmac_f32_16x16x64_bf16 v[32:35], v[20:23], a[64:71], v116
    ds_read_b128 v[64:67], v117 offset:10240
    v_smfmac_f32_16x16x64_bf16 v[36:39], v[20:23], a[72:79], v116
    ds_read_b128 v[68:71], v117 offset:11264
    v_smfmac_f32_16x16x64_bf16 v[40:43], v[8:11], a[96:103], v116
    ds_read_b128 v[72:75], v117 offset:12288
    v_smfmac_f32_16x16x64_bf16 v[40:43], v[16:19], a[128:135], v116
    ds_read_b128 v[76:79], v117 offset:13312
    v_smfmac_f32_16x16x64_bf16 v[40:43], v[20:23], a[160:167], v116
    s_waitcnt vmcnt(2)
    v_max3_u32 v15, v4, v5, v6
    v_smfmac_f32_16x16x64_bf16 v[44:47], v[8:11], a[104:111], v116
    v_max_u32 v15, v15, v7
    v_smfmac_f32_16x16x64_bf16 v[44:47], v[16:19], a[136:143], v116
    s_waitcnt vmcnt(1) lgkmcnt(0)
    v_cmp_lt_u32 vcc, s56, v15
    v_smfmac_f32_16x16x64_bf16 v[44:47], v[20:23], a[168:175], v116
    s_cbranch_vccnz L_mret_25
L_mgo_26:
    v_smfmac_f32_16x16x64_bf16 v[44:47], v[4:7], v[24:31], v116
    s_barrier
    ds_read_b128 v[12:15], v117 offset:4096
    v_smfmac_f32_16x16x64_bf16 v[32:35], v[4:7], v[88:95], v116
    ds_read_b128 v[24:27], v117 offset:7168
    v_smfmac_f32_16x16x64_bf16 v[36:39], v[4:7], v[96:103], v116
    ds_read_b128 v[28:31], v117 offset:6144
    v_smfmac_f32_16x16x64_bf16 v[40:43], v[4:7], v[104:111], v116
    ds_read_b128 v[88:91], v117 offset:26624
    s_waitcnt lgkmcnt(3)
    v_smfmac_f32_16x16x64_bf16 v[32:35], v[12:15], a[16:23], v116
    ds_read_b128 v[92:95], v117 offset:27648
    s_waitcnt lgkmcnt(3)
    v_smfmac_f32_16x16x64_bf16 v[32:35], v[24:27], a[48:55], v116
    buffer_load_dwordx4 v117, s[8:11], s30 offen lds
    s_waitcnt lgkmcnt(2)
    v_smfmac_f32_16x16x64_bf16 v[32:35], v[28:31], a[80:87], v116
    ds_read_b128 v[96:99], v117 offset:23552
    v_smfmac_f32_16x16x64_bf16 v[36:39], v[12:15], a[24:31], v116
    ds_read_b128 v[100:103], v117 offset:23552
    v_smfmac_f32_16x16x64_bf16 v[36:39], v[24:27], a[56:63], v116
    buffer_load_dwordx4 v117, s[8:11], s30 offen offset:1024 lds
    s_add_u32 m0, s52, 0x6000
    v_add_f32 v32, v32, v34
    v_smfmac_f32_16x16x64_bf16 v[36:39], v[28:31], a[88:95], v116
    ds_read_b128 v[104:107], v117 offset:23552
    v_add_f32 v33, v33, v35
    v_smfmac_f32_16x16x64_bf16 v[40:43], v[12:15], a[112:119], v116
    ds_read_b128 v[108:111], v117 offset:23552
    v_mul_f32 v32, s34, v32
    v_smfmac_f32_16x16x64_bf16 v[40:43], v[24:27], a[144:151], v116
    buffer_load_dword v125, v119, s[8:11], s28 offen sc1
    v_mul_f32 v33, s34, v33
    v_smfmac_f32_16x16x64_bf16 v[40:43], v[28:31], a[176:183], v116
    ds_read_b128 v[0:3], v124
    v_add_f32 v36, v36, v38
    v_smfmac_f32_16x16x64_bf16 v[48:51], v[4:7], a[208:215], v116
    v_add_f32 v37, v37, v39
    v_smfmac_f32_16x16x64_bf16 v[52:55], v[4:7], a[216:223], v116
    s_waitcnt lgkmcnt(5)
    buffer_load_dwordx4 v117, s[8:11], s31 offen lds
    v_mul_f32 v36, s34, v36
    v_smfmac_f32_16x16x64_bf16 v[44:47], v[12:15], a[120:127], v116
    ds_read_b128 v[4:7], v124 offset:1024
    v_mul_f32 v37, s34, v37
    v_smfmac_f32_16x16x64_bf16 v[44:47], v[24:27], a[152:159], v116
    v_cvt_pk_bf16_f32 v34, v32, v36
    v_smfmac_f32_16x16x64_bf16 v[44:47], v[28:31], a[184:191], v116
    buffer_load_dwordx4 v117, s[8:11], s31 offen offset:1024 lds
    s_mov_b32 m0, 5120
    v_cvt_pk_bf16_f32 v35, v33, v37
    v_add_f32 v40, v40, v42
    v_smfmac_f32_16x16x64_bf16 v[48:51], v[8:11], a[224:231], v116
    ds_write2_b32 v120, v34, v35 offset0:32 offset1:48
    v_add_f32 v41, v41, v43
    v_smfmac_f32_16x16x64_bf16 v[52:55], v[8:11], a[232:239], v116
    v_add_f32 v44, v44, v46
    v_add_f32 v45, v45, v47
    v_cvt_pk_bf16_f32 v113, v40, v44
    v_cvt_pk_bf16_f32 v115, v41, v45
    v_smfmac_f32_16x16x64_bf16 v[48:51], v[12:15], a[240:247], v116
    ds_write2_b32 v120, v113, v115 offset0:0 offset1:16
    v_smfmac_f32_16x16x64_bf16 v[52:55], v[12:15], a[248:255], v116
    s_cmp_eq_u32 s22, 63
    s_cbranch_scc1 L_chain_last_f
    v_smfmac_f32_16x16x64_bf16 v[48:51], v[16:19], v[128:135], v116
    v_smfmac_f32_16x16x64_bf16 v[48:51], v[20:23], v[160:167], v116
    v_smfmac_f32_16x16x64_bf16 v[48:51], v[24:27], v[144:151], v116
    s_waitcnt lgkmcnt(0)
    s_barrier
    v_smfmac_f32_16x16x64_bf16 v[48:51], v[28:31], v[176:183], v116
    ds_read_b128 v[32:35], v121 offset:16384
    ds_read_b128 v[36:39], v121 offset:17408
    v_smfmac_f32_16x16x64_bf16 v[52:55], v[16:19], v[136:143], v116
    ds_read_b128 v[40:43], v121 offset:18432
    ds_read_b128 v[44:47], v121 offset:19456
    v_smfmac_f32_16x16x64_bf16 v[52:55], v[20:23], v[168:175], v116
    ds_read_b128 v[8:11], v124 offset:32768
    v_add_f32 v48, v48, v50
    v_smfmac_f32_16x16x64_bf16 v[52:55], v[24:27], v[152:159], v116
    ds_read_b128 v[12:15], v124 offset:33792
    v_add_f32 v49, v49, v51
    v_smfmac_f32_16x16x64_bf16 v[52:55], v[28:31], v[184:191], v116
    s_waitcnt lgkmcnt(5)
    v_cvt_pk_bf16_f32 v112, v48, v49
    v_mfma_f32_16x16x32_bf16 v[56:59], v[56:59], v[32:35], 0
    s_waitcnt lgkmcnt(4)
    v_mov_b32 v48, s50
    v_mov_b32 v49, s50
    v_mfma_f32_16x16x32_bf16 v[56:59], v[60:63], v[36:39], v[56:59]
    ds_read_b128 v[16:19], v124 offset:2048
    s_waitcnt lgkmcnt(4)
    v_mov_b32 v50, s50
    v_mov_b32 v51, s50
    v_mfma_f32_16x16x32_bf16 v[56:59], v[64:67], v[40:43], v[56:59]
    ds_read_b128 v[20:23], v124 offset:3072
    s_waitcnt lgkmcnt(4)
    v_add_f32 v52, v52, v54
    v_mfma_f32_16x16x32_bf16 v[56:59], v[68:71], v[44:47], v[56:59]
    ds_read_b128 v[24:27], v124 offset:4096
    v_add_f32 v53, v53, v55
    v_mfma_f32_16x16x32_bf16 v[60:63], v[72:75], v[32:35], 0
    ds_read_b128 v[28:31], v124 offset:5120
    v_cvt_pk_bf16_f32 v114, v52, v53
    v_mov_b32 v53, 0
    v_mfma_f32_16x16x32_bf16 v[60:63], v[76:79], v[36:39], v[60:63]
    v_exp_f32 v56, v56
    v_mfma_f32_16x16x32_bf16 v[60:63], v[80:83], v[40:43], v[60:63]
    v_exp_f32 v57, v57
    v_mfma_f32_16x16x32_bf16 v[60:63], v[84:87], v[44:47], v[60:63]
    v_exp_f32 v58, v58
    v_mfma_f32_16x16x32_bf16 v[64:67], v[32:35], v[32:35], 0
    v_exp_f32 v59, v59
    v_cvt_pk_bf16_f32 v68, v56, v57
    v_mfma_f32_16x16x32_bf16 v[64:67], v[36:39], v[36:39], v[64:67]
    v_exp_f32 v60, v60
    v_cvt_pk_bf16_f32 v69, v58, v59
    v_mfma_f32_16x16x32_bf16 v[64:67], v[40:43], v[40:43], v[64:67]
    v_exp_f32 v61, v61
    v_mfma_f32_16x16x32_bf16 v[64:67], v[44:47], v[44:47], v[64:67]
    v_exp_f32 v62, v62
    v_exp_f32 v63, v63
    v_cvt_pk_bf16_f32 v70, v60, v61
    v_cvt_pk_bf16_f32 v71, v62, v63
    s_nop 1
    v_mfma_f32_16x16x32_bf16 v[72:75], v[88:91], v[68:71], 0
    s_nop 0
    v_exp_f32 v64, v64
    v_mfma_f32_16x16x32_bf16 v[76:79], v[92:95], v[68:71], 0
    v_exp_f32 v65, v65
    v_mfma_f32_16x16x32_bf16 v[80:83], v[48:51], v[68:71], 0
    v_cvt_pk_bf16_f32 v52, v64, v65
    s_nop 1
    v_mfma_f32_16x16x16_bf16 v[72:75], v[112:113], v[52:53], v[72:75]
    ds_read_b128 v[32:35], v124 offset:6144
    v_mfma_f32_16x16x16_bf16 v[76:79], v[114:115], v[52:53], v[76:79]
    ds_read_b128 v[36:39], v124 offset:7168
    v_mfma_f32_16x16x16_bf16 v[80:83], v[48:49], v[52:53], v[80:83]
L_norm_27:
    s_mov_b64 vcc, s[36:37]
    v_mov_b32 v122, v122
    v_mov_b32 v122, v122
    v_mov_b32 v122, v122
    v_cndmask_b32_dpp v76, v72, v76, vcc quad_perm:[2,3,2,3] row_mask:0xf bank_mask:0xf
    v_cndmask_b32_dpp v77, v73, v77, vcc quad_perm:[2,3,2,3] row_mask:0xf bank_mask:0xf
    v_cndmask_b32_dpp v78, v74, v78, vcc quad_perm:[2,3,2,3] row_mask:0xf bank_mask:0xf
    v_cndmask_b32_dpp v79, v75, v79, vcc quad_perm:[2,3,2,3] row_mask:0xf bank_mask:0xf
    v_rcp_f32_dpp v84, v80 quad_perm:[2,3,2,3] row_mask:0xf bank_mask:0xf
    s_nop 0
    v_pk_mul_f32 v[76:77], v[76:77], v[84:85] op_sel_hi:[1,0]
    v_pk_mul_f32 v[78:79], v[78:79], v[84:85] op_sel_hi:[1,0]
    v_cvt_pk_bf16_f32 v72, v76, v77
    v_cvt_pk_bf16_f32 v73, v78, v79
    ds_write_b64 v122, v[72:73] offset:20992
    v_max_f32_dpp v86, v80, v84 quad_perm:[2,3,2,3] row_mask:0xf bank_mask:0xf
    v_mov_b32_dpp v60, v72 quad_perm:[0,1,0,1] row_mask:0xf bank_mask:0xf
    v_mov_b32_dpp v61, v73 quad_perm:[0,1,0,1] row_mask:0xf bank_mask:0xf
    v_cmp_lt_f32 vcc, s35, v86
    v_mov_b32_dpp v62, v72 quad_perm:[2,3,2,3] row_mask:0xf bank_mask:0xf
    v_mov_b32_dpp v63, v73 quad_perm:[2,3,2,3] row_mask:0xf bank_mask:0xf
    s_nop 1
    v_smfmac_f32_16x16x64_bf16 v[96:99], v[60:63], v[192:199], v116
    s_cbranch_vccnz L_smax_28
    v_smfmac_f32_16x16x64_bf16 v[100:103], v[60:63], v[224:231], v116
    s_waitcnt lgkmcnt(0)
    s_barrier
    ds_read_b128 v[92:95], v127 offset:20480
    ds_read_b128 v[80:83], v127 offset:22016
    ds_read_b128 v[84:87], v127 offset:21504
    v_smfmac_f32_16x16x64_bf16 v[104:107], v[60:63], v[0:7], v116
    ds_read_b128 v[40:43], v124 offset:34816
    v_smfmac_f32_16x16x64_bf16 v[108:111], v[60:63], v[8:15], v116
    ds_read_b128 v[56:59], v124 offset:36864
    s_waitcnt lgkmcnt(4)
    v_smfmac_f32_16x16x64_bf16 v[96:99], v[92:95], v[200:207], v116
    s_waitcnt lgkmcnt(3)
    v_smfmac_f32_16x16x64_bf16 v[96:99], v[80:83], v[208:215], v116
    ds_read_b128 v[44:47], v124 offset:35840
    s_waitcnt lgkmcnt(3)
    v_smfmac_f32_16x16x64_bf16 v[96:99], v[84:87], v[216:223], v116
    ds_read_b128 v[68:71], v124 offset:39936
    v_smfmac_f32_16x16x64_bf16 v[100:103], v[92:95], v[232:239], v116
    ds_read_b128 v[64:67], v124 offset:38912
    v_smfmac_f32_16x16x64_bf16 v[100:103], v[80:83], v[240:247], v116
    ds_read_b128 v[60:63], v124 offset:37888
    v_cvt_pk_bf16_f32 v72, v96, v98
    v_smfmac_f32_16x16x64_bf16 v[100:103], v[84:87], v[248:255], v116
    v_and_or_b32 v72, v72, -2, s33
    v_smfmac_f32_16x16x64_bf16 v[104:107], v[92:95], v[16:23], v116
    v_cvt_pk_bf16_f32 v74, v97, v99
    v_smfmac_f32_16x16x64_bf16 v[104:107], v[80:83], v[24:31], v116
    v_cvt_pk_bf16_f32 v73, v100, v102
    v_cvt_pk_bf16_f32 v75, v101, v103
    v_smfmac_f32_16x16x64_bf16 v[104:107], v[84:87], v[32:39], v116
    buffer_store_dwordx4 v[72:75], v118, s[8:11], s25 offen
    s_waitcnt lgkmcnt(3)
    v_smfmac_f32_16x16x64_bf16 v[108:111], v[92:95], v[40:47], v116
    s_waitcnt lgkmcnt(0)
    v_smfmac_f32_16x16x64_bf16 v[108:111], v[80:83], v[56:63], v116
    v_cvt_pk_bf16_f32 v76, v104, v106
    v_smfmac_f32_16x16x64_bf16 v[108:111], v[84:87], v[64:71], v116
    v_and_or_b32 v76, v76, -2, s33
    v_cvt_pk_bf16_f32 v78, v105, v107
    v_mov_b32 v122, v122
    v_mov_b32 v122, v122
    v_mov_b32 v122, v122
    v_mov_b32 v122, v122
    v_mov_b32 v122, v122
    v_mov_b32 v122, v122
    v_cvt_pk_bf16_f32 v77, v108, v110
    v_cvt_pk_bf16_f32 v79, v109, v111
    buffer_store_dwordx4 v[76:79], v118, s[8:11], s26 offen
    s_add_u32 s30, s30, 0x40000
    s_add_u32 s31, s31, 0x40000
    s_add_u32 s32, s32, 0x20000
    s_add_u32 s23, s24, 1024
    s_add_u32 s48, s23, 4096
    s_xor_b32 s25, s25, 0x40000
    s_xor_b32 s26, s26, 0x40000
    s_mov_b32 s35, 0x49800000
    s_add_u32 s22, s22, 1
    v_mov_b32 v32, 0
    v_mov_b32 v33, 0
    v_mov_b32 v34, 0
    v_mov_b32 v35, 0
    v_mov_b32 v36, 0
    v_mov_b32 v37, 0
    v_mov_b32 v38, 0
    v_mov_b32 v39, 0
    v_mov_b32 v40, 0
    v_mov_b32 v41, 0
    v_mov_b32 v42, 0
    v_mov_b32 v43, 0
    v_mov_b32 v44, 0
    v_mov_b32 v45, 0
    v_mov_b32 v46, 0
    v_mov_b32 v47, 0
    v_mov_b32 v48, 0
    v_mov_b32 v49, 0
    v_mov_b32 v50, 0
    v_mov_b32 v51, 0
    v_mov_b32 v52, 0
    v_mov_b32 v53, 0
    v_mov_b32 v54, 0
    v_mov_b32 v55, 0
    ds_read_b128 v[80:83], v123
    ds_read_b128 v[84:87], v123 offset:1024
    ds_read_b128 v[56:59], v123 offset:2048
    ds_read_b128 v[60:63], v123 offset:3072
    ds_read_b128 v[64:67], v123 offset:32768
    ds_read_b128 v[68:71], v123 offset:33792
    ds_read_b128 v[72:75], v123 offset:34816
    ds_read_b128 v[76:79], v123 offset:35840
    ds_read_b128 v[88:91], v123 offset:4096
    ds_read_b128 v[92:95], v123 offset:5120
    ds_read_b128 v[96:99], v123 offset:6144
    ds_read_b128 v[100:103], v123 offset:7168
    ds_read_b128 v[104:107], v123 offset:36864
    ds_read_b128 v[108:111], v123 offset:37888
    ds_read_b128 v[24:27], v123 offset:38912
    ds_read_b128 v[28:31], v123 offset:39936
    s_add_u32 s24, s24, 8192
    s_bitset0_b32 s24, 15
    s_xor_b32 s55, s24, 16384
    s_xor_b32 s29, s29, 0x40000
    s_xor_b32 s53, s29, 1024
    s_bfe_u32 s33, s22, 0x10001
    s_add_u32 s40, s22, 5
    s_lshr_b32 s40, s40, 2
    s_min_u32 s40, s40, 16
    s_bfm_b32 s58, s40, 0
    s_waitcnt vmcnt(4)
    v_cmp_eq_u32 vcc, 0, v125
    s_nop 0
    s_and_b64 vcc, vcc, s[58:59]
    s_cbranch_scc1 L_kvw_29
L_kvb_30:
    v_mov_b32 v15, 0
    s_nop 2
    v_mov_b32 v15, 0
    s_nop 2
    v_mov_b32 v15, 0
    s_nop 2
    v_mov_b32 v15, 0
    s_nop 2
    v_mov_b32 v15, 0
    s_nop 2
    v_mov_b32 v15, 0
    s_nop 2
    v_mov_b32 v15, 0
    s_nop 2
    v_mov_b32 v15, 0
    s_nop 2
    v_mov_b32 v15, 0
    s_nop 2
    v_mov_b32 v15, 0
    s_nop 2
    v_mov_b32 v15, 0
    s_nop 2
    v_mov_b32 v15, 0
    s_nop 2
    v_mov_b32 v15, 0
    s_nop 2
    v_mov_b32 v15, 0
    s_nop 2
    v_mov_b32 v15, 0
    s_nop 2
    v_mov_b32 v15, 0
    s_nop 2
    v_mov_b32 v15, 0
    s_nop 2
    v_mov_b32 v15, 0
    s_nop 2
    v_mov_b32 v15, 0
    s_nop 2
    v_mov_b32 v15, 0
    s_nop 2
    v_mov_b32 v15, 0
    s_nop 2
    v_mov_b32 v15, 0
    s_nop 2
    v_mov_b32 v15, 0
    s_nop 2
    v_mov_b32 v15, 0
    s_nop 2
    v_mov_b32 v15, 0
    s_nop 2
    v_mov_b32 v15, 0
    s_nop 2
    v_mov_b32 v15, 0
    s_nop 2
    v_mov_b32 v15, 0
    s_nop 2
    v_mov_b32 v15, 0
    s_nop 2
    v_mov_b32 v15, 0
    s_nop 2
    v_mov_b32 v15, 0
    s_nop 2
    s_waitcnt lgkmcnt(0)
    s_branch L_chain_top1_f
.p2align 6
L_chain_top2_f:
    buffer_load_dwordx4 v[0:3], v117, s[8:11], s23 offen nt
    v_mov_b32 v48, 0
    v_mov_b32 v49, 0
    v_mov_b32 v50, 0
    v_mov_b32 v51, 0
    v_mov_b32 v52, 0
    v_mov_b32 v53, 0
    v_mov_b32 v15, 0
    v_mov_b32 v15, 0
    v_mov_b32 v15, 0
    v_mov_b32 v15, 0
    v_mov_b32 v15, 0
    v_mov_b32 v15, 0
    v_mov_b32 v15, 0
    v_mov_b32 v15, 0
    v_mov_b32 v15, 0
    v_mov_b32 v15, 0
    buffer_load_dwordx4 v[0:3], v117, s[8:11], s23 offen sc1
    s_waitcnt vmcnt(3)
    v_mov_b32 v36, 0
    v_mov_b32 v37, 0
    v_mov_b32 v38, 0
    v_mov_b32 v39, 0
    v_mov_b32 v40, 0
    v_mov_b32 v41, 0
    v_mov_b32 v42, 0
    v_mov_b32 v43, 0
    v_mov_b32 v44, 0
    v_mov_b32 v45, 0
    v_mov_b32 v46, 0
    v_mov_b32 v47, 0
    v_mov_b32 v15, 0
    v_mov_b32 v15, 0
    v_mov_b32 v15, 0
    v_mov_b32 v15, 0
L_mret_31:
    buffer_load_dwordx4 v[0:3], v117, s[8:11], s23 offen sc1
    s_add_u32 s45, s45, 1
    s_cmp_lt_u32 s45, 0x10000
    s_cselect_b32 s56, -2, -1
    s_nop 3
    v_mov_b32 v32, 0
    v_mov_b32 v33, 0
    v_mov_b32 v34, 0
    v_mov_b32 v35, 0
    s_waitcnt vmcnt(2)
    v_max3_u32 v15, v0, v1, v2
    v_max_u32 v15, v15, v3
    v_cmp_lt_u32 vcc, s56, v15
    v_smfmac_f32_16x16x64_bf16 v[32:35], v[0:3], v[80:87], v116
    s_cbranch_vccnz L_mret_31
    ds_write_b128 v117, v[0:3] offset:2048
    v_smfmac_f32_16x16x64_bf16 v[36:39], v[0:3], v[56:63], v116
    buffer_load_dwordx4 v[4:7], v117, s[8:11], s48 offen nt
    v_smfmac_f32_16x16x64_bf16 v[40:43], v[0:3], v[64:71], v116
    buffer_load_dwordx4 v117, s[8:11], s48 offen nt lds
    s_mov_b32 m0, 12288
    v_smfmac_f32_16x16x64_bf16 v[44:47], v[0:3], v[72:79], v116
    s_waitcnt lgkmcnt(0)
    s_barrier
    ds_read_b128 v[8:11], v117 offset:3072
    v_smfmac_f32_16x16x64_bf16 v[48:51], v[0:3], a[192:199], v116
    ds_read_b128 v[16:19], v117
    ds_read_b128 v[20:23], v117 offset:1024
    v_smfmac_f32_16x16x64_bf16 v[52:55], v[0:3], a[200:207], v116
    ds_read_b128 v[80:83], v117 offset:14336
    s_waitcnt lgkmcnt(3)
    v_smfmac_f32_16x16x64_bf16 v[32:35], v[8:11], a[0:7], v116
    ds_read_b128 v[84:87], v117 offset:15360
    v_smfmac_f32_16x16x64_bf16 v[36:39], v[8:11], a[8:15], v116
    ds_read_b128 v[56:59], v117 offset:8192
    s_waitcnt lgkmcnt(4)
    v_smfmac_f32_16x16x64_bf16 v[32:35], v[16:19], a[32:39], v116
    ds_read_b128 v[60:63], v117 offset:9216
    v_smfmac_f32_16x16x64_bf16 v[36:39], v[16:19], a[40:47], v116
    ds_read_b128 v[64:67], v117 offset:10240
    s_waitcnt lgkmcnt(5)
    v_smfmac_f32_16x16x64_bf16 v[32:35], v[20:23], a[64:71], v116
    ds_read_b128 v[68:71], v117 offset:11264
    v_smfmac_f32_16x16x64_bf16 v[36:39], v[20:23], a[72:79], v116
    buffer_store_dwordx4 v[112:115], v117, s[8:11], s32 offen sc1
    v_smfmac_f32_16x16x64_bf16 v[40:43], v[8:11], a[96:103], v116
    ds_read_b128 v[72:75], v117 offset:12288
    v_smfmac_f32_16x16x64_bf16 v[40:43], v[16:19], a[128:135], v116
    ds_read_b128 v[76:79], v117 offset:13312
    v_smfmac_f32_16x16x64_bf16 v[40:43], v[20:23], a[160:167], v116
    s_waitcnt vmcnt(2)
    v_max3_u32 v15, v4, v5, v6
    v_smfmac_f32_16x16x64_bf16 v[44:47], v[8:11], a[104:111], v116
    v_max_u32 v15, v15, v7
    v_smfmac_f32_16x16x64_bf16 v[44:47], v[16:19], a[136:143], v116
    s_waitcnt vmcnt(1) lgkmcnt(0)
    v_cmp_lt_u32 vcc, s56, v15
    v_smfmac_f32_16x16x64_bf16 v[44:47], v[20:23], a[168:175], v116
    s_cbranch_vccnz L_mret_32
L_mgo_33:
    v_smfmac_f32_16x16x64_bf16 v[44:47], v[4:7], v[24:31], v116
    s_barrier
    ds_read_b128 v[12:15], v117 offset:7168
    v_smfmac_f32_16x16x64_bf16 v[32:35], v[4:7], v[88:95], v116
    ds_read_b128 v[24:27], v117 offset:4096
    v_smfmac_f32_16x16x64_bf16 v[36:39], v[4:7], v[96:103], v116
    ds_read_b128 v[28:31], v117 offset:5120
    v_smfmac_f32_16x16x64_bf16 v[40:43], v[4:7], v[104:111], v116
    ds_read_b128 v[88:91], v117 offset:28672
    s_waitcnt lgkmcnt(3)
    v_smfmac_f32_16x16x64_bf16 v[32:35], v[12:15], a[16:23], v116
    ds_read_b128 v[92:95], v117 offset:29696
    s_waitcnt lgkmcnt(3)
    v_smfmac_f32_16x16x64_bf16 v[32:35], v[24:27], a[48:55], v116
    buffer_load_dwordx4 v117, s[8:11], s30 offen lds
    s_waitcnt lgkmcnt(2)
    v_smfmac_f32_16x16x64_bf16 v[32:35], v[28:31], a[80:87], v116
    ds_read_b128 v[96:99], v117 offset:23552
    v_smfmac_f32_16x16x64_bf16 v[36:39], v[12:15], a[24:31], v116
    ds_read_b128 v[100:103], v117 offset:23552
    v_smfmac_f32_16x16x64_bf16 v[36:39], v[24:27], a[56:63], v116
    buffer_load_dwordx4 v117, s[8:11], s30 offen offset:1024 lds
    s_add_u32 m0, s52, 0x6000
    v_add_f32 v32, v32, v34
    v_smfmac_f32_16x16x64_bf16 v[36:39], v[28:31], a[88:95], v116
    ds_read_b128 v[104:107], v117 offset:23552
    v_add_f32 v33, v33, v35
    v_smfmac_f32_16x16x64_bf16 v[40:43], v[12:15], a[112:119], v116
    ds_read_b128 v[108:111], v117 offset:23552
    v_mul_f32 v32, s34, v32
    v_smfmac_f32_16x16x64_bf16 v[40:43], v[24:27], a[144:151], v116
    s_waitcnt lgkmcnt(4)
    buffer_load_dwordx4 v117, s[8:11], s31 offen lds
    v_mul_f32 v33, s34, v33
    v_smfmac_f32_16x16x64_bf16 v[40:43], v[28:31], a[176:183], v116
    ds_read_b128 v[0:3], v124
    v_add_f32 v36, v36, v38
    v_smfmac_f32_16x16x64_bf16 v[48:51], v[4:7], a[208:215], v116
    v_add_f32 v37, v37, v39
    v_smfmac_f32_16x16x64_bf16 v[52:55], v[4:7], a[216:223], v116
    buffer_load_dwordx4 v117, s[8:11], s31 offen offset:1024 lds
    s_mov_b32 m0, 6144
    v_mul_f32 v36, s34, v36
    v_smfmac_f32_16x16x64_bf16 v[44:47], v[12:15], a[120:127], v116
    ds_read_b128 v[4:7], v124 offset:1024
    v_mul_f32 v37, s34, v37
    v_smfmac_f32_16x16x64_bf16 v[44:47], v[24:27], a[152:159], v116
    v_cvt_pk_bf16_f32 v34, v32, v36
    v_smfmac_f32_16x16x64_bf16 v[44:47], v[28:31], a[184:191], v116
    v_cvt_pk_bf16_f32 v35, v33, v37
    v_add_f32 v40, v40, v42
    v_smfmac_f32_16x16x64_bf16 v[48:51], v[8:11], a[224:231], v116
    ds_write2_b32 v120, v34, v35 offset0:32 offset1:48
    v_add_f32 v41, v41, v43
    v_smfmac_f32_16x16x64_bf16 v[52:55], v[8:11], a[232:239], v116
    v_add_f32 v44, v44, v46
    v_add_f32 v45, v45, v47
    v_cvt_pk_bf16_f32 v113, v40, v44
    v_cvt_pk_bf16_f32 v115, v41, v45
    v_smfmac_f32_16x16x64_bf16 v[48:51], v[12:15], a[240:247], v116
    ds_write2_b32 v120, v113, v115 offset0:0 offset1:16
    v_smfmac_f32_16x16x64_bf16 v[52:55], v[12:15], a[248:255], v116
    s_cmp_eq_u32 s22, 63
    s_cbranch_scc1 L_chain_last_f
    v_smfmac_f32_16x16x64_bf16 v[48:51], v[16:19], v[128:135], v116
    buffer_store_dword v126, v119, s[8:11], s55 offen
    v_smfmac_f32_16x16x64_bf16 v[48:51], v[20:23], v[160:167], v116
    v_smfmac_f32_16x16x64_bf16 v[48:51], v[24:27], v[144:151], v116
    s_waitcnt lgkmcnt(0)
    s_barrier
    v_smfmac_f32_16x16x64_bf16 v[48:51], v[28:31], v[176:183], v116
    ds_read_b128 v[32:35], v121 offset:16384
    ds_read_b128 v[36:39], v121 offset:17408
    v_smfmac_f32_16x16x64_bf16 v[52:55], v[16:19], v[136:143], v116
    ds_read_b128 v[40:43], v121 offset:18432
    ds_read_b128 v[44:47], v121 offset:19456
    v_smfmac_f32_16x16x64_bf16 v[52:55], v[20:23], v[168:175], v116
    ds_read_b128 v[8:11], v124 offset:32768
    v_add_f32 v48, v48, v50
    v_smfmac_f32_16x16x64_bf16 v[52:55], v[24:27], v[152:159], v116
    ds_read_b128 v[12:15], v124 offset:33792
    v_add_f32 v49, v49, v51
    v_smfmac_f32_16x16x64_bf16 v[52:55], v[28:31], v[184:191], v116
    s_waitcnt lgkmcnt(5)
    v_cvt_pk_bf16_f32 v112, v48, v49
    v_mfma_f32_16x16x32_bf16 v[56:59], v[56:59], v[32:35], 0
    s_waitcnt lgkmcnt(4)
    v_mov_b32 v48, s50
    v_mov_b32 v49, s50
    v_mfma_f32_16x16x32_bf16 v[56:59], v[60:63], v[36:39], v[56:59]
    ds_read_b128 v[16:19], v124 offset:2048
    s_waitcnt lgkmcnt(4)
    v_mov_b32 v50, s50
    v_mov_b32 v51, s50
    v_mfma_f32_16x16x32_bf16 v[56:59], v[64:67], v[40:43], v[56:59]
    ds_read_b128 v[20:23], v124 offset:3072
    s_waitcnt lgkmcnt(4)
    v_add_f32 v52, v52, v54
    v_mfma_f32_16x16x32_bf16 v[56:59], v[68:71], v[44:47], v[56:59]
    ds_read_b128 v[24:27], v124 offset:4096
    v_add_f32 v53, v53, v55
    v_mfma_f32_16x16x32_bf16 v[60:63], v[72:75], v[32:35], 0
    ds_read_b128 v[28:31], v124 offset:5120
    v_cvt_pk_bf16_f32 v114, v52, v53
    v_mov_b32 v53, 0
    v_mfma_f32_16x16x32_bf16 v[60:63], v[76:79], v[36:39], v[60:63]
    v_exp_f32 v56, v56
    v_mfma_f32_16x16x32_bf16 v[60:63], v[80:83], v[40:43], v[60:63]
    v_exp_f32 v57, v57
    v_mfma_f32_16x16x32_bf16 v[60:63], v[84:87], v[44:47], v[60:63]
    v_exp_f32 v58, v58
    v_mfma_f32_16x16x32_bf16 v[64:67], v[32:35], v[32:35], 0
    v_exp_f32 v59, v59
    v_cvt_pk_bf16_f32 v68, v56, v57
    v_mfma_f32_16x16x32_bf16 v[64:67], v[36:39], v[36:39], v[64:67]
    v_exp_f32 v60, v60
    v_cvt_pk_bf16_f32 v69, v58, v59
    v_mfma_f32_16x16x32_bf16 v[64:67], v[40:43], v[40:43], v[64:67]
    v_exp_f32 v61, v61
    v_mfma_f32_16x16x32_bf16 v[64:67], v[44:47], v[44:47], v[64:67]
    v_exp_f32 v62, v62
    v_exp_f32 v63, v63
    v_cvt_pk_bf16_f32 v70, v60, v61
    v_cvt_pk_bf16_f32 v71, v62, v63
    s_nop 1
    v_mfma_f32_16x16x32_bf16 v[72:75], v[88:91], v[68:71], 0
    s_nop 0
    v_exp_f32 v64, v64
    v_mfma_f32_16x16x32_bf16 v[76:79], v[92:95], v[68:71], 0
    v_exp_f32 v65, v65
    v_mfma_f32_16x16x32_bf16 v[80:83], v[48:51], v[68:71], 0
    v_cvt_pk_bf16_f32 v52, v64, v65
    s_nop 1
    v_mfma_f32_16x16x16_bf16 v[72:75], v[112:113], v[52:53], v[72:75]
    ds_read_b128 v[32:35], v124 offset:6144
    v_mfma_f32_16x16x16_bf16 v[76:79], v[114:115], v[52:53], v[76:79]
    ds_read_b128 v[36:39], v124 offset:7168
    v_mfma_f32_16x16x16_bf16 v[80:83], v[48:49], v[52:53], v[80:83]
L_norm_34:
    s_mov_b64 vcc, s[36:37]
    v_mov_b32 v122, v122
    v_mov_b32 v122, v122
    v_mov_b32 v122, v122
    v_cndmask_b32_dpp v76, v72, v76, vcc quad_perm:[2,3,2,3] row_mask:0xf bank_mask:0xf
    v_cndmask_b32_dpp v77, v73, v77, vcc quad_perm:[2,3,2,3] row_mask:0xf bank_mask:0xf
    v_cndmask_b32_dpp v78, v74, v78, vcc quad_perm:[2,3,2,3] row_mask:0xf bank_mask:0xf
    v_cndmask_b32_dpp v79, v75, v79, vcc quad_perm:[2,3,2,3] row_mask:0xf bank_mask:0xf
    v_rcp_f32_dpp v84, v80 quad_perm:[2,3,2,3] row_mask:0xf bank_mask:0xf
    s_nop 0
    v_pk_mul_f32 v[76:77], v[76:77], v[84:85] op_sel_hi:[1,0]
    v_pk_mul_f32 v[78:79], v[78:79], v[84:85] op_sel_hi:[1,0]
    v_cvt_pk_bf16_f32 v72, v76, v77
    v_cvt_pk_bf16_f32 v73, v78, v79
    ds_write_b64 v122, v[72:73] offset:21504
    v_max_f32_dpp v86, v80, v84 quad_perm:[2,3,2,3] row_mask:0xf bank_mask:0xf
    v_mov_b32_dpp v60, v72 quad_perm:[0,1,0,1] row_mask:0xf bank_mask:0xf
    v_mov_b32_dpp v61, v73 quad_perm:[0,1,0,1] row_mask:0xf bank_mask:0xf
    v_cmp_lt_f32 vcc, s35, v86
    v_mov_b32_dpp v62, v72 quad_perm:[2,3,2,3] row_mask:0xf bank_mask:0xf
    v_mov_b32_dpp v63, v73 quad_perm:[2,3,2,3] row_mask:0xf bank_mask:0xf
    s_nop 1
    v_smfmac_f32_16x16x64_bf16 v[96:99], v[60:63], v[192:199], v116
    s_cbranch_vccnz L_smax_35
    v_smfmac_f32_16x16x64_bf16 v[100:103], v[60:63], v[224:231], v116
    s_waitcnt lgkmcnt(0)
    s_barrier
    ds_read_b128 v[92:95], v127 offset:22016
    ds_read_b128 v[80:83], v127 offset:20480
    ds_read_b128 v[84:87], v127 offset:20992
    v_smfmac_f32_16x16x64_bf16 v[104:107], v[60:63], v[0:7], v116
    ds_read_b128 v[40:43], v124 offset:34816
    v_smfmac_f32_16x16x64_bf16 v[108:111], v[60:63], v[8:15], v116
    ds_read_b128 v[56:59], v124 offset:36864
    s_waitcnt lgkmcnt(4)
    v_smfmac_f32_16x16x64_bf16 v[96:99], v[92:95], v[200:207], v116
    s_waitcnt lgkmcnt(3)
    v_smfmac_f32_16x16x64_bf16 v[96:99], v[80:83], v[208:215], v116
    ds_read_b128 v[44:47], v124 offset:35840
    s_waitcnt lgkmcnt(3)
    v_smfmac_f32_16x16x64_bf16 v[96:99], v[84:87], v[216:223], v116
    ds_read_b128 v[68:71], v124 offset:39936
    v_smfmac_f32_16x16x64_bf16 v[100:103], v[92:95], v[232:239], v116
    ds_read_b128 v[64:67], v124 offset:38912
    v_smfmac_f32_16x16x64_bf16 v[100:103], v[80:83], v[240:247], v116
    ds_read_b128 v[60:63], v124 offset:37888
    v_cvt_pk_bf16_f32 v72, v96, v98
    v_smfmac_f32_16x16x64_bf16 v[100:103], v[84:87], v[248:255], v116
    v_and_or_b32 v72, v72, -2, s33
    v_smfmac_f32_16x16x64_bf16 v[104:107], v[92:95], v[16:23], v116
    v_cvt_pk_bf16_f32 v74, v97, v99
    v_smfmac_f32_16x16x64_bf16 v[104:107], v[80:83], v[24:31], v116
    v_cvt_pk_bf16_f32 v73, v100, v102
    v_cvt_pk_bf16_f32 v75, v101, v103
    v_smfmac_f32_16x16x64_bf16 v[104:107], v[84:87], v[32:39], v116
    buffer_store_dwordx4 v[72:75], v118, s[8:11], s25 offen
    s_waitcnt lgkmcnt(3)
    v_smfmac_f32_16x16x64_bf16 v[108:111], v[92:95], v[40:47], v116
    s_waitcnt lgkmcnt(0)
    v_smfmac_f32_16x16x64_bf16 v[108:111], v[80:83], v[56:63], v116
    v_cvt_pk_bf16_f32 v76, v104, v106
    v_smfmac_f32_16x16x64_bf16 v[108:111], v[84:87], v[64:71], v116
    v_and_or_b32 v76, v76, -2, s33
    v_cvt_pk_bf16_f32 v78, v105, v107
    v_mov_b32 v122, v122
    v_mov_b32 v122, v122
    v_mov_b32 v122, v122
    v_mov_b32 v122, v122
    v_mov_b32 v122, v122
    v_mov_b32 v122, v122
    v_cvt_pk_bf16_f32 v77, v108, v110
    v_cvt_pk_bf16_f32 v79, v109, v111
    buffer_store_dwordx4 v[76:79], v118, s[8:11], s26 offen
    ds_read_b128 v[80:83], v123
    ds_read_b128 v[84:87], v123 offset:1024
    ds_read_b128 v[56:59], v123 offset:2048
    ds_read_b128 v[60:63], v123 offset:3072
    ds_read_b128 v[64:67], v123 offset:32768
    ds_read_b128 v[68:71], v123 offset:33792
    ds_read_b128 v[72:75], v123 offset:34816
    ds_read_b128 v[76:79], v123 offset:35840
    ds_read_b128 v[88:91], v123 offset:4096
    ds_read_b128 v[92:95], v123 offset:5120
    ds_read_b128 v[96:99], v123 offset:6144
    ds_read_b128 v[100:103], v123 offset:7168
    ds_read_b128 v[104:107], v123 offset:36864
    ds_read_b128 v[108:111], v123 offset:37888
    ds_read_b128 v[24:27], v123 offset:38912
    ds_read_b128 v[28:31], v123 offset:39936
    s_add_u32 s30, s30, 0x40000
    s_add_u32 s31, s31, 0x40000
    s_add_u32 s32, s32, 0x20000
    s_add_u32 s23, s24, 2048
    s_add_u32 s48, s23, 4096
    s_xor_b32 s25, s25, 0x40000
    s_xor_b32 s26, s26, 0x40000
    s_mov_b32 s35, 0x49800000
    s_add_u32 s22, s22, 1
    v_cndmask_b32 v12, 0, v125, s[68:69]
    v_cndmask_b32 v13, 0, v125, s[70:71]
    v_cndmask_b32 v14, 0, v125, s[72:73]
    v_cndmask_b32 v15, 0, v125, s[74:75]
    v_mov_b32 v54, 0
    v_mov_b32 v55, 0
    v_mov_b32 v52, 0
    v_mov_b32 v52, 0
    v_mov_b32 v52, 0
    v_mov_b32 v52, 0
    v_mov_b32 v52, 0
    v_mov_b32 v52, 0
    v_mov_b32 v52, 0
    v_mov_b32 v52, 0
    v_mov_b32 v52, 0
    v_mov_b32 v52, 0
    v_mov_b32 v52, 0
    v_mov_b32 v52, 0
    v_mov_b32 v52, 0
    v_mov_b32 v52, 0
    v_mov_b32 v52, 0
    v_mov_b32 v52, 0
    v_mov_b32 v52, 0
    v_mov_b32 v52, 0
    v_mov_b32 v52, 0
    buffer_load_dwordx4 v[4:7], v117, s[8:11], s29 offen nt
    buffer_load_dwordx4 v[8:11], v117, s[8:11], s53 offen nt
    buffer_load_dwordx4 v[16:19], v117, s[8:11], s29 offen offset:2048 nt
    buffer_load_dwordx4 v[20:23], v117, s[8:11], s53 offen offset:2048 nt
    v_mov_b32 v52, 0
    v_mov_b32 v52, 0
    v_mov_b32 v52, 0
    v_mov_b32 v52, 0
    v_mov_b32 v52, 0
    v_mov_b32 v52, 0
    v_mov_b32 v52, 0
    v_mov_b32 v52, 0
    v_mov_b32 v52, 0
    v_mov_b32 v52, 0
    v_mov_b32 v52, 0
    v_mov_b32 v52, 0
    v_mov_b32 v52, 0
    v_mov_b32 v52, 0
    v_mov_b32 v52, 0
    v_mov_b32 v52, 0
    v_mov_b32 v52, 0
    v_mov_b32 v52, 0
    v_mov_b32 v52, 0
    v_mov_b32 v52, 0
    v_mov_b32 v52, 0
    v_mov_b32 v52, 0
    v_mov_b32 v52, 0
    v_mov_b32 v52, 0
    v_mov_b32 v52, 0
    v_mov_b32 v52, 0
    v_mov_b32 v52, 0
    v_mov_b32 v52, 0
    v_mov_b32 v52, 0
    v_mov_b32 v52, 0
    v_mov_b32 v52, 0
    v_mov_b32 v52, 0
    v_mov_b32 v52, 0
    v_mov_b32 v52, 0
    v_mov_b32 v52, 0
    v_mov_b32 v52, 0
    v_mov_b32 v52, 0
    v_mov_b32 v52, 0
    v_mov_b32 v52, 0
    v_mov_b32 v52, 0
    buffer_load_dwordx4 v[32:35], v117, s[8:11], s29 offen sc1
    buffer_load_dwordx4 v[36:39], v117, s[8:11], s53 offen sc1
    buffer_load_dwordx4 v[40:43], v117, s[8:11], s29 offen offset:2048 sc1
    buffer_load_dwordx4 v[44:47], v117, s[8:11], s53 offen offset:2048 sc1
    v_mov_b32 v52, 0
L_rl_36:
    s_waitcnt vmcnt(7)
    v_mfma_f32_16x16x32_bf16 v[48:51], v[4:7], v[12:15], 0
    v_xor_b32 v52, s33, v4
    s_waitcnt vmcnt(6)
    v_mfma_f32_16x16x32_bf16 v[48:51], v[8:11], v[12:15], v[48:51]
    v_xor_b32 v53, s33, v8
    v_or_b32 v52, v52, v53
    s_waitcnt vmcnt(5)
    v_mfma_f32_16x16x32_bf16 v[48:51], v[16:19], v[12:15], v[48:51]
    v_xor_b32 v53, s33, v16
    v_or_b32 v52, v52, v53
    s_waitcnt vmcnt(4)
    v_mfma_f32_16x16x32_bf16 v[48:51], v[20:23], v[12:15], v[48:51]
    v_xor_b32 v53, s33, v20
    v_or_b32 v52, v52, v53
    v_and_b32 v52, 1, v52
    v_cmp_ne_u32 vcc, 0, v52
    s_cbranch_vccnz L_rslow_37
L_rgo_38:
    s_nop 2
    v_permlane32_swap_b32 v48, v50
    v_permlane32_swap_b32 v49, v51
    v_pk_add_f32 v[48:49], v[48:49], v[50:51]
    s_mov_b64 exec, s[38:39]
    v_cvt_pk_bf16_f32 v12, v48, v49
    v_min_u32 v12, 0xfffffffe, v12
    buffer_store_dword v12, v119, s[8:11], s24 offen
    s_mov_b64 exec, -1
    s_add_u32 s24, s24, 8192
    s_bitset0_b32 s24, 15
    s_xor_b32 s55, s24, 16384
    s_xor_b32 s29, s29, 0x40000
    s_xor_b32 s53, s29, 1024
    s_bfe_u32 s33, s22, 0x10001
    s_waitcnt lgkmcnt(0)
    s_branch L_chain_top2_f
.p2align 6
L_chain_top3_f:
    buffer_load_dwordx4 v[0:3], v117, s[8:11], s23 offen nt
    v_mov_b32 v48, 0
    v_mov_b32 v49, 0
    v_mov_b32 v50, 0
    v_mov_b32 v51, 0
    v_mov_b32 v52, 0
    v_mov_b32 v53, 0
    v_mov_b32 v15, 0
    v_mov_b32 v15, 0
    v_mov_b32 v15, 0
    v_mov_b32 v15, 0
    v_mov_b32 v15, 0
    v_mov_b32 v15, 0
    v_mov_b32 v15, 0
    v_mov_b32 v15, 0
    v_mov_b32 v15, 0
    v_mov_b32 v15, 0
    buffer_load_dwordx4 v[0:3], v117, s[8:11], s23 offen sc1
    s_waitcnt vmcnt(3)
    v_mov_b32 v36, 0
    v_mov_b32 v37, 0
    v_mov_b32 v38, 0
    v_mov_b32 v39, 0
    v_mov_b32 v40, 0
    v_mov_b32 v41, 0
    v_mov_b32 v42, 0
    v_mov_b32 v43, 0
    v_mov_b32 v44, 0
    v_mov_b32 v45, 0
    v_mov_b32 v46, 0
    v_mov_b32 v47, 0
    v_mov_b32 v15, 0
    v_mov_b32 v15, 0
    v_mov_b32 v15, 0
    v_mov_b32 v15, 0
L_mret_39:
    buffer_load_dwordx4 v[0:3], v117, s[8:11], s23 offen sc1
    s_add_u32 s45, s45, 1
    s_cmp_lt_u32 s45, 0x10000
    s_cselect_b32 s56, -2, -1
    s_nop 3
    v_mov_b32 v32, 0
    v_mov_b32 v33, 0
    v_mov_b32 v34, 0
    v_mov_b32 v35, 0
    s_waitcnt vmcnt(2)
    v_max3_u32 v15, v0, v1, v2
    v_max_u32 v15, v15, v3
    v_cmp_lt_u32 vcc, s56, v15
    v_smfmac_f32_16x16x64_bf16 v[32:35], v[0:3], v[80:87], v116
    s_cbranch_vccnz L_mret_39
    ds_write_b128 v117, v[0:3] offset:3072
    v_smfmac_f32_16x16x64_bf16 v[36:39], v[0:3], v[56:63], v116
    buffer_load_dwordx4 v[4:7], v117, s[8:11], s48 offen nt
    v_smfmac_f32_16x16x64_bf16 v[40:43], v[0:3], v[64:71], v116
    buffer_load_dwordx4 v117, s[8:11], s48 offen nt lds
    s_mov_b32 m0, 14336
    v_smfmac_f32_16x16x64_bf16 v[44:47], v[0:3], v[72:79], v116
    s_waitcnt lgkmcnt(0)
    s_barrier
    ds_read_b128 v[8:11], v117 offset:2048
    v_smfmac_f32_16x16x64_bf16 v[48:51], v[0:3], a[192:199], v116
    ds_read_b128 v[16:19], v117 offset:1024
    ds_read_b128 v[20:23], v117
    v_smfmac_f32_16x16x64_bf16 v[52:55], v[0:3], a[200:207], v116
    ds_read_b128 v[80:83], v117 offset:14336
    s_waitcnt lgkmcnt(3)
    v_smfmac_f32_16x16x64_bf16 v[32:35], v[8:11], a[0:7], v116
    ds_read_b128 v[84:87], v117 offset:15360
    v_smfmac_f32_16x16x64_bf16 v[36:39], v[8:11], a[8:15], v116
    ds_read_b128 v[56:59], v117 offset:8192
    s_waitcnt lgkmcnt(4)
    v_smfmac_f32_16x16x64_bf16 v[32:35], v[16:19], a[32:39], v116
    ds_read_b128 v[60:63], v117 offset:9216
    v_smfmac_f32_16x16x64_bf16 v[36:39], v[16:19], a[40:47], v116
    ds_read_b128 v[64:67], v117 offset:10240
    s_waitcnt lgkmcnt(5)
    v_smfmac_f32_16x16x64_bf16 v[32:35], v[20:23], a[64:71], v116
    ds_read_b128 v[68:71], v117 offset:11264
    v_smfmac_f32_16x16x64_bf16 v[36:39], v[20:23], a[72:79], v116
    ds_read_b128 v[72:75], v117 offset:12288
    v_smfmac_f32_16x16x64_bf16 v[40:43], v[8:11], a[96:103], v116
    ds_read_b128 v[76:79], v117 offset:13312
    v_smfmac_f32_16x16x64_bf16 v[40:43], v[16:19], a[128:135], v116
    buffer_store_dwordx4 v[112:115], v117, s[8:11], s32 offen sc1
    v_smfmac_f32_16x16x64_bf16 v[40:43], v[20:23], a[160:167], v116
    s_waitcnt vmcnt(2)
    v_max3_u32 v15, v4, v5, v6
    v_smfmac_f32_16x16x64_bf16 v[44:47], v[8:11], a[104:111], v116
    v_max_u32 v15, v15, v7
    v_smfmac_f32_16x16x64_bf16 v[44:47], v[16:19], a[136:143], v116
    s_waitcnt vmcnt(1) lgkmcnt(0)
    v_cmp_lt_u32 vcc, s56, v15
    v_smfmac_f32_16x16x64_bf16 v[44:47], v[20:23], a[168:175], v116
    s_cbranch_vccnz L_mret_40
L_mgo_41:
    v_smfmac_f32_16x16x64_bf16 v[44:47], v[4:7], v[24:31], v116
    s_barrier
    ds_read_b128 v[12:15], v117 offset:6144
    v_smfmac_f32_16x16x64_bf16 v[32:35], v[4:7], v[88:95], v116
    ds_read_b128 v[24:27], v117 offset:5120
    v_smfmac_f32_16x16x64_bf16 v[36:39], v[4:7], v[96:103], v116
    ds_read_b128 v[28:31], v117 offset:4096
    v_smfmac_f32_16x16x64_bf16 v[40:43], v[4:7], v[104:111], v116
    ds_read_b128 v[88:91], v117 offset:30720
    s_waitcnt lgkmcnt(3)
    v_smfmac_f32_16x16x64_bf16 v[32:35], v[12:15], a[16:23], v116
    ds_read_b128 v[92:95], v117 offset:31744
    s_waitcnt lgkmcnt(3)
    v_smfmac_f32_16x16x64_bf16 v[32:35], v[24:27], a[48:55], v116
    ds_read_b128 v[96:99], v117 offset:23552
    s_waitcnt lgkmcnt(3)
    v_smfmac_f32_16x16x64_bf16 v[32:35], v[28:31], a[80:87], v116
    buffer_load_dwordx4 v117, s[8:11], s30 offen lds
    v_smfmac_f32_16x16x64_bf16 v[36:39], v[12:15], a[24:31], v116
    ds_read_b128 v[100:103], v117 offset:23552
    v_smfmac_f32_16x16x64_bf16 v[36:39], v[24:27], a[56:63], v116
    ds_read_b128 v[104:107], v117 offset:23552
    v_add_f32 v32, v32, v34
    v_smfmac_f32_16x16x64_bf16 v[36:39], v[28:31], a[88:95], v116
    buffer_load_dwordx4 v117, s[8:11], s30 offen offset:1024 lds
    s_add_u32 m0, s52, 0x6000
    v_add_f32 v33, v33, v35
    v_smfmac_f32_16x16x64_bf16 v[40:43], v[12:15], a[112:119], v116
    ds_read_b128 v[108:111], v117 offset:23552
    v_mul_f32 v32, s34, v32
    v_smfmac_f32_16x16x64_bf16 v[40:43], v[24:27], a[144:151], v116
    ds_read_b128 v[0:3], v124
    v_mul_f32 v33, s34, v33
    v_smfmac_f32_16x16x64_bf16 v[40:43], v[28:31], a[176:183], v116
    s_waitcnt lgkmcnt(5)
    buffer_load_dwordx4 v117, s[8:11], s31 offen lds
    v_add_f32 v36, v36, v38
    v_smfmac_f32_16x16x64_bf16 v[48:51], v[4:7], a[208:215], v116
    v_add_f32 v37, v37, v39
    v_smfmac_f32_16x16x64_bf16 v[52:55], v[4:7], a[216:223], v116
    ds_read_b128 v[4:7], v124 offset:1024
    v_mul_f32 v36, s34, v36
    v_smfmac_f32_16x16x64_bf16 v[44:47], v[12:15], a[120:127], v116
    buffer_load_dwordx4 v117, s[8:11], s31 offen offset:1024 lds
    s_mov_b32 m0, 7168
    v_mul_f32 v37, s34, v37
    v_smfmac_f32_16x16x64_bf16 v[44:47], v[24:27], a[152:159], v116
    v_cvt_pk_bf16_f32 v34, v32, v36
    v_smfmac_f32_16x16x64_bf16 v[44:47], v[28:31], a[184:191], v116
    v_cvt_pk_bf16_f32 v35, v33, v37
    v_add_f32 v40, v40, v42
    v_smfmac_f32_16x16x64_bf16 v[48:51], v[8:11], a[224:231], v116
    ds_write2_b32 v120, v34, v35 offset0:32 offset1:48
    v_add_f32 v41, v41, v43
    v_smfmac_f32_16x16x64_bf16 v[52:55], v[8:11], a[232:239], v116
    v_add_f32 v44, v44, v46
    v_add_f32 v45, v45, v47
    v_cvt_pk_bf16_f32 v113, v40, v44
    v_cvt_pk_bf16_f32 v115, v41, v45
    v_smfmac_f32_16x16x64_bf16 v[48:51], v[12:15], a[240:247], v116
    ds_write2_b32 v120, v113, v115 offset0:0 offset1:16
    v_smfmac_f32_16x16x64_bf16 v[52:55], v[12:15], a[248:255], v116
    s_cmp_eq_u32 s22, 63
    s_cbranch_scc1 L_chain_last_f
    v_smfmac_f32_16x16x64_bf16 v[48:51], v[16:19], v[128:135], v116
    v_smfmac_f32_16x16x64_bf16 v[48:51], v[20:23], v[160:167], v116
    buffer_store_dword v126, v119, s[8:11], s55 offen
    v_smfmac_f32_16x16x64_bf16 v[48:51], v[24:27], v[144:151], v116
    s_waitcnt lgkmcnt(0)
    s_barrier
    v_smfmac_f32_16x16x64_bf16 v[48:51], v[28:31], v[176:183], v116
    ds_read_b128 v[32:35], v121 offset:16384
    ds_read_b128 v[36:39], v121 offset:17408
    v_smfmac_f32_16x16x64_bf16 v[52:55], v[16:19], v[136:143], v116
    ds_read_b128 v[40:43], v121 offset:18432
    ds_read_b128 v[44:47], v121 offset:19456
    v_smfmac_f32_16x16x64_bf16 v[52:55], v[20:23], v[168:175], v116
    ds_read_b128 v[8:11], v124 offset:32768
    v_add_f32 v48, v48, v50
    v_smfmac_f32_16x16x64_bf16 v[52:55], v[24:27], v[152:159], v116
    ds_read_b128 v[12:15], v124 offset:33792
    v_add_f32 v49, v49, v51
    v_smfmac_f32_16x16x64_bf16 v[52:55], v[28:31], v[184:191], v116
    s_waitcnt lgkmcnt(5)
    v_cvt_pk_bf16_f32 v112, v48, v49
    v_mfma_f32_16x16x32_bf16 v[56:59], v[56:59], v[32:35], 0
    s_waitcnt lgkmcnt(4)
    v_mov_b32 v48, s50
    v_mov_b32 v49, s50
    v_mfma_f32_16x16x32_bf16 v[56:59], v[60:63], v[36:39], v[56:59]
    ds_read_b128 v[16:19], v124 offset:2048
    s_waitcnt lgkmcnt(4)
    v_mov_b32 v50, s50
    v_mov_b32 v51, s50
    v_mfma_f32_16x16x32_bf16 v[56:59], v[64:67], v[40:43], v[56:59]
    ds_read_b128 v[20:23], v124 offset:3072
    s_waitcnt lgkmcnt(4)
    v_add_f32 v52, v52, v54
    v_mfma_f32_16x16x32_bf16 v[56:59], v[68:71], v[44:47], v[56:59]
    ds_read_b128 v[24:27], v124 offset:4096
    v_add_f32 v53, v53, v55
    v_mfma_f32_16x16x32_bf16 v[60:63], v[72:75], v[32:35], 0
    ds_read_b128 v[28:31], v124 offset:5120
    v_cvt_pk_bf16_f32 v114, v52, v53
    v_mov_b32 v53, 0
    v_mfma_f32_16x16x32_bf16 v[60:63], v[76:79], v[36:39], v[60:63]
    v_exp_f32 v56, v56
    v_mfma_f32_16x16x32_bf16 v[60:63], v[80:83], v[40:43], v[60:63]
    v_exp_f32 v57, v57
    v_mfma_f32_16x16x32_bf16 v[60:63], v[84:87], v[44:47], v[60:63]
    v_exp_f32 v58, v58
    v_mfma_f32_16x16x32_bf16 v[64:67], v[32:35], v[32:35], 0
    v_exp_f32 v59, v59
    v_cvt_pk_bf16_f32 v68, v56, v57
    v_mfma_f32_16x16x32_bf16 v[64:67], v[36:39], v[36:39], v[64:67]
    v_exp_f32 v60, v60
    v_cvt_pk_bf16_f32 v69, v58, v59
    v_mfma_f32_16x16x32_bf16 v[64:67], v[40:43], v[40:43], v[64:67]
    v_exp_f32 v61, v61
    v_mfma_f32_16x16x32_bf16 v[64:67], v[44:47], v[44:47], v[64:67]
    v_exp_f32 v62, v62
    v_exp_f32 v63, v63
    v_cvt_pk_bf16_f32 v70, v60, v61
    v_cvt_pk_bf16_f32 v71, v62, v63
    s_nop 1
    v_mfma_f32_16x16x32_bf16 v[72:75], v[88:91], v[68:71], 0
    s_nop 0
    v_exp_f32 v64, v64
    v_mfma_f32_16x16x32_bf16 v[76:79], v[92:95], v[68:71], 0
    v_exp_f32 v65, v65
    v_mfma_f32_16x16x32_bf16 v[80:83], v[48:51], v[68:71], 0
    v_cvt_pk_bf16_f32 v52, v64, v65
    s_nop 1
    v_mfma_f32_16x16x16_bf16 v[72:75], v[112:113], v[52:53], v[72:75]
    ds_read_b128 v[32:35], v124 offset:6144
    v_mfma_f32_16x16x16_bf16 v[76:79], v[114:115], v[52:53], v[76:79]
    ds_read_b128 v[36:39], v124 offset:7168
    v_mfma_f32_16x16x16_bf16 v[80:83], v[48:49], v[52:53], v[80:83]
L_norm_42:
    s_mov_b64 vcc, s[36:37]
    v_mov_b32 v122, v122
    v_mov_b32 v122, v122
    v_mov_b32 v122, v122
    v_cndmask_b32_dpp v76, v72, v76, vcc quad_perm:[2,3,2,3] row_mask:0xf bank_mask:0xf
    v_cndmask_b32_dpp v77, v73, v77, vcc quad_perm:[2,3,2,3] row_mask:0xf bank_mask:0xf
    v_cndmask_b32_dpp v78, v74, v78, vcc quad_perm:[2,3,2,3] row_mask:0xf bank_mask:0xf
    v_cndmask_b32_dpp v79, v75, v79, vcc quad_perm:[2,3,2,3] row_mask:0xf bank_mask:0xf
    v_rcp_f32_dpp v84, v80 quad_perm:[2,3,2,3] row_mask:0xf bank_mask:0xf
    s_nop 0
    v_pk_mul_f32 v[76:77], v[76:77], v[84:85] op_sel_hi:[1,0]
    v_pk_mul_f32 v[78:79], v[78:79], v[84:85] op_sel_hi:[1,0]
    v_cvt_pk_bf16_f32 v72, v76, v77
    v_cvt_pk_bf16_f32 v73, v78, v79
    ds_write_b64 v122, v[72:73] offset:22016
    v_max_f32_dpp v86, v80, v84 quad_perm:[2,3,2,3] row_mask:0xf bank_mask:0xf
    v_mov_b32_dpp v60, v72 quad_perm:[0,1,0,1] row_mask:0xf bank_mask:0xf
    v_mov_b32_dpp v61, v73 quad_perm:[0,1,0,1] row_mask:0xf bank_mask:0xf
    v_cmp_lt_f32 vcc, s35, v86
    v_mov_b32_dpp v62, v72 quad_perm:[2,3,2,3] row_mask:0xf bank_mask:0xf
    v_mov_b32_dpp v63, v73 quad_perm:[2,3,2,3] row_mask:0xf bank_mask:0xf
    s_nop 1
    v_smfmac_f32_16x16x64_bf16 v[96:99], v[60:63], v[192:199], v116
    s_cbranch_vccnz L_smax_43
    v_smfmac_f32_16x16x64_bf16 v[100:103], v[60:63], v[224:231], v116
    s_waitcnt lgkmcnt(0)
    s_barrier
    ds_read_b128 v[92:95], v127 offset:21504
    ds_read_b128 v[80:83], v127 offset:20992
    ds_read_b128 v[84:87], v127 offset:20480
    v_smfmac_f32_16x16x64_bf16 v[104:107], v[60:63], v[0:7], v116
    ds_read_b128 v[40:43], v124 offset:34816
    v_smfmac_f32_16x16x64_bf16 v[108:111], v[60:63], v[8:15], v116
    ds_read_b128 v[56:59], v124 offset:36864
    s_waitcnt lgkmcnt(4)
    v_smfmac_f32_16x16x64_bf16 v[96:99], v[92:95], v[200:207], v116
    s_waitcnt lgkmcnt(3)
    v_smfmac_f32_16x16x64_bf16 v[96:99], v[80:83], v[208:215], v116
    ds_read_b128 v[44:47], v124 offset:35840
    s_waitcnt lgkmcnt(3)
    v_smfmac_f32_16x16x64_bf16 v[96:99], v[84:87], v[216:223], v116
    ds_read_b128 v[68:71], v124 offset:39936
    v_smfmac_f32_16x16x64_bf16 v[100:103], v[92:95], v[232:239], v116
    ds_read_b128 v[64:67], v124 offset:38912
    v_smfmac_f32_16x16x64_bf16 v[100:103], v[80:83], v[240:247], v116
    ds_read_b128 v[60:63], v124 offset:37888
    v_cvt_pk_bf16_f32 v72, v96, v98
    v_smfmac_f32_16x16x64_bf16 v[100:103], v[84:87], v[248:255], v116
    v_and_or_b32 v72, v72, -2, s33
    v_smfmac_f32_16x16x64_bf16 v[104:107], v[92:95], v[16:23], v116
    v_cvt_pk_bf16_f32 v74, v97, v99
    v_smfmac_f32_16x16x64_bf16 v[104:107], v[80:83], v[24:31], v116
    v_cvt_pk_bf16_f32 v73, v100, v102
    v_cvt_pk_bf16_f32 v75, v101, v103
    v_smfmac_f32_16x16x64_bf16 v[104:107], v[84:87], v[32:39], v116
    buffer_store_dwordx4 v[72:75], v118, s[8:11], s25 offen
    s_waitcnt lgkmcnt(3)
    v_smfmac_f32_16x16x64_bf16 v[108:111], v[92:95], v[40:47], v116
    s_waitcnt lgkmcnt(0)
    v_smfmac_f32_16x16x64_bf16 v[108:111], v[80:83], v[56:63], v116
    v_cvt_pk_bf16_f32 v76, v104, v106
    v_smfmac_f32_16x16x64_bf16 v[108:111], v[84:87], v[64:71], v116
    v_and_or_b32 v76, v76, -2, s33
    v_cvt_pk_bf16_f32 v78, v105, v107
    v_mov_b32 v122, v122
    v_mov_b32 v122, v122
    v_mov_b32 v122, v122
    v_mov_b32 v122, v122
    v_mov_b32 v122, v122
    v_mov_b32 v122, v122
    v_cvt_pk_bf16_f32 v77, v108, v110
    v_cvt_pk_bf16_f32 v79, v109, v111
    buffer_store_dwordx4 v[76:79], v118, s[8:11], s26 offen
    ds_read_b128 v[80:83], v123
    ds_read_b128 v[84:87], v123 offset:1024
    ds_read_b128 v[56:59], v123 offset:2048
    ds_read_b128 v[60:63], v123 offset:3072
    ds_read_b128 v[64:67], v123 offset:32768
    ds_read_b128 v[68:71], v123 offset:33792
    ds_read_b128 v[72:75], v123 offset:34816
    ds_read_b128 v[76:79], v123 offset:35840
    ds_read_b128 v[88:91], v123 offset:4096
    ds_read_b128 v[92:95], v123 offset:5120
    ds_read_b128 v[96:99], v123 offset:6144
    ds_read_b128 v[100:103], v123 offset:7168
    ds_read_b128 v[104:107], v123 offset:36864
    ds_read_b128 v[108:111], v123 offset:37888
    ds_read_b128 v[24:27], v123 offset:38912
    ds_read_b128 v[28:31], v123 offset:39936
    s_add_u32 s30, s30, 0x40000
    s_add_u32 s31, s31, 0x40000
    s_add_u32 s32, s32, 0x20000
    s_add_u32 s23, s24, 3072
    s_add_u32 s48, s23, 4096
    s_xor_b32 s25, s25, 0x40000
    s_xor_b32 s26, s26, 0x40000
    s_mov_b32 s35, 0x49800000
    s_add_u32 s22, s22, 1
    v_cndmask_b32 v12, 0, v125, s[68:69]
    v_cndmask_b32 v13, 0, v125, s[70:71]
    v_cndmask_b32 v14, 0, v125, s[72:73]
    v_cndmask_b32 v15, 0, v125, s[74:75]
    v_mov_b32 v54, 0
    v_mov_b32 v55, 0
    v_mov_b32 v52, 0
    v_mov_b32 v52, 0
    v_mov_b32 v52, 0
    v_mov_b32 v52, 0
    v_mov_b32 v52, 0
    v_mov_b32 v52, 0
    v_mov_b32 v52, 0
    v_mov_b32 v52, 0
    v_mov_b32 v52, 0
    v_mov_b32 v52, 0
    v_mov_b32 v52, 0
    v_mov_b32 v52, 0
    v_mov_b32 v52, 0
    v_mov_b32 v52, 0
    v_mov_b32 v52, 0
    v_mov_b32 v52, 0
    v_mov_b32 v52, 0
    v_mov_b32 v52, 0
    v_mov_b32 v52, 0
    v_mov_b32 v52, 0
    v_mov_b32 v52, 0
    v_mov_b32 v52, 0
    v_mov_b32 v52, 0
    v_mov_b32 v52, 0
    v_mov_b32 v52, 0
    v_mov_b32 v52, 0
    v_mov_b32 v52, 0
    v_mov_b32 v52, 0
    v_mov_b32 v52, 0
    v_mov_b32 v52, 0
    v_mov_b32 v52, 0
    v_mov_b32 v52, 0
    v_mov_b32 v52, 0
    v_mov_b32 v52, 0
    v_mov_b32 v52, 0
    v_mov_b32 v52, 0
    v_mov_b32 v52, 0
    v_mov_b32 v52, 0
    v_mov_b32 v52, 0
    v_mov_b32 v52, 0
    v_mov_b32 v52, 0
    v_mov_b32 v52, 0
    v_mov_b32 v52, 0
    v_mov_b32 v52, 0
    v_mov_b32 v52, 0
    v_mov_b32 v52, 0
    v_mov_b32 v52, 0
    v_mov_b32 v52, 0
    v_mov_b32 v52, 0
    buffer_load_dwordx4 v[4:7], v117, s[8:11], s29 offen nt
    buffer_load_dwordx4 v[8:11], v117, s[8:11], s53 offen nt
    buffer_load_dwordx4 v[16:19], v117, s[8:11], s29 offen offset:2048 nt
    buffer_load_dwordx4 v[20:23], v117, s[8:11], s53 offen offset:2048 nt
    v_mov_b32 v52, 0
    v_mov_b32 v52, 0
    v_mov_b32 v52, 0
    v_mov_b32 v52, 0
    v_mov_b32 v52, 0
    v_mov_b32 v52, 0
    v_mov_b32 v52, 0
    v_mov_b32 v52, 0
    v_mov_b32 v52, 0
    v_mov_b32 v52, 0
    v_mov_b32 v52, 0
    v_mov_b32 v52, 0
    v_mov_b32 v52, 0
    v_mov_b32 v52, 0
    v_mov_b32 v52, 0
    v_mov_b32 v52, 0
    v_mov_b32 v52, 0
    v_mov_b32 v52, 0
    v_mov_b32 v52, 0
    v_mov_b32 v52, 0
    v_mov_b32 v52, 0
    v_mov_b32 v52, 0
    v_mov_b32 v52, 0
    v_mov_b32 v52, 0
    v_mov_b32 v52, 0
    v_mov_b32 v52, 0
    v_mov_b32 v52, 0
    v_mov_b32 v52, 0
    v_mov_b32 v52, 0
    v_mov_b32 v52, 0
    buffer_load_dwordx4 v[32:35], v117, s[8:11], s29 offen sc1
    buffer_load_dwordx4 v[36:39], v117, s[8:11], s53 offen sc1
    buffer_load_dwordx4 v[40:43], v117, s[8:11], s29 offen offset:2048 sc1
    buffer_load_dwordx4 v[44:47], v117, s[8:11], s53 offen offset:2048 sc1
    v_mov_b32 v52, 0
L_rl_44:
    s_waitcnt vmcnt(7)
    v_mfma_f32_16x16x32_bf16 v[48:51], v[4:7], v[12:15], 0
    v_xor_b32 v52, s33, v4
    s_waitcnt vmcnt(6)
    v_mfma_f32_16x16x32_bf16 v[48:51], v[8:11], v[12:15], v[48:51]
    v_xor_b32 v53, s33, v8
    v_or_b32 v52, v52, v53
    s_waitcnt vmcnt(5)
    v_mfma_f32_16x16x32_bf16 v[48:51], v[16:19], v[12:15], v[48:51]
    v_xor_b32 v53, s33, v16
    v_or_b32 v52, v52, v53
    s_waitcnt vmcnt(4)
    v_mfma_f32_16x16x32_bf16 v[48:51], v[20:23], v[12:15], v[48:51]
    v_xor_b32 v53, s33, v20
    v_or_b32 v52, v52, v53
    v_and_b32 v52, 1, v52
    v_cmp_ne_u32 vcc, 0, v52
    s_cbranch_vccnz L_rslow_45
L_rgo_46:
    s_nop 2
    v_permlane32_swap_b32 v48, v50
    v_permlane32_swap_b32 v49, v51
    v_pk_add_f32 v[48:49], v[48:49], v[50:51]
    s_mov_b64 exec, s[38:39]
    v_cvt_pk_bf16_f32 v12, v48, v49
    v_min_u32 v12, 0xfffffffe, v12
    buffer_store_dword v12, v119, s[8:11], s24 offen
    s_mov_b64 exec, -1
    s_add_u32 s24, s24, 8192
    s_bitset0_b32 s24, 15
    s_xor_b32 s55, s24, 16384
    s_xor_b32 s29, s29, 0x40000
    s_xor_b32 s53, s29, 1024
    s_bfe_u32 s33, s22, 0x10001
    s_waitcnt lgkmcnt(0)
    s_branch L_chain_top3_f
L_chain_last_f:
    s_nop 1
    v_smfmac_f32_16x16x64_bf16 v[48:51], v[16:19], v[128:135], v116
    v_smfmac_f32_16x16x64_bf16 v[48:51], v[20:23], v[160:167], v116
    v_smfmac_f32_16x16x64_bf16 v[48:51], v[24:27], v[144:151], v116
    v_smfmac_f32_16x16x64_bf16 v[48:51], v[28:31], v[176:183], v116
    v_smfmac_f32_16x16x64_bf16 v[52:55], v[16:19], v[136:143], v116
    v_smfmac_f32_16x16x64_bf16 v[52:55], v[20:23], v[168:175], v116
    v_smfmac_f32_16x16x64_bf16 v[52:55], v[24:27], v[152:159], v116
    v_smfmac_f32_16x16x64_bf16 v[52:55], v[28:31], v[184:191], v116
    v_add_f32 v48, v48, v50
    v_add_f32 v49, v49, v51
    v_cvt_pk_bf16_f32 v112, v48, v49
    s_nop 4
    v_add_f32 v52, v52, v54
    v_add_f32 v53, v53, v55
    v_cvt_pk_bf16_f32 v114, v52, v53
    s_add_u32 s32, s32, 0x20000
    buffer_store_dwordx4 v[112:115], v117, s[8:11], s32 offen sc1
    v_mov_b32 v94, 64
    s_waitcnt vmcnt(0) lgkmcnt(0)
    s_barrier
    s_mov_b64 exec, 1
    buffer_store_dword v94, off, s[8:11], s44 sc1
    s_mov_b64 exec, -1
    s_endpgm
L_mret_18:
    s_mov_b32 s43, m0
    s_mov_b32 m0, 4096
    buffer_load_dwordx4 v[4:7], v117, s[8:11], s48 offen sc1
    buffer_load_dwordx4 v117, s[8:11], s48 offen sc1 lds
    s_mov_b32 m0, 8192
    s_mov_b32 m0, s43
    s_waitcnt vmcnt(0)
    v_max3_u32 v15, v4, v5, v6
    v_max_u32 v15, v15, v7
    v_cmp_lt_u32 vcc, s56, v15
    s_add_u32 s47, s47, 1
    s_add_u32 s49, s49, 1
    s_cmp_ge_u32 s49, 0x10000
    s_cbranch_scc1 L_mgo_19
    s_cbranch_vccnz L_mret_18
    s_branch L_mgo_19
L_smax_21:
    s_add_u32 s47, s47, 1
    s_mov_b32 s35, 0x7f800000
    s_waitcnt lgkmcnt(0)
    s_sub_u32 s43, s30, 0x40000
    s_add_u32 s40, s43, 4096
    s_nop 7
    buffer_load_dwordx4 v[56:59], v117, s[8:11], s43 offen
    buffer_load_dwordx4 v[60:63], v117, s[8:11], s43 offen offset:1024
    buffer_load_dwordx4 v[64:67], v117, s[8:11], s43 offen offset:2048
    buffer_load_dwordx4 v[68:71], v117, s[8:11], s43 offen offset:3072
    buffer_load_dwordx4 v[72:75], v117, s[8:11], s40 offen
    buffer_load_dwordx4 v[76:79], v117, s[8:11], s40 offen offset:1024
    buffer_load_dwordx4 v[80:83], v117, s[8:11], s40 offen offset:2048
    buffer_load_dwordx4 v[84:87], v117, s[8:11], s40 offen offset:3072
    ds_read_b128 v[32:35], v121 offset:16384
    ds_read_b128 v[36:39], v121 offset:17408
    ds_read_b128 v[40:43], v121 offset:18432
    ds_read_b128 v[44:47], v121 offset:19456
    v_mov_b32 v96, 0
    v_mov_b32 v97, 0
    v_mov_b32 v98, 0
    v_mov_b32 v99, 0
    v_mov_b32 v100, 0
    v_mov_b32 v101, 0
    v_mov_b32 v102, 0
    v_mov_b32 v103, 0
    v_mov_b32 v104, 0
    v_mov_b32 v105, 0
    v_mov_b32 v106, 0
    v_mov_b32 v107, 0
    v_mov_b32 v108, 0
    v_mov_b32 v109, 0
    v_mov_b32 v110, 0
    v_mov_b32 v111, 0
    s_waitcnt vmcnt(0) lgkmcnt(0)
    v_mfma_f32_16x16x32_bf16 v[56:59], v[56:59], v[32:35], 0
    v_mfma_f32_16x16x32_bf16 v[56:59], v[60:63], v[36:39], v[56:59]
    v_mfma_f32_16x16x32_bf16 v[56:59], v[64:67], v[40:43], v[56:59]
    v_mfma_f32_16x16x32_bf16 v[56:59], v[68:71], v[44:47], v[56:59]
    v_mfma_f32_16x16x32_bf16 v[60:63], v[72:75], v[32:35], 0
    v_mfma_f32_16x16x32_bf16 v[60:63], v[76:79], v[36:39], v[60:63]
    v_mfma_f32_16x16x32_bf16 v[60:63], v[80:83], v[40:43], v[60:63]
    v_mfma_f32_16x16x32_bf16 v[60:63], v[84:87], v[44:47], v[60:63]
    v_mfma_f32_16x16x32_bf16 v[64:67], v[32:35], v[32:35], 0
    v_mfma_f32_16x16x32_bf16 v[64:67], v[36:39], v[36:39], v[64:67]
    v_mfma_f32_16x16x32_bf16 v[64:67], v[40:43], v[40:43], v[64:67]
    v_mfma_f32_16x16x32_bf16 v[64:67], v[44:47], v[44:47], v[64:67]
    v_max3_f32 v84, v56, v57, v58
    v_max3_f32 v84, v84, v59, v60
    v_max3_f32 v84, v84, v61, v62
    s_nop 4
    v_max3_f32 v84, v84, v63, v64
    v_max_f32 v84, v84, v65
    v_mov_b32 v85, v84
    s_nop 1
    v_permlane32_swap_b32 v85, v84
    v_max_f32 v84, v85, v84
    v_mov_b32 v85, v84
    s_nop 1
    v_permlane16_swap_b32 v85, v84
    v_max_f32 v84, v85, v84
    v_sub_f32 v56, v56, v84
    v_sub_f32 v57, v57, v84
    v_sub_f32 v58, v58, v84
    v_sub_f32 v59, v59, v84
    v_sub_f32 v60, v60, v84
    v_sub_f32 v61, v61, v84
    v_sub_f32 v62, v62, v84
    v_sub_f32 v63, v63, v84
    v_sub_f32 v64, v64, v84
    v_sub_f32 v65, v65, v84
    v_exp_f32 v56, v56
    v_exp_f32 v57, v57
    v_exp_f32 v58, v58
    v_exp_f32 v59, v59
    v_exp_f32 v60, v60
    v_exp_f32 v61, v61
    v_exp_f32 v62, v62
    v_exp_f32 v63, v63
    v_exp_f32 v64, v64
    v_exp_f32 v65, v65
    v_cvt_pk_bf16_f32 v68, v56, v57
    v_cvt_pk_bf16_f32 v69, v58, v59
    v_cvt_pk_bf16_f32 v70, v60, v61
    v_cvt_pk_bf16_f32 v71, v62, v63
    v_cvt_pk_bf16_f32 v52, v64, v65
    s_nop 0
    v_mfma_f32_16x16x32_bf16 v[72:75], v[88:91], v[68:71], 0
    v_mfma_f32_16x16x32_bf16 v[76:79], v[92:95], v[68:71], 0
    v_mfma_f32_16x16x32_bf16 v[80:83], v[48:51], v[68:71], 0
    v_mfma_f32_16x16x16_bf16 v[72:75], v[112:113], v[52:53], v[72:75]
    v_mfma_f32_16x16x16_bf16 v[76:79], v[114:115], v[52:53], v[76:79]
    v_mfma_f32_16x16x16_bf16 v[80:83], v[48:49], v[52:53], v[80:83]
    ds_read_b128 v[32:35], v124 offset:6144
    ds_read_b128 v[36:39], v124 offset:7168
    ds_read_b128 v[40:43], v124 offset:34816
    ds_read_b128 v[44:47], v124 offset:35840
    ds_read_b128 v[56:59], v124 offset:36864
    ds_read_b128 v[64:67], v124 offset:38912
    ds_read_b128 v[68:71], v124 offset:39936
    s_waitcnt lgkmcnt(0)
    s_branch L_norm_20
L_kvw_22:
    s_add_u32 s47, s47, 1
    s_add_u32 s49, s49, 1
    s_cmp_ge_u32 s49, 0x10000
    s_cbranch_scc1 L_kvb_23
    s_sleep 4
    buffer_load_dword v125, v119, s[8:11], s28 offen sc1
    s_waitcnt vmcnt(0)
    v_cmp_eq_u32 vcc, 0, v125
    s_nop 0
    s_and_b64 vcc, vcc, s[58:59]
    s_cbranch_scc1 L_kvw_22
    s_branch L_kvb_23
L_mret_25:
    s_mov_b32 s43, m0
    s_mov_b32 m0, 5120
    buffer_load_dwordx4 v[4:7], v117, s[8:11], s48 offen sc1
    buffer_load_dwordx4 v117, s[8:11], s48 offen sc1 lds
    s_mov_b32 m0, 10240
    s_mov_b32 m0, s43
    s_waitcnt vmcnt(0)
    v_max3_u32 v15, v4, v5, v6
    v_max_u32 v15, v15, v7
    v_cmp_lt_u32 vcc, s56, v15
    s_add_u32 s47, s47, 1
    s_add_u32 s49, s49, 1
    s_cmp_ge_u32 s49, 0x10000
    s_cbranch_scc1 L_mgo_26
    s_cbranch_vccnz L_mret_25
    s_branch L_mgo_26
L_smax_28:
    s_add_u32 s47, s47, 1
    s_mov_b32 s35, 0x7f800000
    s_waitcnt lgkmcnt(0)
    s_sub_u32 s43, s30, 0x40800
    s_add_u32 s40, s43, 4096
    s_nop 7
    buffer_load_dwordx4 v[56:59], v117, s[8:11], s43 offen
    buffer_load_dwordx4 v[60:63], v117, s[8:11], s43 offen offset:1024
    buffer_load_dwordx4 v[64:67], v117, s[8:11], s43 offen offset:2048
    buffer_load_dwordx4 v[68:71], v117, s[8:11], s43 offen offset:3072
    buffer_load_dwordx4 v[72:75], v117, s[8:11], s40 offen
    buffer_load_dwordx4 v[76:79], v117, s[8:11], s40 offen offset:1024
    buffer_load_dwordx4 v[80:83], v117, s[8:11], s40 offen offset:2048
    buffer_load_dwordx4 v[84:87], v117, s[8:11], s40 offen offset:3072
    ds_read_b128 v[32:35], v121 offset:16384
    ds_read_b128 v[36:39], v121 offset:17408
    ds_read_b128 v[40:43], v121 offset:18432
    ds_read_b128 v[44:47], v121 offset:19456
    v_mov_b32 v96, 0
    v_mov_b32 v97, 0
    v_mov_b32 v98, 0
    v_mov_b32 v99, 0
    v_mov_b32 v100, 0
    v_mov_b32 v101, 0
    v_mov_b32 v102, 0
    v_mov_b32 v103, 0
    v_mov_b32 v104, 0
    v_mov_b32 v105, 0
    v_mov_b32 v106, 0
    v_mov_b32 v107, 0
    v_mov_b32 v108, 0
    v_mov_b32 v109, 0
    v_mov_b32 v110, 0
    v_mov_b32 v111, 0
    s_waitcnt vmcnt(0) lgkmcnt(0)
    v_mfma_f32_16x16x32_bf16 v[56:59], v[56:59], v[32:35], 0
    v_mfma_f32_16x16x32_bf16 v[56:59], v[60:63], v[36:39], v[56:59]
    v_mfma_f32_16x16x32_bf16 v[56:59], v[64:67], v[40:43], v[56:59]
    v_mfma_f32_16x16x32_bf16 v[56:59], v[68:71], v[44:47], v[56:59]
    v_mfma_f32_16x16x32_bf16 v[60:63], v[72:75], v[32:35], 0
    v_mfma_f32_16x16x32_bf16 v[60:63], v[76:79], v[36:39], v[60:63]
    v_mfma_f32_16x16x32_bf16 v[60:63], v[80:83], v[40:43], v[60:63]
    v_mfma_f32_16x16x32_bf16 v[60:63], v[84:87], v[44:47], v[60:63]
    v_mfma_f32_16x16x32_bf16 v[64:67], v[32:35], v[32:35], 0
    v_mfma_f32_16x16x32_bf16 v[64:67], v[36:39], v[36:39], v[64:67]
    v_mfma_f32_16x16x32_bf16 v[64:67], v[40:43], v[40:43], v[64:67]
    v_mfma_f32_16x16x32_bf16 v[64:67], v[44:47], v[44:47], v[64:67]
    v_max3_f32 v84, v56, v57, v58
    v_max3_f32 v84, v84, v59, v60
    v_max3_f32 v84, v84, v61, v62
    s_nop 4
    v_max3_f32 v84, v84, v63, v64
    v_max_f32 v84, v84, v65
    v_mov_b32 v85, v84
    s_nop 1
    v_permlane32_swap_b32 v85, v84
    v_max_f32 v84, v85, v84
    v_mov_b32 v85, v84
    s_nop 1
    v_permlane16_swap_b32 v85, v84
    v_max_f32 v84, v85, v84
    v_sub_f32 v56, v56, v84
    v_sub_f32 v57, v57, v84
    v_sub_f32 v58, v58, v84
    v_sub_f32 v59, v59, v84
    v_sub_f32 v60, v60, v84
    v_sub_f32 v61, v61, v84
    v_sub_f32 v62, v62, v84
    v_sub_f32 v63, v63, v84
    v_sub_f32 v64, v64, v84
    v_sub_f32 v65, v65, v84
    v_exp_f32 v56, v56
    v_exp_f32 v57, v57
    v_exp_f32 v58, v58
    v_exp_f32 v59, v59
    v_exp_f32 v60, v60
    v_exp_f32 v61, v61
    v_exp_f32 v62, v62
    v_exp_f32 v63, v63
    v_exp_f32 v64, v64
    v_exp_f32 v65, v65
    v_cvt_pk_bf16_f32 v68, v56, v57
    v_cvt_pk_bf16_f32 v69, v58, v59
    v_cvt_pk_bf16_f32 v70, v60, v61
    v_cvt_pk_bf16_f32 v71, v62, v63
    v_cvt_pk_bf16_f32 v52, v64, v65
    s_nop 0
    v_mfma_f32_16x16x32_bf16 v[72:75], v[88:91], v[68:71], 0
    v_mfma_f32_16x16x32_bf16 v[76:79], v[92:95], v[68:71], 0
    v_mfma_f32_16x16x32_bf16 v[80:83], v[48:51], v[68:71], 0
    v_mfma_f32_16x16x16_bf16 v[72:75], v[112:113], v[52:53], v[72:75]
    v_mfma_f32_16x16x16_bf16 v[76:79], v[114:115], v[52:53], v[76:79]
    v_mfma_f32_16x16x16_bf16 v[80:83], v[48:49], v[52:53], v[80:83]
    ds_read_b128 v[32:35], v124 offset:6144
    ds_read_b128 v[36:39], v124 offset:7168
    ds_read_b128 v[40:43], v124 offset:34816
    ds_read_b128 v[44:47], v124 offset:35840
    ds_read_b128 v[56:59], v124 offset:36864
    ds_read_b128 v[64:67], v124 offset:38912
    ds_read_b128 v[68:71], v124 offset:39936
    s_waitcnt lgkmcnt(0)
    s_branch L_norm_27
L_kvw_29:
    s_add_u32 s47, s47, 1
    s_add_u32 s49, s49, 1
    s_cmp_ge_u32 s49, 0x10000
    s_cbranch_scc1 L_kvb_30
    s_sleep 4
    buffer_load_dword v125, v119, s[8:11], s28 offen sc1
    s_waitcnt vmcnt(0)
    v_cmp_eq_u32 vcc, 0, v125
    s_nop 0
    s_and_b64 vcc, vcc, s[58:59]
    s_cbranch_scc1 L_kvw_29
    s_branch L_kvb_30
L_mret_32:
    s_mov_b32 s43, m0
    s_mov_b32 m0, 6144
    buffer_load_dwordx4 v[4:7], v117, s[8:11], s48 offen sc1
    buffer_load_dwordx4 v117, s[8:11], s48 offen sc1 lds
    s_mov_b32 m0, 12288
    s_mov_b32 m0, s43
    s_waitcnt vmcnt(0)
    v_max3_u32 v15, v4, v5, v6
    v_max_u32 v15, v15, v7
    v_cmp_lt_u32 vcc, s56, v15
    s_add_u32 s47, s47, 1
    s_add_u32 s49, s49, 1
    s_cmp_ge_u32 s49, 0x10000
    s_cbranch_scc1 L_mgo_33
    s_cbranch_vccnz L_mret_32
    s_branch L_mgo_33
L_smax_35:
    s_add_u32 s47, s47, 1
    s_mov_b32 s35, 0x7f800000
    s_waitcnt lgkmcnt(0)
    s_sub_u32 s43, s30, 0x41000
    s_add_u32 s40, s43, 4096
    s_nop 7
    buffer_load_dwordx4 v[56:59], v117, s[8:11], s43 offen
    buffer_load_dwordx4 v[60:63], v117, s[8:11], s43 offen offset:1024
    buffer_load_dwordx4 v[64:67], v117, s[8:11], s43 offen offset:2048
    buffer_load_dwordx4 v[68:71], v117, s[8:11], s43 offen offset:3072
    buffer_load_dwordx4 v[72:75], v117, s[8:11], s40 offen
    buffer_load_dwordx4 v[76:79], v117, s[8:11], s40 offen offset:1024
    buffer_load_dwordx4 v[80:83], v117, s[8:11], s40 offen offset:2048
    buffer_load_dwordx4 v[84:87], v117, s[8:11], s40 offen offset:3072
    ds_read_b128 v[32:35], v121 offset:16384
    ds_read_b128 v[36:39], v121 offset:17408
    ds_read_b128 v[40:43], v121 offset:18432
    ds_read_b128 v[44:47], v121 offset:19456
    v_mov_b32 v96, 0
    v_mov_b32 v97, 0
    v_mov_b32 v98, 0
    v_mov_b32 v99, 0
    v_mov_b32 v100, 0
    v_mov_b32 v101, 0
    v_mov_b32 v102, 0
    v_mov_b32 v103, 0
    v_mov_b32 v104, 0
    v_mov_b32 v105, 0
    v_mov_b32 v106, 0
    v_mov_b32 v107, 0
    v_mov_b32 v108, 0
    v_mov_b32 v109, 0
    v_mov_b32 v110, 0
    v_mov_b32 v111, 0
    s_waitcnt vmcnt(0) lgkmcnt(0)
    v_mfma_f32_16x16x32_bf16 v[56:59], v[56:59], v[32:35], 0
    v_mfma_f32_16x16x32_bf16 v[56:59], v[60:63], v[36:39], v[56:59]
    v_mfma_f32_16x16x32_bf16 v[56:59], v[64:67], v[40:43], v[56:59]
    v_mfma_f32_16x16x32_bf16 v[56:59], v[68:71], v[44:47], v[56:59]
    v_mfma_f32_16x16x32_bf16 v[60:63], v[72:75], v[32:35], 0
    v_mfma_f32_16x16x32_bf16 v[60:63], v[76:79], v[36:39], v[60:63]
    v_mfma_f32_16x16x32_bf16 v[60:63], v[80:83], v[40:43], v[60:63]
    v_mfma_f32_16x16x32_bf16 v[60:63], v[84:87], v[44:47], v[60:63]
    v_mfma_f32_16x16x32_bf16 v[64:67], v[32:35], v[32:35], 0
    v_mfma_f32_16x16x32_bf16 v[64:67], v[36:39], v[36:39], v[64:67]
    v_mfma_f32_16x16x32_bf16 v[64:67], v[40:43], v[40:43], v[64:67]
    v_mfma_f32_16x16x32_bf16 v[64:67], v[44:47], v[44:47], v[64:67]
    v_max3_f32 v84, v56, v57, v58
    v_max3_f32 v84, v84, v59, v60
    v_max3_f32 v84, v84, v61, v62
    s_nop 4
    v_max3_f32 v84, v84, v63, v64
    v_max_f32 v84, v84, v65
    v_mov_b32 v85, v84
    s_nop 1
    v_permlane32_swap_b32 v85, v84
    v_max_f32 v84, v85, v84
    v_mov_b32 v85, v84
    s_nop 1
    v_permlane16_swap_b32 v85, v84
    v_max_f32 v84, v85, v84
    v_sub_f32 v56, v56, v84
    v_sub_f32 v57, v57, v84
    v_sub_f32 v58, v58, v84
    v_sub_f32 v59, v59, v84
    v_sub_f32 v60, v60, v84
    v_sub_f32 v61, v61, v84
    v_sub_f32 v62, v62, v84
    v_sub_f32 v63, v63, v84
    v_sub_f32 v64, v64, v84
    v_sub_f32 v65, v65, v84
    v_exp_f32 v56, v56
    v_exp_f32 v57, v57
    v_exp_f32 v58, v58
    v_exp_f32 v59, v59
    v_exp_f32 v60, v60
    v_exp_f32 v61, v61
    v_exp_f32 v62, v62
    v_exp_f32 v63, v63
    v_exp_f32 v64, v64
    v_exp_f32 v65, v65
    v_cvt_pk_bf16_f32 v68, v56, v57
    v_cvt_pk_bf16_f32 v69, v58, v59
    v_cvt_pk_bf16_f32 v70, v60, v61
    v_cvt_pk_bf16_f32 v71, v62, v63
    v_cvt_pk_bf16_f32 v52, v64, v65
    s_nop 0
    v_mfma_f32_16x16x32_bf16 v[72:75], v[88:91], v[68:71], 0
    v_mfma_f32_16x16x32_bf16 v[76:79], v[92:95], v[68:71], 0
    v_mfma_f32_16x16x32_bf16 v[80:83], v[48:51], v[68:71], 0
    v_mfma_f32_16x16x16_bf16 v[72:75], v[112:113], v[52:53], v[72:75]
    v_mfma_f32_16x16x16_bf16 v[76:79], v[114:115], v[52:53], v[76:79]
    v_mfma_f32_16x16x16_bf16 v[80:83], v[48:49], v[52:53], v[80:83]
    ds_read_b128 v[32:35], v124 offset:6144
    ds_read_b128 v[36:39], v124 offset:7168
    ds_read_b128 v[40:43], v124 offset:34816
    ds_read_b128 v[44:47], v124 offset:35840
    ds_read_b128 v[56:59], v124 offset:36864
    ds_read_b128 v[64:67], v124 offset:38912
    ds_read_b128 v[68:71], v124 offset:39936
    s_waitcnt lgkmcnt(0)
    s_branch L_norm_34
L_rslow_37:
    buffer_load_dwordx4 v[4:7], v117, s[8:11], s29 offen sc1
    buffer_load_dwordx4 v[8:11], v117, s[8:11], s53 offen sc1
    buffer_load_dwordx4 v[16:19], v117, s[8:11], s29 offen offset:2048 sc1
    buffer_load_dwordx4 v[20:23], v117, s[8:11], s53 offen offset:2048 sc1
    s_add_u32 s46, s46, 1
    s_add_u32 s49, s49, 1
    s_cmp_ge_u32 s49, 0x10000
    s_cbranch_scc1 L_rgo_38
    s_waitcnt vmcnt(7)
    v_mfma_f32_16x16x32_bf16 v[48:51], v[32:35], v[12:15], 0
    v_xor_b32 v52, s33, v32
    s_waitcnt vmcnt(6)
    v_mfma_f32_16x16x32_bf16 v[48:51], v[36:39], v[12:15], v[48:51]
    v_xor_b32 v53, s33, v36
    v_or_b32 v52, v52, v53
    s_waitcnt vmcnt(5)
    v_mfma_f32_16x16x32_bf16 v[48:51], v[40:43], v[12:15], v[48:51]
    v_xor_b32 v53, s33, v40
    v_or_b32 v52, v52, v53
    s_waitcnt vmcnt(4)
    v_mfma_f32_16x16x32_bf16 v[48:51], v[44:47], v[12:15], v[48:51]
    v_xor_b32 v53, s33, v44
    v_or_b32 v52, v52, v53
    v_and_b32 v52, 1, v52
    v_cmp_ne_u32 vcc, 0, v52
    s_cbranch_vccz L_rgo_38
    buffer_load_dwordx4 v[32:35], v117, s[8:11], s29 offen sc1
    buffer_load_dwordx4 v[36:39], v117, s[8:11], s53 offen sc1
    buffer_load_dwordx4 v[40:43], v117, s[8:11], s29 offen offset:2048 sc1
    buffer_load_dwordx4 v[44:47], v117, s[8:11], s53 offen offset:2048 sc1
    s_add_u32 s46, s46, 1
    s_branch L_rl_36
L_mret_40:
    s_mov_b32 s43, m0
    s_mov_b32 m0, 7168
    buffer_load_dwordx4 v[4:7], v117, s[8:11], s48 offen sc1
    buffer_load_dwordx4 v117, s[8:11], s48 offen sc1 lds
    s_mov_b32 m0, 14336
    s_mov_b32 m0, s43
    s_waitcnt vmcnt(0)
    v_max3_u32 v15, v4, v5, v6
    v_max_u32 v15, v15, v7
    v_cmp_lt_u32 vcc, s56, v15
    s_add_u32 s47, s47, 1
    s_add_u32 s49, s49, 1
    s_cmp_ge_u32 s49, 0x10000
    s_cbranch_scc1 L_mgo_41
    s_cbranch_vccnz L_mret_40
    s_branch L_mgo_41
L_smax_43:
    s_add_u32 s47, s47, 1
    s_mov_b32 s35, 0x7f800000
    s_waitcnt lgkmcnt(0)
    s_sub_u32 s43, s30, 0x41800
    s_add_u32 s40, s43, 4096
    s_nop 7
    buffer_load_dwordx4 v[56:59], v117, s[8:11], s43 offen
    buffer_load_dwordx4 v[60:63], v117, s[8:11], s43 offen offset:1024
    buffer_load_dwordx4 v[64:67], v117, s[8:11], s43 offen offset:2048
    buffer_load_dwordx4 v[68:71], v117, s[8:11], s43 offen offset:3072
    buffer_load_dwordx4 v[72:75], v117, s[8:11], s40 offen
    buffer_load_dwordx4 v[76:79], v117, s[8:11], s40 offen offset:1024
    buffer_load_dwordx4 v[80:83], v117, s[8:11], s40 offen offset:2048
    buffer_load_dwordx4 v[84:87], v117, s[8:11], s40 offen offset:3072
    ds_read_b128 v[32:35], v121 offset:16384
    ds_read_b128 v[36:39], v121 offset:17408
    ds_read_b128 v[40:43], v121 offset:18432
    ds_read_b128 v[44:47], v121 offset:19456
    v_mov_b32 v96, 0
    v_mov_b32 v97, 0
    v_mov_b32 v98, 0
    v_mov_b32 v99, 0
    v_mov_b32 v100, 0
    v_mov_b32 v101, 0
    v_mov_b32 v102, 0
    v_mov_b32 v103, 0
    v_mov_b32 v104, 0
    v_mov_b32 v105, 0
    v_mov_b32 v106, 0
    v_mov_b32 v107, 0
    v_mov_b32 v108, 0
    v_mov_b32 v109, 0
    v_mov_b32 v110, 0
    v_mov_b32 v111, 0
    s_waitcnt vmcnt(0) lgkmcnt(0)
    v_mfma_f32_16x16x32_bf16 v[56:59], v[56:59], v[32:35], 0
    v_mfma_f32_16x16x32_bf16 v[56:59], v[60:63], v[36:39], v[56:59]
    v_mfma_f32_16x16x32_bf16 v[56:59], v[64:67], v[40:43], v[56:59]
    v_mfma_f32_16x16x32_bf16 v[56:59], v[68:71], v[44:47], v[56:59]
    v_mfma_f32_16x16x32_bf16 v[60:63], v[72:75], v[32:35], 0
    v_mfma_f32_16x16x32_bf16 v[60:63], v[76:79], v[36:39], v[60:63]
    v_mfma_f32_16x16x32_bf16 v[60:63], v[80:83], v[40:43], v[60:63]
    v_mfma_f32_16x16x32_bf16 v[60:63], v[84:87], v[44:47], v[60:63]
    v_mfma_f32_16x16x32_bf16 v[64:67], v[32:35], v[32:35], 0
    v_mfma_f32_16x16x32_bf16 v[64:67], v[36:39], v[36:39], v[64:67]
    v_mfma_f32_16x16x32_bf16 v[64:67], v[40:43], v[40:43], v[64:67]
    v_mfma_f32_16x16x32_bf16 v[64:67], v[44:47], v[44:47], v[64:67]
    v_max3_f32 v84, v56, v57, v58
    v_max3_f32 v84, v84, v59, v60
    v_max3_f32 v84, v84, v61, v62
    s_nop 4
    v_max3_f32 v84, v84, v63, v64
    v_max_f32 v84, v84, v65
    v_mov_b32 v85, v84
    s_nop 1
    v_permlane32_swap_b32 v85, v84
    v_max_f32 v84, v85, v84
    v_mov_b32 v85, v84
    s_nop 1
    v_permlane16_swap_b32 v85, v84
    v_max_f32 v84, v85, v84
    v_sub_f32 v56, v56, v84
    v_sub_f32 v57, v57, v84
    v_sub_f32 v58, v58, v84
    v_sub_f32 v59, v59, v84
    v_sub_f32 v60, v60, v84
    v_sub_f32 v61, v61, v84
    v_sub_f32 v62, v62, v84
    v_sub_f32 v63, v63, v84
    v_sub_f32 v64, v64, v84
    v_sub_f32 v65, v65, v84
    v_exp_f32 v56, v56
    v_exp_f32 v57, v57
    v_exp_f32 v58, v58
    v_exp_f32 v59, v59
    v_exp_f32 v60, v60
    v_exp_f32 v61, v61
    v_exp_f32 v62, v62
    v_exp_f32 v63, v63
    v_exp_f32 v64, v64
    v_exp_f32 v65, v65
    v_cvt_pk_bf16_f32 v68, v56, v57
    v_cvt_pk_bf16_f32 v69, v58, v59
    v_cvt_pk_bf16_f32 v70, v60, v61
    v_cvt_pk_bf16_f32 v71, v62, v63
    v_cvt_pk_bf16_f32 v52, v64, v65
    s_nop 0
    v_mfma_f32_16x16x32_bf16 v[72:75], v[88:91], v[68:71], 0
    v_mfma_f32_16x16x32_bf16 v[76:79], v[92:95], v[68:71], 0
    v_mfma_f32_16x16x32_bf16 v[80:83], v[48:51], v[68:71], 0
    v_mfma_f32_16x16x16_bf16 v[72:75], v[112:113], v[52:53], v[72:75]
    v_mfma_f32_16x16x16_bf16 v[76:79], v[114:115], v[52:53], v[76:79]
    v_mfma_f32_16x16x16_bf16 v[80:83], v[48:49], v[52:53], v[80:83]
    ds_read_b128 v[32:35], v124 offset:6144
    ds_read_b128 v[36:39], v124 offset:7168
    ds_read_b128 v[40:43], v124 offset:34816
    ds_read_b128 v[44:47], v124 offset:35840
    ds_read_b128 v[56:59], v124 offset:36864
    ds_read_b128 v[64:67], v124 offset:38912
    ds_read_b128 v[68:71], v124 offset:39936
    s_waitcnt lgkmcnt(0)
    s_branch L_norm_42
L_rslow_45:
    buffer_load_dwordx4 v[4:7], v117, s[8:11], s29 offen sc1
    buffer_load_dwordx4 v[8:11], v117, s[8:11], s53 offen sc1
    buffer_load_dwordx4 v[16:19], v117, s[8:11], s29 offen offset:2048 sc1
    buffer_load_dwordx4 v[20:23], v117, s[8:11], s53 offen offset:2048 sc1
    s_add_u32 s46, s46, 1
    s_add_u32 s49, s49, 1
    s_cmp_ge_u32 s49, 0x10000
    s_cbranch_scc1 L_rgo_46
    s_waitcnt vmcnt(7)
    v_mfma_f32_16x16x32_bf16 v[48:51], v[32:35], v[12:15], 0
    v_xor_b32 v52, s33, v32
    s_waitcnt vmcnt(6)
    v_mfma_f32_16x16x32_bf16 v[48:51], v[36:39], v[12:15], v[48:51]
    v_xor_b32 v53, s33, v36
    v_or_b32 v52, v52, v53
    s_waitcnt vmcnt(5)
    v_mfma_f32_16x16x32_bf16 v[48:51], v[40:43], v[12:15], v[48:51]
    v_xor_b32 v53, s33, v40
    v_or_b32 v52, v52, v53
    s_waitcnt vmcnt(4)
    v_mfma_f32_16x16x32_bf16 v[48:51], v[44:47], v[12:15], v[48:51]
    v_xor_b32 v53, s33, v44
    v_or_b32 v52, v52, v53
    v_and_b32 v52, 1, v52
    v_cmp_ne_u32 vcc, 0, v52
    s_cbranch_vccz L_rgo_46
    buffer_load_dwordx4 v[32:35], v117, s[8:11], s29 offen sc1
    buffer_load_dwordx4 v[36:39], v117, s[8:11], s53 offen sc1
    buffer_load_dwordx4 v[40:43], v117, s[8:11], s29 offen offset:2048 sc1
    buffer_load_dwordx4 v[44:47], v117, s[8:11], s53 offen offset:2048 sc1
    s_add_u32 s46, s46, 1
    s_branch L_rl_44
L_zero:
    s_waitcnt lgkmcnt(0)
    s_and_b32 s9, s9, 0xffff
    s_mov_b32 s10, 0x10000000
    s_mov_b32 s11, 0x20000
    s_and_b32 s93, s93, 0xffff
    s_mov_b32 s94, 0x100
    s_mov_b32 s95, 0x20000
    s_mov_b32 s87, 0
    s_cmp_lg_u32 s86, 0
    s_cbranch_scc1 L_reg_47
    s_lshl_b32 s97, s84, 4
    s_lshl_b32 s96, 1, s85
    v_mov_b32 v250, s96
    v_mov_b32 v251, 256
    s_mov_b64 exec, 1
    buffer_atomic_add_x2 v[250:251], off, s[92:95], s97 offset:64
    s_mov_b64 exec, -1
    s_mov_b32 s86, 1
L_reg_47:
    v_mov_b32 v4, 0
    v_mov_b32 v5, 0
    v_mov_b32 v6, 0
    v_mov_b32 v7, 0
    v_lshlrev_b32 v1, 4, v0
    s_mov_b32 s97, 0x0
    buffer_store_dwordx4 v[4:7], v1, s[8:11], s97 offen sc1
    s_mov_b32 s97, 0x1000
    buffer_store_dwordx4 v[4:7], v1, s[8:11], s97 offen sc1
    s_mov_b32 s97, 0x2000
    buffer_store_dwordx4 v[4:7], v1, s[8:11], s97 offen sc1
    s_mov_b32 s97, 0x3000
    buffer_store_dwordx4 v[4:7], v1, s[8:11], s97 offen sc1
    s_mov_b32 s97, 0x4000
    buffer_store_dwordx4 v[4:7], v1, s[8:11], s97 offen sc1
    s_mov_b32 s97, 0x5000
    buffer_store_dwordx4 v[4:7], v1, s[8:11], s97 offen sc1
    s_mov_b32 s97, 0x6000
    buffer_store_dwordx4 v[4:7], v1, s[8:11], s97 offen sc1
    s_mov_b32 s97, 0x7000
    buffer_store_dwordx4 v[4:7], v1, s[8:11], s97 offen sc1
    s_mov_b32 s97, 0x8000
    buffer_store_dwordx4 v[4:7], v1, s[8:11], s97 offen sc1
    s_waitcnt vmcnt(0)
    s_barrier
    s_cmp_lg_u32 s100, 0
    s_cbranch_scc1 L_flag_48
    v_mov_b32 v2, 1
    s_mov_b64 exec, 1
    buffer_store_dword v2, off, s[92:95], 40 sc1
    s_mov_b64 exec, -1
L_flag_48:
    s_cmp_lg_u32 s100, 0
    s_cbranch_scc1 L_noz
    s_mov_b64 exec, 0xff
    s_mov_b32 s96, 0
L_count:
    buffer_load_dwordx2 v[2:3], v1, s[92:95], 0 offen offset:64 sc1
    s_waitcnt vmcnt(0)
    v_cmp_le_u32 vcc, 8192, v3
    v_add_u32 v2, 1, v2
    v_xor_b32 v3, 8192, v3
    v_or_b32 v2, v2, v3
    s_mov_b32 s4, vcc_lo
    v_cmp_eq_u32 vcc, 0, v2
    v_mov_b32 v2, 1
    s_nop 1
    s_cmp_eq_u32 vcc_lo, 0xff
    s_cbranch_scc1 L_propose
    v_mov_b32 v2, 2
    s_andn2_b32 s4, s4, vcc_lo
    s_cbranch_scc1 L_propose
    s_sleep 2
    s_add_u32 s96, s96, 1
    s_cmp_lt_u32 s96, 0x100
    s_cbranch_scc1 L_count
L_propose:
    v_mov_b32 v3, 0
    s_mov_b64 exec, 1
    buffer_atomic_cmpswap v[2:3], off, s[92:95], 0 offset:36
    s_mov_b64 exec, -1
    s_branch L_noz
L_fallback:
    s_mov_b32 s87, 2
    s_waitcnt vmcnt(0) lgkmcnt(0)
    s_barrier
    v_mbcnt_lo_u32_b32 v0, -1, 0
    v_mbcnt_hi_u32_b32 v0, -1, v0
    s_lshl_b32 s96, s100, 6
    v_add_u32 v0, s96, v0
    s_mov_b32 s97, 44
    s_cmp_lg_u32 s100, 0
    s_cbranch_scc1 L_at_49
    s_mov_b64 exec, 1
    v_mov_b32 v2, 1
    buffer_atomic_add v2, off, s[92:95], s97 sc0
    s_mov_b64 exec, -1
L_at_49:
    s_cmp_lg_u32 s100, 0
    s_cbranch_scc1 L_at2_50
    s_mov_b64 exec, 1
    v_mov_b32 v1, 8
    s_waitcnt vmcnt(0)
    ds_write_b32 v1, v2
    s_waitcnt lgkmcnt(0)
    s_mov_b64 exec, -1
L_at2_50:
    s_barrier
    v_mov_b32 v1, 8
    ds_read_b32 v2, v1
    s_waitcnt lgkmcnt(0)
    v_readfirstlane_b32 s85, v2
    s_barrier
    s_sub_u32 s101, s85, 32
    s_cmp_ge_u32 s85, 32
    s_cbranch_scc1 L_bulk
    s_mov_b32 s20, s85
    v_lshrrev_b32 v4, 6, v0
    s_nop 0
    v_readfirstlane_b32 s21, v4
    v_and_b32 v1, 63, v0
    v_lshrrev_b32 v2, 4, v1
    v_and_b32 v3, 15, v1
    v_lshrrev_b32 v6, 2, v3
    v_lshlrev_b32 v117, 4, v1
    s_lshl_b32 s51, s21, 10
    s_lshl_b32 s52, s21, 11
    s_load_dwordx8 s[60:67], s[0:1], 16
    s_mov_b32 s14, 0x400000
    s_mov_b32 s15, 0x20000
    s_lshl_b32 s41, s20, 8
    s_lshl_b32 s42, s20, 17
    s_lshr_b32 s43, s21, 1
    s_lshl_b32 s43, s43, 2
    v_or_b32 v5, s43, v2
    v_lshlrev_b32 v5, 1, v5
    v_xor_b32 v5, v5, v3
    v_lshrrev_b32 v14, 2, v5
    v_and_b32 v14, 2, v14
    v_lshlrev_b32 v5, 4, v5
    s_lshl_b32 s43, s21, 4
    v_add_u32 v4, s43, v2
    v_lshl_add_u32 v8, v4, 13, v5
    s_waitcnt lgkmcnt(0)
    s_mov_b32 s16, s92
    s_mov_b32 s17, s93
    s_mov_b32 s18, s94
    s_mov_b32 s19, s95
    s_mov_b32 s88, s20
    s_mov_b32 s12, s60
    s_and_b32 s13, s61, 0xffff
    v_xor_b32 v15, 0, v14
    v_lshl_add_u32 v15, v15, 15, v8
    s_add_u32 s43, s41, 0x0
    s_add_u32 m0, s51, 0x8000
    s_nop 0
    buffer_load_dwordx4 v15, s[12:15], s43 offen lds
    s_add_u32 s43, s41, 0x8000
    s_add_u32 m0, s51, 0x9000
    s_nop 0
    buffer_load_dwordx4 v15, s[12:15], s43 offen lds
    s_add_u32 s43, s41, 0x100000
    s_add_u32 m0, s51, 0xa000
    s_nop 0
    buffer_load_dwordx4 v15, s[12:15], s43 offen lds
    s_add_u32 s43, s41, 0x108000
    s_add_u32 m0, s51, 0xb000
    s_nop 0
    buffer_load_dwordx4 v15, s[12:15], s43 offen lds
    s_add_u32 s43, s41, 0x200000
    s_add_u32 m0, s51, 0xc000
    s_nop 0
    buffer_load_dwordx4 v15, s[12:15], s43 offen lds
    s_add_u32 s43, s41, 0x208000
    s_add_u32 m0, s51, 0xd000
    s_nop 0
    buffer_load_dwordx4 v15, s[12:15], s43 offen lds
    s_add_u32 s43, s41, 0x300000
    s_add_u32 m0, s51, 0xe000
    s_nop 0
    buffer_load_dwordx4 v15, s[12:15], s43 offen lds
    s_add_u32 s43, s41, 0x308000
    s_add_u32 m0, s51, 0xf000
    s_nop 0
    buffer_load_dwordx4 v15, s[12:15], s43 offen lds
    v_xor_b32 v15, 2, v14
    v_lshl_add_u32 v15, v15, 15, v8
    s_add_u32 s43, s41, 0x0
    s_add_u32 m0, s51, 0x10000
    s_nop 0
    buffer_load_dwordx4 v15, s[12:15], s43 offen lds
    s_add_u32 s43, s41, 0x8000
    s_add_u32 m0, s51, 0x11000
    s_nop 0
    buffer_load_dwordx4 v15, s[12:15], s43 offen lds
    s_add_u32 s43, s41, 0x100000
    s_add_u32 m0, s51, 0x12000
    s_nop 0
    buffer_load_dwordx4 v15, s[12:15], s43 offen lds
    s_add_u32 s43, s41, 0x108000
    s_add_u32 m0, s51, 0x13000
    s_nop 0
    buffer_load_dwordx4 v15, s[12:15], s43 offen lds
    s_add_u32 s43, s41, 0x200000
    s_add_u32 m0, s51, 0x14000
    s_nop 0
    buffer_load_dwordx4 v15, s[12:15], s43 offen lds
    s_add_u32 s43, s41, 0x208000
    s_add_u32 m0, s51, 0x15000
    s_nop 0
    buffer_load_dwordx4 v15, s[12:15], s43 offen lds
    s_add_u32 s43, s41, 0x300000
    s_add_u32 m0, s51, 0x16000
    s_nop 0
    buffer_load_dwordx4 v15, s[12:15], s43 offen lds
    s_add_u32 s43, s41, 0x308000
    s_add_u32 m0, s51, 0x17000
    s_nop 0
    buffer_load_dwordx4 v15, s[12:15], s43 offen lds
    v_xor_b32 v15, 0, v14
    v_lshl_add_u32 v15, v15, 15, v8
    s_add_u32 s43, s41, 0x80000
    s_add_u32 m0, s51, 0x18000
    s_nop 0
    buffer_load_dwordx4 v15, s[12:15], s43 offen lds
    s_add_u32 s43, s41, 0x88000
    s_add_u32 m0, s51, 0x19000
    s_nop 0
    buffer_load_dwordx4 v15, s[12:15], s43 offen lds
    s_add_u32 s43, s41, 0x180000
    s_add_u32 m0, s51, 0x1a000
    s_nop 0
    buffer_load_dwordx4 v15, s[12:15], s43 offen lds
    s_add_u32 s43, s41, 0x188000
    s_add_u32 m0, s51, 0x1b000
    s_nop 0
    buffer_load_dwordx4 v15, s[12:15], s43 offen lds
    v_and_b32 v4, 2, v3
    v_cmp_ne_u32 vcc, 0, v4
    v_mov_b32 v4, 0x4444
    v_mov_b32 v5, 0xeeee
    v_cndmask_b32 v116, v4, v5, vcc
    v_lshrrev_b32 v5, 1, v2
    v_lshl_add_u32 v4, v6, 3, v5
    s_lshl_b32 s43, s21, 1
    v_add_u32 v4, s43, v4
    v_add_u32 v5, s20, v4
    v_and_b32 v5, 31, v5
    v_lshl_add_u32 v4, v4, 6, v5
    v_and_b32 v5, 1, v2
    v_lshl_add_u32 v4, v4, 1, v5
    v_and_b32 v5, 3, v3
    v_lshl_add_u32 v4, v4, 2, v5
    v_lshlrev_b32 v118, 4, v4
    v_and_b32 v4, 1, v2
    v_lshlrev_b32 v4, 2, v4
    v_and_b32 v7, 2, v2
    v_add_u32 v4, v4, v7
    v_and_b32 v7, 1, v6
    v_add_u32 v4, v4, v7
    v_lshl_add_u32 v4, v4, 2, v5
    v_lshlrev_b32 v4, 2, v4
    s_and_b32 s43, s21, 1
    s_lshl_b32 s43, s43, 12
    s_lshl_b32 s40, s20, 7
    s_add_u32 s43, s43, s40
    v_add_u32 v119, s43, v4
    v_sub_u32 v7, 0, v2
    v_and_b32 v7, 3, v7
    v_xor_b32 v7, v7, v6
    v_lshl_add_u32 v4, v2, 4, v7
    v_and_b32 v5, 3, v3
    v_lshl_add_u32 v4, v4, 2, v5
    s_add_u32 s43, s51, 16384
    v_lshl_add_u32 v120, v4, 2, s43
    v_sub_u32 v7, 0, v6
    v_and_b32 v7, 3, v7
    v_xor_b32 v7, v7, v2
    v_lshl_add_u32 v4, v3, 2, v7
    v_lshlrev_b32 v121, 4, v4
    v_and_b32 v5, 1, v3
    v_lshl_add_u32 v4, v6, 1, v5
    v_lshl_add_u32 v4, v2, 3, v4
    v_lshlrev_b32 v127, 4, v4
    v_and_or_b32 v122, v116, 8, v127
    s_lshl_b32 s43, s21, 13
    s_add_u32 s43, s43, 32768
    v_add_u32 v123, s43, v117
    v_add_u32 v124, 0x10000, v123
    s_mov_b32 s36, 0xcccccccc
    s_mov_b32 s37, 0xcccccccc
    s_mov_b32 s38, 0x00ff00ff
    s_mov_b32 s39, 0x00ff00ff
    s_mov_b32 s34, 0x3e0293ee
    s_mov_b32 s35, 0x49800000
    s_mov_b32 s50, 0x3f803f80
    v_and_b32 v5, 1, v2
    v_or_b32 v5, 0, v5
    v_xor_b32 v5, v5, v6
    v_and_b32 v7, 2, v5
    v_add_u32 v5, v5, v7
    v_lshlrev_b32 v5, 6, v5
    v_and_b32 v7, 3, v3
    v_lshl_add_u32 v7, v7, 4, v5
    s_lshl_b32 s43, s21, 2
    v_add_u32 v4, s43, v2
    v_lshl_add_u32 v10, v4, 10, v7
    v_and_b32 v5, 1, v2
    v_or_b32 v5, 2, v5
    v_xor_b32 v5, v5, v6
    v_and_b32 v7, 2, v5
    v_add_u32 v5, v5, v7
    v_lshlrev_b32 v5, 6, v5
    v_and_b32 v7, 3, v3
    v_lshl_add_u32 v7, v7, 4, v5
    s_lshl_b32 s43, s21, 2
    v_add_u32 v4, s43, v2
    v_lshl_add_u32 v9, v4, 10, v7
    v_and_b32 v5, 1, v2
    v_lshl_add_u32 v4, v5, 3, v6
    v_lshrrev_b32 v7, 1, v2
    v_lshl_add_u32 v4, v7, 5, v4
    v_lshlrev_b32 v4, 8, v4
    v_lshl_or_b32 v5, v5, 2, v6
    v_lshlrev_b32 v5, 5, v5
    s_lshl_b32 s43, s21, 6
    v_xor_b32 v5, s43, v5
    v_add_u32 v4, v4, v5
    v_and_b32 v5, 3, v3
    v_lshl_add_u32 v4, v5, 3, v4
    v_add_u32 v11, 32768, v4
    s_and_b32 s43, s21, 1
    s_lshl_b32 s43, s43, 12
    v_add_u32 v11, s43, v11
    v_and_b32 v5, 1, v2
    v_lshlrev_b32 v4, 4, v5
    v_lshl_add_u32 v4, v7, 2, v4
    v_and_b32 v7, 1, v6
    v_add_u32 v4, v4, v7
    s_lshl_b32 s43, s21, 5
    v_add_u32 v4, s43, v4
    v_lshlrev_b32 v4, 8, v4
    v_lshl_or_b32 v5, v5, 1, v7
    s_lshl_b32 s43, s21, 1
    s_and_b32 s43, s43, 3
    v_xor_b32 v5, s43, v5
    v_lshl_add_u32 v4, v5, 6, v4
    v_lshrrev_b32 v5, 1, v6
    v_lshl_add_u32 v4, v5, 5, v4
    v_and_b32 v5, 3, v3
    v_lshl_add_u32 v4, v5, 3, v4
    v_add_u32 v12, 32768, v4
    v_mov_b32 v16, -1
    v_mov_b32 v17, -1
    v_mov_b32 v18, -1
    v_mov_b32 v19, -1
    s_lshl_b32 s43, s20, 13
    s_add_u32 s43, s43, 0x7100000
    s_and_b32 s40, s21, 1
    s_lshl_b32 s40, s40, 12
    s_add_u32 s29, s43, s40
    s_add_u32 s43, s43, s52
    s_xor_b32 s40, s43, 0x40000
    buffer_store_dwordx4 v[16:19], v117, s[8:11], s43 offen sc1
    buffer_store_dwordx4 v[16:19], v117, s[8:11], s43 offen offset:1024 sc1
    buffer_store_dwordx4 v[16:19], v117, s[8:11], s40 offen sc1
    buffer_store_dwordx4 v[16:19], v117, s[8:11], s40 offen offset:1024 sc1
    s_mov_b32 s43, 0x7012000
    buffer_store_dword v16, v119, s[8:11], s43 offen sc1
    s_mov_b32 s43, 0x7014000
    buffer_store_dword v16, v119, s[8:11], s43 offen sc1
    s_mov_b32 s43, 0x7016000
    buffer_store_dword v16, v119, s[8:11], s43 offen sc1
    s_load_dwordx2 s[4:5], s[0:1], 8
    s_waitcnt lgkmcnt(0)
    s_and_b32 s5, s5, 0xffff
    s_mov_b32 s6, 8192
    s_mov_b32 s7, 0x20000
    v_and_b32 v20, 1, v2
    v_and_b32 v21, 1, v6
    v_lshl_add_u32 v20, v20, 1, v21
    v_lshlrev_b32 v20, 9, v20
    v_and_b32 v21, 3, v3
    v_lshl_add_u32 v20, v21, 4, v20
    v_and_b32 v21, 2, v2
    v_add_u32 v20, v20, v21
    s_and_b32 s43, s20, 1
    s_lshl_b32 s43, s43, 11
    s_bfe_u32 s40, s20, 0x20001
    s_lshl_b32 s40, s40, 7
    s_add_u32 s43, s43, s40
    s_and_b32 s40, s21, 1
    s_lshl_b32 s40, s40, 6
    s_add_u32 s43, s43, s40
    s_lshr_b32 s40, s20, 3
    s_lshl_b32 s40, s40, 2
    s_add_u32 s43, s43, s40
    v_add_u32 v20, s43, v20
    v_lshlrev_b32 v20, 1, v20
    buffer_load_dword v21, v20, s[4:7], 0 offen
    s_mov_b32 s57, 0
    s_lshl_b32 s43, s20, 13
    s_add_u32 s43, s43, s52
    s_add_u32 s30, s43, 0x1000000
    s_add_u32 s31, s43, 0x2000000
    s_lshr_b32 s43, s43, 1
    s_add_u32 s32, s43, 0x220000
    s_waitcnt vmcnt(20)
    s_barrier
    v_xor_b32 v13, 0x0, v11
    v_add_u32 v13, 0x0, v13
    ds_read_b64_tr_b16 v[80:81], v13
    ds_read_b64_tr_b16 v[82:83], v13 offset:1024
    ds_read_b64_tr_b16 v[84:85], v13 offset:16384
    ds_read_b64_tr_b16 v[86:87], v13 offset:17408
    v_xor_b32 v13, 0x20, v11
    v_add_u32 v13, 0x0, v13
    ds_read_b64_tr_b16 v[56:57], v13
    ds_read_b64_tr_b16 v[58:59], v13 offset:1024
    ds_read_b64_tr_b16 v[60:61], v13 offset:16384
    ds_read_b64_tr_b16 v[62:63], v13 offset:17408
    v_xor_b32 v13, 0x1000, v11
    v_add_u32 v13, 0x0, v13
    ds_read_b64_tr_b16 a[0:1], v13
    ds_read_b64_tr_b16 a[2:3], v13 offset:1024
    ds_read_b64_tr_b16 a[4:5], v13 offset:16384
    ds_read_b64_tr_b16 a[6:7], v13 offset:17408
    v_xor_b32 v13, 0x1020, v11
    v_add_u32 v13, 0x0, v13
    ds_read_b64_tr_b16 a[8:9], v13
    ds_read_b64_tr_b16 a[10:11], v13 offset:1024
    ds_read_b64_tr_b16 a[12:13], v13 offset:16384
    ds_read_b64_tr_b16 a[14:15], v13 offset:17408
    s_waitcnt lgkmcnt(0)
    s_barrier
    s_add_u32 s43, s41, 0x280000
    s_add_u32 m0, s51, 0x1c000
    s_nop 0
    buffer_load_dwordx4 v15, s[12:15], s43 offen lds
    s_add_u32 s43, s41, 0x288000
    s_add_u32 m0, s51, 0x1d000
    s_nop 0
    buffer_load_dwordx4 v15, s[12:15], s43 offen lds
    s_add_u32 s43, s41, 0x380000
    s_add_u32 m0, s51, 0x1e000
    s_nop 0
    buffer_load_dwordx4 v15, s[12:15], s43 offen lds
    s_add_u32 s43, s41, 0x388000
    s_add_u32 m0, s51, 0x1f000
    s_nop 0
    buffer_load_dwordx4 v15, s[12:15], s43 offen lds
    v_xor_b32 v15, 2, v14
    v_lshl_add_u32 v15, v15, 15, v8
    s_add_u32 s43, s41, 0x80000
    s_add_u32 m0, s51, 0x20000
    s_nop 0
    buffer_load_dwordx4 v15, s[12:15], s43 offen lds
    s_add_u32 s43, s41, 0x88000
    s_add_u32 m0, s51, 0x21000
    s_nop 0
    buffer_load_dwordx4 v15, s[12:15], s43 offen lds
    s_add_u32 s43, s41, 0x180000
    s_add_u32 m0, s51, 0x22000
    s_nop 0
    buffer_load_dwordx4 v15, s[12:15], s43 offen lds
    s_add_u32 s43, s41, 0x188000
    s_add_u32 m0, s51, 0x23000
    s_nop 0
    buffer_load_dwordx4 v15, s[12:15], s43 offen lds
    s_waitcnt vmcnt(20)
    s_barrier
    v_xor_b32 v13, 0x0, v11
    v_add_u32 v13, 0x8000, v13
    ds_read_b64_tr_b16 a[32:33], v13
    ds_read_b64_tr_b16 a[34:35], v13 offset:1024
    ds_read_b64_tr_b16 a[36:37], v13 offset:16384
    ds_read_b64_tr_b16 a[38:39], v13 offset:17408
    v_xor_b32 v13, 0x20, v11
    v_add_u32 v13, 0x8000, v13
    ds_read_b64_tr_b16 a[40:41], v13
    ds_read_b64_tr_b16 a[42:43], v13 offset:1024
    ds_read_b64_tr_b16 a[44:45], v13 offset:16384
    ds_read_b64_tr_b16 a[46:47], v13 offset:17408
    v_xor_b32 v13, 0x1000, v11
    v_add_u32 v13, 0x8000, v13
    ds_read_b64_tr_b16 a[64:65], v13
    ds_read_b64_tr_b16 a[66:67], v13 offset:1024
    ds_read_b64_tr_b16 a[68:69], v13 offset:16384
    ds_read_b64_tr_b16 a[70:71], v13 offset:17408
    v_xor_b32 v13, 0x1020, v11
    v_add_u32 v13, 0x8000, v13
    ds_read_b64_tr_b16 a[72:73], v13
    ds_read_b64_tr_b16 a[74:75], v13 offset:1024
    ds_read_b64_tr_b16 a[76:77], v13 offset:16384
    ds_read_b64_tr_b16 a[78:79], v13 offset:17408
    s_waitcnt lgkmcnt(0)
    s_barrier
    s_add_u32 s43, s41, 0x280000
    s_add_u32 m0, s51, 0x24000
    s_nop 0
    buffer_load_dwordx4 v15, s[12:15], s43 offen lds
    s_add_u32 s43, s41, 0x288000
    s_add_u32 m0, s51, 0x25000
    s_nop 0
    buffer_load_dwordx4 v15, s[12:15], s43 offen lds
    s_add_u32 s43, s41, 0x380000
    s_add_u32 m0, s51, 0x26000
    s_nop 0
    buffer_load_dwordx4 v15, s[12:15], s43 offen lds
    s_add_u32 s43, s41, 0x388000
    s_add_u32 m0, s51, 0x27000
    s_nop 0
    buffer_load_dwordx4 v15, s[12:15], s43 offen lds
    s_mov_b32 s12, s62
    s_and_b32 s13, s63, 0xffff
    v_xor_b32 v15, 0, v14
    v_lshl_add_u32 v15, v15, 15, v8
    s_add_u32 s43, s41, 0x0
    s_add_u32 m0, s51, 0x8000
    s_nop 0
    buffer_load_dwordx4 v15, s[12:15], s43 offen lds
    s_add_u32 s43, s41, 0x8000
    s_add_u32 m0, s51, 0x9000
    s_nop 0
    buffer_load_dwordx4 v15, s[12:15], s43 offen lds
    s_add_u32 s43, s41, 0x100000
    s_add_u32 m0, s51, 0xa000
    s_nop 0
    buffer_load_dwordx4 v15, s[12:15], s43 offen lds
    s_add_u32 s43, s41, 0x108000
    s_add_u32 m0, s51, 0xb000
    s_nop 0
    buffer_load_dwordx4 v15, s[12:15], s43 offen lds
    s_waitcnt vmcnt(12)
    s_barrier
    v_xor_b32 v13, 0x0, v11
    v_add_u32 v13, 0x10000, v13
    ds_read_b64_tr_b16 v[88:89], v13
    ds_read_b64_tr_b16 v[90:91], v13 offset:1024
    ds_read_b64_tr_b16 v[92:93], v13 offset:16384
    ds_read_b64_tr_b16 v[94:95], v13 offset:17408
    v_xor_b32 v13, 0x20, v11
    v_add_u32 v13, 0x10000, v13
    ds_read_b64_tr_b16 v[96:97], v13
    ds_read_b64_tr_b16 v[98:99], v13 offset:1024
    ds_read_b64_tr_b16 v[100:101], v13 offset:16384
    ds_read_b64_tr_b16 v[102:103], v13 offset:17408
    v_xor_b32 v13, 0x1000, v11
    v_add_u32 v13, 0x10000, v13
    ds_read_b64_tr_b16 a[16:17], v13
    ds_read_b64_tr_b16 a[18:19], v13 offset:1024
    ds_read_b64_tr_b16 a[20:21], v13 offset:16384
    ds_read_b64_tr_b16 a[22:23], v13 offset:17408
    v_xor_b32 v13, 0x1020, v11
    v_add_u32 v13, 0x10000, v13
    ds_read_b64_tr_b16 a[24:25], v13
    ds_read_b64_tr_b16 a[26:27], v13 offset:1024
    ds_read_b64_tr_b16 a[28:29], v13 offset:16384
    ds_read_b64_tr_b16 a[30:31], v13 offset:17408
    s_waitcnt lgkmcnt(0)
    s_barrier
    s_add_u32 s43, s41, 0x200000
    s_add_u32 m0, s51, 0xc000
    s_nop 0
    buffer_load_dwordx4 v15, s[12:15], s43 offen lds
    s_add_u32 s43, s41, 0x208000
    s_add_u32 m0, s51, 0xd000
    s_nop 0
    buffer_load_dwordx4 v15, s[12:15], s43 offen lds
    s_add_u32 s43, s41, 0x300000
    s_add_u32 m0, s51, 0xe000
    s_nop 0
    buffer_load_dwordx4 v15, s[12:15], s43 offen lds
    s_add_u32 s43, s41, 0x308000
    s_add_u32 m0, s51, 0xf000
    s_nop 0
    buffer_load_dwordx4 v15, s[12:15], s43 offen lds
    v_xor_b32 v15, 2, v14
    v_lshl_add_u32 v15, v15, 15, v8
    s_add_u32 s43, s41, 0x0
    s_add_u32 m0, s51, 0x10000
    s_nop 0
    buffer_load_dwordx4 v15, s[12:15], s43 offen lds
    s_add_u32 s43, s41, 0x8000
    s_add_u32 m0, s51, 0x11000
    s_nop 0
    buffer_load_dwordx4 v15, s[12:15], s43 offen lds
    s_add_u32 s43, s41, 0x100000
    s_add_u32 m0, s51, 0x12000
    s_nop 0
    buffer_load_dwordx4 v15, s[12:15], s43 offen lds
    s_add_u32 s43, s41, 0x108000
    s_add_u32 m0, s51, 0x13000
    s_nop 0
    buffer_load_dwordx4 v15, s[12:15], s43 offen lds
    s_waitcnt vmcnt(12)
    s_barrier
    v_xor_b32 v13, 0x0, v11
    v_add_u32 v13, 0x18000, v13
    ds_read_b64_tr_b16 a[48:49], v13
    ds_read_b64_tr_b16 a[50:51], v13 offset:1024
    ds_read_b64_tr_b16 a[52:53], v13 offset:16384
    ds_read_b64_tr_b16 a[54:55], v13 offset:17408
    v_xor_b32 v13, 0x20, v11
    v_add_u32 v13, 0x18000, v13
    ds_read_b64_tr_b16 a[56:57], v13
    ds_read_b64_tr_b16 a[58:59], v13 offset:1024
    ds_read_b64_tr_b16 a[60:61], v13 offset:16384
    ds_read_b64_tr_b16 a[62:63], v13 offset:17408
    v_xor_b32 v13, 0x1000, v11
    v_add_u32 v13, 0x18000, v13
    ds_read_b64_tr_b16 a[80:81], v13
    ds_read_b64_tr_b16 a[82:83], v13 offset:1024
    ds_read_b64_tr_b16 a[84:85], v13 offset:16384
    ds_read_b64_tr_b16 a[86:87], v13 offset:17408
    v_xor_b32 v13, 0x1020, v11
    v_add_u32 v13, 0x18000, v13
    ds_read_b64_tr_b16 a[88:89], v13
    ds_read_b64_tr_b16 a[90:91], v13 offset:1024
    ds_read_b64_tr_b16 a[92:93], v13 offset:16384
    ds_read_b64_tr_b16 a[94:95], v13 offset:17408
    s_waitcnt lgkmcnt(0)
    s_barrier
    s_add_u32 s43, s41, 0x200000
    s_add_u32 m0, s51, 0x14000
    s_nop 0
    buffer_load_dwordx4 v15, s[12:15], s43 offen lds
    s_add_u32 s43, s41, 0x208000
    s_add_u32 m0, s51, 0x15000
    s_nop 0
    buffer_load_dwordx4 v15, s[12:15], s43 offen lds
    s_add_u32 s43, s41, 0x300000
    s_add_u32 m0, s51, 0x16000
    s_nop 0
    buffer_load_dwordx4 v15, s[12:15], s43 offen lds
    s_add_u32 s43, s41, 0x308000
    s_add_u32 m0, s51, 0x17000
    s_nop 0
    buffer_load_dwordx4 v15, s[12:15], s43 offen lds
    v_xor_b32 v15, 0, v14
    v_lshl_add_u32 v15, v15, 15, v8
    s_add_u32 s43, s41, 0x80000
    s_add_u32 m0, s51, 0x18000
    s_nop 0
    buffer_load_dwordx4 v15, s[12:15], s43 offen lds
    s_add_u32 s43, s41, 0x88000
    s_add_u32 m0, s51, 0x19000
    s_nop 0
    buffer_load_dwordx4 v15, s[12:15], s43 offen lds
    s_add_u32 s43, s41, 0x180000
    s_add_u32 m0, s51, 0x1a000
    s_nop 0
    buffer_load_dwordx4 v15, s[12:15], s43 offen lds
    s_add_u32 s43, s41, 0x188000
    s_add_u32 m0, s51, 0x1b000
    s_nop 0
    buffer_load_dwordx4 v15, s[12:15], s43 offen lds
    s_waitcnt vmcnt(12)
    v_min_u32 v21, 0xfffffffe, v21
    s_mov_b32 s43, 0x7010000
    s_mov_b64 exec, s[38:39]
    buffer_store_dword v21, v119, s[8:11], s43 offen sc1
    s_mov_b64 exec, -1
    s_barrier
    v_xor_b32 v13, 0x0, v11
    v_add_u32 v13, 0x0, v13
    ds_read_b64_tr_b16 v[64:65], v13
    ds_read_b64_tr_b16 v[66:67], v13 offset:1024
    ds_read_b64_tr_b16 v[68:69], v13 offset:16384
    ds_read_b64_tr_b16 v[70:71], v13 offset:17408
    v_xor_b32 v13, 0x20, v11
    v_add_u32 v13, 0x0, v13
    ds_read_b64_tr_b16 v[72:73], v13
    ds_read_b64_tr_b16 v[74:75], v13 offset:1024
    ds_read_b64_tr_b16 v[76:77], v13 offset:16384
    ds_read_b64_tr_b16 v[78:79], v13 offset:17408
    v_xor_b32 v13, 0x1000, v11
    v_add_u32 v13, 0x0, v13
    ds_read_b64_tr_b16 a[96:97], v13
    ds_read_b64_tr_b16 a[98:99], v13 offset:1024
    ds_read_b64_tr_b16 a[100:101], v13 offset:16384
    ds_read_b64_tr_b16 a[102:103], v13 offset:17408
    v_xor_b32 v13, 0x1020, v11
    v_add_u32 v13, 0x0, v13
    ds_read_b64_tr_b16 a[104:105], v13
    ds_read_b64_tr_b16 a[106:107], v13 offset:1024
    ds_read_b64_tr_b16 a[108:109], v13 offset:16384
    ds_read_b64_tr_b16 a[110:111], v13 offset:17408
    s_waitcnt lgkmcnt(0)
    s_barrier
    s_add_u32 s43, s41, 0x280000
    s_add_u32 m0, s51, 0x1c000
    s_nop 0
    buffer_load_dwordx4 v15, s[12:15], s43 offen lds
    s_add_u32 s43, s41, 0x288000
    s_add_u32 m0, s51, 0x1d000
    s_nop 0
    buffer_load_dwordx4 v15, s[12:15], s43 offen lds
    s_add_u32 s43, s41, 0x380000
    s_add_u32 m0, s51, 0x1e000
    s_nop 0
    buffer_load_dwordx4 v15, s[12:15], s43 offen lds
    s_add_u32 s43, s41, 0x388000
    s_add_u32 m0, s51, 0x1f000
    s_nop 0
    buffer_load_dwordx4 v15, s[12:15], s43 offen lds
    v_xor_b32 v15, 2, v14
    v_lshl_add_u32 v15, v15, 15, v8
    s_add_u32 s43, s41, 0x80000
    s_add_u32 m0, s51, 0x20000
    s_nop 0
    buffer_load_dwordx4 v15, s[12:15], s43 offen lds
    s_add_u32 s43, s41, 0x88000
    s_add_u32 m0, s51, 0x21000
    s_nop 0
    buffer_load_dwordx4 v15, s[12:15], s43 offen lds
    s_add_u32 s43, s41, 0x180000
    s_add_u32 m0, s51, 0x22000
    s_nop 0
    buffer_load_dwordx4 v15, s[12:15], s43 offen lds
    s_add_u32 s43, s41, 0x188000
    s_add_u32 m0, s51, 0x23000
    s_nop 0
    buffer_load_dwordx4 v15, s[12:15], s43 offen lds
    s_waitcnt vmcnt(12)
    s_barrier
    v_xor_b32 v13, 0x0, v11
    v_add_u32 v13, 0x8000, v13
    ds_read_b64_tr_b16 a[128:129], v13
    ds_read_b64_tr_b16 a[130:131], v13 offset:1024
    ds_read_b64_tr_b16 a[132:133], v13 offset:16384
    ds_read_b64_tr_b16 a[134:135], v13 offset:17408
    v_xor_b32 v13, 0x20, v11
    v_add_u32 v13, 0x8000, v13
    ds_read_b64_tr_b16 a[136:137], v13
    ds_read_b64_tr_b16 a[138:139], v13 offset:1024
    ds_read_b64_tr_b16 a[140:141], v13 offset:16384
    ds_read_b64_tr_b16 a[142:143], v13 offset:17408
    v_xor_b32 v13, 0x1000, v11
    v_add_u32 v13, 0x8000, v13
    ds_read_b64_tr_b16 a[160:161], v13
    ds_read_b64_tr_b16 a[162:163], v13 offset:1024
    ds_read_b64_tr_b16 a[164:165], v13 offset:16384
    ds_read_b64_tr_b16 a[166:167], v13 offset:17408
    v_xor_b32 v13, 0x1020, v11
    v_add_u32 v13, 0x8000, v13
    ds_read_b64_tr_b16 a[168:169], v13
    ds_read_b64_tr_b16 a[170:171], v13 offset:1024
    ds_read_b64_tr_b16 a[172:173], v13 offset:16384
    ds_read_b64_tr_b16 a[174:175], v13 offset:17408
    s_waitcnt lgkmcnt(0)
    s_barrier
    s_add_u32 s43, s41, 0x280000
    s_add_u32 m0, s51, 0x24000
    s_nop 0
    buffer_load_dwordx4 v15, s[12:15], s43 offen lds
    s_add_u32 s43, s41, 0x288000
    s_add_u32 m0, s51, 0x25000
    s_nop 0
    buffer_load_dwordx4 v15, s[12:15], s43 offen lds
    s_add_u32 s43, s41, 0x380000
    s_add_u32 m0, s51, 0x26000
    s_nop 0
    buffer_load_dwordx4 v15, s[12:15], s43 offen lds
    s_add_u32 s43, s41, 0x388000
    s_add_u32 m0, s51, 0x27000
    s_nop 0
    buffer_load_dwordx4 v15, s[12:15], s43 offen lds
    s_mov_b32 s12, s64
    s_and_b32 s13, s65, 0xffff
    v_xor_b32 v15, 0, v14
    v_lshl_add_u32 v15, v15, 15, v8
    s_add_u32 s43, s41, 0x0
    s_add_u32 m0, s51, 0x8000
    s_nop 0
    buffer_load_dwordx4 v15, s[12:15], s43 offen lds
    s_add_u32 s43, s41, 0x8000
    s_add_u32 m0, s51, 0x9000
    s_nop 0
    buffer_load_dwordx4 v15, s[12:15], s43 offen lds
    s_add_u32 s43, s41, 0x100000
    s_add_u32 m0, s51, 0xa000
    s_nop 0
    buffer_load_dwordx4 v15, s[12:15], s43 offen lds
    s_add_u32 s43, s41, 0x108000
    s_add_u32 m0, s51, 0xb000
    s_nop 0
    buffer_load_dwordx4 v15, s[12:15], s43 offen lds
    s_waitcnt vmcnt(12)
    s_barrier
    v_xor_b32 v13, 0x0, v11
    v_add_u32 v13, 0x10000, v13
    ds_read_b64_tr_b16 v[104:105], v13
    ds_read_b64_tr_b16 v[106:107], v13 offset:1024
    ds_read_b64_tr_b16 v[108:109], v13 offset:16384
    ds_read_b64_tr_b16 v[110:111], v13 offset:17408
    v_xor_b32 v13, 0x20, v11
    v_add_u32 v13, 0x10000, v13
    ds_read_b64_tr_b16 v[32:33], v13
    ds_read_b64_tr_b16 v[34:35], v13 offset:1024
    ds_read_b64_tr_b16 v[36:37], v13 offset:16384
    ds_read_b64_tr_b16 v[38:39], v13 offset:17408
    v_xor_b32 v13, 0x1000, v11
    v_add_u32 v13, 0x10000, v13
    ds_read_b64_tr_b16 a[112:113], v13
    ds_read_b64_tr_b16 a[114:115], v13 offset:1024
    ds_read_b64_tr_b16 a[116:117], v13 offset:16384
    ds_read_b64_tr_b16 a[118:119], v13 offset:17408
    v_xor_b32 v13, 0x1020, v11
    v_add_u32 v13, 0x10000, v13
    ds_read_b64_tr_b16 a[120:121], v13
    ds_read_b64_tr_b16 a[122:123], v13 offset:1024
    ds_read_b64_tr_b16 a[124:125], v13 offset:16384
    ds_read_b64_tr_b16 a[126:127], v13 offset:17408
    s_waitcnt lgkmcnt(0)
    s_barrier
    s_add_u32 s43, s41, 0x200000
    s_add_u32 m0, s51, 0xc000
    s_nop 0
    buffer_load_dwordx4 v15, s[12:15], s43 offen lds
    s_add_u32 s43, s41, 0x208000
    s_add_u32 m0, s51, 0xd000
    s_nop 0
    buffer_load_dwordx4 v15, s[12:15], s43 offen lds
    s_add_u32 s43, s41, 0x300000
    s_add_u32 m0, s51, 0xe000
    s_nop 0
    buffer_load_dwordx4 v15, s[12:15], s43 offen lds
    s_add_u32 s43, s41, 0x308000
    s_add_u32 m0, s51, 0xf000
    s_nop 0
    buffer_load_dwordx4 v15, s[12:15], s43 offen lds
    v_xor_b32 v15, 2, v14
    v_lshl_add_u32 v15, v15, 15, v8
    s_add_u32 s43, s41, 0x0
    s_add_u32 m0, s51, 0x10000
    s_nop 0
    buffer_load_dwordx4 v15, s[12:15], s43 offen lds
    s_add_u32 s43, s41, 0x8000
    s_add_u32 m0, s51, 0x11000
    s_nop 0
    buffer_load_dwordx4 v15, s[12:15], s43 offen lds
    s_add_u32 s43, s41, 0x100000
    s_add_u32 m0, s51, 0x12000
    s_nop 0
    buffer_load_dwordx4 v15, s[12:15], s43 offen lds
    s_add_u32 s43, s41, 0x108000
    s_add_u32 m0, s51, 0x13000
    s_nop 0
    buffer_load_dwordx4 v15, s[12:15], s43 offen lds
    s_waitcnt vmcnt(12)
    s_barrier
    v_xor_b32 v13, 0x0, v11
    v_add_u32 v13, 0x18000, v13
    ds_read_b64_tr_b16 a[144:145], v13
    ds_read_b64_tr_b16 a[146:147], v13 offset:1024
    ds_read_b64_tr_b16 a[148:149], v13 offset:16384
    ds_read_b64_tr_b16 a[150:151], v13 offset:17408
    v_xor_b32 v13, 0x20, v11
    v_add_u32 v13, 0x18000, v13
    ds_read_b64_tr_b16 a[152:153], v13
    ds_read_b64_tr_b16 a[154:155], v13 offset:1024
    ds_read_b64_tr_b16 a[156:157], v13 offset:16384
    ds_read_b64_tr_b16 a[158:159], v13 offset:17408
    v_xor_b32 v13, 0x1000, v11
    v_add_u32 v13, 0x18000, v13
    ds_read_b64_tr_b16 a[176:177], v13
    ds_read_b64_tr_b16 a[178:179], v13 offset:1024
    ds_read_b64_tr_b16 a[180:181], v13 offset:16384
    ds_read_b64_tr_b16 a[182:183], v13 offset:17408
    v_xor_b32 v13, 0x1020, v11
    v_add_u32 v13, 0x18000, v13
    ds_read_b64_tr_b16 a[184:185], v13
    ds_read_b64_tr_b16 a[186:187], v13 offset:1024
    ds_read_b64_tr_b16 a[188:189], v13 offset:16384
    ds_read_b64_tr_b16 a[190:191], v13 offset:17408
    s_waitcnt lgkmcnt(0)
    s_barrier
    s_add_u32 s43, s41, 0x200000
    s_add_u32 m0, s51, 0x14000
    s_nop 0
    buffer_load_dwordx4 v15, s[12:15], s43 offen lds
    s_add_u32 s43, s41, 0x208000
    s_add_u32 m0, s51, 0x15000
    s_nop 0
    buffer_load_dwordx4 v15, s[12:15], s43 offen lds
    s_add_u32 s43, s41, 0x300000
    s_add_u32 m0, s51, 0x16000
    s_nop 0
    buffer_load_dwordx4 v15, s[12:15], s43 offen lds
    s_add_u32 s43, s41, 0x308000
    s_add_u32 m0, s51, 0x17000
    s_nop 0
    buffer_load_dwordx4 v15, s[12:15], s43 offen lds
    s_mov_b32 s12, s66
    s_and_b32 s13, s67, 0xffff
    s_add_u32 s43, s42, 0x80
    s_add_u32 m0, s51, 0x18000
    s_nop 0
    buffer_load_dwordx4 v10, s[12:15], s43 offen lds
    s_add_u32 s43, s42, 0x4080
    s_add_u32 m0, s51, 0x19000
    s_nop 0
    buffer_load_dwordx4 v9, s[12:15], s43 offen lds
    s_add_u32 s43, s42, 0x8080
    s_add_u32 m0, s51, 0x1a000
    s_nop 0
    buffer_load_dwordx4 v10, s[12:15], s43 offen lds
    s_add_u32 s43, s42, 0xc080
    s_add_u32 m0, s51, 0x1b000
    s_nop 0
    buffer_load_dwordx4 v9, s[12:15], s43 offen lds
    s_waitcnt vmcnt(12)
    s_barrier
    v_xor_b32 v13, 0x0, v11
    v_add_u32 v13, 0x0, v13
    ds_read_b64_tr_b16 a[192:193], v13
    ds_read_b64_tr_b16 a[194:195], v13 offset:1024
    ds_read_b64_tr_b16 a[196:197], v13 offset:16384
    ds_read_b64_tr_b16 a[198:199], v13 offset:17408
    v_xor_b32 v13, 0x20, v11
    v_add_u32 v13, 0x0, v13
    ds_read_b64_tr_b16 a[200:201], v13
    ds_read_b64_tr_b16 a[202:203], v13 offset:1024
    ds_read_b64_tr_b16 a[204:205], v13 offset:16384
    ds_read_b64_tr_b16 a[206:207], v13 offset:17408
    v_xor_b32 v13, 0x1000, v11
    v_add_u32 v13, 0x0, v13
    ds_read_b64_tr_b16 a[224:225], v13
    ds_read_b64_tr_b16 a[226:227], v13 offset:1024
    ds_read_b64_tr_b16 a[228:229], v13 offset:16384
    ds_read_b64_tr_b16 a[230:231], v13 offset:17408
    v_xor_b32 v13, 0x1020, v11
    v_add_u32 v13, 0x0, v13
    ds_read_b64_tr_b16 a[232:233], v13
    ds_read_b64_tr_b16 a[234:235], v13 offset:1024
    ds_read_b64_tr_b16 a[236:237], v13 offset:16384
    ds_read_b64_tr_b16 a[238:239], v13 offset:17408
    s_waitcnt lgkmcnt(0)
    s_barrier
    s_add_u32 s43, s42, 0x10280
    s_add_u32 m0, s51, 0x1c000
    s_nop 0
    buffer_load_dwordx4 v10, s[12:15], s43 offen lds
    s_add_u32 s43, s42, 0x14280
    s_add_u32 m0, s51, 0x1d000
    s_nop 0
    buffer_load_dwordx4 v9, s[12:15], s43 offen lds
    s_add_u32 s43, s42, 0x18280
    s_add_u32 m0, s51, 0x1e000
    s_nop 0
    buffer_load_dwordx4 v10, s[12:15], s43 offen lds
    s_add_u32 s43, s42, 0x1c280
    s_add_u32 m0, s51, 0x1f000
    s_nop 0
    buffer_load_dwordx4 v9, s[12:15], s43 offen lds
    s_add_u32 s43, s42, 0x10080
    s_add_u32 m0, s51, 0x20000
    s_nop 0
    buffer_load_dwordx4 v10, s[12:15], s43 offen lds
    s_add_u32 s43, s42, 0x14080
    s_add_u32 m0, s51, 0x21000
    s_nop 0
    buffer_load_dwordx4 v9, s[12:15], s43 offen lds
    s_add_u32 s43, s42, 0x18080
    s_add_u32 m0, s51, 0x22000
    s_nop 0
    buffer_load_dwordx4 v10, s[12:15], s43 offen lds
    s_add_u32 s43, s42, 0x1c080
    s_add_u32 m0, s51, 0x23000
    s_nop 0
    buffer_load_dwordx4 v9, s[12:15], s43 offen lds
    s_waitcnt vmcnt(12)
    s_barrier
    s_cmp_lg_u32 s21, 0
    s_cbranch_scc1 L_arr_51
    v_mov_b32 v23, 1
    s_mov_b64 exec, 1
    buffer_atomic_add v23, off, s[16:19], 0 offset:8
    s_mov_b64 exec, -1
L_arr_51:
    v_xor_b32 v13, 0x0, v11
    v_add_u32 v13, 0x8000, v13
    ds_read_b64_tr_b16 v[128:129], v13
    ds_read_b64_tr_b16 v[130:131], v13 offset:1024
    ds_read_b64_tr_b16 v[132:133], v13 offset:16384
    ds_read_b64_tr_b16 v[134:135], v13 offset:17408
    v_xor_b32 v13, 0x20, v11
    v_add_u32 v13, 0x8000, v13
    ds_read_b64_tr_b16 v[136:137], v13
    ds_read_b64_tr_b16 v[138:139], v13 offset:1024
    ds_read_b64_tr_b16 v[140:141], v13 offset:16384
    ds_read_b64_tr_b16 v[142:143], v13 offset:17408
    v_xor_b32 v13, 0x1000, v11
    v_add_u32 v13, 0x8000, v13
    ds_read_b64_tr_b16 v[160:161], v13
    ds_read_b64_tr_b16 v[162:163], v13 offset:1024
    ds_read_b64_tr_b16 v[164:165], v13 offset:16384
    ds_read_b64_tr_b16 v[166:167], v13 offset:17408
    v_xor_b32 v13, 0x1020, v11
    v_add_u32 v13, 0x8000, v13
    ds_read_b64_tr_b16 v[168:169], v13
    ds_read_b64_tr_b16 v[170:171], v13 offset:1024
    ds_read_b64_tr_b16 v[172:173], v13 offset:16384
    ds_read_b64_tr_b16 v[174:175], v13 offset:17408
    s_waitcnt lgkmcnt(0)
    s_barrier
    s_add_u32 s43, s42, 0x280
    s_add_u32 m0, s51, 0x24000
    s_nop 0
    buffer_load_dwordx4 v10, s[12:15], s43 offen lds
    s_add_u32 s43, s42, 0x4280
    s_add_u32 m0, s51, 0x25000
    s_nop 0
    buffer_load_dwordx4 v9, s[12:15], s43 offen lds
    s_add_u32 s43, s42, 0x8280
    s_add_u32 m0, s51, 0x26000
    s_nop 0
    buffer_load_dwordx4 v10, s[12:15], s43 offen lds
    s_add_u32 s43, s42, 0xc280
    s_add_u32 m0, s51, 0x27000
    s_nop 0
    buffer_load_dwordx4 v9, s[12:15], s43 offen lds
    s_mov_b32 s12, s64
    s_and_b32 s13, s65, 0xffff
    v_xor_b32 v15, 0, v14
    v_lshl_add_u32 v15, v15, 15, v8
    s_add_u32 s43, s41, 0x80000
    s_add_u32 m0, s51, 0x8000
    s_nop 0
    buffer_load_dwordx4 v15, s[12:15], s43 offen lds
    s_add_u32 s43, s41, 0x88000
    s_add_u32 m0, s51, 0x9000
    s_nop 0
    buffer_load_dwordx4 v15, s[12:15], s43 offen lds
    s_add_u32 s43, s41, 0x180000
    s_add_u32 m0, s51, 0xa000
    s_nop 0
    buffer_load_dwordx4 v15, s[12:15], s43 offen lds
    s_add_u32 s43, s41, 0x188000
    s_add_u32 m0, s51, 0xb000
    s_nop 0
    buffer_load_dwordx4 v15, s[12:15], s43 offen lds
    s_waitcnt vmcnt(12)
    s_barrier
    v_xor_b32 v13, 0x0, v12
    v_add_u32 v13, 0x10000, v13
    ds_read_b64_tr_b16 v[192:193], v13
    ds_read_b64_tr_b16 v[194:195], v13 offset:512
    ds_read_b64_tr_b16 v[196:197], v13 offset:2048
    ds_read_b64_tr_b16 v[198:199], v13 offset:2560
    v_xor_b32 v13, 0x2000, v12
    v_add_u32 v13, 0x10000, v13
    ds_read_b64_tr_b16 v[200:201], v13
    ds_read_b64_tr_b16 v[202:203], v13 offset:512
    ds_read_b64_tr_b16 v[204:205], v13 offset:2048
    ds_read_b64_tr_b16 v[206:207], v13 offset:2560
    v_xor_b32 v13, 0x40, v12
    v_add_u32 v13, 0x10000, v13
    ds_read_b64_tr_b16 v[224:225], v13
    ds_read_b64_tr_b16 v[226:227], v13 offset:512
    ds_read_b64_tr_b16 v[228:229], v13 offset:2048
    ds_read_b64_tr_b16 v[230:231], v13 offset:2560
    v_xor_b32 v13, 0x2040, v12
    v_add_u32 v13, 0x10000, v13
    ds_read_b64_tr_b16 v[232:233], v13
    ds_read_b64_tr_b16 v[234:235], v13 offset:512
    ds_read_b64_tr_b16 v[236:237], v13 offset:2048
    ds_read_b64_tr_b16 v[238:239], v13 offset:2560
    s_waitcnt lgkmcnt(0)
    s_barrier
    s_add_u32 s43, s41, 0x280000
    s_add_u32 m0, s51, 0xc000
    s_nop 0
    buffer_load_dwordx4 v15, s[12:15], s43 offen lds
    s_add_u32 s43, s41, 0x288000
    s_add_u32 m0, s51, 0xd000
    s_nop 0
    buffer_load_dwordx4 v15, s[12:15], s43 offen lds
    s_add_u32 s43, s41, 0x380000
    s_add_u32 m0, s51, 0xe000
    s_nop 0
    buffer_load_dwordx4 v15, s[12:15], s43 offen lds
    s_add_u32 s43, s41, 0x388000
    s_add_u32 m0, s51, 0xf000
    s_nop 0
    buffer_load_dwordx4 v15, s[12:15], s43 offen lds
    v_xor_b32 v15, 2, v14
    v_lshl_add_u32 v15, v15, 15, v8
    s_add_u32 s43, s41, 0x80000
    s_add_u32 m0, s51, 0x10000
    s_nop 0
    buffer_load_dwordx4 v15, s[12:15], s43 offen lds
    s_add_u32 s43, s41, 0x88000
    s_add_u32 m0, s51, 0x11000
    s_nop 0
    buffer_load_dwordx4 v15, s[12:15], s43 offen lds
    s_add_u32 s43, s41, 0x180000
    s_add_u32 m0, s51, 0x12000
    s_nop 0
    buffer_load_dwordx4 v15, s[12:15], s43 offen lds
    s_add_u32 s43, s41, 0x188000
    s_add_u32 m0, s51, 0x13000
    s_nop 0
    buffer_load_dwordx4 v15, s[12:15], s43 offen lds
    s_waitcnt vmcnt(12)
    s_barrier
    v_xor_b32 v13, 0x0, v12
    v_add_u32 v13, 0x18000, v13
    ds_read_b64_tr_b16 v[208:209], v13
    ds_read_b64_tr_b16 v[210:211], v13 offset:512
    ds_read_b64_tr_b16 v[212:213], v13 offset:2048
    ds_read_b64_tr_b16 v[214:215], v13 offset:2560
    v_xor_b32 v13, 0x2000, v12
    v_add_u32 v13, 0x18000, v13
    ds_read_b64_tr_b16 v[216:217], v13
    ds_read_b64_tr_b16 v[218:219], v13 offset:512
    ds_read_b64_tr_b16 v[220:221], v13 offset:2048
    ds_read_b64_tr_b16 v[222:223], v13 offset:2560
    v_xor_b32 v13, 0x40, v12
    v_add_u32 v13, 0x18000, v13
    ds_read_b64_tr_b16 v[240:241], v13
    ds_read_b64_tr_b16 v[242:243], v13 offset:512
    ds_read_b64_tr_b16 v[244:245], v13 offset:2048
    ds_read_b64_tr_b16 v[246:247], v13 offset:2560
    v_xor_b32 v13, 0x2040, v12
    v_add_u32 v13, 0x18000, v13
    ds_read_b64_tr_b16 v[248:249], v13
    ds_read_b64_tr_b16 v[250:251], v13 offset:512
    ds_read_b64_tr_b16 v[252:253], v13 offset:2048
    ds_read_b64_tr_b16 v[254:255], v13 offset:2560
    s_waitcnt lgkmcnt(0)
    s_barrier
    s_add_u32 s43, s41, 0x280000
    s_add_u32 m0, s51, 0x14000
    s_nop 0
    buffer_load_dwordx4 v15, s[12:15], s43 offen lds
    s_add_u32 s43, s41, 0x288000
    s_add_u32 m0, s51, 0x15000
    s_nop 0
    buffer_load_dwordx4 v15, s[12:15], s43 offen lds
    s_add_u32 s43, s41, 0x380000
    s_add_u32 m0, s51, 0x16000
    s_nop 0
    buffer_load_dwordx4 v15, s[12:15], s43 offen lds
    s_add_u32 s43, s41, 0x388000
    s_add_u32 m0, s51, 0x17000
    s_nop 0
    buffer_load_dwordx4 v15, s[12:15], s43 offen lds
    ds_write_b128 v124, v[192:195]
    ds_write_b128 v124, v[196:199] offset:1024
    ds_write_b128 v124, v[200:203] offset:2048
    ds_write_b128 v124, v[204:207] offset:3072
    ds_write_b128 v124, v[208:211] offset:4096
    ds_write_b128 v124, v[212:215] offset:5120
    ds_write_b128 v124, v[216:219] offset:6144
    ds_write_b128 v124, v[220:223] offset:7168
    ds_write_b128 v124, v[224:227] offset:32768
    ds_write_b128 v124, v[228:231] offset:33792
    ds_write_b128 v124, v[232:235] offset:34816
    ds_write_b128 v124, v[236:239] offset:35840
    ds_write_b128 v124, v[240:243] offset:36864
    ds_write_b128 v124, v[244:247] offset:37888
    ds_write_b128 v124, v[248:251] offset:38912
    ds_write_b128 v124, v[252:255] offset:39936
    s_waitcnt vmcnt(8)
    s_barrier
    v_xor_b32 v13, 0x0, v11
    v_add_u32 v13, 0x0, v13
    ds_read_b64_tr_b16 a[208:209], v13
    ds_read_b64_tr_b16 a[210:211], v13 offset:1024
    ds_read_b64_tr_b16 a[212:213], v13 offset:16384
    ds_read_b64_tr_b16 a[214:215], v13 offset:17408
    v_xor_b32 v13, 0x20, v11
    v_add_u32 v13, 0x0, v13
    ds_read_b64_tr_b16 a[216:217], v13
    ds_read_b64_tr_b16 a[218:219], v13 offset:1024
    ds_read_b64_tr_b16 a[220:221], v13 offset:16384
    ds_read_b64_tr_b16 a[222:223], v13 offset:17408
    v_xor_b32 v13, 0x1000, v11
    v_add_u32 v13, 0x0, v13
    ds_read_b64_tr_b16 a[240:241], v13
    ds_read_b64_tr_b16 a[242:243], v13 offset:1024
    ds_read_b64_tr_b16 a[244:245], v13 offset:16384
    ds_read_b64_tr_b16 a[246:247], v13 offset:17408
    v_xor_b32 v13, 0x1020, v11
    v_add_u32 v13, 0x0, v13
    ds_read_b64_tr_b16 a[248:249], v13
    ds_read_b64_tr_b16 a[250:251], v13 offset:1024
    ds_read_b64_tr_b16 a[252:253], v13 offset:16384
    ds_read_b64_tr_b16 a[254:255], v13 offset:17408
    s_waitcnt lgkmcnt(0)
    s_barrier
    s_mov_b32 s12, s66
    s_and_b32 s13, s67, 0xffff
    s_add_u32 s43, s42, 0x0
    s_add_u32 m0, s51, 0x8000
    s_nop 0
    buffer_load_dwordx4 v10, s[12:15], s43 offen lds
    s_add_u32 s43, s42, 0x4000
    s_add_u32 m0, s51, 0x9000
    s_nop 0
    buffer_load_dwordx4 v9, s[12:15], s43 offen lds
    s_add_u32 s43, s42, 0x8000
    s_add_u32 m0, s51, 0xa000
    s_nop 0
    buffer_load_dwordx4 v10, s[12:15], s43 offen lds
    s_add_u32 s43, s42, 0xc000
    s_add_u32 m0, s51, 0xb000
    s_nop 0
    buffer_load_dwordx4 v9, s[12:15], s43 offen lds
    s_add_u32 s43, s42, 0x10200
    s_add_u32 m0, s51, 0xc000
    s_nop 0
    buffer_load_dwordx4 v10, s[12:15], s43 offen lds
    s_add_u32 s43, s42, 0x14200
    s_add_u32 m0, s51, 0xd000
    s_nop 0
    buffer_load_dwordx4 v9, s[12:15], s43 offen lds
    s_add_u32 s43, s42, 0x18200
    s_add_u32 m0, s51, 0xe000
    s_nop 0
    buffer_load_dwordx4 v10, s[12:15], s43 offen lds
    s_add_u32 s43, s42, 0x1c200
    s_add_u32 m0, s51, 0xf000
    s_nop 0
    buffer_load_dwordx4 v9, s[12:15], s43 offen lds
    s_waitcnt vmcnt(8)
    s_barrier
    v_xor_b32 v13, 0x0, v11
    v_add_u32 v13, 0x8000, v13
    ds_read_b64_tr_b16 v[144:145], v13
    ds_read_b64_tr_b16 v[146:147], v13 offset:1024
    ds_read_b64_tr_b16 v[148:149], v13 offset:16384
    ds_read_b64_tr_b16 v[150:151], v13 offset:17408
    v_xor_b32 v13, 0x20, v11
    v_add_u32 v13, 0x8000, v13
    ds_read_b64_tr_b16 v[152:153], v13
    ds_read_b64_tr_b16 v[154:155], v13 offset:1024
    ds_read_b64_tr_b16 v[156:157], v13 offset:16384
    ds_read_b64_tr_b16 v[158:159], v13 offset:17408
    v_xor_b32 v13, 0x1000, v11
    v_add_u32 v13, 0x8000, v13
    ds_read_b64_tr_b16 v[176:177], v13
    ds_read_b64_tr_b16 v[178:179], v13 offset:1024
    ds_read_b64_tr_b16 v[180:181], v13 offset:16384
    ds_read_b64_tr_b16 v[182:183], v13 offset:17408
    v_xor_b32 v13, 0x1020, v11
    v_add_u32 v13, 0x8000, v13
    ds_read_b64_tr_b16 v[184:185], v13
    ds_read_b64_tr_b16 v[186:187], v13 offset:1024
    ds_read_b64_tr_b16 v[188:189], v13 offset:16384
    ds_read_b64_tr_b16 v[190:191], v13 offset:17408
    s_waitcnt lgkmcnt(0)
    s_barrier
    s_add_u32 s43, s42, 0x10000
    s_add_u32 m0, s51, 0x10000
    s_nop 0
    buffer_load_dwordx4 v10, s[12:15], s43 offen lds
    s_add_u32 s43, s42, 0x14000
    s_add_u32 m0, s51, 0x11000
    s_nop 0
    buffer_load_dwordx4 v9, s[12:15], s43 offen lds
    s_add_u32 s43, s42, 0x18000
    s_add_u32 m0, s51, 0x12000
    s_nop 0
    buffer_load_dwordx4 v10, s[12:15], s43 offen lds
    s_add_u32 s43, s42, 0x1c000
    s_add_u32 m0, s51, 0x13000
    s_nop 0
    buffer_load_dwordx4 v9, s[12:15], s43 offen lds
    s_add_u32 s43, s42, 0x200
    s_add_u32 m0, s51, 0x14000
    s_nop 0
    buffer_load_dwordx4 v10, s[12:15], s43 offen lds
    s_add_u32 s43, s42, 0x4200
    s_add_u32 m0, s51, 0x15000
    s_nop 0
    buffer_load_dwordx4 v9, s[12:15], s43 offen lds
    s_add_u32 s43, s42, 0x8200
    s_add_u32 m0, s51, 0x16000
    s_nop 0
    buffer_load_dwordx4 v10, s[12:15], s43 offen lds
    s_add_u32 s43, s42, 0xc200
    s_add_u32 m0, s51, 0x17000
    s_nop 0
    buffer_load_dwordx4 v9, s[12:15], s43 offen lds
    s_waitcnt vmcnt(8)
    s_barrier
    v_xor_b32 v13, 0x0, v12
    v_add_u32 v13, 0x0, v13
    ds_read_b64_tr_b16 v[192:193], v13
    ds_read_b64_tr_b16 v[194:195], v13 offset:512
    ds_read_b64_tr_b16 v[196:197], v13 offset:2048
    ds_read_b64_tr_b16 v[198:199], v13 offset:2560
    v_xor_b32 v13, 0x2000, v12
    v_add_u32 v13, 0x0, v13
    ds_read_b64_tr_b16 v[200:201], v13
    ds_read_b64_tr_b16 v[202:203], v13 offset:512
    ds_read_b64_tr_b16 v[204:205], v13 offset:2048
    ds_read_b64_tr_b16 v[206:207], v13 offset:2560
    v_xor_b32 v13, 0x40, v12
    v_add_u32 v13, 0x0, v13
    ds_read_b64_tr_b16 v[224:225], v13
    ds_read_b64_tr_b16 v[226:227], v13 offset:512
    ds_read_b64_tr_b16 v[228:229], v13 offset:2048
    ds_read_b64_tr_b16 v[230:231], v13 offset:2560
    v_xor_b32 v13, 0x2040, v12
    v_add_u32 v13, 0x0, v13
    ds_read_b64_tr_b16 v[232:233], v13
    ds_read_b64_tr_b16 v[234:235], v13 offset:512
    ds_read_b64_tr_b16 v[236:237], v13 offset:2048
    ds_read_b64_tr_b16 v[238:239], v13 offset:2560
    s_lshr_b32 s43, s20, 1
    s_lshl_b32 s43, s43, 7
    s_and_b32 s40, s20, 1
    s_lshl_b32 s40, s40, 4
    s_add_u32 s43, s43, s40
    s_add_u32 s44, s43, 0x1000
    s_cmp_eq_u32 s21, 0
    s_cselect_b32 s44, s44, 0x7ff00000
    s_mov_b32 s22, 0
    s_mov_b32 s33, 0
    s_xor_b32 s53, s29, 1024
    s_add_u32 s23, s51, 0x7010000
    s_add_u32 s48, s23, 4096
    s_mov_b32 s24, 0x7012000
    s_add_u32 s55, s24, 16384
    s_mov_b32 s25, 0x7100000
    s_mov_b32 s26, 0x7101000
    v_mov_b32 v112, 0
    v_mov_b32 v113, 0
    v_mov_b32 v114, 0
    v_mov_b32 v115, 0
    ds_write_b128 v117, v[112:115] offset:22528
    ds_write_b128 v117, v[112:115] offset:23552
    s_cmp_lg_u32 s21, 0
    s_cselect_b32 s40, -1, 0
    v_mov_b32 v126, s40
    v_bfe_u32 v1, v117, 4, 1
    v_lshlrev_b32 v1, 4, v1
    s_movk_i32 s43, 0x3f80
    v_lshlrev_b32 v125, v1, s43
    v_bfe_u32 v1, v117, 5, 3
    v_cmp_eq_u32 s[68:69], 0, v1
    v_cmp_eq_u32 s[70:71], 1, v1
    v_cmp_eq_u32 s[72:73], 2, v1
    v_cmp_eq_u32 s[74:75], 3, v1
    v_lshrrev_b32 v1, 2, v117
    s_cmp_lt_u32 s21, 2
    s_cselect_b64 vcc, -1, 0
    v_cndmask_b32 v119, v119, v1, vcc
    v_mov_b32 v40, 0
    v_mov_b32 v41, 0
    v_mov_b32 v42, 0
    v_mov_b32 v43, 0
    v_mov_b32 v44, 0
    v_mov_b32 v45, 0
    v_mov_b32 v46, 0
    v_mov_b32 v47, 0
    v_mov_b32 v48, 0
    v_mov_b32 v49, 0
    v_mov_b32 v50, 0
    v_mov_b32 v51, 0
    v_mov_b32 v52, 0
    v_mov_b32 v53, 0
    v_mov_b32 v54, 0
    v_mov_b32 v55, 0
    s_mov_b32 s45, 0
    s_mov_b32 s46, 0
    s_mov_b32 s47, 0
    s_mov_b32 s76, 0
    s_and_b32 s43, s21, 1
    s_lshl_b32 s43, s43, 5
    s_add_u32 s43, s43, s20
    s_lshl_b32 s43, s43, 6
    s_add_u32 s28, s43, 0x2000
    s_mov_b32 s59, 0
    s_waitcnt vmcnt(0) lgkmcnt(0)
    s_barrier
    v_xor_b32 v13, 0x0, v12
    v_add_u32 v13, 0x8000, v13
    ds_read_b64_tr_b16 v[208:209], v13
    ds_read_b64_tr_b16 v[210:211], v13 offset:512
    ds_read_b64_tr_b16 v[212:213], v13 offset:2048
    ds_read_b64_tr_b16 v[214:215], v13 offset:2560
    v_xor_b32 v13, 0x2000, v12
    v_add_u32 v13, 0x8000, v13
    ds_read_b64_tr_b16 v[216:217], v13
    ds_read_b64_tr_b16 v[218:219], v13 offset:512
    ds_read_b64_tr_b16 v[220:221], v13 offset:2048
    ds_read_b64_tr_b16 v[222:223], v13 offset:2560
    v_xor_b32 v13, 0x40, v12
    v_add_u32 v13, 0x8000, v13
    ds_read_b64_tr_b16 v[240:241], v13
    ds_read_b64_tr_b16 v[242:243], v13 offset:512
    ds_read_b64_tr_b16 v[244:245], v13 offset:2048
    ds_read_b64_tr_b16 v[246:247], v13 offset:2560
    v_xor_b32 v13, 0x2040, v12
    v_add_u32 v13, 0x8000, v13
    ds_read_b64_tr_b16 v[248:249], v13
    ds_read_b64_tr_b16 v[250:251], v13 offset:512
    ds_read_b64_tr_b16 v[252:253], v13 offset:2048
    ds_read_b64_tr_b16 v[254:255], v13 offset:2560
    ds_write_b128 v123, v[80:83]
    ds_write_b128 v123, v[84:87] offset:1024
    ds_write_b128 v123, v[56:59] offset:2048
    ds_write_b128 v123, v[60:63] offset:3072
    ds_write_b128 v123, v[88:91] offset:4096
    ds_write_b128 v123, v[92:95] offset:5120
    ds_write_b128 v123, v[96:99] offset:6144
    ds_write_b128 v123, v[100:103] offset:7168
    s_cmp_eq_u32 s57, 1
    s_cbranch_scc1 L_started_52
    v_lshrrev_b32 v1, 4, v117
    v_and_b32 v2, 15, v1
    v_lshrrev_b32 v1, 4, v1
    v_lshlrev_b32 v1, 11, v1
    v_lshl_add_u32 v1, v2, 2, v1
    s_lshl_b32 s43, s20, 6
    s_add_u32 s43, s43, 0x2000
    s_mov_b32 exec_lo, 0x10001
    s_mov_b32 exec_hi, 0
    s_mov_b32 s96, 0
L_poll_53:
    buffer_load_dword v2, v1, s[8:11], s43 offen sc1
    s_waitcnt vmcnt(0)
    v_cmp_gt_u32 vcc, 1, v2
    s_cbranch_vccz L_polld_54
    s_sleep 8
    s_add_u32 s96, s96, 1
    s_cmp_lt_u32 s96, 0x10000
    s_cbranch_scc1 L_poll_53
L_polld_54:
    s_mov_b64 exec, -1
    s_add_u32 m0, s52, 8192
    s_nop 0
    buffer_load_dwordx4 v117, s[8:11], s30 offen lds
    buffer_load_dwordx4 v117, s[8:11], s30 offen offset:1024 lds
    s_add_u32 m0, s52, 0x6000
    s_nop 0
    buffer_load_dwordx4 v117, s[8:11], s31 offen lds
    buffer_load_dwordx4 v117, s[8:11], s31 offen offset:1024 lds
    s_mov_b32 s49, 0
L_cb_poll_56:
    buffer_load_dword v3, off, s[16:19], 0 offset:8 sc1
    s_waitcnt vmcnt(0)
    v_readfirstlane_b32 s43, v3
    s_nop 0
    s_cmp_ge_u32 s43, 32
    s_cbranch_scc1 L_started_52
    s_sleep 8
    s_add_u32 s49, s49, 1
    s_cmp_lt_u32 s49, 0x40000
    s_cbranch_scc1 L_cb_poll_56
L_started_52:
    s_add_u32 m0, s51, 4096
    v_mov_b32 v24, v32
    v_mov_b32 v25, v33
    v_mov_b32 v26, v34
    v_mov_b32 v27, v35
    v_mov_b32 v28, v36
    v_mov_b32 v29, v37
    v_mov_b32 v30, v38
    v_mov_b32 v31, v39
    s_add_u32 s30, s30, 0x40000
    s_add_u32 s31, s31, 0x40000
    s_mov_b32 s49, 0
    s_waitcnt vmcnt(0) lgkmcnt(0)
    s_barrier
    ds_write_b128 v123, v[64:67] offset:32768
    ds_write_b128 v123, v[68:71] offset:33792
    ds_write_b128 v123, v[72:75] offset:34816
    ds_write_b128 v123, v[76:79] offset:35840
    ds_write_b128 v123, v[104:107] offset:36864
    ds_write_b128 v123, v[108:111] offset:37888
    ds_write_b128 v123, v[32:35] offset:38912
    ds_write_b128 v123, v[36:39] offset:39936
    v_mov_b32 v32, 0
    v_mov_b32 v33, 0
    v_mov_b32 v34, 0
    v_mov_b32 v35, 0
    v_mov_b32 v36, 0
    v_mov_b32 v37, 0
    v_mov_b32 v38, 0
    v_mov_b32 v39, 0
    s_nop 4
    s_cmp_eq_u32 s21, 1
    s_cbranch_scc1 L_chain_top1_s
    s_cmp_eq_u32 s21, 2
    s_cbranch_scc1 L_chain_top2_s
    s_cmp_eq_u32 s21, 3
    s_cbranch_scc1 L_chain_top3_s
.p2align 6
L_chain_top0_s:
    buffer_load_dwordx4 v[0:3], v117, s[8:11], s23 offen sc1
    v_mov_b32 v15, 0
    v_mov_b32 v15, 0
    v_mov_b32 v15, 0
    v_mov_b32 v15, 0
    v_mov_b32 v15, 0
    v_mov_b32 v15, 0
    v_mov_b32 v15, 0
    v_mov_b32 v15, 0
    v_mov_b32 v15, 0
    v_mov_b32 v15, 0
    v_mov_b32 v15, 0
    v_mov_b32 v15, 0
    v_mov_b32 v15, 0
    v_mov_b32 v15, 0
    v_mov_b32 v15, 0
    v_mov_b32 v15, 0
    buffer_load_dwordx4 v[0:3], v117, s[8:11], s23 offen sc1
    v_mov_b32 v15, 0
    v_mov_b32 v15, 0
    v_mov_b32 v15, 0
    v_mov_b32 v15, 0
    v_mov_b32 v15, 0
    v_mov_b32 v15, 0
    v_mov_b32 v15, 0
    v_mov_b32 v15, 0
    v_mov_b32 v15, 0
    v_mov_b32 v15, 0
    v_mov_b32 v15, 0
    v_mov_b32 v15, 0
    v_mov_b32 v15, 0
    v_mov_b32 v15, 0
    v_mov_b32 v15, 0
    v_mov_b32 v15, 0
L_mret_58:
    buffer_load_dwordx4 v[0:3], v117, s[8:11], s23 offen sc1
    s_add_u32 s45, s45, 1
    s_cmp_lt_u32 s45, 0x10000
    s_cselect_b32 s56, -2, -1
    s_nop 3
    v_mov_b32 v32, 0
    v_mov_b32 v33, 0
    v_mov_b32 v34, 0
    v_mov_b32 v35, 0
    s_waitcnt vmcnt(2)
    v_max3_u32 v15, v0, v1, v2
    v_max_u32 v15, v15, v3
    v_cmp_lt_u32 vcc, s56, v15
    v_smfmac_f32_16x16x64_bf16 v[32:35], v[0:3], v[80:87], v116
    s_cbranch_vccnz L_mret_58
    ds_write_b128 v117, v[0:3]
    v_smfmac_f32_16x16x64_bf16 v[36:39], v[0:3], v[56:63], v116
    buffer_load_dwordx4 v[4:7], v117, s[8:11], s48 offen sc1
    v_smfmac_f32_16x16x64_bf16 v[40:43], v[0:3], v[64:71], v116
    buffer_load_dwordx4 v117, s[8:11], s48 offen sc1 lds
    s_mov_b32 m0, 8192
    v_smfmac_f32_16x16x64_bf16 v[44:47], v[0:3], v[72:79], v116
    s_waitcnt lgkmcnt(0)
    s_barrier
    ds_read_b128 v[8:11], v117 offset:1024
    v_smfmac_f32_16x16x64_bf16 v[48:51], v[0:3], a[192:199], v116
    ds_read_b128 v[16:19], v117 offset:2048
    ds_read_b128 v[20:23], v117 offset:3072
    v_smfmac_f32_16x16x64_bf16 v[52:55], v[0:3], a[200:207], v116
    ds_read_b128 v[80:83], v117 offset:14336
    s_waitcnt lgkmcnt(3)
    v_smfmac_f32_16x16x64_bf16 v[32:35], v[8:11], a[0:7], v116
    ds_read_b128 v[84:87], v117 offset:15360
    v_smfmac_f32_16x16x64_bf16 v[36:39], v[8:11], a[8:15], v116
    buffer_store_dwordx4 v[112:115], v117, s[8:11], s32 offen sc1
    s_waitcnt lgkmcnt(3)
    v_smfmac_f32_16x16x64_bf16 v[32:35], v[16:19], a[32:39], v116
    ds_read_b128 v[56:59], v117 offset:8192
    v_smfmac_f32_16x16x64_bf16 v[36:39], v[16:19], a[40:47], v116
    ds_read_b128 v[60:63], v117 offset:9216
    s_waitcnt lgkmcnt(4)
    v_smfmac_f32_16x16x64_bf16 v[32:35], v[20:23], a[64:71], v116
    ds_read_b128 v[64:67], v117 offset:10240
    v_smfmac_f32_16x16x64_bf16 v[36:39], v[20:23], a[72:79], v116
    ds_read_b128 v[68:71], v117 offset:11264
    v_smfmac_f32_16x16x64_bf16 v[40:43], v[8:11], a[96:103], v116
    ds_read_b128 v[72:75], v117 offset:12288
    v_smfmac_f32_16x16x64_bf16 v[40:43], v[16:19], a[128:135], v116
    ds_read_b128 v[76:79], v117 offset:13312
    v_smfmac_f32_16x16x64_bf16 v[40:43], v[20:23], a[160:167], v116
    s_waitcnt vmcnt(2)
    v_max3_u32 v15, v4, v5, v6
    v_smfmac_f32_16x16x64_bf16 v[44:47], v[8:11], a[104:111], v116
    v_max_u32 v15, v15, v7
    v_smfmac_f32_16x16x64_bf16 v[44:47], v[16:19], a[136:143], v116
    s_waitcnt vmcnt(1) lgkmcnt(0)
    v_cmp_lt_u32 vcc, s56, v15
    v_smfmac_f32_16x16x64_bf16 v[44:47], v[20:23], a[168:175], v116
    s_cbranch_vccnz L_mret_59
L_mgo_60:
    v_smfmac_f32_16x16x64_bf16 v[44:47], v[4:7], v[24:31], v116
    s_barrier
    ds_read_b128 v[12:15], v117 offset:5120
    v_smfmac_f32_16x16x64_bf16 v[32:35], v[4:7], v[88:95], v116
    ds_read_b128 v[24:27], v117 offset:6144
    v_smfmac_f32_16x16x64_bf16 v[36:39], v[4:7], v[96:103], v116
    ds_read_b128 v[28:31], v117 offset:7168
    v_smfmac_f32_16x16x64_bf16 v[40:43], v[4:7], v[104:111], v116
    ds_read_b128 v[88:91], v117 offset:24576
    s_waitcnt lgkmcnt(3)
    v_smfmac_f32_16x16x64_bf16 v[32:35], v[12:15], a[16:23], v116
    ds_read_b128 v[92:95], v117 offset:25600
    s_waitcnt lgkmcnt(3)
    v_smfmac_f32_16x16x64_bf16 v[32:35], v[24:27], a[48:55], v116
    buffer_load_dwordx4 v117, s[8:11], s30 offen lds
    s_waitcnt lgkmcnt(2)
    v_smfmac_f32_16x16x64_bf16 v[32:35], v[28:31], a[80:87], v116
    ds_read_b128 v[96:99], v117 offset:23552
    v_smfmac_f32_16x16x64_bf16 v[36:39], v[12:15], a[24:31], v116
    ds_read_b128 v[100:103], v117 offset:23552
    v_smfmac_f32_16x16x64_bf16 v[36:39], v[24:27], a[56:63], v116
    buffer_load_dwordx4 v117, s[8:11], s30 offen offset:1024 lds
    s_add_u32 m0, s52, 0x6000
    v_add_f32 v32, v32, v34
    v_smfmac_f32_16x16x64_bf16 v[36:39], v[28:31], a[88:95], v116
    ds_read_b128 v[104:107], v117 offset:23552
    v_add_f32 v33, v33, v35
    v_smfmac_f32_16x16x64_bf16 v[40:43], v[12:15], a[112:119], v116
    ds_read_b128 v[108:111], v117 offset:23552
    v_mul_f32 v32, s34, v32
    v_smfmac_f32_16x16x64_bf16 v[40:43], v[24:27], a[144:151], v116
    buffer_load_dword v125, v119, s[8:11], s28 offen sc1
    v_mul_f32 v33, s34, v33
    v_smfmac_f32_16x16x64_bf16 v[40:43], v[28:31], a[176:183], v116
    ds_read_b128 v[0:3], v124
    v_add_f32 v36, v36, v38
    v_smfmac_f32_16x16x64_bf16 v[48:51], v[4:7], a[208:215], v116
    v_add_f32 v37, v37, v39
    v_smfmac_f32_16x16x64_bf16 v[52:55], v[4:7], a[216:223], v116
    s_waitcnt lgkmcnt(5)
    buffer_load_dwordx4 v117, s[8:11], s31 offen lds
    v_mul_f32 v36, s34, v36
    v_smfmac_f32_16x16x64_bf16 v[44:47], v[12:15], a[120:127], v116
    ds_read_b128 v[4:7], v124 offset:1024
    v_mul_f32 v37, s34, v37
    v_smfmac_f32_16x16x64_bf16 v[44:47], v[24:27], a[152:159], v116
    v_cvt_pk_bf16_f32 v34, v32, v36
    v_smfmac_f32_16x16x64_bf16 v[44:47], v[28:31], a[184:191], v116
    buffer_load_dwordx4 v117, s[8:11], s31 offen offset:1024 lds
    s_mov_b32 m0, 4096
    v_cvt_pk_bf16_f32 v35, v33, v37
    v_add_f32 v40, v40, v42
    v_smfmac_f32_16x16x64_bf16 v[48:51], v[8:11], a[224:231], v116
    ds_write2_b32 v120, v34, v35 offset0:32 offset1:48
    v_add_f32 v41, v41, v43
    v_smfmac_f32_16x16x64_bf16 v[52:55], v[8:11], a[232:239], v116
    v_add_f32 v44, v44, v46
    v_add_f32 v45, v45, v47
    v_cvt_pk_bf16_f32 v113, v40, v44
    v_cvt_pk_bf16_f32 v115, v41, v45
    v_smfmac_f32_16x16x64_bf16 v[48:51], v[12:15], a[240:247], v116
    ds_write2_b32 v120, v113, v115 offset0:0 offset1:16
    v_smfmac_f32_16x16x64_bf16 v[52:55], v[12:15], a[248:255], v116
    s_cmp_eq_u32 s22, 63
    s_cbranch_scc1 L_chain_last_s
    buffer_store_dword v126, off, s[8:11], s44 sc1
    v_smfmac_f32_16x16x64_bf16 v[48:51], v[16:19], v[128:135], v116
    v_smfmac_f32_16x16x64_bf16 v[48:51], v[20:23], v[160:167], v116
    v_smfmac_f32_16x16x64_bf16 v[48:51], v[24:27], v[144:151], v116
    s_waitcnt lgkmcnt(0)
    s_barrier
    v_smfmac_f32_16x16x64_bf16 v[48:51], v[28:31], v[176:183], v116
    ds_read_b128 v[32:35], v121 offset:16384
    ds_read_b128 v[36:39], v121 offset:17408
    v_smfmac_f32_16x16x64_bf16 v[52:55], v[16:19], v[136:143], v116
    ds_read_b128 v[40:43], v121 offset:18432
    ds_read_b128 v[44:47], v121 offset:19456
    v_smfmac_f32_16x16x64_bf16 v[52:55], v[20:23], v[168:175], v116
    ds_read_b128 v[8:11], v124 offset:32768
    v_add_f32 v48, v48, v50
    v_smfmac_f32_16x16x64_bf16 v[52:55], v[24:27], v[152:159], v116
    ds_read_b128 v[12:15], v124 offset:33792
    v_add_f32 v49, v49, v51
    v_smfmac_f32_16x16x64_bf16 v[52:55], v[28:31], v[184:191], v116
    s_waitcnt lgkmcnt(5)
    v_cvt_pk_bf16_f32 v112, v48, v49
    v_mfma_f32_16x16x32_bf16 v[56:59], v[56:59], v[32:35], 0
    s_waitcnt lgkmcnt(4)
    v_mov_b32 v48, s50
    v_mov_b32 v49, s50
    v_mfma_f32_16x16x32_bf16 v[56:59], v[60:63], v[36:39], v[56:59]
    ds_read_b128 v[16:19], v124 offset:2048
    s_waitcnt lgkmcnt(4)
    v_mov_b32 v50, s50
    v_mov_b32 v51, s50
    v_mfma_f32_16x16x32_bf16 v[56:59], v[64:67], v[40:43], v[56:59]
    ds_read_b128 v[20:23], v124 offset:3072
    s_waitcnt lgkmcnt(4)
    v_add_f32 v52, v52, v54
    v_mfma_f32_16x16x32_bf16 v[56:59], v[68:71], v[44:47], v[56:59]
    ds_read_b128 v[24:27], v124 offset:4096
    v_add_f32 v53, v53, v55
    v_mfma_f32_16x16x32_bf16 v[60:63], v[72:75], v[32:35], 0
    ds_read_b128 v[28:31], v124 offset:5120
    v_cvt_pk_bf16_f32 v114, v52, v53
    v_mov_b32 v53, 0
    v_mfma_f32_16x16x32_bf16 v[60:63], v[76:79], v[36:39], v[60:63]
    v_exp_f32 v56, v56
    v_mfma_f32_16x16x32_bf16 v[60:63], v[80:83], v[40:43], v[60:63]
    v_exp_f32 v57, v57
    v_mfma_f32_16x16x32_bf16 v[60:63], v[84:87], v[44:47], v[60:63]
    v_exp_f32 v58, v58
    v_mfma_f32_16x16x32_bf16 v[64:67], v[32:35], v[32:35], 0
    v_exp_f32 v59, v59
    v_cvt_pk_bf16_f32 v68, v56, v57
    v_mfma_f32_16x16x32_bf16 v[64:67], v[36:39], v[36:39], v[64:67]
    v_exp_f32 v60, v60
    v_cvt_pk_bf16_f32 v69, v58, v59
    v_mfma_f32_16x16x32_bf16 v[64:67], v[40:43], v[40:43], v[64:67]
    v_exp_f32 v61, v61
    v_mfma_f32_16x16x32_bf16 v[64:67], v[44:47], v[44:47], v[64:67]
    v_exp_f32 v62, v62
    v_exp_f32 v63, v63
    v_cvt_pk_bf16_f32 v70, v60, v61
    v_cvt_pk_bf16_f32 v71, v62, v63
    s_nop 1
    v_mfma_f32_16x16x32_bf16 v[72:75], v[88:91], v[68:71], 0
    s_nop 0
    v_exp_f32 v64, v64
    v_mfma_f32_16x16x32_bf16 v[76:79], v[92:95], v[68:71], 0
    v_exp_f32 v65, v65
    v_mfma_f32_16x16x32_bf16 v[80:83], v[48:51], v[68:71], 0
    v_cvt_pk_bf16_f32 v52, v64, v65
    s_nop 1
    v_mfma_f32_16x16x16_bf16 v[72:75], v[112:113], v[52:53], v[72:75]
    ds_read_b128 v[32:35], v124 offset:6144
    v_mfma_f32_16x16x16_bf16 v[76:79], v[114:115], v[52:53], v[76:79]
    ds_read_b128 v[36:39], v124 offset:7168
    v_mfma_f32_16x16x16_bf16 v[80:83], v[48:49], v[52:53], v[80:83]
L_norm_61:
    s_mov_b64 vcc, s[36:37]
    v_mov_b32 v122, v122
    v_mov_b32 v122, v122
    v_mov_b32 v122, v122
    v_cndmask_b32_dpp v76, v72, v76, vcc quad_perm:[2,3,2,3] row_mask:0xf bank_mask:0xf
    v_cndmask_b32_dpp v77, v73, v77, vcc quad_perm:[2,3,2,3] row_mask:0xf bank_mask:0xf
    v_cndmask_b32_dpp v78, v74, v78, vcc quad_perm:[2,3,2,3] row_mask:0xf bank_mask:0xf
    v_cndmask_b32_dpp v79, v75, v79, vcc quad_perm:[2,3,2,3] row_mask:0xf bank_mask:0xf
    v_rcp_f32_dpp v84, v80 quad_perm:[2,3,2,3] row_mask:0xf bank_mask:0xf
    s_nop 0
    v_pk_mul_f32 v[76:77], v[76:77], v[84:85] op_sel_hi:[1,0]
    v_pk_mul_f32 v[78:79], v[78:79], v[84:85] op_sel_hi:[1,0]
    v_cvt_pk_bf16_f32 v72, v76, v77
    v_cvt_pk_bf16_f32 v73, v78, v79
    ds_write_b64 v122, v[72:73] offset:20480
    v_max_f32_dpp v86, v80, v84 quad_perm:[2,3,2,3] row_mask:0xf bank_mask:0xf
    v_mov_b32_dpp v60, v72 quad_perm:[0,1,0,1] row_mask:0xf bank_mask:0xf
    v_mov_b32_dpp v61, v73 quad_perm:[0,1,0,1] row_mask:0xf bank_mask:0xf
    v_cmp_lt_f32 vcc, s35, v86
    v_mov_b32_dpp v62, v72 quad_perm:[2,3,2,3] row_mask:0xf bank_mask:0xf
    v_mov_b32_dpp v63, v73 quad_perm:[2,3,2,3] row_mask:0xf bank_mask:0xf
    s_nop 1
    v_smfmac_f32_16x16x64_bf16 v[96:99], v[60:63], v[192:199], v116
    s_cbranch_vccnz L_smax_62
    v_smfmac_f32_16x16x64_bf16 v[100:103], v[60:63], v[224:231], v116
    s_waitcnt lgkmcnt(0)
    s_barrier
    ds_read_b128 v[92:95], v127 offset:20992
    ds_read_b128 v[80:83], v127 offset:21504
    ds_read_b128 v[84:87], v127 offset:22016
    v_smfmac_f32_16x16x64_bf16 v[104:107], v[60:63], v[0:7], v116
    ds_read_b128 v[40:43], v124 offset:34816
    v_smfmac_f32_16x16x64_bf16 v[108:111], v[60:63], v[8:15], v116
    ds_read_b128 v[56:59], v124 offset:36864
    s_waitcnt lgkmcnt(4)
    v_smfmac_f32_16x16x64_bf16 v[96:99], v[92:95], v[200:207], v116
    s_waitcnt lgkmcnt(3)
    v_smfmac_f32_16x16x64_bf16 v[96:99], v[80:83], v[208:215], v116
    ds_read_b128 v[44:47], v124 offset:35840
    s_waitcnt lgkmcnt(3)
    v_smfmac_f32_16x16x64_bf16 v[96:99], v[84:87], v[216:223], v116
    ds_read_b128 v[68:71], v124 offset:39936
    v_smfmac_f32_16x16x64_bf16 v[100:103], v[92:95], v[232:239], v116
    ds_read_b128 v[64:67], v124 offset:38912
    v_smfmac_f32_16x16x64_bf16 v[100:103], v[80:83], v[240:247], v116
    ds_read_b128 v[60:63], v124 offset:37888
    v_cvt_pk_bf16_f32 v72, v96, v98
    v_smfmac_f32_16x16x64_bf16 v[100:103], v[84:87], v[248:255], v116
    v_and_or_b32 v72, v72, -2, s33
    v_smfmac_f32_16x16x64_bf16 v[104:107], v[92:95], v[16:23], v116
    v_cvt_pk_bf16_f32 v74, v97, v99
    v_smfmac_f32_16x16x64_bf16 v[104:107], v[80:83], v[24:31], v116
    v_cvt_pk_bf16_f32 v73, v100, v102
    v_cvt_pk_bf16_f32 v75, v101, v103
    v_smfmac_f32_16x16x64_bf16 v[104:107], v[84:87], v[32:39], v116
    buffer_store_dwordx4 v[72:75], v118, s[8:11], s25 offen sc1
    s_waitcnt lgkmcnt(3)
    v_smfmac_f32_16x16x64_bf16 v[108:111], v[92:95], v[40:47], v116
    s_waitcnt lgkmcnt(0)
    v_smfmac_f32_16x16x64_bf16 v[108:111], v[80:83], v[56:63], v116
    v_cvt_pk_bf16_f32 v76, v104, v106
    v_smfmac_f32_16x16x64_bf16 v[108:111], v[84:87], v[64:71], v116
    v_and_or_b32 v76, v76, -2, s33
    v_cvt_pk_bf16_f32 v78, v105, v107
    v_mov_b32 v122, v122
    v_mov_b32 v122, v122
    v_mov_b32 v122, v122
    v_mov_b32 v122, v122
    v_mov_b32 v122, v122
    v_mov_b32 v122, v122
    v_cvt_pk_bf16_f32 v77, v108, v110
    v_cvt_pk_bf16_f32 v79, v109, v111
    buffer_store_dwordx4 v[76:79], v118, s[8:11], s26 offen sc1
    s_add_u32 s30, s30, 0x40000
    s_add_u32 s31, s31, 0x40000
    s_add_u32 s32, s32, 0x20000
    s_add_u32 s23, s24, 0
    s_add_u32 s48, s23, 4096
    s_xor_b32 s25, s25, 0x40000
    s_xor_b32 s26, s26, 0x40000
    s_mov_b32 s35, 0x49800000
    v_mov_b32 v126, s22
    s_add_u32 s22, s22, 1
    v_mov_b32 v32, 0
    v_mov_b32 v33, 0
    v_mov_b32 v34, 0
    v_mov_b32 v35, 0
    v_mov_b32 v36, 0
    v_mov_b32 v37, 0
    v_mov_b32 v38, 0
    v_mov_b32 v39, 0
    v_mov_b32 v40, 0
    v_mov_b32 v41, 0
    v_mov_b32 v42, 0
    v_mov_b32 v43, 0
    v_mov_b32 v44, 0
    v_mov_b32 v45, 0
    v_mov_b32 v46, 0
    v_mov_b32 v47, 0
    v_mov_b32 v48, 0
    v_mov_b32 v49, 0
    v_mov_b32 v50, 0
    v_mov_b32 v51, 0
    v_mov_b32 v52, 0
    v_mov_b32 v53, 0
    v_mov_b32 v54, 0
    v_mov_b32 v55, 0
    ds_read_b128 v[80:83], v123
    ds_read_b128 v[84:87], v123 offset:1024
    ds_read_b128 v[56:59], v123 offset:2048
    ds_read_b128 v[60:63], v123 offset:3072
    ds_read_b128 v[64:67], v123 offset:32768
    ds_read_b128 v[68:71], v123 offset:33792
    ds_read_b128 v[72:75], v123 offset:34816
    ds_read_b128 v[76:79], v123 offset:35840
    ds_read_b128 v[88:91], v123 offset:4096
    ds_read_b128 v[92:95], v123 offset:5120
    ds_read_b128 v[96:99], v123 offset:6144
    ds_read_b128 v[100:103], v123 offset:7168
    ds_read_b128 v[104:107], v123 offset:36864
    ds_read_b128 v[108:111], v123 offset:37888
    ds_read_b128 v[24:27], v123 offset:38912
    ds_read_b128 v[28:31], v123 offset:39936
    s_add_u32 s24, s24, 8192
    s_bitset0_b32 s24, 15
    s_xor_b32 s55, s24, 16384
    s_xor_b32 s29, s29, 0x40000
    s_xor_b32 s53, s29, 1024
    s_bfe_u32 s33, s22, 0x10001
    s_add_u32 s40, s22, 5
    s_lshr_b32 s40, s40, 2
    s_min_u32 s40, s40, 16
    s_bfm_b32 s58, s40, 0
    s_waitcnt vmcnt(5)
    v_cmp_eq_u32 vcc, 0, v125
    s_nop 0
    s_and_b64 vcc, vcc, s[58:59]
    s_cbranch_scc1 L_kvw_63
L_kvb_64:
    v_mov_b32 v15, 0
    s_nop 2
    v_mov_b32 v15, 0
    s_nop 2
    v_mov_b32 v15, 0
    s_nop 2
    v_mov_b32 v15, 0
    s_nop 2
    v_mov_b32 v15, 0
    s_nop 2
    v_mov_b32 v15, 0
    s_nop 2
    v_mov_b32 v15, 0
    s_nop 2
    v_mov_b32 v15, 0
    s_nop 2
    v_mov_b32 v15, 0
    s_nop 2
    v_mov_b32 v15, 0
    s_nop 2
    v_mov_b32 v15, 0
    s_nop 2
    v_mov_b32 v15, 0
    s_nop 2
    v_mov_b32 v15, 0
    s_nop 2
    v_mov_b32 v15, 0
    s_nop 2
    v_mov_b32 v15, 0
    s_nop 2
    v_mov_b32 v15, 0
    s_nop 2
    v_mov_b32 v15, 0
    s_nop 2
    v_mov_b32 v15, 0
    s_nop 2
    v_mov_b32 v15, 0
    s_nop 2
    v_mov_b32 v15, 0
    s_nop 2
    v_mov_b32 v15, 0
    s_nop 2
    v_mov_b32 v15, 0
    s_nop 2
    v_mov_b32 v15, 0
    s_nop 2
    v_mov_b32 v15, 0
    s_nop 2
    v_mov_b32 v15, 0
    s_nop 2
    v_mov_b32 v15, 0
    s_nop 2
    v_mov_b32 v15, 0
    s_nop 2
    v_mov_b32 v15, 0
    s_nop 2
    v_mov_b32 v15, 0
    s_nop 2
    v_mov_b32 v15, 0
    s_nop 2
    v_mov_b32 v15, 0
    s_nop 2
    s_waitcnt lgkmcnt(0)
    s_branch L_chain_top0_s
.p2align 6
L_chain_top1_s:
    buffer_load_dwordx4 v[0:3], v117, s[8:11], s23 offen sc1
    v_mov_b32 v15, 0
    v_mov_b32 v15, 0
    v_mov_b32 v15, 0
    v_mov_b32 v15, 0
    v_mov_b32 v15, 0
    v_mov_b32 v15, 0
    v_mov_b32 v15, 0
    v_mov_b32 v15, 0
    v_mov_b32 v15, 0
    v_mov_b32 v15, 0
    v_mov_b32 v15, 0
    v_mov_b32 v15, 0
    v_mov_b32 v15, 0
    v_mov_b32 v15, 0
    v_mov_b32 v15, 0
    v_mov_b32 v15, 0
    buffer_load_dwordx4 v[0:3], v117, s[8:11], s23 offen sc1
    v_mov_b32 v15, 0
    v_mov_b32 v15, 0
    v_mov_b32 v15, 0
    v_mov_b32 v15, 0
    v_mov_b32 v15, 0
    v_mov_b32 v15, 0
    v_mov_b32 v15, 0
    v_mov_b32 v15, 0
    v_mov_b32 v15, 0
    v_mov_b32 v15, 0
    v_mov_b32 v15, 0
    v_mov_b32 v15, 0
    v_mov_b32 v15, 0
    v_mov_b32 v15, 0
    v_mov_b32 v15, 0
    v_mov_b32 v15, 0
L_mret_65:
    buffer_load_dwordx4 v[0:3], v117, s[8:11], s23 offen sc1
    s_add_u32 s45, s45, 1
    s_cmp_lt_u32 s45, 0x10000
    s_cselect_b32 s56, -2, -1
    s_nop 3
    v_mov_b32 v32, 0
    v_mov_b32 v33, 0
    v_mov_b32 v34, 0
    v_mov_b32 v35, 0
    s_waitcnt vmcnt(2)
    v_max3_u32 v15, v0, v1, v2
    v_max_u32 v15, v15, v3
    v_cmp_lt_u32 vcc, s56, v15
    v_smfmac_f32_16x16x64_bf16 v[32:35], v[0:3], v[80:87], v116
    s_cbranch_vccnz L_mret_65
    ds_write_b128 v117, v[0:3] offset:1024
    v_smfmac_f32_16x16x64_bf16 v[36:39], v[0:3], v[56:63], v116
    buffer_load_dwordx4 v[4:7], v117, s[8:11], s48 offen sc1
    v_smfmac_f32_16x16x64_bf16 v[40:43], v[0:3], v[64:71], v116
    buffer_load_dwordx4 v117, s[8:11], s48 offen sc1 lds
    s_mov_b32 m0, 10240
    v_smfmac_f32_16x16x64_bf16 v[44:47], v[0:3], v[72:79], v116
    s_waitcnt lgkmcnt(0)
    s_barrier
    ds_read_b128 v[8:11], v117
    v_smfmac_f32_16x16x64_bf16 v[48:51], v[0:3], a[192:199], v116
    ds_read_b128 v[16:19], v117 offset:3072
    ds_read_b128 v[20:23], v117 offset:2048
    v_smfmac_f32_16x16x64_bf16 v[52:55], v[0:3], a[200:207], v116
    ds_read_b128 v[80:83], v117 offset:14336
    s_waitcnt lgkmcnt(3)
    v_smfmac_f32_16x16x64_bf16 v[32:35], v[8:11], a[0:7], v116
    ds_read_b128 v[84:87], v117 offset:15360
    v_smfmac_f32_16x16x64_bf16 v[36:39], v[8:11], a[8:15], v116
    ds_read_b128 v[56:59], v117 offset:8192
    s_waitcnt lgkmcnt(4)
    v_smfmac_f32_16x16x64_bf16 v[32:35], v[16:19], a[32:39], v116
    ds_read_b128 v[60:63], v117 offset:9216
    v_smfmac_f32_16x16x64_bf16 v[36:39], v[16:19], a[40:47], v116
    buffer_store_dwordx4 v[112:115], v117, s[8:11], s32 offen sc1
    s_waitcnt lgkmcnt(4)
    v_smfmac_f32_16x16x64_bf16 v[32:35], v[20:23], a[64:71], v116
    ds_read_b128 v[64:67], v117 offset:10240
    v_smfmac_f32_16x16x64_bf16 v[36:39], v[20:23], a[72:79], v116
    ds_read_b128 v[68:71], v117 offset:11264
    v_smfmac_f32_16x16x64_bf16 v[40:43], v[8:11], a[96:103], v116
    ds_read_b128 v[72:75], v117 offset:12288
    v_smfmac_f32_16x16x64_bf16 v[40:43], v[16:19], a[128:135], v116
    ds_read_b128 v[76:79], v117 offset:13312
    v_smfmac_f32_16x16x64_bf16 v[40:43], v[20:23], a[160:167], v116
    s_waitcnt vmcnt(2)
    v_max3_u32 v15, v4, v5, v6
    v_smfmac_f32_16x16x64_bf16 v[44:47], v[8:11], a[104:111], v116
    v_max_u32 v15, v15, v7
    v_smfmac_f32_16x16x64_bf16 v[44:47], v[16:19], a[136:143], v116
    s_waitcnt vmcnt(1) lgkmcnt(0)
    v_cmp_lt_u32 vcc, s56, v15
    v_smfmac_f32_16x16x64_bf16 v[44:47], v[20:23], a[168:175], v116
    s_cbranch_vccnz L_mret_66
L_mgo_67:
    v_smfmac_f32_16x16x64_bf16 v[44:47], v[4:7], v[24:31], v116
    s_barrier
    ds_read_b128 v[12:15], v117 offset:4096
    v_smfmac_f32_16x16x64_bf16 v[32:35], v[4:7], v[88:95], v116
    ds_read_b128 v[24:27], v117 offset:7168
    v_smfmac_f32_16x16x64_bf16 v[36:39], v[4:7], v[96:103], v116
    ds_read_b128 v[28:31], v117 offset:6144
    v_smfmac_f32_16x16x64_bf16 v[40:43], v[4:7], v[104:111], v116
    ds_read_b128 v[88:91], v117 offset:26624
    s_waitcnt lgkmcnt(3)
    v_smfmac_f32_16x16x64_bf16 v[32:35], v[12:15], a[16:23], v116
    ds_read_b128 v[92:95], v117 offset:27648
    s_waitcnt lgkmcnt(3)
    v_smfmac_f32_16x16x64_bf16 v[32:35], v[24:27], a[48:55], v116
    buffer_load_dwordx4 v117, s[8:11], s30 offen lds
    s_waitcnt lgkmcnt(2)
    v_smfmac_f32_16x16x64_bf16 v[32:35], v[28:31], a[80:87], v116
    ds_read_b128 v[96:99], v117 offset:23552
    v_smfmac_f32_16x16x64_bf16 v[36:39], v[12:15], a[24:31], v116
    ds_read_b128 v[100:103], v117 offset:23552
    v_smfmac_f32_16x16x64_bf16 v[36:39], v[24:27], a[56:63], v116
    buffer_load_dwordx4 v117, s[8:11], s30 offen offset:1024 lds
    s_add_u32 m0, s52, 0x6000
    v_add_f32 v32, v32, v34
    v_smfmac_f32_16x16x64_bf16 v[36:39], v[28:31], a[88:95], v116
    ds_read_b128 v[104:107], v117 offset:23552
    v_add_f32 v33, v33, v35
    v_smfmac_f32_16x16x64_bf16 v[40:43], v[12:15], a[112:119], v116
    ds_read_b128 v[108:111], v117 offset:23552
    v_mul_f32 v32, s34, v32
    v_smfmac_f32_16x16x64_bf16 v[40:43], v[24:27], a[144:151], v116
    buffer_load_dword v125, v119, s[8:11], s28 offen sc1
    v_mul_f32 v33, s34, v33
    v_smfmac_f32_16x16x64_bf16 v[40:43], v[28:31], a[176:183], v116
    ds_read_b128 v[0:3], v124
    v_add_f32 v36, v36, v38
    v_smfmac_f32_16x16x64_bf16 v[48:51], v[4:7], a[208:215], v116
    v_add_f32 v37, v37, v39
    v_smfmac_f32_16x16x64_bf16 v[52:55], v[4:7], a[216:223], v116
    s_waitcnt lgkmcnt(5)
    buffer_load_dwordx4 v117, s[8:11], s31 offen lds
    v_mul_f32 v36, s34, v36
    v_smfmac_f32_16x16x64_bf16 v[44:47], v[12:15], a[120:127], v116
    ds_read_b128 v[4:7], v124 offset:1024
    v_mul_f32 v37, s34, v37
    v_smfmac_f32_16x16x64_bf16 v[44:47], v[24:27], a[152:159], v116
    v_cvt_pk_bf16_f32 v34, v32, v36
    v_smfmac_f32_16x16x64_bf16 v[44:47], v[28:31], a[184:191], v116
    buffer_load_dwordx4 v117, s[8:11], s31 offen offset:1024 lds
    s_mov_b32 m0, 5120
    v_cvt_pk_bf16_f32 v35, v33, v37
    v_add_f32 v40, v40, v42
    v_smfmac_f32_16x16x64_bf16 v[48:51], v[8:11], a[224:231], v116
    ds_write2_b32 v120, v34, v35 offset0:32 offset1:48
    v_add_f32 v41, v41, v43
    v_smfmac_f32_16x16x64_bf16 v[52:55], v[8:11], a[232:239], v116
    v_add_f32 v44, v44, v46
    v_add_f32 v45, v45, v47
    v_cvt_pk_bf16_f32 v113, v40, v44
    v_cvt_pk_bf16_f32 v115, v41, v45
    v_smfmac_f32_16x16x64_bf16 v[48:51], v[12:15], a[240:247], v116
    ds_write2_b32 v120, v113, v115 offset0:0 offset1:16
    v_smfmac_f32_16x16x64_bf16 v[52:55], v[12:15], a[248:255], v116
    s_cmp_eq_u32 s22, 63
    s_cbranch_scc1 L_chain_last_s
    v_smfmac_f32_16x16x64_bf16 v[48:51], v[16:19], v[128:135], v116
    v_smfmac_f32_16x16x64_bf16 v[48:51], v[20:23], v[160:167], v116
    v_smfmac_f32_16x16x64_bf16 v[48:51], v[24:27], v[144:151], v116
    s_waitcnt lgkmcnt(0)
    s_barrier
    v_smfmac_f32_16x16x64_bf16 v[48:51], v[28:31], v[176:183], v116
    ds_read_b128 v[32:35], v121 offset:16384
    ds_read_b128 v[36:39], v121 offset:17408
    v_smfmac_f32_16x16x64_bf16 v[52:55], v[16:19], v[136:143], v116
    ds_read_b128 v[40:43], v121 offset:18432
    ds_read_b128 v[44:47], v121 offset:19456
    v_smfmac_f32_16x16x64_bf16 v[52:55], v[20:23], v[168:175], v116
    ds_read_b128 v[8:11], v124 offset:32768
    v_add_f32 v48, v48, v50
    v_smfmac_f32_16x16x64_bf16 v[52:55], v[24:27], v[152:159], v116
    ds_read_b128 v[12:15], v124 offset:33792
    v_add_f32 v49, v49, v51
    v_smfmac_f32_16x16x64_bf16 v[52:55], v[28:31], v[184:191], v116
    s_waitcnt lgkmcnt(5)
    v_cvt_pk_bf16_f32 v112, v48, v49
    v_mfma_f32_16x16x32_bf16 v[56:59], v[56:59], v[32:35], 0
    s_waitcnt lgkmcnt(4)
    v_mov_b32 v48, s50
    v_mov_b32 v49, s50
    v_mfma_f32_16x16x32_bf16 v[56:59], v[60:63], v[36:39], v[56:59]
    ds_read_b128 v[16:19], v124 offset:2048
    s_waitcnt lgkmcnt(4)
    v_mov_b32 v50, s50
    v_mov_b32 v51, s50
    v_mfma_f32_16x16x32_bf16 v[56:59], v[64:67], v[40:43], v[56:59]
    ds_read_b128 v[20:23], v124 offset:3072
    s_waitcnt lgkmcnt(4)
    v_add_f32 v52, v52, v54
    v_mfma_f32_16x16x32_bf16 v[56:59], v[68:71], v[44:47], v[56:59]
    ds_read_b128 v[24:27], v124 offset:4096
    v_add_f32 v53, v53, v55
    v_mfma_f32_16x16x32_bf16 v[60:63], v[72:75], v[32:35], 0
    ds_read_b128 v[28:31], v124 offset:5120
    v_cvt_pk_bf16_f32 v114, v52, v53
    v_mov_b32 v53, 0
    v_mfma_f32_16x16x32_bf16 v[60:63], v[76:79], v[36:39], v[60:63]
    v_exp_f32 v56, v56
    v_mfma_f32_16x16x32_bf16 v[60:63], v[80:83], v[40:43], v[60:63]
    v_exp_f32 v57, v57
    v_mfma_f32_16x16x32_bf16 v[60:63], v[84:87], v[44:47], v[60:63]
    v_exp_f32 v58, v58
    v_mfma_f32_16x16x32_bf16 v[64:67], v[32:35], v[32:35], 0
    v_exp_f32 v59, v59
    v_cvt_pk_bf16_f32 v68, v56, v57
    v_mfma_f32_16x16x32_bf16 v[64:67], v[36:39], v[36:39], v[64:67]
    v_exp_f32 v60, v60
    v_cvt_pk_bf16_f32 v69, v58, v59
    v_mfma_f32_16x16x32_bf16 v[64:67], v[40:43], v[40:43], v[64:67]
    v_exp_f32 v61, v61
    v_mfma_f32_16x16x32_bf16 v[64:67], v[44:47], v[44:47], v[64:67]
    v_exp_f32 v62, v62
    v_exp_f32 v63, v63
    v_cvt_pk_bf16_f32 v70, v60, v61
    v_cvt_pk_bf16_f32 v71, v62, v63
    s_nop 1
    v_mfma_f32_16x16x32_bf16 v[72:75], v[88:91], v[68:71], 0
    s_nop 0
    v_exp_f32 v64, v64
    v_mfma_f32_16x16x32_bf16 v[76:79], v[92:95], v[68:71], 0
    v_exp_f32 v65, v65
    v_mfma_f32_16x16x32_bf16 v[80:83], v[48:51], v[68:71], 0
    v_cvt_pk_bf16_f32 v52, v64, v65
    s_nop 1
    v_mfma_f32_16x16x16_bf16 v[72:75], v[112:113], v[52:53], v[72:75]
    ds_read_b128 v[32:35], v124 offset:6144
    v_mfma_f32_16x16x16_bf16 v[76:79], v[114:115], v[52:53], v[76:79]
    ds_read_b128 v[36:39], v124 offset:7168
    v_mfma_f32_16x16x16_bf16 v[80:83], v[48:49], v[52:53], v[80:83]
L_norm_68:
    s_mov_b64 vcc, s[36:37]
    v_mov_b32 v122, v122
    v_mov_b32 v122, v122
    v_mov_b32 v122, v122
    v_cndmask_b32_dpp v76, v72, v76, vcc quad_perm:[2,3,2,3] row_mask:0xf bank_mask:0xf
    v_cndmask_b32_dpp v77, v73, v77, vcc quad_perm:[2,3,2,3] row_mask:0xf bank_mask:0xf
    v_cndmask_b32_dpp v78, v74, v78, vcc quad_perm:[2,3,2,3] row_mask:0xf bank_mask:0xf
    v_cndmask_b32_dpp v79, v75, v79, vcc quad_perm:[2,3,2,3] row_mask:0xf bank_mask:0xf
    v_rcp_f32_dpp v84, v80 quad_perm:[2,3,2,3] row_mask:0xf bank_mask:0xf
    s_nop 0
    v_pk_mul_f32 v[76:77], v[76:77], v[84:85] op_sel_hi:[1,0]
    v_pk_mul_f32 v[78:79], v[78:79], v[84:85] op_sel_hi:[1,0]
    v_cvt_pk_bf16_f32 v72, v76, v77
    v_cvt_pk_bf16_f32 v73, v78, v79
    ds_write_b64 v122, v[72:73] offset:20992
    v_max_f32_dpp v86, v80, v84 quad_perm:[2,3,2,3] row_mask:0xf bank_mask:0xf
    v_mov_b32_dpp v60, v72 quad_perm:[0,1,0,1] row_mask:0xf bank_mask:0xf
    v_mov_b32_dpp v61, v73 quad_perm:[0,1,0,1] row_mask:0xf bank_mask:0xf
    v_cmp_lt_f32 vcc, s35, v86
    v_mov_b32_dpp v62, v72 quad_perm:[2,3,2,3] row_mask:0xf bank_mask:0xf
    v_mov_b32_dpp v63, v73 quad_perm:[2,3,2,3] row_mask:0xf bank_mask:0xf
    s_nop 1
    v_smfmac_f32_16x16x64_bf16 v[96:99], v[60:63], v[192:199], v116
    s_cbranch_vccnz L_smax_69
    v_smfmac_f32_16x16x64_bf16 v[100:103], v[60:63], v[224:231], v116
    s_waitcnt lgkmcnt(0)
    s_barrier
    ds_read_b128 v[92:95], v127 offset:20480
    ds_read_b128 v[80:83], v127 offset:22016
    ds_read_b128 v[84:87], v127 offset:21504
    v_smfmac_f32_16x16x64_bf16 v[104:107], v[60:63], v[0:7], v116
    ds_read_b128 v[40:43], v124 offset:34816
    v_smfmac_f32_16x16x64_bf16 v[108:111], v[60:63], v[8:15], v116
    ds_read_b128 v[56:59], v124 offset:36864
    s_waitcnt lgkmcnt(4)
    v_smfmac_f32_16x16x64_bf16 v[96:99], v[92:95], v[200:207], v116
    s_waitcnt lgkmcnt(3)
    v_smfmac_f32_16x16x64_bf16 v[96:99], v[80:83], v[208:215], v116
    ds_read_b128 v[44:47], v124 offset:35840
    s_waitcnt lgkmcnt(3)
    v_smfmac_f32_16x16x64_bf16 v[96:99], v[84:87], v[216:223], v116
    ds_read_b128 v[68:71], v124 offset:39936
    v_smfmac_f32_16x16x64_bf16 v[100:103], v[92:95], v[232:239], v116
    ds_read_b128 v[64:67], v124 offset:38912
    v_smfmac_f32_16x16x64_bf16 v[100:103], v[80:83], v[240:247], v116
    ds_read_b128 v[60:63], v124 offset:37888
    v_cvt_pk_bf16_f32 v72, v96, v98
    v_smfmac_f32_16x16x64_bf16 v[100:103], v[84:87], v[248:255], v116
    v_and_or_b32 v72, v72, -2, s33
    v_smfmac_f32_16x16x64_bf16 v[104:107], v[92:95], v[16:23], v116
    v_cvt_pk_bf16_f32 v74, v97, v99
    v_smfmac_f32_16x16x64_bf16 v[104:107], v[80:83], v[24:31], v116
    v_cvt_pk_bf16_f32 v73, v100, v102
    v_cvt_pk_bf16_f32 v75, v101, v103
    v_smfmac_f32_16x16x64_bf16 v[104:107], v[84:87], v[32:39], v116
    buffer_store_dwordx4 v[72:75], v118, s[8:11], s25 offen sc1
    s_waitcnt lgkmcnt(3)
    v_smfmac_f32_16x16x64_bf16 v[108:111], v[92:95], v[40:47], v116
    s_waitcnt lgkmcnt(0)
    v_smfmac_f32_16x16x64_bf16 v[108:111], v[80:83], v[56:63], v116
    v_cvt_pk_bf16_f32 v76, v104, v106
    v_smfmac_f32_16x16x64_bf16 v[108:111], v[84:87], v[64:71], v116
    v_and_or_b32 v76, v76, -2, s33
    v_cvt_pk_bf16_f32 v78, v105, v107
    v_mov_b32 v122, v122
    v_mov_b32 v122, v122
    v_mov_b32 v122, v122
    v_mov_b32 v122, v122
    v_mov_b32 v122, v122
    v_mov_b32 v122, v122
    v_cvt_pk_bf16_f32 v77, v108, v110
    v_cvt_pk_bf16_f32 v79, v109, v111
    buffer_store_dwordx4 v[76:79], v118, s[8:11], s26 offen sc1
    s_add_u32 s30, s30, 0x40000
    s_add_u32 s31, s31, 0x40000
    s_add_u32 s32, s32, 0x20000
    s_add_u32 s23, s24, 1024
    s_add_u32 s48, s23, 4096
    s_xor_b32 s25, s25, 0x40000
    s_xor_b32 s26, s26, 0x40000
    s_mov_b32 s35, 0x49800000
    s_add_u32 s22, s22, 1
    v_mov_b32 v32, 0
    v_mov_b32 v33, 0
    v_mov_b32 v34, 0
    v_mov_b32 v35, 0
    v_mov_b32 v36, 0
    v_mov_b32 v37, 0
    v_mov_b32 v38, 0
    v_mov_b32 v39, 0
    v_mov_b32 v40, 0
    v_mov_b32 v41, 0
    v_mov_b32 v42, 0
    v_mov_b32 v43, 0
    v_mov_b32 v44, 0
    v_mov_b32 v45, 0
    v_mov_b32 v46, 0
    v_mov_b32 v47, 0
    v_mov_b32 v48, 0
    v_mov_b32 v49, 0
    v_mov_b32 v50, 0
    v_mov_b32 v51, 0
    v_mov_b32 v52, 0
    v_mov_b32 v53, 0
    v_mov_b32 v54, 0
    v_mov_b32 v55, 0
    ds_read_b128 v[80:83], v123
    ds_read_b128 v[84:87], v123 offset:1024
    ds_read_b128 v[56:59], v123 offset:2048
    ds_read_b128 v[60:63], v123 offset:3072
    ds_read_b128 v[64:67], v123 offset:32768
    ds_read_b128 v[68:71], v123 offset:33792
    ds_read_b128 v[72:75], v123 offset:34816
    ds_read_b128 v[76:79], v123 offset:35840
    ds_read_b128 v[88:91], v123 offset:4096
    ds_read_b128 v[92:95], v123 offset:5120
    ds_read_b128 v[96:99], v123 offset:6144
    ds_read_b128 v[100:103], v123 offset:7168
    ds_read_b128 v[104:107], v123 offset:36864
    ds_read_b128 v[108:111], v123 offset:37888
    ds_read_b128 v[24:27], v123 offset:38912
    ds_read_b128 v[28:31], v123 offset:39936
    s_add_u32 s24, s24, 8192
    s_bitset0_b32 s24, 15
    s_xor_b32 s55, s24, 16384
    s_xor_b32 s29, s29, 0x40000
    s_xor_b32 s53, s29, 1024
    s_bfe_u32 s33, s22, 0x10001
    s_add_u32 s40, s22, 5
    s_lshr_b32 s40, s40, 2
    s_min_u32 s40, s40, 16
    s_bfm_b32 s58, s40, 0
    s_waitcnt vmcnt(4)
    v_cmp_eq_u32 vcc, 0, v125
    s_nop 0
    s_and_b64 vcc, vcc, s[58:59]
    s_cbranch_scc1 L_kvw_70
L_kvb_71:
    v_mov_b32 v15, 0
    s_nop 2
    v_mov_b32 v15, 0
    s_nop 2
    v_mov_b32 v15, 0
    s_nop 2
    v_mov_b32 v15, 0
    s_nop 2
    v_mov_b32 v15, 0
    s_nop 2
    v_mov_b32 v15, 0
    s_nop 2
    v_mov_b32 v15, 0
    s_nop 2
    v_mov_b32 v15, 0
    s_nop 2
    v_mov_b32 v15, 0
    s_nop 2
    v_mov_b32 v15, 0
    s_nop 2
    v_mov_b32 v15, 0
    s_nop 2
    v_mov_b32 v15, 0
    s_nop 2
    v_mov_b32 v15, 0
    s_nop 2
    v_mov_b32 v15, 0
    s_nop 2
    v_mov_b32 v15, 0
    s_nop 2
    v_mov_b32 v15, 0
    s_nop 2
    v_mov_b32 v15, 0
    s_nop 2
    v_mov_b32 v15, 0
    s_nop 2
    v_mov_b32 v15, 0
    s_nop 2
    v_mov_b32 v15, 0
    s_nop 2
    v_mov_b32 v15, 0
    s_nop 2
    v_mov_b32 v15, 0
    s_nop 2
    v_mov_b32 v15, 0
    s_nop 2
    v_mov_b32 v15, 0
    s_nop 2
    v_mov_b32 v15, 0
    s_nop 2
    v_mov_b32 v15, 0
    s_nop 2
    v_mov_b32 v15, 0
    s_nop 2
    v_mov_b32 v15, 0
    s_nop 2
    v_mov_b32 v15, 0
    s_nop 2
    v_mov_b32 v15, 0
    s_nop 2
    v_mov_b32 v15, 0
    s_nop 2
    s_waitcnt lgkmcnt(0)
    s_branch L_chain_top1_s
.p2align 6
L_chain_top2_s:
    buffer_load_dwordx4 v[0:3], v117, s[8:11], s23 offen sc1
    v_mov_b32 v48, 0
    v_mov_b32 v49, 0
    v_mov_b32 v50, 0
    v_mov_b32 v51, 0
    v_mov_b32 v52, 0
    v_mov_b32 v53, 0
    v_mov_b32 v15, 0
    v_mov_b32 v15, 0
    v_mov_b32 v15, 0
    v_mov_b32 v15, 0
    v_mov_b32 v15, 0
    v_mov_b32 v15, 0
    v_mov_b32 v15, 0
    v_mov_b32 v15, 0
    v_mov_b32 v15, 0
    v_mov_b32 v15, 0
    buffer_load_dwordx4 v[0:3], v117, s[8:11], s23 offen sc1
    s_waitcnt vmcnt(3)
    v_mov_b32 v36, 0
    v_mov_b32 v37, 0
    v_mov_b32 v38, 0
    v_mov_b32 v39, 0
    v_mov_b32 v40, 0
    v_mov_b32 v41, 0
    v_mov_b32 v42, 0
    v_mov_b32 v43, 0
    v_mov_b32 v44, 0
    v_mov_b32 v45, 0
    v_mov_b32 v46, 0
    v_mov_b32 v47, 0
    v_mov_b32 v15, 0
    v_mov_b32 v15, 0
    v_mov_b32 v15, 0
    v_mov_b32 v15, 0
L_mret_72:
    buffer_load_dwordx4 v[0:3], v117, s[8:11], s23 offen sc1
    s_add_u32 s45, s45, 1
    s_cmp_lt_u32 s45, 0x10000
    s_cselect_b32 s56, -2, -1
    s_nop 3
    v_mov_b32 v32, 0
    v_mov_b32 v33, 0
    v_mov_b32 v34, 0
    v_mov_b32 v35, 0
    s_waitcnt vmcnt(2)
    v_max3_u32 v15, v0, v1, v2
    v_max_u32 v15, v15, v3
    v_cmp_lt_u32 vcc, s56, v15
    v_smfmac_f32_16x16x64_bf16 v[32:35], v[0:3], v[80:87], v116
    s_cbranch_vccnz L_mret_72
    ds_write_b128 v117, v[0:3] offset:2048
    v_smfmac_f32_16x16x64_bf16 v[36:39], v[0:3], v[56:63], v116
    buffer_load_dwordx4 v[4:7], v117, s[8:11], s48 offen sc1
    v_smfmac_f32_16x16x64_bf16 v[40:43], v[0:3], v[64:71], v116
    buffer_load_dwordx4 v117, s[8:11], s48 offen sc1 lds
    s_mov_b32 m0, 12288
    v_smfmac_f32_16x16x64_bf16 v[44:47], v[0:3], v[72:79], v116
    s_waitcnt lgkmcnt(0)
    s_barrier
    ds_read_b128 v[8:11], v117 offset:3072
    v_smfmac_f32_16x16x64_bf16 v[48:51], v[0:3], a[192:199], v116
    ds_read_b128 v[16:19], v117
    ds_read_b128 v[20:23], v117 offset:1024
    v_smfmac_f32_16x16x64_bf16 v[52:55], v[0:3], a[200:207], v116
    ds_read_b128 v[80:83], v117 offset:14336
    s_waitcnt lgkmcnt(3)
    v_smfmac_f32_16x16x64_bf16 v[32:35], v[8:11], a[0:7], v116
    ds_read_b128 v[84:87], v117 offset:15360
    v_smfmac_f32_16x16x64_bf16 v[36:39], v[8:11], a[8:15], v116
    ds_read_b128 v[56:59], v117 offset:8192
    s_waitcnt lgkmcnt(4)
    v_smfmac_f32_16x16x64_bf16 v[32:35], v[16:19], a[32:39], v116
    ds_read_b128 v[60:63], v117 offset:9216
    v_smfmac_f32_16x16x64_bf16 v[36:39], v[16:19], a[40:47], v116
    ds_read_b128 v[64:67], v117 offset:10240
    s_waitcnt lgkmcnt(5)
    v_smfmac_f32_16x16x64_bf16 v[32:35], v[20:23], a[64:71], v116
    ds_read_b128 v[68:71], v117 offset:11264
    v_smfmac_f32_16x16x64_bf16 v[36:39], v[20:23], a[72:79], v116
    buffer_store_dwordx4 v[112:115], v117, s[8:11], s32 offen sc1
    v_smfmac_f32_16x16x64_bf16 v[40:43], v[8:11], a[96:103], v116
    ds_read_b128 v[72:75], v117 offset:12288
    v_smfmac_f32_16x16x64_bf16 v[40:43], v[16:19], a[128:135], v116
    ds_read_b128 v[76:79], v117 offset:13312
    v_smfmac_f32_16x16x64_bf16 v[40:43], v[20:23], a[160:167], v116
    s_waitcnt vmcnt(2)
    v_max3_u32 v15, v4, v5, v6
    v_smfmac_f32_16x16x64_bf16 v[44:47], v[8:11], a[104:111], v116
    v_max_u32 v15, v15, v7
    v_smfmac_f32_16x16x64_bf16 v[44:47], v[16:19], a[136:143], v116
    s_waitcnt vmcnt(1) lgkmcnt(0)
    v_cmp_lt_u32 vcc, s56, v15
    v_smfmac_f32_16x16x64_bf16 v[44:47], v[20:23], a[168:175], v116
    s_cbranch_vccnz L_mret_73
L_mgo_74:
    v_smfmac_f32_16x16x64_bf16 v[44:47], v[4:7], v[24:31], v116
    s_barrier
    ds_read_b128 v[12:15], v117 offset:7168
    v_smfmac_f32_16x16x64_bf16 v[32:35], v[4:7], v[88:95], v116
    ds_read_b128 v[24:27], v117 offset:4096
    v_smfmac_f32_16x16x64_bf16 v[36:39], v[4:7], v[96:103], v116
    ds_read_b128 v[28:31], v117 offset:5120
    v_smfmac_f32_16x16x64_bf16 v[40:43], v[4:7], v[104:111], v116
    ds_read_b128 v[88:91], v117 offset:28672
    s_waitcnt lgkmcnt(3)
    v_smfmac_f32_16x16x64_bf16 v[32:35], v[12:15], a[16:23], v116
    ds_read_b128 v[92:95], v117 offset:29696
    s_waitcnt lgkmcnt(3)
    v_smfmac_f32_16x16x64_bf16 v[32:35], v[24:27], a[48:55], v116
    buffer_load_dwordx4 v117, s[8:11], s30 offen lds
    s_waitcnt lgkmcnt(2)
    v_smfmac_f32_16x16x64_bf16 v[32:35], v[28:31], a[80:87], v116
    ds_read_b128 v[96:99], v117 offset:23552
    v_smfmac_f32_16x16x64_bf16 v[36:39], v[12:15], a[24:31], v116
    ds_read_b128 v[100:103], v117 offset:23552
    v_smfmac_f32_16x16x64_bf16 v[36:39], v[24:27], a[56:63], v116
    buffer_load_dwordx4 v117, s[8:11], s30 offen offset:1024 lds
    s_add_u32 m0, s52, 0x6000
    v_add_f32 v32, v32, v34
    v_smfmac_f32_16x16x64_bf16 v[36:39], v[28:31], a[88:95], v116
    ds_read_b128 v[104:107], v117 offset:23552
    v_add_f32 v33, v33, v35
    v_smfmac_f32_16x16x64_bf16 v[40:43], v[12:15], a[112:119], v116
    ds_read_b128 v[108:111], v117 offset:23552
    v_mul_f32 v32, s34, v32
    v_smfmac_f32_16x16x64_bf16 v[40:43], v[24:27], a[144:151], v116
    s_waitcnt lgkmcnt(4)
    buffer_load_dwordx4 v117, s[8:11], s31 offen lds
    v_mul_f32 v33, s34, v33
    v_smfmac_f32_16x16x64_bf16 v[40:43], v[28:31], a[176:183], v116
    ds_read_b128 v[0:3], v124
    v_add_f32 v36, v36, v38
    v_smfmac_f32_16x16x64_bf16 v[48:51], v[4:7], a[208:215], v116
    v_add_f32 v37, v37, v39
    v_smfmac_f32_16x16x64_bf16 v[52:55], v[4:7], a[216:223], v116
    buffer_load_dwordx4 v117, s[8:11], s31 offen offset:1024 lds
    s_mov_b32 m0, 6144
    v_mul_f32 v36, s34, v36
    v_smfmac_f32_16x16x64_bf16 v[44:47], v[12:15], a[120:127], v116
    ds_read_b128 v[4:7], v124 offset:1024
    v_mul_f32 v37, s34, v37
    v_smfmac_f32_16x16x64_bf16 v[44:47], v[24:27], a[152:159], v116
    v_cvt_pk_bf16_f32 v34, v32, v36
    v_smfmac_f32_16x16x64_bf16 v[44:47], v[28:31], a[184:191], v116
    v_cvt_pk_bf16_f32 v35, v33, v37
    v_add_f32 v40, v40, v42
    v_smfmac_f32_16x16x64_bf16 v[48:51], v[8:11], a[224:231], v116
    ds_write2_b32 v120, v34, v35 offset0:32 offset1:48
    v_add_f32 v41, v41, v43
    v_smfmac_f32_16x16x64_bf16 v[52:55], v[8:11], a[232:239], v116
    v_add_f32 v44, v44, v46
    v_add_f32 v45, v45, v47
    v_cvt_pk_bf16_f32 v113, v40, v44
    v_cvt_pk_bf16_f32 v115, v41, v45
    v_smfmac_f32_16x16x64_bf16 v[48:51], v[12:15], a[240:247], v116
    ds_write2_b32 v120, v113, v115 offset0:0 offset1:16
    v_smfmac_f32_16x16x64_bf16 v[52:55], v[12:15], a[248:255], v116
    s_cmp_eq_u32 s22, 63
    s_cbranch_scc1 L_chain_last_s
    v_smfmac_f32_16x16x64_bf16 v[48:51], v[16:19], v[128:135], v116
    buffer_store_dword v126, v119, s[8:11], s55 offen sc1
    v_smfmac_f32_16x16x64_bf16 v[48:51], v[20:23], v[160:167], v116
    v_smfmac_f32_16x16x64_bf16 v[48:51], v[24:27], v[144:151], v116
    s_waitcnt lgkmcnt(0)
    s_barrier
    v_smfmac_f32_16x16x64_bf16 v[48:51], v[28:31], v[176:183], v116
    ds_read_b128 v[32:35], v121 offset:16384
    ds_read_b128 v[36:39], v121 offset:17408
    v_smfmac_f32_16x16x64_bf16 v[52:55], v[16:19], v[136:143], v116
    ds_read_b128 v[40:43], v121 offset:18432
    ds_read_b128 v[44:47], v121 offset:19456
    v_smfmac_f32_16x16x64_bf16 v[52:55], v[20:23], v[168:175], v116
    ds_read_b128 v[8:11], v124 offset:32768
    v_add_f32 v48, v48, v50
    v_smfmac_f32_16x16x64_bf16 v[52:55], v[24:27], v[152:159], v116
    ds_read_b128 v[12:15], v124 offset:33792
    v_add_f32 v49, v49, v51
    v_smfmac_f32_16x16x64_bf16 v[52:55], v[28:31], v[184:191], v116
    s_waitcnt lgkmcnt(5)
    v_cvt_pk_bf16_f32 v112, v48, v49
    v_mfma_f32_16x16x32_bf16 v[56:59], v[56:59], v[32:35], 0
    s_waitcnt lgkmcnt(4)
    v_mov_b32 v48, s50
    v_mov_b32 v49, s50
    v_mfma_f32_16x16x32_bf16 v[56:59], v[60:63], v[36:39], v[56:59]
    ds_read_b128 v[16:19], v124 offset:2048
    s_waitcnt lgkmcnt(4)
    v_mov_b32 v50, s50
    v_mov_b32 v51, s50
    v_mfma_f32_16x16x32_bf16 v[56:59], v[64:67], v[40:43], v[56:59]
    ds_read_b128 v[20:23], v124 offset:3072
    s_waitcnt lgkmcnt(4)
    v_add_f32 v52, v52, v54
    v_mfma_f32_16x16x32_bf16 v[56:59], v[68:71], v[44:47], v[56:59]
    ds_read_b128 v[24:27], v124 offset:4096
    v_add_f32 v53, v53, v55
    v_mfma_f32_16x16x32_bf16 v[60:63], v[72:75], v[32:35], 0
    ds_read_b128 v[28:31], v124 offset:5120
    v_cvt_pk_bf16_f32 v114, v52, v53
    v_mov_b32 v53, 0
    v_mfma_f32_16x16x32_bf16 v[60:63], v[76:79], v[36:39], v[60:63]
    v_exp_f32 v56, v56
    v_mfma_f32_16x16x32_bf16 v[60:63], v[80:83], v[40:43], v[60:63]
    v_exp_f32 v57, v57
    v_mfma_f32_16x16x32_bf16 v[60:63], v[84:87], v[44:47], v[60:63]
    v_exp_f32 v58, v58
    v_mfma_f32_16x16x32_bf16 v[64:67], v[32:35], v[32:35], 0
    v_exp_f32 v59, v59
    v_cvt_pk_bf16_f32 v68, v56, v57
    v_mfma_f32_16x16x32_bf16 v[64:67], v[36:39], v[36:39], v[64:67]
    v_exp_f32 v60, v60
    v_cvt_pk_bf16_f32 v69, v58, v59
    v_mfma_f32_16x16x32_bf16 v[64:67], v[40:43], v[40:43], v[64:67]
    v_exp_f32 v61, v61
    v_mfma_f32_16x16x32_bf16 v[64:67], v[44:47], v[44:47], v[64:67]
    v_exp_f32 v62, v62
    v_exp_f32 v63, v63
    v_cvt_pk_bf16_f32 v70, v60, v61
    v_cvt_pk_bf16_f32 v71, v62, v63
    s_nop 1
    v_mfma_f32_16x16x32_bf16 v[72:75], v[88:91], v[68:71], 0
    s_nop 0
    v_exp_f32 v64, v64
    v_mfma_f32_16x16x32_bf16 v[76:79], v[92:95], v[68:71], 0
    v_exp_f32 v65, v65
    v_mfma_f32_16x16x32_bf16 v[80:83], v[48:51], v[68:71], 0
    v_cvt_pk_bf16_f32 v52, v64, v65
    s_nop 1
    v_mfma_f32_16x16x16_bf16 v[72:75], v[112:113], v[52:53], v[72:75]
    ds_read_b128 v[32:35], v124 offset:6144
    v_mfma_f32_16x16x16_bf16 v[76:79], v[114:115], v[52:53], v[76:79]
    ds_read_b128 v[36:39], v124 offset:7168
    v_mfma_f32_16x16x16_bf16 v[80:83], v[48:49], v[52:53], v[80:83]
L_norm_75:
    s_mov_b64 vcc, s[36:37]
    v_mov_b32 v122, v122
    v_mov_b32 v122, v122
    v_mov_b32 v122, v122
    v_cndmask_b32_dpp v76, v72, v76, vcc quad_perm:[2,3,2,3] row_mask:0xf bank_mask:0xf
    v_cndmask_b32_dpp v77, v73, v77, vcc quad_perm:[2,3,2,3] row_mask:0xf bank_mask:0xf
    v_cndmask_b32_dpp v78, v74, v78, vcc quad_perm:[2,3,2,3] row_mask:0xf bank_mask:0xf
    v_cndmask_b32_dpp v79, v75, v79, vcc quad_perm:[2,3,2,3] row_mask:0xf bank_mask:0xf
    v_rcp_f32_dpp v84, v80 quad_perm:[2,3,2,3] row_mask:0xf bank_mask:0xf
    s_nop 0
    v_pk_mul_f32 v[76:77], v[76:77], v[84:85] op_sel_hi:[1,0]
    v_pk_mul_f32 v[78:79], v[78:79], v[84:85] op_sel_hi:[1,0]
    v_cvt_pk_bf16_f32 v72, v76, v77
    v_cvt_pk_bf16_f32 v73, v78, v79
    ds_write_b64 v122, v[72:73] offset:21504
    v_max_f32_dpp v86, v80, v84 quad_perm:[2,3,2,3] row_mask:0xf bank_mask:0xf
    v_mov_b32_dpp v60, v72 quad_perm:[0,1,0,1] row_mask:0xf bank_mask:0xf
    v_mov_b32_dpp v61, v73 quad_perm:[0,1,0,1] row_mask:0xf bank_mask:0xf
    v_cmp_lt_f32 vcc, s35, v86
    v_mov_b32_dpp v62, v72 quad_perm:[2,3,2,3] row_mask:0xf bank_mask:0xf
    v_mov_b32_dpp v63, v73 quad_perm:[2,3,2,3] row_mask:0xf bank_mask:0xf
    s_nop 1
    v_smfmac_f32_16x16x64_bf16 v[96:99], v[60:63], v[192:199], v116
    s_cbranch_vccnz L_smax_76
    v_smfmac_f32_16x16x64_bf16 v[100:103], v[60:63], v[224:231], v116
    s_waitcnt lgkmcnt(0)
    s_barrier
    ds_read_b128 v[92:95], v127 offset:22016
    ds_read_b128 v[80:83], v127 offset:20480
    ds_read_b128 v[84:87], v127 offset:20992
    v_smfmac_f32_16x16x64_bf16 v[104:107], v[60:63], v[0:7], v116
    ds_read_b128 v[40:43], v124 offset:34816
    v_smfmac_f32_16x16x64_bf16 v[108:111], v[60:63], v[8:15], v116
    ds_read_b128 v[56:59], v124 offset:36864
    s_waitcnt lgkmcnt(4)
    v_smfmac_f32_16x16x64_bf16 v[96:99], v[92:95], v[200:207], v116
    s_waitcnt lgkmcnt(3)
    v_smfmac_f32_16x16x64_bf16 v[96:99], v[80:83], v[208:215], v116
    ds_read_b128 v[44:47], v124 offset:35840
    s_waitcnt lgkmcnt(3)
    v_smfmac_f32_16x16x64_bf16 v[96:99], v[84:87], v[216:223], v116
    ds_read_b128 v[68:71], v124 offset:39936
    v_smfmac_f32_16x16x64_bf16 v[100:103], v[92:95], v[232:239], v116
    ds_read_b128 v[64:67], v124 offset:38912
    v_smfmac_f32_16x16x64_bf16 v[100:103], v[80:83], v[240:247], v116
    ds_read_b128 v[60:63], v124 offset:37888
    v_cvt_pk_bf16_f32 v72, v96, v98
    v_smfmac_f32_16x16x64_bf16 v[100:103], v[84:87], v[248:255], v116
    v_and_or_b32 v72, v72, -2, s33
    v_smfmac_f32_16x16x64_bf16 v[104:107], v[92:95], v[16:23], v116
    v_cvt_pk_bf16_f32 v74, v97, v99
    v_smfmac_f32_16x16x64_bf16 v[104:107], v[80:83], v[24:31], v116
    v_cvt_pk_bf16_f32 v73, v100, v102
    v_cvt_pk_bf16_f32 v75, v101, v103
    v_smfmac_f32_16x16x64_bf16 v[104:107], v[84:87], v[32:39], v116
    buffer_store_dwordx4 v[72:75], v118, s[8:11], s25 offen sc1
    s_waitcnt lgkmcnt(3)
    v_smfmac_f32_16x16x64_bf16 v[108:111], v[92:95], v[40:47], v116
    s_waitcnt lgkmcnt(0)
    v_smfmac_f32_16x16x64_bf16 v[108:111], v[80:83], v[56:63], v116
    v_cvt_pk_bf16_f32 v76, v104, v106
    v_smfmac_f32_16x16x64_bf16 v[108:111], v[84:87], v[64:71], v116
    v_and_or_b32 v76, v76, -2, s33
    v_cvt_pk_bf16_f32 v78, v105, v107
    v_mov_b32 v122, v122
    v_mov_b32 v122, v122
    v_mov_b32 v122, v122
    v_mov_b32 v122, v122
    v_mov_b32 v122, v122
    v_mov_b32 v122, v122
    v_cvt_pk_bf16_f32 v77, v108, v110
    v_cvt_pk_bf16_f32 v79, v109, v111
    buffer_store_dwordx4 v[76:79], v118, s[8:11], s26 offen sc1
    ds_read_b128 v[80:83], v123
    ds_read_b128 v[84:87], v123 offset:1024
    ds_read_b128 v[56:59], v123 offset:2048
    ds_read_b128 v[60:63], v123 offset:3072
    ds_read_b128 v[64:67], v123 offset:32768
    ds_read_b128 v[68:71], v123 offset:33792
    ds_read_b128 v[72:75], v123 offset:34816
    ds_read_b128 v[76:79], v123 offset:35840
    ds_read_b128 v[88:91], v123 offset:4096
    ds_read_b128 v[92:95], v123 offset:5120
    ds_read_b128 v[96:99], v123 offset:6144
    ds_read_b128 v[100:103], v123 offset:7168
    ds_read_b128 v[104:107], v123 offset:36864
    ds_read_b128 v[108:111], v123 offset:37888
    ds_read_b128 v[24:27], v123 offset:38912
    ds_read_b128 v[28:31], v123 offset:39936
    s_add_u32 s30, s30, 0x40000
    s_add_u32 s31, s31, 0x40000
    s_add_u32 s32, s32, 0x20000
    s_add_u32 s23, s24, 2048
    s_add_u32 s48, s23, 4096
    s_xor_b32 s25, s25, 0x40000
    s_xor_b32 s26, s26, 0x40000
    s_mov_b32 s35, 0x49800000
    s_add_u32 s22, s22, 1
    v_cndmask_b32 v12, 0, v125, s[68:69]
    v_cndmask_b32 v13, 0, v125, s[70:71]
    v_cndmask_b32 v14, 0, v125, s[72:73]
    v_cndmask_b32 v15, 0, v125, s[74:75]
    v_mov_b32 v54, 0
    v_mov_b32 v55, 0
    v_mov_b32 v52, 0
    v_mov_b32 v52, 0
    v_mov_b32 v52, 0
    v_mov_b32 v52, 0
    v_mov_b32 v52, 0
    v_mov_b32 v52, 0
    v_mov_b32 v52, 0
    v_mov_b32 v52, 0
    v_mov_b32 v52, 0
    v_mov_b32 v52, 0
    v_mov_b32 v52, 0
    v_mov_b32 v52, 0
    v_mov_b32 v52, 0
    v_mov_b32 v52, 0
    v_mov_b32 v52, 0
    v_mov_b32 v52, 0
    v_mov_b32 v52, 0
    v_mov_b32 v52, 0
    v_mov_b32 v52, 0
    buffer_load_dwordx4 v[4:7], v117, s[8:11], s29 offen sc1
    buffer_load_dwordx4 v[8:11], v117, s[8:11], s53 offen sc1
    buffer_load_dwordx4 v[16:19], v117, s[8:11], s29 offen offset:2048 sc1
    buffer_load_dwordx4 v[20:23], v117, s[8:11], s53 offen offset:2048 sc1
    v_mov_b32 v52, 0
    v_mov_b32 v52, 0
    v_mov_b32 v52, 0
    v_mov_b32 v52, 0
    v_mov_b32 v52, 0
    v_mov_b32 v52, 0
    v_mov_b32 v52, 0
    v_mov_b32 v52, 0
    v_mov_b32 v52, 0
    v_mov_b32 v52, 0
    v_mov_b32 v52, 0
    v_mov_b32 v52, 0
    v_mov_b32 v52, 0
    v_mov_b32 v52, 0
    v_mov_b32 v52, 0
    v_mov_b32 v52, 0
    v_mov_b32 v52, 0
    v_mov_b32 v52, 0
    v_mov_b32 v52, 0
    v_mov_b32 v52, 0
    v_mov_b32 v52, 0
    v_mov_b32 v52, 0
    v_mov_b32 v52, 0
    v_mov_b32 v52, 0
    v_mov_b32 v52, 0
    v_mov_b32 v52, 0
    v_mov_b32 v52, 0
    v_mov_b32 v52, 0
    v_mov_b32 v52, 0
    v_mov_b32 v52, 0
    v_mov_b32 v52, 0
    v_mov_b32 v52, 0
    v_mov_b32 v52, 0
    v_mov_b32 v52, 0
    v_mov_b32 v52, 0
    v_mov_b32 v52, 0
    v_mov_b32 v52, 0
    v_mov_b32 v52, 0
    v_mov_b32 v52, 0
    v_mov_b32 v52, 0
    buffer_load_dwordx4 v[32:35], v117, s[8:11], s29 offen sc1
    buffer_load_dwordx4 v[36:39], v117, s[8:11], s53 offen sc1
    buffer_load_dwordx4 v[40:43], v117, s[8:11], s29 offen offset:2048 sc1
    buffer_load_dwordx4 v[44:47], v117, s[8:11], s53 offen offset:2048 sc1
    v_mov_b32 v52, 0
L_rl_77:
    s_waitcnt vmcnt(7)
    v_mfma_f32_16x16x32_bf16 v[48:51], v[4:7], v[12:15], 0
    v_xor_b32 v52, s33, v4
    s_waitcnt vmcnt(6)
    v_mfma_f32_16x16x32_bf16 v[48:51], v[8:11], v[12:15], v[48:51]
    v_xor_b32 v53, s33, v8
    v_or_b32 v52, v52, v53
    s_waitcnt vmcnt(5)
    v_mfma_f32_16x16x32_bf16 v[48:51], v[16:19], v[12:15], v[48:51]
    v_xor_b32 v53, s33, v16
    v_or_b32 v52, v52, v53
    s_waitcnt vmcnt(4)
    v_mfma_f32_16x16x32_bf16 v[48:51], v[20:23], v[12:15], v[48:51]
    v_xor_b32 v53, s33, v20
    v_or_b32 v52, v52, v53
    v_and_b32 v52, 1, v52
    v_cmp_ne_u32 vcc, 0, v52
    s_cbranch_vccnz L_rslow_78
L_rgo_79:
    s_nop 2
    v_permlane32_swap_b32 v48, v50
    v_permlane32_swap_b32 v49, v51
    v_pk_add_f32 v[48:49], v[48:49], v[50:51]
    s_mov_b64 exec, s[38:39]
    v_cvt_pk_bf16_f32 v12, v48, v49
    v_min_u32 v12, 0xfffffffe, v12
    buffer_store_dword v12, v119, s[8:11], s24 offen sc1
    s_mov_b64 exec, -1
    s_add_u32 s24, s24, 8192
    s_bitset0_b32 s24, 15
    s_xor_b32 s55, s24, 16384
    s_xor_b32 s29, s29, 0x40000
    s_xor_b32 s53, s29, 1024
    s_bfe_u32 s33, s22, 0x10001
    s_waitcnt lgkmcnt(0)
    s_branch L_chain_top2_s
.p2align 6
L_chain_top3_s:
    buffer_load_dwordx4 v[0:3], v117, s[8:11], s23 offen sc1
    v_mov_b32 v48, 0
    v_mov_b32 v49, 0
    v_mov_b32 v50, 0
    v_mov_b32 v51, 0
    v_mov_b32 v52, 0
    v_mov_b32 v53, 0
    v_mov_b32 v15, 0
    v_mov_b32 v15, 0
    v_mov_b32 v15, 0
    v_mov_b32 v15, 0
    v_mov_b32 v15, 0
    v_mov_b32 v15, 0
    v_mov_b32 v15, 0
    v_mov_b32 v15, 0
    v_mov_b32 v15, 0
    v_mov_b32 v15, 0
    buffer_load_dwordx4 v[0:3], v117, s[8:11], s23 offen sc1
    s_waitcnt vmcnt(3)
    v_mov_b32 v36, 0
    v_mov_b32 v37, 0
    v_mov_b32 v38, 0
    v_mov_b32 v39, 0
    v_mov_b32 v40, 0
    v_mov_b32 v41, 0
    v_mov_b32 v42, 0
    v_mov_b32 v43, 0
    v_mov_b32 v44, 0
    v_mov_b32 v45, 0
    v_mov_b32 v46, 0
    v_mov_b32 v47, 0
    v_mov_b32 v15, 0
    v_mov_b32 v15, 0
    v_mov_b32 v15, 0
    v_mov_b32 v15, 0
L_mret_80:
    buffer_load_dwordx4 v[0:3], v117, s[8:11], s23 offen sc1
    s_add_u32 s45, s45, 1
    s_cmp_lt_u32 s45, 0x10000
    s_cselect_b32 s56, -2, -1
    s_nop 3
    v_mov_b32 v32, 0
    v_mov_b32 v33, 0
    v_mov_b32 v34, 0
    v_mov_b32 v35, 0
    s_waitcnt vmcnt(2)
    v_max3_u32 v15, v0, v1, v2
    v_max_u32 v15, v15, v3
    v_cmp_lt_u32 vcc, s56, v15
    v_smfmac_f32_16x16x64_bf16 v[32:35], v[0:3], v[80:87], v116
    s_cbranch_vccnz L_mret_80
    ds_write_b128 v117, v[0:3] offset:3072
    v_smfmac_f32_16x16x64_bf16 v[36:39], v[0:3], v[56:63], v116
    buffer_load_dwordx4 v[4:7], v117, s[8:11], s48 offen sc1
    v_smfmac_f32_16x16x64_bf16 v[40:43], v[0:3], v[64:71], v116
    buffer_load_dwordx4 v117, s[8:11], s48 offen sc1 lds
    s_mov_b32 m0, 14336
    v_smfmac_f32_16x16x64_bf16 v[44:47], v[0:3], v[72:79], v116
    s_waitcnt lgkmcnt(0)
    s_barrier
    ds_read_b128 v[8:11], v117 offset:2048
    v_smfmac_f32_16x16x64_bf16 v[48:51], v[0:3], a[192:199], v116
    ds_read_b128 v[16:19], v117 offset:1024
    ds_read_b128 v[20:23], v117
    v_smfmac_f32_16x16x64_bf16 v[52:55], v[0:3], a[200:207], v116
    ds_read_b128 v[80:83], v117 offset:14336
    s_waitcnt lgkmcnt(3)
    v_smfmac_f32_16x16x64_bf16 v[32:35], v[8:11], a[0:7], v116
    ds_read_b128 v[84:87], v117 offset:15360
    v_smfmac_f32_16x16x64_bf16 v[36:39], v[8:11], a[8:15], v116
    ds_read_b128 v[56:59], v117 offset:8192
    s_waitcnt lgkmcnt(4)
    v_smfmac_f32_16x16x64_bf16 v[32:35], v[16:19], a[32:39], v116
    ds_read_b128 v[60:63], v117 offset:9216
    v_smfmac_f32_16x16x64_bf16 v[36:39], v[16:19], a[40:47], v116
    ds_read_b128 v[64:67], v117 offset:10240
    s_waitcnt lgkmcnt(5)
    v_smfmac_f32_16x16x64_bf16 v[32:35], v[20:23], a[64:71], v116
    ds_read_b128 v[68:71], v117 offset:11264
    v_smfmac_f32_16x16x64_bf16 v[36:39], v[20:23], a[72:79], v116
    ds_read_b128 v[72:75], v117 offset:12288
    v_smfmac_f32_16x16x64_bf16 v[40:43], v[8:11], a[96:103], v116
    ds_read_b128 v[76:79], v117 offset:13312
    v_smfmac_f32_16x16x64_bf16 v[40:43], v[16:19], a[128:135], v116
    buffer_store_dwordx4 v[112:115], v117, s[8:11], s32 offen sc1
    v_smfmac_f32_16x16x64_bf16 v[40:43], v[20:23], a[160:167], v116
    s_waitcnt vmcnt(2)
    v_max3_u32 v15, v4, v5, v6
    v_smfmac_f32_16x16x64_bf16 v[44:47], v[8:11], a[104:111], v116
    v_max_u32 v15, v15, v7
    v_smfmac_f32_16x16x64_bf16 v[44:47], v[16:19], a[136:143], v116
    s_waitcnt vmcnt(1) lgkmcnt(0)
    v_cmp_lt_u32 vcc, s56, v15
    v_smfmac_f32_16x16x64_bf16 v[44:47], v[20:23], a[168:175], v116
    s_cbranch_vccnz L_mret_81
L_mgo_82:
    v_smfmac_f32_16x16x64_bf16 v[44:47], v[4:7], v[24:31], v116
    s_barrier
    ds_read_b128 v[12:15], v117 offset:6144
    v_smfmac_f32_16x16x64_bf16 v[32:35], v[4:7], v[88:95], v116
    ds_read_b128 v[24:27], v117 offset:5120
    v_smfmac_f32_16x16x64_bf16 v[36:39], v[4:7], v[96:103], v116
    ds_read_b128 v[28:31], v117 offset:4096
    v_smfmac_f32_16x16x64_bf16 v[40:43], v[4:7], v[104:111], v116
    ds_read_b128 v[88:91], v117 offset:30720
    s_waitcnt lgkmcnt(3)
    v_smfmac_f32_16x16x64_bf16 v[32:35], v[12:15], a[16:23], v116
    ds_read_b128 v[92:95], v117 offset:31744
    s_waitcnt lgkmcnt(3)
    v_smfmac_f32_16x16x64_bf16 v[32:35], v[24:27], a[48:55], v116
    ds_read_b128 v[96:99], v117 offset:23552
    s_waitcnt lgkmcnt(3)
    v_smfmac_f32_16x16x64_bf16 v[32:35], v[28:31], a[80:87], v116
    buffer_load_dwordx4 v117, s[8:11], s30 offen lds
    v_smfmac_f32_16x16x64_bf16 v[36:39], v[12:15], a[24:31], v116
    ds_read_b128 v[100:103], v117 offset:23552
    v_smfmac_f32_16x16x64_bf16 v[36:39], v[24:27], a[56:63], v116
    ds_read_b128 v[104:107], v117 offset:23552
    v_add_f32 v32, v32, v34
    v_smfmac_f32_16x16x64_bf16 v[36:39], v[28:31], a[88:95], v116
    buffer_load_dwordx4 v117, s[8:11], s30 offen offset:1024 lds
    s_add_u32 m0, s52, 0x6000
    v_add_f32 v33, v33, v35
    v_smfmac_f32_16x16x64_bf16 v[40:43], v[12:15], a[112:119], v116
    ds_read_b128 v[108:111], v117 offset:23552
    v_mul_f32 v32, s34, v32
    v_smfmac_f32_16x16x64_bf16 v[40:43], v[24:27], a[144:151], v116
    ds_read_b128 v[0:3], v124
    v_mul_f32 v33, s34, v33
    v_smfmac_f32_16x16x64_bf16 v[40:43], v[28:31], a[176:183], v116
    s_waitcnt lgkmcnt(5)
    buffer_load_dwordx4 v117, s[8:11], s31 offen lds
    v_add_f32 v36, v36, v38
    v_smfmac_f32_16x16x64_bf16 v[48:51], v[4:7], a[208:215], v116
    v_add_f32 v37, v37, v39
    v_smfmac_f32_16x16x64_bf16 v[52:55], v[4:7], a[216:223], v116
    ds_read_b128 v[4:7], v124 offset:1024
    v_mul_f32 v36, s34, v36
    v_smfmac_f32_16x16x64_bf16 v[44:47], v[12:15], a[120:127], v116
    buffer_load_dwordx4 v117, s[8:11], s31 offen offset:1024 lds
    s_mov_b32 m0, 7168
    v_mul_f32 v37, s34, v37
    v_smfmac_f32_16x16x64_bf16 v[44:47], v[24:27], a[152:159], v116
    v_cvt_pk_bf16_f32 v34, v32, v36
    v_smfmac_f32_16x16x64_bf16 v[44:47], v[28:31], a[184:191], v116
    v_cvt_pk_bf16_f32 v35, v33, v37
    v_add_f32 v40, v40, v42
    v_smfmac_f32_16x16x64_bf16 v[48:51], v[8:11], a[224:231], v116
    ds_write2_b32 v120, v34, v35 offset0:32 offset1:48
    v_add_f32 v41, v41, v43
    v_smfmac_f32_16x16x64_bf16 v[52:55], v[8:11], a[232:239], v116
    v_add_f32 v44, v44, v46
    v_add_f32 v45, v45, v47
    v_cvt_pk_bf16_f32 v113, v40, v44
    v_cvt_pk_bf16_f32 v115, v41, v45
    v_smfmac_f32_16x16x64_bf16 v[48:51], v[12:15], a[240:247], v116
    ds_write2_b32 v120, v113, v115 offset0:0 offset1:16
    v_smfmac_f32_16x16x64_bf16 v[52:55], v[12:15], a[248:255], v116
    s_cmp_eq_u32 s22, 63
    s_cbranch_scc1 L_chain_last_s
    v_smfmac_f32_16x16x64_bf16 v[48:51], v[16:19], v[128:135], v116
    v_smfmac_f32_16x16x64_bf16 v[48:51], v[20:23], v[160:167], v116
    buffer_store_dword v126, v119, s[8:11], s55 offen sc1
    v_smfmac_f32_16x16x64_bf16 v[48:51], v[24:27], v[144:151], v116
    s_waitcnt lgkmcnt(0)
    s_barrier
    v_smfmac_f32_16x16x64_bf16 v[48:51], v[28:31], v[176:183], v116
    ds_read_b128 v[32:35], v121 offset:16384
    ds_read_b128 v[36:39], v121 offset:17408
    v_smfmac_f32_16x16x64_bf16 v[52:55], v[16:19], v[136:143], v116
    ds_read_b128 v[40:43], v121 offset:18432
    ds_read_b128 v[44:47], v121 offset:19456
    v_smfmac_f32_16x16x64_bf16 v[52:55], v[20:23], v[168:175], v116
    ds_read_b128 v[8:11], v124 offset:32768
    v_add_f32 v48, v48, v50
    v_smfmac_f32_16x16x64_bf16 v[52:55], v[24:27], v[152:159], v116
    ds_read_b128 v[12:15], v124 offset:33792
    v_add_f32 v49, v49, v51
    v_smfmac_f32_16x16x64_bf16 v[52:55], v[28:31], v[184:191], v116
    s_waitcnt lgkmcnt(5)
    v_cvt_pk_bf16_f32 v112, v48, v49
    v_mfma_f32_16x16x32_bf16 v[56:59], v[56:59], v[32:35], 0
    s_waitcnt lgkmcnt(4)
    v_mov_b32 v48, s50
    v_mov_b32 v49, s50
    v_mfma_f32_16x16x32_bf16 v[56:59], v[60:63], v[36:39], v[56:59]
    ds_read_b128 v[16:19], v124 offset:2048
    s_waitcnt lgkmcnt(4)
    v_mov_b32 v50, s50
    v_mov_b32 v51, s50
    v_mfma_f32_16x16x32_bf16 v[56:59], v[64:67], v[40:43], v[56:59]
    ds_read_b128 v[20:23], v124 offset:3072
    s_waitcnt lgkmcnt(4)
    v_add_f32 v52, v52, v54
    v_mfma_f32_16x16x32_bf16 v[56:59], v[68:71], v[44:47], v[56:59]
    ds_read_b128 v[24:27], v124 offset:4096
    v_add_f32 v53, v53, v55
    v_mfma_f32_16x16x32_bf16 v[60:63], v[72:75], v[32:35], 0
    ds_read_b128 v[28:31], v124 offset:5120
    v_cvt_pk_bf16_f32 v114, v52, v53
    v_mov_b32 v53, 0
    v_mfma_f32_16x16x32_bf16 v[60:63], v[76:79], v[36:39], v[60:63]
    v_exp_f32 v56, v56
    v_mfma_f32_16x16x32_bf16 v[60:63], v[80:83], v[40:43], v[60:63]
    v_exp_f32 v57, v57
    v_mfma_f32_16x16x32_bf16 v[60:63], v[84:87], v[44:47], v[60:63]
    v_exp_f32 v58, v58
    v_mfma_f32_16x16x32_bf16 v[64:67], v[32:35], v[32:35], 0
    v_exp_f32 v59, v59
    v_cvt_pk_bf16_f32 v68, v56, v57
    v_mfma_f32_16x16x32_bf16 v[64:67], v[36:39], v[36:39], v[64:67]
    v_exp_f32 v60, v60
    v_cvt_pk_bf16_f32 v69, v58, v59
    v_mfma_f32_16x16x32_bf16 v[64:67], v[40:43], v[40:43], v[64:67]
    v_exp_f32 v61, v61
    v_mfma_f32_16x16x32_bf16 v[64:67], v[44:47], v[44:47], v[64:67]
    v_exp_f32 v62, v62
    v_exp_f32 v63, v63
    v_cvt_pk_bf16_f32 v70, v60, v61
    v_cvt_pk_bf16_f32 v71, v62, v63
    s_nop 1
    v_mfma_f32_16x16x32_bf16 v[72:75], v[88:91], v[68:71], 0
    s_nop 0
    v_exp_f32 v64, v64
    v_mfma_f32_16x16x32_bf16 v[76:79], v[92:95], v[68:71], 0
    v_exp_f32 v65, v65
    v_mfma_f32_16x16x32_bf16 v[80:83], v[48:51], v[68:71], 0
    v_cvt_pk_bf16_f32 v52, v64, v65
    s_nop 1
    v_mfma_f32_16x16x16_bf16 v[72:75], v[112:113], v[52:53], v[72:75]
    ds_read_b128 v[32:35], v124 offset:6144
    v_mfma_f32_16x16x16_bf16 v[76:79], v[114:115], v[52:53], v[76:79]
    ds_read_b128 v[36:39], v124 offset:7168
    v_mfma_f32_16x16x16_bf16 v[80:83], v[48:49], v[52:53], v[80:83]
L_norm_83:
    s_mov_b64 vcc, s[36:37]
    v_mov_b32 v122, v122
    v_mov_b32 v122, v122
    v_mov_b32 v122, v122
    v_cndmask_b32_dpp v76, v72, v76, vcc quad_perm:[2,3,2,3] row_mask:0xf bank_mask:0xf
    v_cndmask_b32_dpp v77, v73, v77, vcc quad_perm:[2,3,2,3] row_mask:0xf bank_mask:0xf
    v_cndmask_b32_dpp v78, v74, v78, vcc quad_perm:[2,3,2,3] row_mask:0xf bank_mask:0xf
    v_cndmask_b32_dpp v79, v75, v79, vcc quad_perm:[2,3,2,3] row_mask:0xf bank_mask:0xf
    v_rcp_f32_dpp v84, v80 quad_perm:[2,3,2,3] row_mask:0xf bank_mask:0xf
    s_nop 0
    v_pk_mul_f32 v[76:77], v[76:77], v[84:85] op_sel_hi:[1,0]
    v_pk_mul_f32 v[78:79], v[78:79], v[84:85] op_sel_hi:[1,0]
    v_cvt_pk_bf16_f32 v72, v76, v77
    v_cvt_pk_bf16_f32 v73, v78, v79
    ds_write_b64 v122, v[72:73] offset:22016
    v_max_f32_dpp v86, v80, v84 quad_perm:[2,3,2,3] row_mask:0xf bank_mask:0xf
    v_mov_b32_dpp v60, v72 quad_perm:[0,1,0,1] row_mask:0xf bank_mask:0xf
    v_mov_b32_dpp v61, v73 quad_perm:[0,1,0,1] row_mask:0xf bank_mask:0xf
    v_cmp_lt_f32 vcc, s35, v86
    v_mov_b32_dpp v62, v72 quad_perm:[2,3,2,3] row_mask:0xf bank_mask:0xf
    v_mov_b32_dpp v63, v73 quad_perm:[2,3,2,3] row_mask:0xf bank_mask:0xf
    s_nop 1
    v_smfmac_f32_16x16x64_bf16 v[96:99], v[60:63], v[192:199], v116
    s_cbranch_vccnz L_smax_84
    v_smfmac_f32_16x16x64_bf16 v[100:103], v[60:63], v[224:231], v116
    s_waitcnt lgkmcnt(0)
    s_barrier
    ds_read_b128 v[92:95], v127 offset:21504
    ds_read_b128 v[80:83], v127 offset:20992
    ds_read_b128 v[84:87], v127 offset:20480
    v_smfmac_f32_16x16x64_bf16 v[104:107], v[60:63], v[0:7], v116
    ds_read_b128 v[40:43], v124 offset:34816
    v_smfmac_f32_16x16x64_bf16 v[108:111], v[60:63], v[8:15], v116
    ds_read_b128 v[56:59], v124 offset:36864
    s_waitcnt lgkmcnt(4)
    v_smfmac_f32_16x16x64_bf16 v[96:99], v[92:95], v[200:207], v116
    s_waitcnt lgkmcnt(3)
    v_smfmac_f32_16x16x64_bf16 v[96:99], v[80:83], v[208:215], v116
    ds_read_b128 v[44:47], v124 offset:35840
    s_waitcnt lgkmcnt(3)
    v_smfmac_f32_16x16x64_bf16 v[96:99], v[84:87], v[216:223], v116
    ds_read_b128 v[68:71], v124 offset:39936
    v_smfmac_f32_16x16x64_bf16 v[100:103], v[92:95], v[232:239], v116
    ds_read_b128 v[64:67], v124 offset:38912
    v_smfmac_f32_16x16x64_bf16 v[100:103], v[80:83], v[240:247], v116
    ds_read_b128 v[60:63], v124 offset:37888
    v_cvt_pk_bf16_f32 v72, v96, v98
    v_smfmac_f32_16x16x64_bf16 v[100:103], v[84:87], v[248:255], v116
    v_and_or_b32 v72, v72, -2, s33
    v_smfmac_f32_16x16x64_bf16 v[104:107], v[92:95], v[16:23], v116
    v_cvt_pk_bf16_f32 v74, v97, v99
    v_smfmac_f32_16x16x64_bf16 v[104:107], v[80:83], v[24:31], v116
    v_cvt_pk_bf16_f32 v73, v100, v102
    v_cvt_pk_bf16_f32 v75, v101, v103
    v_smfmac_f32_16x16x64_bf16 v[104:107], v[84:87], v[32:39], v116
    buffer_store_dwordx4 v[72:75], v118, s[8:11], s25 offen sc1
    s_waitcnt lgkmcnt(3)
    v_smfmac_f32_16x16x64_bf16 v[108:111], v[92:95], v[40:47], v116
    s_waitcnt lgkmcnt(0)
    v_smfmac_f32_16x16x64_bf16 v[108:111], v[80:83], v[56:63], v116
    v_cvt_pk_bf16_f32 v76, v104, v106
    v_smfmac_f32_16x16x64_bf16 v[108:111], v[84:87], v[64:71], v116
    v_and_or_b32 v76, v76, -2, s33
    v_cvt_pk_bf16_f32 v78, v105, v107
    v_mov_b32 v122, v122
    v_mov_b32 v122, v122
    v_mov_b32 v122, v122
    v_mov_b32 v122, v122
    v_mov_b32 v122, v122
    v_mov_b32 v122, v122
    v_cvt_pk_bf16_f32 v77, v108, v110
    v_cvt_pk_bf16_f32 v79, v109, v111
    buffer_store_dwordx4 v[76:79], v118, s[8:11], s26 offen sc1
    ds_read_b128 v[80:83], v123
    ds_read_b128 v[84:87], v123 offset:1024
    ds_read_b128 v[56:59], v123 offset:2048
    ds_read_b128 v[60:63], v123 offset:3072
    ds_read_b128 v[64:67], v123 offset:32768
    ds_read_b128 v[68:71], v123 offset:33792
    ds_read_b128 v[72:75], v123 offset:34816
    ds_read_b128 v[76:79], v123 offset:35840
    ds_read_b128 v[88:91], v123 offset:4096
    ds_read_b128 v[92:95], v123 offset:5120
    ds_read_b128 v[96:99], v123 offset:6144
    ds_read_b128 v[100:103], v123 offset:7168
    ds_read_b128 v[104:107], v123 offset:36864
    ds_read_b128 v[108:111], v123 offset:37888
    ds_read_b128 v[24:27], v123 offset:38912
    ds_read_b128 v[28:31], v123 offset:39936
    s_add_u32 s30, s30, 0x40000
    s_add_u32 s31, s31, 0x40000
    s_add_u32 s32, s32, 0x20000
    s_add_u32 s23, s24, 3072
    s_add_u32 s48, s23, 4096
    s_xor_b32 s25, s25, 0x40000
    s_xor_b32 s26, s26, 0x40000
    s_mov_b32 s35, 0x49800000
    s_add_u32 s22, s22, 1
    v_cndmask_b32 v12, 0, v125, s[68:69]
    v_cndmask_b32 v13, 0, v125, s[70:71]
    v_cndmask_b32 v14, 0, v125, s[72:73]
    v_cndmask_b32 v15, 0, v125, s[74:75]
    v_mov_b32 v54, 0
    v_mov_b32 v55, 0
    v_mov_b32 v52, 0
    v_mov_b32 v52, 0
    v_mov_b32 v52, 0
    v_mov_b32 v52, 0
    v_mov_b32 v52, 0
    v_mov_b32 v52, 0
    v_mov_b32 v52, 0
    v_mov_b32 v52, 0
    v_mov_b32 v52, 0
    v_mov_b32 v52, 0
    v_mov_b32 v52, 0
    v_mov_b32 v52, 0
    v_mov_b32 v52, 0
    v_mov_b32 v52, 0
    v_mov_b32 v52, 0
    v_mov_b32 v52, 0
    v_mov_b32 v52, 0
    v_mov_b32 v52, 0
    v_mov_b32 v52, 0
    v_mov_b32 v52, 0
    v_mov_b32 v52, 0
    v_mov_b32 v52, 0
    v_mov_b32 v52, 0
    v_mov_b32 v52, 0
    v_mov_b32 v52, 0
    v_mov_b32 v52, 0
    v_mov_b32 v52, 0
    v_mov_b32 v52, 0
    v_mov_b32 v52, 0
    v_mov_b32 v52, 0
    v_mov_b32 v52, 0
    v_mov_b32 v52, 0
    v_mov_b32 v52, 0
    v_mov_b32 v52, 0
    v_mov_b32 v52, 0
    v_mov_b32 v52, 0
    v_mov_b32 v52, 0
    v_mov_b32 v52, 0
    v_mov_b32 v52, 0
    v_mov_b32 v52, 0
    v_mov_b32 v52, 0
    v_mov_b32 v52, 0
    v_mov_b32 v52, 0
    v_mov_b32 v52, 0
    v_mov_b32 v52, 0
    v_mov_b32 v52, 0
    v_mov_b32 v52, 0
    v_mov_b32 v52, 0
    v_mov_b32 v52, 0
    buffer_load_dwordx4 v[4:7], v117, s[8:11], s29 offen sc1
    buffer_load_dwordx4 v[8:11], v117, s[8:11], s53 offen sc1
    buffer_load_dwordx4 v[16:19], v117, s[8:11], s29 offen offset:2048 sc1
    buffer_load_dwordx4 v[20:23], v117, s[8:11], s53 offen offset:2048 sc1
    v_mov_b32 v52, 0
    v_mov_b32 v52, 0
    v_mov_b32 v52, 0
    v_mov_b32 v52, 0
    v_mov_b32 v52, 0
    v_mov_b32 v52, 0
    v_mov_b32 v52, 0
    v_mov_b32 v52, 0
    v_mov_b32 v52, 0
    v_mov_b32 v52, 0
    v_mov_b32 v52, 0
    v_mov_b32 v52, 0
    v_mov_b32 v52, 0
    v_mov_b32 v52, 0
    v_mov_b32 v52, 0
    v_mov_b32 v52, 0
    v_mov_b32 v52, 0
    v_mov_b32 v52, 0
    v_mov_b32 v52, 0
    v_mov_b32 v52, 0
    v_mov_b32 v52, 0
    v_mov_b32 v52, 0
    v_mov_b32 v52, 0
    v_mov_b32 v52, 0
    v_mov_b32 v52, 0
    v_mov_b32 v52, 0
    v_mov_b32 v52, 0
    v_mov_b32 v52, 0
    v_mov_b32 v52, 0
    v_mov_b32 v52, 0
    buffer_load_dwordx4 v[32:35], v117, s[8:11], s29 offen sc1
    buffer_load_dwordx4 v[36:39], v117, s[8:11], s53 offen sc1
    buffer_load_dwordx4 v[40:43], v117, s[8:11], s29 offen offset:2048 sc1
    buffer_load_dwordx4 v[44:47], v117, s[8:11], s53 offen offset:2048 sc1
    v_mov_b32 v52, 0
L_rl_85:
    s_waitcnt vmcnt(7)
    v_mfma_f32_16x16x32_bf16 v[48:51], v[4:7], v[12:15], 0
    v_xor_b32 v52, s33, v4
    s_waitcnt vmcnt(6)
    v_mfma_f32_16x16x32_bf16 v[48:51], v[8:11], v[12:15], v[48:51]
    v_xor_b32 v53, s33, v8
    v_or_b32 v52, v52, v53
    s_waitcnt vmcnt(5)
    v_mfma_f32_16x16x32_bf16 v[48:51], v[16:19], v[12:15], v[48:51]
    v_xor_b32 v53, s33, v16
    v_or_b32 v52, v52, v53
    s_waitcnt vmcnt(4)
    v_mfma_f32_16x16x32_bf16 v[48:51], v[20:23], v[12:15], v[48:51]
    v_xor_b32 v53, s33, v20
    v_or_b32 v52, v52, v53
    v_and_b32 v52, 1, v52
    v_cmp_ne_u32 vcc, 0, v52
    s_cbranch_vccnz L_rslow_86
L_rgo_87:
    s_nop 2
    v_permlane32_swap_b32 v48, v50
    v_permlane32_swap_b32 v49, v51
    v_pk_add_f32 v[48:49], v[48:49], v[50:51]
    s_mov_b64 exec, s[38:39]
    v_cvt_pk_bf16_f32 v12, v48, v49
    v_min_u32 v12, 0xfffffffe, v12
    buffer_store_dword v12, v119, s[8:11], s24 offen sc1
    s_mov_b64 exec, -1
    s_add_u32 s24, s24, 8192
    s_bitset0_b32 s24, 15
    s_xor_b32 s55, s24, 16384
    s_xor_b32 s29, s29, 0x40000
    s_xor_b32 s53, s29, 1024
    s_bfe_u32 s33, s22, 0x10001
    s_waitcnt lgkmcnt(0)
    s_branch L_chain_top3_s
L_chain_last_s:
    s_nop 1
    v_smfmac_f32_16x16x64_bf16 v[48:51], v[16:19], v[128:135], v116
    v_smfmac_f32_16x16x64_bf16 v[48:51], v[20:23], v[160:167], v116
    v_smfmac_f32_16x16x64_bf16 v[48:51], v[24:27], v[144:151], v116
    v_smfmac_f32_16x16x64_bf16 v[48:51], v[28:31], v[176:183], v116
    v_smfmac_f32_16x16x64_bf16 v[52:55], v[16:19], v[136:143], v116
    v_smfmac_f32_16x16x64_bf16 v[52:55], v[20:23], v[168:175], v116
    v_smfmac_f32_16x16x64_bf16 v[52:55], v[24:27], v[152:159], v116
    v_smfmac_f32_16x16x64_bf16 v[52:55], v[28:31], v[184:191], v116
    v_add_f32 v48, v48, v50
    v_add_f32 v49, v49, v51
    v_cvt_pk_bf16_f32 v112, v48, v49
    s_nop 4
    v_add_f32 v52, v52, v54
    v_add_f32 v53, v53, v55
    v_cvt_pk_bf16_f32 v114, v52, v53
    s_add_u32 s32, s32, 0x20000
    buffer_store_dwordx4 v[112:115], v117, s[8:11], s32 offen sc1
    v_mov_b32 v94, 64
    s_waitcnt vmcnt(0) lgkmcnt(0)
    s_barrier
    s_mov_b64 exec, 1
    buffer_store_dword v94, off, s[8:11], s44 sc1
    s_mov_b64 exec, -1
    s_endpgm
L_mret_59:
    s_mov_b32 s43, m0
    s_mov_b32 m0, 4096
    buffer_load_dwordx4 v[4:7], v117, s[8:11], s48 offen sc1
    buffer_load_dwordx4 v117, s[8:11], s48 offen sc1 lds
    s_mov_b32 m0, 8192
    s_mov_b32 m0, s43
    s_waitcnt vmcnt(0)
    v_max3_u32 v15, v4, v5, v6
    v_max_u32 v15, v15, v7
    v_cmp_lt_u32 vcc, s56, v15
    s_add_u32 s47, s47, 1
    s_add_u32 s49, s49, 1
    s_cmp_ge_u32 s49, 0x10000
    s_cbranch_scc1 L_mgo_60
    s_cbranch_vccnz L_mret_59
    s_branch L_mgo_60
L_smax_62:
    s_add_u32 s47, s47, 1
    s_mov_b32 s35, 0x7f800000
    s_waitcnt lgkmcnt(0)
    s_sub_u32 s43, s30, 0x40000
    s_add_u32 s40, s43, 4096
    s_nop 7
    buffer_load_dwordx4 v[56:59], v117, s[8:11], s43 offen
    buffer_load_dwordx4 v[60:63], v117, s[8:11], s43 offen offset:1024
    buffer_load_dwordx4 v[64:67], v117, s[8:11], s43 offen offset:2048
    buffer_load_dwordx4 v[68:71], v117, s[8:11], s43 offen offset:3072
    buffer_load_dwordx4 v[72:75], v117, s[8:11], s40 offen
    buffer_load_dwordx4 v[76:79], v117, s[8:11], s40 offen offset:1024
    buffer_load_dwordx4 v[80:83], v117, s[8:11], s40 offen offset:2048
    buffer_load_dwordx4 v[84:87], v117, s[8:11], s40 offen offset:3072
    ds_read_b128 v[32:35], v121 offset:16384
    ds_read_b128 v[36:39], v121 offset:17408
    ds_read_b128 v[40:43], v121 offset:18432
    ds_read_b128 v[44:47], v121 offset:19456
    v_mov_b32 v96, 0
    v_mov_b32 v97, 0
    v_mov_b32 v98, 0
    v_mov_b32 v99, 0
    v_mov_b32 v100, 0
    v_mov_b32 v101, 0
    v_mov_b32 v102, 0
    v_mov_b32 v103, 0
    v_mov_b32 v104, 0
    v_mov_b32 v105, 0
    v_mov_b32 v106, 0
    v_mov_b32 v107, 0
    v_mov_b32 v108, 0
    v_mov_b32 v109, 0
    v_mov_b32 v110, 0
    v_mov_b32 v111, 0
    s_waitcnt vmcnt(0) lgkmcnt(0)
    v_mfma_f32_16x16x32_bf16 v[56:59], v[56:59], v[32:35], 0
    v_mfma_f32_16x16x32_bf16 v[56:59], v[60:63], v[36:39], v[56:59]
    v_mfma_f32_16x16x32_bf16 v[56:59], v[64:67], v[40:43], v[56:59]
    v_mfma_f32_16x16x32_bf16 v[56:59], v[68:71], v[44:47], v[56:59]
    v_mfma_f32_16x16x32_bf16 v[60:63], v[72:75], v[32:35], 0
    v_mfma_f32_16x16x32_bf16 v[60:63], v[76:79], v[36:39], v[60:63]
    v_mfma_f32_16x16x32_bf16 v[60:63], v[80:83], v[40:43], v[60:63]
    v_mfma_f32_16x16x32_bf16 v[60:63], v[84:87], v[44:47], v[60:63]
    v_mfma_f32_16x16x32_bf16 v[64:67], v[32:35], v[32:35], 0
    v_mfma_f32_16x16x32_bf16 v[64:67], v[36:39], v[36:39], v[64:67]
    v_mfma_f32_16x16x32_bf16 v[64:67], v[40:43], v[40:43], v[64:67]
    v_mfma_f32_16x16x32_bf16 v[64:67], v[44:47], v[44:47], v[64:67]
    v_max3_f32 v84, v56, v57, v58
    v_max3_f32 v84, v84, v59, v60
    v_max3_f32 v84, v84, v61, v62
    s_nop 4
    v_max3_f32 v84, v84, v63, v64
    v_max_f32 v84, v84, v65
    v_mov_b32 v85, v84
    s_nop 1
    v_permlane32_swap_b32 v85, v84
    v_max_f32 v84, v85, v84
    v_mov_b32 v85, v84
    s_nop 1
    v_permlane16_swap_b32 v85, v84
    v_max_f32 v84, v85, v84
    v_sub_f32 v56, v56, v84
    v_sub_f32 v57, v57, v84
    v_sub_f32 v58, v58, v84
    v_sub_f32 v59, v59, v84
    v_sub_f32 v60, v60, v84
    v_sub_f32 v61, v61, v84
    v_sub_f32 v62, v62, v84
    v_sub_f32 v63, v63, v84
    v_sub_f32 v64, v64, v84
    v_sub_f32 v65, v65, v84
    v_exp_f32 v56, v56
    v_exp_f32 v57, v57
    v_exp_f32 v58, v58
    v_exp_f32 v59, v59
    v_exp_f32 v60, v60
    v_exp_f32 v61, v61
    v_exp_f32 v62, v62
    v_exp_f32 v63, v63
    v_exp_f32 v64, v64
    v_exp_f32 v65, v65
    v_cvt_pk_bf16_f32 v68, v56, v57
    v_cvt_pk_bf16_f32 v69, v58, v59
    v_cvt_pk_bf16_f32 v70, v60, v61
    v_cvt_pk_bf16_f32 v71, v62, v63
    v_cvt_pk_bf16_f32 v52, v64, v65
    s_nop 0
    v_mfma_f32_16x16x32_bf16 v[72:75], v[88:91], v[68:71], 0
    v_mfma_f32_16x16x32_bf16 v[76:79], v[92:95], v[68:71], 0
    v_mfma_f32_16x16x32_bf16 v[80:83], v[48:51], v[68:71], 0
    v_mfma_f32_16x16x16_bf16 v[72:75], v[112:113], v[52:53], v[72:75]
    v_mfma_f32_16x16x16_bf16 v[76:79], v[114:115], v[52:53], v[76:79]
    v_mfma_f32_16x16x16_bf16 v[80:83], v[48:49], v[52:53], v[80:83]
    ds_read_b128 v[32:35], v124 offset:6144
    ds_read_b128 v[36:39], v124 offset:7168
    ds_read_b128 v[40:43], v124 offset:34816
    ds_read_b128 v[44:47], v124 offset:35840
    ds_read_b128 v[56:59], v124 offset:36864
    ds_read_b128 v[64:67], v124 offset:38912
    ds_read_b128 v[68:71], v124 offset:39936
    s_waitcnt lgkmcnt(0)
    s_branch L_norm_61
L_kvw_63:
    s_add_u32 s47, s47, 1
    s_add_u32 s49, s49, 1
    s_cmp_ge_u32 s49, 0x10000
    s_cbranch_scc1 L_kvb_64
    s_sleep 4
    buffer_load_dword v125, v119, s[8:11], s28 offen sc1
    s_waitcnt vmcnt(0)
    v_cmp_eq_u32 vcc, 0, v125
    s_nop 0
    s_and_b64 vcc, vcc, s[58:59]
    s_cbranch_scc1 L_kvw_63
    s_branch L_kvb_64
L_mret_66:
    s_mov_b32 s43, m0
    s_mov_b32 m0, 5120
    buffer_load_dwordx4 v[4:7], v117, s[8:11], s48 offen sc1
    buffer_load_dwordx4 v117, s[8:11], s48 offen sc1 lds
    s_mov_b32 m0, 10240
    s_mov_b32 m0, s43
    s_waitcnt vmcnt(0)
    v_max3_u32 v15, v4, v5, v6
    v_max_u32 v15, v15, v7
    v_cmp_lt_u32 vcc, s56, v15
    s_add_u32 s47, s47, 1
    s_add_u32 s49, s49, 1
    s_cmp_ge_u32 s49, 0x10000
    s_cbranch_scc1 L_mgo_67
    s_cbranch_vccnz L_mret_66
    s_branch L_mgo_67
L_smax_69:
    s_add_u32 s47, s47, 1
    s_mov_b32 s35, 0x7f800000
    s_waitcnt lgkmcnt(0)
    s_sub_u32 s43, s30, 0x40800
    s_add_u32 s40, s43, 4096
    s_nop 7
    buffer_load_dwordx4 v[56:59], v117, s[8:11], s43 offen
    buffer_load_dwordx4 v[60:63], v117, s[8:11], s43 offen offset:1024
    buffer_load_dwordx4 v[64:67], v117, s[8:11], s43 offen offset:2048
    buffer_load_dwordx4 v[68:71], v117, s[8:11], s43 offen offset:3072
    buffer_load_dwordx4 v[72:75], v117, s[8:11], s40 offen
    buffer_load_dwordx4 v[76:79], v117, s[8:11], s40 offen offset:1024
    buffer_load_dwordx4 v[80:83], v117, s[8:11], s40 offen offset:2048
    buffer_load_dwordx4 v[84:87], v117, s[8:11], s40 offen offset:3072
    ds_read_b128 v[32:35], v121 offset:16384
    ds_read_b128 v[36:39], v121 offset:17408
    ds_read_b128 v[40:43], v121 offset:18432
    ds_read_b128 v[44:47], v121 offset:19456
    v_mov_b32 v96, 0
    v_mov_b32 v97, 0
    v_mov_b32 v98, 0
    v_mov_b32 v99, 0
    v_mov_b32 v100, 0
    v_mov_b32 v101, 0
    v_mov_b32 v102, 0
    v_mov_b32 v103, 0
    v_mov_b32 v104, 0
    v_mov_b32 v105, 0
    v_mov_b32 v106, 0
    v_mov_b32 v107, 0
    v_mov_b32 v108, 0
    v_mov_b32 v109, 0
    v_mov_b32 v110, 0
    v_mov_b32 v111, 0
    s_waitcnt vmcnt(0) lgkmcnt(0)
    v_mfma_f32_16x16x32_bf16 v[56:59], v[56:59], v[32:35], 0
    v_mfma_f32_16x16x32_bf16 v[56:59], v[60:63], v[36:39], v[56:59]
    v_mfma_f32_16x16x32_bf16 v[56:59], v[64:67], v[40:43], v[56:59]
    v_mfma_f32_16x16x32_bf16 v[56:59], v[68:71], v[44:47], v[56:59]
    v_mfma_f32_16x16x32_bf16 v[60:63], v[72:75], v[32:35], 0
    v_mfma_f32_16x16x32_bf16 v[60:63], v[76:79], v[36:39], v[60:63]
    v_mfma_f32_16x16x32_bf16 v[60:63], v[80:83], v[40:43], v[60:63]
    v_mfma_f32_16x16x32_bf16 v[60:63], v[84:87], v[44:47], v[60:63]
    v_mfma_f32_16x16x32_bf16 v[64:67], v[32:35], v[32:35], 0
    v_mfma_f32_16x16x32_bf16 v[64:67], v[36:39], v[36:39], v[64:67]
    v_mfma_f32_16x16x32_bf16 v[64:67], v[40:43], v[40:43], v[64:67]
    v_mfma_f32_16x16x32_bf16 v[64:67], v[44:47], v[44:47], v[64:67]
    v_max3_f32 v84, v56, v57, v58
    v_max3_f32 v84, v84, v59, v60
    v_max3_f32 v84, v84, v61, v62
    s_nop 4
    v_max3_f32 v84, v84, v63, v64
    v_max_f32 v84, v84, v65
    v_mov_b32 v85, v84
    s_nop 1
    v_permlane32_swap_b32 v85, v84
    v_max_f32 v84, v85, v84
    v_mov_b32 v85, v84
    s_nop 1
    v_permlane16_swap_b32 v85, v84
    v_max_f32 v84, v85, v84
    v_sub_f32 v56, v56, v84
    v_sub_f32 v57, v57, v84
    v_sub_f32 v58, v58, v84
    v_sub_f32 v59, v59, v84
    v_sub_f32 v60, v60, v84
    v_sub_f32 v61, v61, v84
    v_sub_f32 v62, v62, v84
    v_sub_f32 v63, v63, v84
    v_sub_f32 v64, v64, v84
    v_sub_f32 v65, v65, v84
    v_exp_f32 v56, v56
    v_exp_f32 v57, v57
    v_exp_f32 v58, v58
    v_exp_f32 v59, v59
    v_exp_f32 v60, v60
    v_exp_f32 v61, v61
    v_exp_f32 v62, v62
    v_exp_f32 v63, v63
    v_exp_f32 v64, v64
    v_exp_f32 v65, v65
    v_cvt_pk_bf16_f32 v68, v56, v57
    v_cvt_pk_bf16_f32 v69, v58, v59
    v_cvt_pk_bf16_f32 v70, v60, v61
    v_cvt_pk_bf16_f32 v71, v62, v63
    v_cvt_pk_bf16_f32 v52, v64, v65
    s_nop 0
    v_mfma_f32_16x16x32_bf16 v[72:75], v[88:91], v[68:71], 0
    v_mfma_f32_16x16x32_bf16 v[76:79], v[92:95], v[68:71], 0
    v_mfma_f32_16x16x32_bf16 v[80:83], v[48:51], v[68:71], 0
    v_mfma_f32_16x16x16_bf16 v[72:75], v[112:113], v[52:53], v[72:75]
    v_mfma_f32_16x16x16_bf16 v[76:79], v[114:115], v[52:53], v[76:79]
    v_mfma_f32_16x16x16_bf16 v[80:83], v[48:49], v[52:53], v[80:83]
    ds_read_b128 v[32:35], v124 offset:6144
    ds_read_b128 v[36:39], v124 offset:7168
    ds_read_b128 v[40:43], v124 offset:34816
    ds_read_b128 v[44:47], v124 offset:35840
    ds_read_b128 v[56:59], v124 offset:36864
    ds_read_b128 v[64:67], v124 offset:38912
    ds_read_b128 v[68:71], v124 offset:39936
    s_waitcnt lgkmcnt(0)
    s_branch L_norm_68
L_kvw_70:
    s_add_u32 s47, s47, 1
    s_add_u32 s49, s49, 1
    s_cmp_ge_u32 s49, 0x10000
    s_cbranch_scc1 L_kvb_71
    s_sleep 4
    buffer_load_dword v125, v119, s[8:11], s28 offen sc1
    s_waitcnt vmcnt(0)
    v_cmp_eq_u32 vcc, 0, v125
    s_nop 0
    s_and_b64 vcc, vcc, s[58:59]
    s_cbranch_scc1 L_kvw_70
    s_branch L_kvb_71
L_mret_73:
    s_mov_b32 s43, m0
    s_mov_b32 m0, 6144
    buffer_load_dwordx4 v[4:7], v117, s[8:11], s48 offen sc1
    buffer_load_dwordx4 v117, s[8:11], s48 offen sc1 lds
    s_mov_b32 m0, 12288
    s_mov_b32 m0, s43
    s_waitcnt vmcnt(0)
    v_max3_u32 v15, v4, v5, v6
    v_max_u32 v15, v15, v7
    v_cmp_lt_u32 vcc, s56, v15
    s_add_u32 s47, s47, 1
    s_add_u32 s49, s49, 1
    s_cmp_ge_u32 s49, 0x10000
    s_cbranch_scc1 L_mgo_74
    s_cbranch_vccnz L_mret_73
    s_branch L_mgo_74
L_smax_76:
    s_add_u32 s47, s47, 1
    s_mov_b32 s35, 0x7f800000
    s_waitcnt lgkmcnt(0)
    s_sub_u32 s43, s30, 0x41000
    s_add_u32 s40, s43, 4096
    s_nop 7
    buffer_load_dwordx4 v[56:59], v117, s[8:11], s43 offen
    buffer_load_dwordx4 v[60:63], v117, s[8:11], s43 offen offset:1024
    buffer_load_dwordx4 v[64:67], v117, s[8:11], s43 offen offset:2048
    buffer_load_dwordx4 v[68:71], v117, s[8:11], s43 offen offset:3072
    buffer_load_dwordx4 v[72:75], v117, s[8:11], s40 offen
    buffer_load_dwordx4 v[76:79], v117, s[8:11], s40 offen offset:1024
    buffer_load_dwordx4 v[80:83], v117, s[8:11], s40 offen offset:2048
    buffer_load_dwordx4 v[84:87], v117, s[8:11], s40 offen offset:3072
    ds_read_b128 v[32:35], v121 offset:16384
    ds_read_b128 v[36:39], v121 offset:17408
    ds_read_b128 v[40:43], v121 offset:18432
    ds_read_b128 v[44:47], v121 offset:19456
    v_mov_b32 v96, 0
    v_mov_b32 v97, 0
    v_mov_b32 v98, 0
    v_mov_b32 v99, 0
    v_mov_b32 v100, 0
    v_mov_b32 v101, 0
    v_mov_b32 v102, 0
    v_mov_b32 v103, 0
    v_mov_b32 v104, 0
    v_mov_b32 v105, 0
    v_mov_b32 v106, 0
    v_mov_b32 v107, 0
    v_mov_b32 v108, 0
    v_mov_b32 v109, 0
    v_mov_b32 v110, 0
    v_mov_b32 v111, 0
    s_waitcnt vmcnt(0) lgkmcnt(0)
    v_mfma_f32_16x16x32_bf16 v[56:59], v[56:59], v[32:35], 0
    v_mfma_f32_16x16x32_bf16 v[56:59], v[60:63], v[36:39], v[56:59]
    v_mfma_f32_16x16x32_bf16 v[56:59], v[64:67], v[40:43], v[56:59]
    v_mfma_f32_16x16x32_bf16 v[56:59], v[68:71], v[44:47], v[56:59]
    v_mfma_f32_16x16x32_bf16 v[60:63], v[72:75], v[32:35], 0
    v_mfma_f32_16x16x32_bf16 v[60:63], v[76:79], v[36:39], v[60:63]
    v_mfma_f32_16x16x32_bf16 v[60:63], v[80:83], v[40:43], v[60:63]
    v_mfma_f32_16x16x32_bf16 v[60:63], v[84:87], v[44:47], v[60:63]
    v_mfma_f32_16x16x32_bf16 v[64:67], v[32:35], v[32:35], 0
    v_mfma_f32_16x16x32_bf16 v[64:67], v[36:39], v[36:39], v[64:67]
    v_mfma_f32_16x16x32_bf16 v[64:67], v[40:43], v[40:43], v[64:67]
    v_mfma_f32_16x16x32_bf16 v[64:67], v[44:47], v[44:47], v[64:67]
    v_max3_f32 v84, v56, v57, v58
    v_max3_f32 v84, v84, v59, v60
    v_max3_f32 v84, v84, v61, v62
    s_nop 4
    v_max3_f32 v84, v84, v63, v64
    v_max_f32 v84, v84, v65
    v_mov_b32 v85, v84
    s_nop 1
    v_permlane32_swap_b32 v85, v84
    v_max_f32 v84, v85, v84
    v_mov_b32 v85, v84
    s_nop 1
    v_permlane16_swap_b32 v85, v84
    v_max_f32 v84, v85, v84
    v_sub_f32 v56, v56, v84
    v_sub_f32 v57, v57, v84
    v_sub_f32 v58, v58, v84
    v_sub_f32 v59, v59, v84
    v_sub_f32 v60, v60, v84
    v_sub_f32 v61, v61, v84
    v_sub_f32 v62, v62, v84
    v_sub_f32 v63, v63, v84
    v_sub_f32 v64, v64, v84
    v_sub_f32 v65, v65, v84
    v_exp_f32 v56, v56
    v_exp_f32 v57, v57
    v_exp_f32 v58, v58
    v_exp_f32 v59, v59
    v_exp_f32 v60, v60
    v_exp_f32 v61, v61
    v_exp_f32 v62, v62
    v_exp_f32 v63, v63
    v_exp_f32 v64, v64
    v_exp_f32 v65, v65
    v_cvt_pk_bf16_f32 v68, v56, v57
    v_cvt_pk_bf16_f32 v69, v58, v59
    v_cvt_pk_bf16_f32 v70, v60, v61
    v_cvt_pk_bf16_f32 v71, v62, v63
    v_cvt_pk_bf16_f32 v52, v64, v65
    s_nop 0
    v_mfma_f32_16x16x32_bf16 v[72:75], v[88:91], v[68:71], 0
    v_mfma_f32_16x16x32_bf16 v[76:79], v[92:95], v[68:71], 0
    v_mfma_f32_16x16x32_bf16 v[80:83], v[48:51], v[68:71], 0
    v_mfma_f32_16x16x16_bf16 v[72:75], v[112:113], v[52:53], v[72:75]
    v_mfma_f32_16x16x16_bf16 v[76:79], v[114:115], v[52:53], v[76:79]
    v_mfma_f32_16x16x16_bf16 v[80:83], v[48:49], v[52:53], v[80:83]
    ds_read_b128 v[32:35], v124 offset:6144
    ds_read_b128 v[36:39], v124 offset:7168
    ds_read_b128 v[40:43], v124 offset:34816
    ds_read_b128 v[44:47], v124 offset:35840
    ds_read_b128 v[56:59], v124 offset:36864
    ds_read_b128 v[64:67], v124 offset:38912
    ds_read_b128 v[68:71], v124 offset:39936
    s_waitcnt lgkmcnt(0)
    s_branch L_norm_75
L_rslow_78:
    buffer_load_dwordx4 v[4:7], v117, s[8:11], s29 offen sc1
    buffer_load_dwordx4 v[8:11], v117, s[8:11], s53 offen sc1
    buffer_load_dwordx4 v[16:19], v117, s[8:11], s29 offen offset:2048 sc1
    buffer_load_dwordx4 v[20:23], v117, s[8:11], s53 offen offset:2048 sc1
    s_add_u32 s46, s46, 1
    s_add_u32 s49, s49, 1
    s_cmp_ge_u32 s49, 0x10000
    s_cbranch_scc1 L_rgo_79
    s_waitcnt vmcnt(7)
    v_mfma_f32_16x16x32_bf16 v[48:51], v[32:35], v[12:15], 0
    v_xor_b32 v52, s33, v32
    s_waitcnt vmcnt(6)
    v_mfma_f32_16x16x32_bf16 v[48:51], v[36:39], v[12:15], v[48:51]
    v_xor_b32 v53, s33, v36
    v_or_b32 v52, v52, v53
    s_waitcnt vmcnt(5)
    v_mfma_f32_16x16x32_bf16 v[48:51], v[40:43], v[12:15], v[48:51]
    v_xor_b32 v53, s33, v40
    v_or_b32 v52, v52, v53
    s_waitcnt vmcnt(4)
    v_mfma_f32_16x16x32_bf16 v[48:51], v[44:47], v[12:15], v[48:51]
    v_xor_b32 v53, s33, v44
    v_or_b32 v52, v52, v53
    v_and_b32 v52, 1, v52
    v_cmp_ne_u32 vcc, 0, v52
    s_cbranch_vccz L_rgo_79
    buffer_load_dwordx4 v[32:35], v117, s[8:11], s29 offen sc1
    buffer_load_dwordx4 v[36:39], v117, s[8:11], s53 offen sc1
    buffer_load_dwordx4 v[40:43], v117, s[8:11], s29 offen offset:2048 sc1
    buffer_load_dwordx4 v[44:47], v117, s[8:11], s53 offen offset:2048 sc1
    s_add_u32 s46, s46, 1
    s_branch L_rl_77
L_mret_81:
    s_mov_b32 s43, m0
    s_mov_b32 m0, 7168
    buffer_load_dwordx4 v[4:7], v117, s[8:11], s48 offen sc1
    buffer_load_dwordx4 v117, s[8:11], s48 offen sc1 lds
    s_mov_b32 m0, 14336
    s_mov_b32 m0, s43
    s_waitcnt vmcnt(0)
    v_max3_u32 v15, v4, v5, v6
    v_max_u32 v15, v15, v7
    v_cmp_lt_u32 vcc, s56, v15
    s_add_u32 s47, s47, 1
    s_add_u32 s49, s49, 1
    s_cmp_ge_u32 s49, 0x10000
    s_cbranch_scc1 L_mgo_82
    s_cbranch_vccnz L_mret_81
    s_branch L_mgo_82
L_smax_84:
    s_add_u32 s47, s47, 1
    s_mov_b32 s35, 0x7f800000
    s_waitcnt lgkmcnt(0)
    s_sub_u32 s43, s30, 0x41800
    s_add_u32 s40, s43, 4096
    s_nop 7
    buffer_load_dwordx4 v[56:59], v117, s[8:11], s43 offen
    buffer_load_dwordx4 v[60:63], v117, s[8:11], s43 offen offset:1024
    buffer_load_dwordx4 v[64:67], v117, s[8:11], s43 offen offset:2048
    buffer_load_dwordx4 v[68:71], v117, s[8:11], s43 offen offset:3072
    buffer_load_dwordx4 v[72:75], v117, s[8:11], s40 offen
    buffer_load_dwordx4 v[76:79], v117, s[8:11], s40 offen offset:1024
    buffer_load_dwordx4 v[80:83], v117, s[8:11], s40 offen offset:2048
    buffer_load_dwordx4 v[84:87], v117, s[8:11], s40 offen offset:3072
    ds_read_b128 v[32:35], v121 offset:16384
    ds_read_b128 v[36:39], v121 offset:17408
    ds_read_b128 v[40:43], v121 offset:18432
    ds_read_b128 v[44:47], v121 offset:19456
    v_mov_b32 v96, 0
    v_mov_b32 v97, 0
    v_mov_b32 v98, 0
    v_mov_b32 v99, 0
    v_mov_b32 v100, 0
    v_mov_b32 v101, 0
    v_mov_b32 v102, 0
    v_mov_b32 v103, 0
    v_mov_b32 v104, 0
    v_mov_b32 v105, 0
    v_mov_b32 v106, 0
    v_mov_b32 v107, 0
    v_mov_b32 v108, 0
    v_mov_b32 v109, 0
    v_mov_b32 v110, 0
    v_mov_b32 v111, 0
    s_waitcnt vmcnt(0) lgkmcnt(0)
    v_mfma_f32_16x16x32_bf16 v[56:59], v[56:59], v[32:35], 0
    v_mfma_f32_16x16x32_bf16 v[56:59], v[60:63], v[36:39], v[56:59]
    v_mfma_f32_16x16x32_bf16 v[56:59], v[64:67], v[40:43], v[56:59]
    v_mfma_f32_16x16x32_bf16 v[56:59], v[68:71], v[44:47], v[56:59]
    v_mfma_f32_16x16x32_bf16 v[60:63], v[72:75], v[32:35], 0
    v_mfma_f32_16x16x32_bf16 v[60:63], v[76:79], v[36:39], v[60:63]
    v_mfma_f32_16x16x32_bf16 v[60:63], v[80:83], v[40:43], v[60:63]
    v_mfma_f32_16x16x32_bf16 v[60:63], v[84:87], v[44:47], v[60:63]
    v_mfma_f32_16x16x32_bf16 v[64:67], v[32:35], v[32:35], 0
    v_mfma_f32_16x16x32_bf16 v[64:67], v[36:39], v[36:39], v[64:67]
    v_mfma_f32_16x16x32_bf16 v[64:67], v[40:43], v[40:43], v[64:67]
    v_mfma_f32_16x16x32_bf16 v[64:67], v[44:47], v[44:47], v[64:67]
    v_max3_f32 v84, v56, v57, v58
    v_max3_f32 v84, v84, v59, v60
    v_max3_f32 v84, v84, v61, v62
    s_nop 4
    v_max3_f32 v84, v84, v63, v64
    v_max_f32 v84, v84, v65
    v_mov_b32 v85, v84
    s_nop 1
    v_permlane32_swap_b32 v85, v84
    v_max_f32 v84, v85, v84
    v_mov_b32 v85, v84
    s_nop 1
    v_permlane16_swap_b32 v85, v84
    v_max_f32 v84, v85, v84
    v_sub_f32 v56, v56, v84
    v_sub_f32 v57, v57, v84
    v_sub_f32 v58, v58, v84
    v_sub_f32 v59, v59, v84
    v_sub_f32 v60, v60, v84
    v_sub_f32 v61, v61, v84
    v_sub_f32 v62, v62, v84
    v_sub_f32 v63, v63, v84
    v_sub_f32 v64, v64, v84
    v_sub_f32 v65, v65, v84
    v_exp_f32 v56, v56
    v_exp_f32 v57, v57
    v_exp_f32 v58, v58
    v_exp_f32 v59, v59
    v_exp_f32 v60, v60
    v_exp_f32 v61, v61
    v_exp_f32 v62, v62
    v_exp_f32 v63, v63
    v_exp_f32 v64, v64
    v_exp_f32 v65, v65
    v_cvt_pk_bf16_f32 v68, v56, v57
    v_cvt_pk_bf16_f32 v69, v58, v59
    v_cvt_pk_bf16_f32 v70, v60, v61
    v_cvt_pk_bf16_f32 v71, v62, v63
    v_cvt_pk_bf16_f32 v52, v64, v65
    s_nop 0
    v_mfma_f32_16x16x32_bf16 v[72:75], v[88:91], v[68:71], 0
    v_mfma_f32_16x16x32_bf16 v[76:79], v[92:95], v[68:71], 0
    v_mfma_f32_16x16x32_bf16 v[80:83], v[48:51], v[68:71], 0
    v_mfma_f32_16x16x16_bf16 v[72:75], v[112:113], v[52:53], v[72:75]
    v_mfma_f32_16x16x16_bf16 v[76:79], v[114:115], v[52:53], v[76:79]
    v_mfma_f32_16x16x16_bf16 v[80:83], v[48:49], v[52:53], v[80:83]
    ds_read_b128 v[32:35], v124 offset:6144
    ds_read_b128 v[36:39], v124 offset:7168
    ds_read_b128 v[40:43], v124 offset:34816
    ds_read_b128 v[44:47], v124 offset:35840
    ds_read_b128 v[56:59], v124 offset:36864
    ds_read_b128 v[64:67], v124 offset:38912
    ds_read_b128 v[68:71], v124 offset:39936
    s_waitcnt lgkmcnt(0)
    s_branch L_norm_83
L_rslow_86:
    buffer_load_dwordx4 v[4:7], v117, s[8:11], s29 offen sc1
    buffer_load_dwordx4 v[8:11], v117, s[8:11], s53 offen sc1
    buffer_load_dwordx4 v[16:19], v117, s[8:11], s29 offen offset:2048 sc1
    buffer_load_dwordx4 v[20:23], v117, s[8:11], s53 offen offset:2048 sc1
    s_add_u32 s46, s46, 1
    s_add_u32 s49, s49, 1
    s_cmp_ge_u32 s49, 0x10000
    s_cbranch_scc1 L_rgo_87
    s_waitcnt vmcnt(7)
    v_mfma_f32_16x16x32_bf16 v[48:51], v[32:35], v[12:15], 0
    v_xor_b32 v52, s33, v32
    s_waitcnt vmcnt(6)
    v_mfma_f32_16x16x32_bf16 v[48:51], v[36:39], v[12:15], v[48:51]
    v_xor_b32 v53, s33, v36
    v_or_b32 v52, v52, v53
    s_waitcnt vmcnt(5)
    v_mfma_f32_16x16x32_bf16 v[48:51], v[40:43], v[12:15], v[48:51]
    v_xor_b32 v53, s33, v40
    v_or_b32 v52, v52, v53
    s_waitcnt vmcnt(4)
    v_mfma_f32_16x16x32_bf16 v[48:51], v[44:47], v[12:15], v[48:51]
    v_xor_b32 v53, s33, v44
    v_or_b32 v52, v52, v53
    v_and_b32 v52, 1, v52
    v_cmp_ne_u32 vcc, 0, v52
    s_cbranch_vccz L_rgo_87
    buffer_load_dwordx4 v[32:35], v117, s[8:11], s29 offen sc1
    buffer_load_dwordx4 v[36:39], v117, s[8:11], s53 offen sc1
    buffer_load_dwordx4 v[40:43], v117, s[8:11], s29 offen offset:2048 sc1
    buffer_load_dwordx4 v[44:47], v117, s[8:11], s53 offen offset:2048 sc1
    s_add_u32 s46, s46, 1
    s_branch L_rl_85
L_bulk:
    s_load_dwordx8 s[60:67], s[0:1], 16
    s_load_dwordx2 s[12:13], s[0:1], 0
    s_waitcnt lgkmcnt(0)
    s_branch L_bulk2
.p2align 7
L_other:
    s_sub_u32 s101, s84, 1
    s_lshl_b32 s101, s101, 5
    s_add_u32 s101, s101, s85
    s_cmp_ge_u32 s85, 2
    s_cbranch_scc1 L_nobc
    v_lshlrev_b32 v1, 6, v0
    s_lshl_b32 s96, s85, 14
    s_getpc_b64 s[4:5]
L_pc_88:
    s_add_u32 s4, s4, L_bulk2-L_pc_88
    s_addc_u32 s5, s5, 0
    v_add_u32 v1, s96, v1
    v_min_u32 v1, L_code_end-L_bulk2-4, v1
    global_load_dword v255, v1, s[4:5]
L_nobc:
    s_waitcnt lgkmcnt(0)
    s_and_b32 s9, s9, 0xffff
    s_mov_b32 s10, 0x10000000
    s_mov_b32 s11, 0x20000
    s_and_b32 s93, s93, 0xffff
    s_mov_b32 s94, 0x100
    s_mov_b32 s95, 0x20000
    s_mov_b32 s87, 0
    s_cmp_lg_u32 s86, 0
    s_cbranch_scc1 L_reg_89
    s_lshl_b32 s97, s84, 4
    s_lshl_b32 s96, 1, s85
    v_mov_b32 v250, s96
    v_mov_b32 v251, 256
    s_mov_b64 exec, 1
    buffer_atomic_add_x2 v[250:251], off, s[92:95], s97 offset:64
    s_mov_b64 exec, -1
    s_mov_b32 s86, 1
L_reg_89:
L_bulk2:
    s_add_u32 s88, s101, 32
    s_mov_b32 s41, 0
    s_lshr_b32 s20, s101, 6
    s_and_b32 s22, s101, 63
    s_cmp_ge_u32 s101, 192
    s_cselect_b32 s37, 32, 1000
L_p1go:
    s_mov_b32 s40, 0
    s_mov_b32 s80, 0
    s_mov_b32 s23, 0
L_p1_pass:
    v_mbcnt_lo_u32_b32 v0, -1, 0
    v_mbcnt_hi_u32_b32 v0, -1, v0
    s_lshl_b32 s96, s100, 6
    v_add_u32 v0, s96, v0
    s_and_b32 s13, s13, 0xffff
    s_mov_b32 s14, 0x200000
    s_mov_b32 s15, 0x20000
    v_lshrrev_b32 v147, 6, v0
    s_nop 0
    v_readfirstlane_b32 s21, v147
    v_and_b32 v144, 63, v0
    v_lshrrev_b32 v145, 4, v144
    v_and_b32 v146, 15, v144
    v_lshrrev_b32 v149, 2, v146
    v_lshlrev_b32 v137, 4, v144
    s_lshl_b32 s29, s21, 10
    s_lshl_b32 s26, s20, 7
    s_lshl_b32 s27, s21, 5
    s_add_u32 s26, s26, s27
    v_add_u32 v147, s26, v146
    v_lshlrev_b32 v147, 10, v147
    v_lshl_add_u32 v139, v145, 4, v147
    s_mov_b32 s26, 0x0
    buffer_load_dwordx4 v[0:3], v139, s[12:15], s26 offen
    buffer_load_dwordx4 v[4:7], v139, s[12:15], s26 offen offset:64
    buffer_load_dwordx4 v[8:11], v139, s[12:15], s26 offen offset:128
    buffer_load_dwordx4 v[12:15], v139, s[12:15], s26 offen offset:192
    buffer_load_dwordx4 v[16:19], v139, s[12:15], s26 offen offset:256
    buffer_load_dwordx4 v[20:23], v139, s[12:15], s26 offen offset:320
    buffer_load_dwordx4 v[24:27], v139, s[12:15], s26 offen offset:384
    buffer_load_dwordx4 v[28:31], v139, s[12:15], s26 offen offset:448
    buffer_load_dwordx4 v[32:35], v139, s[12:15], s26 offen offset:512
    buffer_load_dwordx4 v[36:39], v139, s[12:15], s26 offen offset:576
    buffer_load_dwordx4 v[40:43], v139, s[12:15], s26 offen offset:640
    buffer_load_dwordx4 v[44:47], v139, s[12:15], s26 offen offset:704
    buffer_load_dwordx4 v[48:51], v139, s[12:15], s26 offen offset:768
    buffer_load_dwordx4 v[52:55], v139, s[12:15], s26 offen offset:832
    buffer_load_dwordx4 v[56:59], v139, s[12:15], s26 offen offset:896
    buffer_load_dwordx4 v[60:63], v139, s[12:15], s26 offen offset:960
    s_mov_b32 s26, 0x4000
    buffer_load_dwordx4 v[64:67], v139, s[12:15], s26 offen
    buffer_load_dwordx4 v[68:71], v139, s[12:15], s26 offen offset:64
    buffer_load_dwordx4 v[72:75], v139, s[12:15], s26 offen offset:128
    buffer_load_dwordx4 v[76:79], v139, s[12:15], s26 offen offset:192
    buffer_load_dwordx4 v[80:83], v139, s[12:15], s26 offen offset:256
    buffer_load_dwordx4 v[84:87], v139, s[12:15], s26 offen offset:320
    buffer_load_dwordx4 v[88:91], v139, s[12:15], s26 offen offset:384
    buffer_load_dwordx4 v[92:95], v139, s[12:15], s26 offen offset:448
    buffer_load_dwordx4 v[96:99], v139, s[12:15], s26 offen offset:512
    buffer_load_dwordx4 v[100:103], v139, s[12:15], s26 offen offset:576
    buffer_load_dwordx4 v[104:107], v139, s[12:15], s26 offen offset:640
    buffer_load_dwordx4 v[108:111], v139, s[12:15], s26 offen offset:704
    buffer_load_dwordx4 v[112:115], v139, s[12:15], s26 offen offset:768
    buffer_load_dwordx4 v[116:119], v139, s[12:15], s26 offen offset:832
    buffer_load_dwordx4 v[120:123], v139, s[12:15], s26 offen offset:896
    buffer_load_dwordx4 v[124:127], v139, s[12:15], s26 offen offset:960
    s_lshr_b32 s26, s21, 1
    s_lshl_b32 s26, s26, 2
    v_or_b32 v148, s26, v145
    v_lshlrev_b32 v148, 1, v148
    v_xor_b32 v148, v148, v146
    v_lshlrev_b32 v148, 4, v148
    s_lshl_b32 s26, s21, 2
    v_add_u32 v147, s26, v145
    v_lshl_add_u32 v136, v147, 13, v148
    v_lshl_add_u32 v147, v145, 3, v149
    v_lshlrev_b32 v147, 8, v147
    v_and_b32 v148, 1, v145
    v_lshl_or_b32 v148, v148, 2, v149
    v_lshl_add_u32 v147, v148, 5, v147
    v_and_b32 v148, 3, v146
    v_lshl_add_u32 v128, v148, 3, v147
    v_xor_b32 v129, 32, v128
    v_xor_b32 v130, 64, v128
    v_xor_b32 v131, 96, v128
    v_xor_b32 v132, 128, v128
    v_xor_b32 v133, 160, v128
    v_xor_b32 v134, 192, v128
    v_xor_b32 v135, 224, v128
    s_mov_b32 s19, 0x20000
    s_mov_b32 s38, s22
    s_mov_b32 s39, s22
    v_mov_b32 v158, 0x3f803f80
    s_lshr_b32 s26, s39, 5
    s_cmp_eq_u32 s26, 0
    s_cselect_b64 s[16:17], s[62:63], s[60:61]
    s_cmp_eq_u32 s26, 1
    s_cselect_b64 s[16:17], s[64:65], s[16:17]
    s_and_b32 s17, s17, 0xffff
    s_cmp_lt_u32 s39, 96
    s_cselect_b32 s18, 0x400000, 0
    s_and_b32 s24, s39, 31
    s_lshl_b32 s24, s24, 8
    s_waitcnt vmcnt(16)
    v_pk_mov_b32 v[150:151], 0, 0
    v_pk_mov_b32 v[152:153], 0, 0
    v_dot2_f32_bf16 v150, v0, v158, v150
    v_dot2_f32_bf16 v152, v0, v0, v152
    v_dot2_f32_bf16 v151, v1, v158, v151
    v_dot2_f32_bf16 v153, v1, v1, v153
    v_dot2_f32_bf16 v150, v2, v158, v150
    v_dot2_f32_bf16 v152, v2, v2, v152
    v_dot2_f32_bf16 v151, v3, v158, v151
    v_dot2_f32_bf16 v153, v3, v3, v153
    v_dot2_f32_bf16 v150, v4, v158, v150
    v_dot2_f32_bf16 v152, v4, v4, v152
    v_dot2_f32_bf16 v151, v5, v158, v151
    v_dot2_f32_bf16 v153, v5, v5, v153
    v_dot2_f32_bf16 v150, v6, v158, v150
    v_dot2_f32_bf16 v152, v6, v6, v152
    v_dot2_f32_bf16 v151, v7, v158, v151
    v_dot2_f32_bf16 v153, v7, v7, v153
    v_dot2_f32_bf16 v150, v8, v158, v150
    v_dot2_f32_bf16 v152, v8, v8, v152
    v_dot2_f32_bf16 v151, v9, v158, v151
    v_dot2_f32_bf16 v153, v9, v9, v153
    v_dot2_f32_bf16 v150, v10, v158, v150
    v_dot2_f32_bf16 v152, v10, v10, v152
    v_dot2_f32_bf16 v151, v11, v158, v151
    v_dot2_f32_bf16 v153, v11, v11, v153
    v_dot2_f32_bf16 v150, v12, v158, v150
    v_dot2_f32_bf16 v152, v12, v12, v152
    v_dot2_f32_bf16 v151, v13, v158, v151
    v_dot2_f32_bf16 v153, v13, v13, v153
    v_dot2_f32_bf16 v150, v14, v158, v150
    v_dot2_f32_bf16 v152, v14, v14, v152
    v_dot2_f32_bf16 v151, v15, v158, v151
    v_dot2_f32_bf16 v153, v15, v15, v153
    v_dot2_f32_bf16 v150, v16, v158, v150
    v_dot2_f32_bf16 v152, v16, v16, v152
    v_dot2_f32_bf16 v151, v17, v158, v151
    v_dot2_f32_bf16 v153, v17, v17, v153
    v_dot2_f32_bf16 v150, v18, v158, v150
    v_dot2_f32_bf16 v152, v18, v18, v152
    v_dot2_f32_bf16 v151, v19, v158, v151
    v_dot2_f32_bf16 v153, v19, v19, v153
    v_dot2_f32_bf16 v150, v20, v158, v150
    v_dot2_f32_bf16 v152, v20, v20, v152
    v_dot2_f32_bf16 v151, v21, v158, v151
    v_dot2_f32_bf16 v153, v21, v21, v153
    v_dot2_f32_bf16 v150, v22, v158, v150
    v_dot2_f32_bf16 v152, v22, v22, v152
    v_dot2_f32_bf16 v151, v23, v158, v151
    v_dot2_f32_bf16 v153, v23, v23, v153
    v_dot2_f32_bf16 v150, v24, v158, v150
    v_dot2_f32_bf16 v152, v24, v24, v152
    v_dot2_f32_bf16 v151, v25, v158, v151
    v_dot2_f32_bf16 v153, v25, v25, v153
    v_dot2_f32_bf16 v150, v26, v158, v150
    v_dot2_f32_bf16 v152, v26, v26, v152
    v_dot2_f32_bf16 v151, v27, v158, v151
    v_dot2_f32_bf16 v153, v27, v27, v153
    v_dot2_f32_bf16 v150, v28, v158, v150
    v_dot2_f32_bf16 v152, v28, v28, v152
    v_dot2_f32_bf16 v151, v29, v158, v151
    v_dot2_f32_bf16 v153, v29, v29, v153
    v_dot2_f32_bf16 v150, v30, v158, v150
    v_dot2_f32_bf16 v152, v30, v30, v152
    v_dot2_f32_bf16 v151, v31, v158, v151
    v_dot2_f32_bf16 v153, v31, v31, v153
    v_dot2_f32_bf16 v150, v32, v158, v150
    v_dot2_f32_bf16 v152, v32, v32, v152
    v_dot2_f32_bf16 v151, v33, v158, v151
    v_dot2_f32_bf16 v153, v33, v33, v153
    v_dot2_f32_bf16 v150, v34, v158, v150
    v_dot2_f32_bf16 v152, v34, v34, v152
    v_dot2_f32_bf16 v151, v35, v158, v151
    v_dot2_f32_bf16 v153, v35, v35, v153
    v_dot2_f32_bf16 v150, v36, v158, v150
    v_dot2_f32_bf16 v152, v36, v36, v152
    v_dot2_f32_bf16 v151, v37, v158, v151
    v_dot2_f32_bf16 v153, v37, v37, v153
    v_dot2_f32_bf16 v150, v38, v158, v150
    v_dot2_f32_bf16 v152, v38, v38, v152
    v_dot2_f32_bf16 v151, v39, v158, v151
    v_dot2_f32_bf16 v153, v39, v39, v153
    v_dot2_f32_bf16 v150, v40, v158, v150
    v_dot2_f32_bf16 v152, v40, v40, v152
    v_dot2_f32_bf16 v151, v41, v158, v151
    v_dot2_f32_bf16 v153, v41, v41, v153
    v_dot2_f32_bf16 v150, v42, v158, v150
    v_dot2_f32_bf16 v152, v42, v42, v152
    v_dot2_f32_bf16 v151, v43, v158, v151
    v_dot2_f32_bf16 v153, v43, v43, v153
    v_dot2_f32_bf16 v150, v44, v158, v150
    v_dot2_f32_bf16 v152, v44, v44, v152
    v_dot2_f32_bf16 v151, v45, v158, v151
    v_dot2_f32_bf16 v153, v45, v45, v153
    v_dot2_f32_bf16 v150, v46, v158, v150
    v_dot2_f32_bf16 v152, v46, v46, v152
    v_dot2_f32_bf16 v151, v47, v158, v151
    v_dot2_f32_bf16 v153, v47, v47, v153
    v_dot2_f32_bf16 v150, v48, v158, v150
    v_dot2_f32_bf16 v152, v48, v48, v152
    v_dot2_f32_bf16 v151, v49, v158, v151
    v_dot2_f32_bf16 v153, v49, v49, v153
    s_add_u32 s26, s24, 0x0
    s_add_u32 m0, s29, 0x0
    s_nop 0
    buffer_load_dwordx4 v136, s[16:19], s26 offen lds
    v_dot2_f32_bf16 v150, v50, v158, v150
    v_dot2_f32_bf16 v152, v50, v50, v152
    v_dot2_f32_bf16 v151, v51, v158, v151
    v_dot2_f32_bf16 v153, v51, v51, v153
    v_dot2_f32_bf16 v150, v52, v158, v150
    v_dot2_f32_bf16 v152, v52, v52, v152
    v_dot2_f32_bf16 v151, v53, v158, v151
    v_dot2_f32_bf16 v153, v53, v53, v153
    v_dot2_f32_bf16 v150, v54, v158, v150
    v_dot2_f32_bf16 v152, v54, v54, v152
    v_dot2_f32_bf16 v151, v55, v158, v151
    v_dot2_f32_bf16 v153, v55, v55, v153
    v_dot2_f32_bf16 v150, v56, v158, v150
    v_dot2_f32_bf16 v152, v56, v56, v152
    v_dot2_f32_bf16 v151, v57, v158, v151
    v_dot2_f32_bf16 v153, v57, v57, v153
    v_dot2_f32_bf16 v150, v58, v158, v150
    v_dot2_f32_bf16 v152, v58, v58, v152
    v_dot2_f32_bf16 v151, v59, v158, v151
    v_dot2_f32_bf16 v153, v59, v59, v153
    v_dot2_f32_bf16 v150, v60, v158, v150
    v_dot2_f32_bf16 v152, v60, v60, v152
    v_dot2_f32_bf16 v151, v61, v158, v151
    v_dot2_f32_bf16 v153, v61, v61, v153
    v_dot2_f32_bf16 v150, v62, v158, v150
    v_dot2_f32_bf16 v152, v62, v62, v152
    v_dot2_f32_bf16 v151, v63, v158, v151
    v_dot2_f32_bf16 v153, v63, v63, v153
    s_nop 1
    v_add_f32 v150, v150, v151
    v_add_f32 v152, v152, v153
    v_mov_b32 v157, v150
    s_nop 1
    v_permlane32_swap_b32 v157, v150
    v_add_f32 v150, v157, v150
    v_mov_b32 v157, v150
    s_nop 1
    v_permlane16_swap_b32 v157, v150
    v_add_f32 v150, v157, v150
    v_mov_b32 v157, v152
    s_nop 1
    v_permlane32_swap_b32 v157, v152
    v_add_f32 v152, v157, v152
    v_mov_b32 v157, v152
    s_nop 1
    v_permlane16_swap_b32 v157, v152
    v_add_f32 v152, v157, v152
    v_mul_f32 v150, 0x3b000000, v150
    v_cvt_pk_bf16_f32 v154, v150, v150
    v_and_b32 v154, 0xffff0000, v154
    v_sub_f32 v156, v150, v154
    v_mul_f32 v157, v150, v150
    v_mul_f32 v152, 0x3b000000, v152
    v_sub_f32 v152, v152, v157
    v_max_f32 v152, 0, v152
    v_cvt_pk_bf16_f32 v152, v152, v152
    v_and_b32 v152, 0xffff0000, v152
    v_add_f32 v152, 0x3727c5ac, v152
    v_cvt_pk_bf16_f32 v152, v152, v152
    v_and_b32 v152, 0xffff0000, v152
    v_sqrt_f32 v152, v152
    s_nop 0
    v_cvt_pk_bf16_f32 v152, v152, v152
    v_and_b32 v152, 0xffff0000, v152
    v_rcp_f32 v152, v152
    v_lshlrev_b32 v160, 16, v0
    v_and_b32 v161, 0xffff0000, v0
    v_lshlrev_b32 v162, 16, v1
    v_and_b32 v163, 0xffff0000, v1
    v_lshlrev_b32 v164, 16, v2
    v_and_b32 v165, 0xffff0000, v2
    v_lshlrev_b32 v166, 16, v3
    v_and_b32 v167, 0xffff0000, v3
    v_lshlrev_b32 v168, 16, v4
    v_and_b32 v169, 0xffff0000, v4
    v_lshlrev_b32 v170, 16, v5
    v_and_b32 v171, 0xffff0000, v5
    v_lshlrev_b32 v172, 16, v6
    v_and_b32 v173, 0xffff0000, v6
    v_lshlrev_b32 v174, 16, v7
    v_and_b32 v175, 0xffff0000, v7
    v_pk_add_f32 v[160:161], v[160:161], v[154:155] op_sel_hi:[1,0] neg_lo:[0,1] neg_hi:[0,1]
    v_pk_add_f32 v[162:163], v[162:163], v[154:155] op_sel_hi:[1,0] neg_lo:[0,1] neg_hi:[0,1]
    v_pk_add_f32 v[164:165], v[164:165], v[154:155] op_sel_hi:[1,0] neg_lo:[0,1] neg_hi:[0,1]
    v_pk_add_f32 v[166:167], v[166:167], v[154:155] op_sel_hi:[1,0] neg_lo:[0,1] neg_hi:[0,1]
    v_pk_add_f32 v[168:169], v[168:169], v[154:155] op_sel_hi:[1,0] neg_lo:[0,1] neg_hi:[0,1]
    v_pk_add_f32 v[170:171], v[170:171], v[154:155] op_sel_hi:[1,0] neg_lo:[0,1] neg_hi:[0,1]
    s_add_u32 s26, s24, 0x20000
    s_add_u32 m0, s29, 0x1000
    s_nop 0
    buffer_load_dwordx4 v136, s[16:19], s26 offen lds
    v_pk_add_f32 v[172:173], v[172:173], v[154:155] op_sel_hi:[1,0] neg_lo:[0,1] neg_hi:[0,1]
    v_pk_add_f32 v[174:175], v[174:175], v[154:155] op_sel_hi:[1,0] neg_lo:[0,1] neg_hi:[0,1]
    v_cvt_pk_bf16_f32 v0, v160, v161
    v_cvt_pk_bf16_f32 v1, v162, v163
    v_cvt_pk_bf16_f32 v2, v164, v165
    v_cvt_pk_bf16_f32 v3, v166, v167
    v_cvt_pk_bf16_f32 v4, v168, v169
    v_cvt_pk_bf16_f32 v5, v170, v171
    v_cvt_pk_bf16_f32 v6, v172, v173
    v_cvt_pk_bf16_f32 v7, v174, v175
    v_lshlrev_b32 v160, 16, v0
    v_and_b32 v161, 0xffff0000, v0
    v_lshlrev_b32 v162, 16, v1
    v_and_b32 v163, 0xffff0000, v1
    v_lshlrev_b32 v164, 16, v2
    v_and_b32 v165, 0xffff0000, v2
    v_lshlrev_b32 v166, 16, v3
    v_and_b32 v167, 0xffff0000, v3
    v_lshlrev_b32 v168, 16, v4
    v_and_b32 v169, 0xffff0000, v4
    v_lshlrev_b32 v170, 16, v5
    v_and_b32 v171, 0xffff0000, v5
    v_lshlrev_b32 v172, 16, v6
    v_and_b32 v173, 0xffff0000, v6
    v_lshlrev_b32 v174, 16, v7
    v_and_b32 v175, 0xffff0000, v7
    v_pk_mul_f32 v[160:161], v[160:161], v[152:153] op_sel_hi:[1,0]
    v_pk_mul_f32 v[162:163], v[162:163], v[152:153] op_sel_hi:[1,0]
    v_pk_mul_f32 v[164:165], v[164:165], v[152:153] op_sel_hi:[1,0]
    v_pk_mul_f32 v[166:167], v[166:167], v[152:153] op_sel_hi:[1,0]
    v_pk_mul_f32 v[168:169], v[168:169], v[152:153] op_sel_hi:[1,0]
    v_pk_mul_f32 v[170:171], v[170:171], v[152:153] op_sel_hi:[1,0]
    v_pk_mul_f32 v[172:173], v[172:173], v[152:153] op_sel_hi:[1,0]
    v_pk_mul_f32 v[174:175], v[174:175], v[152:153] op_sel_hi:[1,0]
    v_cvt_pk_bf16_f32 v160, v160, v161
    v_cvt_pk_bf16_f32 v162, v162, v163
    v_cvt_pk_bf16_f32 v164, v164, v165
    v_cvt_pk_bf16_f32 v166, v166, v167
    v_cvt_pk_bf16_f32 v168, v168, v169
    v_cvt_pk_bf16_f32 v170, v170, v171
    v_cvt_pk_bf16_f32 v172, v172, v173
    v_cvt_pk_bf16_f32 v174, v174, v175
    v_accvgpr_write_b32 a0, v160
    v_accvgpr_write_b32 a1, v162
    v_accvgpr_write_b32 a2, v164
    v_accvgpr_write_b32 a3, v166
    v_accvgpr_write_b32 a4, v168
    v_accvgpr_write_b32 a5, v170
    v_accvgpr_write_b32 a6, v172
    v_accvgpr_write_b32 a7, v174
    s_add_u32 s26, s24, 0x40000
    s_add_u32 m0, s29, 0x2000
    s_nop 0
    buffer_load_dwordx4 v136, s[16:19], s26 offen lds
    v_lshlrev_b32 v160, 16, v8
    v_and_b32 v161, 0xffff0000, v8
    v_lshlrev_b32 v162, 16, v9
    v_and_b32 v163, 0xffff0000, v9
    v_lshlrev_b32 v164, 16, v10
    v_and_b32 v165, 0xffff0000, v10
    v_lshlrev_b32 v166, 16, v11
    v_and_b32 v167, 0xffff0000, v11
    v_lshlrev_b32 v168, 16, v12
    v_and_b32 v169, 0xffff0000, v12
    v_lshlrev_b32 v170, 16, v13
    v_and_b32 v171, 0xffff0000, v13
    v_lshlrev_b32 v172, 16, v14
    v_and_b32 v173, 0xffff0000, v14
    v_lshlrev_b32 v174, 16, v15
    v_and_b32 v175, 0xffff0000, v15
    v_pk_add_f32 v[160:161], v[160:161], v[154:155] op_sel_hi:[1,0] neg_lo:[0,1] neg_hi:[0,1]
    v_pk_add_f32 v[162:163], v[162:163], v[154:155] op_sel_hi:[1,0] neg_lo:[0,1] neg_hi:[0,1]
    v_pk_add_f32 v[164:165], v[164:165], v[154:155] op_sel_hi:[1,0] neg_lo:[0,1] neg_hi:[0,1]
    v_pk_add_f32 v[166:167], v[166:167], v[154:155] op_sel_hi:[1,0] neg_lo:[0,1] neg_hi:[0,1]
    v_pk_add_f32 v[168:169], v[168:169], v[154:155] op_sel_hi:[1,0] neg_lo:[0,1] neg_hi:[0,1]
    v_pk_add_f32 v[170:171], v[170:171], v[154:155] op_sel_hi:[1,0] neg_lo:[0,1] neg_hi:[0,1]
    v_pk_add_f32 v[172:173], v[172:173], v[154:155] op_sel_hi:[1,0] neg_lo:[0,1] neg_hi:[0,1]
    v_pk_add_f32 v[174:175], v[174:175], v[154:155] op_sel_hi:[1,0] neg_lo:[0,1] neg_hi:[0,1]
    v_cvt_pk_bf16_f32 v8, v160, v161
    v_cvt_pk_bf16_f32 v9, v162, v163
    v_cvt_pk_bf16_f32 v10, v164, v165
    v_cvt_pk_bf16_f32 v11, v166, v167
    v_cvt_pk_bf16_f32 v12, v168, v169
    v_cvt_pk_bf16_f32 v13, v170, v171
    v_cvt_pk_bf16_f32 v14, v172, v173
    v_cvt_pk_bf16_f32 v15, v174, v175
    v_lshlrev_b32 v160, 16, v8
    v_and_b32 v161, 0xffff0000, v8
    v_lshlrev_b32 v162, 16, v9
    v_and_b32 v163, 0xffff0000, v9
    v_lshlrev_b32 v164, 16, v10
    v_and_b32 v165, 0xffff0000, v10
    v_lshlrev_b32 v166, 16, v11
    v_and_b32 v167, 0xffff0000, v11
    v_lshlrev_b32 v168, 16, v12
    v_and_b32 v169, 0xffff0000, v12
    v_lshlrev_b32 v170, 16, v13
    v_and_b32 v171, 0xffff0000, v13
    v_lshlrev_b32 v172, 16, v14
    v_and_b32 v173, 0xffff0000, v14
    v_lshlrev_b32 v174, 16, v15
    v_and_b32 v175, 0xffff0000, v15
    v_pk_mul_f32 v[160:161], v[160:161], v[152:153] op_sel_hi:[1,0]
    v_pk_mul_f32 v[162:163], v[162:163], v[152:153] op_sel_hi:[1,0]
    s_add_u32 s26, s24, 0x60000
    s_add_u32 m0, s29, 0x3000
    s_nop 0
    buffer_load_dwordx4 v136, s[16:19], s26 offen lds
    v_pk_mul_f32 v[164:165], v[164:165], v[152:153] op_sel_hi:[1,0]
    v_pk_mul_f32 v[166:167], v[166:167], v[152:153] op_sel_hi:[1,0]
    v_pk_mul_f32 v[168:169], v[168:169], v[152:153] op_sel_hi:[1,0]
    v_pk_mul_f32 v[170:171], v[170:171], v[152:153] op_sel_hi:[1,0]
    v_pk_mul_f32 v[172:173], v[172:173], v[152:153] op_sel_hi:[1,0]
    v_pk_mul_f32 v[174:175], v[174:175], v[152:153] op_sel_hi:[1,0]
    v_cvt_pk_bf16_f32 v160, v160, v161
    v_cvt_pk_bf16_f32 v162, v162, v163
    v_cvt_pk_bf16_f32 v164, v164, v165
    v_cvt_pk_bf16_f32 v166, v166, v167
    v_cvt_pk_bf16_f32 v168, v168, v169
    v_cvt_pk_bf16_f32 v170, v170, v171
    v_cvt_pk_bf16_f32 v172, v172, v173
    v_cvt_pk_bf16_f32 v174, v174, v175
    v_accvgpr_write_b32 a8, v160
    v_accvgpr_write_b32 a9, v162
    v_accvgpr_write_b32 a10, v164
    v_accvgpr_write_b32 a11, v166
    v_accvgpr_write_b32 a12, v168
    v_accvgpr_write_b32 a13, v170
    v_accvgpr_write_b32 a14, v172
    v_accvgpr_write_b32 a15, v174
    v_lshlrev_b32 v160, 16, v16
    v_and_b32 v161, 0xffff0000, v16
    v_lshlrev_b32 v162, 16, v17
    v_and_b32 v163, 0xffff0000, v17
    v_lshlrev_b32 v164, 16, v18
    v_and_b32 v165, 0xffff0000, v18
    v_lshlrev_b32 v166, 16, v19
    v_and_b32 v167, 0xffff0000, v19
    v_lshlrev_b32 v168, 16, v20
    v_and_b32 v169, 0xffff0000, v20
    v_lshlrev_b32 v170, 16, v21
    v_and_b32 v171, 0xffff0000, v21
    v_lshlrev_b32 v172, 16, v22
    v_and_b32 v173, 0xffff0000, v22
    v_lshlrev_b32 v174, 16, v23
    v_and_b32 v175, 0xffff0000, v23
    v_pk_add_f32 v[160:161], v[160:161], v[154:155] op_sel_hi:[1,0] neg_lo:[0,1] neg_hi:[0,1]
    v_pk_add_f32 v[162:163], v[162:163], v[154:155] op_sel_hi:[1,0] neg_lo:[0,1] neg_hi:[0,1]
    v_pk_add_f32 v[164:165], v[164:165], v[154:155] op_sel_hi:[1,0] neg_lo:[0,1] neg_hi:[0,1]
    v_pk_add_f32 v[166:167], v[166:167], v[154:155] op_sel_hi:[1,0] neg_lo:[0,1] neg_hi:[0,1]
    v_pk_add_f32 v[168:169], v[168:169], v[154:155] op_sel_hi:[1,0] neg_lo:[0,1] neg_hi:[0,1]
    v_pk_add_f32 v[170:171], v[170:171], v[154:155] op_sel_hi:[1,0] neg_lo:[0,1] neg_hi:[0,1]
    v_pk_add_f32 v[172:173], v[172:173], v[154:155] op_sel_hi:[1,0] neg_lo:[0,1] neg_hi:[0,1]
    v_pk_add_f32 v[174:175], v[174:175], v[154:155] op_sel_hi:[1,0] neg_lo:[0,1] neg_hi:[0,1]
    v_cvt_pk_bf16_f32 v16, v160, v161
    v_cvt_pk_bf16_f32 v17, v162, v163
    v_cvt_pk_bf16_f32 v18, v164, v165
    v_cvt_pk_bf16_f32 v19, v166, v167
    s_add_u32 s26, s24, 0x80000
    s_add_u32 m0, s29, 0x4000
    s_nop 0
    buffer_load_dwordx4 v136, s[16:19], s26 offen lds
    v_cvt_pk_bf16_f32 v20, v168, v169
    v_cvt_pk_bf16_f32 v21, v170, v171
    v_cvt_pk_bf16_f32 v22, v172, v173
    v_cvt_pk_bf16_f32 v23, v174, v175
    v_lshlrev_b32 v160, 16, v16
    v_and_b32 v161, 0xffff0000, v16
    v_lshlrev_b32 v162, 16, v17
    v_and_b32 v163, 0xffff0000, v17
    v_lshlrev_b32 v164, 16, v18
    v_and_b32 v165, 0xffff0000, v18
    v_lshlrev_b32 v166, 16, v19
    v_and_b32 v167, 0xffff0000, v19
    v_lshlrev_b32 v168, 16, v20
    v_and_b32 v169, 0xffff0000, v20
    v_lshlrev_b32 v170, 16, v21
    v_and_b32 v171, 0xffff0000, v21
    v_lshlrev_b32 v172, 16, v22
    v_and_b32 v173, 0xffff0000, v22
    v_lshlrev_b32 v174, 16, v23
    v_and_b32 v175, 0xffff0000, v23
    v_pk_mul_f32 v[160:161], v[160:161], v[152:153] op_sel_hi:[1,0]
    v_pk_mul_f32 v[162:163], v[162:163], v[152:153] op_sel_hi:[1,0]
    v_pk_mul_f32 v[164:165], v[164:165], v[152:153] op_sel_hi:[1,0]
    v_pk_mul_f32 v[166:167], v[166:167], v[152:153] op_sel_hi:[1,0]
    v_pk_mul_f32 v[168:169], v[168:169], v[152:153] op_sel_hi:[1,0]
    v_pk_mul_f32 v[170:171], v[170:171], v[152:153] op_sel_hi:[1,0]
    v_pk_mul_f32 v[172:173], v[172:173], v[152:153] op_sel_hi:[1,0]
    v_pk_mul_f32 v[174:175], v[174:175], v[152:153] op_sel_hi:[1,0]
    v_cvt_pk_bf16_f32 v160, v160, v161
    v_cvt_pk_bf16_f32 v162, v162, v163
    v_cvt_pk_bf16_f32 v164, v164, v165
    v_cvt_pk_bf16_f32 v166, v166, v167
    v_cvt_pk_bf16_f32 v168, v168, v169
    v_cvt_pk_bf16_f32 v170, v170, v171
    v_cvt_pk_bf16_f32 v172, v172, v173
    v_cvt_pk_bf16_f32 v174, v174, v175
    v_accvgpr_write_b32 a16, v160
    v_accvgpr_write_b32 a17, v162
    v_accvgpr_write_b32 a18, v164
    v_accvgpr_write_b32 a19, v166
    v_accvgpr_write_b32 a20, v168
    v_accvgpr_write_b32 a21, v170
    v_accvgpr_write_b32 a22, v172
    v_accvgpr_write_b32 a23, v174
    v_lshlrev_b32 v160, 16, v24
    v_and_b32 v161, 0xffff0000, v24
    v_lshlrev_b32 v162, 16, v25
    v_and_b32 v163, 0xffff0000, v25
    v_lshlrev_b32 v164, 16, v26
    v_and_b32 v165, 0xffff0000, v26
    s_add_u32 s26, s24, 0xa0000
    s_add_u32 m0, s29, 0x5000
    s_nop 0
    buffer_load_dwordx4 v136, s[16:19], s26 offen lds
    v_lshlrev_b32 v166, 16, v27
    v_and_b32 v167, 0xffff0000, v27
    v_lshlrev_b32 v168, 16, v28
    v_and_b32 v169, 0xffff0000, v28
    v_lshlrev_b32 v170, 16, v29
    v_and_b32 v171, 0xffff0000, v29
    v_lshlrev_b32 v172, 16, v30
    v_and_b32 v173, 0xffff0000, v30
    v_lshlrev_b32 v174, 16, v31
    v_and_b32 v175, 0xffff0000, v31
    v_pk_add_f32 v[160:161], v[160:161], v[154:155] op_sel_hi:[1,0] neg_lo:[0,1] neg_hi:[0,1]
    v_pk_add_f32 v[162:163], v[162:163], v[154:155] op_sel_hi:[1,0] neg_lo:[0,1] neg_hi:[0,1]
    v_pk_add_f32 v[164:165], v[164:165], v[154:155] op_sel_hi:[1,0] neg_lo:[0,1] neg_hi:[0,1]
    v_pk_add_f32 v[166:167], v[166:167], v[154:155] op_sel_hi:[1,0] neg_lo:[0,1] neg_hi:[0,1]
    v_pk_add_f32 v[168:169], v[168:169], v[154:155] op_sel_hi:[1,0] neg_lo:[0,1] neg_hi:[0,1]
    v_pk_add_f32 v[170:171], v[170:171], v[154:155] op_sel_hi:[1,0] neg_lo:[0,1] neg_hi:[0,1]
    v_pk_add_f32 v[172:173], v[172:173], v[154:155] op_sel_hi:[1,0] neg_lo:[0,1] neg_hi:[0,1]
    v_pk_add_f32 v[174:175], v[174:175], v[154:155] op_sel_hi:[1,0] neg_lo:[0,1] neg_hi:[0,1]
    v_cvt_pk_bf16_f32 v24, v160, v161
    v_cvt_pk_bf16_f32 v25, v162, v163
    v_cvt_pk_bf16_f32 v26, v164, v165
    v_cvt_pk_bf16_f32 v27, v166, v167
    v_cvt_pk_bf16_f32 v28, v168, v169
    v_cvt_pk_bf16_f32 v29, v170, v171
    v_cvt_pk_bf16_f32 v30, v172, v173
    v_cvt_pk_bf16_f32 v31, v174, v175
    v_lshlrev_b32 v160, 16, v24
    v_and_b32 v161, 0xffff0000, v24
    v_lshlrev_b32 v162, 16, v25
    v_and_b32 v163, 0xffff0000, v25
    v_lshlrev_b32 v164, 16, v26
    v_and_b32 v165, 0xffff0000, v26
    v_lshlrev_b32 v166, 16, v27
    v_and_b32 v167, 0xffff0000, v27
    v_lshlrev_b32 v168, 16, v28
    v_and_b32 v169, 0xffff0000, v28
    v_lshlrev_b32 v170, 16, v29
    v_and_b32 v171, 0xffff0000, v29
    v_lshlrev_b32 v172, 16, v30
    v_and_b32 v173, 0xffff0000, v30
    v_lshlrev_b32 v174, 16, v31
    v_and_b32 v175, 0xffff0000, v31
    v_pk_mul_f32 v[160:161], v[160:161], v[152:153] op_sel_hi:[1,0]
    v_pk_mul_f32 v[162:163], v[162:163], v[152:153] op_sel_hi:[1,0]
    v_pk_mul_f32 v[164:165], v[164:165], v[152:153] op_sel_hi:[1,0]
    v_pk_mul_f32 v[166:167], v[166:167], v[152:153] op_sel_hi:[1,0]
    v_pk_mul_f32 v[168:169], v[168:169], v[152:153] op_sel_hi:[1,0]
    v_pk_mul_f32 v[170:171], v[170:171], v[152:153] op_sel_hi:[1,0]
    v_pk_mul_f32 v[172:173], v[172:173], v[152:153] op_sel_hi:[1,0]
    v_pk_mul_f32 v[174:175], v[174:175], v[152:153] op_sel_hi:[1,0]
    s_add_u32 s26, s24, 0xc0000
    s_add_u32 m0, s29, 0x6000
    s_nop 0
    buffer_load_dwordx4 v136, s[16:19], s26 offen lds
    v_cvt_pk_bf16_f32 v160, v160, v161
    v_cvt_pk_bf16_f32 v162, v162, v163
    v_cvt_pk_bf16_f32 v164, v164, v165
    v_cvt_pk_bf16_f32 v166, v166, v167
    v_cvt_pk_bf16_f32 v168, v168, v169
    v_cvt_pk_bf16_f32 v170, v170, v171
    v_cvt_pk_bf16_f32 v172, v172, v173
    v_cvt_pk_bf16_f32 v174, v174, v175
    v_accvgpr_write_b32 a24, v160
    v_accvgpr_write_b32 a25, v162
    v_accvgpr_write_b32 a26, v164
    v_accvgpr_write_b32 a27, v166
    v_accvgpr_write_b32 a28, v168
    v_accvgpr_write_b32 a29, v170
    v_accvgpr_write_b32 a30, v172
    v_accvgpr_write_b32 a31, v174
    v_lshlrev_b32 v160, 16, v32
    v_and_b32 v161, 0xffff0000, v32
    v_lshlrev_b32 v162, 16, v33
    v_and_b32 v163, 0xffff0000, v33
    v_lshlrev_b32 v164, 16, v34
    v_and_b32 v165, 0xffff0000, v34
    v_lshlrev_b32 v166, 16, v35
    v_and_b32 v167, 0xffff0000, v35
    v_lshlrev_b32 v168, 16, v36
    v_and_b32 v169, 0xffff0000, v36
    v_lshlrev_b32 v170, 16, v37
    v_and_b32 v171, 0xffff0000, v37
    v_lshlrev_b32 v172, 16, v38
    v_and_b32 v173, 0xffff0000, v38
    v_lshlrev_b32 v174, 16, v39
    v_and_b32 v175, 0xffff0000, v39
    v_pk_add_f32 v[160:161], v[160:161], v[154:155] op_sel_hi:[1,0] neg_lo:[0,1] neg_hi:[0,1]
    v_pk_add_f32 v[162:163], v[162:163], v[154:155] op_sel_hi:[1,0] neg_lo:[0,1] neg_hi:[0,1]
    v_pk_add_f32 v[164:165], v[164:165], v[154:155] op_sel_hi:[1,0] neg_lo:[0,1] neg_hi:[0,1]
    v_pk_add_f32 v[166:167], v[166:167], v[154:155] op_sel_hi:[1,0] neg_lo:[0,1] neg_hi:[0,1]
    v_pk_add_f32 v[168:169], v[168:169], v[154:155] op_sel_hi:[1,0] neg_lo:[0,1] neg_hi:[0,1]
    v_pk_add_f32 v[170:171], v[170:171], v[154:155] op_sel_hi:[1,0] neg_lo:[0,1] neg_hi:[0,1]
    v_pk_add_f32 v[172:173], v[172:173], v[154:155] op_sel_hi:[1,0] neg_lo:[0,1] neg_hi:[0,1]
    v_pk_add_f32 v[174:175], v[174:175], v[154:155] op_sel_hi:[1,0] neg_lo:[0,1] neg_hi:[0,1]
    v_cvt_pk_bf16_f32 v32, v160, v161
    v_cvt_pk_bf16_f32 v33, v162, v163
    v_cvt_pk_bf16_f32 v34, v164, v165
    v_cvt_pk_bf16_f32 v35, v166, v167
    v_cvt_pk_bf16_f32 v36, v168, v169
    v_cvt_pk_bf16_f32 v37, v170, v171
    v_cvt_pk_bf16_f32 v38, v172, v173
    v_cvt_pk_bf16_f32 v39, v174, v175
    v_lshlrev_b32 v160, 16, v32
    v_and_b32 v161, 0xffff0000, v32
    s_add_u32 s26, s24, 0xe0000
    s_add_u32 m0, s29, 0x7000
    s_nop 0
    buffer_load_dwordx4 v136, s[16:19], s26 offen lds
    v_lshlrev_b32 v162, 16, v33
    v_and_b32 v163, 0xffff0000, v33
    v_lshlrev_b32 v164, 16, v34
    v_and_b32 v165, 0xffff0000, v34
    v_lshlrev_b32 v166, 16, v35
    v_and_b32 v167, 0xffff0000, v35
    v_lshlrev_b32 v168, 16, v36
    v_and_b32 v169, 0xffff0000, v36
    v_lshlrev_b32 v170, 16, v37
    v_and_b32 v171, 0xffff0000, v37
    v_lshlrev_b32 v172, 16, v38
    v_and_b32 v173, 0xffff0000, v38
    v_lshlrev_b32 v174, 16, v39
    v_and_b32 v175, 0xffff0000, v39
    v_pk_mul_f32 v[160:161], v[160:161], v[152:153] op_sel_hi:[1,0]
    v_pk_mul_f32 v[162:163], v[162:163], v[152:153] op_sel_hi:[1,0]
    v_pk_mul_f32 v[164:165], v[164:165], v[152:153] op_sel_hi:[1,0]
    v_pk_mul_f32 v[166:167], v[166:167], v[152:153] op_sel_hi:[1,0]
    v_pk_mul_f32 v[168:169], v[168:169], v[152:153] op_sel_hi:[1,0]
    v_pk_mul_f32 v[170:171], v[170:171], v[152:153] op_sel_hi:[1,0]
    v_pk_mul_f32 v[172:173], v[172:173], v[152:153] op_sel_hi:[1,0]
    v_pk_mul_f32 v[174:175], v[174:175], v[152:153] op_sel_hi:[1,0]
    v_cvt_pk_bf16_f32 v160, v160, v161
    v_cvt_pk_bf16_f32 v162, v162, v163
    v_cvt_pk_bf16_f32 v164, v164, v165
    v_cvt_pk_bf16_f32 v166, v166, v167
    v_cvt_pk_bf16_f32 v168, v168, v169
    v_cvt_pk_bf16_f32 v170, v170, v171
    v_cvt_pk_bf16_f32 v172, v172, v173
    v_cvt_pk_bf16_f32 v174, v174, v175
    v_accvgpr_write_b32 a32, v160
    v_accvgpr_write_b32 a33, v162
    v_accvgpr_write_b32 a34, v164
    v_accvgpr_write_b32 a35, v166
    v_accvgpr_write_b32 a36, v168
    v_accvgpr_write_b32 a37, v170
    v_accvgpr_write_b32 a38, v172
    v_accvgpr_write_b32 a39, v174
    v_lshlrev_b32 v160, 16, v40
    v_and_b32 v161, 0xffff0000, v40
    v_lshlrev_b32 v162, 16, v41
    v_and_b32 v163, 0xffff0000, v41
    v_lshlrev_b32 v164, 16, v42
    v_and_b32 v165, 0xffff0000, v42
    v_lshlrev_b32 v166, 16, v43
    v_and_b32 v167, 0xffff0000, v43
    v_lshlrev_b32 v168, 16, v44
    v_and_b32 v169, 0xffff0000, v44
    v_lshlrev_b32 v170, 16, v45
    v_and_b32 v171, 0xffff0000, v45
    s_add_u32 s26, s24, 0x100000
    s_add_u32 m0, s29, 0x8000
    s_nop 0
    buffer_load_dwordx4 v136, s[16:19], s26 offen lds
    v_lshlrev_b32 v172, 16, v46
    v_and_b32 v173, 0xffff0000, v46
    v_lshlrev_b32 v174, 16, v47
    v_and_b32 v175, 0xffff0000, v47
    v_pk_add_f32 v[160:161], v[160:161], v[154:155] op_sel_hi:[1,0] neg_lo:[0,1] neg_hi:[0,1]
    v_pk_add_f32 v[162:163], v[162:163], v[154:155] op_sel_hi:[1,0] neg_lo:[0,1] neg_hi:[0,1]
    v_pk_add_f32 v[164:165], v[164:165], v[154:155] op_sel_hi:[1,0] neg_lo:[0,1] neg_hi:[0,1]
    v_pk_add_f32 v[166:167], v[166:167], v[154:155] op_sel_hi:[1,0] neg_lo:[0,1] neg_hi:[0,1]
    v_pk_add_f32 v[168:169], v[168:169], v[154:155] op_sel_hi:[1,0] neg_lo:[0,1] neg_hi:[0,1]
    v_pk_add_f32 v[170:171], v[170:171], v[154:155] op_sel_hi:[1,0] neg_lo:[0,1] neg_hi:[0,1]
    v_pk_add_f32 v[172:173], v[172:173], v[154:155] op_sel_hi:[1,0] neg_lo:[0,1] neg_hi:[0,1]
    v_pk_add_f32 v[174:175], v[174:175], v[154:155] op_sel_hi:[1,0] neg_lo:[0,1] neg_hi:[0,1]
    v_cvt_pk_bf16_f32 v40, v160, v161
    v_cvt_pk_bf16_f32 v41, v162, v163
    v_cvt_pk_bf16_f32 v42, v164, v165
    v_cvt_pk_bf16_f32 v43, v166, v167
    v_cvt_pk_bf16_f32 v44, v168, v169
    v_cvt_pk_bf16_f32 v45, v170, v171
    v_cvt_pk_bf16_f32 v46, v172, v173
    v_cvt_pk_bf16_f32 v47, v174, v175
    v_lshlrev_b32 v160, 16, v40
    v_and_b32 v161, 0xffff0000, v40
    v_lshlrev_b32 v162, 16, v41
    v_and_b32 v163, 0xffff0000, v41
    v_lshlrev_b32 v164, 16, v42
    v_and_b32 v165, 0xffff0000, v42
    v_lshlrev_b32 v166, 16, v43
    v_and_b32 v167, 0xffff0000, v43
    v_lshlrev_b32 v168, 16, v44
    v_and_b32 v169, 0xffff0000, v44
    v_lshlrev_b32 v170, 16, v45
    v_and_b32 v171, 0xffff0000, v45
    v_lshlrev_b32 v172, 16, v46
    v_and_b32 v173, 0xffff0000, v46
    v_lshlrev_b32 v174, 16, v47
    v_and_b32 v175, 0xffff0000, v47
    v_pk_mul_f32 v[160:161], v[160:161], v[152:153] op_sel_hi:[1,0]
    v_pk_mul_f32 v[162:163], v[162:163], v[152:153] op_sel_hi:[1,0]
    v_pk_mul_f32 v[164:165], v[164:165], v[152:153] op_sel_hi:[1,0]
    v_pk_mul_f32 v[166:167], v[166:167], v[152:153] op_sel_hi:[1,0]
    v_pk_mul_f32 v[168:169], v[168:169], v[152:153] op_sel_hi:[1,0]
    v_pk_mul_f32 v[170:171], v[170:171], v[152:153] op_sel_hi:[1,0]
    v_pk_mul_f32 v[172:173], v[172:173], v[152:153] op_sel_hi:[1,0]
    v_pk_mul_f32 v[174:175], v[174:175], v[152:153] op_sel_hi:[1,0]
    v_cvt_pk_bf16_f32 v160, v160, v161
    v_cvt_pk_bf16_f32 v162, v162, v163
    v_cvt_pk_bf16_f32 v164, v164, v165
    v_cvt_pk_bf16_f32 v166, v166, v167
    v_cvt_pk_bf16_f32 v168, v168, v169
    v_cvt_pk_bf16_f32 v170, v170, v171
    s_add_u32 s26, s24, 0x120000
    s_add_u32 m0, s29, 0x9000
    s_nop 0
    buffer_load_dwordx4 v136, s[16:19], s26 offen lds
    v_cvt_pk_bf16_f32 v172, v172, v173
    v_cvt_pk_bf16_f32 v174, v174, v175
    v_accvgpr_write_b32 a40, v160
    v_accvgpr_write_b32 a41, v162
    v_accvgpr_write_b32 a42, v164
    v_accvgpr_write_b32 a43, v166
    v_accvgpr_write_b32 a44, v168
    v_accvgpr_write_b32 a45, v170
    v_accvgpr_write_b32 a46, v172
    v_accvgpr_write_b32 a47, v174
    v_lshlrev_b32 v160, 16, v48
    v_and_b32 v161, 0xffff0000, v48
    v_lshlrev_b32 v162, 16, v49
    v_and_b32 v163, 0xffff0000, v49
    v_lshlrev_b32 v164, 16, v50
    v_and_b32 v165, 0xffff0000, v50
    v_lshlrev_b32 v166, 16, v51
    v_and_b32 v167, 0xffff0000, v51
    v_lshlrev_b32 v168, 16, v52
    v_and_b32 v169, 0xffff0000, v52
    v_lshlrev_b32 v170, 16, v53
    v_and_b32 v171, 0xffff0000, v53
    v_lshlrev_b32 v172, 16, v54
    v_and_b32 v173, 0xffff0000, v54
    v_lshlrev_b32 v174, 16, v55
    v_and_b32 v175, 0xffff0000, v55
    v_pk_add_f32 v[160:161], v[160:161], v[154:155] op_sel_hi:[1,0] neg_lo:[0,1] neg_hi:[0,1]
    v_pk_add_f32 v[162:163], v[162:163], v[154:155] op_sel_hi:[1,0] neg_lo:[0,1] neg_hi:[0,1]
    v_pk_add_f32 v[164:165], v[164:165], v[154:155] op_sel_hi:[1,0] neg_lo:[0,1] neg_hi:[0,1]
    v_pk_add_f32 v[166:167], v[166:167], v[154:155] op_sel_hi:[1,0] neg_lo:[0,1] neg_hi:[0,1]
    v_pk_add_f32 v[168:169], v[168:169], v[154:155] op_sel_hi:[1,0] neg_lo:[0,1] neg_hi:[0,1]
    v_pk_add_f32 v[170:171], v[170:171], v[154:155] op_sel_hi:[1,0] neg_lo:[0,1] neg_hi:[0,1]
    v_pk_add_f32 v[172:173], v[172:173], v[154:155] op_sel_hi:[1,0] neg_lo:[0,1] neg_hi:[0,1]
    v_pk_add_f32 v[174:175], v[174:175], v[154:155] op_sel_hi:[1,0] neg_lo:[0,1] neg_hi:[0,1]
    v_cvt_pk_bf16_f32 v48, v160, v161
    v_cvt_pk_bf16_f32 v49, v162, v163
    v_cvt_pk_bf16_f32 v50, v164, v165
    v_cvt_pk_bf16_f32 v51, v166, v167
    v_cvt_pk_bf16_f32 v52, v168, v169
    v_cvt_pk_bf16_f32 v53, v170, v171
    v_cvt_pk_bf16_f32 v54, v172, v173
    v_cvt_pk_bf16_f32 v55, v174, v175
    v_lshlrev_b32 v160, 16, v48
    v_and_b32 v161, 0xffff0000, v48
    v_lshlrev_b32 v162, 16, v49
    v_and_b32 v163, 0xffff0000, v49
    v_lshlrev_b32 v164, 16, v50
    v_and_b32 v165, 0xffff0000, v50
    v_lshlrev_b32 v166, 16, v51
    v_and_b32 v167, 0xffff0000, v51
    s_add_u32 s26, s24, 0x140000
    s_add_u32 m0, s29, 0xa000
    s_nop 0
    buffer_load_dwordx4 v136, s[16:19], s26 offen lds
    v_lshlrev_b32 v168, 16, v52
    v_and_b32 v169, 0xffff0000, v52
    v_lshlrev_b32 v170, 16, v53
    v_and_b32 v171, 0xffff0000, v53
    v_lshlrev_b32 v172, 16, v54
    v_and_b32 v173, 0xffff0000, v54
    v_lshlrev_b32 v174, 16, v55
    v_and_b32 v175, 0xffff0000, v55
    v_pk_mul_f32 v[160:161], v[160:161], v[152:153] op_sel_hi:[1,0]
    v_pk_mul_f32 v[162:163], v[162:163], v[152:153] op_sel_hi:[1,0]
    v_pk_mul_f32 v[164:165], v[164:165], v[152:153] op_sel_hi:[1,0]
    v_pk_mul_f32 v[166:167], v[166:167], v[152:153] op_sel_hi:[1,0]
    v_pk_mul_f32 v[168:169], v[168:169], v[152:153] op_sel_hi:[1,0]
    v_pk_mul_f32 v[170:171], v[170:171], v[152:153] op_sel_hi:[1,0]
    v_pk_mul_f32 v[172:173], v[172:173], v[152:153] op_sel_hi:[1,0]
    v_pk_mul_f32 v[174:175], v[174:175], v[152:153] op_sel_hi:[1,0]
    v_cvt_pk_bf16_f32 v160, v160, v161
    v_cvt_pk_bf16_f32 v162, v162, v163
    v_cvt_pk_bf16_f32 v164, v164, v165
    v_cvt_pk_bf16_f32 v166, v166, v167
    v_cvt_pk_bf16_f32 v168, v168, v169
    v_cvt_pk_bf16_f32 v170, v170, v171
    v_cvt_pk_bf16_f32 v172, v172, v173
    v_cvt_pk_bf16_f32 v174, v174, v175
    v_accvgpr_write_b32 a48, v160
    v_accvgpr_write_b32 a49, v162
    v_accvgpr_write_b32 a50, v164
    v_accvgpr_write_b32 a51, v166
    v_accvgpr_write_b32 a52, v168
    v_accvgpr_write_b32 a53, v170
    v_accvgpr_write_b32 a54, v172
    v_accvgpr_write_b32 a55, v174
    v_lshlrev_b32 v160, 16, v56
    v_and_b32 v161, 0xffff0000, v56
    v_lshlrev_b32 v162, 16, v57
    v_and_b32 v163, 0xffff0000, v57
    v_lshlrev_b32 v164, 16, v58
    v_and_b32 v165, 0xffff0000, v58
    v_lshlrev_b32 v166, 16, v59
    v_and_b32 v167, 0xffff0000, v59
    v_lshlrev_b32 v168, 16, v60
    v_and_b32 v169, 0xffff0000, v60
    v_lshlrev_b32 v170, 16, v61
    v_and_b32 v171, 0xffff0000, v61
    v_lshlrev_b32 v172, 16, v62
    v_and_b32 v173, 0xffff0000, v62
    v_lshlrev_b32 v174, 16, v63
    v_and_b32 v175, 0xffff0000, v63
    v_pk_add_f32 v[160:161], v[160:161], v[154:155] op_sel_hi:[1,0] neg_lo:[0,1] neg_hi:[0,1]
    v_pk_add_f32 v[162:163], v[162:163], v[154:155] op_sel_hi:[1,0] neg_lo:[0,1] neg_hi:[0,1]
    s_add_u32 s26, s24, 0x160000
    s_add_u32 m0, s29, 0xb000
    s_nop 0
    buffer_load_dwordx4 v136, s[16:19], s26 offen lds
    v_pk_add_f32 v[164:165], v[164:165], v[154:155] op_sel_hi:[1,0] neg_lo:[0,1] neg_hi:[0,1]
    v_pk_add_f32 v[166:167], v[166:167], v[154:155] op_sel_hi:[1,0] neg_lo:[0,1] neg_hi:[0,1]
    v_pk_add_f32 v[168:169], v[168:169], v[154:155] op_sel_hi:[1,0] neg_lo:[0,1] neg_hi:[0,1]
    v_pk_add_f32 v[170:171], v[170:171], v[154:155] op_sel_hi:[1,0] neg_lo:[0,1] neg_hi:[0,1]
    v_pk_add_f32 v[172:173], v[172:173], v[154:155] op_sel_hi:[1,0] neg_lo:[0,1] neg_hi:[0,1]
    v_pk_add_f32 v[174:175], v[174:175], v[154:155] op_sel_hi:[1,0] neg_lo:[0,1] neg_hi:[0,1]
    v_cvt_pk_bf16_f32 v56, v160, v161
    v_cvt_pk_bf16_f32 v57, v162, v163
    v_cvt_pk_bf16_f32 v58, v164, v165
    v_cvt_pk_bf16_f32 v59, v166, v167
    v_cvt_pk_bf16_f32 v60, v168, v169
    v_cvt_pk_bf16_f32 v61, v170, v171
    v_cvt_pk_bf16_f32 v62, v172, v173
    v_cvt_pk_bf16_f32 v63, v174, v175
    v_lshlrev_b32 v160, 16, v56
    v_and_b32 v161, 0xffff0000, v56
    v_lshlrev_b32 v162, 16, v57
    v_and_b32 v163, 0xffff0000, v57
    v_lshlrev_b32 v164, 16, v58
    v_and_b32 v165, 0xffff0000, v58
    v_lshlrev_b32 v166, 16, v59
    v_and_b32 v167, 0xffff0000, v59
    v_lshlrev_b32 v168, 16, v60
    v_and_b32 v169, 0xffff0000, v60
    v_lshlrev_b32 v170, 16, v61
    v_and_b32 v171, 0xffff0000, v61
    v_lshlrev_b32 v172, 16, v62
    v_and_b32 v173, 0xffff0000, v62
    v_lshlrev_b32 v174, 16, v63
    v_and_b32 v175, 0xffff0000, v63
    v_pk_mul_f32 v[160:161], v[160:161], v[152:153] op_sel_hi:[1,0]
    v_pk_mul_f32 v[162:163], v[162:163], v[152:153] op_sel_hi:[1,0]
    v_pk_mul_f32 v[164:165], v[164:165], v[152:153] op_sel_hi:[1,0]
    v_pk_mul_f32 v[166:167], v[166:167], v[152:153] op_sel_hi:[1,0]
    v_pk_mul_f32 v[168:169], v[168:169], v[152:153] op_sel_hi:[1,0]
    v_pk_mul_f32 v[170:171], v[170:171], v[152:153] op_sel_hi:[1,0]
    v_pk_mul_f32 v[172:173], v[172:173], v[152:153] op_sel_hi:[1,0]
    v_pk_mul_f32 v[174:175], v[174:175], v[152:153] op_sel_hi:[1,0]
    v_cvt_pk_bf16_f32 v160, v160, v161
    v_cvt_pk_bf16_f32 v162, v162, v163
    v_cvt_pk_bf16_f32 v164, v164, v165
    v_cvt_pk_bf16_f32 v166, v166, v167
    v_cvt_pk_bf16_f32 v168, v168, v169
    v_cvt_pk_bf16_f32 v170, v170, v171
    v_cvt_pk_bf16_f32 v172, v172, v173
    v_cvt_pk_bf16_f32 v174, v174, v175
    v_accvgpr_write_b32 a56, v160
    v_accvgpr_write_b32 a57, v162
    v_accvgpr_write_b32 a58, v164
    v_accvgpr_write_b32 a59, v166
    s_add_u32 s26, s24, 0x180000
    s_add_u32 m0, s29, 0xc000
    s_nop 0
    buffer_load_dwordx4 v136, s[16:19], s26 offen lds
    v_accvgpr_write_b32 a60, v168
    v_accvgpr_write_b32 a61, v170
    v_accvgpr_write_b32 a62, v172
    v_accvgpr_write_b32 a63, v174
    s_waitcnt vmcnt(13)
    v_pk_mov_b32 v[150:151], 0, 0
    v_pk_mov_b32 v[152:153], 0, 0
    v_dot2_f32_bf16 v150, v64, v158, v150
    v_dot2_f32_bf16 v152, v64, v64, v152
    v_dot2_f32_bf16 v151, v65, v158, v151
    v_dot2_f32_bf16 v153, v65, v65, v153
    v_dot2_f32_bf16 v150, v66, v158, v150
    v_dot2_f32_bf16 v152, v66, v66, v152
    v_dot2_f32_bf16 v151, v67, v158, v151
    v_dot2_f32_bf16 v153, v67, v67, v153
    v_dot2_f32_bf16 v150, v68, v158, v150
    v_dot2_f32_bf16 v152, v68, v68, v152
    v_dot2_f32_bf16 v151, v69, v158, v151
    v_dot2_f32_bf16 v153, v69, v69, v153
    v_dot2_f32_bf16 v150, v70, v158, v150
    v_dot2_f32_bf16 v152, v70, v70, v152
    v_dot2_f32_bf16 v151, v71, v158, v151
    v_dot2_f32_bf16 v153, v71, v71, v153
    v_dot2_f32_bf16 v150, v72, v158, v150
    v_dot2_f32_bf16 v152, v72, v72, v152
    v_dot2_f32_bf16 v151, v73, v158, v151
    v_dot2_f32_bf16 v153, v73, v73, v153
    v_dot2_f32_bf16 v150, v74, v158, v150
    v_dot2_f32_bf16 v152, v74, v74, v152
    v_dot2_f32_bf16 v151, v75, v158, v151
    v_dot2_f32_bf16 v153, v75, v75, v153
    v_dot2_f32_bf16 v150, v76, v158, v150
    v_dot2_f32_bf16 v152, v76, v76, v152
    v_dot2_f32_bf16 v151, v77, v158, v151
    v_dot2_f32_bf16 v153, v77, v77, v153
    v_dot2_f32_bf16 v150, v78, v158, v150
    v_dot2_f32_bf16 v152, v78, v78, v152
    v_dot2_f32_bf16 v151, v79, v158, v151
    v_dot2_f32_bf16 v153, v79, v79, v153
    v_dot2_f32_bf16 v150, v80, v158, v150
    v_dot2_f32_bf16 v152, v80, v80, v152
    v_dot2_f32_bf16 v151, v81, v158, v151
    v_dot2_f32_bf16 v153, v81, v81, v153
    v_dot2_f32_bf16 v150, v82, v158, v150
    v_dot2_f32_bf16 v152, v82, v82, v152
    v_dot2_f32_bf16 v151, v83, v158, v151
    v_dot2_f32_bf16 v153, v83, v83, v153
    v_dot2_f32_bf16 v150, v84, v158, v150
    v_dot2_f32_bf16 v152, v84, v84, v152
    v_dot2_f32_bf16 v151, v85, v158, v151
    v_dot2_f32_bf16 v153, v85, v85, v153
    v_dot2_f32_bf16 v150, v86, v158, v150
    v_dot2_f32_bf16 v152, v86, v86, v152
    s_add_u32 s26, s24, 0x1a0000
    s_add_u32 m0, s29, 0xd000
    s_nop 0
    buffer_load_dwordx4 v136, s[16:19], s26 offen lds
    v_dot2_f32_bf16 v151, v87, v158, v151
    v_dot2_f32_bf16 v153, v87, v87, v153
    v_dot2_f32_bf16 v150, v88, v158, v150
    v_dot2_f32_bf16 v152, v88, v88, v152
    v_dot2_f32_bf16 v151, v89, v158, v151
    v_dot2_f32_bf16 v153, v89, v89, v153
    v_dot2_f32_bf16 v150, v90, v158, v150
    v_dot2_f32_bf16 v152, v90, v90, v152
    v_dot2_f32_bf16 v151, v91, v158, v151
    v_dot2_f32_bf16 v153, v91, v91, v153
    v_dot2_f32_bf16 v150, v92, v158, v150
    v_dot2_f32_bf16 v152, v92, v92, v152
    v_dot2_f32_bf16 v151, v93, v158, v151
    v_dot2_f32_bf16 v153, v93, v93, v153
    v_dot2_f32_bf16 v150, v94, v158, v150
    v_dot2_f32_bf16 v152, v94, v94, v152
    v_dot2_f32_bf16 v151, v95, v158, v151
    v_dot2_f32_bf16 v153, v95, v95, v153
    v_dot2_f32_bf16 v150, v96, v158, v150
    v_dot2_f32_bf16 v152, v96, v96, v152
    v_dot2_f32_bf16 v151, v97, v158, v151
    v_dot2_f32_bf16 v153, v97, v97, v153
    v_dot2_f32_bf16 v150, v98, v158, v150
    v_dot2_f32_bf16 v152, v98, v98, v152
    v_dot2_f32_bf16 v151, v99, v158, v151
    v_dot2_f32_bf16 v153, v99, v99, v153
    v_dot2_f32_bf16 v150, v100, v158, v150
    v_dot2_f32_bf16 v152, v100, v100, v152
    v_dot2_f32_bf16 v151, v101, v158, v151
    v_dot2_f32_bf16 v153, v101, v101, v153
    v_dot2_f32_bf16 v150, v102, v158, v150
    v_dot2_f32_bf16 v152, v102, v102, v152
    v_dot2_f32_bf16 v151, v103, v158, v151
    v_dot2_f32_bf16 v153, v103, v103, v153
    v_dot2_f32_bf16 v150, v104, v158, v150
    v_dot2_f32_bf16 v152, v104, v104, v152
    v_dot2_f32_bf16 v151, v105, v158, v151
    v_dot2_f32_bf16 v153, v105, v105, v153
    v_dot2_f32_bf16 v150, v106, v158, v150
    v_dot2_f32_bf16 v152, v106, v106, v152
    v_dot2_f32_bf16 v151, v107, v158, v151
    v_dot2_f32_bf16 v153, v107, v107, v153
    v_dot2_f32_bf16 v150, v108, v158, v150
    v_dot2_f32_bf16 v152, v108, v108, v152
    v_dot2_f32_bf16 v151, v109, v158, v151
    v_dot2_f32_bf16 v153, v109, v109, v153
    v_dot2_f32_bf16 v150, v110, v158, v150
    v_dot2_f32_bf16 v152, v110, v110, v152
    v_dot2_f32_bf16 v151, v111, v158, v151
    v_dot2_f32_bf16 v153, v111, v111, v153
    s_add_u32 s26, s24, 0x1c0000
    s_add_u32 m0, s29, 0xe000
    s_nop 0
    buffer_load_dwordx4 v136, s[16:19], s26 offen lds
    v_dot2_f32_bf16 v150, v112, v158, v150
    v_dot2_f32_bf16 v152, v112, v112, v152
    v_dot2_f32_bf16 v151, v113, v158, v151
    v_dot2_f32_bf16 v153, v113, v113, v153
    v_dot2_f32_bf16 v150, v114, v158, v150
    v_dot2_f32_bf16 v152, v114, v114, v152
    v_dot2_f32_bf16 v151, v115, v158, v151
    v_dot2_f32_bf16 v153, v115, v115, v153
    v_dot2_f32_bf16 v150, v116, v158, v150
    v_dot2_f32_bf16 v152, v116, v116, v152
    v_dot2_f32_bf16 v151, v117, v158, v151
    v_dot2_f32_bf16 v153, v117, v117, v153
    v_dot2_f32_bf16 v150, v118, v158, v150
    v_dot2_f32_bf16 v152, v118, v118, v152
    v_dot2_f32_bf16 v151, v119, v158, v151
    v_dot2_f32_bf16 v153, v119, v119, v153
    v_dot2_f32_bf16 v150, v120, v158, v150
    v_dot2_f32_bf16 v152, v120, v120, v152
    v_dot2_f32_bf16 v151, v121, v158, v151
    v_dot2_f32_bf16 v153, v121, v121, v153
    v_dot2_f32_bf16 v150, v122, v158, v150
    v_dot2_f32_bf16 v152, v122, v122, v152
    v_dot2_f32_bf16 v151, v123, v158, v151
    v_dot2_f32_bf16 v153, v123, v123, v153
    v_dot2_f32_bf16 v150, v124, v158, v150
    v_dot2_f32_bf16 v152, v124, v124, v152
    v_dot2_f32_bf16 v151, v125, v158, v151
    v_dot2_f32_bf16 v153, v125, v125, v153
    v_dot2_f32_bf16 v150, v126, v158, v150
    v_dot2_f32_bf16 v152, v126, v126, v152
    v_dot2_f32_bf16 v151, v127, v158, v151
    v_dot2_f32_bf16 v153, v127, v127, v153
    s_nop 1
    v_add_f32 v150, v150, v151
    v_add_f32 v152, v152, v153
    v_mov_b32 v157, v150
    s_nop 1
    v_permlane32_swap_b32 v157, v150
    v_add_f32 v150, v157, v150
    v_mov_b32 v157, v150
    s_nop 1
    v_permlane16_swap_b32 v157, v150
    v_add_f32 v150, v157, v150
    v_mov_b32 v157, v152
    s_nop 1
    v_permlane32_swap_b32 v157, v152
    v_add_f32 v152, v157, v152
    v_mov_b32 v157, v152
    s_nop 1
    v_permlane16_swap_b32 v157, v152
    v_add_f32 v152, v157, v152
    v_mul_f32 v150, 0x3b000000, v150
    v_cvt_pk_bf16_f32 v154, v150, v150
    v_and_b32 v154, 0xffff0000, v154
    v_sub_f32 v156, v150, v154
    v_mul_f32 v157, v150, v150
    v_mul_f32 v152, 0x3b000000, v152
    v_sub_f32 v152, v152, v157
    v_max_f32 v152, 0, v152
    v_cvt_pk_bf16_f32 v152, v152, v152
    v_and_b32 v152, 0xffff0000, v152
    v_add_f32 v152, 0x3727c5ac, v152
    v_cvt_pk_bf16_f32 v152, v152, v152
    v_and_b32 v152, 0xffff0000, v152
    v_sqrt_f32 v152, v152
    s_nop 0
    v_cvt_pk_bf16_f32 v152, v152, v152
    v_and_b32 v152, 0xffff0000, v152
    v_rcp_f32 v152, v152
    v_lshlrev_b32 v160, 16, v64
    v_and_b32 v161, 0xffff0000, v64
    v_lshlrev_b32 v162, 16, v65
    v_and_b32 v163, 0xffff0000, v65
    v_lshlrev_b32 v164, 16, v66
    v_and_b32 v165, 0xffff0000, v66
    v_lshlrev_b32 v166, 16, v67
    v_and_b32 v167, 0xffff0000, v67
    v_lshlrev_b32 v168, 16, v68
    v_and_b32 v169, 0xffff0000, v68
    v_lshlrev_b32 v170, 16, v69
    v_and_b32 v171, 0xffff0000, v69
    v_lshlrev_b32 v172, 16, v70
    v_and_b32 v173, 0xffff0000, v70
    v_lshlrev_b32 v174, 16, v71
    v_and_b32 v175, 0xffff0000, v71
    v_pk_add_f32 v[160:161], v[160:161], v[154:155] op_sel_hi:[1,0] neg_lo:[0,1] neg_hi:[0,1]
    v_pk_add_f32 v[162:163], v[162:163], v[154:155] op_sel_hi:[1,0] neg_lo:[0,1] neg_hi:[0,1]
    s_add_u32 s26, s24, 0x1e0000
    s_add_u32 m0, s29, 0xf000
    s_nop 0
    buffer_load_dwordx4 v136, s[16:19], s26 offen lds
    v_pk_add_f32 v[164:165], v[164:165], v[154:155] op_sel_hi:[1,0] neg_lo:[0,1] neg_hi:[0,1]
    v_pk_add_f32 v[166:167], v[166:167], v[154:155] op_sel_hi:[1,0] neg_lo:[0,1] neg_hi:[0,1]
    v_pk_add_f32 v[168:169], v[168:169], v[154:155] op_sel_hi:[1,0] neg_lo:[0,1] neg_hi:[0,1]
    v_pk_add_f32 v[170:171], v[170:171], v[154:155] op_sel_hi:[1,0] neg_lo:[0,1] neg_hi:[0,1]
    v_pk_add_f32 v[172:173], v[172:173], v[154:155] op_sel_hi:[1,0] neg_lo:[0,1] neg_hi:[0,1]
    v_pk_add_f32 v[174:175], v[174:175], v[154:155] op_sel_hi:[1,0] neg_lo:[0,1] neg_hi:[0,1]
    v_cvt_pk_bf16_f32 v64, v160, v161
    v_cvt_pk_bf16_f32 v65, v162, v163
    v_cvt_pk_bf16_f32 v66, v164, v165
    v_cvt_pk_bf16_f32 v67, v166, v167
    v_cvt_pk_bf16_f32 v68, v168, v169
    v_cvt_pk_bf16_f32 v69, v170, v171
    v_cvt_pk_bf16_f32 v70, v172, v173
    v_cvt_pk_bf16_f32 v71, v174, v175
    v_lshlrev_b32 v160, 16, v64
    v_and_b32 v161, 0xffff0000, v64
    v_lshlrev_b32 v162, 16, v65
    v_and_b32 v163, 0xffff0000, v65
    v_lshlrev_b32 v164, 16, v66
    v_and_b32 v165, 0xffff0000, v66
    v_lshlrev_b32 v166, 16, v67
    v_and_b32 v167, 0xffff0000, v67
    v_lshlrev_b32 v168, 16, v68
    v_and_b32 v169, 0xffff0000, v68
    v_lshlrev_b32 v170, 16, v69
    v_and_b32 v171, 0xffff0000, v69
    v_lshlrev_b32 v172, 16, v70
    v_and_b32 v173, 0xffff0000, v70
    v_lshlrev_b32 v174, 16, v71
    v_and_b32 v175, 0xffff0000, v71
    v_pk_mul_f32 v[160:161], v[160:161], v[152:153] op_sel_hi:[1,0]
    v_pk_mul_f32 v[162:163], v[162:163], v[152:153] op_sel_hi:[1,0]
    v_pk_mul_f32 v[164:165], v[164:165], v[152:153] op_sel_hi:[1,0]
    v_pk_mul_f32 v[166:167], v[166:167], v[152:153] op_sel_hi:[1,0]
    v_pk_mul_f32 v[168:169], v[168:169], v[152:153] op_sel_hi:[1,0]
    v_pk_mul_f32 v[170:171], v[170:171], v[152:153] op_sel_hi:[1,0]
    v_pk_mul_f32 v[172:173], v[172:173], v[152:153] op_sel_hi:[1,0]
    v_pk_mul_f32 v[174:175], v[174:175], v[152:153] op_sel_hi:[1,0]
    v_cvt_pk_bf16_f32 v160, v160, v161
    v_cvt_pk_bf16_f32 v162, v162, v163
    v_cvt_pk_bf16_f32 v164, v164, v165
    v_cvt_pk_bf16_f32 v166, v166, v167
    v_cvt_pk_bf16_f32 v168, v168, v169
    v_cvt_pk_bf16_f32 v170, v170, v171
    v_cvt_pk_bf16_f32 v172, v172, v173
    v_cvt_pk_bf16_f32 v174, v174, v175
    v_accvgpr_write_b32 a64, v160
    v_accvgpr_write_b32 a65, v162
    v_accvgpr_write_b32 a66, v164
    v_accvgpr_write_b32 a67, v166
    s_add_u32 s26, s24, 0x200000
    s_add_u32 m0, s29, 0x10000
    s_nop 0
    buffer_load_dwordx4 v136, s[16:19], s26 offen lds
    v_accvgpr_write_b32 a68, v168
    v_accvgpr_write_b32 a69, v170
    v_accvgpr_write_b32 a70, v172
    v_accvgpr_write_b32 a71, v174
    v_lshlrev_b32 v160, 16, v72
    v_and_b32 v161, 0xffff0000, v72
    v_lshlrev_b32 v162, 16, v73
    v_and_b32 v163, 0xffff0000, v73
    v_lshlrev_b32 v164, 16, v74
    v_and_b32 v165, 0xffff0000, v74
    v_lshlrev_b32 v166, 16, v75
    v_and_b32 v167, 0xffff0000, v75
    v_lshlrev_b32 v168, 16, v76
    v_and_b32 v169, 0xffff0000, v76
    v_lshlrev_b32 v170, 16, v77
    v_and_b32 v171, 0xffff0000, v77
    v_lshlrev_b32 v172, 16, v78
    v_and_b32 v173, 0xffff0000, v78
    v_lshlrev_b32 v174, 16, v79
    v_and_b32 v175, 0xffff0000, v79
    v_pk_add_f32 v[160:161], v[160:161], v[154:155] op_sel_hi:[1,0] neg_lo:[0,1] neg_hi:[0,1]
    v_pk_add_f32 v[162:163], v[162:163], v[154:155] op_sel_hi:[1,0] neg_lo:[0,1] neg_hi:[0,1]
    v_pk_add_f32 v[164:165], v[164:165], v[154:155] op_sel_hi:[1,0] neg_lo:[0,1] neg_hi:[0,1]
    v_pk_add_f32 v[166:167], v[166:167], v[154:155] op_sel_hi:[1,0] neg_lo:[0,1] neg_hi:[0,1]
    v_pk_add_f32 v[168:169], v[168:169], v[154:155] op_sel_hi:[1,0] neg_lo:[0,1] neg_hi:[0,1]
    v_pk_add_f32 v[170:171], v[170:171], v[154:155] op_sel_hi:[1,0] neg_lo:[0,1] neg_hi:[0,1]
    v_pk_add_f32 v[172:173], v[172:173], v[154:155] op_sel_hi:[1,0] neg_lo:[0,1] neg_hi:[0,1]
    v_pk_add_f32 v[174:175], v[174:175], v[154:155] op_sel_hi:[1,0] neg_lo:[0,1] neg_hi:[0,1]
    v_cvt_pk_bf16_f32 v72, v160, v161
    v_cvt_pk_bf16_f32 v73, v162, v163
    v_cvt_pk_bf16_f32 v74, v164, v165
    v_cvt_pk_bf16_f32 v75, v166, v167
    v_cvt_pk_bf16_f32 v76, v168, v169
    v_cvt_pk_bf16_f32 v77, v170, v171
    v_cvt_pk_bf16_f32 v78, v172, v173
    v_cvt_pk_bf16_f32 v79, v174, v175
    v_lshlrev_b32 v160, 16, v72
    v_and_b32 v161, 0xffff0000, v72
    v_lshlrev_b32 v162, 16, v73
    v_and_b32 v163, 0xffff0000, v73
    v_lshlrev_b32 v164, 16, v74
    v_and_b32 v165, 0xffff0000, v74
    v_lshlrev_b32 v166, 16, v75
    v_and_b32 v167, 0xffff0000, v75
    v_lshlrev_b32 v168, 16, v76
    v_and_b32 v169, 0xffff0000, v76
    v_lshlrev_b32 v170, 16, v77
    v_and_b32 v171, 0xffff0000, v77
    v_lshlrev_b32 v172, 16, v78
    v_and_b32 v173, 0xffff0000, v78
    s_add_u32 s26, s24, 0x220000
    s_add_u32 m0, s29, 0x11000
    s_nop 0
    buffer_load_dwordx4 v136, s[16:19], s26 offen lds
    v_lshlrev_b32 v174, 16, v79
    v_and_b32 v175, 0xffff0000, v79
    v_pk_mul_f32 v[160:161], v[160:161], v[152:153] op_sel_hi:[1,0]
    v_pk_mul_f32 v[162:163], v[162:163], v[152:153] op_sel_hi:[1,0]
    v_pk_mul_f32 v[164:165], v[164:165], v[152:153] op_sel_hi:[1,0]
    v_pk_mul_f32 v[166:167], v[166:167], v[152:153] op_sel_hi:[1,0]
    v_pk_mul_f32 v[168:169], v[168:169], v[152:153] op_sel_hi:[1,0]
    v_pk_mul_f32 v[170:171], v[170:171], v[152:153] op_sel_hi:[1,0]
    v_pk_mul_f32 v[172:173], v[172:173], v[152:153] op_sel_hi:[1,0]
    v_pk_mul_f32 v[174:175], v[174:175], v[152:153] op_sel_hi:[1,0]
    v_cvt_pk_bf16_f32 v160, v160, v161
    v_cvt_pk_bf16_f32 v162, v162, v163
    v_cvt_pk_bf16_f32 v164, v164, v165
    v_cvt_pk_bf16_f32 v166, v166, v167
    v_cvt_pk_bf16_f32 v168, v168, v169
    v_cvt_pk_bf16_f32 v170, v170, v171
    v_cvt_pk_bf16_f32 v172, v172, v173
    v_cvt_pk_bf16_f32 v174, v174, v175
    v_accvgpr_write_b32 a72, v160
    v_accvgpr_write_b32 a73, v162
    v_accvgpr_write_b32 a74, v164
    v_accvgpr_write_b32 a75, v166
    v_accvgpr_write_b32 a76, v168
    v_accvgpr_write_b32 a77, v170
    v_accvgpr_write_b32 a78, v172
    v_accvgpr_write_b32 a79, v174
    v_lshlrev_b32 v160, 16, v80
    v_and_b32 v161, 0xffff0000, v80
    v_lshlrev_b32 v162, 16, v81
    v_and_b32 v163, 0xffff0000, v81
    v_lshlrev_b32 v164, 16, v82
    v_and_b32 v165, 0xffff0000, v82
    v_lshlrev_b32 v166, 16, v83
    v_and_b32 v167, 0xffff0000, v83
    v_lshlrev_b32 v168, 16, v84
    v_and_b32 v169, 0xffff0000, v84
    v_lshlrev_b32 v170, 16, v85
    v_and_b32 v171, 0xffff0000, v85
    v_lshlrev_b32 v172, 16, v86
    v_and_b32 v173, 0xffff0000, v86
    v_lshlrev_b32 v174, 16, v87
    v_and_b32 v175, 0xffff0000, v87
    v_pk_add_f32 v[160:161], v[160:161], v[154:155] op_sel_hi:[1,0] neg_lo:[0,1] neg_hi:[0,1]
    v_pk_add_f32 v[162:163], v[162:163], v[154:155] op_sel_hi:[1,0] neg_lo:[0,1] neg_hi:[0,1]
    v_pk_add_f32 v[164:165], v[164:165], v[154:155] op_sel_hi:[1,0] neg_lo:[0,1] neg_hi:[0,1]
    v_pk_add_f32 v[166:167], v[166:167], v[154:155] op_sel_hi:[1,0] neg_lo:[0,1] neg_hi:[0,1]
    v_pk_add_f32 v[168:169], v[168:169], v[154:155] op_sel_hi:[1,0] neg_lo:[0,1] neg_hi:[0,1]
    v_pk_add_f32 v[170:171], v[170:171], v[154:155] op_sel_hi:[1,0] neg_lo:[0,1] neg_hi:[0,1]
    v_pk_add_f32 v[172:173], v[172:173], v[154:155] op_sel_hi:[1,0] neg_lo:[0,1] neg_hi:[0,1]
    v_pk_add_f32 v[174:175], v[174:175], v[154:155] op_sel_hi:[1,0] neg_lo:[0,1] neg_hi:[0,1]
    s_add_u32 s26, s24, 0x240000
    s_add_u32 m0, s29, 0x12000
    s_nop 0
    buffer_load_dwordx4 v136, s[16:19], s26 offen lds
    v_cvt_pk_bf16_f32 v80, v160, v161
    v_cvt_pk_bf16_f32 v81, v162, v163
    v_cvt_pk_bf16_f32 v82, v164, v165
    v_cvt_pk_bf16_f32 v83, v166, v167
    v_cvt_pk_bf16_f32 v84, v168, v169
    v_cvt_pk_bf16_f32 v85, v170, v171
    v_cvt_pk_bf16_f32 v86, v172, v173
    v_cvt_pk_bf16_f32 v87, v174, v175
    v_lshlrev_b32 v160, 16, v80
    v_and_b32 v161, 0xffff0000, v80
    v_lshlrev_b32 v162, 16, v81
    v_and_b32 v163, 0xffff0000, v81
    v_lshlrev_b32 v164, 16, v82
    v_and_b32 v165, 0xffff0000, v82
    v_lshlrev_b32 v166, 16, v83
    v_and_b32 v167, 0xffff0000, v83
    v_lshlrev_b32 v168, 16, v84
    v_and_b32 v169, 0xffff0000, v84
    v_lshlrev_b32 v170, 16, v85
    v_and_b32 v171, 0xffff0000, v85
    v_lshlrev_b32 v172, 16, v86
    v_and_b32 v173, 0xffff0000, v86
    v_lshlrev_b32 v174, 16, v87
    v_and_b32 v175, 0xffff0000, v87
    v_pk_mul_f32 v[160:161], v[160:161], v[152:153] op_sel_hi:[1,0]
    v_pk_mul_f32 v[162:163], v[162:163], v[152:153] op_sel_hi:[1,0]
    v_pk_mul_f32 v[164:165], v[164:165], v[152:153] op_sel_hi:[1,0]
    v_pk_mul_f32 v[166:167], v[166:167], v[152:153] op_sel_hi:[1,0]
    v_pk_mul_f32 v[168:169], v[168:169], v[152:153] op_sel_hi:[1,0]
    v_pk_mul_f32 v[170:171], v[170:171], v[152:153] op_sel_hi:[1,0]
    v_pk_mul_f32 v[172:173], v[172:173], v[152:153] op_sel_hi:[1,0]
    v_pk_mul_f32 v[174:175], v[174:175], v[152:153] op_sel_hi:[1,0]
    v_cvt_pk_bf16_f32 v160, v160, v161
    v_cvt_pk_bf16_f32 v162, v162, v163
    v_cvt_pk_bf16_f32 v164, v164, v165
    v_cvt_pk_bf16_f32 v166, v166, v167
    v_cvt_pk_bf16_f32 v168, v168, v169
    v_cvt_pk_bf16_f32 v170, v170, v171
    v_cvt_pk_bf16_f32 v172, v172, v173
    v_cvt_pk_bf16_f32 v174, v174, v175
    v_accvgpr_write_b32 a80, v160
    v_accvgpr_write_b32 a81, v162
    v_accvgpr_write_b32 a82, v164
    v_accvgpr_write_b32 a83, v166
    v_accvgpr_write_b32 a84, v168
    v_accvgpr_write_b32 a85, v170
    v_accvgpr_write_b32 a86, v172
    v_accvgpr_write_b32 a87, v174
    v_lshlrev_b32 v160, 16, v88
    v_and_b32 v161, 0xffff0000, v88
    s_add_u32 s26, s24, 0x260000
    s_add_u32 m0, s29, 0x13000
    s_nop 0
    buffer_load_dwordx4 v136, s[16:19], s26 offen lds
    v_lshlrev_b32 v162, 16, v89
    v_and_b32 v163, 0xffff0000, v89
    v_lshlrev_b32 v164, 16, v90
    v_and_b32 v165, 0xffff0000, v90
    v_lshlrev_b32 v166, 16, v91
    v_and_b32 v167, 0xffff0000, v91
    v_lshlrev_b32 v168, 16, v92
    v_and_b32 v169, 0xffff0000, v92
    v_lshlrev_b32 v170, 16, v93
    v_and_b32 v171, 0xffff0000, v93
    v_lshlrev_b32 v172, 16, v94
    v_and_b32 v173, 0xffff0000, v94
    v_lshlrev_b32 v174, 16, v95
    v_and_b32 v175, 0xffff0000, v95
    v_pk_add_f32 v[160:161], v[160:161], v[154:155] op_sel_hi:[1,0] neg_lo:[0,1] neg_hi:[0,1]
    v_pk_add_f32 v[162:163], v[162:163], v[154:155] op_sel_hi:[1,0] neg_lo:[0,1] neg_hi:[0,1]
    v_pk_add_f32 v[164:165], v[164:165], v[154:155] op_sel_hi:[1,0] neg_lo:[0,1] neg_hi:[0,1]
    v_pk_add_f32 v[166:167], v[166:167], v[154:155] op_sel_hi:[1,0] neg_lo:[0,1] neg_hi:[0,1]
    v_pk_add_f32 v[168:169], v[168:169], v[154:155] op_sel_hi:[1,0] neg_lo:[0,1] neg_hi:[0,1]
    v_pk_add_f32 v[170:171], v[170:171], v[154:155] op_sel_hi:[1,0] neg_lo:[0,1] neg_hi:[0,1]
    v_pk_add_f32 v[172:173], v[172:173], v[154:155] op_sel_hi:[1,0] neg_lo:[0,1] neg_hi:[0,1]
    v_pk_add_f32 v[174:175], v[174:175], v[154:155] op_sel_hi:[1,0] neg_lo:[0,1] neg_hi:[0,1]
    v_cvt_pk_bf16_f32 v88, v160, v161
    v_cvt_pk_bf16_f32 v89, v162, v163
    v_cvt_pk_bf16_f32 v90, v164, v165
    v_cvt_pk_bf16_f32 v91, v166, v167
    v_cvt_pk_bf16_f32 v92, v168, v169
    v_cvt_pk_bf16_f32 v93, v170, v171
    v_cvt_pk_bf16_f32 v94, v172, v173
    v_cvt_pk_bf16_f32 v95, v174, v175
    v_lshlrev_b32 v160, 16, v88
    v_and_b32 v161, 0xffff0000, v88
    v_lshlrev_b32 v162, 16, v89
    v_and_b32 v163, 0xffff0000, v89
    v_lshlrev_b32 v164, 16, v90
    v_and_b32 v165, 0xffff0000, v90
    v_lshlrev_b32 v166, 16, v91
    v_and_b32 v167, 0xffff0000, v91
    v_lshlrev_b32 v168, 16, v92
    v_and_b32 v169, 0xffff0000, v92
    v_lshlrev_b32 v170, 16, v93
    v_and_b32 v171, 0xffff0000, v93
    v_lshlrev_b32 v172, 16, v94
    v_and_b32 v173, 0xffff0000, v94
    v_lshlrev_b32 v174, 16, v95
    v_and_b32 v175, 0xffff0000, v95
    v_pk_mul_f32 v[160:161], v[160:161], v[152:153] op_sel_hi:[1,0]
    v_pk_mul_f32 v[162:163], v[162:163], v[152:153] op_sel_hi:[1,0]
    v_pk_mul_f32 v[164:165], v[164:165], v[152:153] op_sel_hi:[1,0]
    v_pk_mul_f32 v[166:167], v[166:167], v[152:153] op_sel_hi:[1,0]
    s_add_u32 s26, s24, 0x280000
    s_add_u32 m0, s29, 0x14000
    s_nop 0
    buffer_load_dwordx4 v136, s[16:19], s26 offen lds
    v_pk_mul_f32 v[168:169], v[168:169], v[152:153] op_sel_hi:[1,0]
    v_pk_mul_f32 v[170:171], v[170:171], v[152:153] op_sel_hi:[1,0]
    v_pk_mul_f32 v[172:173], v[172:173], v[152:153] op_sel_hi:[1,0]
    v_pk_mul_f32 v[174:175], v[174:175], v[152:153] op_sel_hi:[1,0]
    v_cvt_pk_bf16_f32 v160, v160, v161
    v_cvt_pk_bf16_f32 v162, v162, v163
    v_cvt_pk_bf16_f32 v164, v164, v165
    v_cvt_pk_bf16_f32 v166, v166, v167
    v_cvt_pk_bf16_f32 v168, v168, v169
    v_cvt_pk_bf16_f32 v170, v170, v171
    v_cvt_pk_bf16_f32 v172, v172, v173
    v_cvt_pk_bf16_f32 v174, v174, v175
    v_accvgpr_write_b32 a88, v160
    v_accvgpr_write_b32 a89, v162
    v_accvgpr_write_b32 a90, v164
    v_accvgpr_write_b32 a91, v166
    v_accvgpr_write_b32 a92, v168
    v_accvgpr_write_b32 a93, v170
    v_accvgpr_write_b32 a94, v172
    v_accvgpr_write_b32 a95, v174
    v_lshlrev_b32 v160, 16, v96
    v_and_b32 v161, 0xffff0000, v96
    v_lshlrev_b32 v162, 16, v97
    v_and_b32 v163, 0xffff0000, v97
    v_lshlrev_b32 v164, 16, v98
    v_and_b32 v165, 0xffff0000, v98
    v_lshlrev_b32 v166, 16, v99
    v_and_b32 v167, 0xffff0000, v99
    v_lshlrev_b32 v168, 16, v100
    v_and_b32 v169, 0xffff0000, v100
    v_lshlrev_b32 v170, 16, v101
    v_and_b32 v171, 0xffff0000, v101
    v_lshlrev_b32 v172, 16, v102
    v_and_b32 v173, 0xffff0000, v102
    v_lshlrev_b32 v174, 16, v103
    v_and_b32 v175, 0xffff0000, v103
    v_pk_add_f32 v[160:161], v[160:161], v[154:155] op_sel_hi:[1,0] neg_lo:[0,1] neg_hi:[0,1]
    v_pk_add_f32 v[162:163], v[162:163], v[154:155] op_sel_hi:[1,0] neg_lo:[0,1] neg_hi:[0,1]
    v_pk_add_f32 v[164:165], v[164:165], v[154:155] op_sel_hi:[1,0] neg_lo:[0,1] neg_hi:[0,1]
    v_pk_add_f32 v[166:167], v[166:167], v[154:155] op_sel_hi:[1,0] neg_lo:[0,1] neg_hi:[0,1]
    v_pk_add_f32 v[168:169], v[168:169], v[154:155] op_sel_hi:[1,0] neg_lo:[0,1] neg_hi:[0,1]
    v_pk_add_f32 v[170:171], v[170:171], v[154:155] op_sel_hi:[1,0] neg_lo:[0,1] neg_hi:[0,1]
    v_pk_add_f32 v[172:173], v[172:173], v[154:155] op_sel_hi:[1,0] neg_lo:[0,1] neg_hi:[0,1]
    v_pk_add_f32 v[174:175], v[174:175], v[154:155] op_sel_hi:[1,0] neg_lo:[0,1] neg_hi:[0,1]
    v_cvt_pk_bf16_f32 v96, v160, v161
    v_cvt_pk_bf16_f32 v97, v162, v163
    v_cvt_pk_bf16_f32 v98, v164, v165
    v_cvt_pk_bf16_f32 v99, v166, v167
    v_cvt_pk_bf16_f32 v100, v168, v169
    v_cvt_pk_bf16_f32 v101, v170, v171
    s_add_u32 s26, s24, 0x2a0000
    s_add_u32 m0, s29, 0x15000
    s_nop 0
    buffer_load_dwordx4 v136, s[16:19], s26 offen lds
    v_cvt_pk_bf16_f32 v102, v172, v173
    v_cvt_pk_bf16_f32 v103, v174, v175
    v_lshlrev_b32 v160, 16, v96
    v_and_b32 v161, 0xffff0000, v96
    v_lshlrev_b32 v162, 16, v97
    v_and_b32 v163, 0xffff0000, v97
    v_lshlrev_b32 v164, 16, v98
    v_and_b32 v165, 0xffff0000, v98
    v_lshlrev_b32 v166, 16, v99
    v_and_b32 v167, 0xffff0000, v99
    v_lshlrev_b32 v168, 16, v100
    v_and_b32 v169, 0xffff0000, v100
    v_lshlrev_b32 v170, 16, v101
    v_and_b32 v171, 0xffff0000, v101
    v_lshlrev_b32 v172, 16, v102
    v_and_b32 v173, 0xffff0000, v102
    v_lshlrev_b32 v174, 16, v103
    v_and_b32 v175, 0xffff0000, v103
    v_pk_mul_f32 v[160:161], v[160:161], v[152:153] op_sel_hi:[1,0]
    v_pk_mul_f32 v[162:163], v[162:163], v[152:153] op_sel_hi:[1,0]
    v_pk_mul_f32 v[164:165], v[164:165], v[152:153] op_sel_hi:[1,0]
    v_pk_mul_f32 v[166:167], v[166:167], v[152:153] op_sel_hi:[1,0]
    v_pk_mul_f32 v[168:169], v[168:169], v[152:153] op_sel_hi:[1,0]
    v_pk_mul_f32 v[170:171], v[170:171], v[152:153] op_sel_hi:[1,0]
    v_pk_mul_f32 v[172:173], v[172:173], v[152:153] op_sel_hi:[1,0]
    v_pk_mul_f32 v[174:175], v[174:175], v[152:153] op_sel_hi:[1,0]
    v_cvt_pk_bf16_f32 v160, v160, v161
    v_cvt_pk_bf16_f32 v162, v162, v163
    v_cvt_pk_bf16_f32 v164, v164, v165
    v_cvt_pk_bf16_f32 v166, v166, v167
    v_cvt_pk_bf16_f32 v168, v168, v169
    v_cvt_pk_bf16_f32 v170, v170, v171
    v_cvt_pk_bf16_f32 v172, v172, v173
    v_cvt_pk_bf16_f32 v174, v174, v175
    v_accvgpr_write_b32 a96, v160
    v_accvgpr_write_b32 a97, v162
    v_accvgpr_write_b32 a98, v164
    v_accvgpr_write_b32 a99, v166
    v_accvgpr_write_b32 a100, v168
    v_accvgpr_write_b32 a101, v170
    v_accvgpr_write_b32 a102, v172
    v_accvgpr_write_b32 a103, v174
    v_lshlrev_b32 v160, 16, v104
    v_and_b32 v161, 0xffff0000, v104
    v_lshlrev_b32 v162, 16, v105
    v_and_b32 v163, 0xffff0000, v105
    v_lshlrev_b32 v164, 16, v106
    v_and_b32 v165, 0xffff0000, v106
    v_lshlrev_b32 v166, 16, v107
    v_and_b32 v167, 0xffff0000, v107
    s_add_u32 s26, s24, 0x2c0000
    s_add_u32 m0, s29, 0x16000
    s_nop 0
    buffer_load_dwordx4 v136, s[16:19], s26 offen lds
    v_lshlrev_b32 v168, 16, v108
    v_and_b32 v169, 0xffff0000, v108
    v_lshlrev_b32 v170, 16, v109
    v_and_b32 v171, 0xffff0000, v109
    v_lshlrev_b32 v172, 16, v110
    v_and_b32 v173, 0xffff0000, v110
    v_lshlrev_b32 v174, 16, v111
    v_and_b32 v175, 0xffff0000, v111
    v_pk_add_f32 v[160:161], v[160:161], v[154:155] op_sel_hi:[1,0] neg_lo:[0,1] neg_hi:[0,1]
    v_pk_add_f32 v[162:163], v[162:163], v[154:155] op_sel_hi:[1,0] neg_lo:[0,1] neg_hi:[0,1]
    v_pk_add_f32 v[164:165], v[164:165], v[154:155] op_sel_hi:[1,0] neg_lo:[0,1] neg_hi:[0,1]
    v_pk_add_f32 v[166:167], v[166:167], v[154:155] op_sel_hi:[1,0] neg_lo:[0,1] neg_hi:[0,1]
    v_pk_add_f32 v[168:169], v[168:169], v[154:155] op_sel_hi:[1,0] neg_lo:[0,1] neg_hi:[0,1]
    v_pk_add_f32 v[170:171], v[170:171], v[154:155] op_sel_hi:[1,0] neg_lo:[0,1] neg_hi:[0,1]
    v_pk_add_f32 v[172:173], v[172:173], v[154:155] op_sel_hi:[1,0] neg_lo:[0,1] neg_hi:[0,1]
    v_pk_add_f32 v[174:175], v[174:175], v[154:155] op_sel_hi:[1,0] neg_lo:[0,1] neg_hi:[0,1]
    v_cvt_pk_bf16_f32 v104, v160, v161
    v_cvt_pk_bf16_f32 v105, v162, v163
    v_cvt_pk_bf16_f32 v106, v164, v165
    v_cvt_pk_bf16_f32 v107, v166, v167
    v_cvt_pk_bf16_f32 v108, v168, v169
    v_cvt_pk_bf16_f32 v109, v170, v171
    v_cvt_pk_bf16_f32 v110, v172, v173
    v_cvt_pk_bf16_f32 v111, v174, v175
    v_lshlrev_b32 v160, 16, v104
    v_and_b32 v161, 0xffff0000, v104
    v_lshlrev_b32 v162, 16, v105
    v_and_b32 v163, 0xffff0000, v105
    v_lshlrev_b32 v164, 16, v106
    v_and_b32 v165, 0xffff0000, v106
    v_lshlrev_b32 v166, 16, v107
    v_and_b32 v167, 0xffff0000, v107
    v_lshlrev_b32 v168, 16, v108
    v_and_b32 v169, 0xffff0000, v108
    v_lshlrev_b32 v170, 16, v109
    v_and_b32 v171, 0xffff0000, v109
    v_lshlrev_b32 v172, 16, v110
    v_and_b32 v173, 0xffff0000, v110
    v_lshlrev_b32 v174, 16, v111
    v_and_b32 v175, 0xffff0000, v111
    v_pk_mul_f32 v[160:161], v[160:161], v[152:153] op_sel_hi:[1,0]
    v_pk_mul_f32 v[162:163], v[162:163], v[152:153] op_sel_hi:[1,0]
    v_pk_mul_f32 v[164:165], v[164:165], v[152:153] op_sel_hi:[1,0]
    v_pk_mul_f32 v[166:167], v[166:167], v[152:153] op_sel_hi:[1,0]
    v_pk_mul_f32 v[168:169], v[168:169], v[152:153] op_sel_hi:[1,0]
    v_pk_mul_f32 v[170:171], v[170:171], v[152:153] op_sel_hi:[1,0]
    v_pk_mul_f32 v[172:173], v[172:173], v[152:153] op_sel_hi:[1,0]
    v_pk_mul_f32 v[174:175], v[174:175], v[152:153] op_sel_hi:[1,0]
    v_cvt_pk_bf16_f32 v160, v160, v161
    v_cvt_pk_bf16_f32 v162, v162, v163
    s_add_u32 s26, s24, 0x2e0000
    s_add_u32 m0, s29, 0x17000
    s_nop 0
    buffer_load_dwordx4 v136, s[16:19], s26 offen lds
    v_cvt_pk_bf16_f32 v164, v164, v165
    v_cvt_pk_bf16_f32 v166, v166, v167
    v_cvt_pk_bf16_f32 v168, v168, v169
    v_cvt_pk_bf16_f32 v170, v170, v171
    v_cvt_pk_bf16_f32 v172, v172, v173
    v_cvt_pk_bf16_f32 v174, v174, v175
    v_accvgpr_write_b32 a104, v160
    v_accvgpr_write_b32 a105, v162
    v_accvgpr_write_b32 a106, v164
    v_accvgpr_write_b32 a107, v166
    v_accvgpr_write_b32 a108, v168
    v_accvgpr_write_b32 a109, v170
    v_accvgpr_write_b32 a110, v172
    v_accvgpr_write_b32 a111, v174
    v_lshlrev_b32 v160, 16, v112
    v_and_b32 v161, 0xffff0000, v112
    v_lshlrev_b32 v162, 16, v113
    v_and_b32 v163, 0xffff0000, v113
    v_lshlrev_b32 v164, 16, v114
    v_and_b32 v165, 0xffff0000, v114
    v_lshlrev_b32 v166, 16, v115
    v_and_b32 v167, 0xffff0000, v115
    v_lshlrev_b32 v168, 16, v116
    v_and_b32 v169, 0xffff0000, v116
    v_lshlrev_b32 v170, 16, v117
    v_and_b32 v171, 0xffff0000, v117
    v_lshlrev_b32 v172, 16, v118
    v_and_b32 v173, 0xffff0000, v118
    v_lshlrev_b32 v174, 16, v119
    v_and_b32 v175, 0xffff0000, v119
    v_pk_add_f32 v[160:161], v[160:161], v[154:155] op_sel_hi:[1,0] neg_lo:[0,1] neg_hi:[0,1]
    v_pk_add_f32 v[162:163], v[162:163], v[154:155] op_sel_hi:[1,0] neg_lo:[0,1] neg_hi:[0,1]
    v_pk_add_f32 v[164:165], v[164:165], v[154:155] op_sel_hi:[1,0] neg_lo:[0,1] neg_hi:[0,1]
    v_pk_add_f32 v[166:167], v[166:167], v[154:155] op_sel_hi:[1,0] neg_lo:[0,1] neg_hi:[0,1]
    v_pk_add_f32 v[168:169], v[168:169], v[154:155] op_sel_hi:[1,0] neg_lo:[0,1] neg_hi:[0,1]
    v_pk_add_f32 v[170:171], v[170:171], v[154:155] op_sel_hi:[1,0] neg_lo:[0,1] neg_hi:[0,1]
    v_pk_add_f32 v[172:173], v[172:173], v[154:155] op_sel_hi:[1,0] neg_lo:[0,1] neg_hi:[0,1]
    v_pk_add_f32 v[174:175], v[174:175], v[154:155] op_sel_hi:[1,0] neg_lo:[0,1] neg_hi:[0,1]
    v_cvt_pk_bf16_f32 v112, v160, v161
    v_cvt_pk_bf16_f32 v113, v162, v163
    v_cvt_pk_bf16_f32 v114, v164, v165
    v_cvt_pk_bf16_f32 v115, v166, v167
    v_cvt_pk_bf16_f32 v116, v168, v169
    v_cvt_pk_bf16_f32 v117, v170, v171
    v_cvt_pk_bf16_f32 v118, v172, v173
    v_cvt_pk_bf16_f32 v119, v174, v175
    v_lshlrev_b32 v160, 16, v112
    v_and_b32 v161, 0xffff0000, v112
    v_lshlrev_b32 v162, 16, v113
    v_and_b32 v163, 0xffff0000, v113
    v_lshlrev_b32 v138, 2, v137
    v_lshlrev_b32 v138, 3, v137
    s_sub_u32 s26, s101, 96
    s_lshl_b32 s26, s26, 2
    s_add_u32 s26, s26, s21
    s_min_u32 s26, s26, 512
    s_lshl_b32 s26, s26, 13
    s_cmp_eq_u32 s41, 0
    s_cselect_b32 s6, 0x400000, 0
    s_mov_b32 s7, 0x20000
    s_mov_b32 s4, s66
    s_and_b32 s5, s67, 0xffff
    buffer_load_dword v143, v138, s[4:7], s26 offen
    v_lshlrev_b32 v164, 16, v114
    v_and_b32 v165, 0xffff0000, v114
    v_lshlrev_b32 v166, 16, v115
    v_and_b32 v167, 0xffff0000, v115
    v_lshlrev_b32 v168, 16, v116
    v_and_b32 v169, 0xffff0000, v116
    v_lshlrev_b32 v170, 16, v117
    v_and_b32 v171, 0xffff0000, v117
    v_lshlrev_b32 v172, 16, v118
    v_and_b32 v173, 0xffff0000, v118
    v_lshlrev_b32 v174, 16, v119
    v_and_b32 v175, 0xffff0000, v119
    v_pk_mul_f32 v[160:161], v[160:161], v[152:153] op_sel_hi:[1,0]
    v_pk_mul_f32 v[162:163], v[162:163], v[152:153] op_sel_hi:[1,0]
    v_pk_mul_f32 v[164:165], v[164:165], v[152:153] op_sel_hi:[1,0]
    v_pk_mul_f32 v[166:167], v[166:167], v[152:153] op_sel_hi:[1,0]
    v_pk_mul_f32 v[168:169], v[168:169], v[152:153] op_sel_hi:[1,0]
    v_pk_mul_f32 v[170:171], v[170:171], v[152:153] op_sel_hi:[1,0]
    v_pk_mul_f32 v[172:173], v[172:173], v[152:153] op_sel_hi:[1,0]
    v_pk_mul_f32 v[174:175], v[174:175], v[152:153] op_sel_hi:[1,0]
    v_cvt_pk_bf16_f32 v160, v160, v161
    v_cvt_pk_bf16_f32 v162, v162, v163
    v_cvt_pk_bf16_f32 v164, v164, v165
    v_cvt_pk_bf16_f32 v166, v166, v167
    v_cvt_pk_bf16_f32 v168, v168, v169
    v_cvt_pk_bf16_f32 v170, v170, v171
    v_cvt_pk_bf16_f32 v172, v172, v173
    v_cvt_pk_bf16_f32 v174, v174, v175
    v_accvgpr_write_b32 a112, v160
    v_accvgpr_write_b32 a113, v162
    v_accvgpr_write_b32 a114, v164
    v_accvgpr_write_b32 a115, v166
    v_accvgpr_write_b32 a116, v168
    v_accvgpr_write_b32 a117, v170
    v_accvgpr_write_b32 a118, v172
    v_accvgpr_write_b32 a119, v174
    v_lshlrev_b32 v160, 16, v120
    v_and_b32 v161, 0xffff0000, v120
    v_lshlrev_b32 v162, 16, v121
    v_and_b32 v163, 0xffff0000, v121
    v_lshlrev_b32 v164, 16, v122
    v_and_b32 v165, 0xffff0000, v122
    v_lshlrev_b32 v166, 16, v123
    v_and_b32 v167, 0xffff0000, v123
    v_lshlrev_b32 v168, 16, v124
    v_and_b32 v169, 0xffff0000, v124
    v_lshlrev_b32 v170, 16, v125
    v_and_b32 v171, 0xffff0000, v125
    v_lshlrev_b32 v172, 16, v126
    v_and_b32 v173, 0xffff0000, v126
    v_lshlrev_b32 v174, 16, v127
    v_and_b32 v175, 0xffff0000, v127
    v_pk_add_f32 v[160:161], v[160:161], v[154:155] op_sel_hi:[1,0] neg_lo:[0,1] neg_hi:[0,1]
    v_pk_add_f32 v[162:163], v[162:163], v[154:155] op_sel_hi:[1,0] neg_lo:[0,1] neg_hi:[0,1]
    v_pk_add_f32 v[164:165], v[164:165], v[154:155] op_sel_hi:[1,0] neg_lo:[0,1] neg_hi:[0,1]
    v_pk_add_f32 v[166:167], v[166:167], v[154:155] op_sel_hi:[1,0] neg_lo:[0,1] neg_hi:[0,1]
    v_pk_add_f32 v[168:169], v[168:169], v[154:155] op_sel_hi:[1,0] neg_lo:[0,1] neg_hi:[0,1]
    v_pk_add_f32 v[170:171], v[170:171], v[154:155] op_sel_hi:[1,0] neg_lo:[0,1] neg_hi:[0,1]
    v_pk_add_f32 v[172:173], v[172:173], v[154:155] op_sel_hi:[1,0] neg_lo:[0,1] neg_hi:[0,1]
    v_pk_add_f32 v[174:175], v[174:175], v[154:155] op_sel_hi:[1,0] neg_lo:[0,1] neg_hi:[0,1]
    v_cvt_pk_bf16_f32 v120, v160, v161
    v_cvt_pk_bf16_f32 v121, v162, v163
    v_cvt_pk_bf16_f32 v122, v164, v165
    v_cvt_pk_bf16_f32 v123, v166, v167
    v_cvt_pk_bf16_f32 v124, v168, v169
    v_cvt_pk_bf16_f32 v125, v170, v171
    v_cvt_pk_bf16_f32 v126, v172, v173
    v_cvt_pk_bf16_f32 v127, v174, v175
    v_lshlrev_b32 v160, 16, v120
    v_and_b32 v161, 0xffff0000, v120
    v_lshlrev_b32 v162, 16, v121
    v_and_b32 v163, 0xffff0000, v121
    v_lshlrev_b32 v164, 16, v122
    v_and_b32 v165, 0xffff0000, v122
    v_lshlrev_b32 v166, 16, v123
    v_and_b32 v167, 0xffff0000, v123
    v_lshlrev_b32 v168, 16, v124
    v_and_b32 v169, 0xffff0000, v124
    v_lshlrev_b32 v170, 16, v125
    v_and_b32 v171, 0xffff0000, v125
    v_lshlrev_b32 v172, 16, v126
    v_and_b32 v173, 0xffff0000, v126
    v_lshlrev_b32 v174, 16, v127
    v_and_b32 v175, 0xffff0000, v127
    v_pk_mul_f32 v[160:161], v[160:161], v[152:153] op_sel_hi:[1,0]
    v_pk_mul_f32 v[162:163], v[162:163], v[152:153] op_sel_hi:[1,0]
    v_pk_mul_f32 v[164:165], v[164:165], v[152:153] op_sel_hi:[1,0]
    v_pk_mul_f32 v[166:167], v[166:167], v[152:153] op_sel_hi:[1,0]
    v_pk_mul_f32 v[168:169], v[168:169], v[152:153] op_sel_hi:[1,0]
    v_pk_mul_f32 v[170:171], v[170:171], v[152:153] op_sel_hi:[1,0]
    v_pk_mul_f32 v[172:173], v[172:173], v[152:153] op_sel_hi:[1,0]
    v_pk_mul_f32 v[174:175], v[174:175], v[152:153] op_sel_hi:[1,0]
    v_cvt_pk_bf16_f32 v160, v160, v161
    v_cvt_pk_bf16_f32 v162, v162, v163
    v_cvt_pk_bf16_f32 v164, v164, v165
    v_cvt_pk_bf16_f32 v166, v166, v167
    v_cvt_pk_bf16_f32 v168, v168, v169
    v_cvt_pk_bf16_f32 v170, v170, v171
    v_cvt_pk_bf16_f32 v172, v172, v173
    v_cvt_pk_bf16_f32 v174, v174, v175
    v_accvgpr_write_b32 a120, v160
    v_accvgpr_write_b32 a121, v162
    v_accvgpr_write_b32 a122, v164
    v_accvgpr_write_b32 a123, v166
    v_accvgpr_write_b32 a124, v168
    v_accvgpr_write_b32 a125, v170
    v_accvgpr_write_b32 a126, v172
    v_accvgpr_write_b32 a127, v174
    buffer_load_dwordx2 v[140:141], off, s[92:95], 0 offset:36 sc1
    s_nop 3
L_p1_unit:
    s_cmp_ge_u32 s38, 96
    s_cbranch_scc1 L_p1_end
    s_lshr_b32 s26, s38, 5
    s_add_u32 s27, s26, 1
    s_lshl_b32 s25, s27, 24
    s_lshl_b32 s27, s20, 2
    s_add_u32 s27, s27, s21
    s_lshl_b32 s27, s27, 5
    s_and_b32 s28, s38, 31
    s_add_u32 s27, s27, s28
    s_lshl_b32 s27, s27, 13
    s_add_u32 s25, s25, s27
    s_lshr_b32 s26, s38, 5
    s_cmp_eq_u32 s26, 1
    s_cbranch_scc1 L_p1_v
    s_waitcnt vmcnt(16)
    s_barrier
    ds_read_b64_tr_b16 v[64:65], v128
    ds_read_b64_tr_b16 v[66:67], v128 offset:1024
    ds_read_b64_tr_b16 v[68:69], v129
    ds_read_b64_tr_b16 v[70:71], v129 offset:1024
    ds_read_b64_tr_b16 v[72:73], v130
    ds_read_b64_tr_b16 v[74:75], v130 offset:1024
    ds_read_b64_tr_b16 v[76:77], v131
    ds_read_b64_tr_b16 v[78:79], v131 offset:1024
    ds_read_b64_tr_b16 v[80:81], v132
    ds_read_b64_tr_b16 v[82:83], v132 offset:1024
    ds_read_b64_tr_b16 v[84:85], v133
    ds_read_b64_tr_b16 v[86:87], v133 offset:1024
    ds_read_b64_tr_b16 v[88:89], v134
    ds_read_b64_tr_b16 v[90:91], v134 offset:1024
    s_waitcnt lgkmcnt(12)
    v_mfma_f32_16x16x32_bf16 v[0:3], v[64:67], a[0:3], 0
    ds_read_b64_tr_b16 v[92:93], v135
    v_mfma_f32_16x16x32_bf16 v[4:7], v[64:67], a[64:67], 0
    ds_read_b64_tr_b16 v[94:95], v135 offset:1024
    s_add_u32 s26, s24, 0x300000
    s_add_u32 m0, s29, 0x18000
    s_nop 0
    buffer_load_dwordx4 v136, s[16:19], s26 offen lds
    s_waitcnt lgkmcnt(12)
    v_mfma_f32_16x16x32_bf16 v[8:11], v[68:71], a[0:3], 0
    ds_read_b64_tr_b16 v[96:97], v128 offset:8192
    v_mfma_f32_16x16x32_bf16 v[12:15], v[68:71], a[64:67], 0
    ds_read_b64_tr_b16 v[98:99], v128 offset:9216
    s_add_u32 s26, s24, 0x320000
    s_add_u32 m0, s29, 0x19000
    s_nop 0
    buffer_load_dwordx4 v136, s[16:19], s26 offen lds
    s_waitcnt lgkmcnt(12)
    v_mfma_f32_16x16x32_bf16 v[16:19], v[72:75], a[0:3], 0
    ds_read_b64_tr_b16 v[100:101], v129 offset:8192
    v_mfma_f32_16x16x32_bf16 v[20:23], v[72:75], a[64:67], 0
    ds_read_b64_tr_b16 v[102:103], v129 offset:9216
    s_add_u32 s26, s24, 0x340000
    s_add_u32 m0, s29, 0x1a000
    s_nop 0
    buffer_load_dwordx4 v136, s[16:19], s26 offen lds
    s_waitcnt lgkmcnt(12)
    v_mfma_f32_16x16x32_bf16 v[24:27], v[76:79], a[0:3], 0
    ds_read_b64_tr_b16 v[104:105], v130 offset:8192
    v_mfma_f32_16x16x32_bf16 v[28:31], v[76:79], a[64:67], 0
    ds_read_b64_tr_b16 v[106:107], v130 offset:9216
    s_add_u32 s26, s24, 0x360000
    s_add_u32 m0, s29, 0x1b000
    s_nop 0
    buffer_load_dwordx4 v136, s[16:19], s26 offen lds
    s_waitcnt lgkmcnt(12)
    v_mfma_f32_16x16x32_bf16 v[32:35], v[80:83], a[0:3], 0
    ds_read_b64_tr_b16 v[108:109], v131 offset:8192
    v_mfma_f32_16x16x32_bf16 v[36:39], v[80:83], a[64:67], 0
    ds_read_b64_tr_b16 v[110:111], v131 offset:9216
    s_add_u32 s26, s24, 0x380000
    s_add_u32 m0, s29, 0x1c000
    s_nop 0
    buffer_load_dwordx4 v136, s[16:19], s26 offen lds
    s_waitcnt lgkmcnt(12)
    v_mfma_f32_16x16x32_bf16 v[40:43], v[84:87], a[0:3], 0
    ds_read_b64_tr_b16 v[112:113], v132 offset:8192
    v_mfma_f32_16x16x32_bf16 v[44:47], v[84:87], a[64:67], 0
    ds_read_b64_tr_b16 v[114:115], v132 offset:9216
    s_add_u32 s26, s24, 0x3a0000
    s_add_u32 m0, s29, 0x1d000
    s_nop 0
    buffer_load_dwordx4 v136, s[16:19], s26 offen lds
    s_waitcnt lgkmcnt(12)
    v_mfma_f32_16x16x32_bf16 v[48:51], v[88:91], a[0:3], 0
    ds_read_b64_tr_b16 v[116:117], v133 offset:8192
    v_mfma_f32_16x16x32_bf16 v[52:55], v[88:91], a[64:67], 0
    ds_read_b64_tr_b16 v[118:119], v133 offset:9216
    s_add_u32 s26, s24, 0x3c0000
    s_add_u32 m0, s29, 0x1e000
    s_nop 0
    buffer_load_dwordx4 v136, s[16:19], s26 offen lds
    s_waitcnt lgkmcnt(12)
    v_mfma_f32_16x16x32_bf16 v[56:59], v[92:95], a[0:3], 0
    ds_read_b64_tr_b16 v[120:121], v134 offset:8192
    v_mfma_f32_16x16x32_bf16 v[60:63], v[92:95], a[64:67], 0
    ds_read_b64_tr_b16 v[122:123], v134 offset:9216
    s_add_u32 s26, s24, 0x3e0000
    s_add_u32 m0, s29, 0x1f000
    s_nop 0
    buffer_load_dwordx4 v136, s[16:19], s26 offen lds
    s_waitcnt lgkmcnt(12)
    v_mfma_f32_16x16x32_bf16 v[0:3], v[96:99], a[4:7], v[0:3]
    ds_read_b64_tr_b16 v[124:125], v135 offset:8192
    v_mfma_f32_16x16x32_bf16 v[4:7], v[96:99], a[68:71], v[4:7]
    ds_read_b64_tr_b16 v[126:127], v135 offset:9216
    s_waitcnt lgkmcnt(12)
    v_mfma_f32_16x16x32_bf16 v[8:11], v[100:103], a[4:7], v[8:11]
    ds_read_b64_tr_b16 v[64:65], v128 offset:16384
    v_mfma_f32_16x16x32_bf16 v[12:15], v[100:103], a[68:71], v[12:15]
    ds_read_b64_tr_b16 v[66:67], v128 offset:17408
    s_waitcnt lgkmcnt(12)
    v_mfma_f32_16x16x32_bf16 v[16:19], v[104:107], a[4:7], v[16:19]
    ds_read_b64_tr_b16 v[68:69], v129 offset:16384
    v_mfma_f32_16x16x32_bf16 v[20:23], v[104:107], a[68:71], v[20:23]
    ds_read_b64_tr_b16 v[70:71], v129 offset:17408
    s_waitcnt lgkmcnt(12)
    v_mfma_f32_16x16x32_bf16 v[24:27], v[108:111], a[4:7], v[24:27]
    ds_read_b64_tr_b16 v[72:73], v130 offset:16384
    v_mfma_f32_16x16x32_bf16 v[28:31], v[108:111], a[68:71], v[28:31]
    ds_read_b64_tr_b16 v[74:75], v130 offset:17408
    s_waitcnt lgkmcnt(12)
    v_mfma_f32_16x16x32_bf16 v[32:35], v[112:115], a[4:7], v[32:35]
    ds_read_b64_tr_b16 v[76:77], v131 offset:16384
    v_mfma_f32_16x16x32_bf16 v[36:39], v[112:115], a[68:71], v[36:39]
    ds_read_b64_tr_b16 v[78:79], v131 offset:17408
    s_waitcnt lgkmcnt(12)
    v_mfma_f32_16x16x32_bf16 v[40:43], v[116:119], a[4:7], v[40:43]
    ds_read_b64_tr_b16 v[80:81], v132 offset:16384
    v_mfma_f32_16x16x32_bf16 v[44:47], v[116:119], a[68:71], v[44:47]
    ds_read_b64_tr_b16 v[82:83], v132 offset:17408
    s_waitcnt lgkmcnt(12)
    v_mfma_f32_16x16x32_bf16 v[48:51], v[120:123], a[4:7], v[48:51]
    ds_read_b64_tr_b16 v[84:85], v133 offset:16384
    v_mfma_f32_16x16x32_bf16 v[52:55], v[120:123], a[68:71], v[52:55]
    ds_read_b64_tr_b16 v[86:87], v133 offset:17408
    s_waitcnt lgkmcnt(12)
    v_mfma_f32_16x16x32_bf16 v[56:59], v[124:127], a[4:7], v[56:59]
    ds_read_b64_tr_b16 v[88:89], v134 offset:16384
    v_mfma_f32_16x16x32_bf16 v[60:63], v[124:127], a[68:71], v[60:63]
    ds_read_b64_tr_b16 v[90:91], v134 offset:17408
    s_waitcnt lgkmcnt(12)
    v_mfma_f32_16x16x32_bf16 v[0:3], v[64:67], a[8:11], v[0:3]
    ds_read_b64_tr_b16 v[92:93], v135 offset:16384
    v_mfma_f32_16x16x32_bf16 v[4:7], v[64:67], a[72:75], v[4:7]
    ds_read_b64_tr_b16 v[94:95], v135 offset:17408
    s_waitcnt lgkmcnt(12)
    v_mfma_f32_16x16x32_bf16 v[8:11], v[68:71], a[8:11], v[8:11]
    ds_read_b64_tr_b16 v[96:97], v128 offset:24576
    v_mfma_f32_16x16x32_bf16 v[12:15], v[68:71], a[72:75], v[12:15]
    ds_read_b64_tr_b16 v[98:99], v128 offset:25600
    s_waitcnt lgkmcnt(12)
    v_mfma_f32_16x16x32_bf16 v[16:19], v[72:75], a[8:11], v[16:19]
    ds_read_b64_tr_b16 v[100:101], v129 offset:24576
    v_mfma_f32_16x16x32_bf16 v[20:23], v[72:75], a[72:75], v[20:23]
    ds_read_b64_tr_b16 v[102:103], v129 offset:25600
    s_waitcnt lgkmcnt(12)
    v_mfma_f32_16x16x32_bf16 v[24:27], v[76:79], a[8:11], v[24:27]
    ds_read_b64_tr_b16 v[104:105], v130 offset:24576
    v_mfma_f32_16x16x32_bf16 v[28:31], v[76:79], a[72:75], v[28:31]
    ds_read_b64_tr_b16 v[106:107], v130 offset:25600
    s_waitcnt lgkmcnt(12)
    v_mfma_f32_16x16x32_bf16 v[32:35], v[80:83], a[8:11], v[32:35]
    ds_read_b64_tr_b16 v[108:109], v131 offset:24576
    v_mfma_f32_16x16x32_bf16 v[36:39], v[80:83], a[72:75], v[36:39]
    ds_read_b64_tr_b16 v[110:111], v131 offset:25600
    s_waitcnt lgkmcnt(12)
    v_mfma_f32_16x16x32_bf16 v[40:43], v[84:87], a[8:11], v[40:43]
    ds_read_b64_tr_b16 v[112:113], v132 offset:24576
    v_mfma_f32_16x16x32_bf16 v[44:47], v[84:87], a[72:75], v[44:47]
    ds_read_b64_tr_b16 v[114:115], v132 offset:25600
    s_waitcnt lgkmcnt(12)
    v_mfma_f32_16x16x32_bf16 v[48:51], v[88:91], a[8:11], v[48:51]
    ds_read_b64_tr_b16 v[116:117], v133 offset:24576
    v_mfma_f32_16x16x32_bf16 v[52:55], v[88:91], a[72:75], v[52:55]
    ds_read_b64_tr_b16 v[118:119], v133 offset:25600
    s_waitcnt lgkmcnt(12)
    v_mfma_f32_16x16x32_bf16 v[56:59], v[92:95], a[8:11], v[56:59]
    ds_read_b64_tr_b16 v[120:121], v134 offset:24576
    v_mfma_f32_16x16x32_bf16 v[60:63], v[92:95], a[72:75], v[60:63]
    ds_read_b64_tr_b16 v[122:123], v134 offset:25600
    s_waitcnt lgkmcnt(12)
    v_mfma_f32_16x16x32_bf16 v[0:3], v[96:99], a[12:15], v[0:3]
    ds_read_b64_tr_b16 v[124:125], v135 offset:24576
    v_mfma_f32_16x16x32_bf16 v[4:7], v[96:99], a[76:79], v[4:7]
    ds_read_b64_tr_b16 v[126:127], v135 offset:25600
    s_waitcnt lgkmcnt(12)
    v_mfma_f32_16x16x32_bf16 v[8:11], v[100:103], a[12:15], v[8:11]
    v_mfma_f32_16x16x32_bf16 v[12:15], v[100:103], a[76:79], v[12:15]
    s_waitcnt lgkmcnt(10)
    v_mfma_f32_16x16x32_bf16 v[16:19], v[104:107], a[12:15], v[16:19]
    v_mfma_f32_16x16x32_bf16 v[20:23], v[104:107], a[76:79], v[20:23]
    s_waitcnt lgkmcnt(8)
    v_mfma_f32_16x16x32_bf16 v[24:27], v[108:111], a[12:15], v[24:27]
    v_mfma_f32_16x16x32_bf16 v[28:31], v[108:111], a[76:79], v[28:31]
    s_waitcnt lgkmcnt(6)
    v_mfma_f32_16x16x32_bf16 v[32:35], v[112:115], a[12:15], v[32:35]
    v_mfma_f32_16x16x32_bf16 v[36:39], v[112:115], a[76:79], v[36:39]
    s_waitcnt lgkmcnt(4)
    v_mfma_f32_16x16x32_bf16 v[40:43], v[116:119], a[12:15], v[40:43]
    v_mfma_f32_16x16x32_bf16 v[44:47], v[116:119], a[76:79], v[44:47]
    s_waitcnt lgkmcnt(2)
    v_mfma_f32_16x16x32_bf16 v[48:51], v[120:123], a[12:15], v[48:51]
    v_mfma_f32_16x16x32_bf16 v[52:55], v[120:123], a[76:79], v[52:55]
    s_waitcnt lgkmcnt(0)
    v_mfma_f32_16x16x32_bf16 v[56:59], v[124:127], a[12:15], v[56:59]
    v_mfma_f32_16x16x32_bf16 v[60:63], v[124:127], a[76:79], v[60:63]
    s_waitcnt vmcnt(16)
    s_barrier
    ds_read_b64_tr_b16 v[64:65], v128 offset:32768
    ds_read_b64_tr_b16 v[66:67], v128 offset:33792
    ds_read_b64_tr_b16 v[68:69], v129 offset:32768
    ds_read_b64_tr_b16 v[70:71], v129 offset:33792
    ds_read_b64_tr_b16 v[72:73], v130 offset:32768
    ds_read_b64_tr_b16 v[74:75], v130 offset:33792
    ds_read_b64_tr_b16 v[76:77], v131 offset:32768
    ds_read_b64_tr_b16 v[78:79], v131 offset:33792
    ds_read_b64_tr_b16 v[80:81], v132 offset:32768
    ds_read_b64_tr_b16 v[82:83], v132 offset:33792
    ds_read_b64_tr_b16 v[84:85], v133 offset:32768
    ds_read_b64_tr_b16 v[86:87], v133 offset:33792
    ds_read_b64_tr_b16 v[88:89], v134 offset:32768
    ds_read_b64_tr_b16 v[90:91], v134 offset:33792
    s_add_u32 s39, s39, s37
    s_lshr_b32 s26, s39, 5
    s_cmp_eq_u32 s26, 0
    s_cselect_b64 s[16:17], s[62:63], s[60:61]
    s_cmp_eq_u32 s26, 1
    s_cselect_b64 s[16:17], s[64:65], s[16:17]
    s_and_b32 s17, s17, 0xffff
    s_cmp_lt_u32 s39, 96
    s_cselect_b32 s18, 0x400000, 0
    s_and_b32 s24, s39, 31
    s_lshl_b32 s24, s24, 8
    s_waitcnt lgkmcnt(12)
    v_mfma_f32_16x16x32_bf16 v[0:3], v[64:67], a[16:19], v[0:3]
    ds_read_b64_tr_b16 v[92:93], v135 offset:32768
    v_mfma_f32_16x16x32_bf16 v[4:7], v[64:67], a[80:83], v[4:7]
    ds_read_b64_tr_b16 v[94:95], v135 offset:33792
    s_add_u32 s26, s24, 0x0
    s_add_u32 m0, s29, 0x0
    s_nop 0
    buffer_load_dwordx4 v136, s[16:19], s26 offen lds
    s_waitcnt lgkmcnt(12)
    v_mfma_f32_16x16x32_bf16 v[8:11], v[68:71], a[16:19], v[8:11]
    ds_read_b64_tr_b16 v[96:97], v128 offset:40960
    v_mfma_f32_16x16x32_bf16 v[12:15], v[68:71], a[80:83], v[12:15]
    ds_read_b64_tr_b16 v[98:99], v128 offset:41984
    s_add_u32 s26, s24, 0x20000
    s_add_u32 m0, s29, 0x1000
    s_nop 0
    buffer_load_dwordx4 v136, s[16:19], s26 offen lds
    s_waitcnt lgkmcnt(12)
    v_mfma_f32_16x16x32_bf16 v[16:19], v[72:75], a[16:19], v[16:19]
    ds_read_b64_tr_b16 v[100:101], v129 offset:40960
    v_mfma_f32_16x16x32_bf16 v[20:23], v[72:75], a[80:83], v[20:23]
    ds_read_b64_tr_b16 v[102:103], v129 offset:41984
    s_add_u32 s26, s24, 0x40000
    s_add_u32 m0, s29, 0x2000
    s_nop 0
    buffer_load_dwordx4 v136, s[16:19], s26 offen lds
    s_waitcnt lgkmcnt(12)
    v_mfma_f32_16x16x32_bf16 v[24:27], v[76:79], a[16:19], v[24:27]
    ds_read_b64_tr_b16 v[104:105], v130 offset:40960
    v_mfma_f32_16x16x32_bf16 v[28:31], v[76:79], a[80:83], v[28:31]
    ds_read_b64_tr_b16 v[106:107], v130 offset:41984
    s_add_u32 s26, s24, 0x60000
    s_add_u32 m0, s29, 0x3000
    s_nop 0
    buffer_load_dwordx4 v136, s[16:19], s26 offen lds
    s_waitcnt lgkmcnt(12)
    v_mfma_f32_16x16x32_bf16 v[32:35], v[80:83], a[16:19], v[32:35]
    ds_read_b64_tr_b16 v[108:109], v131 offset:40960
    v_mfma_f32_16x16x32_bf16 v[36:39], v[80:83], a[80:83], v[36:39]
    ds_read_b64_tr_b16 v[110:111], v131 offset:41984
    s_add_u32 s26, s24, 0x80000
    s_add_u32 m0, s29, 0x4000
    s_nop 0
    buffer_load_dwordx4 v136, s[16:19], s26 offen lds
    s_waitcnt lgkmcnt(12)
    v_mfma_f32_16x16x32_bf16 v[40:43], v[84:87], a[16:19], v[40:43]
    ds_read_b64_tr_b16 v[112:113], v132 offset:40960
    v_mfma_f32_16x16x32_bf16 v[44:47], v[84:87], a[80:83], v[44:47]
    ds_read_b64_tr_b16 v[114:115], v132 offset:41984
    s_add_u32 s26, s24, 0xa0000
    s_add_u32 m0, s29, 0x5000
    s_nop 0
    buffer_load_dwordx4 v136, s[16:19], s26 offen lds
    s_waitcnt lgkmcnt(12)
    v_mfma_f32_16x16x32_bf16 v[48:51], v[88:91], a[16:19], v[48:51]
    ds_read_b64_tr_b16 v[116:117], v133 offset:40960
    v_mfma_f32_16x16x32_bf16 v[52:55], v[88:91], a[80:83], v[52:55]
    ds_read_b64_tr_b16 v[118:119], v133 offset:41984
    s_add_u32 s26, s24, 0xc0000
    s_add_u32 m0, s29, 0x6000
    s_nop 0
    buffer_load_dwordx4 v136, s[16:19], s26 offen lds
    s_waitcnt lgkmcnt(12)
    v_mfma_f32_16x16x32_bf16 v[56:59], v[92:95], a[16:19], v[56:59]
    ds_read_b64_tr_b16 v[120:121], v134 offset:40960
    v_mfma_f32_16x16x32_bf16 v[60:63], v[92:95], a[80:83], v[60:63]
    ds_read_b64_tr_b16 v[122:123], v134 offset:41984
    s_add_u32 s26, s24, 0xe0000
    s_add_u32 m0, s29, 0x7000
    s_nop 0
    buffer_load_dwordx4 v136, s[16:19], s26 offen lds
    s_waitcnt lgkmcnt(12)
    v_mfma_f32_16x16x32_bf16 v[0:3], v[96:99], a[20:23], v[0:3]
    ds_read_b64_tr_b16 v[124:125], v135 offset:40960
    v_mfma_f32_16x16x32_bf16 v[4:7], v[96:99], a[84:87], v[4:7]
    ds_read_b64_tr_b16 v[126:127], v135 offset:41984
    s_waitcnt lgkmcnt(12)
    v_mfma_f32_16x16x32_bf16 v[8:11], v[100:103], a[20:23], v[8:11]
    ds_read_b64_tr_b16 v[64:65], v128 offset:49152
    v_mfma_f32_16x16x32_bf16 v[12:15], v[100:103], a[84:87], v[12:15]
    ds_read_b64_tr_b16 v[66:67], v128 offset:50176
    s_waitcnt lgkmcnt(12)
    v_mfma_f32_16x16x32_bf16 v[16:19], v[104:107], a[20:23], v[16:19]
    ds_read_b64_tr_b16 v[68:69], v129 offset:49152
    v_mfma_f32_16x16x32_bf16 v[20:23], v[104:107], a[84:87], v[20:23]
    ds_read_b64_tr_b16 v[70:71], v129 offset:50176
    s_waitcnt lgkmcnt(12)
    v_mfma_f32_16x16x32_bf16 v[24:27], v[108:111], a[20:23], v[24:27]
    ds_read_b64_tr_b16 v[72:73], v130 offset:49152
    v_mfma_f32_16x16x32_bf16 v[28:31], v[108:111], a[84:87], v[28:31]
    ds_read_b64_tr_b16 v[74:75], v130 offset:50176
    s_waitcnt lgkmcnt(12)
    v_mfma_f32_16x16x32_bf16 v[32:35], v[112:115], a[20:23], v[32:35]
    ds_read_b64_tr_b16 v[76:77], v131 offset:49152
    v_mfma_f32_16x16x32_bf16 v[36:39], v[112:115], a[84:87], v[36:39]
    ds_read_b64_tr_b16 v[78:79], v131 offset:50176
    s_waitcnt lgkmcnt(12)
    v_mfma_f32_16x16x32_bf16 v[40:43], v[116:119], a[20:23], v[40:43]
    ds_read_b64_tr_b16 v[80:81], v132 offset:49152
    v_mfma_f32_16x16x32_bf16 v[44:47], v[116:119], a[84:87], v[44:47]
    ds_read_b64_tr_b16 v[82:83], v132 offset:50176
    s_waitcnt lgkmcnt(12)
    v_mfma_f32_16x16x32_bf16 v[48:51], v[120:123], a[20:23], v[48:51]
    ds_read_b64_tr_b16 v[84:85], v133 offset:49152
    v_mfma_f32_16x16x32_bf16 v[52:55], v[120:123], a[84:87], v[52:55]
    ds_read_b64_tr_b16 v[86:87], v133 offset:50176
    s_waitcnt lgkmcnt(12)
    v_mfma_f32_16x16x32_bf16 v[56:59], v[124:127], a[20:23], v[56:59]
    ds_read_b64_tr_b16 v[88:89], v134 offset:49152
    v_mfma_f32_16x16x32_bf16 v[60:63], v[124:127], a[84:87], v[60:63]
    ds_read_b64_tr_b16 v[90:91], v134 offset:50176
    s_waitcnt lgkmcnt(12)
    v_mfma_f32_16x16x32_bf16 v[0:3], v[64:67], a[24:27], v[0:3]
    ds_read_b64_tr_b16 v[92:93], v135 offset:49152
    v_mfma_f32_16x16x32_bf16 v[4:7], v[64:67], a[88:91], v[4:7]
    ds_read_b64_tr_b16 v[94:95], v135 offset:50176
    s_waitcnt lgkmcnt(12)
    v_mfma_f32_16x16x32_bf16 v[8:11], v[68:71], a[24:27], v[8:11]
    ds_read_b64_tr_b16 v[96:97], v128 offset:57344
    v_mfma_f32_16x16x32_bf16 v[12:15], v[68:71], a[88:91], v[12:15]
    ds_read_b64_tr_b16 v[98:99], v128 offset:58368
    s_waitcnt lgkmcnt(12)
    v_mfma_f32_16x16x32_bf16 v[16:19], v[72:75], a[24:27], v[16:19]
    ds_read_b64_tr_b16 v[100:101], v129 offset:57344
    v_mfma_f32_16x16x32_bf16 v[20:23], v[72:75], a[88:91], v[20:23]
    ds_read_b64_tr_b16 v[102:103], v129 offset:58368
    s_waitcnt lgkmcnt(12)
    v_mfma_f32_16x16x32_bf16 v[24:27], v[76:79], a[24:27], v[24:27]
    ds_read_b64_tr_b16 v[104:105], v130 offset:57344
    v_mfma_f32_16x16x32_bf16 v[28:31], v[76:79], a[88:91], v[28:31]
    ds_read_b64_tr_b16 v[106:107], v130 offset:58368
    s_waitcnt lgkmcnt(12)
    v_mfma_f32_16x16x32_bf16 v[32:35], v[80:83], a[24:27], v[32:35]
    ds_read_b64_tr_b16 v[108:109], v131 offset:57344
    v_mfma_f32_16x16x32_bf16 v[36:39], v[80:83], a[88:91], v[36:39]
    ds_read_b64_tr_b16 v[110:111], v131 offset:58368
    s_waitcnt lgkmcnt(12)
    v_mfma_f32_16x16x32_bf16 v[40:43], v[84:87], a[24:27], v[40:43]
    ds_read_b64_tr_b16 v[112:113], v132 offset:57344
    v_mfma_f32_16x16x32_bf16 v[44:47], v[84:87], a[88:91], v[44:47]
    ds_read_b64_tr_b16 v[114:115], v132 offset:58368
    s_waitcnt lgkmcnt(12)
    v_mfma_f32_16x16x32_bf16 v[48:51], v[88:91], a[24:27], v[48:51]
    ds_read_b64_tr_b16 v[116:117], v133 offset:57344
    v_mfma_f32_16x16x32_bf16 v[52:55], v[88:91], a[88:91], v[52:55]
    ds_read_b64_tr_b16 v[118:119], v133 offset:58368
    s_waitcnt lgkmcnt(12)
    v_mfma_f32_16x16x32_bf16 v[56:59], v[92:95], a[24:27], v[56:59]
    ds_read_b64_tr_b16 v[120:121], v134 offset:57344
    v_mfma_f32_16x16x32_bf16 v[60:63], v[92:95], a[88:91], v[60:63]
    ds_read_b64_tr_b16 v[122:123], v134 offset:58368
    s_waitcnt lgkmcnt(12)
    v_mfma_f32_16x16x32_bf16 v[0:3], v[96:99], a[28:31], v[0:3]
    ds_read_b64_tr_b16 v[124:125], v135 offset:57344
    v_mfma_f32_16x16x32_bf16 v[4:7], v[96:99], a[92:95], v[4:7]
    ds_read_b64_tr_b16 v[126:127], v135 offset:58368
    s_waitcnt lgkmcnt(12)
    v_mfma_f32_16x16x32_bf16 v[8:11], v[100:103], a[28:31], v[8:11]
    v_mfma_f32_16x16x32_bf16 v[12:15], v[100:103], a[92:95], v[12:15]
    s_waitcnt lgkmcnt(10)
    v_mfma_f32_16x16x32_bf16 v[16:19], v[104:107], a[28:31], v[16:19]
    v_mfma_f32_16x16x32_bf16 v[20:23], v[104:107], a[92:95], v[20:23]
    s_waitcnt lgkmcnt(8)
    v_mfma_f32_16x16x32_bf16 v[24:27], v[108:111], a[28:31], v[24:27]
    v_mfma_f32_16x16x32_bf16 v[28:31], v[108:111], a[92:95], v[28:31]
    s_waitcnt lgkmcnt(6)
    v_mfma_f32_16x16x32_bf16 v[32:35], v[112:115], a[28:31], v[32:35]
    v_mfma_f32_16x16x32_bf16 v[36:39], v[112:115], a[92:95], v[36:39]
    s_waitcnt lgkmcnt(4)
    v_mfma_f32_16x16x32_bf16 v[40:43], v[116:119], a[28:31], v[40:43]
    v_mfma_f32_16x16x32_bf16 v[44:47], v[116:119], a[92:95], v[44:47]
    s_waitcnt lgkmcnt(2)
    v_mfma_f32_16x16x32_bf16 v[48:51], v[120:123], a[28:31], v[48:51]
    v_mfma_f32_16x16x32_bf16 v[52:55], v[120:123], a[92:95], v[52:55]
    s_waitcnt lgkmcnt(0)
    v_mfma_f32_16x16x32_bf16 v[56:59], v[124:127], a[28:31], v[56:59]
    v_mfma_f32_16x16x32_bf16 v[60:63], v[124:127], a[92:95], v[60:63]
    v_xor_b32 v128, 0x10000, v128
    v_xor_b32 v129, 0x10000, v129
    v_xor_b32 v130, 0x10000, v130
    v_xor_b32 v131, 0x10000, v131
    v_xor_b32 v132, 0x10000, v132
    v_xor_b32 v133, 0x10000, v133
    v_xor_b32 v134, 0x10000, v134
    v_xor_b32 v135, 0x10000, v135
    s_waitcnt vmcnt(16)
    s_barrier
    ds_read_b64_tr_b16 v[64:65], v128
    ds_read_b64_tr_b16 v[66:67], v128 offset:1024
    ds_read_b64_tr_b16 v[68:69], v129
    ds_read_b64_tr_b16 v[70:71], v129 offset:1024
    ds_read_b64_tr_b16 v[72:73], v130
    ds_read_b64_tr_b16 v[74:75], v130 offset:1024
    ds_read_b64_tr_b16 v[76:77], v131
    ds_read_b64_tr_b16 v[78:79], v131 offset:1024
    ds_read_b64_tr_b16 v[80:81], v132
    ds_read_b64_tr_b16 v[82:83], v132 offset:1024
    ds_read_b64_tr_b16 v[84:85], v133
    ds_read_b64_tr_b16 v[86:87], v133 offset:1024
    ds_read_b64_tr_b16 v[88:89], v134
    ds_read_b64_tr_b16 v[90:91], v134 offset:1024
    s_cmp_eq_u32 s40, 0
    s_cbranch_scc1 L_nopf_90
    s_cmp_lg_u32 s87, 0
    s_cbranch_scc1 L_modeok_91
    v_readfirstlane_b32 s96, v140
    v_readfirstlane_b32 s97, v141
    s_nop 0
    s_cmp_lg_u32 s97, 0
    s_cselect_b32 s87, s96, 0
    s_cmp_eq_u32 s87, 1
    s_cbranch_scc1 L_modeok_91
    s_mov_b32 s96, 0
L_mode_92:
    buffer_load_dwordx2 v[140:141], off, s[92:95], 0 offset:36 sc1
    s_waitcnt vmcnt(0)
    v_readfirstlane_b32 s87, v140
    v_readfirstlane_b32 s97, v141
    s_nop 0
    s_min_u32 s97, s97, s87
    s_cmp_lg_u32 s97, 0
    s_cbranch_scc1 L_moded_93
    s_sleep 4
    s_add_u32 s96, s96, 1
    s_cmp_lg_u32 s96, 0x100
    s_cbranch_scc1 L_modef_94
    v_mov_b32 v140, 2
    v_mov_b32 v141, 0
    s_mov_b64 exec, 1
    buffer_atomic_cmpswap v[140:141], off, s[92:95], 0 offset:36
    s_mov_b64 exec, -1
L_modef_94:
    s_cmp_lt_u32 s96, 0x10000
    s_cbranch_scc1 L_mode_92
L_moded_93:
    s_cmp_lg_u32 s87, 1
    s_cbranch_scc1 L_fallback
L_modeok_91:
    s_cmp_lg_u32 s100, 0
    s_cbranch_scc1 L_flag_95
    v_mov_b32 v138, 1
    s_mov_b64 exec, 1
    buffer_store_dword v138, off, s[8:11], s40 sc1
    s_mov_b64 exec, -1
L_flag_95:
    s_mov_b32 s40, 0
L_nopf_90:
    s_waitcnt lgkmcnt(12)
    v_mfma_f32_16x16x32_bf16 v[0:3], v[64:67], a[32:35], v[0:3]
    ds_read_b64_tr_b16 v[92:93], v135
    v_mfma_f32_16x16x32_bf16 v[4:7], v[64:67], a[96:99], v[4:7]
    ds_read_b64_tr_b16 v[94:95], v135 offset:1024
    s_add_u32 s26, s24, 0x100000
    s_add_u32 m0, s29, 0x8000
    s_nop 0
    buffer_load_dwordx4 v136, s[16:19], s26 offen lds
    s_waitcnt lgkmcnt(12)
    v_mfma_f32_16x16x32_bf16 v[8:11], v[68:71], a[32:35], v[8:11]
    ds_read_b64_tr_b16 v[96:97], v128 offset:8192
    v_mfma_f32_16x16x32_bf16 v[12:15], v[68:71], a[96:99], v[12:15]
    ds_read_b64_tr_b16 v[98:99], v128 offset:9216
    s_add_u32 s26, s24, 0x120000
    s_add_u32 m0, s29, 0x9000
    s_nop 0
    buffer_load_dwordx4 v136, s[16:19], s26 offen lds
    s_waitcnt lgkmcnt(12)
    v_mfma_f32_16x16x32_bf16 v[16:19], v[72:75], a[32:35], v[16:19]
    ds_read_b64_tr_b16 v[100:101], v129 offset:8192
    v_mfma_f32_16x16x32_bf16 v[20:23], v[72:75], a[96:99], v[20:23]
    ds_read_b64_tr_b16 v[102:103], v129 offset:9216
    s_add_u32 s26, s24, 0x140000
    s_add_u32 m0, s29, 0xa000
    s_nop 0
    buffer_load_dwordx4 v136, s[16:19], s26 offen lds
    s_waitcnt lgkmcnt(12)
    v_mfma_f32_16x16x32_bf16 v[24:27], v[76:79], a[32:35], v[24:27]
    ds_read_b64_tr_b16 v[104:105], v130 offset:8192
    v_mfma_f32_16x16x32_bf16 v[28:31], v[76:79], a[96:99], v[28:31]
    ds_read_b64_tr_b16 v[106:107], v130 offset:9216
    s_add_u32 s26, s24, 0x160000
    s_add_u32 m0, s29, 0xb000
    s_nop 0
    buffer_load_dwordx4 v136, s[16:19], s26 offen lds
    s_waitcnt lgkmcnt(12)
    v_mfma_f32_16x16x32_bf16 v[32:35], v[80:83], a[32:35], v[32:35]
    ds_read_b64_tr_b16 v[108:109], v131 offset:8192
    v_mfma_f32_16x16x32_bf16 v[36:39], v[80:83], a[96:99], v[36:39]
    ds_read_b64_tr_b16 v[110:111], v131 offset:9216
    s_add_u32 s26, s24, 0x180000
    s_add_u32 m0, s29, 0xc000
    s_nop 0
    buffer_load_dwordx4 v136, s[16:19], s26 offen lds
    s_waitcnt lgkmcnt(12)
    v_mfma_f32_16x16x32_bf16 v[40:43], v[84:87], a[32:35], v[40:43]
    ds_read_b64_tr_b16 v[112:113], v132 offset:8192
    v_mfma_f32_16x16x32_bf16 v[44:47], v[84:87], a[96:99], v[44:47]
    ds_read_b64_tr_b16 v[114:115], v132 offset:9216
    s_add_u32 s26, s24, 0x1a0000
    s_add_u32 m0, s29, 0xd000
    s_nop 0
    buffer_load_dwordx4 v136, s[16:19], s26 offen lds
    s_waitcnt lgkmcnt(12)
    v_mfma_f32_16x16x32_bf16 v[48:51], v[88:91], a[32:35], v[48:51]
    ds_read_b64_tr_b16 v[116:117], v133 offset:8192
    v_mfma_f32_16x16x32_bf16 v[52:55], v[88:91], a[96:99], v[52:55]
    ds_read_b64_tr_b16 v[118:119], v133 offset:9216
    s_add_u32 s26, s24, 0x1c0000
    s_add_u32 m0, s29, 0xe000
    s_nop 0
    buffer_load_dwordx4 v136, s[16:19], s26 offen lds
    s_waitcnt lgkmcnt(12)
    v_mfma_f32_16x16x32_bf16 v[56:59], v[92:95], a[32:35], v[56:59]
    ds_read_b64_tr_b16 v[120:121], v134 offset:8192
    v_mfma_f32_16x16x32_bf16 v[60:63], v[92:95], a[96:99], v[60:63]
    ds_read_b64_tr_b16 v[122:123], v134 offset:9216
    s_add_u32 s26, s24, 0x1e0000
    s_add_u32 m0, s29, 0xf000
    s_nop 0
    buffer_load_dwordx4 v136, s[16:19], s26 offen lds
    s_waitcnt lgkmcnt(12)
    v_mfma_f32_16x16x32_bf16 v[0:3], v[96:99], a[36:39], v[0:3]
    ds_read_b64_tr_b16 v[124:125], v135 offset:8192
    v_mfma_f32_16x16x32_bf16 v[4:7], v[96:99], a[100:103], v[4:7]
    ds_read_b64_tr_b16 v[126:127], v135 offset:9216
    s_waitcnt lgkmcnt(12)
    v_mfma_f32_16x16x32_bf16 v[8:11], v[100:103], a[36:39], v[8:11]
    ds_read_b64_tr_b16 v[64:65], v128 offset:16384
    v_mfma_f32_16x16x32_bf16 v[12:15], v[100:103], a[100:103], v[12:15]
    ds_read_b64_tr_b16 v[66:67], v128 offset:17408
    s_waitcnt lgkmcnt(12)
    v_mfma_f32_16x16x32_bf16 v[16:19], v[104:107], a[36:39], v[16:19]
    ds_read_b64_tr_b16 v[68:69], v129 offset:16384
    v_mfma_f32_16x16x32_bf16 v[20:23], v[104:107], a[100:103], v[20:23]
    ds_read_b64_tr_b16 v[70:71], v129 offset:17408
    s_waitcnt lgkmcnt(12)
    v_mfma_f32_16x16x32_bf16 v[24:27], v[108:111], a[36:39], v[24:27]
    ds_read_b64_tr_b16 v[72:73], v130 offset:16384
    v_mfma_f32_16x16x32_bf16 v[28:31], v[108:111], a[100:103], v[28:31]
    ds_read_b64_tr_b16 v[74:75], v130 offset:17408
    s_waitcnt lgkmcnt(12)
    v_mfma_f32_16x16x32_bf16 v[32:35], v[112:115], a[36:39], v[32:35]
    ds_read_b64_tr_b16 v[76:77], v131 offset:16384
    v_mfma_f32_16x16x32_bf16 v[36:39], v[112:115], a[100:103], v[36:39]
    ds_read_b64_tr_b16 v[78:79], v131 offset:17408
    s_waitcnt lgkmcnt(12)
    v_mfma_f32_16x16x32_bf16 v[40:43], v[116:119], a[36:39], v[40:43]
    ds_read_b64_tr_b16 v[80:81], v132 offset:16384
    v_mfma_f32_16x16x32_bf16 v[44:47], v[116:119], a[100:103], v[44:47]
    ds_read_b64_tr_b16 v[82:83], v132 offset:17408
    s_waitcnt lgkmcnt(12)
    v_mfma_f32_16x16x32_bf16 v[48:51], v[120:123], a[36:39], v[48:51]
    ds_read_b64_tr_b16 v[84:85], v133 offset:16384
    v_mfma_f32_16x16x32_bf16 v[52:55], v[120:123], a[100:103], v[52:55]
    ds_read_b64_tr_b16 v[86:87], v133 offset:17408
    s_waitcnt lgkmcnt(12)
    v_mfma_f32_16x16x32_bf16 v[56:59], v[124:127], a[36:39], v[56:59]
    ds_read_b64_tr_b16 v[88:89], v134 offset:16384
    v_mfma_f32_16x16x32_bf16 v[60:63], v[124:127], a[100:103], v[60:63]
    ds_read_b64_tr_b16 v[90:91], v134 offset:17408
    s_waitcnt lgkmcnt(12)
    v_mfma_f32_16x16x32_bf16 v[0:3], v[64:67], a[40:43], v[0:3]
    ds_read_b64_tr_b16 v[92:93], v135 offset:16384
    v_mfma_f32_16x16x32_bf16 v[4:7], v[64:67], a[104:107], v[4:7]
    ds_read_b64_tr_b16 v[94:95], v135 offset:17408
    s_waitcnt lgkmcnt(12)
    v_mfma_f32_16x16x32_bf16 v[8:11], v[68:71], a[40:43], v[8:11]
    ds_read_b64_tr_b16 v[96:97], v128 offset:24576
    v_mfma_f32_16x16x32_bf16 v[12:15], v[68:71], a[104:107], v[12:15]
    ds_read_b64_tr_b16 v[98:99], v128 offset:25600
    s_waitcnt lgkmcnt(12)
    v_mfma_f32_16x16x32_bf16 v[16:19], v[72:75], a[40:43], v[16:19]
    ds_read_b64_tr_b16 v[100:101], v129 offset:24576
    v_mfma_f32_16x16x32_bf16 v[20:23], v[72:75], a[104:107], v[20:23]
    ds_read_b64_tr_b16 v[102:103], v129 offset:25600
    s_waitcnt lgkmcnt(12)
    v_mfma_f32_16x16x32_bf16 v[24:27], v[76:79], a[40:43], v[24:27]
    ds_read_b64_tr_b16 v[104:105], v130 offset:24576
    v_mfma_f32_16x16x32_bf16 v[28:31], v[76:79], a[104:107], v[28:31]
    ds_read_b64_tr_b16 v[106:107], v130 offset:25600
    s_waitcnt lgkmcnt(12)
    v_mfma_f32_16x16x32_bf16 v[32:35], v[80:83], a[40:43], v[32:35]
    ds_read_b64_tr_b16 v[108:109], v131 offset:24576
    v_mfma_f32_16x16x32_bf16 v[36:39], v[80:83], a[104:107], v[36:39]
    ds_read_b64_tr_b16 v[110:111], v131 offset:25600
    s_waitcnt lgkmcnt(12)
    v_mfma_f32_16x16x32_bf16 v[40:43], v[84:87], a[40:43], v[40:43]
    ds_read_b64_tr_b16 v[112:113], v132 offset:24576
    v_mfma_f32_16x16x32_bf16 v[44:47], v[84:87], a[104:107], v[44:47]
    ds_read_b64_tr_b16 v[114:115], v132 offset:25600
    s_waitcnt lgkmcnt(12)
    v_mfma_f32_16x16x32_bf16 v[48:51], v[88:91], a[40:43], v[48:51]
    ds_read_b64_tr_b16 v[116:117], v133 offset:24576
    v_mfma_f32_16x16x32_bf16 v[52:55], v[88:91], a[104:107], v[52:55]
    ds_read_b64_tr_b16 v[118:119], v133 offset:25600
    s_waitcnt lgkmcnt(12)
    v_mfma_f32_16x16x32_bf16 v[56:59], v[92:95], a[40:43], v[56:59]
    ds_read_b64_tr_b16 v[120:121], v134 offset:24576
    v_mfma_f32_16x16x32_bf16 v[60:63], v[92:95], a[104:107], v[60:63]
    ds_read_b64_tr_b16 v[122:123], v134 offset:25600
    s_waitcnt lgkmcnt(12)
    v_mfma_f32_16x16x32_bf16 v[0:3], v[96:99], a[44:47], v[0:3]
    ds_read_b64_tr_b16 v[124:125], v135 offset:24576
    v_mfma_f32_16x16x32_bf16 v[4:7], v[96:99], a[108:111], v[4:7]
    ds_read_b64_tr_b16 v[126:127], v135 offset:25600
    s_waitcnt lgkmcnt(12)
    v_mfma_f32_16x16x32_bf16 v[8:11], v[100:103], a[44:47], v[8:11]
    v_mfma_f32_16x16x32_bf16 v[12:15], v[100:103], a[108:111], v[12:15]
    s_waitcnt lgkmcnt(10)
    v_mfma_f32_16x16x32_bf16 v[16:19], v[104:107], a[44:47], v[16:19]
    v_mfma_f32_16x16x32_bf16 v[20:23], v[104:107], a[108:111], v[20:23]
    s_waitcnt lgkmcnt(8)
    v_mfma_f32_16x16x32_bf16 v[24:27], v[108:111], a[44:47], v[24:27]
    v_mfma_f32_16x16x32_bf16 v[28:31], v[108:111], a[108:111], v[28:31]
    s_waitcnt lgkmcnt(6)
    v_mfma_f32_16x16x32_bf16 v[32:35], v[112:115], a[44:47], v[32:35]
    v_mfma_f32_16x16x32_bf16 v[36:39], v[112:115], a[108:111], v[36:39]
    s_waitcnt lgkmcnt(4)
    v_mfma_f32_16x16x32_bf16 v[40:43], v[116:119], a[44:47], v[40:43]
    v_mfma_f32_16x16x32_bf16 v[44:47], v[116:119], a[108:111], v[44:47]
    s_waitcnt lgkmcnt(2)
    v_mfma_f32_16x16x32_bf16 v[48:51], v[120:123], a[44:47], v[48:51]
    v_mfma_f32_16x16x32_bf16 v[52:55], v[120:123], a[108:111], v[52:55]
    s_waitcnt lgkmcnt(0)
    v_mfma_f32_16x16x32_bf16 v[56:59], v[124:127], a[44:47], v[56:59]
    v_mfma_f32_16x16x32_bf16 v[60:63], v[124:127], a[108:111], v[60:63]
    s_waitcnt vmcnt(16)
    s_barrier
    ds_read_b64_tr_b16 v[64:65], v128 offset:32768
    ds_read_b64_tr_b16 v[66:67], v128 offset:33792
    ds_read_b64_tr_b16 v[68:69], v129 offset:32768
    ds_read_b64_tr_b16 v[70:71], v129 offset:33792
    ds_read_b64_tr_b16 v[72:73], v130 offset:32768
    ds_read_b64_tr_b16 v[74:75], v130 offset:33792
    ds_read_b64_tr_b16 v[76:77], v131 offset:32768
    ds_read_b64_tr_b16 v[78:79], v131 offset:33792
    ds_read_b64_tr_b16 v[80:81], v132 offset:32768
    ds_read_b64_tr_b16 v[82:83], v132 offset:33792
    ds_read_b64_tr_b16 v[84:85], v133 offset:32768
    ds_read_b64_tr_b16 v[86:87], v133 offset:33792
    ds_read_b64_tr_b16 v[88:89], v134 offset:32768
    ds_read_b64_tr_b16 v[90:91], v134 offset:33792
    s_waitcnt lgkmcnt(12)
    v_mfma_f32_16x16x32_bf16 v[0:3], v[64:67], a[48:51], v[0:3]
    ds_read_b64_tr_b16 v[92:93], v135 offset:32768
    v_mfma_f32_16x16x32_bf16 v[4:7], v[64:67], a[112:115], v[4:7]
    ds_read_b64_tr_b16 v[94:95], v135 offset:33792
    s_add_u32 s26, s24, 0x200000
    s_add_u32 m0, s29, 0x10000
    s_nop 0
    buffer_load_dwordx4 v136, s[16:19], s26 offen lds
    s_waitcnt lgkmcnt(12)
    v_mfma_f32_16x16x32_bf16 v[8:11], v[68:71], a[48:51], v[8:11]
    ds_read_b64_tr_b16 v[96:97], v128 offset:40960
    v_mfma_f32_16x16x32_bf16 v[12:15], v[68:71], a[112:115], v[12:15]
    ds_read_b64_tr_b16 v[98:99], v128 offset:41984
    s_add_u32 s26, s24, 0x220000
    s_add_u32 m0, s29, 0x11000
    s_nop 0
    buffer_load_dwordx4 v136, s[16:19], s26 offen lds
    s_waitcnt lgkmcnt(12)
    v_mfma_f32_16x16x32_bf16 v[16:19], v[72:75], a[48:51], v[16:19]
    ds_read_b64_tr_b16 v[100:101], v129 offset:40960
    v_mfma_f32_16x16x32_bf16 v[20:23], v[72:75], a[112:115], v[20:23]
    ds_read_b64_tr_b16 v[102:103], v129 offset:41984
    s_add_u32 s26, s24, 0x240000
    s_add_u32 m0, s29, 0x12000
    s_nop 0
    buffer_load_dwordx4 v136, s[16:19], s26 offen lds
    s_waitcnt lgkmcnt(12)
    v_mfma_f32_16x16x32_bf16 v[24:27], v[76:79], a[48:51], v[24:27]
    ds_read_b64_tr_b16 v[104:105], v130 offset:40960
    v_mfma_f32_16x16x32_bf16 v[28:31], v[76:79], a[112:115], v[28:31]
    ds_read_b64_tr_b16 v[106:107], v130 offset:41984
    s_add_u32 s26, s24, 0x260000
    s_add_u32 m0, s29, 0x13000
    s_nop 0
    buffer_load_dwordx4 v136, s[16:19], s26 offen lds
    s_waitcnt lgkmcnt(12)
    v_mfma_f32_16x16x32_bf16 v[32:35], v[80:83], a[48:51], v[32:35]
    ds_read_b64_tr_b16 v[108:109], v131 offset:40960
    v_mfma_f32_16x16x32_bf16 v[36:39], v[80:83], a[112:115], v[36:39]
    ds_read_b64_tr_b16 v[110:111], v131 offset:41984
    s_add_u32 s26, s24, 0x280000
    s_add_u32 m0, s29, 0x14000
    s_nop 0
    buffer_load_dwordx4 v136, s[16:19], s26 offen lds
    s_waitcnt lgkmcnt(12)
    v_mfma_f32_16x16x32_bf16 v[40:43], v[84:87], a[48:51], v[40:43]
    ds_read_b64_tr_b16 v[112:113], v132 offset:40960
    v_mfma_f32_16x16x32_bf16 v[44:47], v[84:87], a[112:115], v[44:47]
    ds_read_b64_tr_b16 v[114:115], v132 offset:41984
    s_add_u32 s26, s24, 0x2a0000
    s_add_u32 m0, s29, 0x15000
    s_nop 0
    buffer_load_dwordx4 v136, s[16:19], s26 offen lds
    s_waitcnt lgkmcnt(12)
    v_mfma_f32_16x16x32_bf16 v[48:51], v[88:91], a[48:51], v[48:51]
    ds_read_b64_tr_b16 v[116:117], v133 offset:40960
    v_mfma_f32_16x16x32_bf16 v[52:55], v[88:91], a[112:115], v[52:55]
    ds_read_b64_tr_b16 v[118:119], v133 offset:41984
    s_add_u32 s26, s24, 0x2c0000
    s_add_u32 m0, s29, 0x16000
    s_nop 0
    buffer_load_dwordx4 v136, s[16:19], s26 offen lds
    s_waitcnt lgkmcnt(12)
    v_mfma_f32_16x16x32_bf16 v[56:59], v[92:95], a[48:51], v[56:59]
    ds_read_b64_tr_b16 v[120:121], v134 offset:40960
    v_mfma_f32_16x16x32_bf16 v[60:63], v[92:95], a[112:115], v[60:63]
    ds_read_b64_tr_b16 v[122:123], v134 offset:41984
    s_add_u32 s26, s24, 0x2e0000
    s_add_u32 m0, s29, 0x17000
    s_nop 0
    buffer_load_dwordx4 v136, s[16:19], s26 offen lds
    s_waitcnt lgkmcnt(12)
    v_mfma_f32_16x16x32_bf16 v[0:3], v[96:99], a[52:55], v[0:3]
    ds_read_b64_tr_b16 v[124:125], v135 offset:40960
    v_mfma_f32_16x16x32_bf16 v[4:7], v[96:99], a[116:119], v[4:7]
    ds_read_b64_tr_b16 v[126:127], v135 offset:41984
    s_waitcnt lgkmcnt(12)
    v_mfma_f32_16x16x32_bf16 v[8:11], v[100:103], a[52:55], v[8:11]
    ds_read_b64_tr_b16 v[64:65], v128 offset:49152
    v_mfma_f32_16x16x32_bf16 v[12:15], v[100:103], a[116:119], v[12:15]
    ds_read_b64_tr_b16 v[66:67], v128 offset:50176
    s_waitcnt lgkmcnt(12)
    v_mfma_f32_16x16x32_bf16 v[16:19], v[104:107], a[52:55], v[16:19]
    ds_read_b64_tr_b16 v[68:69], v129 offset:49152
    v_mfma_f32_16x16x32_bf16 v[20:23], v[104:107], a[116:119], v[20:23]
    ds_read_b64_tr_b16 v[70:71], v129 offset:50176
    s_waitcnt lgkmcnt(12)
    v_mfma_f32_16x16x32_bf16 v[24:27], v[108:111], a[52:55], v[24:27]
    ds_read_b64_tr_b16 v[72:73], v130 offset:49152
    v_mfma_f32_16x16x32_bf16 v[28:31], v[108:111], a[116:119], v[28:31]
    ds_read_b64_tr_b16 v[74:75], v130 offset:50176
    s_waitcnt lgkmcnt(12)
    v_mfma_f32_16x16x32_bf16 v[32:35], v[112:115], a[52:55], v[32:35]
    ds_read_b64_tr_b16 v[76:77], v131 offset:49152
    v_mfma_f32_16x16x32_bf16 v[36:39], v[112:115], a[116:119], v[36:39]
    ds_read_b64_tr_b16 v[78:79], v131 offset:50176
    s_waitcnt lgkmcnt(12)
    v_mfma_f32_16x16x32_bf16 v[40:43], v[116:119], a[52:55], v[40:43]
    ds_read_b64_tr_b16 v[80:81], v132 offset:49152
    v_mfma_f32_16x16x32_bf16 v[44:47], v[116:119], a[116:119], v[44:47]
    ds_read_b64_tr_b16 v[82:83], v132 offset:50176
    s_waitcnt lgkmcnt(12)
    v_mfma_f32_16x16x32_bf16 v[48:51], v[120:123], a[52:55], v[48:51]
    ds_read_b64_tr_b16 v[84:85], v133 offset:49152
    v_mfma_f32_16x16x32_bf16 v[52:55], v[120:123], a[116:119], v[52:55]
    ds_read_b64_tr_b16 v[86:87], v133 offset:50176
    s_waitcnt lgkmcnt(12)
    v_mfma_f32_16x16x32_bf16 v[56:59], v[124:127], a[52:55], v[56:59]
    ds_read_b64_tr_b16 v[88:89], v134 offset:49152
    v_mfma_f32_16x16x32_bf16 v[60:63], v[124:127], a[116:119], v[60:63]
    ds_read_b64_tr_b16 v[90:91], v134 offset:50176
    s_waitcnt lgkmcnt(12)
    v_mfma_f32_16x16x32_bf16 v[0:3], v[64:67], a[56:59], v[0:3]
    ds_read_b64_tr_b16 v[92:93], v135 offset:49152
    v_mfma_f32_16x16x32_bf16 v[4:7], v[64:67], a[120:123], v[4:7]
    ds_read_b64_tr_b16 v[94:95], v135 offset:50176
    s_waitcnt lgkmcnt(12)
    v_mfma_f32_16x16x32_bf16 v[8:11], v[68:71], a[56:59], v[8:11]
    ds_read_b64_tr_b16 v[96:97], v128 offset:57344
    v_mfma_f32_16x16x32_bf16 v[12:15], v[68:71], a[120:123], v[12:15]
    ds_read_b64_tr_b16 v[98:99], v128 offset:58368
    s_waitcnt lgkmcnt(12)
    v_mfma_f32_16x16x32_bf16 v[16:19], v[72:75], a[56:59], v[16:19]
    ds_read_b64_tr_b16 v[100:101], v129 offset:57344
    v_mfma_f32_16x16x32_bf16 v[20:23], v[72:75], a[120:123], v[20:23]
    ds_read_b64_tr_b16 v[102:103], v129 offset:58368
    s_waitcnt lgkmcnt(12)
    v_mfma_f32_16x16x32_bf16 v[24:27], v[76:79], a[56:59], v[24:27]
    ds_read_b64_tr_b16 v[104:105], v130 offset:57344
    v_mfma_f32_16x16x32_bf16 v[28:31], v[76:79], a[120:123], v[28:31]
    ds_read_b64_tr_b16 v[106:107], v130 offset:58368
    s_waitcnt lgkmcnt(12)
    v_mfma_f32_16x16x32_bf16 v[32:35], v[80:83], a[56:59], v[32:35]
    ds_read_b64_tr_b16 v[108:109], v131 offset:57344
    v_mfma_f32_16x16x32_bf16 v[36:39], v[80:83], a[120:123], v[36:39]
    ds_read_b64_tr_b16 v[110:111], v131 offset:58368
    s_waitcnt lgkmcnt(12)
    v_mfma_f32_16x16x32_bf16 v[40:43], v[84:87], a[56:59], v[40:43]
    ds_read_b64_tr_b16 v[112:113], v132 offset:57344
    v_mfma_f32_16x16x32_bf16 v[44:47], v[84:87], a[120:123], v[44:47]
    ds_read_b64_tr_b16 v[114:115], v132 offset:58368
    s_waitcnt lgkmcnt(12)
    v_mfma_f32_16x16x32_bf16 v[48:51], v[88:91], a[56:59], v[48:51]
    ds_read_b64_tr_b16 v[116:117], v133 offset:57344
    v_mfma_f32_16x16x32_bf16 v[52:55], v[88:91], a[120:123], v[52:55]
    ds_read_b64_tr_b16 v[118:119], v133 offset:58368
    s_waitcnt lgkmcnt(12)
    v_mfma_f32_16x16x32_bf16 v[56:59], v[92:95], a[56:59], v[56:59]
    ds_read_b64_tr_b16 v[120:121], v134 offset:57344
    v_mfma_f32_16x16x32_bf16 v[60:63], v[92:95], a[120:123], v[60:63]
    ds_read_b64_tr_b16 v[122:123], v134 offset:58368
    s_waitcnt lgkmcnt(12)
    v_mfma_f32_16x16x32_bf16 v[0:3], v[96:99], a[60:63], v[0:3]
    ds_read_b64_tr_b16 v[124:125], v135 offset:57344
    v_mfma_f32_16x16x32_bf16 v[4:7], v[96:99], a[124:127], v[4:7]
    ds_read_b64_tr_b16 v[126:127], v135 offset:58368
    s_waitcnt lgkmcnt(12)
    v_mfma_f32_16x16x32_bf16 v[8:11], v[100:103], a[60:63], v[8:11]
    v_mfma_f32_16x16x32_bf16 v[12:15], v[100:103], a[124:127], v[12:15]
    s_waitcnt lgkmcnt(10)
    v_mfma_f32_16x16x32_bf16 v[16:19], v[104:107], a[60:63], v[16:19]
    v_mfma_f32_16x16x32_bf16 v[20:23], v[104:107], a[124:127], v[20:23]
    s_waitcnt lgkmcnt(8)
    v_mfma_f32_16x16x32_bf16 v[24:27], v[108:111], a[60:63], v[24:27]
    v_mfma_f32_16x16x32_bf16 v[28:31], v[108:111], a[124:127], v[28:31]
    s_waitcnt lgkmcnt(6)
    v_mfma_f32_16x16x32_bf16 v[32:35], v[112:115], a[60:63], v[32:35]
    v_mfma_f32_16x16x32_bf16 v[36:39], v[112:115], a[124:127], v[36:39]
    s_waitcnt lgkmcnt(4)
    v_mfma_f32_16x16x32_bf16 v[40:43], v[116:119], a[60:63], v[40:43]
    v_mfma_f32_16x16x32_bf16 v[44:47], v[116:119], a[124:127], v[44:47]
    s_waitcnt lgkmcnt(2)
    v_mfma_f32_16x16x32_bf16 v[48:51], v[120:123], a[60:63], v[48:51]
    v_mfma_f32_16x16x32_bf16 v[52:55], v[120:123], a[124:127], v[52:55]
    s_waitcnt lgkmcnt(0)
    v_mfma_f32_16x16x32_bf16 v[56:59], v[124:127], a[60:63], v[56:59]
    v_mfma_f32_16x16x32_bf16 v[60:63], v[124:127], a[124:127], v[60:63]
    v_xor_b32 v128, 0x10000, v128
    v_xor_b32 v129, 0x10000, v129
    v_xor_b32 v130, 0x10000, v130
    v_xor_b32 v131, 0x10000, v131
    v_xor_b32 v132, 0x10000, v132
    v_xor_b32 v133, 0x10000, v133
    v_xor_b32 v134, 0x10000, v134
    v_xor_b32 v135, 0x10000, v135
    v_cvt_pk_bf16_f32 v144, v0, v8
    v_cvt_pk_bf16_f32 v145, v1, v9
    v_cvt_pk_bf16_f32 v146, v2, v10
    v_cvt_pk_bf16_f32 v147, v3, v11
    buffer_store_dwordx4 v[144:147], v137, s[8:11], s25 offen sc1
    v_cvt_pk_bf16_f32 v148, v16, v24
    v_cvt_pk_bf16_f32 v149, v17, v25
    v_cvt_pk_bf16_f32 v150, v18, v26
    v_cvt_pk_bf16_f32 v151, v19, v27
    buffer_store_dwordx4 v[148:151], v137, s[8:11], s25 offen offset:1024 sc1
    v_cvt_pk_bf16_f32 v152, v32, v40
    v_cvt_pk_bf16_f32 v153, v33, v41
    v_cvt_pk_bf16_f32 v154, v34, v42
    v_cvt_pk_bf16_f32 v155, v35, v43
    buffer_store_dwordx4 v[152:155], v137, s[8:11], s25 offen offset:2048 sc1
    v_cvt_pk_bf16_f32 v156, v48, v56
    v_cvt_pk_bf16_f32 v157, v49, v57
    v_cvt_pk_bf16_f32 v158, v50, v58
    v_cvt_pk_bf16_f32 v159, v51, v59
    buffer_store_dwordx4 v[156:159], v137, s[8:11], s25 offen offset:3072 sc1
    v_cvt_pk_bf16_f32 v144, v4, v12
    v_cvt_pk_bf16_f32 v145, v5, v13
    v_cvt_pk_bf16_f32 v146, v6, v14
    v_cvt_pk_bf16_f32 v147, v7, v15
    s_add_u32 s25, s25, 4096
    buffer_store_dwordx4 v[144:147], v137, s[8:11], s25 offen sc1
    v_cvt_pk_bf16_f32 v148, v20, v28
    v_cvt_pk_bf16_f32 v149, v21, v29
    v_cvt_pk_bf16_f32 v150, v22, v30
    v_cvt_pk_bf16_f32 v151, v23, v31
    buffer_store_dwordx4 v[148:151], v137, s[8:11], s25 offen offset:1024 sc1
    v_cvt_pk_bf16_f32 v152, v36, v44
    v_cvt_pk_bf16_f32 v153, v37, v45
    v_cvt_pk_bf16_f32 v154, v38, v46
    v_cvt_pk_bf16_f32 v155, v39, v47
    buffer_store_dwordx4 v[152:155], v137, s[8:11], s25 offen offset:2048 sc1
    v_cvt_pk_bf16_f32 v156, v52, v60
    v_cvt_pk_bf16_f32 v157, v53, v61
    v_cvt_pk_bf16_f32 v158, v54, v62
    v_cvt_pk_bf16_f32 v159, v55, v63
    buffer_store_dwordx4 v[156:159], v137, s[8:11], s25 offen offset:3072 sc1
    s_branch L_p1_next
L_p1_v:
    s_waitcnt vmcnt(16)
    s_barrier
    ds_read_b64_tr_b16 v[64:65], v128
    ds_read_b64_tr_b16 v[66:67], v128 offset:1024
    ds_read_b64_tr_b16 v[68:69], v129
    ds_read_b64_tr_b16 v[70:71], v129 offset:1024
    ds_read_b64_tr_b16 v[72:73], v130
    ds_read_b64_tr_b16 v[74:75], v130 offset:1024
    ds_read_b64_tr_b16 v[76:77], v131
    ds_read_b64_tr_b16 v[78:79], v131 offset:1024
    ds_read_b64_tr_b16 v[80:81], v132
    ds_read_b64_tr_b16 v[82:83], v132 offset:1024
    ds_read_b64_tr_b16 v[84:85], v133
    ds_read_b64_tr_b16 v[86:87], v133 offset:1024
    ds_read_b64_tr_b16 v[88:89], v134
    ds_read_b64_tr_b16 v[90:91], v134 offset:1024
    s_waitcnt lgkmcnt(12)
    v_mfma_f32_16x16x32_bf16 v[0:3], a[0:3], v[64:67], 0
    ds_read_b64_tr_b16 v[92:93], v135
    v_mfma_f32_16x16x32_bf16 v[4:7], a[64:67], v[64:67], 0
    ds_read_b64_tr_b16 v[94:95], v135 offset:1024
    s_add_u32 s26, s24, 0x300000
    s_add_u32 m0, s29, 0x18000
    s_nop 0
    buffer_load_dwordx4 v136, s[16:19], s26 offen lds
    s_waitcnt lgkmcnt(12)
    v_mfma_f32_16x16x32_bf16 v[8:11], a[0:3], v[68:71], 0
    ds_read_b64_tr_b16 v[96:97], v128 offset:8192
    v_mfma_f32_16x16x32_bf16 v[12:15], a[64:67], v[68:71], 0
    ds_read_b64_tr_b16 v[98:99], v128 offset:9216
    s_add_u32 s26, s24, 0x320000
    s_add_u32 m0, s29, 0x19000
    s_nop 0
    buffer_load_dwordx4 v136, s[16:19], s26 offen lds
    s_waitcnt lgkmcnt(12)
    v_mfma_f32_16x16x32_bf16 v[16:19], a[0:3], v[72:75], 0
    ds_read_b64_tr_b16 v[100:101], v129 offset:8192
    v_mfma_f32_16x16x32_bf16 v[20:23], a[64:67], v[72:75], 0
    ds_read_b64_tr_b16 v[102:103], v129 offset:9216
    s_add_u32 s26, s24, 0x340000
    s_add_u32 m0, s29, 0x1a000
    s_nop 0
    buffer_load_dwordx4 v136, s[16:19], s26 offen lds
    s_waitcnt lgkmcnt(12)
    v_mfma_f32_16x16x32_bf16 v[24:27], a[0:3], v[76:79], 0
    ds_read_b64_tr_b16 v[104:105], v130 offset:8192
    v_mfma_f32_16x16x32_bf16 v[28:31], a[64:67], v[76:79], 0
    ds_read_b64_tr_b16 v[106:107], v130 offset:9216
    s_add_u32 s26, s24, 0x360000
    s_add_u32 m0, s29, 0x1b000
    s_nop 0
    buffer_load_dwordx4 v136, s[16:19], s26 offen lds
    s_waitcnt lgkmcnt(12)
    v_mfma_f32_16x16x32_bf16 v[32:35], a[0:3], v[80:83], 0
    ds_read_b64_tr_b16 v[108:109], v131 offset:8192
    v_mfma_f32_16x16x32_bf16 v[36:39], a[64:67], v[80:83], 0
    ds_read_b64_tr_b16 v[110:111], v131 offset:9216
    s_add_u32 s26, s24, 0x380000
    s_add_u32 m0, s29, 0x1c000
    s_nop 0
    buffer_load_dwordx4 v136, s[16:19], s26 offen lds
    s_waitcnt lgkmcnt(12)
    v_mfma_f32_16x16x32_bf16 v[40:43], a[0:3], v[84:87], 0
    ds_read_b64_tr_b16 v[112:113], v132 offset:8192
    v_mfma_f32_16x16x32_bf16 v[44:47], a[64:67], v[84:87], 0
    ds_read_b64_tr_b16 v[114:115], v132 offset:9216
    s_add_u32 s26, s24, 0x3a0000
    s_add_u32 m0, s29, 0x1d000
    s_nop 0
    buffer_load_dwordx4 v136, s[16:19], s26 offen lds
    s_waitcnt lgkmcnt(12)
    v_mfma_f32_16x16x32_bf16 v[48:51], a[0:3], v[88:91], 0
    ds_read_b64_tr_b16 v[116:117], v133 offset:8192
    v_mfma_f32_16x16x32_bf16 v[52:55], a[64:67], v[88:91], 0
    ds_read_b64_tr_b16 v[118:119], v133 offset:9216
    s_add_u32 s26, s24, 0x3c0000
    s_add_u32 m0, s29, 0x1e000
    s_nop 0
    buffer_load_dwordx4 v136, s[16:19], s26 offen lds
    s_waitcnt lgkmcnt(12)
    v_mfma_f32_16x16x32_bf16 v[56:59], a[0:3], v[92:95], 0
    ds_read_b64_tr_b16 v[120:121], v134 offset:8192
    v_mfma_f32_16x16x32_bf16 v[60:63], a[64:67], v[92:95], 0
    ds_read_b64_tr_b16 v[122:123], v134 offset:9216
    s_add_u32 s26, s24, 0x3e0000
    s_add_u32 m0, s29, 0x1f000
    s_nop 0
    buffer_load_dwordx4 v136, s[16:19], s26 offen lds
    s_waitcnt lgkmcnt(12)
    v_mfma_f32_16x16x32_bf16 v[0:3], a[4:7], v[96:99], v[0:3]
    ds_read_b64_tr_b16 v[124:125], v135 offset:8192
    v_mfma_f32_16x16x32_bf16 v[4:7], a[68:71], v[96:99], v[4:7]
    ds_read_b64_tr_b16 v[126:127], v135 offset:9216
    s_waitcnt lgkmcnt(12)
    v_mfma_f32_16x16x32_bf16 v[8:11], a[4:7], v[100:103], v[8:11]
    ds_read_b64_tr_b16 v[64:65], v128 offset:16384
    v_mfma_f32_16x16x32_bf16 v[12:15], a[68:71], v[100:103], v[12:15]
    ds_read_b64_tr_b16 v[66:67], v128 offset:17408
    s_waitcnt lgkmcnt(12)
    v_mfma_f32_16x16x32_bf16 v[16:19], a[4:7], v[104:107], v[16:19]
    ds_read_b64_tr_b16 v[68:69], v129 offset:16384
    v_mfma_f32_16x16x32_bf16 v[20:23], a[68:71], v[104:107], v[20:23]
    ds_read_b64_tr_b16 v[70:71], v129 offset:17408
    s_waitcnt lgkmcnt(12)
    v_mfma_f32_16x16x32_bf16 v[24:27], a[4:7], v[108:111], v[24:27]
    ds_read_b64_tr_b16 v[72:73], v130 offset:16384
    v_mfma_f32_16x16x32_bf16 v[28:31], a[68:71], v[108:111], v[28:31]
    ds_read_b64_tr_b16 v[74:75], v130 offset:17408
    s_waitcnt lgkmcnt(12)
    v_mfma_f32_16x16x32_bf16 v[32:35], a[4:7], v[112:115], v[32:35]
    ds_read_b64_tr_b16 v[76:77], v131 offset:16384
    v_mfma_f32_16x16x32_bf16 v[36:39], a[68:71], v[112:115], v[36:39]
    ds_read_b64_tr_b16 v[78:79], v131 offset:17408
    s_waitcnt lgkmcnt(12)
    v_mfma_f32_16x16x32_bf16 v[40:43], a[4:7], v[116:119], v[40:43]
    ds_read_b64_tr_b16 v[80:81], v132 offset:16384
    v_mfma_f32_16x16x32_bf16 v[44:47], a[68:71], v[116:119], v[44:47]
    ds_read_b64_tr_b16 v[82:83], v132 offset:17408
    s_waitcnt lgkmcnt(12)
    v_mfma_f32_16x16x32_bf16 v[48:51], a[4:7], v[120:123], v[48:51]
    ds_read_b64_tr_b16 v[84:85], v133 offset:16384
    v_mfma_f32_16x16x32_bf16 v[52:55], a[68:71], v[120:123], v[52:55]
    ds_read_b64_tr_b16 v[86:87], v133 offset:17408
    s_waitcnt lgkmcnt(12)
    v_mfma_f32_16x16x32_bf16 v[56:59], a[4:7], v[124:127], v[56:59]
    ds_read_b64_tr_b16 v[88:89], v134 offset:16384
    v_mfma_f32_16x16x32_bf16 v[60:63], a[68:71], v[124:127], v[60:63]
    ds_read_b64_tr_b16 v[90:91], v134 offset:17408
    s_waitcnt lgkmcnt(12)
    v_mfma_f32_16x16x32_bf16 v[0:3], a[8:11], v[64:67], v[0:3]
    ds_read_b64_tr_b16 v[92:93], v135 offset:16384
    v_mfma_f32_16x16x32_bf16 v[4:7], a[72:75], v[64:67], v[4:7]
    ds_read_b64_tr_b16 v[94:95], v135 offset:17408
    s_waitcnt lgkmcnt(12)
    v_mfma_f32_16x16x32_bf16 v[8:11], a[8:11], v[68:71], v[8:11]
    ds_read_b64_tr_b16 v[96:97], v128 offset:24576
    v_mfma_f32_16x16x32_bf16 v[12:15], a[72:75], v[68:71], v[12:15]
    ds_read_b64_tr_b16 v[98:99], v128 offset:25600
    s_waitcnt lgkmcnt(12)
    v_mfma_f32_16x16x32_bf16 v[16:19], a[8:11], v[72:75], v[16:19]
    ds_read_b64_tr_b16 v[100:101], v129 offset:24576
    v_mfma_f32_16x16x32_bf16 v[20:23], a[72:75], v[72:75], v[20:23]
    ds_read_b64_tr_b16 v[102:103], v129 offset:25600
    s_waitcnt lgkmcnt(12)
    v_mfma_f32_16x16x32_bf16 v[24:27], a[8:11], v[76:79], v[24:27]
    ds_read_b64_tr_b16 v[104:105], v130 offset:24576
    v_mfma_f32_16x16x32_bf16 v[28:31], a[72:75], v[76:79], v[28:31]
    ds_read_b64_tr_b16 v[106:107], v130 offset:25600
    s_waitcnt lgkmcnt(12)
    v_mfma_f32_16x16x32_bf16 v[32:35], a[8:11], v[80:83], v[32:35]
    ds_read_b64_tr_b16 v[108:109], v131 offset:24576
    v_mfma_f32_16x16x32_bf16 v[36:39], a[72:75], v[80:83], v[36:39]
    ds_read_b64_tr_b16 v[110:111], v131 offset:25600
    s_waitcnt lgkmcnt(12)
    v_mfma_f32_16x16x32_bf16 v[40:43], a[8:11], v[84:87], v[40:43]
    ds_read_b64_tr_b16 v[112:113], v132 offset:24576
    v_mfma_f32_16x16x32_bf16 v[44:47], a[72:75], v[84:87], v[44:47]
    ds_read_b64_tr_b16 v[114:115], v132 offset:25600
    s_waitcnt lgkmcnt(12)
    v_mfma_f32_16x16x32_bf16 v[48:51], a[8:11], v[88:91], v[48:51]
    ds_read_b64_tr_b16 v[116:117], v133 offset:24576
    v_mfma_f32_16x16x32_bf16 v[52:55], a[72:75], v[88:91], v[52:55]
    ds_read_b64_tr_b16 v[118:119], v133 offset:25600
    s_waitcnt lgkmcnt(12)
    v_mfma_f32_16x16x32_bf16 v[56:59], a[8:11], v[92:95], v[56:59]
    ds_read_b64_tr_b16 v[120:121], v134 offset:24576
    v_mfma_f32_16x16x32_bf16 v[60:63], a[72:75], v[92:95], v[60:63]
    ds_read_b64_tr_b16 v[122:123], v134 offset:25600
    s_waitcnt lgkmcnt(12)
    v_mfma_f32_16x16x32_bf16 v[0:3], a[12:15], v[96:99], v[0:3]
    ds_read_b64_tr_b16 v[124:125], v135 offset:24576
    v_mfma_f32_16x16x32_bf16 v[4:7], a[76:79], v[96:99], v[4:7]
    ds_read_b64_tr_b16 v[126:127], v135 offset:25600
    s_waitcnt lgkmcnt(12)
    v_mfma_f32_16x16x32_bf16 v[8:11], a[12:15], v[100:103], v[8:11]
    v_mfma_f32_16x16x32_bf16 v[12:15], a[76:79], v[100:103], v[12:15]
    s_waitcnt lgkmcnt(10)
    v_mfma_f32_16x16x32_bf16 v[16:19], a[12:15], v[104:107], v[16:19]
    v_mfma_f32_16x16x32_bf16 v[20:23], a[76:79], v[104:107], v[20:23]
    s_waitcnt lgkmcnt(8)
    v_mfma_f32_16x16x32_bf16 v[24:27], a[12:15], v[108:111], v[24:27]
    v_mfma_f32_16x16x32_bf16 v[28:31], a[76:79], v[108:111], v[28:31]
    s_waitcnt lgkmcnt(6)
    v_mfma_f32_16x16x32_bf16 v[32:35], a[12:15], v[112:115], v[32:35]
    v_mfma_f32_16x16x32_bf16 v[36:39], a[76:79], v[112:115], v[36:39]
    s_waitcnt lgkmcnt(4)
    v_mfma_f32_16x16x32_bf16 v[40:43], a[12:15], v[116:119], v[40:43]
    v_mfma_f32_16x16x32_bf16 v[44:47], a[76:79], v[116:119], v[44:47]
    s_waitcnt lgkmcnt(2)
    v_mfma_f32_16x16x32_bf16 v[48:51], a[12:15], v[120:123], v[48:51]
    v_mfma_f32_16x16x32_bf16 v[52:55], a[76:79], v[120:123], v[52:55]
    s_waitcnt lgkmcnt(0)
    v_mfma_f32_16x16x32_bf16 v[56:59], a[12:15], v[124:127], v[56:59]
    v_mfma_f32_16x16x32_bf16 v[60:63], a[76:79], v[124:127], v[60:63]
    s_waitcnt vmcnt(16)
    s_barrier
    ds_read_b64_tr_b16 v[64:65], v128 offset:32768
    ds_read_b64_tr_b16 v[66:67], v128 offset:33792
    ds_read_b64_tr_b16 v[68:69], v129 offset:32768
    ds_read_b64_tr_b16 v[70:71], v129 offset:33792
    ds_read_b64_tr_b16 v[72:73], v130 offset:32768
    ds_read_b64_tr_b16 v[74:75], v130 offset:33792
    ds_read_b64_tr_b16 v[76:77], v131 offset:32768
    ds_read_b64_tr_b16 v[78:79], v131 offset:33792
    ds_read_b64_tr_b16 v[80:81], v132 offset:32768
    ds_read_b64_tr_b16 v[82:83], v132 offset:33792
    ds_read_b64_tr_b16 v[84:85], v133 offset:32768
    ds_read_b64_tr_b16 v[86:87], v133 offset:33792
    ds_read_b64_tr_b16 v[88:89], v134 offset:32768
    ds_read_b64_tr_b16 v[90:91], v134 offset:33792
    s_add_u32 s39, s39, s37
    s_lshr_b32 s26, s39, 5
    s_cmp_eq_u32 s26, 0
    s_cselect_b64 s[16:17], s[62:63], s[60:61]
    s_cmp_eq_u32 s26, 1
    s_cselect_b64 s[16:17], s[64:65], s[16:17]
    s_and_b32 s17, s17, 0xffff
    s_cmp_lt_u32 s39, 96
    s_cselect_b32 s18, 0x400000, 0
    s_and_b32 s24, s39, 31
    s_lshl_b32 s24, s24, 8
    s_waitcnt lgkmcnt(12)
    v_mfma_f32_16x16x32_bf16 v[0:3], a[16:19], v[64:67], v[0:3]
    ds_read_b64_tr_b16 v[92:93], v135 offset:32768
    v_mfma_f32_16x16x32_bf16 v[4:7], a[80:83], v[64:67], v[4:7]
    ds_read_b64_tr_b16 v[94:95], v135 offset:33792
    s_add_u32 s26, s24, 0x0
    s_add_u32 m0, s29, 0x0
    s_nop 0
    buffer_load_dwordx4 v136, s[16:19], s26 offen lds
    s_waitcnt lgkmcnt(12)
    v_mfma_f32_16x16x32_bf16 v[8:11], a[16:19], v[68:71], v[8:11]
    ds_read_b64_tr_b16 v[96:97], v128 offset:40960
    v_mfma_f32_16x16x32_bf16 v[12:15], a[80:83], v[68:71], v[12:15]
    ds_read_b64_tr_b16 v[98:99], v128 offset:41984
    s_add_u32 s26, s24, 0x20000
    s_add_u32 m0, s29, 0x1000
    s_nop 0
    buffer_load_dwordx4 v136, s[16:19], s26 offen lds
    s_waitcnt lgkmcnt(12)
    v_mfma_f32_16x16x32_bf16 v[16:19], a[16:19], v[72:75], v[16:19]
    ds_read_b64_tr_b16 v[100:101], v129 offset:40960
    v_mfma_f32_16x16x32_bf16 v[20:23], a[80:83], v[72:75], v[20:23]
    ds_read_b64_tr_b16 v[102:103], v129 offset:41984
    s_add_u32 s26, s24, 0x40000
    s_add_u32 m0, s29, 0x2000
    s_nop 0
    buffer_load_dwordx4 v136, s[16:19], s26 offen lds
    s_waitcnt lgkmcnt(12)
    v_mfma_f32_16x16x32_bf16 v[24:27], a[16:19], v[76:79], v[24:27]
    ds_read_b64_tr_b16 v[104:105], v130 offset:40960
    v_mfma_f32_16x16x32_bf16 v[28:31], a[80:83], v[76:79], v[28:31]
    ds_read_b64_tr_b16 v[106:107], v130 offset:41984
    s_add_u32 s26, s24, 0x60000
    s_add_u32 m0, s29, 0x3000
    s_nop 0
    buffer_load_dwordx4 v136, s[16:19], s26 offen lds
    s_waitcnt lgkmcnt(12)
    v_mfma_f32_16x16x32_bf16 v[32:35], a[16:19], v[80:83], v[32:35]
    ds_read_b64_tr_b16 v[108:109], v131 offset:40960
    v_mfma_f32_16x16x32_bf16 v[36:39], a[80:83], v[80:83], v[36:39]
    ds_read_b64_tr_b16 v[110:111], v131 offset:41984
    s_add_u32 s26, s24, 0x80000
    s_add_u32 m0, s29, 0x4000
    s_nop 0
    buffer_load_dwordx4 v136, s[16:19], s26 offen lds
    s_waitcnt lgkmcnt(12)
    v_mfma_f32_16x16x32_bf16 v[40:43], a[16:19], v[84:87], v[40:43]
    ds_read_b64_tr_b16 v[112:113], v132 offset:40960
    v_mfma_f32_16x16x32_bf16 v[44:47], a[80:83], v[84:87], v[44:47]
    ds_read_b64_tr_b16 v[114:115], v132 offset:41984
    s_add_u32 s26, s24, 0xa0000
    s_add_u32 m0, s29, 0x5000
    s_nop 0
    buffer_load_dwordx4 v136, s[16:19], s26 offen lds
    s_waitcnt lgkmcnt(12)
    v_mfma_f32_16x16x32_bf16 v[48:51], a[16:19], v[88:91], v[48:51]
    ds_read_b64_tr_b16 v[116:117], v133 offset:40960
    v_mfma_f32_16x16x32_bf16 v[52:55], a[80:83], v[88:91], v[52:55]
    ds_read_b64_tr_b16 v[118:119], v133 offset:41984
    s_add_u32 s26, s24, 0xc0000
    s_add_u32 m0, s29, 0x6000
    s_nop 0
    buffer_load_dwordx4 v136, s[16:19], s26 offen lds
    s_waitcnt lgkmcnt(12)
    v_mfma_f32_16x16x32_bf16 v[56:59], a[16:19], v[92:95], v[56:59]
    ds_read_b64_tr_b16 v[120:121], v134 offset:40960
    v_mfma_f32_16x16x32_bf16 v[60:63], a[80:83], v[92:95], v[60:63]
    ds_read_b64_tr_b16 v[122:123], v134 offset:41984
    s_add_u32 s26, s24, 0xe0000
    s_add_u32 m0, s29, 0x7000
    s_nop 0
    buffer_load_dwordx4 v136, s[16:19], s26 offen lds
    s_waitcnt lgkmcnt(12)
    v_mfma_f32_16x16x32_bf16 v[0:3], a[20:23], v[96:99], v[0:3]
    ds_read_b64_tr_b16 v[124:125], v135 offset:40960
    v_mfma_f32_16x16x32_bf16 v[4:7], a[84:87], v[96:99], v[4:7]
    ds_read_b64_tr_b16 v[126:127], v135 offset:41984
    s_waitcnt lgkmcnt(12)
    v_mfma_f32_16x16x32_bf16 v[8:11], a[20:23], v[100:103], v[8:11]
    ds_read_b64_tr_b16 v[64:65], v128 offset:49152
    v_mfma_f32_16x16x32_bf16 v[12:15], a[84:87], v[100:103], v[12:15]
    ds_read_b64_tr_b16 v[66:67], v128 offset:50176
    s_waitcnt lgkmcnt(12)
    v_mfma_f32_16x16x32_bf16 v[16:19], a[20:23], v[104:107], v[16:19]
    ds_read_b64_tr_b16 v[68:69], v129 offset:49152
    v_mfma_f32_16x16x32_bf16 v[20:23], a[84:87], v[104:107], v[20:23]
    ds_read_b64_tr_b16 v[70:71], v129 offset:50176
    s_waitcnt lgkmcnt(12)
    v_mfma_f32_16x16x32_bf16 v[24:27], a[20:23], v[108:111], v[24:27]
    ds_read_b64_tr_b16 v[72:73], v130 offset:49152
    v_mfma_f32_16x16x32_bf16 v[28:31], a[84:87], v[108:111], v[28:31]
    ds_read_b64_tr_b16 v[74:75], v130 offset:50176
    s_waitcnt lgkmcnt(12)
    v_mfma_f32_16x16x32_bf16 v[32:35], a[20:23], v[112:115], v[32:35]
    ds_read_b64_tr_b16 v[76:77], v131 offset:49152
    v_mfma_f32_16x16x32_bf16 v[36:39], a[84:87], v[112:115], v[36:39]
    ds_read_b64_tr_b16 v[78:79], v131 offset:50176
    s_waitcnt lgkmcnt(12)
    v_mfma_f32_16x16x32_bf16 v[40:43], a[20:23], v[116:119], v[40:43]
    ds_read_b64_tr_b16 v[80:81], v132 offset:49152
    v_mfma_f32_16x16x32_bf16 v[44:47], a[84:87], v[116:119], v[44:47]
    ds_read_b64_tr_b16 v[82:83], v132 offset:50176
    s_waitcnt lgkmcnt(12)
    v_mfma_f32_16x16x32_bf16 v[48:51], a[20:23], v[120:123], v[48:51]
    ds_read_b64_tr_b16 v[84:85], v133 offset:49152
    v_mfma_f32_16x16x32_bf16 v[52:55], a[84:87], v[120:123], v[52:55]
    ds_read_b64_tr_b16 v[86:87], v133 offset:50176
    s_waitcnt lgkmcnt(12)
    v_mfma_f32_16x16x32_bf16 v[56:59], a[20:23], v[124:127], v[56:59]
    ds_read_b64_tr_b16 v[88:89], v134 offset:49152
    v_mfma_f32_16x16x32_bf16 v[60:63], a[84:87], v[124:127], v[60:63]
    ds_read_b64_tr_b16 v[90:91], v134 offset:50176
    s_waitcnt lgkmcnt(12)
    v_mfma_f32_16x16x32_bf16 v[0:3], a[24:27], v[64:67], v[0:3]
    ds_read_b64_tr_b16 v[92:93], v135 offset:49152
    v_mfma_f32_16x16x32_bf16 v[4:7], a[88:91], v[64:67], v[4:7]
    ds_read_b64_tr_b16 v[94:95], v135 offset:50176
    s_waitcnt lgkmcnt(12)
    v_mfma_f32_16x16x32_bf16 v[8:11], a[24:27], v[68:71], v[8:11]
    ds_read_b64_tr_b16 v[96:97], v128 offset:57344
    v_mfma_f32_16x16x32_bf16 v[12:15], a[88:91], v[68:71], v[12:15]
    ds_read_b64_tr_b16 v[98:99], v128 offset:58368
    s_waitcnt lgkmcnt(12)
    v_mfma_f32_16x16x32_bf16 v[16:19], a[24:27], v[72:75], v[16:19]
    ds_read_b64_tr_b16 v[100:101], v129 offset:57344
    v_mfma_f32_16x16x32_bf16 v[20:23], a[88:91], v[72:75], v[20:23]
    ds_read_b64_tr_b16 v[102:103], v129 offset:58368
    s_waitcnt lgkmcnt(12)
    v_mfma_f32_16x16x32_bf16 v[24:27], a[24:27], v[76:79], v[24:27]
    ds_read_b64_tr_b16 v[104:105], v130 offset:57344
    v_mfma_f32_16x16x32_bf16 v[28:31], a[88:91], v[76:79], v[28:31]
    ds_read_b64_tr_b16 v[106:107], v130 offset:58368
    s_waitcnt lgkmcnt(12)
    v_mfma_f32_16x16x32_bf16 v[32:35], a[24:27], v[80:83], v[32:35]
    ds_read_b64_tr_b16 v[108:109], v131 offset:57344
    v_mfma_f32_16x16x32_bf16 v[36:39], a[88:91], v[80:83], v[36:39]
    ds_read_b64_tr_b16 v[110:111], v131 offset:58368
    s_waitcnt lgkmcnt(12)
    v_mfma_f32_16x16x32_bf16 v[40:43], a[24:27], v[84:87], v[40:43]
    ds_read_b64_tr_b16 v[112:113], v132 offset:57344
    v_mfma_f32_16x16x32_bf16 v[44:47], a[88:91], v[84:87], v[44:47]
    ds_read_b64_tr_b16 v[114:115], v132 offset:58368
    s_waitcnt lgkmcnt(12)
    v_mfma_f32_16x16x32_bf16 v[48:51], a[24:27], v[88:91], v[48:51]
    ds_read_b64_tr_b16 v[116:117], v133 offset:57344
    v_mfma_f32_16x16x32_bf16 v[52:55], a[88:91], v[88:91], v[52:55]
    ds_read_b64_tr_b16 v[118:119], v133 offset:58368
    s_waitcnt lgkmcnt(12)
    v_mfma_f32_16x16x32_bf16 v[56:59], a[24:27], v[92:95], v[56:59]
    ds_read_b64_tr_b16 v[120:121], v134 offset:57344
    v_mfma_f32_16x16x32_bf16 v[60:63], a[88:91], v[92:95], v[60:63]
    ds_read_b64_tr_b16 v[122:123], v134 offset:58368
    s_waitcnt lgkmcnt(12)
    v_mfma_f32_16x16x32_bf16 v[0:3], a[28:31], v[96:99], v[0:3]
    ds_read_b64_tr_b16 v[124:125], v135 offset:57344
    v_mfma_f32_16x16x32_bf16 v[4:7], a[92:95], v[96:99], v[4:7]
    ds_read_b64_tr_b16 v[126:127], v135 offset:58368
    s_waitcnt lgkmcnt(12)
    v_mfma_f32_16x16x32_bf16 v[8:11], a[28:31], v[100:103], v[8:11]
    v_mfma_f32_16x16x32_bf16 v[12:15], a[92:95], v[100:103], v[12:15]
    s_waitcnt lgkmcnt(10)
    v_mfma_f32_16x16x32_bf16 v[16:19], a[28:31], v[104:107], v[16:19]
    v_mfma_f32_16x16x32_bf16 v[20:23], a[92:95], v[104:107], v[20:23]
    s_waitcnt lgkmcnt(8)
    v_mfma_f32_16x16x32_bf16 v[24:27], a[28:31], v[108:111], v[24:27]
    v_mfma_f32_16x16x32_bf16 v[28:31], a[92:95], v[108:111], v[28:31]
    s_waitcnt lgkmcnt(6)
    v_mfma_f32_16x16x32_bf16 v[32:35], a[28:31], v[112:115], v[32:35]
    v_mfma_f32_16x16x32_bf16 v[36:39], a[92:95], v[112:115], v[36:39]
    s_waitcnt lgkmcnt(4)
    v_mfma_f32_16x16x32_bf16 v[40:43], a[28:31], v[116:119], v[40:43]
    v_mfma_f32_16x16x32_bf16 v[44:47], a[92:95], v[116:119], v[44:47]
    s_waitcnt lgkmcnt(2)
    v_mfma_f32_16x16x32_bf16 v[48:51], a[28:31], v[120:123], v[48:51]
    v_mfma_f32_16x16x32_bf16 v[52:55], a[92:95], v[120:123], v[52:55]
    s_waitcnt lgkmcnt(0)
    v_mfma_f32_16x16x32_bf16 v[56:59], a[28:31], v[124:127], v[56:59]
    v_mfma_f32_16x16x32_bf16 v[60:63], a[92:95], v[124:127], v[60:63]
    v_xor_b32 v128, 0x10000, v128
    v_xor_b32 v129, 0x10000, v129
    v_xor_b32 v130, 0x10000, v130
    v_xor_b32 v131, 0x10000, v131
    v_xor_b32 v132, 0x10000, v132
    v_xor_b32 v133, 0x10000, v133
    v_xor_b32 v134, 0x10000, v134
    v_xor_b32 v135, 0x10000, v135
    s_waitcnt vmcnt(16)
    s_barrier
    ds_read_b64_tr_b16 v[64:65], v128
    ds_read_b64_tr_b16 v[66:67], v128 offset:1024
    ds_read_b64_tr_b16 v[68:69], v129
    ds_read_b64_tr_b16 v[70:71], v129 offset:1024
    ds_read_b64_tr_b16 v[72:73], v130
    ds_read_b64_tr_b16 v[74:75], v130 offset:1024
    ds_read_b64_tr_b16 v[76:77], v131
    ds_read_b64_tr_b16 v[78:79], v131 offset:1024
    ds_read_b64_tr_b16 v[80:81], v132
    ds_read_b64_tr_b16 v[82:83], v132 offset:1024
    ds_read_b64_tr_b16 v[84:85], v133
    ds_read_b64_tr_b16 v[86:87], v133 offset:1024
    ds_read_b64_tr_b16 v[88:89], v134
    ds_read_b64_tr_b16 v[90:91], v134 offset:1024
    s_cmp_eq_u32 s40, 0
    s_cbranch_scc1 L_nopf_96
    s_cmp_lg_u32 s87, 0
    s_cbranch_scc1 L_modeok_97
    v_readfirstlane_b32 s96, v140
    v_readfirstlane_b32 s97, v141
    s_nop 0
    s_cmp_lg_u32 s97, 0
    s_cselect_b32 s87, s96, 0
    s_cmp_eq_u32 s87, 1
    s_cbranch_scc1 L_modeok_97
    s_mov_b32 s96, 0
L_mode_98:
    buffer_load_dwordx2 v[140:141], off, s[92:95], 0 offset:36 sc1
    s_waitcnt vmcnt(0)
    v_readfirstlane_b32 s87, v140
    v_readfirstlane_b32 s97, v141
    s_nop 0
    s_min_u32 s97, s97, s87
    s_cmp_lg_u32 s97, 0
    s_cbranch_scc1 L_moded_99
    s_sleep 4
    s_add_u32 s96, s96, 1
    s_cmp_lg_u32 s96, 0x100
    s_cbranch_scc1 L_modef_100
    v_mov_b32 v140, 2
    v_mov_b32 v141, 0
    s_mov_b64 exec, 1
    buffer_atomic_cmpswap v[140:141], off, s[92:95], 0 offset:36
    s_mov_b64 exec, -1
L_modef_100:
    s_cmp_lt_u32 s96, 0x10000
    s_cbranch_scc1 L_mode_98
L_moded_99:
    s_cmp_lg_u32 s87, 1
    s_cbranch_scc1 L_fallback
L_modeok_97:
    s_cmp_lg_u32 s100, 0
    s_cbranch_scc1 L_flag_101
    v_mov_b32 v138, 1
    s_mov_b64 exec, 1
    buffer_store_dword v138, off, s[8:11], s40 sc1
    s_mov_b64 exec, -1
L_flag_101:
    s_mov_b32 s40, 0
L_nopf_96:
    s_waitcnt lgkmcnt(12)
    v_mfma_f32_16x16x32_bf16 v[0:3], a[32:35], v[64:67], v[0:3]
    ds_read_b64_tr_b16 v[92:93], v135
    v_mfma_f32_16x16x32_bf16 v[4:7], a[96:99], v[64:67], v[4:7]
    ds_read_b64_tr_b16 v[94:95], v135 offset:1024
    s_add_u32 s26, s24, 0x100000
    s_add_u32 m0, s29, 0x8000
    s_nop 0
    buffer_load_dwordx4 v136, s[16:19], s26 offen lds
    s_waitcnt lgkmcnt(12)
    v_mfma_f32_16x16x32_bf16 v[8:11], a[32:35], v[68:71], v[8:11]
    ds_read_b64_tr_b16 v[96:97], v128 offset:8192
    v_mfma_f32_16x16x32_bf16 v[12:15], a[96:99], v[68:71], v[12:15]
    ds_read_b64_tr_b16 v[98:99], v128 offset:9216
    s_add_u32 s26, s24, 0x120000
    s_add_u32 m0, s29, 0x9000
    s_nop 0
    buffer_load_dwordx4 v136, s[16:19], s26 offen lds
    s_waitcnt lgkmcnt(12)
    v_mfma_f32_16x16x32_bf16 v[16:19], a[32:35], v[72:75], v[16:19]
    ds_read_b64_tr_b16 v[100:101], v129 offset:8192
    v_mfma_f32_16x16x32_bf16 v[20:23], a[96:99], v[72:75], v[20:23]
    ds_read_b64_tr_b16 v[102:103], v129 offset:9216
    s_add_u32 s26, s24, 0x140000
    s_add_u32 m0, s29, 0xa000
    s_nop 0
    buffer_load_dwordx4 v136, s[16:19], s26 offen lds
    s_waitcnt lgkmcnt(12)
    v_mfma_f32_16x16x32_bf16 v[24:27], a[32:35], v[76:79], v[24:27]
    ds_read_b64_tr_b16 v[104:105], v130 offset:8192
    v_mfma_f32_16x16x32_bf16 v[28:31], a[96:99], v[76:79], v[28:31]
    ds_read_b64_tr_b16 v[106:107], v130 offset:9216
    s_add_u32 s26, s24, 0x160000
    s_add_u32 m0, s29, 0xb000
    s_nop 0
    buffer_load_dwordx4 v136, s[16:19], s26 offen lds
    s_waitcnt lgkmcnt(12)
    v_mfma_f32_16x16x32_bf16 v[32:35], a[32:35], v[80:83], v[32:35]
    ds_read_b64_tr_b16 v[108:109], v131 offset:8192
    v_mfma_f32_16x16x32_bf16 v[36:39], a[96:99], v[80:83], v[36:39]
    ds_read_b64_tr_b16 v[110:111], v131 offset:9216
    s_add_u32 s26, s24, 0x180000
    s_add_u32 m0, s29, 0xc000
    s_nop 0
    buffer_load_dwordx4 v136, s[16:19], s26 offen lds
    s_waitcnt lgkmcnt(12)
    v_mfma_f32_16x16x32_bf16 v[40:43], a[32:35], v[84:87], v[40:43]
    ds_read_b64_tr_b16 v[112:113], v132 offset:8192
    v_mfma_f32_16x16x32_bf16 v[44:47], a[96:99], v[84:87], v[44:47]
    ds_read_b64_tr_b16 v[114:115], v132 offset:9216
    s_add_u32 s26, s24, 0x1a0000
    s_add_u32 m0, s29, 0xd000
    s_nop 0
    buffer_load_dwordx4 v136, s[16:19], s26 offen lds
    s_waitcnt lgkmcnt(12)
    v_mfma_f32_16x16x32_bf16 v[48:51], a[32:35], v[88:91], v[48:51]
    ds_read_b64_tr_b16 v[116:117], v133 offset:8192
    v_mfma_f32_16x16x32_bf16 v[52:55], a[96:99], v[88:91], v[52:55]
    ds_read_b64_tr_b16 v[118:119], v133 offset:9216
    s_add_u32 s26, s24, 0x1c0000
    s_add_u32 m0, s29, 0xe000
    s_nop 0
    buffer_load_dwordx4 v136, s[16:19], s26 offen lds
    s_waitcnt lgkmcnt(12)
    v_mfma_f32_16x16x32_bf16 v[56:59], a[32:35], v[92:95], v[56:59]
    ds_read_b64_tr_b16 v[120:121], v134 offset:8192
    v_mfma_f32_16x16x32_bf16 v[60:63], a[96:99], v[92:95], v[60:63]
    ds_read_b64_tr_b16 v[122:123], v134 offset:9216
    s_add_u32 s26, s24, 0x1e0000
    s_add_u32 m0, s29, 0xf000
    s_nop 0
    buffer_load_dwordx4 v136, s[16:19], s26 offen lds
    s_waitcnt lgkmcnt(12)
    v_mfma_f32_16x16x32_bf16 v[0:3], a[36:39], v[96:99], v[0:3]
    ds_read_b64_tr_b16 v[124:125], v135 offset:8192
    v_mfma_f32_16x16x32_bf16 v[4:7], a[100:103], v[96:99], v[4:7]
    ds_read_b64_tr_b16 v[126:127], v135 offset:9216
    s_waitcnt lgkmcnt(12)
    v_mfma_f32_16x16x32_bf16 v[8:11], a[36:39], v[100:103], v[8:11]
    ds_read_b64_tr_b16 v[64:65], v128 offset:16384
    v_mfma_f32_16x16x32_bf16 v[12:15], a[100:103], v[100:103], v[12:15]
    ds_read_b64_tr_b16 v[66:67], v128 offset:17408
    s_waitcnt lgkmcnt(12)
    v_mfma_f32_16x16x32_bf16 v[16:19], a[36:39], v[104:107], v[16:19]
    ds_read_b64_tr_b16 v[68:69], v129 offset:16384
    v_mfma_f32_16x16x32_bf16 v[20:23], a[100:103], v[104:107], v[20:23]
    ds_read_b64_tr_b16 v[70:71], v129 offset:17408
    s_waitcnt lgkmcnt(12)
    v_mfma_f32_16x16x32_bf16 v[24:27], a[36:39], v[108:111], v[24:27]
    ds_read_b64_tr_b16 v[72:73], v130 offset:16384
    v_mfma_f32_16x16x32_bf16 v[28:31], a[100:103], v[108:111], v[28:31]
    ds_read_b64_tr_b16 v[74:75], v130 offset:17408
    s_waitcnt lgkmcnt(12)
    v_mfma_f32_16x16x32_bf16 v[32:35], a[36:39], v[112:115], v[32:35]
    ds_read_b64_tr_b16 v[76:77], v131 offset:16384
    v_mfma_f32_16x16x32_bf16 v[36:39], a[100:103], v[112:115], v[36:39]
    ds_read_b64_tr_b16 v[78:79], v131 offset:17408
    s_waitcnt lgkmcnt(12)
    v_mfma_f32_16x16x32_bf16 v[40:43], a[36:39], v[116:119], v[40:43]
    ds_read_b64_tr_b16 v[80:81], v132 offset:16384
    v_mfma_f32_16x16x32_bf16 v[44:47], a[100:103], v[116:119], v[44:47]
    ds_read_b64_tr_b16 v[82:83], v132 offset:17408
    s_waitcnt lgkmcnt(12)
    v_mfma_f32_16x16x32_bf16 v[48:51], a[36:39], v[120:123], v[48:51]
    ds_read_b64_tr_b16 v[84:85], v133 offset:16384
    v_mfma_f32_16x16x32_bf16 v[52:55], a[100:103], v[120:123], v[52:55]
    ds_read_b64_tr_b16 v[86:87], v133 offset:17408
    s_waitcnt lgkmcnt(12)
    v_mfma_f32_16x16x32_bf16 v[56:59], a[36:39], v[124:127], v[56:59]
    ds_read_b64_tr_b16 v[88:89], v134 offset:16384
    v_mfma_f32_16x16x32_bf16 v[60:63], a[100:103], v[124:127], v[60:63]
    ds_read_b64_tr_b16 v[90:91], v134 offset:17408
    s_waitcnt lgkmcnt(12)
    v_mfma_f32_16x16x32_bf16 v[0:3], a[40:43], v[64:67], v[0:3]
    ds_read_b64_tr_b16 v[92:93], v135 offset:16384
    v_mfma_f32_16x16x32_bf16 v[4:7], a[104:107], v[64:67], v[4:7]
    ds_read_b64_tr_b16 v[94:95], v135 offset:17408
    s_waitcnt lgkmcnt(12)
    v_mfma_f32_16x16x32_bf16 v[8:11], a[40:43], v[68:71], v[8:11]
    ds_read_b64_tr_b16 v[96:97], v128 offset:24576
    v_mfma_f32_16x16x32_bf16 v[12:15], a[104:107], v[68:71], v[12:15]
    ds_read_b64_tr_b16 v[98:99], v128 offset:25600
    s_waitcnt lgkmcnt(12)
    v_mfma_f32_16x16x32_bf16 v[16:19], a[40:43], v[72:75], v[16:19]
    ds_read_b64_tr_b16 v[100:101], v129 offset:24576
    v_mfma_f32_16x16x32_bf16 v[20:23], a[104:107], v[72:75], v[20:23]
    ds_read_b64_tr_b16 v[102:103], v129 offset:25600
    s_waitcnt lgkmcnt(12)
    v_mfma_f32_16x16x32_bf16 v[24:27], a[40:43], v[76:79], v[24:27]
    ds_read_b64_tr_b16 v[104:105], v130 offset:24576
    v_mfma_f32_16x16x32_bf16 v[28:31], a[104:107], v[76:79], v[28:31]
    ds_read_b64_tr_b16 v[106:107], v130 offset:25600
    s_waitcnt lgkmcnt(12)
    v_mfma_f32_16x16x32_bf16 v[32:35], a[40:43], v[80:83], v[32:35]
    ds_read_b64_tr_b16 v[108:109], v131 offset:24576
    v_mfma_f32_16x16x32_bf16 v[36:39], a[104:107], v[80:83], v[36:39]
    ds_read_b64_tr_b16 v[110:111], v131 offset:25600
    s_waitcnt lgkmcnt(12)
    v_mfma_f32_16x16x32_bf16 v[40:43], a[40:43], v[84:87], v[40:43]
    ds_read_b64_tr_b16 v[112:113], v132 offset:24576
    v_mfma_f32_16x16x32_bf16 v[44:47], a[104:107], v[84:87], v[44:47]
    ds_read_b64_tr_b16 v[114:115], v132 offset:25600
    s_waitcnt lgkmcnt(12)
    v_mfma_f32_16x16x32_bf16 v[48:51], a[40:43], v[88:91], v[48:51]
    ds_read_b64_tr_b16 v[116:117], v133 offset:24576
    v_mfma_f32_16x16x32_bf16 v[52:55], a[104:107], v[88:91], v[52:55]
    ds_read_b64_tr_b16 v[118:119], v133 offset:25600
    s_waitcnt lgkmcnt(12)
    v_mfma_f32_16x16x32_bf16 v[56:59], a[40:43], v[92:95], v[56:59]
    ds_read_b64_tr_b16 v[120:121], v134 offset:24576
    v_mfma_f32_16x16x32_bf16 v[60:63], a[104:107], v[92:95], v[60:63]
    ds_read_b64_tr_b16 v[122:123], v134 offset:25600
    s_waitcnt lgkmcnt(12)
    v_mfma_f32_16x16x32_bf16 v[0:3], a[44:47], v[96:99], v[0:3]
    ds_read_b64_tr_b16 v[124:125], v135 offset:24576
    v_mfma_f32_16x16x32_bf16 v[4:7], a[108:111], v[96:99], v[4:7]
    ds_read_b64_tr_b16 v[126:127], v135 offset:25600
    s_waitcnt lgkmcnt(12)
    v_mfma_f32_16x16x32_bf16 v[8:11], a[44:47], v[100:103], v[8:11]
    v_mfma_f32_16x16x32_bf16 v[12:15], a[108:111], v[100:103], v[12:15]
    s_waitcnt lgkmcnt(10)
    v_mfma_f32_16x16x32_bf16 v[16:19], a[44:47], v[104:107], v[16:19]
    v_mfma_f32_16x16x32_bf16 v[20:23], a[108:111], v[104:107], v[20:23]
    s_waitcnt lgkmcnt(8)
    v_mfma_f32_16x16x32_bf16 v[24:27], a[44:47], v[108:111], v[24:27]
    v_mfma_f32_16x16x32_bf16 v[28:31], a[108:111], v[108:111], v[28:31]
    s_waitcnt lgkmcnt(6)
    v_mfma_f32_16x16x32_bf16 v[32:35], a[44:47], v[112:115], v[32:35]
    v_mfma_f32_16x16x32_bf16 v[36:39], a[108:111], v[112:115], v[36:39]
    s_waitcnt lgkmcnt(4)
    v_mfma_f32_16x16x32_bf16 v[40:43], a[44:47], v[116:119], v[40:43]
    v_mfma_f32_16x16x32_bf16 v[44:47], a[108:111], v[116:119], v[44:47]
    s_waitcnt lgkmcnt(2)
    v_mfma_f32_16x16x32_bf16 v[48:51], a[44:47], v[120:123], v[48:51]
    v_mfma_f32_16x16x32_bf16 v[52:55], a[108:111], v[120:123], v[52:55]
    s_waitcnt lgkmcnt(0)
    v_mfma_f32_16x16x32_bf16 v[56:59], a[44:47], v[124:127], v[56:59]
    v_mfma_f32_16x16x32_bf16 v[60:63], a[108:111], v[124:127], v[60:63]
    s_waitcnt vmcnt(16)
    s_barrier
    ds_read_b64_tr_b16 v[64:65], v128 offset:32768
    ds_read_b64_tr_b16 v[66:67], v128 offset:33792
    ds_read_b64_tr_b16 v[68:69], v129 offset:32768
    ds_read_b64_tr_b16 v[70:71], v129 offset:33792
    ds_read_b64_tr_b16 v[72:73], v130 offset:32768
    ds_read_b64_tr_b16 v[74:75], v130 offset:33792
    ds_read_b64_tr_b16 v[76:77], v131 offset:32768
    ds_read_b64_tr_b16 v[78:79], v131 offset:33792
    ds_read_b64_tr_b16 v[80:81], v132 offset:32768
    ds_read_b64_tr_b16 v[82:83], v132 offset:33792
    ds_read_b64_tr_b16 v[84:85], v133 offset:32768
    ds_read_b64_tr_b16 v[86:87], v133 offset:33792
    ds_read_b64_tr_b16 v[88:89], v134 offset:32768
    ds_read_b64_tr_b16 v[90:91], v134 offset:33792
    s_waitcnt lgkmcnt(12)
    v_mfma_f32_16x16x32_bf16 v[0:3], a[48:51], v[64:67], v[0:3]
    ds_read_b64_tr_b16 v[92:93], v135 offset:32768
    v_mfma_f32_16x16x32_bf16 v[4:7], a[112:115], v[64:67], v[4:7]
    ds_read_b64_tr_b16 v[94:95], v135 offset:33792
    s_add_u32 s26, s24, 0x200000
    s_add_u32 m0, s29, 0x10000
    s_nop 0
    buffer_load_dwordx4 v136, s[16:19], s26 offen lds
    s_waitcnt lgkmcnt(12)
    v_mfma_f32_16x16x32_bf16 v[8:11], a[48:51], v[68:71], v[8:11]
    ds_read_b64_tr_b16 v[96:97], v128 offset:40960
    v_mfma_f32_16x16x32_bf16 v[12:15], a[112:115], v[68:71], v[12:15]
    ds_read_b64_tr_b16 v[98:99], v128 offset:41984
    s_add_u32 s26, s24, 0x220000
    s_add_u32 m0, s29, 0x11000
    s_nop 0
    buffer_load_dwordx4 v136, s[16:19], s26 offen lds
    s_waitcnt lgkmcnt(12)
    v_mfma_f32_16x16x32_bf16 v[16:19], a[48:51], v[72:75], v[16:19]
    ds_read_b64_tr_b16 v[100:101], v129 offset:40960
    v_mfma_f32_16x16x32_bf16 v[20:23], a[112:115], v[72:75], v[20:23]
    ds_read_b64_tr_b16 v[102:103], v129 offset:41984
    s_add_u32 s26, s24, 0x240000
    s_add_u32 m0, s29, 0x12000
    s_nop 0
    buffer_load_dwordx4 v136, s[16:19], s26 offen lds
    s_waitcnt lgkmcnt(12)
    v_mfma_f32_16x16x32_bf16 v[24:27], a[48:51], v[76:79], v[24:27]
    ds_read_b64_tr_b16 v[104:105], v130 offset:40960
    v_mfma_f32_16x16x32_bf16 v[28:31], a[112:115], v[76:79], v[28:31]
    ds_read_b64_tr_b16 v[106:107], v130 offset:41984
    s_add_u32 s26, s24, 0x260000
    s_add_u32 m0, s29, 0x13000
    s_nop 0
    buffer_load_dwordx4 v136, s[16:19], s26 offen lds
    s_waitcnt lgkmcnt(12)
    v_mfma_f32_16x16x32_bf16 v[32:35], a[48:51], v[80:83], v[32:35]
    ds_read_b64_tr_b16 v[108:109], v131 offset:40960
    v_mfma_f32_16x16x32_bf16 v[36:39], a[112:115], v[80:83], v[36:39]
    ds_read_b64_tr_b16 v[110:111], v131 offset:41984
    s_add_u32 s26, s24, 0x280000
    s_add_u32 m0, s29, 0x14000
    s_nop 0
    buffer_load_dwordx4 v136, s[16:19], s26 offen lds
    s_waitcnt lgkmcnt(12)
    v_mfma_f32_16x16x32_bf16 v[40:43], a[48:51], v[84:87], v[40:43]
    ds_read_b64_tr_b16 v[112:113], v132 offset:40960
    v_mfma_f32_16x16x32_bf16 v[44:47], a[112:115], v[84:87], v[44:47]
    ds_read_b64_tr_b16 v[114:115], v132 offset:41984
    s_add_u32 s26, s24, 0x2a0000
    s_add_u32 m0, s29, 0x15000
    s_nop 0
    buffer_load_dwordx4 v136, s[16:19], s26 offen lds
    s_waitcnt lgkmcnt(12)
    v_mfma_f32_16x16x32_bf16 v[48:51], a[48:51], v[88:91], v[48:51]
    ds_read_b64_tr_b16 v[116:117], v133 offset:40960
    v_mfma_f32_16x16x32_bf16 v[52:55], a[112:115], v[88:91], v[52:55]
    ds_read_b64_tr_b16 v[118:119], v133 offset:41984
    s_add_u32 s26, s24, 0x2c0000
    s_add_u32 m0, s29, 0x16000
    s_nop 0
    buffer_load_dwordx4 v136, s[16:19], s26 offen lds
    s_waitcnt lgkmcnt(12)
    v_mfma_f32_16x16x32_bf16 v[56:59], a[48:51], v[92:95], v[56:59]
    ds_read_b64_tr_b16 v[120:121], v134 offset:40960
    v_mfma_f32_16x16x32_bf16 v[60:63], a[112:115], v[92:95], v[60:63]
    ds_read_b64_tr_b16 v[122:123], v134 offset:41984
    s_add_u32 s26, s24, 0x2e0000
    s_add_u32 m0, s29, 0x17000
    s_nop 0
    buffer_load_dwordx4 v136, s[16:19], s26 offen lds
    s_waitcnt lgkmcnt(12)
    v_mfma_f32_16x16x32_bf16 v[0:3], a[52:55], v[96:99], v[0:3]
    ds_read_b64_tr_b16 v[124:125], v135 offset:40960
    v_mfma_f32_16x16x32_bf16 v[4:7], a[116:119], v[96:99], v[4:7]
    ds_read_b64_tr_b16 v[126:127], v135 offset:41984
    s_waitcnt lgkmcnt(12)
    v_mfma_f32_16x16x32_bf16 v[8:11], a[52:55], v[100:103], v[8:11]
    ds_read_b64_tr_b16 v[64:65], v128 offset:49152
    v_mfma_f32_16x16x32_bf16 v[12:15], a[116:119], v[100:103], v[12:15]
    ds_read_b64_tr_b16 v[66:67], v128 offset:50176
    s_waitcnt lgkmcnt(12)
    v_mfma_f32_16x16x32_bf16 v[16:19], a[52:55], v[104:107], v[16:19]
    ds_read_b64_tr_b16 v[68:69], v129 offset:49152
    v_mfma_f32_16x16x32_bf16 v[20:23], a[116:119], v[104:107], v[20:23]
    ds_read_b64_tr_b16 v[70:71], v129 offset:50176
    s_waitcnt lgkmcnt(12)
    v_mfma_f32_16x16x32_bf16 v[24:27], a[52:55], v[108:111], v[24:27]
    ds_read_b64_tr_b16 v[72:73], v130 offset:49152
    v_mfma_f32_16x16x32_bf16 v[28:31], a[116:119], v[108:111], v[28:31]
    ds_read_b64_tr_b16 v[74:75], v130 offset:50176
    s_waitcnt lgkmcnt(12)
    v_mfma_f32_16x16x32_bf16 v[32:35], a[52:55], v[112:115], v[32:35]
    ds_read_b64_tr_b16 v[76:77], v131 offset:49152
    v_mfma_f32_16x16x32_bf16 v[36:39], a[116:119], v[112:115], v[36:39]
    ds_read_b64_tr_b16 v[78:79], v131 offset:50176
    s_waitcnt lgkmcnt(12)
    v_mfma_f32_16x16x32_bf16 v[40:43], a[52:55], v[116:119], v[40:43]
    ds_read_b64_tr_b16 v[80:81], v132 offset:49152
    v_mfma_f32_16x16x32_bf16 v[44:47], a[116:119], v[116:119], v[44:47]
    ds_read_b64_tr_b16 v[82:83], v132 offset:50176
    s_waitcnt lgkmcnt(12)
    v_mfma_f32_16x16x32_bf16 v[48:51], a[52:55], v[120:123], v[48:51]
    ds_read_b64_tr_b16 v[84:85], v133 offset:49152
    v_mfma_f32_16x16x32_bf16 v[52:55], a[116:119], v[120:123], v[52:55]
    ds_read_b64_tr_b16 v[86:87], v133 offset:50176
    s_waitcnt lgkmcnt(12)
    v_mfma_f32_16x16x32_bf16 v[56:59], a[52:55], v[124:127], v[56:59]
    ds_read_b64_tr_b16 v[88:89], v134 offset:49152
    v_mfma_f32_16x16x32_bf16 v[60:63], a[116:119], v[124:127], v[60:63]
    ds_read_b64_tr_b16 v[90:91], v134 offset:50176
    s_waitcnt lgkmcnt(12)
    v_mfma_f32_16x16x32_bf16 v[0:3], a[56:59], v[64:67], v[0:3]
    ds_read_b64_tr_b16 v[92:93], v135 offset:49152
    v_mfma_f32_16x16x32_bf16 v[4:7], a[120:123], v[64:67], v[4:7]
    ds_read_b64_tr_b16 v[94:95], v135 offset:50176
    s_waitcnt lgkmcnt(12)
    v_mfma_f32_16x16x32_bf16 v[8:11], a[56:59], v[68:71], v[8:11]
    ds_read_b64_tr_b16 v[96:97], v128 offset:57344
    v_mfma_f32_16x16x32_bf16 v[12:15], a[120:123], v[68:71], v[12:15]
    ds_read_b64_tr_b16 v[98:99], v128 offset:58368
    s_waitcnt lgkmcnt(12)
    v_mfma_f32_16x16x32_bf16 v[16:19], a[56:59], v[72:75], v[16:19]
    ds_read_b64_tr_b16 v[100:101], v129 offset:57344
    v_mfma_f32_16x16x32_bf16 v[20:23], a[120:123], v[72:75], v[20:23]
    ds_read_b64_tr_b16 v[102:103], v129 offset:58368
    s_waitcnt lgkmcnt(12)
    v_mfma_f32_16x16x32_bf16 v[24:27], a[56:59], v[76:79], v[24:27]
    ds_read_b64_tr_b16 v[104:105], v130 offset:57344
    v_mfma_f32_16x16x32_bf16 v[28:31], a[120:123], v[76:79], v[28:31]
    ds_read_b64_tr_b16 v[106:107], v130 offset:58368
    s_waitcnt lgkmcnt(12)
    v_mfma_f32_16x16x32_bf16 v[32:35], a[56:59], v[80:83], v[32:35]
    ds_read_b64_tr_b16 v[108:109], v131 offset:57344
    v_mfma_f32_16x16x32_bf16 v[36:39], a[120:123], v[80:83], v[36:39]
    ds_read_b64_tr_b16 v[110:111], v131 offset:58368
    s_waitcnt lgkmcnt(12)
    v_mfma_f32_16x16x32_bf16 v[40:43], a[56:59], v[84:87], v[40:43]
    ds_read_b64_tr_b16 v[112:113], v132 offset:57344
    v_mfma_f32_16x16x32_bf16 v[44:47], a[120:123], v[84:87], v[44:47]
    ds_read_b64_tr_b16 v[114:115], v132 offset:58368
    s_waitcnt lgkmcnt(12)
    v_mfma_f32_16x16x32_bf16 v[48:51], a[56:59], v[88:91], v[48:51]
    ds_read_b64_tr_b16 v[116:117], v133 offset:57344
    v_mfma_f32_16x16x32_bf16 v[52:55], a[120:123], v[88:91], v[52:55]
    ds_read_b64_tr_b16 v[118:119], v133 offset:58368
    s_waitcnt lgkmcnt(12)
    v_mfma_f32_16x16x32_bf16 v[56:59], a[56:59], v[92:95], v[56:59]
    ds_read_b64_tr_b16 v[120:121], v134 offset:57344
    v_mfma_f32_16x16x32_bf16 v[60:63], a[120:123], v[92:95], v[60:63]
    ds_read_b64_tr_b16 v[122:123], v134 offset:58368
    s_waitcnt lgkmcnt(12)
    v_mfma_f32_16x16x32_bf16 v[0:3], a[60:63], v[96:99], v[0:3]
    ds_read_b64_tr_b16 v[124:125], v135 offset:57344
    v_mfma_f32_16x16x32_bf16 v[4:7], a[124:127], v[96:99], v[4:7]
    ds_read_b64_tr_b16 v[126:127], v135 offset:58368
    s_waitcnt lgkmcnt(12)
    v_mfma_f32_16x16x32_bf16 v[8:11], a[60:63], v[100:103], v[8:11]
    v_mfma_f32_16x16x32_bf16 v[12:15], a[124:127], v[100:103], v[12:15]
    s_waitcnt lgkmcnt(10)
    v_mfma_f32_16x16x32_bf16 v[16:19], a[60:63], v[104:107], v[16:19]
    v_mfma_f32_16x16x32_bf16 v[20:23], a[124:127], v[104:107], v[20:23]
    s_waitcnt lgkmcnt(8)
    v_mfma_f32_16x16x32_bf16 v[24:27], a[60:63], v[108:111], v[24:27]
    v_mfma_f32_16x16x32_bf16 v[28:31], a[124:127], v[108:111], v[28:31]
    s_waitcnt lgkmcnt(6)
    v_mfma_f32_16x16x32_bf16 v[32:35], a[60:63], v[112:115], v[32:35]
    v_mfma_f32_16x16x32_bf16 v[36:39], a[124:127], v[112:115], v[36:39]
    s_waitcnt lgkmcnt(4)
    v_mfma_f32_16x16x32_bf16 v[40:43], a[60:63], v[116:119], v[40:43]
    v_mfma_f32_16x16x32_bf16 v[44:47], a[124:127], v[116:119], v[44:47]
    s_waitcnt lgkmcnt(2)
    v_mfma_f32_16x16x32_bf16 v[48:51], a[60:63], v[120:123], v[48:51]
    v_mfma_f32_16x16x32_bf16 v[52:55], a[124:127], v[120:123], v[52:55]
    s_waitcnt lgkmcnt(0)
    v_mfma_f32_16x16x32_bf16 v[56:59], a[60:63], v[124:127], v[56:59]
    v_mfma_f32_16x16x32_bf16 v[60:63], a[124:127], v[124:127], v[60:63]
    v_xor_b32 v128, 0x10000, v128
    v_xor_b32 v129, 0x10000, v129
    v_xor_b32 v130, 0x10000, v130
    v_xor_b32 v131, 0x10000, v131
    v_xor_b32 v132, 0x10000, v132
    v_xor_b32 v133, 0x10000, v133
    v_xor_b32 v134, 0x10000, v134
    v_xor_b32 v135, 0x10000, v135
    v_cvt_pk_bf16_f32 v144, v0, v1
    v_cvt_pk_bf16_f32 v145, v2, v3
    v_cvt_pk_bf16_f32 v146, v4, v5
    v_cvt_pk_bf16_f32 v147, v6, v7
    buffer_store_dwordx4 v[144:147], v137, s[8:11], s25 offen sc1
    v_cvt_pk_bf16_f32 v148, v8, v9
    v_cvt_pk_bf16_f32 v149, v10, v11
    v_cvt_pk_bf16_f32 v150, v12, v13
    v_cvt_pk_bf16_f32 v151, v14, v15
    buffer_store_dwordx4 v[148:151], v137, s[8:11], s25 offen offset:1024 sc1
    v_cvt_pk_bf16_f32 v152, v16, v17
    v_cvt_pk_bf16_f32 v153, v18, v19
    v_cvt_pk_bf16_f32 v154, v20, v21
    v_cvt_pk_bf16_f32 v155, v22, v23
    buffer_store_dwordx4 v[152:155], v137, s[8:11], s25 offen offset:2048 sc1
    v_cvt_pk_bf16_f32 v156, v24, v25
    v_cvt_pk_bf16_f32 v157, v26, v27
    v_cvt_pk_bf16_f32 v158, v28, v29
    v_cvt_pk_bf16_f32 v159, v30, v31
    buffer_store_dwordx4 v[156:159], v137, s[8:11], s25 offen offset:3072 sc1
    v_cvt_pk_bf16_f32 v144, v32, v33
    v_cvt_pk_bf16_f32 v145, v34, v35
    v_cvt_pk_bf16_f32 v146, v36, v37
    v_cvt_pk_bf16_f32 v147, v38, v39
    s_add_u32 s25, s25, 4096
    buffer_store_dwordx4 v[144:147], v137, s[8:11], s25 offen sc1
    v_cvt_pk_bf16_f32 v148, v40, v41
    v_cvt_pk_bf16_f32 v149, v42, v43
    v_cvt_pk_bf16_f32 v150, v44, v45
    v_cvt_pk_bf16_f32 v151, v46, v47
    buffer_store_dwordx4 v[148:151], v137, s[8:11], s25 offen offset:1024 sc1
    v_cvt_pk_bf16_f32 v152, v48, v49
    v_cvt_pk_bf16_f32 v153, v50, v51
    v_cvt_pk_bf16_f32 v154, v52, v53
    v_cvt_pk_bf16_f32 v155, v54, v55
    buffer_store_dwordx4 v[152:155], v137, s[8:11], s25 offen offset:2048 sc1
    v_cvt_pk_bf16_f32 v156, v56, v57
    v_cvt_pk_bf16_f32 v157, v58, v59
    v_cvt_pk_bf16_f32 v158, v60, v61
    v_cvt_pk_bf16_f32 v159, v62, v63
    buffer_store_dwordx4 v[156:159], v137, s[8:11], s25 offen offset:3072 sc1
    s_cmp_lg_u32 s20, 15
    s_cbranch_scc1 L_p1_next
    v_mov_b32 v0, -1
    v_mov_b32 v1, -1
    v_mov_b32 v2, -1
    v_mov_b32 v3, -1
    s_sub_u32 s26, s25, 0x2001000
    s_lshr_b32 s26, s26, 1
    s_add_u32 s26, s26, 0x240000
    buffer_store_dwordx4 v[0:3], v137, s[8:11], s26 offen sc1
    buffer_store_dwordx4 v[0:3], v137, s[8:11], s26 offen offset:1024 sc1
    buffer_store_dwordx4 v[0:3], v137, s[8:11], s26 offen offset:2048 sc1
    buffer_store_dwordx4 v[0:3], v137, s[8:11], s26 offen offset:3072 sc1
    s_nop 1
L_p1_next:
    s_add_u32 s80, s80, 1
    s_lshl_b32 s40, s38, 4
    s_add_u32 s40, s40, s20
    s_lshl_b32 s40, s40, 2
    s_add_u32 s40, s40, 0x2000
    s_sub_u32 s44, s25, 4095
    s_add_u32 s38, s38, s37
    s_branch L_p1_unit
L_p1_end:
    s_waitcnt vmcnt(0)
    s_barrier
    s_cmp_eq_u32 s40, 0
    s_cbranch_scc1 L_nopf_102
    s_cmp_lg_u32 s87, 0
    s_cbranch_scc1 L_modeok_103
    v_readfirstlane_b32 s96, v140
    v_readfirstlane_b32 s97, v141
    s_nop 0
    s_cmp_lg_u32 s97, 0
    s_cselect_b32 s87, s96, 0
    s_cmp_eq_u32 s87, 1
    s_cbranch_scc1 L_modeok_103
    s_mov_b32 s96, 0
L_mode_104:
    buffer_load_dwordx2 v[140:141], off, s[92:95], 0 offset:36 sc1
    s_waitcnt vmcnt(0)
    v_readfirstlane_b32 s87, v140
    v_readfirstlane_b32 s97, v141
    s_nop 0
    s_min_u32 s97, s97, s87
    s_cmp_lg_u32 s97, 0
    s_cbranch_scc1 L_moded_105
    s_sleep 4
    s_add_u32 s96, s96, 1
    s_cmp_lg_u32 s96, 0x100
    s_cbranch_scc1 L_modef_106
    v_mov_b32 v140, 2
    v_mov_b32 v141, 0
    s_mov_b64 exec, 1
    buffer_atomic_cmpswap v[140:141], off, s[92:95], 0 offset:36
    s_mov_b64 exec, -1
L_modef_106:
    s_cmp_lt_u32 s96, 0x10000
    s_cbranch_scc1 L_mode_104
L_moded_105:
    s_cmp_lg_u32 s87, 1
    s_cbranch_scc1 L_fallback
L_modeok_103:
    s_cmp_lg_u32 s100, 0
    s_cbranch_scc1 L_flag_107
    v_mov_b32 v138, 1
    s_mov_b64 exec, 1
    buffer_store_dword v138, off, s[8:11], s40 sc1
    s_mov_b64 exec, -1
L_flag_107:
    s_mov_b32 s40, 0
L_nopf_102:
    s_cmp_lg_u32 s41, 0
    s_cbranch_scc1 L_p1done
    s_mov_b32 s41, 1
    s_mul_i32 s22, s101, 171
    s_lshr_b32 s22, s22, 11
    s_mul_i32 s26, s22, 12
    s_sub_u32 s20, s101, s26
    s_add_u32 s20, s20, 4
    s_mul_i32 s27, s101, 683
    s_lshr_b32 s27, s27, 11
    s_mul_i32 s26, s27, 3
    s_sub_u32 s26, s101, s26
    s_cmp_eq_u32 s26, 2
    s_cselect_b32 s28, 10, 11
    s_cmp_ge_u32 s101, 192
    s_cselect_b32 s20, s26, s20
    s_cselect_b32 s22, s27, s22
    s_cselect_b32 s37, s28, 16
    s_branch L_p1_pass
L_p1done:
    v_mbcnt_lo_u32_b32 v0, -1, 0
    v_mbcnt_hi_u32_b32 v0, -1, v0
    s_lshl_b32 s96, s100, 6
    v_add_u32 v0, s96, v0
    s_and_b32 s20, s101, 15
    s_lshr_b32 s22, s101, 4
    s_mov_b32 s23, 14
    v_mov_b32 v1, 0
    s_lshl_b32 s24, s20, 7
    s_add_u32 s24, s24, 0x1000
    s_mul_i32 s25, s22, 14
    s_lshr_b32 s25, s25, 4
    s_add_u32 s25, s25, 12
    s_cmp_lg_u32 s100, 0
    s_cbranch_scc1 L_polls_110
    s_mov_b32 exec_lo, 0x1
    s_mov_b32 exec_hi, 0
    s_mov_b32 s96, 0
L_poll_108:
    buffer_load_dword v2, v1, s[8:11], s24 offen sc1
    s_waitcnt vmcnt(0)
    v_cmp_gt_u32 vcc, s25, v2
    s_cbranch_vccz L_polld_109
    v_readfirstlane_b32 s97, v2
    s_nop 0
    s_sub_u32 s97, s25, s97
    s_cmp_lt_i32 s97, 3
    s_cbranch_scc1 L_near_111
    s_sleep 40
    s_cmp_lt_i32 s97, 5
    s_cbranch_scc1 L_near_111
    s_sleep 100
L_near_111:
    s_sleep 4
    s_add_u32 s96, s96, 1
    s_cmp_lt_u32 s96, 0x10000
    s_cbranch_scc1 L_poll_108
L_polld_109:
    s_mov_b64 exec, -1
L_polls_110:
    s_barrier
    s_load_dwordx2 s[12:13], s[0:1], 40
    s_waitcnt lgkmcnt(0)
    s_and_b32 s13, s13, 0xffff
    s_mov_b32 s14, 0x400000
    s_mov_b32 s15, 0x20000
    v_lshrrev_b32 v4, 6, v0
    s_nop 0
    v_readfirstlane_b32 s21, v4
    v_and_b32 v1, 63, v0
    v_lshrrev_b32 v2, 4, v1
    v_and_b32 v3, 15, v1
    v_lshrrev_b32 v6, 2, v3
    v_lshlrev_b32 v240, 4, v1
    v_lshlrev_b32 v241, 3, v1
    s_lshl_b32 s27, s21, 10
    s_lshl_b32 s24, s21, 5
    v_xor_b32 v4, s24, v240
    v_add_u32 v8, s27, v4
    v_xor_b32 v9, 128, v8
    v_lshl_add_u32 v4, v2, 2, v6
    v_and_b32 v5, 7, v4
    v_lshlrev_b32 v4, 10, v4
    v_lshl_add_u32 v4, v5, 5, v4
    v_and_b32 v5, 3, v3
    v_lshlrev_b32 v5, 4, v5
    v_xor_b32 v4, v5, v4
    s_lshl_b32 s24, s21, 8
    v_add_u32 v10, s24, v4
    s_lshl_b32 s25, s20, 18
    s_add_u32 s24, s25, 0x0
    s_add_u32 m0, s27, 0x0
    s_nop 0
    buffer_load_dwordx4 v8, s[12:15], s24 offen lds
    s_add_u32 s24, s25, 0x1000
    s_add_u32 m0, s27, 0x1000
    s_nop 0
    buffer_load_dwordx4 v9, s[12:15], s24 offen lds
    s_add_u32 s24, s25, 0x2000
    s_add_u32 m0, s27, 0x2000
    s_nop 0
    buffer_load_dwordx4 v8, s[12:15], s24 offen lds
    s_add_u32 s24, s25, 0x3000
    s_add_u32 m0, s27, 0x3000
    s_nop 0
    buffer_load_dwordx4 v9, s[12:15], s24 offen lds
    s_add_u32 s24, s25, 0x4000
    s_add_u32 m0, s27, 0x4000
    s_nop 0
    buffer_load_dwordx4 v8, s[12:15], s24 offen lds
    s_add_u32 s24, s25, 0x5000
    s_add_u32 m0, s27, 0x5000
    s_nop 0
    buffer_load_dwordx4 v9, s[12:15], s24 offen lds
    s_add_u32 s24, s25, 0x6000
    s_add_u32 m0, s27, 0x6000
    s_nop 0
    buffer_load_dwordx4 v8, s[12:15], s24 offen lds
    s_add_u32 s24, s25, 0x7000
    s_add_u32 m0, s27, 0x7000
    s_nop 0
    buffer_load_dwordx4 v9, s[12:15], s24 offen lds
    s_add_u32 s24, s25, 0x8000
    s_add_u32 m0, s27, 0x8000
    s_nop 0
    buffer_load_dwordx4 v8, s[12:15], s24 offen lds
    s_add_u32 s24, s25, 0x9000
    s_add_u32 m0, s27, 0x9000
    s_nop 0
    buffer_load_dwordx4 v9, s[12:15], s24 offen lds
    s_add_u32 s24, s25, 0xa000
    s_add_u32 m0, s27, 0xa000
    s_nop 0
    buffer_load_dwordx4 v8, s[12:15], s24 offen lds
    s_add_u32 s24, s25, 0xb000
    s_add_u32 m0, s27, 0xb000
    s_nop 0
    buffer_load_dwordx4 v9, s[12:15], s24 offen lds
    s_add_u32 s24, s25, 0xc000
    s_add_u32 m0, s27, 0xc000
    s_nop 0
    buffer_load_dwordx4 v8, s[12:15], s24 offen lds
    s_add_u32 s24, s25, 0xd000
    s_add_u32 m0, s27, 0xd000
    s_nop 0
    buffer_load_dwordx4 v9, s[12:15], s24 offen lds
    s_add_u32 s24, s25, 0xe000
    s_add_u32 m0, s27, 0xe000
    s_nop 0
    buffer_load_dwordx4 v8, s[12:15], s24 offen lds
    s_add_u32 s24, s25, 0xf000
    s_add_u32 m0, s27, 0xf000
    s_nop 0
    buffer_load_dwordx4 v9, s[12:15], s24 offen lds
    s_add_u32 s24, s25, 0x10000
    s_add_u32 m0, s27, 0x10000
    s_nop 0
    buffer_load_dwordx4 v8, s[12:15], s24 offen lds
    s_add_u32 s24, s25, 0x11000
    s_add_u32 m0, s27, 0x11000
    s_nop 0
    buffer_load_dwordx4 v9, s[12:15], s24 offen lds
    s_add_u32 s24, s25, 0x12000
    s_add_u32 m0, s27, 0x12000
    s_nop 0
    buffer_load_dwordx4 v8, s[12:15], s24 offen lds
    s_add_u32 s24, s25, 0x13000
    s_add_u32 m0, s27, 0x13000
    s_nop 0
    buffer_load_dwordx4 v9, s[12:15], s24 offen lds
    s_add_u32 s24, s25, 0x14000
    s_add_u32 m0, s27, 0x14000
    s_nop 0
    buffer_load_dwordx4 v8, s[12:15], s24 offen lds
    s_add_u32 s24, s25, 0x15000
    s_add_u32 m0, s27, 0x15000
    s_nop 0
    buffer_load_dwordx4 v9, s[12:15], s24 offen lds
    s_add_u32 s24, s25, 0x16000
    s_add_u32 m0, s27, 0x16000
    s_nop 0
    buffer_load_dwordx4 v8, s[12:15], s24 offen lds
    s_add_u32 s24, s25, 0x17000
    s_add_u32 m0, s27, 0x17000
    s_nop 0
    buffer_load_dwordx4 v9, s[12:15], s24 offen lds
    s_add_u32 s24, s25, 0x18000
    s_add_u32 m0, s27, 0x18000
    s_nop 0
    buffer_load_dwordx4 v8, s[12:15], s24 offen lds
    s_add_u32 s24, s25, 0x19000
    s_add_u32 m0, s27, 0x19000
    s_nop 0
    buffer_load_dwordx4 v9, s[12:15], s24 offen lds
    s_add_u32 s24, s25, 0x1a000
    s_add_u32 m0, s27, 0x1a000
    s_nop 0
    buffer_load_dwordx4 v8, s[12:15], s24 offen lds
    s_add_u32 s24, s25, 0x1b000
    s_add_u32 m0, s27, 0x1b000
    s_nop 0
    buffer_load_dwordx4 v9, s[12:15], s24 offen lds
    s_add_u32 s24, s25, 0x1c000
    s_add_u32 m0, s27, 0x1c000
    s_nop 0
    buffer_load_dwordx4 v8, s[12:15], s24 offen lds
    s_add_u32 s24, s25, 0x1d000
    s_add_u32 m0, s27, 0x1d000
    s_nop 0
    buffer_load_dwordx4 v9, s[12:15], s24 offen lds
    s_add_u32 s24, s25, 0x1e000
    s_add_u32 m0, s27, 0x1e000
    s_nop 0
    buffer_load_dwordx4 v8, s[12:15], s24 offen lds
    s_add_u32 s24, s25, 0x1f000
    s_add_u32 m0, s27, 0x1f000
    s_nop 0
    buffer_load_dwordx4 v9, s[12:15], s24 offen lds
    s_waitcnt vmcnt(0)
    s_barrier
    v_xor_b32 v11, 0x0, v10
    ds_read_b64_tr_b16 a[0:1], v11
    ds_read_b64_tr_b16 a[2:3], v11 offset:16384
    ds_read_b64_tr_b16 a[32:33], v11 offset:32768
    ds_read_b64_tr_b16 a[34:35], v11 offset:49152
    v_xor_b32 v11, 0x8, v10
    ds_read_b64_tr_b16 a[4:5], v11
    ds_read_b64_tr_b16 a[6:7], v11 offset:16384
    ds_read_b64_tr_b16 a[36:37], v11 offset:32768
    ds_read_b64_tr_b16 a[38:39], v11 offset:49152
    s_waitcnt lgkmcnt(0)
    v_xor_b32 v11, 0x40, v10
    ds_read_b64_tr_b16 a[8:9], v11
    ds_read_b64_tr_b16 a[10:11], v11 offset:16384
    ds_read_b64_tr_b16 a[40:41], v11 offset:32768
    ds_read_b64_tr_b16 a[42:43], v11 offset:49152
    v_xor_b32 v11, 0x48, v10
    ds_read_b64_tr_b16 a[12:13], v11
    ds_read_b64_tr_b16 a[14:15], v11 offset:16384
    ds_read_b64_tr_b16 a[44:45], v11 offset:32768
    ds_read_b64_tr_b16 a[46:47], v11 offset:49152
    s_waitcnt lgkmcnt(0)
    v_xor_b32 v11, 0x80, v10
    ds_read_b64_tr_b16 a[16:17], v11
    ds_read_b64_tr_b16 a[18:19], v11 offset:16384
    ds_read_b64_tr_b16 a[48:49], v11 offset:32768
    ds_read_b64_tr_b16 a[50:51], v11 offset:49152
    v_xor_b32 v11, 0x88, v10
    ds_read_b64_tr_b16 a[20:21], v11
    ds_read_b64_tr_b16 a[22:23], v11 offset:16384
    ds_read_b64_tr_b16 a[52:53], v11 offset:32768
    ds_read_b64_tr_b16 a[54:55], v11 offset:49152
    s_waitcnt lgkmcnt(0)
    v_xor_b32 v11, 0xc0, v10
    ds_read_b64_tr_b16 a[24:25], v11
    ds_read_b64_tr_b16 a[26:27], v11 offset:16384
    ds_read_b64_tr_b16 a[56:57], v11 offset:32768
    ds_read_b64_tr_b16 a[58:59], v11 offset:49152
    v_xor_b32 v11, 0xc8, v10
    ds_read_b64_tr_b16 a[28:29], v11
    ds_read_b64_tr_b16 a[30:31], v11 offset:16384
    ds_read_b64_tr_b16 a[60:61], v11 offset:32768
    ds_read_b64_tr_b16 a[62:63], v11 offset:49152
    s_waitcnt lgkmcnt(0)
    v_xor_b32 v11, 0x10000, v10
    ds_read_b64_tr_b16 a[64:65], v11
    ds_read_b64_tr_b16 a[66:67], v11 offset:16384
    ds_read_b64_tr_b16 a[96:97], v11 offset:32768
    ds_read_b64_tr_b16 a[98:99], v11 offset:49152
    v_xor_b32 v11, 0x10008, v10
    ds_read_b64_tr_b16 a[68:69], v11
    ds_read_b64_tr_b16 a[70:71], v11 offset:16384
    ds_read_b64_tr_b16 a[100:101], v11 offset:32768
    ds_read_b64_tr_b16 a[102:103], v11 offset:49152
    s_waitcnt lgkmcnt(0)
    v_xor_b32 v11, 0x10040, v10
    ds_read_b64_tr_b16 a[72:73], v11
    ds_read_b64_tr_b16 a[74:75], v11 offset:16384
    ds_read_b64_tr_b16 a[104:105], v11 offset:32768
    ds_read_b64_tr_b16 a[106:107], v11 offset:49152
    v_xor_b32 v11, 0x10048, v10
    ds_read_b64_tr_b16 a[76:77], v11
    ds_read_b64_tr_b16 a[78:79], v11 offset:16384
    ds_read_b64_tr_b16 a[108:109], v11 offset:32768
    ds_read_b64_tr_b16 a[110:111], v11 offset:49152
    s_waitcnt lgkmcnt(0)
    v_xor_b32 v11, 0x10080, v10
    ds_read_b64_tr_b16 a[80:81], v11
    ds_read_b64_tr_b16 a[82:83], v11 offset:16384
    ds_read_b64_tr_b16 a[112:113], v11 offset:32768
    ds_read_b64_tr_b16 a[114:115], v11 offset:49152
    v_xor_b32 v11, 0x10088, v10
    ds_read_b64_tr_b16 a[84:85], v11
    ds_read_b64_tr_b16 a[86:87], v11 offset:16384
    ds_read_b64_tr_b16 a[116:117], v11 offset:32768
    ds_read_b64_tr_b16 a[118:119], v11 offset:49152
    s_waitcnt lgkmcnt(0)
    v_xor_b32 v11, 0x100c0, v10
    ds_read_b64_tr_b16 a[88:89], v11
    ds_read_b64_tr_b16 a[90:91], v11 offset:16384
    ds_read_b64_tr_b16 a[120:121], v11 offset:32768
    ds_read_b64_tr_b16 a[122:123], v11 offset:49152
    v_xor_b32 v11, 0x100c8, v10
    ds_read_b64_tr_b16 a[92:93], v11
    ds_read_b64_tr_b16 a[94:95], v11 offset:16384
    ds_read_b64_tr_b16 a[124:125], v11 offset:32768
    ds_read_b64_tr_b16 a[126:127], v11 offset:49152
    s_waitcnt lgkmcnt(0)
    s_barrier
    s_lshl_b32 s25, s20, 18
    s_add_u32 s24, s25, 0x20000
    s_add_u32 m0, s27, 0x0
    s_nop 0
    buffer_load_dwordx4 v8, s[12:15], s24 offen lds
    s_add_u32 s24, s25, 0x21000
    s_add_u32 m0, s27, 0x1000
    s_nop 0
    buffer_load_dwordx4 v9, s[12:15], s24 offen lds
    s_add_u32 s24, s25, 0x22000
    s_add_u32 m0, s27, 0x2000
    s_nop 0
    buffer_load_dwordx4 v8, s[12:15], s24 offen lds
    s_add_u32 s24, s25, 0x23000
    s_add_u32 m0, s27, 0x3000
    s_nop 0
    buffer_load_dwordx4 v9, s[12:15], s24 offen lds
    s_add_u32 s24, s25, 0x24000
    s_add_u32 m0, s27, 0x4000
    s_nop 0
    buffer_load_dwordx4 v8, s[12:15], s24 offen lds
    s_add_u32 s24, s25, 0x25000
    s_add_u32 m0, s27, 0x5000
    s_nop 0
    buffer_load_dwordx4 v9, s[12:15], s24 offen lds
    s_add_u32 s24, s25, 0x26000
    s_add_u32 m0, s27, 0x6000
    s_nop 0
    buffer_load_dwordx4 v8, s[12:15], s24 offen lds
    s_add_u32 s24, s25, 0x27000
    s_add_u32 m0, s27, 0x7000
    s_nop 0
    buffer_load_dwordx4 v9, s[12:15], s24 offen lds
    s_add_u32 s24, s25, 0x28000
    s_add_u32 m0, s27, 0x8000
    s_nop 0
    buffer_load_dwordx4 v8, s[12:15], s24 offen lds
    s_add_u32 s24, s25, 0x29000
    s_add_u32 m0, s27, 0x9000
    s_nop 0
    buffer_load_dwordx4 v9, s[12:15], s24 offen lds
    s_add_u32 s24, s25, 0x2a000
    s_add_u32 m0, s27, 0xa000
    s_nop 0
    buffer_load_dwordx4 v8, s[12:15], s24 offen lds
    s_add_u32 s24, s25, 0x2b000
    s_add_u32 m0, s27, 0xb000
    s_nop 0
    buffer_load_dwordx4 v9, s[12:15], s24 offen lds
    s_add_u32 s24, s25, 0x2c000
    s_add_u32 m0, s27, 0xc000
    s_nop 0
    buffer_load_dwordx4 v8, s[12:15], s24 offen lds
    s_add_u32 s24, s25, 0x2d000
    s_add_u32 m0, s27, 0xd000
    s_nop 0
    buffer_load_dwordx4 v9, s[12:15], s24 offen lds
    s_add_u32 s24, s25, 0x2e000
    s_add_u32 m0, s27, 0xe000
    s_nop 0
    buffer_load_dwordx4 v8, s[12:15], s24 offen lds
    s_add_u32 s24, s25, 0x2f000
    s_add_u32 m0, s27, 0xf000
    s_nop 0
    buffer_load_dwordx4 v9, s[12:15], s24 offen lds
    s_add_u32 s24, s25, 0x30000
    s_add_u32 m0, s27, 0x10000
    s_nop 0
    buffer_load_dwordx4 v8, s[12:15], s24 offen lds
    s_add_u32 s24, s25, 0x31000
    s_add_u32 m0, s27, 0x11000
    s_nop 0
    buffer_load_dwordx4 v9, s[12:15], s24 offen lds
    s_add_u32 s24, s25, 0x32000
    s_add_u32 m0, s27, 0x12000
    s_nop 0
    buffer_load_dwordx4 v8, s[12:15], s24 offen lds
    s_add_u32 s24, s25, 0x33000
    s_add_u32 m0, s27, 0x13000
    s_nop 0
    buffer_load_dwordx4 v9, s[12:15], s24 offen lds
    s_add_u32 s24, s25, 0x34000
    s_add_u32 m0, s27, 0x14000
    s_nop 0
    buffer_load_dwordx4 v8, s[12:15], s24 offen lds
    s_add_u32 s24, s25, 0x35000
    s_add_u32 m0, s27, 0x15000
    s_nop 0
    buffer_load_dwordx4 v9, s[12:15], s24 offen lds
    s_add_u32 s24, s25, 0x36000
    s_add_u32 m0, s27, 0x16000
    s_nop 0
    buffer_load_dwordx4 v8, s[12:15], s24 offen lds
    s_add_u32 s24, s25, 0x37000
    s_add_u32 m0, s27, 0x17000
    s_nop 0
    buffer_load_dwordx4 v9, s[12:15], s24 offen lds
    s_add_u32 s24, s25, 0x38000
    s_add_u32 m0, s27, 0x18000
    s_nop 0
    buffer_load_dwordx4 v8, s[12:15], s24 offen lds
    s_add_u32 s24, s25, 0x39000
    s_add_u32 m0, s27, 0x19000
    s_nop 0
    buffer_load_dwordx4 v9, s[12:15], s24 offen lds
    s_add_u32 s24, s25, 0x3a000
    s_add_u32 m0, s27, 0x1a000
    s_nop 0
    buffer_load_dwordx4 v8, s[12:15], s24 offen lds
    s_add_u32 s24, s25, 0x3b000
    s_add_u32 m0, s27, 0x1b000
    s_nop 0
    buffer_load_dwordx4 v9, s[12:15], s24 offen lds
    s_add_u32 s24, s25, 0x3c000
    s_add_u32 m0, s27, 0x1c000
    s_nop 0
    buffer_load_dwordx4 v8, s[12:15], s24 offen lds
    s_add_u32 s24, s25, 0x3d000
    s_add_u32 m0, s27, 0x1d000
    s_nop 0
    buffer_load_dwordx4 v9, s[12:15], s24 offen lds
    s_add_u32 s24, s25, 0x3e000
    s_add_u32 m0, s27, 0x1e000
    s_nop 0
    buffer_load_dwordx4 v8, s[12:15], s24 offen lds
    s_add_u32 s24, s25, 0x3f000
    s_add_u32 m0, s27, 0x1f000
    s_nop 0
    buffer_load_dwordx4 v9, s[12:15], s24 offen lds
    s_waitcnt vmcnt(0)
    s_barrier
    v_xor_b32 v11, 0x0, v10
    ds_read_b64_tr_b16 a[128:129], v11
    ds_read_b64_tr_b16 a[130:131], v11 offset:16384
    ds_read_b64_tr_b16 a[160:161], v11 offset:32768
    ds_read_b64_tr_b16 a[162:163], v11 offset:49152
    v_xor_b32 v11, 0x8, v10
    ds_read_b64_tr_b16 a[132:133], v11
    ds_read_b64_tr_b16 a[134:135], v11 offset:16384
    ds_read_b64_tr_b16 a[164:165], v11 offset:32768
    ds_read_b64_tr_b16 a[166:167], v11 offset:49152
    s_waitcnt lgkmcnt(0)
    v_xor_b32 v11, 0x40, v10
    ds_read_b64_tr_b16 a[136:137], v11
    ds_read_b64_tr_b16 a[138:139], v11 offset:16384
    ds_read_b64_tr_b16 a[168:169], v11 offset:32768
    ds_read_b64_tr_b16 a[170:171], v11 offset:49152
    v_xor_b32 v11, 0x48, v10
    ds_read_b64_tr_b16 a[140:141], v11
    ds_read_b64_tr_b16 a[142:143], v11 offset:16384
    ds_read_b64_tr_b16 a[172:173], v11 offset:32768
    ds_read_b64_tr_b16 a[174:175], v11 offset:49152
    s_waitcnt lgkmcnt(0)
    v_xor_b32 v11, 0x80, v10
    ds_read_b64_tr_b16 a[144:145], v11
    ds_read_b64_tr_b16 a[146:147], v11 offset:16384
    ds_read_b64_tr_b16 a[176:177], v11 offset:32768
    ds_read_b64_tr_b16 a[178:179], v11 offset:49152
    v_xor_b32 v11, 0x88, v10
    ds_read_b64_tr_b16 a[148:149], v11
    ds_read_b64_tr_b16 a[150:151], v11 offset:16384
    ds_read_b64_tr_b16 a[180:181], v11 offset:32768
    ds_read_b64_tr_b16 a[182:183], v11 offset:49152
    s_waitcnt lgkmcnt(0)
    v_xor_b32 v11, 0xc0, v10
    ds_read_b64_tr_b16 a[152:153], v11
    ds_read_b64_tr_b16 a[154:155], v11 offset:16384
    ds_read_b64_tr_b16 a[184:185], v11 offset:32768
    ds_read_b64_tr_b16 a[186:187], v11 offset:49152
    v_xor_b32 v11, 0xc8, v10
    ds_read_b64_tr_b16 a[156:157], v11
    ds_read_b64_tr_b16 a[158:159], v11 offset:16384
    ds_read_b64_tr_b16 a[188:189], v11 offset:32768
    ds_read_b64_tr_b16 a[190:191], v11 offset:49152
    s_waitcnt lgkmcnt(0)
    v_xor_b32 v11, 0x10000, v10
    ds_read_b64_tr_b16 a[192:193], v11
    ds_read_b64_tr_b16 a[194:195], v11 offset:16384
    ds_read_b64_tr_b16 a[224:225], v11 offset:32768
    ds_read_b64_tr_b16 a[226:227], v11 offset:49152
    v_xor_b32 v11, 0x10008, v10
    ds_read_b64_tr_b16 a[196:197], v11
    ds_read_b64_tr_b16 a[198:199], v11 offset:16384
    ds_read_b64_tr_b16 a[228:229], v11 offset:32768
    ds_read_b64_tr_b16 a[230:231], v11 offset:49152
    s_waitcnt lgkmcnt(0)
    v_xor_b32 v11, 0x10040, v10
    ds_read_b64_tr_b16 a[200:201], v11
    ds_read_b64_tr_b16 a[202:203], v11 offset:16384
    ds_read_b64_tr_b16 a[232:233], v11 offset:32768
    ds_read_b64_tr_b16 a[234:235], v11 offset:49152
    v_xor_b32 v11, 0x10048, v10
    ds_read_b64_tr_b16 a[204:205], v11
    ds_read_b64_tr_b16 a[206:207], v11 offset:16384
    ds_read_b64_tr_b16 a[236:237], v11 offset:32768
    ds_read_b64_tr_b16 a[238:239], v11 offset:49152
    s_waitcnt lgkmcnt(0)
    v_xor_b32 v11, 0x10080, v10
    ds_read_b64_tr_b16 a[208:209], v11
    ds_read_b64_tr_b16 a[210:211], v11 offset:16384
    ds_read_b64_tr_b16 a[240:241], v11 offset:32768
    ds_read_b64_tr_b16 a[242:243], v11 offset:49152
    v_xor_b32 v11, 0x10088, v10
    ds_read_b64_tr_b16 a[212:213], v11
    ds_read_b64_tr_b16 a[214:215], v11 offset:16384
    ds_read_b64_tr_b16 a[244:245], v11 offset:32768
    ds_read_b64_tr_b16 a[246:247], v11 offset:49152
    s_waitcnt lgkmcnt(0)
    v_xor_b32 v11, 0x100c0, v10
    ds_read_b64_tr_b16 a[216:217], v11
    ds_read_b64_tr_b16 a[218:219], v11 offset:16384
    ds_read_b64_tr_b16 a[248:249], v11 offset:32768
    ds_read_b64_tr_b16 a[250:251], v11 offset:49152
    v_xor_b32 v11, 0x100c8, v10
    ds_read_b64_tr_b16 a[220:221], v11
    ds_read_b64_tr_b16 a[222:223], v11 offset:16384
    ds_read_b64_tr_b16 a[252:253], v11 offset:32768
    ds_read_b64_tr_b16 a[254:255], v11 offset:49152
    s_waitcnt lgkmcnt(0)
    s_barrier
    s_and_b32 s24, s21, 1
    s_lshl_b32 s24, s24, 4
    v_add_u32 v4, s24, v3
    v_lshlrev_b32 v5, 2, v2
    v_sub_u32 v4, v4, v5
    v_cmp_le_i32 s[30:31], 0, v4
    v_cmp_le_i32 s[32:33], 1, v4
    v_cmp_le_i32 s[34:35], 2, v4
    v_cmp_le_i32 s[36:37], 3, v4
    v_cmp_le_i32 s[38:39], 16, v4
    v_cmp_le_i32 s[40:41], 17, v4
    v_cmp_le_i32 s[42:43], 18, v4
    v_cmp_le_i32 s[44:45], 19, v4
    s_mov_b32 s28, 0x3e0293ee
    s_mov_b32 s29, 0x3e0293ee
    s_mov_b32 s53, 0xff000000
    v_mov_b32 v136, 0x3f803f80
    v_mov_b32 v137, 0x3f803f80
    v_mov_b32 v138, 0x3f803f80
    v_mov_b32 v139, 0x3f803f80
    v_lshlrev_b32 v4, 10, v3
    v_lshl_add_u32 v4, v2, 4, v4
    s_lshl_b32 s24, s21, 8
    v_add_u32 v242, s24, v4
    s_lshl_b32 s24, s21, 12
    v_add_u32 v243, s24, v240
    v_mov_b32 v244, v240
    s_add_u32 s24, s24, 0x22000
    v_xor_b32 v7, v2, v6
    v_lshl_add_u32 v4, v2, 4, v7
    v_and_b32 v5, 3, v3
    v_lshl_add_u32 v4, v4, 2, v5
    v_lshl_add_u32 v253, v4, 2, s24
    v_lshl_add_u32 v4, v3, 2, v7
    v_lshl_add_u32 v254, v4, 4, s24
    s_load_dwordx2 s[12:13], s[0:1], 0
    s_waitcnt lgkmcnt(0)
    s_and_b32 s13, s13, 0xffff
    s_mov_b32 s14, 0x200000
    s_mov_b32 s15, 0x20000
    s_load_dwordx2 s[16:17], s[0:1], 96
    s_waitcnt lgkmcnt(0)
    s_and_b32 s17, s17, 0xffff
    s_mov_b32 s18, 0x200000
    s_mov_b32 s19, 0x20000
    s_load_dwordx2 s[56:57], s[0:1], 64
    s_waitcnt lgkmcnt(0)
    s_and_b32 s57, s57, 0xffff
    s_mov_b32 s58, 0x400
    s_mov_b32 s59, 0x20000
    v_and_b32 v100, 63, v0
    v_lshlrev_b32 v240, 4, v100
    buffer_load_dwordx4 v[236:239], v240, s[56:59], 0 offen
    s_mov_b32 s65, 0x3f80
    s_mov_b32 s66, 0x3f800000
    s_waitcnt vmcnt(0)
    s_sub_u32 s67, s101, 128
    s_cmp_ge_u32 s67, 56
    s_cbranch_scc1 L_nostage_112
L_nostage_112:
    v_lshrrev_b32 v246, 2, v240
    s_lshl_b32 s24, s20, 7
    s_add_u32 s24, s24, 0x2000
    s_cmp_lg_u32 s100, 0
    s_cbranch_scc1 L_polls_115
    s_mov_b32 exec_lo, 0xffffffff
    s_mov_b32 exec_hi, 0
    s_mov_b32 s96, 0
L_poll_113:
    buffer_load_dword v247, v246, s[8:11], s24 offen sc1
    s_waitcnt vmcnt(0)
    v_cmp_gt_u32 vcc, 1, v247
    s_cbranch_vccz L_polld_114
    s_sleep 32
    s_add_u32 s96, s96, 1
    s_cmp_lt_u32 s96, 0x10000
    s_cbranch_scc1 L_poll_113
L_polld_114:
    s_mov_b64 exec, -1
L_polls_115:
    s_barrier
    s_lshl_b32 s24, s20, 7
    s_add_u32 s24, s24, 0x2800
    s_cmp_lg_u32 s100, 0
    s_cbranch_scc1 L_polls_118
    s_mov_b32 exec_lo, 0xffffffff
    s_mov_b32 exec_hi, 0
    s_mov_b32 s96, 0
L_poll_116:
    buffer_load_dword v247, v246, s[8:11], s24 offen sc1
    s_waitcnt vmcnt(0)
    v_cmp_gt_u32 vcc, 1, v247
    s_cbranch_vccz L_polld_117
    s_sleep 32
    s_add_u32 s96, s96, 1
    s_cmp_lt_u32 s96, 0x10000
    s_cbranch_scc1 L_poll_116
L_polld_117:
    s_mov_b64 exec, -1
L_polls_118:
    s_barrier
    s_lshl_b32 s24, s20, 7
    s_add_u32 s24, s24, 0x3000
    s_cmp_lg_u32 s100, 0
    s_cbranch_scc1 L_polls_121
    s_mov_b32 exec_lo, 0xffffffff
    s_mov_b32 exec_hi, 0
    s_mov_b32 s96, 0
L_poll_119:
    buffer_load_dword v247, v246, s[8:11], s24 offen sc1
    s_waitcnt vmcnt(0)
    v_cmp_gt_u32 vcc, 1, v247
    s_cbranch_vccz L_polld_120
    s_sleep 32
    s_add_u32 s96, s96, 1
    s_cmp_lt_u32 s96, 0x10000
    s_cbranch_scc1 L_poll_119
L_polld_120:
    s_mov_b64 exec, -1
L_polls_121:
    s_barrier
    s_mov_b32 s80, 0
    s_mov_b32 s82, 0
L_p2_seg:
    s_cmp_ge_u32 s22, 64
    s_cbranch_scc1 L_p2_end
    v_lshrrev_b32 v246, 2, v240
    s_lshl_b32 s24, s20, 7
    s_add_u32 s24, s24, 0x1000
    s_mul_i32 s25, s22, 10
    s_lshr_b32 s25, s25, 4
    s_add_u32 s25, s25, 17
    s_cmp_lg_u32 s100, 0
    s_cbranch_scc1 L_polls_124
    s_mov_b32 exec_lo, 0x1
    s_mov_b32 exec_hi, 0
    s_mov_b32 s96, 0
L_poll_122:
    buffer_load_dword v247, v246, s[8:11], s24 offen sc1
    s_waitcnt vmcnt(0)
    v_cmp_gt_u32 vcc, s25, v247
    s_cbranch_vccz L_polld_123
    v_readfirstlane_b32 s97, v247
    s_nop 0
    s_sub_u32 s97, s25, s97
    s_cmp_lt_i32 s97, 3
    s_cbranch_scc1 L_near_125
    s_sleep 40
    s_cmp_lt_i32 s97, 5
    s_cbranch_scc1 L_near_125
    s_sleep 100
L_near_125:
    s_sleep 4
    s_add_u32 s96, s96, 1
    s_cmp_lt_u32 s96, 0x10000
    s_cbranch_scc1 L_poll_122
L_polld_123:
    s_mov_b64 exec, -1
L_polls_124:
    s_barrier
    s_cmp_ge_u32 s67, 56
    s_cbranch_scc1 L_nostage_126
    v_mbcnt_lo_u32_b32 v0, -1, 0
    v_mbcnt_hi_u32_b32 v0, -1, v0
    s_lshl_b32 s96, s100, 6
    v_add_u32 v0, s96, v0
    v_lshrrev_b32 v2, 6, v0
    s_nop 0
    v_readfirstlane_b32 s68, v2
    v_and_b32 v1, 63, v0
    s_lshl_b32 s73, s68, 10
    v_lshrrev_b32 v2, 2, v1
    s_lshl_b32 s71, s68, 4
    v_add_u32 v2, s71, v2
    s_movk_i32 s71, 3584
    v_mul_lo_u32 v2, v2, s71
    v_and_b32 v3, 3, v1
    v_lshl_add_u32 v4, v3, 4, v2
    s_cmp_lg_u32 s80, 0
    s_cbranch_scc1 L_part_127
    s_load_dwordx2 s[76:77], s[0:1], 72
    s_waitcnt lgkmcnt(0)
    s_and_b32 s77, s77, 0xffff
    s_mov_b32 s78, 0x1c0000
    s_mov_b32 s79, 0x20000
    s_lshl_b32 s71, s67, 6
    s_add_u32 s71, s71, 0x0
    s_add_u32 m0, s73, 0x8000
    s_nop 0
    buffer_load_dwordx4 v4, s[76:79], s71 offen lds
    s_lshl_b32 s71, s67, 6
    s_add_u32 s71, s71, 0x38000
    s_add_u32 m0, s73, 0x9000
    s_nop 0
    buffer_load_dwordx4 v4, s[76:79], s71 offen lds
    s_lshl_b32 s71, s67, 6
    s_add_u32 s71, s71, 0x70000
    s_add_u32 m0, s73, 0xa000
    s_nop 0
    buffer_load_dwordx4 v4, s[76:79], s71 offen lds
    s_lshl_b32 s71, s67, 6
    s_add_u32 s71, s71, 0xa8000
    s_add_u32 m0, s73, 0xb000
    s_nop 0
    buffer_load_dwordx4 v4, s[76:79], s71 offen lds
    s_lshl_b32 s71, s67, 6
    s_add_u32 s71, s71, 0xe0000
    s_add_u32 m0, s73, 0xc000
    s_nop 0
    buffer_load_dwordx4 v4, s[76:79], s71 offen lds
    s_lshl_b32 s71, s67, 6
    s_add_u32 s71, s71, 0x118000
    s_add_u32 m0, s73, 0xd000
    s_nop 0
    buffer_load_dwordx4 v4, s[76:79], s71 offen lds
    s_lshl_b32 s71, s67, 6
    s_add_u32 s71, s71, 0x150000
    s_add_u32 m0, s73, 0xe000
    s_nop 0
    buffer_load_dwordx4 v4, s[76:79], s71 offen lds
    s_lshl_b32 s71, s67, 6
    s_add_u32 s71, s71, 0x188000
    s_add_u32 m0, s73, 0xf000
    s_nop 0
    buffer_load_dwordx4 v4, s[76:79], s71 offen lds
L_part_127:
    s_cmp_lg_u32 s80, 4
    s_cbranch_scc1 L_part_128
    s_load_dwordx2 s[76:77], s[0:1], 80
    s_waitcnt lgkmcnt(0)
    s_and_b32 s77, s77, 0xffff
    s_mov_b32 s78, 0x1c0000
    s_mov_b32 s79, 0x20000
    s_lshl_b32 s71, s67, 6
    s_add_u32 s71, s71, 0x0
    s_add_u32 m0, s73, 0x10000
    s_nop 0
    buffer_load_dwordx4 v4, s[76:79], s71 offen lds
    s_lshl_b32 s71, s67, 6
    s_add_u32 s71, s71, 0x38000
    s_add_u32 m0, s73, 0x11000
    s_nop 0
    buffer_load_dwordx4 v4, s[76:79], s71 offen lds
    s_lshl_b32 s71, s67, 6
    s_add_u32 s71, s71, 0x70000
    s_add_u32 m0, s73, 0x12000
    s_nop 0
    buffer_load_dwordx4 v4, s[76:79], s71 offen lds
    s_lshl_b32 s71, s67, 6
    s_add_u32 s71, s71, 0xa8000
    s_add_u32 m0, s73, 0x13000
    s_nop 0
    buffer_load_dwordx4 v4, s[76:79], s71 offen lds
    s_lshl_b32 s71, s67, 6
    s_add_u32 s71, s71, 0xe0000
    s_add_u32 m0, s73, 0x14000
    s_nop 0
    buffer_load_dwordx4 v4, s[76:79], s71 offen lds
    s_lshl_b32 s71, s67, 6
    s_add_u32 s71, s71, 0x118000
    s_add_u32 m0, s73, 0x15000
    s_nop 0
    buffer_load_dwordx4 v4, s[76:79], s71 offen lds
    s_lshl_b32 s71, s67, 6
    s_add_u32 s71, s71, 0x150000
    s_add_u32 m0, s73, 0x16000
    s_nop 0
    buffer_load_dwordx4 v4, s[76:79], s71 offen lds
    s_lshl_b32 s71, s67, 6
    s_add_u32 s71, s71, 0x188000
    s_add_u32 m0, s73, 0x17000
    s_nop 0
    buffer_load_dwordx4 v4, s[76:79], s71 offen lds
L_part_128:
    s_cmp_lg_u32 s80, 8
    s_cbranch_scc1 L_part_129
    s_load_dwordx2 s[76:77], s[0:1], 88
    s_waitcnt lgkmcnt(0)
    s_and_b32 s77, s77, 0xffff
    s_mov_b32 s78, 0x1c0000
    s_mov_b32 s79, 0x20000
    v_lshlrev_b32 v5, 4, v1
    v_add_u32 v5, s73, v5
    s_lshl_b32 s71, s67, 15
    s_add_u32 s71, s71, 0
    s_add_u32 m0, s73, 0x18000
    s_nop 0
    buffer_load_dwordx4 v5, s[76:79], s71 offen lds
    s_lshl_b32 s71, s67, 15
    s_add_u32 s71, s71, 4096
    s_add_u32 m0, s73, 0x19000
    s_nop 0
    buffer_load_dwordx4 v5, s[76:79], s71 offen lds
    s_lshl_b32 s71, s67, 15
    s_add_u32 s71, s71, 8192
    s_add_u32 m0, s73, 0x1a000
    s_nop 0
    buffer_load_dwordx4 v5, s[76:79], s71 offen lds
    s_lshl_b32 s71, s67, 15
    s_add_u32 s71, s71, 12288
    s_add_u32 m0, s73, 0x1b000
    s_nop 0
    buffer_load_dwordx4 v5, s[76:79], s71 offen lds
    s_lshl_b32 s71, s67, 15
    s_add_u32 s71, s71, 16384
    s_add_u32 m0, s73, 0x1c000
    s_nop 0
    buffer_load_dwordx4 v5, s[76:79], s71 offen lds
    s_lshl_b32 s71, s67, 15
    s_add_u32 s71, s71, 20480
    s_add_u32 m0, s73, 0x1d000
    s_nop 0
    buffer_load_dwordx4 v5, s[76:79], s71 offen lds
    s_lshl_b32 s71, s67, 15
    s_add_u32 s71, s71, 24576
    s_add_u32 m0, s73, 0x1e000
    s_nop 0
    buffer_load_dwordx4 v5, s[76:79], s71 offen lds
    s_lshl_b32 s71, s67, 15
    s_add_u32 s71, s71, 28672
    s_add_u32 m0, s73, 0x1f000
    s_nop 0
    buffer_load_dwordx4 v5, s[76:79], s71 offen lds
L_part_129:
L_nostage_126:
    s_lshl_b32 s24, s22, 5
    s_lshl_b32 s25, s20, 1
    s_add_u32 s24, s24, s25
    s_lshr_b32 s25, s21, 1
    s_add_u32 s24, s24, s25
    s_lshl_b32 s25, s24, 13
    s_add_u32 s47, s25, 0x1000000
    s_add_u32 s54, s47, 4096
    s_add_u32 s48, s25, 0x2000000
    s_add_u32 s55, s48, 4096
    s_and_b32 s26, s21, 1
    s_lshl_b32 s26, s26, 12
    s_add_u32 s46, s25, s26
    s_add_u32 s46, s46, 0x3000000
    s_lshl_b32 s25, s24, 12
    s_add_u32 s49, s25, 0x240000
    s_lshl_b32 s24, s22, 4
    s_add_u32 s24, s24, s20
    s_lshl_b32 s24, s24, 15
    s_add_u32 s51, s24, 0x4000000
    s_cmp_ge_u32 s22, 60
    s_cselect_b32 s81, 1, 0
    s_lshl_b32 s60, s20, 1
    s_and_b32 s24, s100, 1
    s_add_u32 s60, s60, s24
    s_cmp_ge_u32 s22, 62
    s_cselect_b32 s24, 1, 0
    s_max_u32 s82, s82, s24
    s_lshl_b32 s24, s82, 3
    s_and_b32 s24, s24, 16
    s_add_u32 s24, s24, s20
    s_cmp_lg_u32 s82, 0
    s_cselect_b32 s60, s24, s60
    s_lshl_b32 s24, s22, 5
    s_add_u32 s60, s60, s24
    s_lshl_b32 s64, s60, 10
    buffer_load_dwordx4 v[96:99], v240, s[12:15], s64 offen
    s_lshl_b32 s52, s22, 6
    s_add_u32 s52, s52, 0x4000
    s_lshl_b32 s24, s22, 7
    s_and_b32 s25, s82, 2
    s_lshl_b32 s25, s25, 7
    s_add_u32 s24, s24, s25
    s_add_u32 s24, s24, 0x6a00
    s_cmp_lg_u32 s81, 0
    s_cselect_b32 s52, s24, s52
    s_cmp_ge_u32 s22, 62
    s_cselect_b32 s83, s87, 0
    s_and_b32 s83, s83, 1
    s_cbranch_scc0 L_notouch_130
    buffer_load_dword v245, off, s[8:11], s52 sc1
    v_lshlrev_b32 v246, 3, v240
    s_lshl_b32 s24, s21, 13
    s_add_u32 s24, s24, s51
    buffer_load_dword v245, v246, s[8:11], s24 offen sc1
L_notouch_130:
    buffer_load_dwordx4 v[0:3], v240, s[8:11], s46 offen
    buffer_load_dwordx4 v[4:7], v240, s[8:11], s46 offen offset:1024
    buffer_load_dwordx4 v[8:11], v240, s[8:11], s46 offen offset:2048
    buffer_load_dwordx4 v[12:15], v240, s[8:11], s46 offen offset:3072
    buffer_load_dwordx4 v[16:19], v240, s[8:11], s47 offen
    buffer_load_dwordx4 v[20:23], v240, s[8:11], s47 offen offset:1024
    buffer_load_dwordx4 v[24:27], v240, s[8:11], s47 offen offset:2048
    buffer_load_dwordx4 v[28:31], v240, s[8:11], s47 offen offset:3072
    buffer_load_dwordx4 v[32:35], v240, s[8:11], s54 offen
    buffer_load_dwordx4 v[36:39], v240, s[8:11], s54 offen offset:1024
    buffer_load_dwordx4 v[40:43], v240, s[8:11], s54 offen offset:2048
    buffer_load_dwordx4 v[44:47], v240, s[8:11], s54 offen offset:3072
    buffer_load_dwordx4 v[64:67], v240, s[8:11], s48 offen
    buffer_load_dwordx4 v[68:71], v240, s[8:11], s48 offen offset:1024
    buffer_load_dwordx4 v[72:75], v240, s[8:11], s48 offen offset:2048
    buffer_load_dwordx4 v[76:79], v240, s[8:11], s48 offen offset:3072
    buffer_load_dwordx4 v[80:83], v240, s[8:11], s55 offen
    buffer_load_dwordx4 v[84:87], v240, s[8:11], s55 offen offset:1024
    buffer_load_dwordx4 v[88:91], v240, s[8:11], s55 offen offset:2048
    buffer_load_dwordx4 v[92:95], v240, s[8:11], s55 offen offset:3072
    s_waitcnt vmcnt(8)
    v_mfma_f32_16x16x32_bf16 v[116:119], v[16:19], v[0:3], 0
    v_mfma_f32_16x16x32_bf16 v[116:119], v[20:23], v[4:7], v[116:119]
    v_mfma_f32_16x16x32_bf16 v[116:119], v[24:27], v[8:11], v[116:119]
    v_mfma_f32_16x16x32_bf16 v[116:119], v[28:31], v[12:15], v[116:119]
    v_mfma_f32_16x16x32_bf16 v[120:123], v[32:35], v[0:3], 0
    v_mfma_f32_16x16x32_bf16 v[120:123], v[36:39], v[4:7], v[120:123]
    v_mfma_f32_16x16x32_bf16 v[120:123], v[40:43], v[8:11], v[120:123]
    v_mfma_f32_16x16x32_bf16 v[120:123], v[44:47], v[12:15], v[120:123]
    v_mov_b32 v247, s53
    v_cndmask_b32 v116, v247, v116, s[30:31]
    v_cndmask_b32 v117, v247, v117, s[32:33]
    v_cndmask_b32 v118, v247, v118, s[34:35]
    v_cndmask_b32 v119, v247, v119, s[36:37]
    s_nop 2
    v_cndmask_b32 v120, v247, v120, s[38:39]
    v_cndmask_b32 v121, v247, v121, s[40:41]
    v_cndmask_b32 v122, v247, v122, s[42:43]
    v_cndmask_b32 v123, v247, v123, s[44:45]
    v_max3_f32 v251, v116, v117, v118
    v_max3_f32 v251, v251, v119, v120
    v_max3_f32 v251, v251, v121, v122
    v_lshrrev_b32 v246, 2, v240
    s_lshl_b32 s24, s20, 7
    s_add_u32 s24, s24, 0x1000
    s_add_u32 s25, s22, 1
    s_sub_u32 s26, s22, 1
    s_min_u32 s26, s26, 61
    s_cmp_lg_u32 s81, 0
    s_cselect_b32 s25, s26, s25
    s_cmp_lg_u32 s100, 0
    s_cbranch_scc1 L_polls_133
    s_mov_b32 exec_lo, 0x11
    s_mov_b32 exec_hi, 0
    s_mov_b32 s96, 0
L_poll_131:
    buffer_load_dword v247, v246, s[8:11], s24 offen sc1
    s_waitcnt vmcnt(0)
    v_cmp_gt_u32 vcc, s25, v247
    s_cbranch_vccz L_polld_132
    v_readfirstlane_b32 s97, v247
    s_nop 0
    s_sub_u32 s97, s25, s97
    s_cmp_lt_i32 s97, 3
    s_cbranch_scc1 L_near_134
    s_sleep 40
    s_cmp_lt_i32 s97, 5
    s_cbranch_scc1 L_near_134
    s_sleep 100
L_near_134:
    s_sleep 4
    s_add_u32 s96, s96, 1
    s_cmp_lt_u32 s96, 0x10000
    s_cbranch_scc1 L_poll_131
L_polld_132:
    s_mov_b64 exec, -1
L_polls_133:
    s_barrier
    s_cmp_eq_u32 s81, 0
    s_cbranch_scc1 L_kmf_136
    s_lshr_b32 s26, s21, 1
    s_lshl_b32 s26, s26, 4
    s_add_u32 s24, s24, s26
    s_mov_b32 s96, 0
    buffer_load_dword v245, off, s[8:11], s24 sc1
    buffer_load_dwordx4 v[220:223], v240, s[8:11], s49 offen sc1
    buffer_load_dwordx4 v[224:227], v240, s[8:11], s49 offen offset:1024 sc1
    buffer_load_dwordx4 v[228:231], v240, s[8:11], s49 offen offset:2048 sc1
    buffer_load_dwordx4 v[232:235], v240, s[8:11], s49 offen offset:3072 sc1
    s_sleep 14
L_kmp_135:
    buffer_load_dword v245, off, s[8:11], s24 sc1
    buffer_load_dwordx4 v[220:223], v240, s[8:11], s49 offen sc1
    buffer_load_dwordx4 v[224:227], v240, s[8:11], s49 offen offset:1024 sc1
    buffer_load_dwordx4 v[228:231], v240, s[8:11], s49 offen offset:2048 sc1
    buffer_load_dwordx4 v[232:235], v240, s[8:11], s49 offen offset:3072 sc1
    s_add_u32 s96, s96, 1
    s_waitcnt vmcnt(5)
    v_max3_u32 v246, v220, v221, v222
    v_max3_u32 v246, v246, v223, v224
    v_max3_u32 v246, v246, v225, v226
    v_max3_u32 v246, v246, v227, v228
    v_max3_u32 v246, v246, v229, v230
    v_max3_u32 v246, v246, v231, v232
    v_max3_u32 v246, v246, v233, v234
    v_max_u32 v246, v246, v235
    v_cmp_eq_u32 vcc, -1, v246
    v_readfirstlane_b32 s26, v245
    s_cbranch_vccz L_kmo_137
    s_cmp_gt_u32 s26, s22
    s_cbranch_scc1 L_kmf_136
    s_cmp_lt_u32 s96, 0x10000
    s_cbranch_scc1 L_kmp_135
L_kmf_136:
    buffer_load_dwordx4 v[220:223], v240, s[8:11], s49 offen sc1
    buffer_load_dwordx4 v[224:227], v240, s[8:11], s49 offen offset:1024 sc1
    buffer_load_dwordx4 v[228:231], v240, s[8:11], s49 offen offset:2048 sc1
    buffer_load_dwordx4 v[232:235], v240, s[8:11], s49 offen offset:3072 sc1
    s_waitcnt vmcnt(0)
L_kmo_137:
    s_mov_b32 s62, 0x8f00
    buffer_load_dword v104, off, s[8:11], s62 sc1
    ds_write_b32 v253, v221
    ds_write_b32 v253, v223 offset:64
    ds_write_b32 v253, v225 offset:1024
    ds_write_b32 v253, v227 offset:1088
    ds_write_b32 v253, v229 offset:2048
    ds_write_b32 v253, v231 offset:2112
    ds_write_b32 v253, v233 offset:3072
    ds_write_b32 v253, v235 offset:3136
    ds_read_b128 v[48:51], v254
    ds_read_b128 v[52:55], v254 offset:1024
    ds_read_b128 v[56:59], v254 offset:2048
    ds_read_b128 v[60:63], v254 offset:3072
    s_waitcnt lgkmcnt(0)
    v_mfma_f32_16x16x32_bf16 v[112:115], v[48:51], v[0:3], 0
    v_mfma_f32_16x16x32_bf16 v[112:115], v[52:55], v[4:7], v[112:115]
    v_mfma_f32_16x16x32_bf16 v[112:115], v[56:59], v[8:11], v[112:115]
    v_mfma_f32_16x16x32_bf16 v[112:115], v[60:63], v[12:15], v[112:115]
    v_mov_b32 v246, v251
    s_nop 6
    v_max3_f32 v246, v246, v123, v112
    v_max_f32 v246, v246, v113
    v_mov_b32 v247, v246
    s_nop 1
    v_permlane32_swap_b32 v247, v246
    v_max_f32 v246, v247, v246
    v_mov_b32 v247, v246
    s_nop 1
    v_permlane16_swap_b32 v247, v246
    v_max_f32 v246, v247, v246
    v_mul_f32 v248, s28, v246
    v_pk_fma_f32 v[116:117], v[116:117], s[28:29], v[248:249] op_sel_hi:[1,1,0] neg_lo:[0,0,1] neg_hi:[0,0,1]
    v_pk_fma_f32 v[118:119], v[118:119], s[28:29], v[248:249] op_sel_hi:[1,1,0] neg_lo:[0,0,1] neg_hi:[0,0,1]
    v_pk_fma_f32 v[120:121], v[120:121], s[28:29], v[248:249] op_sel_hi:[1,1,0] neg_lo:[0,0,1] neg_hi:[0,0,1]
    v_pk_fma_f32 v[122:123], v[122:123], s[28:29], v[248:249] op_sel_hi:[1,1,0] neg_lo:[0,0,1] neg_hi:[0,0,1]
    v_pk_fma_f32 v[112:113], v[112:113], s[28:29], v[248:249] op_sel_hi:[1,1,0] neg_lo:[0,0,1] neg_hi:[0,0,1]
    v_exp_f32 v116, v116
    v_exp_f32 v117, v117
    v_exp_f32 v118, v118
    v_exp_f32 v119, v119
    v_exp_f32 v120, v120
    v_exp_f32 v121, v121
    v_exp_f32 v122, v122
    v_exp_f32 v123, v123
    v_exp_f32 v112, v112
    v_exp_f32 v113, v113
    v_cvt_pk_bf16_f32 v124, v116, v117
    v_cvt_pk_bf16_f32 v125, v118, v119
    v_cvt_pk_bf16_f32 v126, v120, v121
    v_cvt_pk_bf16_f32 v127, v122, v123
    v_cvt_pk_bf16_f32 v128, v112, v113
    v_mov_b32 v129, 0
    v_mfma_f32_16x16x32_bf16 v[132:135], v[136:139], v[124:127], 0
    v_mfma_f32_16x16x32_bf16 v[140:143], v[64:67], v[124:127], 0
    v_mfma_f32_16x16x32_bf16 v[144:147], v[68:71], v[124:127], 0
    v_mfma_f32_16x16x32_bf16 v[148:151], v[72:75], v[124:127], 0
    v_mfma_f32_16x16x32_bf16 v[152:155], v[76:79], v[124:127], 0
    v_mfma_f32_16x16x32_bf16 v[156:159], v[80:83], v[124:127], 0
    v_mfma_f32_16x16x32_bf16 v[160:163], v[84:87], v[124:127], 0
    v_mfma_f32_16x16x32_bf16 v[164:167], v[88:91], v[124:127], 0
    v_mfma_f32_16x16x32_bf16 v[168:171], v[92:95], v[124:127], 0
    v_mfma_f32_16x16x16_bf16 v[132:135], v[136:137], v[128:129], v[132:135]
    v_mfma_f32_16x16x16_bf16 v[140:143], v[220:221], v[128:129], v[140:143]
    v_mfma_f32_16x16x16_bf16 v[144:147], v[222:223], v[128:129], v[144:147]
    v_mfma_f32_16x16x16_bf16 v[148:151], v[224:225], v[128:129], v[148:151]
    v_mfma_f32_16x16x16_bf16 v[152:155], v[226:227], v[128:129], v[152:155]
    v_mfma_f32_16x16x16_bf16 v[156:159], v[228:229], v[128:129], v[156:159]
    v_mfma_f32_16x16x16_bf16 v[160:163], v[230:231], v[128:129], v[160:163]
    v_mfma_f32_16x16x16_bf16 v[164:167], v[232:233], v[128:129], v[164:167]
    v_mfma_f32_16x16x16_bf16 v[168:171], v[234:235], v[128:129], v[168:171]
    v_rcp_f32 v250, v132
    s_nop 0
    v_pk_mul_f32 v[140:141], v[140:141], v[250:251] op_sel_hi:[1,0]
    v_pk_mul_f32 v[142:143], v[142:143], v[250:251] op_sel_hi:[1,0]
    v_pk_mul_f32 v[144:145], v[144:145], v[250:251] op_sel_hi:[1,0]
    v_pk_mul_f32 v[146:147], v[146:147], v[250:251] op_sel_hi:[1,0]
    v_pk_mul_f32 v[148:149], v[148:149], v[250:251] op_sel_hi:[1,0]
    v_pk_mul_f32 v[150:151], v[150:151], v[250:251] op_sel_hi:[1,0]
    v_pk_mul_f32 v[152:153], v[152:153], v[250:251] op_sel_hi:[1,0]
    v_pk_mul_f32 v[154:155], v[154:155], v[250:251] op_sel_hi:[1,0]
    v_pk_mul_f32 v[156:157], v[156:157], v[250:251] op_sel_hi:[1,0]
    v_pk_mul_f32 v[158:159], v[158:159], v[250:251] op_sel_hi:[1,0]
    v_pk_mul_f32 v[160:161], v[160:161], v[250:251] op_sel_hi:[1,0]
    v_pk_mul_f32 v[162:163], v[162:163], v[250:251] op_sel_hi:[1,0]
    v_pk_mul_f32 v[164:165], v[164:165], v[250:251] op_sel_hi:[1,0]
    v_pk_mul_f32 v[166:167], v[166:167], v[250:251] op_sel_hi:[1,0]
    v_pk_mul_f32 v[168:169], v[168:169], v[250:251] op_sel_hi:[1,0]
    v_pk_mul_f32 v[170:171], v[170:171], v[250:251] op_sel_hi:[1,0]
    v_cvt_pk_bf16_f32 v140, v140, v141
    v_cvt_pk_bf16_f32 v141, v142, v143
    v_cvt_pk_bf16_f32 v142, v144, v145
    v_cvt_pk_bf16_f32 v143, v146, v147
    v_cvt_pk_bf16_f32 v144, v148, v149
    v_cvt_pk_bf16_f32 v145, v150, v151
    v_cvt_pk_bf16_f32 v146, v152, v153
    v_cvt_pk_bf16_f32 v147, v154, v155
    v_cvt_pk_bf16_f32 v148, v156, v157
    v_cvt_pk_bf16_f32 v149, v158, v159
    v_cvt_pk_bf16_f32 v150, v160, v161
    v_cvt_pk_bf16_f32 v151, v162, v163
    v_cvt_pk_bf16_f32 v152, v164, v165
    v_cvt_pk_bf16_f32 v153, v166, v167
    v_cvt_pk_bf16_f32 v154, v168, v169
    v_cvt_pk_bf16_f32 v155, v170, v171
    ds_write_b128 v243, v[140:143]
    ds_write_b128 v243, v[144:147] offset:1024
    ds_write_b128 v243, v[148:151] offset:2048
    ds_write_b128 v243, v[152:155] offset:3072
    s_waitcnt lgkmcnt(0)
    s_barrier
    s_lshr_b32 s25, s82, 1
    s_lshl_b32 s24, s25, 12
    v_add_u32 v246, s24, v244
    ds_read_b128 v[0:3], v246
    ds_read_b128 v[4:7], v246 offset:1024
    ds_read_b128 v[8:11], v246 offset:2048
    ds_read_b128 v[12:15], v246 offset:3072
    ds_read_b128 v[32:35], v246 offset:8192
    ds_read_b128 v[36:39], v246 offset:9216
    ds_read_b128 v[40:43], v246 offset:10240
    ds_read_b128 v[44:47], v246 offset:11264
    s_lshl_b32 s25, s25, 14
    s_add_u32 s51, s51, s25
    v_xor_b32 v243, 0x4000, v243
    s_waitcnt lgkmcnt(7)
    v_mfma_f32_16x16x32_bf16 v[172:175], a[0:3], v[0:3], 0
    v_mfma_f32_16x16x32_bf16 v[176:179], a[4:7], v[0:3], 0
    s_waitcnt lgkmcnt(6)
    v_mfma_f32_16x16x32_bf16 v[172:175], a[32:35], v[4:7], v[172:175]
    v_mfma_f32_16x16x32_bf16 v[176:179], a[36:39], v[4:7], v[176:179]
    s_waitcnt lgkmcnt(5)
    v_mfma_f32_16x16x32_bf16 v[172:175], a[64:67], v[8:11], v[172:175]
    v_mfma_f32_16x16x32_bf16 v[176:179], a[68:71], v[8:11], v[176:179]
    s_waitcnt lgkmcnt(4)
    v_mfma_f32_16x16x32_bf16 v[172:175], a[96:99], v[12:15], v[172:175]
    v_mfma_f32_16x16x32_bf16 v[176:179], a[100:103], v[12:15], v[176:179]
    s_waitcnt lgkmcnt(3)
    v_mfma_f32_16x16x32_bf16 v[172:175], a[128:131], v[32:35], v[172:175]
    v_mfma_f32_16x16x32_bf16 v[176:179], a[132:135], v[32:35], v[176:179]
    s_waitcnt lgkmcnt(2)
    v_mfma_f32_16x16x32_bf16 v[172:175], a[160:163], v[36:39], v[172:175]
    v_mfma_f32_16x16x32_bf16 v[176:179], a[164:167], v[36:39], v[176:179]
    s_waitcnt lgkmcnt(1)
    v_mfma_f32_16x16x32_bf16 v[172:175], a[192:195], v[40:43], v[172:175]
    v_mfma_f32_16x16x32_bf16 v[176:179], a[196:199], v[40:43], v[176:179]
    s_waitcnt lgkmcnt(0)
    v_mfma_f32_16x16x32_bf16 v[172:175], a[224:227], v[44:47], v[172:175]
    v_mfma_f32_16x16x32_bf16 v[176:179], a[228:231], v[44:47], v[176:179]
    v_mfma_f32_16x16x32_bf16 v[180:183], a[8:11], v[0:3], 0
    v_mfma_f32_16x16x32_bf16 v[184:187], a[12:15], v[0:3], 0
    ds_read_b128 v[16:19], v244 offset:4096
    v_mfma_f32_16x16x32_bf16 v[180:183], a[40:43], v[4:7], v[180:183]
    v_mfma_f32_16x16x32_bf16 v[184:187], a[44:47], v[4:7], v[184:187]
    ds_read_b128 v[20:23], v244 offset:5120
    v_cvt_pk_bf16_f32 v140, v172, v173
    v_cvt_pk_bf16_f32 v141, v174, v175
    v_cvt_pk_bf16_f32 v142, v176, v177
    v_cvt_pk_bf16_f32 v143, v178, v179
    s_add_u32 s24, s51, 0
    s_cmp_lg_u32 s83, 0
    s_cbranch_scc1 L_near_140
    buffer_store_dwordx4 v[140:143], v242, s[8:11], s24 offen sc1
    s_branch L_far_141
L_near_140:
    buffer_store_dwordx4 v[140:143], v242, s[8:11], s24 offen
L_far_141:
    v_mfma_f32_16x16x32_bf16 v[180:183], a[72:75], v[8:11], v[180:183]
    v_mfma_f32_16x16x32_bf16 v[184:187], a[76:79], v[8:11], v[184:187]
    ds_read_b128 v[24:27], v244 offset:6144
    v_mfma_f32_16x16x32_bf16 v[180:183], a[104:107], v[12:15], v[180:183]
    v_mfma_f32_16x16x32_bf16 v[184:187], a[108:111], v[12:15], v[184:187]
    ds_read_b128 v[28:31], v244 offset:7168
    v_mfma_f32_16x16x32_bf16 v[180:183], a[136:139], v[32:35], v[180:183]
    v_mfma_f32_16x16x32_bf16 v[184:187], a[140:143], v[32:35], v[184:187]
    ds_read_b128 v[48:51], v244 offset:12288
    v_mfma_f32_16x16x32_bf16 v[180:183], a[168:171], v[36:39], v[180:183]
    v_mfma_f32_16x16x32_bf16 v[184:187], a[172:175], v[36:39], v[184:187]
    ds_read_b128 v[52:55], v244 offset:13312
    v_mfma_f32_16x16x32_bf16 v[180:183], a[200:203], v[40:43], v[180:183]
    v_mfma_f32_16x16x32_bf16 v[184:187], a[204:207], v[40:43], v[184:187]
    ds_read_b128 v[56:59], v244 offset:14336
    v_mfma_f32_16x16x32_bf16 v[180:183], a[232:235], v[44:47], v[180:183]
    v_mfma_f32_16x16x32_bf16 v[184:187], a[236:239], v[44:47], v[184:187]
    ds_read_b128 v[60:63], v244 offset:15360
    v_mfma_f32_16x16x32_bf16 v[188:191], a[16:19], v[0:3], 0
    v_mfma_f32_16x16x32_bf16 v[192:195], a[20:23], v[0:3], 0
    v_mfma_f32_16x16x32_bf16 v[188:191], a[48:51], v[4:7], v[188:191]
    v_mfma_f32_16x16x32_bf16 v[192:195], a[52:55], v[4:7], v[192:195]
    v_cvt_pk_bf16_f32 v144, v180, v181
    v_cvt_pk_bf16_f32 v145, v182, v183
    v_cvt_pk_bf16_f32 v146, v184, v185
    v_cvt_pk_bf16_f32 v147, v186, v187
    s_cmp_lg_u32 s83, 0
    s_cbranch_scc1 L_near_142
    buffer_store_dwordx4 v[144:147], v242, s[8:11], s24 offen offset:64 sc1
    s_branch L_far_143
L_near_142:
    buffer_store_dwordx4 v[144:147], v242, s[8:11], s24 offen offset:64
L_far_143:
    v_mfma_f32_16x16x32_bf16 v[188:191], a[80:83], v[8:11], v[188:191]
    v_mfma_f32_16x16x32_bf16 v[192:195], a[84:87], v[8:11], v[192:195]
    v_mfma_f32_16x16x32_bf16 v[188:191], a[112:115], v[12:15], v[188:191]
    v_mfma_f32_16x16x32_bf16 v[192:195], a[116:119], v[12:15], v[192:195]
    v_mfma_f32_16x16x32_bf16 v[188:191], a[144:147], v[32:35], v[188:191]
    v_mfma_f32_16x16x32_bf16 v[192:195], a[148:151], v[32:35], v[192:195]
    v_mfma_f32_16x16x32_bf16 v[188:191], a[176:179], v[36:39], v[188:191]
    v_mfma_f32_16x16x32_bf16 v[192:195], a[180:183], v[36:39], v[192:195]
    v_mfma_f32_16x16x32_bf16 v[188:191], a[208:211], v[40:43], v[188:191]
    v_mfma_f32_16x16x32_bf16 v[192:195], a[212:215], v[40:43], v[192:195]
    v_mfma_f32_16x16x32_bf16 v[188:191], a[240:243], v[44:47], v[188:191]
    v_mfma_f32_16x16x32_bf16 v[192:195], a[244:247], v[44:47], v[192:195]
    v_mfma_f32_16x16x32_bf16 v[196:199], a[24:27], v[0:3], 0
    v_mfma_f32_16x16x32_bf16 v[200:203], a[28:31], v[0:3], 0
    v_mfma_f32_16x16x32_bf16 v[196:199], a[56:59], v[4:7], v[196:199]
    v_mfma_f32_16x16x32_bf16 v[200:203], a[60:63], v[4:7], v[200:203]
    v_cvt_pk_bf16_f32 v148, v188, v189
    v_cvt_pk_bf16_f32 v149, v190, v191
    v_cvt_pk_bf16_f32 v150, v192, v193
    v_cvt_pk_bf16_f32 v151, v194, v195
    s_cmp_lg_u32 s83, 0
    s_cbranch_scc1 L_near_144
    buffer_store_dwordx4 v[148:151], v242, s[8:11], s24 offen offset:128 sc1
    s_branch L_far_145
L_near_144:
    buffer_store_dwordx4 v[148:151], v242, s[8:11], s24 offen offset:128
L_far_145:
    v_mfma_f32_16x16x32_bf16 v[196:199], a[88:91], v[8:11], v[196:199]
    v_mfma_f32_16x16x32_bf16 v[200:203], a[92:95], v[8:11], v[200:203]
    v_mfma_f32_16x16x32_bf16 v[196:199], a[120:123], v[12:15], v[196:199]
    v_mfma_f32_16x16x32_bf16 v[200:203], a[124:127], v[12:15], v[200:203]
    v_mfma_f32_16x16x32_bf16 v[196:199], a[152:155], v[32:35], v[196:199]
    v_mfma_f32_16x16x32_bf16 v[200:203], a[156:159], v[32:35], v[200:203]
    v_mfma_f32_16x16x32_bf16 v[196:199], a[184:187], v[36:39], v[196:199]
    v_mfma_f32_16x16x32_bf16 v[200:203], a[188:191], v[36:39], v[200:203]
    v_mfma_f32_16x16x32_bf16 v[196:199], a[216:219], v[40:43], v[196:199]
    v_mfma_f32_16x16x32_bf16 v[200:203], a[220:223], v[40:43], v[200:203]
    v_mfma_f32_16x16x32_bf16 v[196:199], a[248:251], v[44:47], v[196:199]
    v_mfma_f32_16x16x32_bf16 v[200:203], a[252:255], v[44:47], v[200:203]
    v_xor_b32 v244, 0x4000, v244
    s_cmp_lg_u32 s82, 0
    s_cbranch_scc1 L_half_138
    s_waitcnt lgkmcnt(0)
    v_mfma_f32_16x16x32_bf16 v[204:207], a[0:3], v[16:19], 0
    v_mfma_f32_16x16x32_bf16 v[208:211], a[4:7], v[16:19], 0
    v_mfma_f32_16x16x32_bf16 v[204:207], a[32:35], v[20:23], v[204:207]
    v_mfma_f32_16x16x32_bf16 v[208:211], a[36:39], v[20:23], v[208:211]
    v_cvt_pk_bf16_f32 v152, v196, v197
    v_cvt_pk_bf16_f32 v153, v198, v199
    v_cvt_pk_bf16_f32 v154, v200, v201
    v_cvt_pk_bf16_f32 v155, v202, v203
    s_cmp_lg_u32 s83, 0
    s_cbranch_scc1 L_near_146
    buffer_store_dwordx4 v[152:155], v242, s[8:11], s24 offen offset:192 sc1
    s_branch L_far_147
L_near_146:
    buffer_store_dwordx4 v[152:155], v242, s[8:11], s24 offen offset:192
L_far_147:
    v_mfma_f32_16x16x32_bf16 v[204:207], a[64:67], v[24:27], v[204:207]
    v_mfma_f32_16x16x32_bf16 v[208:211], a[68:71], v[24:27], v[208:211]
    v_mfma_f32_16x16x32_bf16 v[204:207], a[96:99], v[28:31], v[204:207]
    v_mfma_f32_16x16x32_bf16 v[208:211], a[100:103], v[28:31], v[208:211]
    v_mfma_f32_16x16x32_bf16 v[204:207], a[128:131], v[48:51], v[204:207]
    v_mfma_f32_16x16x32_bf16 v[208:211], a[132:135], v[48:51], v[208:211]
    v_mfma_f32_16x16x32_bf16 v[204:207], a[160:163], v[52:55], v[204:207]
    v_mfma_f32_16x16x32_bf16 v[208:211], a[164:167], v[52:55], v[208:211]
    v_mfma_f32_16x16x32_bf16 v[204:207], a[192:195], v[56:59], v[204:207]
    v_mfma_f32_16x16x32_bf16 v[208:211], a[196:199], v[56:59], v[208:211]
    v_mfma_f32_16x16x32_bf16 v[204:207], a[224:227], v[60:63], v[204:207]
    v_mfma_f32_16x16x32_bf16 v[208:211], a[228:231], v[60:63], v[208:211]
    v_mfma_f32_16x16x32_bf16 v[212:215], a[8:11], v[16:19], 0
    v_mfma_f32_16x16x32_bf16 v[216:219], a[12:15], v[16:19], 0
    v_mfma_f32_16x16x32_bf16 v[212:215], a[40:43], v[20:23], v[212:215]
    v_mfma_f32_16x16x32_bf16 v[216:219], a[44:47], v[20:23], v[216:219]
    v_cvt_pk_bf16_f32 v140, v204, v205
    v_cvt_pk_bf16_f32 v141, v206, v207
    v_cvt_pk_bf16_f32 v142, v208, v209
    v_cvt_pk_bf16_f32 v143, v210, v211
    s_add_u32 s24, s51, 16384
    s_cmp_lg_u32 s83, 0
    s_cbranch_scc1 L_near_148
    buffer_store_dwordx4 v[140:143], v242, s[8:11], s24 offen sc1
    s_branch L_far_149
L_near_148:
    buffer_store_dwordx4 v[140:143], v242, s[8:11], s24 offen
L_far_149:
    v_mfma_f32_16x16x32_bf16 v[212:215], a[72:75], v[24:27], v[212:215]
    v_mfma_f32_16x16x32_bf16 v[216:219], a[76:79], v[24:27], v[216:219]
    v_mfma_f32_16x16x32_bf16 v[212:215], a[104:107], v[28:31], v[212:215]
    v_mfma_f32_16x16x32_bf16 v[216:219], a[108:111], v[28:31], v[216:219]
    v_mfma_f32_16x16x32_bf16 v[212:215], a[136:139], v[48:51], v[212:215]
    v_mfma_f32_16x16x32_bf16 v[216:219], a[140:143], v[48:51], v[216:219]
    v_mfma_f32_16x16x32_bf16 v[212:215], a[168:171], v[52:55], v[212:215]
    v_mfma_f32_16x16x32_bf16 v[216:219], a[172:175], v[52:55], v[216:219]
    v_mfma_f32_16x16x32_bf16 v[212:215], a[200:203], v[56:59], v[212:215]
    v_mfma_f32_16x16x32_bf16 v[216:219], a[204:207], v[56:59], v[216:219]
    v_mfma_f32_16x16x32_bf16 v[212:215], a[232:235], v[60:63], v[212:215]
    v_mfma_f32_16x16x32_bf16 v[216:219], a[236:239], v[60:63], v[216:219]
    s_waitcnt vmcnt(5)
    v_mfma_f32_16x16x32_bf16 v[220:223], a[16:19], v[16:19], 0
    v_mfma_f32_16x16x32_bf16 v[224:227], a[20:23], v[16:19], 0
    v_mfma_f32_16x16x32_bf16 v[220:223], a[48:51], v[20:23], v[220:223]
    v_mfma_f32_16x16x32_bf16 v[224:227], a[52:55], v[20:23], v[224:227]
    v_cvt_pk_bf16_f32 v144, v212, v213
    v_cvt_pk_bf16_f32 v145, v214, v215
    v_cvt_pk_bf16_f32 v146, v216, v217
    v_cvt_pk_bf16_f32 v147, v218, v219
    s_cmp_lg_u32 s83, 0
    s_cbranch_scc1 L_near_150
    buffer_store_dwordx4 v[144:147], v242, s[8:11], s24 offen offset:64 sc1
    s_branch L_far_151
L_near_150:
    buffer_store_dwordx4 v[144:147], v242, s[8:11], s24 offen offset:64
L_far_151:
    v_mfma_f32_16x16x32_bf16 v[220:223], a[80:83], v[24:27], v[220:223]
    v_mfma_f32_16x16x32_bf16 v[224:227], a[84:87], v[24:27], v[224:227]
    v_mfma_f32_16x16x32_bf16 v[220:223], a[112:115], v[28:31], v[220:223]
    v_mfma_f32_16x16x32_bf16 v[224:227], a[116:119], v[28:31], v[224:227]
    v_mfma_f32_16x16x32_bf16 v[220:223], a[144:147], v[48:51], v[220:223]
    v_mfma_f32_16x16x32_bf16 v[224:227], a[148:151], v[48:51], v[224:227]
    v_mfma_f32_16x16x32_bf16 v[220:223], a[176:179], v[52:55], v[220:223]
    v_mfma_f32_16x16x32_bf16 v[224:227], a[180:183], v[52:55], v[224:227]
    v_mfma_f32_16x16x32_bf16 v[220:223], a[208:211], v[56:59], v[220:223]
    v_mfma_f32_16x16x32_bf16 v[224:227], a[212:215], v[56:59], v[224:227]
    v_mfma_f32_16x16x32_bf16 v[220:223], a[240:243], v[60:63], v[220:223]
    v_mfma_f32_16x16x32_bf16 v[224:227], a[244:247], v[60:63], v[224:227]
    v_mfma_f32_16x16x32_bf16 v[228:231], a[24:27], v[16:19], 0
    v_mfma_f32_16x16x32_bf16 v[232:235], a[28:31], v[16:19], 0
    v_mfma_f32_16x16x32_bf16 v[228:231], a[56:59], v[20:23], v[228:231]
    v_mfma_f32_16x16x32_bf16 v[232:235], a[60:63], v[20:23], v[232:235]
    v_cvt_pk_bf16_f32 v148, v220, v221
    v_cvt_pk_bf16_f32 v149, v222, v223
    v_cvt_pk_bf16_f32 v150, v224, v225
    v_cvt_pk_bf16_f32 v151, v226, v227
    s_cmp_lg_u32 s83, 0
    s_cbranch_scc1 L_near_152
    buffer_store_dwordx4 v[148:151], v242, s[8:11], s24 offen offset:128 sc1
    s_branch L_far_153
L_near_152:
    buffer_store_dwordx4 v[148:151], v242, s[8:11], s24 offen offset:128
L_far_153:
    v_mfma_f32_16x16x32_bf16 v[228:231], a[88:91], v[24:27], v[228:231]
    v_mfma_f32_16x16x32_bf16 v[232:235], a[92:95], v[24:27], v[232:235]
    v_mfma_f32_16x16x32_bf16 v[228:231], a[120:123], v[28:31], v[228:231]
    v_mfma_f32_16x16x32_bf16 v[232:235], a[124:127], v[28:31], v[232:235]
    v_mfma_f32_16x16x32_bf16 v[228:231], a[152:155], v[48:51], v[228:231]
    v_mfma_f32_16x16x32_bf16 v[232:235], a[156:159], v[48:51], v[232:235]
    v_mfma_f32_16x16x32_bf16 v[228:231], a[184:187], v[52:55], v[228:231]
    v_mfma_f32_16x16x32_bf16 v[232:235], a[188:191], v[52:55], v[232:235]
    v_mfma_f32_16x16x32_bf16 v[228:231], a[216:219], v[56:59], v[228:231]
    v_mfma_f32_16x16x32_bf16 v[232:235], a[220:223], v[56:59], v[232:235]
    v_mfma_f32_16x16x32_bf16 v[228:231], a[248:251], v[60:63], v[228:231]
    v_mfma_f32_16x16x32_bf16 v[232:235], a[252:255], v[60:63], v[232:235]
    s_nop 3
    v_cvt_pk_bf16_f32 v152, v228, v229
    v_cvt_pk_bf16_f32 v153, v230, v231
    s_nop 1
    v_cvt_pk_bf16_f32 v154, v232, v233
    v_cvt_pk_bf16_f32 v155, v234, v235
    s_cmp_lg_u32 s83, 0
    s_cbranch_scc1 L_near_154
    buffer_store_dwordx4 v[152:155], v242, s[8:11], s24 offen offset:192 sc1
    s_branch L_far_155
L_near_154:
    buffer_store_dwordx4 v[152:155], v242, s[8:11], s24 offen offset:192
L_far_155:
    s_branch L_proj_139
L_half_138:
    s_nop 7
    v_cvt_pk_bf16_f32 v152, v196, v197
    v_cvt_pk_bf16_f32 v153, v198, v199
    v_cvt_pk_bf16_f32 v154, v200, v201
    v_cvt_pk_bf16_f32 v155, v202, v203
    s_cmp_lg_u32 s83, 0
    s_cbranch_scc1 L_near_156
    buffer_store_dwordx4 v[152:155], v242, s[8:11], s24 offen offset:192 sc1
    s_branch L_far_157
L_near_156:
    buffer_store_dwordx4 v[152:155], v242, s[8:11], s24 offen offset:192
L_far_157:
    s_waitcnt lgkmcnt(0)
L_proj_139:
    s_waitcnt vmcnt(0)
    s_barrier
    s_lshl_b32 s24, s20, 2
    s_add_u32 s24, s24, s52
    s_cmp_lg_u32 s100, 0
    s_cbranch_scc1 L_flag_158
    v_mov_b32 v246, 1
    s_mov_b64 exec, 1
    s_cmp_lg_u32 s83, 0
    s_cbranch_scc1 L_near_159
    buffer_store_dword v246, off, s[8:11], s24 sc1
    s_branch L_far_160
L_near_159:
    buffer_store_dword v246, off, s[8:11], s24
L_far_160:
    s_mov_b64 exec, -1
L_flag_158:
    v_lshrrev_b32 v246, 2, v240
    s_cmp_lg_u32 s100, 0
    s_cbranch_scc1 L_polls_163
    s_mov_b32 exec_lo, 0xffff
    s_mov_b32 exec_hi, 0
    s_mov_b32 s96, 0
L_poll_161:
    buffer_load_dword v247, v246, s[8:11], s52 offen sc1
    s_waitcnt vmcnt(0)
    v_cmp_gt_u32 vcc, 1, v247
    s_cbranch_vccz L_polld_162
    s_sleep 1
    s_add_u32 s96, s96, 1
    s_cmp_lt_u32 s96, 0x10000
    s_cbranch_scc1 L_poll_161
L_polld_162:
    s_mov_b64 exec, -1
L_polls_163:
    s_barrier
    s_cmp_lg_u32 s82, 0
    s_cselect_b32 s24, 1, 2
    s_cmp_ge_u32 s100, s24
    s_cbranch_scc1 L_nofin_164
    s_lshr_b32 s62, s60, 5
    s_lshl_b32 s62, s62, 19
    s_and_b32 s63, s60, 31
    s_lshl_b32 s63, s63, 10
    s_add_u32 s62, s62, s63
    s_add_u32 s62, s62, 0x4000000
    buffer_load_dwordx4 v[0:3], v240, s[8:11], s62 offen
    s_add_u32 s62, s62, 32768
    buffer_load_dwordx4 v[4:7], v240, s[8:11], s62 offen
    s_add_u32 s62, s62, 32768
    buffer_load_dwordx4 v[8:11], v240, s[8:11], s62 offen
    s_add_u32 s62, s62, 32768
    buffer_load_dwordx4 v[12:15], v240, s[8:11], s62 offen
    s_add_u32 s62, s62, 32768
    buffer_load_dwordx4 v[16:19], v240, s[8:11], s62 offen
    s_add_u32 s62, s62, 32768
    buffer_load_dwordx4 v[20:23], v240, s[8:11], s62 offen
    s_add_u32 s62, s62, 32768
    buffer_load_dwordx4 v[24:27], v240, s[8:11], s62 offen
    s_add_u32 s62, s62, 32768
    buffer_load_dwordx4 v[28:31], v240, s[8:11], s62 offen
    s_add_u32 s62, s62, 32768
    buffer_load_dwordx4 v[32:35], v240, s[8:11], s62 offen
    s_add_u32 s62, s62, 32768
    buffer_load_dwordx4 v[36:39], v240, s[8:11], s62 offen
    s_add_u32 s62, s62, 32768
    buffer_load_dwordx4 v[40:43], v240, s[8:11], s62 offen
    s_add_u32 s62, s62, 32768
    buffer_load_dwordx4 v[44:47], v240, s[8:11], s62 offen
    s_add_u32 s62, s62, 32768
    buffer_load_dwordx4 v[48:51], v240, s[8:11], s62 offen
    s_add_u32 s62, s62, 32768
    buffer_load_dwordx4 v[52:55], v240, s[8:11], s62 offen
    s_add_u32 s62, s62, 32768
    buffer_load_dwordx4 v[56:59], v240, s[8:11], s62 offen
    s_add_u32 s62, s62, 32768
    buffer_load_dwordx4 v[60:63], v240, s[8:11], s62 offen
    v_mov_b32 v68, 0
    v_mov_b32 v69, 0
    v_mov_b32 v70, 0
    v_mov_b32 v71, 0
    v_mov_b32 v72, 0
    v_mov_b32 v73, 0
    v_mov_b32 v74, 0
    v_mov_b32 v75, 0
    s_waitcnt vmcnt(15)
    v_dot2_f32_bf16 v68, v0, s65, v68
    v_dot2_f32_bf16 v69, v0, s66, v69
    v_dot2_f32_bf16 v70, v1, s65, v70
    v_dot2_f32_bf16 v71, v1, s66, v71
    v_dot2_f32_bf16 v72, v2, s65, v72
    v_dot2_f32_bf16 v73, v2, s66, v73
    v_dot2_f32_bf16 v74, v3, s65, v74
    v_dot2_f32_bf16 v75, v3, s66, v75
    s_waitcnt vmcnt(14)
    v_dot2_f32_bf16 v68, v4, s65, v68
    v_dot2_f32_bf16 v69, v4, s66, v69
    v_dot2_f32_bf16 v70, v5, s65, v70
    v_dot2_f32_bf16 v71, v5, s66, v71
    v_dot2_f32_bf16 v72, v6, s65, v72
    v_dot2_f32_bf16 v73, v6, s66, v73
    v_dot2_f32_bf16 v74, v7, s65, v74
    v_dot2_f32_bf16 v75, v7, s66, v75
    s_waitcnt vmcnt(13)
    v_dot2_f32_bf16 v68, v8, s65, v68
    v_dot2_f32_bf16 v69, v8, s66, v69
    v_dot2_f32_bf16 v70, v9, s65, v70
    v_dot2_f32_bf16 v71, v9, s66, v71
    v_dot2_f32_bf16 v72, v10, s65, v72
    v_dot2_f32_bf16 v73, v10, s66, v73
    v_dot2_f32_bf16 v74, v11, s65, v74
    v_dot2_f32_bf16 v75, v11, s66, v75
    s_waitcnt vmcnt(12)
    v_dot2_f32_bf16 v68, v12, s65, v68
    v_dot2_f32_bf16 v69, v12, s66, v69
    v_dot2_f32_bf16 v70, v13, s65, v70
    v_dot2_f32_bf16 v71, v13, s66, v71
    v_dot2_f32_bf16 v72, v14, s65, v72
    v_dot2_f32_bf16 v73, v14, s66, v73
    v_dot2_f32_bf16 v74, v15, s65, v74
    v_dot2_f32_bf16 v75, v15, s66, v75
    s_waitcnt vmcnt(11)
    v_dot2_f32_bf16 v68, v16, s65, v68
    v_dot2_f32_bf16 v69, v16, s66, v69
    v_dot2_f32_bf16 v70, v17, s65, v70
    v_dot2_f32_bf16 v71, v17, s66, v71
    v_dot2_f32_bf16 v72, v18, s65, v72
    v_dot2_f32_bf16 v73, v18, s66, v73
    v_dot2_f32_bf16 v74, v19, s65, v74
    v_dot2_f32_bf16 v75, v19, s66, v75
    s_waitcnt vmcnt(10)
    v_dot2_f32_bf16 v68, v20, s65, v68
    v_dot2_f32_bf16 v69, v20, s66, v69
    v_dot2_f32_bf16 v70, v21, s65, v70
    v_dot2_f32_bf16 v71, v21, s66, v71
    v_dot2_f32_bf16 v72, v22, s65, v72
    v_dot2_f32_bf16 v73, v22, s66, v73
    v_dot2_f32_bf16 v74, v23, s65, v74
    v_dot2_f32_bf16 v75, v23, s66, v75
    s_waitcnt vmcnt(9)
    v_dot2_f32_bf16 v68, v24, s65, v68
    v_dot2_f32_bf16 v69, v24, s66, v69
    v_dot2_f32_bf16 v70, v25, s65, v70
    v_dot2_f32_bf16 v71, v25, s66, v71
    v_dot2_f32_bf16 v72, v26, s65, v72
    v_dot2_f32_bf16 v73, v26, s66, v73
    v_dot2_f32_bf16 v74, v27, s65, v74
    v_dot2_f32_bf16 v75, v27, s66, v75
    s_waitcnt vmcnt(8)
    v_dot2_f32_bf16 v68, v28, s65, v68
    v_dot2_f32_bf16 v69, v28, s66, v69
    v_dot2_f32_bf16 v70, v29, s65, v70
    v_dot2_f32_bf16 v71, v29, s66, v71
    v_dot2_f32_bf16 v72, v30, s65, v72
    v_dot2_f32_bf16 v73, v30, s66, v73
    v_dot2_f32_bf16 v74, v31, s65, v74
    v_dot2_f32_bf16 v75, v31, s66, v75
    s_waitcnt vmcnt(7)
    v_dot2_f32_bf16 v68, v32, s65, v68
    v_dot2_f32_bf16 v69, v32, s66, v69
    v_dot2_f32_bf16 v70, v33, s65, v70
    v_dot2_f32_bf16 v71, v33, s66, v71
    v_dot2_f32_bf16 v72, v34, s65, v72
    v_dot2_f32_bf16 v73, v34, s66, v73
    v_dot2_f32_bf16 v74, v35, s65, v74
    v_dot2_f32_bf16 v75, v35, s66, v75
    s_waitcnt vmcnt(6)
    v_dot2_f32_bf16 v68, v36, s65, v68
    v_dot2_f32_bf16 v69, v36, s66, v69
    v_dot2_f32_bf16 v70, v37, s65, v70
    v_dot2_f32_bf16 v71, v37, s66, v71
    v_dot2_f32_bf16 v72, v38, s65, v72
    v_dot2_f32_bf16 v73, v38, s66, v73
    v_dot2_f32_bf16 v74, v39, s65, v74
    v_dot2_f32_bf16 v75, v39, s66, v75
    s_waitcnt vmcnt(5)
    v_dot2_f32_bf16 v68, v40, s65, v68
    v_dot2_f32_bf16 v69, v40, s66, v69
    v_dot2_f32_bf16 v70, v41, s65, v70
    v_dot2_f32_bf16 v71, v41, s66, v71
    v_dot2_f32_bf16 v72, v42, s65, v72
    v_dot2_f32_bf16 v73, v42, s66, v73
    v_dot2_f32_bf16 v74, v43, s65, v74
    v_dot2_f32_bf16 v75, v43, s66, v75
    s_waitcnt vmcnt(4)
    v_dot2_f32_bf16 v68, v44, s65, v68
    v_dot2_f32_bf16 v69, v44, s66, v69
    v_dot2_f32_bf16 v70, v45, s65, v70
    v_dot2_f32_bf16 v71, v45, s66, v71
    v_dot2_f32_bf16 v72, v46, s65, v72
    v_dot2_f32_bf16 v73, v46, s66, v73
    v_dot2_f32_bf16 v74, v47, s65, v74
    v_dot2_f32_bf16 v75, v47, s66, v75
    s_waitcnt vmcnt(3)
    v_dot2_f32_bf16 v68, v48, s65, v68
    v_dot2_f32_bf16 v69, v48, s66, v69
    v_dot2_f32_bf16 v70, v49, s65, v70
    v_dot2_f32_bf16 v71, v49, s66, v71
    v_dot2_f32_bf16 v72, v50, s65, v72
    v_dot2_f32_bf16 v73, v50, s66, v73
    v_dot2_f32_bf16 v74, v51, s65, v74
    v_dot2_f32_bf16 v75, v51, s66, v75
    s_waitcnt vmcnt(2)
    v_dot2_f32_bf16 v68, v52, s65, v68
    v_dot2_f32_bf16 v69, v52, s66, v69
    v_dot2_f32_bf16 v70, v53, s65, v70
    v_dot2_f32_bf16 v71, v53, s66, v71
    v_dot2_f32_bf16 v72, v54, s65, v72
    v_dot2_f32_bf16 v73, v54, s66, v73
    v_dot2_f32_bf16 v74, v55, s65, v74
    v_dot2_f32_bf16 v75, v55, s66, v75
    s_waitcnt vmcnt(1)
    v_dot2_f32_bf16 v68, v56, s65, v68
    v_dot2_f32_bf16 v69, v56, s66, v69
    v_dot2_f32_bf16 v70, v57, s65, v70
    v_dot2_f32_bf16 v71, v57, s66, v71
    v_dot2_f32_bf16 v72, v58, s65, v72
    v_dot2_f32_bf16 v73, v58, s66, v73
    v_dot2_f32_bf16 v74, v59, s65, v74
    v_dot2_f32_bf16 v75, v59, s66, v75
    s_waitcnt vmcnt(0)
    v_dot2_f32_bf16 v68, v60, s65, v68
    v_dot2_f32_bf16 v69, v60, s66, v69
    v_dot2_f32_bf16 v70, v61, s65, v70
    v_dot2_f32_bf16 v71, v61, s66, v71
    v_dot2_f32_bf16 v72, v62, s65, v72
    v_dot2_f32_bf16 v73, v62, s66, v73
    v_dot2_f32_bf16 v74, v63, s65, v74
    v_dot2_f32_bf16 v75, v63, s66, v75
    v_cvt_pk_bf16_f32 v0, v68, v69
    v_cvt_pk_bf16_f32 v1, v70, v71
    v_cvt_pk_bf16_f32 v2, v72, v73
    v_cvt_pk_bf16_f32 v3, v74, v75
    v_lshlrev_b32 v68, 16, v0
    v_and_b32 v69, 0xffff0000, v0
    v_lshlrev_b32 v76, 16, v96
    v_and_b32 v77, 0xffff0000, v96
    v_lshlrev_b32 v70, 16, v1
    v_and_b32 v71, 0xffff0000, v1
    v_lshlrev_b32 v78, 16, v97
    v_and_b32 v79, 0xffff0000, v97
    v_lshlrev_b32 v72, 16, v2
    v_and_b32 v73, 0xffff0000, v2
    v_lshlrev_b32 v80, 16, v98
    v_and_b32 v81, 0xffff0000, v98
    v_lshlrev_b32 v74, 16, v3
    v_and_b32 v75, 0xffff0000, v3
    v_lshlrev_b32 v82, 16, v99
    v_and_b32 v83, 0xffff0000, v99
    v_pk_add_f32 v[68:69], v[68:69], v[76:77]
    v_pk_add_f32 v[70:71], v[70:71], v[78:79]
    v_pk_add_f32 v[72:73], v[72:73], v[80:81]
    v_pk_add_f32 v[74:75], v[74:75], v[82:83]
    v_cvt_pk_bf16_f32 v4, v68, v69
    v_cvt_pk_bf16_f32 v5, v70, v71
    v_cvt_pk_bf16_f32 v6, v72, v73
    v_cvt_pk_bf16_f32 v7, v74, v75
    v_lshlrev_b32 v68, 16, v4
    v_and_b32 v69, 0xffff0000, v4
    v_lshlrev_b32 v70, 16, v5
    v_and_b32 v71, 0xffff0000, v5
    v_lshlrev_b32 v72, 16, v6
    v_and_b32 v73, 0xffff0000, v6
    v_lshlrev_b32 v74, 16, v7
    v_and_b32 v75, 0xffff0000, v7
    s_add_u32 s62, s64, 0x6000000
    buffer_store_dwordx4 v[4:7], v240, s[8:11], s62 offen sc1
    v_add_f32 v84, v68, v69
    v_add_f32 v84, v84, v70
    v_add_f32 v84, v84, v71
    v_add_f32 v84, v84, v72
    v_add_f32 v84, v84, v73
    v_add_f32 v84, v84, v74
    v_add_f32 v84, v84, v75
    s_nop 1
    v_add_f32_dpp v84, v84, v84 row_ror:1 row_mask:0xf bank_mask:0xf
    s_nop 1
    v_add_f32_dpp v84, v84, v84 row_ror:2 row_mask:0xf bank_mask:0xf
    s_nop 1
    v_add_f32_dpp v84, v84, v84 row_ror:4 row_mask:0xf bank_mask:0xf
    s_nop 1
    v_add_f32_dpp v84, v84, v84 row_ror:8 row_mask:0xf bank_mask:0xf
    v_mov_b32 v85, v84
    s_nop 1
    v_permlane32_swap_b32 v85, v84
    v_add_f32 v84, v85, v84
    v_mov_b32 v85, v84
    s_nop 1
    v_permlane16_swap_b32 v85, v84
    v_add_f32 v84, v85, v84
    v_mul_f32 v84, 0x3b000000, v84
    v_cvt_pk_bf16_f32 v86, v84, v84
    v_and_b32 v86, 0xffff0000, v86
    v_sub_f32 v87, v84, v86
    v_sub_f32 v76, v68, v86
    v_sub_f32 v77, v69, v86
    v_sub_f32 v78, v70, v86
    v_sub_f32 v79, v71, v86
    v_sub_f32 v80, v72, v86
    v_sub_f32 v81, v73, v86
    v_sub_f32 v82, v74, v86
    v_sub_f32 v83, v75, v86
    v_mul_f32 v100, v76, v76
    v_fmac_f32 v100, v77, v77
    v_fmac_f32 v100, v78, v78
    v_fmac_f32 v100, v79, v79
    v_fmac_f32 v100, v80, v80
    v_fmac_f32 v100, v81, v81
    v_fmac_f32 v100, v82, v82
    v_fmac_f32 v100, v83, v83
    s_nop 1
    v_add_f32_dpp v100, v100, v100 row_ror:1 row_mask:0xf bank_mask:0xf
    s_nop 1
    v_add_f32_dpp v100, v100, v100 row_ror:2 row_mask:0xf bank_mask:0xf
    s_nop 1
    v_add_f32_dpp v100, v100, v100 row_ror:4 row_mask:0xf bank_mask:0xf
    s_nop 1
    v_add_f32_dpp v100, v100, v100 row_ror:8 row_mask:0xf bank_mask:0xf
    v_mov_b32 v85, v100
    s_nop 1
    v_permlane32_swap_b32 v85, v100
    v_add_f32 v100, v85, v100
    v_mov_b32 v85, v100
    s_nop 1
    v_permlane16_swap_b32 v85, v100
    v_add_f32 v100, v85, v100
    v_mul_f32 v85, v87, v87
    v_mul_f32 v100, 0x3b000000, v100
    v_sub_f32 v100, v100, v85
    v_max_f32 v100, 0, v100
    v_cvt_pk_bf16_f32 v100, v100, v100
    v_and_b32 v100, 0xffff0000, v100
    v_add_f32 v100, 0x3727c5ac, v100
    v_cvt_pk_bf16_f32 v100, v100, v100
    v_and_b32 v100, 0xffff0000, v100
    v_sqrt_f32 v100, v100
    s_nop 0
    v_cvt_pk_bf16_f32 v100, v100, v100
    v_and_b32 v100, 0xffff0000, v100
    v_rcp_f32 v100, v100
    v_cvt_pk_bf16_f32 v8, v76, v77
    v_cvt_pk_bf16_f32 v9, v78, v79
    v_cvt_pk_bf16_f32 v10, v80, v81
    v_cvt_pk_bf16_f32 v11, v82, v83
    v_lshlrev_b32 v76, 16, v8
    v_and_b32 v77, 0xffff0000, v8
    v_lshlrev_b32 v78, 16, v9
    v_and_b32 v79, 0xffff0000, v9
    v_lshlrev_b32 v80, 16, v10
    v_and_b32 v81, 0xffff0000, v10
    v_lshlrev_b32 v82, 16, v11
    v_and_b32 v83, 0xffff0000, v11
    v_mul_f32 v76, v100, v76
    v_mul_f32 v77, v100, v77
    v_mul_f32 v78, v100, v78
    v_mul_f32 v79, v100, v79
    v_mul_f32 v80, v100, v80
    v_mul_f32 v81, v100, v81
    v_mul_f32 v82, v100, v82
    v_mul_f32 v83, v100, v83
    v_cvt_pk_bf16_f32 v8, v76, v77
    v_cvt_pk_bf16_f32 v9, v78, v79
    v_cvt_pk_bf16_f32 v10, v80, v81
    v_cvt_pk_bf16_f32 v11, v82, v83
    v_lshlrev_b32 v76, 16, v8
    v_and_b32 v77, 0xffff0000, v8
    v_lshlrev_b32 v78, 16, v9
    v_and_b32 v79, 0xffff0000, v9
    v_lshlrev_b32 v80, 16, v10
    v_and_b32 v81, 0xffff0000, v10
    v_lshlrev_b32 v82, 16, v11
    v_and_b32 v83, 0xffff0000, v11
    s_add_u32 s62, s64, 0x6200000
    buffer_store_dwordx4 v[8:11], v240, s[8:11], s62 offen sc1
    v_pk_add_f32 v[68:69], v[68:69], v[76:77]
    v_pk_add_f32 v[70:71], v[70:71], v[78:79]
    v_pk_add_f32 v[72:73], v[72:73], v[80:81]
    v_pk_add_f32 v[74:75], v[74:75], v[82:83]
    v_cvt_pk_bf16_f32 v12, v68, v69
    v_cvt_pk_bf16_f32 v13, v70, v71
    v_cvt_pk_bf16_f32 v14, v72, v73
    v_cvt_pk_bf16_f32 v15, v74, v75
    buffer_store_dwordx4 v[12:15], v240, s[16:19], s64 offen sc1
    v_lshlrev_b32 v88, 16, v236
    v_and_b32 v89, 0xffff0000, v236
    v_lshlrev_b32 v90, 16, v237
    v_and_b32 v91, 0xffff0000, v237
    v_lshlrev_b32 v92, 16, v238
    v_and_b32 v93, 0xffff0000, v238
    v_lshlrev_b32 v94, 16, v239
    v_and_b32 v95, 0xffff0000, v239
    v_mul_f32 v84, v76, v88
    v_fmac_f32 v84, v77, v89
    v_fmac_f32 v84, v78, v90
    v_fmac_f32 v84, v79, v91
    v_fmac_f32 v84, v80, v92
    v_fmac_f32 v84, v81, v93
    v_fmac_f32 v84, v82, v94
    v_fmac_f32 v84, v83, v95
    s_nop 1
    v_add_f32_dpp v84, v84, v84 row_ror:1 row_mask:0xf bank_mask:0xf
    s_nop 1
    v_add_f32_dpp v84, v84, v84 row_ror:2 row_mask:0xf bank_mask:0xf
    s_nop 1
    v_add_f32_dpp v84, v84, v84 row_ror:4 row_mask:0xf bank_mask:0xf
    s_nop 1
    v_add_f32_dpp v84, v84, v84 row_ror:8 row_mask:0xf bank_mask:0xf
    v_mov_b32 v85, v84
    s_nop 1
    v_permlane32_swap_b32 v85, v84
    v_add_f32 v84, v85, v84
    v_mov_b32 v85, v84
    s_nop 1
    v_permlane16_swap_b32 v85, v84
    v_add_f32 v84, v85, v84
    v_cvt_pk_bf16_f32 v84, v84, v84
    v_and_b32 v84, 0xffff0000, v84
    v_ashrrev_i32 v85, 31, v84
    v_or_b32 v85, 0x80000000, v85
    v_xor_b32 v84, v84, v85
    v_and_b32 v84, 0xffff0000, v84
    s_sub_u32 s62, 0x87ff, s60
    v_or_b32 v84, s62, v84
    s_lshl_b32 s62, s60, 2
    s_mov_b64 exec, 1
    s_add_u32 s63, s62, 0x6e00
    s_cmp_ge_u32 s60, 1920
    s_cselect_b32 s63, s63, 0x7ff00000
    buffer_store_dword v84, off, s[8:11], s63 sc1
    v_cmp_ge_u32 vcc, v104, v84
    s_cselect_b32 s63, 1, 0
    s_and_b32 s63, s63, vcc_lo
    s_cbranch_scc1 L_nokey_165
    s_add_u32 s62, s62, 0x6000
    s_waitcnt vmcnt(0)
    buffer_store_dword v84, off, s[8:11], s62 sc1
L_nokey_165:
    s_mov_b64 exec, -1
L_nofin_164:
    s_add_u32 s80, s80, 4
    s_add_u32 s22, s22, s23
    s_sub_u32 s24, s22, 68
    s_cmp_lt_u32 s24, 2
    s_cselect_b32 s82, 2, 0
    s_cselect_b32 s24, 6, 0
    s_sub_u32 s22, s22, s24
    s_branch L_p2_seg
L_p2_end:
    s_cmp_ge_u32 s67, 56
    s_cbranch_scc1 L_exit
    s_mov_b32 s74, 0
    s_mov_b32 s75, 0
    v_mov_b32 v202, 0x7ffffff0
    v_mbcnt_lo_u32_b32 v0, -1, 0
    v_mbcnt_hi_u32_b32 v0, -1, v0
    s_lshl_b32 s96, s100, 6
    v_add_u32 v0, s96, v0
    v_lshlrev_b32 v1, 6, v0
    s_getpc_b64 s[70:71]
L_pc_166:
    s_add_u32 s70, s70, L_ffn_round-L_pc_166
    s_addc_u32 s71, s71, 0
    v_min_u32 v1, L_code_end-L_ffn_round-4, v1
    global_load_dword v3, v1, s[70:71]
    v_mov_b32 v1, 0
    s_and_b32 s71, s101, 15
    s_lshl_b32 s71, s71, 7
    s_add_u32 s71, s71, 0x1000
    s_mov_b32 s72, 57
    s_cmp_lg_u32 s100, 0
    s_cbranch_scc1 L_polls_169
    s_mov_b32 exec_lo, 0x1
    s_mov_b32 exec_hi, 0
    s_mov_b32 s96, 0
L_poll_167:
    buffer_load_dword v2, v1, s[8:11], s71 offen sc1
    s_waitcnt vmcnt(0)
    v_cmp_gt_u32 vcc, s72, v2
    s_cbranch_vccz L_polld_168
    v_readfirstlane_b32 s97, v2
    s_nop 0
    s_sub_u32 s97, s72, s97
    s_cmp_lt_i32 s97, 3
    s_cbranch_scc1 L_near_170
    s_sleep 40
    s_cmp_lt_i32 s97, 5
    s_cbranch_scc1 L_near_170
    s_sleep 100
L_near_170:
    s_sleep 16
    s_add_u32 s96, s96, 1
    s_cmp_lt_u32 s96, 0x10000
    s_cbranch_scc1 L_poll_167
L_polld_168:
    s_mov_b64 exec, -1
L_polls_169:
    s_barrier
L_ffn_round:
    v_mbcnt_lo_u32_b32 v0, -1, 0
    v_mbcnt_hi_u32_b32 v0, -1, v0
    s_lshl_b32 s96, s100, 6
    v_add_u32 v0, s96, v0
    s_cmp_lg_u32 s75, 0
    s_cbranch_scc1 L_ffn_re
    v_lshlrev_b32 v30, 5, v0
    s_mov_b32 s69, 0x6000
    v_cmp_le_u32 vcc, 224, v0
    v_mov_b32 v29, s75
    v_add_u32 v29, -1, v29
    v_cndmask_b32 v19, 0, v29, vcc
    s_mov_b32 s70, 0
L_kpoll_171:
    buffer_load_dwordx4 v[20:23], v30, s[8:11], s69 offen sc1
    buffer_load_dwordx4 v[24:27], v30, s[8:11], s69 offen offset:16 sc1
    s_waitcnt vmcnt(0)
    v_min3_u32 v28, v20, v21, v22
    v_min3_u32 v28, v28, v23, v24
    v_min3_u32 v28, v28, v25, v26
    v_min_u32 v28, v28, v27
    v_or_b32 v28, v28, v19
    v_cmp_eq_u32 vcc, 0, v28
    s_cbranch_vccz L_kpolld_172
    s_sleep 6
    s_add_u32 s70, s70, 1
    s_cmp_lt_u32 s70, 0x10000
    s_cbranch_scc1 L_kpoll_171
L_kpolld_172:
    v_bfi_b32 v20, v19, 0, v20
    v_bfi_b32 v21, v19, 0, v21
    v_bfi_b32 v22, v19, 0, v22
    v_bfi_b32 v23, v19, 0, v23
    v_bfi_b32 v24, v19, 0, v24
    v_bfi_b32 v25, v19, 0, v25
    v_bfi_b32 v26, v19, 0, v26
    v_bfi_b32 v27, v19, 0, v27
    v_lshrrev_b32 v30, 6, v0
    v_lshlrev_b32 v30, 2, v30
    v_add_u32 v30, 0x20400, v30
    v_mov_b32 v31, 0x20400
    s_waitcnt vmcnt(0)
    v_max3_u32 v28, v20, v21, v22
    v_max3_u32 v28, v28, v23, v24
    v_max3_u32 v28, v28, v25, v26
    v_max_u32 v28, v28, v27
    s_nop 1
    v_max_u32_dpp v28, v28, v28 row_ror:1 row_mask:0xf bank_mask:0xf
    s_nop 1
    v_max_u32_dpp v28, v28, v28 row_ror:2 row_mask:0xf bank_mask:0xf
    s_nop 1
    v_max_u32_dpp v28, v28, v28 row_ror:4 row_mask:0xf bank_mask:0xf
    s_nop 1
    v_max_u32_dpp v28, v28, v28 row_ror:8 row_mask:0xf bank_mask:0xf
    v_mov_b32 v29, v28
    s_nop 1
    v_permlane32_swap_b32 v29, v28
    v_max_u32 v28, v29, v28
    v_mov_b32 v29, v28
    s_nop 1
    v_permlane16_swap_b32 v29, v28
    v_max_u32 v28, v29, v28
    ds_write_b32 v30, v28
    s_waitcnt lgkmcnt(0)
    s_barrier
    ds_read_b128 v[16:19], v31
    s_waitcnt lgkmcnt(0)
    v_max3_u32 v28, v16, v17, v18
    v_max_u32 v28, v28, v19
    s_nop 0
    v_readfirstlane_b32 s69, v28
    s_nop 1
    v_cmp_ne_u32 vcc, s69, v20
    s_nop 1
    v_cndmask_b32 v20, 0, v20, vcc
    v_cmp_ne_u32 vcc, s69, v21
    s_nop 1
    v_cndmask_b32 v21, 0, v21, vcc
    v_cmp_ne_u32 vcc, s69, v22
    s_nop 1
    v_cndmask_b32 v22, 0, v22, vcc
    v_cmp_ne_u32 vcc, s69, v23
    s_nop 1
    v_cndmask_b32 v23, 0, v23, vcc
    v_cmp_ne_u32 vcc, s69, v24
    s_nop 1
    v_cndmask_b32 v24, 0, v24, vcc
    v_cmp_ne_u32 vcc, s69, v25
    s_nop 1
    v_cndmask_b32 v25, 0, v25, vcc
    v_cmp_ne_u32 vcc, s69, v26
    s_nop 1
    v_cndmask_b32 v26, 0, v26, vcc
    v_cmp_ne_u32 vcc, s69, v27
    s_nop 1
    v_cndmask_b32 v27, 0, v27, vcc
    v_max3_u32 v28, v20, v21, v22
    v_max3_u32 v28, v28, v23, v24
    v_max3_u32 v28, v28, v25, v26
    v_max_u32 v28, v28, v27
    s_nop 1
    v_max_u32_dpp v28, v28, v28 row_ror:1 row_mask:0xf bank_mask:0xf
    s_nop 1
    v_max_u32_dpp v28, v28, v28 row_ror:2 row_mask:0xf bank_mask:0xf
    s_nop 1
    v_max_u32_dpp v28, v28, v28 row_ror:4 row_mask:0xf bank_mask:0xf
    s_nop 1
    v_max_u32_dpp v28, v28, v28 row_ror:8 row_mask:0xf bank_mask:0xf
    v_mov_b32 v29, v28
    s_nop 1
    v_permlane32_swap_b32 v29, v28
    v_max_u32 v28, v29, v28
    v_mov_b32 v29, v28
    s_nop 1
    v_permlane16_swap_b32 v29, v28
    v_max_u32 v28, v29, v28
    ds_write_b32 v30, v28 offset:16
    s_waitcnt lgkmcnt(0)
    s_barrier
    ds_read_b128 v[16:19], v31 offset:16
    s_waitcnt lgkmcnt(0)
    v_max3_u32 v28, v16, v17, v18
    v_max_u32 v28, v28, v19
    s_nop 0
    v_readfirstlane_b32 s70, v28
    s_barrier
    s_cmp_lg_u32 s67, 55
    s_cbranch_scc1 L_ffn_sel
    s_mov_b32 s71, 0x8f00
    s_cmp_lg_u32 s100, 0
    s_cbranch_scc1 L_flag_173
    v_mov_b32 v2, s70
    s_mov_b64 exec, 1
    buffer_store_dword v2, off, s[8:11], s71 sc1
    s_mov_b64 exec, -1
L_flag_173:
    s_branch L_ffn_sel
L_ffn_re:
    v_and_b32 v24, 63, v0
    v_lshlrev_b32 v24, 3, v24
    v_mov_b32 v23, 0x20400
    s_cmp_lg_u32 s100, 0
    s_cbranch_scc1 L_rselw_177
    s_mov_b32 s71, 0x7e00
    s_mov_b32 s71, 0x7c00
    s_cmp_eq_u32 s75, 1
    s_cselect_b32 s71, s71, 0x8c00
    s_mov_b32 s72, 0
L_rsel_174:
    buffer_load_dwordx2 v[20:21], v24, s[8:11], s71 offen sc1
    s_waitcnt vmcnt(0)
    v_min_u32 v22, v20, v21
    v_cmp_eq_u32 vcc, 0, v22
    s_cbranch_vccz L_rseld_175
    s_sleep 1
    s_add_u32 s72, s72, 1
    s_cmp_lt_u32 s72, 0x10000
    s_cbranch_scc1 L_rsel_174
L_rseld_175:
    v_max_u32 v22, v20, v21
    v_cmp_lt_u32 vcc, s70, v22
    s_cbranch_vccz L_rsele_176
    s_cmp_lg_u32 s71, 0x8c00
    s_cbranch_scc1 L_rackd_179
    s_mov_b32 s71, 0x7e00
L_rack_178:
    buffer_load_dwordx2 v[26:27], v24, s[8:11], s71 offen sc1
    s_add_u32 s72, s72, 1
    s_waitcnt vmcnt(0)
    v_sub_u32 v26, v20, v26
    v_sub_u32 v27, v21, v27
    v_max_u32 v26, v26, v27
    v_cmp_lt_u32 vcc, s70, v26
    s_cbranch_vccz L_rackd_179
    s_cmp_lt_u32 s72, 0x10000
    s_cbranch_scc1 L_rack_178
L_rackd_179:
    v_max_u32_dpp v22, v22, v22 row_ror:1 row_mask:0xf bank_mask:0xf
    s_nop 1
    v_max_u32_dpp v22, v22, v22 row_ror:2 row_mask:0xf bank_mask:0xf
    s_nop 1
    v_max_u32_dpp v22, v22, v22 row_ror:4 row_mask:0xf bank_mask:0xf
    s_nop 1
    v_max_u32_dpp v22, v22, v22 row_ror:8 row_mask:0xf bank_mask:0xf
    v_mov_b32 v23, v22
    s_nop 1
    v_permlane32_swap_b32 v23, v22
    v_max_u32 v22, v23, v22
    v_mov_b32 v23, v22
    s_nop 1
    v_permlane16_swap_b32 v23, v22
    v_max_u32 v22, v23, v22
    s_nop 0
    v_readfirstlane_b32 s71, v22
    s_nop 1
    v_cmp_ne_u32 vcc, s71, v20
    s_nop 1
    v_cndmask_b32 v20, 0, v20, vcc
    v_cmp_ne_u32 vcc, s71, v21
    s_nop 1
    v_cndmask_b32 v21, 0, v21, vcc
    v_max_u32 v22, v20, v21
    s_nop 1
    v_max_u32_dpp v22, v22, v22 row_ror:1 row_mask:0xf bank_mask:0xf
    s_nop 1
    v_max_u32_dpp v22, v22, v22 row_ror:2 row_mask:0xf bank_mask:0xf
    s_nop 1
    v_max_u32_dpp v22, v22, v22 row_ror:4 row_mask:0xf bank_mask:0xf
    s_nop 1
    v_max_u32_dpp v22, v22, v22 row_ror:8 row_mask:0xf bank_mask:0xf
    v_mov_b32 v23, v22
    s_nop 1
    v_permlane32_swap_b32 v23, v22
    v_max_u32 v22, v23, v22
    v_mov_b32 v23, v22
    s_nop 1
    v_permlane16_swap_b32 v23, v22
    v_max_u32 v22, v23, v22
    s_nop 0
    v_readfirstlane_b32 s72, v22
    s_nop 0
    s_max_u32 s70, s70, s72
    s_min_u32 s72, s71, s69
    s_max_u32 s70, s70, s72
    s_max_u32 s69, s69, s71
L_rsele_176:
    v_mov_b32 v23, 0x20400
    v_mov_b32 v20, s69
    v_mov_b32 v21, s70
    ds_write_b64 v23, v[20:21]
    s_waitcnt lgkmcnt(0)
L_rselw_177:
    s_barrier
    ds_read_b64 v[20:21], v23
    s_waitcnt lgkmcnt(0)
    v_readfirstlane_b32 s69, v20
    v_readfirstlane_b32 s70, v21
    s_barrier
    s_nop 3
L_ffn_sel:
    s_and_b32 s71, s69, 2047
    s_lshl_b32 s71, s71, 11
    s_and_b32 s72, s70, 2047
    s_or_b32 s71, s71, s72
    s_add_u32 s71, s71, 1
    s_cmp_eq_u32 s71, s74
    s_cbranch_scc1 L_ffn_same
    s_mov_b32 s74, s71
    v_and_b32 v1, 63, v0
    v_lshrrev_b32 v2, 4, v1
    v_and_b32 v3, 15, v1
    v_lshrrev_b32 v6, 2, v3
    s_and_b32 s71, s69, 2047
    s_sub_u32 s71, 2047, s71
    s_and_b32 s72, s70, 2047
    s_sub_u32 s72, 2047, s72
    v_and_b32 v4, 1, v3
    v_cmp_eq_u32 vcc, 0, v4
    v_mov_b32 v4, s71
    v_mov_b32 v5, s72
    v_cndmask_b32 v4, v5, v4, vcc
    v_lshlrev_b32 v4, 10, v4
    v_lshl_add_u32 v4, v2, 4, v4
    s_mov_b32 s71, 0x6200000
    buffer_load_dwordx4 v[32:35], v4, s[8:11], s71 offen
    buffer_load_dwordx4 v[36:39], v4, s[8:11], s71 offen offset:64
    buffer_load_dwordx4 v[40:43], v4, s[8:11], s71 offen offset:128
    buffer_load_dwordx4 v[44:47], v4, s[8:11], s71 offen offset:192
    buffer_load_dwordx4 v[48:51], v4, s[8:11], s71 offen offset:256
    buffer_load_dwordx4 v[52:55], v4, s[8:11], s71 offen offset:320
    buffer_load_dwordx4 v[56:59], v4, s[8:11], s71 offen offset:384
    buffer_load_dwordx4 v[60:63], v4, s[8:11], s71 offen offset:448
    buffer_load_dwordx4 v[64:67], v4, s[8:11], s71 offen offset:512
    buffer_load_dwordx4 v[68:71], v4, s[8:11], s71 offen offset:576
    buffer_load_dwordx4 v[72:75], v4, s[8:11], s71 offen offset:640
    buffer_load_dwordx4 v[76:79], v4, s[8:11], s71 offen offset:704
    buffer_load_dwordx4 v[80:83], v4, s[8:11], s71 offen offset:768
    buffer_load_dwordx4 v[84:87], v4, s[8:11], s71 offen offset:832
    buffer_load_dwordx4 v[88:91], v4, s[8:11], s71 offen offset:896
    buffer_load_dwordx4 v[92:95], v4, s[8:11], s71 offen offset:960
    v_lshl_add_u32 v4, v2, 3, v6
    v_lshlrev_b32 v4, 6, v4
    v_and_b32 v5, 3, v3
    v_lshl_add_u32 v4, v5, 3, v4
    s_lshr_b32 s71, s68, 1
    s_lshl_b32 s71, s71, 15
    s_and_b32 s72, s68, 1
    s_lshl_b32 s72, s72, 5
    s_add_u32 s71, s71, s72
    s_add_u32 s71, s71, 0x8000
    v_add_u32 v7, s71, v4
    ds_read_b64_tr_b16 v[96:97], v7
    ds_read_b64_tr_b16 v[98:99], v7 offset:256
    ds_read_b64_tr_b16 v[100:101], v7 offset:2048
    ds_read_b64_tr_b16 v[102:103], v7 offset:2304
    ds_read_b64_tr_b16 v[104:105], v7 offset:4096
    ds_read_b64_tr_b16 v[106:107], v7 offset:4352
    ds_read_b64_tr_b16 v[108:109], v7 offset:6144
    ds_read_b64_tr_b16 v[110:111], v7 offset:6400
    s_waitcnt lgkmcnt(0)
    ds_read_b64_tr_b16 v[112:113], v7 offset:8192
    ds_read_b64_tr_b16 v[114:115], v7 offset:8448
    ds_read_b64_tr_b16 v[116:117], v7 offset:10240
    ds_read_b64_tr_b16 v[118:119], v7 offset:10496
    ds_read_b64_tr_b16 v[120:121], v7 offset:12288
    ds_read_b64_tr_b16 v[122:123], v7 offset:12544
    ds_read_b64_tr_b16 v[124:125], v7 offset:14336
    ds_read_b64_tr_b16 v[126:127], v7 offset:14592
    s_waitcnt lgkmcnt(0)
    ds_read_b64_tr_b16 v[128:129], v7 offset:16384
    ds_read_b64_tr_b16 v[130:131], v7 offset:16640
    ds_read_b64_tr_b16 v[132:133], v7 offset:18432
    ds_read_b64_tr_b16 v[134:135], v7 offset:18688
    ds_read_b64_tr_b16 v[136:137], v7 offset:20480
    ds_read_b64_tr_b16 v[138:139], v7 offset:20736
    ds_read_b64_tr_b16 v[140:141], v7 offset:22528
    ds_read_b64_tr_b16 v[142:143], v7 offset:22784
    s_waitcnt lgkmcnt(0)
    ds_read_b64_tr_b16 v[144:145], v7 offset:24576
    ds_read_b64_tr_b16 v[146:147], v7 offset:24832
    ds_read_b64_tr_b16 v[148:149], v7 offset:26624
    ds_read_b64_tr_b16 v[150:151], v7 offset:26880
    ds_read_b64_tr_b16 v[152:153], v7 offset:28672
    ds_read_b64_tr_b16 v[154:155], v7 offset:28928
    ds_read_b64_tr_b16 v[156:157], v7 offset:30720
    ds_read_b64_tr_b16 v[158:159], v7 offset:30976
    s_waitcnt lgkmcnt(0)
    s_waitcnt vmcnt(0)
    v_mfma_f32_16x16x32_bf16 v[8:11], v[32:35], v[96:99], 0
    v_mfma_f32_16x16x32_bf16 v[8:11], v[36:39], v[100:103], v[8:11]
    v_mfma_f32_16x16x32_bf16 v[8:11], v[40:43], v[104:107], v[8:11]
    v_mfma_f32_16x16x32_bf16 v[8:11], v[44:47], v[108:111], v[8:11]
    v_mfma_f32_16x16x32_bf16 v[8:11], v[48:51], v[112:115], v[8:11]
    v_mfma_f32_16x16x32_bf16 v[8:11], v[52:55], v[116:119], v[8:11]
    v_mfma_f32_16x16x32_bf16 v[8:11], v[56:59], v[120:123], v[8:11]
    v_mfma_f32_16x16x32_bf16 v[8:11], v[60:63], v[124:127], v[8:11]
    v_mfma_f32_16x16x32_bf16 v[8:11], v[64:67], v[128:131], v[8:11]
    v_mfma_f32_16x16x32_bf16 v[8:11], v[68:71], v[132:135], v[8:11]
    v_mfma_f32_16x16x32_bf16 v[8:11], v[72:75], v[136:139], v[8:11]
    v_mfma_f32_16x16x32_bf16 v[8:11], v[76:79], v[140:143], v[8:11]
    v_mfma_f32_16x16x32_bf16 v[8:11], v[80:83], v[144:147], v[8:11]
    v_mfma_f32_16x16x32_bf16 v[8:11], v[84:87], v[148:151], v[8:11]
    v_mfma_f32_16x16x32_bf16 v[8:11], v[88:91], v[152:155], v[8:11]
    v_mfma_f32_16x16x32_bf16 v[8:11], v[92:95], v[156:159], v[8:11]
    s_nop 7
    v_cvt_pk_bf16_f32 v8, v8, v8
    v_and_b32 v8, 0xffff0000, v8
    v_cvt_pk_bf16_f32 v9, v9, v9
    v_and_b32 v9, 0xffff0000, v9
    s_cmp_ge_u32 s68, 2
    s_cbranch_scc1 L_ffn_up_180
    v_mul_f32 v13, 0xbfb8aa3b, v8
    v_exp_f32 v13, v13
    s_nop 0
    v_add_f32 v13, 1.0, v13
    v_rcp_f32 v12, v13
    s_nop 0
    v_mul_f32 v8, v12, v8
    v_cvt_pk_bf16_f32 v8, v8, v8
    v_and_b32 v8, 0xffff0000, v8
    v_mul_f32 v13, 0xbfb8aa3b, v9
    v_exp_f32 v13, v13
    s_nop 0
    v_add_f32 v13, 1.0, v13
    v_rcp_f32 v12, v13
    s_nop 0
    v_mul_f32 v9, v12, v9
    v_cvt_pk_bf16_f32 v9, v9, v9
    v_and_b32 v9, 0xffff0000, v9
    s_nop 4
L_ffn_up_180:
    s_lshr_b32 s71, s68, 1
    s_lshl_b32 s71, s71, 8
    s_and_b32 s72, s68, 1
    s_lshl_b32 s72, s72, 6
    s_add_u32 s71, s71, s72
    s_add_u32 s71, s71, 0x20000
    v_lshlrev_b32 v4, 2, v3
    v_add_u32 v4, s71, v4
    ds_write_b32 v4, v8
    ds_write_b32 v4, v9 offset:128
    s_waitcnt lgkmcnt(0)
    s_barrier
    v_and_b32 v4, 1, v3
    v_lshlrev_b32 v4, 7, v4
    v_lshl_add_u32 v4, v2, 5, v4
    v_add_u32 v4, 0x20000, v4
    ds_read_b128 v[32:35], v4
    ds_read_b128 v[36:39], v4 offset:16
    ds_read_b128 v[40:43], v4 offset:256
    ds_read_b128 v[44:47], v4 offset:272
    v_lshl_add_u32 v5, v2, 3, v6
    v_lshlrev_b32 v5, 10, v5
    v_and_b32 v7, 3, v3
    v_lshl_add_u32 v5, v7, 3, v5
    s_lshl_b32 s71, s68, 8
    s_add_u32 s71, s71, 0x18000
    v_add_u32 v7, s71, v5
    s_waitcnt lgkmcnt(0)
    ds_read_b64_tr_b16 v[96:97], v7
    ds_read_b64_tr_b16 v[98:99], v7 offset:4096
    ds_read_b64_tr_b16 v[100:101], v7 offset:32
    ds_read_b64_tr_b16 v[102:103], v7 offset:4128
    ds_read_b64_tr_b16 v[104:105], v7 offset:64
    ds_read_b64_tr_b16 v[106:107], v7 offset:4160
    ds_read_b64_tr_b16 v[108:109], v7 offset:96
    ds_read_b64_tr_b16 v[110:111], v7 offset:4192
    s_waitcnt lgkmcnt(0)
    ds_read_b64_tr_b16 v[112:113], v7 offset:128
    ds_read_b64_tr_b16 v[114:115], v7 offset:4224
    ds_read_b64_tr_b16 v[116:117], v7 offset:160
    ds_read_b64_tr_b16 v[118:119], v7 offset:4256
    ds_read_b64_tr_b16 v[120:121], v7 offset:192
    ds_read_b64_tr_b16 v[122:123], v7 offset:4288
    ds_read_b64_tr_b16 v[124:125], v7 offset:224
    ds_read_b64_tr_b16 v[126:127], v7 offset:4320
    v_mul_f32 v32, v32, v40
    v_mul_f32 v33, v33, v41
    v_mul_f32 v34, v34, v42
    v_mul_f32 v35, v35, v43
    v_mul_f32 v36, v36, v44
    v_mul_f32 v37, v37, v45
    v_mul_f32 v38, v38, v46
    v_mul_f32 v39, v39, v47
    v_cvt_pk_bf16_f32 v48, v32, v33
    v_cvt_pk_bf16_f32 v49, v34, v35
    v_cvt_pk_bf16_f32 v50, v36, v37
    v_cvt_pk_bf16_f32 v51, v38, v39
    s_waitcnt lgkmcnt(0)
    s_nop 0
    v_mfma_f32_16x16x32_bf16 v[56:59], v[48:51], v[96:99], 0
    v_mfma_f32_16x16x32_bf16 v[60:63], v[48:51], v[100:103], 0
    v_mfma_f32_16x16x32_bf16 v[64:67], v[48:51], v[104:107], 0
    v_mfma_f32_16x16x32_bf16 v[68:71], v[48:51], v[108:111], 0
    v_mfma_f32_16x16x32_bf16 v[72:75], v[48:51], v[112:115], 0
    v_mfma_f32_16x16x32_bf16 v[76:79], v[48:51], v[116:119], 0
    v_mfma_f32_16x16x32_bf16 v[80:83], v[48:51], v[120:123], 0
    v_mfma_f32_16x16x32_bf16 v[84:87], v[48:51], v[124:127], 0
    v_cmp_eq_u32 vcc, 0, v2
    v_lshlrev_b32 v4, 11, v2
    v_lshl_add_u32 v4, v3, 2, v4
    s_lshl_b32 s71, s67, 12
    s_lshl_b32 s72, s68, 9
    s_add_u32 s71, s71, s72
    s_add_u32 s71, s71, 0x6410000
    v_cndmask_b32 v56, v57, v56, vcc
    v_cndmask_b32 v60, v61, v60, vcc
    v_cndmask_b32 v64, v65, v64, vcc
    v_cndmask_b32 v68, v69, v68, vcc
    v_cndmask_b32 v72, v73, v72, vcc
    v_cndmask_b32 v76, v77, v76, vcc
    v_cndmask_b32 v80, v81, v80, vcc
    v_cndmask_b32 v84, v85, v84, vcc
    s_mov_b32 exec_hi, 0
    buffer_store_dword v56, v4, s[8:11], s71 offen sc1
    buffer_store_dword v60, v4, s[8:11], s71 offen offset:64 sc1
    buffer_store_dword v64, v4, s[8:11], s71 offen offset:128 sc1
    buffer_store_dword v68, v4, s[8:11], s71 offen offset:192 sc1
    buffer_store_dword v72, v4, s[8:11], s71 offen offset:256 sc1
    buffer_store_dword v76, v4, s[8:11], s71 offen offset:320 sc1
    buffer_store_dword v80, v4, s[8:11], s71 offen offset:384 sc1
    buffer_store_dword v84, v4, s[8:11], s71 offen offset:448 sc1
    s_mov_b64 exec, -1
    s_waitcnt vmcnt(0)
    s_barrier
    s_lshl_b32 s71, s67, 2
    s_lshl_b32 s72, s75, 8
    s_add_u32 s71, s71, s72
    s_add_u32 s71, s71, 0x8000
    s_cmp_lg_u32 s100, 0
    s_cbranch_scc1 L_flag_181
    v_mov_b32 v2, s74
    s_mov_b64 exec, 1
    buffer_store_dword v2, off, s[8:11], s71 sc1
    s_mov_b64 exec, -1
L_flag_181:
    s_cmp_ge_u32 s67, 8
    s_cbranch_scc1 L_ffn_same
    s_load_dwordx2 s[16:17], s[0:1], 96
    s_waitcnt lgkmcnt(0)
    s_and_b32 s17, s17, 0xffff
    s_mov_b32 s18, 0x200000
    s_mov_b32 s19, 0x20000
    v_and_b32 v3, 63, v0
    s_cmp_lt_u32 s100, 2
    s_cselect_b32 s71, s69, s70
    v_mov_b32 v5, s71
    s_and_b32 s71, s71, 2047
    s_sub_u32 s71, 2047, s71
    s_lshl_b32 s71, s71, 10
    s_lshl_b32 s72, s67, 1
    s_and_b32 s96, s100, 1
    s_add_u32 s72, s72, s96
    s_lshl_b32 s96, s72, 6
    s_add_u32 s71, s71, s96
    v_and_b32 v4, 7, v3
    v_lshlrev_b32 v6, 3, v4
    v_add_u32 v6, s71, v6
    v_lshrrev_b32 v7, 3, v3
    v_lshlrev_b32 v7, 12, v7
    v_lshl_add_u32 v7, v4, 4, v7
    s_lshl_b32 s72, s72, 7
    s_lshr_b32 s96, s100, 1
    s_lshl_b32 s96, s96, 11
    s_add_u32 s72, s72, s96
    v_add_u32 v7, s72, v7
    s_mov_b32 s71, 0x6000000
    s_mov_b32 s72, 0x6200000
    buffer_load_dwordx2 v[8:9], v6, s[8:11], s71 offen sc1
    buffer_load_dwordx2 v[10:11], v6, s[8:11], s72 offen sc1
    v_and_b32 v5, 0xffff0000, v5
    v_ashrrev_i32 v4, 31, v5
    v_not_b32 v4, v4
    v_or_b32 v4, 0x80000000, v4
    v_xor_b32 v5, v5, v4
    v_and_b32 v5, 0xffff0000, v5
    v_mul_f32 v23, 0xbfb8aa3b, v5
    v_exp_f32 v23, v23
    s_nop 0
    v_add_f32 v23, 1.0, v23
    v_rcp_f32 v22, v23
    s_nop 0
    v_cvt_pk_bf16_f32 v22, v22, v22
    v_and_b32 v22, 0xffff0000, v22
    v_lshlrev_b32 v1, 2, v0
    s_lshl_b32 s71, s75, 8
    s_add_u32 s71, s71, 0x8000
    s_cmp_lg_u32 s100, 0
    s_cbranch_scc1 L_polls_184
    s_mov_b32 exec_hi, 0xffffff
    s_mov_b32 s96, 0
L_poll_182:
    buffer_load_dword v2, v1, s[8:11], s71 offen sc1
    s_waitcnt vmcnt(0)
    v_cmp_ne_u32 vcc, s74, v2
    s_cbranch_vccz L_polld_183
    s_sleep 2
    s_add_u32 s96, s96, 1
    s_cmp_lt_u32 s96, 0x10000
    s_cbranch_scc1 L_poll_182
L_polld_183:
    s_mov_b64 exec, -1
L_polls_184:
    s_barrier
    s_mov_b32 s71, 0x6410000
    buffer_load_dwordx4 v[32:35], v7, s[8:11], s71 offen sc1
    s_add_u32 s71, s71, 32768
    buffer_load_dwordx4 v[36:39], v7, s[8:11], s71 offen sc1
    s_add_u32 s71, s71, 32768
    buffer_load_dwordx4 v[40:43], v7, s[8:11], s71 offen sc1
    s_add_u32 s71, s71, 32768
    buffer_load_dwordx4 v[44:47], v7, s[8:11], s71 offen sc1
    s_add_u32 s71, s71, 32768
    buffer_load_dwordx4 v[48:51], v7, s[8:11], s71 offen sc1
    s_add_u32 s71, s71, 32768
    buffer_load_dwordx4 v[52:55], v7, s[8:11], s71 offen sc1
    s_add_u32 s71, s71, 32768
    buffer_load_dwordx4 v[56:59], v7, s[8:11], s71 offen sc1
    s_add_u32 s71, s71, 32768
    s_waitcnt vmcnt(7)
    v_lshlrev_b32 v12, 16, v8
    v_and_b32 v13, 0xffff0000, v8
    v_lshlrev_b32 v16, 16, v10
    v_and_b32 v17, 0xffff0000, v10
    v_lshlrev_b32 v14, 16, v9
    v_and_b32 v15, 0xffff0000, v9
    v_lshlrev_b32 v18, 16, v11
    v_and_b32 v19, 0xffff0000, v11
    s_waitcnt vmcnt(0)
    v_pk_add_f32 v[32:33], v[32:33], v[36:37]
    v_pk_add_f32 v[34:35], v[34:35], v[38:39]
    v_pk_add_f32 v[32:33], v[32:33], v[40:41]
    v_pk_add_f32 v[34:35], v[34:35], v[42:43]
    v_pk_add_f32 v[32:33], v[32:33], v[44:45]
    v_pk_add_f32 v[34:35], v[34:35], v[46:47]
    v_pk_add_f32 v[32:33], v[32:33], v[48:49]
    v_pk_add_f32 v[34:35], v[34:35], v[50:51]
    v_pk_add_f32 v[32:33], v[32:33], v[52:53]
    v_pk_add_f32 v[34:35], v[34:35], v[54:55]
    v_pk_add_f32 v[32:33], v[32:33], v[56:57]
    v_pk_add_f32 v[34:35], v[34:35], v[58:59]
    s_nop 0
    v_add_f32_dpp v32, v32, v32 row_ror:8 row_mask:0xf bank_mask:0xf
    v_add_f32_dpp v33, v33, v33 row_ror:8 row_mask:0xf bank_mask:0xf
    v_add_f32_dpp v34, v34, v34 row_ror:8 row_mask:0xf bank_mask:0xf
    v_add_f32_dpp v35, v35, v35 row_ror:8 row_mask:0xf bank_mask:0xf
    v_mov_b32 v24, v32
    s_nop 1
    v_permlane32_swap_b32 v24, v32
    v_add_f32 v32, v24, v32
    v_mov_b32 v24, v32
    s_nop 1
    v_permlane16_swap_b32 v24, v32
    v_add_f32 v32, v24, v32
    v_mov_b32 v24, v33
    s_nop 1
    v_permlane32_swap_b32 v24, v33
    v_add_f32 v33, v24, v33
    v_mov_b32 v24, v33
    s_nop 1
    v_permlane16_swap_b32 v24, v33
    v_add_f32 v33, v24, v33
    v_mov_b32 v24, v34
    s_nop 1
    v_permlane32_swap_b32 v24, v34
    v_add_f32 v34, v24, v34
    v_mov_b32 v24, v34
    s_nop 1
    v_permlane16_swap_b32 v24, v34
    v_add_f32 v34, v24, v34
    v_mov_b32 v24, v35
    s_nop 1
    v_permlane32_swap_b32 v24, v35
    v_add_f32 v35, v24, v35
    v_mov_b32 v24, v35
    s_nop 1
    v_permlane16_swap_b32 v24, v35
    v_add_f32 v35, v24, v35
    v_cvt_pk_bf16_f32 v32, v32, v32
    v_and_b32 v32, 0xffff0000, v32
    v_mul_f32 v32, v22, v32
    v_cvt_pk_bf16_f32 v32, v32, v32
    v_and_b32 v32, 0xffff0000, v32
    v_add_f32 v32, v16, v32
    v_cvt_pk_bf16_f32 v32, v32, v32
    v_and_b32 v32, 0xffff0000, v32
    v_add_f32 v32, v12, v32
    v_cvt_pk_bf16_f32 v33, v33, v33
    v_and_b32 v33, 0xffff0000, v33
    v_mul_f32 v33, v22, v33
    v_cvt_pk_bf16_f32 v33, v33, v33
    v_and_b32 v33, 0xffff0000, v33
    v_add_f32 v33, v17, v33
    v_cvt_pk_bf16_f32 v33, v33, v33
    v_and_b32 v33, 0xffff0000, v33
    v_add_f32 v33, v13, v33
    v_cvt_pk_bf16_f32 v34, v34, v34
    v_and_b32 v34, 0xffff0000, v34
    v_mul_f32 v34, v22, v34
    v_cvt_pk_bf16_f32 v34, v34, v34
    v_and_b32 v34, 0xffff0000, v34
    v_add_f32 v34, v18, v34
    v_cvt_pk_bf16_f32 v34, v34, v34
    v_and_b32 v34, 0xffff0000, v34
    v_add_f32 v34, v14, v34
    v_cvt_pk_bf16_f32 v35, v35, v35
    v_and_b32 v35, 0xffff0000, v35
    v_mul_f32 v35, v22, v35
    v_cvt_pk_bf16_f32 v35, v35, v35
    v_and_b32 v35, 0xffff0000, v35
    v_add_f32 v35, v19, v35
    v_cvt_pk_bf16_f32 v35, v35, v35
    v_and_b32 v35, 0xffff0000, v35
    v_add_f32 v35, v15, v35
    v_cvt_pk_bf16_f32 v200, v32, v33
    v_cvt_pk_bf16_f32 v201, v34, v35
    v_mov_b32 v202, v6
L_ffn_same:
    s_add_u32 s75, s75, 1
    s_cmp_lt_u32 s75, 3
    s_cbranch_scc1 L_ffn_round
    s_cmp_ge_u32 s67, 8
    s_cbranch_scc1 L_exit
    s_mov_b32 exec_lo, 0xff
    s_mov_b32 exec_hi, 0
    buffer_store_dwordx2 v[200:201], v202, s[16:19], 0 offen
    s_mov_b64 exec, -1
    s_waitcnt vmcnt(0)
L_exit:
    s_endpgm
L_code_end:
.section .rodata,"a"
.p2align 6
.amdhsa_kernel sequential_preLN__memory_aug_recurrent_mem_tr__moe_arch_mod__prompt_kernel
  .amdhsa_next_free_vgpr 512
  .amdhsa_next_free_sgpr 102
  .amdhsa_accum_offset 256
  .amdhsa_group_segment_fixed_size 0
  .amdhsa_kernarg_size 120
  .amdhsa_user_sgpr_count 2
  .amdhsa_user_sgpr_kernarg_segment_ptr 1
  .amdhsa_system_sgpr_workgroup_id_x 1
  .amdhsa_float_denorm_mode_32 3
.end_amdhsa_kernel
```

```asm
; @launch grid=(256,1,1) block=(256,1,1) lds=163840
.amdgcn_target "amdgcn-amd-amdhsa--gfx950"
.text
.globl sequential_preLN__memory_aug_recurrent_mem_tr__moe_arch_mod__prompt_kernel
.p2align 8
.type sequential_preLN__memory_aug_recurrent_mem_tr__moe_arch_mod__prompt_kernel,@function
sequential_preLN__memory_aug_recurrent_mem_tr__moe_arch_mod__prompt_kernel:
    s_cmp_ge_u32 s2, 256
    s_cbranch_scc1 L_exit
    s_load_dwordx2 s[8:9], s[0:1], 112
    s_load_dwordx2 s[92:93], s[0:1], 104
    s_load_dwordx8 s[60:67], s[0:1], 16
    s_load_dwordx2 s[12:13], s[0:1], 0
    v_lshrrev_b32 v1, 6, v0
    s_nop 0
    v_readfirstlane_b32 s100, v1
    s_getreg_b32 s84, hwreg(HW_REG_XCC_ID)
    s_and_b32 s84, s84, 7
    s_lshr_b32 s85, s2, 3
    s_mov_b32 s86, s100
    s_cmp_eq_u32 s2, 7
    s_cbranch_scc1 L_zero
L_noz:
    s_cmp_lg_u32 s84, 0
    s_cbranch_scc1 L_other
    s_xor_b32 s20, s85, 0
    v_lshrrev_b32 v4, 6, v0
    s_nop 0
    v_readfirstlane_b32 s21, v4
    v_and_b32 v1, 63, v0
    v_lshrrev_b32 v2, 4, v1
    v_and_b32 v3, 15, v1
    v_lshrrev_b32 v6, 2, v3
    v_lshlrev_b32 v117, 4, v1
    s_lshl_b32 s51, s21, 10
    s_lshl_b32 s52, s21, 11
    s_mov_b32 s14, 0x400000
    s_mov_b32 s15, 0x20000
    s_lshl_b32 s41, s20, 8
    s_lshl_b32 s42, s20, 17
    s_lshr_b32 s43, s21, 1
    s_lshl_b32 s43, s43, 2
    v_or_b32 v5, s43, v2
    v_lshlrev_b32 v5, 1, v5
    v_xor_b32 v5, v5, v3
    v_lshrrev_b32 v14, 2, v5
    v_and_b32 v14, 2, v14
    v_lshlrev_b32 v5, 4, v5
    s_lshl_b32 s43, s21, 4
    v_add_u32 v4, s43, v2
    v_lshl_add_u32 v8, v4, 13, v5
    s_cmp_lg_u32 s20, 27
    s_cbranch_scc1 L_nocc_1
    v_lshlrev_b32 v25, 3, v117
    s_lshl_b32 s43, s21, 13
    s_getpc_b64 s[4:5]
L_pc_2:
    s_add_u32 s4, s4, L_nocc_1-L_pc_2
    s_addc_u32 s5, s5, 0
    v_add_u32 v25, s43, v25
    v_min_u32 v25, L_code_end-L_nocc_1-4, v25
    global_load_dword v29, v25, s[4:5]
L_nocc_1:
    v_mul_u32_u24 v22, 57, v0
    v_lshrrev_b32 v22, 11, v22
    v_mul_u32_u24 v23, 36, v22
    v_sub_u32 v23, v0, v23
    v_and_b32 v25, 3, v23
    v_and_or_b32 v23, v23, 60, 1
    v_min_u32 v23, 31, v23
    v_lshl_add_u32 v23, v23, 2, v25
    v_lshlrev_b32 v31, 6, v23
    s_add_u32 s43, s20, 2
    s_lshr_b32 s43, s43, 2
    s_sub_u32 s43, s20, s43
    s_mul_i32 s43, s43, 7
    v_add_u32 v22, s43, v22
    s_waitcnt lgkmcnt(0)
    s_mov_b32 s4, s60
    s_and_b32 s5, s61, 0xffff
    s_lshr_b32 s6, 0x5ddddddd, s20
    s_and_b32 s6, s6, 1
    s_lshl_b32 s6, s6, 22
    s_mov_b32 s7, 0x20000
    v_add_u32 v23, 0, v22
    v_and_b32 v25, 448, v23
    v_add_u32 v23, v23, v25
    v_lshl_add_u32 v23, v23, 13, v31
    s_mov_b32 s43, 0x80000
    buffer_load_dword v30, v23, s[4:7], s43 offen
    s_mov_b32 s4, s60
    s_and_b32 s5, s61, 0xffff
    s_lshr_b32 s6, 0x5ddddddd, s20
    s_and_b32 s6, s6, 1
    s_lshl_b32 s6, s6, 22
    s_mov_b32 s7, 0x20000
    v_add_u32 v23, 161, v22
    v_and_b32 v25, 448, v23
    v_add_u32 v23, v23, v25
    v_lshl_add_u32 v23, v23, 13, v31
    s_mov_b32 s43, 0x80000
    buffer_load_dword v30, v23, s[4:7], s43 offen
    s_and_b32 s9, s9, 0xffff
    s_mov_b32 s10, 0x10000000
    s_mov_b32 s11, 0x20000
    s_and_b32 s93, s93, 0xffff
    s_mov_b32 s94, 0x100
    s_mov_b32 s95, 0x20000
    s_mov_b32 s87, 0
    s_cmp_lg_u32 s86, 0
    s_cbranch_scc1 L_reg_3
    s_lshl_b32 s97, s84, 4
    s_lshl_b32 s96, 1, s85
    v_mov_b32 v250, s96
    v_mov_b32 v251, 256
    s_mov_b64 exec, 1
    buffer_atomic_add_x2 v[250:251], off, s[92:95], s97 offset:64
    s_mov_b64 exec, -1
    s_mov_b32 s86, 1
L_reg_3:
    s_mov_b32 s16, s92
    s_mov_b32 s17, s93
    s_mov_b32 s18, s94
    s_mov_b32 s19, s95
    s_mov_b32 s88, s20
    s_mov_b32 s12, s60
    s_and_b32 s13, s61, 0xffff
    v_xor_b32 v15, 0, v14
    v_lshl_add_u32 v15, v15, 15, v8
    s_add_u32 s43, s41, 0x0
    s_add_u32 m0, s51, 0x8000
    s_nop 0
    buffer_load_dwordx4 v15, s[12:15], s43 offen lds
    s_add_u32 s43, s41, 0x8000
    s_add_u32 m0, s51, 0x9000
    s_nop 0
    buffer_load_dwordx4 v15, s[12:15], s43 offen lds
    s_add_u32 s43, s41, 0x100000
    s_add_u32 m0, s51, 0xa000
    s_nop 0
    buffer_load_dwordx4 v15, s[12:15], s43 offen lds
    s_add_u32 s43, s41, 0x108000
    s_add_u32 m0, s51, 0xb000
    s_nop 0
    buffer_load_dwordx4 v15, s[12:15], s43 offen lds
    s_add_u32 s43, s41, 0x200000
    s_add_u32 m0, s51, 0xc000
    s_nop 0
    buffer_load_dwordx4 v15, s[12:15], s43 offen lds
    s_add_u32 s43, s41, 0x208000
    s_add_u32 m0, s51, 0xd000
    s_nop 0
    buffer_load_dwordx4 v15, s[12:15], s43 offen lds
    s_add_u32 s43, s41, 0x300000
    s_add_u32 m0, s51, 0xe000
    s_nop 0
    buffer_load_dwordx4 v15, s[12:15], s43 offen lds
    s_add_u32 s43, s41, 0x308000
    s_add_u32 m0, s51, 0xf000
    s_nop 0
    buffer_load_dwordx4 v15, s[12:15], s43 offen lds
    v_xor_b32 v15, 2, v14
    v_lshl_add_u32 v15, v15, 15, v8
    s_add_u32 s43, s41, 0x0
    s_add_u32 m0, s51, 0x10000
    s_nop 0
    buffer_load_dwordx4 v15, s[12:15], s43 offen lds
    s_add_u32 s43, s41, 0x8000
    s_add_u32 m0, s51, 0x11000
    s_nop 0
    buffer_load_dwordx4 v15, s[12:15], s43 offen lds
    s_add_u32 s43, s41, 0x100000
    s_add_u32 m0, s51, 0x12000
    s_nop 0
    buffer_load_dwordx4 v15, s[12:15], s43 offen lds
    s_add_u32 s43, s41, 0x108000
    s_add_u32 m0, s51, 0x13000
    s_nop 0
    buffer_load_dwordx4 v15, s[12:15], s43 offen lds
    s_add_u32 s43, s41, 0x200000
    s_add_u32 m0, s51, 0x14000
    s_nop 0
    buffer_load_dwordx4 v15, s[12:15], s43 offen lds
    s_add_u32 s43, s41, 0x208000
    s_add_u32 m0, s51, 0x15000
    s_nop 0
    buffer_load_dwordx4 v15, s[12:15], s43 offen lds
    s_add_u32 s43, s41, 0x300000
    s_add_u32 m0, s51, 0x16000
    s_nop 0
    buffer_load_dwordx4 v15, s[12:15], s43 offen lds
    s_add_u32 s43, s41, 0x308000
    s_add_u32 m0, s51, 0x17000
    s_nop 0
    buffer_load_dwordx4 v15, s[12:15], s43 offen lds
    v_xor_b32 v15, 0, v14
    v_lshl_add_u32 v15, v15, 15, v8
    s_add_u32 s43, s41, 0x80000
    s_add_u32 m0, s51, 0x18000
    s_nop 0
    buffer_load_dwordx4 v15, s[12:15], s43 offen lds
    s_add_u32 s43, s41, 0x88000
    s_add_u32 m0, s51, 0x19000
    s_nop 0
    buffer_load_dwordx4 v15, s[12:15], s43 offen lds
    s_add_u32 s43, s41, 0x180000
    s_add_u32 m0, s51, 0x1a000
    s_nop 0
    buffer_load_dwordx4 v15, s[12:15], s43 offen lds
    s_add_u32 s43, s41, 0x188000
    s_add_u32 m0, s51, 0x1b000
    s_nop 0
    buffer_load_dwordx4 v15, s[12:15], s43 offen lds
    v_and_b32 v4, 2, v3
    v_cmp_ne_u32 vcc, 0, v4
    v_mov_b32 v4, 0x4444
    v_mov_b32 v5, 0xeeee
    v_cndmask_b32 v116, v4, v5, vcc
    v_lshrrev_b32 v5, 1, v2
    v_lshl_add_u32 v4, v6, 3, v5
    s_lshl_b32 s43, s21, 1
    v_add_u32 v4, s43, v4
    v_add_u32 v5, s20, v4
    v_and_b32 v5, 31, v5
    v_lshl_add_u32 v4, v4, 6, v5
    v_and_b32 v5, 1, v2
    v_lshl_add_u32 v4, v4, 1, v5
    v_and_b32 v5, 3, v3
    v_lshl_add_u32 v4, v4, 2, v5
    v_lshlrev_b32 v118, 4, v4
    v_and_b32 v4, 1, v2
    v_lshlrev_b32 v4, 2, v4
    v_and_b32 v7, 2, v2
    v_add_u32 v4, v4, v7
    v_and_b32 v7, 1, v6
    v_add_u32 v4, v4, v7
    v_lshl_add_u32 v4, v4, 2, v5
    v_lshlrev_b32 v4, 2, v4
    s_and_b32 s43, s21, 1
    s_lshl_b32 s43, s43, 12
    s_lshl_b32 s40, s20, 7
    s_add_u32 s43, s43, s40
    v_add_u32 v119, s43, v4
    v_sub_u32 v7, 0, v2
    v_and_b32 v7, 3, v7
    v_xor_b32 v7, v7, v6
    v_lshl_add_u32 v4, v2, 4, v7
    v_and_b32 v5, 3, v3
    v_lshl_add_u32 v4, v4, 2, v5
    s_add_u32 s43, s51, 16384
    v_lshl_add_u32 v120, v4, 2, s43
    v_sub_u32 v7, 0, v6
    v_and_b32 v7, 3, v7
    v_xor_b32 v7, v7, v2
    v_lshl_add_u32 v4, v3, 2, v7
    v_lshlrev_b32 v121, 4, v4
    v_and_b32 v5, 1, v3
    v_lshl_add_u32 v4, v6, 1, v5
    v_lshl_add_u32 v4, v2, 3, v4
    v_lshlrev_b32 v127, 4, v4
    v_and_or_b32 v122, v116, 8, v127
    s_lshl_b32 s43, s21, 13
    s_add_u32 s43, s43, 32768
    v_add_u32 v123, s43, v117
    v_add_u32 v124, 0x10000, v123
    s_mov_b32 s36, 0xcccccccc
    s_mov_b32 s37, 0xcccccccc
    s_mov_b32 s38, 0x00ff00ff
    s_mov_b32 s39, 0x00ff00ff
    s_mov_b32 s34, 0x3e0293ee
    s_mov_b32 s35, 0x49800000
    s_mov_b32 s50, 0x3f803f80
    v_and_b32 v5, 1, v2
    v_or_b32 v5, 0, v5
    v_xor_b32 v5, v5, v6
    v_and_b32 v7, 2, v5
    v_add_u32 v5, v5, v7
    v_lshlrev_b32 v5, 6, v5
    v_and_b32 v7, 3, v3
    v_lshl_add_u32 v7, v7, 4, v5
    s_lshl_b32 s43, s21, 2
    v_add_u32 v4, s43, v2
    v_lshl_add_u32 v10, v4, 10, v7
    v_and_b32 v5, 1, v2
    v_or_b32 v5, 2, v5
    v_xor_b32 v5, v5, v6
    v_and_b32 v7, 2, v5
    v_add_u32 v5, v5, v7
    v_lshlrev_b32 v5, 6, v5
    v_and_b32 v7, 3, v3
    v_lshl_add_u32 v7, v7, 4, v5
    s_lshl_b32 s43, s21, 2
    v_add_u32 v4, s43, v2
    v_lshl_add_u32 v9, v4, 10, v7
    v_and_b32 v5, 1, v2
    v_lshl_add_u32 v4, v5, 3, v6
    v_lshrrev_b32 v7, 1, v2
    v_lshl_add_u32 v4, v7, 5, v4
    v_lshlrev_b32 v4, 8, v4
    v_lshl_or_b32 v5, v5, 2, v6
    v_lshlrev_b32 v5, 5, v5
    s_lshl_b32 s43, s21, 6
    v_xor_b32 v5, s43, v5
    v_add_u32 v4, v4, v5
    v_and_b32 v5, 3, v3
    v_lshl_add_u32 v4, v5, 3, v4
    v_add_u32 v11, 32768, v4
    s_and_b32 s43, s21, 1
    s_lshl_b32 s43, s43, 12
    v_add_u32 v11, s43, v11
    v_and_b32 v5, 1, v2
    v_lshlrev_b32 v4, 4, v5
    v_lshl_add_u32 v4, v7, 2, v4
    v_and_b32 v7, 1, v6
    v_add_u32 v4, v4, v7
    s_lshl_b32 s43, s21, 5
    v_add_u32 v4, s43, v4
    v_lshlrev_b32 v4, 8, v4
    v_lshl_or_b32 v5, v5, 1, v7
    s_lshl_b32 s43, s21, 1
    s_and_b32 s43, s43, 3
    v_xor_b32 v5, s43, v5
    v_lshl_add_u32 v4, v5, 6, v4
    v_lshrrev_b32 v5, 1, v6
    v_lshl_add_u32 v4, v5, 5, v4
    v_and_b32 v5, 3, v3
    v_lshl_add_u32 v4, v5, 3, v4
    v_add_u32 v12, 32768, v4
    v_lshlrev_b32 v4, 18, v2
    v_lshl_add_u32 v4, v3, 7, v4
    s_lshl_b32 s43, s20, 13
    s_add_u32 s43, s43, s52
    s_add_u32 s43, s43, 0xf0000
    v_add_u32 v4, s43, v4
    v_and_b32 v5, 3, v3
    v_lshl_add_u32 v5, v5, 13, v119
    v_cmp_gt_u32 vcc, 2, v2
    s_nop 1
    v_cndmask_b32 v7, v5, v4, vcc
    v_mov_b32 v16, -1
    v_mov_b32 v17, -1
    v_mov_b32 v18, -1
    v_mov_b32 v19, -1
    s_lshl_b32 s43, s20, 13
    s_add_u32 s43, s43, 0x100000
    s_and_b32 s40, s21, 1
    s_lshl_b32 s40, s40, 12
    s_add_u32 s29, s43, s40
    s_add_u32 s43, s43, s52
    s_xor_b32 s40, s43, 0x40000
    buffer_store_dwordx4 v[16:19], v117, s[8:11], s43 offen
    buffer_store_dwordx4 v[16:19], v117, s[8:11], s43 offen offset:1024
    buffer_store_dwordx4 v[16:19], v117, s[8:11], s40 offen
    buffer_store_dwordx4 v[16:19], v117, s[8:11], s40 offen offset:1024
    s_mov_b32 s43, 0x12000
    buffer_store_dword v16, v119, s[8:11], s43 offen
    s_mov_b32 s43, 0x14000
    buffer_store_dword v16, v119, s[8:11], s43 offen
    s_mov_b32 s43, 0x16000
    buffer_store_dword v16, v119, s[8:11], s43 offen
    s_load_dwordx2 s[4:5], s[0:1], 8
    s_waitcnt lgkmcnt(0)
    s_and_b32 s5, s5, 0xffff
    s_mov_b32 s6, 8192
    s_mov_b32 s7, 0x20000
    v_and_b32 v20, 1, v2
    v_and_b32 v21, 1, v6
    v_lshl_add_u32 v20, v20, 1, v21
    v_lshlrev_b32 v20, 9, v20
    v_and_b32 v21, 3, v3
    v_lshl_add_u32 v20, v21, 4, v20
    v_and_b32 v21, 2, v2
    v_add_u32 v20, v20, v21
    s_and_b32 s43, s20, 1
    s_lshl_b32 s43, s43, 11
    s_bfe_u32 s40, s20, 0x20001
    s_lshl_b32 s40, s40, 7
    s_add_u32 s43, s43, s40
    s_and_b32 s40, s21, 1
    s_lshl_b32 s40, s40, 6
    s_add_u32 s43, s43, s40
    s_lshr_b32 s40, s20, 3
    s_lshl_b32 s40, s40, 2
    s_add_u32 s43, s43, s40
    v_add_u32 v20, s43, v20
    v_lshlrev_b32 v20, 1, v20
    buffer_load_dword v21, v20, s[4:7], 0 offen
    s_mov_b32 s57, 0
    s_lshl_b32 s43, s20, 13
    s_add_u32 s43, s43, s52
    s_add_u32 s30, s43, 0x1000000
    s_add_u32 s31, s43, 0x2000000
    s_lshr_b32 s43, s43, 1
    s_add_u32 s32, s43, 0x220000
    s_waitcnt vmcnt(20)
    s_barrier
    v_xor_b32 v13, 0x0, v11
    v_add_u32 v13, 0x0, v13
    ds_read_b64_tr_b16 v[80:81], v13
    ds_read_b64_tr_b16 v[82:83], v13 offset:1024
    ds_read_b64_tr_b16 v[84:85], v13 offset:16384
    ds_read_b64_tr_b16 v[86:87], v13 offset:17408
    v_xor_b32 v13, 0x20, v11
    v_add_u32 v13, 0x0, v13
    ds_read_b64_tr_b16 v[56:57], v13
    ds_read_b64_tr_b16 v[58:59], v13 offset:1024
    ds_read_b64_tr_b16 v[60:61], v13 offset:16384
    ds_read_b64_tr_b16 v[62:63], v13 offset:17408
    v_xor_b32 v13, 0x1000, v11
    v_add_u32 v13, 0x0, v13
    ds_read_b64_tr_b16 a[0:1], v13
    ds_read_b64_tr_b16 a[2:3], v13 offset:1024
    ds_read_b64_tr_b16 a[4:5], v13 offset:16384
    ds_read_b64_tr_b16 a[6:7], v13 offset:17408
    v_xor_b32 v13, 0x1020, v11
    v_add_u32 v13, 0x0, v13
    ds_read_b64_tr_b16 a[8:9], v13
    ds_read_b64_tr_b16 a[10:11], v13 offset:1024
    ds_read_b64_tr_b16 a[12:13], v13 offset:16384
    ds_read_b64_tr_b16 a[14:15], v13 offset:17408
    s_waitcnt lgkmcnt(0)
    s_barrier
    s_mov_b32 s4, s62
    s_and_b32 s5, s63, 0xffff
    s_lshr_b32 s6, 0x5ddddddd, s20
    s_and_b32 s6, s6, 1
    s_lshl_b32 s6, s6, 22
    s_mov_b32 s7, 0x20000
    v_add_u32 v23, 0, v22
    v_and_b32 v25, 448, v23
    v_add_u32 v23, v23, v25
    v_lshl_add_u32 v23, v23, 13, v31
    s_mov_b32 s43, 0x0
    buffer_load_dword v30, v23, s[4:7], s43 offen
    s_add_u32 s43, s41, 0x280000
    s_add_u32 m0, s51, 0x1c000
    s_nop 0
    buffer_load_dwordx4 v15, s[12:15], s43 offen lds
    s_add_u32 s43, s41, 0x288000
    s_add_u32 m0, s51, 0x1d000
    s_nop 0
    buffer_load_dwordx4 v15, s[12:15], s43 offen lds
    s_add_u32 s43, s41, 0x380000
    s_add_u32 m0, s51, 0x1e000
    s_nop 0
    buffer_load_dwordx4 v15, s[12:15], s43 offen lds
    s_add_u32 s43, s41, 0x388000
    s_add_u32 m0, s51, 0x1f000
    s_nop 0
    buffer_load_dwordx4 v15, s[12:15], s43 offen lds
    v_xor_b32 v15, 2, v14
    v_lshl_add_u32 v15, v15, 15, v8
    s_add_u32 s43, s41, 0x80000
    s_add_u32 m0, s51, 0x20000
    s_nop 0
    buffer_load_dwordx4 v15, s[12:15], s43 offen lds
    s_add_u32 s43, s41, 0x88000
    s_add_u32 m0, s51, 0x21000
    s_nop 0
    buffer_load_dwordx4 v15, s[12:15], s43 offen lds
    s_add_u32 s43, s41, 0x180000
    s_add_u32 m0, s51, 0x22000
    s_nop 0
    buffer_load_dwordx4 v15, s[12:15], s43 offen lds
    s_add_u32 s43, s41, 0x188000
    s_add_u32 m0, s51, 0x23000
    s_nop 0
    buffer_load_dwordx4 v15, s[12:15], s43 offen lds
    s_waitcnt vmcnt(21)
    s_barrier
    v_xor_b32 v13, 0x0, v11
    v_add_u32 v13, 0x8000, v13
    ds_read_b64_tr_b16 a[32:33], v13
    ds_read_b64_tr_b16 a[34:35], v13 offset:1024
    ds_read_b64_tr_b16 a[36:37], v13 offset:16384
    ds_read_b64_tr_b16 a[38:39], v13 offset:17408
    v_xor_b32 v13, 0x20, v11
    v_add_u32 v13, 0x8000, v13
    ds_read_b64_tr_b16 a[40:41], v13
    ds_read_b64_tr_b16 a[42:43], v13 offset:1024
    ds_read_b64_tr_b16 a[44:45], v13 offset:16384
    ds_read_b64_tr_b16 a[46:47], v13 offset:17408
    v_xor_b32 v13, 0x1000, v11
    v_add_u32 v13, 0x8000, v13
    ds_read_b64_tr_b16 a[64:65], v13
    ds_read_b64_tr_b16 a[66:67], v13 offset:1024
    ds_read_b64_tr_b16 a[68:69], v13 offset:16384
    ds_read_b64_tr_b16 a[70:71], v13 offset:17408
    v_xor_b32 v13, 0x1020, v11
    v_add_u32 v13, 0x8000, v13
    ds_read_b64_tr_b16 a[72:73], v13
    ds_read_b64_tr_b16 a[74:75], v13 offset:1024
    ds_read_b64_tr_b16 a[76:77], v13 offset:16384
    ds_read_b64_tr_b16 a[78:79], v13 offset:17408
    s_waitcnt lgkmcnt(0)
    s_barrier
    s_add_u32 s43, s41, 0x280000
    s_add_u32 m0, s51, 0x24000
    s_nop 0
    buffer_load_dwordx4 v15, s[12:15], s43 offen lds
    s_add_u32 s43, s41, 0x288000
    s_add_u32 m0, s51, 0x25000
    s_nop 0
    buffer_load_dwordx4 v15, s[12:15], s43 offen lds
    s_add_u32 s43, s41, 0x380000
    s_add_u32 m0, s51, 0x26000
    s_nop 0
    buffer_load_dwordx4 v15, s[12:15], s43 offen lds
    s_add_u32 s43, s41, 0x388000
    s_add_u32 m0, s51, 0x27000
    s_nop 0
    buffer_load_dwordx4 v15, s[12:15], s43 offen lds
    s_mov_b32 s12, s62
    s_and_b32 s13, s63, 0xffff
    v_xor_b32 v15, 0, v14
    v_lshl_add_u32 v15, v15, 15, v8
    s_add_u32 s43, s41, 0x0
    s_add_u32 m0, s51, 0x8000
    s_nop 0
    buffer_load_dwordx4 v15, s[12:15], s43 offen lds
    s_add_u32 s43, s41, 0x8000
    s_add_u32 m0, s51, 0x9000
    s_nop 0
    buffer_load_dwordx4 v15, s[12:15], s43 offen lds
    s_add_u32 s43, s41, 0x100000
    s_add_u32 m0, s51, 0xa000
    s_nop 0
    buffer_load_dwordx4 v15, s[12:15], s43 offen lds
    s_add_u32 s43, s41, 0x108000
    s_add_u32 m0, s51, 0xb000
    s_nop 0
    buffer_load_dwordx4 v15, s[12:15], s43 offen lds
    s_waitcnt vmcnt(12)
    s_barrier
    v_xor_b32 v13, 0x0, v11
    v_add_u32 v13, 0x10000, v13
    ds_read_b64_tr_b16 v[88:89], v13
    ds_read_b64_tr_b16 v[90:91], v13 offset:1024
    ds_read_b64_tr_b16 v[92:93], v13 offset:16384
    ds_read_b64_tr_b16 v[94:95], v13 offset:17408
    v_xor_b32 v13, 0x20, v11
    v_add_u32 v13, 0x10000, v13
    ds_read_b64_tr_b16 v[96:97], v13
    ds_read_b64_tr_b16 v[98:99], v13 offset:1024
    ds_read_b64_tr_b16 v[100:101], v13 offset:16384
    ds_read_b64_tr_b16 v[102:103], v13 offset:17408
    v_xor_b32 v13, 0x1000, v11
    v_add_u32 v13, 0x10000, v13
    ds_read_b64_tr_b16 a[16:17], v13
    ds_read_b64_tr_b16 a[18:19], v13 offset:1024
    ds_read_b64_tr_b16 a[20:21], v13 offset:16384
    ds_read_b64_tr_b16 a[22:23], v13 offset:17408
    v_xor_b32 v13, 0x1020, v11
    v_add_u32 v13, 0x10000, v13
    ds_read_b64_tr_b16 a[24:25], v13
    ds_read_b64_tr_b16 a[26:27], v13 offset:1024
    ds_read_b64_tr_b16 a[28:29], v13 offset:16384
    ds_read_b64_tr_b16 a[30:31], v13 offset:17408
    s_waitcnt lgkmcnt(0)
    s_barrier
    s_add_u32 s43, s41, 0x200000
    s_add_u32 m0, s51, 0xc000
    s_nop 0
    buffer_load_dwordx4 v15, s[12:15], s43 offen lds
    s_add_u32 s43, s41, 0x208000
    s_add_u32 m0, s51, 0xd000
    s_nop 0
    buffer_load_dwordx4 v15, s[12:15], s43 offen lds
    s_add_u32 s43, s41, 0x300000
    s_add_u32 m0, s51, 0xe000
    s_nop 0
    buffer_load_dwordx4 v15, s[12:15], s43 offen lds
    s_add_u32 s43, s41, 0x308000
    s_add_u32 m0, s51, 0xf000
    s_nop 0
    buffer_load_dwordx4 v15, s[12:15], s43 offen lds
    v_xor_b32 v15, 2, v14
    v_lshl_add_u32 v15, v15, 15, v8
    s_add_u32 s43, s41, 0x0
    s_add_u32 m0, s51, 0x10000
    s_nop 0
    buffer_load_dwordx4 v15, s[12:15], s43 offen lds
    s_add_u32 s43, s41, 0x8000
    s_add_u32 m0, s51, 0x11000
    s_nop 0
    buffer_load_dwordx4 v15, s[12:15], s43 offen lds
    s_add_u32 s43, s41, 0x100000
    s_add_u32 m0, s51, 0x12000
    s_nop 0
    buffer_load_dwordx4 v15, s[12:15], s43 offen lds
    s_add_u32 s43, s41, 0x108000
    s_add_u32 m0, s51, 0x13000
    s_nop 0
    buffer_load_dwordx4 v15, s[12:15], s43 offen lds
    s_waitcnt vmcnt(12)
    s_barrier
    v_xor_b32 v13, 0x0, v11
    v_add_u32 v13, 0x18000, v13
    ds_read_b64_tr_b16 a[48:49], v13
    ds_read_b64_tr_b16 a[50:51], v13 offset:1024
    ds_read_b64_tr_b16 a[52:53], v13 offset:16384
    ds_read_b64_tr_b16 a[54:55], v13 offset:17408
    v_xor_b32 v13, 0x20, v11
    v_add_u32 v13, 0x18000, v13
    ds_read_b64_tr_b16 a[56:57], v13
    ds_read_b64_tr_b16 a[58:59], v13 offset:1024
    ds_read_b64_tr_b16 a[60:61], v13 offset:16384
    ds_read_b64_tr_b16 a[62:63], v13 offset:17408
    v_xor_b32 v13, 0x1000, v11
    v_add_u32 v13, 0x18000, v13
    ds_read_b64_tr_b16 a[80:81], v13
    ds_read_b64_tr_b16 a[82:83], v13 offset:1024
    ds_read_b64_tr_b16 a[84:85], v13 offset:16384
    ds_read_b64_tr_b16 a[86:87], v13 offset:17408
    v_xor_b32 v13, 0x1020, v11
    v_add_u32 v13, 0x18000, v13
    ds_read_b64_tr_b16 a[88:89], v13
    ds_read_b64_tr_b16 a[90:91], v13 offset:1024
    ds_read_b64_tr_b16 a[92:93], v13 offset:16384
    ds_read_b64_tr_b16 a[94:95], v13 offset:17408
    s_waitcnt lgkmcnt(0)
    s_barrier
    s_add_u32 s43, s41, 0x200000
    s_add_u32 m0, s51, 0x14000
    s_nop 0
    buffer_load_dwordx4 v15, s[12:15], s43 offen lds
    s_add_u32 s43, s41, 0x208000
    s_add_u32 m0, s51, 0x15000
    s_nop 0
    buffer_load_dwordx4 v15, s[12:15], s43 offen lds
    s_add_u32 s43, s41, 0x300000
    s_add_u32 m0, s51, 0x16000
    s_nop 0
    buffer_load_dwordx4 v15, s[12:15], s43 offen lds
    s_add_u32 s43, s41, 0x308000
    s_add_u32 m0, s51, 0x17000
    s_nop 0
    buffer_load_dwordx4 v15, s[12:15], s43 offen lds
    v_xor_b32 v15, 0, v14
    v_lshl_add_u32 v15, v15, 15, v8
    s_add_u32 s43, s41, 0x80000
    s_add_u32 m0, s51, 0x18000
    s_nop 0
    buffer_load_dwordx4 v15, s[12:15], s43 offen lds
    s_add_u32 s43, s41, 0x88000
    s_add_u32 m0, s51, 0x19000
    s_nop 0
    buffer_load_dwordx4 v15, s[12:15], s43 offen lds
    s_add_u32 s43, s41, 0x180000
    s_add_u32 m0, s51, 0x1a000
    s_nop 0
    buffer_load_dwordx4 v15, s[12:15], s43 offen lds
    s_add_u32 s43, s41, 0x188000
    s_add_u32 m0, s51, 0x1b000
    s_nop 0
    buffer_load_dwordx4 v15, s[12:15], s43 offen lds
    s_waitcnt vmcnt(12)
    v_min_u32 v21, 0xfffffffe, v21
    s_mov_b32 s43, 0x10000
    s_mov_b64 exec, s[38:39]
    buffer_store_dword v21, v119, s[8:11], s43 offen
    s_mov_b64 exec, -1
    s_barrier
    v_xor_b32 v13, 0x0, v11
    v_add_u32 v13, 0x0, v13
    ds_read_b64_tr_b16 v[64:65], v13
    ds_read_b64_tr_b16 v[66:67], v13 offset:1024
    ds_read_b64_tr_b16 v[68:69], v13 offset:16384
    ds_read_b64_tr_b16 v[70:71], v13 offset:17408
    v_xor_b32 v13, 0x20, v11
    v_add_u32 v13, 0x0, v13
    ds_read_b64_tr_b16 v[72:73], v13
    ds_read_b64_tr_b16 v[74:75], v13 offset:1024
    ds_read_b64_tr_b16 v[76:77], v13 offset:16384
    ds_read_b64_tr_b16 v[78:79], v13 offset:17408
    v_xor_b32 v13, 0x1000, v11
    v_add_u32 v13, 0x0, v13
    ds_read_b64_tr_b16 a[96:97], v13
    ds_read_b64_tr_b16 a[98:99], v13 offset:1024
    ds_read_b64_tr_b16 a[100:101], v13 offset:16384
    ds_read_b64_tr_b16 a[102:103], v13 offset:17408
    v_xor_b32 v13, 0x1020, v11
    v_add_u32 v13, 0x0, v13
    ds_read_b64_tr_b16 a[104:105], v13
    ds_read_b64_tr_b16 a[106:107], v13 offset:1024
    ds_read_b64_tr_b16 a[108:109], v13 offset:16384
    ds_read_b64_tr_b16 a[110:111], v13 offset:17408
    s_waitcnt lgkmcnt(0)
    s_barrier
    s_add_u32 s43, s41, 0x280000
    s_add_u32 m0, s51, 0x1c000
    s_nop 0
    buffer_load_dwordx4 v15, s[12:15], s43 offen lds
    s_add_u32 s43, s41, 0x288000
    s_add_u32 m0, s51, 0x1d000
    s_nop 0
    buffer_load_dwordx4 v15, s[12:15], s43 offen lds
    s_add_u32 s43, s41, 0x380000
    s_add_u32 m0, s51, 0x1e000
    s_nop 0
    buffer_load_dwordx4 v15, s[12:15], s43 offen lds
    s_add_u32 s43, s41, 0x388000
    s_add_u32 m0, s51, 0x1f000
    s_nop 0
    buffer_load_dwordx4 v15, s[12:15], s43 offen lds
    v_xor_b32 v15, 2, v14
    v_lshl_add_u32 v15, v15, 15, v8
    s_add_u32 s43, s41, 0x80000
    s_add_u32 m0, s51, 0x20000
    s_nop 0
    buffer_load_dwordx4 v15, s[12:15], s43 offen lds
    s_add_u32 s43, s41, 0x88000
    s_add_u32 m0, s51, 0x21000
    s_nop 0
    buffer_load_dwordx4 v15, s[12:15], s43 offen lds
    s_add_u32 s43, s41, 0x180000
    s_add_u32 m0, s51, 0x22000
    s_nop 0
    buffer_load_dwordx4 v15, s[12:15], s43 offen lds
    s_add_u32 s43, s41, 0x188000
    s_add_u32 m0, s51, 0x23000
    s_nop 0
    buffer_load_dwordx4 v15, s[12:15], s43 offen lds
    s_waitcnt vmcnt(12)
    s_barrier
    v_xor_b32 v13, 0x0, v11
    v_add_u32 v13, 0x8000, v13
    ds_read_b64_tr_b16 a[128:129], v13
    ds_read_b64_tr_b16 a[130:131], v13 offset:1024
    ds_read_b64_tr_b16 a[132:133], v13 offset:16384
    ds_read_b64_tr_b16 a[134:135], v13 offset:17408
    v_xor_b32 v13, 0x20, v11
    v_add_u32 v13, 0x8000, v13
    ds_read_b64_tr_b16 a[136:137], v13
    ds_read_b64_tr_b16 a[138:139], v13 offset:1024
    ds_read_b64_tr_b16 a[140:141], v13 offset:16384
    ds_read_b64_tr_b16 a[142:143], v13 offset:17408
    v_xor_b32 v13, 0x1000, v11
    v_add_u32 v13, 0x8000, v13
    ds_read_b64_tr_b16 a[160:161], v13
    ds_read_b64_tr_b16 a[162:163], v13 offset:1024
    ds_read_b64_tr_b16 a[164:165], v13 offset:16384
    ds_read_b64_tr_b16 a[166:167], v13 offset:17408
    v_xor_b32 v13, 0x1020, v11
    v_add_u32 v13, 0x8000, v13
    ds_read_b64_tr_b16 a[168:169], v13
    ds_read_b64_tr_b16 a[170:171], v13 offset:1024
    ds_read_b64_tr_b16 a[172:173], v13 offset:16384
    ds_read_b64_tr_b16 a[174:175], v13 offset:17408
    s_waitcnt lgkmcnt(0)
    s_barrier
    buffer_load_dwordx2 v[26:27], off, s[16:19], 0 offset:36 sc1
    s_add_u32 s43, s41, 0x280000
    s_add_u32 m0, s51, 0x24000
    s_nop 0
    buffer_load_dwordx4 v15, s[12:15], s43 offen lds
    s_add_u32 s43, s41, 0x288000
    s_add_u32 m0, s51, 0x25000
    s_nop 0
    buffer_load_dwordx4 v15, s[12:15], s43 offen lds
    s_add_u32 s43, s41, 0x380000
    s_add_u32 m0, s51, 0x26000
    s_nop 0
    buffer_load_dwordx4 v15, s[12:15], s43 offen lds
    s_add_u32 s43, s41, 0x388000
    s_add_u32 m0, s51, 0x27000
    s_nop 0
    buffer_load_dwordx4 v15, s[12:15], s43 offen lds
    s_mov_b32 s12, s64
    s_and_b32 s13, s65, 0xffff
    v_xor_b32 v15, 0, v14
    v_lshl_add_u32 v15, v15, 15, v8
    s_add_u32 s43, s41, 0x0
    s_add_u32 m0, s51, 0x8000
    s_nop 0
    buffer_load_dwordx4 v15, s[12:15], s43 offen lds
    s_add_u32 s43, s41, 0x8000
    s_add_u32 m0, s51, 0x9000
    s_nop 0
    buffer_load_dwordx4 v15, s[12:15], s43 offen lds
    s_add_u32 s43, s41, 0x100000
    s_add_u32 m0, s51, 0xa000
    s_nop 0
    buffer_load_dwordx4 v15, s[12:15], s43 offen lds
    s_add_u32 s43, s41, 0x108000
    s_add_u32 m0, s51, 0xb000
    s_nop 0
    buffer_load_dwordx4 v15, s[12:15], s43 offen lds
    s_waitcnt vmcnt(13)
    s_barrier
    v_xor_b32 v13, 0x0, v11
    v_add_u32 v13, 0x10000, v13
    ds_read_b64_tr_b16 v[104:105], v13
    ds_read_b64_tr_b16 v[106:107], v13 offset:1024
    ds_read_b64_tr_b16 v[108:109], v13 offset:16384
    ds_read_b64_tr_b16 v[110:111], v13 offset:17408
    v_xor_b32 v13, 0x20, v11
    v_add_u32 v13, 0x10000, v13
    ds_read_b64_tr_b16 v[32:33], v13
    ds_read_b64_tr_b16 v[34:35], v13 offset:1024
    ds_read_b64_tr_b16 v[36:37], v13 offset:16384
    ds_read_b64_tr_b16 v[38:39], v13 offset:17408
    v_xor_b32 v13, 0x1000, v11
    v_add_u32 v13, 0x10000, v13
    ds_read_b64_tr_b16 a[112:113], v13
    ds_read_b64_tr_b16 a[114:115], v13 offset:1024
    ds_read_b64_tr_b16 a[116:117], v13 offset:16384
    ds_read_b64_tr_b16 a[118:119], v13 offset:17408
    v_xor_b32 v13, 0x1020, v11
    v_add_u32 v13, 0x10000, v13
    ds_read_b64_tr_b16 a[120:121], v13
    ds_read_b64_tr_b16 a[122:123], v13 offset:1024
    ds_read_b64_tr_b16 a[124:125], v13 offset:16384
    ds_read_b64_tr_b16 a[126:127], v13 offset:17408
    s_waitcnt lgkmcnt(0)
    s_barrier
    s_add_u32 s43, s41, 0x200000
    s_add_u32 m0, s51, 0xc000
    s_nop 0
    buffer_load_dwordx4 v15, s[12:15], s43 offen lds
    s_add_u32 s43, s41, 0x208000
    s_add_u32 m0, s51, 0xd000
    s_nop 0
    buffer_load_dwordx4 v15, s[12:15], s43 offen lds
    s_add_u32 s43, s41, 0x300000
    s_add_u32 m0, s51, 0xe000
    s_nop 0
    buffer_load_dwordx4 v15, s[12:15], s43 offen lds
    s_add_u32 s43, s41, 0x308000
    s_add_u32 m0, s51, 0xf000
    s_nop 0
    buffer_load_dwordx4 v15, s[12:15], s43 offen lds
    v_xor_b32 v15, 2, v14
    v_lshl_add_u32 v15, v15, 15, v8
    s_add_u32 s43, s41, 0x0
    s_add_u32 m0, s51, 0x10000
    s_nop 0
    buffer_load_dwordx4 v15, s[12:15], s43 offen lds
    s_add_u32 s43, s41, 0x8000
    s_add_u32 m0, s51, 0x11000
    s_nop 0
    buffer_load_dwordx4 v15, s[12:15], s43 offen lds
    s_add_u32 s43, s41, 0x100000
    s_add_u32 m0, s51, 0x12000
    s_nop 0
    buffer_load_dwordx4 v15, s[12:15], s43 offen lds
    s_add_u32 s43, s41, 0x108000
    s_add_u32 m0, s51, 0x13000
    s_nop 0
    buffer_load_dwordx4 v15, s[12:15], s43 offen lds
    s_waitcnt vmcnt(12)
    s_barrier
    v_xor_b32 v13, 0x0, v11
    v_add_u32 v13, 0x18000, v13
    ds_read_b64_tr_b16 a[144:145], v13
    ds_read_b64_tr_b16 a[146:147], v13 offset:1024
    ds_read_b64_tr_b16 a[148:149], v13 offset:16384
    ds_read_b64_tr_b16 a[150:151], v13 offset:17408
    v_xor_b32 v13, 0x20, v11
    v_add_u32 v13, 0x18000, v13
    ds_read_b64_tr_b16 a[152:153], v13
    ds_read_b64_tr_b16 a[154:155], v13 offset:1024
    ds_read_b64_tr_b16 a[156:157], v13 offset:16384
    ds_read_b64_tr_b16 a[158:159], v13 offset:17408
    v_xor_b32 v13, 0x1000, v11
    v_add_u32 v13, 0x18000, v13
    ds_read_b64_tr_b16 a[176:177], v13
    ds_read_b64_tr_b16 a[178:179], v13 offset:1024
    ds_read_b64_tr_b16 a[180:181], v13 offset:16384
    ds_read_b64_tr_b16 a[182:183], v13 offset:17408
    v_xor_b32 v13, 0x1020, v11
    v_add_u32 v13, 0x18000, v13
    ds_read_b64_tr_b16 a[184:185], v13
    ds_read_b64_tr_b16 a[186:187], v13 offset:1024
    ds_read_b64_tr_b16 a[188:189], v13 offset:16384
    ds_read_b64_tr_b16 a[190:191], v13 offset:17408
    s_waitcnt lgkmcnt(0)
    s_barrier
    s_add_u32 s43, s41, 0x200000
    s_add_u32 m0, s51, 0x14000
    s_nop 0
    buffer_load_dwordx4 v15, s[12:15], s43 offen lds
    s_add_u32 s43, s41, 0x208000
    s_add_u32 m0, s51, 0x15000
    s_nop 0
    buffer_load_dwordx4 v15, s[12:15], s43 offen lds
    s_add_u32 s43, s41, 0x300000
    s_add_u32 m0, s51, 0x16000
    s_nop 0
    buffer_load_dwordx4 v15, s[12:15], s43 offen lds
    s_add_u32 s43, s41, 0x308000
    s_add_u32 m0, s51, 0x17000
    s_nop 0
    buffer_load_dwordx4 v15, s[12:15], s43 offen lds
    s_mov_b32 s12, s66
    s_and_b32 s13, s67, 0xffff
    s_add_u32 s43, s42, 0x80
    s_add_u32 m0, s51, 0x18000
    s_nop 0
    buffer_load_dwordx4 v10, s[12:15], s43 offen lds
    s_add_u32 s43, s42, 0x4080
    s_add_u32 m0, s51, 0x19000
    s_nop 0
    buffer_load_dwordx4 v9, s[12:15], s43 offen lds
    s_add_u32 s43, s42, 0x8080
    s_add_u32 m0, s51, 0x1a000
    s_nop 0
    buffer_load_dwordx4 v10, s[12:15], s43 offen lds
    s_add_u32 s43, s42, 0xc080
    s_add_u32 m0, s51, 0x1b000
    s_nop 0
    buffer_load_dwordx4 v9, s[12:15], s43 offen lds
    s_waitcnt vmcnt(12)
    s_barrier
    v_xor_b32 v13, 0x0, v11
    v_add_u32 v13, 0x0, v13
    ds_read_b64_tr_b16 a[192:193], v13
    ds_read_b64_tr_b16 a[194:195], v13 offset:1024
    ds_read_b64_tr_b16 a[196:197], v13 offset:16384
    ds_read_b64_tr_b16 a[198:199], v13 offset:17408
    v_xor_b32 v13, 0x20, v11
    v_add_u32 v13, 0x0, v13
    ds_read_b64_tr_b16 a[200:201], v13
    ds_read_b64_tr_b16 a[202:203], v13 offset:1024
    ds_read_b64_tr_b16 a[204:205], v13 offset:16384
    ds_read_b64_tr_b16 a[206:207], v13 offset:17408
    v_xor_b32 v13, 0x1000, v11
    v_add_u32 v13, 0x0, v13
    ds_read_b64_tr_b16 a[224:225], v13
    ds_read_b64_tr_b16 a[226:227], v13 offset:1024
    ds_read_b64_tr_b16 a[228:229], v13 offset:16384
    ds_read_b64_tr_b16 a[230:231], v13 offset:17408
    v_xor_b32 v13, 0x1020, v11
    v_add_u32 v13, 0x0, v13
    ds_read_b64_tr_b16 a[232:233], v13
    ds_read_b64_tr_b16 a[234:235], v13 offset:1024
    ds_read_b64_tr_b16 a[236:237], v13 offset:16384
    ds_read_b64_tr_b16 a[238:239], v13 offset:17408
    s_waitcnt lgkmcnt(0)
    s_barrier
    s_add_u32 s43, s42, 0x10280
    s_add_u32 m0, s51, 0x1c000
    s_nop 0
    buffer_load_dwordx4 v10, s[12:15], s43 offen lds
    s_add_u32 s43, s42, 0x14280
    s_add_u32 m0, s51, 0x1d000
    s_nop 0
    buffer_load_dwordx4 v9, s[12:15], s43 offen lds
    s_add_u32 s43, s42, 0x18280
    s_add_u32 m0, s51, 0x1e000
    s_nop 0
    buffer_load_dwordx4 v10, s[12:15], s43 offen lds
    s_add_u32 s43, s42, 0x1c280
    s_add_u32 m0, s51, 0x1f000
    s_nop 0
    buffer_load_dwordx4 v9, s[12:15], s43 offen lds
    s_add_u32 s43, s42, 0x10080
    s_add_u32 m0, s51, 0x20000
    s_nop 0
    buffer_load_dwordx4 v10, s[12:15], s43 offen lds
    s_add_u32 s43, s42, 0x14080
    s_add_u32 m0, s51, 0x21000
    s_nop 0
    buffer_load_dwordx4 v9, s[12:15], s43 offen lds
    s_add_u32 s43, s42, 0x18080
    s_add_u32 m0, s51, 0x22000
    s_nop 0
    buffer_load_dwordx4 v10, s[12:15], s43 offen lds
    s_add_u32 s43, s42, 0x1c080
    s_add_u32 m0, s51, 0x23000
    s_nop 0
    buffer_load_dwordx4 v9, s[12:15], s43 offen lds
    s_waitcnt vmcnt(12)
    v_readfirstlane_b32 s57, v26
    v_readfirstlane_b32 s43, v27
    s_nop 0
    s_cmp_lg_u32 s43, 0
    s_cselect_b32 s57, s57, 0
    s_barrier
    s_cmp_lg_u32 s21, 0
    s_cbranch_scc1 L_arr_4
    v_mov_b32 v23, 1
    s_mov_b64 exec, 1
    buffer_atomic_add v23, off, s[16:19], 0 offset:4
    s_mov_b64 exec, -1
L_arr_4:
    v_xor_b32 v13, 0x0, v11
    v_add_u32 v13, 0x8000, v13
    ds_read_b64_tr_b16 v[128:129], v13
    ds_read_b64_tr_b16 v[130:131], v13 offset:1024
    ds_read_b64_tr_b16 v[132:133], v13 offset:16384
    ds_read_b64_tr_b16 v[134:135], v13 offset:17408
    v_xor_b32 v13, 0x20, v11
    v_add_u32 v13, 0x8000, v13
    ds_read_b64_tr_b16 v[136:137], v13
    ds_read_b64_tr_b16 v[138:139], v13 offset:1024
    ds_read_b64_tr_b16 v[140:141], v13 offset:16384
    ds_read_b64_tr_b16 v[142:143], v13 offset:17408
    v_xor_b32 v13, 0x1000, v11
    v_add_u32 v13, 0x8000, v13
    ds_read_b64_tr_b16 v[160:161], v13
    ds_read_b64_tr_b16 v[162:163], v13 offset:1024
    ds_read_b64_tr_b16 v[164:165], v13 offset:16384
    ds_read_b64_tr_b16 v[166:167], v13 offset:17408
    v_xor_b32 v13, 0x1020, v11
    v_add_u32 v13, 0x8000, v13
    ds_read_b64_tr_b16 v[168:169], v13
    ds_read_b64_tr_b16 v[170:171], v13 offset:1024
    ds_read_b64_tr_b16 v[172:173], v13 offset:16384
    ds_read_b64_tr_b16 v[174:175], v13 offset:17408
    s_waitcnt lgkmcnt(0)
    s_barrier
    s_add_u32 s43, s42, 0x280
    s_add_u32 m0, s51, 0x24000
    s_nop 0
    buffer_load_dwordx4 v10, s[12:15], s43 offen lds
    s_add_u32 s43, s42, 0x4280
    s_add_u32 m0, s51, 0x25000
    s_nop 0
    buffer_load_dwordx4 v9, s[12:15], s43 offen lds
    s_add_u32 s43, s42, 0x8280
    s_add_u32 m0, s51, 0x26000
    s_nop 0
    buffer_load_dwordx4 v10, s[12:15], s43 offen lds
    s_add_u32 s43, s42, 0xc280
    s_add_u32 m0, s51, 0x27000
    s_nop 0
    buffer_load_dwordx4 v9, s[12:15], s43 offen lds
    s_mov_b32 s12, s64
    s_and_b32 s13, s65, 0xffff
    v_xor_b32 v15, 0, v14
    v_lshl_add_u32 v15, v15, 15, v8
    s_add_u32 s43, s41, 0x80000
    s_add_u32 m0, s51, 0x8000
    s_nop 0
    buffer_load_dwordx4 v15, s[12:15], s43 offen lds
    s_add_u32 s43, s41, 0x88000
    s_add_u32 m0, s51, 0x9000
    s_nop 0
    buffer_load_dwordx4 v15, s[12:15], s43 offen lds
    s_add_u32 s43, s41, 0x180000
    s_add_u32 m0, s51, 0xa000
    s_nop 0
    buffer_load_dwordx4 v15, s[12:15], s43 offen lds
    s_add_u32 s43, s41, 0x188000
    s_add_u32 m0, s51, 0xb000
    s_nop 0
    buffer_load_dwordx4 v15, s[12:15], s43 offen lds
    s_waitcnt vmcnt(12)
    s_barrier
    v_xor_b32 v13, 0x0, v12
    v_add_u32 v13, 0x10000, v13
    ds_read_b64_tr_b16 v[192:193], v13
    ds_read_b64_tr_b16 v[194:195], v13 offset:512
    ds_read_b64_tr_b16 v[196:197], v13 offset:2048
    ds_read_b64_tr_b16 v[198:199], v13 offset:2560
    v_xor_b32 v13, 0x2000, v12
    v_add_u32 v13, 0x10000, v13
    ds_read_b64_tr_b16 v[200:201], v13
    ds_read_b64_tr_b16 v[202:203], v13 offset:512
    ds_read_b64_tr_b16 v[204:205], v13 offset:2048
    ds_read_b64_tr_b16 v[206:207], v13 offset:2560
    v_xor_b32 v13, 0x40, v12
    v_add_u32 v13, 0x10000, v13
    ds_read_b64_tr_b16 v[224:225], v13
    ds_read_b64_tr_b16 v[226:227], v13 offset:512
    ds_read_b64_tr_b16 v[228:229], v13 offset:2048
    ds_read_b64_tr_b16 v[230:231], v13 offset:2560
    v_xor_b32 v13, 0x2040, v12
    v_add_u32 v13, 0x10000, v13
    ds_read_b64_tr_b16 v[232:233], v13
    ds_read_b64_tr_b16 v[234:235], v13 offset:512
    ds_read_b64_tr_b16 v[236:237], v13 offset:2048
    ds_read_b64_tr_b16 v[238:239], v13 offset:2560
    s_waitcnt lgkmcnt(0)
    s_barrier
    s_add_u32 s43, s41, 0x280000
    s_add_u32 m0, s51, 0xc000
    s_nop 0
    buffer_load_dwordx4 v15, s[12:15], s43 offen lds
    s_add_u32 s43, s41, 0x288000
    s_add_u32 m0, s51, 0xd000
    s_nop 0
    buffer_load_dwordx4 v15, s[12:15], s43 offen lds
    s_add_u32 s43, s41, 0x380000
    s_add_u32 m0, s51, 0xe000
    s_nop 0
    buffer_load_dwordx4 v15, s[12:15], s43 offen lds
    s_add_u32 s43, s41, 0x388000
    s_add_u32 m0, s51, 0xf000
    s_nop 0
    buffer_load_dwordx4 v15, s[12:15], s43 offen lds
    v_xor_b32 v15, 2, v14
    v_lshl_add_u32 v15, v15, 15, v8
    s_add_u32 s43, s41, 0x80000
    s_add_u32 m0, s51, 0x10000
    s_nop 0
    buffer_load_dwordx4 v15, s[12:15], s43 offen lds
    s_add_u32 s43, s41, 0x88000
    s_add_u32 m0, s51, 0x11000
    s_nop 0
    buffer_load_dwordx4 v15, s[12:15], s43 offen lds
    s_add_u32 s43, s41, 0x180000
    s_add_u32 m0, s51, 0x12000
    s_nop 0
    buffer_load_dwordx4 v15, s[12:15], s43 offen lds
    s_add_u32 s43, s41, 0x188000
    s_add_u32 m0, s51, 0x13000
    s_nop 0
    buffer_load_dwordx4 v15, s[12:15], s43 offen lds
    s_waitcnt vmcnt(12)
    s_barrier
    v_xor_b32 v13, 0x0, v12
    v_add_u32 v13, 0x18000, v13
    ds_read_b64_tr_b16 v[208:209], v13
    ds_read_b64_tr_b16 v[210:211], v13 offset:512
    ds_read_b64_tr_b16 v[212:213], v13 offset:2048
    ds_read_b64_tr_b16 v[214:215], v13 offset:2560
    v_xor_b32 v13, 0x2000, v12
    v_add_u32 v13, 0x18000, v13
    ds_read_b64_tr_b16 v[216:217], v13
    ds_read_b64_tr_b16 v[218:219], v13 offset:512
    ds_read_b64_tr_b16 v[220:221], v13 offset:2048
    ds_read_b64_tr_b16 v[222:223], v13 offset:2560
    v_xor_b32 v13, 0x40, v12
    v_add_u32 v13, 0x18000, v13
    ds_read_b64_tr_b16 v[240:241], v13
    ds_read_b64_tr_b16 v[242:243], v13 offset:512
    ds_read_b64_tr_b16 v[244:245], v13 offset:2048
    ds_read_b64_tr_b16 v[246:247], v13 offset:2560
    v_xor_b32 v13, 0x2040, v12
    v_add_u32 v13, 0x18000, v13
    ds_read_b64_tr_b16 v[248:249], v13
    ds_read_b64_tr_b16 v[250:251], v13 offset:512
    ds_read_b64_tr_b16 v[252:253], v13 offset:2048
    ds_read_b64_tr_b16 v[254:255], v13 offset:2560
    s_waitcnt lgkmcnt(0)
    s_barrier
    s_add_u32 s43, s41, 0x280000
    s_add_u32 m0, s51, 0x14000
    s_nop 0
    buffer_load_dwordx4 v15, s[12:15], s43 offen lds
    s_add_u32 s43, s41, 0x288000
    s_add_u32 m0, s51, 0x15000
    s_nop 0
    buffer_load_dwordx4 v15, s[12:15], s43 offen lds
    s_add_u32 s43, s41, 0x380000
    s_add_u32 m0, s51, 0x16000
    s_nop 0
    buffer_load_dwordx4 v15, s[12:15], s43 offen lds
    s_add_u32 s43, s41, 0x388000
    s_add_u32 m0, s51, 0x17000
    s_nop 0
    buffer_load_dwordx4 v15, s[12:15], s43 offen lds
    ds_write_b128 v124, v[192:195]
    ds_write_b128 v124, v[196:199] offset:1024
    ds_write_b128 v124, v[200:203] offset:2048
    ds_write_b128 v124, v[204:207] offset:3072
    ds_write_b128 v124, v[208:211] offset:4096
    ds_write_b128 v124, v[212:215] offset:5120
    ds_write_b128 v124, v[216:219] offset:6144
    ds_write_b128 v124, v[220:223] offset:7168
    ds_write_b128 v124, v[224:227] offset:32768
    ds_write_b128 v124, v[228:231] offset:33792
    ds_write_b128 v124, v[232:235] offset:34816
    ds_write_b128 v124, v[236:239] offset:35840
    ds_write_b128 v124, v[240:243] offset:36864
    ds_write_b128 v124, v[244:247] offset:37888
    ds_write_b128 v124, v[248:251] offset:38912
    ds_write_b128 v124, v[252:255] offset:39936
    s_waitcnt vmcnt(8)
    s_barrier
    v_xor_b32 v13, 0x0, v11
    v_add_u32 v13, 0x0, v13
    ds_read_b64_tr_b16 a[208:209], v13
    ds_read_b64_tr_b16 a[210:211], v13 offset:1024
    ds_read_b64_tr_b16 a[212:213], v13 offset:16384
    ds_read_b64_tr_b16 a[214:215], v13 offset:17408
    v_xor_b32 v13, 0x20, v11
    v_add_u32 v13, 0x0, v13
    ds_read_b64_tr_b16 a[216:217], v13
    ds_read_b64_tr_b16 a[218:219], v13 offset:1024
    ds_read_b64_tr_b16 a[220:221], v13 offset:16384
    ds_read_b64_tr_b16 a[222:223], v13 offset:17408
    v_xor_b32 v13, 0x1000, v11
    v_add_u32 v13, 0x0, v13
    ds_read_b64_tr_b16 a[240:241], v13
    ds_read_b64_tr_b16 a[242:243], v13 offset:1024
    ds_read_b64_tr_b16 a[244:245], v13 offset:16384
    ds_read_b64_tr_b16 a[246:247], v13 offset:17408
    v_xor_b32 v13, 0x1020, v11
    v_add_u32 v13, 0x0, v13
    ds_read_b64_tr_b16 a[248:249], v13
    ds_read_b64_tr_b16 a[250:251], v13 offset:1024
    ds_read_b64_tr_b16 a[252:253], v13 offset:16384
    ds_read_b64_tr_b16 a[254:255], v13 offset:17408
    s_waitcnt lgkmcnt(0)
    s_barrier
    s_mov_b32 s43, 0x10000
    buffer_load_dword v30, v7, s[8:11], s43 offen sc1
    s_cmp_lg_u32 s20, 28
    s_cbranch_scc1 L_nocc_5
    v_lshlrev_b32 v25, 2, v117
    s_lshl_b32 s43, s21, 12
    s_getpc_b64 s[4:5]
L_pc_6:
    s_add_u32 s4, s4, L_nocc_5-L_pc_6
    s_addc_u32 s5, s5, 0
    v_add_u32 v25, s43, v25
    v_min_u32 v25, L_code_end-L_nocc_5-4, v25
    global_load_dword v29, v25, s[4:5]
L_nocc_5:
L_chain_warm:
    s_mov_b32 s12, s66
    s_and_b32 s13, s67, 0xffff
    s_add_u32 s43, s42, 0x0
    s_add_u32 m0, s51, 0x8000
    s_nop 0
    buffer_load_dwordx4 v10, s[12:15], s43 offen lds
    s_add_u32 s43, s42, 0x4000
    s_add_u32 m0, s51, 0x9000
    s_nop 0
    buffer_load_dwordx4 v9, s[12:15], s43 offen lds
    s_add_u32 s43, s42, 0x8000
    s_add_u32 m0, s51, 0xa000
    s_nop 0
    buffer_load_dwordx4 v10, s[12:15], s43 offen lds
    s_add_u32 s43, s42, 0xc000
    s_add_u32 m0, s51, 0xb000
    s_nop 0
    buffer_load_dwordx4 v9, s[12:15], s43 offen lds
    s_add_u32 s43, s42, 0x10200
    s_add_u32 m0, s51, 0xc000
    s_nop 0
    buffer_load_dwordx4 v10, s[12:15], s43 offen lds
    s_add_u32 s43, s42, 0x14200
    s_add_u32 m0, s51, 0xd000
    s_nop 0
    buffer_load_dwordx4 v9, s[12:15], s43 offen lds
    s_add_u32 s43, s42, 0x18200
    s_add_u32 m0, s51, 0xe000
    s_nop 0
    buffer_load_dwordx4 v10, s[12:15], s43 offen lds
    s_add_u32 s43, s42, 0x1c200
    s_add_u32 m0, s51, 0xf000
    s_nop 0
    buffer_load_dwordx4 v9, s[12:15], s43 offen lds
    s_waitcnt vmcnt(9)
    s_barrier
    v_xor_b32 v13, 0x0, v11
    v_add_u32 v13, 0x8000, v13
    ds_read_b64_tr_b16 v[144:145], v13
    ds_read_b64_tr_b16 v[146:147], v13 offset:1024
    ds_read_b64_tr_b16 v[148:149], v13 offset:16384
    ds_read_b64_tr_b16 v[150:151], v13 offset:17408
    v_xor_b32 v13, 0x20, v11
    v_add_u32 v13, 0x8000, v13
    ds_read_b64_tr_b16 v[152:153], v13
    ds_read_b64_tr_b16 v[154:155], v13 offset:1024
    ds_read_b64_tr_b16 v[156:157], v13 offset:16384
    ds_read_b64_tr_b16 v[158:159], v13 offset:17408
    v_xor_b32 v13, 0x1000, v11
    v_add_u32 v13, 0x8000, v13
    ds_read_b64_tr_b16 v[176:177], v13
    ds_read_b64_tr_b16 v[178:179], v13 offset:1024
    ds_read_b64_tr_b16 v[180:181], v13 offset:16384
    ds_read_b64_tr_b16 v[182:183], v13 offset:17408
    v_xor_b32 v13, 0x1020, v11
    v_add_u32 v13, 0x8000, v13
    ds_read_b64_tr_b16 v[184:185], v13
    ds_read_b64_tr_b16 v[186:187], v13 offset:1024
    ds_read_b64_tr_b16 v[188:189], v13 offset:16384
    ds_read_b64_tr_b16 v[190:191], v13 offset:17408
    s_waitcnt lgkmcnt(0)
    s_barrier
    s_add_u32 s43, s42, 0x10000
    s_add_u32 m0, s51, 0x10000
    s_nop 0
    buffer_load_dwordx4 v10, s[12:15], s43 offen lds
    s_add_u32 s43, s42, 0x14000
    s_add_u32 m0, s51, 0x11000
    s_nop 0
    buffer_load_dwordx4 v9, s[12:15], s43 offen lds
    s_add_u32 s43, s42, 0x18000
    s_add_u32 m0, s51, 0x12000
    s_nop 0
    buffer_load_dwordx4 v10, s[12:15], s43 offen lds
    s_add_u32 s43, s42, 0x1c000
    s_add_u32 m0, s51, 0x13000
    s_nop 0
    buffer_load_dwordx4 v9, s[12:15], s43 offen lds
    s_add_u32 s43, s42, 0x200
    s_add_u32 m0, s51, 0x14000
    s_nop 0
    buffer_load_dwordx4 v10, s[12:15], s43 offen lds
    s_add_u32 s43, s42, 0x4200
    s_add_u32 m0, s51, 0x15000
    s_nop 0
    buffer_load_dwordx4 v9, s[12:15], s43 offen lds
    s_add_u32 s43, s42, 0x8200
    s_add_u32 m0, s51, 0x16000
    s_nop 0
    buffer_load_dwordx4 v10, s[12:15], s43 offen lds
    s_add_u32 s43, s42, 0xc200
    s_add_u32 m0, s51, 0x17000
    s_nop 0
    buffer_load_dwordx4 v9, s[12:15], s43 offen lds
    v_lshlrev_b32 v26, 3, v117
    v_and_b32 v26, 2048, v26
    s_lshl_b32 s43, s20, 6
    s_add_u32 s43, s43, 0x2000
    buffer_load_dword v26, v26, s[8:11], s43 offen sc1
    buffer_load_dword v27, off, s[16:19], 0 offset:4 sc1
    s_waitcnt vmcnt(10)
    v_min_u32 v21, 0xfffffffe, v21
    s_mov_b32 s43, 0x10000
    s_mov_b64 exec, s[38:39]
    buffer_store_dword v21, v119, s[8:11], s43 offen
    s_mov_b64 exec, -1
    v_mov_b32 v16, -1
    v_mov_b32 v17, -1
    v_mov_b32 v18, -1
    v_mov_b32 v19, -1
    s_lshl_b32 s43, s20, 13
    s_add_u32 s43, s43, 0x100000
    s_and_b32 s40, s21, 1
    s_lshl_b32 s40, s40, 12
    s_add_u32 s29, s43, s40
    s_add_u32 s43, s43, s52
    s_xor_b32 s40, s43, 0x40000
    buffer_store_dwordx4 v[16:19], v117, s[8:11], s40 offen
    buffer_store_dwordx4 v[16:19], v117, s[8:11], s40 offen offset:1024
    s_mov_b32 s43, 0x12000
    buffer_store_dword v16, v119, s[8:11], s43 offen
    s_mov_b32 s43, 0x14000
    buffer_store_dword v16, v119, s[8:11], s43 offen
    s_mov_b32 s43, 0x16000
    buffer_store_dword v16, v119, s[8:11], s43 offen
    s_barrier
    v_xor_b32 v13, 0x0, v12
    v_add_u32 v13, 0x0, v13
    ds_read_b64_tr_b16 v[192:193], v13
    ds_read_b64_tr_b16 v[194:195], v13 offset:512
    ds_read_b64_tr_b16 v[196:197], v13 offset:2048
    ds_read_b64_tr_b16 v[198:199], v13 offset:2560
    v_xor_b32 v13, 0x2000, v12
    v_add_u32 v13, 0x0, v13
    ds_read_b64_tr_b16 v[200:201], v13
    ds_read_b64_tr_b16 v[202:203], v13 offset:512
    ds_read_b64_tr_b16 v[204:205], v13 offset:2048
    ds_read_b64_tr_b16 v[206:207], v13 offset:2560
    v_xor_b32 v13, 0x40, v12
    v_add_u32 v13, 0x0, v13
    ds_read_b64_tr_b16 v[224:225], v13
    ds_read_b64_tr_b16 v[226:227], v13 offset:512
    ds_read_b64_tr_b16 v[228:229], v13 offset:2048
    ds_read_b64_tr_b16 v[230:231], v13 offset:2560
    v_xor_b32 v13, 0x2040, v12
    v_add_u32 v13, 0x0, v13
    ds_read_b64_tr_b16 v[232:233], v13
    ds_read_b64_tr_b16 v[234:235], v13 offset:512
    ds_read_b64_tr_b16 v[236:237], v13 offset:2048
    ds_read_b64_tr_b16 v[238:239], v13 offset:2560
    s_lshr_b32 s43, s20, 1
    s_lshl_b32 s43, s43, 7
    s_and_b32 s40, s20, 1
    s_lshl_b32 s40, s40, 4
    s_add_u32 s43, s43, s40
    s_add_u32 s44, s43, 0x1000
    s_cmp_eq_u32 s21, 0
    s_cselect_b32 s44, s44, 0x7ff00000
    s_mov_b32 s22, 0
    s_mov_b32 s33, 0
    s_xor_b32 s53, s29, 1024
    s_add_u32 s23, s51, 0x10000
    s_add_u32 s48, s23, 4096
    s_mov_b32 s24, 0x12000
    s_add_u32 s55, s24, 16384
    s_mov_b32 s25, 0x100000
    s_mov_b32 s26, 0x101000
    v_mov_b32 v112, 0
    v_mov_b32 v113, 0
    v_mov_b32 v114, 0
    v_mov_b32 v115, 0
    ds_write_b128 v117, v[112:115] offset:22528
    ds_write_b128 v117, v[112:115] offset:23552
    s_cmp_lg_u32 s21, 0
    s_cselect_b32 s40, -1, 0
    v_mov_b32 v126, s40
    v_bfe_u32 v1, v117, 4, 1
    v_lshlrev_b32 v1, 4, v1
    s_movk_i32 s43, 0x3f80
    v_lshlrev_b32 v125, v1, s43
    v_bfe_u32 v1, v117, 5, 3
    v_cmp_eq_u32 s[68:69], 0, v1
    v_cmp_eq_u32 s[70:71], 1, v1
    v_cmp_eq_u32 s[72:73], 2, v1
    v_cmp_eq_u32 s[74:75], 3, v1
    v_lshrrev_b32 v1, 2, v117
    s_cmp_lt_u32 s21, 2
    s_cselect_b64 vcc, -1, 0
    v_cndmask_b32 v119, v119, v1, vcc
    v_mov_b32 v40, 0
    v_mov_b32 v41, 0
    v_mov_b32 v42, 0
    v_mov_b32 v43, 0
    v_mov_b32 v44, 0
    v_mov_b32 v45, 0
    v_mov_b32 v46, 0
    v_mov_b32 v47, 0
    v_mov_b32 v48, 0
    v_mov_b32 v49, 0
    v_mov_b32 v50, 0
    v_mov_b32 v51, 0
    v_mov_b32 v52, 0
    v_mov_b32 v53, 0
    v_mov_b32 v54, 0
    v_mov_b32 v55, 0
    s_mov_b32 s45, 0
    s_mov_b32 s46, 0
    s_mov_b32 s47, 0
    s_mov_b32 s76, 0
    s_and_b32 s43, s21, 1
    s_lshl_b32 s43, s43, 5
    s_add_u32 s43, s43, s20
    s_lshl_b32 s43, s43, 6
    s_add_u32 s28, s43, 0x2000
    s_mov_b32 s59, 0
    s_waitcnt vmcnt(6) lgkmcnt(0)
    v_readlane_b32 s43, v26, 0
    v_readlane_b32 s40, v26, 16
    s_nop 0
    s_min_u32 s43, s43, s40
    s_cmp_lg_u32 s43, 0
    s_cselect_b32 s57, s57, 0
    v_readfirstlane_b32 s43, v27
    s_nop 0
    s_cmp_ge_u32 s43, 32
    s_cselect_b32 s57, s57, 0
    s_cmp_lg_u32 s57, 1
    s_cbranch_scc1 L_nokv_7
    s_add_u32 m0, s52, 8192
    s_nop 0
    buffer_load_dwordx4 v117, s[8:11], s30 offen lds
    buffer_load_dwordx4 v117, s[8:11], s30 offen offset:1024 lds
    s_add_u32 m0, s52, 0x6000
    s_nop 0
    buffer_load_dwordx4 v117, s[8:11], s31 offen lds
    buffer_load_dwordx4 v117, s[8:11], s31 offen offset:1024 lds
L_nokv_7:
    s_barrier
    v_xor_b32 v13, 0x0, v12
    v_add_u32 v13, 0x8000, v13
    ds_read_b64_tr_b16 v[208:209], v13
    ds_read_b64_tr_b16 v[210:211], v13 offset:512
    ds_read_b64_tr_b16 v[212:213], v13 offset:2048
    ds_read_b64_tr_b16 v[214:215], v13 offset:2560
    v_xor_b32 v13, 0x2000, v12
    v_add_u32 v13, 0x8000, v13
    ds_read_b64_tr_b16 v[216:217], v13
    ds_read_b64_tr_b16 v[218:219], v13 offset:512
    ds_read_b64_tr_b16 v[220:221], v13 offset:2048
    ds_read_b64_tr_b16 v[222:223], v13 offset:2560
    v_xor_b32 v13, 0x40, v12
    v_add_u32 v13, 0x8000, v13
    ds_read_b64_tr_b16 v[240:241], v13
    ds_read_b64_tr_b16 v[242:243], v13 offset:512
    ds_read_b64_tr_b16 v[244:245], v13 offset:2048
    ds_read_b64_tr_b16 v[246:247], v13 offset:2560
    v_xor_b32 v13, 0x2040, v12
    v_add_u32 v13, 0x8000, v13
    ds_read_b64_tr_b16 v[248:249], v13
    ds_read_b64_tr_b16 v[250:251], v13 offset:512
    ds_read_b64_tr_b16 v[252:253], v13 offset:2048
    ds_read_b64_tr_b16 v[254:255], v13 offset:2560
    ds_write_b128 v123, v[80:83]
    ds_write_b128 v123, v[84:87] offset:1024
    ds_write_b128 v123, v[56:59] offset:2048
    ds_write_b128 v123, v[60:63] offset:3072
    ds_write_b128 v123, v[88:91] offset:4096
    ds_write_b128 v123, v[92:95] offset:5120
    ds_write_b128 v123, v[96:99] offset:6144
    ds_write_b128 v123, v[100:103] offset:7168
    s_cmp_eq_u32 s57, 1
    s_cbranch_scc1 L_started_8
    s_mov_b32 s96, 0
L_mode_9:
    buffer_load_dwordx2 v[2:3], off, s[92:95], 0 offset:36 sc1
    s_waitcnt vmcnt(0)
    v_readfirstlane_b32 s87, v2
    v_readfirstlane_b32 s97, v3
    s_nop 0
    s_min_u32 s97, s97, s87
    s_cmp_lg_u32 s97, 0
    s_cbranch_scc1 L_moded_10
    s_sleep 4
    s_add_u32 s96, s96, 1
    s_cmp_lg_u32 s96, 0x100
    s_cbranch_scc1 L_modef_11
    v_mov_b32 v2, 2
    v_mov_b32 v3, 0
    s_mov_b64 exec, 1
    buffer_atomic_cmpswap v[2:3], off, s[92:95], 0 offset:36
    s_mov_b64 exec, -1
L_modef_11:
    s_cmp_lt_u32 s96, 0x10000
    s_cbranch_scc1 L_mode_9
L_moded_10:
    s_cmp_lg_u32 s87, 1
    s_cbranch_scc1 L_fallback
    v_lshrrev_b32 v1, 4, v117
    v_and_b32 v2, 15, v1
    v_lshrrev_b32 v1, 4, v1
    v_lshlrev_b32 v1, 11, v1
    v_lshl_add_u32 v1, v2, 2, v1
    s_lshl_b32 s43, s20, 6
    s_add_u32 s43, s43, 0x2000
    s_mov_b32 exec_lo, 0x10001
    s_mov_b32 exec_hi, 0
    s_mov_b32 s96, 0
L_poll_12:
    buffer_load_dword v2, v1, s[8:11], s43 offen sc1
    s_waitcnt vmcnt(0)
    v_cmp_gt_u32 vcc, 1, v2
    s_cbranch_vccz L_polld_13
    s_sleep 8
    s_add_u32 s96, s96, 1
    s_cmp_lt_u32 s96, 0x10000
    s_cbranch_scc1 L_poll_12
L_polld_13:
    s_mov_b64 exec, -1
    s_add_u32 m0, s52, 8192
    s_nop 0
    buffer_load_dwordx4 v117, s[8:11], s30 offen lds
    buffer_load_dwordx4 v117, s[8:11], s30 offen offset:1024 lds
    s_add_u32 m0, s52, 0x6000
    s_nop 0
    buffer_load_dwordx4 v117, s[8:11], s31 offen lds
    buffer_load_dwordx4 v117, s[8:11], s31 offen offset:1024 lds
    s_mov_b32 s49, 0
L_cb_poll_15:
    buffer_load_dword v3, off, s[16:19], 0 offset:4 sc1
    s_waitcnt vmcnt(0)
    v_readfirstlane_b32 s43, v3
    s_nop 0
    s_cmp_ge_u32 s43, 32
    s_cbranch_scc1 L_started_8
    s_sleep 8
    s_add_u32 s49, s49, 1
    s_cmp_lt_u32 s49, 0x40000
    s_cbranch_scc1 L_cb_poll_15
L_started_8:
    s_add_u32 m0, s51, 4096
    v_mov_b32 v24, v32
    v_mov_b32 v25, v33
    v_mov_b32 v26, v34
    v_mov_b32 v27, v35
    v_mov_b32 v28, v36
    v_mov_b32 v29, v37
    v_mov_b32 v30, v38
    v_mov_b32 v31, v39
    s_add_u32 s30, s30, 0x40000
    s_add_u32 s31, s31, 0x40000
    s_mov_b32 s49, 0
    s_waitcnt vmcnt(0) lgkmcnt(0)
    s_barrier
    ds_write_b128 v123, v[64:67] offset:32768
    ds_write_b128 v123, v[68:71] offset:33792
    ds_write_b128 v123, v[72:75] offset:34816
    ds_write_b128 v123, v[76:79] offset:35840
    ds_write_b128 v123, v[104:107] offset:36864
    ds_write_b128 v123, v[108:111] offset:37888
    ds_write_b128 v123, v[32:35] offset:38912
    ds_write_b128 v123, v[36:39] offset:39936
    v_mov_b32 v32, 0
    v_mov_b32 v33, 0
    v_mov_b32 v34, 0
    v_mov_b32 v35, 0
    v_mov_b32 v36, 0
    v_mov_b32 v37, 0
    v_mov_b32 v38, 0
    v_mov_b32 v39, 0
    s_nop 4
    s_cmp_eq_u32 s21, 1
    s_cbranch_scc1 L_chain_top1_f
    s_cmp_eq_u32 s21, 2
    s_cbranch_scc1 L_chain_top2_f
    s_cmp_eq_u32 s21, 3
    s_cbranch_scc1 L_chain_top3_f
.p2align 6
L_chain_top0_f:
    buffer_load_dwordx4 v[0:3], v117, s[8:11], s23 offen nt
    v_mov_b32 v15, 0
    v_mov_b32 v15, 0
    v_mov_b32 v15, 0
    v_mov_b32 v15, 0
    v_mov_b32 v15, 0
    v_mov_b32 v15, 0
    v_mov_b32 v15, 0
    v_mov_b32 v15, 0
    v_mov_b32 v15, 0
    v_mov_b32 v15, 0
    v_mov_b32 v15, 0
    v_mov_b32 v15, 0
    v_mov_b32 v15, 0
    v_mov_b32 v15, 0
    v_mov_b32 v15, 0
    v_mov_b32 v15, 0
    buffer_load_dwordx4 v[0:3], v117, s[8:11], s23 offen sc1
    v_mov_b32 v15, 0
    v_mov_b32 v15, 0
    v_mov_b32 v15, 0
    v_mov_b32 v15, 0
    v_mov_b32 v15, 0
    v_mov_b32 v15, 0
    v_mov_b32 v15, 0
    v_mov_b32 v15, 0
    v_mov_b32 v15, 0
    v_mov_b32 v15, 0
    v_mov_b32 v15, 0
    v_mov_b32 v15, 0
    v_mov_b32 v15, 0
    v_mov_b32 v15, 0
    v_mov_b32 v15, 0
    v_mov_b32 v15, 0
L_mret_17:
    buffer_load_dwordx4 v[0:3], v117, s[8:11], s23 offen sc1
    s_add_u32 s45, s45, 1
    s_cmp_lt_u32 s45, 0x10000
    s_cselect_b32 s56, -2, -1
    s_nop 3
    v_mov_b32 v32, 0
    v_mov_b32 v33, 0
    v_mov_b32 v34, 0
    v_mov_b32 v35, 0
    s_waitcnt vmcnt(2)
    v_max3_u32 v15, v0, v1, v2
    v_max_u32 v15, v15, v3
    v_cmp_lt_u32 vcc, s56, v15
    v_smfmac_f32_16x16x64_bf16 v[32:35], v[0:3], v[80:87], v116
    s_cbranch_vccnz L_mret_17
    ds_write_b128 v117, v[0:3]
    v_smfmac_f32_16x16x64_bf16 v[36:39], v[0:3], v[56:63], v116
    buffer_load_dwordx4 v[4:7], v117, s[8:11], s48 offen nt
    v_smfmac_f32_16x16x64_bf16 v[40:43], v[0:3], v[64:71], v116
    buffer_load_dwordx4 v117, s[8:11], s48 offen nt lds
    s_mov_b32 m0, 8192
    v_smfmac_f32_16x16x64_bf16 v[44:47], v[0:3], v[72:79], v116
    s_waitcnt lgkmcnt(0)
    s_barrier
    ds_read_b128 v[8:11], v117 offset:1024
    v_smfmac_f32_16x16x64_bf16 v[48:51], v[0:3], a[192:199], v116
    ds_read_b128 v[16:19], v117 offset:2048
    ds_read_b128 v[20:23], v117 offset:3072
    v_smfmac_f32_16x16x64_bf16 v[52:55], v[0:3], a[200:207], v116
    ds_read_b128 v[80:83], v117 offset:14336
    s_waitcnt lgkmcnt(3)
    v_smfmac_f32_16x16x64_bf16 v[32:35], v[8:11], a[0:7], v116
    ds_read_b128 v[84:87], v117 offset:15360
    v_smfmac_f32_16x16x64_bf16 v[36:39], v[8:11], a[8:15], v116
    buffer_store_dwordx4 v[112:115], v117, s[8:11], s32 offen sc1
    s_waitcnt lgkmcnt(3)
    v_smfmac_f32_16x16x64_bf16 v[32:35], v[16:19], a[32:39], v116
    ds_read_b128 v[56:59], v117 offset:8192
    v_smfmac_f32_16x16x64_bf16 v[36:39], v[16:19], a[40:47], v116
    ds_read_b128 v[60:63], v117 offset:9216
    s_waitcnt lgkmcnt(4)
    v_smfmac_f32_16x16x64_bf16 v[32:35], v[20:23], a[64:71], v116
    ds_read_b128 v[64:67], v117 offset:10240
    v_smfmac_f32_16x16x64_bf16 v[36:39], v[20:23], a[72:79], v116
    ds_read_b128 v[68:71], v117 offset:11264
    v_smfmac_f32_16x16x64_bf16 v[40:43], v[8:11], a[96:103], v116
    ds_read_b128 v[72:75], v117 offset:12288
    v_smfmac_f32_16x16x64_bf16 v[40:43], v[16:19], a[128:135], v116
    ds_read_b128 v[76:79], v117 offset:13312
    v_smfmac_f32_16x16x64_bf16 v[40:43], v[20:23], a[160:167], v116
    s_waitcnt vmcnt(2)
    v_max3_u32 v15, v4, v5, v6
    v_smfmac_f32_16x16x64_bf16 v[44:47], v[8:11], a[104:111], v116
    v_max_u32 v15, v15, v7
    v_smfmac_f32_16x16x64_bf16 v[44:47], v[16:19], a[136:143], v116
    s_waitcnt vmcnt(1) lgkmcnt(0)
    v_cmp_lt_u32 vcc, s56, v15
    v_smfmac_f32_16x16x64_bf16 v[44:47], v[20:23], a[168:175], v116
    s_cbranch_vccnz L_mret_18
L_mgo_19:
    v_smfmac_f32_16x16x64_bf16 v[44:47], v[4:7], v[24:31], v116
    s_barrier
    ds_read_b128 v[12:15], v117 offset:5120
    v_smfmac_f32_16x16x64_bf16 v[32:35], v[4:7], v[88:95], v116
    ds_read_b128 v[24:27], v117 offset:6144
    v_smfmac_f32_16x16x64_bf16 v[36:39], v[4:7], v[96:103], v116
    ds_read_b128 v[28:31], v117 offset:7168
    v_smfmac_f32_16x16x64_bf16 v[40:43], v[4:7], v[104:111], v116
    ds_read_b128 v[88:91], v117 offset:24576
    s_waitcnt lgkmcnt(3)
    v_smfmac_f32_16x16x64_bf16 v[32:35], v[12:15], a[16:23], v116
    ds_read_b128 v[92:95], v117 offset:25600
    s_waitcnt lgkmcnt(3)
    v_smfmac_f32_16x16x64_bf16 v[32:35], v[24:27], a[48:55], v116
    buffer_load_dwordx4 v117, s[8:11], s30 offen lds
    s_waitcnt lgkmcnt(2)
    v_smfmac_f32_16x16x64_bf16 v[32:35], v[28:31], a[80:87], v116
    ds_read_b128 v[96:99], v117 offset:23552
    v_smfmac_f32_16x16x64_bf16 v[36:39], v[12:15], a[24:31], v116
    ds_read_b128 v[100:103], v117 offset:23552
    v_smfmac_f32_16x16x64_bf16 v[36:39], v[24:27], a[56:63], v116
    buffer_load_dwordx4 v117, s[8:11], s30 offen offset:1024 lds
    s_add_u32 m0, s52, 0x6000
    v_add_f32 v32, v32, v34
    v_smfmac_f32_16x16x64_bf16 v[36:39], v[28:31], a[88:95], v116
    ds_read_b128 v[104:107], v117 offset:23552
    v_add_f32 v33, v33, v35
    v_smfmac_f32_16x16x64_bf16 v[40:43], v[12:15], a[112:119], v116
    ds_read_b128 v[108:111], v117 offset:23552
    v_mul_f32 v32, s34, v32
    v_smfmac_f32_16x16x64_bf16 v[40:43], v[24:27], a[144:151], v116
    buffer_load_dword v125, v119, s[8:11], s28 offen sc1
    v_mul_f32 v33, s34, v33
    v_smfmac_f32_16x16x64_bf16 v[40:43], v[28:31], a[176:183], v116
    ds_read_b128 v[0:3], v124
    v_add_f32 v36, v36, v38
    v_smfmac_f32_16x16x64_bf16 v[48:51], v[4:7], a[208:215], v116
    v_add_f32 v37, v37, v39
    v_smfmac_f32_16x16x64_bf16 v[52:55], v[4:7], a[216:223], v116
    s_waitcnt lgkmcnt(5)
    buffer_load_dwordx4 v117, s[8:11], s31 offen lds
    v_mul_f32 v36, s34, v36
    v_smfmac_f32_16x16x64_bf16 v[44:47], v[12:15], a[120:127], v116
    ds_read_b128 v[4:7], v124 offset:1024
    v_mul_f32 v37, s34, v37
    v_smfmac_f32_16x16x64_bf16 v[44:47], v[24:27], a[152:159], v116
    v_cvt_pk_bf16_f32 v34, v32, v36
    v_smfmac_f32_16x16x64_bf16 v[44:47], v[28:31], a[184:191], v116
    buffer_load_dwordx4 v117, s[8:11], s31 offen offset:1024 lds
    s_mov_b32 m0, 4096
    v_cvt_pk_bf16_f32 v35, v33, v37
    v_add_f32 v40, v40, v42
    v_smfmac_f32_16x16x64_bf16 v[48:51], v[8:11], a[224:231], v116
    ds_write2_b32 v120, v34, v35 offset0:32 offset1:48
    v_add_f32 v41, v41, v43
    v_smfmac_f32_16x16x64_bf16 v[52:55], v[8:11], a[232:239], v116
    v_add_f32 v44, v44, v46
    v_add_f32 v45, v45, v47
    v_cvt_pk_bf16_f32 v113, v40, v44
    v_cvt_pk_bf16_f32 v115, v41, v45
    v_smfmac_f32_16x16x64_bf16 v[48:51], v[12:15], a[240:247], v116
    ds_write2_b32 v120, v113, v115 offset0:0 offset1:16
    v_smfmac_f32_16x16x64_bf16 v[52:55], v[12:15], a[248:255], v116
    s_cmp_eq_u32 s22, 63
    s_cbranch_scc1 L_chain_last_f
    buffer_store_dword v126, off, s[8:11], s44 sc1
    v_smfmac_f32_16x16x64_bf16 v[48:51], v[16:19], v[128:135], v116
    v_smfmac_f32_16x16x64_bf16 v[48:51], v[20:23], v[160:167], v116
    v_smfmac_f32_16x16x64_bf16 v[48:51], v[24:27], v[144:151], v116
    s_waitcnt lgkmcnt(0)
    s_barrier
    v_smfmac_f32_16x16x64_bf16 v[48:51], v[28:31], v[176:183], v116
    ds_read_b128 v[32:35], v121 offset:16384
    ds_read_b128 v[36:39], v121 offset:17408
    v_smfmac_f32_16x16x64_bf16 v[52:55], v[16:19], v[136:143], v116
    ds_read_b128 v[40:43], v121 offset:18432
    ds_read_b128 v[44:47], v121 offset:19456
    v_smfmac_f32_16x16x64_bf16 v[52:55], v[20:23], v[168:175], v116
    ds_read_b128 v[8:11], v124 offset:32768
    v_add_f32 v48, v48, v50
    v_smfmac_f32_16x16x64_bf16 v[52:55], v[24:27], v[152:159], v116
    ds_read_b128 v[12:15], v124 offset:33792
    v_add_f32 v49, v49, v51
    v_smfmac_f32_16x16x64_bf16 v[52:55], v[28:31], v[184:191], v116
    s_waitcnt lgkmcnt(5)
    v_cvt_pk_bf16_f32 v112, v48, v49
    v_mfma_f32_16x16x32_bf16 v[56:59], v[56:59], v[32:35], 0
    s_waitcnt lgkmcnt(4)
    v_mov_b32 v48, s50
    v_mov_b32 v49, s50
    v_mfma_f32_16x16x32_bf16 v[56:59], v[60:63], v[36:39], v[56:59]
    ds_read_b128 v[16:19], v124 offset:2048
    s_waitcnt lgkmcnt(4)
    v_mov_b32 v50, s50
    v_mov_b32 v51, s50
    v_mfma_f32_16x16x32_bf16 v[56:59], v[64:67], v[40:43], v[56:59]
    ds_read_b128 v[20:23], v124 offset:3072
    s_waitcnt lgkmcnt(4)
    v_add_f32 v52, v52, v54
    v_mfma_f32_16x16x32_bf16 v[56:59], v[68:71], v[44:47], v[56:59]
    ds_read_b128 v[24:27], v124 offset:4096
    v_add_f32 v53, v53, v55
    v_mfma_f32_16x16x32_bf16 v[60:63], v[72:75], v[32:35], 0
    ds_read_b128 v[28:31], v124 offset:5120
    v_cvt_pk_bf16_f32 v114, v52, v53
    v_mov_b32 v53, 0
    v_mfma_f32_16x16x32_bf16 v[60:63], v[76:79], v[36:39], v[60:63]
    v_exp_f32 v56, v56
    v_mfma_f32_16x16x32_bf16 v[60:63], v[80:83], v[40:43], v[60:63]
    v_exp_f32 v57, v57
    v_mfma_f32_16x16x32_bf16 v[60:63], v[84:87], v[44:47], v[60:63]
    v_exp_f32 v58, v58
    v_mfma_f32_16x16x32_bf16 v[64:67], v[32:35], v[32:35], 0
    v_exp_f32 v59, v59
    v_cvt_pk_bf16_f32 v68, v56, v57
    v_mfma_f32_16x16x32_bf16 v[64:67], v[36:39], v[36:39], v[64:67]
    v_exp_f32 v60, v60
    v_cvt_pk_bf16_f32 v69, v58, v59
    v_mfma_f32_16x16x32_bf16 v[64:67], v[40:43], v[40:43], v[64:67]
    v_exp_f32 v61, v61
    v_mfma_f32_16x16x32_bf16 v[64:67], v[44:47], v[44:47], v[64:67]
    v_exp_f32 v62, v62
    v_exp_f32 v63, v63
    v_cvt_pk_bf16_f32 v70, v60, v61
    v_cvt_pk_bf16_f32 v71, v62, v63
    s_nop 1
    v_mfma_f32_16x16x32_bf16 v[72:75], v[88:91], v[68:71], 0
    s_nop 0
    v_exp_f32 v64, v64
    v_mfma_f32_16x16x32_bf16 v[76:79], v[92:95], v[68:71], 0
    v_exp_f32 v65, v65
    v_mfma_f32_16x16x32_bf16 v[80:83], v[48:51], v[68:71], 0
    v_cvt_pk_bf16_f32 v52, v64, v65
    s_nop 1
    v_mfma_f32_16x16x16_bf16 v[72:75], v[112:113], v[52:53], v[72:75]
    ds_read_b128 v[32:35], v124 offset:6144
    v_mfma_f32_16x16x16_bf16 v[76:79], v[114:115], v[52:53], v[76:79]
    ds_read_b128 v[36:39], v124 offset:7168
    v_mfma_f32_16x16x16_bf16 v[80:83], v[48:49], v[52:53], v[80:83]
L_norm_20:
    s_mov_b64 vcc, s[36:37]
    v_mov_b32 v122, v122
    v_mov_b32 v122, v122
    v_mov_b32 v122, v122
    v_cndmask_b32_dpp v76, v72, v76, vcc quad_perm:[2,3,2,3] row_mask:0xf bank_mask:0xf
    v_cndmask_b32_dpp v77, v73, v77, vcc quad_perm:[2,3,2,3] row_mask:0xf bank_mask:0xf
    v_cndmask_b32_dpp v78, v74, v78, vcc quad_perm:[2,3,2,3] row_mask:0xf bank_mask:0xf
    v_cndmask_b32_dpp v79, v75, v79, vcc quad_perm:[2,3,2,3] row_mask:0xf bank_mask:0xf
    v_rcp_f32_dpp v84, v80 quad_perm:[2,3,2,3] row_mask:0xf bank_mask:0xf
    s_nop 0
    v_pk_mul_f32 v[76:77], v[76:77], v[84:85] op_sel_hi:[1,0]
    v_pk_mul_f32 v[78:79], v[78:79], v[84:85] op_sel_hi:[1,0]
    v_cvt_pk_bf16_f32 v72, v76, v77
    v_cvt_pk_bf16_f32 v73, v78, v79
    ds_write_b64 v122, v[72:73] offset:20480
    v_max_f32_dpp v86, v80, v84 quad_perm:[2,3,2,3] row_mask:0xf bank_mask:0xf
    v_mov_b32_dpp v60, v72 quad_perm:[0,1,0,1] row_mask:0xf bank_mask:0xf
    v_mov_b32_dpp v61, v73 quad_perm:[0,1,0,1] row_mask:0xf bank_mask:0xf
    v_cmp_lt_f32 vcc, s35, v86
    v_mov_b32_dpp v62, v72 quad_perm:[2,3,2,3] row_mask:0xf bank_mask:0xf
    v_mov_b32_dpp v63, v73 quad_perm:[2,3,2,3] row_mask:0xf bank_mask:0xf
    s_nop 1
    v_smfmac_f32_16x16x64_bf16 v[96:99], v[60:63], v[192:199], v116
    s_cbranch_vccnz L_smax_21
    v_smfmac_f32_16x16x64_bf16 v[100:103], v[60:63], v[224:231], v116
    s_waitcnt lgkmcnt(0)
    s_barrier
    ds_read_b128 v[92:95], v127 offset:20992
    ds_read_b128 v[80:83], v127 offset:21504
    ds_read_b128 v[84:87], v127 offset:22016
    v_smfmac_f32_16x16x64_bf16 v[104:107], v[60:63], v[0:7], v116
    ds_read_b128 v[40:43], v124 offset:34816
    v_smfmac_f32_16x16x64_bf16 v[108:111], v[60:63], v[8:15], v116
    ds_read_b128 v[56:59], v124 offset:36864
    s_waitcnt lgkmcnt(4)
    v_smfmac_f32_16x16x64_bf16 v[96:99], v[92:95], v[200:207], v116
    s_waitcnt lgkmcnt(3)
    v_smfmac_f32_16x16x64_bf16 v[96:99], v[80:83], v[208:215], v116
    ds_read_b128 v[44:47], v124 offset:35840
    s_waitcnt lgkmcnt(3)
    v_smfmac_f32_16x16x64_bf16 v[96:99], v[84:87], v[216:223], v116
    ds_read_b128 v[68:71], v124 offset:39936
    v_smfmac_f32_16x16x64_bf16 v[100:103], v[92:95], v[232:239], v116
    ds_read_b128 v[64:67], v124 offset:38912
    v_smfmac_f32_16x16x64_bf16 v[100:103], v[80:83], v[240:247], v116
    ds_read_b128 v[60:63], v124 offset:37888
    v_cvt_pk_bf16_f32 v72, v96, v98
    v_smfmac_f32_16x16x64_bf16 v[100:103], v[84:87], v[248:255], v116
    v_and_or_b32 v72, v72, -2, s33
    v_smfmac_f32_16x16x64_bf16 v[104:107], v[92:95], v[16:23], v116
    v_cvt_pk_bf16_f32 v74, v97, v99
    v_smfmac_f32_16x16x64_bf16 v[104:107], v[80:83], v[24:31], v116
    v_cvt_pk_bf16_f32 v73, v100, v102
    v_cvt_pk_bf16_f32 v75, v101, v103
    v_smfmac_f32_16x16x64_bf16 v[104:107], v[84:87], v[32:39], v116
    buffer_store_dwordx4 v[72:75], v118, s[8:11], s25 offen
    s_waitcnt lgkmcnt(3)
    v_smfmac_f32_16x16x64_bf16 v[108:111], v[92:95], v[40:47], v116
    s_waitcnt lgkmcnt(0)
    v_smfmac_f32_16x16x64_bf16 v[108:111], v[80:83], v[56:63], v116
    v_cvt_pk_bf16_f32 v76, v104, v106
    v_smfmac_f32_16x16x64_bf16 v[108:111], v[84:87], v[64:71], v116
    v_and_or_b32 v76, v76, -2, s33
    v_cvt_pk_bf16_f32 v78, v105, v107
    v_mov_b32 v122, v122
    v_mov_b32 v122, v122
    v_mov_b32 v122, v122
    v_mov_b32 v122, v122
    v_mov_b32 v122, v122
    v_mov_b32 v122, v122
    v_cvt_pk_bf16_f32 v77, v108, v110
    v_cvt_pk_bf16_f32 v79, v109, v111
    buffer_store_dwordx4 v[76:79], v118, s[8:11], s26 offen
    s_add_u32 s30, s30, 0x40000
    s_add_u32 s31, s31, 0x40000
    s_add_u32 s32, s32, 0x20000
    s_add_u32 s23, s24, 0
    s_add_u32 s48, s23, 4096
    s_xor_b32 s25, s25, 0x40000
    s_xor_b32 s26, s26, 0x40000
    s_mov_b32 s35, 0x49800000
    v_mov_b32 v126, s22
    s_add_u32 s22, s22, 1
    v_mov_b32 v32, 0
    v_mov_b32 v33, 0
    v_mov_b32 v34, 0
    v_mov_b32 v35, 0
    v_mov_b32 v36, 0
    v_mov_b32 v37, 0
    v_mov_b32 v38, 0
    v_mov_b32 v39, 0
    v_mov_b32 v40, 0
    v_mov_b32 v41, 0
    v_mov_b32 v42, 0
    v_mov_b32 v43, 0
    v_mov_b32 v44, 0
    v_mov_b32 v45, 0
    v_mov_b32 v46, 0
    v_mov_b32 v47, 0
    v_mov_b32 v48, 0
    v_mov_b32 v49, 0
    v_mov_b32 v50, 0
    v_mov_b32 v51, 0
    v_mov_b32 v52, 0
    v_mov_b32 v53, 0
    v_mov_b32 v54, 0
    v_mov_b32 v55, 0
    ds_read_b128 v[80:83], v123
    ds_read_b128 v[84:87], v123 offset:1024
    ds_read_b128 v[56:59], v123 offset:2048
    ds_read_b128 v[60:63], v123 offset:3072
    ds_read_b128 v[64:67], v123 offset:32768
    ds_read_b128 v[68:71], v123 offset:33792
    ds_read_b128 v[72:75], v123 offset:34816
    ds_read_b128 v[76:79], v123 offset:35840
    ds_read_b128 v[88:91], v123 offset:4096
    ds_read_b128 v[92:95], v123 offset:5120
    ds_read_b128 v[96:99], v123 offset:6144
    ds_read_b128 v[100:103], v123 offset:7168
    ds_read_b128 v[104:107], v123 offset:36864
    ds_read_b128 v[108:111], v123 offset:37888
    ds_read_b128 v[24:27], v123 offset:38912
    ds_read_b128 v[28:31], v123 offset:39936
    s_add_u32 s24, s24, 8192
    s_bitset0_b32 s24, 15
    s_xor_b32 s55, s24, 16384
    s_xor_b32 s29, s29, 0x40000
    s_xor_b32 s53, s29, 1024
    s_bfe_u32 s33, s22, 0x10001
    s_add_u32 s40, s22, 5
    s_lshr_b32 s40, s40, 2
    s_min_u32 s40, s40, 16
    s_bfm_b32 s58, s40, 0
    s_waitcnt vmcnt(5)
    v_cmp_eq_u32 vcc, 0, v125
    s_nop 0
    s_and_b64 vcc, vcc, s[58:59]
    s_cbranch_scc1 L_kvw_22
L_kvb_23:
    v_mov_b32 v15, 0
    s_nop 2
    v_mov_b32 v15, 0
    s_nop 2
    v_mov_b32 v15, 0
    s_nop 2
    v_mov_b32 v15, 0
    s_nop 2
    v_mov_b32 v15, 0
    s_nop 2
    v_mov_b32 v15, 0
    s_nop 2
    v_mov_b32 v15, 0
    s_nop 2
    v_mov_b32 v15, 0
    s_nop 2
    v_mov_b32 v15, 0
    s_nop 2
    v_mov_b32 v15, 0
    s_nop 2
    v_mov_b32 v15, 0
    s_nop 2
    v_mov_b32 v15, 0
    s_nop 2
    v_mov_b32 v15, 0
    s_nop 2
    v_mov_b32 v15, 0
    s_nop 2
    v_mov_b32 v15, 0
    s_nop 2
    v_mov_b32 v15, 0
    s_nop 2
    v_mov_b32 v15, 0
    s_nop 2
    v_mov_b32 v15, 0
    s_nop 2
    v_mov_b32 v15, 0
    s_nop 2
    v_mov_b32 v15, 0
    s_nop 2
    v_mov_b32 v15, 0
    s_nop 2
    v_mov_b32 v15, 0
    s_nop 2
    v_mov_b32 v15, 0
    s_nop 2
    v_mov_b32 v15, 0
    s_nop 2
    v_mov_b32 v15, 0
    s_nop 2
    v_mov_b32 v15, 0
    s_nop 2
    v_mov_b32 v15, 0
    s_nop 2
    v_mov_b32 v15, 0
    s_nop 2
    v_mov_b32 v15, 0
    s_nop 2
    v_mov_b32 v15, 0
    s_nop 2
    v_mov_b32 v15, 0
    s_nop 2
    s_waitcnt lgkmcnt(0)
    s_branch L_chain_top0_f
.p2align 6
L_chain_top1_f:
    buffer_load_dwordx4 v[0:3], v117, s[8:11], s23 offen nt
    v_mov_b32 v15, 0
    v_mov_b32 v15, 0
    v_mov_b32 v15, 0
    v_mov_b32 v15, 0
    v_mov_b32 v15, 0
    v_mov_b32 v15, 0
    v_mov_b32 v15, 0
    v_mov_b32 v15, 0
    v_mov_b32 v15, 0
    v_mov_b32 v15, 0
    v_mov_b32 v15, 0
    v_mov_b32 v15, 0
    v_mov_b32 v15, 0
    v_mov_b32 v15, 0
    v_mov_b32 v15, 0
    v_mov_b32 v15, 0
    buffer_load_dwordx4 v[0:3], v117, s[8:11], s23 offen sc1
    v_mov_b32 v15, 0
    v_mov_b32 v15, 0
    v_mov_b32 v15, 0
    v_mov_b32 v15, 0
    v_mov_b32 v15, 0
    v_mov_b32 v15, 0
    v_mov_b32 v15, 0
    v_mov_b32 v15, 0
    v_mov_b32 v15, 0
    v_mov_b32 v15, 0
    v_mov_b32 v15, 0
    v_mov_b32 v15, 0
    v_mov_b32 v15, 0
    v_mov_b32 v15, 0
    v_mov_b32 v15, 0
    v_mov_b32 v15, 0
L_mret_24:
    buffer_load_dwordx4 v[0:3], v117, s[8:11], s23 offen sc1
    s_add_u32 s45, s45, 1
    s_cmp_lt_u32 s45, 0x10000
    s_cselect_b32 s56, -2, -1
    s_nop 3
    v_mov_b32 v32, 0
    v_mov_b32 v33, 0
    v_mov_b32 v34, 0
    v_mov_b32 v35, 0
    s_waitcnt vmcnt(2)
    v_max3_u32 v15, v0, v1, v2
    v_max_u32 v15, v15, v3
    v_cmp_lt_u32 vcc, s56, v15
    v_smfmac_f32_16x16x64_bf16 v[32:35], v[0:3], v[80:87], v116
    s_cbranch_vccnz L_mret_24
    ds_write_b128 v117, v[0:3] offset:1024
    v_smfmac_f32_16x16x64_bf16 v[36:39], v[0:3], v[56:63], v116
    buffer_load_dwordx4 v[4:7], v117, s[8:11], s48 offen nt
    v_smfmac_f32_16x16x64_bf16 v[40:43], v[0:3], v[64:71], v116
    buffer_load_dwordx4 v117, s[8:11], s48 offen nt lds
    s_mov_b32 m0, 10240
    v_smfmac_f32_16x16x64_bf16 v[44:47], v[0:3], v[72:79], v116
    s_waitcnt lgkmcnt(0)
    s_barrier
    ds_read_b128 v[8:11], v117
    v_smfmac_f32_16x16x64_bf16 v[48:51], v[0:3], a[192:199], v116
    ds_read_b128 v[16:19], v117 offset:3072
    ds_read_b128 v[20:23], v117 offset:2048
    v_smfmac_f32_16x16x64_bf16 v[52:55], v[0:3], a[200:207], v116
    ds_read_b128 v[80:83], v117 offset:14336
    s_waitcnt lgkmcnt(3)
    v_smfmac_f32_16x16x64_bf16 v[32:35], v[8:11], a[0:7], v116
    ds_read_b128 v[84:87], v117 offset:15360
    v_smfmac_f32_16x16x64_bf16 v[36:39], v[8:11], a[8:15], v116
    ds_read_b128 v[56:59], v117 offset:8192
    s_waitcnt lgkmcnt(4)
    v_smfmac_f32_16x16x64_bf16 v[32:35], v[16:19], a[32:39], v116
    ds_read_b128 v[60:63], v117 offset:9216
    v_smfmac_f32_16x16x64_bf16 v[36:39], v[16:19], a[40:47], v116
    buffer_store_dwordx4 v[112:115], v117, s[8:11], s32 offen sc1
    s_waitcnt lgkmcnt(4)
    v_smfmac_f32_16x16x64_bf16 v[32:35], v[20:23], a[64:71], v116
    ds_read_b128 v[64:67], v117 offset:10240
    v_smfmac_f32_16x16x64_bf16 v[36:39], v[20:23], a[72:79], v116
    ds_read_b128 v[68:71], v117 offset:11264
    v_smfmac_f32_16x16x64_bf16 v[40:43], v[8:11], a[96:103], v116
    ds_read_b128 v[72:75], v117 offset:12288
    v_smfmac_f32_16x16x64_bf16 v[40:43], v[16:19], a[128:135], v116
    ds_read_b128 v[76:79], v117 offset:13312
    v_smfmac_f32_16x16x64_bf16 v[40:43], v[20:23], a[160:167], v116
    s_waitcnt vmcnt(2)
    v_max3_u32 v15, v4, v5, v6
    v_smfmac_f32_16x16x64_bf16 v[44:47], v[8:11], a[104:111], v116
    v_max_u32 v15, v15, v7
    v_smfmac_f32_16x16x64_bf16 v[44:47], v[16:19], a[136:143], v116
    s_waitcnt vmcnt(1) lgkmcnt(0)
    v_cmp_lt_u32 vcc, s56, v15
    v_smfmac_f32_16x16x64_bf16 v[44:47], v[20:23], a[168:175], v116
    s_cbranch_vccnz L_mret_25
L_mgo_26:
    v_smfmac_f32_16x16x64_bf16 v[44:47], v[4:7], v[24:31], v116
    s_barrier
    ds_read_b128 v[12:15], v117 offset:4096
    v_smfmac_f32_16x16x64_bf16 v[32:35], v[4:7], v[88:95], v116
    ds_read_b128 v[24:27], v117 offset:7168
    v_smfmac_f32_16x16x64_bf16 v[36:39], v[4:7], v[96:103], v116
    ds_read_b128 v[28:31], v117 offset:6144
    v_smfmac_f32_16x16x64_bf16 v[40:43], v[4:7], v[104:111], v116
    ds_read_b128 v[88:91], v117 offset:26624
    s_waitcnt lgkmcnt(3)
    v_smfmac_f32_16x16x64_bf16 v[32:35], v[12:15], a[16:23], v116
    ds_read_b128 v[92:95], v117 offset:27648
    s_waitcnt lgkmcnt(3)
    v_smfmac_f32_16x16x64_bf16 v[32:35], v[24:27], a[48:55], v116
    buffer_load_dwordx4 v117, s[8:11], s30 offen lds
    s_waitcnt lgkmcnt(2)
    v_smfmac_f32_16x16x64_bf16 v[32:35], v[28:31], a[80:87], v116
    ds_read_b128 v[96:99], v117 offset:23552
    v_smfmac_f32_16x16x64_bf16 v[36:39], v[12:15], a[24:31], v116
    ds_read_b128 v[100:103], v117 offset:23552
    v_smfmac_f32_16x16x64_bf16 v[36:39], v[24:27], a[56:63], v116
    buffer_load_dwordx4 v117, s[8:11], s30 offen offset:1024 lds
    s_add_u32 m0, s52, 0x6000
    v_add_f32 v32, v32, v34
    v_smfmac_f32_16x16x64_bf16 v[36:39], v[28:31], a[88:95], v116
    ds_read_b128 v[104:107], v117 offset:23552
    v_add_f32 v33, v33, v35
    v_smfmac_f32_16x16x64_bf16 v[40:43], v[12:15], a[112:119], v116
    ds_read_b128 v[108:111], v117 offset:23552
    v_mul_f32 v32, s34, v32
    v_smfmac_f32_16x16x64_bf16 v[40:43], v[24:27], a[144:151], v116
    buffer_load_dword v125, v119, s[8:11], s28 offen sc1
    v_mul_f32 v33, s34, v33
    v_smfmac_f32_16x16x64_bf16 v[40:43], v[28:31], a[176:183], v116
    ds_read_b128 v[0:3], v124
    v_add_f32 v36, v36, v38
    v_smfmac_f32_16x16x64_bf16 v[48:51], v[4:7], a[208:215], v116
    v_add_f32 v37, v37, v39
    v_smfmac_f32_16x16x64_bf16 v[52:55], v[4:7], a[216:223], v116
    s_waitcnt lgkmcnt(5)
    buffer_load_dwordx4 v117, s[8:11], s31 offen lds
    v_mul_f32 v36, s34, v36
    v_smfmac_f32_16x16x64_bf16 v[44:47], v[12:15], a[120:127], v116
    ds_read_b128 v[4:7], v124 offset:1024
    v_mul_f32 v37, s34, v37
    v_smfmac_f32_16x16x64_bf16 v[44:47], v[24:27], a[152:159], v116
    v_cvt_pk_bf16_f32 v34, v32, v36
    v_smfmac_f32_16x16x64_bf16 v[44:47], v[28:31], a[184:191], v116
    buffer_load_dwordx4 v117, s[8:11], s31 offen offset:1024 lds
    s_mov_b32 m0, 5120
    v_cvt_pk_bf16_f32 v35, v33, v37
    v_add_f32 v40, v40, v42
    v_smfmac_f32_16x16x64_bf16 v[48:51], v[8:11], a[224:231], v116
    ds_write2_b32 v120, v34, v35 offset0:32 offset1:48
    v_add_f32 v41, v41, v43
    v_smfmac_f32_16x16x64_bf16 v[52:55], v[8:11], a[232:239], v116
    v_add_f32 v44, v44, v46
    v_add_f32 v45, v45, v47
    v_cvt_pk_bf16_f32 v113, v40, v44
    v_cvt_pk_bf16_f32 v115, v41, v45
    v_smfmac_f32_16x16x64_bf16 v[48:51], v[12:15], a[240:247], v116
    ds_write2_b32 v120, v113, v115 offset0:0 offset1:16
    v_smfmac_f32_16x16x64_bf16 v[52:55], v[12:15], a[248:255], v116
    s_cmp_eq_u32 s22, 63
    s_cbranch_scc1 L_chain_last_f
    v_smfmac_f32_16x16x64_bf16 v[48:51], v[16:19], v[128:135], v116
    v_smfmac_f32_16x16x64_bf16 v[48:51], v[20:23], v[160:167], v116
    v_smfmac_f32_16x16x64_bf16 v[48:51], v[24:27], v[144:151], v116
    s_waitcnt lgkmcnt(0)
    s_barrier
    v_smfmac_f32_16x16x64_bf16 v[48:51], v[28:31], v[176:183], v116
    ds_read_b128 v[32:35], v121 offset:16384
    ds_read_b128 v[36:39], v121 offset:17408
    v_smfmac_f32_16x16x64_bf16 v[52:55], v[16:19], v[136:143], v116
    ds_read_b128 v[40:43], v121 offset:18432
    ds_read_b128 v[44:47], v121 offset:19456
    v_smfmac_f32_16x16x64_bf16 v[52:55], v[20:23], v[168:175], v116
    ds_read_b128 v[8:11], v124 offset:32768
    v_add_f32 v48, v48, v50
    v_smfmac_f32_16x16x64_bf16 v[52:55], v[24:27], v[152:159], v116
    ds_read_b128 v[12:15], v124 offset:33792
    v_add_f32 v49, v49, v51
    v_smfmac_f32_16x16x64_bf16 v[52:55], v[28:31], v[184:191], v116
    s_waitcnt lgkmcnt(5)
    v_cvt_pk_bf16_f32 v112, v48, v49
    v_mfma_f32_16x16x32_bf16 v[56:59], v[56:59], v[32:35], 0
    s_waitcnt lgkmcnt(4)
    v_mov_b32 v48, s50
    v_mov_b32 v49, s50
    v_mfma_f32_16x16x32_bf16 v[56:59], v[60:63], v[36:39], v[56:59]
    ds_read_b128 v[16:19], v124 offset:2048
    s_waitcnt lgkmcnt(4)
    v_mov_b32 v50, s50
    v_mov_b32 v51, s50
    v_mfma_f32_16x16x32_bf16 v[56:59], v[64:67], v[40:43], v[56:59]
    ds_read_b128 v[20:23], v124 offset:3072
    s_waitcnt lgkmcnt(4)
    v_add_f32 v52, v52, v54
    v_mfma_f32_16x16x32_bf16 v[56:59], v[68:71], v[44:47], v[56:59]
    ds_read_b128 v[24:27], v124 offset:4096
    v_add_f32 v53, v53, v55
    v_mfma_f32_16x16x32_bf16 v[60:63], v[72:75], v[32:35], 0
    ds_read_b128 v[28:31], v124 offset:5120
    v_cvt_pk_bf16_f32 v114, v52, v53
    v_mov_b32 v53, 0
    v_mfma_f32_16x16x32_bf16 v[60:63], v[76:79], v[36:39], v[60:63]
    v_exp_f32 v56, v56
    v_mfma_f32_16x16x32_bf16 v[60:63], v[80:83], v[40:43], v[60:63]
    v_exp_f32 v57, v57
    v_mfma_f32_16x16x32_bf16 v[60:63], v[84:87], v[44:47], v[60:63]
    v_exp_f32 v58, v58
    v_mfma_f32_16x16x32_bf16 v[64:67], v[32:35], v[32:35], 0
    v_exp_f32 v59, v59
    v_cvt_pk_bf16_f32 v68, v56, v57
    v_mfma_f32_16x16x32_bf16 v[64:67], v[36:39], v[36:39], v[64:67]
    v_exp_f32 v60, v60
    v_cvt_pk_bf16_f32 v69, v58, v59
    v_mfma_f32_16x16x32_bf16 v[64:67], v[40:43], v[40:43], v[64:67]
    v_exp_f32 v61, v61
    v_mfma_f32_16x16x32_bf16 v[64:67], v[44:47], v[44:47], v[64:67]
    v_exp_f32 v62, v62
    v_exp_f32 v63, v63
    v_cvt_pk_bf16_f32 v70, v60, v61
    v_cvt_pk_bf16_f32 v71, v62, v63
    s_nop 1
    v_mfma_f32_16x16x32_bf16 v[72:75], v[88:91], v[68:71], 0
    s_nop 0
    v_exp_f32 v64, v64
    v_mfma_f32_16x16x32_bf16 v[76:79], v[92:95], v[68:71], 0
    v_exp_f32 v65, v65
    v_mfma_f32_16x16x32_bf16 v[80:83], v[48:51], v[68:71], 0
    v_cvt_pk_bf16_f32 v52, v64, v65
    s_nop 1
    v_mfma_f32_16x16x16_bf16 v[72:75], v[112:113], v[52:53], v[72:75]
    ds_read_b128 v[32:35], v124 offset:6144
    v_mfma_f32_16x16x16_bf16 v[76:79], v[114:115], v[52:53], v[76:79]
    ds_read_b128 v[36:39], v124 offset:7168
    v_mfma_f32_16x16x16_bf16 v[80:83], v[48:49], v[52:53], v[80:83]
L_norm_27:
    s_mov_b64 vcc, s[36:37]
    v_mov_b32 v122, v122
    v_mov_b32 v122, v122
    v_mov_b32 v122, v122
    v_cndmask_b32_dpp v76, v72, v76, vcc quad_perm:[2,3,2,3] row_mask:0xf bank_mask:0xf
    v_cndmask_b32_dpp v77, v73, v77, vcc quad_perm:[2,3,2,3] row_mask:0xf bank_mask:0xf
    v_cndmask_b32_dpp v78, v74, v78, vcc quad_perm:[2,3,2,3] row_mask:0xf bank_mask:0xf
    v_cndmask_b32_dpp v79, v75, v79, vcc quad_perm:[2,3,2,3] row_mask:0xf bank_mask:0xf
    v_rcp_f32_dpp v84, v80 quad_perm:[2,3,2,3] row_mask:0xf bank_mask:0xf
    s_nop 0
    v_pk_mul_f32 v[76:77], v[76:77], v[84:85] op_sel_hi:[1,0]
    v_pk_mul_f32 v[78:79], v[78:79], v[84:85] op_sel_hi:[1,0]
    v_cvt_pk_bf16_f32 v72, v76, v77
    v_cvt_pk_bf16_f32 v73, v78, v79
    ds_write_b64 v122, v[72:73] offset:20992
    v_max_f32_dpp v86, v80, v84 quad_perm:[2,3,2,3] row_mask:0xf bank_mask:0xf
    v_mov_b32_dpp v60, v72 quad_perm:[0,1,0,1] row_mask:0xf bank_mask:0xf
    v_mov_b32_dpp v61, v73 quad_perm:[0,1,0,1] row_mask:0xf bank_mask:0xf
    v_cmp_lt_f32 vcc, s35, v86
    v_mov_b32_dpp v62, v72 quad_perm:[2,3,2,3] row_mask:0xf bank_mask:0xf
    v_mov_b32_dpp v63, v73 quad_perm:[2,3,2,3] row_mask:0xf bank_mask:0xf
    s_nop 1
    v_smfmac_f32_16x16x64_bf16 v[96:99], v[60:63], v[192:199], v116
    s_cbranch_vccnz L_smax_28
    v_smfmac_f32_16x16x64_bf16 v[100:103], v[60:63], v[224:231], v116
    s_waitcnt lgkmcnt(0)
    s_barrier
    ds_read_b128 v[92:95], v127 offset:20480
    ds_read_b128 v[80:83], v127 offset:22016
    ds_read_b128 v[84:87], v127 offset:21504
    v_smfmac_f32_16x16x64_bf16 v[104:107], v[60:63], v[0:7], v116
    ds_read_b128 v[40:43], v124 offset:34816
    v_smfmac_f32_16x16x64_bf16 v[108:111], v[60:63], v[8:15], v116
    ds_read_b128 v[56:59], v124 offset:36864
    s_waitcnt lgkmcnt(4)
    v_smfmac_f32_16x16x64_bf16 v[96:99], v[92:95], v[200:207], v116
    s_waitcnt lgkmcnt(3)
    v_smfmac_f32_16x16x64_bf16 v[96:99], v[80:83], v[208:215], v116
    ds_read_b128 v[44:47], v124 offset:35840
    s_waitcnt lgkmcnt(3)
    v_smfmac_f32_16x16x64_bf16 v[96:99], v[84:87], v[216:223], v116
    ds_read_b128 v[68:71], v124 offset:39936
    v_smfmac_f32_16x16x64_bf16 v[100:103], v[92:95], v[232:239], v116
    ds_read_b128 v[64:67], v124 offset:38912
    v_smfmac_f32_16x16x64_bf16 v[100:103], v[80:83], v[240:247], v116
    ds_read_b128 v[60:63], v124 offset:37888
    v_cvt_pk_bf16_f32 v72, v96, v98
    v_smfmac_f32_16x16x64_bf16 v[100:103], v[84:87], v[248:255], v116
    v_and_or_b32 v72, v72, -2, s33
    v_smfmac_f32_16x16x64_bf16 v[104:107], v[92:95], v[16:23], v116
    v_cvt_pk_bf16_f32 v74, v97, v99
    v_smfmac_f32_16x16x64_bf16 v[104:107], v[80:83], v[24:31], v116
    v_cvt_pk_bf16_f32 v73, v100, v102
    v_cvt_pk_bf16_f32 v75, v101, v103
    v_smfmac_f32_16x16x64_bf16 v[104:107], v[84:87], v[32:39], v116
    buffer_store_dwordx4 v[72:75], v118, s[8:11], s25 offen
    s_waitcnt lgkmcnt(3)
    v_smfmac_f32_16x16x64_bf16 v[108:111], v[92:95], v[40:47], v116
    s_waitcnt lgkmcnt(0)
    v_smfmac_f32_16x16x64_bf16 v[108:111], v[80:83], v[56:63], v116
    v_cvt_pk_bf16_f32 v76, v104, v106
    v_smfmac_f32_16x16x64_bf16 v[108:111], v[84:87], v[64:71], v116
    v_and_or_b32 v76, v76, -2, s33
    v_cvt_pk_bf16_f32 v78, v105, v107
    v_mov_b32 v122, v122
    v_mov_b32 v122, v122
    v_mov_b32 v122, v122
    v_mov_b32 v122, v122
    v_mov_b32 v122, v122
    v_mov_b32 v122, v122
    v_cvt_pk_bf16_f32 v77, v108, v110
    v_cvt_pk_bf16_f32 v79, v109, v111
    buffer_store_dwordx4 v[76:79], v118, s[8:11], s26 offen
    s_add_u32 s30, s30, 0x40000
    s_add_u32 s31, s31, 0x40000
    s_add_u32 s32, s32, 0x20000
    s_add_u32 s23, s24, 1024
    s_add_u32 s48, s23, 4096
    s_xor_b32 s25, s25, 0x40000
    s_xor_b32 s26, s26, 0x40000
    s_mov_b32 s35, 0x49800000
    s_add_u32 s22, s22, 1
    v_mov_b32 v32, 0
    v_mov_b32 v33, 0
    v_mov_b32 v34, 0
    v_mov_b32 v35, 0
    v_mov_b32 v36, 0
    v_mov_b32 v37, 0
    v_mov_b32 v38, 0
    v_mov_b32 v39, 0
    v_mov_b32 v40, 0
    v_mov_b32 v41, 0
    v_mov_b32 v42, 0
    v_mov_b32 v43, 0
    v_mov_b32 v44, 0
    v_mov_b32 v45, 0
    v_mov_b32 v46, 0
    v_mov_b32 v47, 0
    v_mov_b32 v48, 0
    v_mov_b32 v49, 0
    v_mov_b32 v50, 0
    v_mov_b32 v51, 0
    v_mov_b32 v52, 0
    v_mov_b32 v53, 0
    v_mov_b32 v54, 0
    v_mov_b32 v55, 0
    ds_read_b128 v[80:83], v123
    ds_read_b128 v[84:87], v123 offset:1024
    ds_read_b128 v[56:59], v123 offset:2048
    ds_read_b128 v[60:63], v123 offset:3072
    ds_read_b128 v[64:67], v123 offset:32768
    ds_read_b128 v[68:71], v123 offset:33792
    ds_read_b128 v[72:75], v123 offset:34816
    ds_read_b128 v[76:79], v123 offset:35840
    ds_read_b128 v[88:91], v123 offset:4096
    ds_read_b128 v[92:95], v123 offset:5120
    ds_read_b128 v[96:99], v123 offset:6144
    ds_read_b128 v[100:103], v123 offset:7168
    ds_read_b128 v[104:107], v123 offset:36864
    ds_read_b128 v[108:111], v123 offset:37888
    ds_read_b128 v[24:27], v123 offset:38912
    ds_read_b128 v[28:31], v123 offset:39936
    s_add_u32 s24, s24, 8192
    s_bitset0_b32 s24, 15
    s_xor_b32 s55, s24, 16384
    s_xor_b32 s29, s29, 0x40000
    s_xor_b32 s53, s29, 1024
    s_bfe_u32 s33, s22, 0x10001
    s_add_u32 s40, s22, 5
    s_lshr_b32 s40, s40, 2
    s_min_u32 s40, s40, 16
    s_bfm_b32 s58, s40, 0
    s_waitcnt vmcnt(4)
    v_cmp_eq_u32 vcc, 0, v125
    s_nop 0
    s_and_b64 vcc, vcc, s[58:59]
    s_cbranch_scc1 L_kvw_29
L_kvb_30:
    v_mov_b32 v15, 0
    s_nop 2
    v_mov_b32 v15, 0
    s_nop 2
    v_mov_b32 v15, 0
    s_nop 2
    v_mov_b32 v15, 0
    s_nop 2
    v_mov_b32 v15, 0
    s_nop 2
    v_mov_b32 v15, 0
    s_nop 2
    v_mov_b32 v15, 0
    s_nop 2
    v_mov_b32 v15, 0
    s_nop 2
    v_mov_b32 v15, 0
    s_nop 2
    v_mov_b32 v15, 0
    s_nop 2
    v_mov_b32 v15, 0
    s_nop 2
    v_mov_b32 v15, 0
    s_nop 2
    v_mov_b32 v15, 0
    s_nop 2
    v_mov_b32 v15, 0
    s_nop 2
    v_mov_b32 v15, 0
    s_nop 2
    v_mov_b32 v15, 0
    s_nop 2
    v_mov_b32 v15, 0
    s_nop 2
    v_mov_b32 v15, 0
    s_nop 2
    v_mov_b32 v15, 0
    s_nop 2
    v_mov_b32 v15, 0
    s_nop 2
    v_mov_b32 v15, 0
    s_nop 2
    v_mov_b32 v15, 0
    s_nop 2
    v_mov_b32 v15, 0
    s_nop 2
    v_mov_b32 v15, 0
    s_nop 2
    v_mov_b32 v15, 0
    s_nop 2
    v_mov_b32 v15, 0
    s_nop 2
    v_mov_b32 v15, 0
    s_nop 2
    v_mov_b32 v15, 0
    s_nop 2
    v_mov_b32 v15, 0
    s_nop 2
    v_mov_b32 v15, 0
    s_nop 2
    v_mov_b32 v15, 0
    s_nop 2
    s_waitcnt lgkmcnt(0)
    s_branch L_chain_top1_f
.p2align 6
L_chain_top2_f:
    buffer_load_dwordx4 v[0:3], v117, s[8:11], s23 offen nt
    v_mov_b32 v48, 0
    v_mov_b32 v49, 0
    v_mov_b32 v50, 0
    v_mov_b32 v51, 0
    v_mov_b32 v52, 0
    v_mov_b32 v53, 0
    v_mov_b32 v15, 0
    v_mov_b32 v15, 0
    v_mov_b32 v15, 0
    v_mov_b32 v15, 0
    v_mov_b32 v15, 0
    v_mov_b32 v15, 0
    v_mov_b32 v15, 0
    v_mov_b32 v15, 0
    v_mov_b32 v15, 0
    v_mov_b32 v15, 0
    buffer_load_dwordx4 v[0:3], v117, s[8:11], s23 offen sc1
    s_waitcnt vmcnt(3)
    v_mov_b32 v36, 0
    v_mov_b32 v37, 0
    v_mov_b32 v38, 0
    v_mov_b32 v39, 0
    v_mov_b32 v40, 0
    v_mov_b32 v41, 0
    v_mov_b32 v42, 0
    v_mov_b32 v43, 0
    v_mov_b32 v44, 0
    v_mov_b32 v45, 0
    v_mov_b32 v46, 0
    v_mov_b32 v47, 0
    v_mov_b32 v15, 0
    v_mov_b32 v15, 0
    v_mov_b32 v15, 0
    v_mov_b32 v15, 0
L_mret_31:
    buffer_load_dwordx4 v[0:3], v117, s[8:11], s23 offen sc1
    s_add_u32 s45, s45, 1
    s_cmp_lt_u32 s45, 0x10000
    s_cselect_b32 s56, -2, -1
    s_nop 3
    v_mov_b32 v32, 0
    v_mov_b32 v33, 0
    v_mov_b32 v34, 0
    v_mov_b32 v35, 0
    s_waitcnt vmcnt(2)
    v_max3_u32 v15, v0, v1, v2
    v_max_u32 v15, v15, v3
    v_cmp_lt_u32 vcc, s56, v15
    v_smfmac_f32_16x16x64_bf16 v[32:35], v[0:3], v[80:87], v116
    s_cbranch_vccnz L_mret_31
    ds_write_b128 v117, v[0:3] offset:2048
    v_smfmac_f32_16x16x64_bf16 v[36:39], v[0:3], v[56:63], v116
    buffer_load_dwordx4 v[4:7], v117, s[8:11], s48 offen nt
    v_smfmac_f32_16x16x64_bf16 v[40:43], v[0:3], v[64:71], v116
    buffer_load_dwordx4 v117, s[8:11], s48 offen nt lds
    s_mov_b32 m0, 12288
    v_smfmac_f32_16x16x64_bf16 v[44:47], v[0:3], v[72:79], v116
    s_waitcnt lgkmcnt(0)
    s_barrier
    ds_read_b128 v[8:11], v117 offset:3072
    v_smfmac_f32_16x16x64_bf16 v[48:51], v[0:3], a[192:199], v116
    ds_read_b128 v[16:19], v117
    ds_read_b128 v[20:23], v117 offset:1024
    v_smfmac_f32_16x16x64_bf16 v[52:55], v[0:3], a[200:207], v116
    ds_read_b128 v[80:83], v117 offset:14336
    s_waitcnt lgkmcnt(3)
    v_smfmac_f32_16x16x64_bf16 v[32:35], v[8:11], a[0:7], v116
    ds_read_b128 v[84:87], v117 offset:15360
    v_smfmac_f32_16x16x64_bf16 v[36:39], v[8:11], a[8:15], v116
    ds_read_b128 v[56:59], v117 offset:8192
    s_waitcnt lgkmcnt(4)
    v_smfmac_f32_16x16x64_bf16 v[32:35], v[16:19], a[32:39], v116
    ds_read_b128 v[60:63], v117 offset:9216
    v_smfmac_f32_16x16x64_bf16 v[36:39], v[16:19], a[40:47], v116
    ds_read_b128 v[64:67], v117 offset:10240
    s_waitcnt lgkmcnt(5)
    v_smfmac_f32_16x16x64_bf16 v[32:35], v[20:23], a[64:71], v116
    ds_read_b128 v[68:71], v117 offset:11264
    v_smfmac_f32_16x16x64_bf16 v[36:39], v[20:23], a[72:79], v116
    buffer_store_dwordx4 v[112:115], v117, s[8:11], s32 offen sc1
    v_smfmac_f32_16x16x64_bf16 v[40:43], v[8:11], a[96:103], v116
    ds_read_b128 v[72:75], v117 offset:12288
    v_smfmac_f32_16x16x64_bf16 v[40:43], v[16:19], a[128:135], v116
    ds_read_b128 v[76:79], v117 offset:13312
    v_smfmac_f32_16x16x64_bf16 v[40:43], v[20:23], a[160:167], v116
    s_waitcnt vmcnt(2)
    v_max3_u32 v15, v4, v5, v6
    v_smfmac_f32_16x16x64_bf16 v[44:47], v[8:11], a[104:111], v116
    v_max_u32 v15, v15, v7
    v_smfmac_f32_16x16x64_bf16 v[44:47], v[16:19], a[136:143], v116
    s_waitcnt vmcnt(1) lgkmcnt(0)
    v_cmp_lt_u32 vcc, s56, v15
    v_smfmac_f32_16x16x64_bf16 v[44:47], v[20:23], a[168:175], v116
    s_cbranch_vccnz L_mret_32
L_mgo_33:
    v_smfmac_f32_16x16x64_bf16 v[44:47], v[4:7], v[24:31], v116
    s_barrier
    ds_read_b128 v[12:15], v117 offset:7168
    v_smfmac_f32_16x16x64_bf16 v[32:35], v[4:7], v[88:95], v116
    ds_read_b128 v[24:27], v117 offset:4096
    v_smfmac_f32_16x16x64_bf16 v[36:39], v[4:7], v[96:103], v116
    ds_read_b128 v[28:31], v117 offset:5120
    v_smfmac_f32_16x16x64_bf16 v[40:43], v[4:7], v[104:111], v116
    ds_read_b128 v[88:91], v117 offset:28672
    s_waitcnt lgkmcnt(3)
    v_smfmac_f32_16x16x64_bf16 v[32:35], v[12:15], a[16:23], v116
    ds_read_b128 v[92:95], v117 offset:29696
    s_waitcnt lgkmcnt(3)
    v_smfmac_f32_16x16x64_bf16 v[32:35], v[24:27], a[48:55], v116
    buffer_load_dwordx4 v117, s[8:11], s30 offen lds
    s_waitcnt lgkmcnt(2)
    v_smfmac_f32_16x16x64_bf16 v[32:35], v[28:31], a[80:87], v116
    ds_read_b128 v[96:99], v117 offset:23552
    v_smfmac_f32_16x16x64_bf16 v[36:39], v[12:15], a[24:31], v116
    ds_read_b128 v[100:103], v117 offset:23552
    v_smfmac_f32_16x16x64_bf16 v[36:39], v[24:27], a[56:63], v116
    buffer_load_dwordx4 v117, s[8:11], s30 offen offset:1024 lds
    s_add_u32 m0, s52, 0x6000
    v_add_f32 v32, v32, v34
    v_smfmac_f32_16x16x64_bf16 v[36:39], v[28:31], a[88:95], v116
    ds_read_b128 v[104:107], v117 offset:23552
    v_add_f32 v33, v33, v35
    v_smfmac_f32_16x16x64_bf16 v[40:43], v[12:15], a[112:119], v116
    ds_read_b128 v[108:111], v117 offset:23552
    v_mul_f32 v32, s34, v32
    v_smfmac_f32_16x16x64_bf16 v[40:43], v[24:27], a[144:151], v116
    s_waitcnt lgkmcnt(4)
    buffer_load_dwordx4 v117, s[8:11], s31 offen lds
    v_mul_f32 v33, s34, v33
    v_smfmac_f32_16x16x64_bf16 v[40:43], v[28:31], a[176:183], v116
    ds_read_b128 v[0:3], v124
    v_add_f32 v36, v36, v38
    v_smfmac_f32_16x16x64_bf16 v[48:51], v[4:7], a[208:215], v116
    v_add_f32 v37, v37, v39
    v_smfmac_f32_16x16x64_bf16 v[52:55], v[4:7], a[216:223], v116
    buffer_load_dwordx4 v117, s[8:11], s31 offen offset:1024 lds
    s_mov_b32 m0, 6144
    v_mul_f32 v36, s34, v36
    v_smfmac_f32_16x16x64_bf16 v[44:47], v[12:15], a[120:127], v116
    ds_read_b128 v[4:7], v124 offset:1024
    v_mul_f32 v37, s34, v37
    v_smfmac_f32_16x16x64_bf16 v[44:47], v[24:27], a[152:159], v116
    v_cvt_pk_bf16_f32 v34, v32, v36
    v_smfmac_f32_16x16x64_bf16 v[44:47], v[28:31], a[184:191], v116
    v_cvt_pk_bf16_f32 v35, v33, v37
    v_add_f32 v40, v40, v42
    v_smfmac_f32_16x16x64_bf16 v[48:51], v[8:11], a[224:231], v116
    ds_write2_b32 v120, v34, v35 offset0:32 offset1:48
    v_add_f32 v41, v41, v43
    v_smfmac_f32_16x16x64_bf16 v[52:55], v[8:11], a[232:239], v116
    v_add_f32 v44, v44, v46
    v_add_f32 v45, v45, v47
    v_cvt_pk_bf16_f32 v113, v40, v44
    v_cvt_pk_bf16_f32 v115, v41, v45
    v_smfmac_f32_16x16x64_bf16 v[48:51], v[12:15], a[240:247], v116
    ds_write2_b32 v120, v113, v115 offset0:0 offset1:16
    v_smfmac_f32_16x16x64_bf16 v[52:55], v[12:15], a[248:255], v116
    s_cmp_eq_u32 s22, 63
    s_cbranch_scc1 L_chain_last_f
    v_smfmac_f32_16x16x64_bf16 v[48:51], v[16:19], v[128:135], v116
    buffer_store_dword v126, v119, s[8:11], s55 offen
    v_smfmac_f32_16x16x64_bf16 v[48:51], v[20:23], v[160:167], v116
    v_smfmac_f32_16x16x64_bf16 v[48:51], v[24:27], v[144:151], v116
    s_waitcnt lgkmcnt(0)
    s_barrier
    v_smfmac_f32_16x16x64_bf16 v[48:51], v[28:31], v[176:183], v116
    ds_read_b128 v[32:35], v121 offset:16384
    ds_read_b128 v[36:39], v121 offset:17408
    v_smfmac_f32_16x16x64_bf16 v[52:55], v[16:19], v[136:143], v116
    ds_read_b128 v[40:43], v121 offset:18432
    ds_read_b128 v[44:47], v121 offset:19456
    v_smfmac_f32_16x16x64_bf16 v[52:55], v[20:23], v[168:175], v116
    ds_read_b128 v[8:11], v124 offset:32768
    v_add_f32 v48, v48, v50
    v_smfmac_f32_16x16x64_bf16 v[52:55], v[24:27], v[152:159], v116
    ds_read_b128 v[12:15], v124 offset:33792
    v_add_f32 v49, v49, v51
    v_smfmac_f32_16x16x64_bf16 v[52:55], v[28:31], v[184:191], v116
    s_waitcnt lgkmcnt(5)
    v_cvt_pk_bf16_f32 v112, v48, v49
    v_mfma_f32_16x16x32_bf16 v[56:59], v[56:59], v[32:35], 0
    s_waitcnt lgkmcnt(4)
    v_mov_b32 v48, s50
    v_mov_b32 v49, s50
    v_mfma_f32_16x16x32_bf16 v[56:59], v[60:63], v[36:39], v[56:59]
    ds_read_b128 v[16:19], v124 offset:2048
    s_waitcnt lgkmcnt(4)
    v_mov_b32 v50, s50
    v_mov_b32 v51, s50
    v_mfma_f32_16x16x32_bf16 v[56:59], v[64:67], v[40:43], v[56:59]
    ds_read_b128 v[20:23], v124 offset:3072
    s_waitcnt lgkmcnt(4)
    v_add_f32 v52, v52, v54
    v_mfma_f32_16x16x32_bf16 v[56:59], v[68:71], v[44:47], v[56:59]
    ds_read_b128 v[24:27], v124 offset:4096
    v_add_f32 v53, v53, v55
    v_mfma_f32_16x16x32_bf16 v[60:63], v[72:75], v[32:35], 0
    ds_read_b128 v[28:31], v124 offset:5120
    v_cvt_pk_bf16_f32 v114, v52, v53
    v_mov_b32 v53, 0
    v_mfma_f32_16x16x32_bf16 v[60:63], v[76:79], v[36:39], v[60:63]
    v_exp_f32 v56, v56
    v_mfma_f32_16x16x32_bf16 v[60:63], v[80:83], v[40:43], v[60:63]
    v_exp_f32 v57, v57
    v_mfma_f32_16x16x32_bf16 v[60:63], v[84:87], v[44:47], v[60:63]
    v_exp_f32 v58, v58
    v_mfma_f32_16x16x32_bf16 v[64:67], v[32:35], v[32:35], 0
    v_exp_f32 v59, v59
    v_cvt_pk_bf16_f32 v68, v56, v57
    v_mfma_f32_16x16x32_bf16 v[64:67], v[36:39], v[36:39], v[64:67]
    v_exp_f32 v60, v60
    v_cvt_pk_bf16_f32 v69, v58, v59
    v_mfma_f32_16x16x32_bf16 v[64:67], v[40:43], v[40:43], v[64:67]
    v_exp_f32 v61, v61
    v_mfma_f32_16x16x32_bf16 v[64:67], v[44:47], v[44:47], v[64:67]
    v_exp_f32 v62, v62
    v_exp_f32 v63, v63
    v_cvt_pk_bf16_f32 v70, v60, v61
    v_cvt_pk_bf16_f32 v71, v62, v63
    s_nop 1
    v_mfma_f32_16x16x32_bf16 v[72:75], v[88:91], v[68:71], 0
    s_nop 0
    v_exp_f32 v64, v64
    v_mfma_f32_16x16x32_bf16 v[76:79], v[92:95], v[68:71], 0
    v_exp_f32 v65, v65
    v_mfma_f32_16x16x32_bf16 v[80:83], v[48:51], v[68:71], 0
    v_cvt_pk_bf16_f32 v52, v64, v65
    s_nop 1
    v_mfma_f32_16x16x16_bf16 v[72:75], v[112:113], v[52:53], v[72:75]
    ds_read_b128 v[32:35], v124 offset:6144
    v_mfma_f32_16x16x16_bf16 v[76:79], v[114:115], v[52:53], v[76:79]
    ds_read_b128 v[36:39], v124 offset:7168
    v_mfma_f32_16x16x16_bf16 v[80:83], v[48:49], v[52:53], v[80:83]
L_norm_34:
    s_mov_b64 vcc, s[36:37]
    v_mov_b32 v122, v122
    v_mov_b32 v122, v122
    v_mov_b32 v122, v122
    v_cndmask_b32_dpp v76, v72, v76, vcc quad_perm:[2,3,2,3] row_mask:0xf bank_mask:0xf
    v_cndmask_b32_dpp v77, v73, v77, vcc quad_perm:[2,3,2,3] row_mask:0xf bank_mask:0xf
    v_cndmask_b32_dpp v78, v74, v78, vcc quad_perm:[2,3,2,3] row_mask:0xf bank_mask:0xf
    v_cndmask_b32_dpp v79, v75, v79, vcc quad_perm:[2,3,2,3] row_mask:0xf bank_mask:0xf
    v_rcp_f32_dpp v84, v80 quad_perm:[2,3,2,3] row_mask:0xf bank_mask:0xf
    s_nop 0
    v_pk_mul_f32 v[76:77], v[76:77], v[84:85] op_sel_hi:[1,0]
    v_pk_mul_f32 v[78:79], v[78:79], v[84:85] op_sel_hi:[1,0]
    v_cvt_pk_bf16_f32 v72, v76, v77
    v_cvt_pk_bf16_f32 v73, v78, v79
    ds_write_b64 v122, v[72:73] offset:21504
    v_max_f32_dpp v86, v80, v84 quad_perm:[2,3,2,3] row_mask:0xf bank_mask:0xf
    v_mov_b32_dpp v60, v72 quad_perm:[0,1,0,1] row_mask:0xf bank_mask:0xf
    v_mov_b32_dpp v61, v73 quad_perm:[0,1,0,1] row_mask:0xf bank_mask:0xf
    v_cmp_lt_f32 vcc, s35, v86
    v_mov_b32_dpp v62, v72 quad_perm:[2,3,2,3] row_mask:0xf bank_mask:0xf
    v_mov_b32_dpp v63, v73 quad_perm:[2,3,2,3] row_mask:0xf bank_mask:0xf
    s_nop 1
    v_smfmac_f32_16x16x64_bf16 v[96:99], v[60:63], v[192:199], v116
    s_cbranch_vccnz L_smax_35
    v_smfmac_f32_16x16x64_bf16 v[100:103], v[60:63], v[224:231], v116
    s_waitcnt lgkmcnt(0)
    s_barrier
    ds_read_b128 v[92:95], v127 offset:22016
    ds_read_b128 v[80:83], v127 offset:20480
    ds_read_b128 v[84:87], v127 offset:20992
    v_smfmac_f32_16x16x64_bf16 v[104:107], v[60:63], v[0:7], v116
    ds_read_b128 v[40:43], v124 offset:34816
    v_smfmac_f32_16x16x64_bf16 v[108:111], v[60:63], v[8:15], v116
    ds_read_b128 v[56:59], v124 offset:36864
    s_waitcnt lgkmcnt(4)
    v_smfmac_f32_16x16x64_bf16 v[96:99], v[92:95], v[200:207], v116
    s_waitcnt lgkmcnt(3)
    v_smfmac_f32_16x16x64_bf16 v[96:99], v[80:83], v[208:215], v116
    ds_read_b128 v[44:47], v124 offset:35840
    s_waitcnt lgkmcnt(3)
    v_smfmac_f32_16x16x64_bf16 v[96:99], v[84:87], v[216:223], v116
    ds_read_b128 v[68:71], v124 offset:39936
    v_smfmac_f32_16x16x64_bf16 v[100:103], v[92:95], v[232:239], v116
    ds_read_b128 v[64:67], v124 offset:38912
    v_smfmac_f32_16x16x64_bf16 v[100:103], v[80:83], v[240:247], v116
    ds_read_b128 v[60:63], v124 offset:37888
    v_cvt_pk_bf16_f32 v72, v96, v98
    v_smfmac_f32_16x16x64_bf16 v[100:103], v[84:87], v[248:255], v116
    v_and_or_b32 v72, v72, -2, s33
    v_smfmac_f32_16x16x64_bf16 v[104:107], v[92:95], v[16:23], v116
    v_cvt_pk_bf16_f32 v74, v97, v99
    v_smfmac_f32_16x16x64_bf16 v[104:107], v[80:83], v[24:31], v116
    v_cvt_pk_bf16_f32 v73, v100, v102
    v_cvt_pk_bf16_f32 v75, v101, v103
    v_smfmac_f32_16x16x64_bf16 v[104:107], v[84:87], v[32:39], v116
    buffer_store_dwordx4 v[72:75], v118, s[8:11], s25 offen
    s_waitcnt lgkmcnt(3)
    v_smfmac_f32_16x16x64_bf16 v[108:111], v[92:95], v[40:47], v116
    s_waitcnt lgkmcnt(0)
    v_smfmac_f32_16x16x64_bf16 v[108:111], v[80:83], v[56:63], v116
    v_cvt_pk_bf16_f32 v76, v104, v106
    v_smfmac_f32_16x16x64_bf16 v[108:111], v[84:87], v[64:71], v116
    v_and_or_b32 v76, v76, -2, s33
    v_cvt_pk_bf16_f32 v78, v105, v107
    v_mov_b32 v122, v122
    v_mov_b32 v122, v122
    v_mov_b32 v122, v122
    v_mov_b32 v122, v122
    v_mov_b32 v122, v122
    v_mov_b32 v122, v122
    v_cvt_pk_bf16_f32 v77, v108, v110
    v_cvt_pk_bf16_f32 v79, v109, v111
    buffer_store_dwordx4 v[76:79], v118, s[8:11], s26 offen
    ds_read_b128 v[80:83], v123
    ds_read_b128 v[84:87], v123 offset:1024
    ds_read_b128 v[56:59], v123 offset:2048
    ds_read_b128 v[60:63], v123 offset:3072
    ds_read_b128 v[64:67], v123 offset:32768
    ds_read_b128 v[68:71], v123 offset:33792
    ds_read_b128 v[72:75], v123 offset:34816
    ds_read_b128 v[76:79], v123 offset:35840
    ds_read_b128 v[88:91], v123 offset:4096
    ds_read_b128 v[92:95], v123 offset:5120
    ds_read_b128 v[96:99], v123 offset:6144
    ds_read_b128 v[100:103], v123 offset:7168
    ds_read_b128 v[104:107], v123 offset:36864
    ds_read_b128 v[108:111], v123 offset:37888
    ds_read_b128 v[24:27], v123 offset:38912
    ds_read_b128 v[28:31], v123 offset:39936
    s_add_u32 s30, s30, 0x40000
    s_add_u32 s31, s31, 0x40000
    s_add_u32 s32, s32, 0x20000
    s_add_u32 s23, s24, 2048
    s_add_u32 s48, s23, 4096
    s_xor_b32 s25, s25, 0x40000
    s_xor_b32 s26, s26, 0x40000
    s_mov_b32 s35, 0x49800000
    s_add_u32 s22, s22, 1
    v_cndmask_b32 v12, 0, v125, s[68:69]
    v_cndmask_b32 v13, 0, v125, s[70:71]
    v_cndmask_b32 v14, 0, v125, s[72:73]
    v_cndmask_b32 v15, 0, v125, s[74:75]
    v_mov_b32 v54, 0
    v_mov_b32 v55, 0
    v_mov_b32 v52, 0
    v_mov_b32 v52, 0
    v_mov_b32 v52, 0
    v_mov_b32 v52, 0
    v_mov_b32 v52, 0
    v_mov_b32 v52, 0
    v_mov_b32 v52, 0
    v_mov_b32 v52, 0
    v_mov_b32 v52, 0
    v_mov_b32 v52, 0
    v_mov_b32 v52, 0
    v_mov_b32 v52, 0
    v_mov_b32 v52, 0
    v_mov_b32 v52, 0
    v_mov_b32 v52, 0
    v_mov_b32 v52, 0
    v_mov_b32 v52, 0
    v_mov_b32 v52, 0
    v_mov_b32 v52, 0
    buffer_load_dwordx4 v[4:7], v117, s[8:11], s29 offen nt
    buffer_load_dwordx4 v[8:11], v117, s[8:11], s53 offen nt
    buffer_load_dwordx4 v[16:19], v117, s[8:11], s29 offen offset:2048 nt
    buffer_load_dwordx4 v[20:23], v117, s[8:11], s53 offen offset:2048 nt
    v_mov_b32 v52, 0
    v_mov_b32 v52, 0
    v_mov_b32 v52, 0
    v_mov_b32 v52, 0
    v_mov_b32 v52, 0
    v_mov_b32 v52, 0
    v_mov_b32 v52, 0
    v_mov_b32 v52, 0
    v_mov_b32 v52, 0
    v_mov_b32 v52, 0
    v_mov_b32 v52, 0
    v_mov_b32 v52, 0
    v_mov_b32 v52, 0
    v_mov_b32 v52, 0
    v_mov_b32 v52, 0
    v_mov_b32 v52, 0
    v_mov_b32 v52, 0
    v_mov_b32 v52, 0
    v_mov_b32 v52, 0
    v_mov_b32 v52, 0
    v_mov_b32 v52, 0
    v_mov_b32 v52, 0
    v_mov_b32 v52, 0
    v_mov_b32 v52, 0
    v_mov_b32 v52, 0
    v_mov_b32 v52, 0
    v_mov_b32 v52, 0
    v_mov_b32 v52, 0
    v_mov_b32 v52, 0
    v_mov_b32 v52, 0
    v_mov_b32 v52, 0
    v_mov_b32 v52, 0
    v_mov_b32 v52, 0
    v_mov_b32 v52, 0
    v_mov_b32 v52, 0
    v_mov_b32 v52, 0
    v_mov_b32 v52, 0
    v_mov_b32 v52, 0
    v_mov_b32 v52, 0
    v_mov_b32 v52, 0
    buffer_load_dwordx4 v[32:35], v117, s[8:11], s29 offen sc1
    buffer_load_dwordx4 v[36:39], v117, s[8:11], s53 offen sc1
    buffer_load_dwordx4 v[40:43], v117, s[8:11], s29 offen offset:2048 sc1
    buffer_load_dwordx4 v[44:47], v117, s[8:11], s53 offen offset:2048 sc1
    v_mov_b32 v52, 0
L_rl_36:
    s_waitcnt vmcnt(7)
    v_mfma_f32_16x16x32_bf16 v[48:51], v[4:7], v[12:15], 0
    v_xor_b32 v52, s33, v4
    s_waitcnt vmcnt(6)
    v_mfma_f32_16x16x32_bf16 v[48:51], v[8:11], v[12:15], v[48:51]
    v_xor_b32 v53, s33, v8
    v_or_b32 v52, v52, v53
    s_waitcnt vmcnt(5)
    v_mfma_f32_16x16x32_bf16 v[48:51], v[16:19], v[12:15], v[48:51]
    v_xor_b32 v53, s33, v16
    v_or_b32 v52, v52, v53
    s_waitcnt vmcnt(4)
    v_mfma_f32_16x16x32_bf16 v[48:51], v[20:23], v[12:15], v[48:51]
    v_xor_b32 v53, s33, v20
    v_or_b32 v52, v52, v53
    v_and_b32 v52, 1, v52
    v_cmp_ne_u32 vcc, 0, v52
    s_cbranch_vccnz L_rslow_37
L_rgo_38:
    s_nop 2
    v_permlane32_swap_b32 v48, v50
    v_permlane32_swap_b32 v49, v51
    v_pk_add_f32 v[48:49], v[48:49], v[50:51]
    s_mov_b64 exec, s[38:39]
    v_cvt_pk_bf16_f32 v12, v48, v49
    v_min_u32 v12, 0xfffffffe, v12
    buffer_store_dword v12, v119, s[8:11], s24 offen
    s_mov_b64 exec, -1
    s_add_u32 s24, s24, 8192
    s_bitset0_b32 s24, 15
    s_xor_b32 s55, s24, 16384
    s_xor_b32 s29, s29, 0x40000
    s_xor_b32 s53, s29, 1024
    s_bfe_u32 s33, s22, 0x10001
    s_waitcnt lgkmcnt(0)
    s_branch L_chain_top2_f
.p2align 6
L_chain_top3_f:
    buffer_load_dwordx4 v[0:3], v117, s[8:11], s23 offen nt
    v_mov_b32 v48, 0
    v_mov_b32 v49, 0
    v_mov_b32 v50, 0
    v_mov_b32 v51, 0
    v_mov_b32 v52, 0
    v_mov_b32 v53, 0
    v_mov_b32 v15, 0
    v_mov_b32 v15, 0
    v_mov_b32 v15, 0
    v_mov_b32 v15, 0
    v_mov_b32 v15, 0
    v_mov_b32 v15, 0
    v_mov_b32 v15, 0
    v_mov_b32 v15, 0
    v_mov_b32 v15, 0
    v_mov_b32 v15, 0
    buffer_load_dwordx4 v[0:3], v117, s[8:11], s23 offen sc1
    s_waitcnt vmcnt(3)
    v_mov_b32 v36, 0
    v_mov_b32 v37, 0
    v_mov_b32 v38, 0
    v_mov_b32 v39, 0
    v_mov_b32 v40, 0
    v_mov_b32 v41, 0
    v_mov_b32 v42, 0
    v_mov_b32 v43, 0
    v_mov_b32 v44, 0
    v_mov_b32 v45, 0
    v_mov_b32 v46, 0
    v_mov_b32 v47, 0
    v_mov_b32 v15, 0
    v_mov_b32 v15, 0
    v_mov_b32 v15, 0
    v_mov_b32 v15, 0
L_mret_39:
    buffer_load_dwordx4 v[0:3], v117, s[8:11], s23 offen sc1
    s_add_u32 s45, s45, 1
    s_cmp_lt_u32 s45, 0x10000
    s_cselect_b32 s56, -2, -1
    s_nop 3
    v_mov_b32 v32, 0
    v_mov_b32 v33, 0
    v_mov_b32 v34, 0
    v_mov_b32 v35, 0
    s_waitcnt vmcnt(2)
    v_max3_u32 v15, v0, v1, v2
    v_max_u32 v15, v15, v3
    v_cmp_lt_u32 vcc, s56, v15
    v_smfmac_f32_16x16x64_bf16 v[32:35], v[0:3], v[80:87], v116
    s_cbranch_vccnz L_mret_39
    ds_write_b128 v117, v[0:3] offset:3072
    v_smfmac_f32_16x16x64_bf16 v[36:39], v[0:3], v[56:63], v116
    buffer_load_dwordx4 v[4:7], v117, s[8:11], s48 offen nt
    v_smfmac_f32_16x16x64_bf16 v[40:43], v[0:3], v[64:71], v116
    buffer_load_dwordx4 v117, s[8:11], s48 offen nt lds
    s_mov_b32 m0, 14336
    v_smfmac_f32_16x16x64_bf16 v[44:47], v[0:3], v[72:79], v116
    s_waitcnt lgkmcnt(0)
    s_barrier
    ds_read_b128 v[8:11], v117 offset:2048
    v_smfmac_f32_16x16x64_bf16 v[48:51], v[0:3], a[192:199], v116
    ds_read_b128 v[16:19], v117 offset:1024
    ds_read_b128 v[20:23], v117
    v_smfmac_f32_16x16x64_bf16 v[52:55], v[0:3], a[200:207], v116
    ds_read_b128 v[80:83], v117 offset:14336
    s_waitcnt lgkmcnt(3)
    v_smfmac_f32_16x16x64_bf16 v[32:35], v[8:11], a[0:7], v116
    ds_read_b128 v[84:87], v117 offset:15360
    v_smfmac_f32_16x16x64_bf16 v[36:39], v[8:11], a[8:15], v116
    ds_read_b128 v[56:59], v117 offset:8192
    s_waitcnt lgkmcnt(4)
    v_smfmac_f32_16x16x64_bf16 v[32:35], v[16:19], a[32:39], v116
    ds_read_b128 v[60:63], v117 offset:9216
    v_smfmac_f32_16x16x64_bf16 v[36:39], v[16:19], a[40:47], v116
    ds_read_b128 v[64:67], v117 offset:10240
    s_waitcnt lgkmcnt(5)
    v_smfmac_f32_16x16x64_bf16 v[32:35], v[20:23], a[64:71], v116
    ds_read_b128 v[68:71], v117 offset:11264
    v_smfmac_f32_16x16x64_bf16 v[36:39], v[20:23], a[72:79], v116
    ds_read_b128 v[72:75], v117 offset:12288
    v_smfmac_f32_16x16x64_bf16 v[40:43], v[8:11], a[96:103], v116
    ds_read_b128 v[76:79], v117 offset:13312
    v_smfmac_f32_16x16x64_bf16 v[40:43], v[16:19], a[128:135], v116
    buffer_store_dwordx4 v[112:115], v117, s[8:11], s32 offen sc1
    v_smfmac_f32_16x16x64_bf16 v[40:43], v[20:23], a[160:167], v116
    s_waitcnt vmcnt(2)
    v_max3_u32 v15, v4, v5, v6
    v_smfmac_f32_16x16x64_bf16 v[44:47], v[8:11], a[104:111], v116
    v_max_u32 v15, v15, v7
    v_smfmac_f32_16x16x64_bf16 v[44:47], v[16:19], a[136:143], v116
    s_waitcnt vmcnt(1) lgkmcnt(0)
    v_cmp_lt_u32 vcc, s56, v15
    v_smfmac_f32_16x16x64_bf16 v[44:47], v[20:23], a[168:175], v116
    s_cbranch_vccnz L_mret_40
L_mgo_41:
    v_smfmac_f32_16x16x64_bf16 v[44:47], v[4:7], v[24:31], v116
    s_barrier
    ds_read_b128 v[12:15], v117 offset:6144
    v_smfmac_f32_16x16x64_bf16 v[32:35], v[4:7], v[88:95], v116
    ds_read_b128 v[24:27], v117 offset:5120
    v_smfmac_f32_16x16x64_bf16 v[36:39], v[4:7], v[96:103], v116
    ds_read_b128 v[28:31], v117 offset:4096
    v_smfmac_f32_16x16x64_bf16 v[40:43], v[4:7], v[104:111], v116
    ds_read_b128 v[88:91], v117 offset:30720
    s_waitcnt lgkmcnt(3)
    v_smfmac_f32_16x16x64_bf16 v[32:35], v[12:15], a[16:23], v116
    ds_read_b128 v[92:95], v117 offset:31744
    s_waitcnt lgkmcnt(3)
    v_smfmac_f32_16x16x64_bf16 v[32:35], v[24:27], a[48:55], v116
    ds_read_b128 v[96:99], v117 offset:23552
    s_waitcnt lgkmcnt(3)
    v_smfmac_f32_16x16x64_bf16 v[32:35], v[28:31], a[80:87], v116
    buffer_load_dwordx4 v117, s[8:11], s30 offen lds
    v_smfmac_f32_16x16x64_bf16 v[36:39], v[12:15], a[24:31], v116
    ds_read_b128 v[100:103], v117 offset:23552
    v_smfmac_f32_16x16x64_bf16 v[36:39], v[24:27], a[56:63], v116
    ds_read_b128 v[104:107], v117 offset:23552
    v_add_f32 v32, v32, v34
    v_smfmac_f32_16x16x64_bf16 v[36:39], v[28:31], a[88:95], v116
    buffer_load_dwordx4 v117, s[8:11], s30 offen offset:1024 lds
    s_add_u32 m0, s52, 0x6000
    v_add_f32 v33, v33, v35
    v_smfmac_f32_16x16x64_bf16 v[40:43], v[12:15], a[112:119], v116
    ds_read_b128 v[108:111], v117 offset:23552
    v_mul_f32 v32, s34, v32
    v_smfmac_f32_16x16x64_bf16 v[40:43], v[24:27], a[144:151], v116
    ds_read_b128 v[0:3], v124
    v_mul_f32 v33, s34, v33
    v_smfmac_f32_16x16x64_bf16 v[40:43], v[28:31], a[176:183], v116
    s_waitcnt lgkmcnt(5)
    buffer_load_dwordx4 v117, s[8:11], s31 offen lds
    v_add_f32 v36, v36, v38
    v_smfmac_f32_16x16x64_bf16 v[48:51], v[4:7], a[208:215], v116
    v_add_f32 v37, v37, v39
    v_smfmac_f32_16x16x64_bf16 v[52:55], v[4:7], a[216:223], v116
    ds_read_b128 v[4:7], v124 offset:1024
    v_mul_f32 v36, s34, v36
    v_smfmac_f32_16x16x64_bf16 v[44:47], v[12:15], a[120:127], v116
    buffer_load_dwordx4 v117, s[8:11], s31 offen offset:1024 lds
    s_mov_b32 m0, 7168
    v_mul_f32 v37, s34, v37
    v_smfmac_f32_16x16x64_bf16 v[44:47], v[24:27], a[152:159], v116
    v_cvt_pk_bf16_f32 v34, v32, v36
    v_smfmac_f32_16x16x64_bf16 v[44:47], v[28:31], a[184:191], v116
    v_cvt_pk_bf16_f32 v35, v33, v37
    v_add_f32 v40, v40, v42
    v_smfmac_f32_16x16x64_bf16 v[48:51], v[8:11], a[224:231], v116
    ds_write2_b32 v120, v34, v35 offset0:32 offset1:48
    v_add_f32 v41, v41, v43
    v_smfmac_f32_16x16x64_bf16 v[52:55], v[8:11], a[232:239], v116
    v_add_f32 v44, v44, v46
    v_add_f32 v45, v45, v47
    v_cvt_pk_bf16_f32 v113, v40, v44
    v_cvt_pk_bf16_f32 v115, v41, v45
    v_smfmac_f32_16x16x64_bf16 v[48:51], v[12:15], a[240:247], v116
    ds_write2_b32 v120, v113, v115 offset0:0 offset1:16
    v_smfmac_f32_16x16x64_bf16 v[52:55], v[12:15], a[248:255], v116
    s_cmp_eq_u32 s22, 63
    s_cbranch_scc1 L_chain_last_f
    v_smfmac_f32_16x16x64_bf16 v[48:51], v[16:19], v[128:135], v116
    v_smfmac_f32_16x16x64_bf16 v[48:51], v[20:23], v[160:167], v116
    buffer_store_dword v126, v119, s[8:11], s55 offen
    v_smfmac_f32_16x16x64_bf16 v[48:51], v[24:27], v[144:151], v116
    s_waitcnt lgkmcnt(0)
    s_barrier
    v_smfmac_f32_16x16x64_bf16 v[48:51], v[28:31], v[176:183], v116
    ds_read_b128 v[32:35], v121 offset:16384
    ds_read_b128 v[36:39], v121 offset:17408
    v_smfmac_f32_16x16x64_bf16 v[52:55], v[16:19], v[136:143], v116
    ds_read_b128 v[40:43], v121 offset:18432
    ds_read_b128 v[44:47], v121 offset:19456
    v_smfmac_f32_16x16x64_bf16 v[52:55], v[20:23], v[168:175], v116
    ds_read_b128 v[8:11], v124 offset:32768
    v_add_f32 v48, v48, v50
    v_smfmac_f32_16x16x64_bf16 v[52:55], v[24:27], v[152:159], v116
    ds_read_b128 v[12:15], v124 offset:33792
    v_add_f32 v49, v49, v51
    v_smfmac_f32_16x16x64_bf16 v[52:55], v[28:31], v[184:191], v116
    s_waitcnt lgkmcnt(5)
    v_cvt_pk_bf16_f32 v112, v48, v49
    v_mfma_f32_16x16x32_bf16 v[56:59], v[56:59], v[32:35], 0
    s_waitcnt lgkmcnt(4)
    v_mov_b32 v48, s50
    v_mov_b32 v49, s50
    v_mfma_f32_16x16x32_bf16 v[56:59], v[60:63], v[36:39], v[56:59]
    ds_read_b128 v[16:19], v124 offset:2048
    s_waitcnt lgkmcnt(4)
    v_mov_b32 v50, s50
    v_mov_b32 v51, s50
    v_mfma_f32_16x16x32_bf16 v[56:59], v[64:67], v[40:43], v[56:59]
    ds_read_b128 v[20:23], v124 offset:3072
    s_waitcnt lgkmcnt(4)
    v_add_f32 v52, v52, v54
    v_mfma_f32_16x16x32_bf16 v[56:59], v[68:71], v[44:47], v[56:59]
    ds_read_b128 v[24:27], v124 offset:4096
    v_add_f32 v53, v53, v55
    v_mfma_f32_16x16x32_bf16 v[60:63], v[72:75], v[32:35], 0
    ds_read_b128 v[28:31], v124 offset:5120
    v_cvt_pk_bf16_f32 v114, v52, v53
    v_mov_b32 v53, 0
    v_mfma_f32_16x16x32_bf16 v[60:63], v[76:79], v[36:39], v[60:63]
    v_exp_f32 v56, v56
    v_mfma_f32_16x16x32_bf16 v[60:63], v[80:83], v[40:43], v[60:63]
    v_exp_f32 v57, v57
    v_mfma_f32_16x16x32_bf16 v[60:63], v[84:87], v[44:47], v[60:63]
    v_exp_f32 v58, v58
    v_mfma_f32_16x16x32_bf16 v[64:67], v[32:35], v[32:35], 0
    v_exp_f32 v59, v59
    v_cvt_pk_bf16_f32 v68, v56, v57
    v_mfma_f32_16x16x32_bf16 v[64:67], v[36:39], v[36:39], v[64:67]
    v_exp_f32 v60, v60
    v_cvt_pk_bf16_f32 v69, v58, v59
    v_mfma_f32_16x16x32_bf16 v[64:67], v[40:43], v[40:43], v[64:67]
    v_exp_f32 v61, v61
    v_mfma_f32_16x16x32_bf16 v[64:67], v[44:47], v[44:47], v[64:67]
    v_exp_f32 v62, v62
    v_exp_f32 v63, v63
    v_cvt_pk_bf16_f32 v70, v60, v61
    v_cvt_pk_bf16_f32 v71, v62, v63
    s_nop 1
    v_mfma_f32_16x16x32_bf16 v[72:75], v[88:91], v[68:71], 0
    s_nop 0
    v_exp_f32 v64, v64
    v_mfma_f32_16x16x32_bf16 v[76:79], v[92:95], v[68:71], 0
    v_exp_f32 v65, v65
    v_mfma_f32_16x16x32_bf16 v[80:83], v[48:51], v[68:71], 0
    v_cvt_pk_bf16_f32 v52, v64, v65
    s_nop 1
    v_mfma_f32_16x16x16_bf16 v[72:75], v[112:113], v[52:53], v[72:75]
    ds_read_b128 v[32:35], v124 offset:6144
    v_mfma_f32_16x16x16_bf16 v[76:79], v[114:115], v[52:53], v[76:79]
    ds_read_b128 v[36:39], v124 offset:7168
    v_mfma_f32_16x16x16_bf16 v[80:83], v[48:49], v[52:53], v[80:83]
L_norm_42:
    s_mov_b64 vcc, s[36:37]
    v_mov_b32 v122, v122
    v_mov_b32 v122, v122
    v_mov_b32 v122, v122
    v_cndmask_b32_dpp v76, v72, v76, vcc quad_perm:[2,3,2,3] row_mask:0xf bank_mask:0xf
    v_cndmask_b32_dpp v77, v73, v77, vcc quad_perm:[2,3,2,3] row_mask:0xf bank_mask:0xf
    v_cndmask_b32_dpp v78, v74, v78, vcc quad_perm:[2,3,2,3] row_mask:0xf bank_mask:0xf
    v_cndmask_b32_dpp v79, v75, v79, vcc quad_perm:[2,3,2,3] row_mask:0xf bank_mask:0xf
    v_rcp_f32_dpp v84, v80 quad_perm:[2,3,2,3] row_mask:0xf bank_mask:0xf
    s_nop 0
    v_pk_mul_f32 v[76:77], v[76:77], v[84:85] op_sel_hi:[1,0]
    v_pk_mul_f32 v[78:79], v[78:79], v[84:85] op_sel_hi:[1,0]
    v_cvt_pk_bf16_f32 v72, v76, v77
    v_cvt_pk_bf16_f32 v73, v78, v79
    ds_write_b64 v122, v[72:73] offset:22016
    v_max_f32_dpp v86, v80, v84 quad_perm:[2,3,2,3] row_mask:0xf bank_mask:0xf
    v_mov_b32_dpp v60, v72 quad_perm:[0,1,0,1] row_mask:0xf bank_mask:0xf
    v_mov_b32_dpp v61, v73 quad_perm:[0,1,0,1] row_mask:0xf bank_mask:0xf
    v_cmp_lt_f32 vcc, s35, v86
    v_mov_b32_dpp v62, v72 quad_perm:[2,3,2,3] row_mask:0xf bank_mask:0xf
    v_mov_b32_dpp v63, v73 quad_perm:[2,3,2,3] row_mask:0xf bank_mask:0xf
    s_nop 1
    v_smfmac_f32_16x16x64_bf16 v[96:99], v[60:63], v[192:199], v116
    s_cbranch_vccnz L_smax_43
    v_smfmac_f32_16x16x64_bf16 v[100:103], v[60:63], v[224:231], v116
    s_waitcnt lgkmcnt(0)
    s_barrier
    ds_read_b128 v[92:95], v127 offset:21504
    ds_read_b128 v[80:83], v127 offset:20992
    ds_read_b128 v[84:87], v127 offset:20480
    v_smfmac_f32_16x16x64_bf16 v[104:107], v[60:63], v[0:7], v116
    ds_read_b128 v[40:43], v124 offset:34816
    v_smfmac_f32_16x16x64_bf16 v[108:111], v[60:63], v[8:15], v116
    ds_read_b128 v[56:59], v124 offset:36864
    s_waitcnt lgkmcnt(4)
    v_smfmac_f32_16x16x64_bf16 v[96:99], v[92:95], v[200:207], v116
    s_waitcnt lgkmcnt(3)
    v_smfmac_f32_16x16x64_bf16 v[96:99], v[80:83], v[208:215], v116
    ds_read_b128 v[44:47], v124 offset:35840
    s_waitcnt lgkmcnt(3)
    v_smfmac_f32_16x16x64_bf16 v[96:99], v[84:87], v[216:223], v116
    ds_read_b128 v[68:71], v124 offset:39936
    v_smfmac_f32_16x16x64_bf16 v[100:103], v[92:95], v[232:239], v116
    ds_read_b128 v[64:67], v124 offset:38912
    v_smfmac_f32_16x16x64_bf16 v[100:103], v[80:83], v[240:247], v116
    ds_read_b128 v[60:63], v124 offset:37888
    v_cvt_pk_bf16_f32 v72, v96, v98
    v_smfmac_f32_16x16x64_bf16 v[100:103], v[84:87], v[248:255], v116
    v_and_or_b32 v72, v72, -2, s33
    v_smfmac_f32_16x16x64_bf16 v[104:107], v[92:95], v[16:23], v116
    v_cvt_pk_bf16_f32 v74, v97, v99
    v_smfmac_f32_16x16x64_bf16 v[104:107], v[80:83], v[24:31], v116
    v_cvt_pk_bf16_f32 v73, v100, v102
    v_cvt_pk_bf16_f32 v75, v101, v103
    v_smfmac_f32_16x16x64_bf16 v[104:107], v[84:87], v[32:39], v116
    buffer_store_dwordx4 v[72:75], v118, s[8:11], s25 offen
    s_waitcnt lgkmcnt(3)
    v_smfmac_f32_16x16x64_bf16 v[108:111], v[92:95], v[40:47], v116
    s_waitcnt lgkmcnt(0)
    v_smfmac_f32_16x16x64_bf16 v[108:111], v[80:83], v[56:63], v116
    v_cvt_pk_bf16_f32 v76, v104, v106
    v_smfmac_f32_16x16x64_bf16 v[108:111], v[84:87], v[64:71], v116
    v_and_or_b32 v76, v76, -2, s33
    v_cvt_pk_bf16_f32 v78, v105, v107
    v_mov_b32 v122, v122
    v_mov_b32 v122, v122
    v_mov_b32 v122, v122
    v_mov_b32 v122, v122
    v_mov_b32 v122, v122
    v_mov_b32 v122, v122
    v_cvt_pk_bf16_f32 v77, v108, v110
    v_cvt_pk_bf16_f32 v79, v109, v111
    buffer_store_dwordx4 v[76:79], v118, s[8:11], s26 offen
    ds_read_b128 v[80:83], v123
    ds_read_b128 v[84:87], v123 offset:1024
    ds_read_b128 v[56:59], v123 offset:2048
    ds_read_b128 v[60:63], v123 offset:3072
    ds_read_b128 v[64:67], v123 offset:32768
    ds_read_b128 v[68:71], v123 offset:33792
    ds_read_b128 v[72:75], v123 offset:34816
    ds_read_b128 v[76:79], v123 offset:35840
    ds_read_b128 v[88:91], v123 offset:4096
    ds_read_b128 v[92:95], v123 offset:5120
    ds_read_b128 v[96:99], v123 offset:6144
    ds_read_b128 v[100:103], v123 offset:7168
    ds_read_b128 v[104:107], v123 offset:36864
    ds_read_b128 v[108:111], v123 offset:37888
    ds_read_b128 v[24:27], v123 offset:38912
    ds_read_b128 v[28:31], v123 offset:39936
    s_add_u32 s30, s30, 0x40000
    s_add_u32 s31, s31, 0x40000
    s_add_u32 s32, s32, 0x20000
    s_add_u32 s23, s24, 3072
    s_add_u32 s48, s23, 4096
    s_xor_b32 s25, s25, 0x40000
    s_xor_b32 s26, s26, 0x40000
    s_mov_b32 s35, 0x49800000
    s_add_u32 s22, s22, 1
    v_cndmask_b32 v12, 0, v125, s[68:69]
    v_cndmask_b32 v13, 0, v125, s[70:71]
    v_cndmask_b32 v14, 0, v125, s[72:73]
    v_cndmask_b32 v15, 0, v125, s[74:75]
    v_mov_b32 v54, 0
    v_mov_b32 v55, 0
    v_mov_b32 v52, 0
    v_mov_b32 v52, 0
    v_mov_b32 v52, 0
    v_mov_b32 v52, 0
    v_mov_b32 v52, 0
    v_mov_b32 v52, 0
    v_mov_b32 v52, 0
    v_mov_b32 v52, 0
    v_mov_b32 v52, 0
    v_mov_b32 v52, 0
    v_mov_b32 v52, 0
    v_mov_b32 v52, 0
    v_mov_b32 v52, 0
    v_mov_b32 v52, 0
    v_mov_b32 v52, 0
    v_mov_b32 v52, 0
    v_mov_b32 v52, 0
    v_mov_b32 v52, 0
    v_mov_b32 v52, 0
    v_mov_b32 v52, 0
    v_mov_b32 v52, 0
    v_mov_b32 v52, 0
    v_mov_b32 v52, 0
    v_mov_b32 v52, 0
    v_mov_b32 v52, 0
    v_mov_b32 v52, 0
    v_mov_b32 v52, 0
    v_mov_b32 v52, 0
    v_mov_b32 v52, 0
    v_mov_b32 v52, 0
    v_mov_b32 v52, 0
    v_mov_b32 v52, 0
    v_mov_b32 v52, 0
    v_mov_b32 v52, 0
    v_mov_b32 v52, 0
    v_mov_b32 v52, 0
    v_mov_b32 v52, 0
    v_mov_b32 v52, 0
    v_mov_b32 v52, 0
    v_mov_b32 v52, 0
    v_mov_b32 v52, 0
    v_mov_b32 v52, 0
    v_mov_b32 v52, 0
    v_mov_b32 v52, 0
    v_mov_b32 v52, 0
    v_mov_b32 v52, 0
    v_mov_b32 v52, 0
    v_mov_b32 v52, 0
    v_mov_b32 v52, 0
    buffer_load_dwordx4 v[4:7], v117, s[8:11], s29 offen nt
    buffer_load_dwordx4 v[8:11], v117, s[8:11], s53 offen nt
    buffer_load_dwordx4 v[16:19], v117, s[8:11], s29 offen offset:2048 nt
    buffer_load_dwordx4 v[20:23], v117, s[8:11], s53 offen offset:2048 nt
    v_mov_b32 v52, 0
    v_mov_b32 v52, 0
    v_mov_b32 v52, 0
    v_mov_b32 v52, 0
    v_mov_b32 v52, 0
    v_mov_b32 v52, 0
    v_mov_b32 v52, 0
    v_mov_b32 v52, 0
    v_mov_b32 v52, 0
    v_mov_b32 v52, 0
    v_mov_b32 v52, 0
    v_mov_b32 v52, 0
    v_mov_b32 v52, 0
    v_mov_b32 v52, 0
    v_mov_b32 v52, 0
    v_mov_b32 v52, 0
    v_mov_b32 v52, 0
    v_mov_b32 v52, 0
    v_mov_b32 v52, 0
    v_mov_b32 v52, 0
    v_mov_b32 v52, 0
    v_mov_b32 v52, 0
    v_mov_b32 v52, 0
    v_mov_b32 v52, 0
    v_mov_b32 v52, 0
    v_mov_b32 v52, 0
    v_mov_b32 v52, 0
    v_mov_b32 v52, 0
    v_mov_b32 v52, 0
    v_mov_b32 v52, 0
    buffer_load_dwordx4 v[32:35], v117, s[8:11], s29 offen sc1
    buffer_load_dwordx4 v[36:39], v117, s[8:11], s53 offen sc1
    buffer_load_dwordx4 v[40:43], v117, s[8:11], s29 offen offset:2048 sc1
    buffer_load_dwordx4 v[44:47], v117, s[8:11], s53 offen offset:2048 sc1
    v_mov_b32 v52, 0
L_rl_44:
    s_waitcnt vmcnt(7)
    v_mfma_f32_16x16x32_bf16 v[48:51], v[4:7], v[12:15], 0
    v_xor_b32 v52, s33, v4
    s_waitcnt vmcnt(6)
    v_mfma_f32_16x16x32_bf16 v[48:51], v[8:11], v[12:15], v[48:51]
    v_xor_b32 v53, s33, v8
    v_or_b32 v52, v52, v53
    s_waitcnt vmcnt(5)
    v_mfma_f32_16x16x32_bf16 v[48:51], v[16:19], v[12:15], v[48:51]
    v_xor_b32 v53, s33, v16
    v_or_b32 v52, v52, v53
    s_waitcnt vmcnt(4)
    v_mfma_f32_16x16x32_bf16 v[48:51], v[20:23], v[12:15], v[48:51]
    v_xor_b32 v53, s33, v20
    v_or_b32 v52, v52, v53
    v_and_b32 v52, 1, v52
    v_cmp_ne_u32 vcc, 0, v52
    s_cbranch_vccnz L_rslow_45
L_rgo_46:
    s_nop 2
    v_permlane32_swap_b32 v48, v50
    v_permlane32_swap_b32 v49, v51
    v_pk_add_f32 v[48:49], v[48:49], v[50:51]
    s_mov_b64 exec, s[38:39]
    v_cvt_pk_bf16_f32 v12, v48, v49
    v_min_u32 v12, 0xfffffffe, v12
    buffer_store_dword v12, v119, s[8:11], s24 offen
    s_mov_b64 exec, -1
    s_add_u32 s24, s24, 8192
    s_bitset0_b32 s24, 15
    s_xor_b32 s55, s24, 16384
    s_xor_b32 s29, s29, 0x40000
    s_xor_b32 s53, s29, 1024
    s_bfe_u32 s33, s22, 0x10001
    s_waitcnt lgkmcnt(0)
    s_branch L_chain_top3_f
L_chain_last_f:
    s_nop 1
    v_smfmac_f32_16x16x64_bf16 v[48:51], v[16:19], v[128:135], v116
    v_smfmac_f32_16x16x64_bf16 v[48:51], v[20:23], v[160:167], v116
    v_smfmac_f32_16x16x64_bf16 v[48:51], v[24:27], v[144:151], v116
    v_smfmac_f32_16x16x64_bf16 v[48:51], v[28:31], v[176:183], v116
    v_smfmac_f32_16x16x64_bf16 v[52:55], v[16:19], v[136:143], v116
    v_smfmac_f32_16x16x64_bf16 v[52:55], v[20:23], v[168:175], v116
    v_smfmac_f32_16x16x64_bf16 v[52:55], v[24:27], v[152:159], v116
    v_smfmac_f32_16x16x64_bf16 v[52:55], v[28:31], v[184:191], v116
    v_add_f32 v48, v48, v50
    v_add_f32 v49, v49, v51
    v_cvt_pk_bf16_f32 v112, v48, v49
    s_nop 4
    v_add_f32 v52, v52, v54
    v_add_f32 v53, v53, v55
    v_cvt_pk_bf16_f32 v114, v52, v53
    s_add_u32 s32, s32, 0x20000
    buffer_store_dwordx4 v[112:115], v117, s[8:11], s32 offen sc1
    v_mov_b32 v94, 64
    s_waitcnt vmcnt(0) lgkmcnt(0)
    s_barrier
    s_mov_b64 exec, 1
    buffer_store_dword v94, off, s[8:11], s44 sc1
    s_mov_b64 exec, -1
    s_endpgm
L_mret_18:
    s_mov_b32 s43, m0
    s_mov_b32 m0, 4096
    buffer_load_dwordx4 v[4:7], v117, s[8:11], s48 offen sc1
    buffer_load_dwordx4 v117, s[8:11], s48 offen sc1 lds
    s_mov_b32 m0, 8192
    s_mov_b32 m0, s43
    s_waitcnt vmcnt(0)
    v_max3_u32 v15, v4, v5, v6
    v_max_u32 v15, v15, v7
    v_cmp_lt_u32 vcc, s56, v15
    s_add_u32 s47, s47, 1
    s_add_u32 s49, s49, 1
    s_cmp_ge_u32 s49, 0x10000
    s_cbranch_scc1 L_mgo_19
    s_cbranch_vccnz L_mret_18
    s_branch L_mgo_19
L_smax_21:
    s_add_u32 s47, s47, 1
    s_mov_b32 s35, 0x7f800000
    s_waitcnt lgkmcnt(0)
    s_sub_u32 s43, s30, 0x40000
    s_add_u32 s40, s43, 4096
    s_nop 7
    buffer_load_dwordx4 v[56:59], v117, s[8:11], s43 offen
    buffer_load_dwordx4 v[60:63], v117, s[8:11], s43 offen offset:1024
    buffer_load_dwordx4 v[64:67], v117, s[8:11], s43 offen offset:2048
    buffer_load_dwordx4 v[68:71], v117, s[8:11], s43 offen offset:3072
    buffer_load_dwordx4 v[72:75], v117, s[8:11], s40 offen
    buffer_load_dwordx4 v[76:79], v117, s[8:11], s40 offen offset:1024
    buffer_load_dwordx4 v[80:83], v117, s[8:11], s40 offen offset:2048
    buffer_load_dwordx4 v[84:87], v117, s[8:11], s40 offen offset:3072
    ds_read_b128 v[32:35], v121 offset:16384
    ds_read_b128 v[36:39], v121 offset:17408
    ds_read_b128 v[40:43], v121 offset:18432
    ds_read_b128 v[44:47], v121 offset:19456
    v_mov_b32 v96, 0
    v_mov_b32 v97, 0
    v_mov_b32 v98, 0
    v_mov_b32 v99, 0
    v_mov_b32 v100, 0
    v_mov_b32 v101, 0
    v_mov_b32 v102, 0
    v_mov_b32 v103, 0
    v_mov_b32 v104, 0
    v_mov_b32 v105, 0
    v_mov_b32 v106, 0
    v_mov_b32 v107, 0
    v_mov_b32 v108, 0
    v_mov_b32 v109, 0
    v_mov_b32 v110, 0
    v_mov_b32 v111, 0
    s_waitcnt vmcnt(0) lgkmcnt(0)
    v_mfma_f32_16x16x32_bf16 v[56:59], v[56:59], v[32:35], 0
    v_mfma_f32_16x16x32_bf16 v[56:59], v[60:63], v[36:39], v[56:59]
    v_mfma_f32_16x16x32_bf16 v[56:59], v[64:67], v[40:43], v[56:59]
    v_mfma_f32_16x16x32_bf16 v[56:59], v[68:71], v[44:47], v[56:59]
    v_mfma_f32_16x16x32_bf16 v[60:63], v[72:75], v[32:35], 0
    v_mfma_f32_16x16x32_bf16 v[60:63], v[76:79], v[36:39], v[60:63]
    v_mfma_f32_16x16x32_bf16 v[60:63], v[80:83], v[40:43], v[60:63]
    v_mfma_f32_16x16x32_bf16 v[60:63], v[84:87], v[44:47], v[60:63]
    v_mfma_f32_16x16x32_bf16 v[64:67], v[32:35], v[32:35], 0
    v_mfma_f32_16x16x32_bf16 v[64:67], v[36:39], v[36:39], v[64:67]
    v_mfma_f32_16x16x32_bf16 v[64:67], v[40:43], v[40:43], v[64:67]
    v_mfma_f32_16x16x32_bf16 v[64:67], v[44:47], v[44:47], v[64:67]
    v_max3_f32 v84, v56, v57, v58
    v_max3_f32 v84, v84, v59, v60
    v_max3_f32 v84, v84, v61, v62
    s_nop 4
    v_max3_f32 v84, v84, v63, v64
    v_max_f32 v84, v84, v65
    v_mov_b32 v85, v84
    s_nop 1
    v_permlane32_swap_b32 v85, v84
    v_max_f32 v84, v85, v84
    v_mov_b32 v85, v84
    s_nop 1
    v_permlane16_swap_b32 v85, v84
    v_max_f32 v84, v85, v84
    v_sub_f32 v56, v56, v84
    v_sub_f32 v57, v57, v84
    v_sub_f32 v58, v58, v84
    v_sub_f32 v59, v59, v84
    v_sub_f32 v60, v60, v84
    v_sub_f32 v61, v61, v84
    v_sub_f32 v62, v62, v84
    v_sub_f32 v63, v63, v84
    v_sub_f32 v64, v64, v84
    v_sub_f32 v65, v65, v84
    v_exp_f32 v56, v56
    v_exp_f32 v57, v57
    v_exp_f32 v58, v58
    v_exp_f32 v59, v59
    v_exp_f32 v60, v60
    v_exp_f32 v61, v61
    v_exp_f32 v62, v62
    v_exp_f32 v63, v63
    v_exp_f32 v64, v64
    v_exp_f32 v65, v65
    v_cvt_pk_bf16_f32 v68, v56, v57
    v_cvt_pk_bf16_f32 v69, v58, v59
    v_cvt_pk_bf16_f32 v70, v60, v61
    v_cvt_pk_bf16_f32 v71, v62, v63
    v_cvt_pk_bf16_f32 v52, v64, v65
    s_nop 0
    v_mfma_f32_16x16x32_bf16 v[72:75], v[88:91], v[68:71], 0
    v_mfma_f32_16x16x32_bf16 v[76:79], v[92:95], v[68:71], 0
    v_mfma_f32_16x16x32_bf16 v[80:83], v[48:51], v[68:71], 0
    v_mfma_f32_16x16x16_bf16 v[72:75], v[112:113], v[52:53], v[72:75]
    v_mfma_f32_16x16x16_bf16 v[76:79], v[114:115], v[52:53], v[76:79]
    v_mfma_f32_16x16x16_bf16 v[80:83], v[48:49], v[52:53], v[80:83]
    ds_read_b128 v[32:35], v124 offset:6144
    ds_read_b128 v[36:39], v124 offset:7168
    ds_read_b128 v[40:43], v124 offset:34816
    ds_read_b128 v[44:47], v124 offset:35840
    ds_read_b128 v[56:59], v124 offset:36864
    ds_read_b128 v[64:67], v124 offset:38912
    ds_read_b128 v[68:71], v124 offset:39936
    s_waitcnt lgkmcnt(0)
    s_branch L_norm_20
L_kvw_22:
    s_add_u32 s47, s47, 1
    s_add_u32 s49, s49, 1
    s_cmp_ge_u32 s49, 0x10000
    s_cbranch_scc1 L_kvb_23
    s_sleep 4
    buffer_load_dword v125, v119, s[8:11], s28 offen sc1
    s_waitcnt vmcnt(0)
    v_cmp_eq_u32 vcc, 0, v125
    s_nop 0
    s_and_b64 vcc, vcc, s[58:59]
    s_cbranch_scc1 L_kvw_22
    s_branch L_kvb_23
L_mret_25:
    s_mov_b32 s43, m0
    s_mov_b32 m0, 5120
    buffer_load_dwordx4 v[4:7], v117, s[8:11], s48 offen sc1
    buffer_load_dwordx4 v117, s[8:11], s48 offen sc1 lds
    s_mov_b32 m0, 10240
    s_mov_b32 m0, s43
    s_waitcnt vmcnt(0)
    v_max3_u32 v15, v4, v5, v6
    v_max_u32 v15, v15, v7
    v_cmp_lt_u32 vcc, s56, v15
    s_add_u32 s47, s47, 1
    s_add_u32 s49, s49, 1
    s_cmp_ge_u32 s49, 0x10000
    s_cbranch_scc1 L_mgo_26
    s_cbranch_vccnz L_mret_25
    s_branch L_mgo_26
L_smax_28:
    s_add_u32 s47, s47, 1
    s_mov_b32 s35, 0x7f800000
    s_waitcnt lgkmcnt(0)
    s_sub_u32 s43, s30, 0x40800
    s_add_u32 s40, s43, 4096
    s_nop 7
    buffer_load_dwordx4 v[56:59], v117, s[8:11], s43 offen
    buffer_load_dwordx4 v[60:63], v117, s[8:11], s43 offen offset:1024
    buffer_load_dwordx4 v[64:67], v117, s[8:11], s43 offen offset:2048
    buffer_load_dwordx4 v[68:71], v117, s[8:11], s43 offen offset:3072
    buffer_load_dwordx4 v[72:75], v117, s[8:11], s40 offen
    buffer_load_dwordx4 v[76:79], v117, s[8:11], s40 offen offset:1024
    buffer_load_dwordx4 v[80:83], v117, s[8:11], s40 offen offset:2048
    buffer_load_dwordx4 v[84:87], v117, s[8:11], s40 offen offset:3072
    ds_read_b128 v[32:35], v121 offset:16384
    ds_read_b128 v[36:39], v121 offset:17408
    ds_read_b128 v[40:43], v121 offset:18432
    ds_read_b128 v[44:47], v121 offset:19456
    v_mov_b32 v96, 0
    v_mov_b32 v97, 0
    v_mov_b32 v98, 0
    v_mov_b32 v99, 0
    v_mov_b32 v100, 0
    v_mov_b32 v101, 0
    v_mov_b32 v102, 0
    v_mov_b32 v103, 0
    v_mov_b32 v104, 0
    v_mov_b32 v105, 0
    v_mov_b32 v106, 0
    v_mov_b32 v107, 0
    v_mov_b32 v108, 0
    v_mov_b32 v109, 0
    v_mov_b32 v110, 0
    v_mov_b32 v111, 0
    s_waitcnt vmcnt(0) lgkmcnt(0)
    v_mfma_f32_16x16x32_bf16 v[56:59], v[56:59], v[32:35], 0
    v_mfma_f32_16x16x32_bf16 v[56:59], v[60:63], v[36:39], v[56:59]
    v_mfma_f32_16x16x32_bf16 v[56:59], v[64:67], v[40:43], v[56:59]
    v_mfma_f32_16x16x32_bf16 v[56:59], v[68:71], v[44:47], v[56:59]
    v_mfma_f32_16x16x32_bf16 v[60:63], v[72:75], v[32:35], 0
    v_mfma_f32_16x16x32_bf16 v[60:63], v[76:79], v[36:39], v[60:63]
    v_mfma_f32_16x16x32_bf16 v[60:63], v[80:83], v[40:43], v[60:63]
    v_mfma_f32_16x16x32_bf16 v[60:63], v[84:87], v[44:47], v[60:63]
    v_mfma_f32_16x16x32_bf16 v[64:67], v[32:35], v[32:35], 0
    v_mfma_f32_16x16x32_bf16 v[64:67], v[36:39], v[36:39], v[64:67]
    v_mfma_f32_16x16x32_bf16 v[64:67], v[40:43], v[40:43], v[64:67]
    v_mfma_f32_16x16x32_bf16 v[64:67], v[44:47], v[44:47], v[64:67]
    v_max3_f32 v84, v56, v57, v58
    v_max3_f32 v84, v84, v59, v60
    v_max3_f32 v84, v84, v61, v62
    s_nop 4
    v_max3_f32 v84, v84, v63, v64
    v_max_f32 v84, v84, v65
    v_mov_b32 v85, v84
    s_nop 1
    v_permlane32_swap_b32 v85, v84
    v_max_f32 v84, v85, v84
    v_mov_b32 v85, v84
    s_nop 1
    v_permlane16_swap_b32 v85, v84
    v_max_f32 v84, v85, v84
    v_sub_f32 v56, v56, v84
    v_sub_f32 v57, v57, v84
    v_sub_f32 v58, v58, v84
    v_sub_f32 v59, v59, v84
    v_sub_f32 v60, v60, v84
    v_sub_f32 v61, v61, v84
    v_sub_f32 v62, v62, v84
    v_sub_f32 v63, v63, v84
    v_sub_f32 v64, v64, v84
    v_sub_f32 v65, v65, v84
    v_exp_f32 v56, v56
    v_exp_f32 v57, v57
    v_exp_f32 v58, v58
    v_exp_f32 v59, v59
    v_exp_f32 v60, v60
    v_exp_f32 v61, v61
    v_exp_f32 v62, v62
    v_exp_f32 v63, v63
    v_exp_f32 v64, v64
    v_exp_f32 v65, v65
    v_cvt_pk_bf16_f32 v68, v56, v57
    v_cvt_pk_bf16_f32 v69, v58, v59
    v_cvt_pk_bf16_f32 v70, v60, v61
    v_cvt_pk_bf16_f32 v71, v62, v63
    v_cvt_pk_bf16_f32 v52, v64, v65
    s_nop 0
    v_mfma_f32_16x16x32_bf16 v[72:75], v[88:91], v[68:71], 0
    v_mfma_f32_16x16x32_bf16 v[76:79], v[92:95], v[68:71], 0
    v_mfma_f32_16x16x32_bf16 v[80:83], v[48:51], v[68:71], 0
    v_mfma_f32_16x16x16_bf16 v[72:75], v[112:113], v[52:53], v[72:75]
    v_mfma_f32_16x16x16_bf16 v[76:79], v[114:115], v[52:53], v[76:79]
    v_mfma_f32_16x16x16_bf16 v[80:83], v[48:49], v[52:53], v[80:83]
    ds_read_b128 v[32:35], v124 offset:6144
    ds_read_b128 v[36:39], v124 offset:7168
    ds_read_b128 v[40:43], v124 offset:34816
    ds_read_b128 v[44:47], v124 offset:35840
    ds_read_b128 v[56:59], v124 offset:36864
    ds_read_b128 v[64:67], v124 offset:38912
    ds_read_b128 v[68:71], v124 offset:39936
    s_waitcnt lgkmcnt(0)
    s_branch L_norm_27
L_kvw_29:
    s_add_u32 s47, s47, 1
    s_add_u32 s49, s49, 1
    s_cmp_ge_u32 s49, 0x10000
    s_cbranch_scc1 L_kvb_30
    s_sleep 4
    buffer_load_dword v125, v119, s[8:11], s28 offen sc1
    s_waitcnt vmcnt(0)
    v_cmp_eq_u32 vcc, 0, v125
    s_nop 0
    s_and_b64 vcc, vcc, s[58:59]
    s_cbranch_scc1 L_kvw_29
    s_branch L_kvb_30
L_mret_32:
    s_mov_b32 s43, m0
    s_mov_b32 m0, 6144
    buffer_load_dwordx4 v[4:7], v117, s[8:11], s48 offen sc1
    buffer_load_dwordx4 v117, s[8:11], s48 offen sc1 lds
    s_mov_b32 m0, 12288
    s_mov_b32 m0, s43
    s_waitcnt vmcnt(0)
    v_max3_u32 v15, v4, v5, v6
    v_max_u32 v15, v15, v7
    v_cmp_lt_u32 vcc, s56, v15
    s_add_u32 s47, s47, 1
    s_add_u32 s49, s49, 1
    s_cmp_ge_u32 s49, 0x10000
    s_cbranch_scc1 L_mgo_33
    s_cbranch_vccnz L_mret_32
    s_branch L_mgo_33
L_smax_35:
    s_add_u32 s47, s47, 1
    s_mov_b32 s35, 0x7f800000
    s_waitcnt lgkmcnt(0)
    s_sub_u32 s43, s30, 0x41000
    s_add_u32 s40, s43, 4096
    s_nop 7
    buffer_load_dwordx4 v[56:59], v117, s[8:11], s43 offen
    buffer_load_dwordx4 v[60:63], v117, s[8:11], s43 offen offset:1024
    buffer_load_dwordx4 v[64:67], v117, s[8:11], s43 offen offset:2048
    buffer_load_dwordx4 v[68:71], v117, s[8:11], s43 offen offset:3072
    buffer_load_dwordx4 v[72:75], v117, s[8:11], s40 offen
    buffer_load_dwordx4 v[76:79], v117, s[8:11], s40 offen offset:1024
    buffer_load_dwordx4 v[80:83], v117, s[8:11], s40 offen offset:2048
    buffer_load_dwordx4 v[84:87], v117, s[8:11], s40 offen offset:3072
    ds_read_b128 v[32:35], v121 offset:16384
    ds_read_b128 v[36:39], v121 offset:17408
    ds_read_b128 v[40:43], v121 offset:18432
    ds_read_b128 v[44:47], v121 offset:19456
    v_mov_b32 v96, 0
    v_mov_b32 v97, 0
    v_mov_b32 v98, 0
    v_mov_b32 v99, 0
    v_mov_b32 v100, 0
    v_mov_b32 v101, 0
    v_mov_b32 v102, 0
    v_mov_b32 v103, 0
    v_mov_b32 v104, 0
    v_mov_b32 v105, 0
    v_mov_b32 v106, 0
    v_mov_b32 v107, 0
    v_mov_b32 v108, 0
    v_mov_b32 v109, 0
    v_mov_b32 v110, 0
    v_mov_b32 v111, 0
    s_waitcnt vmcnt(0) lgkmcnt(0)
    v_mfma_f32_16x16x32_bf16 v[56:59], v[56:59], v[32:35], 0
    v_mfma_f32_16x16x32_bf16 v[56:59], v[60:63], v[36:39], v[56:59]
    v_mfma_f32_16x16x32_bf16 v[56:59], v[64:67], v[40:43], v[56:59]
    v_mfma_f32_16x16x32_bf16 v[56:59], v[68:71], v[44:47], v[56:59]
    v_mfma_f32_16x16x32_bf16 v[60:63], v[72:75], v[32:35], 0
    v_mfma_f32_16x16x32_bf16 v[60:63], v[76:79], v[36:39], v[60:63]
    v_mfma_f32_16x16x32_bf16 v[60:63], v[80:83], v[40:43], v[60:63]
    v_mfma_f32_16x16x32_bf16 v[60:63], v[84:87], v[44:47], v[60:63]
    v_mfma_f32_16x16x32_bf16 v[64:67], v[32:35], v[32:35], 0
    v_mfma_f32_16x16x32_bf16 v[64:67], v[36:39], v[36:39], v[64:67]
    v_mfma_f32_16x16x32_bf16 v[64:67], v[40:43], v[40:43], v[64:67]
    v_mfma_f32_16x16x32_bf16 v[64:67], v[44:47], v[44:47], v[64:67]
    v_max3_f32 v84, v56, v57, v58
    v_max3_f32 v84, v84, v59, v60
    v_max3_f32 v84, v84, v61, v62
    s_nop 4
    v_max3_f32 v84, v84, v63, v64
    v_max_f32 v84, v84, v65
    v_mov_b32 v85, v84
    s_nop 1
    v_permlane32_swap_b32 v85, v84
    v_max_f32 v84, v85, v84
    v_mov_b32 v85, v84
    s_nop 1
    v_permlane16_swap_b32 v85, v84
    v_max_f32 v84, v85, v84
    v_sub_f32 v56, v56, v84
    v_sub_f32 v57, v57, v84
    v_sub_f32 v58, v58, v84
    v_sub_f32 v59, v59, v84
    v_sub_f32 v60, v60, v84
    v_sub_f32 v61, v61, v84
    v_sub_f32 v62, v62, v84
    v_sub_f32 v63, v63, v84
    v_sub_f32 v64, v64, v84
    v_sub_f32 v65, v65, v84
    v_exp_f32 v56, v56
    v_exp_f32 v57, v57
    v_exp_f32 v58, v58
    v_exp_f32 v59, v59
    v_exp_f32 v60, v60
    v_exp_f32 v61, v61
    v_exp_f32 v62, v62
    v_exp_f32 v63, v63
    v_exp_f32 v64, v64
    v_exp_f32 v65, v65
    v_cvt_pk_bf16_f32 v68, v56, v57
    v_cvt_pk_bf16_f32 v69, v58, v59
    v_cvt_pk_bf16_f32 v70, v60, v61
    v_cvt_pk_bf16_f32 v71, v62, v63
    v_cvt_pk_bf16_f32 v52, v64, v65
    s_nop 0
    v_mfma_f32_16x16x32_bf16 v[72:75], v[88:91], v[68:71], 0
    v_mfma_f32_16x16x32_bf16 v[76:79], v[92:95], v[68:71], 0
    v_mfma_f32_16x16x32_bf16 v[80:83], v[48:51], v[68:71], 0
    v_mfma_f32_16x16x16_bf16 v[72:75], v[112:113], v[52:53], v[72:75]
    v_mfma_f32_16x16x16_bf16 v[76:79], v[114:115], v[52:53], v[76:79]
    v_mfma_f32_16x16x16_bf16 v[80:83], v[48:49], v[52:53], v[80:83]
    ds_read_b128 v[32:35], v124 offset:6144
    ds_read_b128 v[36:39], v124 offset:7168
    ds_read_b128 v[40:43], v124 offset:34816
    ds_read_b128 v[44:47], v124 offset:35840
    ds_read_b128 v[56:59], v124 offset:36864
    ds_read_b128 v[64:67], v124 offset:38912
    ds_read_b128 v[68:71], v124 offset:39936
    s_waitcnt lgkmcnt(0)
    s_branch L_norm_34
L_rslow_37:
    buffer_load_dwordx4 v[4:7], v117, s[8:11], s29 offen sc1
    buffer_load_dwordx4 v[8:11], v117, s[8:11], s53 offen sc1
    buffer_load_dwordx4 v[16:19], v117, s[8:11], s29 offen offset:2048 sc1
    buffer_load_dwordx4 v[20:23], v117, s[8:11], s53 offen offset:2048 sc1
    s_add_u32 s46, s46, 1
    s_add_u32 s49, s49, 1
    s_cmp_ge_u32 s49, 0x10000
    s_cbranch_scc1 L_rgo_38
    s_waitcnt vmcnt(7)
    v_mfma_f32_16x16x32_bf16 v[48:51], v[32:35], v[12:15], 0
    v_xor_b32 v52, s33, v32
    s_waitcnt vmcnt(6)
    v_mfma_f32_16x16x32_bf16 v[48:51], v[36:39], v[12:15], v[48:51]
    v_xor_b32 v53, s33, v36
    v_or_b32 v52, v52, v53
    s_waitcnt vmcnt(5)
    v_mfma_f32_16x16x32_bf16 v[48:51], v[40:43], v[12:15], v[48:51]
    v_xor_b32 v53, s33, v40
    v_or_b32 v52, v52, v53
    s_waitcnt vmcnt(4)
    v_mfma_f32_16x16x32_bf16 v[48:51], v[44:47], v[12:15], v[48:51]
    v_xor_b32 v53, s33, v44
    v_or_b32 v52, v52, v53
    v_and_b32 v52, 1, v52
    v_cmp_ne_u32 vcc, 0, v52
    s_cbranch_vccz L_rgo_38
    buffer_load_dwordx4 v[32:35], v117, s[8:11], s29 offen sc1
    buffer_load_dwordx4 v[36:39], v117, s[8:11], s53 offen sc1
    buffer_load_dwordx4 v[40:43], v117, s[8:11], s29 offen offset:2048 sc1
    buffer_load_dwordx4 v[44:47], v117, s[8:11], s53 offen offset:2048 sc1
    s_add_u32 s46, s46, 1
    s_branch L_rl_36
L_mret_40:
    s_mov_b32 s43, m0
    s_mov_b32 m0, 7168
    buffer_load_dwordx4 v[4:7], v117, s[8:11], s48 offen sc1
    buffer_load_dwordx4 v117, s[8:11], s48 offen sc1 lds
    s_mov_b32 m0, 14336
    s_mov_b32 m0, s43
    s_waitcnt vmcnt(0)
    v_max3_u32 v15, v4, v5, v6
    v_max_u32 v15, v15, v7
    v_cmp_lt_u32 vcc, s56, v15
    s_add_u32 s47, s47, 1
    s_add_u32 s49, s49, 1
    s_cmp_ge_u32 s49, 0x10000
    s_cbranch_scc1 L_mgo_41
    s_cbranch_vccnz L_mret_40
    s_branch L_mgo_41
L_smax_43:
    s_add_u32 s47, s47, 1
    s_mov_b32 s35, 0x7f800000
    s_waitcnt lgkmcnt(0)
    s_sub_u32 s43, s30, 0x41800
    s_add_u32 s40, s43, 4096
    s_nop 7
    buffer_load_dwordx4 v[56:59], v117, s[8:11], s43 offen
    buffer_load_dwordx4 v[60:63], v117, s[8:11], s43 offen offset:1024
    buffer_load_dwordx4 v[64:67], v117, s[8:11], s43 offen offset:2048
    buffer_load_dwordx4 v[68:71], v117, s[8:11], s43 offen offset:3072
    buffer_load_dwordx4 v[72:75], v117, s[8:11], s40 offen
    buffer_load_dwordx4 v[76:79], v117, s[8:11], s40 offen offset:1024
    buffer_load_dwordx4 v[80:83], v117, s[8:11], s40 offen offset:2048
    buffer_load_dwordx4 v[84:87], v117, s[8:11], s40 offen offset:3072
    ds_read_b128 v[32:35], v121 offset:16384
    ds_read_b128 v[36:39], v121 offset:17408
    ds_read_b128 v[40:43], v121 offset:18432
    ds_read_b128 v[44:47], v121 offset:19456
    v_mov_b32 v96, 0
    v_mov_b32 v97, 0
    v_mov_b32 v98, 0
    v_mov_b32 v99, 0
    v_mov_b32 v100, 0
    v_mov_b32 v101, 0
    v_mov_b32 v102, 0
    v_mov_b32 v103, 0
    v_mov_b32 v104, 0
    v_mov_b32 v105, 0
    v_mov_b32 v106, 0
    v_mov_b32 v107, 0
    v_mov_b32 v108, 0
    v_mov_b32 v109, 0
    v_mov_b32 v110, 0
    v_mov_b32 v111, 0
    s_waitcnt vmcnt(0) lgkmcnt(0)
    v_mfma_f32_16x16x32_bf16 v[56:59], v[56:59], v[32:35], 0
    v_mfma_f32_16x16x32_bf16 v[56:59], v[60:63], v[36:39], v[56:59]
    v_mfma_f32_16x16x32_bf16 v[56:59], v[64:67], v[40:43], v[56:59]
    v_mfma_f32_16x16x32_bf16 v[56:59], v[68:71], v[44:47], v[56:59]
    v_mfma_f32_16x16x32_bf16 v[60:63], v[72:75], v[32:35], 0
    v_mfma_f32_16x16x32_bf16 v[60:63], v[76:79], v[36:39], v[60:63]
    v_mfma_f32_16x16x32_bf16 v[60:63], v[80:83], v[40:43], v[60:63]
    v_mfma_f32_16x16x32_bf16 v[60:63], v[84:87], v[44:47], v[60:63]
    v_mfma_f32_16x16x32_bf16 v[64:67], v[32:35], v[32:35], 0
    v_mfma_f32_16x16x32_bf16 v[64:67], v[36:39], v[36:39], v[64:67]
    v_mfma_f32_16x16x32_bf16 v[64:67], v[40:43], v[40:43], v[64:67]
    v_mfma_f32_16x16x32_bf16 v[64:67], v[44:47], v[44:47], v[64:67]
    v_max3_f32 v84, v56, v57, v58
    v_max3_f32 v84, v84, v59, v60
    v_max3_f32 v84, v84, v61, v62
    s_nop 4
    v_max3_f32 v84, v84, v63, v64
    v_max_f32 v84, v84, v65
    v_mov_b32 v85, v84
    s_nop 1
    v_permlane32_swap_b32 v85, v84
    v_max_f32 v84, v85, v84
    v_mov_b32 v85, v84
    s_nop 1
    v_permlane16_swap_b32 v85, v84
    v_max_f32 v84, v85, v84
    v_sub_f32 v56, v56, v84
    v_sub_f32 v57, v57, v84
    v_sub_f32 v58, v58, v84
    v_sub_f32 v59, v59, v84
    v_sub_f32 v60, v60, v84
    v_sub_f32 v61, v61, v84
    v_sub_f32 v62, v62, v84
    v_sub_f32 v63, v63, v84
    v_sub_f32 v64, v64, v84
    v_sub_f32 v65, v65, v84
    v_exp_f32 v56, v56
    v_exp_f32 v57, v57
    v_exp_f32 v58, v58
    v_exp_f32 v59, v59
    v_exp_f32 v60, v60
    v_exp_f32 v61, v61
    v_exp_f32 v62, v62
    v_exp_f32 v63, v63
    v_exp_f32 v64, v64
    v_exp_f32 v65, v65
    v_cvt_pk_bf16_f32 v68, v56, v57
    v_cvt_pk_bf16_f32 v69, v58, v59
    v_cvt_pk_bf16_f32 v70, v60, v61
    v_cvt_pk_bf16_f32 v71, v62, v63
    v_cvt_pk_bf16_f32 v52, v64, v65
    s_nop 0
    v_mfma_f32_16x16x32_bf16 v[72:75], v[88:91], v[68:71], 0
    v_mfma_f32_16x16x32_bf16 v[76:79], v[92:95], v[68:71], 0
    v_mfma_f32_16x16x32_bf16 v[80:83], v[48:51], v[68:71], 0
    v_mfma_f32_16x16x16_bf16 v[72:75], v[112:113], v[52:53], v[72:75]
    v_mfma_f32_16x16x16_bf16 v[76:79], v[114:115], v[52:53], v[76:79]
    v_mfma_f32_16x16x16_bf16 v[80:83], v[48:49], v[52:53], v[80:83]
    ds_read_b128 v[32:35], v124 offset:6144
    ds_read_b128 v[36:39], v124 offset:7168
    ds_read_b128 v[40:43], v124 offset:34816
    ds_read_b128 v[44:47], v124 offset:35840
    ds_read_b128 v[56:59], v124 offset:36864
    ds_read_b128 v[64:67], v124 offset:38912
    ds_read_b128 v[68:71], v124 offset:39936
    s_waitcnt lgkmcnt(0)
    s_branch L_norm_42
L_rslow_45:
    buffer_load_dwordx4 v[4:7], v117, s[8:11], s29 offen sc1
    buffer_load_dwordx4 v[8:11], v117, s[8:11], s53 offen sc1
    buffer_load_dwordx4 v[16:19], v117, s[8:11], s29 offen offset:2048 sc1
    buffer_load_dwordx4 v[20:23], v117, s[8:11], s53 offen offset:2048 sc1
    s_add_u32 s46, s46, 1
    s_add_u32 s49, s49, 1
    s_cmp_ge_u32 s49, 0x10000
    s_cbranch_scc1 L_rgo_46
    s_waitcnt vmcnt(7)
    v_mfma_f32_16x16x32_bf16 v[48:51], v[32:35], v[12:15], 0
    v_xor_b32 v52, s33, v32
    s_waitcnt vmcnt(6)
    v_mfma_f32_16x16x32_bf16 v[48:51], v[36:39], v[12:15], v[48:51]
    v_xor_b32 v53, s33, v36
    v_or_b32 v52, v52, v53
    s_waitcnt vmcnt(5)
    v_mfma_f32_16x16x32_bf16 v[48:51], v[40:43], v[12:15], v[48:51]
    v_xor_b32 v53, s33, v40
    v_or_b32 v52, v52, v53
    s_waitcnt vmcnt(4)
    v_mfma_f32_16x16x32_bf16 v[48:51], v[44:47], v[12:15], v[48:51]
    v_xor_b32 v53, s33, v44
    v_or_b32 v52, v52, v53
    v_and_b32 v52, 1, v52
    v_cmp_ne_u32 vcc, 0, v52
    s_cbranch_vccz L_rgo_46
    buffer_load_dwordx4 v[32:35], v117, s[8:11], s29 offen sc1
    buffer_load_dwordx4 v[36:39], v117, s[8:11], s53 offen sc1
    buffer_load_dwordx4 v[40:43], v117, s[8:11], s29 offen offset:2048 sc1
    buffer_load_dwordx4 v[44:47], v117, s[8:11], s53 offen offset:2048 sc1
    s_add_u32 s46, s46, 1
    s_branch L_rl_44
L_zero:
    s_waitcnt lgkmcnt(0)
    s_and_b32 s9, s9, 0xffff
    s_mov_b32 s10, 0x10000000
    s_mov_b32 s11, 0x20000
    s_and_b32 s93, s93, 0xffff
    s_mov_b32 s94, 0x100
    s_mov_b32 s95, 0x20000
    s_mov_b32 s87, 0
    s_cmp_lg_u32 s86, 0
    s_cbranch_scc1 L_reg_47
    s_lshl_b32 s97, s84, 4
    s_lshl_b32 s96, 1, s85
    v_mov_b32 v250, s96
    v_mov_b32 v251, 256
    s_mov_b64 exec, 1
    buffer_atomic_add_x2 v[250:251], off, s[92:95], s97 offset:64
    s_mov_b64 exec, -1
    s_mov_b32 s86, 1
L_reg_47:
    v_mov_b32 v4, 0
    v_mov_b32 v5, 0
    v_mov_b32 v6, 0
    v_mov_b32 v7, 0
    v_lshlrev_b32 v1, 4, v0
    s_mov_b32 s97, 0x0
    buffer_store_dwordx4 v[4:7], v1, s[8:11], s97 offen sc1
    s_mov_b32 s97, 0x1000
    buffer_store_dwordx4 v[4:7], v1, s[8:11], s97 offen sc1
    s_mov_b32 s97, 0x2000
    buffer_store_dwordx4 v[4:7], v1, s[8:11], s97 offen sc1
    s_mov_b32 s97, 0x3000
    buffer_store_dwordx4 v[4:7], v1, s[8:11], s97 offen sc1
    s_mov_b32 s97, 0x4000
    buffer_store_dwordx4 v[4:7], v1, s[8:11], s97 offen sc1
    s_mov_b32 s97, 0x5000
    buffer_store_dwordx4 v[4:7], v1, s[8:11], s97 offen sc1
    s_mov_b32 s97, 0x6000
    buffer_store_dwordx4 v[4:7], v1, s[8:11], s97 offen sc1
    s_mov_b32 s97, 0x7000
    buffer_store_dwordx4 v[4:7], v1, s[8:11], s97 offen sc1
    s_mov_b32 s97, 0x8000
    buffer_store_dwordx4 v[4:7], v1, s[8:11], s97 offen sc1
    s_mov_b32 s97, 0x9000
    buffer_store_dwordx4 v[4:7], v1, s[8:11], s97 offen sc1
    s_mov_b32 s97, 0xa000
    buffer_store_dwordx4 v[4:7], v1, s[8:11], s97 offen sc1
    s_waitcnt vmcnt(0)
    s_barrier
    s_cmp_lg_u32 s100, 0
    s_cbranch_scc1 L_flag_48
    v_mov_b32 v2, 1
    s_mov_b64 exec, 1
    buffer_store_dword v2, off, s[92:95], 40 sc1
    s_mov_b64 exec, -1
L_flag_48:
    s_cmp_lg_u32 s100, 0
    s_cbranch_scc1 L_noz
    s_mov_b64 exec, 0xff
    s_mov_b32 s96, 0
L_count:
    buffer_load_dwordx2 v[2:3], v1, s[92:95], 0 offen offset:64 sc1
    s_waitcnt vmcnt(0)
    v_cmp_le_u32 vcc, 8192, v3
    v_add_u32 v2, 1, v2
    v_xor_b32 v3, 8192, v3
    v_or_b32 v2, v2, v3
    s_mov_b32 s4, vcc_lo
    v_cmp_eq_u32 vcc, 0, v2
    v_mov_b32 v2, 1
    s_nop 1
    s_cmp_eq_u32 vcc_lo, 0xff
    s_cbranch_scc1 L_propose
    v_mov_b32 v2, 2
    s_andn2_b32 s4, s4, vcc_lo
    s_cbranch_scc1 L_propose
    s_sleep 2
    s_add_u32 s96, s96, 1
    s_cmp_lt_u32 s96, 0x100
    s_cbranch_scc1 L_count
L_propose:
    v_mov_b32 v3, 0
    s_mov_b64 exec, 1
    buffer_atomic_cmpswap v[2:3], off, s[92:95], 0 offset:36
    s_mov_b64 exec, -1
    s_branch L_noz
L_fallback:
    s_mov_b32 s87, 2
    s_waitcnt vmcnt(0) lgkmcnt(0)
    s_barrier
    v_mbcnt_lo_u32_b32 v0, -1, 0
    v_mbcnt_hi_u32_b32 v0, -1, v0
    s_lshl_b32 s96, s100, 6
    v_add_u32 v0, s96, v0
    s_mov_b32 s97, 44
    s_cmp_lg_u32 s100, 0
    s_cbranch_scc1 L_at_49
    s_mov_b64 exec, 1
    v_mov_b32 v2, 1
    buffer_atomic_add v2, off, s[92:95], s97 sc0
    s_mov_b64 exec, -1
L_at_49:
    s_cmp_lg_u32 s100, 0
    s_cbranch_scc1 L_at2_50
    s_mov_b64 exec, 1
    v_mov_b32 v1, 8
    s_waitcnt vmcnt(0)
    ds_write_b32 v1, v2
    s_waitcnt lgkmcnt(0)
    s_mov_b64 exec, -1
L_at2_50:
    s_barrier
    v_mov_b32 v1, 8
    ds_read_b32 v2, v1
    s_waitcnt lgkmcnt(0)
    v_readfirstlane_b32 s85, v2
    s_barrier
    s_sub_u32 s101, s85, 32
    s_cmp_ge_u32 s85, 32
    s_cbranch_scc1 L_bulk
    s_mov_b32 s20, s85
    v_lshrrev_b32 v4, 6, v0
    s_nop 0
    v_readfirstlane_b32 s21, v4
    v_and_b32 v1, 63, v0
    v_lshrrev_b32 v2, 4, v1
    v_and_b32 v3, 15, v1
    v_lshrrev_b32 v6, 2, v3
    v_lshlrev_b32 v117, 4, v1
    s_lshl_b32 s51, s21, 10
    s_lshl_b32 s52, s21, 11
    s_load_dwordx8 s[60:67], s[0:1], 16
    s_mov_b32 s14, 0x400000
    s_mov_b32 s15, 0x20000
    s_lshl_b32 s41, s20, 8
    s_lshl_b32 s42, s20, 17
    s_lshr_b32 s43, s21, 1
    s_lshl_b32 s43, s43, 2
    v_or_b32 v5, s43, v2
    v_lshlrev_b32 v5, 1, v5
    v_xor_b32 v5, v5, v3
    v_lshrrev_b32 v14, 2, v5
    v_and_b32 v14, 2, v14
    v_lshlrev_b32 v5, 4, v5
    s_lshl_b32 s43, s21, 4
    v_add_u32 v4, s43, v2
    v_lshl_add_u32 v8, v4, 13, v5
    s_waitcnt lgkmcnt(0)
    s_mov_b32 s16, s92
    s_mov_b32 s17, s93
    s_mov_b32 s18, s94
    s_mov_b32 s19, s95
    s_mov_b32 s88, s20
    s_mov_b32 s12, s60
    s_and_b32 s13, s61, 0xffff
    v_xor_b32 v15, 0, v14
    v_lshl_add_u32 v15, v15, 15, v8
    s_add_u32 s43, s41, 0x0
    s_add_u32 m0, s51, 0x8000
    s_nop 0
    buffer_load_dwordx4 v15, s[12:15], s43 offen lds
    s_add_u32 s43, s41, 0x8000
    s_add_u32 m0, s51, 0x9000
    s_nop 0
    buffer_load_dwordx4 v15, s[12:15], s43 offen lds
    s_add_u32 s43, s41, 0x100000
    s_add_u32 m0, s51, 0xa000
    s_nop 0
    buffer_load_dwordx4 v15, s[12:15], s43 offen lds
    s_add_u32 s43, s41, 0x108000
    s_add_u32 m0, s51, 0xb000
    s_nop 0
    buffer_load_dwordx4 v15, s[12:15], s43 offen lds
    s_add_u32 s43, s41, 0x200000
    s_add_u32 m0, s51, 0xc000
    s_nop 0
    buffer_load_dwordx4 v15, s[12:15], s43 offen lds
    s_add_u32 s43, s41, 0x208000
    s_add_u32 m0, s51, 0xd000
    s_nop 0
    buffer_load_dwordx4 v15, s[12:15], s43 offen lds
    s_add_u32 s43, s41, 0x300000
    s_add_u32 m0, s51, 0xe000
    s_nop 0
    buffer_load_dwordx4 v15, s[12:15], s43 offen lds
    s_add_u32 s43, s41, 0x308000
    s_add_u32 m0, s51, 0xf000
    s_nop 0
    buffer_load_dwordx4 v15, s[12:15], s43 offen lds
    v_xor_b32 v15, 2, v14
    v_lshl_add_u32 v15, v15, 15, v8
    s_add_u32 s43, s41, 0x0
    s_add_u32 m0, s51, 0x10000
    s_nop 0
    buffer_load_dwordx4 v15, s[12:15], s43 offen lds
    s_add_u32 s43, s41, 0x8000
    s_add_u32 m0, s51, 0x11000
    s_nop 0
    buffer_load_dwordx4 v15, s[12:15], s43 offen lds
    s_add_u32 s43, s41, 0x100000
    s_add_u32 m0, s51, 0x12000
    s_nop 0
    buffer_load_dwordx4 v15, s[12:15], s43 offen lds
    s_add_u32 s43, s41, 0x108000
    s_add_u32 m0, s51, 0x13000
    s_nop 0
    buffer_load_dwordx4 v15, s[12:15], s43 offen lds
    s_add_u32 s43, s41, 0x200000
    s_add_u32 m0, s51, 0x14000
    s_nop 0
    buffer_load_dwordx4 v15, s[12:15], s43 offen lds
    s_add_u32 s43, s41, 0x208000
    s_add_u32 m0, s51, 0x15000
    s_nop 0
    buffer_load_dwordx4 v15, s[12:15], s43 offen lds
    s_add_u32 s43, s41, 0x300000
    s_add_u32 m0, s51, 0x16000
    s_nop 0
    buffer_load_dwordx4 v15, s[12:15], s43 offen lds
    s_add_u32 s43, s41, 0x308000
    s_add_u32 m0, s51, 0x17000
    s_nop 0
    buffer_load_dwordx4 v15, s[12:15], s43 offen lds
    v_xor_b32 v15, 0, v14
    v_lshl_add_u32 v15, v15, 15, v8
    s_add_u32 s43, s41, 0x80000
    s_add_u32 m0, s51, 0x18000
    s_nop 0
    buffer_load_dwordx4 v15, s[12:15], s43 offen lds
    s_add_u32 s43, s41, 0x88000
    s_add_u32 m0, s51, 0x19000
    s_nop 0
    buffer_load_dwordx4 v15, s[12:15], s43 offen lds
    s_add_u32 s43, s41, 0x180000
    s_add_u32 m0, s51, 0x1a000
    s_nop 0
    buffer_load_dwordx4 v15, s[12:15], s43 offen lds
    s_add_u32 s43, s41, 0x188000
    s_add_u32 m0, s51, 0x1b000
    s_nop 0
    buffer_load_dwordx4 v15, s[12:15], s43 offen lds
    v_and_b32 v4, 2, v3
    v_cmp_ne_u32 vcc, 0, v4
    v_mov_b32 v4, 0x4444
    v_mov_b32 v5, 0xeeee
    v_cndmask_b32 v116, v4, v5, vcc
    v_lshrrev_b32 v5, 1, v2
    v_lshl_add_u32 v4, v6, 3, v5
    s_lshl_b32 s43, s21, 1
    v_add_u32 v4, s43, v4
    v_add_u32 v5, s20, v4
    v_and_b32 v5, 31, v5
    v_lshl_add_u32 v4, v4, 6, v5
    v_and_b32 v5, 1, v2
    v_lshl_add_u32 v4, v4, 1, v5
    v_and_b32 v5, 3, v3
    v_lshl_add_u32 v4, v4, 2, v5
    v_lshlrev_b32 v118, 4, v4
    v_and_b32 v4, 1, v2
    v_lshlrev_b32 v4, 2, v4
    v_and_b32 v7, 2, v2
    v_add_u32 v4, v4, v7
    v_and_b32 v7, 1, v6
    v_add_u32 v4, v4, v7
    v_lshl_add_u32 v4, v4, 2, v5
    v_lshlrev_b32 v4, 2, v4
    s_and_b32 s43, s21, 1
    s_lshl_b32 s43, s43, 12
    s_lshl_b32 s40, s20, 7
    s_add_u32 s43, s43, s40
    v_add_u32 v119, s43, v4
    v_sub_u32 v7, 0, v2
    v_and_b32 v7, 3, v7
    v_xor_b32 v7, v7, v6
    v_lshl_add_u32 v4, v2, 4, v7
    v_and_b32 v5, 3, v3
    v_lshl_add_u32 v4, v4, 2, v5
    s_add_u32 s43, s51, 16384
    v_lshl_add_u32 v120, v4, 2, s43
    v_sub_u32 v7, 0, v6
    v_and_b32 v7, 3, v7
    v_xor_b32 v7, v7, v2
    v_lshl_add_u32 v4, v3, 2, v7
    v_lshlrev_b32 v121, 4, v4
    v_and_b32 v5, 1, v3
    v_lshl_add_u32 v4, v6, 1, v5
    v_lshl_add_u32 v4, v2, 3, v4
    v_lshlrev_b32 v127, 4, v4
    v_and_or_b32 v122, v116, 8, v127
    s_lshl_b32 s43, s21, 13
    s_add_u32 s43, s43, 32768
    v_add_u32 v123, s43, v117
    v_add_u32 v124, 0x10000, v123
    s_mov_b32 s36, 0xcccccccc
    s_mov_b32 s37, 0xcccccccc
    s_mov_b32 s38, 0x00ff00ff
    s_mov_b32 s39, 0x00ff00ff
    s_mov_b32 s34, 0x3e0293ee
    s_mov_b32 s35, 0x49800000
    s_mov_b32 s50, 0x3f803f80
    v_and_b32 v5, 1, v2
    v_or_b32 v5, 0, v5
    v_xor_b32 v5, v5, v6
    v_and_b32 v7, 2, v5
    v_add_u32 v5, v5, v7
    v_lshlrev_b32 v5, 6, v5
    v_and_b32 v7, 3, v3
    v_lshl_add_u32 v7, v7, 4, v5
    s_lshl_b32 s43, s21, 2
    v_add_u32 v4, s43, v2
    v_lshl_add_u32 v10, v4, 10, v7
    v_and_b32 v5, 1, v2
    v_or_b32 v5, 2, v5
    v_xor_b32 v5, v5, v6
    v_and_b32 v7, 2, v5
    v_add_u32 v5, v5, v7
    v_lshlrev_b32 v5, 6, v5
    v_and_b32 v7, 3, v3
    v_lshl_add_u32 v7, v7, 4, v5
    s_lshl_b32 s43, s21, 2
    v_add_u32 v4, s43, v2
    v_lshl_add_u32 v9, v4, 10, v7
    v_and_b32 v5, 1, v2
    v_lshl_add_u32 v4, v5, 3, v6
    v_lshrrev_b32 v7, 1, v2
    v_lshl_add_u32 v4, v7, 5, v4
    v_lshlrev_b32 v4, 8, v4
    v_lshl_or_b32 v5, v5, 2, v6
    v_lshlrev_b32 v5, 5, v5
    s_lshl_b32 s43, s21, 6
    v_xor_b32 v5, s43, v5
    v_add_u32 v4, v4, v5
    v_and_b32 v5, 3, v3
    v_lshl_add_u32 v4, v5, 3, v4
    v_add_u32 v11, 32768, v4
    s_and_b32 s43, s21, 1
    s_lshl_b32 s43, s43, 12
    v_add_u32 v11, s43, v11
    v_and_b32 v5, 1, v2
    v_lshlrev_b32 v4, 4, v5
    v_lshl_add_u32 v4, v7, 2, v4
    v_and_b32 v7, 1, v6
    v_add_u32 v4, v4, v7
    s_lshl_b32 s43, s21, 5
    v_add_u32 v4, s43, v4
    v_lshlrev_b32 v4, 8, v4
    v_lshl_or_b32 v5, v5, 1, v7
    s_lshl_b32 s43, s21, 1
    s_and_b32 s43, s43, 3
    v_xor_b32 v5, s43, v5
    v_lshl_add_u32 v4, v5, 6, v4
    v_lshrrev_b32 v5, 1, v6
    v_lshl_add_u32 v4, v5, 5, v4
    v_and_b32 v5, 3, v3
    v_lshl_add_u32 v4, v5, 3, v4
    v_add_u32 v12, 32768, v4
    v_mov_b32 v16, -1
    v_mov_b32 v17, -1
    v_mov_b32 v18, -1
    v_mov_b32 v19, -1
    s_lshl_b32 s43, s20, 13
    s_add_u32 s43, s43, 0x7100000
    s_and_b32 s40, s21, 1
    s_lshl_b32 s40, s40, 12
    s_add_u32 s29, s43, s40
    s_add_u32 s43, s43, s52
    s_xor_b32 s40, s43, 0x40000
    buffer_store_dwordx4 v[16:19], v117, s[8:11], s43 offen sc1
    buffer_store_dwordx4 v[16:19], v117, s[8:11], s43 offen offset:1024 sc1
    buffer_store_dwordx4 v[16:19], v117, s[8:11], s40 offen sc1
    buffer_store_dwordx4 v[16:19], v117, s[8:11], s40 offen offset:1024 sc1
    s_mov_b32 s43, 0x7012000
    buffer_store_dword v16, v119, s[8:11], s43 offen sc1
    s_mov_b32 s43, 0x7014000
    buffer_store_dword v16, v119, s[8:11], s43 offen sc1
    s_mov_b32 s43, 0x7016000
    buffer_store_dword v16, v119, s[8:11], s43 offen sc1
    s_load_dwordx2 s[4:5], s[0:1], 8
    s_waitcnt lgkmcnt(0)
    s_and_b32 s5, s5, 0xffff
    s_mov_b32 s6, 8192
    s_mov_b32 s7, 0x20000
    v_and_b32 v20, 1, v2
    v_and_b32 v21, 1, v6
    v_lshl_add_u32 v20, v20, 1, v21
    v_lshlrev_b32 v20, 9, v20
    v_and_b32 v21, 3, v3
    v_lshl_add_u32 v20, v21, 4, v20
    v_and_b32 v21, 2, v2
    v_add_u32 v20, v20, v21
    s_and_b32 s43, s20, 1
    s_lshl_b32 s43, s43, 11
    s_bfe_u32 s40, s20, 0x20001
    s_lshl_b32 s40, s40, 7
    s_add_u32 s43, s43, s40
    s_and_b32 s40, s21, 1
    s_lshl_b32 s40, s40, 6
    s_add_u32 s43, s43, s40
    s_lshr_b32 s40, s20, 3
    s_lshl_b32 s40, s40, 2
    s_add_u32 s43, s43, s40
    v_add_u32 v20, s43, v20
    v_lshlrev_b32 v20, 1, v20
    buffer_load_dword v21, v20, s[4:7], 0 offen
    s_mov_b32 s57, 0
    s_lshl_b32 s43, s20, 13
    s_add_u32 s43, s43, s52
    s_add_u32 s30, s43, 0x1000000
    s_add_u32 s31, s43, 0x2000000
    s_lshr_b32 s43, s43, 1
    s_add_u32 s32, s43, 0x220000
    s_waitcnt vmcnt(20)
    s_barrier
    v_xor_b32 v13, 0x0, v11
    v_add_u32 v13, 0x0, v13
    ds_read_b64_tr_b16 v[80:81], v13
    ds_read_b64_tr_b16 v[82:83], v13 offset:1024
    ds_read_b64_tr_b16 v[84:85], v13 offset:16384
    ds_read_b64_tr_b16 v[86:87], v13 offset:17408
    v_xor_b32 v13, 0x20, v11
    v_add_u32 v13, 0x0, v13
    ds_read_b64_tr_b16 v[56:57], v13
    ds_read_b64_tr_b16 v[58:59], v13 offset:1024
    ds_read_b64_tr_b16 v[60:61], v13 offset:16384
    ds_read_b64_tr_b16 v[62:63], v13 offset:17408
    v_xor_b32 v13, 0x1000, v11
    v_add_u32 v13, 0x0, v13
    ds_read_b64_tr_b16 a[0:1], v13
    ds_read_b64_tr_b16 a[2:3], v13 offset:1024
    ds_read_b64_tr_b16 a[4:5], v13 offset:16384
    ds_read_b64_tr_b16 a[6:7], v13 offset:17408
    v_xor_b32 v13, 0x1020, v11
    v_add_u32 v13, 0x0, v13
    ds_read_b64_tr_b16 a[8:9], v13
    ds_read_b64_tr_b16 a[10:11], v13 offset:1024
    ds_read_b64_tr_b16 a[12:13], v13 offset:16384
    ds_read_b64_tr_b16 a[14:15], v13 offset:17408
    s_waitcnt lgkmcnt(0)
    s_barrier
    s_add_u32 s43, s41, 0x280000
    s_add_u32 m0, s51, 0x1c000
    s_nop 0
    buffer_load_dwordx4 v15, s[12:15], s43 offen lds
    s_add_u32 s43, s41, 0x288000
    s_add_u32 m0, s51, 0x1d000
    s_nop 0
    buffer_load_dwordx4 v15, s[12:15], s43 offen lds
    s_add_u32 s43, s41, 0x380000
    s_add_u32 m0, s51, 0x1e000
    s_nop 0
    buffer_load_dwordx4 v15, s[12:15], s43 offen lds
    s_add_u32 s43, s41, 0x388000
    s_add_u32 m0, s51, 0x1f000
    s_nop 0
    buffer_load_dwordx4 v15, s[12:15], s43 offen lds
    v_xor_b32 v15, 2, v14
    v_lshl_add_u32 v15, v15, 15, v8
    s_add_u32 s43, s41, 0x80000
    s_add_u32 m0, s51, 0x20000
    s_nop 0
    buffer_load_dwordx4 v15, s[12:15], s43 offen lds
    s_add_u32 s43, s41, 0x88000
    s_add_u32 m0, s51, 0x21000
    s_nop 0
    buffer_load_dwordx4 v15, s[12:15], s43 offen lds
    s_add_u32 s43, s41, 0x180000
    s_add_u32 m0, s51, 0x22000
    s_nop 0
    buffer_load_dwordx4 v15, s[12:15], s43 offen lds
    s_add_u32 s43, s41, 0x188000
    s_add_u32 m0, s51, 0x23000
    s_nop 0
    buffer_load_dwordx4 v15, s[12:15], s43 offen lds
    s_waitcnt vmcnt(20)
    s_barrier
    v_xor_b32 v13, 0x0, v11
    v_add_u32 v13, 0x8000, v13
    ds_read_b64_tr_b16 a[32:33], v13
    ds_read_b64_tr_b16 a[34:35], v13 offset:1024
    ds_read_b64_tr_b16 a[36:37], v13 offset:16384
    ds_read_b64_tr_b16 a[38:39], v13 offset:17408
    v_xor_b32 v13, 0x20, v11
    v_add_u32 v13, 0x8000, v13
    ds_read_b64_tr_b16 a[40:41], v13
    ds_read_b64_tr_b16 a[42:43], v13 offset:1024
    ds_read_b64_tr_b16 a[44:45], v13 offset:16384
    ds_read_b64_tr_b16 a[46:47], v13 offset:17408
    v_xor_b32 v13, 0x1000, v11
    v_add_u32 v13, 0x8000, v13
    ds_read_b64_tr_b16 a[64:65], v13
    ds_read_b64_tr_b16 a[66:67], v13 offset:1024
    ds_read_b64_tr_b16 a[68:69], v13 offset:16384
    ds_read_b64_tr_b16 a[70:71], v13 offset:17408
    v_xor_b32 v13, 0x1020, v11
    v_add_u32 v13, 0x8000, v13
    ds_read_b64_tr_b16 a[72:73], v13
    ds_read_b64_tr_b16 a[74:75], v13 offset:1024
    ds_read_b64_tr_b16 a[76:77], v13 offset:16384
    ds_read_b64_tr_b16 a[78:79], v13 offset:17408
    s_waitcnt lgkmcnt(0)
    s_barrier
    s_add_u32 s43, s41, 0x280000
    s_add_u32 m0, s51, 0x24000
    s_nop 0
    buffer_load_dwordx4 v15, s[12:15], s43 offen lds
    s_add_u32 s43, s41, 0x288000
    s_add_u32 m0, s51, 0x25000
    s_nop 0
    buffer_load_dwordx4 v15, s[12:15], s43 offen lds
    s_add_u32 s43, s41, 0x380000
    s_add_u32 m0, s51, 0x26000
    s_nop 0
    buffer_load_dwordx4 v15, s[12:15], s43 offen lds
    s_add_u32 s43, s41, 0x388000
    s_add_u32 m0, s51, 0x27000
    s_nop 0
    buffer_load_dwordx4 v15, s[12:15], s43 offen lds
    s_mov_b32 s12, s62
    s_and_b32 s13, s63, 0xffff
    v_xor_b32 v15, 0, v14
    v_lshl_add_u32 v15, v15, 15, v8
    s_add_u32 s43, s41, 0x0
    s_add_u32 m0, s51, 0x8000
    s_nop 0
    buffer_load_dwordx4 v15, s[12:15], s43 offen lds
    s_add_u32 s43, s41, 0x8000
    s_add_u32 m0, s51, 0x9000
    s_nop 0
    buffer_load_dwordx4 v15, s[12:15], s43 offen lds
    s_add_u32 s43, s41, 0x100000
    s_add_u32 m0, s51, 0xa000
    s_nop 0
    buffer_load_dwordx4 v15, s[12:15], s43 offen lds
    s_add_u32 s43, s41, 0x108000
    s_add_u32 m0, s51, 0xb000
    s_nop 0
    buffer_load_dwordx4 v15, s[12:15], s43 offen lds
    s_waitcnt vmcnt(12)
    s_barrier
    v_xor_b32 v13, 0x0, v11
    v_add_u32 v13, 0x10000, v13
    ds_read_b64_tr_b16 v[88:89], v13
    ds_read_b64_tr_b16 v[90:91], v13 offset:1024
    ds_read_b64_tr_b16 v[92:93], v13 offset:16384
    ds_read_b64_tr_b16 v[94:95], v13 offset:17408
    v_xor_b32 v13, 0x20, v11
    v_add_u32 v13, 0x10000, v13
    ds_read_b64_tr_b16 v[96:97], v13
    ds_read_b64_tr_b16 v[98:99], v13 offset:1024
    ds_read_b64_tr_b16 v[100:101], v13 offset:16384
    ds_read_b64_tr_b16 v[102:103], v13 offset:17408
    v_xor_b32 v13, 0x1000, v11
    v_add_u32 v13, 0x10000, v13
    ds_read_b64_tr_b16 a[16:17], v13
    ds_read_b64_tr_b16 a[18:19], v13 offset:1024
    ds_read_b64_tr_b16 a[20:21], v13 offset:16384
    ds_read_b64_tr_b16 a[22:23], v13 offset:17408
    v_xor_b32 v13, 0x1020, v11
    v_add_u32 v13, 0x10000, v13
    ds_read_b64_tr_b16 a[24:25], v13
    ds_read_b64_tr_b16 a[26:27], v13 offset:1024
    ds_read_b64_tr_b16 a[28:29], v13 offset:16384
    ds_read_b64_tr_b16 a[30:31], v13 offset:17408
    s_waitcnt lgkmcnt(0)
    s_barrier
    s_add_u32 s43, s41, 0x200000
    s_add_u32 m0, s51, 0xc000
    s_nop 0
    buffer_load_dwordx4 v15, s[12:15], s43 offen lds
    s_add_u32 s43, s41, 0x208000
    s_add_u32 m0, s51, 0xd000
    s_nop 0
    buffer_load_dwordx4 v15, s[12:15], s43 offen lds
    s_add_u32 s43, s41, 0x300000
    s_add_u32 m0, s51, 0xe000
    s_nop 0
    buffer_load_dwordx4 v15, s[12:15], s43 offen lds
    s_add_u32 s43, s41, 0x308000
    s_add_u32 m0, s51, 0xf000
    s_nop 0
    buffer_load_dwordx4 v15, s[12:15], s43 offen lds
    v_xor_b32 v15, 2, v14
    v_lshl_add_u32 v15, v15, 15, v8
    s_add_u32 s43, s41, 0x0
    s_add_u32 m0, s51, 0x10000
    s_nop 0
    buffer_load_dwordx4 v15, s[12:15], s43 offen lds
    s_add_u32 s43, s41, 0x8000
    s_add_u32 m0, s51, 0x11000
    s_nop 0
    buffer_load_dwordx4 v15, s[12:15], s43 offen lds
    s_add_u32 s43, s41, 0x100000
    s_add_u32 m0, s51, 0x12000
    s_nop 0
    buffer_load_dwordx4 v15, s[12:15], s43 offen lds
    s_add_u32 s43, s41, 0x108000
    s_add_u32 m0, s51, 0x13000
    s_nop 0
    buffer_load_dwordx4 v15, s[12:15], s43 offen lds
    s_waitcnt vmcnt(12)
    s_barrier
    v_xor_b32 v13, 0x0, v11
    v_add_u32 v13, 0x18000, v13
    ds_read_b64_tr_b16 a[48:49], v13
    ds_read_b64_tr_b16 a[50:51], v13 offset:1024
    ds_read_b64_tr_b16 a[52:53], v13 offset:16384
    ds_read_b64_tr_b16 a[54:55], v13 offset:17408
    v_xor_b32 v13, 0x20, v11
    v_add_u32 v13, 0x18000, v13
    ds_read_b64_tr_b16 a[56:57], v13
    ds_read_b64_tr_b16 a[58:59], v13 offset:1024
    ds_read_b64_tr_b16 a[60:61], v13 offset:16384
    ds_read_b64_tr_b16 a[62:63], v13 offset:17408
    v_xor_b32 v13, 0x1000, v11
    v_add_u32 v13, 0x18000, v13
    ds_read_b64_tr_b16 a[80:81], v13
    ds_read_b64_tr_b16 a[82:83], v13 offset:1024
    ds_read_b64_tr_b16 a[84:85], v13 offset:16384
    ds_read_b64_tr_b16 a[86:87], v13 offset:17408
    v_xor_b32 v13, 0x1020, v11
    v_add_u32 v13, 0x18000, v13
    ds_read_b64_tr_b16 a[88:89], v13
    ds_read_b64_tr_b16 a[90:91], v13 offset:1024
    ds_read_b64_tr_b16 a[92:93], v13 offset:16384
    ds_read_b64_tr_b16 a[94:95], v13 offset:17408
    s_waitcnt lgkmcnt(0)
    s_barrier
    s_add_u32 s43, s41, 0x200000
    s_add_u32 m0, s51, 0x14000
    s_nop 0
    buffer_load_dwordx4 v15, s[12:15], s43 offen lds
    s_add_u32 s43, s41, 0x208000
    s_add_u32 m0, s51, 0x15000
    s_nop 0
    buffer_load_dwordx4 v15, s[12:15], s43 offen lds
    s_add_u32 s43, s41, 0x300000
    s_add_u32 m0, s51, 0x16000
    s_nop 0
    buffer_load_dwordx4 v15, s[12:15], s43 offen lds
    s_add_u32 s43, s41, 0x308000
    s_add_u32 m0, s51, 0x17000
    s_nop 0
    buffer_load_dwordx4 v15, s[12:15], s43 offen lds
    v_xor_b32 v15, 0, v14
    v_lshl_add_u32 v15, v15, 15, v8
    s_add_u32 s43, s41, 0x80000
    s_add_u32 m0, s51, 0x18000
    s_nop 0
    buffer_load_dwordx4 v15, s[12:15], s43 offen lds
    s_add_u32 s43, s41, 0x88000
    s_add_u32 m0, s51, 0x19000
    s_nop 0
    buffer_load_dwordx4 v15, s[12:15], s43 offen lds
    s_add_u32 s43, s41, 0x180000
    s_add_u32 m0, s51, 0x1a000
    s_nop 0
    buffer_load_dwordx4 v15, s[12:15], s43 offen lds
    s_add_u32 s43, s41, 0x188000
    s_add_u32 m0, s51, 0x1b000
    s_nop 0
    buffer_load_dwordx4 v15, s[12:15], s43 offen lds
    s_waitcnt vmcnt(12)
    v_min_u32 v21, 0xfffffffe, v21
    s_mov_b32 s43, 0x7010000
    s_mov_b64 exec, s[38:39]
    buffer_store_dword v21, v119, s[8:11], s43 offen sc1
    s_mov_b64 exec, -1
    s_barrier
    v_xor_b32 v13, 0x0, v11
    v_add_u32 v13, 0x0, v13
    ds_read_b64_tr_b16 v[64:65], v13
    ds_read_b64_tr_b16 v[66:67], v13 offset:1024
    ds_read_b64_tr_b16 v[68:69], v13 offset:16384
    ds_read_b64_tr_b16 v[70:71], v13 offset:17408
    v_xor_b32 v13, 0x20, v11
    v_add_u32 v13, 0x0, v13
    ds_read_b64_tr_b16 v[72:73], v13
    ds_read_b64_tr_b16 v[74:75], v13 offset:1024
    ds_read_b64_tr_b16 v[76:77], v13 offset:16384
    ds_read_b64_tr_b16 v[78:79], v13 offset:17408
    v_xor_b32 v13, 0x1000, v11
    v_add_u32 v13, 0x0, v13
    ds_read_b64_tr_b16 a[96:97], v13
    ds_read_b64_tr_b16 a[98:99], v13 offset:1024
    ds_read_b64_tr_b16 a[100:101], v13 offset:16384
    ds_read_b64_tr_b16 a[102:103], v13 offset:17408
    v_xor_b32 v13, 0x1020, v11
    v_add_u32 v13, 0x0, v13
    ds_read_b64_tr_b16 a[104:105], v13
    ds_read_b64_tr_b16 a[106:107], v13 offset:1024
    ds_read_b64_tr_b16 a[108:109], v13 offset:16384
    ds_read_b64_tr_b16 a[110:111], v13 offset:17408
    s_waitcnt lgkmcnt(0)
    s_barrier
    s_add_u32 s43, s41, 0x280000
    s_add_u32 m0, s51, 0x1c000
    s_nop 0
    buffer_load_dwordx4 v15, s[12:15], s43 offen lds
    s_add_u32 s43, s41, 0x288000
    s_add_u32 m0, s51, 0x1d000
    s_nop 0
    buffer_load_dwordx4 v15, s[12:15], s43 offen lds
    s_add_u32 s43, s41, 0x380000
    s_add_u32 m0, s51, 0x1e000
    s_nop 0
    buffer_load_dwordx4 v15, s[12:15], s43 offen lds
    s_add_u32 s43, s41, 0x388000
    s_add_u32 m0, s51, 0x1f000
    s_nop 0
    buffer_load_dwordx4 v15, s[12:15], s43 offen lds
    v_xor_b32 v15, 2, v14
    v_lshl_add_u32 v15, v15, 15, v8
    s_add_u32 s43, s41, 0x80000
    s_add_u32 m0, s51, 0x20000
    s_nop 0
    buffer_load_dwordx4 v15, s[12:15], s43 offen lds
    s_add_u32 s43, s41, 0x88000
    s_add_u32 m0, s51, 0x21000
    s_nop 0
    buffer_load_dwordx4 v15, s[12:15], s43 offen lds
    s_add_u32 s43, s41, 0x180000
    s_add_u32 m0, s51, 0x22000
    s_nop 0
    buffer_load_dwordx4 v15, s[12:15], s43 offen lds
    s_add_u32 s43, s41, 0x188000
    s_add_u32 m0, s51, 0x23000
    s_nop 0
    buffer_load_dwordx4 v15, s[12:15], s43 offen lds
    s_waitcnt vmcnt(12)
    s_barrier
    v_xor_b32 v13, 0x0, v11
    v_add_u32 v13, 0x8000, v13
    ds_read_b64_tr_b16 a[128:129], v13
    ds_read_b64_tr_b16 a[130:131], v13 offset:1024
    ds_read_b64_tr_b16 a[132:133], v13 offset:16384
    ds_read_b64_tr_b16 a[134:135], v13 offset:17408
    v_xor_b32 v13, 0x20, v11
    v_add_u32 v13, 0x8000, v13
    ds_read_b64_tr_b16 a[136:137], v13
    ds_read_b64_tr_b16 a[138:139], v13 offset:1024
    ds_read_b64_tr_b16 a[140:141], v13 offset:16384
    ds_read_b64_tr_b16 a[142:143], v13 offset:17408
    v_xor_b32 v13, 0x1000, v11
    v_add_u32 v13, 0x8000, v13
    ds_read_b64_tr_b16 a[160:161], v13
    ds_read_b64_tr_b16 a[162:163], v13 offset:1024
    ds_read_b64_tr_b16 a[164:165], v13 offset:16384
    ds_read_b64_tr_b16 a[166:167], v13 offset:17408
    v_xor_b32 v13, 0x1020, v11
    v_add_u32 v13, 0x8000, v13
    ds_read_b64_tr_b16 a[168:169], v13
    ds_read_b64_tr_b16 a[170:171], v13 offset:1024
    ds_read_b64_tr_b16 a[172:173], v13 offset:16384
    ds_read_b64_tr_b16 a[174:175], v13 offset:17408
    s_waitcnt lgkmcnt(0)
    s_barrier
    s_add_u32 s43, s41, 0x280000
    s_add_u32 m0, s51, 0x24000
    s_nop 0
    buffer_load_dwordx4 v15, s[12:15], s43 offen lds
    s_add_u32 s43, s41, 0x288000
    s_add_u32 m0, s51, 0x25000
    s_nop 0
    buffer_load_dwordx4 v15, s[12:15], s43 offen lds
    s_add_u32 s43, s41, 0x380000
    s_add_u32 m0, s51, 0x26000
    s_nop 0
    buffer_load_dwordx4 v15, s[12:15], s43 offen lds
    s_add_u32 s43, s41, 0x388000
    s_add_u32 m0, s51, 0x27000
    s_nop 0
    buffer_load_dwordx4 v15, s[12:15], s43 offen lds
    s_mov_b32 s12, s64
    s_and_b32 s13, s65, 0xffff
    v_xor_b32 v15, 0, v14
    v_lshl_add_u32 v15, v15, 15, v8
    s_add_u32 s43, s41, 0x0
    s_add_u32 m0, s51, 0x8000
    s_nop 0
    buffer_load_dwordx4 v15, s[12:15], s43 offen lds
    s_add_u32 s43, s41, 0x8000
    s_add_u32 m0, s51, 0x9000
    s_nop 0
    buffer_load_dwordx4 v15, s[12:15], s43 offen lds
    s_add_u32 s43, s41, 0x100000
    s_add_u32 m0, s51, 0xa000
    s_nop 0
    buffer_load_dwordx4 v15, s[12:15], s43 offen lds
    s_add_u32 s43, s41, 0x108000
    s_add_u32 m0, s51, 0xb000
    s_nop 0
    buffer_load_dwordx4 v15, s[12:15], s43 offen lds
    s_waitcnt vmcnt(12)
    s_barrier
    v_xor_b32 v13, 0x0, v11
    v_add_u32 v13, 0x10000, v13
    ds_read_b64_tr_b16 v[104:105], v13
    ds_read_b64_tr_b16 v[106:107], v13 offset:1024
    ds_read_b64_tr_b16 v[108:109], v13 offset:16384
    ds_read_b64_tr_b16 v[110:111], v13 offset:17408
    v_xor_b32 v13, 0x20, v11
    v_add_u32 v13, 0x10000, v13
    ds_read_b64_tr_b16 v[32:33], v13
    ds_read_b64_tr_b16 v[34:35], v13 offset:1024
    ds_read_b64_tr_b16 v[36:37], v13 offset:16384
    ds_read_b64_tr_b16 v[38:39], v13 offset:17408
    v_xor_b32 v13, 0x1000, v11
    v_add_u32 v13, 0x10000, v13
    ds_read_b64_tr_b16 a[112:113], v13
    ds_read_b64_tr_b16 a[114:115], v13 offset:1024
    ds_read_b64_tr_b16 a[116:117], v13 offset:16384
    ds_read_b64_tr_b16 a[118:119], v13 offset:17408
    v_xor_b32 v13, 0x1020, v11
    v_add_u32 v13, 0x10000, v13
    ds_read_b64_tr_b16 a[120:121], v13
    ds_read_b64_tr_b16 a[122:123], v13 offset:1024
    ds_read_b64_tr_b16 a[124:125], v13 offset:16384
    ds_read_b64_tr_b16 a[126:127], v13 offset:17408
    s_waitcnt lgkmcnt(0)
    s_barrier
    s_add_u32 s43, s41, 0x200000
    s_add_u32 m0, s51, 0xc000
    s_nop 0
    buffer_load_dwordx4 v15, s[12:15], s43 offen lds
    s_add_u32 s43, s41, 0x208000
    s_add_u32 m0, s51, 0xd000
    s_nop 0
    buffer_load_dwordx4 v15, s[12:15], s43 offen lds
    s_add_u32 s43, s41, 0x300000
    s_add_u32 m0, s51, 0xe000
    s_nop 0
    buffer_load_dwordx4 v15, s[12:15], s43 offen lds
    s_add_u32 s43, s41, 0x308000
    s_add_u32 m0, s51, 0xf000
    s_nop 0
    buffer_load_dwordx4 v15, s[12:15], s43 offen lds
    v_xor_b32 v15, 2, v14
    v_lshl_add_u32 v15, v15, 15, v8
    s_add_u32 s43, s41, 0x0
    s_add_u32 m0, s51, 0x10000
    s_nop 0
    buffer_load_dwordx4 v15, s[12:15], s43 offen lds
    s_add_u32 s43, s41, 0x8000
    s_add_u32 m0, s51, 0x11000
    s_nop 0
    buffer_load_dwordx4 v15, s[12:15], s43 offen lds
    s_add_u32 s43, s41, 0x100000
    s_add_u32 m0, s51, 0x12000
    s_nop 0
    buffer_load_dwordx4 v15, s[12:15], s43 offen lds
    s_add_u32 s43, s41, 0x108000
    s_add_u32 m0, s51, 0x13000
    s_nop 0
    buffer_load_dwordx4 v15, s[12:15], s43 offen lds
    s_waitcnt vmcnt(12)
    s_barrier
    v_xor_b32 v13, 0x0, v11
    v_add_u32 v13, 0x18000, v13
    ds_read_b64_tr_b16 a[144:145], v13
    ds_read_b64_tr_b16 a[146:147], v13 offset:1024
    ds_read_b64_tr_b16 a[148:149], v13 offset:16384
    ds_read_b64_tr_b16 a[150:151], v13 offset:17408
    v_xor_b32 v13, 0x20, v11
    v_add_u32 v13, 0x18000, v13
    ds_read_b64_tr_b16 a[152:153], v13
    ds_read_b64_tr_b16 a[154:155], v13 offset:1024
    ds_read_b64_tr_b16 a[156:157], v13 offset:16384
    ds_read_b64_tr_b16 a[158:159], v13 offset:17408
    v_xor_b32 v13, 0x1000, v11
    v_add_u32 v13, 0x18000, v13
    ds_read_b64_tr_b16 a[176:177], v13
    ds_read_b64_tr_b16 a[178:179], v13 offset:1024
    ds_read_b64_tr_b16 a[180:181], v13 offset:16384
    ds_read_b64_tr_b16 a[182:183], v13 offset:17408
    v_xor_b32 v13, 0x1020, v11
    v_add_u32 v13, 0x18000, v13
    ds_read_b64_tr_b16 a[184:185], v13
    ds_read_b64_tr_b16 a[186:187], v13 offset:1024
    ds_read_b64_tr_b16 a[188:189], v13 offset:16384
    ds_read_b64_tr_b16 a[190:191], v13 offset:17408
    s_waitcnt lgkmcnt(0)
    s_barrier
    s_add_u32 s43, s41, 0x200000
    s_add_u32 m0, s51, 0x14000
    s_nop 0
    buffer_load_dwordx4 v15, s[12:15], s43 offen lds
    s_add_u32 s43, s41, 0x208000
    s_add_u32 m0, s51, 0x15000
    s_nop 0
    buffer_load_dwordx4 v15, s[12:15], s43 offen lds
    s_add_u32 s43, s41, 0x300000
    s_add_u32 m0, s51, 0x16000
    s_nop 0
    buffer_load_dwordx4 v15, s[12:15], s43 offen lds
    s_add_u32 s43, s41, 0x308000
    s_add_u32 m0, s51, 0x17000
    s_nop 0
    buffer_load_dwordx4 v15, s[12:15], s43 offen lds
    s_mov_b32 s12, s66
    s_and_b32 s13, s67, 0xffff
    s_add_u32 s43, s42, 0x80
    s_add_u32 m0, s51, 0x18000
    s_nop 0
    buffer_load_dwordx4 v10, s[12:15], s43 offen lds
    s_add_u32 s43, s42, 0x4080
    s_add_u32 m0, s51, 0x19000
    s_nop 0
    buffer_load_dwordx4 v9, s[12:15], s43 offen lds
    s_add_u32 s43, s42, 0x8080
    s_add_u32 m0, s51, 0x1a000
    s_nop 0
    buffer_load_dwordx4 v10, s[12:15], s43 offen lds
    s_add_u32 s43, s42, 0xc080
    s_add_u32 m0, s51, 0x1b000
    s_nop 0
    buffer_load_dwordx4 v9, s[12:15], s43 offen lds
    s_waitcnt vmcnt(12)
    s_barrier
    v_xor_b32 v13, 0x0, v11
    v_add_u32 v13, 0x0, v13
    ds_read_b64_tr_b16 a[192:193], v13
    ds_read_b64_tr_b16 a[194:195], v13 offset:1024
    ds_read_b64_tr_b16 a[196:197], v13 offset:16384
    ds_read_b64_tr_b16 a[198:199], v13 offset:17408
    v_xor_b32 v13, 0x20, v11
    v_add_u32 v13, 0x0, v13
    ds_read_b64_tr_b16 a[200:201], v13
    ds_read_b64_tr_b16 a[202:203], v13 offset:1024
    ds_read_b64_tr_b16 a[204:205], v13 offset:16384
    ds_read_b64_tr_b16 a[206:207], v13 offset:17408
    v_xor_b32 v13, 0x1000, v11
    v_add_u32 v13, 0x0, v13
    ds_read_b64_tr_b16 a[224:225], v13
    ds_read_b64_tr_b16 a[226:227], v13 offset:1024
    ds_read_b64_tr_b16 a[228:229], v13 offset:16384
    ds_read_b64_tr_b16 a[230:231], v13 offset:17408
    v_xor_b32 v13, 0x1020, v11
    v_add_u32 v13, 0x0, v13
    ds_read_b64_tr_b16 a[232:233], v13
    ds_read_b64_tr_b16 a[234:235], v13 offset:1024
    ds_read_b64_tr_b16 a[236:237], v13 offset:16384
    ds_read_b64_tr_b16 a[238:239], v13 offset:17408
    s_waitcnt lgkmcnt(0)
    s_barrier
    s_add_u32 s43, s42, 0x10280
    s_add_u32 m0, s51, 0x1c000
    s_nop 0
    buffer_load_dwordx4 v10, s[12:15], s43 offen lds
    s_add_u32 s43, s42, 0x14280
    s_add_u32 m0, s51, 0x1d000
    s_nop 0
    buffer_load_dwordx4 v9, s[12:15], s43 offen lds
    s_add_u32 s43, s42, 0x18280
    s_add_u32 m0, s51, 0x1e000
    s_nop 0
    buffer_load_dwordx4 v10, s[12:15], s43 offen lds
    s_add_u32 s43, s42, 0x1c280
    s_add_u32 m0, s51, 0x1f000
    s_nop 0
    buffer_load_dwordx4 v9, s[12:15], s43 offen lds
    s_add_u32 s43, s42, 0x10080
    s_add_u32 m0, s51, 0x20000
    s_nop 0
    buffer_load_dwordx4 v10, s[12:15], s43 offen lds
    s_add_u32 s43, s42, 0x14080
    s_add_u32 m0, s51, 0x21000
    s_nop 0
    buffer_load_dwordx4 v9, s[12:15], s43 offen lds
    s_add_u32 s43, s42, 0x18080
    s_add_u32 m0, s51, 0x22000
    s_nop 0
    buffer_load_dwordx4 v10, s[12:15], s43 offen lds
    s_add_u32 s43, s42, 0x1c080
    s_add_u32 m0, s51, 0x23000
    s_nop 0
    buffer_load_dwordx4 v9, s[12:15], s43 offen lds
    s_waitcnt vmcnt(12)
    s_barrier
    s_cmp_lg_u32 s21, 0
    s_cbranch_scc1 L_arr_51
    v_mov_b32 v23, 1
    s_mov_b64 exec, 1
    buffer_atomic_add v23, off, s[16:19], 0 offset:8
    s_mov_b64 exec, -1
L_arr_51:
    v_xor_b32 v13, 0x0, v11
    v_add_u32 v13, 0x8000, v13
    ds_read_b64_tr_b16 v[128:129], v13
    ds_read_b64_tr_b16 v[130:131], v13 offset:1024
    ds_read_b64_tr_b16 v[132:133], v13 offset:16384
    ds_read_b64_tr_b16 v[134:135], v13 offset:17408
    v_xor_b32 v13, 0x20, v11
    v_add_u32 v13, 0x8000, v13
    ds_read_b64_tr_b16 v[136:137], v13
    ds_read_b64_tr_b16 v[138:139], v13 offset:1024
    ds_read_b64_tr_b16 v[140:141], v13 offset:16384
    ds_read_b64_tr_b16 v[142:143], v13 offset:17408
    v_xor_b32 v13, 0x1000, v11
    v_add_u32 v13, 0x8000, v13
    ds_read_b64_tr_b16 v[160:161], v13
    ds_read_b64_tr_b16 v[162:163], v13 offset:1024
    ds_read_b64_tr_b16 v[164:165], v13 offset:16384
    ds_read_b64_tr_b16 v[166:167], v13 offset:17408
    v_xor_b32 v13, 0x1020, v11
    v_add_u32 v13, 0x8000, v13
    ds_read_b64_tr_b16 v[168:169], v13
    ds_read_b64_tr_b16 v[170:171], v13 offset:1024
    ds_read_b64_tr_b16 v[172:173], v13 offset:16384
    ds_read_b64_tr_b16 v[174:175], v13 offset:17408
    s_waitcnt lgkmcnt(0)
    s_barrier
    s_add_u32 s43, s42, 0x280
    s_add_u32 m0, s51, 0x24000
    s_nop 0
    buffer_load_dwordx4 v10, s[12:15], s43 offen lds
    s_add_u32 s43, s42, 0x4280
    s_add_u32 m0, s51, 0x25000
    s_nop 0
    buffer_load_dwordx4 v9, s[12:15], s43 offen lds
    s_add_u32 s43, s42, 0x8280
    s_add_u32 m0, s51, 0x26000
    s_nop 0
    buffer_load_dwordx4 v10, s[12:15], s43 offen lds
    s_add_u32 s43, s42, 0xc280
    s_add_u32 m0, s51, 0x27000
    s_nop 0
    buffer_load_dwordx4 v9, s[12:15], s43 offen lds
    s_mov_b32 s12, s64
    s_and_b32 s13, s65, 0xffff
    v_xor_b32 v15, 0, v14
    v_lshl_add_u32 v15, v15, 15, v8
    s_add_u32 s43, s41, 0x80000
    s_add_u32 m0, s51, 0x8000
    s_nop 0
    buffer_load_dwordx4 v15, s[12:15], s43 offen lds
    s_add_u32 s43, s41, 0x88000
    s_add_u32 m0, s51, 0x9000
    s_nop 0
    buffer_load_dwordx4 v15, s[12:15], s43 offen lds
    s_add_u32 s43, s41, 0x180000
    s_add_u32 m0, s51, 0xa000
    s_nop 0
    buffer_load_dwordx4 v15, s[12:15], s43 offen lds
    s_add_u32 s43, s41, 0x188000
    s_add_u32 m0, s51, 0xb000
    s_nop 0
    buffer_load_dwordx4 v15, s[12:15], s43 offen lds
    s_waitcnt vmcnt(12)
    s_barrier
    v_xor_b32 v13, 0x0, v12
    v_add_u32 v13, 0x10000, v13
    ds_read_b64_tr_b16 v[192:193], v13
    ds_read_b64_tr_b16 v[194:195], v13 offset:512
    ds_read_b64_tr_b16 v[196:197], v13 offset:2048
    ds_read_b64_tr_b16 v[198:199], v13 offset:2560
    v_xor_b32 v13, 0x2000, v12
    v_add_u32 v13, 0x10000, v13
    ds_read_b64_tr_b16 v[200:201], v13
    ds_read_b64_tr_b16 v[202:203], v13 offset:512
    ds_read_b64_tr_b16 v[204:205], v13 offset:2048
    ds_read_b64_tr_b16 v[206:207], v13 offset:2560
    v_xor_b32 v13, 0x40, v12
    v_add_u32 v13, 0x10000, v13
    ds_read_b64_tr_b16 v[224:225], v13
    ds_read_b64_tr_b16 v[226:227], v13 offset:512
    ds_read_b64_tr_b16 v[228:229], v13 offset:2048
    ds_read_b64_tr_b16 v[230:231], v13 offset:2560
    v_xor_b32 v13, 0x2040, v12
    v_add_u32 v13, 0x10000, v13
    ds_read_b64_tr_b16 v[232:233], v13
    ds_read_b64_tr_b16 v[234:235], v13 offset:512
    ds_read_b64_tr_b16 v[236:237], v13 offset:2048
    ds_read_b64_tr_b16 v[238:239], v13 offset:2560
    s_waitcnt lgkmcnt(0)
    s_barrier
    s_add_u32 s43, s41, 0x280000
    s_add_u32 m0, s51, 0xc000
    s_nop 0
    buffer_load_dwordx4 v15, s[12:15], s43 offen lds
    s_add_u32 s43, s41, 0x288000
    s_add_u32 m0, s51, 0xd000
    s_nop 0
    buffer_load_dwordx4 v15, s[12:15], s43 offen lds
    s_add_u32 s43, s41, 0x380000
    s_add_u32 m0, s51, 0xe000
    s_nop 0
    buffer_load_dwordx4 v15, s[12:15], s43 offen lds
    s_add_u32 s43, s41, 0x388000
    s_add_u32 m0, s51, 0xf000
    s_nop 0
    buffer_load_dwordx4 v15, s[12:15], s43 offen lds
    v_xor_b32 v15, 2, v14
    v_lshl_add_u32 v15, v15, 15, v8
    s_add_u32 s43, s41, 0x80000
    s_add_u32 m0, s51, 0x10000
    s_nop 0
    buffer_load_dwordx4 v15, s[12:15], s43 offen lds
    s_add_u32 s43, s41, 0x88000
    s_add_u32 m0, s51, 0x11000
    s_nop 0
    buffer_load_dwordx4 v15, s[12:15], s43 offen lds
    s_add_u32 s43, s41, 0x180000
    s_add_u32 m0, s51, 0x12000
    s_nop 0
    buffer_load_dwordx4 v15, s[12:15], s43 offen lds
    s_add_u32 s43, s41, 0x188000
    s_add_u32 m0, s51, 0x13000
    s_nop 0
    buffer_load_dwordx4 v15, s[12:15], s43 offen lds
    s_waitcnt vmcnt(12)
    s_barrier
    v_xor_b32 v13, 0x0, v12
    v_add_u32 v13, 0x18000, v13
    ds_read_b64_tr_b16 v[208:209], v13
    ds_read_b64_tr_b16 v[210:211], v13 offset:512
    ds_read_b64_tr_b16 v[212:213], v13 offset:2048
    ds_read_b64_tr_b16 v[214:215], v13 offset:2560
    v_xor_b32 v13, 0x2000, v12
    v_add_u32 v13, 0x18000, v13
    ds_read_b64_tr_b16 v[216:217], v13
    ds_read_b64_tr_b16 v[218:219], v13 offset:512
    ds_read_b64_tr_b16 v[220:221], v13 offset:2048
    ds_read_b64_tr_b16 v[222:223], v13 offset:2560
    v_xor_b32 v13, 0x40, v12
    v_add_u32 v13, 0x18000, v13
    ds_read_b64_tr_b16 v[240:241], v13
    ds_read_b64_tr_b16 v[242:243], v13 offset:512
    ds_read_b64_tr_b16 v[244:245], v13 offset:2048
    ds_read_b64_tr_b16 v[246:247], v13 offset:2560
    v_xor_b32 v13, 0x2040, v12
    v_add_u32 v13, 0x18000, v13
    ds_read_b64_tr_b16 v[248:249], v13
    ds_read_b64_tr_b16 v[250:251], v13 offset:512
    ds_read_b64_tr_b16 v[252:253], v13 offset:2048
    ds_read_b64_tr_b16 v[254:255], v13 offset:2560
    s_waitcnt lgkmcnt(0)
    s_barrier
    s_add_u32 s43, s41, 0x280000
    s_add_u32 m0, s51, 0x14000
    s_nop 0
    buffer_load_dwordx4 v15, s[12:15], s43 offen lds
    s_add_u32 s43, s41, 0x288000
    s_add_u32 m0, s51, 0x15000
    s_nop 0
    buffer_load_dwordx4 v15, s[12:15], s43 offen lds
    s_add_u32 s43, s41, 0x380000
    s_add_u32 m0, s51, 0x16000
    s_nop 0
    buffer_load_dwordx4 v15, s[12:15], s43 offen lds
    s_add_u32 s43, s41, 0x388000
    s_add_u32 m0, s51, 0x17000
    s_nop 0
    buffer_load_dwordx4 v15, s[12:15], s43 offen lds
    ds_write_b128 v124, v[192:195]
    ds_write_b128 v124, v[196:199] offset:1024
    ds_write_b128 v124, v[200:203] offset:2048
    ds_write_b128 v124, v[204:207] offset:3072
    ds_write_b128 v124, v[208:211] offset:4096
    ds_write_b128 v124, v[212:215] offset:5120
    ds_write_b128 v124, v[216:219] offset:6144
    ds_write_b128 v124, v[220:223] offset:7168
    ds_write_b128 v124, v[224:227] offset:32768
    ds_write_b128 v124, v[228:231] offset:33792
    ds_write_b128 v124, v[232:235] offset:34816
    ds_write_b128 v124, v[236:239] offset:35840
    ds_write_b128 v124, v[240:243] offset:36864
    ds_write_b128 v124, v[244:247] offset:37888
    ds_write_b128 v124, v[248:251] offset:38912
    ds_write_b128 v124, v[252:255] offset:39936
    s_waitcnt vmcnt(8)
    s_barrier
    v_xor_b32 v13, 0x0, v11
    v_add_u32 v13, 0x0, v13
    ds_read_b64_tr_b16 a[208:209], v13
    ds_read_b64_tr_b16 a[210:211], v13 offset:1024
    ds_read_b64_tr_b16 a[212:213], v13 offset:16384
    ds_read_b64_tr_b16 a[214:215], v13 offset:17408
    v_xor_b32 v13, 0x20, v11
    v_add_u32 v13, 0x0, v13
    ds_read_b64_tr_b16 a[216:217], v13
    ds_read_b64_tr_b16 a[218:219], v13 offset:1024
    ds_read_b64_tr_b16 a[220:221], v13 offset:16384
    ds_read_b64_tr_b16 a[222:223], v13 offset:17408
    v_xor_b32 v13, 0x1000, v11
    v_add_u32 v13, 0x0, v13
    ds_read_b64_tr_b16 a[240:241], v13
    ds_read_b64_tr_b16 a[242:243], v13 offset:1024
    ds_read_b64_tr_b16 a[244:245], v13 offset:16384
    ds_read_b64_tr_b16 a[246:247], v13 offset:17408
    v_xor_b32 v13, 0x1020, v11
    v_add_u32 v13, 0x0, v13
    ds_read_b64_tr_b16 a[248:249], v13
    ds_read_b64_tr_b16 a[250:251], v13 offset:1024
    ds_read_b64_tr_b16 a[252:253], v13 offset:16384
    ds_read_b64_tr_b16 a[254:255], v13 offset:17408
    s_waitcnt lgkmcnt(0)
    s_barrier
    s_mov_b32 s12, s66
    s_and_b32 s13, s67, 0xffff
    s_add_u32 s43, s42, 0x0
    s_add_u32 m0, s51, 0x8000
    s_nop 0
    buffer_load_dwordx4 v10, s[12:15], s43 offen lds
    s_add_u32 s43, s42, 0x4000
    s_add_u32 m0, s51, 0x9000
    s_nop 0
    buffer_load_dwordx4 v9, s[12:15], s43 offen lds
    s_add_u32 s43, s42, 0x8000
    s_add_u32 m0, s51, 0xa000
    s_nop 0
    buffer_load_dwordx4 v10, s[12:15], s43 offen lds
    s_add_u32 s43, s42, 0xc000
    s_add_u32 m0, s51, 0xb000
    s_nop 0
    buffer_load_dwordx4 v9, s[12:15], s43 offen lds
    s_add_u32 s43, s42, 0x10200
    s_add_u32 m0, s51, 0xc000
    s_nop 0
    buffer_load_dwordx4 v10, s[12:15], s43 offen lds
    s_add_u32 s43, s42, 0x14200
    s_add_u32 m0, s51, 0xd000
    s_nop 0
    buffer_load_dwordx4 v9, s[12:15], s43 offen lds
    s_add_u32 s43, s42, 0x18200
    s_add_u32 m0, s51, 0xe000
    s_nop 0
    buffer_load_dwordx4 v10, s[12:15], s43 offen lds
    s_add_u32 s43, s42, 0x1c200
    s_add_u32 m0, s51, 0xf000
    s_nop 0
    buffer_load_dwordx4 v9, s[12:15], s43 offen lds
    s_waitcnt vmcnt(8)
    s_barrier
    v_xor_b32 v13, 0x0, v11
    v_add_u32 v13, 0x8000, v13
    ds_read_b64_tr_b16 v[144:145], v13
    ds_read_b64_tr_b16 v[146:147], v13 offset:1024
    ds_read_b64_tr_b16 v[148:149], v13 offset:16384
    ds_read_b64_tr_b16 v[150:151], v13 offset:17408
    v_xor_b32 v13, 0x20, v11
    v_add_u32 v13, 0x8000, v13
    ds_read_b64_tr_b16 v[152:153], v13
    ds_read_b64_tr_b16 v[154:155], v13 offset:1024
    ds_read_b64_tr_b16 v[156:157], v13 offset:16384
    ds_read_b64_tr_b16 v[158:159], v13 offset:17408
    v_xor_b32 v13, 0x1000, v11
    v_add_u32 v13, 0x8000, v13
    ds_read_b64_tr_b16 v[176:177], v13
    ds_read_b64_tr_b16 v[178:179], v13 offset:1024
    ds_read_b64_tr_b16 v[180:181], v13 offset:16384
    ds_read_b64_tr_b16 v[182:183], v13 offset:17408
    v_xor_b32 v13, 0x1020, v11
    v_add_u32 v13, 0x8000, v13
    ds_read_b64_tr_b16 v[184:185], v13
    ds_read_b64_tr_b16 v[186:187], v13 offset:1024
    ds_read_b64_tr_b16 v[188:189], v13 offset:16384
    ds_read_b64_tr_b16 v[190:191], v13 offset:17408
    s_waitcnt lgkmcnt(0)
    s_barrier
    s_add_u32 s43, s42, 0x10000
    s_add_u32 m0, s51, 0x10000
    s_nop 0
    buffer_load_dwordx4 v10, s[12:15], s43 offen lds
    s_add_u32 s43, s42, 0x14000
    s_add_u32 m0, s51, 0x11000
    s_nop 0
    buffer_load_dwordx4 v9, s[12:15], s43 offen lds
    s_add_u32 s43, s42, 0x18000
    s_add_u32 m0, s51, 0x12000
    s_nop 0
    buffer_load_dwordx4 v10, s[12:15], s43 offen lds
    s_add_u32 s43, s42, 0x1c000
    s_add_u32 m0, s51, 0x13000
    s_nop 0
    buffer_load_dwordx4 v9, s[12:15], s43 offen lds
    s_add_u32 s43, s42, 0x200
    s_add_u32 m0, s51, 0x14000
    s_nop 0
    buffer_load_dwordx4 v10, s[12:15], s43 offen lds
    s_add_u32 s43, s42, 0x4200
    s_add_u32 m0, s51, 0x15000
    s_nop 0
    buffer_load_dwordx4 v9, s[12:15], s43 offen lds
    s_add_u32 s43, s42, 0x8200
    s_add_u32 m0, s51, 0x16000
    s_nop 0
    buffer_load_dwordx4 v10, s[12:15], s43 offen lds
    s_add_u32 s43, s42, 0xc200
    s_add_u32 m0, s51, 0x17000
    s_nop 0
    buffer_load_dwordx4 v9, s[12:15], s43 offen lds
    s_waitcnt vmcnt(8)
    s_barrier
    v_xor_b32 v13, 0x0, v12
    v_add_u32 v13, 0x0, v13
    ds_read_b64_tr_b16 v[192:193], v13
    ds_read_b64_tr_b16 v[194:195], v13 offset:512
    ds_read_b64_tr_b16 v[196:197], v13 offset:2048
    ds_read_b64_tr_b16 v[198:199], v13 offset:2560
    v_xor_b32 v13, 0x2000, v12
    v_add_u32 v13, 0x0, v13
    ds_read_b64_tr_b16 v[200:201], v13
    ds_read_b64_tr_b16 v[202:203], v13 offset:512
    ds_read_b64_tr_b16 v[204:205], v13 offset:2048
    ds_read_b64_tr_b16 v[206:207], v13 offset:2560
    v_xor_b32 v13, 0x40, v12
    v_add_u32 v13, 0x0, v13
    ds_read_b64_tr_b16 v[224:225], v13
    ds_read_b64_tr_b16 v[226:227], v13 offset:512
    ds_read_b64_tr_b16 v[228:229], v13 offset:2048
    ds_read_b64_tr_b16 v[230:231], v13 offset:2560
    v_xor_b32 v13, 0x2040, v12
    v_add_u32 v13, 0x0, v13
    ds_read_b64_tr_b16 v[232:233], v13
    ds_read_b64_tr_b16 v[234:235], v13 offset:512
    ds_read_b64_tr_b16 v[236:237], v13 offset:2048
    ds_read_b64_tr_b16 v[238:239], v13 offset:2560
    s_lshr_b32 s43, s20, 1
    s_lshl_b32 s43, s43, 7
    s_and_b32 s40, s20, 1
    s_lshl_b32 s40, s40, 4
    s_add_u32 s43, s43, s40
    s_add_u32 s44, s43, 0x1000
    s_cmp_eq_u32 s21, 0
    s_cselect_b32 s44, s44, 0x7ff00000
    s_mov_b32 s22, 0
    s_mov_b32 s33, 0
    s_xor_b32 s53, s29, 1024
    s_add_u32 s23, s51, 0x7010000
    s_add_u32 s48, s23, 4096
    s_mov_b32 s24, 0x7012000
    s_add_u32 s55, s24, 16384
    s_mov_b32 s25, 0x7100000
    s_mov_b32 s26, 0x7101000
    v_mov_b32 v112, 0
    v_mov_b32 v113, 0
    v_mov_b32 v114, 0
    v_mov_b32 v115, 0
    ds_write_b128 v117, v[112:115] offset:22528
    ds_write_b128 v117, v[112:115] offset:23552
    s_cmp_lg_u32 s21, 0
    s_cselect_b32 s40, -1, 0
    v_mov_b32 v126, s40
    v_bfe_u32 v1, v117, 4, 1
    v_lshlrev_b32 v1, 4, v1
    s_movk_i32 s43, 0x3f80
    v_lshlrev_b32 v125, v1, s43
    v_bfe_u32 v1, v117, 5, 3
    v_cmp_eq_u32 s[68:69], 0, v1
    v_cmp_eq_u32 s[70:71], 1, v1
    v_cmp_eq_u32 s[72:73], 2, v1
    v_cmp_eq_u32 s[74:75], 3, v1
    v_lshrrev_b32 v1, 2, v117
    s_cmp_lt_u32 s21, 2
    s_cselect_b64 vcc, -1, 0
    v_cndmask_b32 v119, v119, v1, vcc
    v_mov_b32 v40, 0
    v_mov_b32 v41, 0
    v_mov_b32 v42, 0
    v_mov_b32 v43, 0
    v_mov_b32 v44, 0
    v_mov_b32 v45, 0
    v_mov_b32 v46, 0
    v_mov_b32 v47, 0
    v_mov_b32 v48, 0
    v_mov_b32 v49, 0
    v_mov_b32 v50, 0
    v_mov_b32 v51, 0
    v_mov_b32 v52, 0
    v_mov_b32 v53, 0
    v_mov_b32 v54, 0
    v_mov_b32 v55, 0
    s_mov_b32 s45, 0
    s_mov_b32 s46, 0
    s_mov_b32 s47, 0
    s_mov_b32 s76, 0
    s_and_b32 s43, s21, 1
    s_lshl_b32 s43, s43, 5
    s_add_u32 s43, s43, s20
    s_lshl_b32 s43, s43, 6
    s_add_u32 s28, s43, 0x2000
    s_mov_b32 s59, 0
    s_waitcnt vmcnt(0) lgkmcnt(0)
    s_barrier
    v_xor_b32 v13, 0x0, v12
    v_add_u32 v13, 0x8000, v13
    ds_read_b64_tr_b16 v[208:209], v13
    ds_read_b64_tr_b16 v[210:211], v13 offset:512
    ds_read_b64_tr_b16 v[212:213], v13 offset:2048
    ds_read_b64_tr_b16 v[214:215], v13 offset:2560
    v_xor_b32 v13, 0x2000, v12
    v_add_u32 v13, 0x8000, v13
    ds_read_b64_tr_b16 v[216:217], v13
    ds_read_b64_tr_b16 v[218:219], v13 offset:512
    ds_read_b64_tr_b16 v[220:221], v13 offset:2048
    ds_read_b64_tr_b16 v[222:223], v13 offset:2560
    v_xor_b32 v13, 0x40, v12
    v_add_u32 v13, 0x8000, v13
    ds_read_b64_tr_b16 v[240:241], v13
    ds_read_b64_tr_b16 v[242:243], v13 offset:512
    ds_read_b64_tr_b16 v[244:245], v13 offset:2048
    ds_read_b64_tr_b16 v[246:247], v13 offset:2560
    v_xor_b32 v13, 0x2040, v12
    v_add_u32 v13, 0x8000, v13
    ds_read_b64_tr_b16 v[248:249], v13
    ds_read_b64_tr_b16 v[250:251], v13 offset:512
    ds_read_b64_tr_b16 v[252:253], v13 offset:2048
    ds_read_b64_tr_b16 v[254:255], v13 offset:2560
    ds_write_b128 v123, v[80:83]
    ds_write_b128 v123, v[84:87] offset:1024
    ds_write_b128 v123, v[56:59] offset:2048
    ds_write_b128 v123, v[60:63] offset:3072
    ds_write_b128 v123, v[88:91] offset:4096
    ds_write_b128 v123, v[92:95] offset:5120
    ds_write_b128 v123, v[96:99] offset:6144
    ds_write_b128 v123, v[100:103] offset:7168
    s_cmp_eq_u32 s57, 1
    s_cbranch_scc1 L_started_52
    v_lshrrev_b32 v1, 4, v117
    v_and_b32 v2, 15, v1
    v_lshrrev_b32 v1, 4, v1
    v_lshlrev_b32 v1, 11, v1
    v_lshl_add_u32 v1, v2, 2, v1
    s_lshl_b32 s43, s20, 6
    s_add_u32 s43, s43, 0x2000
    s_mov_b32 exec_lo, 0x10001
    s_mov_b32 exec_hi, 0
    s_mov_b32 s96, 0
L_poll_53:
    buffer_load_dword v2, v1, s[8:11], s43 offen sc1
    s_waitcnt vmcnt(0)
    v_cmp_gt_u32 vcc, 1, v2
    s_cbranch_vccz L_polld_54
    s_sleep 8
    s_add_u32 s96, s96, 1
    s_cmp_lt_u32 s96, 0x10000
    s_cbranch_scc1 L_poll_53
L_polld_54:
    s_mov_b64 exec, -1
    s_add_u32 m0, s52, 8192
    s_nop 0
    buffer_load_dwordx4 v117, s[8:11], s30 offen lds
    buffer_load_dwordx4 v117, s[8:11], s30 offen offset:1024 lds
    s_add_u32 m0, s52, 0x6000
    s_nop 0
    buffer_load_dwordx4 v117, s[8:11], s31 offen lds
    buffer_load_dwordx4 v117, s[8:11], s31 offen offset:1024 lds
    s_mov_b32 s49, 0
L_cb_poll_56:
    buffer_load_dword v3, off, s[16:19], 0 offset:8 sc1
    s_waitcnt vmcnt(0)
    v_readfirstlane_b32 s43, v3
    s_nop 0
    s_cmp_ge_u32 s43, 32
    s_cbranch_scc1 L_started_52
    s_sleep 8
    s_add_u32 s49, s49, 1
    s_cmp_lt_u32 s49, 0x40000
    s_cbranch_scc1 L_cb_poll_56
L_started_52:
    s_add_u32 m0, s51, 4096
    v_mov_b32 v24, v32
    v_mov_b32 v25, v33
    v_mov_b32 v26, v34
    v_mov_b32 v27, v35
    v_mov_b32 v28, v36
    v_mov_b32 v29, v37
    v_mov_b32 v30, v38
    v_mov_b32 v31, v39
    s_add_u32 s30, s30, 0x40000
    s_add_u32 s31, s31, 0x40000
    s_mov_b32 s49, 0
    s_waitcnt vmcnt(0) lgkmcnt(0)
    s_barrier
    ds_write_b128 v123, v[64:67] offset:32768
    ds_write_b128 v123, v[68:71] offset:33792
    ds_write_b128 v123, v[72:75] offset:34816
    ds_write_b128 v123, v[76:79] offset:35840
    ds_write_b128 v123, v[104:107] offset:36864
    ds_write_b128 v123, v[108:111] offset:37888
    ds_write_b128 v123, v[32:35] offset:38912
    ds_write_b128 v123, v[36:39] offset:39936
    v_mov_b32 v32, 0
    v_mov_b32 v33, 0
    v_mov_b32 v34, 0
    v_mov_b32 v35, 0
    v_mov_b32 v36, 0
    v_mov_b32 v37, 0
    v_mov_b32 v38, 0
    v_mov_b32 v39, 0
    s_nop 4
    s_cmp_eq_u32 s21, 1
    s_cbranch_scc1 L_chain_top1_s
    s_cmp_eq_u32 s21, 2
    s_cbranch_scc1 L_chain_top2_s
    s_cmp_eq_u32 s21, 3
    s_cbranch_scc1 L_chain_top3_s
.p2align 6
L_chain_top0_s:
    buffer_load_dwordx4 v[0:3], v117, s[8:11], s23 offen sc1
    v_mov_b32 v15, 0
    v_mov_b32 v15, 0
    v_mov_b32 v15, 0
    v_mov_b32 v15, 0
    v_mov_b32 v15, 0
    v_mov_b32 v15, 0
    v_mov_b32 v15, 0
    v_mov_b32 v15, 0
    v_mov_b32 v15, 0
    v_mov_b32 v15, 0
    v_mov_b32 v15, 0
    v_mov_b32 v15, 0
    v_mov_b32 v15, 0
    v_mov_b32 v15, 0
    v_mov_b32 v15, 0
    v_mov_b32 v15, 0
    buffer_load_dwordx4 v[0:3], v117, s[8:11], s23 offen sc1
    v_mov_b32 v15, 0
    v_mov_b32 v15, 0
    v_mov_b32 v15, 0
    v_mov_b32 v15, 0
    v_mov_b32 v15, 0
    v_mov_b32 v15, 0
    v_mov_b32 v15, 0
    v_mov_b32 v15, 0
    v_mov_b32 v15, 0
    v_mov_b32 v15, 0
    v_mov_b32 v15, 0
    v_mov_b32 v15, 0
    v_mov_b32 v15, 0
    v_mov_b32 v15, 0
    v_mov_b32 v15, 0
    v_mov_b32 v15, 0
L_mret_58:
    buffer_load_dwordx4 v[0:3], v117, s[8:11], s23 offen sc1
    s_add_u32 s45, s45, 1
    s_cmp_lt_u32 s45, 0x10000
    s_cselect_b32 s56, -2, -1
    s_nop 3
    v_mov_b32 v32, 0
    v_mov_b32 v33, 0
    v_mov_b32 v34, 0
    v_mov_b32 v35, 0
    s_waitcnt vmcnt(2)
    v_max3_u32 v15, v0, v1, v2
    v_max_u32 v15, v15, v3
    v_cmp_lt_u32 vcc, s56, v15
    v_smfmac_f32_16x16x64_bf16 v[32:35], v[0:3], v[80:87], v116
    s_cbranch_vccnz L_mret_58
    ds_write_b128 v117, v[0:3]
    v_smfmac_f32_16x16x64_bf16 v[36:39], v[0:3], v[56:63], v116
    buffer_load_dwordx4 v[4:7], v117, s[8:11], s48 offen sc1
    v_smfmac_f32_16x16x64_bf16 v[40:43], v[0:3], v[64:71], v116
    buffer_load_dwordx4 v117, s[8:11], s48 offen sc1 lds
    s_mov_b32 m0, 8192
    v_smfmac_f32_16x16x64_bf16 v[44:47], v[0:3], v[72:79], v116
    s_waitcnt lgkmcnt(0)
    s_barrier
    ds_read_b128 v[8:11], v117 offset:1024
    v_smfmac_f32_16x16x64_bf16 v[48:51], v[0:3], a[192:199], v116
    ds_read_b128 v[16:19], v117 offset:2048
    ds_read_b128 v[20:23], v117 offset:3072
    v_smfmac_f32_16x16x64_bf16 v[52:55], v[0:3], a[200:207], v116
    ds_read_b128 v[80:83], v117 offset:14336
    s_waitcnt lgkmcnt(3)
    v_smfmac_f32_16x16x64_bf16 v[32:35], v[8:11], a[0:7], v116
    ds_read_b128 v[84:87], v117 offset:15360
    v_smfmac_f32_16x16x64_bf16 v[36:39], v[8:11], a[8:15], v116
    buffer_store_dwordx4 v[112:115], v117, s[8:11], s32 offen sc1
    s_waitcnt lgkmcnt(3)
    v_smfmac_f32_16x16x64_bf16 v[32:35], v[16:19], a[32:39], v116
    ds_read_b128 v[56:59], v117 offset:8192
    v_smfmac_f32_16x16x64_bf16 v[36:39], v[16:19], a[40:47], v116
    ds_read_b128 v[60:63], v117 offset:9216
    s_waitcnt lgkmcnt(4)
    v_smfmac_f32_16x16x64_bf16 v[32:35], v[20:23], a[64:71], v116
    ds_read_b128 v[64:67], v117 offset:10240
    v_smfmac_f32_16x16x64_bf16 v[36:39], v[20:23], a[72:79], v116
    ds_read_b128 v[68:71], v117 offset:11264
    v_smfmac_f32_16x16x64_bf16 v[40:43], v[8:11], a[96:103], v116
    ds_read_b128 v[72:75], v117 offset:12288
    v_smfmac_f32_16x16x64_bf16 v[40:43], v[16:19], a[128:135], v116
    ds_read_b128 v[76:79], v117 offset:13312
    v_smfmac_f32_16x16x64_bf16 v[40:43], v[20:23], a[160:167], v116
    s_waitcnt vmcnt(2)
    v_max3_u32 v15, v4, v5, v6
    v_smfmac_f32_16x16x64_bf16 v[44:47], v[8:11], a[104:111], v116
    v_max_u32 v15, v15, v7
    v_smfmac_f32_16x16x64_bf16 v[44:47], v[16:19], a[136:143], v116
    s_waitcnt vmcnt(1) lgkmcnt(0)
    v_cmp_lt_u32 vcc, s56, v15
    v_smfmac_f32_16x16x64_bf16 v[44:47], v[20:23], a[168:175], v116
    s_cbranch_vccnz L_mret_59
L_mgo_60:
    v_smfmac_f32_16x16x64_bf16 v[44:47], v[4:7], v[24:31], v116
    s_barrier
    ds_read_b128 v[12:15], v117 offset:5120
    v_smfmac_f32_16x16x64_bf16 v[32:35], v[4:7], v[88:95], v116
    ds_read_b128 v[24:27], v117 offset:6144
    v_smfmac_f32_16x16x64_bf16 v[36:39], v[4:7], v[96:103], v116
    ds_read_b128 v[28:31], v117 offset:7168
    v_smfmac_f32_16x16x64_bf16 v[40:43], v[4:7], v[104:111], v116
    ds_read_b128 v[88:91], v117 offset:24576
    s_waitcnt lgkmcnt(3)
    v_smfmac_f32_16x16x64_bf16 v[32:35], v[12:15], a[16:23], v116
    ds_read_b128 v[92:95], v117 offset:25600
    s_waitcnt lgkmcnt(3)
    v_smfmac_f32_16x16x64_bf16 v[32:35], v[24:27], a[48:55], v116
    buffer_load_dwordx4 v117, s[8:11], s30 offen lds
    s_waitcnt lgkmcnt(2)
    v_smfmac_f32_16x16x64_bf16 v[32:35], v[28:31], a[80:87], v116
    ds_read_b128 v[96:99], v117 offset:23552
    v_smfmac_f32_16x16x64_bf16 v[36:39], v[12:15], a[24:31], v116
    ds_read_b128 v[100:103], v117 offset:23552
    v_smfmac_f32_16x16x64_bf16 v[36:39], v[24:27], a[56:63], v116
    buffer_load_dwordx4 v117, s[8:11], s30 offen offset:1024 lds
    s_add_u32 m0, s52, 0x6000
    v_add_f32 v32, v32, v34
    v_smfmac_f32_16x16x64_bf16 v[36:39], v[28:31], a[88:95], v116
    ds_read_b128 v[104:107], v117 offset:23552
    v_add_f32 v33, v33, v35
    v_smfmac_f32_16x16x64_bf16 v[40:43], v[12:15], a[112:119], v116
    ds_read_b128 v[108:111], v117 offset:23552
    v_mul_f32 v32, s34, v32
    v_smfmac_f32_16x16x64_bf16 v[40:43], v[24:27], a[144:151], v116
    buffer_load_dword v125, v119, s[8:11], s28 offen sc1
    v_mul_f32 v33, s34, v33
    v_smfmac_f32_16x16x64_bf16 v[40:43], v[28:31], a[176:183], v116
    ds_read_b128 v[0:3], v124
    v_add_f32 v36, v36, v38
    v_smfmac_f32_16x16x64_bf16 v[48:51], v[4:7], a[208:215], v116
    v_add_f32 v37, v37, v39
    v_smfmac_f32_16x16x64_bf16 v[52:55], v[4:7], a[216:223], v116
    s_waitcnt lgkmcnt(5)
    buffer_load_dwordx4 v117, s[8:11], s31 offen lds
    v_mul_f32 v36, s34, v36
    v_smfmac_f32_16x16x64_bf16 v[44:47], v[12:15], a[120:127], v116
    ds_read_b128 v[4:7], v124 offset:1024
    v_mul_f32 v37, s34, v37
    v_smfmac_f32_16x16x64_bf16 v[44:47], v[24:27], a[152:159], v116
    v_cvt_pk_bf16_f32 v34, v32, v36
    v_smfmac_f32_16x16x64_bf16 v[44:47], v[28:31], a[184:191], v116
    buffer_load_dwordx4 v117, s[8:11], s31 offen offset:1024 lds
    s_mov_b32 m0, 4096
    v_cvt_pk_bf16_f32 v35, v33, v37
    v_add_f32 v40, v40, v42
    v_smfmac_f32_16x16x64_bf16 v[48:51], v[8:11], a[224:231], v116
    ds_write2_b32 v120, v34, v35 offset0:32 offset1:48
    v_add_f32 v41, v41, v43
    v_smfmac_f32_16x16x64_bf16 v[52:55], v[8:11], a[232:239], v116
    v_add_f32 v44, v44, v46
    v_add_f32 v45, v45, v47
    v_cvt_pk_bf16_f32 v113, v40, v44
    v_cvt_pk_bf16_f32 v115, v41, v45
    v_smfmac_f32_16x16x64_bf16 v[48:51], v[12:15], a[240:247], v116
    ds_write2_b32 v120, v113, v115 offset0:0 offset1:16
    v_smfmac_f32_16x16x64_bf16 v[52:55], v[12:15], a[248:255], v116
    s_cmp_eq_u32 s22, 63
    s_cbranch_scc1 L_chain_last_s
    buffer_store_dword v126, off, s[8:11], s44 sc1
    v_smfmac_f32_16x16x64_bf16 v[48:51], v[16:19], v[128:135], v116
    v_smfmac_f32_16x16x64_bf16 v[48:51], v[20:23], v[160:167], v116
    v_smfmac_f32_16x16x64_bf16 v[48:51], v[24:27], v[144:151], v116
    s_waitcnt lgkmcnt(0)
    s_barrier
    v_smfmac_f32_16x16x64_bf16 v[48:51], v[28:31], v[176:183], v116
    ds_read_b128 v[32:35], v121 offset:16384
    ds_read_b128 v[36:39], v121 offset:17408
    v_smfmac_f32_16x16x64_bf16 v[52:55], v[16:19], v[136:143], v116
    ds_read_b128 v[40:43], v121 offset:18432
    ds_read_b128 v[44:47], v121 offset:19456
    v_smfmac_f32_16x16x64_bf16 v[52:55], v[20:23], v[168:175], v116
    ds_read_b128 v[8:11], v124 offset:32768
    v_add_f32 v48, v48, v50
    v_smfmac_f32_16x16x64_bf16 v[52:55], v[24:27], v[152:159], v116
    ds_read_b128 v[12:15], v124 offset:33792
    v_add_f32 v49, v49, v51
    v_smfmac_f32_16x16x64_bf16 v[52:55], v[28:31], v[184:191], v116
    s_waitcnt lgkmcnt(5)
    v_cvt_pk_bf16_f32 v112, v48, v49
    v_mfma_f32_16x16x32_bf16 v[56:59], v[56:59], v[32:35], 0
    s_waitcnt lgkmcnt(4)
    v_mov_b32 v48, s50
    v_mov_b32 v49, s50
    v_mfma_f32_16x16x32_bf16 v[56:59], v[60:63], v[36:39], v[56:59]
    ds_read_b128 v[16:19], v124 offset:2048
    s_waitcnt lgkmcnt(4)
    v_mov_b32 v50, s50
    v_mov_b32 v51, s50
    v_mfma_f32_16x16x32_bf16 v[56:59], v[64:67], v[40:43], v[56:59]
    ds_read_b128 v[20:23], v124 offset:3072
    s_waitcnt lgkmcnt(4)
    v_add_f32 v52, v52, v54
    v_mfma_f32_16x16x32_bf16 v[56:59], v[68:71], v[44:47], v[56:59]
    ds_read_b128 v[24:27], v124 offset:4096
    v_add_f32 v53, v53, v55
    v_mfma_f32_16x16x32_bf16 v[60:63], v[72:75], v[32:35], 0
    ds_read_b128 v[28:31], v124 offset:5120
    v_cvt_pk_bf16_f32 v114, v52, v53
    v_mov_b32 v53, 0
    v_mfma_f32_16x16x32_bf16 v[60:63], v[76:79], v[36:39], v[60:63]
    v_exp_f32 v56, v56
    v_mfma_f32_16x16x32_bf16 v[60:63], v[80:83], v[40:43], v[60:63]
    v_exp_f32 v57, v57
    v_mfma_f32_16x16x32_bf16 v[60:63], v[84:87], v[44:47], v[60:63]
    v_exp_f32 v58, v58
    v_mfma_f32_16x16x32_bf16 v[64:67], v[32:35], v[32:35], 0
    v_exp_f32 v59, v59
    v_cvt_pk_bf16_f32 v68, v56, v57
    v_mfma_f32_16x16x32_bf16 v[64:67], v[36:39], v[36:39], v[64:67]
    v_exp_f32 v60, v60
    v_cvt_pk_bf16_f32 v69, v58, v59
    v_mfma_f32_16x16x32_bf16 v[64:67], v[40:43], v[40:43], v[64:67]
    v_exp_f32 v61, v61
    v_mfma_f32_16x16x32_bf16 v[64:67], v[44:47], v[44:47], v[64:67]
    v_exp_f32 v62, v62
    v_exp_f32 v63, v63
    v_cvt_pk_bf16_f32 v70, v60, v61
    v_cvt_pk_bf16_f32 v71, v62, v63
    s_nop 1
    v_mfma_f32_16x16x32_bf16 v[72:75], v[88:91], v[68:71], 0
    s_nop 0
    v_exp_f32 v64, v64
    v_mfma_f32_16x16x32_bf16 v[76:79], v[92:95], v[68:71], 0
    v_exp_f32 v65, v65
    v_mfma_f32_16x16x32_bf16 v[80:83], v[48:51], v[68:71], 0
    v_cvt_pk_bf16_f32 v52, v64, v65
    s_nop 1
    v_mfma_f32_16x16x16_bf16 v[72:75], v[112:113], v[52:53], v[72:75]
    ds_read_b128 v[32:35], v124 offset:6144
    v_mfma_f32_16x16x16_bf16 v[76:79], v[114:115], v[52:53], v[76:79]
    ds_read_b128 v[36:39], v124 offset:7168
    v_mfma_f32_16x16x16_bf16 v[80:83], v[48:49], v[52:53], v[80:83]
L_norm_61:
    s_mov_b64 vcc, s[36:37]
    v_mov_b32 v122, v122
    v_mov_b32 v122, v122
    v_mov_b32 v122, v122
    v_cndmask_b32_dpp v76, v72, v76, vcc quad_perm:[2,3,2,3] row_mask:0xf bank_mask:0xf
    v_cndmask_b32_dpp v77, v73, v77, vcc quad_perm:[2,3,2,3] row_mask:0xf bank_mask:0xf
    v_cndmask_b32_dpp v78, v74, v78, vcc quad_perm:[2,3,2,3] row_mask:0xf bank_mask:0xf
    v_cndmask_b32_dpp v79, v75, v79, vcc quad_perm:[2,3,2,3] row_mask:0xf bank_mask:0xf
    v_rcp_f32_dpp v84, v80 quad_perm:[2,3,2,3] row_mask:0xf bank_mask:0xf
    s_nop 0
    v_pk_mul_f32 v[76:77], v[76:77], v[84:85] op_sel_hi:[1,0]
    v_pk_mul_f32 v[78:79], v[78:79], v[84:85] op_sel_hi:[1,0]
    v_cvt_pk_bf16_f32 v72, v76, v77
    v_cvt_pk_bf16_f32 v73, v78, v79
    ds_write_b64 v122, v[72:73] offset:20480
    v_max_f32_dpp v86, v80, v84 quad_perm:[2,3,2,3] row_mask:0xf bank_mask:0xf
    v_mov_b32_dpp v60, v72 quad_perm:[0,1,0,1] row_mask:0xf bank_mask:0xf
    v_mov_b32_dpp v61, v73 quad_perm:[0,1,0,1] row_mask:0xf bank_mask:0xf
    v_cmp_lt_f32 vcc, s35, v86
    v_mov_b32_dpp v62, v72 quad_perm:[2,3,2,3] row_mask:0xf bank_mask:0xf
    v_mov_b32_dpp v63, v73 quad_perm:[2,3,2,3] row_mask:0xf bank_mask:0xf
    s_nop 1
    v_smfmac_f32_16x16x64_bf16 v[96:99], v[60:63], v[192:199], v116
    s_cbranch_vccnz L_smax_62
    v_smfmac_f32_16x16x64_bf16 v[100:103], v[60:63], v[224:231], v116
    s_waitcnt lgkmcnt(0)
    s_barrier
    ds_read_b128 v[92:95], v127 offset:20992
    ds_read_b128 v[80:83], v127 offset:21504
    ds_read_b128 v[84:87], v127 offset:22016
    v_smfmac_f32_16x16x64_bf16 v[104:107], v[60:63], v[0:7], v116
    ds_read_b128 v[40:43], v124 offset:34816
    v_smfmac_f32_16x16x64_bf16 v[108:111], v[60:63], v[8:15], v116
    ds_read_b128 v[56:59], v124 offset:36864
    s_waitcnt lgkmcnt(4)
    v_smfmac_f32_16x16x64_bf16 v[96:99], v[92:95], v[200:207], v116
    s_waitcnt lgkmcnt(3)
    v_smfmac_f32_16x16x64_bf16 v[96:99], v[80:83], v[208:215], v116
    ds_read_b128 v[44:47], v124 offset:35840
    s_waitcnt lgkmcnt(3)
    v_smfmac_f32_16x16x64_bf16 v[96:99], v[84:87], v[216:223], v116
    ds_read_b128 v[68:71], v124 offset:39936
    v_smfmac_f32_16x16x64_bf16 v[100:103], v[92:95], v[232:239], v116
    ds_read_b128 v[64:67], v124 offset:38912
    v_smfmac_f32_16x16x64_bf16 v[100:103], v[80:83], v[240:247], v116
    ds_read_b128 v[60:63], v124 offset:37888
    v_cvt_pk_bf16_f32 v72, v96, v98
    v_smfmac_f32_16x16x64_bf16 v[100:103], v[84:87], v[248:255], v116
    v_and_or_b32 v72, v72, -2, s33
    v_smfmac_f32_16x16x64_bf16 v[104:107], v[92:95], v[16:23], v116
    v_cvt_pk_bf16_f32 v74, v97, v99
    v_smfmac_f32_16x16x64_bf16 v[104:107], v[80:83], v[24:31], v116
    v_cvt_pk_bf16_f32 v73, v100, v102
    v_cvt_pk_bf16_f32 v75, v101, v103
    v_smfmac_f32_16x16x64_bf16 v[104:107], v[84:87], v[32:39], v116
    buffer_store_dwordx4 v[72:75], v118, s[8:11], s25 offen sc1
    s_waitcnt lgkmcnt(3)
    v_smfmac_f32_16x16x64_bf16 v[108:111], v[92:95], v[40:47], v116
    s_waitcnt lgkmcnt(0)
    v_smfmac_f32_16x16x64_bf16 v[108:111], v[80:83], v[56:63], v116
    v_cvt_pk_bf16_f32 v76, v104, v106
    v_smfmac_f32_16x16x64_bf16 v[108:111], v[84:87], v[64:71], v116
    v_and_or_b32 v76, v76, -2, s33
    v_cvt_pk_bf16_f32 v78, v105, v107
    v_mov_b32 v122, v122
    v_mov_b32 v122, v122
    v_mov_b32 v122, v122
    v_mov_b32 v122, v122
    v_mov_b32 v122, v122
    v_mov_b32 v122, v122
    v_cvt_pk_bf16_f32 v77, v108, v110
    v_cvt_pk_bf16_f32 v79, v109, v111
    buffer_store_dwordx4 v[76:79], v118, s[8:11], s26 offen sc1
    s_add_u32 s30, s30, 0x40000
    s_add_u32 s31, s31, 0x40000
    s_add_u32 s32, s32, 0x20000
    s_add_u32 s23, s24, 0
    s_add_u32 s48, s23, 4096
    s_xor_b32 s25, s25, 0x40000
    s_xor_b32 s26, s26, 0x40000
    s_mov_b32 s35, 0x49800000
    v_mov_b32 v126, s22
    s_add_u32 s22, s22, 1
    v_mov_b32 v32, 0
    v_mov_b32 v33, 0
    v_mov_b32 v34, 0
    v_mov_b32 v35, 0
    v_mov_b32 v36, 0
    v_mov_b32 v37, 0
    v_mov_b32 v38, 0
    v_mov_b32 v39, 0
    v_mov_b32 v40, 0
    v_mov_b32 v41, 0
    v_mov_b32 v42, 0
    v_mov_b32 v43, 0
    v_mov_b32 v44, 0
    v_mov_b32 v45, 0
    v_mov_b32 v46, 0
    v_mov_b32 v47, 0
    v_mov_b32 v48, 0
    v_mov_b32 v49, 0
    v_mov_b32 v50, 0
    v_mov_b32 v51, 0
    v_mov_b32 v52, 0
    v_mov_b32 v53, 0
    v_mov_b32 v54, 0
    v_mov_b32 v55, 0
    ds_read_b128 v[80:83], v123
    ds_read_b128 v[84:87], v123 offset:1024
    ds_read_b128 v[56:59], v123 offset:2048
    ds_read_b128 v[60:63], v123 offset:3072
    ds_read_b128 v[64:67], v123 offset:32768
    ds_read_b128 v[68:71], v123 offset:33792
    ds_read_b128 v[72:75], v123 offset:34816
    ds_read_b128 v[76:79], v123 offset:35840
    ds_read_b128 v[88:91], v123 offset:4096
    ds_read_b128 v[92:95], v123 offset:5120
    ds_read_b128 v[96:99], v123 offset:6144
    ds_read_b128 v[100:103], v123 offset:7168
    ds_read_b128 v[104:107], v123 offset:36864
    ds_read_b128 v[108:111], v123 offset:37888
    ds_read_b128 v[24:27], v123 offset:38912
    ds_read_b128 v[28:31], v123 offset:39936
    s_add_u32 s24, s24, 8192
    s_bitset0_b32 s24, 15
    s_xor_b32 s55, s24, 16384
    s_xor_b32 s29, s29, 0x40000
    s_xor_b32 s53, s29, 1024
    s_bfe_u32 s33, s22, 0x10001
    s_add_u32 s40, s22, 5
    s_lshr_b32 s40, s40, 2
    s_min_u32 s40, s40, 16
    s_bfm_b32 s58, s40, 0
    s_waitcnt vmcnt(5)
    v_cmp_eq_u32 vcc, 0, v125
    s_nop 0
    s_and_b64 vcc, vcc, s[58:59]
    s_cbranch_scc1 L_kvw_63
L_kvb_64:
    v_mov_b32 v15, 0
    s_nop 2
    v_mov_b32 v15, 0
    s_nop 2
    v_mov_b32 v15, 0
    s_nop 2
    v_mov_b32 v15, 0
    s_nop 2
    v_mov_b32 v15, 0
    s_nop 2
    v_mov_b32 v15, 0
    s_nop 2
    v_mov_b32 v15, 0
    s_nop 2
    v_mov_b32 v15, 0
    s_nop 2
    v_mov_b32 v15, 0
    s_nop 2
    v_mov_b32 v15, 0
    s_nop 2
    v_mov_b32 v15, 0
    s_nop 2
    v_mov_b32 v15, 0
    s_nop 2
    v_mov_b32 v15, 0
    s_nop 2
    v_mov_b32 v15, 0
    s_nop 2
    v_mov_b32 v15, 0
    s_nop 2
    v_mov_b32 v15, 0
    s_nop 2
    v_mov_b32 v15, 0
    s_nop 2
    v_mov_b32 v15, 0
    s_nop 2
    v_mov_b32 v15, 0
    s_nop 2
    v_mov_b32 v15, 0
    s_nop 2
    v_mov_b32 v15, 0
    s_nop 2
    v_mov_b32 v15, 0
    s_nop 2
    v_mov_b32 v15, 0
    s_nop 2
    v_mov_b32 v15, 0
    s_nop 2
    v_mov_b32 v15, 0
    s_nop 2
    v_mov_b32 v15, 0
    s_nop 2
    v_mov_b32 v15, 0
    s_nop 2
    v_mov_b32 v15, 0
    s_nop 2
    v_mov_b32 v15, 0
    s_nop 2
    v_mov_b32 v15, 0
    s_nop 2
    v_mov_b32 v15, 0
    s_nop 2
    s_waitcnt lgkmcnt(0)
    s_branch L_chain_top0_s
.p2align 6
L_chain_top1_s:
    buffer_load_dwordx4 v[0:3], v117, s[8:11], s23 offen sc1
    v_mov_b32 v15, 0
    v_mov_b32 v15, 0
    v_mov_b32 v15, 0
    v_mov_b32 v15, 0
    v_mov_b32 v15, 0
    v_mov_b32 v15, 0
    v_mov_b32 v15, 0
    v_mov_b32 v15, 0
    v_mov_b32 v15, 0
    v_mov_b32 v15, 0
    v_mov_b32 v15, 0
    v_mov_b32 v15, 0
    v_mov_b32 v15, 0
    v_mov_b32 v15, 0
    v_mov_b32 v15, 0
    v_mov_b32 v15, 0
    buffer_load_dwordx4 v[0:3], v117, s[8:11], s23 offen sc1
    v_mov_b32 v15, 0
    v_mov_b32 v15, 0
    v_mov_b32 v15, 0
    v_mov_b32 v15, 0
    v_mov_b32 v15, 0
    v_mov_b32 v15, 0
    v_mov_b32 v15, 0
    v_mov_b32 v15, 0
    v_mov_b32 v15, 0
    v_mov_b32 v15, 0
    v_mov_b32 v15, 0
    v_mov_b32 v15, 0
    v_mov_b32 v15, 0
    v_mov_b32 v15, 0
    v_mov_b32 v15, 0
    v_mov_b32 v15, 0
L_mret_65:
    buffer_load_dwordx4 v[0:3], v117, s[8:11], s23 offen sc1
    s_add_u32 s45, s45, 1
    s_cmp_lt_u32 s45, 0x10000
    s_cselect_b32 s56, -2, -1
    s_nop 3
    v_mov_b32 v32, 0
    v_mov_b32 v33, 0
    v_mov_b32 v34, 0
    v_mov_b32 v35, 0
    s_waitcnt vmcnt(2)
    v_max3_u32 v15, v0, v1, v2
    v_max_u32 v15, v15, v3
    v_cmp_lt_u32 vcc, s56, v15
    v_smfmac_f32_16x16x64_bf16 v[32:35], v[0:3], v[80:87], v116
    s_cbranch_vccnz L_mret_65
    ds_write_b128 v117, v[0:3] offset:1024
    v_smfmac_f32_16x16x64_bf16 v[36:39], v[0:3], v[56:63], v116
    buffer_load_dwordx4 v[4:7], v117, s[8:11], s48 offen sc1
    v_smfmac_f32_16x16x64_bf16 v[40:43], v[0:3], v[64:71], v116
    buffer_load_dwordx4 v117, s[8:11], s48 offen sc1 lds
    s_mov_b32 m0, 10240
    v_smfmac_f32_16x16x64_bf16 v[44:47], v[0:3], v[72:79], v116
    s_waitcnt lgkmcnt(0)
    s_barrier
    ds_read_b128 v[8:11], v117
    v_smfmac_f32_16x16x64_bf16 v[48:51], v[0:3], a[192:199], v116
    ds_read_b128 v[16:19], v117 offset:3072
    ds_read_b128 v[20:23], v117 offset:2048
    v_smfmac_f32_16x16x64_bf16 v[52:55], v[0:3], a[200:207], v116
    ds_read_b128 v[80:83], v117 offset:14336
    s_waitcnt lgkmcnt(3)
    v_smfmac_f32_16x16x64_bf16 v[32:35], v[8:11], a[0:7], v116
    ds_read_b128 v[84:87], v117 offset:15360
    v_smfmac_f32_16x16x64_bf16 v[36:39], v[8:11], a[8:15], v116
    ds_read_b128 v[56:59], v117 offset:8192
    s_waitcnt lgkmcnt(4)
    v_smfmac_f32_16x16x64_bf16 v[32:35], v[16:19], a[32:39], v116
    ds_read_b128 v[60:63], v117 offset:9216
    v_smfmac_f32_16x16x64_bf16 v[36:39], v[16:19], a[40:47], v116
    buffer_store_dwordx4 v[112:115], v117, s[8:11], s32 offen sc1
    s_waitcnt lgkmcnt(4)
    v_smfmac_f32_16x16x64_bf16 v[32:35], v[20:23], a[64:71], v116
    ds_read_b128 v[64:67], v117 offset:10240
    v_smfmac_f32_16x16x64_bf16 v[36:39], v[20:23], a[72:79], v116
    ds_read_b128 v[68:71], v117 offset:11264
    v_smfmac_f32_16x16x64_bf16 v[40:43], v[8:11], a[96:103], v116
    ds_read_b128 v[72:75], v117 offset:12288
    v_smfmac_f32_16x16x64_bf16 v[40:43], v[16:19], a[128:135], v116
    ds_read_b128 v[76:79], v117 offset:13312
    v_smfmac_f32_16x16x64_bf16 v[40:43], v[20:23], a[160:167], v116
    s_waitcnt vmcnt(2)
    v_max3_u32 v15, v4, v5, v6
    v_smfmac_f32_16x16x64_bf16 v[44:47], v[8:11], a[104:111], v116
    v_max_u32 v15, v15, v7
    v_smfmac_f32_16x16x64_bf16 v[44:47], v[16:19], a[136:143], v116
    s_waitcnt vmcnt(1) lgkmcnt(0)
    v_cmp_lt_u32 vcc, s56, v15
    v_smfmac_f32_16x16x64_bf16 v[44:47], v[20:23], a[168:175], v116
    s_cbranch_vccnz L_mret_66
L_mgo_67:
    v_smfmac_f32_16x16x64_bf16 v[44:47], v[4:7], v[24:31], v116
    s_barrier
    ds_read_b128 v[12:15], v117 offset:4096
    v_smfmac_f32_16x16x64_bf16 v[32:35], v[4:7], v[88:95], v116
    ds_read_b128 v[24:27], v117 offset:7168
    v_smfmac_f32_16x16x64_bf16 v[36:39], v[4:7], v[96:103], v116
    ds_read_b128 v[28:31], v117 offset:6144
    v_smfmac_f32_16x16x64_bf16 v[40:43], v[4:7], v[104:111], v116
    ds_read_b128 v[88:91], v117 offset:26624
    s_waitcnt lgkmcnt(3)
    v_smfmac_f32_16x16x64_bf16 v[32:35], v[12:15], a[16:23], v116
    ds_read_b128 v[92:95], v117 offset:27648
    s_waitcnt lgkmcnt(3)
    v_smfmac_f32_16x16x64_bf16 v[32:35], v[24:27], a[48:55], v116
    buffer_load_dwordx4 v117, s[8:11], s30 offen lds
    s_waitcnt lgkmcnt(2)
    v_smfmac_f32_16x16x64_bf16 v[32:35], v[28:31], a[80:87], v116
    ds_read_b128 v[96:99], v117 offset:23552
    v_smfmac_f32_16x16x64_bf16 v[36:39], v[12:15], a[24:31], v116
    ds_read_b128 v[100:103], v117 offset:23552
    v_smfmac_f32_16x16x64_bf16 v[36:39], v[24:27], a[56:63], v116
    buffer_load_dwordx4 v117, s[8:11], s30 offen offset:1024 lds
    s_add_u32 m0, s52, 0x6000
    v_add_f32 v32, v32, v34
    v_smfmac_f32_16x16x64_bf16 v[36:39], v[28:31], a[88:95], v116
    ds_read_b128 v[104:107], v117 offset:23552
    v_add_f32 v33, v33, v35
    v_smfmac_f32_16x16x64_bf16 v[40:43], v[12:15], a[112:119], v116
    ds_read_b128 v[108:111], v117 offset:23552
    v_mul_f32 v32, s34, v32
    v_smfmac_f32_16x16x64_bf16 v[40:43], v[24:27], a[144:151], v116
    buffer_load_dword v125, v119, s[8:11], s28 offen sc1
    v_mul_f32 v33, s34, v33
    v_smfmac_f32_16x16x64_bf16 v[40:43], v[28:31], a[176:183], v116
    ds_read_b128 v[0:3], v124
    v_add_f32 v36, v36, v38
    v_smfmac_f32_16x16x64_bf16 v[48:51], v[4:7], a[208:215], v116
    v_add_f32 v37, v37, v39
    v_smfmac_f32_16x16x64_bf16 v[52:55], v[4:7], a[216:223], v116
    s_waitcnt lgkmcnt(5)
    buffer_load_dwordx4 v117, s[8:11], s31 offen lds
    v_mul_f32 v36, s34, v36
    v_smfmac_f32_16x16x64_bf16 v[44:47], v[12:15], a[120:127], v116
    ds_read_b128 v[4:7], v124 offset:1024
    v_mul_f32 v37, s34, v37
    v_smfmac_f32_16x16x64_bf16 v[44:47], v[24:27], a[152:159], v116
    v_cvt_pk_bf16_f32 v34, v32, v36
    v_smfmac_f32_16x16x64_bf16 v[44:47], v[28:31], a[184:191], v116
    buffer_load_dwordx4 v117, s[8:11], s31 offen offset:1024 lds
    s_mov_b32 m0, 5120
    v_cvt_pk_bf16_f32 v35, v33, v37
    v_add_f32 v40, v40, v42
    v_smfmac_f32_16x16x64_bf16 v[48:51], v[8:11], a[224:231], v116
    ds_write2_b32 v120, v34, v35 offset0:32 offset1:48
    v_add_f32 v41, v41, v43
    v_smfmac_f32_16x16x64_bf16 v[52:55], v[8:11], a[232:239], v116
    v_add_f32 v44, v44, v46
    v_add_f32 v45, v45, v47
    v_cvt_pk_bf16_f32 v113, v40, v44
    v_cvt_pk_bf16_f32 v115, v41, v45
    v_smfmac_f32_16x16x64_bf16 v[48:51], v[12:15], a[240:247], v116
    ds_write2_b32 v120, v113, v115 offset0:0 offset1:16
    v_smfmac_f32_16x16x64_bf16 v[52:55], v[12:15], a[248:255], v116
    s_cmp_eq_u32 s22, 63
    s_cbranch_scc1 L_chain_last_s
    v_smfmac_f32_16x16x64_bf16 v[48:51], v[16:19], v[128:135], v116
    v_smfmac_f32_16x16x64_bf16 v[48:51], v[20:23], v[160:167], v116
    v_smfmac_f32_16x16x64_bf16 v[48:51], v[24:27], v[144:151], v116
    s_waitcnt lgkmcnt(0)
    s_barrier
    v_smfmac_f32_16x16x64_bf16 v[48:51], v[28:31], v[176:183], v116
    ds_read_b128 v[32:35], v121 offset:16384
    ds_read_b128 v[36:39], v121 offset:17408
    v_smfmac_f32_16x16x64_bf16 v[52:55], v[16:19], v[136:143], v116
    ds_read_b128 v[40:43], v121 offset:18432
    ds_read_b128 v[44:47], v121 offset:19456
    v_smfmac_f32_16x16x64_bf16 v[52:55], v[20:23], v[168:175], v116
    ds_read_b128 v[8:11], v124 offset:32768
    v_add_f32 v48, v48, v50
    v_smfmac_f32_16x16x64_bf16 v[52:55], v[24:27], v[152:159], v116
    ds_read_b128 v[12:15], v124 offset:33792
    v_add_f32 v49, v49, v51
    v_smfmac_f32_16x16x64_bf16 v[52:55], v[28:31], v[184:191], v116
    s_waitcnt lgkmcnt(5)
    v_cvt_pk_bf16_f32 v112, v48, v49
    v_mfma_f32_16x16x32_bf16 v[56:59], v[56:59], v[32:35], 0
    s_waitcnt lgkmcnt(4)
    v_mov_b32 v48, s50
    v_mov_b32 v49, s50
    v_mfma_f32_16x16x32_bf16 v[56:59], v[60:63], v[36:39], v[56:59]
    ds_read_b128 v[16:19], v124 offset:2048
    s_waitcnt lgkmcnt(4)
    v_mov_b32 v50, s50
    v_mov_b32 v51, s50
    v_mfma_f32_16x16x32_bf16 v[56:59], v[64:67], v[40:43], v[56:59]
    ds_read_b128 v[20:23], v124 offset:3072
    s_waitcnt lgkmcnt(4)
    v_add_f32 v52, v52, v54
    v_mfma_f32_16x16x32_bf16 v[56:59], v[68:71], v[44:47], v[56:59]
    ds_read_b128 v[24:27], v124 offset:4096
    v_add_f32 v53, v53, v55
    v_mfma_f32_16x16x32_bf16 v[60:63], v[72:75], v[32:35], 0
    ds_read_b128 v[28:31], v124 offset:5120
    v_cvt_pk_bf16_f32 v114, v52, v53
    v_mov_b32 v53, 0
    v_mfma_f32_16x16x32_bf16 v[60:63], v[76:79], v[36:39], v[60:63]
    v_exp_f32 v56, v56
    v_mfma_f32_16x16x32_bf16 v[60:63], v[80:83], v[40:43], v[60:63]
    v_exp_f32 v57, v57
    v_mfma_f32_16x16x32_bf16 v[60:63], v[84:87], v[44:47], v[60:63]
    v_exp_f32 v58, v58
    v_mfma_f32_16x16x32_bf16 v[64:67], v[32:35], v[32:35], 0
    v_exp_f32 v59, v59
    v_cvt_pk_bf16_f32 v68, v56, v57
    v_mfma_f32_16x16x32_bf16 v[64:67], v[36:39], v[36:39], v[64:67]
    v_exp_f32 v60, v60
    v_cvt_pk_bf16_f32 v69, v58, v59
    v_mfma_f32_16x16x32_bf16 v[64:67], v[40:43], v[40:43], v[64:67]
    v_exp_f32 v61, v61
    v_mfma_f32_16x16x32_bf16 v[64:67], v[44:47], v[44:47], v[64:67]
    v_exp_f32 v62, v62
    v_exp_f32 v63, v63
    v_cvt_pk_bf16_f32 v70, v60, v61
    v_cvt_pk_bf16_f32 v71, v62, v63
    s_nop 1
    v_mfma_f32_16x16x32_bf16 v[72:75], v[88:91], v[68:71], 0
    s_nop 0
    v_exp_f32 v64, v64
    v_mfma_f32_16x16x32_bf16 v[76:79], v[92:95], v[68:71], 0
    v_exp_f32 v65, v65
    v_mfma_f32_16x16x32_bf16 v[80:83], v[48:51], v[68:71], 0
    v_cvt_pk_bf16_f32 v52, v64, v65
    s_nop 1
    v_mfma_f32_16x16x16_bf16 v[72:75], v[112:113], v[52:53], v[72:75]
    ds_read_b128 v[32:35], v124 offset:6144
    v_mfma_f32_16x16x16_bf16 v[76:79], v[114:115], v[52:53], v[76:79]
    ds_read_b128 v[36:39], v124 offset:7168
    v_mfma_f32_16x16x16_bf16 v[80:83], v[48:49], v[52:53], v[80:83]
L_norm_68:
    s_mov_b64 vcc, s[36:37]
    v_mov_b32 v122, v122
    v_mov_b32 v122, v122
    v_mov_b32 v122, v122
    v_cndmask_b32_dpp v76, v72, v76, vcc quad_perm:[2,3,2,3] row_mask:0xf bank_mask:0xf
    v_cndmask_b32_dpp v77, v73, v77, vcc quad_perm:[2,3,2,3] row_mask:0xf bank_mask:0xf
    v_cndmask_b32_dpp v78, v74, v78, vcc quad_perm:[2,3,2,3] row_mask:0xf bank_mask:0xf
    v_cndmask_b32_dpp v79, v75, v79, vcc quad_perm:[2,3,2,3] row_mask:0xf bank_mask:0xf
    v_rcp_f32_dpp v84, v80 quad_perm:[2,3,2,3] row_mask:0xf bank_mask:0xf
    s_nop 0
    v_pk_mul_f32 v[76:77], v[76:77], v[84:85] op_sel_hi:[1,0]
    v_pk_mul_f32 v[78:79], v[78:79], v[84:85] op_sel_hi:[1,0]
    v_cvt_pk_bf16_f32 v72, v76, v77
    v_cvt_pk_bf16_f32 v73, v78, v79
    ds_write_b64 v122, v[72:73] offset:20992
    v_max_f32_dpp v86, v80, v84 quad_perm:[2,3,2,3] row_mask:0xf bank_mask:0xf
    v_mov_b32_dpp v60, v72 quad_perm:[0,1,0,1] row_mask:0xf bank_mask:0xf
    v_mov_b32_dpp v61, v73 quad_perm:[0,1,0,1] row_mask:0xf bank_mask:0xf
    v_cmp_lt_f32 vcc, s35, v86
    v_mov_b32_dpp v62, v72 quad_perm:[2,3,2,3] row_mask:0xf bank_mask:0xf
    v_mov_b32_dpp v63, v73 quad_perm:[2,3,2,3] row_mask:0xf bank_mask:0xf
    s_nop 1
    v_smfmac_f32_16x16x64_bf16 v[96:99], v[60:63], v[192:199], v116
    s_cbranch_vccnz L_smax_69
    v_smfmac_f32_16x16x64_bf16 v[100:103], v[60:63], v[224:231], v116
    s_waitcnt lgkmcnt(0)
    s_barrier
    ds_read_b128 v[92:95], v127 offset:20480
    ds_read_b128 v[80:83], v127 offset:22016
    ds_read_b128 v[84:87], v127 offset:21504
    v_smfmac_f32_16x16x64_bf16 v[104:107], v[60:63], v[0:7], v116
    ds_read_b128 v[40:43], v124 offset:34816
    v_smfmac_f32_16x16x64_bf16 v[108:111], v[60:63], v[8:15], v116
    ds_read_b128 v[56:59], v124 offset:36864
    s_waitcnt lgkmcnt(4)
    v_smfmac_f32_16x16x64_bf16 v[96:99], v[92:95], v[200:207], v116
    s_waitcnt lgkmcnt(3)
    v_smfmac_f32_16x16x64_bf16 v[96:99], v[80:83], v[208:215], v116
    ds_read_b128 v[44:47], v124 offset:35840
    s_waitcnt lgkmcnt(3)
    v_smfmac_f32_16x16x64_bf16 v[96:99], v[84:87], v[216:223], v116
    ds_read_b128 v[68:71], v124 offset:39936
    v_smfmac_f32_16x16x64_bf16 v[100:103], v[92:95], v[232:239], v116
    ds_read_b128 v[64:67], v124 offset:38912
    v_smfmac_f32_16x16x64_bf16 v[100:103], v[80:83], v[240:247], v116
    ds_read_b128 v[60:63], v124 offset:37888
    v_cvt_pk_bf16_f32 v72, v96, v98
    v_smfmac_f32_16x16x64_bf16 v[100:103], v[84:87], v[248:255], v116
    v_and_or_b32 v72, v72, -2, s33
    v_smfmac_f32_16x16x64_bf16 v[104:107], v[92:95], v[16:23], v116
    v_cvt_pk_bf16_f32 v74, v97, v99
    v_smfmac_f32_16x16x64_bf16 v[104:107], v[80:83], v[24:31], v116
    v_cvt_pk_bf16_f32 v73, v100, v102
    v_cvt_pk_bf16_f32 v75, v101, v103
    v_smfmac_f32_16x16x64_bf16 v[104:107], v[84:87], v[32:39], v116
    buffer_store_dwordx4 v[72:75], v118, s[8:11], s25 offen sc1
    s_waitcnt lgkmcnt(3)
    v_smfmac_f32_16x16x64_bf16 v[108:111], v[92:95], v[40:47], v116
    s_waitcnt lgkmcnt(0)
    v_smfmac_f32_16x16x64_bf16 v[108:111], v[80:83], v[56:63], v116
    v_cvt_pk_bf16_f32 v76, v104, v106
    v_smfmac_f32_16x16x64_bf16 v[108:111], v[84:87], v[64:71], v116
    v_and_or_b32 v76, v76, -2, s33
    v_cvt_pk_bf16_f32 v78, v105, v107
    v_mov_b32 v122, v122
    v_mov_b32 v122, v122
    v_mov_b32 v122, v122
    v_mov_b32 v122, v122
    v_mov_b32 v122, v122
    v_mov_b32 v122, v122
    v_cvt_pk_bf16_f32 v77, v108, v110
    v_cvt_pk_bf16_f32 v79, v109, v111
    buffer_store_dwordx4 v[76:79], v118, s[8:11], s26 offen sc1
    s_add_u32 s30, s30, 0x40000
    s_add_u32 s31, s31, 0x40000
    s_add_u32 s32, s32, 0x20000
    s_add_u32 s23, s24, 1024
    s_add_u32 s48, s23, 4096
    s_xor_b32 s25, s25, 0x40000
    s_xor_b32 s26, s26, 0x40000
    s_mov_b32 s35, 0x49800000
    s_add_u32 s22, s22, 1
    v_mov_b32 v32, 0
    v_mov_b32 v33, 0
    v_mov_b32 v34, 0
    v_mov_b32 v35, 0
    v_mov_b32 v36, 0
    v_mov_b32 v37, 0
    v_mov_b32 v38, 0
    v_mov_b32 v39, 0
    v_mov_b32 v40, 0
    v_mov_b32 v41, 0
    v_mov_b32 v42, 0
    v_mov_b32 v43, 0
    v_mov_b32 v44, 0
    v_mov_b32 v45, 0
    v_mov_b32 v46, 0
    v_mov_b32 v47, 0
    v_mov_b32 v48, 0
    v_mov_b32 v49, 0
    v_mov_b32 v50, 0
    v_mov_b32 v51, 0
    v_mov_b32 v52, 0
    v_mov_b32 v53, 0
    v_mov_b32 v54, 0
    v_mov_b32 v55, 0
    ds_read_b128 v[80:83], v123
    ds_read_b128 v[84:87], v123 offset:1024
    ds_read_b128 v[56:59], v123 offset:2048
    ds_read_b128 v[60:63], v123 offset:3072
    ds_read_b128 v[64:67], v123 offset:32768
    ds_read_b128 v[68:71], v123 offset:33792
    ds_read_b128 v[72:75], v123 offset:34816
    ds_read_b128 v[76:79], v123 offset:35840
    ds_read_b128 v[88:91], v123 offset:4096
    ds_read_b128 v[92:95], v123 offset:5120
    ds_read_b128 v[96:99], v123 offset:6144
    ds_read_b128 v[100:103], v123 offset:7168
    ds_read_b128 v[104:107], v123 offset:36864
    ds_read_b128 v[108:111], v123 offset:37888
    ds_read_b128 v[24:27], v123 offset:38912
    ds_read_b128 v[28:31], v123 offset:39936
    s_add_u32 s24, s24, 8192
    s_bitset0_b32 s24, 15
    s_xor_b32 s55, s24, 16384
    s_xor_b32 s29, s29, 0x40000
    s_xor_b32 s53, s29, 1024
    s_bfe_u32 s33, s22, 0x10001
    s_add_u32 s40, s22, 5
    s_lshr_b32 s40, s40, 2
    s_min_u32 s40, s40, 16
    s_bfm_b32 s58, s40, 0
    s_waitcnt vmcnt(4)
    v_cmp_eq_u32 vcc, 0, v125
    s_nop 0
    s_and_b64 vcc, vcc, s[58:59]
    s_cbranch_scc1 L_kvw_70
L_kvb_71:
    v_mov_b32 v15, 0
    s_nop 2
    v_mov_b32 v15, 0
    s_nop 2
    v_mov_b32 v15, 0
    s_nop 2
    v_mov_b32 v15, 0
    s_nop 2
    v_mov_b32 v15, 0
    s_nop 2
    v_mov_b32 v15, 0
    s_nop 2
    v_mov_b32 v15, 0
    s_nop 2
    v_mov_b32 v15, 0
    s_nop 2
    v_mov_b32 v15, 0
    s_nop 2
    v_mov_b32 v15, 0
    s_nop 2
    v_mov_b32 v15, 0
    s_nop 2
    v_mov_b32 v15, 0
    s_nop 2
    v_mov_b32 v15, 0
    s_nop 2
    v_mov_b32 v15, 0
    s_nop 2
    v_mov_b32 v15, 0
    s_nop 2
    v_mov_b32 v15, 0
    s_nop 2
    v_mov_b32 v15, 0
    s_nop 2
    v_mov_b32 v15, 0
    s_nop 2
    v_mov_b32 v15, 0
    s_nop 2
    v_mov_b32 v15, 0
    s_nop 2
    v_mov_b32 v15, 0
    s_nop 2
    v_mov_b32 v15, 0
    s_nop 2
    v_mov_b32 v15, 0
    s_nop 2
    v_mov_b32 v15, 0
    s_nop 2
    v_mov_b32 v15, 0
    s_nop 2
    v_mov_b32 v15, 0
    s_nop 2
    v_mov_b32 v15, 0
    s_nop 2
    v_mov_b32 v15, 0
    s_nop 2
    v_mov_b32 v15, 0
    s_nop 2
    v_mov_b32 v15, 0
    s_nop 2
    v_mov_b32 v15, 0
    s_nop 2
    s_waitcnt lgkmcnt(0)
    s_branch L_chain_top1_s
.p2align 6
L_chain_top2_s:
    buffer_load_dwordx4 v[0:3], v117, s[8:11], s23 offen sc1
    v_mov_b32 v48, 0
    v_mov_b32 v49, 0
    v_mov_b32 v50, 0
    v_mov_b32 v51, 0
    v_mov_b32 v52, 0
    v_mov_b32 v53, 0
    v_mov_b32 v15, 0
    v_mov_b32 v15, 0
    v_mov_b32 v15, 0
    v_mov_b32 v15, 0
    v_mov_b32 v15, 0
    v_mov_b32 v15, 0
    v_mov_b32 v15, 0
    v_mov_b32 v15, 0
    v_mov_b32 v15, 0
    v_mov_b32 v15, 0
    buffer_load_dwordx4 v[0:3], v117, s[8:11], s23 offen sc1
    s_waitcnt vmcnt(3)
    v_mov_b32 v36, 0
    v_mov_b32 v37, 0
    v_mov_b32 v38, 0
    v_mov_b32 v39, 0
    v_mov_b32 v40, 0
    v_mov_b32 v41, 0
    v_mov_b32 v42, 0
    v_mov_b32 v43, 0
    v_mov_b32 v44, 0
    v_mov_b32 v45, 0
    v_mov_b32 v46, 0
    v_mov_b32 v47, 0
    v_mov_b32 v15, 0
    v_mov_b32 v15, 0
    v_mov_b32 v15, 0
    v_mov_b32 v15, 0
L_mret_72:
    buffer_load_dwordx4 v[0:3], v117, s[8:11], s23 offen sc1
    s_add_u32 s45, s45, 1
    s_cmp_lt_u32 s45, 0x10000
    s_cselect_b32 s56, -2, -1
    s_nop 3
    v_mov_b32 v32, 0
    v_mov_b32 v33, 0
    v_mov_b32 v34, 0
    v_mov_b32 v35, 0
    s_waitcnt vmcnt(2)
    v_max3_u32 v15, v0, v1, v2
    v_max_u32 v15, v15, v3
    v_cmp_lt_u32 vcc, s56, v15
    v_smfmac_f32_16x16x64_bf16 v[32:35], v[0:3], v[80:87], v116
    s_cbranch_vccnz L_mret_72
    ds_write_b128 v117, v[0:3] offset:2048
    v_smfmac_f32_16x16x64_bf16 v[36:39], v[0:3], v[56:63], v116
    buffer_load_dwordx4 v[4:7], v117, s[8:11], s48 offen sc1
    v_smfmac_f32_16x16x64_bf16 v[40:43], v[0:3], v[64:71], v116
    buffer_load_dwordx4 v117, s[8:11], s48 offen sc1 lds
    s_mov_b32 m0, 12288
    v_smfmac_f32_16x16x64_bf16 v[44:47], v[0:3], v[72:79], v116
    s_waitcnt lgkmcnt(0)
    s_barrier
    ds_read_b128 v[8:11], v117 offset:3072
    v_smfmac_f32_16x16x64_bf16 v[48:51], v[0:3], a[192:199], v116
    ds_read_b128 v[16:19], v117
    ds_read_b128 v[20:23], v117 offset:1024
    v_smfmac_f32_16x16x64_bf16 v[52:55], v[0:3], a[200:207], v116
    ds_read_b128 v[80:83], v117 offset:14336
    s_waitcnt lgkmcnt(3)
    v_smfmac_f32_16x16x64_bf16 v[32:35], v[8:11], a[0:7], v116
    ds_read_b128 v[84:87], v117 offset:15360
    v_smfmac_f32_16x16x64_bf16 v[36:39], v[8:11], a[8:15], v116
    ds_read_b128 v[56:59], v117 offset:8192
    s_waitcnt lgkmcnt(4)
    v_smfmac_f32_16x16x64_bf16 v[32:35], v[16:19], a[32:39], v116
    ds_read_b128 v[60:63], v117 offset:9216
    v_smfmac_f32_16x16x64_bf16 v[36:39], v[16:19], a[40:47], v116
    ds_read_b128 v[64:67], v117 offset:10240
    s_waitcnt lgkmcnt(5)
    v_smfmac_f32_16x16x64_bf16 v[32:35], v[20:23], a[64:71], v116
    ds_read_b128 v[68:71], v117 offset:11264
    v_smfmac_f32_16x16x64_bf16 v[36:39], v[20:23], a[72:79], v116
    buffer_store_dwordx4 v[112:115], v117, s[8:11], s32 offen sc1
    v_smfmac_f32_16x16x64_bf16 v[40:43], v[8:11], a[96:103], v116
    ds_read_b128 v[72:75], v117 offset:12288
    v_smfmac_f32_16x16x64_bf16 v[40:43], v[16:19], a[128:135], v116
    ds_read_b128 v[76:79], v117 offset:13312
    v_smfmac_f32_16x16x64_bf16 v[40:43], v[20:23], a[160:167], v116
    s_waitcnt vmcnt(2)
    v_max3_u32 v15, v4, v5, v6
    v_smfmac_f32_16x16x64_bf16 v[44:47], v[8:11], a[104:111], v116
    v_max_u32 v15, v15, v7
    v_smfmac_f32_16x16x64_bf16 v[44:47], v[16:19], a[136:143], v116
    s_waitcnt vmcnt(1) lgkmcnt(0)
    v_cmp_lt_u32 vcc, s56, v15
    v_smfmac_f32_16x16x64_bf16 v[44:47], v[20:23], a[168:175], v116
    s_cbranch_vccnz L_mret_73
L_mgo_74:
    v_smfmac_f32_16x16x64_bf16 v[44:47], v[4:7], v[24:31], v116
    s_barrier
    ds_read_b128 v[12:15], v117 offset:7168
    v_smfmac_f32_16x16x64_bf16 v[32:35], v[4:7], v[88:95], v116
    ds_read_b128 v[24:27], v117 offset:4096
    v_smfmac_f32_16x16x64_bf16 v[36:39], v[4:7], v[96:103], v116
    ds_read_b128 v[28:31], v117 offset:5120
    v_smfmac_f32_16x16x64_bf16 v[40:43], v[4:7], v[104:111], v116
    ds_read_b128 v[88:91], v117 offset:28672
    s_waitcnt lgkmcnt(3)
    v_smfmac_f32_16x16x64_bf16 v[32:35], v[12:15], a[16:23], v116
    ds_read_b128 v[92:95], v117 offset:29696
    s_waitcnt lgkmcnt(3)
    v_smfmac_f32_16x16x64_bf16 v[32:35], v[24:27], a[48:55], v116
    buffer_load_dwordx4 v117, s[8:11], s30 offen lds
    s_waitcnt lgkmcnt(2)
    v_smfmac_f32_16x16x64_bf16 v[32:35], v[28:31], a[80:87], v116
    ds_read_b128 v[96:99], v117 offset:23552
    v_smfmac_f32_16x16x64_bf16 v[36:39], v[12:15], a[24:31], v116
    ds_read_b128 v[100:103], v117 offset:23552
    v_smfmac_f32_16x16x64_bf16 v[36:39], v[24:27], a[56:63], v116
    buffer_load_dwordx4 v117, s[8:11], s30 offen offset:1024 lds
    s_add_u32 m0, s52, 0x6000
    v_add_f32 v32, v32, v34
    v_smfmac_f32_16x16x64_bf16 v[36:39], v[28:31], a[88:95], v116
    ds_read_b128 v[104:107], v117 offset:23552
    v_add_f32 v33, v33, v35
    v_smfmac_f32_16x16x64_bf16 v[40:43], v[12:15], a[112:119], v116
    ds_read_b128 v[108:111], v117 offset:23552
    v_mul_f32 v32, s34, v32
    v_smfmac_f32_16x16x64_bf16 v[40:43], v[24:27], a[144:151], v116
    s_waitcnt lgkmcnt(4)
    buffer_load_dwordx4 v117, s[8:11], s31 offen lds
    v_mul_f32 v33, s34, v33
    v_smfmac_f32_16x16x64_bf16 v[40:43], v[28:31], a[176:183], v116
    ds_read_b128 v[0:3], v124
    v_add_f32 v36, v36, v38
    v_smfmac_f32_16x16x64_bf16 v[48:51], v[4:7], a[208:215], v116
    v_add_f32 v37, v37, v39
    v_smfmac_f32_16x16x64_bf16 v[52:55], v[4:7], a[216:223], v116
    buffer_load_dwordx4 v117, s[8:11], s31 offen offset:1024 lds
    s_mov_b32 m0, 6144
    v_mul_f32 v36, s34, v36
    v_smfmac_f32_16x16x64_bf16 v[44:47], v[12:15], a[120:127], v116
    ds_read_b128 v[4:7], v124 offset:1024
    v_mul_f32 v37, s34, v37
    v_smfmac_f32_16x16x64_bf16 v[44:47], v[24:27], a[152:159], v116
    v_cvt_pk_bf16_f32 v34, v32, v36
    v_smfmac_f32_16x16x64_bf16 v[44:47], v[28:31], a[184:191], v116
    v_cvt_pk_bf16_f32 v35, v33, v37
    v_add_f32 v40, v40, v42
    v_smfmac_f32_16x16x64_bf16 v[48:51], v[8:11], a[224:231], v116
    ds_write2_b32 v120, v34, v35 offset0:32 offset1:48
    v_add_f32 v41, v41, v43
    v_smfmac_f32_16x16x64_bf16 v[52:55], v[8:11], a[232:239], v116
    v_add_f32 v44, v44, v46
    v_add_f32 v45, v45, v47
    v_cvt_pk_bf16_f32 v113, v40, v44
    v_cvt_pk_bf16_f32 v115, v41, v45
    v_smfmac_f32_16x16x64_bf16 v[48:51], v[12:15], a[240:247], v116
    ds_write2_b32 v120, v113, v115 offset0:0 offset1:16
    v_smfmac_f32_16x16x64_bf16 v[52:55], v[12:15], a[248:255], v116
    s_cmp_eq_u32 s22, 63
    s_cbranch_scc1 L_chain_last_s
    v_smfmac_f32_16x16x64_bf16 v[48:51], v[16:19], v[128:135], v116
    buffer_store_dword v126, v119, s[8:11], s55 offen sc1
    v_smfmac_f32_16x16x64_bf16 v[48:51], v[20:23], v[160:167], v116
    v_smfmac_f32_16x16x64_bf16 v[48:51], v[24:27], v[144:151], v116
    s_waitcnt lgkmcnt(0)
    s_barrier
    v_smfmac_f32_16x16x64_bf16 v[48:51], v[28:31], v[176:183], v116
    ds_read_b128 v[32:35], v121 offset:16384
    ds_read_b128 v[36:39], v121 offset:17408
    v_smfmac_f32_16x16x64_bf16 v[52:55], v[16:19], v[136:143], v116
    ds_read_b128 v[40:43], v121 offset:18432
    ds_read_b128 v[44:47], v121 offset:19456
    v_smfmac_f32_16x16x64_bf16 v[52:55], v[20:23], v[168:175], v116
    ds_read_b128 v[8:11], v124 offset:32768
    v_add_f32 v48, v48, v50
    v_smfmac_f32_16x16x64_bf16 v[52:55], v[24:27], v[152:159], v116
    ds_read_b128 v[12:15], v124 offset:33792
    v_add_f32 v49, v49, v51
    v_smfmac_f32_16x16x64_bf16 v[52:55], v[28:31], v[184:191], v116
    s_waitcnt lgkmcnt(5)
    v_cvt_pk_bf16_f32 v112, v48, v49
    v_mfma_f32_16x16x32_bf16 v[56:59], v[56:59], v[32:35], 0
    s_waitcnt lgkmcnt(4)
    v_mov_b32 v48, s50
    v_mov_b32 v49, s50
    v_mfma_f32_16x16x32_bf16 v[56:59], v[60:63], v[36:39], v[56:59]
    ds_read_b128 v[16:19], v124 offset:2048
    s_waitcnt lgkmcnt(4)
    v_mov_b32 v50, s50
    v_mov_b32 v51, s50
    v_mfma_f32_16x16x32_bf16 v[56:59], v[64:67], v[40:43], v[56:59]
    ds_read_b128 v[20:23], v124 offset:3072
    s_waitcnt lgkmcnt(4)
    v_add_f32 v52, v52, v54
    v_mfma_f32_16x16x32_bf16 v[56:59], v[68:71], v[44:47], v[56:59]
    ds_read_b128 v[24:27], v124 offset:4096
    v_add_f32 v53, v53, v55
    v_mfma_f32_16x16x32_bf16 v[60:63], v[72:75], v[32:35], 0
    ds_read_b128 v[28:31], v124 offset:5120
    v_cvt_pk_bf16_f32 v114, v52, v53
    v_mov_b32 v53, 0
    v_mfma_f32_16x16x32_bf16 v[60:63], v[76:79], v[36:39], v[60:63]
    v_exp_f32 v56, v56
    v_mfma_f32_16x16x32_bf16 v[60:63], v[80:83], v[40:43], v[60:63]
    v_exp_f32 v57, v57
    v_mfma_f32_16x16x32_bf16 v[60:63], v[84:87], v[44:47], v[60:63]
    v_exp_f32 v58, v58
    v_mfma_f32_16x16x32_bf16 v[64:67], v[32:35], v[32:35], 0
    v_exp_f32 v59, v59
    v_cvt_pk_bf16_f32 v68, v56, v57
    v_mfma_f32_16x16x32_bf16 v[64:67], v[36:39], v[36:39], v[64:67]
    v_exp_f32 v60, v60
    v_cvt_pk_bf16_f32 v69, v58, v59
    v_mfma_f32_16x16x32_bf16 v[64:67], v[40:43], v[40:43], v[64:67]
    v_exp_f32 v61, v61
    v_mfma_f32_16x16x32_bf16 v[64:67], v[44:47], v[44:47], v[64:67]
    v_exp_f32 v62, v62
    v_exp_f32 v63, v63
    v_cvt_pk_bf16_f32 v70, v60, v61
    v_cvt_pk_bf16_f32 v71, v62, v63
    s_nop 1
    v_mfma_f32_16x16x32_bf16 v[72:75], v[88:91], v[68:71], 0
    s_nop 0
    v_exp_f32 v64, v64
    v_mfma_f32_16x16x32_bf16 v[76:79], v[92:95], v[68:71], 0
    v_exp_f32 v65, v65
    v_mfma_f32_16x16x32_bf16 v[80:83], v[48:51], v[68:71], 0
    v_cvt_pk_bf16_f32 v52, v64, v65
    s_nop 1
    v_mfma_f32_16x16x16_bf16 v[72:75], v[112:113], v[52:53], v[72:75]
    ds_read_b128 v[32:35], v124 offset:6144
    v_mfma_f32_16x16x16_bf16 v[76:79], v[114:115], v[52:53], v[76:79]
    ds_read_b128 v[36:39], v124 offset:7168
    v_mfma_f32_16x16x16_bf16 v[80:83], v[48:49], v[52:53], v[80:83]
L_norm_75:
    s_mov_b64 vcc, s[36:37]
    v_mov_b32 v122, v122
    v_mov_b32 v122, v122
    v_mov_b32 v122, v122
    v_cndmask_b32_dpp v76, v72, v76, vcc quad_perm:[2,3,2,3] row_mask:0xf bank_mask:0xf
    v_cndmask_b32_dpp v77, v73, v77, vcc quad_perm:[2,3,2,3] row_mask:0xf bank_mask:0xf
    v_cndmask_b32_dpp v78, v74, v78, vcc quad_perm:[2,3,2,3] row_mask:0xf bank_mask:0xf
    v_cndmask_b32_dpp v79, v75, v79, vcc quad_perm:[2,3,2,3] row_mask:0xf bank_mask:0xf
    v_rcp_f32_dpp v84, v80 quad_perm:[2,3,2,3] row_mask:0xf bank_mask:0xf
    s_nop 0
    v_pk_mul_f32 v[76:77], v[76:77], v[84:85] op_sel_hi:[1,0]
    v_pk_mul_f32 v[78:79], v[78:79], v[84:85] op_sel_hi:[1,0]
    v_cvt_pk_bf16_f32 v72, v76, v77
    v_cvt_pk_bf16_f32 v73, v78, v79
    ds_write_b64 v122, v[72:73] offset:21504
    v_max_f32_dpp v86, v80, v84 quad_perm:[2,3,2,3] row_mask:0xf bank_mask:0xf
    v_mov_b32_dpp v60, v72 quad_perm:[0,1,0,1] row_mask:0xf bank_mask:0xf
    v_mov_b32_dpp v61, v73 quad_perm:[0,1,0,1] row_mask:0xf bank_mask:0xf
    v_cmp_lt_f32 vcc, s35, v86
    v_mov_b32_dpp v62, v72 quad_perm:[2,3,2,3] row_mask:0xf bank_mask:0xf
    v_mov_b32_dpp v63, v73 quad_perm:[2,3,2,3] row_mask:0xf bank_mask:0xf
    s_nop 1
    v_smfmac_f32_16x16x64_bf16 v[96:99], v[60:63], v[192:199], v116
    s_cbranch_vccnz L_smax_76
    v_smfmac_f32_16x16x64_bf16 v[100:103], v[60:63], v[224:231], v116
    s_waitcnt lgkmcnt(0)
    s_barrier
    ds_read_b128 v[92:95], v127 offset:22016
    ds_read_b128 v[80:83], v127 offset:20480
    ds_read_b128 v[84:87], v127 offset:20992
    v_smfmac_f32_16x16x64_bf16 v[104:107], v[60:63], v[0:7], v116
    ds_read_b128 v[40:43], v124 offset:34816
    v_smfmac_f32_16x16x64_bf16 v[108:111], v[60:63], v[8:15], v116
    ds_read_b128 v[56:59], v124 offset:36864
    s_waitcnt lgkmcnt(4)
    v_smfmac_f32_16x16x64_bf16 v[96:99], v[92:95], v[200:207], v116
    s_waitcnt lgkmcnt(3)
    v_smfmac_f32_16x16x64_bf16 v[96:99], v[80:83], v[208:215], v116
    ds_read_b128 v[44:47], v124 offset:35840
    s_waitcnt lgkmcnt(3)
    v_smfmac_f32_16x16x64_bf16 v[96:99], v[84:87], v[216:223], v116
    ds_read_b128 v[68:71], v124 offset:39936
    v_smfmac_f32_16x16x64_bf16 v[100:103], v[92:95], v[232:239], v116
    ds_read_b128 v[64:67], v124 offset:38912
    v_smfmac_f32_16x16x64_bf16 v[100:103], v[80:83], v[240:247], v116
    ds_read_b128 v[60:63], v124 offset:37888
    v_cvt_pk_bf16_f32 v72, v96, v98
    v_smfmac_f32_16x16x64_bf16 v[100:103], v[84:87], v[248:255], v116
    v_and_or_b32 v72, v72, -2, s33
    v_smfmac_f32_16x16x64_bf16 v[104:107], v[92:95], v[16:23], v116
    v_cvt_pk_bf16_f32 v74, v97, v99
    v_smfmac_f32_16x16x64_bf16 v[104:107], v[80:83], v[24:31], v116
    v_cvt_pk_bf16_f32 v73, v100, v102
    v_cvt_pk_bf16_f32 v75, v101, v103
    v_smfmac_f32_16x16x64_bf16 v[104:107], v[84:87], v[32:39], v116
    buffer_store_dwordx4 v[72:75], v118, s[8:11], s25 offen sc1
    s_waitcnt lgkmcnt(3)
    v_smfmac_f32_16x16x64_bf16 v[108:111], v[92:95], v[40:47], v116
    s_waitcnt lgkmcnt(0)
    v_smfmac_f32_16x16x64_bf16 v[108:111], v[80:83], v[56:63], v116
    v_cvt_pk_bf16_f32 v76, v104, v106
    v_smfmac_f32_16x16x64_bf16 v[108:111], v[84:87], v[64:71], v116
    v_and_or_b32 v76, v76, -2, s33
    v_cvt_pk_bf16_f32 v78, v105, v107
    v_mov_b32 v122, v122
    v_mov_b32 v122, v122
    v_mov_b32 v122, v122
    v_mov_b32 v122, v122
    v_mov_b32 v122, v122
    v_mov_b32 v122, v122
    v_cvt_pk_bf16_f32 v77, v108, v110
    v_cvt_pk_bf16_f32 v79, v109, v111
    buffer_store_dwordx4 v[76:79], v118, s[8:11], s26 offen sc1
    ds_read_b128 v[80:83], v123
    ds_read_b128 v[84:87], v123 offset:1024
    ds_read_b128 v[56:59], v123 offset:2048
    ds_read_b128 v[60:63], v123 offset:3072
    ds_read_b128 v[64:67], v123 offset:32768
    ds_read_b128 v[68:71], v123 offset:33792
    ds_read_b128 v[72:75], v123 offset:34816
    ds_read_b128 v[76:79], v123 offset:35840
    ds_read_b128 v[88:91], v123 offset:4096
    ds_read_b128 v[92:95], v123 offset:5120
    ds_read_b128 v[96:99], v123 offset:6144
    ds_read_b128 v[100:103], v123 offset:7168
    ds_read_b128 v[104:107], v123 offset:36864
    ds_read_b128 v[108:111], v123 offset:37888
    ds_read_b128 v[24:27], v123 offset:38912
    ds_read_b128 v[28:31], v123 offset:39936
    s_add_u32 s30, s30, 0x40000
    s_add_u32 s31, s31, 0x40000
    s_add_u32 s32, s32, 0x20000
    s_add_u32 s23, s24, 2048
    s_add_u32 s48, s23, 4096
    s_xor_b32 s25, s25, 0x40000
    s_xor_b32 s26, s26, 0x40000
    s_mov_b32 s35, 0x49800000
    s_add_u32 s22, s22, 1
    v_cndmask_b32 v12, 0, v125, s[68:69]
    v_cndmask_b32 v13, 0, v125, s[70:71]
    v_cndmask_b32 v14, 0, v125, s[72:73]
    v_cndmask_b32 v15, 0, v125, s[74:75]
    v_mov_b32 v54, 0
    v_mov_b32 v55, 0
    v_mov_b32 v52, 0
    v_mov_b32 v52, 0
    v_mov_b32 v52, 0
    v_mov_b32 v52, 0
    v_mov_b32 v52, 0
    v_mov_b32 v52, 0
    v_mov_b32 v52, 0
    v_mov_b32 v52, 0
    v_mov_b32 v52, 0
    v_mov_b32 v52, 0
    v_mov_b32 v52, 0
    v_mov_b32 v52, 0
    v_mov_b32 v52, 0
    v_mov_b32 v52, 0
    v_mov_b32 v52, 0
    v_mov_b32 v52, 0
    v_mov_b32 v52, 0
    v_mov_b32 v52, 0
    v_mov_b32 v52, 0
    buffer_load_dwordx4 v[4:7], v117, s[8:11], s29 offen sc1
    buffer_load_dwordx4 v[8:11], v117, s[8:11], s53 offen sc1
    buffer_load_dwordx4 v[16:19], v117, s[8:11], s29 offen offset:2048 sc1
    buffer_load_dwordx4 v[20:23], v117, s[8:11], s53 offen offset:2048 sc1
    v_mov_b32 v52, 0
    v_mov_b32 v52, 0
    v_mov_b32 v52, 0
    v_mov_b32 v52, 0
    v_mov_b32 v52, 0
    v_mov_b32 v52, 0
    v_mov_b32 v52, 0
    v_mov_b32 v52, 0
    v_mov_b32 v52, 0
    v_mov_b32 v52, 0
    v_mov_b32 v52, 0
    v_mov_b32 v52, 0
    v_mov_b32 v52, 0
    v_mov_b32 v52, 0
    v_mov_b32 v52, 0
    v_mov_b32 v52, 0
    v_mov_b32 v52, 0
    v_mov_b32 v52, 0
    v_mov_b32 v52, 0
    v_mov_b32 v52, 0
    v_mov_b32 v52, 0
    v_mov_b32 v52, 0
    v_mov_b32 v52, 0
    v_mov_b32 v52, 0
    v_mov_b32 v52, 0
    v_mov_b32 v52, 0
    v_mov_b32 v52, 0
    v_mov_b32 v52, 0
    v_mov_b32 v52, 0
    v_mov_b32 v52, 0
    v_mov_b32 v52, 0
    v_mov_b32 v52, 0
    v_mov_b32 v52, 0
    v_mov_b32 v52, 0
    v_mov_b32 v52, 0
    v_mov_b32 v52, 0
    v_mov_b32 v52, 0
    v_mov_b32 v52, 0
    v_mov_b32 v52, 0
    v_mov_b32 v52, 0
    buffer_load_dwordx4 v[32:35], v117, s[8:11], s29 offen sc1
    buffer_load_dwordx4 v[36:39], v117, s[8:11], s53 offen sc1
    buffer_load_dwordx4 v[40:43], v117, s[8:11], s29 offen offset:2048 sc1
    buffer_load_dwordx4 v[44:47], v117, s[8:11], s53 offen offset:2048 sc1
    v_mov_b32 v52, 0
L_rl_77:
    s_waitcnt vmcnt(7)
    v_mfma_f32_16x16x32_bf16 v[48:51], v[4:7], v[12:15], 0
    v_xor_b32 v52, s33, v4
    s_waitcnt vmcnt(6)
    v_mfma_f32_16x16x32_bf16 v[48:51], v[8:11], v[12:15], v[48:51]
    v_xor_b32 v53, s33, v8
    v_or_b32 v52, v52, v53
    s_waitcnt vmcnt(5)
    v_mfma_f32_16x16x32_bf16 v[48:51], v[16:19], v[12:15], v[48:51]
    v_xor_b32 v53, s33, v16
    v_or_b32 v52, v52, v53
    s_waitcnt vmcnt(4)
    v_mfma_f32_16x16x32_bf16 v[48:51], v[20:23], v[12:15], v[48:51]
    v_xor_b32 v53, s33, v20
    v_or_b32 v52, v52, v53
    v_and_b32 v52, 1, v52
    v_cmp_ne_u32 vcc, 0, v52
    s_cbranch_vccnz L_rslow_78
L_rgo_79:
    s_nop 2
    v_permlane32_swap_b32 v48, v50
    v_permlane32_swap_b32 v49, v51
    v_pk_add_f32 v[48:49], v[48:49], v[50:51]
    s_mov_b64 exec, s[38:39]
    v_cvt_pk_bf16_f32 v12, v48, v49
    v_min_u32 v12, 0xfffffffe, v12
    buffer_store_dword v12, v119, s[8:11], s24 offen sc1
    s_mov_b64 exec, -1
    s_add_u32 s24, s24, 8192
    s_bitset0_b32 s24, 15
    s_xor_b32 s55, s24, 16384
    s_xor_b32 s29, s29, 0x40000
    s_xor_b32 s53, s29, 1024
    s_bfe_u32 s33, s22, 0x10001
    s_waitcnt lgkmcnt(0)
    s_branch L_chain_top2_s
.p2align 6
L_chain_top3_s:
    buffer_load_dwordx4 v[0:3], v117, s[8:11], s23 offen sc1
    v_mov_b32 v48, 0
    v_mov_b32 v49, 0
    v_mov_b32 v50, 0
    v_mov_b32 v51, 0
    v_mov_b32 v52, 0
    v_mov_b32 v53, 0
    v_mov_b32 v15, 0
    v_mov_b32 v15, 0
    v_mov_b32 v15, 0
    v_mov_b32 v15, 0
    v_mov_b32 v15, 0
    v_mov_b32 v15, 0
    v_mov_b32 v15, 0
    v_mov_b32 v15, 0
    v_mov_b32 v15, 0
    v_mov_b32 v15, 0
    buffer_load_dwordx4 v[0:3], v117, s[8:11], s23 offen sc1
    s_waitcnt vmcnt(3)
    v_mov_b32 v36, 0
    v_mov_b32 v37, 0
    v_mov_b32 v38, 0
    v_mov_b32 v39, 0
    v_mov_b32 v40, 0
    v_mov_b32 v41, 0
    v_mov_b32 v42, 0
    v_mov_b32 v43, 0
    v_mov_b32 v44, 0
    v_mov_b32 v45, 0
    v_mov_b32 v46, 0
    v_mov_b32 v47, 0
    v_mov_b32 v15, 0
    v_mov_b32 v15, 0
    v_mov_b32 v15, 0
    v_mov_b32 v15, 0
L_mret_80:
    buffer_load_dwordx4 v[0:3], v117, s[8:11], s23 offen sc1
    s_add_u32 s45, s45, 1
    s_cmp_lt_u32 s45, 0x10000
    s_cselect_b32 s56, -2, -1
    s_nop 3
    v_mov_b32 v32, 0
    v_mov_b32 v33, 0
    v_mov_b32 v34, 0
    v_mov_b32 v35, 0
    s_waitcnt vmcnt(2)
    v_max3_u32 v15, v0, v1, v2
    v_max_u32 v15, v15, v3
    v_cmp_lt_u32 vcc, s56, v15
    v_smfmac_f32_16x16x64_bf16 v[32:35], v[0:3], v[80:87], v116
    s_cbranch_vccnz L_mret_80
    ds_write_b128 v117, v[0:3] offset:3072
    v_smfmac_f32_16x16x64_bf16 v[36:39], v[0:3], v[56:63], v116
    buffer_load_dwordx4 v[4:7], v117, s[8:11], s48 offen sc1
    v_smfmac_f32_16x16x64_bf16 v[40:43], v[0:3], v[64:71], v116
    buffer_load_dwordx4 v117, s[8:11], s48 offen sc1 lds
    s_mov_b32 m0, 14336
    v_smfmac_f32_16x16x64_bf16 v[44:47], v[0:3], v[72:79], v116
    s_waitcnt lgkmcnt(0)
    s_barrier
    ds_read_b128 v[8:11], v117 offset:2048
    v_smfmac_f32_16x16x64_bf16 v[48:51], v[0:3], a[192:199], v116
    ds_read_b128 v[16:19], v117 offset:1024
    ds_read_b128 v[20:23], v117
    v_smfmac_f32_16x16x64_bf16 v[52:55], v[0:3], a[200:207], v116
    ds_read_b128 v[80:83], v117 offset:14336
    s_waitcnt lgkmcnt(3)
    v_smfmac_f32_16x16x64_bf16 v[32:35], v[8:11], a[0:7], v116
    ds_read_b128 v[84:87], v117 offset:15360
    v_smfmac_f32_16x16x64_bf16 v[36:39], v[8:11], a[8:15], v116
    ds_read_b128 v[56:59], v117 offset:8192
    s_waitcnt lgkmcnt(4)
    v_smfmac_f32_16x16x64_bf16 v[32:35], v[16:19], a[32:39], v116
    ds_read_b128 v[60:63], v117 offset:9216
    v_smfmac_f32_16x16x64_bf16 v[36:39], v[16:19], a[40:47], v116
    ds_read_b128 v[64:67], v117 offset:10240
    s_waitcnt lgkmcnt(5)
    v_smfmac_f32_16x16x64_bf16 v[32:35], v[20:23], a[64:71], v116
    ds_read_b128 v[68:71], v117 offset:11264
    v_smfmac_f32_16x16x64_bf16 v[36:39], v[20:23], a[72:79], v116
    ds_read_b128 v[72:75], v117 offset:12288
    v_smfmac_f32_16x16x64_bf16 v[40:43], v[8:11], a[96:103], v116
    ds_read_b128 v[76:79], v117 offset:13312
    v_smfmac_f32_16x16x64_bf16 v[40:43], v[16:19], a[128:135], v116
    buffer_store_dwordx4 v[112:115], v117, s[8:11], s32 offen sc1
    v_smfmac_f32_16x16x64_bf16 v[40:43], v[20:23], a[160:167], v116
    s_waitcnt vmcnt(2)
    v_max3_u32 v15, v4, v5, v6
    v_smfmac_f32_16x16x64_bf16 v[44:47], v[8:11], a[104:111], v116
    v_max_u32 v15, v15, v7
    v_smfmac_f32_16x16x64_bf16 v[44:47], v[16:19], a[136:143], v116
    s_waitcnt vmcnt(1) lgkmcnt(0)
    v_cmp_lt_u32 vcc, s56, v15
    v_smfmac_f32_16x16x64_bf16 v[44:47], v[20:23], a[168:175], v116
    s_cbranch_vccnz L_mret_81
L_mgo_82:
    v_smfmac_f32_16x16x64_bf16 v[44:47], v[4:7], v[24:31], v116
    s_barrier
    ds_read_b128 v[12:15], v117 offset:6144
    v_smfmac_f32_16x16x64_bf16 v[32:35], v[4:7], v[88:95], v116
    ds_read_b128 v[24:27], v117 offset:5120
    v_smfmac_f32_16x16x64_bf16 v[36:39], v[4:7], v[96:103], v116
    ds_read_b128 v[28:31], v117 offset:4096
    v_smfmac_f32_16x16x64_bf16 v[40:43], v[4:7], v[104:111], v116
    ds_read_b128 v[88:91], v117 offset:30720
    s_waitcnt lgkmcnt(3)
    v_smfmac_f32_16x16x64_bf16 v[32:35], v[12:15], a[16:23], v116
    ds_read_b128 v[92:95], v117 offset:31744
    s_waitcnt lgkmcnt(3)
    v_smfmac_f32_16x16x64_bf16 v[32:35], v[24:27], a[48:55], v116
    ds_read_b128 v[96:99], v117 offset:23552
    s_waitcnt lgkmcnt(3)
    v_smfmac_f32_16x16x64_bf16 v[32:35], v[28:31], a[80:87], v116
    buffer_load_dwordx4 v117, s[8:11], s30 offen lds
    v_smfmac_f32_16x16x64_bf16 v[36:39], v[12:15], a[24:31], v116
    ds_read_b128 v[100:103], v117 offset:23552
    v_smfmac_f32_16x16x64_bf16 v[36:39], v[24:27], a[56:63], v116
    ds_read_b128 v[104:107], v117 offset:23552
    v_add_f32 v32, v32, v34
    v_smfmac_f32_16x16x64_bf16 v[36:39], v[28:31], a[88:95], v116
    buffer_load_dwordx4 v117, s[8:11], s30 offen offset:1024 lds
    s_add_u32 m0, s52, 0x6000
    v_add_f32 v33, v33, v35
    v_smfmac_f32_16x16x64_bf16 v[40:43], v[12:15], a[112:119], v116
    ds_read_b128 v[108:111], v117 offset:23552
    v_mul_f32 v32, s34, v32
    v_smfmac_f32_16x16x64_bf16 v[40:43], v[24:27], a[144:151], v116
    ds_read_b128 v[0:3], v124
    v_mul_f32 v33, s34, v33
    v_smfmac_f32_16x16x64_bf16 v[40:43], v[28:31], a[176:183], v116
    s_waitcnt lgkmcnt(5)
    buffer_load_dwordx4 v117, s[8:11], s31 offen lds
    v_add_f32 v36, v36, v38
    v_smfmac_f32_16x16x64_bf16 v[48:51], v[4:7], a[208:215], v116
    v_add_f32 v37, v37, v39
    v_smfmac_f32_16x16x64_bf16 v[52:55], v[4:7], a[216:223], v116
    ds_read_b128 v[4:7], v124 offset:1024
    v_mul_f32 v36, s34, v36
    v_smfmac_f32_16x16x64_bf16 v[44:47], v[12:15], a[120:127], v116
    buffer_load_dwordx4 v117, s[8:11], s31 offen offset:1024 lds
    s_mov_b32 m0, 7168
    v_mul_f32 v37, s34, v37
    v_smfmac_f32_16x16x64_bf16 v[44:47], v[24:27], a[152:159], v116
    v_cvt_pk_bf16_f32 v34, v32, v36
    v_smfmac_f32_16x16x64_bf16 v[44:47], v[28:31], a[184:191], v116
    v_cvt_pk_bf16_f32 v35, v33, v37
    v_add_f32 v40, v40, v42
    v_smfmac_f32_16x16x64_bf16 v[48:51], v[8:11], a[224:231], v116
    ds_write2_b32 v120, v34, v35 offset0:32 offset1:48
    v_add_f32 v41, v41, v43
    v_smfmac_f32_16x16x64_bf16 v[52:55], v[8:11], a[232:239], v116
    v_add_f32 v44, v44, v46
    v_add_f32 v45, v45, v47
    v_cvt_pk_bf16_f32 v113, v40, v44
    v_cvt_pk_bf16_f32 v115, v41, v45
    v_smfmac_f32_16x16x64_bf16 v[48:51], v[12:15], a[240:247], v116
    ds_write2_b32 v120, v113, v115 offset0:0 offset1:16
    v_smfmac_f32_16x16x64_bf16 v[52:55], v[12:15], a[248:255], v116
    s_cmp_eq_u32 s22, 63
    s_cbranch_scc1 L_chain_last_s
    v_smfmac_f32_16x16x64_bf16 v[48:51], v[16:19], v[128:135], v116
    v_smfmac_f32_16x16x64_bf16 v[48:51], v[20:23], v[160:167], v116
    buffer_store_dword v126, v119, s[8:11], s55 offen sc1
    v_smfmac_f32_16x16x64_bf16 v[48:51], v[24:27], v[144:151], v116
    s_waitcnt lgkmcnt(0)
    s_barrier
    v_smfmac_f32_16x16x64_bf16 v[48:51], v[28:31], v[176:183], v116
    ds_read_b128 v[32:35], v121 offset:16384
    ds_read_b128 v[36:39], v121 offset:17408
    v_smfmac_f32_16x16x64_bf16 v[52:55], v[16:19], v[136:143], v116
    ds_read_b128 v[40:43], v121 offset:18432
    ds_read_b128 v[44:47], v121 offset:19456
    v_smfmac_f32_16x16x64_bf16 v[52:55], v[20:23], v[168:175], v116
    ds_read_b128 v[8:11], v124 offset:32768
    v_add_f32 v48, v48, v50
    v_smfmac_f32_16x16x64_bf16 v[52:55], v[24:27], v[152:159], v116
    ds_read_b128 v[12:15], v124 offset:33792
    v_add_f32 v49, v49, v51
    v_smfmac_f32_16x16x64_bf16 v[52:55], v[28:31], v[184:191], v116
    s_waitcnt lgkmcnt(5)
    v_cvt_pk_bf16_f32 v112, v48, v49
    v_mfma_f32_16x16x32_bf16 v[56:59], v[56:59], v[32:35], 0
    s_waitcnt lgkmcnt(4)
    v_mov_b32 v48, s50
    v_mov_b32 v49, s50
    v_mfma_f32_16x16x32_bf16 v[56:59], v[60:63], v[36:39], v[56:59]
    ds_read_b128 v[16:19], v124 offset:2048
    s_waitcnt lgkmcnt(4)
    v_mov_b32 v50, s50
    v_mov_b32 v51, s50
    v_mfma_f32_16x16x32_bf16 v[56:59], v[64:67], v[40:43], v[56:59]
    ds_read_b128 v[20:23], v124 offset:3072
    s_waitcnt lgkmcnt(4)
    v_add_f32 v52, v52, v54
    v_mfma_f32_16x16x32_bf16 v[56:59], v[68:71], v[44:47], v[56:59]
    ds_read_b128 v[24:27], v124 offset:4096
    v_add_f32 v53, v53, v55
    v_mfma_f32_16x16x32_bf16 v[60:63], v[72:75], v[32:35], 0
    ds_read_b128 v[28:31], v124 offset:5120
    v_cvt_pk_bf16_f32 v114, v52, v53
    v_mov_b32 v53, 0
    v_mfma_f32_16x16x32_bf16 v[60:63], v[76:79], v[36:39], v[60:63]
    v_exp_f32 v56, v56
    v_mfma_f32_16x16x32_bf16 v[60:63], v[80:83], v[40:43], v[60:63]
    v_exp_f32 v57, v57
    v_mfma_f32_16x16x32_bf16 v[60:63], v[84:87], v[44:47], v[60:63]
    v_exp_f32 v58, v58
    v_mfma_f32_16x16x32_bf16 v[64:67], v[32:35], v[32:35], 0
    v_exp_f32 v59, v59
    v_cvt_pk_bf16_f32 v68, v56, v57
    v_mfma_f32_16x16x32_bf16 v[64:67], v[36:39], v[36:39], v[64:67]
    v_exp_f32 v60, v60
    v_cvt_pk_bf16_f32 v69, v58, v59
    v_mfma_f32_16x16x32_bf16 v[64:67], v[40:43], v[40:43], v[64:67]
    v_exp_f32 v61, v61
    v_mfma_f32_16x16x32_bf16 v[64:67], v[44:47], v[44:47], v[64:67]
    v_exp_f32 v62, v62
    v_exp_f32 v63, v63
    v_cvt_pk_bf16_f32 v70, v60, v61
    v_cvt_pk_bf16_f32 v71, v62, v63
    s_nop 1
    v_mfma_f32_16x16x32_bf16 v[72:75], v[88:91], v[68:71], 0
    s_nop 0
    v_exp_f32 v64, v64
    v_mfma_f32_16x16x32_bf16 v[76:79], v[92:95], v[68:71], 0
    v_exp_f32 v65, v65
    v_mfma_f32_16x16x32_bf16 v[80:83], v[48:51], v[68:71], 0
    v_cvt_pk_bf16_f32 v52, v64, v65
    s_nop 1
    v_mfma_f32_16x16x16_bf16 v[72:75], v[112:113], v[52:53], v[72:75]
    ds_read_b128 v[32:35], v124 offset:6144
    v_mfma_f32_16x16x16_bf16 v[76:79], v[114:115], v[52:53], v[76:79]
    ds_read_b128 v[36:39], v124 offset:7168
    v_mfma_f32_16x16x16_bf16 v[80:83], v[48:49], v[52:53], v[80:83]
L_norm_83:
    s_mov_b64 vcc, s[36:37]
    v_mov_b32 v122, v122
    v_mov_b32 v122, v122
    v_mov_b32 v122, v122
    v_cndmask_b32_dpp v76, v72, v76, vcc quad_perm:[2,3,2,3] row_mask:0xf bank_mask:0xf
    v_cndmask_b32_dpp v77, v73, v77, vcc quad_perm:[2,3,2,3] row_mask:0xf bank_mask:0xf
    v_cndmask_b32_dpp v78, v74, v78, vcc quad_perm:[2,3,2,3] row_mask:0xf bank_mask:0xf
    v_cndmask_b32_dpp v79, v75, v79, vcc quad_perm:[2,3,2,3] row_mask:0xf bank_mask:0xf
    v_rcp_f32_dpp v84, v80 quad_perm:[2,3,2,3] row_mask:0xf bank_mask:0xf
    s_nop 0
    v_pk_mul_f32 v[76:77], v[76:77], v[84:85] op_sel_hi:[1,0]
    v_pk_mul_f32 v[78:79], v[78:79], v[84:85] op_sel_hi:[1,0]
    v_cvt_pk_bf16_f32 v72, v76, v77
    v_cvt_pk_bf16_f32 v73, v78, v79
    ds_write_b64 v122, v[72:73] offset:22016
    v_max_f32_dpp v86, v80, v84 quad_perm:[2,3,2,3] row_mask:0xf bank_mask:0xf
    v_mov_b32_dpp v60, v72 quad_perm:[0,1,0,1] row_mask:0xf bank_mask:0xf
    v_mov_b32_dpp v61, v73 quad_perm:[0,1,0,1] row_mask:0xf bank_mask:0xf
    v_cmp_lt_f32 vcc, s35, v86
    v_mov_b32_dpp v62, v72 quad_perm:[2,3,2,3] row_mask:0xf bank_mask:0xf
    v_mov_b32_dpp v63, v73 quad_perm:[2,3,2,3] row_mask:0xf bank_mask:0xf
    s_nop 1
    v_smfmac_f32_16x16x64_bf16 v[96:99], v[60:63], v[192:199], v116
    s_cbranch_vccnz L_smax_84
    v_smfmac_f32_16x16x64_bf16 v[100:103], v[60:63], v[224:231], v116
    s_waitcnt lgkmcnt(0)
    s_barrier
    ds_read_b128 v[92:95], v127 offset:21504
    ds_read_b128 v[80:83], v127 offset:20992
    ds_read_b128 v[84:87], v127 offset:20480
    v_smfmac_f32_16x16x64_bf16 v[104:107], v[60:63], v[0:7], v116
    ds_read_b128 v[40:43], v124 offset:34816
    v_smfmac_f32_16x16x64_bf16 v[108:111], v[60:63], v[8:15], v116
    ds_read_b128 v[56:59], v124 offset:36864
    s_waitcnt lgkmcnt(4)
    v_smfmac_f32_16x16x64_bf16 v[96:99], v[92:95], v[200:207], v116
    s_waitcnt lgkmcnt(3)
    v_smfmac_f32_16x16x64_bf16 v[96:99], v[80:83], v[208:215], v116
    ds_read_b128 v[44:47], v124 offset:35840
    s_waitcnt lgkmcnt(3)
    v_smfmac_f32_16x16x64_bf16 v[96:99], v[84:87], v[216:223], v116
    ds_read_b128 v[68:71], v124 offset:39936
    v_smfmac_f32_16x16x64_bf16 v[100:103], v[92:95], v[232:239], v116
    ds_read_b128 v[64:67], v124 offset:38912
    v_smfmac_f32_16x16x64_bf16 v[100:103], v[80:83], v[240:247], v116
    ds_read_b128 v[60:63], v124 offset:37888
    v_cvt_pk_bf16_f32 v72, v96, v98
    v_smfmac_f32_16x16x64_bf16 v[100:103], v[84:87], v[248:255], v116
    v_and_or_b32 v72, v72, -2, s33
    v_smfmac_f32_16x16x64_bf16 v[104:107], v[92:95], v[16:23], v116
    v_cvt_pk_bf16_f32 v74, v97, v99
    v_smfmac_f32_16x16x64_bf16 v[104:107], v[80:83], v[24:31], v116
    v_cvt_pk_bf16_f32 v73, v100, v102
    v_cvt_pk_bf16_f32 v75, v101, v103
    v_smfmac_f32_16x16x64_bf16 v[104:107], v[84:87], v[32:39], v116
    buffer_store_dwordx4 v[72:75], v118, s[8:11], s25 offen sc1
    s_waitcnt lgkmcnt(3)
    v_smfmac_f32_16x16x64_bf16 v[108:111], v[92:95], v[40:47], v116
    s_waitcnt lgkmcnt(0)
    v_smfmac_f32_16x16x64_bf16 v[108:111], v[80:83], v[56:63], v116
    v_cvt_pk_bf16_f32 v76, v104, v106
    v_smfmac_f32_16x16x64_bf16 v[108:111], v[84:87], v[64:71], v116
    v_and_or_b32 v76, v76, -2, s33
    v_cvt_pk_bf16_f32 v78, v105, v107
    v_mov_b32 v122, v122
    v_mov_b32 v122, v122
    v_mov_b32 v122, v122
    v_mov_b32 v122, v122
    v_mov_b32 v122, v122
    v_mov_b32 v122, v122
    v_cvt_pk_bf16_f32 v77, v108, v110
    v_cvt_pk_bf16_f32 v79, v109, v111
    buffer_store_dwordx4 v[76:79], v118, s[8:11], s26 offen sc1
    ds_read_b128 v[80:83], v123
    ds_read_b128 v[84:87], v123 offset:1024
    ds_read_b128 v[56:59], v123 offset:2048
    ds_read_b128 v[60:63], v123 offset:3072
    ds_read_b128 v[64:67], v123 offset:32768
    ds_read_b128 v[68:71], v123 offset:33792
    ds_read_b128 v[72:75], v123 offset:34816
    ds_read_b128 v[76:79], v123 offset:35840
    ds_read_b128 v[88:91], v123 offset:4096
    ds_read_b128 v[92:95], v123 offset:5120
    ds_read_b128 v[96:99], v123 offset:6144
    ds_read_b128 v[100:103], v123 offset:7168
    ds_read_b128 v[104:107], v123 offset:36864
    ds_read_b128 v[108:111], v123 offset:37888
    ds_read_b128 v[24:27], v123 offset:38912
    ds_read_b128 v[28:31], v123 offset:39936
    s_add_u32 s30, s30, 0x40000
    s_add_u32 s31, s31, 0x40000
    s_add_u32 s32, s32, 0x20000
    s_add_u32 s23, s24, 3072
    s_add_u32 s48, s23, 4096
    s_xor_b32 s25, s25, 0x40000
    s_xor_b32 s26, s26, 0x40000
    s_mov_b32 s35, 0x49800000
    s_add_u32 s22, s22, 1
    v_cndmask_b32 v12, 0, v125, s[68:69]
    v_cndmask_b32 v13, 0, v125, s[70:71]
    v_cndmask_b32 v14, 0, v125, s[72:73]
    v_cndmask_b32 v15, 0, v125, s[74:75]
    v_mov_b32 v54, 0
    v_mov_b32 v55, 0
    v_mov_b32 v52, 0
    v_mov_b32 v52, 0
    v_mov_b32 v52, 0
    v_mov_b32 v52, 0
    v_mov_b32 v52, 0
    v_mov_b32 v52, 0
    v_mov_b32 v52, 0
    v_mov_b32 v52, 0
    v_mov_b32 v52, 0
    v_mov_b32 v52, 0
    v_mov_b32 v52, 0
    v_mov_b32 v52, 0
    v_mov_b32 v52, 0
    v_mov_b32 v52, 0
    v_mov_b32 v52, 0
    v_mov_b32 v52, 0
    v_mov_b32 v52, 0
    v_mov_b32 v52, 0
    v_mov_b32 v52, 0
    v_mov_b32 v52, 0
    v_mov_b32 v52, 0
    v_mov_b32 v52, 0
    v_mov_b32 v52, 0
    v_mov_b32 v52, 0
    v_mov_b32 v52, 0
    v_mov_b32 v52, 0
    v_mov_b32 v52, 0
    v_mov_b32 v52, 0
    v_mov_b32 v52, 0
    v_mov_b32 v52, 0
    v_mov_b32 v52, 0
    v_mov_b32 v52, 0
    v_mov_b32 v52, 0
    v_mov_b32 v52, 0
    v_mov_b32 v52, 0
    v_mov_b32 v52, 0
    v_mov_b32 v52, 0
    v_mov_b32 v52, 0
    v_mov_b32 v52, 0
    v_mov_b32 v52, 0
    v_mov_b32 v52, 0
    v_mov_b32 v52, 0
    v_mov_b32 v52, 0
    v_mov_b32 v52, 0
    v_mov_b32 v52, 0
    v_mov_b32 v52, 0
    v_mov_b32 v52, 0
    v_mov_b32 v52, 0
    v_mov_b32 v52, 0
    buffer_load_dwordx4 v[4:7], v117, s[8:11], s29 offen sc1
    buffer_load_dwordx4 v[8:11], v117, s[8:11], s53 offen sc1
    buffer_load_dwordx4 v[16:19], v117, s[8:11], s29 offen offset:2048 sc1
    buffer_load_dwordx4 v[20:23], v117, s[8:11], s53 offen offset:2048 sc1
    v_mov_b32 v52, 0
    v_mov_b32 v52, 0
    v_mov_b32 v52, 0
    v_mov_b32 v52, 0
    v_mov_b32 v52, 0
    v_mov_b32 v52, 0
    v_mov_b32 v52, 0
    v_mov_b32 v52, 0
    v_mov_b32 v52, 0
    v_mov_b32 v52, 0
    v_mov_b32 v52, 0
    v_mov_b32 v52, 0
    v_mov_b32 v52, 0
    v_mov_b32 v52, 0
    v_mov_b32 v52, 0
    v_mov_b32 v52, 0
    v_mov_b32 v52, 0
    v_mov_b32 v52, 0
    v_mov_b32 v52, 0
    v_mov_b32 v52, 0
    v_mov_b32 v52, 0
    v_mov_b32 v52, 0
    v_mov_b32 v52, 0
    v_mov_b32 v52, 0
    v_mov_b32 v52, 0
    v_mov_b32 v52, 0
    v_mov_b32 v52, 0
    v_mov_b32 v52, 0
    v_mov_b32 v52, 0
    v_mov_b32 v52, 0
    buffer_load_dwordx4 v[32:35], v117, s[8:11], s29 offen sc1
    buffer_load_dwordx4 v[36:39], v117, s[8:11], s53 offen sc1
    buffer_load_dwordx4 v[40:43], v117, s[8:11], s29 offen offset:2048 sc1
    buffer_load_dwordx4 v[44:47], v117, s[8:11], s53 offen offset:2048 sc1
    v_mov_b32 v52, 0
L_rl_85:
    s_waitcnt vmcnt(7)
    v_mfma_f32_16x16x32_bf16 v[48:51], v[4:7], v[12:15], 0
    v_xor_b32 v52, s33, v4
    s_waitcnt vmcnt(6)
    v_mfma_f32_16x16x32_bf16 v[48:51], v[8:11], v[12:15], v[48:51]
    v_xor_b32 v53, s33, v8
    v_or_b32 v52, v52, v53
    s_waitcnt vmcnt(5)
    v_mfma_f32_16x16x32_bf16 v[48:51], v[16:19], v[12:15], v[48:51]
    v_xor_b32 v53, s33, v16
    v_or_b32 v52, v52, v53
    s_waitcnt vmcnt(4)
    v_mfma_f32_16x16x32_bf16 v[48:51], v[20:23], v[12:15], v[48:51]
    v_xor_b32 v53, s33, v20
    v_or_b32 v52, v52, v53
    v_and_b32 v52, 1, v52
    v_cmp_ne_u32 vcc, 0, v52
    s_cbranch_vccnz L_rslow_86
L_rgo_87:
    s_nop 2
    v_permlane32_swap_b32 v48, v50
    v_permlane32_swap_b32 v49, v51
    v_pk_add_f32 v[48:49], v[48:49], v[50:51]
    s_mov_b64 exec, s[38:39]
    v_cvt_pk_bf16_f32 v12, v48, v49
    v_min_u32 v12, 0xfffffffe, v12
    buffer_store_dword v12, v119, s[8:11], s24 offen sc1
    s_mov_b64 exec, -1
    s_add_u32 s24, s24, 8192
    s_bitset0_b32 s24, 15
    s_xor_b32 s55, s24, 16384
    s_xor_b32 s29, s29, 0x40000
    s_xor_b32 s53, s29, 1024
    s_bfe_u32 s33, s22, 0x10001
    s_waitcnt lgkmcnt(0)
    s_branch L_chain_top3_s
L_chain_last_s:
    s_nop 1
    v_smfmac_f32_16x16x64_bf16 v[48:51], v[16:19], v[128:135], v116
    v_smfmac_f32_16x16x64_bf16 v[48:51], v[20:23], v[160:167], v116
    v_smfmac_f32_16x16x64_bf16 v[48:51], v[24:27], v[144:151], v116
    v_smfmac_f32_16x16x64_bf16 v[48:51], v[28:31], v[176:183], v116
    v_smfmac_f32_16x16x64_bf16 v[52:55], v[16:19], v[136:143], v116
    v_smfmac_f32_16x16x64_bf16 v[52:55], v[20:23], v[168:175], v116
    v_smfmac_f32_16x16x64_bf16 v[52:55], v[24:27], v[152:159], v116
    v_smfmac_f32_16x16x64_bf16 v[52:55], v[28:31], v[184:191], v116
    v_add_f32 v48, v48, v50
    v_add_f32 v49, v49, v51
    v_cvt_pk_bf16_f32 v112, v48, v49
    s_nop 4
    v_add_f32 v52, v52, v54
    v_add_f32 v53, v53, v55
    v_cvt_pk_bf16_f32 v114, v52, v53
    s_add_u32 s32, s32, 0x20000
    buffer_store_dwordx4 v[112:115], v117, s[8:11], s32 offen sc1
    v_mov_b32 v94, 64
    s_waitcnt vmcnt(0) lgkmcnt(0)
    s_barrier
    s_mov_b64 exec, 1
    buffer_store_dword v94, off, s[8:11], s44 sc1
    s_mov_b64 exec, -1
    s_endpgm
L_mret_59:
    s_mov_b32 s43, m0
    s_mov_b32 m0, 4096
    buffer_load_dwordx4 v[4:7], v117, s[8:11], s48 offen sc1
    buffer_load_dwordx4 v117, s[8:11], s48 offen sc1 lds
    s_mov_b32 m0, 8192
    s_mov_b32 m0, s43
    s_waitcnt vmcnt(0)
    v_max3_u32 v15, v4, v5, v6
    v_max_u32 v15, v15, v7
    v_cmp_lt_u32 vcc, s56, v15
    s_add_u32 s47, s47, 1
    s_add_u32 s49, s49, 1
    s_cmp_ge_u32 s49, 0x10000
    s_cbranch_scc1 L_mgo_60
    s_cbranch_vccnz L_mret_59
    s_branch L_mgo_60
L_smax_62:
    s_add_u32 s47, s47, 1
    s_mov_b32 s35, 0x7f800000
    s_waitcnt lgkmcnt(0)
    s_sub_u32 s43, s30, 0x40000
    s_add_u32 s40, s43, 4096
    s_nop 7
    buffer_load_dwordx4 v[56:59], v117, s[8:11], s43 offen
    buffer_load_dwordx4 v[60:63], v117, s[8:11], s43 offen offset:1024
    buffer_load_dwordx4 v[64:67], v117, s[8:11], s43 offen offset:2048
    buffer_load_dwordx4 v[68:71], v117, s[8:11], s43 offen offset:3072
    buffer_load_dwordx4 v[72:75], v117, s[8:11], s40 offen
    buffer_load_dwordx4 v[76:79], v117, s[8:11], s40 offen offset:1024
    buffer_load_dwordx4 v[80:83], v117, s[8:11], s40 offen offset:2048
    buffer_load_dwordx4 v[84:87], v117, s[8:11], s40 offen offset:3072
    ds_read_b128 v[32:35], v121 offset:16384
    ds_read_b128 v[36:39], v121 offset:17408
    ds_read_b128 v[40:43], v121 offset:18432
    ds_read_b128 v[44:47], v121 offset:19456
    v_mov_b32 v96, 0
    v_mov_b32 v97, 0
    v_mov_b32 v98, 0
    v_mov_b32 v99, 0
    v_mov_b32 v100, 0
    v_mov_b32 v101, 0
    v_mov_b32 v102, 0
    v_mov_b32 v103, 0
    v_mov_b32 v104, 0
    v_mov_b32 v105, 0
    v_mov_b32 v106, 0
    v_mov_b32 v107, 0
    v_mov_b32 v108, 0
    v_mov_b32 v109, 0
    v_mov_b32 v110, 0
    v_mov_b32 v111, 0
    s_waitcnt vmcnt(0) lgkmcnt(0)
    v_mfma_f32_16x16x32_bf16 v[56:59], v[56:59], v[32:35], 0
    v_mfma_f32_16x16x32_bf16 v[56:59], v[60:63], v[36:39], v[56:59]
    v_mfma_f32_16x16x32_bf16 v[56:59], v[64:67], v[40:43], v[56:59]
    v_mfma_f32_16x16x32_bf16 v[56:59], v[68:71], v[44:47], v[56:59]
    v_mfma_f32_16x16x32_bf16 v[60:63], v[72:75], v[32:35], 0
    v_mfma_f32_16x16x32_bf16 v[60:63], v[76:79], v[36:39], v[60:63]
    v_mfma_f32_16x16x32_bf16 v[60:63], v[80:83], v[40:43], v[60:63]
    v_mfma_f32_16x16x32_bf16 v[60:63], v[84:87], v[44:47], v[60:63]
    v_mfma_f32_16x16x32_bf16 v[64:67], v[32:35], v[32:35], 0
    v_mfma_f32_16x16x32_bf16 v[64:67], v[36:39], v[36:39], v[64:67]
    v_mfma_f32_16x16x32_bf16 v[64:67], v[40:43], v[40:43], v[64:67]
    v_mfma_f32_16x16x32_bf16 v[64:67], v[44:47], v[44:47], v[64:67]
    v_max3_f32 v84, v56, v57, v58
    v_max3_f32 v84, v84, v59, v60
    v_max3_f32 v84, v84, v61, v62
    s_nop 4
    v_max3_f32 v84, v84, v63, v64
    v_max_f32 v84, v84, v65
    v_mov_b32 v85, v84
    s_nop 1
    v_permlane32_swap_b32 v85, v84
    v_max_f32 v84, v85, v84
    v_mov_b32 v85, v84
    s_nop 1
    v_permlane16_swap_b32 v85, v84
    v_max_f32 v84, v85, v84
    v_sub_f32 v56, v56, v84
    v_sub_f32 v57, v57, v84
    v_sub_f32 v58, v58, v84
    v_sub_f32 v59, v59, v84
    v_sub_f32 v60, v60, v84
    v_sub_f32 v61, v61, v84
    v_sub_f32 v62, v62, v84
    v_sub_f32 v63, v63, v84
    v_sub_f32 v64, v64, v84
    v_sub_f32 v65, v65, v84
    v_exp_f32 v56, v56
    v_exp_f32 v57, v57
    v_exp_f32 v58, v58
    v_exp_f32 v59, v59
    v_exp_f32 v60, v60
    v_exp_f32 v61, v61
    v_exp_f32 v62, v62
    v_exp_f32 v63, v63
    v_exp_f32 v64, v64
    v_exp_f32 v65, v65
    v_cvt_pk_bf16_f32 v68, v56, v57
    v_cvt_pk_bf16_f32 v69, v58, v59
    v_cvt_pk_bf16_f32 v70, v60, v61
    v_cvt_pk_bf16_f32 v71, v62, v63
    v_cvt_pk_bf16_f32 v52, v64, v65
    s_nop 0
    v_mfma_f32_16x16x32_bf16 v[72:75], v[88:91], v[68:71], 0
    v_mfma_f32_16x16x32_bf16 v[76:79], v[92:95], v[68:71], 0
    v_mfma_f32_16x16x32_bf16 v[80:83], v[48:51], v[68:71], 0
    v_mfma_f32_16x16x16_bf16 v[72:75], v[112:113], v[52:53], v[72:75]
    v_mfma_f32_16x16x16_bf16 v[76:79], v[114:115], v[52:53], v[76:79]
    v_mfma_f32_16x16x16_bf16 v[80:83], v[48:49], v[52:53], v[80:83]
    ds_read_b128 v[32:35], v124 offset:6144
    ds_read_b128 v[36:39], v124 offset:7168
    ds_read_b128 v[40:43], v124 offset:34816
    ds_read_b128 v[44:47], v124 offset:35840
    ds_read_b128 v[56:59], v124 offset:36864
    ds_read_b128 v[64:67], v124 offset:38912
    ds_read_b128 v[68:71], v124 offset:39936
    s_waitcnt lgkmcnt(0)
    s_branch L_norm_61
L_kvw_63:
    s_add_u32 s47, s47, 1
    s_add_u32 s49, s49, 1
    s_cmp_ge_u32 s49, 0x10000
    s_cbranch_scc1 L_kvb_64
    s_sleep 4
    buffer_load_dword v125, v119, s[8:11], s28 offen sc1
    s_waitcnt vmcnt(0)
    v_cmp_eq_u32 vcc, 0, v125
    s_nop 0
    s_and_b64 vcc, vcc, s[58:59]
    s_cbranch_scc1 L_kvw_63
    s_branch L_kvb_64
L_mret_66:
    s_mov_b32 s43, m0
    s_mov_b32 m0, 5120
    buffer_load_dwordx4 v[4:7], v117, s[8:11], s48 offen sc1
    buffer_load_dwordx4 v117, s[8:11], s48 offen sc1 lds
    s_mov_b32 m0, 10240
    s_mov_b32 m0, s43
    s_waitcnt vmcnt(0)
    v_max3_u32 v15, v4, v5, v6
    v_max_u32 v15, v15, v7
    v_cmp_lt_u32 vcc, s56, v15
    s_add_u32 s47, s47, 1
    s_add_u32 s49, s49, 1
    s_cmp_ge_u32 s49, 0x10000
    s_cbranch_scc1 L_mgo_67
    s_cbranch_vccnz L_mret_66
    s_branch L_mgo_67
L_smax_69:
    s_add_u32 s47, s47, 1
    s_mov_b32 s35, 0x7f800000
    s_waitcnt lgkmcnt(0)
    s_sub_u32 s43, s30, 0x40800
    s_add_u32 s40, s43, 4096
    s_nop 7
    buffer_load_dwordx4 v[56:59], v117, s[8:11], s43 offen
    buffer_load_dwordx4 v[60:63], v117, s[8:11], s43 offen offset:1024
    buffer_load_dwordx4 v[64:67], v117, s[8:11], s43 offen offset:2048
    buffer_load_dwordx4 v[68:71], v117, s[8:11], s43 offen offset:3072
    buffer_load_dwordx4 v[72:75], v117, s[8:11], s40 offen
    buffer_load_dwordx4 v[76:79], v117, s[8:11], s40 offen offset:1024
    buffer_load_dwordx4 v[80:83], v117, s[8:11], s40 offen offset:2048
    buffer_load_dwordx4 v[84:87], v117, s[8:11], s40 offen offset:3072
    ds_read_b128 v[32:35], v121 offset:16384
    ds_read_b128 v[36:39], v121 offset:17408
    ds_read_b128 v[40:43], v121 offset:18432
    ds_read_b128 v[44:47], v121 offset:19456
    v_mov_b32 v96, 0
    v_mov_b32 v97, 0
    v_mov_b32 v98, 0
    v_mov_b32 v99, 0
    v_mov_b32 v100, 0
    v_mov_b32 v101, 0
    v_mov_b32 v102, 0
    v_mov_b32 v103, 0
    v_mov_b32 v104, 0
    v_mov_b32 v105, 0
    v_mov_b32 v106, 0
    v_mov_b32 v107, 0
    v_mov_b32 v108, 0
    v_mov_b32 v109, 0
    v_mov_b32 v110, 0
    v_mov_b32 v111, 0
    s_waitcnt vmcnt(0) lgkmcnt(0)
    v_mfma_f32_16x16x32_bf16 v[56:59], v[56:59], v[32:35], 0
    v_mfma_f32_16x16x32_bf16 v[56:59], v[60:63], v[36:39], v[56:59]
    v_mfma_f32_16x16x32_bf16 v[56:59], v[64:67], v[40:43], v[56:59]
    v_mfma_f32_16x16x32_bf16 v[56:59], v[68:71], v[44:47], v[56:59]
    v_mfma_f32_16x16x32_bf16 v[60:63], v[72:75], v[32:35], 0
    v_mfma_f32_16x16x32_bf16 v[60:63], v[76:79], v[36:39], v[60:63]
    v_mfma_f32_16x16x32_bf16 v[60:63], v[80:83], v[40:43], v[60:63]
    v_mfma_f32_16x16x32_bf16 v[60:63], v[84:87], v[44:47], v[60:63]
    v_mfma_f32_16x16x32_bf16 v[64:67], v[32:35], v[32:35], 0
    v_mfma_f32_16x16x32_bf16 v[64:67], v[36:39], v[36:39], v[64:67]
    v_mfma_f32_16x16x32_bf16 v[64:67], v[40:43], v[40:43], v[64:67]
    v_mfma_f32_16x16x32_bf16 v[64:67], v[44:47], v[44:47], v[64:67]
    v_max3_f32 v84, v56, v57, v58
    v_max3_f32 v84, v84, v59, v60
    v_max3_f32 v84, v84, v61, v62
    s_nop 4
    v_max3_f32 v84, v84, v63, v64
    v_max_f32 v84, v84, v65
    v_mov_b32 v85, v84
    s_nop 1
    v_permlane32_swap_b32 v85, v84
    v_max_f32 v84, v85, v84
    v_mov_b32 v85, v84
    s_nop 1
    v_permlane16_swap_b32 v85, v84
    v_max_f32 v84, v85, v84
    v_sub_f32 v56, v56, v84
    v_sub_f32 v57, v57, v84
    v_sub_f32 v58, v58, v84
    v_sub_f32 v59, v59, v84
    v_sub_f32 v60, v60, v84
    v_sub_f32 v61, v61, v84
    v_sub_f32 v62, v62, v84
    v_sub_f32 v63, v63, v84
    v_sub_f32 v64, v64, v84
    v_sub_f32 v65, v65, v84
    v_exp_f32 v56, v56
    v_exp_f32 v57, v57
    v_exp_f32 v58, v58
    v_exp_f32 v59, v59
    v_exp_f32 v60, v60
    v_exp_f32 v61, v61
    v_exp_f32 v62, v62
    v_exp_f32 v63, v63
    v_exp_f32 v64, v64
    v_exp_f32 v65, v65
    v_cvt_pk_bf16_f32 v68, v56, v57
    v_cvt_pk_bf16_f32 v69, v58, v59
    v_cvt_pk_bf16_f32 v70, v60, v61
    v_cvt_pk_bf16_f32 v71, v62, v63
    v_cvt_pk_bf16_f32 v52, v64, v65
    s_nop 0
    v_mfma_f32_16x16x32_bf16 v[72:75], v[88:91], v[68:71], 0
    v_mfma_f32_16x16x32_bf16 v[76:79], v[92:95], v[68:71], 0
    v_mfma_f32_16x16x32_bf16 v[80:83], v[48:51], v[68:71], 0
    v_mfma_f32_16x16x16_bf16 v[72:75], v[112:113], v[52:53], v[72:75]
    v_mfma_f32_16x16x16_bf16 v[76:79], v[114:115], v[52:53], v[76:79]
    v_mfma_f32_16x16x16_bf16 v[80:83], v[48:49], v[52:53], v[80:83]
    ds_read_b128 v[32:35], v124 offset:6144
    ds_read_b128 v[36:39], v124 offset:7168
    ds_read_b128 v[40:43], v124 offset:34816
    ds_read_b128 v[44:47], v124 offset:35840
    ds_read_b128 v[56:59], v124 offset:36864
    ds_read_b128 v[64:67], v124 offset:38912
    ds_read_b128 v[68:71], v124 offset:39936
    s_waitcnt lgkmcnt(0)
    s_branch L_norm_68
L_kvw_70:
    s_add_u32 s47, s47, 1
    s_add_u32 s49, s49, 1
    s_cmp_ge_u32 s49, 0x10000
    s_cbranch_scc1 L_kvb_71
    s_sleep 4
    buffer_load_dword v125, v119, s[8:11], s28 offen sc1
    s_waitcnt vmcnt(0)
    v_cmp_eq_u32 vcc, 0, v125
    s_nop 0
    s_and_b64 vcc, vcc, s[58:59]
    s_cbranch_scc1 L_kvw_70
    s_branch L_kvb_71
L_mret_73:
    s_mov_b32 s43, m0
    s_mov_b32 m0, 6144
    buffer_load_dwordx4 v[4:7], v117, s[8:11], s48 offen sc1
    buffer_load_dwordx4 v117, s[8:11], s48 offen sc1 lds
    s_mov_b32 m0, 12288
    s_mov_b32 m0, s43
    s_waitcnt vmcnt(0)
    v_max3_u32 v15, v4, v5, v6
    v_max_u32 v15, v15, v7
    v_cmp_lt_u32 vcc, s56, v15
    s_add_u32 s47, s47, 1
    s_add_u32 s49, s49, 1
    s_cmp_ge_u32 s49, 0x10000
    s_cbranch_scc1 L_mgo_74
    s_cbranch_vccnz L_mret_73
    s_branch L_mgo_74
L_smax_76:
    s_add_u32 s47, s47, 1
    s_mov_b32 s35, 0x7f800000
    s_waitcnt lgkmcnt(0)
    s_sub_u32 s43, s30, 0x41000
    s_add_u32 s40, s43, 4096
    s_nop 7
    buffer_load_dwordx4 v[56:59], v117, s[8:11], s43 offen
    buffer_load_dwordx4 v[60:63], v117, s[8:11], s43 offen offset:1024
    buffer_load_dwordx4 v[64:67], v117, s[8:11], s43 offen offset:2048
    buffer_load_dwordx4 v[68:71], v117, s[8:11], s43 offen offset:3072
    buffer_load_dwordx4 v[72:75], v117, s[8:11], s40 offen
    buffer_load_dwordx4 v[76:79], v117, s[8:11], s40 offen offset:1024
    buffer_load_dwordx4 v[80:83], v117, s[8:11], s40 offen offset:2048
    buffer_load_dwordx4 v[84:87], v117, s[8:11], s40 offen offset:3072
    ds_read_b128 v[32:35], v121 offset:16384
    ds_read_b128 v[36:39], v121 offset:17408
    ds_read_b128 v[40:43], v121 offset:18432
    ds_read_b128 v[44:47], v121 offset:19456
    v_mov_b32 v96, 0
    v_mov_b32 v97, 0
    v_mov_b32 v98, 0
    v_mov_b32 v99, 0
    v_mov_b32 v100, 0
    v_mov_b32 v101, 0
    v_mov_b32 v102, 0
    v_mov_b32 v103, 0
    v_mov_b32 v104, 0
    v_mov_b32 v105, 0
    v_mov_b32 v106, 0
    v_mov_b32 v107, 0
    v_mov_b32 v108, 0
    v_mov_b32 v109, 0
    v_mov_b32 v110, 0
    v_mov_b32 v111, 0
    s_waitcnt vmcnt(0) lgkmcnt(0)
    v_mfma_f32_16x16x32_bf16 v[56:59], v[56:59], v[32:35], 0
    v_mfma_f32_16x16x32_bf16 v[56:59], v[60:63], v[36:39], v[56:59]
    v_mfma_f32_16x16x32_bf16 v[56:59], v[64:67], v[40:43], v[56:59]
    v_mfma_f32_16x16x32_bf16 v[56:59], v[68:71], v[44:47], v[56:59]
    v_mfma_f32_16x16x32_bf16 v[60:63], v[72:75], v[32:35], 0
    v_mfma_f32_16x16x32_bf16 v[60:63], v[76:79], v[36:39], v[60:63]
    v_mfma_f32_16x16x32_bf16 v[60:63], v[80:83], v[40:43], v[60:63]
    v_mfma_f32_16x16x32_bf16 v[60:63], v[84:87], v[44:47], v[60:63]
    v_mfma_f32_16x16x32_bf16 v[64:67], v[32:35], v[32:35], 0
    v_mfma_f32_16x16x32_bf16 v[64:67], v[36:39], v[36:39], v[64:67]
    v_mfma_f32_16x16x32_bf16 v[64:67], v[40:43], v[40:43], v[64:67]
    v_mfma_f32_16x16x32_bf16 v[64:67], v[44:47], v[44:47], v[64:67]
    v_max3_f32 v84, v56, v57, v58
    v_max3_f32 v84, v84, v59, v60
    v_max3_f32 v84, v84, v61, v62
    s_nop 4
    v_max3_f32 v84, v84, v63, v64
    v_max_f32 v84, v84, v65
    v_mov_b32 v85, v84
    s_nop 1
    v_permlane32_swap_b32 v85, v84
    v_max_f32 v84, v85, v84
    v_mov_b32 v85, v84
    s_nop 1
    v_permlane16_swap_b32 v85, v84
    v_max_f32 v84, v85, v84
    v_sub_f32 v56, v56, v84
    v_sub_f32 v57, v57, v84
    v_sub_f32 v58, v58, v84
    v_sub_f32 v59, v59, v84
    v_sub_f32 v60, v60, v84
    v_sub_f32 v61, v61, v84
    v_sub_f32 v62, v62, v84
    v_sub_f32 v63, v63, v84
    v_sub_f32 v64, v64, v84
    v_sub_f32 v65, v65, v84
    v_exp_f32 v56, v56
    v_exp_f32 v57, v57
    v_exp_f32 v58, v58
    v_exp_f32 v59, v59
    v_exp_f32 v60, v60
    v_exp_f32 v61, v61
    v_exp_f32 v62, v62
    v_exp_f32 v63, v63
    v_exp_f32 v64, v64
    v_exp_f32 v65, v65
    v_cvt_pk_bf16_f32 v68, v56, v57
    v_cvt_pk_bf16_f32 v69, v58, v59
    v_cvt_pk_bf16_f32 v70, v60, v61
    v_cvt_pk_bf16_f32 v71, v62, v63
    v_cvt_pk_bf16_f32 v52, v64, v65
    s_nop 0
    v_mfma_f32_16x16x32_bf16 v[72:75], v[88:91], v[68:71], 0
    v_mfma_f32_16x16x32_bf16 v[76:79], v[92:95], v[68:71], 0
    v_mfma_f32_16x16x32_bf16 v[80:83], v[48:51], v[68:71], 0
    v_mfma_f32_16x16x16_bf16 v[72:75], v[112:113], v[52:53], v[72:75]
    v_mfma_f32_16x16x16_bf16 v[76:79], v[114:115], v[52:53], v[76:79]
    v_mfma_f32_16x16x16_bf16 v[80:83], v[48:49], v[52:53], v[80:83]
    ds_read_b128 v[32:35], v124 offset:6144
    ds_read_b128 v[36:39], v124 offset:7168
    ds_read_b128 v[40:43], v124 offset:34816
    ds_read_b128 v[44:47], v124 offset:35840
    ds_read_b128 v[56:59], v124 offset:36864
    ds_read_b128 v[64:67], v124 offset:38912
    ds_read_b128 v[68:71], v124 offset:39936
    s_waitcnt lgkmcnt(0)
    s_branch L_norm_75
L_rslow_78:
    buffer_load_dwordx4 v[4:7], v117, s[8:11], s29 offen sc1
    buffer_load_dwordx4 v[8:11], v117, s[8:11], s53 offen sc1
    buffer_load_dwordx4 v[16:19], v117, s[8:11], s29 offen offset:2048 sc1
    buffer_load_dwordx4 v[20:23], v117, s[8:11], s53 offen offset:2048 sc1
    s_add_u32 s46, s46, 1
    s_add_u32 s49, s49, 1
    s_cmp_ge_u32 s49, 0x10000
    s_cbranch_scc1 L_rgo_79
    s_waitcnt vmcnt(7)
    v_mfma_f32_16x16x32_bf16 v[48:51], v[32:35], v[12:15], 0
    v_xor_b32 v52, s33, v32
    s_waitcnt vmcnt(6)
    v_mfma_f32_16x16x32_bf16 v[48:51], v[36:39], v[12:15], v[48:51]
    v_xor_b32 v53, s33, v36
    v_or_b32 v52, v52, v53
    s_waitcnt vmcnt(5)
    v_mfma_f32_16x16x32_bf16 v[48:51], v[40:43], v[12:15], v[48:51]
    v_xor_b32 v53, s33, v40
    v_or_b32 v52, v52, v53
    s_waitcnt vmcnt(4)
    v_mfma_f32_16x16x32_bf16 v[48:51], v[44:47], v[12:15], v[48:51]
    v_xor_b32 v53, s33, v44
    v_or_b32 v52, v52, v53
    v_and_b32 v52, 1, v52
    v_cmp_ne_u32 vcc, 0, v52
    s_cbranch_vccz L_rgo_79
    buffer_load_dwordx4 v[32:35], v117, s[8:11], s29 offen sc1
    buffer_load_dwordx4 v[36:39], v117, s[8:11], s53 offen sc1
    buffer_load_dwordx4 v[40:43], v117, s[8:11], s29 offen offset:2048 sc1
    buffer_load_dwordx4 v[44:47], v117, s[8:11], s53 offen offset:2048 sc1
    s_add_u32 s46, s46, 1
    s_branch L_rl_77
L_mret_81:
    s_mov_b32 s43, m0
    s_mov_b32 m0, 7168
    buffer_load_dwordx4 v[4:7], v117, s[8:11], s48 offen sc1
    buffer_load_dwordx4 v117, s[8:11], s48 offen sc1 lds
    s_mov_b32 m0, 14336
    s_mov_b32 m0, s43
    s_waitcnt vmcnt(0)
    v_max3_u32 v15, v4, v5, v6
    v_max_u32 v15, v15, v7
    v_cmp_lt_u32 vcc, s56, v15
    s_add_u32 s47, s47, 1
    s_add_u32 s49, s49, 1
    s_cmp_ge_u32 s49, 0x10000
    s_cbranch_scc1 L_mgo_82
    s_cbranch_vccnz L_mret_81
    s_branch L_mgo_82
L_smax_84:
    s_add_u32 s47, s47, 1
    s_mov_b32 s35, 0x7f800000
    s_waitcnt lgkmcnt(0)
    s_sub_u32 s43, s30, 0x41800
    s_add_u32 s40, s43, 4096
    s_nop 7
    buffer_load_dwordx4 v[56:59], v117, s[8:11], s43 offen
    buffer_load_dwordx4 v[60:63], v117, s[8:11], s43 offen offset:1024
    buffer_load_dwordx4 v[64:67], v117, s[8:11], s43 offen offset:2048
    buffer_load_dwordx4 v[68:71], v117, s[8:11], s43 offen offset:3072
    buffer_load_dwordx4 v[72:75], v117, s[8:11], s40 offen
    buffer_load_dwordx4 v[76:79], v117, s[8:11], s40 offen offset:1024
    buffer_load_dwordx4 v[80:83], v117, s[8:11], s40 offen offset:2048
    buffer_load_dwordx4 v[84:87], v117, s[8:11], s40 offen offset:3072
    ds_read_b128 v[32:35], v121 offset:16384
    ds_read_b128 v[36:39], v121 offset:17408
    ds_read_b128 v[40:43], v121 offset:18432
    ds_read_b128 v[44:47], v121 offset:19456
    v_mov_b32 v96, 0
    v_mov_b32 v97, 0
    v_mov_b32 v98, 0
    v_mov_b32 v99, 0
    v_mov_b32 v100, 0
    v_mov_b32 v101, 0
    v_mov_b32 v102, 0
    v_mov_b32 v103, 0
    v_mov_b32 v104, 0
    v_mov_b32 v105, 0
    v_mov_b32 v106, 0
    v_mov_b32 v107, 0
    v_mov_b32 v108, 0
    v_mov_b32 v109, 0
    v_mov_b32 v110, 0
    v_mov_b32 v111, 0
    s_waitcnt vmcnt(0) lgkmcnt(0)
    v_mfma_f32_16x16x32_bf16 v[56:59], v[56:59], v[32:35], 0
    v_mfma_f32_16x16x32_bf16 v[56:59], v[60:63], v[36:39], v[56:59]
    v_mfma_f32_16x16x32_bf16 v[56:59], v[64:67], v[40:43], v[56:59]
    v_mfma_f32_16x16x32_bf16 v[56:59], v[68:71], v[44:47], v[56:59]
    v_mfma_f32_16x16x32_bf16 v[60:63], v[72:75], v[32:35], 0
    v_mfma_f32_16x16x32_bf16 v[60:63], v[76:79], v[36:39], v[60:63]
    v_mfma_f32_16x16x32_bf16 v[60:63], v[80:83], v[40:43], v[60:63]
    v_mfma_f32_16x16x32_bf16 v[60:63], v[84:87], v[44:47], v[60:63]
    v_mfma_f32_16x16x32_bf16 v[64:67], v[32:35], v[32:35], 0
    v_mfma_f32_16x16x32_bf16 v[64:67], v[36:39], v[36:39], v[64:67]
    v_mfma_f32_16x16x32_bf16 v[64:67], v[40:43], v[40:43], v[64:67]
    v_mfma_f32_16x16x32_bf16 v[64:67], v[44:47], v[44:47], v[64:67]
    v_max3_f32 v84, v56, v57, v58
    v_max3_f32 v84, v84, v59, v60
    v_max3_f32 v84, v84, v61, v62
    s_nop 4
    v_max3_f32 v84, v84, v63, v64
    v_max_f32 v84, v84, v65
    v_mov_b32 v85, v84
    s_nop 1
    v_permlane32_swap_b32 v85, v84
    v_max_f32 v84, v85, v84
    v_mov_b32 v85, v84
    s_nop 1
    v_permlane16_swap_b32 v85, v84
    v_max_f32 v84, v85, v84
    v_sub_f32 v56, v56, v84
    v_sub_f32 v57, v57, v84
    v_sub_f32 v58, v58, v84
    v_sub_f32 v59, v59, v84
    v_sub_f32 v60, v60, v84
    v_sub_f32 v61, v61, v84
    v_sub_f32 v62, v62, v84
    v_sub_f32 v63, v63, v84
    v_sub_f32 v64, v64, v84
    v_sub_f32 v65, v65, v84
    v_exp_f32 v56, v56
    v_exp_f32 v57, v57
    v_exp_f32 v58, v58
    v_exp_f32 v59, v59
    v_exp_f32 v60, v60
    v_exp_f32 v61, v61
    v_exp_f32 v62, v62
    v_exp_f32 v63, v63
    v_exp_f32 v64, v64
    v_exp_f32 v65, v65
    v_cvt_pk_bf16_f32 v68, v56, v57
    v_cvt_pk_bf16_f32 v69, v58, v59
    v_cvt_pk_bf16_f32 v70, v60, v61
    v_cvt_pk_bf16_f32 v71, v62, v63
    v_cvt_pk_bf16_f32 v52, v64, v65
    s_nop 0
    v_mfma_f32_16x16x32_bf16 v[72:75], v[88:91], v[68:71], 0
    v_mfma_f32_16x16x32_bf16 v[76:79], v[92:95], v[68:71], 0
    v_mfma_f32_16x16x32_bf16 v[80:83], v[48:51], v[68:71], 0
    v_mfma_f32_16x16x16_bf16 v[72:75], v[112:113], v[52:53], v[72:75]
    v_mfma_f32_16x16x16_bf16 v[76:79], v[114:115], v[52:53], v[76:79]
    v_mfma_f32_16x16x16_bf16 v[80:83], v[48:49], v[52:53], v[80:83]
    ds_read_b128 v[32:35], v124 offset:6144
    ds_read_b128 v[36:39], v124 offset:7168
    ds_read_b128 v[40:43], v124 offset:34816
    ds_read_b128 v[44:47], v124 offset:35840
    ds_read_b128 v[56:59], v124 offset:36864
    ds_read_b128 v[64:67], v124 offset:38912
    ds_read_b128 v[68:71], v124 offset:39936
    s_waitcnt lgkmcnt(0)
    s_branch L_norm_83
L_rslow_86:
    buffer_load_dwordx4 v[4:7], v117, s[8:11], s29 offen sc1
    buffer_load_dwordx4 v[8:11], v117, s[8:11], s53 offen sc1
    buffer_load_dwordx4 v[16:19], v117, s[8:11], s29 offen offset:2048 sc1
    buffer_load_dwordx4 v[20:23], v117, s[8:11], s53 offen offset:2048 sc1
    s_add_u32 s46, s46, 1
    s_add_u32 s49, s49, 1
    s_cmp_ge_u32 s49, 0x10000
    s_cbranch_scc1 L_rgo_87
    s_waitcnt vmcnt(7)
    v_mfma_f32_16x16x32_bf16 v[48:51], v[32:35], v[12:15], 0
    v_xor_b32 v52, s33, v32
    s_waitcnt vmcnt(6)
    v_mfma_f32_16x16x32_bf16 v[48:51], v[36:39], v[12:15], v[48:51]
    v_xor_b32 v53, s33, v36
    v_or_b32 v52, v52, v53
    s_waitcnt vmcnt(5)
    v_mfma_f32_16x16x32_bf16 v[48:51], v[40:43], v[12:15], v[48:51]
    v_xor_b32 v53, s33, v40
    v_or_b32 v52, v52, v53
    s_waitcnt vmcnt(4)
    v_mfma_f32_16x16x32_bf16 v[48:51], v[44:47], v[12:15], v[48:51]
    v_xor_b32 v53, s33, v44
    v_or_b32 v52, v52, v53
    v_and_b32 v52, 1, v52
    v_cmp_ne_u32 vcc, 0, v52
    s_cbranch_vccz L_rgo_87
    buffer_load_dwordx4 v[32:35], v117, s[8:11], s29 offen sc1
    buffer_load_dwordx4 v[36:39], v117, s[8:11], s53 offen sc1
    buffer_load_dwordx4 v[40:43], v117, s[8:11], s29 offen offset:2048 sc1
    buffer_load_dwordx4 v[44:47], v117, s[8:11], s53 offen offset:2048 sc1
    s_add_u32 s46, s46, 1
    s_branch L_rl_85
L_bulk:
    s_load_dwordx8 s[60:67], s[0:1], 16
    s_load_dwordx2 s[12:13], s[0:1], 0
    s_waitcnt lgkmcnt(0)
    s_branch L_bulk2
.p2align 7
L_other:
    s_sub_u32 s101, s84, 1
    s_lshl_b32 s101, s101, 5
    s_add_u32 s101, s101, s85
    s_cmp_ge_u32 s85, 2
    s_cbranch_scc1 L_nobc
    v_lshlrev_b32 v1, 6, v0
    s_lshl_b32 s96, s85, 14
    s_getpc_b64 s[4:5]
L_pc_88:
    s_add_u32 s4, s4, L_bulk2-L_pc_88
    s_addc_u32 s5, s5, 0
    v_add_u32 v1, s96, v1
    v_min_u32 v1, L_code_end-L_bulk2-4, v1
    global_load_dword v255, v1, s[4:5]
L_nobc:
    s_waitcnt lgkmcnt(0)
    s_and_b32 s9, s9, 0xffff
    s_mov_b32 s10, 0x10000000
    s_mov_b32 s11, 0x20000
    s_and_b32 s93, s93, 0xffff
    s_mov_b32 s94, 0x100
    s_mov_b32 s95, 0x20000
    s_mov_b32 s87, 0
    s_cmp_lg_u32 s86, 0
    s_cbranch_scc1 L_reg_89
    s_lshl_b32 s97, s84, 4
    s_lshl_b32 s96, 1, s85
    v_mov_b32 v250, s96
    v_mov_b32 v251, 256
    s_mov_b64 exec, 1
    buffer_atomic_add_x2 v[250:251], off, s[92:95], s97 offset:64
    s_mov_b64 exec, -1
    s_mov_b32 s86, 1
L_reg_89:
L_bulk2:
    s_add_u32 s88, s101, 32
    s_mov_b32 s41, 0
    s_lshr_b32 s20, s101, 6
    s_and_b32 s22, s101, 63
    s_cmp_ge_u32 s101, 192
    s_cselect_b32 s37, 32, 1000
L_p1go:
    s_mov_b32 s40, 0
    s_mov_b32 s80, 0
    s_mov_b32 s23, 0
L_p1_pass:
    v_mbcnt_lo_u32_b32 v0, -1, 0
    v_mbcnt_hi_u32_b32 v0, -1, v0
    s_lshl_b32 s96, s100, 6
    v_add_u32 v0, s96, v0
    s_and_b32 s13, s13, 0xffff
    s_mov_b32 s14, 0x200000
    s_mov_b32 s15, 0x20000
    v_lshrrev_b32 v147, 6, v0
    s_nop 0
    v_readfirstlane_b32 s21, v147
    v_and_b32 v144, 63, v0
    v_lshrrev_b32 v145, 4, v144
    v_and_b32 v146, 15, v144
    v_lshrrev_b32 v149, 2, v146
    v_lshlrev_b32 v137, 4, v144
    s_lshl_b32 s29, s21, 10
    s_lshl_b32 s26, s20, 7
    s_lshl_b32 s27, s21, 5
    s_add_u32 s26, s26, s27
    v_add_u32 v147, s26, v146
    v_lshlrev_b32 v147, 10, v147
    v_lshl_add_u32 v139, v145, 4, v147
    s_mov_b32 s26, 0x0
    buffer_load_dwordx4 v[0:3], v139, s[12:15], s26 offen
    buffer_load_dwordx4 v[4:7], v139, s[12:15], s26 offen offset:64
    buffer_load_dwordx4 v[8:11], v139, s[12:15], s26 offen offset:128
    buffer_load_dwordx4 v[12:15], v139, s[12:15], s26 offen offset:192
    buffer_load_dwordx4 v[16:19], v139, s[12:15], s26 offen offset:256
    buffer_load_dwordx4 v[20:23], v139, s[12:15], s26 offen offset:320
    buffer_load_dwordx4 v[24:27], v139, s[12:15], s26 offen offset:384
    buffer_load_dwordx4 v[28:31], v139, s[12:15], s26 offen offset:448
    buffer_load_dwordx4 v[32:35], v139, s[12:15], s26 offen offset:512
    buffer_load_dwordx4 v[36:39], v139, s[12:15], s26 offen offset:576
    buffer_load_dwordx4 v[40:43], v139, s[12:15], s26 offen offset:640
    buffer_load_dwordx4 v[44:47], v139, s[12:15], s26 offen offset:704
    buffer_load_dwordx4 v[48:51], v139, s[12:15], s26 offen offset:768
    buffer_load_dwordx4 v[52:55], v139, s[12:15], s26 offen offset:832
    buffer_load_dwordx4 v[56:59], v139, s[12:15], s26 offen offset:896
    buffer_load_dwordx4 v[60:63], v139, s[12:15], s26 offen offset:960
    s_mov_b32 s26, 0x4000
    buffer_load_dwordx4 v[64:67], v139, s[12:15], s26 offen
    buffer_load_dwordx4 v[68:71], v139, s[12:15], s26 offen offset:64
    buffer_load_dwordx4 v[72:75], v139, s[12:15], s26 offen offset:128
    buffer_load_dwordx4 v[76:79], v139, s[12:15], s26 offen offset:192
    buffer_load_dwordx4 v[80:83], v139, s[12:15], s26 offen offset:256
    buffer_load_dwordx4 v[84:87], v139, s[12:15], s26 offen offset:320
    buffer_load_dwordx4 v[88:91], v139, s[12:15], s26 offen offset:384
    buffer_load_dwordx4 v[92:95], v139, s[12:15], s26 offen offset:448
    buffer_load_dwordx4 v[96:99], v139, s[12:15], s26 offen offset:512
    buffer_load_dwordx4 v[100:103], v139, s[12:15], s26 offen offset:576
    buffer_load_dwordx4 v[104:107], v139, s[12:15], s26 offen offset:640
    buffer_load_dwordx4 v[108:111], v139, s[12:15], s26 offen offset:704
    buffer_load_dwordx4 v[112:115], v139, s[12:15], s26 offen offset:768
    buffer_load_dwordx4 v[116:119], v139, s[12:15], s26 offen offset:832
    buffer_load_dwordx4 v[120:123], v139, s[12:15], s26 offen offset:896
    buffer_load_dwordx4 v[124:127], v139, s[12:15], s26 offen offset:960
    s_lshr_b32 s26, s21, 1
    s_lshl_b32 s26, s26, 2
    v_or_b32 v148, s26, v145
    v_lshlrev_b32 v148, 1, v148
    v_xor_b32 v148, v148, v146
    v_lshlrev_b32 v148, 4, v148
    s_lshl_b32 s26, s21, 2
    v_add_u32 v147, s26, v145
    v_lshl_add_u32 v136, v147, 13, v148
    v_lshl_add_u32 v147, v145, 3, v149
    v_lshlrev_b32 v147, 8, v147
    v_and_b32 v148, 1, v145
    v_lshl_or_b32 v148, v148, 2, v149
    v_lshl_add_u32 v147, v148, 5, v147
    v_and_b32 v148, 3, v146
    v_lshl_add_u32 v128, v148, 3, v147
    v_xor_b32 v129, 32, v128
    v_xor_b32 v130, 64, v128
    v_xor_b32 v131, 96, v128
    v_xor_b32 v132, 128, v128
    v_xor_b32 v133, 160, v128
    v_xor_b32 v134, 192, v128
    v_xor_b32 v135, 224, v128
    s_mov_b32 s19, 0x20000
    s_mov_b32 s38, s22
    s_mov_b32 s39, s22
    v_mov_b32 v158, 0x3f803f80
    s_lshr_b32 s26, s39, 5
    s_cmp_eq_u32 s26, 0
    s_cselect_b64 s[16:17], s[62:63], s[60:61]
    s_cmp_eq_u32 s26, 1
    s_cselect_b64 s[16:17], s[64:65], s[16:17]
    s_and_b32 s17, s17, 0xffff
    s_cmp_lt_u32 s39, 96
    s_cselect_b32 s18, 0x400000, 0
    s_and_b32 s24, s39, 31
    s_lshl_b32 s24, s24, 8
    s_waitcnt vmcnt(16)
    v_pk_mov_b32 v[150:151], 0, 0
    v_pk_mov_b32 v[152:153], 0, 0
    v_dot2_f32_bf16 v150, v0, v158, v150
    v_dot2_f32_bf16 v152, v0, v0, v152
    v_dot2_f32_bf16 v151, v1, v158, v151
    v_dot2_f32_bf16 v153, v1, v1, v153
    v_dot2_f32_bf16 v150, v2, v158, v150
    v_dot2_f32_bf16 v152, v2, v2, v152
    v_dot2_f32_bf16 v151, v3, v158, v151
    v_dot2_f32_bf16 v153, v3, v3, v153
    v_dot2_f32_bf16 v150, v4, v158, v150
    v_dot2_f32_bf16 v152, v4, v4, v152
    v_dot2_f32_bf16 v151, v5, v158, v151
    v_dot2_f32_bf16 v153, v5, v5, v153
    v_dot2_f32_bf16 v150, v6, v158, v150
    v_dot2_f32_bf16 v152, v6, v6, v152
    v_dot2_f32_bf16 v151, v7, v158, v151
    v_dot2_f32_bf16 v153, v7, v7, v153
    v_dot2_f32_bf16 v150, v8, v158, v150
    v_dot2_f32_bf16 v152, v8, v8, v152
    v_dot2_f32_bf16 v151, v9, v158, v151
    v_dot2_f32_bf16 v153, v9, v9, v153
    v_dot2_f32_bf16 v150, v10, v158, v150
    v_dot2_f32_bf16 v152, v10, v10, v152
    v_dot2_f32_bf16 v151, v11, v158, v151
    v_dot2_f32_bf16 v153, v11, v11, v153
    v_dot2_f32_bf16 v150, v12, v158, v150
    v_dot2_f32_bf16 v152, v12, v12, v152
    v_dot2_f32_bf16 v151, v13, v158, v151
    v_dot2_f32_bf16 v153, v13, v13, v153
    v_dot2_f32_bf16 v150, v14, v158, v150
    v_dot2_f32_bf16 v152, v14, v14, v152
    v_dot2_f32_bf16 v151, v15, v158, v151
    v_dot2_f32_bf16 v153, v15, v15, v153
    v_dot2_f32_bf16 v150, v16, v158, v150
    v_dot2_f32_bf16 v152, v16, v16, v152
    v_dot2_f32_bf16 v151, v17, v158, v151
    v_dot2_f32_bf16 v153, v17, v17, v153
    v_dot2_f32_bf16 v150, v18, v158, v150
    v_dot2_f32_bf16 v152, v18, v18, v152
    v_dot2_f32_bf16 v151, v19, v158, v151
    v_dot2_f32_bf16 v153, v19, v19, v153
    v_dot2_f32_bf16 v150, v20, v158, v150
    v_dot2_f32_bf16 v152, v20, v20, v152
    v_dot2_f32_bf16 v151, v21, v158, v151
    v_dot2_f32_bf16 v153, v21, v21, v153
    v_dot2_f32_bf16 v150, v22, v158, v150
    v_dot2_f32_bf16 v152, v22, v22, v152
    v_dot2_f32_bf16 v151, v23, v158, v151
    v_dot2_f32_bf16 v153, v23, v23, v153
    v_dot2_f32_bf16 v150, v24, v158, v150
    v_dot2_f32_bf16 v152, v24, v24, v152
    v_dot2_f32_bf16 v151, v25, v158, v151
    v_dot2_f32_bf16 v153, v25, v25, v153
    v_dot2_f32_bf16 v150, v26, v158, v150
    v_dot2_f32_bf16 v152, v26, v26, v152
    v_dot2_f32_bf16 v151, v27, v158, v151
    v_dot2_f32_bf16 v153, v27, v27, v153
    v_dot2_f32_bf16 v150, v28, v158, v150
    v_dot2_f32_bf16 v152, v28, v28, v152
    v_dot2_f32_bf16 v151, v29, v158, v151
    v_dot2_f32_bf16 v153, v29, v29, v153
    v_dot2_f32_bf16 v150, v30, v158, v150
    v_dot2_f32_bf16 v152, v30, v30, v152
    v_dot2_f32_bf16 v151, v31, v158, v151
    v_dot2_f32_bf16 v153, v31, v31, v153
    v_dot2_f32_bf16 v150, v32, v158, v150
    v_dot2_f32_bf16 v152, v32, v32, v152
    v_dot2_f32_bf16 v151, v33, v158, v151
    v_dot2_f32_bf16 v153, v33, v33, v153
    v_dot2_f32_bf16 v150, v34, v158, v150
    v_dot2_f32_bf16 v152, v34, v34, v152
    v_dot2_f32_bf16 v151, v35, v158, v151
    v_dot2_f32_bf16 v153, v35, v35, v153
    v_dot2_f32_bf16 v150, v36, v158, v150
    v_dot2_f32_bf16 v152, v36, v36, v152
    v_dot2_f32_bf16 v151, v37, v158, v151
    v_dot2_f32_bf16 v153, v37, v37, v153
    v_dot2_f32_bf16 v150, v38, v158, v150
    v_dot2_f32_bf16 v152, v38, v38, v152
    v_dot2_f32_bf16 v151, v39, v158, v151
    v_dot2_f32_bf16 v153, v39, v39, v153
    v_dot2_f32_bf16 v150, v40, v158, v150
    v_dot2_f32_bf16 v152, v40, v40, v152
    v_dot2_f32_bf16 v151, v41, v158, v151
    v_dot2_f32_bf16 v153, v41, v41, v153
    v_dot2_f32_bf16 v150, v42, v158, v150
    v_dot2_f32_bf16 v152, v42, v42, v152
    v_dot2_f32_bf16 v151, v43, v158, v151
    v_dot2_f32_bf16 v153, v43, v43, v153
    v_dot2_f32_bf16 v150, v44, v158, v150
    v_dot2_f32_bf16 v152, v44, v44, v152
    v_dot2_f32_bf16 v151, v45, v158, v151
    v_dot2_f32_bf16 v153, v45, v45, v153
    v_dot2_f32_bf16 v150, v46, v158, v150
    v_dot2_f32_bf16 v152, v46, v46, v152
    v_dot2_f32_bf16 v151, v47, v158, v151
    v_dot2_f32_bf16 v153, v47, v47, v153
    v_dot2_f32_bf16 v150, v48, v158, v150
    v_dot2_f32_bf16 v152, v48, v48, v152
    v_dot2_f32_bf16 v151, v49, v158, v151
    v_dot2_f32_bf16 v153, v49, v49, v153
    s_add_u32 s26, s24, 0x0
    s_add_u32 m0, s29, 0x0
    s_nop 0
    buffer_load_dwordx4 v136, s[16:19], s26 offen lds
    v_dot2_f32_bf16 v150, v50, v158, v150
    v_dot2_f32_bf16 v152, v50, v50, v152
    v_dot2_f32_bf16 v151, v51, v158, v151
    v_dot2_f32_bf16 v153, v51, v51, v153
    v_dot2_f32_bf16 v150, v52, v158, v150
    v_dot2_f32_bf16 v152, v52, v52, v152
    v_dot2_f32_bf16 v151, v53, v158, v151
    v_dot2_f32_bf16 v153, v53, v53, v153
    v_dot2_f32_bf16 v150, v54, v158, v150
    v_dot2_f32_bf16 v152, v54, v54, v152
    v_dot2_f32_bf16 v151, v55, v158, v151
    v_dot2_f32_bf16 v153, v55, v55, v153
    v_dot2_f32_bf16 v150, v56, v158, v150
    v_dot2_f32_bf16 v152, v56, v56, v152
    v_dot2_f32_bf16 v151, v57, v158, v151
    v_dot2_f32_bf16 v153, v57, v57, v153
    v_dot2_f32_bf16 v150, v58, v158, v150
    v_dot2_f32_bf16 v152, v58, v58, v152
    v_dot2_f32_bf16 v151, v59, v158, v151
    v_dot2_f32_bf16 v153, v59, v59, v153
    v_dot2_f32_bf16 v150, v60, v158, v150
    v_dot2_f32_bf16 v152, v60, v60, v152
    v_dot2_f32_bf16 v151, v61, v158, v151
    v_dot2_f32_bf16 v153, v61, v61, v153
    v_dot2_f32_bf16 v150, v62, v158, v150
    v_dot2_f32_bf16 v152, v62, v62, v152
    v_dot2_f32_bf16 v151, v63, v158, v151
    v_dot2_f32_bf16 v153, v63, v63, v153
    s_nop 1
    v_add_f32 v150, v150, v151
    v_add_f32 v152, v152, v153
    v_mov_b32 v157, v150
    s_nop 1
    v_permlane32_swap_b32 v157, v150
    v_add_f32 v150, v157, v150
    v_mov_b32 v157, v150
    s_nop 1
    v_permlane16_swap_b32 v157, v150
    v_add_f32 v150, v157, v150
    v_mov_b32 v157, v152
    s_nop 1
    v_permlane32_swap_b32 v157, v152
    v_add_f32 v152, v157, v152
    v_mov_b32 v157, v152
    s_nop 1
    v_permlane16_swap_b32 v157, v152
    v_add_f32 v152, v157, v152
    v_mul_f32 v150, 0x3b000000, v150
    v_cvt_pk_bf16_f32 v154, v150, v150
    v_and_b32 v154, 0xffff0000, v154
    v_sub_f32 v156, v150, v154
    v_mul_f32 v157, v150, v150
    v_mul_f32 v152, 0x3b000000, v152
    v_sub_f32 v152, v152, v157
    v_max_f32 v152, 0, v152
    v_cvt_pk_bf16_f32 v152, v152, v152
    v_and_b32 v152, 0xffff0000, v152
    v_add_f32 v152, 0x3727c5ac, v152
    v_cvt_pk_bf16_f32 v152, v152, v152
    v_and_b32 v152, 0xffff0000, v152
    v_sqrt_f32 v152, v152
    s_nop 0
    v_cvt_pk_bf16_f32 v152, v152, v152
    v_and_b32 v152, 0xffff0000, v152
    v_rcp_f32 v152, v152
    v_lshlrev_b32 v160, 16, v0
    v_and_b32 v161, 0xffff0000, v0
    v_lshlrev_b32 v162, 16, v1
    v_and_b32 v163, 0xffff0000, v1
    v_lshlrev_b32 v164, 16, v2
    v_and_b32 v165, 0xffff0000, v2
    v_lshlrev_b32 v166, 16, v3
    v_and_b32 v167, 0xffff0000, v3
    v_lshlrev_b32 v168, 16, v4
    v_and_b32 v169, 0xffff0000, v4
    v_lshlrev_b32 v170, 16, v5
    v_and_b32 v171, 0xffff0000, v5
    v_lshlrev_b32 v172, 16, v6
    v_and_b32 v173, 0xffff0000, v6
    v_lshlrev_b32 v174, 16, v7
    v_and_b32 v175, 0xffff0000, v7
    v_pk_add_f32 v[160:161], v[160:161], v[154:155] op_sel_hi:[1,0] neg_lo:[0,1] neg_hi:[0,1]
    v_pk_add_f32 v[162:163], v[162:163], v[154:155] op_sel_hi:[1,0] neg_lo:[0,1] neg_hi:[0,1]
    v_pk_add_f32 v[164:165], v[164:165], v[154:155] op_sel_hi:[1,0] neg_lo:[0,1] neg_hi:[0,1]
    v_pk_add_f32 v[166:167], v[166:167], v[154:155] op_sel_hi:[1,0] neg_lo:[0,1] neg_hi:[0,1]
    v_pk_add_f32 v[168:169], v[168:169], v[154:155] op_sel_hi:[1,0] neg_lo:[0,1] neg_hi:[0,1]
    v_pk_add_f32 v[170:171], v[170:171], v[154:155] op_sel_hi:[1,0] neg_lo:[0,1] neg_hi:[0,1]
    s_add_u32 s26, s24, 0x20000
    s_add_u32 m0, s29, 0x1000
    s_nop 0
    buffer_load_dwordx4 v136, s[16:19], s26 offen lds
    v_pk_add_f32 v[172:173], v[172:173], v[154:155] op_sel_hi:[1,0] neg_lo:[0,1] neg_hi:[0,1]
    v_pk_add_f32 v[174:175], v[174:175], v[154:155] op_sel_hi:[1,0] neg_lo:[0,1] neg_hi:[0,1]
    v_cvt_pk_bf16_f32 v0, v160, v161
    v_cvt_pk_bf16_f32 v1, v162, v163
    v_cvt_pk_bf16_f32 v2, v164, v165
    v_cvt_pk_bf16_f32 v3, v166, v167
    v_cvt_pk_bf16_f32 v4, v168, v169
    v_cvt_pk_bf16_f32 v5, v170, v171
    v_cvt_pk_bf16_f32 v6, v172, v173
    v_cvt_pk_bf16_f32 v7, v174, v175
    v_lshlrev_b32 v160, 16, v0
    v_and_b32 v161, 0xffff0000, v0
    v_lshlrev_b32 v162, 16, v1
    v_and_b32 v163, 0xffff0000, v1
    v_lshlrev_b32 v164, 16, v2
    v_and_b32 v165, 0xffff0000, v2
    v_lshlrev_b32 v166, 16, v3
    v_and_b32 v167, 0xffff0000, v3
    v_lshlrev_b32 v168, 16, v4
    v_and_b32 v169, 0xffff0000, v4
    v_lshlrev_b32 v170, 16, v5
    v_and_b32 v171, 0xffff0000, v5
    v_lshlrev_b32 v172, 16, v6
    v_and_b32 v173, 0xffff0000, v6
    v_lshlrev_b32 v174, 16, v7
    v_and_b32 v175, 0xffff0000, v7
    v_pk_mul_f32 v[160:161], v[160:161], v[152:153] op_sel_hi:[1,0]
    v_pk_mul_f32 v[162:163], v[162:163], v[152:153] op_sel_hi:[1,0]
    v_pk_mul_f32 v[164:165], v[164:165], v[152:153] op_sel_hi:[1,0]
    v_pk_mul_f32 v[166:167], v[166:167], v[152:153] op_sel_hi:[1,0]
    v_pk_mul_f32 v[168:169], v[168:169], v[152:153] op_sel_hi:[1,0]
    v_pk_mul_f32 v[170:171], v[170:171], v[152:153] op_sel_hi:[1,0]
    v_pk_mul_f32 v[172:173], v[172:173], v[152:153] op_sel_hi:[1,0]
    v_pk_mul_f32 v[174:175], v[174:175], v[152:153] op_sel_hi:[1,0]
    v_cvt_pk_bf16_f32 v160, v160, v161
    v_cvt_pk_bf16_f32 v162, v162, v163
    v_cvt_pk_bf16_f32 v164, v164, v165
    v_cvt_pk_bf16_f32 v166, v166, v167
    v_cvt_pk_bf16_f32 v168, v168, v169
    v_cvt_pk_bf16_f32 v170, v170, v171
    v_cvt_pk_bf16_f32 v172, v172, v173
    v_cvt_pk_bf16_f32 v174, v174, v175
    v_accvgpr_write_b32 a0, v160
    v_accvgpr_write_b32 a1, v162
    v_accvgpr_write_b32 a2, v164
    v_accvgpr_write_b32 a3, v166
    v_accvgpr_write_b32 a4, v168
    v_accvgpr_write_b32 a5, v170
    v_accvgpr_write_b32 a6, v172
    v_accvgpr_write_b32 a7, v174
    s_add_u32 s26, s24, 0x40000
    s_add_u32 m0, s29, 0x2000
    s_nop 0
    buffer_load_dwordx4 v136, s[16:19], s26 offen lds
    v_lshlrev_b32 v160, 16, v8
    v_and_b32 v161, 0xffff0000, v8
    v_lshlrev_b32 v162, 16, v9
    v_and_b32 v163, 0xffff0000, v9
    v_lshlrev_b32 v164, 16, v10
    v_and_b32 v165, 0xffff0000, v10
    v_lshlrev_b32 v166, 16, v11
    v_and_b32 v167, 0xffff0000, v11
    v_lshlrev_b32 v168, 16, v12
    v_and_b32 v169, 0xffff0000, v12
    v_lshlrev_b32 v170, 16, v13
    v_and_b32 v171, 0xffff0000, v13
    v_lshlrev_b32 v172, 16, v14
    v_and_b32 v173, 0xffff0000, v14
    v_lshlrev_b32 v174, 16, v15
    v_and_b32 v175, 0xffff0000, v15
    v_pk_add_f32 v[160:161], v[160:161], v[154:155] op_sel_hi:[1,0] neg_lo:[0,1] neg_hi:[0,1]
    v_pk_add_f32 v[162:163], v[162:163], v[154:155] op_sel_hi:[1,0] neg_lo:[0,1] neg_hi:[0,1]
    v_pk_add_f32 v[164:165], v[164:165], v[154:155] op_sel_hi:[1,0] neg_lo:[0,1] neg_hi:[0,1]
    v_pk_add_f32 v[166:167], v[166:167], v[154:155] op_sel_hi:[1,0] neg_lo:[0,1] neg_hi:[0,1]
    v_pk_add_f32 v[168:169], v[168:169], v[154:155] op_sel_hi:[1,0] neg_lo:[0,1] neg_hi:[0,1]
    v_pk_add_f32 v[170:171], v[170:171], v[154:155] op_sel_hi:[1,0] neg_lo:[0,1] neg_hi:[0,1]
    v_pk_add_f32 v[172:173], v[172:173], v[154:155] op_sel_hi:[1,0] neg_lo:[0,1] neg_hi:[0,1]
    v_pk_add_f32 v[174:175], v[174:175], v[154:155] op_sel_hi:[1,0] neg_lo:[0,1] neg_hi:[0,1]
    v_cvt_pk_bf16_f32 v8, v160, v161
    v_cvt_pk_bf16_f32 v9, v162, v163
    v_cvt_pk_bf16_f32 v10, v164, v165
    v_cvt_pk_bf16_f32 v11, v166, v167
    v_cvt_pk_bf16_f32 v12, v168, v169
    v_cvt_pk_bf16_f32 v13, v170, v171
    v_cvt_pk_bf16_f32 v14, v172, v173
    v_cvt_pk_bf16_f32 v15, v174, v175
    v_lshlrev_b32 v160, 16, v8
    v_and_b32 v161, 0xffff0000, v8
    v_lshlrev_b32 v162, 16, v9
    v_and_b32 v163, 0xffff0000, v9
    v_lshlrev_b32 v164, 16, v10
    v_and_b32 v165, 0xffff0000, v10
    v_lshlrev_b32 v166, 16, v11
    v_and_b32 v167, 0xffff0000, v11
    v_lshlrev_b32 v168, 16, v12
    v_and_b32 v169, 0xffff0000, v12
    v_lshlrev_b32 v170, 16, v13
    v_and_b32 v171, 0xffff0000, v13
    v_lshlrev_b32 v172, 16, v14
    v_and_b32 v173, 0xffff0000, v14
    v_lshlrev_b32 v174, 16, v15
    v_and_b32 v175, 0xffff0000, v15
    v_pk_mul_f32 v[160:161], v[160:161], v[152:153] op_sel_hi:[1,0]
    v_pk_mul_f32 v[162:163], v[162:163], v[152:153] op_sel_hi:[1,0]
    s_add_u32 s26, s24, 0x60000
    s_add_u32 m0, s29, 0x3000
    s_nop 0
    buffer_load_dwordx4 v136, s[16:19], s26 offen lds
    v_pk_mul_f32 v[164:165], v[164:165], v[152:153] op_sel_hi:[1,0]
    v_pk_mul_f32 v[166:167], v[166:167], v[152:153] op_sel_hi:[1,0]
    v_pk_mul_f32 v[168:169], v[168:169], v[152:153] op_sel_hi:[1,0]
    v_pk_mul_f32 v[170:171], v[170:171], v[152:153] op_sel_hi:[1,0]
    v_pk_mul_f32 v[172:173], v[172:173], v[152:153] op_sel_hi:[1,0]
    v_pk_mul_f32 v[174:175], v[174:175], v[152:153] op_sel_hi:[1,0]
    v_cvt_pk_bf16_f32 v160, v160, v161
    v_cvt_pk_bf16_f32 v162, v162, v163
    v_cvt_pk_bf16_f32 v164, v164, v165
    v_cvt_pk_bf16_f32 v166, v166, v167
    v_cvt_pk_bf16_f32 v168, v168, v169
    v_cvt_pk_bf16_f32 v170, v170, v171
    v_cvt_pk_bf16_f32 v172, v172, v173
    v_cvt_pk_bf16_f32 v174, v174, v175
    v_accvgpr_write_b32 a8, v160
    v_accvgpr_write_b32 a9, v162
    v_accvgpr_write_b32 a10, v164
    v_accvgpr_write_b32 a11, v166
    v_accvgpr_write_b32 a12, v168
    v_accvgpr_write_b32 a13, v170
    v_accvgpr_write_b32 a14, v172
    v_accvgpr_write_b32 a15, v174
    v_lshlrev_b32 v160, 16, v16
    v_and_b32 v161, 0xffff0000, v16
    v_lshlrev_b32 v162, 16, v17
    v_and_b32 v163, 0xffff0000, v17
    v_lshlrev_b32 v164, 16, v18
    v_and_b32 v165, 0xffff0000, v18
    v_lshlrev_b32 v166, 16, v19
    v_and_b32 v167, 0xffff0000, v19
    v_lshlrev_b32 v168, 16, v20
    v_and_b32 v169, 0xffff0000, v20
    v_lshlrev_b32 v170, 16, v21
    v_and_b32 v171, 0xffff0000, v21
    v_lshlrev_b32 v172, 16, v22
    v_and_b32 v173, 0xffff0000, v22
    v_lshlrev_b32 v174, 16, v23
    v_and_b32 v175, 0xffff0000, v23
    v_pk_add_f32 v[160:161], v[160:161], v[154:155] op_sel_hi:[1,0] neg_lo:[0,1] neg_hi:[0,1]
    v_pk_add_f32 v[162:163], v[162:163], v[154:155] op_sel_hi:[1,0] neg_lo:[0,1] neg_hi:[0,1]
    v_pk_add_f32 v[164:165], v[164:165], v[154:155] op_sel_hi:[1,0] neg_lo:[0,1] neg_hi:[0,1]
    v_pk_add_f32 v[166:167], v[166:167], v[154:155] op_sel_hi:[1,0] neg_lo:[0,1] neg_hi:[0,1]
    v_pk_add_f32 v[168:169], v[168:169], v[154:155] op_sel_hi:[1,0] neg_lo:[0,1] neg_hi:[0,1]
    v_pk_add_f32 v[170:171], v[170:171], v[154:155] op_sel_hi:[1,0] neg_lo:[0,1] neg_hi:[0,1]
    v_pk_add_f32 v[172:173], v[172:173], v[154:155] op_sel_hi:[1,0] neg_lo:[0,1] neg_hi:[0,1]
    v_pk_add_f32 v[174:175], v[174:175], v[154:155] op_sel_hi:[1,0] neg_lo:[0,1] neg_hi:[0,1]
    v_cvt_pk_bf16_f32 v16, v160, v161
    v_cvt_pk_bf16_f32 v17, v162, v163
    v_cvt_pk_bf16_f32 v18, v164, v165
    v_cvt_pk_bf16_f32 v19, v166, v167
    s_add_u32 s26, s24, 0x80000
    s_add_u32 m0, s29, 0x4000
    s_nop 0
    buffer_load_dwordx4 v136, s[16:19], s26 offen lds
    v_cvt_pk_bf16_f32 v20, v168, v169
    v_cvt_pk_bf16_f32 v21, v170, v171
    v_cvt_pk_bf16_f32 v22, v172, v173
    v_cvt_pk_bf16_f32 v23, v174, v175
    v_lshlrev_b32 v160, 16, v16
    v_and_b32 v161, 0xffff0000, v16
    v_lshlrev_b32 v162, 16, v17
    v_and_b32 v163, 0xffff0000, v17
    v_lshlrev_b32 v164, 16, v18
    v_and_b32 v165, 0xffff0000, v18
    v_lshlrev_b32 v166, 16, v19
    v_and_b32 v167, 0xffff0000, v19
    v_lshlrev_b32 v168, 16, v20
    v_and_b32 v169, 0xffff0000, v20
    v_lshlrev_b32 v170, 16, v21
    v_and_b32 v171, 0xffff0000, v21
    v_lshlrev_b32 v172, 16, v22
    v_and_b32 v173, 0xffff0000, v22
    v_lshlrev_b32 v174, 16, v23
    v_and_b32 v175, 0xffff0000, v23
    v_pk_mul_f32 v[160:161], v[160:161], v[152:153] op_sel_hi:[1,0]
    v_pk_mul_f32 v[162:163], v[162:163], v[152:153] op_sel_hi:[1,0]
    v_pk_mul_f32 v[164:165], v[164:165], v[152:153] op_sel_hi:[1,0]
    v_pk_mul_f32 v[166:167], v[166:167], v[152:153] op_sel_hi:[1,0]
    v_pk_mul_f32 v[168:169], v[168:169], v[152:153] op_sel_hi:[1,0]
    v_pk_mul_f32 v[170:171], v[170:171], v[152:153] op_sel_hi:[1,0]
    v_pk_mul_f32 v[172:173], v[172:173], v[152:153] op_sel_hi:[1,0]
    v_pk_mul_f32 v[174:175], v[174:175], v[152:153] op_sel_hi:[1,0]
    v_cvt_pk_bf16_f32 v160, v160, v161
    v_cvt_pk_bf16_f32 v162, v162, v163
    v_cvt_pk_bf16_f32 v164, v164, v165
    v_cvt_pk_bf16_f32 v166, v166, v167
    v_cvt_pk_bf16_f32 v168, v168, v169
    v_cvt_pk_bf16_f32 v170, v170, v171
    v_cvt_pk_bf16_f32 v172, v172, v173
    v_cvt_pk_bf16_f32 v174, v174, v175
    v_accvgpr_write_b32 a16, v160
    v_accvgpr_write_b32 a17, v162
    v_accvgpr_write_b32 a18, v164
    v_accvgpr_write_b32 a19, v166
    v_accvgpr_write_b32 a20, v168
    v_accvgpr_write_b32 a21, v170
    v_accvgpr_write_b32 a22, v172
    v_accvgpr_write_b32 a23, v174
    v_lshlrev_b32 v160, 16, v24
    v_and_b32 v161, 0xffff0000, v24
    v_lshlrev_b32 v162, 16, v25
    v_and_b32 v163, 0xffff0000, v25
    v_lshlrev_b32 v164, 16, v26
    v_and_b32 v165, 0xffff0000, v26
    s_add_u32 s26, s24, 0xa0000
    s_add_u32 m0, s29, 0x5000
    s_nop 0
    buffer_load_dwordx4 v136, s[16:19], s26 offen lds
    v_lshlrev_b32 v166, 16, v27
    v_and_b32 v167, 0xffff0000, v27
    v_lshlrev_b32 v168, 16, v28
    v_and_b32 v169, 0xffff0000, v28
    v_lshlrev_b32 v170, 16, v29
    v_and_b32 v171, 0xffff0000, v29
    v_lshlrev_b32 v172, 16, v30
    v_and_b32 v173, 0xffff0000, v30
    v_lshlrev_b32 v174, 16, v31
    v_and_b32 v175, 0xffff0000, v31
    v_pk_add_f32 v[160:161], v[160:161], v[154:155] op_sel_hi:[1,0] neg_lo:[0,1] neg_hi:[0,1]
    v_pk_add_f32 v[162:163], v[162:163], v[154:155] op_sel_hi:[1,0] neg_lo:[0,1] neg_hi:[0,1]
    v_pk_add_f32 v[164:165], v[164:165], v[154:155] op_sel_hi:[1,0] neg_lo:[0,1] neg_hi:[0,1]
    v_pk_add_f32 v[166:167], v[166:167], v[154:155] op_sel_hi:[1,0] neg_lo:[0,1] neg_hi:[0,1]
    v_pk_add_f32 v[168:169], v[168:169], v[154:155] op_sel_hi:[1,0] neg_lo:[0,1] neg_hi:[0,1]
    v_pk_add_f32 v[170:171], v[170:171], v[154:155] op_sel_hi:[1,0] neg_lo:[0,1] neg_hi:[0,1]
    v_pk_add_f32 v[172:173], v[172:173], v[154:155] op_sel_hi:[1,0] neg_lo:[0,1] neg_hi:[0,1]
    v_pk_add_f32 v[174:175], v[174:175], v[154:155] op_sel_hi:[1,0] neg_lo:[0,1] neg_hi:[0,1]
    v_cvt_pk_bf16_f32 v24, v160, v161
    v_cvt_pk_bf16_f32 v25, v162, v163
    v_cvt_pk_bf16_f32 v26, v164, v165
    v_cvt_pk_bf16_f32 v27, v166, v167
    v_cvt_pk_bf16_f32 v28, v168, v169
    v_cvt_pk_bf16_f32 v29, v170, v171
    v_cvt_pk_bf16_f32 v30, v172, v173
    v_cvt_pk_bf16_f32 v31, v174, v175
    v_lshlrev_b32 v160, 16, v24
    v_and_b32 v161, 0xffff0000, v24
    v_lshlrev_b32 v162, 16, v25
    v_and_b32 v163, 0xffff0000, v25
    v_lshlrev_b32 v164, 16, v26
    v_and_b32 v165, 0xffff0000, v26
    v_lshlrev_b32 v166, 16, v27
    v_and_b32 v167, 0xffff0000, v27
    v_lshlrev_b32 v168, 16, v28
    v_and_b32 v169, 0xffff0000, v28
    v_lshlrev_b32 v170, 16, v29
    v_and_b32 v171, 0xffff0000, v29
    v_lshlrev_b32 v172, 16, v30
    v_and_b32 v173, 0xffff0000, v30
    v_lshlrev_b32 v174, 16, v31
    v_and_b32 v175, 0xffff0000, v31
    v_pk_mul_f32 v[160:161], v[160:161], v[152:153] op_sel_hi:[1,0]
    v_pk_mul_f32 v[162:163], v[162:163], v[152:153] op_sel_hi:[1,0]
    v_pk_mul_f32 v[164:165], v[164:165], v[152:153] op_sel_hi:[1,0]
    v_pk_mul_f32 v[166:167], v[166:167], v[152:153] op_sel_hi:[1,0]
    v_pk_mul_f32 v[168:169], v[168:169], v[152:153] op_sel_hi:[1,0]
    v_pk_mul_f32 v[170:171], v[170:171], v[152:153] op_sel_hi:[1,0]
    v_pk_mul_f32 v[172:173], v[172:173], v[152:153] op_sel_hi:[1,0]
    v_pk_mul_f32 v[174:175], v[174:175], v[152:153] op_sel_hi:[1,0]
    s_add_u32 s26, s24, 0xc0000
    s_add_u32 m0, s29, 0x6000
    s_nop 0
    buffer_load_dwordx4 v136, s[16:19], s26 offen lds
    v_cvt_pk_bf16_f32 v160, v160, v161
    v_cvt_pk_bf16_f32 v162, v162, v163
    v_cvt_pk_bf16_f32 v164, v164, v165
    v_cvt_pk_bf16_f32 v166, v166, v167
    v_cvt_pk_bf16_f32 v168, v168, v169
    v_cvt_pk_bf16_f32 v170, v170, v171
    v_cvt_pk_bf16_f32 v172, v172, v173
    v_cvt_pk_bf16_f32 v174, v174, v175
    v_accvgpr_write_b32 a24, v160
    v_accvgpr_write_b32 a25, v162
    v_accvgpr_write_b32 a26, v164
    v_accvgpr_write_b32 a27, v166
    v_accvgpr_write_b32 a28, v168
    v_accvgpr_write_b32 a29, v170
    v_accvgpr_write_b32 a30, v172
    v_accvgpr_write_b32 a31, v174
    v_lshlrev_b32 v160, 16, v32
    v_and_b32 v161, 0xffff0000, v32
    v_lshlrev_b32 v162, 16, v33
    v_and_b32 v163, 0xffff0000, v33
    v_lshlrev_b32 v164, 16, v34
    v_and_b32 v165, 0xffff0000, v34
    v_lshlrev_b32 v166, 16, v35
    v_and_b32 v167, 0xffff0000, v35
    v_lshlrev_b32 v168, 16, v36
    v_and_b32 v169, 0xffff0000, v36
    v_lshlrev_b32 v170, 16, v37
    v_and_b32 v171, 0xffff0000, v37
    v_lshlrev_b32 v172, 16, v38
    v_and_b32 v173, 0xffff0000, v38
    v_lshlrev_b32 v174, 16, v39
    v_and_b32 v175, 0xffff0000, v39
    v_pk_add_f32 v[160:161], v[160:161], v[154:155] op_sel_hi:[1,0] neg_lo:[0,1] neg_hi:[0,1]
    v_pk_add_f32 v[162:163], v[162:163], v[154:155] op_sel_hi:[1,0] neg_lo:[0,1] neg_hi:[0,1]
    v_pk_add_f32 v[164:165], v[164:165], v[154:155] op_sel_hi:[1,0] neg_lo:[0,1] neg_hi:[0,1]
    v_pk_add_f32 v[166:167], v[166:167], v[154:155] op_sel_hi:[1,0] neg_lo:[0,1] neg_hi:[0,1]
    v_pk_add_f32 v[168:169], v[168:169], v[154:155] op_sel_hi:[1,0] neg_lo:[0,1] neg_hi:[0,1]
    v_pk_add_f32 v[170:171], v[170:171], v[154:155] op_sel_hi:[1,0] neg_lo:[0,1] neg_hi:[0,1]
    v_pk_add_f32 v[172:173], v[172:173], v[154:155] op_sel_hi:[1,0] neg_lo:[0,1] neg_hi:[0,1]
    v_pk_add_f32 v[174:175], v[174:175], v[154:155] op_sel_hi:[1,0] neg_lo:[0,1] neg_hi:[0,1]
    v_cvt_pk_bf16_f32 v32, v160, v161
    v_cvt_pk_bf16_f32 v33, v162, v163
    v_cvt_pk_bf16_f32 v34, v164, v165
    v_cvt_pk_bf16_f32 v35, v166, v167
    v_cvt_pk_bf16_f32 v36, v168, v169
    v_cvt_pk_bf16_f32 v37, v170, v171
    v_cvt_pk_bf16_f32 v38, v172, v173
    v_cvt_pk_bf16_f32 v39, v174, v175
    v_lshlrev_b32 v160, 16, v32
    v_and_b32 v161, 0xffff0000, v32
    s_add_u32 s26, s24, 0xe0000
    s_add_u32 m0, s29, 0x7000
    s_nop 0
    buffer_load_dwordx4 v136, s[16:19], s26 offen lds
    v_lshlrev_b32 v162, 16, v33
    v_and_b32 v163, 0xffff0000, v33
    v_lshlrev_b32 v164, 16, v34
    v_and_b32 v165, 0xffff0000, v34
    v_lshlrev_b32 v166, 16, v35
    v_and_b32 v167, 0xffff0000, v35
    v_lshlrev_b32 v168, 16, v36
    v_and_b32 v169, 0xffff0000, v36
    v_lshlrev_b32 v170, 16, v37
    v_and_b32 v171, 0xffff0000, v37
    v_lshlrev_b32 v172, 16, v38
    v_and_b32 v173, 0xffff0000, v38
    v_lshlrev_b32 v174, 16, v39
    v_and_b32 v175, 0xffff0000, v39
    v_pk_mul_f32 v[160:161], v[160:161], v[152:153] op_sel_hi:[1,0]
    v_pk_mul_f32 v[162:163], v[162:163], v[152:153] op_sel_hi:[1,0]
    v_pk_mul_f32 v[164:165], v[164:165], v[152:153] op_sel_hi:[1,0]
    v_pk_mul_f32 v[166:167], v[166:167], v[152:153] op_sel_hi:[1,0]
    v_pk_mul_f32 v[168:169], v[168:169], v[152:153] op_sel_hi:[1,0]
    v_pk_mul_f32 v[170:171], v[170:171], v[152:153] op_sel_hi:[1,0]
    v_pk_mul_f32 v[172:173], v[172:173], v[152:153] op_sel_hi:[1,0]
    v_pk_mul_f32 v[174:175], v[174:175], v[152:153] op_sel_hi:[1,0]
    v_cvt_pk_bf16_f32 v160, v160, v161
    v_cvt_pk_bf16_f32 v162, v162, v163
    v_cvt_pk_bf16_f32 v164, v164, v165
    v_cvt_pk_bf16_f32 v166, v166, v167
    v_cvt_pk_bf16_f32 v168, v168, v169
    v_cvt_pk_bf16_f32 v170, v170, v171
    v_cvt_pk_bf16_f32 v172, v172, v173
    v_cvt_pk_bf16_f32 v174, v174, v175
    v_accvgpr_write_b32 a32, v160
    v_accvgpr_write_b32 a33, v162
    v_accvgpr_write_b32 a34, v164
    v_accvgpr_write_b32 a35, v166
    v_accvgpr_write_b32 a36, v168
    v_accvgpr_write_b32 a37, v170
    v_accvgpr_write_b32 a38, v172
    v_accvgpr_write_b32 a39, v174
    v_lshlrev_b32 v160, 16, v40
    v_and_b32 v161, 0xffff0000, v40
    v_lshlrev_b32 v162, 16, v41
    v_and_b32 v163, 0xffff0000, v41
    v_lshlrev_b32 v164, 16, v42
    v_and_b32 v165, 0xffff0000, v42
    v_lshlrev_b32 v166, 16, v43
    v_and_b32 v167, 0xffff0000, v43
    v_lshlrev_b32 v168, 16, v44
    v_and_b32 v169, 0xffff0000, v44
    v_lshlrev_b32 v170, 16, v45
    v_and_b32 v171, 0xffff0000, v45
    s_add_u32 s26, s24, 0x100000
    s_add_u32 m0, s29, 0x8000
    s_nop 0
    buffer_load_dwordx4 v136, s[16:19], s26 offen lds
    v_lshlrev_b32 v172, 16, v46
    v_and_b32 v173, 0xffff0000, v46
    v_lshlrev_b32 v174, 16, v47
    v_and_b32 v175, 0xffff0000, v47
    v_pk_add_f32 v[160:161], v[160:161], v[154:155] op_sel_hi:[1,0] neg_lo:[0,1] neg_hi:[0,1]
    v_pk_add_f32 v[162:163], v[162:163], v[154:155] op_sel_hi:[1,0] neg_lo:[0,1] neg_hi:[0,1]
    v_pk_add_f32 v[164:165], v[164:165], v[154:155] op_sel_hi:[1,0] neg_lo:[0,1] neg_hi:[0,1]
    v_pk_add_f32 v[166:167], v[166:167], v[154:155] op_sel_hi:[1,0] neg_lo:[0,1] neg_hi:[0,1]
    v_pk_add_f32 v[168:169], v[168:169], v[154:155] op_sel_hi:[1,0] neg_lo:[0,1] neg_hi:[0,1]
    v_pk_add_f32 v[170:171], v[170:171], v[154:155] op_sel_hi:[1,0] neg_lo:[0,1] neg_hi:[0,1]
    v_pk_add_f32 v[172:173], v[172:173], v[154:155] op_sel_hi:[1,0] neg_lo:[0,1] neg_hi:[0,1]
    v_pk_add_f32 v[174:175], v[174:175], v[154:155] op_sel_hi:[1,0] neg_lo:[0,1] neg_hi:[0,1]
    v_cvt_pk_bf16_f32 v40, v160, v161
    v_cvt_pk_bf16_f32 v41, v162, v163
    v_cvt_pk_bf16_f32 v42, v164, v165
    v_cvt_pk_bf16_f32 v43, v166, v167
    v_cvt_pk_bf16_f32 v44, v168, v169
    v_cvt_pk_bf16_f32 v45, v170, v171
    v_cvt_pk_bf16_f32 v46, v172, v173
    v_cvt_pk_bf16_f32 v47, v174, v175
    v_lshlrev_b32 v160, 16, v40
    v_and_b32 v161, 0xffff0000, v40
    v_lshlrev_b32 v162, 16, v41
    v_and_b32 v163, 0xffff0000, v41
    v_lshlrev_b32 v164, 16, v42
    v_and_b32 v165, 0xffff0000, v42
    v_lshlrev_b32 v166, 16, v43
    v_and_b32 v167, 0xffff0000, v43
    v_lshlrev_b32 v168, 16, v44
    v_and_b32 v169, 0xffff0000, v44
    v_lshlrev_b32 v170, 16, v45
    v_and_b32 v171, 0xffff0000, v45
    v_lshlrev_b32 v172, 16, v46
    v_and_b32 v173, 0xffff0000, v46
    v_lshlrev_b32 v174, 16, v47
    v_and_b32 v175, 0xffff0000, v47
    v_pk_mul_f32 v[160:161], v[160:161], v[152:153] op_sel_hi:[1,0]
    v_pk_mul_f32 v[162:163], v[162:163], v[152:153] op_sel_hi:[1,0]
    v_pk_mul_f32 v[164:165], v[164:165], v[152:153] op_sel_hi:[1,0]
    v_pk_mul_f32 v[166:167], v[166:167], v[152:153] op_sel_hi:[1,0]
    v_pk_mul_f32 v[168:169], v[168:169], v[152:153] op_sel_hi:[1,0]
    v_pk_mul_f32 v[170:171], v[170:171], v[152:153] op_sel_hi:[1,0]
    v_pk_mul_f32 v[172:173], v[172:173], v[152:153] op_sel_hi:[1,0]
    v_pk_mul_f32 v[174:175], v[174:175], v[152:153] op_sel_hi:[1,0]
    v_cvt_pk_bf16_f32 v160, v160, v161
    v_cvt_pk_bf16_f32 v162, v162, v163
    v_cvt_pk_bf16_f32 v164, v164, v165
    v_cvt_pk_bf16_f32 v166, v166, v167
    v_cvt_pk_bf16_f32 v168, v168, v169
    v_cvt_pk_bf16_f32 v170, v170, v171
    s_add_u32 s26, s24, 0x120000
    s_add_u32 m0, s29, 0x9000
    s_nop 0
    buffer_load_dwordx4 v136, s[16:19], s26 offen lds
    v_cvt_pk_bf16_f32 v172, v172, v173
    v_cvt_pk_bf16_f32 v174, v174, v175
    v_accvgpr_write_b32 a40, v160
    v_accvgpr_write_b32 a41, v162
    v_accvgpr_write_b32 a42, v164
    v_accvgpr_write_b32 a43, v166
    v_accvgpr_write_b32 a44, v168
    v_accvgpr_write_b32 a45, v170
    v_accvgpr_write_b32 a46, v172
    v_accvgpr_write_b32 a47, v174
    v_lshlrev_b32 v160, 16, v48
    v_and_b32 v161, 0xffff0000, v48
    v_lshlrev_b32 v162, 16, v49
    v_and_b32 v163, 0xffff0000, v49
    v_lshlrev_b32 v164, 16, v50
    v_and_b32 v165, 0xffff0000, v50
    v_lshlrev_b32 v166, 16, v51
    v_and_b32 v167, 0xffff0000, v51
    v_lshlrev_b32 v168, 16, v52
    v_and_b32 v169, 0xffff0000, v52
    v_lshlrev_b32 v170, 16, v53
    v_and_b32 v171, 0xffff0000, v53
    v_lshlrev_b32 v172, 16, v54
    v_and_b32 v173, 0xffff0000, v54
    v_lshlrev_b32 v174, 16, v55
    v_and_b32 v175, 0xffff0000, v55
    v_pk_add_f32 v[160:161], v[160:161], v[154:155] op_sel_hi:[1,0] neg_lo:[0,1] neg_hi:[0,1]
    v_pk_add_f32 v[162:163], v[162:163], v[154:155] op_sel_hi:[1,0] neg_lo:[0,1] neg_hi:[0,1]
    v_pk_add_f32 v[164:165], v[164:165], v[154:155] op_sel_hi:[1,0] neg_lo:[0,1] neg_hi:[0,1]
    v_pk_add_f32 v[166:167], v[166:167], v[154:155] op_sel_hi:[1,0] neg_lo:[0,1] neg_hi:[0,1]
    v_pk_add_f32 v[168:169], v[168:169], v[154:155] op_sel_hi:[1,0] neg_lo:[0,1] neg_hi:[0,1]
    v_pk_add_f32 v[170:171], v[170:171], v[154:155] op_sel_hi:[1,0] neg_lo:[0,1] neg_hi:[0,1]
    v_pk_add_f32 v[172:173], v[172:173], v[154:155] op_sel_hi:[1,0] neg_lo:[0,1] neg_hi:[0,1]
    v_pk_add_f32 v[174:175], v[174:175], v[154:155] op_sel_hi:[1,0] neg_lo:[0,1] neg_hi:[0,1]
    v_cvt_pk_bf16_f32 v48, v160, v161
    v_cvt_pk_bf16_f32 v49, v162, v163
    v_cvt_pk_bf16_f32 v50, v164, v165
    v_cvt_pk_bf16_f32 v51, v166, v167
    v_cvt_pk_bf16_f32 v52, v168, v169
    v_cvt_pk_bf16_f32 v53, v170, v171
    v_cvt_pk_bf16_f32 v54, v172, v173
    v_cvt_pk_bf16_f32 v55, v174, v175
    v_lshlrev_b32 v160, 16, v48
    v_and_b32 v161, 0xffff0000, v48
    v_lshlrev_b32 v162, 16, v49
    v_and_b32 v163, 0xffff0000, v49
    v_lshlrev_b32 v164, 16, v50
    v_and_b32 v165, 0xffff0000, v50
    v_lshlrev_b32 v166, 16, v51
    v_and_b32 v167, 0xffff0000, v51
    s_add_u32 s26, s24, 0x140000
    s_add_u32 m0, s29, 0xa000
    s_nop 0
    buffer_load_dwordx4 v136, s[16:19], s26 offen lds
    v_lshlrev_b32 v168, 16, v52
    v_and_b32 v169, 0xffff0000, v52
    v_lshlrev_b32 v170, 16, v53
    v_and_b32 v171, 0xffff0000, v53
    v_lshlrev_b32 v172, 16, v54
    v_and_b32 v173, 0xffff0000, v54
    v_lshlrev_b32 v174, 16, v55
    v_and_b32 v175, 0xffff0000, v55
    v_pk_mul_f32 v[160:161], v[160:161], v[152:153] op_sel_hi:[1,0]
    v_pk_mul_f32 v[162:163], v[162:163], v[152:153] op_sel_hi:[1,0]
    v_pk_mul_f32 v[164:165], v[164:165], v[152:153] op_sel_hi:[1,0]
    v_pk_mul_f32 v[166:167], v[166:167], v[152:153] op_sel_hi:[1,0]
    v_pk_mul_f32 v[168:169], v[168:169], v[152:153] op_sel_hi:[1,0]
    v_pk_mul_f32 v[170:171], v[170:171], v[152:153] op_sel_hi:[1,0]
    v_pk_mul_f32 v[172:173], v[172:173], v[152:153] op_sel_hi:[1,0]
    v_pk_mul_f32 v[174:175], v[174:175], v[152:153] op_sel_hi:[1,0]
    v_cvt_pk_bf16_f32 v160, v160, v161
    v_cvt_pk_bf16_f32 v162, v162, v163
    v_cvt_pk_bf16_f32 v164, v164, v165
    v_cvt_pk_bf16_f32 v166, v166, v167
    v_cvt_pk_bf16_f32 v168, v168, v169
    v_cvt_pk_bf16_f32 v170, v170, v171
    v_cvt_pk_bf16_f32 v172, v172, v173
    v_cvt_pk_bf16_f32 v174, v174, v175
    v_accvgpr_write_b32 a48, v160
    v_accvgpr_write_b32 a49, v162
    v_accvgpr_write_b32 a50, v164
    v_accvgpr_write_b32 a51, v166
    v_accvgpr_write_b32 a52, v168
    v_accvgpr_write_b32 a53, v170
    v_accvgpr_write_b32 a54, v172
    v_accvgpr_write_b32 a55, v174
    v_lshlrev_b32 v160, 16, v56
    v_and_b32 v161, 0xffff0000, v56
    v_lshlrev_b32 v162, 16, v57
    v_and_b32 v163, 0xffff0000, v57
    v_lshlrev_b32 v164, 16, v58
    v_and_b32 v165, 0xffff0000, v58
    v_lshlrev_b32 v166, 16, v59
    v_and_b32 v167, 0xffff0000, v59
    v_lshlrev_b32 v168, 16, v60
    v_and_b32 v169, 0xffff0000, v60
    v_lshlrev_b32 v170, 16, v61
    v_and_b32 v171, 0xffff0000, v61
    v_lshlrev_b32 v172, 16, v62
    v_and_b32 v173, 0xffff0000, v62
    v_lshlrev_b32 v174, 16, v63
    v_and_b32 v175, 0xffff0000, v63
    v_pk_add_f32 v[160:161], v[160:161], v[154:155] op_sel_hi:[1,0] neg_lo:[0,1] neg_hi:[0,1]
    v_pk_add_f32 v[162:163], v[162:163], v[154:155] op_sel_hi:[1,0] neg_lo:[0,1] neg_hi:[0,1]
    s_add_u32 s26, s24, 0x160000
    s_add_u32 m0, s29, 0xb000
    s_nop 0
    buffer_load_dwordx4 v136, s[16:19], s26 offen lds
    v_pk_add_f32 v[164:165], v[164:165], v[154:155] op_sel_hi:[1,0] neg_lo:[0,1] neg_hi:[0,1]
    v_pk_add_f32 v[166:167], v[166:167], v[154:155] op_sel_hi:[1,0] neg_lo:[0,1] neg_hi:[0,1]
    v_pk_add_f32 v[168:169], v[168:169], v[154:155] op_sel_hi:[1,0] neg_lo:[0,1] neg_hi:[0,1]
    v_pk_add_f32 v[170:171], v[170:171], v[154:155] op_sel_hi:[1,0] neg_lo:[0,1] neg_hi:[0,1]
    v_pk_add_f32 v[172:173], v[172:173], v[154:155] op_sel_hi:[1,0] neg_lo:[0,1] neg_hi:[0,1]
    v_pk_add_f32 v[174:175], v[174:175], v[154:155] op_sel_hi:[1,0] neg_lo:[0,1] neg_hi:[0,1]
    v_cvt_pk_bf16_f32 v56, v160, v161
    v_cvt_pk_bf16_f32 v57, v162, v163
    v_cvt_pk_bf16_f32 v58, v164, v165
    v_cvt_pk_bf16_f32 v59, v166, v167
    v_cvt_pk_bf16_f32 v60, v168, v169
    v_cvt_pk_bf16_f32 v61, v170, v171
    v_cvt_pk_bf16_f32 v62, v172, v173
    v_cvt_pk_bf16_f32 v63, v174, v175
    v_lshlrev_b32 v160, 16, v56
    v_and_b32 v161, 0xffff0000, v56
    v_lshlrev_b32 v162, 16, v57
    v_and_b32 v163, 0xffff0000, v57
    v_lshlrev_b32 v164, 16, v58
    v_and_b32 v165, 0xffff0000, v58
    v_lshlrev_b32 v166, 16, v59
    v_and_b32 v167, 0xffff0000, v59
    v_lshlrev_b32 v168, 16, v60
    v_and_b32 v169, 0xffff0000, v60
    v_lshlrev_b32 v170, 16, v61
    v_and_b32 v171, 0xffff0000, v61
    v_lshlrev_b32 v172, 16, v62
    v_and_b32 v173, 0xffff0000, v62
    v_lshlrev_b32 v174, 16, v63
    v_and_b32 v175, 0xffff0000, v63
    v_pk_mul_f32 v[160:161], v[160:161], v[152:153] op_sel_hi:[1,0]
    v_pk_mul_f32 v[162:163], v[162:163], v[152:153] op_sel_hi:[1,0]
    v_pk_mul_f32 v[164:165], v[164:165], v[152:153] op_sel_hi:[1,0]
    v_pk_mul_f32 v[166:167], v[166:167], v[152:153] op_sel_hi:[1,0]
    v_pk_mul_f32 v[168:169], v[168:169], v[152:153] op_sel_hi:[1,0]
    v_pk_mul_f32 v[170:171], v[170:171], v[152:153] op_sel_hi:[1,0]
    v_pk_mul_f32 v[172:173], v[172:173], v[152:153] op_sel_hi:[1,0]
    v_pk_mul_f32 v[174:175], v[174:175], v[152:153] op_sel_hi:[1,0]
    v_cvt_pk_bf16_f32 v160, v160, v161
    v_cvt_pk_bf16_f32 v162, v162, v163
    v_cvt_pk_bf16_f32 v164, v164, v165
    v_cvt_pk_bf16_f32 v166, v166, v167
    v_cvt_pk_bf16_f32 v168, v168, v169
    v_cvt_pk_bf16_f32 v170, v170, v171
    v_cvt_pk_bf16_f32 v172, v172, v173
    v_cvt_pk_bf16_f32 v174, v174, v175
    v_accvgpr_write_b32 a56, v160
    v_accvgpr_write_b32 a57, v162
    v_accvgpr_write_b32 a58, v164
    v_accvgpr_write_b32 a59, v166
    s_add_u32 s26, s24, 0x180000
    s_add_u32 m0, s29, 0xc000
    s_nop 0
    buffer_load_dwordx4 v136, s[16:19], s26 offen lds
    v_accvgpr_write_b32 a60, v168
    v_accvgpr_write_b32 a61, v170
    v_accvgpr_write_b32 a62, v172
    v_accvgpr_write_b32 a63, v174
    s_waitcnt vmcnt(13)
    v_pk_mov_b32 v[150:151], 0, 0
    v_pk_mov_b32 v[152:153], 0, 0
    v_dot2_f32_bf16 v150, v64, v158, v150
    v_dot2_f32_bf16 v152, v64, v64, v152
    v_dot2_f32_bf16 v151, v65, v158, v151
    v_dot2_f32_bf16 v153, v65, v65, v153
    v_dot2_f32_bf16 v150, v66, v158, v150
    v_dot2_f32_bf16 v152, v66, v66, v152
    v_dot2_f32_bf16 v151, v67, v158, v151
    v_dot2_f32_bf16 v153, v67, v67, v153
    v_dot2_f32_bf16 v150, v68, v158, v150
    v_dot2_f32_bf16 v152, v68, v68, v152
    v_dot2_f32_bf16 v151, v69, v158, v151
    v_dot2_f32_bf16 v153, v69, v69, v153
    v_dot2_f32_bf16 v150, v70, v158, v150
    v_dot2_f32_bf16 v152, v70, v70, v152
    v_dot2_f32_bf16 v151, v71, v158, v151
    v_dot2_f32_bf16 v153, v71, v71, v153
    v_dot2_f32_bf16 v150, v72, v158, v150
    v_dot2_f32_bf16 v152, v72, v72, v152
    v_dot2_f32_bf16 v151, v73, v158, v151
    v_dot2_f32_bf16 v153, v73, v73, v153
    v_dot2_f32_bf16 v150, v74, v158, v150
    v_dot2_f32_bf16 v152, v74, v74, v152
    v_dot2_f32_bf16 v151, v75, v158, v151
    v_dot2_f32_bf16 v153, v75, v75, v153
    v_dot2_f32_bf16 v150, v76, v158, v150
    v_dot2_f32_bf16 v152, v76, v76, v152
    v_dot2_f32_bf16 v151, v77, v158, v151
    v_dot2_f32_bf16 v153, v77, v77, v153
    v_dot2_f32_bf16 v150, v78, v158, v150
    v_dot2_f32_bf16 v152, v78, v78, v152
    v_dot2_f32_bf16 v151, v79, v158, v151
    v_dot2_f32_bf16 v153, v79, v79, v153
    v_dot2_f32_bf16 v150, v80, v158, v150
    v_dot2_f32_bf16 v152, v80, v80, v152
    v_dot2_f32_bf16 v151, v81, v158, v151
    v_dot2_f32_bf16 v153, v81, v81, v153
    v_dot2_f32_bf16 v150, v82, v158, v150
    v_dot2_f32_bf16 v152, v82, v82, v152
    v_dot2_f32_bf16 v151, v83, v158, v151
    v_dot2_f32_bf16 v153, v83, v83, v153
    v_dot2_f32_bf16 v150, v84, v158, v150
    v_dot2_f32_bf16 v152, v84, v84, v152
    v_dot2_f32_bf16 v151, v85, v158, v151
    v_dot2_f32_bf16 v153, v85, v85, v153
    v_dot2_f32_bf16 v150, v86, v158, v150
    v_dot2_f32_bf16 v152, v86, v86, v152
    s_add_u32 s26, s24, 0x1a0000
    s_add_u32 m0, s29, 0xd000
    s_nop 0
    buffer_load_dwordx4 v136, s[16:19], s26 offen lds
    v_dot2_f32_bf16 v151, v87, v158, v151
    v_dot2_f32_bf16 v153, v87, v87, v153
    v_dot2_f32_bf16 v150, v88, v158, v150
    v_dot2_f32_bf16 v152, v88, v88, v152
    v_dot2_f32_bf16 v151, v89, v158, v151
    v_dot2_f32_bf16 v153, v89, v89, v153
    v_dot2_f32_bf16 v150, v90, v158, v150
    v_dot2_f32_bf16 v152, v90, v90, v152
    v_dot2_f32_bf16 v151, v91, v158, v151
    v_dot2_f32_bf16 v153, v91, v91, v153
    v_dot2_f32_bf16 v150, v92, v158, v150
    v_dot2_f32_bf16 v152, v92, v92, v152
    v_dot2_f32_bf16 v151, v93, v158, v151
    v_dot2_f32_bf16 v153, v93, v93, v153
    v_dot2_f32_bf16 v150, v94, v158, v150
    v_dot2_f32_bf16 v152, v94, v94, v152
    v_dot2_f32_bf16 v151, v95, v158, v151
    v_dot2_f32_bf16 v153, v95, v95, v153
    v_dot2_f32_bf16 v150, v96, v158, v150
    v_dot2_f32_bf16 v152, v96, v96, v152
    v_dot2_f32_bf16 v151, v97, v158, v151
    v_dot2_f32_bf16 v153, v97, v97, v153
    v_dot2_f32_bf16 v150, v98, v158, v150
    v_dot2_f32_bf16 v152, v98, v98, v152
    v_dot2_f32_bf16 v151, v99, v158, v151
    v_dot2_f32_bf16 v153, v99, v99, v153
    v_dot2_f32_bf16 v150, v100, v158, v150
    v_dot2_f32_bf16 v152, v100, v100, v152
    v_dot2_f32_bf16 v151, v101, v158, v151
    v_dot2_f32_bf16 v153, v101, v101, v153
    v_dot2_f32_bf16 v150, v102, v158, v150
    v_dot2_f32_bf16 v152, v102, v102, v152
    v_dot2_f32_bf16 v151, v103, v158, v151
    v_dot2_f32_bf16 v153, v103, v103, v153
    v_dot2_f32_bf16 v150, v104, v158, v150
    v_dot2_f32_bf16 v152, v104, v104, v152
    v_dot2_f32_bf16 v151, v105, v158, v151
    v_dot2_f32_bf16 v153, v105, v105, v153
    v_dot2_f32_bf16 v150, v106, v158, v150
    v_dot2_f32_bf16 v152, v106, v106, v152
    v_dot2_f32_bf16 v151, v107, v158, v151
    v_dot2_f32_bf16 v153, v107, v107, v153
    v_dot2_f32_bf16 v150, v108, v158, v150
    v_dot2_f32_bf16 v152, v108, v108, v152
    v_dot2_f32_bf16 v151, v109, v158, v151
    v_dot2_f32_bf16 v153, v109, v109, v153
    v_dot2_f32_bf16 v150, v110, v158, v150
    v_dot2_f32_bf16 v152, v110, v110, v152
    v_dot2_f32_bf16 v151, v111, v158, v151
    v_dot2_f32_bf16 v153, v111, v111, v153
    s_add_u32 s26, s24, 0x1c0000
    s_add_u32 m0, s29, 0xe000
    s_nop 0
    buffer_load_dwordx4 v136, s[16:19], s26 offen lds
    v_dot2_f32_bf16 v150, v112, v158, v150
    v_dot2_f32_bf16 v152, v112, v112, v152
    v_dot2_f32_bf16 v151, v113, v158, v151
    v_dot2_f32_bf16 v153, v113, v113, v153
    v_dot2_f32_bf16 v150, v114, v158, v150
    v_dot2_f32_bf16 v152, v114, v114, v152
    v_dot2_f32_bf16 v151, v115, v158, v151
    v_dot2_f32_bf16 v153, v115, v115, v153
    v_dot2_f32_bf16 v150, v116, v158, v150
    v_dot2_f32_bf16 v152, v116, v116, v152
    v_dot2_f32_bf16 v151, v117, v158, v151
    v_dot2_f32_bf16 v153, v117, v117, v153
    v_dot2_f32_bf16 v150, v118, v158, v150
    v_dot2_f32_bf16 v152, v118, v118, v152
    v_dot2_f32_bf16 v151, v119, v158, v151
    v_dot2_f32_bf16 v153, v119, v119, v153
    v_dot2_f32_bf16 v150, v120, v158, v150
    v_dot2_f32_bf16 v152, v120, v120, v152
    v_dot2_f32_bf16 v151, v121, v158, v151
    v_dot2_f32_bf16 v153, v121, v121, v153
    v_dot2_f32_bf16 v150, v122, v158, v150
    v_dot2_f32_bf16 v152, v122, v122, v152
    v_dot2_f32_bf16 v151, v123, v158, v151
    v_dot2_f32_bf16 v153, v123, v123, v153
    v_dot2_f32_bf16 v150, v124, v158, v150
    v_dot2_f32_bf16 v152, v124, v124, v152
    v_dot2_f32_bf16 v151, v125, v158, v151
    v_dot2_f32_bf16 v153, v125, v125, v153
    v_dot2_f32_bf16 v150, v126, v158, v150
    v_dot2_f32_bf16 v152, v126, v126, v152
    v_dot2_f32_bf16 v151, v127, v158, v151
    v_dot2_f32_bf16 v153, v127, v127, v153
    s_nop 1
    v_add_f32 v150, v150, v151
    v_add_f32 v152, v152, v153
    v_mov_b32 v157, v150
    s_nop 1
    v_permlane32_swap_b32 v157, v150
    v_add_f32 v150, v157, v150
    v_mov_b32 v157, v150
    s_nop 1
    v_permlane16_swap_b32 v157, v150
    v_add_f32 v150, v157, v150
    v_mov_b32 v157, v152
    s_nop 1
    v_permlane32_swap_b32 v157, v152
    v_add_f32 v152, v157, v152
    v_mov_b32 v157, v152
    s_nop 1
    v_permlane16_swap_b32 v157, v152
    v_add_f32 v152, v157, v152
    v_mul_f32 v150, 0x3b000000, v150
    v_cvt_pk_bf16_f32 v154, v150, v150
    v_and_b32 v154, 0xffff0000, v154
    v_sub_f32 v156, v150, v154
    v_mul_f32 v157, v150, v150
    v_mul_f32 v152, 0x3b000000, v152
    v_sub_f32 v152, v152, v157
    v_max_f32 v152, 0, v152
    v_cvt_pk_bf16_f32 v152, v152, v152
    v_and_b32 v152, 0xffff0000, v152
    v_add_f32 v152, 0x3727c5ac, v152
    v_cvt_pk_bf16_f32 v152, v152, v152
    v_and_b32 v152, 0xffff0000, v152
    v_sqrt_f32 v152, v152
    s_nop 0
    v_cvt_pk_bf16_f32 v152, v152, v152
    v_and_b32 v152, 0xffff0000, v152
    v_rcp_f32 v152, v152
    v_lshlrev_b32 v160, 16, v64
    v_and_b32 v161, 0xffff0000, v64
    v_lshlrev_b32 v162, 16, v65
    v_and_b32 v163, 0xffff0000, v65
    v_lshlrev_b32 v164, 16, v66
    v_and_b32 v165, 0xffff0000, v66
    v_lshlrev_b32 v166, 16, v67
    v_and_b32 v167, 0xffff0000, v67
    v_lshlrev_b32 v168, 16, v68
    v_and_b32 v169, 0xffff0000, v68
    v_lshlrev_b32 v170, 16, v69
    v_and_b32 v171, 0xffff0000, v69
    v_lshlrev_b32 v172, 16, v70
    v_and_b32 v173, 0xffff0000, v70
    v_lshlrev_b32 v174, 16, v71
    v_and_b32 v175, 0xffff0000, v71
    v_pk_add_f32 v[160:161], v[160:161], v[154:155] op_sel_hi:[1,0] neg_lo:[0,1] neg_hi:[0,1]
    v_pk_add_f32 v[162:163], v[162:163], v[154:155] op_sel_hi:[1,0] neg_lo:[0,1] neg_hi:[0,1]
    s_add_u32 s26, s24, 0x1e0000
    s_add_u32 m0, s29, 0xf000
    s_nop 0
    buffer_load_dwordx4 v136, s[16:19], s26 offen lds
    v_pk_add_f32 v[164:165], v[164:165], v[154:155] op_sel_hi:[1,0] neg_lo:[0,1] neg_hi:[0,1]
    v_pk_add_f32 v[166:167], v[166:167], v[154:155] op_sel_hi:[1,0] neg_lo:[0,1] neg_hi:[0,1]
    v_pk_add_f32 v[168:169], v[168:169], v[154:155] op_sel_hi:[1,0] neg_lo:[0,1] neg_hi:[0,1]
    v_pk_add_f32 v[170:171], v[170:171], v[154:155] op_sel_hi:[1,0] neg_lo:[0,1] neg_hi:[0,1]
    v_pk_add_f32 v[172:173], v[172:173], v[154:155] op_sel_hi:[1,0] neg_lo:[0,1] neg_hi:[0,1]
    v_pk_add_f32 v[174:175], v[174:175], v[154:155] op_sel_hi:[1,0] neg_lo:[0,1] neg_hi:[0,1]
    v_cvt_pk_bf16_f32 v64, v160, v161
    v_cvt_pk_bf16_f32 v65, v162, v163
    v_cvt_pk_bf16_f32 v66, v164, v165
    v_cvt_pk_bf16_f32 v67, v166, v167
    v_cvt_pk_bf16_f32 v68, v168, v169
    v_cvt_pk_bf16_f32 v69, v170, v171
    v_cvt_pk_bf16_f32 v70, v172, v173
    v_cvt_pk_bf16_f32 v71, v174, v175
    v_lshlrev_b32 v160, 16, v64
    v_and_b32 v161, 0xffff0000, v64
    v_lshlrev_b32 v162, 16, v65
    v_and_b32 v163, 0xffff0000, v65
    v_lshlrev_b32 v164, 16, v66
    v_and_b32 v165, 0xffff0000, v66
    v_lshlrev_b32 v166, 16, v67
    v_and_b32 v167, 0xffff0000, v67
    v_lshlrev_b32 v168, 16, v68
    v_and_b32 v169, 0xffff0000, v68
    v_lshlrev_b32 v170, 16, v69
    v_and_b32 v171, 0xffff0000, v69
    v_lshlrev_b32 v172, 16, v70
    v_and_b32 v173, 0xffff0000, v70
    v_lshlrev_b32 v174, 16, v71
    v_and_b32 v175, 0xffff0000, v71
    v_pk_mul_f32 v[160:161], v[160:161], v[152:153] op_sel_hi:[1,0]
    v_pk_mul_f32 v[162:163], v[162:163], v[152:153] op_sel_hi:[1,0]
    v_pk_mul_f32 v[164:165], v[164:165], v[152:153] op_sel_hi:[1,0]
    v_pk_mul_f32 v[166:167], v[166:167], v[152:153] op_sel_hi:[1,0]
    v_pk_mul_f32 v[168:169], v[168:169], v[152:153] op_sel_hi:[1,0]
    v_pk_mul_f32 v[170:171], v[170:171], v[152:153] op_sel_hi:[1,0]
    v_pk_mul_f32 v[172:173], v[172:173], v[152:153] op_sel_hi:[1,0]
    v_pk_mul_f32 v[174:175], v[174:175], v[152:153] op_sel_hi:[1,0]
    v_cvt_pk_bf16_f32 v160, v160, v161
    v_cvt_pk_bf16_f32 v162, v162, v163
    v_cvt_pk_bf16_f32 v164, v164, v165
    v_cvt_pk_bf16_f32 v166, v166, v167
    v_cvt_pk_bf16_f32 v168, v168, v169
    v_cvt_pk_bf16_f32 v170, v170, v171
    v_cvt_pk_bf16_f32 v172, v172, v173
    v_cvt_pk_bf16_f32 v174, v174, v175
    v_accvgpr_write_b32 a64, v160
    v_accvgpr_write_b32 a65, v162
    v_accvgpr_write_b32 a66, v164
    v_accvgpr_write_b32 a67, v166
    s_add_u32 s26, s24, 0x200000
    s_add_u32 m0, s29, 0x10000
    s_nop 0
    buffer_load_dwordx4 v136, s[16:19], s26 offen lds
    v_accvgpr_write_b32 a68, v168
    v_accvgpr_write_b32 a69, v170
    v_accvgpr_write_b32 a70, v172
    v_accvgpr_write_b32 a71, v174
    v_lshlrev_b32 v160, 16, v72
    v_and_b32 v161, 0xffff0000, v72
    v_lshlrev_b32 v162, 16, v73
    v_and_b32 v163, 0xffff0000, v73
    v_lshlrev_b32 v164, 16, v74
    v_and_b32 v165, 0xffff0000, v74
    v_lshlrev_b32 v166, 16, v75
    v_and_b32 v167, 0xffff0000, v75
    v_lshlrev_b32 v168, 16, v76
    v_and_b32 v169, 0xffff0000, v76
    v_lshlrev_b32 v170, 16, v77
    v_and_b32 v171, 0xffff0000, v77
    v_lshlrev_b32 v172, 16, v78
    v_and_b32 v173, 0xffff0000, v78
    v_lshlrev_b32 v174, 16, v79
    v_and_b32 v175, 0xffff0000, v79
    v_pk_add_f32 v[160:161], v[160:161], v[154:155] op_sel_hi:[1,0] neg_lo:[0,1] neg_hi:[0,1]
    v_pk_add_f32 v[162:163], v[162:163], v[154:155] op_sel_hi:[1,0] neg_lo:[0,1] neg_hi:[0,1]
    v_pk_add_f32 v[164:165], v[164:165], v[154:155] op_sel_hi:[1,0] neg_lo:[0,1] neg_hi:[0,1]
    v_pk_add_f32 v[166:167], v[166:167], v[154:155] op_sel_hi:[1,0] neg_lo:[0,1] neg_hi:[0,1]
    v_pk_add_f32 v[168:169], v[168:169], v[154:155] op_sel_hi:[1,0] neg_lo:[0,1] neg_hi:[0,1]
    v_pk_add_f32 v[170:171], v[170:171], v[154:155] op_sel_hi:[1,0] neg_lo:[0,1] neg_hi:[0,1]
    v_pk_add_f32 v[172:173], v[172:173], v[154:155] op_sel_hi:[1,0] neg_lo:[0,1] neg_hi:[0,1]
    v_pk_add_f32 v[174:175], v[174:175], v[154:155] op_sel_hi:[1,0] neg_lo:[0,1] neg_hi:[0,1]
    v_cvt_pk_bf16_f32 v72, v160, v161
    v_cvt_pk_bf16_f32 v73, v162, v163
    v_cvt_pk_bf16_f32 v74, v164, v165
    v_cvt_pk_bf16_f32 v75, v166, v167
    v_cvt_pk_bf16_f32 v76, v168, v169
    v_cvt_pk_bf16_f32 v77, v170, v171
    v_cvt_pk_bf16_f32 v78, v172, v173
    v_cvt_pk_bf16_f32 v79, v174, v175
    v_lshlrev_b32 v160, 16, v72
    v_and_b32 v161, 0xffff0000, v72
    v_lshlrev_b32 v162, 16, v73
    v_and_b32 v163, 0xffff0000, v73
    v_lshlrev_b32 v164, 16, v74
    v_and_b32 v165, 0xffff0000, v74
    v_lshlrev_b32 v166, 16, v75
    v_and_b32 v167, 0xffff0000, v75
    v_lshlrev_b32 v168, 16, v76
    v_and_b32 v169, 0xffff0000, v76
    v_lshlrev_b32 v170, 16, v77
    v_and_b32 v171, 0xffff0000, v77
    v_lshlrev_b32 v172, 16, v78
    v_and_b32 v173, 0xffff0000, v78
    s_add_u32 s26, s24, 0x220000
    s_add_u32 m0, s29, 0x11000
    s_nop 0
    buffer_load_dwordx4 v136, s[16:19], s26 offen lds
    v_lshlrev_b32 v174, 16, v79
    v_and_b32 v175, 0xffff0000, v79
    v_pk_mul_f32 v[160:161], v[160:161], v[152:153] op_sel_hi:[1,0]
    v_pk_mul_f32 v[162:163], v[162:163], v[152:153] op_sel_hi:[1,0]
    v_pk_mul_f32 v[164:165], v[164:165], v[152:153] op_sel_hi:[1,0]
    v_pk_mul_f32 v[166:167], v[166:167], v[152:153] op_sel_hi:[1,0]
    v_pk_mul_f32 v[168:169], v[168:169], v[152:153] op_sel_hi:[1,0]
    v_pk_mul_f32 v[170:171], v[170:171], v[152:153] op_sel_hi:[1,0]
    v_pk_mul_f32 v[172:173], v[172:173], v[152:153] op_sel_hi:[1,0]
    v_pk_mul_f32 v[174:175], v[174:175], v[152:153] op_sel_hi:[1,0]
    v_cvt_pk_bf16_f32 v160, v160, v161
    v_cvt_pk_bf16_f32 v162, v162, v163
    v_cvt_pk_bf16_f32 v164, v164, v165
    v_cvt_pk_bf16_f32 v166, v166, v167
    v_cvt_pk_bf16_f32 v168, v168, v169
    v_cvt_pk_bf16_f32 v170, v170, v171
    v_cvt_pk_bf16_f32 v172, v172, v173
    v_cvt_pk_bf16_f32 v174, v174, v175
    v_accvgpr_write_b32 a72, v160
    v_accvgpr_write_b32 a73, v162
    v_accvgpr_write_b32 a74, v164
    v_accvgpr_write_b32 a75, v166
    v_accvgpr_write_b32 a76, v168
    v_accvgpr_write_b32 a77, v170
    v_accvgpr_write_b32 a78, v172
    v_accvgpr_write_b32 a79, v174
    v_lshlrev_b32 v160, 16, v80
    v_and_b32 v161, 0xffff0000, v80
    v_lshlrev_b32 v162, 16, v81
    v_and_b32 v163, 0xffff0000, v81
    v_lshlrev_b32 v164, 16, v82
    v_and_b32 v165, 0xffff0000, v82
    v_lshlrev_b32 v166, 16, v83
    v_and_b32 v167, 0xffff0000, v83
    v_lshlrev_b32 v168, 16, v84
    v_and_b32 v169, 0xffff0000, v84
    v_lshlrev_b32 v170, 16, v85
    v_and_b32 v171, 0xffff0000, v85
    v_lshlrev_b32 v172, 16, v86
    v_and_b32 v173, 0xffff0000, v86
    v_lshlrev_b32 v174, 16, v87
    v_and_b32 v175, 0xffff0000, v87
    v_pk_add_f32 v[160:161], v[160:161], v[154:155] op_sel_hi:[1,0] neg_lo:[0,1] neg_hi:[0,1]
    v_pk_add_f32 v[162:163], v[162:163], v[154:155] op_sel_hi:[1,0] neg_lo:[0,1] neg_hi:[0,1]
    v_pk_add_f32 v[164:165], v[164:165], v[154:155] op_sel_hi:[1,0] neg_lo:[0,1] neg_hi:[0,1]
    v_pk_add_f32 v[166:167], v[166:167], v[154:155] op_sel_hi:[1,0] neg_lo:[0,1] neg_hi:[0,1]
    v_pk_add_f32 v[168:169], v[168:169], v[154:155] op_sel_hi:[1,0] neg_lo:[0,1] neg_hi:[0,1]
    v_pk_add_f32 v[170:171], v[170:171], v[154:155] op_sel_hi:[1,0] neg_lo:[0,1] neg_hi:[0,1]
    v_pk_add_f32 v[172:173], v[172:173], v[154:155] op_sel_hi:[1,0] neg_lo:[0,1] neg_hi:[0,1]
    v_pk_add_f32 v[174:175], v[174:175], v[154:155] op_sel_hi:[1,0] neg_lo:[0,1] neg_hi:[0,1]
    s_add_u32 s26, s24, 0x240000
    s_add_u32 m0, s29, 0x12000
    s_nop 0
    buffer_load_dwordx4 v136, s[16:19], s26 offen lds
    v_cvt_pk_bf16_f32 v80, v160, v161
    v_cvt_pk_bf16_f32 v81, v162, v163
    v_cvt_pk_bf16_f32 v82, v164, v165
    v_cvt_pk_bf16_f32 v83, v166, v167
    v_cvt_pk_bf16_f32 v84, v168, v169
    v_cvt_pk_bf16_f32 v85, v170, v171
    v_cvt_pk_bf16_f32 v86, v172, v173
    v_cvt_pk_bf16_f32 v87, v174, v175
    v_lshlrev_b32 v160, 16, v80
    v_and_b32 v161, 0xffff0000, v80
    v_lshlrev_b32 v162, 16, v81
    v_and_b32 v163, 0xffff0000, v81
    v_lshlrev_b32 v164, 16, v82
    v_and_b32 v165, 0xffff0000, v82
    v_lshlrev_b32 v166, 16, v83
    v_and_b32 v167, 0xffff0000, v83
    v_lshlrev_b32 v168, 16, v84
    v_and_b32 v169, 0xffff0000, v84
    v_lshlrev_b32 v170, 16, v85
    v_and_b32 v171, 0xffff0000, v85
    v_lshlrev_b32 v172, 16, v86
    v_and_b32 v173, 0xffff0000, v86
    v_lshlrev_b32 v174, 16, v87
    v_and_b32 v175, 0xffff0000, v87
    v_pk_mul_f32 v[160:161], v[160:161], v[152:153] op_sel_hi:[1,0]
    v_pk_mul_f32 v[162:163], v[162:163], v[152:153] op_sel_hi:[1,0]
    v_pk_mul_f32 v[164:165], v[164:165], v[152:153] op_sel_hi:[1,0]
    v_pk_mul_f32 v[166:167], v[166:167], v[152:153] op_sel_hi:[1,0]
    v_pk_mul_f32 v[168:169], v[168:169], v[152:153] op_sel_hi:[1,0]
    v_pk_mul_f32 v[170:171], v[170:171], v[152:153] op_sel_hi:[1,0]
    v_pk_mul_f32 v[172:173], v[172:173], v[152:153] op_sel_hi:[1,0]
    v_pk_mul_f32 v[174:175], v[174:175], v[152:153] op_sel_hi:[1,0]
    v_cvt_pk_bf16_f32 v160, v160, v161
    v_cvt_pk_bf16_f32 v162, v162, v163
    v_cvt_pk_bf16_f32 v164, v164, v165
    v_cvt_pk_bf16_f32 v166, v166, v167
    v_cvt_pk_bf16_f32 v168, v168, v169
    v_cvt_pk_bf16_f32 v170, v170, v171
    v_cvt_pk_bf16_f32 v172, v172, v173
    v_cvt_pk_bf16_f32 v174, v174, v175
    v_accvgpr_write_b32 a80, v160
    v_accvgpr_write_b32 a81, v162
    v_accvgpr_write_b32 a82, v164
    v_accvgpr_write_b32 a83, v166
    v_accvgpr_write_b32 a84, v168
    v_accvgpr_write_b32 a85, v170
    v_accvgpr_write_b32 a86, v172
    v_accvgpr_write_b32 a87, v174
    v_lshlrev_b32 v160, 16, v88
    v_and_b32 v161, 0xffff0000, v88
    s_add_u32 s26, s24, 0x260000
    s_add_u32 m0, s29, 0x13000
    s_nop 0
    buffer_load_dwordx4 v136, s[16:19], s26 offen lds
    v_lshlrev_b32 v162, 16, v89
    v_and_b32 v163, 0xffff0000, v89
    v_lshlrev_b32 v164, 16, v90
    v_and_b32 v165, 0xffff0000, v90
    v_lshlrev_b32 v166, 16, v91
    v_and_b32 v167, 0xffff0000, v91
    v_lshlrev_b32 v168, 16, v92
    v_and_b32 v169, 0xffff0000, v92
    v_lshlrev_b32 v170, 16, v93
    v_and_b32 v171, 0xffff0000, v93
    v_lshlrev_b32 v172, 16, v94
    v_and_b32 v173, 0xffff0000, v94
    v_lshlrev_b32 v174, 16, v95
    v_and_b32 v175, 0xffff0000, v95
    v_pk_add_f32 v[160:161], v[160:161], v[154:155] op_sel_hi:[1,0] neg_lo:[0,1] neg_hi:[0,1]
    v_pk_add_f32 v[162:163], v[162:163], v[154:155] op_sel_hi:[1,0] neg_lo:[0,1] neg_hi:[0,1]
    v_pk_add_f32 v[164:165], v[164:165], v[154:155] op_sel_hi:[1,0] neg_lo:[0,1] neg_hi:[0,1]
    v_pk_add_f32 v[166:167], v[166:167], v[154:155] op_sel_hi:[1,0] neg_lo:[0,1] neg_hi:[0,1]
    v_pk_add_f32 v[168:169], v[168:169], v[154:155] op_sel_hi:[1,0] neg_lo:[0,1] neg_hi:[0,1]
    v_pk_add_f32 v[170:171], v[170:171], v[154:155] op_sel_hi:[1,0] neg_lo:[0,1] neg_hi:[0,1]
    v_pk_add_f32 v[172:173], v[172:173], v[154:155] op_sel_hi:[1,0] neg_lo:[0,1] neg_hi:[0,1]
    v_pk_add_f32 v[174:175], v[174:175], v[154:155] op_sel_hi:[1,0] neg_lo:[0,1] neg_hi:[0,1]
    v_cvt_pk_bf16_f32 v88, v160, v161
    v_cvt_pk_bf16_f32 v89, v162, v163
    v_cvt_pk_bf16_f32 v90, v164, v165
    v_cvt_pk_bf16_f32 v91, v166, v167
    v_cvt_pk_bf16_f32 v92, v168, v169
    v_cvt_pk_bf16_f32 v93, v170, v171
    v_cvt_pk_bf16_f32 v94, v172, v173
    v_cvt_pk_bf16_f32 v95, v174, v175
    v_lshlrev_b32 v160, 16, v88
    v_and_b32 v161, 0xffff0000, v88
    v_lshlrev_b32 v162, 16, v89
    v_and_b32 v163, 0xffff0000, v89
    v_lshlrev_b32 v164, 16, v90
    v_and_b32 v165, 0xffff0000, v90
    v_lshlrev_b32 v166, 16, v91
    v_and_b32 v167, 0xffff0000, v91
    v_lshlrev_b32 v168, 16, v92
    v_and_b32 v169, 0xffff0000, v92
    v_lshlrev_b32 v170, 16, v93
    v_and_b32 v171, 0xffff0000, v93
    v_lshlrev_b32 v172, 16, v94
    v_and_b32 v173, 0xffff0000, v94
    v_lshlrev_b32 v174, 16, v95
    v_and_b32 v175, 0xffff0000, v95
    v_pk_mul_f32 v[160:161], v[160:161], v[152:153] op_sel_hi:[1,0]
    v_pk_mul_f32 v[162:163], v[162:163], v[152:153] op_sel_hi:[1,0]
    v_pk_mul_f32 v[164:165], v[164:165], v[152:153] op_sel_hi:[1,0]
    v_pk_mul_f32 v[166:167], v[166:167], v[152:153] op_sel_hi:[1,0]
    s_add_u32 s26, s24, 0x280000
    s_add_u32 m0, s29, 0x14000
    s_nop 0
    buffer_load_dwordx4 v136, s[16:19], s26 offen lds
    v_pk_mul_f32 v[168:169], v[168:169], v[152:153] op_sel_hi:[1,0]
    v_pk_mul_f32 v[170:171], v[170:171], v[152:153] op_sel_hi:[1,0]
    v_pk_mul_f32 v[172:173], v[172:173], v[152:153] op_sel_hi:[1,0]
    v_pk_mul_f32 v[174:175], v[174:175], v[152:153] op_sel_hi:[1,0]
    v_cvt_pk_bf16_f32 v160, v160, v161
    v_cvt_pk_bf16_f32 v162, v162, v163
    v_cvt_pk_bf16_f32 v164, v164, v165
    v_cvt_pk_bf16_f32 v166, v166, v167
    v_cvt_pk_bf16_f32 v168, v168, v169
    v_cvt_pk_bf16_f32 v170, v170, v171
    v_cvt_pk_bf16_f32 v172, v172, v173
    v_cvt_pk_bf16_f32 v174, v174, v175
    v_accvgpr_write_b32 a88, v160
    v_accvgpr_write_b32 a89, v162
    v_accvgpr_write_b32 a90, v164
    v_accvgpr_write_b32 a91, v166
    v_accvgpr_write_b32 a92, v168
    v_accvgpr_write_b32 a93, v170
    v_accvgpr_write_b32 a94, v172
    v_accvgpr_write_b32 a95, v174
    v_lshlrev_b32 v160, 16, v96
    v_and_b32 v161, 0xffff0000, v96
    v_lshlrev_b32 v162, 16, v97
    v_and_b32 v163, 0xffff0000, v97
    v_lshlrev_b32 v164, 16, v98
    v_and_b32 v165, 0xffff0000, v98
    v_lshlrev_b32 v166, 16, v99
    v_and_b32 v167, 0xffff0000, v99
    v_lshlrev_b32 v168, 16, v100
    v_and_b32 v169, 0xffff0000, v100
    v_lshlrev_b32 v170, 16, v101
    v_and_b32 v171, 0xffff0000, v101
    v_lshlrev_b32 v172, 16, v102
    v_and_b32 v173, 0xffff0000, v102
    v_lshlrev_b32 v174, 16, v103
    v_and_b32 v175, 0xffff0000, v103
    v_pk_add_f32 v[160:161], v[160:161], v[154:155] op_sel_hi:[1,0] neg_lo:[0,1] neg_hi:[0,1]
    v_pk_add_f32 v[162:163], v[162:163], v[154:155] op_sel_hi:[1,0] neg_lo:[0,1] neg_hi:[0,1]
    v_pk_add_f32 v[164:165], v[164:165], v[154:155] op_sel_hi:[1,0] neg_lo:[0,1] neg_hi:[0,1]
    v_pk_add_f32 v[166:167], v[166:167], v[154:155] op_sel_hi:[1,0] neg_lo:[0,1] neg_hi:[0,1]
    v_pk_add_f32 v[168:169], v[168:169], v[154:155] op_sel_hi:[1,0] neg_lo:[0,1] neg_hi:[0,1]
    v_pk_add_f32 v[170:171], v[170:171], v[154:155] op_sel_hi:[1,0] neg_lo:[0,1] neg_hi:[0,1]
    v_pk_add_f32 v[172:173], v[172:173], v[154:155] op_sel_hi:[1,0] neg_lo:[0,1] neg_hi:[0,1]
    v_pk_add_f32 v[174:175], v[174:175], v[154:155] op_sel_hi:[1,0] neg_lo:[0,1] neg_hi:[0,1]
    v_cvt_pk_bf16_f32 v96, v160, v161
    v_cvt_pk_bf16_f32 v97, v162, v163
    v_cvt_pk_bf16_f32 v98, v164, v165
    v_cvt_pk_bf16_f32 v99, v166, v167
    v_cvt_pk_bf16_f32 v100, v168, v169
    v_cvt_pk_bf16_f32 v101, v170, v171
    s_add_u32 s26, s24, 0x2a0000
    s_add_u32 m0, s29, 0x15000
    s_nop 0
    buffer_load_dwordx4 v136, s[16:19], s26 offen lds
    v_cvt_pk_bf16_f32 v102, v172, v173
    v_cvt_pk_bf16_f32 v103, v174, v175
    v_lshlrev_b32 v160, 16, v96
    v_and_b32 v161, 0xffff0000, v96
    v_lshlrev_b32 v162, 16, v97
    v_and_b32 v163, 0xffff0000, v97
    v_lshlrev_b32 v164, 16, v98
    v_and_b32 v165, 0xffff0000, v98
    v_lshlrev_b32 v166, 16, v99
    v_and_b32 v167, 0xffff0000, v99
    v_lshlrev_b32 v168, 16, v100
    v_and_b32 v169, 0xffff0000, v100
    v_lshlrev_b32 v170, 16, v101
    v_and_b32 v171, 0xffff0000, v101
    v_lshlrev_b32 v172, 16, v102
    v_and_b32 v173, 0xffff0000, v102
    v_lshlrev_b32 v174, 16, v103
    v_and_b32 v175, 0xffff0000, v103
    v_pk_mul_f32 v[160:161], v[160:161], v[152:153] op_sel_hi:[1,0]
    v_pk_mul_f32 v[162:163], v[162:163], v[152:153] op_sel_hi:[1,0]
    v_pk_mul_f32 v[164:165], v[164:165], v[152:153] op_sel_hi:[1,0]
    v_pk_mul_f32 v[166:167], v[166:167], v[152:153] op_sel_hi:[1,0]
    v_pk_mul_f32 v[168:169], v[168:169], v[152:153] op_sel_hi:[1,0]
    v_pk_mul_f32 v[170:171], v[170:171], v[152:153] op_sel_hi:[1,0]
    v_pk_mul_f32 v[172:173], v[172:173], v[152:153] op_sel_hi:[1,0]
    v_pk_mul_f32 v[174:175], v[174:175], v[152:153] op_sel_hi:[1,0]
    v_cvt_pk_bf16_f32 v160, v160, v161
    v_cvt_pk_bf16_f32 v162, v162, v163
    v_cvt_pk_bf16_f32 v164, v164, v165
    v_cvt_pk_bf16_f32 v166, v166, v167
    v_cvt_pk_bf16_f32 v168, v168, v169
    v_cvt_pk_bf16_f32 v170, v170, v171
    v_cvt_pk_bf16_f32 v172, v172, v173
    v_cvt_pk_bf16_f32 v174, v174, v175
    v_accvgpr_write_b32 a96, v160
    v_accvgpr_write_b32 a97, v162
    v_accvgpr_write_b32 a98, v164
    v_accvgpr_write_b32 a99, v166
    v_accvgpr_write_b32 a100, v168
    v_accvgpr_write_b32 a101, v170
    v_accvgpr_write_b32 a102, v172
    v_accvgpr_write_b32 a103, v174
    v_lshlrev_b32 v160, 16, v104
    v_and_b32 v161, 0xffff0000, v104
    v_lshlrev_b32 v162, 16, v105
    v_and_b32 v163, 0xffff0000, v105
    v_lshlrev_b32 v164, 16, v106
    v_and_b32 v165, 0xffff0000, v106
    v_lshlrev_b32 v166, 16, v107
    v_and_b32 v167, 0xffff0000, v107
    s_add_u32 s26, s24, 0x2c0000
    s_add_u32 m0, s29, 0x16000
    s_nop 0
    buffer_load_dwordx4 v136, s[16:19], s26 offen lds
    v_lshlrev_b32 v168, 16, v108
    v_and_b32 v169, 0xffff0000, v108
    v_lshlrev_b32 v170, 16, v109
    v_and_b32 v171, 0xffff0000, v109
    v_lshlrev_b32 v172, 16, v110
    v_and_b32 v173, 0xffff0000, v110
    v_lshlrev_b32 v174, 16, v111
    v_and_b32 v175, 0xffff0000, v111
    v_pk_add_f32 v[160:161], v[160:161], v[154:155] op_sel_hi:[1,0] neg_lo:[0,1] neg_hi:[0,1]
    v_pk_add_f32 v[162:163], v[162:163], v[154:155] op_sel_hi:[1,0] neg_lo:[0,1] neg_hi:[0,1]
    v_pk_add_f32 v[164:165], v[164:165], v[154:155] op_sel_hi:[1,0] neg_lo:[0,1] neg_hi:[0,1]
    v_pk_add_f32 v[166:167], v[166:167], v[154:155] op_sel_hi:[1,0] neg_lo:[0,1] neg_hi:[0,1]
    v_pk_add_f32 v[168:169], v[168:169], v[154:155] op_sel_hi:[1,0] neg_lo:[0,1] neg_hi:[0,1]
    v_pk_add_f32 v[170:171], v[170:171], v[154:155] op_sel_hi:[1,0] neg_lo:[0,1] neg_hi:[0,1]
    v_pk_add_f32 v[172:173], v[172:173], v[154:155] op_sel_hi:[1,0] neg_lo:[0,1] neg_hi:[0,1]
    v_pk_add_f32 v[174:175], v[174:175], v[154:155] op_sel_hi:[1,0] neg_lo:[0,1] neg_hi:[0,1]
    v_cvt_pk_bf16_f32 v104, v160, v161
    v_cvt_pk_bf16_f32 v105, v162, v163
    v_cvt_pk_bf16_f32 v106, v164, v165
    v_cvt_pk_bf16_f32 v107, v166, v167
    v_cvt_pk_bf16_f32 v108, v168, v169
    v_cvt_pk_bf16_f32 v109, v170, v171
    v_cvt_pk_bf16_f32 v110, v172, v173
    v_cvt_pk_bf16_f32 v111, v174, v175
    v_lshlrev_b32 v160, 16, v104
    v_and_b32 v161, 0xffff0000, v104
    v_lshlrev_b32 v162, 16, v105
    v_and_b32 v163, 0xffff0000, v105
    v_lshlrev_b32 v164, 16, v106
    v_and_b32 v165, 0xffff0000, v106
    v_lshlrev_b32 v166, 16, v107
    v_and_b32 v167, 0xffff0000, v107
    v_lshlrev_b32 v168, 16, v108
    v_and_b32 v169, 0xffff0000, v108
    v_lshlrev_b32 v170, 16, v109
    v_and_b32 v171, 0xffff0000, v109
    v_lshlrev_b32 v172, 16, v110
    v_and_b32 v173, 0xffff0000, v110
    v_lshlrev_b32 v174, 16, v111
    v_and_b32 v175, 0xffff0000, v111
    v_pk_mul_f32 v[160:161], v[160:161], v[152:153] op_sel_hi:[1,0]
    v_pk_mul_f32 v[162:163], v[162:163], v[152:153] op_sel_hi:[1,0]
    v_pk_mul_f32 v[164:165], v[164:165], v[152:153] op_sel_hi:[1,0]
    v_pk_mul_f32 v[166:167], v[166:167], v[152:153] op_sel_hi:[1,0]
    v_pk_mul_f32 v[168:169], v[168:169], v[152:153] op_sel_hi:[1,0]
    v_pk_mul_f32 v[170:171], v[170:171], v[152:153] op_sel_hi:[1,0]
    v_pk_mul_f32 v[172:173], v[172:173], v[152:153] op_sel_hi:[1,0]
    v_pk_mul_f32 v[174:175], v[174:175], v[152:153] op_sel_hi:[1,0]
    v_cvt_pk_bf16_f32 v160, v160, v161
    v_cvt_pk_bf16_f32 v162, v162, v163
    s_add_u32 s26, s24, 0x2e0000
    s_add_u32 m0, s29, 0x17000
    s_nop 0
    buffer_load_dwordx4 v136, s[16:19], s26 offen lds
    v_cvt_pk_bf16_f32 v164, v164, v165
    v_cvt_pk_bf16_f32 v166, v166, v167
    v_cvt_pk_bf16_f32 v168, v168, v169
    v_cvt_pk_bf16_f32 v170, v170, v171
    v_cvt_pk_bf16_f32 v172, v172, v173
    v_cvt_pk_bf16_f32 v174, v174, v175
    v_accvgpr_write_b32 a104, v160
    v_accvgpr_write_b32 a105, v162
    v_accvgpr_write_b32 a106, v164
    v_accvgpr_write_b32 a107, v166
    v_accvgpr_write_b32 a108, v168
    v_accvgpr_write_b32 a109, v170
    v_accvgpr_write_b32 a110, v172
    v_accvgpr_write_b32 a111, v174
    v_lshlrev_b32 v160, 16, v112
    v_and_b32 v161, 0xffff0000, v112
    v_lshlrev_b32 v162, 16, v113
    v_and_b32 v163, 0xffff0000, v113
    v_lshlrev_b32 v164, 16, v114
    v_and_b32 v165, 0xffff0000, v114
    v_lshlrev_b32 v166, 16, v115
    v_and_b32 v167, 0xffff0000, v115
    v_lshlrev_b32 v168, 16, v116
    v_and_b32 v169, 0xffff0000, v116
    v_lshlrev_b32 v170, 16, v117
    v_and_b32 v171, 0xffff0000, v117
    v_lshlrev_b32 v172, 16, v118
    v_and_b32 v173, 0xffff0000, v118
    v_lshlrev_b32 v174, 16, v119
    v_and_b32 v175, 0xffff0000, v119
    v_pk_add_f32 v[160:161], v[160:161], v[154:155] op_sel_hi:[1,0] neg_lo:[0,1] neg_hi:[0,1]
    v_pk_add_f32 v[162:163], v[162:163], v[154:155] op_sel_hi:[1,0] neg_lo:[0,1] neg_hi:[0,1]
    v_pk_add_f32 v[164:165], v[164:165], v[154:155] op_sel_hi:[1,0] neg_lo:[0,1] neg_hi:[0,1]
    v_pk_add_f32 v[166:167], v[166:167], v[154:155] op_sel_hi:[1,0] neg_lo:[0,1] neg_hi:[0,1]
    v_pk_add_f32 v[168:169], v[168:169], v[154:155] op_sel_hi:[1,0] neg_lo:[0,1] neg_hi:[0,1]
    v_pk_add_f32 v[170:171], v[170:171], v[154:155] op_sel_hi:[1,0] neg_lo:[0,1] neg_hi:[0,1]
    v_pk_add_f32 v[172:173], v[172:173], v[154:155] op_sel_hi:[1,0] neg_lo:[0,1] neg_hi:[0,1]
    v_pk_add_f32 v[174:175], v[174:175], v[154:155] op_sel_hi:[1,0] neg_lo:[0,1] neg_hi:[0,1]
    v_cvt_pk_bf16_f32 v112, v160, v161
    v_cvt_pk_bf16_f32 v113, v162, v163
    v_cvt_pk_bf16_f32 v114, v164, v165
    v_cvt_pk_bf16_f32 v115, v166, v167
    v_cvt_pk_bf16_f32 v116, v168, v169
    v_cvt_pk_bf16_f32 v117, v170, v171
    v_cvt_pk_bf16_f32 v118, v172, v173
    v_cvt_pk_bf16_f32 v119, v174, v175
    v_lshlrev_b32 v160, 16, v112
    v_and_b32 v161, 0xffff0000, v112
    v_lshlrev_b32 v162, 16, v113
    v_and_b32 v163, 0xffff0000, v113
    v_lshlrev_b32 v138, 2, v137
    v_lshlrev_b32 v138, 3, v137
    s_sub_u32 s26, s101, 96
    s_lshl_b32 s26, s26, 2
    s_add_u32 s26, s26, s21
    s_min_u32 s26, s26, 512
    s_lshl_b32 s26, s26, 13
    s_cmp_eq_u32 s41, 0
    s_cselect_b32 s6, 0x400000, 0
    s_mov_b32 s7, 0x20000
    s_mov_b32 s4, s66
    s_and_b32 s5, s67, 0xffff
    buffer_load_dword v143, v138, s[4:7], s26 offen
    v_lshlrev_b32 v164, 16, v114
    v_and_b32 v165, 0xffff0000, v114
    v_lshlrev_b32 v166, 16, v115
    v_and_b32 v167, 0xffff0000, v115
    v_lshlrev_b32 v168, 16, v116
    v_and_b32 v169, 0xffff0000, v116
    v_lshlrev_b32 v170, 16, v117
    v_and_b32 v171, 0xffff0000, v117
    v_lshlrev_b32 v172, 16, v118
    v_and_b32 v173, 0xffff0000, v118
    v_lshlrev_b32 v174, 16, v119
    v_and_b32 v175, 0xffff0000, v119
    v_pk_mul_f32 v[160:161], v[160:161], v[152:153] op_sel_hi:[1,0]
    v_pk_mul_f32 v[162:163], v[162:163], v[152:153] op_sel_hi:[1,0]
    v_pk_mul_f32 v[164:165], v[164:165], v[152:153] op_sel_hi:[1,0]
    v_pk_mul_f32 v[166:167], v[166:167], v[152:153] op_sel_hi:[1,0]
    v_pk_mul_f32 v[168:169], v[168:169], v[152:153] op_sel_hi:[1,0]
    v_pk_mul_f32 v[170:171], v[170:171], v[152:153] op_sel_hi:[1,0]
    v_pk_mul_f32 v[172:173], v[172:173], v[152:153] op_sel_hi:[1,0]
    v_pk_mul_f32 v[174:175], v[174:175], v[152:153] op_sel_hi:[1,0]
    v_cvt_pk_bf16_f32 v160, v160, v161
    v_cvt_pk_bf16_f32 v162, v162, v163
    v_cvt_pk_bf16_f32 v164, v164, v165
    v_cvt_pk_bf16_f32 v166, v166, v167
    v_cvt_pk_bf16_f32 v168, v168, v169
    v_cvt_pk_bf16_f32 v170, v170, v171
    v_cvt_pk_bf16_f32 v172, v172, v173
    v_cvt_pk_bf16_f32 v174, v174, v175
    v_accvgpr_write_b32 a112, v160
    v_accvgpr_write_b32 a113, v162
    v_accvgpr_write_b32 a114, v164
    v_accvgpr_write_b32 a115, v166
    v_accvgpr_write_b32 a116, v168
    v_accvgpr_write_b32 a117, v170
    v_accvgpr_write_b32 a118, v172
    v_accvgpr_write_b32 a119, v174
    v_lshlrev_b32 v160, 16, v120
    v_and_b32 v161, 0xffff0000, v120
    v_lshlrev_b32 v162, 16, v121
    v_and_b32 v163, 0xffff0000, v121
    v_lshlrev_b32 v164, 16, v122
    v_and_b32 v165, 0xffff0000, v122
    v_lshlrev_b32 v166, 16, v123
    v_and_b32 v167, 0xffff0000, v123
    v_lshlrev_b32 v168, 16, v124
    v_and_b32 v169, 0xffff0000, v124
    v_lshlrev_b32 v170, 16, v125
    v_and_b32 v171, 0xffff0000, v125
    v_lshlrev_b32 v172, 16, v126
    v_and_b32 v173, 0xffff0000, v126
    v_lshlrev_b32 v174, 16, v127
    v_and_b32 v175, 0xffff0000, v127
    v_pk_add_f32 v[160:161], v[160:161], v[154:155] op_sel_hi:[1,0] neg_lo:[0,1] neg_hi:[0,1]
    v_pk_add_f32 v[162:163], v[162:163], v[154:155] op_sel_hi:[1,0] neg_lo:[0,1] neg_hi:[0,1]
    v_pk_add_f32 v[164:165], v[164:165], v[154:155] op_sel_hi:[1,0] neg_lo:[0,1] neg_hi:[0,1]
    v_pk_add_f32 v[166:167], v[166:167], v[154:155] op_sel_hi:[1,0] neg_lo:[0,1] neg_hi:[0,1]
    v_pk_add_f32 v[168:169], v[168:169], v[154:155] op_sel_hi:[1,0] neg_lo:[0,1] neg_hi:[0,1]
    v_pk_add_f32 v[170:171], v[170:171], v[154:155] op_sel_hi:[1,0] neg_lo:[0,1] neg_hi:[0,1]
    v_pk_add_f32 v[172:173], v[172:173], v[154:155] op_sel_hi:[1,0] neg_lo:[0,1] neg_hi:[0,1]
    v_pk_add_f32 v[174:175], v[174:175], v[154:155] op_sel_hi:[1,0] neg_lo:[0,1] neg_hi:[0,1]
    v_cvt_pk_bf16_f32 v120, v160, v161
    v_cvt_pk_bf16_f32 v121, v162, v163
    v_cvt_pk_bf16_f32 v122, v164, v165
    v_cvt_pk_bf16_f32 v123, v166, v167
    v_cvt_pk_bf16_f32 v124, v168, v169
    v_cvt_pk_bf16_f32 v125, v170, v171
    v_cvt_pk_bf16_f32 v126, v172, v173
    v_cvt_pk_bf16_f32 v127, v174, v175
    v_lshlrev_b32 v160, 16, v120
    v_and_b32 v161, 0xffff0000, v120
    v_lshlrev_b32 v162, 16, v121
    v_and_b32 v163, 0xffff0000, v121
    v_lshlrev_b32 v164, 16, v122
    v_and_b32 v165, 0xffff0000, v122
    v_lshlrev_b32 v166, 16, v123
    v_and_b32 v167, 0xffff0000, v123
    v_lshlrev_b32 v168, 16, v124
    v_and_b32 v169, 0xffff0000, v124
    v_lshlrev_b32 v170, 16, v125
    v_and_b32 v171, 0xffff0000, v125
    v_lshlrev_b32 v172, 16, v126
    v_and_b32 v173, 0xffff0000, v126
    v_lshlrev_b32 v174, 16, v127
    v_and_b32 v175, 0xffff0000, v127
    v_pk_mul_f32 v[160:161], v[160:161], v[152:153] op_sel_hi:[1,0]
    v_pk_mul_f32 v[162:163], v[162:163], v[152:153] op_sel_hi:[1,0]
    v_pk_mul_f32 v[164:165], v[164:165], v[152:153] op_sel_hi:[1,0]
    v_pk_mul_f32 v[166:167], v[166:167], v[152:153] op_sel_hi:[1,0]
    v_pk_mul_f32 v[168:169], v[168:169], v[152:153] op_sel_hi:[1,0]
    v_pk_mul_f32 v[170:171], v[170:171], v[152:153] op_sel_hi:[1,0]
    v_pk_mul_f32 v[172:173], v[172:173], v[152:153] op_sel_hi:[1,0]
    v_pk_mul_f32 v[174:175], v[174:175], v[152:153] op_sel_hi:[1,0]
    v_cvt_pk_bf16_f32 v160, v160, v161
    v_cvt_pk_bf16_f32 v162, v162, v163
    v_cvt_pk_bf16_f32 v164, v164, v165
    v_cvt_pk_bf16_f32 v166, v166, v167
    v_cvt_pk_bf16_f32 v168, v168, v169
    v_cvt_pk_bf16_f32 v170, v170, v171
    v_cvt_pk_bf16_f32 v172, v172, v173
    v_cvt_pk_bf16_f32 v174, v174, v175
    v_accvgpr_write_b32 a120, v160
    v_accvgpr_write_b32 a121, v162
    v_accvgpr_write_b32 a122, v164
    v_accvgpr_write_b32 a123, v166
    v_accvgpr_write_b32 a124, v168
    v_accvgpr_write_b32 a125, v170
    v_accvgpr_write_b32 a126, v172
    v_accvgpr_write_b32 a127, v174
    buffer_load_dwordx2 v[140:141], off, s[92:95], 0 offset:36 sc1
    s_nop 3
L_p1_unit:
    s_cmp_ge_u32 s38, 96
    s_cbranch_scc1 L_p1_end
    s_lshr_b32 s26, s38, 5
    s_add_u32 s27, s26, 1
    s_lshl_b32 s25, s27, 24
    s_lshl_b32 s27, s20, 2
    s_add_u32 s27, s27, s21
    s_lshl_b32 s27, s27, 5
    s_and_b32 s28, s38, 31
    s_add_u32 s27, s27, s28
    s_lshl_b32 s27, s27, 13
    s_add_u32 s25, s25, s27
    s_lshr_b32 s26, s38, 5
    s_cmp_eq_u32 s26, 1
    s_cbranch_scc1 L_p1_v
    s_waitcnt vmcnt(16)
    s_barrier
    ds_read_b64_tr_b16 v[64:65], v128
    ds_read_b64_tr_b16 v[66:67], v128 offset:1024
    ds_read_b64_tr_b16 v[68:69], v129
    ds_read_b64_tr_b16 v[70:71], v129 offset:1024
    ds_read_b64_tr_b16 v[72:73], v130
    ds_read_b64_tr_b16 v[74:75], v130 offset:1024
    ds_read_b64_tr_b16 v[76:77], v131
    ds_read_b64_tr_b16 v[78:79], v131 offset:1024
    ds_read_b64_tr_b16 v[80:81], v132
    ds_read_b64_tr_b16 v[82:83], v132 offset:1024
    ds_read_b64_tr_b16 v[84:85], v133
    ds_read_b64_tr_b16 v[86:87], v133 offset:1024
    ds_read_b64_tr_b16 v[88:89], v134
    ds_read_b64_tr_b16 v[90:91], v134 offset:1024
    s_waitcnt lgkmcnt(12)
    v_mfma_f32_16x16x32_bf16 v[0:3], v[64:67], a[0:3], 0
    ds_read_b64_tr_b16 v[92:93], v135
    v_mfma_f32_16x16x32_bf16 v[4:7], v[64:67], a[64:67], 0
    ds_read_b64_tr_b16 v[94:95], v135 offset:1024
    s_add_u32 s26, s24, 0x300000
    s_add_u32 m0, s29, 0x18000
    s_nop 0
    buffer_load_dwordx4 v136, s[16:19], s26 offen lds
    s_waitcnt lgkmcnt(12)
    v_mfma_f32_16x16x32_bf16 v[8:11], v[68:71], a[0:3], 0
    ds_read_b64_tr_b16 v[96:97], v128 offset:8192
    v_mfma_f32_16x16x32_bf16 v[12:15], v[68:71], a[64:67], 0
    ds_read_b64_tr_b16 v[98:99], v128 offset:9216
    s_add_u32 s26, s24, 0x320000
    s_add_u32 m0, s29, 0x19000
    s_nop 0
    buffer_load_dwordx4 v136, s[16:19], s26 offen lds
    s_waitcnt lgkmcnt(12)
    v_mfma_f32_16x16x32_bf16 v[16:19], v[72:75], a[0:3], 0
    ds_read_b64_tr_b16 v[100:101], v129 offset:8192
    v_mfma_f32_16x16x32_bf16 v[20:23], v[72:75], a[64:67], 0
    ds_read_b64_tr_b16 v[102:103], v129 offset:9216
    s_add_u32 s26, s24, 0x340000
    s_add_u32 m0, s29, 0x1a000
    s_nop 0
    buffer_load_dwordx4 v136, s[16:19], s26 offen lds
    s_waitcnt lgkmcnt(12)
    v_mfma_f32_16x16x32_bf16 v[24:27], v[76:79], a[0:3], 0
    ds_read_b64_tr_b16 v[104:105], v130 offset:8192
    v_mfma_f32_16x16x32_bf16 v[28:31], v[76:79], a[64:67], 0
    ds_read_b64_tr_b16 v[106:107], v130 offset:9216
    s_add_u32 s26, s24, 0x360000
    s_add_u32 m0, s29, 0x1b000
    s_nop 0
    buffer_load_dwordx4 v136, s[16:19], s26 offen lds
    s_waitcnt lgkmcnt(12)
    v_mfma_f32_16x16x32_bf16 v[32:35], v[80:83], a[0:3], 0
    ds_read_b64_tr_b16 v[108:109], v131 offset:8192
    v_mfma_f32_16x16x32_bf16 v[36:39], v[80:83], a[64:67], 0
    ds_read_b64_tr_b16 v[110:111], v131 offset:9216
    s_add_u32 s26, s24, 0x380000
    s_add_u32 m0, s29, 0x1c000
    s_nop 0
    buffer_load_dwordx4 v136, s[16:19], s26 offen lds
    s_waitcnt lgkmcnt(12)
    v_mfma_f32_16x16x32_bf16 v[40:43], v[84:87], a[0:3], 0
    ds_read_b64_tr_b16 v[112:113], v132 offset:8192
    v_mfma_f32_16x16x32_bf16 v[44:47], v[84:87], a[64:67], 0
    ds_read_b64_tr_b16 v[114:115], v132 offset:9216
    s_add_u32 s26, s24, 0x3a0000
    s_add_u32 m0, s29, 0x1d000
    s_nop 0
    buffer_load_dwordx4 v136, s[16:19], s26 offen lds
    s_waitcnt lgkmcnt(12)
    v_mfma_f32_16x16x32_bf16 v[48:51], v[88:91], a[0:3], 0
    ds_read_b64_tr_b16 v[116:117], v133 offset:8192
    v_mfma_f32_16x16x32_bf16 v[52:55], v[88:91], a[64:67], 0
    ds_read_b64_tr_b16 v[118:119], v133 offset:9216
    s_add_u32 s26, s24, 0x3c0000
    s_add_u32 m0, s29, 0x1e000
    s_nop 0
    buffer_load_dwordx4 v136, s[16:19], s26 offen lds
    s_waitcnt lgkmcnt(12)
    v_mfma_f32_16x16x32_bf16 v[56:59], v[92:95], a[0:3], 0
    ds_read_b64_tr_b16 v[120:121], v134 offset:8192
    v_mfma_f32_16x16x32_bf16 v[60:63], v[92:95], a[64:67], 0
    ds_read_b64_tr_b16 v[122:123], v134 offset:9216
    s_add_u32 s26, s24, 0x3e0000
    s_add_u32 m0, s29, 0x1f000
    s_nop 0
    buffer_load_dwordx4 v136, s[16:19], s26 offen lds
    s_waitcnt lgkmcnt(12)
    v_mfma_f32_16x16x32_bf16 v[0:3], v[96:99], a[4:7], v[0:3]
    ds_read_b64_tr_b16 v[124:125], v135 offset:8192
    v_mfma_f32_16x16x32_bf16 v[4:7], v[96:99], a[68:71], v[4:7]
    ds_read_b64_tr_b16 v[126:127], v135 offset:9216
    s_waitcnt lgkmcnt(12)
    v_mfma_f32_16x16x32_bf16 v[8:11], v[100:103], a[4:7], v[8:11]
    ds_read_b64_tr_b16 v[64:65], v128 offset:16384
    v_mfma_f32_16x16x32_bf16 v[12:15], v[100:103], a[68:71], v[12:15]
    ds_read_b64_tr_b16 v[66:67], v128 offset:17408
    s_waitcnt lgkmcnt(12)
    v_mfma_f32_16x16x32_bf16 v[16:19], v[104:107], a[4:7], v[16:19]
    ds_read_b64_tr_b16 v[68:69], v129 offset:16384
    v_mfma_f32_16x16x32_bf16 v[20:23], v[104:107], a[68:71], v[20:23]
    ds_read_b64_tr_b16 v[70:71], v129 offset:17408
    s_waitcnt lgkmcnt(12)
    v_mfma_f32_16x16x32_bf16 v[24:27], v[108:111], a[4:7], v[24:27]
    ds_read_b64_tr_b16 v[72:73], v130 offset:16384
    v_mfma_f32_16x16x32_bf16 v[28:31], v[108:111], a[68:71], v[28:31]
    ds_read_b64_tr_b16 v[74:75], v130 offset:17408
    s_waitcnt lgkmcnt(12)
    v_mfma_f32_16x16x32_bf16 v[32:35], v[112:115], a[4:7], v[32:35]
    ds_read_b64_tr_b16 v[76:77], v131 offset:16384
    v_mfma_f32_16x16x32_bf16 v[36:39], v[112:115], a[68:71], v[36:39]
    ds_read_b64_tr_b16 v[78:79], v131 offset:17408
    s_waitcnt lgkmcnt(12)
    v_mfma_f32_16x16x32_bf16 v[40:43], v[116:119], a[4:7], v[40:43]
    ds_read_b64_tr_b16 v[80:81], v132 offset:16384
    v_mfma_f32_16x16x32_bf16 v[44:47], v[116:119], a[68:71], v[44:47]
    ds_read_b64_tr_b16 v[82:83], v132 offset:17408
    s_waitcnt lgkmcnt(12)
    v_mfma_f32_16x16x32_bf16 v[48:51], v[120:123], a[4:7], v[48:51]
    ds_read_b64_tr_b16 v[84:85], v133 offset:16384
    v_mfma_f32_16x16x32_bf16 v[52:55], v[120:123], a[68:71], v[52:55]
    ds_read_b64_tr_b16 v[86:87], v133 offset:17408
    s_waitcnt lgkmcnt(12)
    v_mfma_f32_16x16x32_bf16 v[56:59], v[124:127], a[4:7], v[56:59]
    ds_read_b64_tr_b16 v[88:89], v134 offset:16384
    v_mfma_f32_16x16x32_bf16 v[60:63], v[124:127], a[68:71], v[60:63]
    ds_read_b64_tr_b16 v[90:91], v134 offset:17408
    s_waitcnt lgkmcnt(12)
    v_mfma_f32_16x16x32_bf16 v[0:3], v[64:67], a[8:11], v[0:3]
    ds_read_b64_tr_b16 v[92:93], v135 offset:16384
    v_mfma_f32_16x16x32_bf16 v[4:7], v[64:67], a[72:75], v[4:7]
    ds_read_b64_tr_b16 v[94:95], v135 offset:17408
    s_waitcnt lgkmcnt(12)
    v_mfma_f32_16x16x32_bf16 v[8:11], v[68:71], a[8:11], v[8:11]
    ds_read_b64_tr_b16 v[96:97], v128 offset:24576
    v_mfma_f32_16x16x32_bf16 v[12:15], v[68:71], a[72:75], v[12:15]
    ds_read_b64_tr_b16 v[98:99], v128 offset:25600
    s_waitcnt lgkmcnt(12)
    v_mfma_f32_16x16x32_bf16 v[16:19], v[72:75], a[8:11], v[16:19]
    ds_read_b64_tr_b16 v[100:101], v129 offset:24576
    v_mfma_f32_16x16x32_bf16 v[20:23], v[72:75], a[72:75], v[20:23]
    ds_read_b64_tr_b16 v[102:103], v129 offset:25600
    s_waitcnt lgkmcnt(12)
    v_mfma_f32_16x16x32_bf16 v[24:27], v[76:79], a[8:11], v[24:27]
    ds_read_b64_tr_b16 v[104:105], v130 offset:24576
    v_mfma_f32_16x16x32_bf16 v[28:31], v[76:79], a[72:75], v[28:31]
    ds_read_b64_tr_b16 v[106:107], v130 offset:25600
    s_waitcnt lgkmcnt(12)
    v_mfma_f32_16x16x32_bf16 v[32:35], v[80:83], a[8:11], v[32:35]
    ds_read_b64_tr_b16 v[108:109], v131 offset:24576
    v_mfma_f32_16x16x32_bf16 v[36:39], v[80:83], a[72:75], v[36:39]
    ds_read_b64_tr_b16 v[110:111], v131 offset:25600
    s_waitcnt lgkmcnt(12)
    v_mfma_f32_16x16x32_bf16 v[40:43], v[84:87], a[8:11], v[40:43]
    ds_read_b64_tr_b16 v[112:113], v132 offset:24576
    v_mfma_f32_16x16x32_bf16 v[44:47], v[84:87], a[72:75], v[44:47]
    ds_read_b64_tr_b16 v[114:115], v132 offset:25600
    s_waitcnt lgkmcnt(12)
    v_mfma_f32_16x16x32_bf16 v[48:51], v[88:91], a[8:11], v[48:51]
    ds_read_b64_tr_b16 v[116:117], v133 offset:24576
    v_mfma_f32_16x16x32_bf16 v[52:55], v[88:91], a[72:75], v[52:55]
    ds_read_b64_tr_b16 v[118:119], v133 offset:25600
    s_waitcnt lgkmcnt(12)
    v_mfma_f32_16x16x32_bf16 v[56:59], v[92:95], a[8:11], v[56:59]
    ds_read_b64_tr_b16 v[120:121], v134 offset:24576
    v_mfma_f32_16x16x32_bf16 v[60:63], v[92:95], a[72:75], v[60:63]
    ds_read_b64_tr_b16 v[122:123], v134 offset:25600
    s_waitcnt lgkmcnt(12)
    v_mfma_f32_16x16x32_bf16 v[0:3], v[96:99], a[12:15], v[0:3]
    ds_read_b64_tr_b16 v[124:125], v135 offset:24576
    v_mfma_f32_16x16x32_bf16 v[4:7], v[96:99], a[76:79], v[4:7]
    ds_read_b64_tr_b16 v[126:127], v135 offset:25600
    s_waitcnt lgkmcnt(12)
    v_mfma_f32_16x16x32_bf16 v[8:11], v[100:103], a[12:15], v[8:11]
    v_mfma_f32_16x16x32_bf16 v[12:15], v[100:103], a[76:79], v[12:15]
    s_waitcnt lgkmcnt(10)
    v_mfma_f32_16x16x32_bf16 v[16:19], v[104:107], a[12:15], v[16:19]
    v_mfma_f32_16x16x32_bf16 v[20:23], v[104:107], a[76:79], v[20:23]
    s_waitcnt lgkmcnt(8)
    v_mfma_f32_16x16x32_bf16 v[24:27], v[108:111], a[12:15], v[24:27]
    v_mfma_f32_16x16x32_bf16 v[28:31], v[108:111], a[76:79], v[28:31]
    s_waitcnt lgkmcnt(6)
    v_mfma_f32_16x16x32_bf16 v[32:35], v[112:115], a[12:15], v[32:35]
    v_mfma_f32_16x16x32_bf16 v[36:39], v[112:115], a[76:79], v[36:39]
    s_waitcnt lgkmcnt(4)
    v_mfma_f32_16x16x32_bf16 v[40:43], v[116:119], a[12:15], v[40:43]
    v_mfma_f32_16x16x32_bf16 v[44:47], v[116:119], a[76:79], v[44:47]
    s_waitcnt lgkmcnt(2)
    v_mfma_f32_16x16x32_bf16 v[48:51], v[120:123], a[12:15], v[48:51]
    v_mfma_f32_16x16x32_bf16 v[52:55], v[120:123], a[76:79], v[52:55]
    s_waitcnt lgkmcnt(0)
    v_mfma_f32_16x16x32_bf16 v[56:59], v[124:127], a[12:15], v[56:59]
    v_mfma_f32_16x16x32_bf16 v[60:63], v[124:127], a[76:79], v[60:63]
    s_waitcnt vmcnt(16)
    s_barrier
    ds_read_b64_tr_b16 v[64:65], v128 offset:32768
    ds_read_b64_tr_b16 v[66:67], v128 offset:33792
    ds_read_b64_tr_b16 v[68:69], v129 offset:32768
    ds_read_b64_tr_b16 v[70:71], v129 offset:33792
    ds_read_b64_tr_b16 v[72:73], v130 offset:32768
    ds_read_b64_tr_b16 v[74:75], v130 offset:33792
    ds_read_b64_tr_b16 v[76:77], v131 offset:32768
    ds_read_b64_tr_b16 v[78:79], v131 offset:33792
    ds_read_b64_tr_b16 v[80:81], v132 offset:32768
    ds_read_b64_tr_b16 v[82:83], v132 offset:33792
    ds_read_b64_tr_b16 v[84:85], v133 offset:32768
    ds_read_b64_tr_b16 v[86:87], v133 offset:33792
    ds_read_b64_tr_b16 v[88:89], v134 offset:32768
    ds_read_b64_tr_b16 v[90:91], v134 offset:33792
    s_add_u32 s39, s39, s37
    s_lshr_b32 s26, s39, 5
    s_cmp_eq_u32 s26, 0
    s_cselect_b64 s[16:17], s[62:63], s[60:61]
    s_cmp_eq_u32 s26, 1
    s_cselect_b64 s[16:17], s[64:65], s[16:17]
    s_and_b32 s17, s17, 0xffff
    s_cmp_lt_u32 s39, 96
    s_cselect_b32 s18, 0x400000, 0
    s_and_b32 s24, s39, 31
    s_lshl_b32 s24, s24, 8
    s_waitcnt lgkmcnt(12)
    v_mfma_f32_16x16x32_bf16 v[0:3], v[64:67], a[16:19], v[0:3]
    ds_read_b64_tr_b16 v[92:93], v135 offset:32768
    v_mfma_f32_16x16x32_bf16 v[4:7], v[64:67], a[80:83], v[4:7]
    ds_read_b64_tr_b16 v[94:95], v135 offset:33792
    s_add_u32 s26, s24, 0x0
    s_add_u32 m0, s29, 0x0
    s_nop 0
    buffer_load_dwordx4 v136, s[16:19], s26 offen lds
    s_waitcnt lgkmcnt(12)
    v_mfma_f32_16x16x32_bf16 v[8:11], v[68:71], a[16:19], v[8:11]
    ds_read_b64_tr_b16 v[96:97], v128 offset:40960
    v_mfma_f32_16x16x32_bf16 v[12:15], v[68:71], a[80:83], v[12:15]
    ds_read_b64_tr_b16 v[98:99], v128 offset:41984
    s_add_u32 s26, s24, 0x20000
    s_add_u32 m0, s29, 0x1000
    s_nop 0
    buffer_load_dwordx4 v136, s[16:19], s26 offen lds
    s_waitcnt lgkmcnt(12)
    v_mfma_f32_16x16x32_bf16 v[16:19], v[72:75], a[16:19], v[16:19]
    ds_read_b64_tr_b16 v[100:101], v129 offset:40960
    v_mfma_f32_16x16x32_bf16 v[20:23], v[72:75], a[80:83], v[20:23]
    ds_read_b64_tr_b16 v[102:103], v129 offset:41984
    s_add_u32 s26, s24, 0x40000
    s_add_u32 m0, s29, 0x2000
    s_nop 0
    buffer_load_dwordx4 v136, s[16:19], s26 offen lds
    s_waitcnt lgkmcnt(12)
    v_mfma_f32_16x16x32_bf16 v[24:27], v[76:79], a[16:19], v[24:27]
    ds_read_b64_tr_b16 v[104:105], v130 offset:40960
    v_mfma_f32_16x16x32_bf16 v[28:31], v[76:79], a[80:83], v[28:31]
    ds_read_b64_tr_b16 v[106:107], v130 offset:41984
    s_add_u32 s26, s24, 0x60000
    s_add_u32 m0, s29, 0x3000
    s_nop 0
    buffer_load_dwordx4 v136, s[16:19], s26 offen lds
    s_waitcnt lgkmcnt(12)
    v_mfma_f32_16x16x32_bf16 v[32:35], v[80:83], a[16:19], v[32:35]
    ds_read_b64_tr_b16 v[108:109], v131 offset:40960
    v_mfma_f32_16x16x32_bf16 v[36:39], v[80:83], a[80:83], v[36:39]
    ds_read_b64_tr_b16 v[110:111], v131 offset:41984
    s_add_u32 s26, s24, 0x80000
    s_add_u32 m0, s29, 0x4000
    s_nop 0
    buffer_load_dwordx4 v136, s[16:19], s26 offen lds
    s_waitcnt lgkmcnt(12)
    v_mfma_f32_16x16x32_bf16 v[40:43], v[84:87], a[16:19], v[40:43]
    ds_read_b64_tr_b16 v[112:113], v132 offset:40960
    v_mfma_f32_16x16x32_bf16 v[44:47], v[84:87], a[80:83], v[44:47]
    ds_read_b64_tr_b16 v[114:115], v132 offset:41984
    s_add_u32 s26, s24, 0xa0000
    s_add_u32 m0, s29, 0x5000
    s_nop 0
    buffer_load_dwordx4 v136, s[16:19], s26 offen lds
    s_waitcnt lgkmcnt(12)
    v_mfma_f32_16x16x32_bf16 v[48:51], v[88:91], a[16:19], v[48:51]
    ds_read_b64_tr_b16 v[116:117], v133 offset:40960
    v_mfma_f32_16x16x32_bf16 v[52:55], v[88:91], a[80:83], v[52:55]
    ds_read_b64_tr_b16 v[118:119], v133 offset:41984
    s_add_u32 s26, s24, 0xc0000
    s_add_u32 m0, s29, 0x6000
    s_nop 0
    buffer_load_dwordx4 v136, s[16:19], s26 offen lds
    s_waitcnt lgkmcnt(12)
    v_mfma_f32_16x16x32_bf16 v[56:59], v[92:95], a[16:19], v[56:59]
    ds_read_b64_tr_b16 v[120:121], v134 offset:40960
    v_mfma_f32_16x16x32_bf16 v[60:63], v[92:95], a[80:83], v[60:63]
    ds_read_b64_tr_b16 v[122:123], v134 offset:41984
    s_add_u32 s26, s24, 0xe0000
    s_add_u32 m0, s29, 0x7000
    s_nop 0
    buffer_load_dwordx4 v136, s[16:19], s26 offen lds
    s_waitcnt lgkmcnt(12)
    v_mfma_f32_16x16x32_bf16 v[0:3], v[96:99], a[20:23], v[0:3]
    ds_read_b64_tr_b16 v[124:125], v135 offset:40960
    v_mfma_f32_16x16x32_bf16 v[4:7], v[96:99], a[84:87], v[4:7]
    ds_read_b64_tr_b16 v[126:127], v135 offset:41984
    s_waitcnt lgkmcnt(12)
    v_mfma_f32_16x16x32_bf16 v[8:11], v[100:103], a[20:23], v[8:11]
    ds_read_b64_tr_b16 v[64:65], v128 offset:49152
    v_mfma_f32_16x16x32_bf16 v[12:15], v[100:103], a[84:87], v[12:15]
    ds_read_b64_tr_b16 v[66:67], v128 offset:50176
    s_waitcnt lgkmcnt(12)
    v_mfma_f32_16x16x32_bf16 v[16:19], v[104:107], a[20:23], v[16:19]
    ds_read_b64_tr_b16 v[68:69], v129 offset:49152
    v_mfma_f32_16x16x32_bf16 v[20:23], v[104:107], a[84:87], v[20:23]
    ds_read_b64_tr_b16 v[70:71], v129 offset:50176
    s_waitcnt lgkmcnt(12)
    v_mfma_f32_16x16x32_bf16 v[24:27], v[108:111], a[20:23], v[24:27]
    ds_read_b64_tr_b16 v[72:73], v130 offset:49152
    v_mfma_f32_16x16x32_bf16 v[28:31], v[108:111], a[84:87], v[28:31]
    ds_read_b64_tr_b16 v[74:75], v130 offset:50176
    s_waitcnt lgkmcnt(12)
    v_mfma_f32_16x16x32_bf16 v[32:35], v[112:115], a[20:23], v[32:35]
    ds_read_b64_tr_b16 v[76:77], v131 offset:49152
    v_mfma_f32_16x16x32_bf16 v[36:39], v[112:115], a[84:87], v[36:39]
    ds_read_b64_tr_b16 v[78:79], v131 offset:50176
    s_waitcnt lgkmcnt(12)
    v_mfma_f32_16x16x32_bf16 v[40:43], v[116:119], a[20:23], v[40:43]
    ds_read_b64_tr_b16 v[80:81], v132 offset:49152
    v_mfma_f32_16x16x32_bf16 v[44:47], v[116:119], a[84:87], v[44:47]
    ds_read_b64_tr_b16 v[82:83], v132 offset:50176
    s_waitcnt lgkmcnt(12)
    v_mfma_f32_16x16x32_bf16 v[48:51], v[120:123], a[20:23], v[48:51]
    ds_read_b64_tr_b16 v[84:85], v133 offset:49152
    v_mfma_f32_16x16x32_bf16 v[52:55], v[120:123], a[84:87], v[52:55]
    ds_read_b64_tr_b16 v[86:87], v133 offset:50176
    s_waitcnt lgkmcnt(12)
    v_mfma_f32_16x16x32_bf16 v[56:59], v[124:127], a[20:23], v[56:59]
    ds_read_b64_tr_b16 v[88:89], v134 offset:49152
    v_mfma_f32_16x16x32_bf16 v[60:63], v[124:127], a[84:87], v[60:63]
    ds_read_b64_tr_b16 v[90:91], v134 offset:50176
    s_waitcnt lgkmcnt(12)
    v_mfma_f32_16x16x32_bf16 v[0:3], v[64:67], a[24:27], v[0:3]
    ds_read_b64_tr_b16 v[92:93], v135 offset:49152
    v_mfma_f32_16x16x32_bf16 v[4:7], v[64:67], a[88:91], v[4:7]
    ds_read_b64_tr_b16 v[94:95], v135 offset:50176
    s_waitcnt lgkmcnt(12)
    v_mfma_f32_16x16x32_bf16 v[8:11], v[68:71], a[24:27], v[8:11]
    ds_read_b64_tr_b16 v[96:97], v128 offset:57344
    v_mfma_f32_16x16x32_bf16 v[12:15], v[68:71], a[88:91], v[12:15]
    ds_read_b64_tr_b16 v[98:99], v128 offset:58368
    s_waitcnt lgkmcnt(12)
    v_mfma_f32_16x16x32_bf16 v[16:19], v[72:75], a[24:27], v[16:19]
    ds_read_b64_tr_b16 v[100:101], v129 offset:57344
    v_mfma_f32_16x16x32_bf16 v[20:23], v[72:75], a[88:91], v[20:23]
    ds_read_b64_tr_b16 v[102:103], v129 offset:58368
    s_waitcnt lgkmcnt(12)
    v_mfma_f32_16x16x32_bf16 v[24:27], v[76:79], a[24:27], v[24:27]
    ds_read_b64_tr_b16 v[104:105], v130 offset:57344
    v_mfma_f32_16x16x32_bf16 v[28:31], v[76:79], a[88:91], v[28:31]
    ds_read_b64_tr_b16 v[106:107], v130 offset:58368
    s_waitcnt lgkmcnt(12)
    v_mfma_f32_16x16x32_bf16 v[32:35], v[80:83], a[24:27], v[32:35]
    ds_read_b64_tr_b16 v[108:109], v131 offset:57344
    v_mfma_f32_16x16x32_bf16 v[36:39], v[80:83], a[88:91], v[36:39]
    ds_read_b64_tr_b16 v[110:111], v131 offset:58368
    s_waitcnt lgkmcnt(12)
    v_mfma_f32_16x16x32_bf16 v[40:43], v[84:87], a[24:27], v[40:43]
    ds_read_b64_tr_b16 v[112:113], v132 offset:57344
    v_mfma_f32_16x16x32_bf16 v[44:47], v[84:87], a[88:91], v[44:47]
    ds_read_b64_tr_b16 v[114:115], v132 offset:58368
    s_waitcnt lgkmcnt(12)
    v_mfma_f32_16x16x32_bf16 v[48:51], v[88:91], a[24:27], v[48:51]
    ds_read_b64_tr_b16 v[116:117], v133 offset:57344
    v_mfma_f32_16x16x32_bf16 v[52:55], v[88:91], a[88:91], v[52:55]
    ds_read_b64_tr_b16 v[118:119], v133 offset:58368
    s_waitcnt lgkmcnt(12)
    v_mfma_f32_16x16x32_bf16 v[56:59], v[92:95], a[24:27], v[56:59]
    ds_read_b64_tr_b16 v[120:121], v134 offset:57344
    v_mfma_f32_16x16x32_bf16 v[60:63], v[92:95], a[88:91], v[60:63]
    ds_read_b64_tr_b16 v[122:123], v134 offset:58368
    s_waitcnt lgkmcnt(12)
    v_mfma_f32_16x16x32_bf16 v[0:3], v[96:99], a[28:31], v[0:3]
    ds_read_b64_tr_b16 v[124:125], v135 offset:57344
    v_mfma_f32_16x16x32_bf16 v[4:7], v[96:99], a[92:95], v[4:7]
    ds_read_b64_tr_b16 v[126:127], v135 offset:58368
    s_waitcnt lgkmcnt(12)
    v_mfma_f32_16x16x32_bf16 v[8:11], v[100:103], a[28:31], v[8:11]
    v_mfma_f32_16x16x32_bf16 v[12:15], v[100:103], a[92:95], v[12:15]
    s_waitcnt lgkmcnt(10)
    v_mfma_f32_16x16x32_bf16 v[16:19], v[104:107], a[28:31], v[16:19]
    v_mfma_f32_16x16x32_bf16 v[20:23], v[104:107], a[92:95], v[20:23]
    s_waitcnt lgkmcnt(8)
    v_mfma_f32_16x16x32_bf16 v[24:27], v[108:111], a[28:31], v[24:27]
    v_mfma_f32_16x16x32_bf16 v[28:31], v[108:111], a[92:95], v[28:31]
    s_waitcnt lgkmcnt(6)
    v_mfma_f32_16x16x32_bf16 v[32:35], v[112:115], a[28:31], v[32:35]
    v_mfma_f32_16x16x32_bf16 v[36:39], v[112:115], a[92:95], v[36:39]
    s_waitcnt lgkmcnt(4)
    v_mfma_f32_16x16x32_bf16 v[40:43], v[116:119], a[28:31], v[40:43]
    v_mfma_f32_16x16x32_bf16 v[44:47], v[116:119], a[92:95], v[44:47]
    s_waitcnt lgkmcnt(2)
    v_mfma_f32_16x16x32_bf16 v[48:51], v[120:123], a[28:31], v[48:51]
    v_mfma_f32_16x16x32_bf16 v[52:55], v[120:123], a[92:95], v[52:55]
    s_waitcnt lgkmcnt(0)
    v_mfma_f32_16x16x32_bf16 v[56:59], v[124:127], a[28:31], v[56:59]
    v_mfma_f32_16x16x32_bf16 v[60:63], v[124:127], a[92:95], v[60:63]
    v_xor_b32 v128, 0x10000, v128
    v_xor_b32 v129, 0x10000, v129
    v_xor_b32 v130, 0x10000, v130
    v_xor_b32 v131, 0x10000, v131
    v_xor_b32 v132, 0x10000, v132
    v_xor_b32 v133, 0x10000, v133
    v_xor_b32 v134, 0x10000, v134
    v_xor_b32 v135, 0x10000, v135
    s_waitcnt vmcnt(16)
    s_barrier
    ds_read_b64_tr_b16 v[64:65], v128
    ds_read_b64_tr_b16 v[66:67], v128 offset:1024
    ds_read_b64_tr_b16 v[68:69], v129
    ds_read_b64_tr_b16 v[70:71], v129 offset:1024
    ds_read_b64_tr_b16 v[72:73], v130
    ds_read_b64_tr_b16 v[74:75], v130 offset:1024
    ds_read_b64_tr_b16 v[76:77], v131
    ds_read_b64_tr_b16 v[78:79], v131 offset:1024
    ds_read_b64_tr_b16 v[80:81], v132
    ds_read_b64_tr_b16 v[82:83], v132 offset:1024
    ds_read_b64_tr_b16 v[84:85], v133
    ds_read_b64_tr_b16 v[86:87], v133 offset:1024
    ds_read_b64_tr_b16 v[88:89], v134
    ds_read_b64_tr_b16 v[90:91], v134 offset:1024
    s_cmp_eq_u32 s40, 0
    s_cbranch_scc1 L_nopf_90
    s_cmp_lg_u32 s87, 0
    s_cbranch_scc1 L_modeok_91
    v_readfirstlane_b32 s96, v140
    v_readfirstlane_b32 s97, v141
    s_nop 0
    s_cmp_lg_u32 s97, 0
    s_cselect_b32 s87, s96, 0
    s_cmp_eq_u32 s87, 1
    s_cbranch_scc1 L_modeok_91
    s_mov_b32 s96, 0
L_mode_92:
    buffer_load_dwordx2 v[140:141], off, s[92:95], 0 offset:36 sc1
    s_waitcnt vmcnt(0)
    v_readfirstlane_b32 s87, v140
    v_readfirstlane_b32 s97, v141
    s_nop 0
    s_min_u32 s97, s97, s87
    s_cmp_lg_u32 s97, 0
    s_cbranch_scc1 L_moded_93
    s_sleep 4
    s_add_u32 s96, s96, 1
    s_cmp_lg_u32 s96, 0x100
    s_cbranch_scc1 L_modef_94
    v_mov_b32 v140, 2
    v_mov_b32 v141, 0
    s_mov_b64 exec, 1
    buffer_atomic_cmpswap v[140:141], off, s[92:95], 0 offset:36
    s_mov_b64 exec, -1
L_modef_94:
    s_cmp_lt_u32 s96, 0x10000
    s_cbranch_scc1 L_mode_92
L_moded_93:
    s_cmp_lg_u32 s87, 1
    s_cbranch_scc1 L_fallback
L_modeok_91:
    s_cmp_lg_u32 s100, 0
    s_cbranch_scc1 L_flag_95
    v_mov_b32 v138, 1
    s_mov_b64 exec, 1
    buffer_store_dword v138, off, s[8:11], s40 sc1
    s_mov_b64 exec, -1
L_flag_95:
    s_mov_b32 s40, 0
L_nopf_90:
    s_waitcnt lgkmcnt(12)
    v_mfma_f32_16x16x32_bf16 v[0:3], v[64:67], a[32:35], v[0:3]
    ds_read_b64_tr_b16 v[92:93], v135
    v_mfma_f32_16x16x32_bf16 v[4:7], v[64:67], a[96:99], v[4:7]
    ds_read_b64_tr_b16 v[94:95], v135 offset:1024
    s_add_u32 s26, s24, 0x100000
    s_add_u32 m0, s29, 0x8000
    s_nop 0
    buffer_load_dwordx4 v136, s[16:19], s26 offen lds
    s_waitcnt lgkmcnt(12)
    v_mfma_f32_16x16x32_bf16 v[8:11], v[68:71], a[32:35], v[8:11]
    ds_read_b64_tr_b16 v[96:97], v128 offset:8192
    v_mfma_f32_16x16x32_bf16 v[12:15], v[68:71], a[96:99], v[12:15]
    ds_read_b64_tr_b16 v[98:99], v128 offset:9216
    s_add_u32 s26, s24, 0x120000
    s_add_u32 m0, s29, 0x9000
    s_nop 0
    buffer_load_dwordx4 v136, s[16:19], s26 offen lds
    s_waitcnt lgkmcnt(12)
    v_mfma_f32_16x16x32_bf16 v[16:19], v[72:75], a[32:35], v[16:19]
    ds_read_b64_tr_b16 v[100:101], v129 offset:8192
    v_mfma_f32_16x16x32_bf16 v[20:23], v[72:75], a[96:99], v[20:23]
    ds_read_b64_tr_b16 v[102:103], v129 offset:9216
    s_add_u32 s26, s24, 0x140000
    s_add_u32 m0, s29, 0xa000
    s_nop 0
    buffer_load_dwordx4 v136, s[16:19], s26 offen lds
    s_waitcnt lgkmcnt(12)
    v_mfma_f32_16x16x32_bf16 v[24:27], v[76:79], a[32:35], v[24:27]
    ds_read_b64_tr_b16 v[104:105], v130 offset:8192
    v_mfma_f32_16x16x32_bf16 v[28:31], v[76:79], a[96:99], v[28:31]
    ds_read_b64_tr_b16 v[106:107], v130 offset:9216
    s_add_u32 s26, s24, 0x160000
    s_add_u32 m0, s29, 0xb000
    s_nop 0
    buffer_load_dwordx4 v136, s[16:19], s26 offen lds
    s_waitcnt lgkmcnt(12)
    v_mfma_f32_16x16x32_bf16 v[32:35], v[80:83], a[32:35], v[32:35]
    ds_read_b64_tr_b16 v[108:109], v131 offset:8192
    v_mfma_f32_16x16x32_bf16 v[36:39], v[80:83], a[96:99], v[36:39]
    ds_read_b64_tr_b16 v[110:111], v131 offset:9216
    s_add_u32 s26, s24, 0x180000
    s_add_u32 m0, s29, 0xc000
    s_nop 0
    buffer_load_dwordx4 v136, s[16:19], s26 offen lds
    s_waitcnt lgkmcnt(12)
    v_mfma_f32_16x16x32_bf16 v[40:43], v[84:87], a[32:35], v[40:43]
    ds_read_b64_tr_b16 v[112:113], v132 offset:8192
    v_mfma_f32_16x16x32_bf16 v[44:47], v[84:87], a[96:99], v[44:47]
    ds_read_b64_tr_b16 v[114:115], v132 offset:9216
    s_add_u32 s26, s24, 0x1a0000
    s_add_u32 m0, s29, 0xd000
    s_nop 0
    buffer_load_dwordx4 v136, s[16:19], s26 offen lds
    s_waitcnt lgkmcnt(12)
    v_mfma_f32_16x16x32_bf16 v[48:51], v[88:91], a[32:35], v[48:51]
    ds_read_b64_tr_b16 v[116:117], v133 offset:8192
    v_mfma_f32_16x16x32_bf16 v[52:55], v[88:91], a[96:99], v[52:55]
    ds_read_b64_tr_b16 v[118:119], v133 offset:9216
    s_add_u32 s26, s24, 0x1c0000
    s_add_u32 m0, s29, 0xe000
    s_nop 0
    buffer_load_dwordx4 v136, s[16:19], s26 offen lds
    s_waitcnt lgkmcnt(12)
    v_mfma_f32_16x16x32_bf16 v[56:59], v[92:95], a[32:35], v[56:59]
    ds_read_b64_tr_b16 v[120:121], v134 offset:8192
    v_mfma_f32_16x16x32_bf16 v[60:63], v[92:95], a[96:99], v[60:63]
    ds_read_b64_tr_b16 v[122:123], v134 offset:9216
    s_add_u32 s26, s24, 0x1e0000
    s_add_u32 m0, s29, 0xf000
    s_nop 0
    buffer_load_dwordx4 v136, s[16:19], s26 offen lds
    s_waitcnt lgkmcnt(12)
    v_mfma_f32_16x16x32_bf16 v[0:3], v[96:99], a[36:39], v[0:3]
    ds_read_b64_tr_b16 v[124:125], v135 offset:8192
    v_mfma_f32_16x16x32_bf16 v[4:7], v[96:99], a[100:103], v[4:7]
    ds_read_b64_tr_b16 v[126:127], v135 offset:9216
    s_waitcnt lgkmcnt(12)
    v_mfma_f32_16x16x32_bf16 v[8:11], v[100:103], a[36:39], v[8:11]
    ds_read_b64_tr_b16 v[64:65], v128 offset:16384
    v_mfma_f32_16x16x32_bf16 v[12:15], v[100:103], a[100:103], v[12:15]
    ds_read_b64_tr_b16 v[66:67], v128 offset:17408
    s_waitcnt lgkmcnt(12)
    v_mfma_f32_16x16x32_bf16 v[16:19], v[104:107], a[36:39], v[16:19]
    ds_read_b64_tr_b16 v[68:69], v129 offset:16384
    v_mfma_f32_16x16x32_bf16 v[20:23], v[104:107], a[100:103], v[20:23]
    ds_read_b64_tr_b16 v[70:71], v129 offset:17408
    s_waitcnt lgkmcnt(12)
    v_mfma_f32_16x16x32_bf16 v[24:27], v[108:111], a[36:39], v[24:27]
    ds_read_b64_tr_b16 v[72:73], v130 offset:16384
    v_mfma_f32_16x16x32_bf16 v[28:31], v[108:111], a[100:103], v[28:31]
    ds_read_b64_tr_b16 v[74:75], v130 offset:17408
    s_waitcnt lgkmcnt(12)
    v_mfma_f32_16x16x32_bf16 v[32:35], v[112:115], a[36:39], v[32:35]
    ds_read_b64_tr_b16 v[76:77], v131 offset:16384
    v_mfma_f32_16x16x32_bf16 v[36:39], v[112:115], a[100:103], v[36:39]
    ds_read_b64_tr_b16 v[78:79], v131 offset:17408
    s_waitcnt lgkmcnt(12)
    v_mfma_f32_16x16x32_bf16 v[40:43], v[116:119], a[36:39], v[40:43]
    ds_read_b64_tr_b16 v[80:81], v132 offset:16384
    v_mfma_f32_16x16x32_bf16 v[44:47], v[116:119], a[100:103], v[44:47]
    ds_read_b64_tr_b16 v[82:83], v132 offset:17408
    s_waitcnt lgkmcnt(12)
    v_mfma_f32_16x16x32_bf16 v[48:51], v[120:123], a[36:39], v[48:51]
    ds_read_b64_tr_b16 v[84:85], v133 offset:16384
    v_mfma_f32_16x16x32_bf16 v[52:55], v[120:123], a[100:103], v[52:55]
    ds_read_b64_tr_b16 v[86:87], v133 offset:17408
    s_waitcnt lgkmcnt(12)
    v_mfma_f32_16x16x32_bf16 v[56:59], v[124:127], a[36:39], v[56:59]
    ds_read_b64_tr_b16 v[88:89], v134 offset:16384
    v_mfma_f32_16x16x32_bf16 v[60:63], v[124:127], a[100:103], v[60:63]
    ds_read_b64_tr_b16 v[90:91], v134 offset:17408
    s_waitcnt lgkmcnt(12)
    v_mfma_f32_16x16x32_bf16 v[0:3], v[64:67], a[40:43], v[0:3]
    ds_read_b64_tr_b16 v[92:93], v135 offset:16384
    v_mfma_f32_16x16x32_bf16 v[4:7], v[64:67], a[104:107], v[4:7]
    ds_read_b64_tr_b16 v[94:95], v135 offset:17408
    s_waitcnt lgkmcnt(12)
    v_mfma_f32_16x16x32_bf16 v[8:11], v[68:71], a[40:43], v[8:11]
    ds_read_b64_tr_b16 v[96:97], v128 offset:24576
    v_mfma_f32_16x16x32_bf16 v[12:15], v[68:71], a[104:107], v[12:15]
    ds_read_b64_tr_b16 v[98:99], v128 offset:25600
    s_waitcnt lgkmcnt(12)
    v_mfma_f32_16x16x32_bf16 v[16:19], v[72:75], a[40:43], v[16:19]
    ds_read_b64_tr_b16 v[100:101], v129 offset:24576
    v_mfma_f32_16x16x32_bf16 v[20:23], v[72:75], a[104:107], v[20:23]
    ds_read_b64_tr_b16 v[102:103], v129 offset:25600
    s_waitcnt lgkmcnt(12)
    v_mfma_f32_16x16x32_bf16 v[24:27], v[76:79], a[40:43], v[24:27]
    ds_read_b64_tr_b16 v[104:105], v130 offset:24576
    v_mfma_f32_16x16x32_bf16 v[28:31], v[76:79], a[104:107], v[28:31]
    ds_read_b64_tr_b16 v[106:107], v130 offset:25600
    s_waitcnt lgkmcnt(12)
    v_mfma_f32_16x16x32_bf16 v[32:35], v[80:83], a[40:43], v[32:35]
    ds_read_b64_tr_b16 v[108:109], v131 offset:24576
    v_mfma_f32_16x16x32_bf16 v[36:39], v[80:83], a[104:107], v[36:39]
    ds_read_b64_tr_b16 v[110:111], v131 offset:25600
    s_waitcnt lgkmcnt(12)
    v_mfma_f32_16x16x32_bf16 v[40:43], v[84:87], a[40:43], v[40:43]
    ds_read_b64_tr_b16 v[112:113], v132 offset:24576
    v_mfma_f32_16x16x32_bf16 v[44:47], v[84:87], a[104:107], v[44:47]
    ds_read_b64_tr_b16 v[114:115], v132 offset:25600
    s_waitcnt lgkmcnt(12)
    v_mfma_f32_16x16x32_bf16 v[48:51], v[88:91], a[40:43], v[48:51]
    ds_read_b64_tr_b16 v[116:117], v133 offset:24576
    v_mfma_f32_16x16x32_bf16 v[52:55], v[88:91], a[104:107], v[52:55]
    ds_read_b64_tr_b16 v[118:119], v133 offset:25600
    s_waitcnt lgkmcnt(12)
    v_mfma_f32_16x16x32_bf16 v[56:59], v[92:95], a[40:43], v[56:59]
    ds_read_b64_tr_b16 v[120:121], v134 offset:24576
    v_mfma_f32_16x16x32_bf16 v[60:63], v[92:95], a[104:107], v[60:63]
    ds_read_b64_tr_b16 v[122:123], v134 offset:25600
    s_waitcnt lgkmcnt(12)
    v_mfma_f32_16x16x32_bf16 v[0:3], v[96:99], a[44:47], v[0:3]
    ds_read_b64_tr_b16 v[124:125], v135 offset:24576
    v_mfma_f32_16x16x32_bf16 v[4:7], v[96:99], a[108:111], v[4:7]
    ds_read_b64_tr_b16 v[126:127], v135 offset:25600
    s_waitcnt lgkmcnt(12)
    v_mfma_f32_16x16x32_bf16 v[8:11], v[100:103], a[44:47], v[8:11]
    v_mfma_f32_16x16x32_bf16 v[12:15], v[100:103], a[108:111], v[12:15]
    s_waitcnt lgkmcnt(10)
    v_mfma_f32_16x16x32_bf16 v[16:19], v[104:107], a[44:47], v[16:19]
    v_mfma_f32_16x16x32_bf16 v[20:23], v[104:107], a[108:111], v[20:23]
    s_waitcnt lgkmcnt(8)
    v_mfma_f32_16x16x32_bf16 v[24:27], v[108:111], a[44:47], v[24:27]
    v_mfma_f32_16x16x32_bf16 v[28:31], v[108:111], a[108:111], v[28:31]
    s_waitcnt lgkmcnt(6)
    v_mfma_f32_16x16x32_bf16 v[32:35], v[112:115], a[44:47], v[32:35]
    v_mfma_f32_16x16x32_bf16 v[36:39], v[112:115], a[108:111], v[36:39]
    s_waitcnt lgkmcnt(4)
    v_mfma_f32_16x16x32_bf16 v[40:43], v[116:119], a[44:47], v[40:43]
    v_mfma_f32_16x16x32_bf16 v[44:47], v[116:119], a[108:111], v[44:47]
    s_waitcnt lgkmcnt(2)
    v_mfma_f32_16x16x32_bf16 v[48:51], v[120:123], a[44:47], v[48:51]
    v_mfma_f32_16x16x32_bf16 v[52:55], v[120:123], a[108:111], v[52:55]
    s_waitcnt lgkmcnt(0)
    v_mfma_f32_16x16x32_bf16 v[56:59], v[124:127], a[44:47], v[56:59]
    v_mfma_f32_16x16x32_bf16 v[60:63], v[124:127], a[108:111], v[60:63]
    s_waitcnt vmcnt(16)
    s_barrier
    ds_read_b64_tr_b16 v[64:65], v128 offset:32768
    ds_read_b64_tr_b16 v[66:67], v128 offset:33792
    ds_read_b64_tr_b16 v[68:69], v129 offset:32768
    ds_read_b64_tr_b16 v[70:71], v129 offset:33792
    ds_read_b64_tr_b16 v[72:73], v130 offset:32768
    ds_read_b64_tr_b16 v[74:75], v130 offset:33792
    ds_read_b64_tr_b16 v[76:77], v131 offset:32768
    ds_read_b64_tr_b16 v[78:79], v131 offset:33792
    ds_read_b64_tr_b16 v[80:81], v132 offset:32768
    ds_read_b64_tr_b16 v[82:83], v132 offset:33792
    ds_read_b64_tr_b16 v[84:85], v133 offset:32768
    ds_read_b64_tr_b16 v[86:87], v133 offset:33792
    ds_read_b64_tr_b16 v[88:89], v134 offset:32768
    ds_read_b64_tr_b16 v[90:91], v134 offset:33792
    s_waitcnt lgkmcnt(12)
    v_mfma_f32_16x16x32_bf16 v[0:3], v[64:67], a[48:51], v[0:3]
    ds_read_b64_tr_b16 v[92:93], v135 offset:32768
    v_mfma_f32_16x16x32_bf16 v[4:7], v[64:67], a[112:115], v[4:7]
    ds_read_b64_tr_b16 v[94:95], v135 offset:33792
    s_add_u32 s26, s24, 0x200000
    s_add_u32 m0, s29, 0x10000
    s_nop 0
    buffer_load_dwordx4 v136, s[16:19], s26 offen lds
    s_waitcnt lgkmcnt(12)
    v_mfma_f32_16x16x32_bf16 v[8:11], v[68:71], a[48:51], v[8:11]
    ds_read_b64_tr_b16 v[96:97], v128 offset:40960
    v_mfma_f32_16x16x32_bf16 v[12:15], v[68:71], a[112:115], v[12:15]
    ds_read_b64_tr_b16 v[98:99], v128 offset:41984
    s_add_u32 s26, s24, 0x220000
    s_add_u32 m0, s29, 0x11000
    s_nop 0
    buffer_load_dwordx4 v136, s[16:19], s26 offen lds
    s_waitcnt lgkmcnt(12)
    v_mfma_f32_16x16x32_bf16 v[16:19], v[72:75], a[48:51], v[16:19]
    ds_read_b64_tr_b16 v[100:101], v129 offset:40960
    v_mfma_f32_16x16x32_bf16 v[20:23], v[72:75], a[112:115], v[20:23]
    ds_read_b64_tr_b16 v[102:103], v129 offset:41984
    s_add_u32 s26, s24, 0x240000
    s_add_u32 m0, s29, 0x12000
    s_nop 0
    buffer_load_dwordx4 v136, s[16:19], s26 offen lds
    s_waitcnt lgkmcnt(12)
    v_mfma_f32_16x16x32_bf16 v[24:27], v[76:79], a[48:51], v[24:27]
    ds_read_b64_tr_b16 v[104:105], v130 offset:40960
    v_mfma_f32_16x16x32_bf16 v[28:31], v[76:79], a[112:115], v[28:31]
    ds_read_b64_tr_b16 v[106:107], v130 offset:41984
    s_add_u32 s26, s24, 0x260000
    s_add_u32 m0, s29, 0x13000
    s_nop 0
    buffer_load_dwordx4 v136, s[16:19], s26 offen lds
    s_waitcnt lgkmcnt(12)
    v_mfma_f32_16x16x32_bf16 v[32:35], v[80:83], a[48:51], v[32:35]
    ds_read_b64_tr_b16 v[108:109], v131 offset:40960
    v_mfma_f32_16x16x32_bf16 v[36:39], v[80:83], a[112:115], v[36:39]
    ds_read_b64_tr_b16 v[110:111], v131 offset:41984
    s_add_u32 s26, s24, 0x280000
    s_add_u32 m0, s29, 0x14000
    s_nop 0
    buffer_load_dwordx4 v136, s[16:19], s26 offen lds
    s_waitcnt lgkmcnt(12)
    v_mfma_f32_16x16x32_bf16 v[40:43], v[84:87], a[48:51], v[40:43]
    ds_read_b64_tr_b16 v[112:113], v132 offset:40960
    v_mfma_f32_16x16x32_bf16 v[44:47], v[84:87], a[112:115], v[44:47]
    ds_read_b64_tr_b16 v[114:115], v132 offset:41984
    s_add_u32 s26, s24, 0x2a0000
    s_add_u32 m0, s29, 0x15000
    s_nop 0
    buffer_load_dwordx4 v136, s[16:19], s26 offen lds
    s_waitcnt lgkmcnt(12)
    v_mfma_f32_16x16x32_bf16 v[48:51], v[88:91], a[48:51], v[48:51]
    ds_read_b64_tr_b16 v[116:117], v133 offset:40960
    v_mfma_f32_16x16x32_bf16 v[52:55], v[88:91], a[112:115], v[52:55]
    ds_read_b64_tr_b16 v[118:119], v133 offset:41984
    s_add_u32 s26, s24, 0x2c0000
    s_add_u32 m0, s29, 0x16000
    s_nop 0
    buffer_load_dwordx4 v136, s[16:19], s26 offen lds
    s_waitcnt lgkmcnt(12)
    v_mfma_f32_16x16x32_bf16 v[56:59], v[92:95], a[48:51], v[56:59]
    ds_read_b64_tr_b16 v[120:121], v134 offset:40960
    v_mfma_f32_16x16x32_bf16 v[60:63], v[92:95], a[112:115], v[60:63]
    ds_read_b64_tr_b16 v[122:123], v134 offset:41984
    s_add_u32 s26, s24, 0x2e0000
    s_add_u32 m0, s29, 0x17000
    s_nop 0
    buffer_load_dwordx4 v136, s[16:19], s26 offen lds
    s_waitcnt lgkmcnt(12)
    v_mfma_f32_16x16x32_bf16 v[0:3], v[96:99], a[52:55], v[0:3]
    ds_read_b64_tr_b16 v[124:125], v135 offset:40960
    v_mfma_f32_16x16x32_bf16 v[4:7], v[96:99], a[116:119], v[4:7]
    ds_read_b64_tr_b16 v[126:127], v135 offset:41984
    s_waitcnt lgkmcnt(12)
    v_mfma_f32_16x16x32_bf16 v[8:11], v[100:103], a[52:55], v[8:11]
    ds_read_b64_tr_b16 v[64:65], v128 offset:49152
    v_mfma_f32_16x16x32_bf16 v[12:15], v[100:103], a[116:119], v[12:15]
    ds_read_b64_tr_b16 v[66:67], v128 offset:50176
    s_waitcnt lgkmcnt(12)
    v_mfma_f32_16x16x32_bf16 v[16:19], v[104:107], a[52:55], v[16:19]
    ds_read_b64_tr_b16 v[68:69], v129 offset:49152
    v_mfma_f32_16x16x32_bf16 v[20:23], v[104:107], a[116:119], v[20:23]
    ds_read_b64_tr_b16 v[70:71], v129 offset:50176
    s_waitcnt lgkmcnt(12)
    v_mfma_f32_16x16x32_bf16 v[24:27], v[108:111], a[52:55], v[24:27]
    ds_read_b64_tr_b16 v[72:73], v130 offset:49152
    v_mfma_f32_16x16x32_bf16 v[28:31], v[108:111], a[116:119], v[28:31]
    ds_read_b64_tr_b16 v[74:75], v130 offset:50176
    s_waitcnt lgkmcnt(12)
    v_mfma_f32_16x16x32_bf16 v[32:35], v[112:115], a[52:55], v[32:35]
    ds_read_b64_tr_b16 v[76:77], v131 offset:49152
    v_mfma_f32_16x16x32_bf16 v[36:39], v[112:115], a[116:119], v[36:39]
    ds_read_b64_tr_b16 v[78:79], v131 offset:50176
    s_waitcnt lgkmcnt(12)
    v_mfma_f32_16x16x32_bf16 v[40:43], v[116:119], a[52:55], v[40:43]
    ds_read_b64_tr_b16 v[80:81], v132 offset:49152
    v_mfma_f32_16x16x32_bf16 v[44:47], v[116:119], a[116:119], v[44:47]
    ds_read_b64_tr_b16 v[82:83], v132 offset:50176
    s_waitcnt lgkmcnt(12)
    v_mfma_f32_16x16x32_bf16 v[48:51], v[120:123], a[52:55], v[48:51]
    ds_read_b64_tr_b16 v[84:85], v133 offset:49152
    v_mfma_f32_16x16x32_bf16 v[52:55], v[120:123], a[116:119], v[52:55]
    ds_read_b64_tr_b16 v[86:87], v133 offset:50176
    s_waitcnt lgkmcnt(12)
    v_mfma_f32_16x16x32_bf16 v[56:59], v[124:127], a[52:55], v[56:59]
    ds_read_b64_tr_b16 v[88:89], v134 offset:49152
    v_mfma_f32_16x16x32_bf16 v[60:63], v[124:127], a[116:119], v[60:63]
    ds_read_b64_tr_b16 v[90:91], v134 offset:50176
    s_waitcnt lgkmcnt(12)
    v_mfma_f32_16x16x32_bf16 v[0:3], v[64:67], a[56:59], v[0:3]
    ds_read_b64_tr_b16 v[92:93], v135 offset:49152
    v_mfma_f32_16x16x32_bf16 v[4:7], v[64:67], a[120:123], v[4:7]
    ds_read_b64_tr_b16 v[94:95], v135 offset:50176
    s_waitcnt lgkmcnt(12)
    v_mfma_f32_16x16x32_bf16 v[8:11], v[68:71], a[56:59], v[8:11]
    ds_read_b64_tr_b16 v[96:97], v128 offset:57344
    v_mfma_f32_16x16x32_bf16 v[12:15], v[68:71], a[120:123], v[12:15]
    ds_read_b64_tr_b16 v[98:99], v128 offset:58368
    s_waitcnt lgkmcnt(12)
    v_mfma_f32_16x16x32_bf16 v[16:19], v[72:75], a[56:59], v[16:19]
    ds_read_b64_tr_b16 v[100:101], v129 offset:57344
    v_mfma_f32_16x16x32_bf16 v[20:23], v[72:75], a[120:123], v[20:23]
    ds_read_b64_tr_b16 v[102:103], v129 offset:58368
    s_waitcnt lgkmcnt(12)
    v_mfma_f32_16x16x32_bf16 v[24:27], v[76:79], a[56:59], v[24:27]
    ds_read_b64_tr_b16 v[104:105], v130 offset:57344
    v_mfma_f32_16x16x32_bf16 v[28:31], v[76:79], a[120:123], v[28:31]
    ds_read_b64_tr_b16 v[106:107], v130 offset:58368
    s_waitcnt lgkmcnt(12)
    v_mfma_f32_16x16x32_bf16 v[32:35], v[80:83], a[56:59], v[32:35]
    ds_read_b64_tr_b16 v[108:109], v131 offset:57344
    v_mfma_f32_16x16x32_bf16 v[36:39], v[80:83], a[120:123], v[36:39]
    ds_read_b64_tr_b16 v[110:111], v131 offset:58368
    s_waitcnt lgkmcnt(12)
    v_mfma_f32_16x16x32_bf16 v[40:43], v[84:87], a[56:59], v[40:43]
    ds_read_b64_tr_b16 v[112:113], v132 offset:57344
    v_mfma_f32_16x16x32_bf16 v[44:47], v[84:87], a[120:123], v[44:47]
    ds_read_b64_tr_b16 v[114:115], v132 offset:58368
    s_waitcnt lgkmcnt(12)
    v_mfma_f32_16x16x32_bf16 v[48:51], v[88:91], a[56:59], v[48:51]
    ds_read_b64_tr_b16 v[116:117], v133 offset:57344
    v_mfma_f32_16x16x32_bf16 v[52:55], v[88:91], a[120:123], v[52:55]
    ds_read_b64_tr_b16 v[118:119], v133 offset:58368
    s_waitcnt lgkmcnt(12)
    v_mfma_f32_16x16x32_bf16 v[56:59], v[92:95], a[56:59], v[56:59]
    ds_read_b64_tr_b16 v[120:121], v134 offset:57344
    v_mfma_f32_16x16x32_bf16 v[60:63], v[92:95], a[120:123], v[60:63]
    ds_read_b64_tr_b16 v[122:123], v134 offset:58368
    s_waitcnt lgkmcnt(12)
    v_mfma_f32_16x16x32_bf16 v[0:3], v[96:99], a[60:63], v[0:3]
    ds_read_b64_tr_b16 v[124:125], v135 offset:57344
    v_mfma_f32_16x16x32_bf16 v[4:7], v[96:99], a[124:127], v[4:7]
    ds_read_b64_tr_b16 v[126:127], v135 offset:58368
    s_waitcnt lgkmcnt(12)
    v_mfma_f32_16x16x32_bf16 v[8:11], v[100:103], a[60:63], v[8:11]
    v_mfma_f32_16x16x32_bf16 v[12:15], v[100:103], a[124:127], v[12:15]
    s_waitcnt lgkmcnt(10)
    v_mfma_f32_16x16x32_bf16 v[16:19], v[104:107], a[60:63], v[16:19]
    v_mfma_f32_16x16x32_bf16 v[20:23], v[104:107], a[124:127], v[20:23]
    s_waitcnt lgkmcnt(8)
    v_mfma_f32_16x16x32_bf16 v[24:27], v[108:111], a[60:63], v[24:27]
    v_mfma_f32_16x16x32_bf16 v[28:31], v[108:111], a[124:127], v[28:31]
    s_waitcnt lgkmcnt(6)
    v_mfma_f32_16x16x32_bf16 v[32:35], v[112:115], a[60:63], v[32:35]
    v_mfma_f32_16x16x32_bf16 v[36:39], v[112:115], a[124:127], v[36:39]
    s_waitcnt lgkmcnt(4)
    v_mfma_f32_16x16x32_bf16 v[40:43], v[116:119], a[60:63], v[40:43]
    v_mfma_f32_16x16x32_bf16 v[44:47], v[116:119], a[124:127], v[44:47]
    s_waitcnt lgkmcnt(2)
    v_mfma_f32_16x16x32_bf16 v[48:51], v[120:123], a[60:63], v[48:51]
    v_mfma_f32_16x16x32_bf16 v[52:55], v[120:123], a[124:127], v[52:55]
    s_waitcnt lgkmcnt(0)
    v_mfma_f32_16x16x32_bf16 v[56:59], v[124:127], a[60:63], v[56:59]
    v_mfma_f32_16x16x32_bf16 v[60:63], v[124:127], a[124:127], v[60:63]
    v_xor_b32 v128, 0x10000, v128
    v_xor_b32 v129, 0x10000, v129
    v_xor_b32 v130, 0x10000, v130
    v_xor_b32 v131, 0x10000, v131
    v_xor_b32 v132, 0x10000, v132
    v_xor_b32 v133, 0x10000, v133
    v_xor_b32 v134, 0x10000, v134
    v_xor_b32 v135, 0x10000, v135
    v_cvt_pk_bf16_f32 v144, v0, v8
    v_cvt_pk_bf16_f32 v145, v1, v9
    v_cvt_pk_bf16_f32 v146, v2, v10
    v_cvt_pk_bf16_f32 v147, v3, v11
    buffer_store_dwordx4 v[144:147], v137, s[8:11], s25 offen sc1
    v_cvt_pk_bf16_f32 v148, v16, v24
    v_cvt_pk_bf16_f32 v149, v17, v25
    v_cvt_pk_bf16_f32 v150, v18, v26
    v_cvt_pk_bf16_f32 v151, v19, v27
    buffer_store_dwordx4 v[148:151], v137, s[8:11], s25 offen offset:1024 sc1
    v_cvt_pk_bf16_f32 v152, v32, v40
    v_cvt_pk_bf16_f32 v153, v33, v41
    v_cvt_pk_bf16_f32 v154, v34, v42
    v_cvt_pk_bf16_f32 v155, v35, v43
    buffer_store_dwordx4 v[152:155], v137, s[8:11], s25 offen offset:2048 sc1
    v_cvt_pk_bf16_f32 v156, v48, v56
    v_cvt_pk_bf16_f32 v157, v49, v57
    v_cvt_pk_bf16_f32 v158, v50, v58
    v_cvt_pk_bf16_f32 v159, v51, v59
    buffer_store_dwordx4 v[156:159], v137, s[8:11], s25 offen offset:3072 sc1
    v_cvt_pk_bf16_f32 v144, v4, v12
    v_cvt_pk_bf16_f32 v145, v5, v13
    v_cvt_pk_bf16_f32 v146, v6, v14
    v_cvt_pk_bf16_f32 v147, v7, v15
    s_add_u32 s25, s25, 4096
    buffer_store_dwordx4 v[144:147], v137, s[8:11], s25 offen sc1
    v_cvt_pk_bf16_f32 v148, v20, v28
    v_cvt_pk_bf16_f32 v149, v21, v29
    v_cvt_pk_bf16_f32 v150, v22, v30
    v_cvt_pk_bf16_f32 v151, v23, v31
    buffer_store_dwordx4 v[148:151], v137, s[8:11], s25 offen offset:1024 sc1
    v_cvt_pk_bf16_f32 v152, v36, v44
    v_cvt_pk_bf16_f32 v153, v37, v45
    v_cvt_pk_bf16_f32 v154, v38, v46
    v_cvt_pk_bf16_f32 v155, v39, v47
    buffer_store_dwordx4 v[152:155], v137, s[8:11], s25 offen offset:2048 sc1
    v_cvt_pk_bf16_f32 v156, v52, v60
    v_cvt_pk_bf16_f32 v157, v53, v61
    v_cvt_pk_bf16_f32 v158, v54, v62
    v_cvt_pk_bf16_f32 v159, v55, v63
    buffer_store_dwordx4 v[156:159], v137, s[8:11], s25 offen offset:3072 sc1
    s_branch L_p1_next
L_p1_v:
    s_waitcnt vmcnt(16)
    s_barrier
    ds_read_b64_tr_b16 v[64:65], v128
    ds_read_b64_tr_b16 v[66:67], v128 offset:1024
    ds_read_b64_tr_b16 v[68:69], v129
    ds_read_b64_tr_b16 v[70:71], v129 offset:1024
    ds_read_b64_tr_b16 v[72:73], v130
    ds_read_b64_tr_b16 v[74:75], v130 offset:1024
    ds_read_b64_tr_b16 v[76:77], v131
    ds_read_b64_tr_b16 v[78:79], v131 offset:1024
    ds_read_b64_tr_b16 v[80:81], v132
    ds_read_b64_tr_b16 v[82:83], v132 offset:1024
    ds_read_b64_tr_b16 v[84:85], v133
    ds_read_b64_tr_b16 v[86:87], v133 offset:1024
    ds_read_b64_tr_b16 v[88:89], v134
    ds_read_b64_tr_b16 v[90:91], v134 offset:1024
    s_waitcnt lgkmcnt(12)
    v_mfma_f32_16x16x32_bf16 v[0:3], a[0:3], v[64:67], 0
    ds_read_b64_tr_b16 v[92:93], v135
    v_mfma_f32_16x16x32_bf16 v[4:7], a[64:67], v[64:67], 0
    ds_read_b64_tr_b16 v[94:95], v135 offset:1024
    s_add_u32 s26, s24, 0x300000
    s_add_u32 m0, s29, 0x18000
    s_nop 0
    buffer_load_dwordx4 v136, s[16:19], s26 offen lds
    s_waitcnt lgkmcnt(12)
    v_mfma_f32_16x16x32_bf16 v[8:11], a[0:3], v[68:71], 0
    ds_read_b64_tr_b16 v[96:97], v128 offset:8192
    v_mfma_f32_16x16x32_bf16 v[12:15], a[64:67], v[68:71], 0
    ds_read_b64_tr_b16 v[98:99], v128 offset:9216
    s_add_u32 s26, s24, 0x320000
    s_add_u32 m0, s29, 0x19000
    s_nop 0
    buffer_load_dwordx4 v136, s[16:19], s26 offen lds
    s_waitcnt lgkmcnt(12)
    v_mfma_f32_16x16x32_bf16 v[16:19], a[0:3], v[72:75], 0
    ds_read_b64_tr_b16 v[100:101], v129 offset:8192
    v_mfma_f32_16x16x32_bf16 v[20:23], a[64:67], v[72:75], 0
    ds_read_b64_tr_b16 v[102:103], v129 offset:9216
    s_add_u32 s26, s24, 0x340000
    s_add_u32 m0, s29, 0x1a000
    s_nop 0
    buffer_load_dwordx4 v136, s[16:19], s26 offen lds
    s_waitcnt lgkmcnt(12)
    v_mfma_f32_16x16x32_bf16 v[24:27], a[0:3], v[76:79], 0
    ds_read_b64_tr_b16 v[104:105], v130 offset:8192
    v_mfma_f32_16x16x32_bf16 v[28:31], a[64:67], v[76:79], 0
    ds_read_b64_tr_b16 v[106:107], v130 offset:9216
    s_add_u32 s26, s24, 0x360000
    s_add_u32 m0, s29, 0x1b000
    s_nop 0
    buffer_load_dwordx4 v136, s[16:19], s26 offen lds
    s_waitcnt lgkmcnt(12)
    v_mfma_f32_16x16x32_bf16 v[32:35], a[0:3], v[80:83], 0
    ds_read_b64_tr_b16 v[108:109], v131 offset:8192
    v_mfma_f32_16x16x32_bf16 v[36:39], a[64:67], v[80:83], 0
    ds_read_b64_tr_b16 v[110:111], v131 offset:9216
    s_add_u32 s26, s24, 0x380000
    s_add_u32 m0, s29, 0x1c000
    s_nop 0
    buffer_load_dwordx4 v136, s[16:19], s26 offen lds
    s_waitcnt lgkmcnt(12)
    v_mfma_f32_16x16x32_bf16 v[40:43], a[0:3], v[84:87], 0
    ds_read_b64_tr_b16 v[112:113], v132 offset:8192
    v_mfma_f32_16x16x32_bf16 v[44:47], a[64:67], v[84:87], 0
    ds_read_b64_tr_b16 v[114:115], v132 offset:9216
    s_add_u32 s26, s24, 0x3a0000
    s_add_u32 m0, s29, 0x1d000
    s_nop 0
    buffer_load_dwordx4 v136, s[16:19], s26 offen lds
    s_waitcnt lgkmcnt(12)
    v_mfma_f32_16x16x32_bf16 v[48:51], a[0:3], v[88:91], 0
    ds_read_b64_tr_b16 v[116:117], v133 offset:8192
    v_mfma_f32_16x16x32_bf16 v[52:55], a[64:67], v[88:91], 0
    ds_read_b64_tr_b16 v[118:119], v133 offset:9216
    s_add_u32 s26, s24, 0x3c0000
    s_add_u32 m0, s29, 0x1e000
    s_nop 0
    buffer_load_dwordx4 v136, s[16:19], s26 offen lds
    s_waitcnt lgkmcnt(12)
    v_mfma_f32_16x16x32_bf16 v[56:59], a[0:3], v[92:95], 0
    ds_read_b64_tr_b16 v[120:121], v134 offset:8192
    v_mfma_f32_16x16x32_bf16 v[60:63], a[64:67], v[92:95], 0
    ds_read_b64_tr_b16 v[122:123], v134 offset:9216
    s_add_u32 s26, s24, 0x3e0000
    s_add_u32 m0, s29, 0x1f000
    s_nop 0
    buffer_load_dwordx4 v136, s[16:19], s26 offen lds
    s_waitcnt lgkmcnt(12)
    v_mfma_f32_16x16x32_bf16 v[0:3], a[4:7], v[96:99], v[0:3]
    ds_read_b64_tr_b16 v[124:125], v135 offset:8192
    v_mfma_f32_16x16x32_bf16 v[4:7], a[68:71], v[96:99], v[4:7]
    ds_read_b64_tr_b16 v[126:127], v135 offset:9216
    s_waitcnt lgkmcnt(12)
    v_mfma_f32_16x16x32_bf16 v[8:11], a[4:7], v[100:103], v[8:11]
    ds_read_b64_tr_b16 v[64:65], v128 offset:16384
    v_mfma_f32_16x16x32_bf16 v[12:15], a[68:71], v[100:103], v[12:15]
    ds_read_b64_tr_b16 v[66:67], v128 offset:17408
    s_waitcnt lgkmcnt(12)
    v_mfma_f32_16x16x32_bf16 v[16:19], a[4:7], v[104:107], v[16:19]
    ds_read_b64_tr_b16 v[68:69], v129 offset:16384
    v_mfma_f32_16x16x32_bf16 v[20:23], a[68:71], v[104:107], v[20:23]
    ds_read_b64_tr_b16 v[70:71], v129 offset:17408
    s_waitcnt lgkmcnt(12)
    v_mfma_f32_16x16x32_bf16 v[24:27], a[4:7], v[108:111], v[24:27]
    ds_read_b64_tr_b16 v[72:73], v130 offset:16384
    v_mfma_f32_16x16x32_bf16 v[28:31], a[68:71], v[108:111], v[28:31]
    ds_read_b64_tr_b16 v[74:75], v130 offset:17408
    s_waitcnt lgkmcnt(12)
    v_mfma_f32_16x16x32_bf16 v[32:35], a[4:7], v[112:115], v[32:35]
    ds_read_b64_tr_b16 v[76:77], v131 offset:16384
    v_mfma_f32_16x16x32_bf16 v[36:39], a[68:71], v[112:115], v[36:39]
    ds_read_b64_tr_b16 v[78:79], v131 offset:17408
    s_waitcnt lgkmcnt(12)
    v_mfma_f32_16x16x32_bf16 v[40:43], a[4:7], v[116:119], v[40:43]
    ds_read_b64_tr_b16 v[80:81], v132 offset:16384
    v_mfma_f32_16x16x32_bf16 v[44:47], a[68:71], v[116:119], v[44:47]
    ds_read_b64_tr_b16 v[82:83], v132 offset:17408
    s_waitcnt lgkmcnt(12)
    v_mfma_f32_16x16x32_bf16 v[48:51], a[4:7], v[120:123], v[48:51]
    ds_read_b64_tr_b16 v[84:85], v133 offset:16384
    v_mfma_f32_16x16x32_bf16 v[52:55], a[68:71], v[120:123], v[52:55]
    ds_read_b64_tr_b16 v[86:87], v133 offset:17408
    s_waitcnt lgkmcnt(12)
    v_mfma_f32_16x16x32_bf16 v[56:59], a[4:7], v[124:127], v[56:59]
    ds_read_b64_tr_b16 v[88:89], v134 offset:16384
    v_mfma_f32_16x16x32_bf16 v[60:63], a[68:71], v[124:127], v[60:63]
    ds_read_b64_tr_b16 v[90:91], v134 offset:17408
    s_waitcnt lgkmcnt(12)
    v_mfma_f32_16x16x32_bf16 v[0:3], a[8:11], v[64:67], v[0:3]
    ds_read_b64_tr_b16 v[92:93], v135 offset:16384
    v_mfma_f32_16x16x32_bf16 v[4:7], a[72:75], v[64:67], v[4:7]
    ds_read_b64_tr_b16 v[94:95], v135 offset:17408
    s_waitcnt lgkmcnt(12)
    v_mfma_f32_16x16x32_bf16 v[8:11], a[8:11], v[68:71], v[8:11]
    ds_read_b64_tr_b16 v[96:97], v128 offset:24576
    v_mfma_f32_16x16x32_bf16 v[12:15], a[72:75], v[68:71], v[12:15]
    ds_read_b64_tr_b16 v[98:99], v128 offset:25600
    s_waitcnt lgkmcnt(12)
    v_mfma_f32_16x16x32_bf16 v[16:19], a[8:11], v[72:75], v[16:19]
    ds_read_b64_tr_b16 v[100:101], v129 offset:24576
    v_mfma_f32_16x16x32_bf16 v[20:23], a[72:75], v[72:75], v[20:23]
    ds_read_b64_tr_b16 v[102:103], v129 offset:25600
    s_waitcnt lgkmcnt(12)
    v_mfma_f32_16x16x32_bf16 v[24:27], a[8:11], v[76:79], v[24:27]
    ds_read_b64_tr_b16 v[104:105], v130 offset:24576
    v_mfma_f32_16x16x32_bf16 v[28:31], a[72:75], v[76:79], v[28:31]
    ds_read_b64_tr_b16 v[106:107], v130 offset:25600
    s_waitcnt lgkmcnt(12)
    v_mfma_f32_16x16x32_bf16 v[32:35], a[8:11], v[80:83], v[32:35]
    ds_read_b64_tr_b16 v[108:109], v131 offset:24576
    v_mfma_f32_16x16x32_bf16 v[36:39], a[72:75], v[80:83], v[36:39]
    ds_read_b64_tr_b16 v[110:111], v131 offset:25600
    s_waitcnt lgkmcnt(12)
    v_mfma_f32_16x16x32_bf16 v[40:43], a[8:11], v[84:87], v[40:43]
    ds_read_b64_tr_b16 v[112:113], v132 offset:24576
    v_mfma_f32_16x16x32_bf16 v[44:47], a[72:75], v[84:87], v[44:47]
    ds_read_b64_tr_b16 v[114:115], v132 offset:25600
    s_waitcnt lgkmcnt(12)
    v_mfma_f32_16x16x32_bf16 v[48:51], a[8:11], v[88:91], v[48:51]
    ds_read_b64_tr_b16 v[116:117], v133 offset:24576
    v_mfma_f32_16x16x32_bf16 v[52:55], a[72:75], v[88:91], v[52:55]
    ds_read_b64_tr_b16 v[118:119], v133 offset:25600
    s_waitcnt lgkmcnt(12)
    v_mfma_f32_16x16x32_bf16 v[56:59], a[8:11], v[92:95], v[56:59]
    ds_read_b64_tr_b16 v[120:121], v134 offset:24576
    v_mfma_f32_16x16x32_bf16 v[60:63], a[72:75], v[92:95], v[60:63]
    ds_read_b64_tr_b16 v[122:123], v134 offset:25600
    s_waitcnt lgkmcnt(12)
    v_mfma_f32_16x16x32_bf16 v[0:3], a[12:15], v[96:99], v[0:3]
    ds_read_b64_tr_b16 v[124:125], v135 offset:24576
    v_mfma_f32_16x16x32_bf16 v[4:7], a[76:79], v[96:99], v[4:7]
    ds_read_b64_tr_b16 v[126:127], v135 offset:25600
    s_waitcnt lgkmcnt(12)
    v_mfma_f32_16x16x32_bf16 v[8:11], a[12:15], v[100:103], v[8:11]
    v_mfma_f32_16x16x32_bf16 v[12:15], a[76:79], v[100:103], v[12:15]
    s_waitcnt lgkmcnt(10)
    v_mfma_f32_16x16x32_bf16 v[16:19], a[12:15], v[104:107], v[16:19]
    v_mfma_f32_16x16x32_bf16 v[20:23], a[76:79], v[104:107], v[20:23]
    s_waitcnt lgkmcnt(8)
    v_mfma_f32_16x16x32_bf16 v[24:27], a[12:15], v[108:111], v[24:27]
    v_mfma_f32_16x16x32_bf16 v[28:31], a[76:79], v[108:111], v[28:31]
    s_waitcnt lgkmcnt(6)
    v_mfma_f32_16x16x32_bf16 v[32:35], a[12:15], v[112:115], v[32:35]
    v_mfma_f32_16x16x32_bf16 v[36:39], a[76:79], v[112:115], v[36:39]
    s_waitcnt lgkmcnt(4)
    v_mfma_f32_16x16x32_bf16 v[40:43], a[12:15], v[116:119], v[40:43]
    v_mfma_f32_16x16x32_bf16 v[44:47], a[76:79], v[116:119], v[44:47]
    s_waitcnt lgkmcnt(2)
    v_mfma_f32_16x16x32_bf16 v[48:51], a[12:15], v[120:123], v[48:51]
    v_mfma_f32_16x16x32_bf16 v[52:55], a[76:79], v[120:123], v[52:55]
    s_waitcnt lgkmcnt(0)
    v_mfma_f32_16x16x32_bf16 v[56:59], a[12:15], v[124:127], v[56:59]
    v_mfma_f32_16x16x32_bf16 v[60:63], a[76:79], v[124:127], v[60:63]
    s_waitcnt vmcnt(16)
    s_barrier
    ds_read_b64_tr_b16 v[64:65], v128 offset:32768
    ds_read_b64_tr_b16 v[66:67], v128 offset:33792
    ds_read_b64_tr_b16 v[68:69], v129 offset:32768
    ds_read_b64_tr_b16 v[70:71], v129 offset:33792
    ds_read_b64_tr_b16 v[72:73], v130 offset:32768
    ds_read_b64_tr_b16 v[74:75], v130 offset:33792
    ds_read_b64_tr_b16 v[76:77], v131 offset:32768
    ds_read_b64_tr_b16 v[78:79], v131 offset:33792
    ds_read_b64_tr_b16 v[80:81], v132 offset:32768
    ds_read_b64_tr_b16 v[82:83], v132 offset:33792
    ds_read_b64_tr_b16 v[84:85], v133 offset:32768
    ds_read_b64_tr_b16 v[86:87], v133 offset:33792
    ds_read_b64_tr_b16 v[88:89], v134 offset:32768
    ds_read_b64_tr_b16 v[90:91], v134 offset:33792
    s_add_u32 s39, s39, s37
    s_lshr_b32 s26, s39, 5
    s_cmp_eq_u32 s26, 0
    s_cselect_b64 s[16:17], s[62:63], s[60:61]
    s_cmp_eq_u32 s26, 1
    s_cselect_b64 s[16:17], s[64:65], s[16:17]
    s_and_b32 s17, s17, 0xffff
    s_cmp_lt_u32 s39, 96
    s_cselect_b32 s18, 0x400000, 0
    s_and_b32 s24, s39, 31
    s_lshl_b32 s24, s24, 8
    s_waitcnt lgkmcnt(12)
    v_mfma_f32_16x16x32_bf16 v[0:3], a[16:19], v[64:67], v[0:3]
    ds_read_b64_tr_b16 v[92:93], v135 offset:32768
    v_mfma_f32_16x16x32_bf16 v[4:7], a[80:83], v[64:67], v[4:7]
    ds_read_b64_tr_b16 v[94:95], v135 offset:33792
    s_add_u32 s26, s24, 0x0
    s_add_u32 m0, s29, 0x0
    s_nop 0
    buffer_load_dwordx4 v136, s[16:19], s26 offen lds
    s_waitcnt lgkmcnt(12)
    v_mfma_f32_16x16x32_bf16 v[8:11], a[16:19], v[68:71], v[8:11]
    ds_read_b64_tr_b16 v[96:97], v128 offset:40960
    v_mfma_f32_16x16x32_bf16 v[12:15], a[80:83], v[68:71], v[12:15]
    ds_read_b64_tr_b16 v[98:99], v128 offset:41984
    s_add_u32 s26, s24, 0x20000
    s_add_u32 m0, s29, 0x1000
    s_nop 0
    buffer_load_dwordx4 v136, s[16:19], s26 offen lds
    s_waitcnt lgkmcnt(12)
    v_mfma_f32_16x16x32_bf16 v[16:19], a[16:19], v[72:75], v[16:19]
    ds_read_b64_tr_b16 v[100:101], v129 offset:40960
    v_mfma_f32_16x16x32_bf16 v[20:23], a[80:83], v[72:75], v[20:23]
    ds_read_b64_tr_b16 v[102:103], v129 offset:41984
    s_add_u32 s26, s24, 0x40000
    s_add_u32 m0, s29, 0x2000
    s_nop 0
    buffer_load_dwordx4 v136, s[16:19], s26 offen lds
    s_waitcnt lgkmcnt(12)
    v_mfma_f32_16x16x32_bf16 v[24:27], a[16:19], v[76:79], v[24:27]
    ds_read_b64_tr_b16 v[104:105], v130 offset:40960
    v_mfma_f32_16x16x32_bf16 v[28:31], a[80:83], v[76:79], v[28:31]
    ds_read_b64_tr_b16 v[106:107], v130 offset:41984
    s_add_u32 s26, s24, 0x60000
    s_add_u32 m0, s29, 0x3000
    s_nop 0
    buffer_load_dwordx4 v136, s[16:19], s26 offen lds
    s_waitcnt lgkmcnt(12)
    v_mfma_f32_16x16x32_bf16 v[32:35], a[16:19], v[80:83], v[32:35]
    ds_read_b64_tr_b16 v[108:109], v131 offset:40960
    v_mfma_f32_16x16x32_bf16 v[36:39], a[80:83], v[80:83], v[36:39]
    ds_read_b64_tr_b16 v[110:111], v131 offset:41984
    s_add_u32 s26, s24, 0x80000
    s_add_u32 m0, s29, 0x4000
    s_nop 0
    buffer_load_dwordx4 v136, s[16:19], s26 offen lds
    s_waitcnt lgkmcnt(12)
    v_mfma_f32_16x16x32_bf16 v[40:43], a[16:19], v[84:87], v[40:43]
    ds_read_b64_tr_b16 v[112:113], v132 offset:40960
    v_mfma_f32_16x16x32_bf16 v[44:47], a[80:83], v[84:87], v[44:47]
    ds_read_b64_tr_b16 v[114:115], v132 offset:41984
    s_add_u32 s26, s24, 0xa0000
    s_add_u32 m0, s29, 0x5000
    s_nop 0
    buffer_load_dwordx4 v136, s[16:19], s26 offen lds
    s_waitcnt lgkmcnt(12)
    v_mfma_f32_16x16x32_bf16 v[48:51], a[16:19], v[88:91], v[48:51]
    ds_read_b64_tr_b16 v[116:117], v133 offset:40960
    v_mfma_f32_16x16x32_bf16 v[52:55], a[80:83], v[88:91], v[52:55]
    ds_read_b64_tr_b16 v[118:119], v133 offset:41984
    s_add_u32 s26, s24, 0xc0000
    s_add_u32 m0, s29, 0x6000
    s_nop 0
    buffer_load_dwordx4 v136, s[16:19], s26 offen lds
    s_waitcnt lgkmcnt(12)
    v_mfma_f32_16x16x32_bf16 v[56:59], a[16:19], v[92:95], v[56:59]
    ds_read_b64_tr_b16 v[120:121], v134 offset:40960
    v_mfma_f32_16x16x32_bf16 v[60:63], a[80:83], v[92:95], v[60:63]
    ds_read_b64_tr_b16 v[122:123], v134 offset:41984
    s_add_u32 s26, s24, 0xe0000
    s_add_u32 m0, s29, 0x7000
    s_nop 0
    buffer_load_dwordx4 v136, s[16:19], s26 offen lds
    s_waitcnt lgkmcnt(12)
    v_mfma_f32_16x16x32_bf16 v[0:3], a[20:23], v[96:99], v[0:3]
    ds_read_b64_tr_b16 v[124:125], v135 offset:40960
    v_mfma_f32_16x16x32_bf16 v[4:7], a[84:87], v[96:99], v[4:7]
    ds_read_b64_tr_b16 v[126:127], v135 offset:41984
    s_waitcnt lgkmcnt(12)
    v_mfma_f32_16x16x32_bf16 v[8:11], a[20:23], v[100:103], v[8:11]
    ds_read_b64_tr_b16 v[64:65], v128 offset:49152
    v_mfma_f32_16x16x32_bf16 v[12:15], a[84:87], v[100:103], v[12:15]
    ds_read_b64_tr_b16 v[66:67], v128 offset:50176
    s_waitcnt lgkmcnt(12)
    v_mfma_f32_16x16x32_bf16 v[16:19], a[20:23], v[104:107], v[16:19]
    ds_read_b64_tr_b16 v[68:69], v129 offset:49152
    v_mfma_f32_16x16x32_bf16 v[20:23], a[84:87], v[104:107], v[20:23]
    ds_read_b64_tr_b16 v[70:71], v129 offset:50176
    s_waitcnt lgkmcnt(12)
    v_mfma_f32_16x16x32_bf16 v[24:27], a[20:23], v[108:111], v[24:27]
    ds_read_b64_tr_b16 v[72:73], v130 offset:49152
    v_mfma_f32_16x16x32_bf16 v[28:31], a[84:87], v[108:111], v[28:31]
    ds_read_b64_tr_b16 v[74:75], v130 offset:50176
    s_waitcnt lgkmcnt(12)
    v_mfma_f32_16x16x32_bf16 v[32:35], a[20:23], v[112:115], v[32:35]
    ds_read_b64_tr_b16 v[76:77], v131 offset:49152
    v_mfma_f32_16x16x32_bf16 v[36:39], a[84:87], v[112:115], v[36:39]
    ds_read_b64_tr_b16 v[78:79], v131 offset:50176
    s_waitcnt lgkmcnt(12)
    v_mfma_f32_16x16x32_bf16 v[40:43], a[20:23], v[116:119], v[40:43]
    ds_read_b64_tr_b16 v[80:81], v132 offset:49152
    v_mfma_f32_16x16x32_bf16 v[44:47], a[84:87], v[116:119], v[44:47]
    ds_read_b64_tr_b16 v[82:83], v132 offset:50176
    s_waitcnt lgkmcnt(12)
    v_mfma_f32_16x16x32_bf16 v[48:51], a[20:23], v[120:123], v[48:51]
    ds_read_b64_tr_b16 v[84:85], v133 offset:49152
    v_mfma_f32_16x16x32_bf16 v[52:55], a[84:87], v[120:123], v[52:55]
    ds_read_b64_tr_b16 v[86:87], v133 offset:50176
    s_waitcnt lgkmcnt(12)
    v_mfma_f32_16x16x32_bf16 v[56:59], a[20:23], v[124:127], v[56:59]
    ds_read_b64_tr_b16 v[88:89], v134 offset:49152
    v_mfma_f32_16x16x32_bf16 v[60:63], a[84:87], v[124:127], v[60:63]
    ds_read_b64_tr_b16 v[90:91], v134 offset:50176
    s_waitcnt lgkmcnt(12)
    v_mfma_f32_16x16x32_bf16 v[0:3], a[24:27], v[64:67], v[0:3]
    ds_read_b64_tr_b16 v[92:93], v135 offset:49152
    v_mfma_f32_16x16x32_bf16 v[4:7], a[88:91], v[64:67], v[4:7]
    ds_read_b64_tr_b16 v[94:95], v135 offset:50176
    s_waitcnt lgkmcnt(12)
    v_mfma_f32_16x16x32_bf16 v[8:11], a[24:27], v[68:71], v[8:11]
    ds_read_b64_tr_b16 v[96:97], v128 offset:57344
    v_mfma_f32_16x16x32_bf16 v[12:15], a[88:91], v[68:71], v[12:15]
    ds_read_b64_tr_b16 v[98:99], v128 offset:58368
    s_waitcnt lgkmcnt(12)
    v_mfma_f32_16x16x32_bf16 v[16:19], a[24:27], v[72:75], v[16:19]
    ds_read_b64_tr_b16 v[100:101], v129 offset:57344
    v_mfma_f32_16x16x32_bf16 v[20:23], a[88:91], v[72:75], v[20:23]
    ds_read_b64_tr_b16 v[102:103], v129 offset:58368
    s_waitcnt lgkmcnt(12)
    v_mfma_f32_16x16x32_bf16 v[24:27], a[24:27], v[76:79], v[24:27]
    ds_read_b64_tr_b16 v[104:105], v130 offset:57344
    v_mfma_f32_16x16x32_bf16 v[28:31], a[88:91], v[76:79], v[28:31]
    ds_read_b64_tr_b16 v[106:107], v130 offset:58368
    s_waitcnt lgkmcnt(12)
    v_mfma_f32_16x16x32_bf16 v[32:35], a[24:27], v[80:83], v[32:35]
    ds_read_b64_tr_b16 v[108:109], v131 offset:57344
    v_mfma_f32_16x16x32_bf16 v[36:39], a[88:91], v[80:83], v[36:39]
    ds_read_b64_tr_b16 v[110:111], v131 offset:58368
    s_waitcnt lgkmcnt(12)
    v_mfma_f32_16x16x32_bf16 v[40:43], a[24:27], v[84:87], v[40:43]
    ds_read_b64_tr_b16 v[112:113], v132 offset:57344
    v_mfma_f32_16x16x32_bf16 v[44:47], a[88:91], v[84:87], v[44:47]
    ds_read_b64_tr_b16 v[114:115], v132 offset:58368
    s_waitcnt lgkmcnt(12)
    v_mfma_f32_16x16x32_bf16 v[48:51], a[24:27], v[88:91], v[48:51]
    ds_read_b64_tr_b16 v[116:117], v133 offset:57344
    v_mfma_f32_16x16x32_bf16 v[52:55], a[88:91], v[88:91], v[52:55]
    ds_read_b64_tr_b16 v[118:119], v133 offset:58368
    s_waitcnt lgkmcnt(12)
    v_mfma_f32_16x16x32_bf16 v[56:59], a[24:27], v[92:95], v[56:59]
    ds_read_b64_tr_b16 v[120:121], v134 offset:57344
    v_mfma_f32_16x16x32_bf16 v[60:63], a[88:91], v[92:95], v[60:63]
    ds_read_b64_tr_b16 v[122:123], v134 offset:58368
    s_waitcnt lgkmcnt(12)
    v_mfma_f32_16x16x32_bf16 v[0:3], a[28:31], v[96:99], v[0:3]
    ds_read_b64_tr_b16 v[124:125], v135 offset:57344
    v_mfma_f32_16x16x32_bf16 v[4:7], a[92:95], v[96:99], v[4:7]
    ds_read_b64_tr_b16 v[126:127], v135 offset:58368
    s_waitcnt lgkmcnt(12)
    v_mfma_f32_16x16x32_bf16 v[8:11], a[28:31], v[100:103], v[8:11]
    v_mfma_f32_16x16x32_bf16 v[12:15], a[92:95], v[100:103], v[12:15]
    s_waitcnt lgkmcnt(10)
    v_mfma_f32_16x16x32_bf16 v[16:19], a[28:31], v[104:107], v[16:19]
    v_mfma_f32_16x16x32_bf16 v[20:23], a[92:95], v[104:107], v[20:23]
    s_waitcnt lgkmcnt(8)
    v_mfma_f32_16x16x32_bf16 v[24:27], a[28:31], v[108:111], v[24:27]
    v_mfma_f32_16x16x32_bf16 v[28:31], a[92:95], v[108:111], v[28:31]
    s_waitcnt lgkmcnt(6)
    v_mfma_f32_16x16x32_bf16 v[32:35], a[28:31], v[112:115], v[32:35]
    v_mfma_f32_16x16x32_bf16 v[36:39], a[92:95], v[112:115], v[36:39]
    s_waitcnt lgkmcnt(4)
    v_mfma_f32_16x16x32_bf16 v[40:43], a[28:31], v[116:119], v[40:43]
    v_mfma_f32_16x16x32_bf16 v[44:47], a[92:95], v[116:119], v[44:47]
    s_waitcnt lgkmcnt(2)
    v_mfma_f32_16x16x32_bf16 v[48:51], a[28:31], v[120:123], v[48:51]
    v_mfma_f32_16x16x32_bf16 v[52:55], a[92:95], v[120:123], v[52:55]
    s_waitcnt lgkmcnt(0)
    v_mfma_f32_16x16x32_bf16 v[56:59], a[28:31], v[124:127], v[56:59]
    v_mfma_f32_16x16x32_bf16 v[60:63], a[92:95], v[124:127], v[60:63]
    v_xor_b32 v128, 0x10000, v128
    v_xor_b32 v129, 0x10000, v129
    v_xor_b32 v130, 0x10000, v130
    v_xor_b32 v131, 0x10000, v131
    v_xor_b32 v132, 0x10000, v132
    v_xor_b32 v133, 0x10000, v133
    v_xor_b32 v134, 0x10000, v134
    v_xor_b32 v135, 0x10000, v135
    s_waitcnt vmcnt(16)
    s_barrier
    ds_read_b64_tr_b16 v[64:65], v128
    ds_read_b64_tr_b16 v[66:67], v128 offset:1024
    ds_read_b64_tr_b16 v[68:69], v129
    ds_read_b64_tr_b16 v[70:71], v129 offset:1024
    ds_read_b64_tr_b16 v[72:73], v130
    ds_read_b64_tr_b16 v[74:75], v130 offset:1024
    ds_read_b64_tr_b16 v[76:77], v131
    ds_read_b64_tr_b16 v[78:79], v131 offset:1024
    ds_read_b64_tr_b16 v[80:81], v132
    ds_read_b64_tr_b16 v[82:83], v132 offset:1024
    ds_read_b64_tr_b16 v[84:85], v133
    ds_read_b64_tr_b16 v[86:87], v133 offset:1024
    ds_read_b64_tr_b16 v[88:89], v134
    ds_read_b64_tr_b16 v[90:91], v134 offset:1024
    s_cmp_eq_u32 s40, 0
    s_cbranch_scc1 L_nopf_96
    s_cmp_lg_u32 s87, 0
    s_cbranch_scc1 L_modeok_97
    v_readfirstlane_b32 s96, v140
    v_readfirstlane_b32 s97, v141
    s_nop 0
    s_cmp_lg_u32 s97, 0
    s_cselect_b32 s87, s96, 0
    s_cmp_eq_u32 s87, 1
    s_cbranch_scc1 L_modeok_97
    s_mov_b32 s96, 0
L_mode_98:
    buffer_load_dwordx2 v[140:141], off, s[92:95], 0 offset:36 sc1
    s_waitcnt vmcnt(0)
    v_readfirstlane_b32 s87, v140
    v_readfirstlane_b32 s97, v141
    s_nop 0
    s_min_u32 s97, s97, s87
    s_cmp_lg_u32 s97, 0
    s_cbranch_scc1 L_moded_99
    s_sleep 4
    s_add_u32 s96, s96, 1
    s_cmp_lg_u32 s96, 0x100
    s_cbranch_scc1 L_modef_100
    v_mov_b32 v140, 2
    v_mov_b32 v141, 0
    s_mov_b64 exec, 1
    buffer_atomic_cmpswap v[140:141], off, s[92:95], 0 offset:36
    s_mov_b64 exec, -1
L_modef_100:
    s_cmp_lt_u32 s96, 0x10000
    s_cbranch_scc1 L_mode_98
L_moded_99:
    s_cmp_lg_u32 s87, 1
    s_cbranch_scc1 L_fallback
L_modeok_97:
    s_cmp_lg_u32 s100, 0
    s_cbranch_scc1 L_flag_101
    v_mov_b32 v138, 1
    s_mov_b64 exec, 1
    buffer_store_dword v138, off, s[8:11], s40 sc1
    s_mov_b64 exec, -1
L_flag_101:
    s_mov_b32 s40, 0
L_nopf_96:
    s_waitcnt lgkmcnt(12)
    v_mfma_f32_16x16x32_bf16 v[0:3], a[32:35], v[64:67], v[0:3]
    ds_read_b64_tr_b16 v[92:93], v135
    v_mfma_f32_16x16x32_bf16 v[4:7], a[96:99], v[64:67], v[4:7]
    ds_read_b64_tr_b16 v[94:95], v135 offset:1024
    s_add_u32 s26, s24, 0x100000
    s_add_u32 m0, s29, 0x8000
    s_nop 0
    buffer_load_dwordx4 v136, s[16:19], s26 offen lds
    s_waitcnt lgkmcnt(12)
    v_mfma_f32_16x16x32_bf16 v[8:11], a[32:35], v[68:71], v[8:11]
    ds_read_b64_tr_b16 v[96:97], v128 offset:8192
    v_mfma_f32_16x16x32_bf16 v[12:15], a[96:99], v[68:71], v[12:15]
    ds_read_b64_tr_b16 v[98:99], v128 offset:9216
    s_add_u32 s26, s24, 0x120000
    s_add_u32 m0, s29, 0x9000
    s_nop 0
    buffer_load_dwordx4 v136, s[16:19], s26 offen lds
    s_waitcnt lgkmcnt(12)
    v_mfma_f32_16x16x32_bf16 v[16:19], a[32:35], v[72:75], v[16:19]
    ds_read_b64_tr_b16 v[100:101], v129 offset:8192
    v_mfma_f32_16x16x32_bf16 v[20:23], a[96:99], v[72:75], v[20:23]
    ds_read_b64_tr_b16 v[102:103], v129 offset:9216
    s_add_u32 s26, s24, 0x140000
    s_add_u32 m0, s29, 0xa000
    s_nop 0
    buffer_load_dwordx4 v136, s[16:19], s26 offen lds
    s_waitcnt lgkmcnt(12)
    v_mfma_f32_16x16x32_bf16 v[24:27], a[32:35], v[76:79], v[24:27]
    ds_read_b64_tr_b16 v[104:105], v130 offset:8192
    v_mfma_f32_16x16x32_bf16 v[28:31], a[96:99], v[76:79], v[28:31]
    ds_read_b64_tr_b16 v[106:107], v130 offset:9216
    s_add_u32 s26, s24, 0x160000
    s_add_u32 m0, s29, 0xb000
    s_nop 0
    buffer_load_dwordx4 v136, s[16:19], s26 offen lds
    s_waitcnt lgkmcnt(12)
    v_mfma_f32_16x16x32_bf16 v[32:35], a[32:35], v[80:83], v[32:35]
    ds_read_b64_tr_b16 v[108:109], v131 offset:8192
    v_mfma_f32_16x16x32_bf16 v[36:39], a[96:99], v[80:83], v[36:39]
    ds_read_b64_tr_b16 v[110:111], v131 offset:9216
    s_add_u32 s26, s24, 0x180000
    s_add_u32 m0, s29, 0xc000
    s_nop 0
    buffer_load_dwordx4 v136, s[16:19], s26 offen lds
    s_waitcnt lgkmcnt(12)
    v_mfma_f32_16x16x32_bf16 v[40:43], a[32:35], v[84:87], v[40:43]
    ds_read_b64_tr_b16 v[112:113], v132 offset:8192
    v_mfma_f32_16x16x32_bf16 v[44:47], a[96:99], v[84:87], v[44:47]
    ds_read_b64_tr_b16 v[114:115], v132 offset:9216
    s_add_u32 s26, s24, 0x1a0000
    s_add_u32 m0, s29, 0xd000
    s_nop 0
    buffer_load_dwordx4 v136, s[16:19], s26 offen lds
    s_waitcnt lgkmcnt(12)
    v_mfma_f32_16x16x32_bf16 v[48:51], a[32:35], v[88:91], v[48:51]
    ds_read_b64_tr_b16 v[116:117], v133 offset:8192
    v_mfma_f32_16x16x32_bf16 v[52:55], a[96:99], v[88:91], v[52:55]
    ds_read_b64_tr_b16 v[118:119], v133 offset:9216
    s_add_u32 s26, s24, 0x1c0000
    s_add_u32 m0, s29, 0xe000
    s_nop 0
    buffer_load_dwordx4 v136, s[16:19], s26 offen lds
    s_waitcnt lgkmcnt(12)
    v_mfma_f32_16x16x32_bf16 v[56:59], a[32:35], v[92:95], v[56:59]
    ds_read_b64_tr_b16 v[120:121], v134 offset:8192
    v_mfma_f32_16x16x32_bf16 v[60:63], a[96:99], v[92:95], v[60:63]
    ds_read_b64_tr_b16 v[122:123], v134 offset:9216
    s_add_u32 s26, s24, 0x1e0000
    s_add_u32 m0, s29, 0xf000
    s_nop 0
    buffer_load_dwordx4 v136, s[16:19], s26 offen lds
    s_waitcnt lgkmcnt(12)
    v_mfma_f32_16x16x32_bf16 v[0:3], a[36:39], v[96:99], v[0:3]
    ds_read_b64_tr_b16 v[124:125], v135 offset:8192
    v_mfma_f32_16x16x32_bf16 v[4:7], a[100:103], v[96:99], v[4:7]
    ds_read_b64_tr_b16 v[126:127], v135 offset:9216
    s_waitcnt lgkmcnt(12)
    v_mfma_f32_16x16x32_bf16 v[8:11], a[36:39], v[100:103], v[8:11]
    ds_read_b64_tr_b16 v[64:65], v128 offset:16384
    v_mfma_f32_16x16x32_bf16 v[12:15], a[100:103], v[100:103], v[12:15]
    ds_read_b64_tr_b16 v[66:67], v128 offset:17408
    s_waitcnt lgkmcnt(12)
    v_mfma_f32_16x16x32_bf16 v[16:19], a[36:39], v[104:107], v[16:19]
    ds_read_b64_tr_b16 v[68:69], v129 offset:16384
    v_mfma_f32_16x16x32_bf16 v[20:23], a[100:103], v[104:107], v[20:23]
    ds_read_b64_tr_b16 v[70:71], v129 offset:17408
    s_waitcnt lgkmcnt(12)
    v_mfma_f32_16x16x32_bf16 v[24:27], a[36:39], v[108:111], v[24:27]
    ds_read_b64_tr_b16 v[72:73], v130 offset:16384
    v_mfma_f32_16x16x32_bf16 v[28:31], a[100:103], v[108:111], v[28:31]
    ds_read_b64_tr_b16 v[74:75], v130 offset:17408
    s_waitcnt lgkmcnt(12)
    v_mfma_f32_16x16x32_bf16 v[32:35], a[36:39], v[112:115], v[32:35]
    ds_read_b64_tr_b16 v[76:77], v131 offset:16384
    v_mfma_f32_16x16x32_bf16 v[36:39], a[100:103], v[112:115], v[36:39]
    ds_read_b64_tr_b16 v[78:79], v131 offset:17408
    s_waitcnt lgkmcnt(12)
    v_mfma_f32_16x16x32_bf16 v[40:43], a[36:39], v[116:119], v[40:43]
    ds_read_b64_tr_b16 v[80:81], v132 offset:16384
    v_mfma_f32_16x16x32_bf16 v[44:47], a[100:103], v[116:119], v[44:47]
    ds_read_b64_tr_b16 v[82:83], v132 offset:17408
    s_waitcnt lgkmcnt(12)
    v_mfma_f32_16x16x32_bf16 v[48:51], a[36:39], v[120:123], v[48:51]
    ds_read_b64_tr_b16 v[84:85], v133 offset:16384
    v_mfma_f32_16x16x32_bf16 v[52:55], a[100:103], v[120:123], v[52:55]
    ds_read_b64_tr_b16 v[86:87], v133 offset:17408
    s_waitcnt lgkmcnt(12)
    v_mfma_f32_16x16x32_bf16 v[56:59], a[36:39], v[124:127], v[56:59]
    ds_read_b64_tr_b16 v[88:89], v134 offset:16384
    v_mfma_f32_16x16x32_bf16 v[60:63], a[100:103], v[124:127], v[60:63]
    ds_read_b64_tr_b16 v[90:91], v134 offset:17408
    s_waitcnt lgkmcnt(12)
    v_mfma_f32_16x16x32_bf16 v[0:3], a[40:43], v[64:67], v[0:3]
    ds_read_b64_tr_b16 v[92:93], v135 offset:16384
    v_mfma_f32_16x16x32_bf16 v[4:7], a[104:107], v[64:67], v[4:7]
    ds_read_b64_tr_b16 v[94:95], v135 offset:17408
    s_waitcnt lgkmcnt(12)
    v_mfma_f32_16x16x32_bf16 v[8:11], a[40:43], v[68:71], v[8:11]
    ds_read_b64_tr_b16 v[96:97], v128 offset:24576
    v_mfma_f32_16x16x32_bf16 v[12:15], a[104:107], v[68:71], v[12:15]
    ds_read_b64_tr_b16 v[98:99], v128 offset:25600
    s_waitcnt lgkmcnt(12)
    v_mfma_f32_16x16x32_bf16 v[16:19], a[40:43], v[72:75], v[16:19]
    ds_read_b64_tr_b16 v[100:101], v129 offset:24576
    v_mfma_f32_16x16x32_bf16 v[20:23], a[104:107], v[72:75], v[20:23]
    ds_read_b64_tr_b16 v[102:103], v129 offset:25600
    s_waitcnt lgkmcnt(12)
    v_mfma_f32_16x16x32_bf16 v[24:27], a[40:43], v[76:79], v[24:27]
    ds_read_b64_tr_b16 v[104:105], v130 offset:24576
    v_mfma_f32_16x16x32_bf16 v[28:31], a[104:107], v[76:79], v[28:31]
    ds_read_b64_tr_b16 v[106:107], v130 offset:25600
    s_waitcnt lgkmcnt(12)
    v_mfma_f32_16x16x32_bf16 v[32:35], a[40:43], v[80:83], v[32:35]
    ds_read_b64_tr_b16 v[108:109], v131 offset:24576
    v_mfma_f32_16x16x32_bf16 v[36:39], a[104:107], v[80:83], v[36:39]
    ds_read_b64_tr_b16 v[110:111], v131 offset:25600
    s_waitcnt lgkmcnt(12)
    v_mfma_f32_16x16x32_bf16 v[40:43], a[40:43], v[84:87], v[40:43]
    ds_read_b64_tr_b16 v[112:113], v132 offset:24576
    v_mfma_f32_16x16x32_bf16 v[44:47], a[104:107], v[84:87], v[44:47]
    ds_read_b64_tr_b16 v[114:115], v132 offset:25600
    s_waitcnt lgkmcnt(12)
    v_mfma_f32_16x16x32_bf16 v[48:51], a[40:43], v[88:91], v[48:51]
    ds_read_b64_tr_b16 v[116:117], v133 offset:24576
    v_mfma_f32_16x16x32_bf16 v[52:55], a[104:107], v[88:91], v[52:55]
    ds_read_b64_tr_b16 v[118:119], v133 offset:25600
    s_waitcnt lgkmcnt(12)
    v_mfma_f32_16x16x32_bf16 v[56:59], a[40:43], v[92:95], v[56:59]
    ds_read_b64_tr_b16 v[120:121], v134 offset:24576
    v_mfma_f32_16x16x32_bf16 v[60:63], a[104:107], v[92:95], v[60:63]
    ds_read_b64_tr_b16 v[122:123], v134 offset:25600
    s_waitcnt lgkmcnt(12)
    v_mfma_f32_16x16x32_bf16 v[0:3], a[44:47], v[96:99], v[0:3]
    ds_read_b64_tr_b16 v[124:125], v135 offset:24576
    v_mfma_f32_16x16x32_bf16 v[4:7], a[108:111], v[96:99], v[4:7]
    ds_read_b64_tr_b16 v[126:127], v135 offset:25600
    s_waitcnt lgkmcnt(12)
    v_mfma_f32_16x16x32_bf16 v[8:11], a[44:47], v[100:103], v[8:11]
    v_mfma_f32_16x16x32_bf16 v[12:15], a[108:111], v[100:103], v[12:15]
    s_waitcnt lgkmcnt(10)
    v_mfma_f32_16x16x32_bf16 v[16:19], a[44:47], v[104:107], v[16:19]
    v_mfma_f32_16x16x32_bf16 v[20:23], a[108:111], v[104:107], v[20:23]
    s_waitcnt lgkmcnt(8)
    v_mfma_f32_16x16x32_bf16 v[24:27], a[44:47], v[108:111], v[24:27]
    v_mfma_f32_16x16x32_bf16 v[28:31], a[108:111], v[108:111], v[28:31]
    s_waitcnt lgkmcnt(6)
    v_mfma_f32_16x16x32_bf16 v[32:35], a[44:47], v[112:115], v[32:35]
    v_mfma_f32_16x16x32_bf16 v[36:39], a[108:111], v[112:115], v[36:39]
    s_waitcnt lgkmcnt(4)
    v_mfma_f32_16x16x32_bf16 v[40:43], a[44:47], v[116:119], v[40:43]
    v_mfma_f32_16x16x32_bf16 v[44:47], a[108:111], v[116:119], v[44:47]
    s_waitcnt lgkmcnt(2)
    v_mfma_f32_16x16x32_bf16 v[48:51], a[44:47], v[120:123], v[48:51]
    v_mfma_f32_16x16x32_bf16 v[52:55], a[108:111], v[120:123], v[52:55]
    s_waitcnt lgkmcnt(0)
    v_mfma_f32_16x16x32_bf16 v[56:59], a[44:47], v[124:127], v[56:59]
    v_mfma_f32_16x16x32_bf16 v[60:63], a[108:111], v[124:127], v[60:63]
    s_waitcnt vmcnt(16)
    s_barrier
    ds_read_b64_tr_b16 v[64:65], v128 offset:32768
    ds_read_b64_tr_b16 v[66:67], v128 offset:33792
    ds_read_b64_tr_b16 v[68:69], v129 offset:32768
    ds_read_b64_tr_b16 v[70:71], v129 offset:33792
    ds_read_b64_tr_b16 v[72:73], v130 offset:32768
    ds_read_b64_tr_b16 v[74:75], v130 offset:33792
    ds_read_b64_tr_b16 v[76:77], v131 offset:32768
    ds_read_b64_tr_b16 v[78:79], v131 offset:33792
    ds_read_b64_tr_b16 v[80:81], v132 offset:32768
    ds_read_b64_tr_b16 v[82:83], v132 offset:33792
    ds_read_b64_tr_b16 v[84:85], v133 offset:32768
    ds_read_b64_tr_b16 v[86:87], v133 offset:33792
    ds_read_b64_tr_b16 v[88:89], v134 offset:32768
    ds_read_b64_tr_b16 v[90:91], v134 offset:33792
    s_waitcnt lgkmcnt(12)
    v_mfma_f32_16x16x32_bf16 v[0:3], a[48:51], v[64:67], v[0:3]
    ds_read_b64_tr_b16 v[92:93], v135 offset:32768
    v_mfma_f32_16x16x32_bf16 v[4:7], a[112:115], v[64:67], v[4:7]
    ds_read_b64_tr_b16 v[94:95], v135 offset:33792
    s_add_u32 s26, s24, 0x200000
    s_add_u32 m0, s29, 0x10000
    s_nop 0
    buffer_load_dwordx4 v136, s[16:19], s26 offen lds
    s_waitcnt lgkmcnt(12)
    v_mfma_f32_16x16x32_bf16 v[8:11], a[48:51], v[68:71], v[8:11]
    ds_read_b64_tr_b16 v[96:97], v128 offset:40960
    v_mfma_f32_16x16x32_bf16 v[12:15], a[112:115], v[68:71], v[12:15]
    ds_read_b64_tr_b16 v[98:99], v128 offset:41984
    s_add_u32 s26, s24, 0x220000
    s_add_u32 m0, s29, 0x11000
    s_nop 0
    buffer_load_dwordx4 v136, s[16:19], s26 offen lds
    s_waitcnt lgkmcnt(12)
    v_mfma_f32_16x16x32_bf16 v[16:19], a[48:51], v[72:75], v[16:19]
    ds_read_b64_tr_b16 v[100:101], v129 offset:40960
    v_mfma_f32_16x16x32_bf16 v[20:23], a[112:115], v[72:75], v[20:23]
    ds_read_b64_tr_b16 v[102:103], v129 offset:41984
    s_add_u32 s26, s24, 0x240000
    s_add_u32 m0, s29, 0x12000
    s_nop 0
    buffer_load_dwordx4 v136, s[16:19], s26 offen lds
    s_waitcnt lgkmcnt(12)
    v_mfma_f32_16x16x32_bf16 v[24:27], a[48:51], v[76:79], v[24:27]
    ds_read_b64_tr_b16 v[104:105], v130 offset:40960
    v_mfma_f32_16x16x32_bf16 v[28:31], a[112:115], v[76:79], v[28:31]
    ds_read_b64_tr_b16 v[106:107], v130 offset:41984
    s_add_u32 s26, s24, 0x260000
    s_add_u32 m0, s29, 0x13000
    s_nop 0
    buffer_load_dwordx4 v136, s[16:19], s26 offen lds
    s_waitcnt lgkmcnt(12)
    v_mfma_f32_16x16x32_bf16 v[32:35], a[48:51], v[80:83], v[32:35]
    ds_read_b64_tr_b16 v[108:109], v131 offset:40960
    v_mfma_f32_16x16x32_bf16 v[36:39], a[112:115], v[80:83], v[36:39]
    ds_read_b64_tr_b16 v[110:111], v131 offset:41984
    s_add_u32 s26, s24, 0x280000
    s_add_u32 m0, s29, 0x14000
    s_nop 0
    buffer_load_dwordx4 v136, s[16:19], s26 offen lds
    s_waitcnt lgkmcnt(12)
    v_mfma_f32_16x16x32_bf16 v[40:43], a[48:51], v[84:87], v[40:43]
    ds_read_b64_tr_b16 v[112:113], v132 offset:40960
    v_mfma_f32_16x16x32_bf16 v[44:47], a[112:115], v[84:87], v[44:47]
    ds_read_b64_tr_b16 v[114:115], v132 offset:41984
    s_add_u32 s26, s24, 0x2a0000
    s_add_u32 m0, s29, 0x15000
    s_nop 0
    buffer_load_dwordx4 v136, s[16:19], s26 offen lds
    s_waitcnt lgkmcnt(12)
    v_mfma_f32_16x16x32_bf16 v[48:51], a[48:51], v[88:91], v[48:51]
    ds_read_b64_tr_b16 v[116:117], v133 offset:40960
    v_mfma_f32_16x16x32_bf16 v[52:55], a[112:115], v[88:91], v[52:55]
    ds_read_b64_tr_b16 v[118:119], v133 offset:41984
    s_add_u32 s26, s24, 0x2c0000
    s_add_u32 m0, s29, 0x16000
    s_nop 0
    buffer_load_dwordx4 v136, s[16:19], s26 offen lds
    s_waitcnt lgkmcnt(12)
    v_mfma_f32_16x16x32_bf16 v[56:59], a[48:51], v[92:95], v[56:59]
    ds_read_b64_tr_b16 v[120:121], v134 offset:40960
    v_mfma_f32_16x16x32_bf16 v[60:63], a[112:115], v[92:95], v[60:63]
    ds_read_b64_tr_b16 v[122:123], v134 offset:41984
    s_add_u32 s26, s24, 0x2e0000
    s_add_u32 m0, s29, 0x17000
    s_nop 0
    buffer_load_dwordx4 v136, s[16:19], s26 offen lds
    s_waitcnt lgkmcnt(12)
    v_mfma_f32_16x16x32_bf16 v[0:3], a[52:55], v[96:99], v[0:3]
    ds_read_b64_tr_b16 v[124:125], v135 offset:40960
    v_mfma_f32_16x16x32_bf16 v[4:7], a[116:119], v[96:99], v[4:7]
    ds_read_b64_tr_b16 v[126:127], v135 offset:41984
    s_waitcnt lgkmcnt(12)
    v_mfma_f32_16x16x32_bf16 v[8:11], a[52:55], v[100:103], v[8:11]
    ds_read_b64_tr_b16 v[64:65], v128 offset:49152
    v_mfma_f32_16x16x32_bf16 v[12:15], a[116:119], v[100:103], v[12:15]
    ds_read_b64_tr_b16 v[66:67], v128 offset:50176
    s_waitcnt lgkmcnt(12)
    v_mfma_f32_16x16x32_bf16 v[16:19], a[52:55], v[104:107], v[16:19]
    ds_read_b64_tr_b16 v[68:69], v129 offset:49152
    v_mfma_f32_16x16x32_bf16 v[20:23], a[116:119], v[104:107], v[20:23]
    ds_read_b64_tr_b16 v[70:71], v129 offset:50176
    s_waitcnt lgkmcnt(12)
    v_mfma_f32_16x16x32_bf16 v[24:27], a[52:55], v[108:111], v[24:27]
    ds_read_b64_tr_b16 v[72:73], v130 offset:49152
    v_mfma_f32_16x16x32_bf16 v[28:31], a[116:119], v[108:111], v[28:31]
    ds_read_b64_tr_b16 v[74:75], v130 offset:50176
    s_waitcnt lgkmcnt(12)
    v_mfma_f32_16x16x32_bf16 v[32:35], a[52:55], v[112:115], v[32:35]
    ds_read_b64_tr_b16 v[76:77], v131 offset:49152
    v_mfma_f32_16x16x32_bf16 v[36:39], a[116:119], v[112:115], v[36:39]
    ds_read_b64_tr_b16 v[78:79], v131 offset:50176
    s_waitcnt lgkmcnt(12)
    v_mfma_f32_16x16x32_bf16 v[40:43], a[52:55], v[116:119], v[40:43]
    ds_read_b64_tr_b16 v[80:81], v132 offset:49152
    v_mfma_f32_16x16x32_bf16 v[44:47], a[116:119], v[116:119], v[44:47]
    ds_read_b64_tr_b16 v[82:83], v132 offset:50176
    s_waitcnt lgkmcnt(12)
    v_mfma_f32_16x16x32_bf16 v[48:51], a[52:55], v[120:123], v[48:51]
    ds_read_b64_tr_b16 v[84:85], v133 offset:49152
    v_mfma_f32_16x16x32_bf16 v[52:55], a[116:119], v[120:123], v[52:55]
    ds_read_b64_tr_b16 v[86:87], v133 offset:50176
    s_waitcnt lgkmcnt(12)
    v_mfma_f32_16x16x32_bf16 v[56:59], a[52:55], v[124:127], v[56:59]
    ds_read_b64_tr_b16 v[88:89], v134 offset:49152
    v_mfma_f32_16x16x32_bf16 v[60:63], a[116:119], v[124:127], v[60:63]
    ds_read_b64_tr_b16 v[90:91], v134 offset:50176
    s_waitcnt lgkmcnt(12)
    v_mfma_f32_16x16x32_bf16 v[0:3], a[56:59], v[64:67], v[0:3]
    ds_read_b64_tr_b16 v[92:93], v135 offset:49152
    v_mfma_f32_16x16x32_bf16 v[4:7], a[120:123], v[64:67], v[4:7]
    ds_read_b64_tr_b16 v[94:95], v135 offset:50176
    s_waitcnt lgkmcnt(12)
    v_mfma_f32_16x16x32_bf16 v[8:11], a[56:59], v[68:71], v[8:11]
    ds_read_b64_tr_b16 v[96:97], v128 offset:57344
    v_mfma_f32_16x16x32_bf16 v[12:15], a[120:123], v[68:71], v[12:15]
    ds_read_b64_tr_b16 v[98:99], v128 offset:58368
    s_waitcnt lgkmcnt(12)
    v_mfma_f32_16x16x32_bf16 v[16:19], a[56:59], v[72:75], v[16:19]
    ds_read_b64_tr_b16 v[100:101], v129 offset:57344
    v_mfma_f32_16x16x32_bf16 v[20:23], a[120:123], v[72:75], v[20:23]
    ds_read_b64_tr_b16 v[102:103], v129 offset:58368
    s_waitcnt lgkmcnt(12)
    v_mfma_f32_16x16x32_bf16 v[24:27], a[56:59], v[76:79], v[24:27]
    ds_read_b64_tr_b16 v[104:105], v130 offset:57344
    v_mfma_f32_16x16x32_bf16 v[28:31], a[120:123], v[76:79], v[28:31]
    ds_read_b64_tr_b16 v[106:107], v130 offset:58368
    s_waitcnt lgkmcnt(12)
    v_mfma_f32_16x16x32_bf16 v[32:35], a[56:59], v[80:83], v[32:35]
    ds_read_b64_tr_b16 v[108:109], v131 offset:57344
    v_mfma_f32_16x16x32_bf16 v[36:39], a[120:123], v[80:83], v[36:39]
    ds_read_b64_tr_b16 v[110:111], v131 offset:58368
    s_waitcnt lgkmcnt(12)
    v_mfma_f32_16x16x32_bf16 v[40:43], a[56:59], v[84:87], v[40:43]
    ds_read_b64_tr_b16 v[112:113], v132 offset:57344
    v_mfma_f32_16x16x32_bf16 v[44:47], a[120:123], v[84:87], v[44:47]
    ds_read_b64_tr_b16 v[114:115], v132 offset:58368
    s_waitcnt lgkmcnt(12)
    v_mfma_f32_16x16x32_bf16 v[48:51], a[56:59], v[88:91], v[48:51]
    ds_read_b64_tr_b16 v[116:117], v133 offset:57344
    v_mfma_f32_16x16x32_bf16 v[52:55], a[120:123], v[88:91], v[52:55]
    ds_read_b64_tr_b16 v[118:119], v133 offset:58368
    s_waitcnt lgkmcnt(12)
    v_mfma_f32_16x16x32_bf16 v[56:59], a[56:59], v[92:95], v[56:59]
    ds_read_b64_tr_b16 v[120:121], v134 offset:57344
    v_mfma_f32_16x16x32_bf16 v[60:63], a[120:123], v[92:95], v[60:63]
    ds_read_b64_tr_b16 v[122:123], v134 offset:58368
    s_waitcnt lgkmcnt(12)
    v_mfma_f32_16x16x32_bf16 v[0:3], a[60:63], v[96:99], v[0:3]
    ds_read_b64_tr_b16 v[124:125], v135 offset:57344
    v_mfma_f32_16x16x32_bf16 v[4:7], a[124:127], v[96:99], v[4:7]
    ds_read_b64_tr_b16 v[126:127], v135 offset:58368
    s_waitcnt lgkmcnt(12)
    v_mfma_f32_16x16x32_bf16 v[8:11], a[60:63], v[100:103], v[8:11]
    v_mfma_f32_16x16x32_bf16 v[12:15], a[124:127], v[100:103], v[12:15]
    s_waitcnt lgkmcnt(10)
    v_mfma_f32_16x16x32_bf16 v[16:19], a[60:63], v[104:107], v[16:19]
    v_mfma_f32_16x16x32_bf16 v[20:23], a[124:127], v[104:107], v[20:23]
    s_waitcnt lgkmcnt(8)
    v_mfma_f32_16x16x32_bf16 v[24:27], a[60:63], v[108:111], v[24:27]
    v_mfma_f32_16x16x32_bf16 v[28:31], a[124:127], v[108:111], v[28:31]
    s_waitcnt lgkmcnt(6)
    v_mfma_f32_16x16x32_bf16 v[32:35], a[60:63], v[112:115], v[32:35]
    v_mfma_f32_16x16x32_bf16 v[36:39], a[124:127], v[112:115], v[36:39]
    s_waitcnt lgkmcnt(4)
    v_mfma_f32_16x16x32_bf16 v[40:43], a[60:63], v[116:119], v[40:43]
    v_mfma_f32_16x16x32_bf16 v[44:47], a[124:127], v[116:119], v[44:47]
    s_waitcnt lgkmcnt(2)
    v_mfma_f32_16x16x32_bf16 v[48:51], a[60:63], v[120:123], v[48:51]
    v_mfma_f32_16x16x32_bf16 v[52:55], a[124:127], v[120:123], v[52:55]
    s_waitcnt lgkmcnt(0)
    v_mfma_f32_16x16x32_bf16 v[56:59], a[60:63], v[124:127], v[56:59]
    v_mfma_f32_16x16x32_bf16 v[60:63], a[124:127], v[124:127], v[60:63]
    v_xor_b32 v128, 0x10000, v128
    v_xor_b32 v129, 0x10000, v129
    v_xor_b32 v130, 0x10000, v130
    v_xor_b32 v131, 0x10000, v131
    v_xor_b32 v132, 0x10000, v132
    v_xor_b32 v133, 0x10000, v133
    v_xor_b32 v134, 0x10000, v134
    v_xor_b32 v135, 0x10000, v135
    v_cvt_pk_bf16_f32 v144, v0, v1
    v_cvt_pk_bf16_f32 v145, v2, v3
    v_cvt_pk_bf16_f32 v146, v4, v5
    v_cvt_pk_bf16_f32 v147, v6, v7
    buffer_store_dwordx4 v[144:147], v137, s[8:11], s25 offen sc1
    v_cvt_pk_bf16_f32 v148, v8, v9
    v_cvt_pk_bf16_f32 v149, v10, v11
    v_cvt_pk_bf16_f32 v150, v12, v13
    v_cvt_pk_bf16_f32 v151, v14, v15
    buffer_store_dwordx4 v[148:151], v137, s[8:11], s25 offen offset:1024 sc1
    v_cvt_pk_bf16_f32 v152, v16, v17
    v_cvt_pk_bf16_f32 v153, v18, v19
    v_cvt_pk_bf16_f32 v154, v20, v21
    v_cvt_pk_bf16_f32 v155, v22, v23
    buffer_store_dwordx4 v[152:155], v137, s[8:11], s25 offen offset:2048 sc1
    v_cvt_pk_bf16_f32 v156, v24, v25
    v_cvt_pk_bf16_f32 v157, v26, v27
    v_cvt_pk_bf16_f32 v158, v28, v29
    v_cvt_pk_bf16_f32 v159, v30, v31
    buffer_store_dwordx4 v[156:159], v137, s[8:11], s25 offen offset:3072 sc1
    v_cvt_pk_bf16_f32 v144, v32, v33
    v_cvt_pk_bf16_f32 v145, v34, v35
    v_cvt_pk_bf16_f32 v146, v36, v37
    v_cvt_pk_bf16_f32 v147, v38, v39
    s_add_u32 s25, s25, 4096
    buffer_store_dwordx4 v[144:147], v137, s[8:11], s25 offen sc1
    v_cvt_pk_bf16_f32 v148, v40, v41
    v_cvt_pk_bf16_f32 v149, v42, v43
    v_cvt_pk_bf16_f32 v150, v44, v45
    v_cvt_pk_bf16_f32 v151, v46, v47
    buffer_store_dwordx4 v[148:151], v137, s[8:11], s25 offen offset:1024 sc1
    v_cvt_pk_bf16_f32 v152, v48, v49
    v_cvt_pk_bf16_f32 v153, v50, v51
    v_cvt_pk_bf16_f32 v154, v52, v53
    v_cvt_pk_bf16_f32 v155, v54, v55
    buffer_store_dwordx4 v[152:155], v137, s[8:11], s25 offen offset:2048 sc1
    v_cvt_pk_bf16_f32 v156, v56, v57
    v_cvt_pk_bf16_f32 v157, v58, v59
    v_cvt_pk_bf16_f32 v158, v60, v61
    v_cvt_pk_bf16_f32 v159, v62, v63
    buffer_store_dwordx4 v[156:159], v137, s[8:11], s25 offen offset:3072 sc1
    s_cmp_lg_u32 s20, 15
    s_cbranch_scc1 L_p1_next
    v_mov_b32 v0, -1
    v_mov_b32 v1, -1
    v_mov_b32 v2, -1
    v_mov_b32 v3, -1
    s_sub_u32 s26, s25, 0x2001000
    s_lshr_b32 s26, s26, 1
    s_add_u32 s26, s26, 0x240000
    buffer_store_dwordx4 v[0:3], v137, s[8:11], s26 offen sc1
    buffer_store_dwordx4 v[0:3], v137, s[8:11], s26 offen offset:1024 sc1
    buffer_store_dwordx4 v[0:3], v137, s[8:11], s26 offen offset:2048 sc1
    buffer_store_dwordx4 v[0:3], v137, s[8:11], s26 offen offset:3072 sc1
    s_nop 1
L_p1_next:
    s_add_u32 s80, s80, 1
    s_lshl_b32 s40, s38, 4
    s_add_u32 s40, s40, s20
    s_lshl_b32 s40, s40, 2
    s_add_u32 s40, s40, 0x2000
    s_sub_u32 s44, s25, 4095
    s_add_u32 s38, s38, s37
    s_branch L_p1_unit
L_p1_end:
    s_waitcnt vmcnt(0)
    s_barrier
    s_cmp_eq_u32 s40, 0
    s_cbranch_scc1 L_nopf_102
    s_cmp_lg_u32 s87, 0
    s_cbranch_scc1 L_modeok_103
    v_readfirstlane_b32 s96, v140
    v_readfirstlane_b32 s97, v141
    s_nop 0
    s_cmp_lg_u32 s97, 0
    s_cselect_b32 s87, s96, 0
    s_cmp_eq_u32 s87, 1
    s_cbranch_scc1 L_modeok_103
    s_mov_b32 s96, 0
L_mode_104:
    buffer_load_dwordx2 v[140:141], off, s[92:95], 0 offset:36 sc1
    s_waitcnt vmcnt(0)
    v_readfirstlane_b32 s87, v140
    v_readfirstlane_b32 s97, v141
    s_nop 0
    s_min_u32 s97, s97, s87
    s_cmp_lg_u32 s97, 0
    s_cbranch_scc1 L_moded_105
    s_sleep 4
    s_add_u32 s96, s96, 1
    s_cmp_lg_u32 s96, 0x100
    s_cbranch_scc1 L_modef_106
    v_mov_b32 v140, 2
    v_mov_b32 v141, 0
    s_mov_b64 exec, 1
    buffer_atomic_cmpswap v[140:141], off, s[92:95], 0 offset:36
    s_mov_b64 exec, -1
L_modef_106:
    s_cmp_lt_u32 s96, 0x10000
    s_cbranch_scc1 L_mode_104
L_moded_105:
    s_cmp_lg_u32 s87, 1
    s_cbranch_scc1 L_fallback
L_modeok_103:
    s_cmp_lg_u32 s100, 0
    s_cbranch_scc1 L_flag_107
    v_mov_b32 v138, 1
    s_mov_b64 exec, 1
    buffer_store_dword v138, off, s[8:11], s40 sc1
    s_mov_b64 exec, -1
L_flag_107:
    s_mov_b32 s40, 0
L_nopf_102:
    s_cmp_lg_u32 s41, 0
    s_cbranch_scc1 L_p1done
    s_mov_b32 s41, 1
    s_mul_i32 s22, s101, 171
    s_lshr_b32 s22, s22, 11
    s_mul_i32 s26, s22, 12
    s_sub_u32 s20, s101, s26
    s_add_u32 s20, s20, 4
    s_mul_i32 s27, s101, 683
    s_lshr_b32 s27, s27, 11
    s_mul_i32 s26, s27, 3
    s_sub_u32 s26, s101, s26
    s_cmp_eq_u32 s26, 2
    s_cselect_b32 s28, 10, 11
    s_cmp_ge_u32 s101, 192
    s_cselect_b32 s20, s26, s20
    s_cselect_b32 s22, s27, s22
    s_cselect_b32 s37, s28, 16
    s_branch L_p1_pass
L_p1done:
    v_mbcnt_lo_u32_b32 v0, -1, 0
    v_mbcnt_hi_u32_b32 v0, -1, v0
    s_lshl_b32 s96, s100, 6
    v_add_u32 v0, s96, v0
    s_and_b32 s20, s101, 15
    s_lshr_b32 s22, s101, 4
    s_mov_b32 s23, 14
    v_mov_b32 v1, 0
    s_lshl_b32 s24, s20, 7
    s_add_u32 s24, s24, 0x1000
    s_mul_i32 s25, s22, 14
    s_lshr_b32 s25, s25, 4
    s_add_u32 s25, s25, 12
    s_cmp_lg_u32 s100, 0
    s_cbranch_scc1 L_polls_110
    s_mov_b32 exec_lo, 0x1
    s_mov_b32 exec_hi, 0
    s_mov_b32 s96, 0
L_poll_108:
    buffer_load_dword v2, v1, s[8:11], s24 offen sc1
    s_waitcnt vmcnt(0)
    v_cmp_gt_u32 vcc, s25, v2
    s_cbranch_vccz L_polld_109
    v_readfirstlane_b32 s97, v2
    s_nop 0
    s_sub_u32 s97, s25, s97
    s_cmp_lt_i32 s97, 3
    s_cbranch_scc1 L_near_111
    s_sleep 40
    s_cmp_lt_i32 s97, 5
    s_cbranch_scc1 L_near_111
    s_sleep 100
L_near_111:
    s_sleep 4
    s_add_u32 s96, s96, 1
    s_cmp_lt_u32 s96, 0x10000
    s_cbranch_scc1 L_poll_108
L_polld_109:
    s_mov_b64 exec, -1
L_polls_110:
    s_barrier
    s_load_dwordx2 s[12:13], s[0:1], 40
    s_waitcnt lgkmcnt(0)
    s_and_b32 s13, s13, 0xffff
    s_mov_b32 s14, 0x400000
    s_mov_b32 s15, 0x20000
    v_lshrrev_b32 v4, 6, v0
    s_nop 0
    v_readfirstlane_b32 s21, v4
    v_and_b32 v1, 63, v0
    v_lshrrev_b32 v2, 4, v1
    v_and_b32 v3, 15, v1
    v_lshrrev_b32 v6, 2, v3
    v_lshlrev_b32 v240, 4, v1
    v_lshlrev_b32 v241, 3, v1
    s_lshl_b32 s27, s21, 10
    s_lshl_b32 s24, s21, 5
    v_xor_b32 v4, s24, v240
    v_add_u32 v8, s27, v4
    v_xor_b32 v9, 128, v8
    v_lshl_add_u32 v4, v2, 2, v6
    v_and_b32 v5, 7, v4
    v_lshlrev_b32 v4, 10, v4
    v_lshl_add_u32 v4, v5, 5, v4
    v_and_b32 v5, 3, v3
    v_lshlrev_b32 v5, 4, v5
    v_xor_b32 v4, v5, v4
    s_lshl_b32 s24, s21, 8
    v_add_u32 v10, s24, v4
    s_lshl_b32 s25, s20, 18
    s_add_u32 s24, s25, 0x0
    s_add_u32 m0, s27, 0x0
    s_nop 0
    buffer_load_dwordx4 v8, s[12:15], s24 offen lds
    s_add_u32 s24, s25, 0x1000
    s_add_u32 m0, s27, 0x1000
    s_nop 0
    buffer_load_dwordx4 v9, s[12:15], s24 offen lds
    s_add_u32 s24, s25, 0x2000
    s_add_u32 m0, s27, 0x2000
    s_nop 0
    buffer_load_dwordx4 v8, s[12:15], s24 offen lds
    s_add_u32 s24, s25, 0x3000
    s_add_u32 m0, s27, 0x3000
    s_nop 0
    buffer_load_dwordx4 v9, s[12:15], s24 offen lds
    s_add_u32 s24, s25, 0x4000
    s_add_u32 m0, s27, 0x4000
    s_nop 0
    buffer_load_dwordx4 v8, s[12:15], s24 offen lds
    s_add_u32 s24, s25, 0x5000
    s_add_u32 m0, s27, 0x5000
    s_nop 0
    buffer_load_dwordx4 v9, s[12:15], s24 offen lds
    s_add_u32 s24, s25, 0x6000
    s_add_u32 m0, s27, 0x6000
    s_nop 0
    buffer_load_dwordx4 v8, s[12:15], s24 offen lds
    s_add_u32 s24, s25, 0x7000
    s_add_u32 m0, s27, 0x7000
    s_nop 0
    buffer_load_dwordx4 v9, s[12:15], s24 offen lds
    s_add_u32 s24, s25, 0x8000
    s_add_u32 m0, s27, 0x8000
    s_nop 0
    buffer_load_dwordx4 v8, s[12:15], s24 offen lds
    s_add_u32 s24, s25, 0x9000
    s_add_u32 m0, s27, 0x9000
    s_nop 0
    buffer_load_dwordx4 v9, s[12:15], s24 offen lds
    s_add_u32 s24, s25, 0xa000
    s_add_u32 m0, s27, 0xa000
    s_nop 0
    buffer_load_dwordx4 v8, s[12:15], s24 offen lds
    s_add_u32 s24, s25, 0xb000
    s_add_u32 m0, s27, 0xb000
    s_nop 0
    buffer_load_dwordx4 v9, s[12:15], s24 offen lds
    s_add_u32 s24, s25, 0xc000
    s_add_u32 m0, s27, 0xc000
    s_nop 0
    buffer_load_dwordx4 v8, s[12:15], s24 offen lds
    s_add_u32 s24, s25, 0xd000
    s_add_u32 m0, s27, 0xd000
    s_nop 0
    buffer_load_dwordx4 v9, s[12:15], s24 offen lds
    s_add_u32 s24, s25, 0xe000
    s_add_u32 m0, s27, 0xe000
    s_nop 0
    buffer_load_dwordx4 v8, s[12:15], s24 offen lds
    s_add_u32 s24, s25, 0xf000
    s_add_u32 m0, s27, 0xf000
    s_nop 0
    buffer_load_dwordx4 v9, s[12:15], s24 offen lds
    s_add_u32 s24, s25, 0x10000
    s_add_u32 m0, s27, 0x10000
    s_nop 0
    buffer_load_dwordx4 v8, s[12:15], s24 offen lds
    s_add_u32 s24, s25, 0x11000
    s_add_u32 m0, s27, 0x11000
    s_nop 0
    buffer_load_dwordx4 v9, s[12:15], s24 offen lds
    s_add_u32 s24, s25, 0x12000
    s_add_u32 m0, s27, 0x12000
    s_nop 0
    buffer_load_dwordx4 v8, s[12:15], s24 offen lds
    s_add_u32 s24, s25, 0x13000
    s_add_u32 m0, s27, 0x13000
    s_nop 0
    buffer_load_dwordx4 v9, s[12:15], s24 offen lds
    s_add_u32 s24, s25, 0x14000
    s_add_u32 m0, s27, 0x14000
    s_nop 0
    buffer_load_dwordx4 v8, s[12:15], s24 offen lds
    s_add_u32 s24, s25, 0x15000
    s_add_u32 m0, s27, 0x15000
    s_nop 0
    buffer_load_dwordx4 v9, s[12:15], s24 offen lds
    s_add_u32 s24, s25, 0x16000
    s_add_u32 m0, s27, 0x16000
    s_nop 0
    buffer_load_dwordx4 v8, s[12:15], s24 offen lds
    s_add_u32 s24, s25, 0x17000
    s_add_u32 m0, s27, 0x17000
    s_nop 0
    buffer_load_dwordx4 v9, s[12:15], s24 offen lds
    s_add_u32 s24, s25, 0x18000
    s_add_u32 m0, s27, 0x18000
    s_nop 0
    buffer_load_dwordx4 v8, s[12:15], s24 offen lds
    s_add_u32 s24, s25, 0x19000
    s_add_u32 m0, s27, 0x19000
    s_nop 0
    buffer_load_dwordx4 v9, s[12:15], s24 offen lds
    s_add_u32 s24, s25, 0x1a000
    s_add_u32 m0, s27, 0x1a000
    s_nop 0
    buffer_load_dwordx4 v8, s[12:15], s24 offen lds
    s_add_u32 s24, s25, 0x1b000
    s_add_u32 m0, s27, 0x1b000
    s_nop 0
    buffer_load_dwordx4 v9, s[12:15], s24 offen lds
    s_add_u32 s24, s25, 0x1c000
    s_add_u32 m0, s27, 0x1c000
    s_nop 0
    buffer_load_dwordx4 v8, s[12:15], s24 offen lds
    s_add_u32 s24, s25, 0x1d000
    s_add_u32 m0, s27, 0x1d000
    s_nop 0
    buffer_load_dwordx4 v9, s[12:15], s24 offen lds
    s_add_u32 s24, s25, 0x1e000
    s_add_u32 m0, s27, 0x1e000
    s_nop 0
    buffer_load_dwordx4 v8, s[12:15], s24 offen lds
    s_add_u32 s24, s25, 0x1f000
    s_add_u32 m0, s27, 0x1f000
    s_nop 0
    buffer_load_dwordx4 v9, s[12:15], s24 offen lds
    s_waitcnt vmcnt(0)
    s_barrier
    v_xor_b32 v11, 0x0, v10
    ds_read_b64_tr_b16 a[0:1], v11
    ds_read_b64_tr_b16 a[2:3], v11 offset:16384
    ds_read_b64_tr_b16 a[32:33], v11 offset:32768
    ds_read_b64_tr_b16 a[34:35], v11 offset:49152
    v_xor_b32 v11, 0x8, v10
    ds_read_b64_tr_b16 a[4:5], v11
    ds_read_b64_tr_b16 a[6:7], v11 offset:16384
    ds_read_b64_tr_b16 a[36:37], v11 offset:32768
    ds_read_b64_tr_b16 a[38:39], v11 offset:49152
    s_waitcnt lgkmcnt(0)
    v_xor_b32 v11, 0x40, v10
    ds_read_b64_tr_b16 a[8:9], v11
    ds_read_b64_tr_b16 a[10:11], v11 offset:16384
    ds_read_b64_tr_b16 a[40:41], v11 offset:32768
    ds_read_b64_tr_b16 a[42:43], v11 offset:49152
    v_xor_b32 v11, 0x48, v10
    ds_read_b64_tr_b16 a[12:13], v11
    ds_read_b64_tr_b16 a[14:15], v11 offset:16384
    ds_read_b64_tr_b16 a[44:45], v11 offset:32768
    ds_read_b64_tr_b16 a[46:47], v11 offset:49152
    s_waitcnt lgkmcnt(0)
    v_xor_b32 v11, 0x80, v10
    ds_read_b64_tr_b16 a[16:17], v11
    ds_read_b64_tr_b16 a[18:19], v11 offset:16384
    ds_read_b64_tr_b16 a[48:49], v11 offset:32768
    ds_read_b64_tr_b16 a[50:51], v11 offset:49152
    v_xor_b32 v11, 0x88, v10
    ds_read_b64_tr_b16 a[20:21], v11
    ds_read_b64_tr_b16 a[22:23], v11 offset:16384
    ds_read_b64_tr_b16 a[52:53], v11 offset:32768
    ds_read_b64_tr_b16 a[54:55], v11 offset:49152
    s_waitcnt lgkmcnt(0)
    v_xor_b32 v11, 0xc0, v10
    ds_read_b64_tr_b16 a[24:25], v11
    ds_read_b64_tr_b16 a[26:27], v11 offset:16384
    ds_read_b64_tr_b16 a[56:57], v11 offset:32768
    ds_read_b64_tr_b16 a[58:59], v11 offset:49152
    v_xor_b32 v11, 0xc8, v10
    ds_read_b64_tr_b16 a[28:29], v11
    ds_read_b64_tr_b16 a[30:31], v11 offset:16384
    ds_read_b64_tr_b16 a[60:61], v11 offset:32768
    ds_read_b64_tr_b16 a[62:63], v11 offset:49152
    s_waitcnt lgkmcnt(0)
    v_xor_b32 v11, 0x10000, v10
    ds_read_b64_tr_b16 a[64:65], v11
    ds_read_b64_tr_b16 a[66:67], v11 offset:16384
    ds_read_b64_tr_b16 a[96:97], v11 offset:32768
    ds_read_b64_tr_b16 a[98:99], v11 offset:49152
    v_xor_b32 v11, 0x10008, v10
    ds_read_b64_tr_b16 a[68:69], v11
    ds_read_b64_tr_b16 a[70:71], v11 offset:16384
    ds_read_b64_tr_b16 a[100:101], v11 offset:32768
    ds_read_b64_tr_b16 a[102:103], v11 offset:49152
    s_waitcnt lgkmcnt(0)
    v_xor_b32 v11, 0x10040, v10
    ds_read_b64_tr_b16 a[72:73], v11
    ds_read_b64_tr_b16 a[74:75], v11 offset:16384
    ds_read_b64_tr_b16 a[104:105], v11 offset:32768
    ds_read_b64_tr_b16 a[106:107], v11 offset:49152
    v_xor_b32 v11, 0x10048, v10
    ds_read_b64_tr_b16 a[76:77], v11
    ds_read_b64_tr_b16 a[78:79], v11 offset:16384
    ds_read_b64_tr_b16 a[108:109], v11 offset:32768
    ds_read_b64_tr_b16 a[110:111], v11 offset:49152
    s_waitcnt lgkmcnt(0)
    v_xor_b32 v11, 0x10080, v10
    ds_read_b64_tr_b16 a[80:81], v11
    ds_read_b64_tr_b16 a[82:83], v11 offset:16384
    ds_read_b64_tr_b16 a[112:113], v11 offset:32768
    ds_read_b64_tr_b16 a[114:115], v11 offset:49152
    v_xor_b32 v11, 0x10088, v10
    ds_read_b64_tr_b16 a[84:85], v11
    ds_read_b64_tr_b16 a[86:87], v11 offset:16384
    ds_read_b64_tr_b16 a[116:117], v11 offset:32768
    ds_read_b64_tr_b16 a[118:119], v11 offset:49152
    s_waitcnt lgkmcnt(0)
    v_xor_b32 v11, 0x100c0, v10
    ds_read_b64_tr_b16 a[88:89], v11
    ds_read_b64_tr_b16 a[90:91], v11 offset:16384
    ds_read_b64_tr_b16 a[120:121], v11 offset:32768
    ds_read_b64_tr_b16 a[122:123], v11 offset:49152
    v_xor_b32 v11, 0x100c8, v10
    ds_read_b64_tr_b16 a[92:93], v11
    ds_read_b64_tr_b16 a[94:95], v11 offset:16384
    ds_read_b64_tr_b16 a[124:125], v11 offset:32768
    ds_read_b64_tr_b16 a[126:127], v11 offset:49152
    s_waitcnt lgkmcnt(0)
    s_barrier
    s_lshl_b32 s25, s20, 18
    s_add_u32 s24, s25, 0x20000
    s_add_u32 m0, s27, 0x0
    s_nop 0
    buffer_load_dwordx4 v8, s[12:15], s24 offen lds
    s_add_u32 s24, s25, 0x21000
    s_add_u32 m0, s27, 0x1000
    s_nop 0
    buffer_load_dwordx4 v9, s[12:15], s24 offen lds
    s_add_u32 s24, s25, 0x22000
    s_add_u32 m0, s27, 0x2000
    s_nop 0
    buffer_load_dwordx4 v8, s[12:15], s24 offen lds
    s_add_u32 s24, s25, 0x23000
    s_add_u32 m0, s27, 0x3000
    s_nop 0
    buffer_load_dwordx4 v9, s[12:15], s24 offen lds
    s_add_u32 s24, s25, 0x24000
    s_add_u32 m0, s27, 0x4000
    s_nop 0
    buffer_load_dwordx4 v8, s[12:15], s24 offen lds
    s_add_u32 s24, s25, 0x25000
    s_add_u32 m0, s27, 0x5000
    s_nop 0
    buffer_load_dwordx4 v9, s[12:15], s24 offen lds
    s_add_u32 s24, s25, 0x26000
    s_add_u32 m0, s27, 0x6000
    s_nop 0
    buffer_load_dwordx4 v8, s[12:15], s24 offen lds
    s_add_u32 s24, s25, 0x27000
    s_add_u32 m0, s27, 0x7000
    s_nop 0
    buffer_load_dwordx4 v9, s[12:15], s24 offen lds
    s_add_u32 s24, s25, 0x28000
    s_add_u32 m0, s27, 0x8000
    s_nop 0
    buffer_load_dwordx4 v8, s[12:15], s24 offen lds
    s_add_u32 s24, s25, 0x29000
    s_add_u32 m0, s27, 0x9000
    s_nop 0
    buffer_load_dwordx4 v9, s[12:15], s24 offen lds
    s_add_u32 s24, s25, 0x2a000
    s_add_u32 m0, s27, 0xa000
    s_nop 0
    buffer_load_dwordx4 v8, s[12:15], s24 offen lds
    s_add_u32 s24, s25, 0x2b000
    s_add_u32 m0, s27, 0xb000
    s_nop 0
    buffer_load_dwordx4 v9, s[12:15], s24 offen lds
    s_add_u32 s24, s25, 0x2c000
    s_add_u32 m0, s27, 0xc000
    s_nop 0
    buffer_load_dwordx4 v8, s[12:15], s24 offen lds
    s_add_u32 s24, s25, 0x2d000
    s_add_u32 m0, s27, 0xd000
    s_nop 0
    buffer_load_dwordx4 v9, s[12:15], s24 offen lds
    s_add_u32 s24, s25, 0x2e000
    s_add_u32 m0, s27, 0xe000
    s_nop 0
    buffer_load_dwordx4 v8, s[12:15], s24 offen lds
    s_add_u32 s24, s25, 0x2f000
    s_add_u32 m0, s27, 0xf000
    s_nop 0
    buffer_load_dwordx4 v9, s[12:15], s24 offen lds
    s_add_u32 s24, s25, 0x30000
    s_add_u32 m0, s27, 0x10000
    s_nop 0
    buffer_load_dwordx4 v8, s[12:15], s24 offen lds
    s_add_u32 s24, s25, 0x31000
    s_add_u32 m0, s27, 0x11000
    s_nop 0
    buffer_load_dwordx4 v9, s[12:15], s24 offen lds
    s_add_u32 s24, s25, 0x32000
    s_add_u32 m0, s27, 0x12000
    s_nop 0
    buffer_load_dwordx4 v8, s[12:15], s24 offen lds
    s_add_u32 s24, s25, 0x33000
    s_add_u32 m0, s27, 0x13000
    s_nop 0
    buffer_load_dwordx4 v9, s[12:15], s24 offen lds
    s_add_u32 s24, s25, 0x34000
    s_add_u32 m0, s27, 0x14000
    s_nop 0
    buffer_load_dwordx4 v8, s[12:15], s24 offen lds
    s_add_u32 s24, s25, 0x35000
    s_add_u32 m0, s27, 0x15000
    s_nop 0
    buffer_load_dwordx4 v9, s[12:15], s24 offen lds
    s_add_u32 s24, s25, 0x36000
    s_add_u32 m0, s27, 0x16000
    s_nop 0
    buffer_load_dwordx4 v8, s[12:15], s24 offen lds
    s_add_u32 s24, s25, 0x37000
    s_add_u32 m0, s27, 0x17000
    s_nop 0
    buffer_load_dwordx4 v9, s[12:15], s24 offen lds
    s_add_u32 s24, s25, 0x38000
    s_add_u32 m0, s27, 0x18000
    s_nop 0
    buffer_load_dwordx4 v8, s[12:15], s24 offen lds
    s_add_u32 s24, s25, 0x39000
    s_add_u32 m0, s27, 0x19000
    s_nop 0
    buffer_load_dwordx4 v9, s[12:15], s24 offen lds
    s_add_u32 s24, s25, 0x3a000
    s_add_u32 m0, s27, 0x1a000
    s_nop 0
    buffer_load_dwordx4 v8, s[12:15], s24 offen lds
    s_add_u32 s24, s25, 0x3b000
    s_add_u32 m0, s27, 0x1b000
    s_nop 0
    buffer_load_dwordx4 v9, s[12:15], s24 offen lds
    s_add_u32 s24, s25, 0x3c000
    s_add_u32 m0, s27, 0x1c000
    s_nop 0
    buffer_load_dwordx4 v8, s[12:15], s24 offen lds
    s_add_u32 s24, s25, 0x3d000
    s_add_u32 m0, s27, 0x1d000
    s_nop 0
    buffer_load_dwordx4 v9, s[12:15], s24 offen lds
    s_add_u32 s24, s25, 0x3e000
    s_add_u32 m0, s27, 0x1e000
    s_nop 0
    buffer_load_dwordx4 v8, s[12:15], s24 offen lds
    s_add_u32 s24, s25, 0x3f000
    s_add_u32 m0, s27, 0x1f000
    s_nop 0
    buffer_load_dwordx4 v9, s[12:15], s24 offen lds
    s_waitcnt vmcnt(0)
    s_barrier
    v_xor_b32 v11, 0x0, v10
    ds_read_b64_tr_b16 a[128:129], v11
    ds_read_b64_tr_b16 a[130:131], v11 offset:16384
    ds_read_b64_tr_b16 a[160:161], v11 offset:32768
    ds_read_b64_tr_b16 a[162:163], v11 offset:49152
    v_xor_b32 v11, 0x8, v10
    ds_read_b64_tr_b16 a[132:133], v11
    ds_read_b64_tr_b16 a[134:135], v11 offset:16384
    ds_read_b64_tr_b16 a[164:165], v11 offset:32768
    ds_read_b64_tr_b16 a[166:167], v11 offset:49152
    s_waitcnt lgkmcnt(0)
    v_xor_b32 v11, 0x40, v10
    ds_read_b64_tr_b16 a[136:137], v11
    ds_read_b64_tr_b16 a[138:139], v11 offset:16384
    ds_read_b64_tr_b16 a[168:169], v11 offset:32768
    ds_read_b64_tr_b16 a[170:171], v11 offset:49152
    v_xor_b32 v11, 0x48, v10
    ds_read_b64_tr_b16 a[140:141], v11
    ds_read_b64_tr_b16 a[142:143], v11 offset:16384
    ds_read_b64_tr_b16 a[172:173], v11 offset:32768
    ds_read_b64_tr_b16 a[174:175], v11 offset:49152
    s_waitcnt lgkmcnt(0)
    v_xor_b32 v11, 0x80, v10
    ds_read_b64_tr_b16 a[144:145], v11
    ds_read_b64_tr_b16 a[146:147], v11 offset:16384
    ds_read_b64_tr_b16 a[176:177], v11 offset:32768
    ds_read_b64_tr_b16 a[178:179], v11 offset:49152
    v_xor_b32 v11, 0x88, v10
    ds_read_b64_tr_b16 a[148:149], v11
    ds_read_b64_tr_b16 a[150:151], v11 offset:16384
    ds_read_b64_tr_b16 a[180:181], v11 offset:32768
    ds_read_b64_tr_b16 a[182:183], v11 offset:49152
    s_waitcnt lgkmcnt(0)
    v_xor_b32 v11, 0xc0, v10
    ds_read_b64_tr_b16 a[152:153], v11
    ds_read_b64_tr_b16 a[154:155], v11 offset:16384
    ds_read_b64_tr_b16 a[184:185], v11 offset:32768
    ds_read_b64_tr_b16 a[186:187], v11 offset:49152
    v_xor_b32 v11, 0xc8, v10
    ds_read_b64_tr_b16 a[156:157], v11
    ds_read_b64_tr_b16 a[158:159], v11 offset:16384
    ds_read_b64_tr_b16 a[188:189], v11 offset:32768
    ds_read_b64_tr_b16 a[190:191], v11 offset:49152
    s_waitcnt lgkmcnt(0)
    v_xor_b32 v11, 0x10000, v10
    ds_read_b64_tr_b16 a[192:193], v11
    ds_read_b64_tr_b16 a[194:195], v11 offset:16384
    ds_read_b64_tr_b16 a[224:225], v11 offset:32768
    ds_read_b64_tr_b16 a[226:227], v11 offset:49152
    v_xor_b32 v11, 0x10008, v10
    ds_read_b64_tr_b16 a[196:197], v11
    ds_read_b64_tr_b16 a[198:199], v11 offset:16384
    ds_read_b64_tr_b16 a[228:229], v11 offset:32768
    ds_read_b64_tr_b16 a[230:231], v11 offset:49152
    s_waitcnt lgkmcnt(0)
    v_xor_b32 v11, 0x10040, v10
    ds_read_b64_tr_b16 a[200:201], v11
    ds_read_b64_tr_b16 a[202:203], v11 offset:16384
    ds_read_b64_tr_b16 a[232:233], v11 offset:32768
    ds_read_b64_tr_b16 a[234:235], v11 offset:49152
    v_xor_b32 v11, 0x10048, v10
    ds_read_b64_tr_b16 a[204:205], v11
    ds_read_b64_tr_b16 a[206:207], v11 offset:16384
    ds_read_b64_tr_b16 a[236:237], v11 offset:32768
    ds_read_b64_tr_b16 a[238:239], v11 offset:49152
    s_waitcnt lgkmcnt(0)
    v_xor_b32 v11, 0x10080, v10
    ds_read_b64_tr_b16 a[208:209], v11
    ds_read_b64_tr_b16 a[210:211], v11 offset:16384
    ds_read_b64_tr_b16 a[240:241], v11 offset:32768
    ds_read_b64_tr_b16 a[242:243], v11 offset:49152
    v_xor_b32 v11, 0x10088, v10
    ds_read_b64_tr_b16 a[212:213], v11
    ds_read_b64_tr_b16 a[214:215], v11 offset:16384
    ds_read_b64_tr_b16 a[244:245], v11 offset:32768
    ds_read_b64_tr_b16 a[246:247], v11 offset:49152
    s_waitcnt lgkmcnt(0)
    v_xor_b32 v11, 0x100c0, v10
    ds_read_b64_tr_b16 a[216:217], v11
    ds_read_b64_tr_b16 a[218:219], v11 offset:16384
    ds_read_b64_tr_b16 a[248:249], v11 offset:32768
    ds_read_b64_tr_b16 a[250:251], v11 offset:49152
    v_xor_b32 v11, 0x100c8, v10
    ds_read_b64_tr_b16 a[220:221], v11
    ds_read_b64_tr_b16 a[222:223], v11 offset:16384
    ds_read_b64_tr_b16 a[252:253], v11 offset:32768
    ds_read_b64_tr_b16 a[254:255], v11 offset:49152
    s_waitcnt lgkmcnt(0)
    s_barrier
    s_and_b32 s24, s21, 1
    s_lshl_b32 s24, s24, 4
    v_add_u32 v4, s24, v3
    v_lshlrev_b32 v5, 2, v2
    v_sub_u32 v4, v4, v5
    v_cmp_le_i32 s[30:31], 0, v4
    v_cmp_le_i32 s[32:33], 1, v4
    v_cmp_le_i32 s[34:35], 2, v4
    v_cmp_le_i32 s[36:37], 3, v4
    v_cmp_le_i32 s[38:39], 16, v4
    v_cmp_le_i32 s[40:41], 17, v4
    v_cmp_le_i32 s[42:43], 18, v4
    v_cmp_le_i32 s[44:45], 19, v4
    s_mov_b32 s28, 0x3e0293ee
    s_mov_b32 s29, 0x3e0293ee
    s_mov_b32 s53, 0xff000000
    v_mov_b32 v136, 0x3f803f80
    v_mov_b32 v137, 0x3f803f80
    v_mov_b32 v138, 0x3f803f80
    v_mov_b32 v139, 0x3f803f80
    v_lshlrev_b32 v4, 10, v3
    v_lshl_add_u32 v4, v2, 4, v4
    s_lshl_b32 s24, s21, 8
    v_add_u32 v242, s24, v4
    s_lshl_b32 s24, s21, 12
    v_add_u32 v243, s24, v240
    v_mov_b32 v244, v240
    s_add_u32 s24, s24, 0x22000
    v_xor_b32 v7, v2, v6
    v_lshl_add_u32 v4, v2, 4, v7
    v_and_b32 v5, 3, v3
    v_lshl_add_u32 v4, v4, 2, v5
    v_lshl_add_u32 v253, v4, 2, s24
    v_lshl_add_u32 v4, v3, 2, v7
    v_lshl_add_u32 v254, v4, 4, s24
    s_load_dwordx2 s[12:13], s[0:1], 0
    s_waitcnt lgkmcnt(0)
    s_and_b32 s13, s13, 0xffff
    s_mov_b32 s14, 0x200000
    s_mov_b32 s15, 0x20000
    s_load_dwordx2 s[16:17], s[0:1], 96
    s_waitcnt lgkmcnt(0)
    s_and_b32 s17, s17, 0xffff
    s_mov_b32 s18, 0x200000
    s_mov_b32 s19, 0x20000
    s_load_dwordx2 s[56:57], s[0:1], 64
    s_waitcnt lgkmcnt(0)
    s_and_b32 s57, s57, 0xffff
    s_mov_b32 s58, 0x400
    s_mov_b32 s59, 0x20000
    v_and_b32 v100, 63, v0
    v_lshlrev_b32 v240, 4, v100
    buffer_load_dwordx4 v[236:239], v240, s[56:59], 0 offen
    s_mov_b32 s65, 0x3f80
    s_mov_b32 s66, 0x3f800000
    s_waitcnt vmcnt(0)
    s_sub_u32 s67, s101, 128
    s_cmp_ge_u32 s67, 56
    s_cbranch_scc1 L_nostage_112
L_nostage_112:
    v_lshrrev_b32 v246, 2, v240
    s_lshl_b32 s24, s20, 7
    s_add_u32 s24, s24, 0x2000
    s_cmp_lg_u32 s100, 0
    s_cbranch_scc1 L_polls_115
    s_mov_b32 exec_lo, 0xffffffff
    s_mov_b32 exec_hi, 0
    s_mov_b32 s96, 0
L_poll_113:
    buffer_load_dword v247, v246, s[8:11], s24 offen sc1
    s_waitcnt vmcnt(0)
    v_cmp_gt_u32 vcc, 1, v247
    s_cbranch_vccz L_polld_114
    s_sleep 32
    s_add_u32 s96, s96, 1
    s_cmp_lt_u32 s96, 0x10000
    s_cbranch_scc1 L_poll_113
L_polld_114:
    s_mov_b64 exec, -1
L_polls_115:
    s_barrier
    s_lshl_b32 s24, s20, 7
    s_add_u32 s24, s24, 0x2800
    s_cmp_lg_u32 s100, 0
    s_cbranch_scc1 L_polls_118
    s_mov_b32 exec_lo, 0xffffffff
    s_mov_b32 exec_hi, 0
    s_mov_b32 s96, 0
L_poll_116:
    buffer_load_dword v247, v246, s[8:11], s24 offen sc1
    s_waitcnt vmcnt(0)
    v_cmp_gt_u32 vcc, 1, v247
    s_cbranch_vccz L_polld_117
    s_sleep 32
    s_add_u32 s96, s96, 1
    s_cmp_lt_u32 s96, 0x10000
    s_cbranch_scc1 L_poll_116
L_polld_117:
    s_mov_b64 exec, -1
L_polls_118:
    s_barrier
    s_lshl_b32 s24, s20, 7
    s_add_u32 s24, s24, 0x3000
    s_cmp_lg_u32 s100, 0
    s_cbranch_scc1 L_polls_121
    s_mov_b32 exec_lo, 0xffffffff
    s_mov_b32 exec_hi, 0
    s_mov_b32 s96, 0
L_poll_119:
    buffer_load_dword v247, v246, s[8:11], s24 offen sc1
    s_waitcnt vmcnt(0)
    v_cmp_gt_u32 vcc, 1, v247
    s_cbranch_vccz L_polld_120
    s_sleep 32
    s_add_u32 s96, s96, 1
    s_cmp_lt_u32 s96, 0x10000
    s_cbranch_scc1 L_poll_119
L_polld_120:
    s_mov_b64 exec, -1
L_polls_121:
    s_barrier
    s_mov_b32 s80, 0
    s_mov_b32 s82, 0
    v_add_u32 v105, 0x8000, v240
    v_add_u32 v106, 0x10000, v240
    v_add_u32 v107, 0x18000, v240
    s_lshl_b32 s24, s21, 12
    s_add_u32 s24, s24, 0x22000
    v_add_u32 v109, s24, v240
    s_nop 4
L_p2_seg:
    s_cmp_ge_u32 s22, 64
    s_cbranch_scc1 L_p2_end
    v_lshrrev_b32 v246, 2, v240
    s_lshl_b32 s24, s20, 7
    s_add_u32 s24, s24, 0x1000
    s_mul_i32 s25, s22, 10
    s_lshr_b32 s25, s25, 4
    s_add_u32 s25, s25, 17
    s_cmp_lg_u32 s100, 0
    s_cbranch_scc1 L_polls_124
    s_mov_b32 exec_lo, 0x1
    s_mov_b32 exec_hi, 0
    s_mov_b32 s96, 0
L_poll_122:
    buffer_load_dword v247, v246, s[8:11], s24 offen sc1
    s_waitcnt vmcnt(0)
    v_cmp_gt_u32 vcc, s25, v247
    s_cbranch_vccz L_polld_123
    v_readfirstlane_b32 s97, v247
    s_nop 0
    s_sub_u32 s97, s25, s97
    s_cmp_lt_i32 s97, 3
    s_cbranch_scc1 L_near_125
    s_sleep 40
    s_cmp_lt_i32 s97, 5
    s_cbranch_scc1 L_near_125
    s_sleep 100
L_near_125:
    s_sleep 4
    s_add_u32 s96, s96, 1
    s_cmp_lt_u32 s96, 0x10000
    s_cbranch_scc1 L_poll_122
L_polld_123:
    s_mov_b64 exec, -1
L_polls_124:
    s_barrier
    s_cmp_ge_u32 s67, 56
    s_cbranch_scc1 L_nostage_126
    v_mbcnt_lo_u32_b32 v0, -1, 0
    v_mbcnt_hi_u32_b32 v0, -1, v0
    s_lshl_b32 s96, s100, 6
    v_add_u32 v0, s96, v0
    v_lshrrev_b32 v2, 6, v0
    s_nop 0
    v_readfirstlane_b32 s68, v2
    v_and_b32 v1, 63, v0
    s_lshl_b32 s73, s68, 10
    v_lshrrev_b32 v2, 2, v1
    s_lshl_b32 s71, s68, 4
    v_add_u32 v2, s71, v2
    s_movk_i32 s71, 3584
    v_mul_lo_u32 v2, v2, s71
    v_and_b32 v3, 3, v1
    v_lshl_add_u32 v4, v3, 4, v2
    s_cmp_lg_u32 s80, 0
    s_cbranch_scc1 L_part_127
    s_load_dwordx2 s[76:77], s[0:1], 72
    s_waitcnt lgkmcnt(0)
    s_and_b32 s77, s77, 0xffff
    s_mov_b32 s78, 0x1c0000
    s_mov_b32 s79, 0x20000
    s_lshl_b32 s71, s67, 6
    s_add_u32 s71, s71, 0x0
    s_add_u32 m0, s73, 0x8000
    s_nop 0
    buffer_load_dwordx4 v4, s[76:79], s71 offen lds
    s_lshl_b32 s71, s67, 6
    s_add_u32 s71, s71, 0x38000
    s_add_u32 m0, s73, 0x9000
    s_nop 0
    buffer_load_dwordx4 v4, s[76:79], s71 offen lds
    s_lshl_b32 s71, s67, 6
    s_add_u32 s71, s71, 0x70000
    s_add_u32 m0, s73, 0xa000
    s_nop 0
    buffer_load_dwordx4 v4, s[76:79], s71 offen lds
    s_lshl_b32 s71, s67, 6
    s_add_u32 s71, s71, 0xa8000
    s_add_u32 m0, s73, 0xb000
    s_nop 0
    buffer_load_dwordx4 v4, s[76:79], s71 offen lds
    s_lshl_b32 s71, s67, 6
    s_add_u32 s71, s71, 0xe0000
    s_add_u32 m0, s73, 0xc000
    s_nop 0
    buffer_load_dwordx4 v4, s[76:79], s71 offen lds
    s_lshl_b32 s71, s67, 6
    s_add_u32 s71, s71, 0x118000
    s_add_u32 m0, s73, 0xd000
    s_nop 0
    buffer_load_dwordx4 v4, s[76:79], s71 offen lds
    s_lshl_b32 s71, s67, 6
    s_add_u32 s71, s71, 0x150000
    s_add_u32 m0, s73, 0xe000
    s_nop 0
    buffer_load_dwordx4 v4, s[76:79], s71 offen lds
    s_lshl_b32 s71, s67, 6
    s_add_u32 s71, s71, 0x188000
    s_add_u32 m0, s73, 0xf000
    s_nop 0
    buffer_load_dwordx4 v4, s[76:79], s71 offen lds
L_part_127:
    s_cmp_lg_u32 s80, 4
    s_cbranch_scc1 L_part_128
    s_load_dwordx2 s[76:77], s[0:1], 80
    s_waitcnt lgkmcnt(0)
    s_and_b32 s77, s77, 0xffff
    s_mov_b32 s78, 0x1c0000
    s_mov_b32 s79, 0x20000
    s_lshl_b32 s71, s67, 6
    s_add_u32 s71, s71, 0x0
    s_add_u32 m0, s73, 0x10000
    s_nop 0
    buffer_load_dwordx4 v4, s[76:79], s71 offen lds
    s_lshl_b32 s71, s67, 6
    s_add_u32 s71, s71, 0x38000
    s_add_u32 m0, s73, 0x11000
    s_nop 0
    buffer_load_dwordx4 v4, s[76:79], s71 offen lds
    s_lshl_b32 s71, s67, 6
    s_add_u32 s71, s71, 0x70000
    s_add_u32 m0, s73, 0x12000
    s_nop 0
    buffer_load_dwordx4 v4, s[76:79], s71 offen lds
    s_lshl_b32 s71, s67, 6
    s_add_u32 s71, s71, 0xa8000
    s_add_u32 m0, s73, 0x13000
    s_nop 0
    buffer_load_dwordx4 v4, s[76:79], s71 offen lds
    s_lshl_b32 s71, s67, 6
    s_add_u32 s71, s71, 0xe0000
    s_add_u32 m0, s73, 0x14000
    s_nop 0
    buffer_load_dwordx4 v4, s[76:79], s71 offen lds
    s_lshl_b32 s71, s67, 6
    s_add_u32 s71, s71, 0x118000
    s_add_u32 m0, s73, 0x15000
    s_nop 0
    buffer_load_dwordx4 v4, s[76:79], s71 offen lds
    s_lshl_b32 s71, s67, 6
    s_add_u32 s71, s71, 0x150000
    s_add_u32 m0, s73, 0x16000
    s_nop 0
    buffer_load_dwordx4 v4, s[76:79], s71 offen lds
    s_lshl_b32 s71, s67, 6
    s_add_u32 s71, s71, 0x188000
    s_add_u32 m0, s73, 0x17000
    s_nop 0
    buffer_load_dwordx4 v4, s[76:79], s71 offen lds
L_part_128:
    s_cmp_lg_u32 s80, 8
    s_cbranch_scc1 L_part_129
    s_load_dwordx2 s[76:77], s[0:1], 88
    s_waitcnt lgkmcnt(0)
    s_and_b32 s77, s77, 0xffff
    s_mov_b32 s78, 0x1c0000
    s_mov_b32 s79, 0x20000
    v_lshlrev_b32 v5, 4, v1
    v_add_u32 v5, s73, v5
    s_lshl_b32 s71, s67, 15
    s_add_u32 s71, s71, 0
    s_add_u32 m0, s73, 0x18000
    s_nop 0
    buffer_load_dwordx4 v5, s[76:79], s71 offen lds
    s_lshl_b32 s71, s67, 15
    s_add_u32 s71, s71, 4096
    s_add_u32 m0, s73, 0x19000
    s_nop 0
    buffer_load_dwordx4 v5, s[76:79], s71 offen lds
    s_lshl_b32 s71, s67, 15
    s_add_u32 s71, s71, 8192
    s_add_u32 m0, s73, 0x1a000
    s_nop 0
    buffer_load_dwordx4 v5, s[76:79], s71 offen lds
    s_lshl_b32 s71, s67, 15
    s_add_u32 s71, s71, 12288
    s_add_u32 m0, s73, 0x1b000
    s_nop 0
    buffer_load_dwordx4 v5, s[76:79], s71 offen lds
    s_lshl_b32 s71, s67, 15
    s_add_u32 s71, s71, 16384
    s_add_u32 m0, s73, 0x1c000
    s_nop 0
    buffer_load_dwordx4 v5, s[76:79], s71 offen lds
    s_lshl_b32 s71, s67, 15
    s_add_u32 s71, s71, 20480
    s_add_u32 m0, s73, 0x1d000
    s_nop 0
    buffer_load_dwordx4 v5, s[76:79], s71 offen lds
    s_lshl_b32 s71, s67, 15
    s_add_u32 s71, s71, 24576
    s_add_u32 m0, s73, 0x1e000
    s_nop 0
    buffer_load_dwordx4 v5, s[76:79], s71 offen lds
    s_lshl_b32 s71, s67, 15
    s_add_u32 s71, s71, 28672
    s_add_u32 m0, s73, 0x1f000
    s_nop 0
    buffer_load_dwordx4 v5, s[76:79], s71 offen lds
L_part_129:
L_nostage_126:
    s_lshl_b32 s24, s22, 5
    s_lshl_b32 s25, s20, 1
    s_add_u32 s24, s24, s25
    s_lshr_b32 s25, s21, 1
    s_add_u32 s24, s24, s25
    s_lshl_b32 s25, s24, 13
    s_add_u32 s47, s25, 0x1000000
    s_add_u32 s54, s47, 4096
    s_add_u32 s48, s25, 0x2000000
    s_add_u32 s55, s48, 4096
    s_and_b32 s26, s21, 1
    s_lshl_b32 s26, s26, 12
    s_add_u32 s46, s25, s26
    s_add_u32 s46, s46, 0x3000000
    s_lshl_b32 s25, s24, 12
    s_add_u32 s49, s25, 0x240000
    s_lshl_b32 s24, s22, 4
    s_add_u32 s24, s24, s20
    s_lshl_b32 s24, s24, 15
    s_add_u32 s51, s24, 0x4000000
    s_cmp_ge_u32 s22, 60
    s_cselect_b32 s81, 1, 0
    s_lshl_b32 s60, s20, 1
    s_lshr_b32 s24, s100, 1
    s_add_u32 s60, s60, s24
    s_cmp_ge_u32 s22, 62
    s_cselect_b32 s24, 1, 0
    s_max_u32 s82, s82, s24
    s_lshl_b32 s24, s82, 3
    s_and_b32 s24, s24, 16
    s_add_u32 s24, s24, s20
    s_cmp_lg_u32 s82, 0
    s_cselect_b32 s60, s24, s60
    s_cselect_b32 s61, 0, 0x20000
    s_cselect_b32 s24, 17, 18
    s_lshl_b32 s50, s100, s24
    s_and_b32 s50, s50, 0x60000
    s_lshl_b32 s24, s60, 10
    s_add_u32 s50, s50, s24
    s_lshl_b32 s24, s22, 19
    s_add_u32 s50, s50, s24
    s_add_u32 s50, s50, 0x4000000
    s_add_u32 s61, s61, s50
    s_and_b32 s24, s82, 2
    s_lshl_b32 s24, s24, 13
    s_add_u32 s51, s51, s24
    s_lshl_b32 s24, s22, 5
    s_add_u32 s60, s60, s24
    s_lshl_b32 s64, s60, 10
    buffer_load_dwordx4 v[96:99], v240, s[12:15], s64 offen
    s_lshl_b32 s52, s22, 6
    s_add_u32 s52, s52, 0x4000
    s_lshl_b32 s24, s22, 7
    s_and_b32 s25, s82, 2
    s_lshl_b32 s25, s25, 7
    s_add_u32 s24, s24, s25
    s_add_u32 s24, s24, 0x6a00
    s_cmp_lg_u32 s81, 0
    s_cselect_b32 s52, s24, s52
    s_cmp_ge_u32 s22, 61
    s_cselect_b32 s83, s87, 0
    s_and_b32 s83, s83, 1
    s_cbranch_scc0 L_notouch_130
    buffer_load_dword v245, off, s[8:11], s52 sc1
    s_cmp_lg_u32 s82, 0
    s_cselect_b32 s25, 2, 3
    v_lshlrev_b32 v246, s25, v240
    s_lshl_b32 s24, s27, s25
    s_add_u32 s24, s24, s51
    buffer_load_dword v245, v246, s[8:11], s24 offen sc1
    s_cmp_eq_u32 s82, 0
    s_cbranch_scc1 L_notouch_130
    s_mov_b32 s83, 3
    v_mov_b32 v140, -1
    v_mov_b32 v141, -1
    v_mov_b32 v142, -1
    v_mov_b32 v143, -1
    s_waitcnt vmcnt(0)
    s_barrier
    buffer_store_dwordx4 v[140:143], v242, s[8:11], s51 offen
    buffer_store_dwordx4 v[140:143], v242, s[8:11], s51 offen offset:64
    buffer_store_dwordx4 v[140:143], v242, s[8:11], s51 offen offset:128
    buffer_store_dwordx4 v[140:143], v242, s[8:11], s51 offen offset:192
L_notouch_130:
    buffer_load_dwordx4 v[0:3], v240, s[8:11], s46 offen
    buffer_load_dwordx4 v[4:7], v240, s[8:11], s46 offen offset:1024
    buffer_load_dwordx4 v[8:11], v240, s[8:11], s46 offen offset:2048
    buffer_load_dwordx4 v[12:15], v240, s[8:11], s46 offen offset:3072
    buffer_load_dwordx4 v[16:19], v240, s[8:11], s47 offen
    buffer_load_dwordx4 v[20:23], v240, s[8:11], s47 offen offset:1024
    buffer_load_dwordx4 v[24:27], v240, s[8:11], s47 offen offset:2048
    buffer_load_dwordx4 v[28:31], v240, s[8:11], s47 offen offset:3072
    buffer_load_dwordx4 v[32:35], v240, s[8:11], s54 offen
    buffer_load_dwordx4 v[36:39], v240, s[8:11], s54 offen offset:1024
    buffer_load_dwordx4 v[40:43], v240, s[8:11], s54 offen offset:2048
    buffer_load_dwordx4 v[44:47], v240, s[8:11], s54 offen offset:3072
    buffer_load_dwordx4 v[64:67], v240, s[8:11], s48 offen
    buffer_load_dwordx4 v[68:71], v240, s[8:11], s48 offen offset:1024
    buffer_load_dwordx4 v[72:75], v240, s[8:11], s48 offen offset:2048
    buffer_load_dwordx4 v[76:79], v240, s[8:11], s48 offen offset:3072
    buffer_load_dwordx4 v[80:83], v240, s[8:11], s55 offen
    buffer_load_dwordx4 v[84:87], v240, s[8:11], s55 offen offset:1024
    buffer_load_dwordx4 v[88:91], v240, s[8:11], s55 offen offset:2048
    buffer_load_dwordx4 v[92:95], v240, s[8:11], s55 offen offset:3072
    s_waitcnt vmcnt(8)
    v_mfma_f32_16x16x32_bf16 v[116:119], v[16:19], v[0:3], 0
    v_mfma_f32_16x16x32_bf16 v[116:119], v[20:23], v[4:7], v[116:119]
    v_mfma_f32_16x16x32_bf16 v[116:119], v[24:27], v[8:11], v[116:119]
    v_mfma_f32_16x16x32_bf16 v[116:119], v[28:31], v[12:15], v[116:119]
    v_mfma_f32_16x16x32_bf16 v[120:123], v[32:35], v[0:3], 0
    v_mfma_f32_16x16x32_bf16 v[120:123], v[36:39], v[4:7], v[120:123]
    v_mfma_f32_16x16x32_bf16 v[120:123], v[40:43], v[8:11], v[120:123]
    v_mfma_f32_16x16x32_bf16 v[120:123], v[44:47], v[12:15], v[120:123]
    v_mov_b32 v247, s53
    v_cndmask_b32 v116, v247, v116, s[30:31]
    v_cndmask_b32 v117, v247, v117, s[32:33]
    v_cndmask_b32 v118, v247, v118, s[34:35]
    v_cndmask_b32 v119, v247, v119, s[36:37]
    s_nop 2
    v_cndmask_b32 v120, v247, v120, s[38:39]
    v_cndmask_b32 v121, v247, v121, s[40:41]
    v_cndmask_b32 v122, v247, v122, s[42:43]
    v_cndmask_b32 v123, v247, v123, s[44:45]
    v_max3_f32 v246, v116, v117, v118
    v_max3_f32 v246, v246, v119, v120
    v_max3_f32 v246, v246, v121, v122
    v_max_f32 v246, v246, v123
    v_mov_b32 v247, v246
    s_nop 1
    v_permlane32_swap_b32 v247, v246
    v_max_f32 v246, v247, v246
    v_mov_b32 v247, v246
    s_nop 1
    v_permlane16_swap_b32 v247, v246
    v_max_f32 v246, v247, v246
    v_mul_f32 v248, s28, v246
    v_pk_fma_f32 v[116:117], v[116:117], s[28:29], v[248:249] op_sel_hi:[1,1,0] neg_lo:[0,0,1] neg_hi:[0,0,1]
    v_pk_fma_f32 v[118:119], v[118:119], s[28:29], v[248:249] op_sel_hi:[1,1,0] neg_lo:[0,0,1] neg_hi:[0,0,1]
    v_pk_fma_f32 v[120:121], v[120:121], s[28:29], v[248:249] op_sel_hi:[1,1,0] neg_lo:[0,0,1] neg_hi:[0,0,1]
    v_pk_fma_f32 v[122:123], v[122:123], s[28:29], v[248:249] op_sel_hi:[1,1,0] neg_lo:[0,0,1] neg_hi:[0,0,1]
    v_exp_f32 v116, v116
    v_exp_f32 v117, v117
    v_exp_f32 v118, v118
    v_exp_f32 v119, v119
    v_exp_f32 v120, v120
    v_exp_f32 v121, v121
    v_exp_f32 v122, v122
    v_exp_f32 v123, v123
    v_cvt_pk_bf16_f32 v124, v116, v117
    v_cvt_pk_bf16_f32 v125, v118, v119
    v_cvt_pk_bf16_f32 v126, v120, v121
    v_cvt_pk_bf16_f32 v127, v122, v123
    v_mov_b32 v129, 0
    s_nop 0
    v_mfma_f32_16x16x32_bf16 v[132:135], v[136:139], v[124:127], 0
    s_waitcnt vmcnt(7)
    v_mfma_f32_16x16x32_bf16 v[140:143], v[64:67], v[124:127], 0
    s_waitcnt vmcnt(6)
    v_mfma_f32_16x16x32_bf16 v[144:147], v[68:71], v[124:127], 0
    s_waitcnt vmcnt(5)
    v_mfma_f32_16x16x32_bf16 v[148:151], v[72:75], v[124:127], 0
    s_waitcnt vmcnt(4)
    v_mfma_f32_16x16x32_bf16 v[152:155], v[76:79], v[124:127], 0
    s_waitcnt vmcnt(3)
    v_mfma_f32_16x16x32_bf16 v[156:159], v[80:83], v[124:127], 0
    s_waitcnt vmcnt(2)
    v_mfma_f32_16x16x32_bf16 v[160:163], v[84:87], v[124:127], 0
    s_waitcnt vmcnt(1)
    v_mfma_f32_16x16x32_bf16 v[164:167], v[88:91], v[124:127], 0
    s_waitcnt vmcnt(0)
    v_mfma_f32_16x16x32_bf16 v[168:171], v[92:95], v[124:127], 0
    v_lshrrev_b32 v246, 2, v240
    s_lshl_b32 s24, s20, 7
    s_add_u32 s24, s24, 0x1000
    s_add_u32 s25, s22, 1
    s_sub_u32 s26, s22, 1
    s_min_u32 s26, s26, 61
    s_cmp_lg_u32 s81, 0
    s_cselect_b32 s25, s26, s25
    s_cmp_lg_u32 s100, 0
    s_cbranch_scc1 L_polls_133
    s_mov_b32 exec_lo, 0x11
    s_mov_b32 exec_hi, 0
    s_mov_b32 s96, 0
L_poll_131:
    buffer_load_dword v247, v246, s[8:11], s24 offen sc1
    s_waitcnt vmcnt(0)
    v_cmp_gt_u32 vcc, s25, v247
    s_cbranch_vccz L_polld_132
    v_readfirstlane_b32 s97, v247
    s_nop 0
    s_sub_u32 s97, s25, s97
    s_cmp_lt_i32 s97, 3
    s_cbranch_scc1 L_near_134
    s_sleep 40
    s_cmp_lt_i32 s97, 5
    s_cbranch_scc1 L_near_134
    s_sleep 100
L_near_134:
    s_sleep 4
    s_add_u32 s96, s96, 1
    s_cmp_lt_u32 s96, 0x10000
    s_cbranch_scc1 L_poll_131
L_polld_132:
    s_mov_b64 exec, -1
L_polls_133:
    s_barrier
    s_cmp_eq_u32 s81, 0
    s_cbranch_scc1 L_kmf_136
    s_cmp_lg_u32 s83, 3
    s_cbranch_scc1 L_noinit_138
    s_lshl_b32 s26, s20, 2
    s_add_u32 s26, s26, s52
    s_cmp_lg_u32 s100, 0
    s_cbranch_scc1 L_flag_139
    v_mov_b32 v246, 1
    s_mov_b64 exec, 1
    buffer_store_dword v246, off, s[8:11], s26
    s_mov_b64 exec, -1
L_flag_139:
L_noinit_138:
    s_lshr_b32 s26, s21, 1
    s_lshl_b32 s26, s26, 4
    s_add_u32 s24, s24, s26
    s_mov_b32 s96, 0
    buffer_load_dword v245, off, s[8:11], s24 sc1
    buffer_load_dwordx4 v[220:223], v240, s[8:11], s49 offen sc1
    buffer_load_dwordx4 v[224:227], v240, s[8:11], s49 offen offset:1024 sc1
    buffer_load_dwordx4 v[228:231], v240, s[8:11], s49 offen offset:2048 sc1
    buffer_load_dwordx4 v[232:235], v240, s[8:11], s49 offen offset:3072 sc1
    s_sleep 14
L_kmp_135:
    buffer_load_dword v245, off, s[8:11], s24 sc1
    buffer_load_dwordx4 v[220:223], v240, s[8:11], s49 offen sc1
    buffer_load_dwordx4 v[224:227], v240, s[8:11], s49 offen offset:1024 sc1
    buffer_load_dwordx4 v[228:231], v240, s[8:11], s49 offen offset:2048 sc1
    buffer_load_dwordx4 v[232:235], v240, s[8:11], s49 offen offset:3072 sc1
    s_add_u32 s96, s96, 1
    s_waitcnt vmcnt(5)
    v_max3_u32 v246, v220, v221, v222
    v_max3_u32 v246, v246, v223, v224
    v_max3_u32 v246, v246, v225, v226
    v_max3_u32 v246, v246, v227, v228
    v_max3_u32 v246, v246, v229, v230
    v_max3_u32 v246, v246, v231, v232
    v_max3_u32 v246, v246, v233, v234
    v_max_u32 v246, v246, v235
    v_cmp_eq_u32 vcc, -1, v246
    v_readfirstlane_b32 s26, v245
    s_cbranch_vccz L_kmo_137
    s_cmp_gt_u32 s26, s22
    s_cbranch_scc1 L_kmf_136
    s_cmp_lt_u32 s96, 0x10000
    s_cbranch_scc1 L_kmp_135
L_kmf_136:
    buffer_load_dwordx4 v[220:223], v240, s[8:11], s49 offen sc1
    buffer_load_dwordx4 v[224:227], v240, s[8:11], s49 offen offset:1024 sc1
    buffer_load_dwordx4 v[228:231], v240, s[8:11], s49 offen offset:2048 sc1
    buffer_load_dwordx4 v[232:235], v240, s[8:11], s49 offen offset:3072 sc1
    s_waitcnt vmcnt(0)
L_kmo_137:
    ds_write_b32 v253, v221
    ds_write_b32 v253, v223 offset:64
    ds_write_b32 v253, v225 offset:1024
    ds_write_b32 v253, v227 offset:1088
    ds_write_b32 v253, v229 offset:2048
    ds_write_b32 v253, v231 offset:2112
    ds_write_b32 v253, v233 offset:3072
    ds_write_b32 v253, v235 offset:3136
    ds_read_b128 v[48:51], v254
    ds_read_b128 v[52:55], v254 offset:1024
    ds_read_b128 v[56:59], v254 offset:2048
    ds_read_b128 v[60:63], v254 offset:3072
    s_cmp_lg_u32 s83, 3
    s_cbranch_scc1 L_noside_140
    s_mov_b32 s62, 0x8f00
    buffer_load_dword v104, off, s[8:11], s62 sc1
    v_bfe_u32 v108, v240, 2, 6
    buffer_load_dword v108, v108, s[8:11], s52 offen sc1
L_noside_140:
    s_waitcnt lgkmcnt(3)
    v_mfma_f32_16x16x32_bf16 v[112:115], v[48:51], v[0:3], 0
    s_waitcnt lgkmcnt(2)
    v_mfma_f32_16x16x32_bf16 v[112:115], v[52:55], v[4:7], v[112:115]
    s_waitcnt lgkmcnt(1)
    v_mfma_f32_16x16x32_bf16 v[112:115], v[56:59], v[8:11], v[112:115]
    s_waitcnt lgkmcnt(0)
    v_mfma_f32_16x16x32_bf16 v[112:115], v[60:63], v[12:15], v[112:115]
    s_nop 7
    v_pk_fma_f32 v[114:115], v[112:113], s[28:29], v[248:249] op_sel_hi:[1,1,0] neg_lo:[0,0,1] neg_hi:[0,0,1]
    v_max_f32 v246, v114, v115
    v_cmp_lt_f32 vcc, 0x42200000, v246
    s_cbranch_vccnz L_redo_141
L_redone_142:
    v_exp_f32 v114, v114
    v_exp_f32 v115, v115
    s_nop 0
    v_cvt_pk_bf16_f32 v128, v114, v115
    s_nop 1
    v_mfma_f32_16x16x16_bf16 v[132:135], v[136:137], v[128:129], v[132:135]
    v_mfma_f32_16x16x16_bf16 v[140:143], v[220:221], v[128:129], v[140:143]
    v_mfma_f32_16x16x16_bf16 v[144:147], v[222:223], v[128:129], v[144:147]
    v_mfma_f32_16x16x16_bf16 v[148:151], v[224:225], v[128:129], v[148:151]
    v_rcp_f32 v250, v132
    v_mfma_f32_16x16x16_bf16 v[152:155], v[226:227], v[128:129], v[152:155]
    v_mul_f32 v140, v250, v140
    v_mul_f32 v141, v250, v141
    v_mfma_f32_16x16x16_bf16 v[156:159], v[228:229], v[128:129], v[156:159]
    v_mul_f32 v142, v250, v142
    v_mul_f32 v143, v250, v143
    v_mfma_f32_16x16x16_bf16 v[160:163], v[230:231], v[128:129], v[160:163]
    v_cvt_pk_bf16_f32 v140, v140, v141
    v_cvt_pk_bf16_f32 v141, v142, v143
    v_mfma_f32_16x16x16_bf16 v[164:167], v[232:233], v[128:129], v[164:167]
    v_mul_f32 v144, v250, v144
    v_mul_f32 v145, v250, v145
    v_mfma_f32_16x16x16_bf16 v[168:171], v[234:235], v[128:129], v[168:171]
    v_mul_f32 v146, v250, v146
    v_mul_f32 v147, v250, v147
    v_cvt_pk_bf16_f32 v142, v144, v145
    v_cvt_pk_bf16_f32 v143, v146, v147
    ds_write_b128 v243, v[140:143]
    v_pk_mul_f32 v[148:149], v[148:149], v[250:251] op_sel_hi:[1,0]
    v_pk_mul_f32 v[150:151], v[150:151], v[250:251] op_sel_hi:[1,0]
    v_cvt_pk_bf16_f32 v144, v148, v149
    v_cvt_pk_bf16_f32 v145, v150, v151
    v_pk_mul_f32 v[152:153], v[152:153], v[250:251] op_sel_hi:[1,0]
    v_pk_mul_f32 v[154:155], v[154:155], v[250:251] op_sel_hi:[1,0]
    v_cvt_pk_bf16_f32 v146, v152, v153
    v_cvt_pk_bf16_f32 v147, v154, v155
    ds_write_b128 v243, v[144:147] offset:1024
    v_pk_mul_f32 v[156:157], v[156:157], v[250:251] op_sel_hi:[1,0]
    v_pk_mul_f32 v[158:159], v[158:159], v[250:251] op_sel_hi:[1,0]
    v_cvt_pk_bf16_f32 v148, v156, v157
    v_cvt_pk_bf16_f32 v149, v158, v159
    v_pk_mul_f32 v[160:161], v[160:161], v[250:251] op_sel_hi:[1,0]
    v_pk_mul_f32 v[162:163], v[162:163], v[250:251] op_sel_hi:[1,0]
    v_cvt_pk_bf16_f32 v150, v160, v161
    v_cvt_pk_bf16_f32 v151, v162, v163
    ds_write_b128 v243, v[148:151] offset:2048
    v_pk_mul_f32 v[164:165], v[164:165], v[250:251] op_sel_hi:[1,0]
    v_pk_mul_f32 v[166:167], v[166:167], v[250:251] op_sel_hi:[1,0]
    v_cvt_pk_bf16_f32 v152, v164, v165
    v_cvt_pk_bf16_f32 v153, v166, v167
    v_pk_mul_f32 v[168:169], v[168:169], v[250:251] op_sel_hi:[1,0]
    v_pk_mul_f32 v[170:171], v[170:171], v[250:251] op_sel_hi:[1,0]
    v_cvt_pk_bf16_f32 v154, v168, v169
    v_cvt_pk_bf16_f32 v155, v170, v171
    ds_write_b128 v243, v[152:155] offset:3072
    s_waitcnt lgkmcnt(0)
    s_barrier
    s_lshr_b32 s25, s82, 1
    s_lshl_b32 s24, s25, 12
    v_add_u32 v246, s24, v244
    ds_read_b128 v[0:3], v246
    ds_read_b128 v[4:7], v246 offset:1024
    ds_read_b128 v[8:11], v246 offset:2048
    ds_read_b128 v[12:15], v246 offset:3072
    ds_read_b128 v[32:35], v246 offset:8192
    ds_read_b128 v[36:39], v246 offset:9216
    ds_read_b128 v[40:43], v246 offset:10240
    ds_read_b128 v[44:47], v246 offset:11264
    v_xor_b32 v243, 0x4000, v243
    s_waitcnt lgkmcnt(7)
    v_mfma_f32_16x16x32_bf16 v[172:175], a[0:3], v[0:3], 0
    v_mfma_f32_16x16x32_bf16 v[176:179], a[4:7], v[0:3], 0
    s_waitcnt lgkmcnt(6)
    v_mfma_f32_16x16x32_bf16 v[172:175], a[32:35], v[4:7], v[172:175]
    v_mfma_f32_16x16x32_bf16 v[176:179], a[36:39], v[4:7], v[176:179]
    s_waitcnt lgkmcnt(5)
    v_mfma_f32_16x16x32_bf16 v[172:175], a[64:67], v[8:11], v[172:175]
    v_mfma_f32_16x16x32_bf16 v[176:179], a[68:71], v[8:11], v[176:179]
    s_waitcnt lgkmcnt(4)
    v_mfma_f32_16x16x32_bf16 v[172:175], a[96:99], v[12:15], v[172:175]
    v_mfma_f32_16x16x32_bf16 v[176:179], a[100:103], v[12:15], v[176:179]
    s_waitcnt lgkmcnt(3)
    v_mfma_f32_16x16x32_bf16 v[172:175], a[128:131], v[32:35], v[172:175]
    v_mfma_f32_16x16x32_bf16 v[176:179], a[132:135], v[32:35], v[176:179]
    s_waitcnt lgkmcnt(2)
    v_mfma_f32_16x16x32_bf16 v[172:175], a[160:163], v[36:39], v[172:175]
    v_mfma_f32_16x16x32_bf16 v[176:179], a[164:167], v[36:39], v[176:179]
    s_waitcnt lgkmcnt(1)
    v_mfma_f32_16x16x32_bf16 v[172:175], a[192:195], v[40:43], v[172:175]
    v_mfma_f32_16x16x32_bf16 v[176:179], a[196:199], v[40:43], v[176:179]
    s_waitcnt lgkmcnt(0)
    v_mfma_f32_16x16x32_bf16 v[172:175], a[224:227], v[44:47], v[172:175]
    v_mfma_f32_16x16x32_bf16 v[176:179], a[228:231], v[44:47], v[176:179]
    v_mfma_f32_16x16x32_bf16 v[180:183], a[8:11], v[0:3], 0
    v_mfma_f32_16x16x32_bf16 v[184:187], a[12:15], v[0:3], 0
    ds_read_b128 v[16:19], v244 offset:4096
    v_mfma_f32_16x16x32_bf16 v[180:183], a[40:43], v[4:7], v[180:183]
    v_mfma_f32_16x16x32_bf16 v[184:187], a[44:47], v[4:7], v[184:187]
    ds_read_b128 v[20:23], v244 offset:5120
    v_cvt_pk_bf16_f32 v140, v172, v173
    v_cvt_pk_bf16_f32 v141, v174, v175
    v_cvt_pk_bf16_f32 v142, v176, v177
    v_cvt_pk_bf16_f32 v143, v178, v179
    v_min_u32 v140, 0xfffffffe, v140
    s_add_u32 s24, s51, 0
    s_cmp_lg_u32 s83, 0
    s_cbranch_scc1 L_near_145
    buffer_store_dwordx4 v[140:143], v242, s[8:11], s24 offen sc1
    s_branch L_far_146
L_near_145:
    buffer_store_dwordx4 v[140:143], v242, s[8:11], s24 offen
L_far_146:
    v_mfma_f32_16x16x32_bf16 v[180:183], a[72:75], v[8:11], v[180:183]
    v_mfma_f32_16x16x32_bf16 v[184:187], a[76:79], v[8:11], v[184:187]
    ds_read_b128 v[24:27], v244 offset:6144
    v_mfma_f32_16x16x32_bf16 v[180:183], a[104:107], v[12:15], v[180:183]
    v_mfma_f32_16x16x32_bf16 v[184:187], a[108:111], v[12:15], v[184:187]
    ds_read_b128 v[28:31], v244 offset:7168
    v_mfma_f32_16x16x32_bf16 v[180:183], a[136:139], v[32:35], v[180:183]
    v_mfma_f32_16x16x32_bf16 v[184:187], a[140:143], v[32:35], v[184:187]
    ds_read_b128 v[48:51], v244 offset:12288
    v_mfma_f32_16x16x32_bf16 v[180:183], a[168:171], v[36:39], v[180:183]
    v_mfma_f32_16x16x32_bf16 v[184:187], a[172:175], v[36:39], v[184:187]
    ds_read_b128 v[52:55], v244 offset:13312
    v_mfma_f32_16x16x32_bf16 v[180:183], a[200:203], v[40:43], v[180:183]
    v_mfma_f32_16x16x32_bf16 v[184:187], a[204:207], v[40:43], v[184:187]
    ds_read_b128 v[56:59], v244 offset:14336
    v_mfma_f32_16x16x32_bf16 v[180:183], a[232:235], v[44:47], v[180:183]
    v_mfma_f32_16x16x32_bf16 v[184:187], a[236:239], v[44:47], v[184:187]
    ds_read_b128 v[60:63], v244 offset:15360
    v_mfma_f32_16x16x32_bf16 v[188:191], a[16:19], v[0:3], 0
    v_mfma_f32_16x16x32_bf16 v[192:195], a[20:23], v[0:3], 0
    v_mfma_f32_16x16x32_bf16 v[188:191], a[48:51], v[4:7], v[188:191]
    v_mfma_f32_16x16x32_bf16 v[192:195], a[52:55], v[4:7], v[192:195]
    v_cvt_pk_bf16_f32 v144, v180, v181
    v_cvt_pk_bf16_f32 v145, v182, v183
    v_cvt_pk_bf16_f32 v146, v184, v185
    v_cvt_pk_bf16_f32 v147, v186, v187
    v_min_u32 v144, 0xfffffffe, v144
    s_cmp_lg_u32 s83, 0
    s_cbranch_scc1 L_near_147
    buffer_store_dwordx4 v[144:147], v242, s[8:11], s24 offen offset:64 sc1
    s_branch L_far_148
L_near_147:
    buffer_store_dwordx4 v[144:147], v242, s[8:11], s24 offen offset:64
L_far_148:
    v_mfma_f32_16x16x32_bf16 v[188:191], a[80:83], v[8:11], v[188:191]
    v_mfma_f32_16x16x32_bf16 v[192:195], a[84:87], v[8:11], v[192:195]
    v_mfma_f32_16x16x32_bf16 v[188:191], a[112:115], v[12:15], v[188:191]
    v_mfma_f32_16x16x32_bf16 v[192:195], a[116:119], v[12:15], v[192:195]
    v_mfma_f32_16x16x32_bf16 v[188:191], a[144:147], v[32:35], v[188:191]
    v_mfma_f32_16x16x32_bf16 v[192:195], a[148:151], v[32:35], v[192:195]
    v_mfma_f32_16x16x32_bf16 v[188:191], a[176:179], v[36:39], v[188:191]
    v_mfma_f32_16x16x32_bf16 v[192:195], a[180:183], v[36:39], v[192:195]
    v_mfma_f32_16x16x32_bf16 v[188:191], a[208:211], v[40:43], v[188:191]
    v_mfma_f32_16x16x32_bf16 v[192:195], a[212:215], v[40:43], v[192:195]
    v_mfma_f32_16x16x32_bf16 v[188:191], a[240:243], v[44:47], v[188:191]
    v_mfma_f32_16x16x32_bf16 v[192:195], a[244:247], v[44:47], v[192:195]
    v_mfma_f32_16x16x32_bf16 v[196:199], a[24:27], v[0:3], 0
    v_mfma_f32_16x16x32_bf16 v[200:203], a[28:31], v[0:3], 0
    v_mfma_f32_16x16x32_bf16 v[196:199], a[56:59], v[4:7], v[196:199]
    v_mfma_f32_16x16x32_bf16 v[200:203], a[60:63], v[4:7], v[200:203]
    v_cvt_pk_bf16_f32 v148, v188, v189
    v_cvt_pk_bf16_f32 v149, v190, v191
    v_cvt_pk_bf16_f32 v150, v192, v193
    v_cvt_pk_bf16_f32 v151, v194, v195
    v_min_u32 v148, 0xfffffffe, v148
    s_cmp_lg_u32 s83, 0
    s_cbranch_scc1 L_near_149
    buffer_store_dwordx4 v[148:151], v242, s[8:11], s24 offen offset:128 sc1
    s_branch L_far_150
L_near_149:
    buffer_store_dwordx4 v[148:151], v242, s[8:11], s24 offen offset:128
L_far_150:
    v_mfma_f32_16x16x32_bf16 v[196:199], a[88:91], v[8:11], v[196:199]
    v_mfma_f32_16x16x32_bf16 v[200:203], a[92:95], v[8:11], v[200:203]
    v_mfma_f32_16x16x32_bf16 v[196:199], a[120:123], v[12:15], v[196:199]
    v_mfma_f32_16x16x32_bf16 v[200:203], a[124:127], v[12:15], v[200:203]
    v_mfma_f32_16x16x32_bf16 v[196:199], a[152:155], v[32:35], v[196:199]
    v_mfma_f32_16x16x32_bf16 v[200:203], a[156:159], v[32:35], v[200:203]
    v_mfma_f32_16x16x32_bf16 v[196:199], a[184:187], v[36:39], v[196:199]
    v_mfma_f32_16x16x32_bf16 v[200:203], a[188:191], v[36:39], v[200:203]
    v_mfma_f32_16x16x32_bf16 v[196:199], a[216:219], v[40:43], v[196:199]
    v_mfma_f32_16x16x32_bf16 v[200:203], a[220:223], v[40:43], v[200:203]
    v_mfma_f32_16x16x32_bf16 v[196:199], a[248:251], v[44:47], v[196:199]
    v_mfma_f32_16x16x32_bf16 v[200:203], a[252:255], v[44:47], v[200:203]
    v_xor_b32 v244, 0x4000, v244
    s_cmp_lg_u32 s82, 0
    s_cbranch_scc1 L_half_143
    s_waitcnt lgkmcnt(0)
    v_mfma_f32_16x16x32_bf16 v[204:207], a[0:3], v[16:19], 0
    v_mfma_f32_16x16x32_bf16 v[208:211], a[4:7], v[16:19], 0
    v_mfma_f32_16x16x32_bf16 v[204:207], a[32:35], v[20:23], v[204:207]
    v_mfma_f32_16x16x32_bf16 v[208:211], a[36:39], v[20:23], v[208:211]
    v_cvt_pk_bf16_f32 v152, v196, v197
    v_cvt_pk_bf16_f32 v153, v198, v199
    v_cvt_pk_bf16_f32 v154, v200, v201
    v_cvt_pk_bf16_f32 v155, v202, v203
    v_min_u32 v152, 0xfffffffe, v152
    s_cmp_lg_u32 s83, 0
    s_cbranch_scc1 L_near_151
    buffer_store_dwordx4 v[152:155], v242, s[8:11], s24 offen offset:192 sc1
    s_branch L_far_152
L_near_151:
    buffer_store_dwordx4 v[152:155], v242, s[8:11], s24 offen offset:192
L_far_152:
    v_mfma_f32_16x16x32_bf16 v[204:207], a[64:67], v[24:27], v[204:207]
    v_mfma_f32_16x16x32_bf16 v[208:211], a[68:71], v[24:27], v[208:211]
    v_mfma_f32_16x16x32_bf16 v[204:207], a[96:99], v[28:31], v[204:207]
    v_mfma_f32_16x16x32_bf16 v[208:211], a[100:103], v[28:31], v[208:211]
    v_mfma_f32_16x16x32_bf16 v[204:207], a[128:131], v[48:51], v[204:207]
    v_mfma_f32_16x16x32_bf16 v[208:211], a[132:135], v[48:51], v[208:211]
    v_mfma_f32_16x16x32_bf16 v[204:207], a[160:163], v[52:55], v[204:207]
    v_mfma_f32_16x16x32_bf16 v[208:211], a[164:167], v[52:55], v[208:211]
    v_mfma_f32_16x16x32_bf16 v[204:207], a[192:195], v[56:59], v[204:207]
    v_mfma_f32_16x16x32_bf16 v[208:211], a[196:199], v[56:59], v[208:211]
    v_mfma_f32_16x16x32_bf16 v[204:207], a[224:227], v[60:63], v[204:207]
    v_mfma_f32_16x16x32_bf16 v[208:211], a[228:231], v[60:63], v[208:211]
    v_mfma_f32_16x16x32_bf16 v[212:215], a[8:11], v[16:19], 0
    v_mfma_f32_16x16x32_bf16 v[216:219], a[12:15], v[16:19], 0
    v_mfma_f32_16x16x32_bf16 v[212:215], a[40:43], v[20:23], v[212:215]
    v_mfma_f32_16x16x32_bf16 v[216:219], a[44:47], v[20:23], v[216:219]
    v_cvt_pk_bf16_f32 v140, v204, v205
    v_cvt_pk_bf16_f32 v141, v206, v207
    v_cvt_pk_bf16_f32 v142, v208, v209
    v_cvt_pk_bf16_f32 v143, v210, v211
    v_min_u32 v140, 0xfffffffe, v140
    s_add_u32 s24, s51, 16384
    s_cmp_lg_u32 s83, 0
    s_cbranch_scc1 L_near_153
    buffer_store_dwordx4 v[140:143], v242, s[8:11], s24 offen sc1
    s_branch L_far_154
L_near_153:
    buffer_store_dwordx4 v[140:143], v242, s[8:11], s24 offen
L_far_154:
    v_mfma_f32_16x16x32_bf16 v[212:215], a[72:75], v[24:27], v[212:215]
    v_mfma_f32_16x16x32_bf16 v[216:219], a[76:79], v[24:27], v[216:219]
    v_mfma_f32_16x16x32_bf16 v[212:215], a[104:107], v[28:31], v[212:215]
    v_mfma_f32_16x16x32_bf16 v[216:219], a[108:111], v[28:31], v[216:219]
    v_mfma_f32_16x16x32_bf16 v[212:215], a[136:139], v[48:51], v[212:215]
    v_mfma_f32_16x16x32_bf16 v[216:219], a[140:143], v[48:51], v[216:219]
    v_mfma_f32_16x16x32_bf16 v[212:215], a[168:171], v[52:55], v[212:215]
    v_mfma_f32_16x16x32_bf16 v[216:219], a[172:175], v[52:55], v[216:219]
    v_mfma_f32_16x16x32_bf16 v[212:215], a[200:203], v[56:59], v[212:215]
    v_mfma_f32_16x16x32_bf16 v[216:219], a[204:207], v[56:59], v[216:219]
    v_mfma_f32_16x16x32_bf16 v[212:215], a[232:235], v[60:63], v[212:215]
    v_mfma_f32_16x16x32_bf16 v[216:219], a[236:239], v[60:63], v[216:219]
    s_waitcnt vmcnt(5)
    v_mfma_f32_16x16x32_bf16 v[220:223], a[16:19], v[16:19], 0
    v_mfma_f32_16x16x32_bf16 v[224:227], a[20:23], v[16:19], 0
    v_mfma_f32_16x16x32_bf16 v[220:223], a[48:51], v[20:23], v[220:223]
    v_mfma_f32_16x16x32_bf16 v[224:227], a[52:55], v[20:23], v[224:227]
    v_cvt_pk_bf16_f32 v144, v212, v213
    v_cvt_pk_bf16_f32 v145, v214, v215
    v_cvt_pk_bf16_f32 v146, v216, v217
    v_cvt_pk_bf16_f32 v147, v218, v219
    v_min_u32 v144, 0xfffffffe, v144
    s_cmp_lg_u32 s83, 0
    s_cbranch_scc1 L_near_155
    buffer_store_dwordx4 v[144:147], v242, s[8:11], s24 offen offset:64 sc1
    s_branch L_far_156
L_near_155:
    buffer_store_dwordx4 v[144:147], v242, s[8:11], s24 offen offset:64
L_far_156:
    v_mfma_f32_16x16x32_bf16 v[220:223], a[80:83], v[24:27], v[220:223]
    v_mfma_f32_16x16x32_bf16 v[224:227], a[84:87], v[24:27], v[224:227]
    v_mfma_f32_16x16x32_bf16 v[220:223], a[112:115], v[28:31], v[220:223]
    v_mfma_f32_16x16x32_bf16 v[224:227], a[116:119], v[28:31], v[224:227]
    v_mfma_f32_16x16x32_bf16 v[220:223], a[144:147], v[48:51], v[220:223]
    v_mfma_f32_16x16x32_bf16 v[224:227], a[148:151], v[48:51], v[224:227]
    v_mfma_f32_16x16x32_bf16 v[220:223], a[176:179], v[52:55], v[220:223]
    v_mfma_f32_16x16x32_bf16 v[224:227], a[180:183], v[52:55], v[224:227]
    v_mfma_f32_16x16x32_bf16 v[220:223], a[208:211], v[56:59], v[220:223]
    v_mfma_f32_16x16x32_bf16 v[224:227], a[212:215], v[56:59], v[224:227]
    v_mfma_f32_16x16x32_bf16 v[220:223], a[240:243], v[60:63], v[220:223]
    v_mfma_f32_16x16x32_bf16 v[224:227], a[244:247], v[60:63], v[224:227]
    v_mfma_f32_16x16x32_bf16 v[228:231], a[24:27], v[16:19], 0
    v_mfma_f32_16x16x32_bf16 v[232:235], a[28:31], v[16:19], 0
    v_mfma_f32_16x16x32_bf16 v[228:231], a[56:59], v[20:23], v[228:231]
    v_mfma_f32_16x16x32_bf16 v[232:235], a[60:63], v[20:23], v[232:235]
    v_cvt_pk_bf16_f32 v148, v220, v221
    v_cvt_pk_bf16_f32 v149, v222, v223
    v_cvt_pk_bf16_f32 v150, v224, v225
    v_cvt_pk_bf16_f32 v151, v226, v227
    v_min_u32 v148, 0xfffffffe, v148
    s_cmp_lg_u32 s83, 0
    s_cbranch_scc1 L_near_157
    buffer_store_dwordx4 v[148:151], v242, s[8:11], s24 offen offset:128 sc1
    s_branch L_far_158
L_near_157:
    buffer_store_dwordx4 v[148:151], v242, s[8:11], s24 offen offset:128
L_far_158:
    v_mfma_f32_16x16x32_bf16 v[228:231], a[88:91], v[24:27], v[228:231]
    v_mfma_f32_16x16x32_bf16 v[232:235], a[92:95], v[24:27], v[232:235]
    v_mfma_f32_16x16x32_bf16 v[228:231], a[120:123], v[28:31], v[228:231]
    v_mfma_f32_16x16x32_bf16 v[232:235], a[124:127], v[28:31], v[232:235]
    v_mfma_f32_16x16x32_bf16 v[228:231], a[152:155], v[48:51], v[228:231]
    v_mfma_f32_16x16x32_bf16 v[232:235], a[156:159], v[48:51], v[232:235]
    v_mfma_f32_16x16x32_bf16 v[228:231], a[184:187], v[52:55], v[228:231]
    v_mfma_f32_16x16x32_bf16 v[232:235], a[188:191], v[52:55], v[232:235]
    v_mfma_f32_16x16x32_bf16 v[228:231], a[216:219], v[56:59], v[228:231]
    v_mfma_f32_16x16x32_bf16 v[232:235], a[220:223], v[56:59], v[232:235]
    v_mfma_f32_16x16x32_bf16 v[228:231], a[248:251], v[60:63], v[228:231]
    v_mfma_f32_16x16x32_bf16 v[232:235], a[252:255], v[60:63], v[232:235]
    s_nop 3
    v_cvt_pk_bf16_f32 v152, v228, v229
    v_cvt_pk_bf16_f32 v153, v230, v231
    s_nop 1
    v_cvt_pk_bf16_f32 v154, v232, v233
    v_cvt_pk_bf16_f32 v155, v234, v235
    v_min_u32 v152, 0xfffffffe, v152
    s_cmp_lg_u32 s83, 0
    s_cbranch_scc1 L_near_159
    buffer_store_dwordx4 v[152:155], v242, s[8:11], s24 offen offset:192 sc1
    s_branch L_far_160
L_near_159:
    buffer_store_dwordx4 v[152:155], v242, s[8:11], s24 offen offset:192
L_far_160:
    s_branch L_proj_144
L_half_143:
    s_nop 7
    v_cvt_pk_bf16_f32 v152, v196, v197
    v_cvt_pk_bf16_f32 v153, v198, v199
    v_cvt_pk_bf16_f32 v154, v200, v201
    v_cvt_pk_bf16_f32 v155, v202, v203
    v_min_u32 v152, 0xfffffffe, v152
    s_cmp_lg_u32 s83, 0
    s_cbranch_scc1 L_near_161
    buffer_store_dwordx4 v[152:155], v242, s[8:11], s24 offen offset:192 sc1
    s_branch L_far_162
L_near_161:
    buffer_store_dwordx4 v[152:155], v242, s[8:11], s24 offen offset:192
L_far_162:
    s_waitcnt lgkmcnt(0)
L_proj_144:
    s_cmp_lg_u32 s83, 3
    s_cbranch_scc1 L_flags_165
    s_waitcnt vmcnt(4)
    v_cmp_eq_u32 vcc, 0, v108
    s_cbranch_vccz L_parts_163
    v_lshrrev_b32 v246, 2, v240
    s_mov_b32 exec_lo, 0xffff
    s_mov_b32 exec_hi, 0
    s_mov_b32 s96, 0
L_poll_166:
    buffer_load_dword v247, v246, s[8:11], s52 offen sc1
    s_waitcnt vmcnt(0)
    v_cmp_gt_u32 vcc, 1, v247
    s_cbranch_vccz L_polld_167
    s_sleep 1
    s_add_u32 s96, s96, 1
    s_cmp_lt_u32 s96, 0x10000
    s_cbranch_scc1 L_poll_166
L_polld_167:
    s_mov_b64 exec, -1
    s_branch L_parts_163
L_flags_165:
    s_mov_b32 s62, 0x8f00
    buffer_load_dword v104, off, s[8:11], s62 sc1
    s_waitcnt vmcnt(0)
    s_barrier
    s_lshl_b32 s26, s20, 2
    s_add_u32 s26, s26, s52
    s_cmp_lg_u32 s100, 0
    s_cbranch_scc1 L_flag_169
    v_mov_b32 v246, 1
    s_mov_b64 exec, 1
    s_cmp_lg_u32 s83, 0
    s_cbranch_scc1 L_near_170
    buffer_store_dword v246, off, s[8:11], s26 sc1
    s_branch L_far_171
L_near_170:
    buffer_store_dword v246, off, s[8:11], s26
L_far_171:
    s_mov_b64 exec, -1
L_flag_169:
    v_lshrrev_b32 v246, 2, v240
    s_cmp_lg_u32 s100, 0
    s_cbranch_scc1 L_polls_174
    s_mov_b32 exec_lo, 0xffff
    s_mov_b32 exec_hi, 0
    s_mov_b32 s96, 0
L_poll_172:
    buffer_load_dword v247, v246, s[8:11], s52 offen sc1
    s_waitcnt vmcnt(0)
    v_cmp_gt_u32 vcc, 1, v247
    s_cbranch_vccz L_polld_173
    s_sleep 1
    s_add_u32 s96, s96, 1
    s_cmp_lt_u32 s96, 0x10000
    s_cbranch_scc1 L_poll_172
L_polld_173:
    s_mov_b64 exec, -1
L_polls_174:
    s_barrier
L_parts_163:
    s_cmp_lg_u32 s83, 0
    s_cbranch_scc1 L_near_181
    buffer_load_dwordx4 v[48:51], v240, s[8:11], s50 offen
    buffer_load_dwordx4 v[52:55], v105, s[8:11], s50 offen
    buffer_load_dwordx4 v[56:59], v106, s[8:11], s50 offen
    buffer_load_dwordx4 v[60:63], v107, s[8:11], s50 offen
    s_branch L_far_182
L_near_181:
    buffer_load_dwordx4 v[48:51], v240, s[8:11], s50 offen sc1
    buffer_load_dwordx4 v[52:55], v105, s[8:11], s50 offen sc1
    buffer_load_dwordx4 v[56:59], v106, s[8:11], s50 offen sc1
    buffer_load_dwordx4 v[60:63], v107, s[8:11], s50 offen sc1
L_far_182:
    v_mov_b32 v68, 0
    v_mov_b32 v69, 0
    v_mov_b32 v70, 0
    v_mov_b32 v71, 0
    v_mov_b32 v72, 0
    v_mov_b32 v73, 0
    v_mov_b32 v74, 0
    v_mov_b32 v75, 0
    s_mov_b32 s96, 0
L_gp_176:
    s_cmp_lg_u32 s83, 0
    s_cbranch_scc1 L_near_183
    buffer_load_dwordx4 v[32:35], v240, s[8:11], s61 offen
    buffer_load_dwordx4 v[36:39], v105, s[8:11], s61 offen
    buffer_load_dwordx4 v[40:43], v106, s[8:11], s61 offen
    buffer_load_dwordx4 v[44:47], v107, s[8:11], s61 offen
    s_branch L_far_184
L_near_183:
    buffer_load_dwordx4 v[32:35], v240, s[8:11], s61 offen sc1
    buffer_load_dwordx4 v[36:39], v105, s[8:11], s61 offen sc1
    buffer_load_dwordx4 v[40:43], v106, s[8:11], s61 offen sc1
    buffer_load_dwordx4 v[44:47], v107, s[8:11], s61 offen sc1
L_far_184:
    s_waitcnt vmcnt(4)
    v_max3_u32 v246, v48, v52, v56
    v_max_u32 v246, v246, v60
    v_cmp_eq_u32 vcc, -1, v246
    s_cbranch_vccz L_gb_177
    buffer_load_dwordx4 v[48:51], v240, s[8:11], s50 offen sc1
    buffer_load_dwordx4 v[52:55], v105, s[8:11], s50 offen sc1
    buffer_load_dwordx4 v[56:59], v106, s[8:11], s50 offen sc1
    buffer_load_dwordx4 v[60:63], v107, s[8:11], s50 offen sc1
    s_waitcnt vmcnt(4)
    v_max3_u32 v246, v32, v36, v40
    v_max_u32 v246, v246, v44
    v_cmp_eq_u32 vcc, -1, v246
    s_add_u32 s96, s96, 1
    s_cbranch_vccz L_ga_178
    s_cmp_lt_u32 s96, 0x10000
    s_cbranch_scc1 L_gp_176
L_gb_177:
    v_dot2_f32_bf16 v68, v48, s65, v68
    v_dot2_f32_bf16 v69, v48, s66, v69
    v_dot2_f32_bf16 v70, v49, s65, v70
    v_dot2_f32_bf16 v71, v49, s66, v71
    v_dot2_f32_bf16 v72, v50, s65, v72
    v_dot2_f32_bf16 v73, v50, s66, v73
    v_dot2_f32_bf16 v74, v51, s65, v74
    v_dot2_f32_bf16 v75, v51, s66, v75
    v_dot2_f32_bf16 v68, v52, s65, v68
    v_dot2_f32_bf16 v69, v52, s66, v69
    v_dot2_f32_bf16 v70, v53, s65, v70
    v_dot2_f32_bf16 v71, v53, s66, v71
    v_dot2_f32_bf16 v72, v54, s65, v72
    v_dot2_f32_bf16 v73, v54, s66, v73
    v_dot2_f32_bf16 v74, v55, s65, v74
    v_dot2_f32_bf16 v75, v55, s66, v75
    v_dot2_f32_bf16 v68, v56, s65, v68
    v_dot2_f32_bf16 v69, v56, s66, v69
    v_dot2_f32_bf16 v70, v57, s65, v70
    v_dot2_f32_bf16 v71, v57, s66, v71
    v_dot2_f32_bf16 v72, v58, s65, v72
    v_dot2_f32_bf16 v73, v58, s66, v73
    v_dot2_f32_bf16 v74, v59, s65, v74
    v_dot2_f32_bf16 v75, v59, s66, v75
    v_dot2_f32_bf16 v68, v60, s65, v68
    v_dot2_f32_bf16 v69, v60, s66, v69
    v_dot2_f32_bf16 v70, v61, s65, v70
    v_dot2_f32_bf16 v71, v61, s66, v71
    v_dot2_f32_bf16 v72, v62, s65, v72
    v_dot2_f32_bf16 v73, v62, s66, v73
    v_dot2_f32_bf16 v74, v63, s65, v74
    v_dot2_f32_bf16 v75, v63, s66, v75
    s_cmp_lg_u32 s82, 0
    s_cbranch_scc1 L_gd_179
    s_waitcnt vmcnt(0)
L_ga_178:
    v_dot2_f32_bf16 v68, v32, s65, v68
    v_dot2_f32_bf16 v69, v32, s66, v69
    v_dot2_f32_bf16 v70, v33, s65, v70
    v_dot2_f32_bf16 v71, v33, s66, v71
    v_dot2_f32_bf16 v72, v34, s65, v72
    v_dot2_f32_bf16 v73, v34, s66, v73
    v_dot2_f32_bf16 v74, v35, s65, v74
    v_dot2_f32_bf16 v75, v35, s66, v75
    v_dot2_f32_bf16 v68, v36, s65, v68
    v_dot2_f32_bf16 v69, v36, s66, v69
    v_dot2_f32_bf16 v70, v37, s65, v70
    v_dot2_f32_bf16 v71, v37, s66, v71
    v_dot2_f32_bf16 v72, v38, s65, v72
    v_dot2_f32_bf16 v73, v38, s66, v73
    v_dot2_f32_bf16 v74, v39, s65, v74
    v_dot2_f32_bf16 v75, v39, s66, v75
    v_dot2_f32_bf16 v68, v40, s65, v68
    v_dot2_f32_bf16 v69, v40, s66, v69
    v_dot2_f32_bf16 v70, v41, s65, v70
    v_dot2_f32_bf16 v71, v41, s66, v71
    v_dot2_f32_bf16 v72, v42, s65, v72
    v_dot2_f32_bf16 v73, v42, s66, v73
    v_dot2_f32_bf16 v74, v43, s65, v74
    v_dot2_f32_bf16 v75, v43, s66, v75
    v_dot2_f32_bf16 v68, v44, s65, v68
    v_dot2_f32_bf16 v69, v44, s66, v69
    v_dot2_f32_bf16 v70, v45, s65, v70
    v_dot2_f32_bf16 v71, v45, s66, v71
    v_dot2_f32_bf16 v72, v46, s65, v72
    v_dot2_f32_bf16 v73, v46, s66, v73
    v_dot2_f32_bf16 v74, v47, s65, v74
    v_dot2_f32_bf16 v75, v47, s66, v75
L_gd_179:
    s_nop 2
    ds_write_b128 v109, v[68:71]
    ds_write_b128 v109, v[72:75] offset:1024
    s_cmp_lg_u32 s82, 0
    s_cselect_b32 s24, 3, 1
    s_and_b32 s24, s24, s100
    s_waitcnt lgkmcnt(0)
    s_barrier
    s_cbranch_scc1 L_nofin_175
    ds_read_b128 v[112:115], v109 offset:4096
    ds_read_b128 v[116:119], v109 offset:5120
    s_cmp_eq_u32 s82, 0
    s_cbranch_scc1 L_g1_180
    ds_read_b128 v[120:123], v109 offset:8192
    ds_read_b128 v[124:127], v109 offset:9216
    ds_read_b128 v[128:131], v109 offset:12288
    ds_read_b128 v[132:135], v109 offset:13312
    s_waitcnt lgkmcnt(0)
    v_pk_add_f32 v[120:121], v[120:121], v[128:129]
    v_pk_add_f32 v[122:123], v[122:123], v[130:131]
    v_pk_add_f32 v[124:125], v[124:125], v[132:133]
    v_pk_add_f32 v[126:127], v[126:127], v[134:135]
    v_pk_add_f32 v[112:113], v[112:113], v[120:121]
    v_pk_add_f32 v[114:115], v[114:115], v[122:123]
    v_pk_add_f32 v[116:117], v[116:117], v[124:125]
    v_pk_add_f32 v[118:119], v[118:119], v[126:127]
L_g1_180:
    s_waitcnt lgkmcnt(0)
    v_pk_add_f32 v[68:69], v[68:69], v[112:113]
    v_pk_add_f32 v[70:71], v[70:71], v[114:115]
    v_pk_add_f32 v[72:73], v[72:73], v[116:117]
    v_pk_add_f32 v[74:75], v[74:75], v[118:119]
    v_cvt_pk_bf16_f32 v0, v68, v69
    v_cvt_pk_bf16_f32 v1, v70, v71
    v_cvt_pk_bf16_f32 v2, v72, v73
    v_cvt_pk_bf16_f32 v3, v74, v75
    v_lshlrev_b32 v68, 16, v0
    v_and_b32 v69, 0xffff0000, v0
    v_lshlrev_b32 v76, 16, v96
    v_and_b32 v77, 0xffff0000, v96
    v_lshlrev_b32 v70, 16, v1
    v_and_b32 v71, 0xffff0000, v1
    v_lshlrev_b32 v78, 16, v97
    v_and_b32 v79, 0xffff0000, v97
    v_lshlrev_b32 v72, 16, v2
    v_and_b32 v73, 0xffff0000, v2
    v_lshlrev_b32 v80, 16, v98
    v_and_b32 v81, 0xffff0000, v98
    v_lshlrev_b32 v74, 16, v3
    v_and_b32 v75, 0xffff0000, v3
    v_lshlrev_b32 v82, 16, v99
    v_and_b32 v83, 0xffff0000, v99
    v_pk_add_f32 v[68:69], v[68:69], v[76:77]
    v_pk_add_f32 v[70:71], v[70:71], v[78:79]
    v_pk_add_f32 v[72:73], v[72:73], v[80:81]
    v_pk_add_f32 v[74:75], v[74:75], v[82:83]
    v_cvt_pk_bf16_f32 v4, v68, v69
    v_cvt_pk_bf16_f32 v5, v70, v71
    v_cvt_pk_bf16_f32 v6, v72, v73
    v_cvt_pk_bf16_f32 v7, v74, v75
    v_lshlrev_b32 v68, 16, v4
    v_and_b32 v69, 0xffff0000, v4
    v_lshlrev_b32 v70, 16, v5
    v_and_b32 v71, 0xffff0000, v5
    v_lshlrev_b32 v72, 16, v6
    v_and_b32 v73, 0xffff0000, v6
    v_lshlrev_b32 v74, 16, v7
    v_and_b32 v75, 0xffff0000, v7
    v_add_f32 v84, v68, v69
    v_add_f32 v84, v84, v70
    v_add_f32 v84, v84, v71
    v_add_f32 v84, v84, v72
    v_add_f32 v84, v84, v73
    v_add_f32 v84, v84, v74
    v_add_f32 v84, v84, v75
    s_nop 1
    v_add_f32_dpp v84, v84, v84 row_ror:1 row_mask:0xf bank_mask:0xf
    s_nop 1
    v_add_f32_dpp v84, v84, v84 row_ror:2 row_mask:0xf bank_mask:0xf
    s_nop 1
    v_add_f32_dpp v84, v84, v84 row_ror:4 row_mask:0xf bank_mask:0xf
    s_nop 1
    v_add_f32_dpp v84, v84, v84 row_ror:8 row_mask:0xf bank_mask:0xf
    v_mov_b32 v85, v84
    s_nop 1
    v_permlane32_swap_b32 v85, v84
    v_add_f32 v84, v85, v84
    v_mov_b32 v85, v84
    s_nop 1
    v_permlane16_swap_b32 v85, v84
    v_add_f32 v84, v85, v84
    v_mul_f32 v84, 0x3b000000, v84
    v_cvt_pk_bf16_f32 v86, v84, v84
    v_and_b32 v86, 0xffff0000, v86
    v_sub_f32 v87, v84, v86
    v_sub_f32 v76, v68, v86
    v_sub_f32 v77, v69, v86
    v_sub_f32 v78, v70, v86
    v_sub_f32 v79, v71, v86
    v_sub_f32 v80, v72, v86
    v_sub_f32 v81, v73, v86
    v_sub_f32 v82, v74, v86
    v_sub_f32 v83, v75, v86
    v_mul_f32 v100, v76, v76
    v_fmac_f32 v100, v77, v77
    v_fmac_f32 v100, v78, v78
    v_fmac_f32 v100, v79, v79
    v_fmac_f32 v100, v80, v80
    v_fmac_f32 v100, v81, v81
    v_fmac_f32 v100, v82, v82
    v_fmac_f32 v100, v83, v83
    s_nop 1
    v_add_f32_dpp v100, v100, v100 row_ror:1 row_mask:0xf bank_mask:0xf
    s_nop 1
    v_add_f32_dpp v100, v100, v100 row_ror:2 row_mask:0xf bank_mask:0xf
    s_nop 1
    v_add_f32_dpp v100, v100, v100 row_ror:4 row_mask:0xf bank_mask:0xf
    s_nop 1
    v_add_f32_dpp v100, v100, v100 row_ror:8 row_mask:0xf bank_mask:0xf
    v_mov_b32 v85, v100
    s_nop 1
    v_permlane32_swap_b32 v85, v100
    v_add_f32 v100, v85, v100
    v_mov_b32 v85, v100
    s_nop 1
    v_permlane16_swap_b32 v85, v100
    v_add_f32 v100, v85, v100
    v_mul_f32 v85, v87, v87
    v_mul_f32 v100, 0x3b000000, v100
    v_sub_f32 v100, v100, v85
    v_max_f32 v100, 0, v100
    v_cvt_pk_bf16_f32 v100, v100, v100
    v_and_b32 v100, 0xffff0000, v100
    v_add_f32 v100, 0x3727c5ac, v100
    v_cvt_pk_bf16_f32 v100, v100, v100
    v_and_b32 v100, 0xffff0000, v100
    v_sqrt_f32 v100, v100
    s_nop 0
    v_cvt_pk_bf16_f32 v100, v100, v100
    v_and_b32 v100, 0xffff0000, v100
    v_rcp_f32 v100, v100
    v_cvt_pk_bf16_f32 v8, v76, v77
    v_cvt_pk_bf16_f32 v9, v78, v79
    v_cvt_pk_bf16_f32 v10, v80, v81
    v_cvt_pk_bf16_f32 v11, v82, v83
    v_lshlrev_b32 v76, 16, v8
    v_and_b32 v77, 0xffff0000, v8
    v_lshlrev_b32 v78, 16, v9
    v_and_b32 v79, 0xffff0000, v9
    v_lshlrev_b32 v80, 16, v10
    v_and_b32 v81, 0xffff0000, v10
    v_lshlrev_b32 v82, 16, v11
    v_and_b32 v83, 0xffff0000, v11
    v_mul_f32 v76, v100, v76
    v_mul_f32 v77, v100, v77
    v_mul_f32 v78, v100, v78
    v_mul_f32 v79, v100, v79
    v_mul_f32 v80, v100, v80
    v_mul_f32 v81, v100, v81
    v_mul_f32 v82, v100, v82
    v_mul_f32 v83, v100, v83
    v_cvt_pk_bf16_f32 v8, v76, v77
    v_cvt_pk_bf16_f32 v9, v78, v79
    v_cvt_pk_bf16_f32 v10, v80, v81
    v_cvt_pk_bf16_f32 v11, v82, v83
    v_lshlrev_b32 v76, 16, v8
    v_and_b32 v77, 0xffff0000, v8
    v_lshlrev_b32 v78, 16, v9
    v_and_b32 v79, 0xffff0000, v9
    v_lshlrev_b32 v80, 16, v10
    v_and_b32 v81, 0xffff0000, v10
    v_lshlrev_b32 v82, 16, v11
    v_and_b32 v83, 0xffff0000, v11
    v_lshlrev_b32 v88, 16, v236
    v_and_b32 v89, 0xffff0000, v236
    v_lshlrev_b32 v90, 16, v237
    v_and_b32 v91, 0xffff0000, v237
    v_lshlrev_b32 v92, 16, v238
    v_and_b32 v93, 0xffff0000, v238
    v_lshlrev_b32 v94, 16, v239
    v_and_b32 v95, 0xffff0000, v239
    v_mul_f32 v84, v76, v88
    v_fmac_f32 v84, v77, v89
    v_fmac_f32 v84, v78, v90
    v_fmac_f32 v84, v79, v91
    v_fmac_f32 v84, v80, v92
    v_fmac_f32 v84, v81, v93
    v_fmac_f32 v84, v82, v94
    v_fmac_f32 v84, v83, v95
    s_nop 1
    v_add_f32_dpp v84, v84, v84 row_ror:1 row_mask:0xf bank_mask:0xf
    s_nop 1
    v_add_f32_dpp v84, v84, v84 row_ror:2 row_mask:0xf bank_mask:0xf
    s_nop 1
    v_add_f32_dpp v84, v84, v84 row_ror:4 row_mask:0xf bank_mask:0xf
    s_nop 1
    v_add_f32_dpp v84, v84, v84 row_ror:8 row_mask:0xf bank_mask:0xf
    v_mov_b32 v85, v84
    s_nop 1
    v_permlane32_swap_b32 v85, v84
    v_add_f32 v84, v85, v84
    v_mov_b32 v85, v84
    s_nop 1
    v_permlane16_swap_b32 v85, v84
    v_add_f32 v84, v85, v84
    v_cvt_pk_bf16_f32 v84, v84, v84
    v_and_b32 v84, 0xffff0000, v84
    v_ashrrev_i32 v85, 31, v84
    v_or_b32 v85, 0x80000000, v85
    v_xor_b32 v84, v84, v85
    v_and_b32 v84, 0xffff0000, v84
    s_sub_u32 s62, 0x87ff, s60
    v_or_b32 v84, s62, v84
    s_lshl_b32 s62, s60, 2
    s_mov_b64 exec, 1
    s_add_u32 s63, s62, 0x6f00
    s_lshl_b32 s96, s60, 7
    s_add_u32 s96, s96, 0xfffcb000
    s_cmp_ge_u32 s60, 1984
    s_cselect_b32 s63, s96, s63
    s_cmp_ge_u32 s60, 1792
    s_cselect_b32 s63, s63, 0x7ff00000
    buffer_store_dword v84, off, s[8:11], s63 sc1
    s_mov_b64 exec, -1
    v_pk_add_f32 v[68:69], v[68:69], v[76:77]
    v_pk_add_f32 v[70:71], v[70:71], v[78:79]
    v_pk_add_f32 v[72:73], v[72:73], v[80:81]
    v_pk_add_f32 v[74:75], v[74:75], v[82:83]
    v_cvt_pk_bf16_f32 v12, v68, v69
    v_cvt_pk_bf16_f32 v13, v70, v71
    v_cvt_pk_bf16_f32 v14, v72, v73
    v_cvt_pk_bf16_f32 v15, v74, v75
    buffer_store_dwordx4 v[12:15], v240, s[16:19], s64 offen sc1
    s_mov_b64 exec, 1
    v_cmp_ge_u32 vcc, v104, v84
    s_cselect_b32 s63, 1, 0
    s_and_b32 s63, s63, vcc_lo
    s_cbranch_scc1 L_nokey_185
    s_mov_b64 exec, -1
    s_add_u32 s63, s64, 0x6000000
    buffer_store_dwordx4 v[4:7], v240, s[8:11], s63 offen sc1
    s_add_u32 s63, s64, 0x6200000
    buffer_store_dwordx4 v[8:11], v240, s[8:11], s63 offen sc1
    s_mov_b64 exec, 1
    s_add_u32 s62, s62, 0x6000
    s_waitcnt vmcnt(0)
    buffer_store_dword v84, off, s[8:11], s62 sc1
L_nokey_185:
    s_mov_b64 exec, -1
L_nofin_175:
    s_add_u32 s80, s80, 4
    s_add_u32 s22, s22, s23
    s_sub_u32 s24, s22, 68
    s_cmp_lt_u32 s24, 2
    s_cselect_b32 s82, 2, 0
    s_cselect_b32 s24, 6, 0
    s_sub_u32 s22, s22, s24
    s_branch L_p2_seg
L_redo_141:
    v_mfma_f32_16x16x32_bf16 v[116:119], v[16:19], v[0:3], 0
    v_mfma_f32_16x16x32_bf16 v[116:119], v[20:23], v[4:7], v[116:119]
    v_mfma_f32_16x16x32_bf16 v[116:119], v[24:27], v[8:11], v[116:119]
    v_mfma_f32_16x16x32_bf16 v[116:119], v[28:31], v[12:15], v[116:119]
    v_mfma_f32_16x16x32_bf16 v[120:123], v[32:35], v[0:3], 0
    v_mfma_f32_16x16x32_bf16 v[120:123], v[36:39], v[4:7], v[120:123]
    v_mfma_f32_16x16x32_bf16 v[120:123], v[40:43], v[8:11], v[120:123]
    v_mfma_f32_16x16x32_bf16 v[120:123], v[44:47], v[12:15], v[120:123]
    v_mov_b32 v247, s53
    v_cndmask_b32 v116, v247, v116, s[30:31]
    v_cndmask_b32 v117, v247, v117, s[32:33]
    v_cndmask_b32 v118, v247, v118, s[34:35]
    v_cndmask_b32 v119, v247, v119, s[36:37]
    s_nop 2
    v_cndmask_b32 v120, v247, v120, s[38:39]
    v_cndmask_b32 v121, v247, v121, s[40:41]
    v_cndmask_b32 v122, v247, v122, s[42:43]
    v_cndmask_b32 v123, v247, v123, s[44:45]
    v_max3_f32 v246, v116, v117, v118
    v_max3_f32 v246, v246, v119, v120
    v_max3_f32 v246, v246, v121, v122
    v_max_f32 v246, v246, v123
    v_max3_f32 v246, v246, v112, v113
    v_mov_b32 v247, v246
    s_nop 1
    v_permlane32_swap_b32 v247, v246
    v_max_f32 v246, v247, v246
    v_mov_b32 v247, v246
    s_nop 1
    v_permlane16_swap_b32 v247, v246
    v_max_f32 v246, v247, v246
    v_mul_f32 v248, s28, v246
    v_pk_fma_f32 v[116:117], v[116:117], s[28:29], v[248:249] op_sel_hi:[1,1,0] neg_lo:[0,0,1] neg_hi:[0,0,1]
    v_pk_fma_f32 v[118:119], v[118:119], s[28:29], v[248:249] op_sel_hi:[1,1,0] neg_lo:[0,0,1] neg_hi:[0,0,1]
    v_pk_fma_f32 v[120:121], v[120:121], s[28:29], v[248:249] op_sel_hi:[1,1,0] neg_lo:[0,0,1] neg_hi:[0,0,1]
    v_pk_fma_f32 v[122:123], v[122:123], s[28:29], v[248:249] op_sel_hi:[1,1,0] neg_lo:[0,0,1] neg_hi:[0,0,1]
    v_exp_f32 v116, v116
    v_exp_f32 v117, v117
    v_exp_f32 v118, v118
    v_exp_f32 v119, v119
    v_exp_f32 v120, v120
    v_exp_f32 v121, v121
    v_exp_f32 v122, v122
    v_exp_f32 v123, v123
    v_cvt_pk_bf16_f32 v124, v116, v117
    v_cvt_pk_bf16_f32 v125, v118, v119
    v_cvt_pk_bf16_f32 v126, v120, v121
    v_cvt_pk_bf16_f32 v127, v122, v123
    v_mov_b32 v129, 0
    s_nop 0
    v_mfma_f32_16x16x32_bf16 v[132:135], v[136:139], v[124:127], 0
    v_mfma_f32_16x16x32_bf16 v[140:143], v[64:67], v[124:127], 0
    v_mfma_f32_16x16x32_bf16 v[144:147], v[68:71], v[124:127], 0
    v_mfma_f32_16x16x32_bf16 v[148:151], v[72:75], v[124:127], 0
    v_mfma_f32_16x16x32_bf16 v[152:155], v[76:79], v[124:127], 0
    v_mfma_f32_16x16x32_bf16 v[156:159], v[80:83], v[124:127], 0
    v_mfma_f32_16x16x32_bf16 v[160:163], v[84:87], v[124:127], 0
    v_mfma_f32_16x16x32_bf16 v[164:167], v[88:91], v[124:127], 0
    v_mfma_f32_16x16x32_bf16 v[168:171], v[92:95], v[124:127], 0
    v_pk_fma_f32 v[114:115], v[112:113], s[28:29], v[248:249] op_sel_hi:[1,1,0] neg_lo:[0,0,1] neg_hi:[0,0,1]
    s_nop 6
    s_branch L_redone_142
L_p2_end:
    s_cmp_ge_u32 s67, 56
    s_cbranch_scc1 L_exit
    s_mov_b32 s74, 0
    s_mov_b32 s75, 0
    v_mov_b32 v202, 0x7ffffff0
    v_mbcnt_lo_u32_b32 v0, -1, 0
    v_mbcnt_hi_u32_b32 v0, -1, v0
    s_lshl_b32 s96, s100, 6
    v_add_u32 v0, s96, v0
    v_lshlrev_b32 v1, 6, v0
    s_getpc_b64 s[70:71]
L_pc_186:
    s_add_u32 s70, s70, L_ffn_round-L_pc_186
    s_addc_u32 s71, s71, 0
    v_min_u32 v1, L_code_end-L_ffn_round-4, v1
    global_load_dword v3, v1, s[70:71]
    v_mov_b32 v1, 0
    s_and_b32 s71, s101, 15
    s_lshl_b32 s71, s71, 7
    s_add_u32 s71, s71, 0x1000
    s_mov_b32 s72, 57
    s_cmp_lg_u32 s100, 0
    s_cbranch_scc1 L_polls_189
    s_mov_b32 exec_lo, 0x1
    s_mov_b32 exec_hi, 0
    s_mov_b32 s96, 0
L_poll_187:
    buffer_load_dword v2, v1, s[8:11], s71 offen sc1
    s_waitcnt vmcnt(0)
    v_cmp_gt_u32 vcc, s72, v2
    s_cbranch_vccz L_polld_188
    v_readfirstlane_b32 s97, v2
    s_nop 0
    s_sub_u32 s97, s72, s97
    s_cmp_lt_i32 s97, 3
    s_cbranch_scc1 L_near_190
    s_sleep 40
    s_cmp_lt_i32 s97, 5
    s_cbranch_scc1 L_near_190
    s_sleep 100
L_near_190:
    s_sleep 16
    s_add_u32 s96, s96, 1
    s_cmp_lt_u32 s96, 0x10000
    s_cbranch_scc1 L_poll_187
L_polld_188:
    s_mov_b64 exec, -1
L_polls_189:
    s_barrier
L_ffn_round:
    v_mbcnt_lo_u32_b32 v0, -1, 0
    v_mbcnt_hi_u32_b32 v0, -1, v0
    s_lshl_b32 s96, s100, 6
    v_add_u32 v0, s96, v0
    s_cmp_lg_u32 s75, 0
    s_cbranch_scc1 L_ffn_re
    v_lshlrev_b32 v30, 5, v0
    s_mov_b32 s69, 0x6000
    v_cmp_le_u32 vcc, 224, v0
    v_mov_b32 v29, s75
    v_add_u32 v29, -1, v29
    v_cndmask_b32 v19, 0, v29, vcc
    s_mov_b32 s70, 0
L_kpoll_191:
    buffer_load_dwordx4 v[20:23], v30, s[8:11], s69 offen sc1
    buffer_load_dwordx4 v[24:27], v30, s[8:11], s69 offen offset:16 sc1
    s_waitcnt vmcnt(0)
    v_min3_u32 v28, v20, v21, v22
    v_min3_u32 v28, v28, v23, v24
    v_min3_u32 v28, v28, v25, v26
    v_min_u32 v28, v28, v27
    v_or_b32 v28, v28, v19
    v_cmp_eq_u32 vcc, 0, v28
    s_cbranch_vccz L_kpolld_192
    s_sleep 6
    s_add_u32 s70, s70, 1
    s_cmp_lt_u32 s70, 0x10000
    s_cbranch_scc1 L_kpoll_191
L_kpolld_192:
    v_bfi_b32 v20, v19, 0, v20
    v_bfi_b32 v21, v19, 0, v21
    v_bfi_b32 v22, v19, 0, v22
    v_bfi_b32 v23, v19, 0, v23
    v_bfi_b32 v24, v19, 0, v24
    v_bfi_b32 v25, v19, 0, v25
    v_bfi_b32 v26, v19, 0, v26
    v_bfi_b32 v27, v19, 0, v27
    v_lshrrev_b32 v30, 6, v0
    v_lshlrev_b32 v30, 2, v30
    v_add_u32 v30, 0x20400, v30
    v_mov_b32 v31, 0x20400
    s_waitcnt vmcnt(0)
    v_max3_u32 v28, v20, v21, v22
    v_max3_u32 v28, v28, v23, v24
    v_max3_u32 v28, v28, v25, v26
    v_max_u32 v28, v28, v27
    s_nop 1
    v_max_u32_dpp v28, v28, v28 row_ror:1 row_mask:0xf bank_mask:0xf
    s_nop 1
    v_max_u32_dpp v28, v28, v28 row_ror:2 row_mask:0xf bank_mask:0xf
    s_nop 1
    v_max_u32_dpp v28, v28, v28 row_ror:4 row_mask:0xf bank_mask:0xf
    s_nop 1
    v_max_u32_dpp v28, v28, v28 row_ror:8 row_mask:0xf bank_mask:0xf
    v_mov_b32 v29, v28
    s_nop 1
    v_permlane32_swap_b32 v29, v28
    v_max_u32 v28, v29, v28
    v_mov_b32 v29, v28
    s_nop 1
    v_permlane16_swap_b32 v29, v28
    v_max_u32 v28, v29, v28
    ds_write_b32 v30, v28
    s_waitcnt lgkmcnt(0)
    s_barrier
    ds_read_b128 v[16:19], v31
    s_waitcnt lgkmcnt(0)
    v_max3_u32 v28, v16, v17, v18
    v_max_u32 v28, v28, v19
    s_nop 0
    v_readfirstlane_b32 s69, v28
    s_nop 1
    v_cmp_ne_u32 vcc, s69, v20
    s_nop 1
    v_cndmask_b32 v20, 0, v20, vcc
    v_cmp_ne_u32 vcc, s69, v21
    s_nop 1
    v_cndmask_b32 v21, 0, v21, vcc
    v_cmp_ne_u32 vcc, s69, v22
    s_nop 1
    v_cndmask_b32 v22, 0, v22, vcc
    v_cmp_ne_u32 vcc, s69, v23
    s_nop 1
    v_cndmask_b32 v23, 0, v23, vcc
    v_cmp_ne_u32 vcc, s69, v24
    s_nop 1
    v_cndmask_b32 v24, 0, v24, vcc
    v_cmp_ne_u32 vcc, s69, v25
    s_nop 1
    v_cndmask_b32 v25, 0, v25, vcc
    v_cmp_ne_u32 vcc, s69, v26
    s_nop 1
    v_cndmask_b32 v26, 0, v26, vcc
    v_cmp_ne_u32 vcc, s69, v27
    s_nop 1
    v_cndmask_b32 v27, 0, v27, vcc
    v_max3_u32 v28, v20, v21, v22
    v_max3_u32 v28, v28, v23, v24
    v_max3_u32 v28, v28, v25, v26
    v_max_u32 v28, v28, v27
    s_nop 1
    v_max_u32_dpp v28, v28, v28 row_ror:1 row_mask:0xf bank_mask:0xf
    s_nop 1
    v_max_u32_dpp v28, v28, v28 row_ror:2 row_mask:0xf bank_mask:0xf
    s_nop 1
    v_max_u32_dpp v28, v28, v28 row_ror:4 row_mask:0xf bank_mask:0xf
    s_nop 1
    v_max_u32_dpp v28, v28, v28 row_ror:8 row_mask:0xf bank_mask:0xf
    v_mov_b32 v29, v28
    s_nop 1
    v_permlane32_swap_b32 v29, v28
    v_max_u32 v28, v29, v28
    v_mov_b32 v29, v28
    s_nop 1
    v_permlane16_swap_b32 v29, v28
    v_max_u32 v28, v29, v28
    ds_write_b32 v30, v28 offset:16
    s_waitcnt lgkmcnt(0)
    s_barrier
    ds_read_b128 v[16:19], v31 offset:16
    s_waitcnt lgkmcnt(0)
    v_max3_u32 v28, v16, v17, v18
    v_max_u32 v28, v28, v19
    s_nop 0
    v_readfirstlane_b32 s70, v28
    s_barrier
    s_cmp_lg_u32 s67, 55
    s_cbranch_scc1 L_ffn_sel
    s_mov_b32 s71, 0x8f00
    s_cmp_lg_u32 s100, 0
    s_cbranch_scc1 L_flag_193
    v_mov_b32 v2, s70
    s_mov_b64 exec, 1
    buffer_store_dword v2, off, s[8:11], s71 sc1
    s_mov_b64 exec, -1
L_flag_193:
    s_branch L_ffn_sel
L_ffn_re:
    v_mul_u32_u24 v30, 12, v0
    v_lshlrev_b32 v31, 7, v0
    v_add_u32 v31, 0x500, v31
    v_mov_b32 v29, 0x20400
    s_cmp_lg_u32 s100, 0
    s_cbranch_scc1 L_rselw_197
    s_mov_b32 s71, 0x8b00
    s_mov_b32 s72, 0
L_rsel_194:
    buffer_load_dword v23, v31, s[8:11], s71 offen sc1
    buffer_load_dwordx3 v[20:22], v30, s[8:11], s71 offen sc1
    s_waitcnt vmcnt(0)
    v_min3_u32 v28, v20, v21, v22
    v_min_u32 v28, v28, v23
    v_cmp_eq_u32 vcc, 0, v28
    s_cbranch_vccz L_rseld_195
    s_sleep 1
    s_add_u32 s72, s72, 1
    s_cmp_lt_u32 s72, 0x10000
    s_cbranch_scc1 L_rsel_194
L_rseld_195:
    v_max3_u32 v28, v20, v21, v22
    v_max_u32 v28, v28, v23
    v_cmp_lt_u32 vcc, s70, v28
    s_cbranch_vccz L_rsele_196
    s_mov_b32 s71, 0x7c00
    v_lshlrev_b32 v31, 2, v0
    v_add_u32 v31, 768, v31
L_rack_198:
    buffer_load_dword v27, v31, s[8:11], s71 offen sc1
    buffer_load_dwordx3 v[24:26], v30, s[8:11], s71 offen sc1
    s_add_u32 s72, s72, 1
    s_waitcnt vmcnt(0)
    v_sub_u32 v24, v20, v24
    v_sub_u32 v25, v21, v25
    v_sub_u32 v26, v22, v26
    v_sub_u32 v27, v23, v27
    v_max3_u32 v28, v24, v25, v26
    v_max_u32 v28, v28, v27
    v_cmp_lt_u32 vcc, s70, v28
    s_cbranch_vccz L_rackd_199
    s_cmp_lt_u32 s72, 0x10000
    s_cbranch_scc1 L_rack_198
L_rackd_199:
    v_max3_u32 v28, v20, v21, v22
    v_max_u32 v28, v28, v23
    s_nop 1
    v_max_u32_dpp v28, v28, v28 row_ror:1 row_mask:0xf bank_mask:0xf
    s_nop 1
    v_max_u32_dpp v28, v28, v28 row_ror:2 row_mask:0xf bank_mask:0xf
    s_nop 1
    v_max_u32_dpp v28, v28, v28 row_ror:4 row_mask:0xf bank_mask:0xf
    s_nop 1
    v_max_u32_dpp v28, v28, v28 row_ror:8 row_mask:0xf bank_mask:0xf
    v_mov_b32 v29, v28
    s_nop 1
    v_permlane32_swap_b32 v29, v28
    v_max_u32 v28, v29, v28
    v_mov_b32 v29, v28
    s_nop 1
    v_permlane16_swap_b32 v29, v28
    v_max_u32 v28, v29, v28
    s_nop 0
    v_readfirstlane_b32 s71, v28
    s_nop 1
    v_cmp_ne_u32 vcc, s71, v20
    s_nop 1
    v_cndmask_b32 v20, 0, v20, vcc
    v_cmp_ne_u32 vcc, s71, v21
    s_nop 1
    v_cndmask_b32 v21, 0, v21, vcc
    v_cmp_ne_u32 vcc, s71, v22
    s_nop 1
    v_cndmask_b32 v22, 0, v22, vcc
    v_cmp_ne_u32 vcc, s71, v23
    s_nop 1
    v_cndmask_b32 v23, 0, v23, vcc
    v_max3_u32 v28, v20, v21, v22
    v_max_u32 v28, v28, v23
    s_nop 1
    v_max_u32_dpp v28, v28, v28 row_ror:1 row_mask:0xf bank_mask:0xf
    s_nop 1
    v_max_u32_dpp v28, v28, v28 row_ror:2 row_mask:0xf bank_mask:0xf
    s_nop 1
    v_max_u32_dpp v28, v28, v28 row_ror:4 row_mask:0xf bank_mask:0xf
    s_nop 1
    v_max_u32_dpp v28, v28, v28 row_ror:8 row_mask:0xf bank_mask:0xf
    v_mov_b32 v29, v28
    s_nop 1
    v_permlane32_swap_b32 v29, v28
    v_max_u32 v28, v29, v28
    v_mov_b32 v29, v28
    s_nop 1
    v_permlane16_swap_b32 v29, v28
    v_max_u32 v28, v29, v28
    s_nop 0
    v_readfirstlane_b32 s72, v28
    s_nop 0
    s_max_u32 s70, s70, s72
    s_min_u32 s72, s71, s69
    s_max_u32 s70, s70, s72
    s_max_u32 s69, s69, s71
    v_mov_b32 v29, 0x20400
L_rsele_196:
    v_mov_b32 v20, s69
    v_mov_b32 v21, s70
    ds_write_b64 v29, v[20:21]
    s_waitcnt lgkmcnt(0)
L_rselw_197:
    s_barrier
    ds_read_b64 v[20:21], v29
    s_waitcnt lgkmcnt(0)
    v_readfirstlane_b32 s69, v20
    v_readfirstlane_b32 s70, v21
    s_nop 3
L_ffn_sel:
    s_and_b32 s71, s69, 2047
    s_lshl_b32 s71, s71, 11
    s_and_b32 s72, s70, 2047
    s_or_b32 s71, s71, s72
    s_add_u32 s71, s71, 1
    s_cmp_eq_u32 s71, s74
    s_cbranch_scc1 L_ffn_same
    s_mov_b32 s74, s71
    s_mov_b32 exec_lo, 0xff
    s_mov_b32 exec_hi, 0
    buffer_store_dwordx2 v[204:205], v202, s[16:19], 0 offen sc1
    s_mov_b64 exec, -1
    v_and_b32 v1, 63, v0
    v_lshrrev_b32 v2, 4, v1
    v_and_b32 v3, 15, v1
    v_lshrrev_b32 v6, 2, v3
    s_and_b32 s71, s69, 2047
    s_sub_u32 s71, 2047, s71
    s_and_b32 s72, s70, 2047
    s_sub_u32 s72, 2047, s72
    v_and_b32 v4, 1, v3
    v_cmp_eq_u32 vcc, 0, v4
    v_mov_b32 v4, s71
    v_mov_b32 v5, s72
    v_cndmask_b32 v4, v5, v4, vcc
    v_lshlrev_b32 v4, 10, v4
    v_lshl_add_u32 v4, v2, 4, v4
    s_mov_b32 s71, 0x6200000
    buffer_load_dwordx4 v[32:35], v4, s[8:11], s71 offen
    buffer_load_dwordx4 v[36:39], v4, s[8:11], s71 offen offset:64
    buffer_load_dwordx4 v[40:43], v4, s[8:11], s71 offen offset:128
    buffer_load_dwordx4 v[44:47], v4, s[8:11], s71 offen offset:192
    buffer_load_dwordx4 v[48:51], v4, s[8:11], s71 offen offset:256
    buffer_load_dwordx4 v[52:55], v4, s[8:11], s71 offen offset:320
    buffer_load_dwordx4 v[56:59], v4, s[8:11], s71 offen offset:384
    buffer_load_dwordx4 v[60:63], v4, s[8:11], s71 offen offset:448
    buffer_load_dwordx4 v[64:67], v4, s[8:11], s71 offen offset:512
    buffer_load_dwordx4 v[68:71], v4, s[8:11], s71 offen offset:576
    buffer_load_dwordx4 v[72:75], v4, s[8:11], s71 offen offset:640
    buffer_load_dwordx4 v[76:79], v4, s[8:11], s71 offen offset:704
    buffer_load_dwordx4 v[80:83], v4, s[8:11], s71 offen offset:768
    buffer_load_dwordx4 v[84:87], v4, s[8:11], s71 offen offset:832
    buffer_load_dwordx4 v[88:91], v4, s[8:11], s71 offen offset:896
    buffer_load_dwordx4 v[92:95], v4, s[8:11], s71 offen offset:960
    v_lshl_add_u32 v4, v2, 3, v6
    v_lshlrev_b32 v4, 6, v4
    v_and_b32 v5, 3, v3
    v_lshl_add_u32 v4, v5, 3, v4
    s_lshr_b32 s71, s68, 1
    s_lshl_b32 s71, s71, 15
    s_and_b32 s72, s68, 1
    s_lshl_b32 s72, s72, 5
    s_add_u32 s71, s71, s72
    s_add_u32 s71, s71, 0x8000
    v_add_u32 v7, s71, v4
    ds_read_b64_tr_b16 v[96:97], v7
    ds_read_b64_tr_b16 v[98:99], v7 offset:256
    ds_read_b64_tr_b16 v[100:101], v7 offset:2048
    ds_read_b64_tr_b16 v[102:103], v7 offset:2304
    ds_read_b64_tr_b16 v[104:105], v7 offset:4096
    ds_read_b64_tr_b16 v[106:107], v7 offset:4352
    ds_read_b64_tr_b16 v[108:109], v7 offset:6144
    ds_read_b64_tr_b16 v[110:111], v7 offset:6400
    s_waitcnt lgkmcnt(0)
    ds_read_b64_tr_b16 v[112:113], v7 offset:8192
    ds_read_b64_tr_b16 v[114:115], v7 offset:8448
    ds_read_b64_tr_b16 v[116:117], v7 offset:10240
    ds_read_b64_tr_b16 v[118:119], v7 offset:10496
    ds_read_b64_tr_b16 v[120:121], v7 offset:12288
    ds_read_b64_tr_b16 v[122:123], v7 offset:12544
    ds_read_b64_tr_b16 v[124:125], v7 offset:14336
    ds_read_b64_tr_b16 v[126:127], v7 offset:14592
    s_waitcnt lgkmcnt(0)
    ds_read_b64_tr_b16 v[128:129], v7 offset:16384
    ds_read_b64_tr_b16 v[130:131], v7 offset:16640
    ds_read_b64_tr_b16 v[132:133], v7 offset:18432
    ds_read_b64_tr_b16 v[134:135], v7 offset:18688
    ds_read_b64_tr_b16 v[136:137], v7 offset:20480
    ds_read_b64_tr_b16 v[138:139], v7 offset:20736
    ds_read_b64_tr_b16 v[140:141], v7 offset:22528
    ds_read_b64_tr_b16 v[142:143], v7 offset:22784
    s_waitcnt lgkmcnt(0)
    ds_read_b64_tr_b16 v[144:145], v7 offset:24576
    ds_read_b64_tr_b16 v[146:147], v7 offset:24832
    ds_read_b64_tr_b16 v[148:149], v7 offset:26624
    ds_read_b64_tr_b16 v[150:151], v7 offset:26880
    ds_read_b64_tr_b16 v[152:153], v7 offset:28672
    ds_read_b64_tr_b16 v[154:155], v7 offset:28928
    ds_read_b64_tr_b16 v[156:157], v7 offset:30720
    ds_read_b64_tr_b16 v[158:159], v7 offset:30976
    s_waitcnt lgkmcnt(0)
    s_waitcnt vmcnt(0)
    v_mfma_f32_16x16x32_bf16 v[8:11], v[32:35], v[96:99], 0
    v_mfma_f32_16x16x32_bf16 v[8:11], v[36:39], v[100:103], v[8:11]
    v_mfma_f32_16x16x32_bf16 v[8:11], v[40:43], v[104:107], v[8:11]
    v_mfma_f32_16x16x32_bf16 v[8:11], v[44:47], v[108:111], v[8:11]
    v_mfma_f32_16x16x32_bf16 v[8:11], v[48:51], v[112:115], v[8:11]
    v_mfma_f32_16x16x32_bf16 v[8:11], v[52:55], v[116:119], v[8:11]
    v_mfma_f32_16x16x32_bf16 v[8:11], v[56:59], v[120:123], v[8:11]
    v_mfma_f32_16x16x32_bf16 v[8:11], v[60:63], v[124:127], v[8:11]
    v_mfma_f32_16x16x32_bf16 v[8:11], v[64:67], v[128:131], v[8:11]
    v_mfma_f32_16x16x32_bf16 v[8:11], v[68:71], v[132:135], v[8:11]
    v_mfma_f32_16x16x32_bf16 v[8:11], v[72:75], v[136:139], v[8:11]
    v_mfma_f32_16x16x32_bf16 v[8:11], v[76:79], v[140:143], v[8:11]
    v_mfma_f32_16x16x32_bf16 v[8:11], v[80:83], v[144:147], v[8:11]
    v_mfma_f32_16x16x32_bf16 v[8:11], v[84:87], v[148:151], v[8:11]
    v_mfma_f32_16x16x32_bf16 v[8:11], v[88:91], v[152:155], v[8:11]
    v_mfma_f32_16x16x32_bf16 v[8:11], v[92:95], v[156:159], v[8:11]
    s_nop 7
    v_cvt_pk_bf16_f32 v8, v8, v8
    v_and_b32 v8, 0xffff0000, v8
    v_cvt_pk_bf16_f32 v9, v9, v9
    v_and_b32 v9, 0xffff0000, v9
    s_cmp_ge_u32 s68, 2
    s_cbranch_scc1 L_ffn_up_200
    v_mul_f32 v13, 0xbfb8aa3b, v8
    v_exp_f32 v13, v13
    s_nop 0
    v_add_f32 v13, 1.0, v13
    v_rcp_f32 v12, v13
    s_nop 0
    v_mul_f32 v8, v12, v8
    v_cvt_pk_bf16_f32 v8, v8, v8
    v_and_b32 v8, 0xffff0000, v8
    v_mul_f32 v13, 0xbfb8aa3b, v9
    v_exp_f32 v13, v13
    s_nop 0
    v_add_f32 v13, 1.0, v13
    v_rcp_f32 v12, v13
    s_nop 0
    v_mul_f32 v9, v12, v9
    v_cvt_pk_bf16_f32 v9, v9, v9
    v_and_b32 v9, 0xffff0000, v9
    s_nop 4
L_ffn_up_200:
    s_lshr_b32 s71, s68, 1
    s_lshl_b32 s71, s71, 8
    s_and_b32 s72, s68, 1
    s_lshl_b32 s72, s72, 6
    s_add_u32 s71, s71, s72
    s_add_u32 s71, s71, 0x20000
    v_lshlrev_b32 v4, 2, v3
    v_add_u32 v4, s71, v4
    ds_write_b32 v4, v8
    ds_write_b32 v4, v9 offset:128
    s_waitcnt lgkmcnt(0)
    s_barrier
    v_and_b32 v4, 1, v3
    v_lshlrev_b32 v4, 7, v4
    v_lshl_add_u32 v4, v2, 5, v4
    v_add_u32 v4, 0x20000, v4
    ds_read_b128 v[32:35], v4
    ds_read_b128 v[36:39], v4 offset:16
    ds_read_b128 v[40:43], v4 offset:256
    ds_read_b128 v[44:47], v4 offset:272
    v_lshl_add_u32 v5, v2, 3, v6
    v_lshlrev_b32 v5, 10, v5
    v_and_b32 v7, 3, v3
    v_lshl_add_u32 v5, v7, 3, v5
    s_lshl_b32 s71, s68, 8
    s_add_u32 s71, s71, 0x18000
    v_add_u32 v7, s71, v5
    s_waitcnt lgkmcnt(0)
    ds_read_b64_tr_b16 v[96:97], v7
    ds_read_b64_tr_b16 v[98:99], v7 offset:4096
    ds_read_b64_tr_b16 v[100:101], v7 offset:32
    ds_read_b64_tr_b16 v[102:103], v7 offset:4128
    ds_read_b64_tr_b16 v[104:105], v7 offset:64
    ds_read_b64_tr_b16 v[106:107], v7 offset:4160
    ds_read_b64_tr_b16 v[108:109], v7 offset:96
    ds_read_b64_tr_b16 v[110:111], v7 offset:4192
    s_waitcnt lgkmcnt(0)
    ds_read_b64_tr_b16 v[112:113], v7 offset:128
    ds_read_b64_tr_b16 v[114:115], v7 offset:4224
    ds_read_b64_tr_b16 v[116:117], v7 offset:160
    ds_read_b64_tr_b16 v[118:119], v7 offset:4256
    ds_read_b64_tr_b16 v[120:121], v7 offset:192
    ds_read_b64_tr_b16 v[122:123], v7 offset:4288
    ds_read_b64_tr_b16 v[124:125], v7 offset:224
    ds_read_b64_tr_b16 v[126:127], v7 offset:4320
    v_mul_f32 v32, v32, v40
    v_mul_f32 v33, v33, v41
    v_mul_f32 v34, v34, v42
    v_mul_f32 v35, v35, v43
    v_mul_f32 v36, v36, v44
    v_mul_f32 v37, v37, v45
    v_mul_f32 v38, v38, v46
    v_mul_f32 v39, v39, v47
    v_cvt_pk_bf16_f32 v48, v32, v33
    v_cvt_pk_bf16_f32 v49, v34, v35
    v_cvt_pk_bf16_f32 v50, v36, v37
    v_cvt_pk_bf16_f32 v51, v38, v39
    s_waitcnt lgkmcnt(0)
    s_nop 0
    v_mfma_f32_16x16x32_bf16 v[56:59], v[48:51], v[96:99], 0
    v_mfma_f32_16x16x32_bf16 v[60:63], v[48:51], v[100:103], 0
    v_mfma_f32_16x16x32_bf16 v[64:67], v[48:51], v[104:107], 0
    v_mfma_f32_16x16x32_bf16 v[68:71], v[48:51], v[108:111], 0
    v_mfma_f32_16x16x32_bf16 v[72:75], v[48:51], v[112:115], 0
    v_mfma_f32_16x16x32_bf16 v[76:79], v[48:51], v[116:119], 0
    v_mfma_f32_16x16x32_bf16 v[80:83], v[48:51], v[120:123], 0
    v_mfma_f32_16x16x32_bf16 v[84:87], v[48:51], v[124:127], 0
    v_cmp_eq_u32 vcc, 0, v2
    v_lshlrev_b32 v4, 11, v2
    v_lshl_add_u32 v4, v3, 2, v4
    s_lshl_b32 s71, s67, 12
    s_lshl_b32 s72, s68, 9
    s_add_u32 s71, s71, s72
    s_add_u32 s71, s71, 0x6410000
    v_cndmask_b32 v56, v57, v56, vcc
    v_cndmask_b32 v60, v61, v60, vcc
    v_cndmask_b32 v64, v65, v64, vcc
    v_cndmask_b32 v68, v69, v68, vcc
    v_cndmask_b32 v72, v73, v72, vcc
    v_cndmask_b32 v76, v77, v76, vcc
    v_cndmask_b32 v80, v81, v80, vcc
    v_cndmask_b32 v84, v85, v84, vcc
    s_mov_b32 exec_hi, 0
    buffer_store_dword v56, v4, s[8:11], s71 offen sc1
    buffer_store_dword v60, v4, s[8:11], s71 offen offset:64 sc1
    buffer_store_dword v64, v4, s[8:11], s71 offen offset:128 sc1
    buffer_store_dword v68, v4, s[8:11], s71 offen offset:192 sc1
    buffer_store_dword v72, v4, s[8:11], s71 offen offset:256 sc1
    buffer_store_dword v76, v4, s[8:11], s71 offen offset:320 sc1
    buffer_store_dword v80, v4, s[8:11], s71 offen offset:384 sc1
    buffer_store_dword v84, v4, s[8:11], s71 offen offset:448 sc1
    s_mov_b64 exec, -1
    s_waitcnt vmcnt(0)
    s_barrier
    s_lshl_b32 s71, s67, 2
    s_lshl_b32 s72, s75, 8
    s_add_u32 s71, s71, s72
    s_add_u32 s71, s71, 0x8000
    s_cmp_lg_u32 s100, 0
    s_cbranch_scc1 L_flag_201
    v_mov_b32 v2, s74
    s_mov_b64 exec, 1
    buffer_store_dword v2, off, s[8:11], s71 sc1
    s_mov_b64 exec, -1
L_flag_201:
    s_cmp_ge_u32 s67, 8
    s_cbranch_scc1 L_ffn_same
    s_load_dwordx2 s[16:17], s[0:1], 96
    s_waitcnt lgkmcnt(0)
    s_and_b32 s17, s17, 0xffff
    s_mov_b32 s18, 0x200000
    s_mov_b32 s19, 0x20000
    v_and_b32 v3, 63, v0
    s_cmp_lt_u32 s100, 2
    s_cselect_b32 s71, s69, s70
    v_mov_b32 v5, s71
    s_and_b32 s71, s71, 2047
    s_sub_u32 s71, 2047, s71
    s_lshl_b32 s71, s71, 10
    s_lshl_b32 s72, s67, 1
    s_and_b32 s96, s100, 1
    s_add_u32 s72, s72, s96
    s_lshl_b32 s96, s72, 6
    s_add_u32 s71, s71, s96
    v_and_b32 v4, 7, v3
    v_lshlrev_b32 v6, 3, v4
    v_add_u32 v6, s71, v6
    v_lshrrev_b32 v7, 3, v3
    v_lshlrev_b32 v7, 12, v7
    v_lshl_add_u32 v7, v4, 4, v7
    s_lshl_b32 s72, s72, 7
    s_lshr_b32 s96, s100, 1
    s_lshl_b32 s96, s96, 11
    s_add_u32 s72, s72, s96
    v_add_u32 v7, s72, v7
    s_mov_b32 s71, 0x6000000
    s_mov_b32 s72, 0x6200000
    buffer_load_dwordx2 v[8:9], v6, s[8:11], s71 offen sc1
    buffer_load_dwordx2 v[10:11], v6, s[8:11], s72 offen sc1
    v_and_b32 v5, 0xffff0000, v5
    v_ashrrev_i32 v4, 31, v5
    v_not_b32 v4, v4
    v_or_b32 v4, 0x80000000, v4
    v_xor_b32 v5, v5, v4
    v_and_b32 v5, 0xffff0000, v5
    v_mul_f32 v23, 0xbfb8aa3b, v5
    v_exp_f32 v23, v23
    s_nop 0
    v_add_f32 v23, 1.0, v23
    v_rcp_f32 v22, v23
    s_nop 0
    v_cvt_pk_bf16_f32 v22, v22, v22
    v_and_b32 v22, 0xffff0000, v22
    v_lshlrev_b32 v1, 2, v0
    s_lshl_b32 s71, s75, 8
    s_add_u32 s71, s71, 0x8000
    s_cmp_lg_u32 s100, 0
    s_cbranch_scc1 L_polls_204
    s_mov_b32 exec_hi, 0xffffff
    s_mov_b32 s96, 0
L_poll_202:
    buffer_load_dword v2, v1, s[8:11], s71 offen sc1
    s_waitcnt vmcnt(0)
    v_cmp_ne_u32 vcc, s74, v2
    s_cbranch_vccz L_polld_203
    s_sleep 2
    s_add_u32 s96, s96, 1
    s_cmp_lt_u32 s96, 0x10000
    s_cbranch_scc1 L_poll_202
L_polld_203:
    s_mov_b64 exec, -1
L_polls_204:
    s_barrier
    s_mov_b32 s71, 0x6410000
    buffer_load_dwordx4 v[32:35], v7, s[8:11], s71 offen sc1
    s_add_u32 s71, s71, 32768
    buffer_load_dwordx4 v[36:39], v7, s[8:11], s71 offen sc1
    s_add_u32 s71, s71, 32768
    buffer_load_dwordx4 v[40:43], v7, s[8:11], s71 offen sc1
    s_add_u32 s71, s71, 32768
    buffer_load_dwordx4 v[44:47], v7, s[8:11], s71 offen sc1
    s_add_u32 s71, s71, 32768
    buffer_load_dwordx4 v[48:51], v7, s[8:11], s71 offen sc1
    s_add_u32 s71, s71, 32768
    buffer_load_dwordx4 v[52:55], v7, s[8:11], s71 offen sc1
    s_add_u32 s71, s71, 32768
    buffer_load_dwordx4 v[56:59], v7, s[8:11], s71 offen sc1
    s_add_u32 s71, s71, 32768
    s_waitcnt vmcnt(7)
    v_lshlrev_b32 v12, 16, v8
    v_and_b32 v13, 0xffff0000, v8
    v_lshlrev_b32 v16, 16, v10
    v_and_b32 v17, 0xffff0000, v10
    v_lshlrev_b32 v14, 16, v9
    v_and_b32 v15, 0xffff0000, v9
    v_lshlrev_b32 v18, 16, v11
    v_and_b32 v19, 0xffff0000, v11
    s_waitcnt vmcnt(0)
    v_pk_add_f32 v[32:33], v[32:33], v[36:37]
    v_pk_add_f32 v[34:35], v[34:35], v[38:39]
    v_pk_add_f32 v[32:33], v[32:33], v[40:41]
    v_pk_add_f32 v[34:35], v[34:35], v[42:43]
    v_pk_add_f32 v[32:33], v[32:33], v[44:45]
    v_pk_add_f32 v[34:35], v[34:35], v[46:47]
    v_pk_add_f32 v[32:33], v[32:33], v[48:49]
    v_pk_add_f32 v[34:35], v[34:35], v[50:51]
    v_pk_add_f32 v[32:33], v[32:33], v[52:53]
    v_pk_add_f32 v[34:35], v[34:35], v[54:55]
    v_pk_add_f32 v[32:33], v[32:33], v[56:57]
    v_pk_add_f32 v[34:35], v[34:35], v[58:59]
    s_nop 0
    v_add_f32_dpp v32, v32, v32 row_ror:8 row_mask:0xf bank_mask:0xf
    v_add_f32_dpp v33, v33, v33 row_ror:8 row_mask:0xf bank_mask:0xf
    v_add_f32_dpp v34, v34, v34 row_ror:8 row_mask:0xf bank_mask:0xf
    v_add_f32_dpp v35, v35, v35 row_ror:8 row_mask:0xf bank_mask:0xf
    v_mov_b32 v24, v32
    s_nop 1
    v_permlane32_swap_b32 v24, v32
    v_add_f32 v32, v24, v32
    v_mov_b32 v24, v32
    s_nop 1
    v_permlane16_swap_b32 v24, v32
    v_add_f32 v32, v24, v32
    v_mov_b32 v24, v33
    s_nop 1
    v_permlane32_swap_b32 v24, v33
    v_add_f32 v33, v24, v33
    v_mov_b32 v24, v33
    s_nop 1
    v_permlane16_swap_b32 v24, v33
    v_add_f32 v33, v24, v33
    v_mov_b32 v24, v34
    s_nop 1
    v_permlane32_swap_b32 v24, v34
    v_add_f32 v34, v24, v34
    v_mov_b32 v24, v34
    s_nop 1
    v_permlane16_swap_b32 v24, v34
    v_add_f32 v34, v24, v34
    v_mov_b32 v24, v35
    s_nop 1
    v_permlane32_swap_b32 v24, v35
    v_add_f32 v35, v24, v35
    v_mov_b32 v24, v35
    s_nop 1
    v_permlane16_swap_b32 v24, v35
    v_add_f32 v35, v24, v35
    v_cvt_pk_bf16_f32 v32, v32, v32
    v_and_b32 v32, 0xffff0000, v32
    v_mul_f32 v32, v22, v32
    v_cvt_pk_bf16_f32 v32, v32, v32
    v_and_b32 v32, 0xffff0000, v32
    v_add_f32 v32, v16, v32
    v_cvt_pk_bf16_f32 v32, v32, v32
    v_and_b32 v32, 0xffff0000, v32
    v_add_f32 v32, v12, v32
    v_cvt_pk_bf16_f32 v33, v33, v33
    v_and_b32 v33, 0xffff0000, v33
    v_mul_f32 v33, v22, v33
    v_cvt_pk_bf16_f32 v33, v33, v33
    v_and_b32 v33, 0xffff0000, v33
    v_add_f32 v33, v17, v33
    v_cvt_pk_bf16_f32 v33, v33, v33
    v_and_b32 v33, 0xffff0000, v33
    v_add_f32 v33, v13, v33
    v_cvt_pk_bf16_f32 v34, v34, v34
    v_and_b32 v34, 0xffff0000, v34
    v_mul_f32 v34, v22, v34
    v_cvt_pk_bf16_f32 v34, v34, v34
    v_and_b32 v34, 0xffff0000, v34
    v_add_f32 v34, v18, v34
    v_cvt_pk_bf16_f32 v34, v34, v34
    v_and_b32 v34, 0xffff0000, v34
    v_add_f32 v34, v14, v34
    v_cvt_pk_bf16_f32 v35, v35, v35
    v_and_b32 v35, 0xffff0000, v35
    v_mul_f32 v35, v22, v35
    v_cvt_pk_bf16_f32 v35, v35, v35
    v_and_b32 v35, 0xffff0000, v35
    v_add_f32 v35, v19, v35
    v_cvt_pk_bf16_f32 v35, v35, v35
    v_and_b32 v35, 0xffff0000, v35
    v_add_f32 v35, v15, v35
    v_cvt_pk_bf16_f32 v200, v32, v33
    v_cvt_pk_bf16_f32 v201, v34, v35
    v_mov_b32 v202, v6
    v_pk_add_f32 v[12:13], v[12:13], v[16:17]
    v_cvt_pk_bf16_f32 v204, v12, v13
    v_pk_add_f32 v[14:15], v[14:15], v[18:19]
    v_cvt_pk_bf16_f32 v205, v14, v15
    s_mov_b32 exec_lo, 0xff
    s_mov_b32 exec_hi, 0
    buffer_store_dwordx2 v[200:201], v202, s[16:19], 0 offen sc1
    s_mov_b64 exec, -1
L_ffn_same:
    s_add_u32 s75, s75, 1
    s_cmp_lt_u32 s75, 2
    s_cbranch_scc1 L_ffn_round
    s_cmp_ge_u32 s67, 8
    s_cbranch_scc1 L_exit
    s_waitcnt vmcnt(0)
L_exit:
    s_endpgm
L_code_end:
.section .rodata,"a"
.p2align 6
.amdhsa_kernel sequential_preLN__memory_aug_recurrent_mem_tr__moe_arch_mod__prompt_kernel
  .amdhsa_next_free_vgpr 512
  .amdhsa_next_free_sgpr 102
  .amdhsa_accum_offset 256
  .amdhsa_group_segment_fixed_size 0
  .amdhsa_kernarg_size 120
  .amdhsa_user_sgpr_count 2
  .amdhsa_user_sgpr_kernarg_segment_ptr 1
  .amdhsa_system_sgpr_workgroup_id_x 1
  .amdhsa_float_denorm_mode_32 3
.end_amdhsa_kernel
```

```asm
; @launch grid=(256,1,1) block=(256,1,1) lds=163840
.amdgcn_target "amdgcn-amd-amdhsa--gfx950"
.text
.globl sequential_preLN__memory_aug_recurrent_mem_tr__moe_arch_mod__prompt_kernel
.p2align 8
.type sequential_preLN__memory_aug_recurrent_mem_tr__moe_arch_mod__prompt_kernel,@function
sequential_preLN__memory_aug_recurrent_mem_tr__moe_arch_mod__prompt_kernel:
    s_cmp_ge_u32 s2, 256
    s_cbranch_scc1 L_exit
    s_load_dwordx2 s[8:9], s[0:1], 112
    s_load_dwordx2 s[92:93], s[0:1], 104
    s_load_dwordx8 s[60:67], s[0:1], 16
    s_load_dwordx2 s[12:13], s[0:1], 0
    v_lshrrev_b32 v1, 6, v0
    s_nop 0
    v_readfirstlane_b32 s100, v1
    s_getreg_b32 s84, hwreg(HW_REG_XCC_ID)
    s_and_b32 s84, s84, 7
    s_lshr_b32 s85, s2, 3
    s_mov_b32 s86, s100
    s_cmp_eq_u32 s2, 7
    s_cbranch_scc1 L_zero
L_noz:
    s_cmp_lg_u32 s84, 0
    s_cbranch_scc1 L_other
    s_xor_b32 s20, s85, 0
    v_lshrrev_b32 v4, 6, v0
    s_nop 0
    v_readfirstlane_b32 s21, v4
    v_and_b32 v1, 63, v0
    v_lshrrev_b32 v2, 4, v1
    v_and_b32 v3, 15, v1
    v_lshrrev_b32 v6, 2, v3
    v_lshlrev_b32 v117, 4, v1
    s_lshl_b32 s51, s21, 10
    s_lshl_b32 s52, s21, 11
    s_mov_b32 s14, 0x400000
    s_mov_b32 s15, 0x20000
    s_lshl_b32 s41, s20, 8
    s_lshl_b32 s42, s20, 17
    s_lshr_b32 s43, s21, 1
    s_lshl_b32 s43, s43, 2
    v_or_b32 v5, s43, v2
    v_lshlrev_b32 v5, 1, v5
    v_xor_b32 v5, v5, v3
    v_lshrrev_b32 v14, 2, v5
    v_and_b32 v14, 2, v14
    v_lshlrev_b32 v5, 4, v5
    s_lshl_b32 s43, s21, 4
    v_add_u32 v4, s43, v2
    v_lshl_add_u32 v8, v4, 13, v5
    s_cmp_lg_u32 s20, 27
    s_cbranch_scc1 L_nocc_1
    v_lshlrev_b32 v25, 3, v117
    s_lshl_b32 s43, s21, 13
    s_getpc_b64 s[4:5]
L_pc_2:
    s_add_u32 s4, s4, L_nocc_1-L_pc_2
    s_addc_u32 s5, s5, 0
    v_add_u32 v25, s43, v25
    v_min_u32 v25, L_code_end-L_nocc_1-4, v25
    global_load_dword v29, v25, s[4:5]
L_nocc_1:
    v_mul_u32_u24 v22, 57, v0
    v_lshrrev_b32 v22, 11, v22
    v_mul_u32_u24 v23, 36, v22
    v_sub_u32 v23, v0, v23
    v_and_b32 v25, 3, v23
    v_and_or_b32 v23, v23, 60, 1
    v_min_u32 v23, 31, v23
    v_lshl_add_u32 v23, v23, 2, v25
    v_lshlrev_b32 v31, 6, v23
    s_add_u32 s43, s20, 2
    s_lshr_b32 s43, s43, 2
    s_sub_u32 s43, s20, s43
    s_mul_i32 s43, s43, 7
    v_add_u32 v22, s43, v22
    s_waitcnt lgkmcnt(0)
    s_mov_b32 s4, s60
    s_and_b32 s5, s61, 0xffff
    s_lshr_b32 s6, 0x5ddddddd, s20
    s_and_b32 s6, s6, 1
    s_lshl_b32 s6, s6, 22
    s_mov_b32 s7, 0x20000
    v_add_u32 v23, 0, v22
    v_and_b32 v25, 448, v23
    v_add_u32 v23, v23, v25
    v_lshl_add_u32 v23, v23, 13, v31
    s_mov_b32 s43, 0x80000
    buffer_load_dword v30, v23, s[4:7], s43 offen
    s_mov_b32 s4, s60
    s_and_b32 s5, s61, 0xffff
    s_lshr_b32 s6, 0x5ddddddd, s20
    s_and_b32 s6, s6, 1
    s_lshl_b32 s6, s6, 22
    s_mov_b32 s7, 0x20000
    v_add_u32 v23, 161, v22
    v_and_b32 v25, 448, v23
    v_add_u32 v23, v23, v25
    v_lshl_add_u32 v23, v23, 13, v31
    s_mov_b32 s43, 0x80000
    buffer_load_dword v30, v23, s[4:7], s43 offen
    s_and_b32 s9, s9, 0xffff
    s_mov_b32 s10, 0x10000000
    s_mov_b32 s11, 0x20000
    s_and_b32 s93, s93, 0xffff
    s_mov_b32 s94, 0x100
    s_mov_b32 s95, 0x20000
    s_mov_b32 s87, 0
    s_cmp_lg_u32 s86, 0
    s_cbranch_scc1 L_reg_3
    s_lshl_b32 s97, s84, 4
    s_lshl_b32 s96, 1, s85
    v_mov_b32 v250, s96
    v_mov_b32 v251, 256
    s_mov_b64 exec, 1
    buffer_atomic_add_x2 v[250:251], off, s[92:95], s97 offset:64
    s_mov_b64 exec, -1
    s_mov_b32 s86, 1
L_reg_3:
    s_mov_b32 s16, s92
    s_mov_b32 s17, s93
    s_mov_b32 s18, s94
    s_mov_b32 s19, s95
    s_mov_b32 s88, s20
    s_mov_b32 s12, s60
    s_and_b32 s13, s61, 0xffff
    v_xor_b32 v15, 0, v14
    v_lshl_add_u32 v15, v15, 15, v8
    s_add_u32 s43, s41, 0x0
    s_add_u32 m0, s51, 0x8000
    s_nop 0
    buffer_load_dwordx4 v15, s[12:15], s43 offen lds
    s_add_u32 s43, s41, 0x8000
    s_add_u32 m0, s51, 0x9000
    s_nop 0
    buffer_load_dwordx4 v15, s[12:15], s43 offen lds
    s_add_u32 s43, s41, 0x100000
    s_add_u32 m0, s51, 0xa000
    s_nop 0
    buffer_load_dwordx4 v15, s[12:15], s43 offen lds
    s_add_u32 s43, s41, 0x108000
    s_add_u32 m0, s51, 0xb000
    s_nop 0
    buffer_load_dwordx4 v15, s[12:15], s43 offen lds
    s_add_u32 s43, s41, 0x200000
    s_add_u32 m0, s51, 0xc000
    s_nop 0
    buffer_load_dwordx4 v15, s[12:15], s43 offen lds
    s_add_u32 s43, s41, 0x208000
    s_add_u32 m0, s51, 0xd000
    s_nop 0
    buffer_load_dwordx4 v15, s[12:15], s43 offen lds
    s_add_u32 s43, s41, 0x300000
    s_add_u32 m0, s51, 0xe000
    s_nop 0
    buffer_load_dwordx4 v15, s[12:15], s43 offen lds
    s_add_u32 s43, s41, 0x308000
    s_add_u32 m0, s51, 0xf000
    s_nop 0
    buffer_load_dwordx4 v15, s[12:15], s43 offen lds
    v_xor_b32 v15, 2, v14
    v_lshl_add_u32 v15, v15, 15, v8
    s_add_u32 s43, s41, 0x0
    s_add_u32 m0, s51, 0x10000
    s_nop 0
    buffer_load_dwordx4 v15, s[12:15], s43 offen lds
    s_add_u32 s43, s41, 0x8000
    s_add_u32 m0, s51, 0x11000
    s_nop 0
    buffer_load_dwordx4 v15, s[12:15], s43 offen lds
    s_add_u32 s43, s41, 0x100000
    s_add_u32 m0, s51, 0x12000
    s_nop 0
    buffer_load_dwordx4 v15, s[12:15], s43 offen lds
    s_add_u32 s43, s41, 0x108000
    s_add_u32 m0, s51, 0x13000
    s_nop 0
    buffer_load_dwordx4 v15, s[12:15], s43 offen lds
    s_add_u32 s43, s41, 0x200000
    s_add_u32 m0, s51, 0x14000
    s_nop 0
    buffer_load_dwordx4 v15, s[12:15], s43 offen lds
    s_add_u32 s43, s41, 0x208000
    s_add_u32 m0, s51, 0x15000
    s_nop 0
    buffer_load_dwordx4 v15, s[12:15], s43 offen lds
    s_add_u32 s43, s41, 0x300000
    s_add_u32 m0, s51, 0x16000
    s_nop 0
    buffer_load_dwordx4 v15, s[12:15], s43 offen lds
    s_add_u32 s43, s41, 0x308000
    s_add_u32 m0, s51, 0x17000
    s_nop 0
    buffer_load_dwordx4 v15, s[12:15], s43 offen lds
    v_xor_b32 v15, 0, v14
    v_lshl_add_u32 v15, v15, 15, v8
    s_add_u32 s43, s41, 0x80000
    s_add_u32 m0, s51, 0x18000
    s_nop 0
    buffer_load_dwordx4 v15, s[12:15], s43 offen lds
    s_add_u32 s43, s41, 0x88000
    s_add_u32 m0, s51, 0x19000
    s_nop 0
    buffer_load_dwordx4 v15, s[12:15], s43 offen lds
    s_add_u32 s43, s41, 0x180000
    s_add_u32 m0, s51, 0x1a000
    s_nop 0
    buffer_load_dwordx4 v15, s[12:15], s43 offen lds
    s_add_u32 s43, s41, 0x188000
    s_add_u32 m0, s51, 0x1b000
    s_nop 0
    buffer_load_dwordx4 v15, s[12:15], s43 offen lds
    v_and_b32 v4, 2, v3
    v_cmp_ne_u32 vcc, 0, v4
    v_mov_b32 v4, 0x4444
    v_mov_b32 v5, 0xeeee
    v_cndmask_b32 v116, v4, v5, vcc
    v_lshrrev_b32 v5, 1, v2
    v_lshl_add_u32 v4, v6, 3, v5
    s_lshl_b32 s43, s21, 1
    v_add_u32 v4, s43, v4
    v_add_u32 v5, s20, v4
    v_and_b32 v5, 31, v5
    v_lshl_add_u32 v4, v4, 6, v5
    v_and_b32 v5, 1, v2
    v_lshl_add_u32 v4, v4, 1, v5
    v_and_b32 v5, 3, v3
    v_lshl_add_u32 v4, v4, 2, v5
    v_lshlrev_b32 v118, 4, v4
    v_and_b32 v4, 1, v2
    v_lshlrev_b32 v4, 2, v4
    v_and_b32 v7, 2, v2
    v_add_u32 v4, v4, v7
    v_and_b32 v7, 1, v6
    v_add_u32 v4, v4, v7
    v_lshl_add_u32 v4, v4, 2, v5
    v_lshlrev_b32 v4, 2, v4
    s_and_b32 s43, s21, 1
    s_lshl_b32 s43, s43, 12
    s_lshl_b32 s40, s20, 7
    s_add_u32 s43, s43, s40
    v_add_u32 v119, s43, v4
    v_sub_u32 v7, 0, v2
    v_and_b32 v7, 3, v7
    v_xor_b32 v7, v7, v6
    v_lshl_add_u32 v4, v2, 4, v7
    v_and_b32 v5, 3, v3
    v_lshl_add_u32 v4, v4, 2, v5
    s_add_u32 s43, s51, 16384
    v_lshl_add_u32 v120, v4, 2, s43
    v_sub_u32 v7, 0, v6
    v_and_b32 v7, 3, v7
    v_xor_b32 v7, v7, v2
    v_lshl_add_u32 v4, v3, 2, v7
    v_lshlrev_b32 v121, 4, v4
    v_and_b32 v5, 1, v3
    v_lshl_add_u32 v4, v6, 1, v5
    v_lshl_add_u32 v4, v2, 3, v4
    v_lshlrev_b32 v127, 4, v4
    v_and_or_b32 v122, v116, 8, v127
    s_lshl_b32 s43, s21, 13
    s_add_u32 s43, s43, 32768
    v_add_u32 v123, s43, v117
    v_add_u32 v124, 0x10000, v123
    s_mov_b32 s36, 0xcccccccc
    s_mov_b32 s37, 0xcccccccc
    s_mov_b32 s38, 0x00ff00ff
    s_mov_b32 s39, 0x00ff00ff
    s_mov_b32 s34, 0x3e0293ee
    s_mov_b32 s35, 0x49800000
    s_mov_b32 s50, 0x3f803f80
    v_and_b32 v5, 1, v2
    v_or_b32 v5, 0, v5
    v_xor_b32 v5, v5, v6
    v_and_b32 v7, 2, v5
    v_add_u32 v5, v5, v7
    v_lshlrev_b32 v5, 6, v5
    v_and_b32 v7, 3, v3
    v_lshl_add_u32 v7, v7, 4, v5
    s_lshl_b32 s43, s21, 2
    v_add_u32 v4, s43, v2
    v_lshl_add_u32 v10, v4, 10, v7
    v_and_b32 v5, 1, v2
    v_or_b32 v5, 2, v5
    v_xor_b32 v5, v5, v6
    v_and_b32 v7, 2, v5
    v_add_u32 v5, v5, v7
    v_lshlrev_b32 v5, 6, v5
    v_and_b32 v7, 3, v3
    v_lshl_add_u32 v7, v7, 4, v5
    s_lshl_b32 s43, s21, 2
    v_add_u32 v4, s43, v2
    v_lshl_add_u32 v9, v4, 10, v7
    v_and_b32 v5, 1, v2
    v_lshl_add_u32 v4, v5, 3, v6
    v_lshrrev_b32 v7, 1, v2
    v_lshl_add_u32 v4, v7, 5, v4
    v_lshlrev_b32 v4, 8, v4
    v_lshl_or_b32 v5, v5, 2, v6
    v_lshlrev_b32 v5, 5, v5
    s_lshl_b32 s43, s21, 6
    v_xor_b32 v5, s43, v5
    v_add_u32 v4, v4, v5
    v_and_b32 v5, 3, v3
    v_lshl_add_u32 v4, v5, 3, v4
    v_add_u32 v11, 32768, v4
    s_and_b32 s43, s21, 1
    s_lshl_b32 s43, s43, 12
    v_add_u32 v11, s43, v11
    v_and_b32 v5, 1, v2
    v_lshlrev_b32 v4, 4, v5
    v_lshl_add_u32 v4, v7, 2, v4
    v_and_b32 v7, 1, v6
    v_add_u32 v4, v4, v7
    s_lshl_b32 s43, s21, 5
    v_add_u32 v4, s43, v4
    v_lshlrev_b32 v4, 8, v4
    v_lshl_or_b32 v5, v5, 1, v7
    s_lshl_b32 s43, s21, 1
    s_and_b32 s43, s43, 3
    v_xor_b32 v5, s43, v5
    v_lshl_add_u32 v4, v5, 6, v4
    v_lshrrev_b32 v5, 1, v6
    v_lshl_add_u32 v4, v5, 5, v4
    v_and_b32 v5, 3, v3
    v_lshl_add_u32 v4, v5, 3, v4
    v_add_u32 v12, 32768, v4
    v_mul_u32_u24 v4, 0x0, v2
    v_lshl_add_u32 v4, v3, 7, v4
    s_lshl_b32 s43, s20, 13
    s_add_u32 s43, s43, s52
    s_add_u32 s43, s43, 0xf0000
    v_add_u32 v4, s43, v4
    v_and_b32 v5, 3, v3
    v_lshl_add_u32 v5, v5, 13, v119
    v_cmp_gt_u32 vcc, 2, v2
    s_nop 1
    v_cndmask_b32 v7, v5, v4, vcc
    v_mov_b32 v16, -1
    v_mov_b32 v17, -1
    v_mov_b32 v18, -1
    v_mov_b32 v19, -1
    s_lshl_b32 s43, s20, 13
    s_add_u32 s43, s43, 0x100000
    s_and_b32 s40, s21, 1
    s_lshl_b32 s40, s40, 12
    s_add_u32 s29, s43, s40
    s_add_u32 s43, s43, s52
    s_xor_b32 s40, s43, 0x0
    buffer_store_dwordx4 v[16:19], v117, s[8:11], s43 offen
    buffer_store_dwordx4 v[16:19], v117, s[8:11], s43 offen offset:1024
    s_mov_b32 s43, 0x12000
    buffer_store_dword v16, v119, s[8:11], s43 offen
    s_mov_b32 s43, 0x14000
    buffer_store_dword v16, v119, s[8:11], s43 offen
    s_mov_b32 s43, 0x16000
    buffer_store_dword v16, v119, s[8:11], s43 offen
    s_load_dwordx2 s[4:5], s[0:1], 8
    s_waitcnt lgkmcnt(0)
    s_and_b32 s5, s5, 0xffff
    s_mov_b32 s6, 8192
    s_mov_b32 s7, 0x20000
    v_and_b32 v20, 1, v2
    v_and_b32 v21, 1, v6
    v_lshl_add_u32 v20, v20, 1, v21
    v_lshlrev_b32 v20, 9, v20
    v_and_b32 v21, 3, v3
    v_lshl_add_u32 v20, v21, 4, v20
    v_and_b32 v21, 2, v2
    v_add_u32 v20, v20, v21
    s_and_b32 s43, s20, 1
    s_lshl_b32 s43, s43, 11
    s_bfe_u32 s40, s20, 0x20001
    s_lshl_b32 s40, s40, 7
    s_add_u32 s43, s43, s40
    s_and_b32 s40, s21, 1
    s_lshl_b32 s40, s40, 6
    s_add_u32 s43, s43, s40
    s_lshr_b32 s40, s20, 3
    s_lshl_b32 s40, s40, 2
    s_add_u32 s43, s43, s40
    v_add_u32 v20, s43, v20
    v_lshlrev_b32 v20, 1, v20
    buffer_load_dword v21, v20, s[4:7], 0 offen
    s_mov_b32 s57, 0
    s_lshl_b32 s43, s20, 13
    s_add_u32 s43, s43, s52
    s_add_u32 s30, s43, 0x1000000
    s_add_u32 s31, s43, 0x2000000
    s_lshr_b32 s43, s43, 1
    s_add_u32 s32, s43, 0x220000
    s_waitcnt vmcnt(18)
    s_barrier
    v_xor_b32 v13, 0x0, v11
    v_add_u32 v13, 0x0, v13
    ds_read_b64_tr_b16 v[80:81], v13
    ds_read_b64_tr_b16 v[82:83], v13 offset:1024
    ds_read_b64_tr_b16 v[84:85], v13 offset:16384
    ds_read_b64_tr_b16 v[86:87], v13 offset:17408
    v_xor_b32 v13, 0x20, v11
    v_add_u32 v13, 0x0, v13
    ds_read_b64_tr_b16 v[56:57], v13
    ds_read_b64_tr_b16 v[58:59], v13 offset:1024
    ds_read_b64_tr_b16 v[60:61], v13 offset:16384
    ds_read_b64_tr_b16 v[62:63], v13 offset:17408
    v_xor_b32 v13, 0x1000, v11
    v_add_u32 v13, 0x0, v13
    ds_read_b64_tr_b16 a[0:1], v13
    ds_read_b64_tr_b16 a[2:3], v13 offset:1024
    ds_read_b64_tr_b16 a[4:5], v13 offset:16384
    ds_read_b64_tr_b16 a[6:7], v13 offset:17408
    v_xor_b32 v13, 0x1020, v11
    v_add_u32 v13, 0x0, v13
    ds_read_b64_tr_b16 a[8:9], v13
    ds_read_b64_tr_b16 a[10:11], v13 offset:1024
    ds_read_b64_tr_b16 a[12:13], v13 offset:16384
    ds_read_b64_tr_b16 a[14:15], v13 offset:17408
    s_waitcnt lgkmcnt(0)
    s_barrier
    s_mov_b32 s4, s62
    s_and_b32 s5, s63, 0xffff
    s_lshr_b32 s6, 0x5ddddddd, s20
    s_and_b32 s6, s6, 1
    s_lshl_b32 s6, s6, 22
    s_mov_b32 s7, 0x20000
    v_add_u32 v23, 0, v22
    v_and_b32 v25, 448, v23
    v_add_u32 v23, v23, v25
    v_lshl_add_u32 v23, v23, 13, v31
    s_mov_b32 s43, 0x0
    buffer_load_dword v30, v23, s[4:7], s43 offen
    s_add_u32 s43, s41, 0x280000
    s_add_u32 m0, s51, 0x1c000
    s_nop 0
    buffer_load_dwordx4 v15, s[12:15], s43 offen lds
    s_add_u32 s43, s41, 0x288000
    s_add_u32 m0, s51, 0x1d000
    s_nop 0
    buffer_load_dwordx4 v15, s[12:15], s43 offen lds
    s_add_u32 s43, s41, 0x380000
    s_add_u32 m0, s51, 0x1e000
    s_nop 0
    buffer_load_dwordx4 v15, s[12:15], s43 offen lds
    s_add_u32 s43, s41, 0x388000
    s_add_u32 m0, s51, 0x1f000
    s_nop 0
    buffer_load_dwordx4 v15, s[12:15], s43 offen lds
    v_xor_b32 v15, 2, v14
    v_lshl_add_u32 v15, v15, 15, v8
    s_add_u32 s43, s41, 0x80000
    s_add_u32 m0, s51, 0x20000
    s_nop 0
    buffer_load_dwordx4 v15, s[12:15], s43 offen lds
    s_add_u32 s43, s41, 0x88000
    s_add_u32 m0, s51, 0x21000
    s_nop 0
    buffer_load_dwordx4 v15, s[12:15], s43 offen lds
    s_add_u32 s43, s41, 0x180000
    s_add_u32 m0, s51, 0x22000
    s_nop 0
    buffer_load_dwordx4 v15, s[12:15], s43 offen lds
    s_add_u32 s43, s41, 0x188000
    s_add_u32 m0, s51, 0x23000
    s_nop 0
    buffer_load_dwordx4 v15, s[12:15], s43 offen lds
    s_waitcnt vmcnt(19)
    s_barrier
    v_xor_b32 v13, 0x0, v11
    v_add_u32 v13, 0x8000, v13
    ds_read_b64_tr_b16 a[32:33], v13
    ds_read_b64_tr_b16 a[34:35], v13 offset:1024
    ds_read_b64_tr_b16 a[36:37], v13 offset:16384
    ds_read_b64_tr_b16 a[38:39], v13 offset:17408
    v_xor_b32 v13, 0x20, v11
    v_add_u32 v13, 0x8000, v13
    ds_read_b64_tr_b16 a[40:41], v13
    ds_read_b64_tr_b16 a[42:43], v13 offset:1024
    ds_read_b64_tr_b16 a[44:45], v13 offset:16384
    ds_read_b64_tr_b16 a[46:47], v13 offset:17408
    v_xor_b32 v13, 0x1000, v11
    v_add_u32 v13, 0x8000, v13
    ds_read_b64_tr_b16 a[64:65], v13
    ds_read_b64_tr_b16 a[66:67], v13 offset:1024
    ds_read_b64_tr_b16 a[68:69], v13 offset:16384
    ds_read_b64_tr_b16 a[70:71], v13 offset:17408
    v_xor_b32 v13, 0x1020, v11
    v_add_u32 v13, 0x8000, v13
    ds_read_b64_tr_b16 a[72:73], v13
    ds_read_b64_tr_b16 a[74:75], v13 offset:1024
    ds_read_b64_tr_b16 a[76:77], v13 offset:16384
    ds_read_b64_tr_b16 a[78:79], v13 offset:17408
    s_waitcnt lgkmcnt(0)
    s_barrier
    s_add_u32 s43, s41, 0x280000
    s_add_u32 m0, s51, 0x24000
    s_nop 0
    buffer_load_dwordx4 v15, s[12:15], s43 offen lds
    s_add_u32 s43, s41, 0x288000
    s_add_u32 m0, s51, 0x25000
    s_nop 0
    buffer_load_dwordx4 v15, s[12:15], s43 offen lds
    s_add_u32 s43, s41, 0x380000
    s_add_u32 m0, s51, 0x26000
    s_nop 0
    buffer_load_dwordx4 v15, s[12:15], s43 offen lds
    s_add_u32 s43, s41, 0x388000
    s_add_u32 m0, s51, 0x27000
    s_nop 0
    buffer_load_dwordx4 v15, s[12:15], s43 offen lds
    s_mov_b32 s12, s62
    s_and_b32 s13, s63, 0xffff
    v_xor_b32 v15, 0, v14
    v_lshl_add_u32 v15, v15, 15, v8
    s_add_u32 s43, s41, 0x0
    s_add_u32 m0, s51, 0x8000
    s_nop 0
    buffer_load_dwordx4 v15, s[12:15], s43 offen lds
    s_add_u32 s43, s41, 0x8000
    s_add_u32 m0, s51, 0x9000
    s_nop 0
    buffer_load_dwordx4 v15, s[12:15], s43 offen lds
    s_add_u32 s43, s41, 0x100000
    s_add_u32 m0, s51, 0xa000
    s_nop 0
    buffer_load_dwordx4 v15, s[12:15], s43 offen lds
    s_add_u32 s43, s41, 0x108000
    s_add_u32 m0, s51, 0xb000
    s_nop 0
    buffer_load_dwordx4 v15, s[12:15], s43 offen lds
    s_waitcnt vmcnt(12)
    s_barrier
    v_xor_b32 v13, 0x0, v11
    v_add_u32 v13, 0x10000, v13
    ds_read_b64_tr_b16 v[88:89], v13
    ds_read_b64_tr_b16 v[90:91], v13 offset:1024
    ds_read_b64_tr_b16 v[92:93], v13 offset:16384
    ds_read_b64_tr_b16 v[94:95], v13 offset:17408
    v_xor_b32 v13, 0x20, v11
    v_add_u32 v13, 0x10000, v13
    ds_read_b64_tr_b16 v[96:97], v13
    ds_read_b64_tr_b16 v[98:99], v13 offset:1024
    ds_read_b64_tr_b16 v[100:101], v13 offset:16384
    ds_read_b64_tr_b16 v[102:103], v13 offset:17408
    v_xor_b32 v13, 0x1000, v11
    v_add_u32 v13, 0x10000, v13
    ds_read_b64_tr_b16 a[16:17], v13
    ds_read_b64_tr_b16 a[18:19], v13 offset:1024
    ds_read_b64_tr_b16 a[20:21], v13 offset:16384
    ds_read_b64_tr_b16 a[22:23], v13 offset:17408
    v_xor_b32 v13, 0x1020, v11
    v_add_u32 v13, 0x10000, v13
    ds_read_b64_tr_b16 a[24:25], v13
    ds_read_b64_tr_b16 a[26:27], v13 offset:1024
    ds_read_b64_tr_b16 a[28:29], v13 offset:16384
    ds_read_b64_tr_b16 a[30:31], v13 offset:17408
    s_waitcnt lgkmcnt(0)
    s_barrier
    s_add_u32 s43, s41, 0x200000
    s_add_u32 m0, s51, 0xc000
    s_nop 0
    buffer_load_dwordx4 v15, s[12:15], s43 offen lds
    s_add_u32 s43, s41, 0x208000
    s_add_u32 m0, s51, 0xd000
    s_nop 0
    buffer_load_dwordx4 v15, s[12:15], s43 offen lds
    s_add_u32 s43, s41, 0x300000
    s_add_u32 m0, s51, 0xe000
    s_nop 0
    buffer_load_dwordx4 v15, s[12:15], s43 offen lds
    s_add_u32 s43, s41, 0x308000
    s_add_u32 m0, s51, 0xf000
    s_nop 0
    buffer_load_dwordx4 v15, s[12:15], s43 offen lds
    v_xor_b32 v15, 2, v14
    v_lshl_add_u32 v15, v15, 15, v8
    s_add_u32 s43, s41, 0x0
    s_add_u32 m0, s51, 0x10000
    s_nop 0
    buffer_load_dwordx4 v15, s[12:15], s43 offen lds
    s_add_u32 s43, s41, 0x8000
    s_add_u32 m0, s51, 0x11000
    s_nop 0
    buffer_load_dwordx4 v15, s[12:15], s43 offen lds
    s_add_u32 s43, s41, 0x100000
    s_add_u32 m0, s51, 0x12000
    s_nop 0
    buffer_load_dwordx4 v15, s[12:15], s43 offen lds
    s_add_u32 s43, s41, 0x108000
    s_add_u32 m0, s51, 0x13000
    s_nop 0
    buffer_load_dwordx4 v15, s[12:15], s43 offen lds
    s_waitcnt vmcnt(12)
    s_barrier
    v_xor_b32 v13, 0x0, v11
    v_add_u32 v13, 0x18000, v13
    ds_read_b64_tr_b16 a[48:49], v13
    ds_read_b64_tr_b16 a[50:51], v13 offset:1024
    ds_read_b64_tr_b16 a[52:53], v13 offset:16384
    ds_read_b64_tr_b16 a[54:55], v13 offset:17408
    v_xor_b32 v13, 0x20, v11
    v_add_u32 v13, 0x18000, v13
    ds_read_b64_tr_b16 a[56:57], v13
    ds_read_b64_tr_b16 a[58:59], v13 offset:1024
    ds_read_b64_tr_b16 a[60:61], v13 offset:16384
    ds_read_b64_tr_b16 a[62:63], v13 offset:17408
    v_xor_b32 v13, 0x1000, v11
    v_add_u32 v13, 0x18000, v13
    ds_read_b64_tr_b16 a[80:81], v13
    ds_read_b64_tr_b16 a[82:83], v13 offset:1024
    ds_read_b64_tr_b16 a[84:85], v13 offset:16384
    ds_read_b64_tr_b16 a[86:87], v13 offset:17408
    v_xor_b32 v13, 0x1020, v11
    v_add_u32 v13, 0x18000, v13
    ds_read_b64_tr_b16 a[88:89], v13
    ds_read_b64_tr_b16 a[90:91], v13 offset:1024
    ds_read_b64_tr_b16 a[92:93], v13 offset:16384
    ds_read_b64_tr_b16 a[94:95], v13 offset:17408
    s_waitcnt lgkmcnt(0)
    s_barrier
    s_add_u32 s43, s41, 0x200000
    s_add_u32 m0, s51, 0x14000
    s_nop 0
    buffer_load_dwordx4 v15, s[12:15], s43 offen lds
    s_add_u32 s43, s41, 0x208000
    s_add_u32 m0, s51, 0x15000
    s_nop 0
    buffer_load_dwordx4 v15, s[12:15], s43 offen lds
    s_add_u32 s43, s41, 0x300000
    s_add_u32 m0, s51, 0x16000
    s_nop 0
    buffer_load_dwordx4 v15, s[12:15], s43 offen lds
    s_add_u32 s43, s41, 0x308000
    s_add_u32 m0, s51, 0x17000
    s_nop 0
    buffer_load_dwordx4 v15, s[12:15], s43 offen lds
    v_xor_b32 v15, 0, v14
    v_lshl_add_u32 v15, v15, 15, v8
    s_add_u32 s43, s41, 0x80000
    s_add_u32 m0, s51, 0x18000
    s_nop 0
    buffer_load_dwordx4 v15, s[12:15], s43 offen lds
    s_add_u32 s43, s41, 0x88000
    s_add_u32 m0, s51, 0x19000
    s_nop 0
    buffer_load_dwordx4 v15, s[12:15], s43 offen lds
    s_add_u32 s43, s41, 0x180000
    s_add_u32 m0, s51, 0x1a000
    s_nop 0
    buffer_load_dwordx4 v15, s[12:15], s43 offen lds
    s_add_u32 s43, s41, 0x188000
    s_add_u32 m0, s51, 0x1b000
    s_nop 0
    buffer_load_dwordx4 v15, s[12:15], s43 offen lds
    s_waitcnt vmcnt(12)
    v_min_u32 v21, 0xfffffffe, v21
    s_mov_b32 s43, 0x10000
    s_mov_b64 exec, s[38:39]
    buffer_store_dword v21, v119, s[8:11], s43 offen
    s_mov_b64 exec, -1
    s_barrier
    v_xor_b32 v13, 0x0, v11
    v_add_u32 v13, 0x0, v13
    ds_read_b64_tr_b16 v[64:65], v13
    ds_read_b64_tr_b16 v[66:67], v13 offset:1024
    ds_read_b64_tr_b16 v[68:69], v13 offset:16384
    ds_read_b64_tr_b16 v[70:71], v13 offset:17408
    v_xor_b32 v13, 0x20, v11
    v_add_u32 v13, 0x0, v13
    ds_read_b64_tr_b16 v[72:73], v13
    ds_read_b64_tr_b16 v[74:75], v13 offset:1024
    ds_read_b64_tr_b16 v[76:77], v13 offset:16384
    ds_read_b64_tr_b16 v[78:79], v13 offset:17408
    v_xor_b32 v13, 0x1000, v11
    v_add_u32 v13, 0x0, v13
    ds_read_b64_tr_b16 a[96:97], v13
    ds_read_b64_tr_b16 a[98:99], v13 offset:1024
    ds_read_b64_tr_b16 a[100:101], v13 offset:16384
    ds_read_b64_tr_b16 a[102:103], v13 offset:17408
    v_xor_b32 v13, 0x1020, v11
    v_add_u32 v13, 0x0, v13
    ds_read_b64_tr_b16 a[104:105], v13
    ds_read_b64_tr_b16 a[106:107], v13 offset:1024
    ds_read_b64_tr_b16 a[108:109], v13 offset:16384
    ds_read_b64_tr_b16 a[110:111], v13 offset:17408
    s_waitcnt lgkmcnt(0)
    s_barrier
    s_add_u32 s43, s41, 0x280000
    s_add_u32 m0, s51, 0x1c000
    s_nop 0
    buffer_load_dwordx4 v15, s[12:15], s43 offen lds
    s_add_u32 s43, s41, 0x288000
    s_add_u32 m0, s51, 0x1d000
    s_nop 0
    buffer_load_dwordx4 v15, s[12:15], s43 offen lds
    s_add_u32 s43, s41, 0x380000
    s_add_u32 m0, s51, 0x1e000
    s_nop 0
    buffer_load_dwordx4 v15, s[12:15], s43 offen lds
    s_add_u32 s43, s41, 0x388000
    s_add_u32 m0, s51, 0x1f000
    s_nop 0
    buffer_load_dwordx4 v15, s[12:15], s43 offen lds
    v_xor_b32 v15, 2, v14
    v_lshl_add_u32 v15, v15, 15, v8
    s_add_u32 s43, s41, 0x80000
    s_add_u32 m0, s51, 0x20000
    s_nop 0
    buffer_load_dwordx4 v15, s[12:15], s43 offen lds
    s_add_u32 s43, s41, 0x88000
    s_add_u32 m0, s51, 0x21000
    s_nop 0
    buffer_load_dwordx4 v15, s[12:15], s43 offen lds
    s_add_u32 s43, s41, 0x180000
    s_add_u32 m0, s51, 0x22000
    s_nop 0
    buffer_load_dwordx4 v15, s[12:15], s43 offen lds
    s_add_u32 s43, s41, 0x188000
    s_add_u32 m0, s51, 0x23000
    s_nop 0
    buffer_load_dwordx4 v15, s[12:15], s43 offen lds
    s_waitcnt vmcnt(12)
    s_barrier
    v_xor_b32 v13, 0x0, v11
    v_add_u32 v13, 0x8000, v13
    ds_read_b64_tr_b16 a[128:129], v13
    ds_read_b64_tr_b16 a[130:131], v13 offset:1024
    ds_read_b64_tr_b16 a[132:133], v13 offset:16384
    ds_read_b64_tr_b16 a[134:135], v13 offset:17408
    v_xor_b32 v13, 0x20, v11
    v_add_u32 v13, 0x8000, v13
    ds_read_b64_tr_b16 a[136:137], v13
    ds_read_b64_tr_b16 a[138:139], v13 offset:1024
    ds_read_b64_tr_b16 a[140:141], v13 offset:16384
    ds_read_b64_tr_b16 a[142:143], v13 offset:17408
    v_xor_b32 v13, 0x1000, v11
    v_add_u32 v13, 0x8000, v13
    ds_read_b64_tr_b16 a[160:161], v13
    ds_read_b64_tr_b16 a[162:163], v13 offset:1024
    ds_read_b64_tr_b16 a[164:165], v13 offset:16384
    ds_read_b64_tr_b16 a[166:167], v13 offset:17408
    v_xor_b32 v13, 0x1020, v11
    v_add_u32 v13, 0x8000, v13
    ds_read_b64_tr_b16 a[168:169], v13
    ds_read_b64_tr_b16 a[170:171], v13 offset:1024
    ds_read_b64_tr_b16 a[172:173], v13 offset:16384
    ds_read_b64_tr_b16 a[174:175], v13 offset:17408
    s_waitcnt lgkmcnt(0)
    s_barrier
    buffer_load_dwordx2 v[26:27], off, s[16:19], 0 offset:36 sc1
    s_add_u32 s43, s41, 0x280000
    s_add_u32 m0, s51, 0x24000
    s_nop 0
    buffer_load_dwordx4 v15, s[12:15], s43 offen lds
    s_add_u32 s43, s41, 0x288000
    s_add_u32 m0, s51, 0x25000
    s_nop 0
    buffer_load_dwordx4 v15, s[12:15], s43 offen lds
    s_add_u32 s43, s41, 0x380000
    s_add_u32 m0, s51, 0x26000
    s_nop 0
    buffer_load_dwordx4 v15, s[12:15], s43 offen lds
    s_add_u32 s43, s41, 0x388000
    s_add_u32 m0, s51, 0x27000
    s_nop 0
    buffer_load_dwordx4 v15, s[12:15], s43 offen lds
    s_mov_b32 s12, s64
    s_and_b32 s13, s65, 0xffff
    v_xor_b32 v15, 0, v14
    v_lshl_add_u32 v15, v15, 15, v8
    s_add_u32 s43, s41, 0x0
    s_add_u32 m0, s51, 0x8000
    s_nop 0
    buffer_load_dwordx4 v15, s[12:15], s43 offen lds
    s_add_u32 s43, s41, 0x8000
    s_add_u32 m0, s51, 0x9000
    s_nop 0
    buffer_load_dwordx4 v15, s[12:15], s43 offen lds
    s_add_u32 s43, s41, 0x100000
    s_add_u32 m0, s51, 0xa000
    s_nop 0
    buffer_load_dwordx4 v15, s[12:15], s43 offen lds
    s_add_u32 s43, s41, 0x108000
    s_add_u32 m0, s51, 0xb000
    s_nop 0
    buffer_load_dwordx4 v15, s[12:15], s43 offen lds
    s_waitcnt vmcnt(13)
    s_barrier
    v_xor_b32 v13, 0x0, v11
    v_add_u32 v13, 0x10000, v13
    ds_read_b64_tr_b16 v[104:105], v13
    ds_read_b64_tr_b16 v[106:107], v13 offset:1024
    ds_read_b64_tr_b16 v[108:109], v13 offset:16384
    ds_read_b64_tr_b16 v[110:111], v13 offset:17408
    v_xor_b32 v13, 0x20, v11
    v_add_u32 v13, 0x10000, v13
    ds_read_b64_tr_b16 v[32:33], v13
    ds_read_b64_tr_b16 v[34:35], v13 offset:1024
    ds_read_b64_tr_b16 v[36:37], v13 offset:16384
    ds_read_b64_tr_b16 v[38:39], v13 offset:17408
    v_xor_b32 v13, 0x1000, v11
    v_add_u32 v13, 0x10000, v13
    ds_read_b64_tr_b16 a[112:113], v13
    ds_read_b64_tr_b16 a[114:115], v13 offset:1024
    ds_read_b64_tr_b16 a[116:117], v13 offset:16384
    ds_read_b64_tr_b16 a[118:119], v13 offset:17408
    v_xor_b32 v13, 0x1020, v11
    v_add_u32 v13, 0x10000, v13
    ds_read_b64_tr_b16 a[120:121], v13
    ds_read_b64_tr_b16 a[122:123], v13 offset:1024
    ds_read_b64_tr_b16 a[124:125], v13 offset:16384
    ds_read_b64_tr_b16 a[126:127], v13 offset:17408
    s_waitcnt lgkmcnt(0)
    s_barrier
    s_add_u32 s43, s41, 0x200000
    s_add_u32 m0, s51, 0xc000
    s_nop 0
    buffer_load_dwordx4 v15, s[12:15], s43 offen lds
    s_add_u32 s43, s41, 0x208000
    s_add_u32 m0, s51, 0xd000
    s_nop 0
    buffer_load_dwordx4 v15, s[12:15], s43 offen lds
    s_add_u32 s43, s41, 0x300000
    s_add_u32 m0, s51, 0xe000
    s_nop 0
    buffer_load_dwordx4 v15, s[12:15], s43 offen lds
    s_add_u32 s43, s41, 0x308000
    s_add_u32 m0, s51, 0xf000
    s_nop 0
    buffer_load_dwordx4 v15, s[12:15], s43 offen lds
    v_xor_b32 v15, 2, v14
    v_lshl_add_u32 v15, v15, 15, v8
    s_add_u32 s43, s41, 0x0
    s_add_u32 m0, s51, 0x10000
    s_nop 0
    buffer_load_dwordx4 v15, s[12:15], s43 offen lds
    s_add_u32 s43, s41, 0x8000
    s_add_u32 m0, s51, 0x11000
    s_nop 0
    buffer_load_dwordx4 v15, s[12:15], s43 offen lds
    s_add_u32 s43, s41, 0x100000
    s_add_u32 m0, s51, 0x12000
    s_nop 0
    buffer_load_dwordx4 v15, s[12:15], s43 offen lds
    s_add_u32 s43, s41, 0x108000
    s_add_u32 m0, s51, 0x13000
    s_nop 0
    buffer_load_dwordx4 v15, s[12:15], s43 offen lds
    s_waitcnt vmcnt(12)
    s_barrier
    v_xor_b32 v13, 0x0, v11
    v_add_u32 v13, 0x18000, v13
    ds_read_b64_tr_b16 a[144:145], v13
    ds_read_b64_tr_b16 a[146:147], v13 offset:1024
    ds_read_b64_tr_b16 a[148:149], v13 offset:16384
    ds_read_b64_tr_b16 a[150:151], v13 offset:17408
    v_xor_b32 v13, 0x20, v11
    v_add_u32 v13, 0x18000, v13
    ds_read_b64_tr_b16 a[152:153], v13
    ds_read_b64_tr_b16 a[154:155], v13 offset:1024
    ds_read_b64_tr_b16 a[156:157], v13 offset:16384
    ds_read_b64_tr_b16 a[158:159], v13 offset:17408
    v_xor_b32 v13, 0x1000, v11
    v_add_u32 v13, 0x18000, v13
    ds_read_b64_tr_b16 a[176:177], v13
    ds_read_b64_tr_b16 a[178:179], v13 offset:1024
    ds_read_b64_tr_b16 a[180:181], v13 offset:16384
    ds_read_b64_tr_b16 a[182:183], v13 offset:17408
    v_xor_b32 v13, 0x1020, v11
    v_add_u32 v13, 0x18000, v13
    ds_read_b64_tr_b16 a[184:185], v13
    ds_read_b64_tr_b16 a[186:187], v13 offset:1024
    ds_read_b64_tr_b16 a[188:189], v13 offset:16384
    ds_read_b64_tr_b16 a[190:191], v13 offset:17408
    s_waitcnt lgkmcnt(0)
    s_barrier
    s_add_u32 s43, s41, 0x200000
    s_add_u32 m0, s51, 0x14000
    s_nop 0
    buffer_load_dwordx4 v15, s[12:15], s43 offen lds
    s_add_u32 s43, s41, 0x208000
    s_add_u32 m0, s51, 0x15000
    s_nop 0
    buffer_load_dwordx4 v15, s[12:15], s43 offen lds
    s_add_u32 s43, s41, 0x300000
    s_add_u32 m0, s51, 0x16000
    s_nop 0
    buffer_load_dwordx4 v15, s[12:15], s43 offen lds
    s_add_u32 s43, s41, 0x308000
    s_add_u32 m0, s51, 0x17000
    s_nop 0
    buffer_load_dwordx4 v15, s[12:15], s43 offen lds
    s_mov_b32 s12, s66
    s_and_b32 s13, s67, 0xffff
    s_add_u32 s43, s42, 0x80
    s_add_u32 m0, s51, 0x18000
    s_nop 0
    buffer_load_dwordx4 v10, s[12:15], s43 offen lds
    s_add_u32 s43, s42, 0x4080
    s_add_u32 m0, s51, 0x19000
    s_nop 0
    buffer_load_dwordx4 v9, s[12:15], s43 offen lds
    s_add_u32 s43, s42, 0x8080
    s_add_u32 m0, s51, 0x1a000
    s_nop 0
    buffer_load_dwordx4 v10, s[12:15], s43 offen lds
    s_add_u32 s43, s42, 0xc080
    s_add_u32 m0, s51, 0x1b000
    s_nop 0
    buffer_load_dwordx4 v9, s[12:15], s43 offen lds
    s_waitcnt vmcnt(12)
    s_barrier
    v_xor_b32 v13, 0x0, v11
    v_add_u32 v13, 0x0, v13
    ds_read_b64_tr_b16 a[192:193], v13
    ds_read_b64_tr_b16 a[194:195], v13 offset:1024
    ds_read_b64_tr_b16 a[196:197], v13 offset:16384
    ds_read_b64_tr_b16 a[198:199], v13 offset:17408
    v_xor_b32 v13, 0x20, v11
    v_add_u32 v13, 0x0, v13
    ds_read_b64_tr_b16 a[200:201], v13
    ds_read_b64_tr_b16 a[202:203], v13 offset:1024
    ds_read_b64_tr_b16 a[204:205], v13 offset:16384
    ds_read_b64_tr_b16 a[206:207], v13 offset:17408
    v_xor_b32 v13, 0x1000, v11
    v_add_u32 v13, 0x0, v13
    ds_read_b64_tr_b16 a[224:225], v13
    ds_read_b64_tr_b16 a[226:227], v13 offset:1024
    ds_read_b64_tr_b16 a[228:229], v13 offset:16384
    ds_read_b64_tr_b16 a[230:231], v13 offset:17408
    v_xor_b32 v13, 0x1020, v11
    v_add_u32 v13, 0x0, v13
    ds_read_b64_tr_b16 a[232:233], v13
    ds_read_b64_tr_b16 a[234:235], v13 offset:1024
    ds_read_b64_tr_b16 a[236:237], v13 offset:16384
    ds_read_b64_tr_b16 a[238:239], v13 offset:17408
    s_waitcnt lgkmcnt(0)
    s_barrier
    s_add_u32 s43, s42, 0x10280
    s_add_u32 m0, s51, 0x1c000
    s_nop 0
    buffer_load_dwordx4 v10, s[12:15], s43 offen lds
    s_add_u32 s43, s42, 0x14280
    s_add_u32 m0, s51, 0x1d000
    s_nop 0
    buffer_load_dwordx4 v9, s[12:15], s43 offen lds
    s_add_u32 s43, s42, 0x18280
    s_add_u32 m0, s51, 0x1e000
    s_nop 0
    buffer_load_dwordx4 v10, s[12:15], s43 offen lds
    s_add_u32 s43, s42, 0x1c280
    s_add_u32 m0, s51, 0x1f000
    s_nop 0
    buffer_load_dwordx4 v9, s[12:15], s43 offen lds
    s_add_u32 s43, s42, 0x10080
    s_add_u32 m0, s51, 0x20000
    s_nop 0
    buffer_load_dwordx4 v10, s[12:15], s43 offen lds
    s_add_u32 s43, s42, 0x14080
    s_add_u32 m0, s51, 0x21000
    s_nop 0
    buffer_load_dwordx4 v9, s[12:15], s43 offen lds
    s_add_u32 s43, s42, 0x18080
    s_add_u32 m0, s51, 0x22000
    s_nop 0
    buffer_load_dwordx4 v10, s[12:15], s43 offen lds
    s_add_u32 s43, s42, 0x1c080
    s_add_u32 m0, s51, 0x23000
    s_nop 0
    buffer_load_dwordx4 v9, s[12:15], s43 offen lds
    s_waitcnt vmcnt(12)
    v_readfirstlane_b32 s57, v26
    v_readfirstlane_b32 s43, v27
    s_nop 0
    s_cmp_lg_u32 s43, 0
    s_cselect_b32 s57, s57, 0
    s_barrier
    s_cmp_lg_u32 s21, 0
    s_cbranch_scc1 L_arr_4
    v_mov_b32 v23, 1
    s_mov_b64 exec, 1
    buffer_atomic_add v23, off, s[16:19], 0 offset:4
    s_mov_b64 exec, -1
L_arr_4:
    v_xor_b32 v13, 0x0, v11
    v_add_u32 v13, 0x8000, v13
    ds_read_b64_tr_b16 v[128:129], v13
    ds_read_b64_tr_b16 v[130:131], v13 offset:1024
    ds_read_b64_tr_b16 v[132:133], v13 offset:16384
    ds_read_b64_tr_b16 v[134:135], v13 offset:17408
    v_xor_b32 v13, 0x20, v11
    v_add_u32 v13, 0x8000, v13
    ds_read_b64_tr_b16 v[136:137], v13
    ds_read_b64_tr_b16 v[138:139], v13 offset:1024
    ds_read_b64_tr_b16 v[140:141], v13 offset:16384
    ds_read_b64_tr_b16 v[142:143], v13 offset:17408
    v_xor_b32 v13, 0x1000, v11
    v_add_u32 v13, 0x8000, v13
    ds_read_b64_tr_b16 v[160:161], v13
    ds_read_b64_tr_b16 v[162:163], v13 offset:1024
    ds_read_b64_tr_b16 v[164:165], v13 offset:16384
    ds_read_b64_tr_b16 v[166:167], v13 offset:17408
    v_xor_b32 v13, 0x1020, v11
    v_add_u32 v13, 0x8000, v13
    ds_read_b64_tr_b16 v[168:169], v13
    ds_read_b64_tr_b16 v[170:171], v13 offset:1024
    ds_read_b64_tr_b16 v[172:173], v13 offset:16384
    ds_read_b64_tr_b16 v[174:175], v13 offset:17408
    s_waitcnt lgkmcnt(0)
    s_barrier
    s_add_u32 s43, s42, 0x280
    s_add_u32 m0, s51, 0x24000
    s_nop 0
    buffer_load_dwordx4 v10, s[12:15], s43 offen lds
    s_add_u32 s43, s42, 0x4280
    s_add_u32 m0, s51, 0x25000
    s_nop 0
    buffer_load_dwordx4 v9, s[12:15], s43 offen lds
    s_add_u32 s43, s42, 0x8280
    s_add_u32 m0, s51, 0x26000
    s_nop 0
    buffer_load_dwordx4 v10, s[12:15], s43 offen lds
    s_add_u32 s43, s42, 0xc280
    s_add_u32 m0, s51, 0x27000
    s_nop 0
    buffer_load_dwordx4 v9, s[12:15], s43 offen lds
    s_mov_b32 s12, s64
    s_and_b32 s13, s65, 0xffff
    v_xor_b32 v15, 0, v14
    v_lshl_add_u32 v15, v15, 15, v8
    s_add_u32 s43, s41, 0x80000
    s_add_u32 m0, s51, 0x8000
    s_nop 0
    buffer_load_dwordx4 v15, s[12:15], s43 offen lds
    s_add_u32 s43, s41, 0x88000
    s_add_u32 m0, s51, 0x9000
    s_nop 0
    buffer_load_dwordx4 v15, s[12:15], s43 offen lds
    s_add_u32 s43, s41, 0x180000
    s_add_u32 m0, s51, 0xa000
    s_nop 0
    buffer_load_dwordx4 v15, s[12:15], s43 offen lds
    s_add_u32 s43, s41, 0x188000
    s_add_u32 m0, s51, 0xb000
    s_nop 0
    buffer_load_dwordx4 v15, s[12:15], s43 offen lds
    s_waitcnt vmcnt(12)
    s_barrier
    v_xor_b32 v13, 0x0, v12
    v_add_u32 v13, 0x10000, v13
    ds_read_b64_tr_b16 v[192:193], v13
    ds_read_b64_tr_b16 v[194:195], v13 offset:512
    ds_read_b64_tr_b16 v[196:197], v13 offset:2048
    ds_read_b64_tr_b16 v[198:199], v13 offset:2560
    v_xor_b32 v13, 0x2000, v12
    v_add_u32 v13, 0x10000, v13
    ds_read_b64_tr_b16 v[200:201], v13
    ds_read_b64_tr_b16 v[202:203], v13 offset:512
    ds_read_b64_tr_b16 v[204:205], v13 offset:2048
    ds_read_b64_tr_b16 v[206:207], v13 offset:2560
    v_xor_b32 v13, 0x40, v12
    v_add_u32 v13, 0x10000, v13
    ds_read_b64_tr_b16 v[224:225], v13
    ds_read_b64_tr_b16 v[226:227], v13 offset:512
    ds_read_b64_tr_b16 v[228:229], v13 offset:2048
    ds_read_b64_tr_b16 v[230:231], v13 offset:2560
    v_xor_b32 v13, 0x2040, v12
    v_add_u32 v13, 0x10000, v13
    ds_read_b64_tr_b16 v[232:233], v13
    ds_read_b64_tr_b16 v[234:235], v13 offset:512
    ds_read_b64_tr_b16 v[236:237], v13 offset:2048
    ds_read_b64_tr_b16 v[238:239], v13 offset:2560
    s_waitcnt lgkmcnt(0)
    s_barrier
    s_add_u32 s43, s41, 0x280000
    s_add_u32 m0, s51, 0xc000
    s_nop 0
    buffer_load_dwordx4 v15, s[12:15], s43 offen lds
    s_add_u32 s43, s41, 0x288000
    s_add_u32 m0, s51, 0xd000
    s_nop 0
    buffer_load_dwordx4 v15, s[12:15], s43 offen lds
    s_add_u32 s43, s41, 0x380000
    s_add_u32 m0, s51, 0xe000
    s_nop 0
    buffer_load_dwordx4 v15, s[12:15], s43 offen lds
    s_add_u32 s43, s41, 0x388000
    s_add_u32 m0, s51, 0xf000
    s_nop 0
    buffer_load_dwordx4 v15, s[12:15], s43 offen lds
    v_xor_b32 v15, 2, v14
    v_lshl_add_u32 v15, v15, 15, v8
    s_add_u32 s43, s41, 0x80000
    s_add_u32 m0, s51, 0x10000
    s_nop 0
    buffer_load_dwordx4 v15, s[12:15], s43 offen lds
    s_add_u32 s43, s41, 0x88000
    s_add_u32 m0, s51, 0x11000
    s_nop 0
    buffer_load_dwordx4 v15, s[12:15], s43 offen lds
    s_add_u32 s43, s41, 0x180000
    s_add_u32 m0, s51, 0x12000
    s_nop 0
    buffer_load_dwordx4 v15, s[12:15], s43 offen lds
    s_add_u32 s43, s41, 0x188000
    s_add_u32 m0, s51, 0x13000
    s_nop 0
    buffer_load_dwordx4 v15, s[12:15], s43 offen lds
    s_waitcnt vmcnt(12)
    s_barrier
    v_xor_b32 v13, 0x0, v12
    v_add_u32 v13, 0x18000, v13
    ds_read_b64_tr_b16 v[208:209], v13
    ds_read_b64_tr_b16 v[210:211], v13 offset:512
    ds_read_b64_tr_b16 v[212:213], v13 offset:2048
    ds_read_b64_tr_b16 v[214:215], v13 offset:2560
    v_xor_b32 v13, 0x2000, v12
    v_add_u32 v13, 0x18000, v13
    ds_read_b64_tr_b16 v[216:217], v13
    ds_read_b64_tr_b16 v[218:219], v13 offset:512
    ds_read_b64_tr_b16 v[220:221], v13 offset:2048
    ds_read_b64_tr_b16 v[222:223], v13 offset:2560
    v_xor_b32 v13, 0x40, v12
    v_add_u32 v13, 0x18000, v13
    ds_read_b64_tr_b16 v[240:241], v13
    ds_read_b64_tr_b16 v[242:243], v13 offset:512
    ds_read_b64_tr_b16 v[244:245], v13 offset:2048
    ds_read_b64_tr_b16 v[246:247], v13 offset:2560
    v_xor_b32 v13, 0x2040, v12
    v_add_u32 v13, 0x18000, v13
    ds_read_b64_tr_b16 v[248:249], v13
    ds_read_b64_tr_b16 v[250:251], v13 offset:512
    ds_read_b64_tr_b16 v[252:253], v13 offset:2048
    ds_read_b64_tr_b16 v[254:255], v13 offset:2560
    s_waitcnt lgkmcnt(0)
    s_barrier
    s_add_u32 s43, s41, 0x280000
    s_add_u32 m0, s51, 0x14000
    s_nop 0
    buffer_load_dwordx4 v15, s[12:15], s43 offen lds
    s_add_u32 s43, s41, 0x288000
    s_add_u32 m0, s51, 0x15000
    s_nop 0
    buffer_load_dwordx4 v15, s[12:15], s43 offen lds
    s_add_u32 s43, s41, 0x380000
    s_add_u32 m0, s51, 0x16000
    s_nop 0
    buffer_load_dwordx4 v15, s[12:15], s43 offen lds
    s_add_u32 s43, s41, 0x388000
    s_add_u32 m0, s51, 0x17000
    s_nop 0
    buffer_load_dwordx4 v15, s[12:15], s43 offen lds
    ds_write_b128 v124, v[192:195]
    ds_write_b128 v124, v[196:199] offset:1024
    ds_write_b128 v124, v[200:203] offset:2048
    ds_write_b128 v124, v[204:207] offset:3072
    ds_write_b128 v124, v[208:211] offset:4096
    ds_write_b128 v124, v[212:215] offset:5120
    ds_write_b128 v124, v[216:219] offset:6144
    ds_write_b128 v124, v[220:223] offset:7168
    ds_write_b128 v124, v[224:227] offset:32768
    ds_write_b128 v124, v[228:231] offset:33792
    ds_write_b128 v124, v[232:235] offset:34816
    ds_write_b128 v124, v[236:239] offset:35840
    ds_write_b128 v124, v[240:243] offset:36864
    ds_write_b128 v124, v[244:247] offset:37888
    ds_write_b128 v124, v[248:251] offset:38912
    ds_write_b128 v124, v[252:255] offset:39936
    s_waitcnt vmcnt(8)
    s_barrier
    v_xor_b32 v13, 0x0, v11
    v_add_u32 v13, 0x0, v13
    ds_read_b64_tr_b16 a[208:209], v13
    ds_read_b64_tr_b16 a[210:211], v13 offset:1024
    ds_read_b64_tr_b16 a[212:213], v13 offset:16384
    ds_read_b64_tr_b16 a[214:215], v13 offset:17408
    v_xor_b32 v13, 0x20, v11
    v_add_u32 v13, 0x0, v13
    ds_read_b64_tr_b16 a[216:217], v13
    ds_read_b64_tr_b16 a[218:219], v13 offset:1024
    ds_read_b64_tr_b16 a[220:221], v13 offset:16384
    ds_read_b64_tr_b16 a[222:223], v13 offset:17408
    v_xor_b32 v13, 0x1000, v11
    v_add_u32 v13, 0x0, v13
    ds_read_b64_tr_b16 a[240:241], v13
    ds_read_b64_tr_b16 a[242:243], v13 offset:1024
    ds_read_b64_tr_b16 a[244:245], v13 offset:16384
    ds_read_b64_tr_b16 a[246:247], v13 offset:17408
    v_xor_b32 v13, 0x1020, v11
    v_add_u32 v13, 0x0, v13
    ds_read_b64_tr_b16 a[248:249], v13
    ds_read_b64_tr_b16 a[250:251], v13 offset:1024
    ds_read_b64_tr_b16 a[252:253], v13 offset:16384
    ds_read_b64_tr_b16 a[254:255], v13 offset:17408
    s_waitcnt lgkmcnt(0)
    s_barrier
    s_mov_b32 s43, 0x10000
    buffer_load_dword v30, v7, s[8:11], s43 offen sc1
    s_cmp_lg_u32 s20, 28
    s_cbranch_scc1 L_nocc_5
    v_lshlrev_b32 v25, 2, v117
    s_lshl_b32 s43, s21, 12
    s_getpc_b64 s[4:5]
L_pc_6:
    s_add_u32 s4, s4, L_nocc_5-L_pc_6
    s_addc_u32 s5, s5, 0
    v_add_u32 v25, s43, v25
    v_min_u32 v25, L_code_end-L_nocc_5-4, v25
    global_load_dword v29, v25, s[4:5]
L_nocc_5:
L_chain_warm:
    s_mov_b32 s12, s66
    s_and_b32 s13, s67, 0xffff
    s_add_u32 s43, s42, 0x0
    s_add_u32 m0, s51, 0x8000
    s_nop 0
    buffer_load_dwordx4 v10, s[12:15], s43 offen lds
    s_add_u32 s43, s42, 0x4000
    s_add_u32 m0, s51, 0x9000
    s_nop 0
    buffer_load_dwordx4 v9, s[12:15], s43 offen lds
    s_add_u32 s43, s42, 0x8000
    s_add_u32 m0, s51, 0xa000
    s_nop 0
    buffer_load_dwordx4 v10, s[12:15], s43 offen lds
    s_add_u32 s43, s42, 0xc000
    s_add_u32 m0, s51, 0xb000
    s_nop 0
    buffer_load_dwordx4 v9, s[12:15], s43 offen lds
    s_add_u32 s43, s42, 0x10200
    s_add_u32 m0, s51, 0xc000
    s_nop 0
    buffer_load_dwordx4 v10, s[12:15], s43 offen lds
    s_add_u32 s43, s42, 0x14200
    s_add_u32 m0, s51, 0xd000
    s_nop 0
    buffer_load_dwordx4 v9, s[12:15], s43 offen lds
    s_add_u32 s43, s42, 0x18200
    s_add_u32 m0, s51, 0xe000
    s_nop 0
    buffer_load_dwordx4 v10, s[12:15], s43 offen lds
    s_add_u32 s43, s42, 0x1c200
    s_add_u32 m0, s51, 0xf000
    s_nop 0
    buffer_load_dwordx4 v9, s[12:15], s43 offen lds
    s_waitcnt vmcnt(9)
    s_barrier
    v_xor_b32 v13, 0x0, v11
    v_add_u32 v13, 0x8000, v13
    ds_read_b64_tr_b16 v[144:145], v13
    ds_read_b64_tr_b16 v[146:147], v13 offset:1024
    ds_read_b64_tr_b16 v[148:149], v13 offset:16384
    ds_read_b64_tr_b16 v[150:151], v13 offset:17408
    v_xor_b32 v13, 0x20, v11
    v_add_u32 v13, 0x8000, v13
    ds_read_b64_tr_b16 v[152:153], v13
    ds_read_b64_tr_b16 v[154:155], v13 offset:1024
    ds_read_b64_tr_b16 v[156:157], v13 offset:16384
    ds_read_b64_tr_b16 v[158:159], v13 offset:17408
    v_xor_b32 v13, 0x1000, v11
    v_add_u32 v13, 0x8000, v13
    ds_read_b64_tr_b16 v[176:177], v13
    ds_read_b64_tr_b16 v[178:179], v13 offset:1024
    ds_read_b64_tr_b16 v[180:181], v13 offset:16384
    ds_read_b64_tr_b16 v[182:183], v13 offset:17408
    v_xor_b32 v13, 0x1020, v11
    v_add_u32 v13, 0x8000, v13
    ds_read_b64_tr_b16 v[184:185], v13
    ds_read_b64_tr_b16 v[186:187], v13 offset:1024
    ds_read_b64_tr_b16 v[188:189], v13 offset:16384
    ds_read_b64_tr_b16 v[190:191], v13 offset:17408
    s_waitcnt lgkmcnt(0)
    s_barrier
    s_add_u32 s43, s42, 0x10000
    s_add_u32 m0, s51, 0x10000
    s_nop 0
    buffer_load_dwordx4 v10, s[12:15], s43 offen lds
    s_add_u32 s43, s42, 0x14000
    s_add_u32 m0, s51, 0x11000
    s_nop 0
    buffer_load_dwordx4 v9, s[12:15], s43 offen lds
    s_add_u32 s43, s42, 0x18000
    s_add_u32 m0, s51, 0x12000
    s_nop 0
    buffer_load_dwordx4 v10, s[12:15], s43 offen lds
    s_add_u32 s43, s42, 0x1c000
    s_add_u32 m0, s51, 0x13000
    s_nop 0
    buffer_load_dwordx4 v9, s[12:15], s43 offen lds
    s_add_u32 s43, s42, 0x200
    s_add_u32 m0, s51, 0x14000
    s_nop 0
    buffer_load_dwordx4 v10, s[12:15], s43 offen lds
    s_add_u32 s43, s42, 0x4200
    s_add_u32 m0, s51, 0x15000
    s_nop 0
    buffer_load_dwordx4 v9, s[12:15], s43 offen lds
    s_add_u32 s43, s42, 0x8200
    s_add_u32 m0, s51, 0x16000
    s_nop 0
    buffer_load_dwordx4 v10, s[12:15], s43 offen lds
    s_add_u32 s43, s42, 0xc200
    s_add_u32 m0, s51, 0x17000
    s_nop 0
    buffer_load_dwordx4 v9, s[12:15], s43 offen lds
    v_lshlrev_b32 v26, 3, v117
    v_and_b32 v26, 2048, v26
    s_lshl_b32 s43, s20, 6
    s_add_u32 s43, s43, 0x2000
    buffer_load_dword v26, v26, s[8:11], s43 offen sc1
    buffer_load_dword v27, off, s[16:19], 0 offset:4 sc1
    s_waitcnt vmcnt(10)
    v_min_u32 v21, 0xfffffffe, v21
    s_mov_b32 s43, 0x10000
    s_mov_b64 exec, s[38:39]
    buffer_store_dword v21, v119, s[8:11], s43 offen
    s_mov_b64 exec, -1
    v_mov_b32 v16, -1
    v_mov_b32 v17, -1
    v_mov_b32 v18, -1
    v_mov_b32 v19, -1
    s_lshl_b32 s43, s20, 13
    s_add_u32 s43, s43, 0x100000
    s_and_b32 s40, s21, 1
    s_lshl_b32 s40, s40, 12
    s_add_u32 s29, s43, s40
    s_add_u32 s43, s43, s52
    s_xor_b32 s40, s43, 0x0
    s_mov_b32 s43, 0x12000
    buffer_store_dword v16, v119, s[8:11], s43 offen
    s_mov_b32 s43, 0x14000
    buffer_store_dword v16, v119, s[8:11], s43 offen
    s_mov_b32 s43, 0x16000
    buffer_store_dword v16, v119, s[8:11], s43 offen
    s_barrier
    v_xor_b32 v13, 0x0, v12
    v_add_u32 v13, 0x0, v13
    ds_read_b64_tr_b16 v[192:193], v13
    ds_read_b64_tr_b16 v[194:195], v13 offset:512
    ds_read_b64_tr_b16 v[196:197], v13 offset:2048
    ds_read_b64_tr_b16 v[198:199], v13 offset:2560
    v_xor_b32 v13, 0x2000, v12
    v_add_u32 v13, 0x0, v13
    ds_read_b64_tr_b16 v[200:201], v13
    ds_read_b64_tr_b16 v[202:203], v13 offset:512
    ds_read_b64_tr_b16 v[204:205], v13 offset:2048
    ds_read_b64_tr_b16 v[206:207], v13 offset:2560
    v_xor_b32 v13, 0x40, v12
    v_add_u32 v13, 0x0, v13
    ds_read_b64_tr_b16 v[224:225], v13
    ds_read_b64_tr_b16 v[226:227], v13 offset:512
    ds_read_b64_tr_b16 v[228:229], v13 offset:2048
    ds_read_b64_tr_b16 v[230:231], v13 offset:2560
    v_xor_b32 v13, 0x2040, v12
    v_add_u32 v13, 0x0, v13
    ds_read_b64_tr_b16 v[232:233], v13
    ds_read_b64_tr_b16 v[234:235], v13 offset:512
    ds_read_b64_tr_b16 v[236:237], v13 offset:2048
    ds_read_b64_tr_b16 v[238:239], v13 offset:2560
    s_lshr_b32 s43, s20, 1
    s_lshl_b32 s43, s43, 7
    s_and_b32 s40, s20, 1
    s_lshl_b32 s40, s40, 4
    s_add_u32 s43, s43, s40
    s_add_u32 s44, s43, 0x1000
    s_cmp_eq_u32 s21, 0
    s_cselect_b32 s44, s44, 0x7ff00000
    s_mov_b32 s22, 0
    s_mov_b32 s33, 0
    s_xor_b32 s53, s29, 1024
    s_add_u32 s23, s51, 0x10000
    s_add_u32 s48, s23, 4096
    s_mov_b32 s24, 0x12000
    s_add_u32 s55, s24, 16384
    s_mov_b32 s25, 0x100000
    s_mov_b32 s26, 0x101000
    v_mov_b32 v112, 0
    v_mov_b32 v113, 0
    v_mov_b32 v114, 0
    v_mov_b32 v115, 0
    ds_write_b128 v117, v[112:115] offset:22528
    ds_write_b128 v117, v[112:115] offset:23552
    s_cmp_lg_u32 s21, 0
    s_cselect_b32 s40, -1, 0
    v_mov_b32 v126, s40
    v_bfe_u32 v1, v117, 4, 1
    v_lshlrev_b32 v1, 4, v1
    s_movk_i32 s43, 0x3f80
    v_lshlrev_b32 v125, v1, s43
    v_bfe_u32 v1, v117, 5, 3
    v_cmp_eq_u32 s[68:69], 0, v1
    v_cmp_eq_u32 s[70:71], 1, v1
    v_cmp_eq_u32 s[72:73], 2, v1
    v_cmp_eq_u32 s[74:75], 3, v1
    v_mov_b32 v40, 0
    v_mov_b32 v41, 0
    v_mov_b32 v42, 0
    v_mov_b32 v43, 0
    v_mov_b32 v44, 0
    v_mov_b32 v45, 0
    v_mov_b32 v46, 0
    v_mov_b32 v47, 0
    v_mov_b32 v48, 0
    v_mov_b32 v49, 0
    v_mov_b32 v50, 0
    v_mov_b32 v51, 0
    v_mov_b32 v52, 0
    v_mov_b32 v53, 0
    v_mov_b32 v54, 0
    v_mov_b32 v55, 0
    s_mov_b32 s45, 0
    s_mov_b32 s46, 0
    s_mov_b32 s47, 0
    s_mov_b32 s76, 0
    s_and_b32 s43, s21, 1
    s_lshl_b32 s43, s43, 5
    s_add_u32 s43, s43, s20
    s_lshl_b32 s43, s43, 6
    s_add_u32 s28, s43, 0x2000
    s_mov_b32 s59, 0
    s_waitcnt vmcnt(4) lgkmcnt(0)
    v_readlane_b32 s43, v26, 0
    v_readlane_b32 s40, v26, 16
    s_nop 0
    s_min_u32 s43, s43, s40
    s_cmp_lg_u32 s43, 0
    s_cselect_b32 s57, s57, 0
    v_readfirstlane_b32 s43, v27
    s_nop 0
    s_cmp_ge_u32 s43, 32
    s_cselect_b32 s57, s57, 0
    s_cmp_lg_u32 s57, 1
    s_cbranch_scc1 L_nokv_7
    s_add_u32 m0, s52, 8192
    s_nop 0
    buffer_load_dwordx4 v117, s[8:11], s30 offen lds
    buffer_load_dwordx4 v117, s[8:11], s30 offen offset:1024 lds
    s_add_u32 m0, s52, 0x6000
    s_nop 0
    buffer_load_dwordx4 v117, s[8:11], s31 offen lds
    buffer_load_dwordx4 v117, s[8:11], s31 offen offset:1024 lds
L_nokv_7:
    s_barrier
    v_xor_b32 v13, 0x0, v12
    v_add_u32 v13, 0x8000, v13
    ds_read_b64_tr_b16 v[208:209], v13
    ds_read_b64_tr_b16 v[210:211], v13 offset:512
    ds_read_b64_tr_b16 v[212:213], v13 offset:2048
    ds_read_b64_tr_b16 v[214:215], v13 offset:2560
    v_xor_b32 v13, 0x2000, v12
    v_add_u32 v13, 0x8000, v13
    ds_read_b64_tr_b16 v[216:217], v13
    ds_read_b64_tr_b16 v[218:219], v13 offset:512
    ds_read_b64_tr_b16 v[220:221], v13 offset:2048
    ds_read_b64_tr_b16 v[222:223], v13 offset:2560
    v_xor_b32 v13, 0x40, v12
    v_add_u32 v13, 0x8000, v13
    ds_read_b64_tr_b16 v[240:241], v13
    ds_read_b64_tr_b16 v[242:243], v13 offset:512
    ds_read_b64_tr_b16 v[244:245], v13 offset:2048
    ds_read_b64_tr_b16 v[246:247], v13 offset:2560
    v_xor_b32 v13, 0x2040, v12
    v_add_u32 v13, 0x8000, v13
    ds_read_b64_tr_b16 v[248:249], v13
    ds_read_b64_tr_b16 v[250:251], v13 offset:512
    ds_read_b64_tr_b16 v[252:253], v13 offset:2048
    ds_read_b64_tr_b16 v[254:255], v13 offset:2560
    ds_write_b128 v123, v[80:83]
    ds_write_b128 v123, v[84:87] offset:1024
    ds_write_b128 v123, v[56:59] offset:2048
    ds_write_b128 v123, v[60:63] offset:3072
    ds_write_b128 v123, v[88:91] offset:4096
    ds_write_b128 v123, v[92:95] offset:5120
    ds_write_b128 v123, v[96:99] offset:6144
    ds_write_b128 v123, v[100:103] offset:7168
    s_cmp_eq_u32 s57, 1
    s_cbranch_scc1 L_started_8
    s_mov_b32 s96, 0
L_mode_9:
    buffer_load_dwordx2 v[2:3], off, s[92:95], 0 offset:36 sc1
    s_waitcnt vmcnt(0)
    v_readfirstlane_b32 s87, v2
    v_readfirstlane_b32 s97, v3
    s_nop 0
    s_min_u32 s97, s97, s87
    s_cmp_lg_u32 s97, 0
    s_cbranch_scc1 L_moded_10
    s_sleep 4
    s_add_u32 s96, s96, 1
    s_cmp_lg_u32 s96, 0x100
    s_cbranch_scc1 L_modef_11
    v_mov_b32 v2, 2
    v_mov_b32 v3, 0
    s_mov_b64 exec, 1
    buffer_atomic_cmpswap v[2:3], off, s[92:95], 0 offset:36
    s_mov_b64 exec, -1
L_modef_11:
    s_cmp_lt_u32 s96, 0x10000
    s_cbranch_scc1 L_mode_9
L_moded_10:
    s_cmp_lg_u32 s87, 1
    s_cbranch_scc1 L_fallback
    v_lshrrev_b32 v1, 4, v117
    v_and_b32 v2, 15, v1
    v_lshrrev_b32 v1, 4, v1
    v_lshlrev_b32 v1, 11, v1
    v_lshl_add_u32 v1, v2, 2, v1
    s_lshl_b32 s43, s20, 6
    s_add_u32 s43, s43, 0x2000
    s_mov_b32 exec_lo, 0x10001
    s_mov_b32 exec_hi, 0
    s_mov_b32 s96, 0
L_poll_12:
    buffer_load_dword v2, v1, s[8:11], s43 offen sc1
    s_waitcnt vmcnt(0)
    v_cmp_gt_u32 vcc, 1, v2
    s_cbranch_vccz L_polld_13
    s_sleep 8
    s_add_u32 s96, s96, 1
    s_cmp_lt_u32 s96, 0x10000
    s_cbranch_scc1 L_poll_12
L_polld_13:
    s_mov_b64 exec, -1
    s_add_u32 m0, s52, 8192
    s_nop 0
    buffer_load_dwordx4 v117, s[8:11], s30 offen lds
    buffer_load_dwordx4 v117, s[8:11], s30 offen offset:1024 lds
    s_add_u32 m0, s52, 0x6000
    s_nop 0
    buffer_load_dwordx4 v117, s[8:11], s31 offen lds
    buffer_load_dwordx4 v117, s[8:11], s31 offen offset:1024 lds
    s_mov_b32 s49, 0
L_cb_poll_15:
    buffer_load_dword v3, off, s[16:19], 0 offset:4 sc1
    s_waitcnt vmcnt(0)
    v_readfirstlane_b32 s43, v3
    s_nop 0
    s_cmp_ge_u32 s43, 32
    s_cbranch_scc1 L_started_8
    s_sleep 8
    s_add_u32 s49, s49, 1
    s_cmp_lt_u32 s49, 0x40000
    s_cbranch_scc1 L_cb_poll_15
L_started_8:
    v_lshrrev_b32 v1, 2, v117
    s_cmp_lt_u32 s21, 2
    s_cselect_b64 vcc, -1, 0
    v_cndmask_b32 v119, v119, v1, vcc
    s_add_u32 m0, s51, 4096
    v_mov_b32 v24, v32
    v_mov_b32 v25, v33
    v_mov_b32 v26, v34
    v_mov_b32 v27, v35
    v_mov_b32 v28, v36
    v_mov_b32 v29, v37
    v_mov_b32 v30, v38
    v_mov_b32 v31, v39
    s_add_u32 s30, s30, 0x40000
    s_add_u32 s31, s31, 0x40000
    s_mov_b32 s49, 0
    s_waitcnt vmcnt(0) lgkmcnt(0)
    s_barrier
    ds_write_b128 v123, v[64:67] offset:32768
    ds_write_b128 v123, v[68:71] offset:33792
    ds_write_b128 v123, v[72:75] offset:34816
    ds_write_b128 v123, v[76:79] offset:35840
    ds_write_b128 v123, v[104:107] offset:36864
    ds_write_b128 v123, v[108:111] offset:37888
    ds_write_b128 v123, v[32:35] offset:38912
    ds_write_b128 v123, v[36:39] offset:39936
    v_mov_b32 v32, 0
    v_mov_b32 v33, 0
    v_mov_b32 v34, 0
    v_mov_b32 v35, 0
    v_mov_b32 v36, 0
    v_mov_b32 v37, 0
    v_mov_b32 v38, 0
    v_mov_b32 v39, 0
    s_nop 4
    s_cmp_eq_u32 s21, 1
    s_cbranch_scc1 L_chain_top1_f
    s_cmp_eq_u32 s21, 2
    s_cbranch_scc1 L_chain_top2_f
    s_cmp_eq_u32 s21, 3
    s_cbranch_scc1 L_chain_top3_f
.p2align 6
L_chain_top0_f:
    buffer_load_dwordx4 v[0:3], v117, s[8:11], s23 offen nt
    v_mov_b32 v15, 0
    v_mov_b32 v15, 0
    v_mov_b32 v15, 0
    v_mov_b32 v15, 0
    v_mov_b32 v15, 0
    v_mov_b32 v15, 0
    v_mov_b32 v15, 0
    v_mov_b32 v15, 0
    v_mov_b32 v15, 0
    v_mov_b32 v15, 0
    v_mov_b32 v15, 0
    v_mov_b32 v15, 0
    v_mov_b32 v15, 0
    v_mov_b32 v15, 0
    v_mov_b32 v15, 0
    v_mov_b32 v15, 0
    buffer_load_dwordx4 v[0:3], v117, s[8:11], s23 offen sc1
    v_mov_b32 v15, 0
    v_mov_b32 v15, 0
    v_mov_b32 v15, 0
    v_mov_b32 v15, 0
    v_mov_b32 v15, 0
    v_mov_b32 v15, 0
    v_mov_b32 v15, 0
    v_mov_b32 v15, 0
    v_mov_b32 v15, 0
    v_mov_b32 v15, 0
    v_mov_b32 v15, 0
    v_mov_b32 v15, 0
    v_mov_b32 v15, 0
    v_mov_b32 v15, 0
    v_mov_b32 v15, 0
    v_mov_b32 v15, 0
L_mret_17:
    buffer_load_dwordx4 v[0:3], v117, s[8:11], s23 offen sc1
    s_add_u32 s45, s45, 1
    s_cmp_lt_u32 s45, 0x10000
    s_cselect_b32 s56, -2, -1
    s_nop 3
    v_mov_b32 v32, 0
    v_mov_b32 v33, 0
    v_mov_b32 v34, 0
    v_mov_b32 v35, 0
    s_waitcnt vmcnt(2)
    v_max3_u32 v15, v0, v1, v2
    v_max_u32 v15, v15, v3
    v_cmp_lt_u32 vcc, s56, v15
    v_smfmac_f32_16x16x64_bf16 v[32:35], v[0:3], v[80:87], v116
    s_cbranch_vccnz L_mret_17
    ds_write_b128 v117, v[0:3]
    v_smfmac_f32_16x16x64_bf16 v[36:39], v[0:3], v[56:63], v116
    buffer_load_dwordx4 v[4:7], v117, s[8:11], s48 offen nt
    v_smfmac_f32_16x16x64_bf16 v[40:43], v[0:3], v[64:71], v116
    buffer_load_dwordx4 v117, s[8:11], s48 offen nt lds
    s_mov_b32 m0, 8192
    v_smfmac_f32_16x16x64_bf16 v[44:47], v[0:3], v[72:79], v116
    s_waitcnt lgkmcnt(0)
    s_barrier
    ds_read_b128 v[8:11], v117 offset:1024
    v_smfmac_f32_16x16x64_bf16 v[48:51], v[0:3], a[192:199], v116
    ds_read_b128 v[16:19], v117 offset:2048
    ds_read_b128 v[20:23], v117 offset:3072
    v_smfmac_f32_16x16x64_bf16 v[52:55], v[0:3], a[200:207], v116
    ds_read_b128 v[80:83], v117 offset:14336
    s_waitcnt lgkmcnt(3)
    v_smfmac_f32_16x16x64_bf16 v[32:35], v[8:11], a[0:7], v116
    ds_read_b128 v[84:87], v117 offset:15360
    v_smfmac_f32_16x16x64_bf16 v[36:39], v[8:11], a[8:15], v116
    buffer_store_dwordx4 v[112:115], v117, s[8:11], s32 offen sc1
    s_waitcnt lgkmcnt(3)
    v_smfmac_f32_16x16x64_bf16 v[32:35], v[16:19], a[32:39], v116
    ds_read_b128 v[56:59], v117 offset:8192
    v_smfmac_f32_16x16x64_bf16 v[36:39], v[16:19], a[40:47], v116
    ds_read_b128 v[60:63], v117 offset:9216
    s_waitcnt lgkmcnt(4)
    v_smfmac_f32_16x16x64_bf16 v[32:35], v[20:23], a[64:71], v116
    ds_read_b128 v[64:67], v117 offset:10240
    v_smfmac_f32_16x16x64_bf16 v[36:39], v[20:23], a[72:79], v116
    ds_read_b128 v[68:71], v117 offset:11264
    v_smfmac_f32_16x16x64_bf16 v[40:43], v[8:11], a[96:103], v116
    ds_read_b128 v[72:75], v117 offset:12288
    v_smfmac_f32_16x16x64_bf16 v[40:43], v[16:19], a[128:135], v116
    ds_read_b128 v[76:79], v117 offset:13312
    v_smfmac_f32_16x16x64_bf16 v[40:43], v[20:23], a[160:167], v116
    s_waitcnt vmcnt(2)
    v_max3_u32 v15, v4, v5, v6
    v_smfmac_f32_16x16x64_bf16 v[44:47], v[8:11], a[104:111], v116
    v_max_u32 v15, v15, v7
    v_smfmac_f32_16x16x64_bf16 v[44:47], v[16:19], a[136:143], v116
    s_waitcnt vmcnt(1) lgkmcnt(0)
    v_cmp_lt_u32 vcc, s56, v15
    v_smfmac_f32_16x16x64_bf16 v[44:47], v[20:23], a[168:175], v116
    s_cbranch_vccnz L_mret_18
L_mgo_19:
    v_smfmac_f32_16x16x64_bf16 v[44:47], v[4:7], v[24:31], v116
    s_barrier
    ds_read_b128 v[12:15], v117 offset:5120
    v_smfmac_f32_16x16x64_bf16 v[32:35], v[4:7], v[88:95], v116
    ds_read_b128 v[24:27], v117 offset:6144
    v_smfmac_f32_16x16x64_bf16 v[36:39], v[4:7], v[96:103], v116
    ds_read_b128 v[28:31], v117 offset:7168
    v_smfmac_f32_16x16x64_bf16 v[40:43], v[4:7], v[104:111], v116
    ds_read_b128 v[88:91], v117 offset:24576
    s_waitcnt lgkmcnt(3)
    v_smfmac_f32_16x16x64_bf16 v[32:35], v[12:15], a[16:23], v116
    ds_read_b128 v[92:95], v117 offset:25600
    s_waitcnt lgkmcnt(3)
    v_smfmac_f32_16x16x64_bf16 v[32:35], v[24:27], a[48:55], v116
    buffer_load_dwordx4 v117, s[8:11], s30 offen lds
    s_waitcnt lgkmcnt(2)
    v_smfmac_f32_16x16x64_bf16 v[32:35], v[28:31], a[80:87], v116
    ds_read_b128 v[96:99], v117 offset:23552
    v_smfmac_f32_16x16x64_bf16 v[36:39], v[12:15], a[24:31], v116
    ds_read_b128 v[100:103], v117 offset:23552
    v_smfmac_f32_16x16x64_bf16 v[36:39], v[24:27], a[56:63], v116
    buffer_load_dwordx4 v117, s[8:11], s30 offen offset:1024 lds
    s_add_u32 m0, s52, 0x6000
    v_add_f32 v32, v32, v34
    v_smfmac_f32_16x16x64_bf16 v[36:39], v[28:31], a[88:95], v116
    ds_read_b128 v[104:107], v117 offset:23552
    v_add_f32 v33, v33, v35
    v_smfmac_f32_16x16x64_bf16 v[40:43], v[12:15], a[112:119], v116
    ds_read_b128 v[108:111], v117 offset:23552
    v_mul_f32 v32, s34, v32
    v_smfmac_f32_16x16x64_bf16 v[40:43], v[24:27], a[144:151], v116
    buffer_load_dword v125, v119, s[8:11], s28 offen sc1
    v_mul_f32 v33, s34, v33
    v_smfmac_f32_16x16x64_bf16 v[40:43], v[28:31], a[176:183], v116
    ds_read_b128 v[0:3], v124
    v_add_f32 v36, v36, v38
    v_smfmac_f32_16x16x64_bf16 v[48:51], v[4:7], a[208:215], v116
    v_add_f32 v37, v37, v39
    v_smfmac_f32_16x16x64_bf16 v[52:55], v[4:7], a[216:223], v116
    s_waitcnt lgkmcnt(5)
    buffer_load_dwordx4 v117, s[8:11], s31 offen lds
    v_mul_f32 v36, s34, v36
    v_smfmac_f32_16x16x64_bf16 v[44:47], v[12:15], a[120:127], v116
    ds_read_b128 v[4:7], v124 offset:1024
    v_mul_f32 v37, s34, v37
    v_smfmac_f32_16x16x64_bf16 v[44:47], v[24:27], a[152:159], v116
    v_cvt_pk_bf16_f32 v34, v32, v36
    v_smfmac_f32_16x16x64_bf16 v[44:47], v[28:31], a[184:191], v116
    buffer_load_dwordx4 v117, s[8:11], s31 offen offset:1024 lds
    s_mov_b32 m0, 4096
    v_cvt_pk_bf16_f32 v35, v33, v37
    v_add_f32 v40, v40, v42
    v_smfmac_f32_16x16x64_bf16 v[48:51], v[8:11], a[224:231], v116
    ds_write2_b32 v120, v34, v35 offset0:32 offset1:48
    v_add_f32 v41, v41, v43
    v_smfmac_f32_16x16x64_bf16 v[52:55], v[8:11], a[232:239], v116
    v_add_f32 v44, v44, v46
    v_add_f32 v45, v45, v47
    v_cvt_pk_bf16_f32 v113, v40, v44
    v_cvt_pk_bf16_f32 v115, v41, v45
    v_smfmac_f32_16x16x64_bf16 v[48:51], v[12:15], a[240:247], v116
    ds_write2_b32 v120, v113, v115 offset0:0 offset1:16
    v_smfmac_f32_16x16x64_bf16 v[52:55], v[12:15], a[248:255], v116
    s_cmp_eq_u32 s22, 63
    s_cbranch_scc1 L_chain_last_f
    buffer_store_dword v126, off, s[8:11], s44 sc1
    v_smfmac_f32_16x16x64_bf16 v[48:51], v[16:19], v[128:135], v116
    v_smfmac_f32_16x16x64_bf16 v[48:51], v[20:23], v[160:167], v116
    v_smfmac_f32_16x16x64_bf16 v[48:51], v[24:27], v[144:151], v116
    s_waitcnt lgkmcnt(0)
    s_barrier
    v_smfmac_f32_16x16x64_bf16 v[48:51], v[28:31], v[176:183], v116
    ds_read_b128 v[32:35], v121 offset:16384
    ds_read_b128 v[36:39], v121 offset:17408
    v_smfmac_f32_16x16x64_bf16 v[52:55], v[16:19], v[136:143], v116
    ds_read_b128 v[40:43], v121 offset:18432
    ds_read_b128 v[44:47], v121 offset:19456
    v_smfmac_f32_16x16x64_bf16 v[52:55], v[20:23], v[168:175], v116
    ds_read_b128 v[8:11], v124 offset:32768
    v_add_f32 v48, v48, v50
    v_smfmac_f32_16x16x64_bf16 v[52:55], v[24:27], v[152:159], v116
    ds_read_b128 v[12:15], v124 offset:33792
    v_add_f32 v49, v49, v51
    v_smfmac_f32_16x16x64_bf16 v[52:55], v[28:31], v[184:191], v116
    s_waitcnt lgkmcnt(5)
    v_cvt_pk_bf16_f32 v112, v48, v49
    v_mfma_f32_16x16x32_bf16 v[56:59], v[56:59], v[32:35], 0
    s_waitcnt lgkmcnt(4)
    v_mov_b32 v48, s50
    v_mov_b32 v49, s50
    v_mfma_f32_16x16x32_bf16 v[56:59], v[60:63], v[36:39], v[56:59]
    ds_read_b128 v[16:19], v124 offset:2048
    s_waitcnt lgkmcnt(4)
    v_mov_b32 v50, s50
    v_mov_b32 v51, s50
    v_mfma_f32_16x16x32_bf16 v[56:59], v[64:67], v[40:43], v[56:59]
    ds_read_b128 v[20:23], v124 offset:3072
    s_waitcnt lgkmcnt(4)
    v_add_f32 v52, v52, v54
    v_mfma_f32_16x16x32_bf16 v[56:59], v[68:71], v[44:47], v[56:59]
    ds_read_b128 v[24:27], v124 offset:4096
    v_add_f32 v53, v53, v55
    v_mfma_f32_16x16x32_bf16 v[60:63], v[72:75], v[32:35], 0
    ds_read_b128 v[28:31], v124 offset:5120
    v_cvt_pk_bf16_f32 v114, v52, v53
    v_mov_b32 v53, 0
    v_mfma_f32_16x16x32_bf16 v[60:63], v[76:79], v[36:39], v[60:63]
    v_exp_f32 v56, v56
    v_mfma_f32_16x16x32_bf16 v[60:63], v[80:83], v[40:43], v[60:63]
    v_exp_f32 v57, v57
    v_mfma_f32_16x16x32_bf16 v[60:63], v[84:87], v[44:47], v[60:63]
    v_exp_f32 v58, v58
    v_mfma_f32_16x16x32_bf16 v[64:67], v[32:35], v[32:35], 0
    v_exp_f32 v59, v59
    v_cvt_pk_bf16_f32 v68, v56, v57
    v_mfma_f32_16x16x32_bf16 v[64:67], v[36:39], v[36:39], v[64:67]
    v_exp_f32 v60, v60
    v_cvt_pk_bf16_f32 v69, v58, v59
    v_mfma_f32_16x16x32_bf16 v[64:67], v[40:43], v[40:43], v[64:67]
    v_exp_f32 v61, v61
    v_mfma_f32_16x16x32_bf16 v[64:67], v[44:47], v[44:47], v[64:67]
    v_exp_f32 v62, v62
    v_exp_f32 v63, v63
    v_cvt_pk_bf16_f32 v70, v60, v61
    v_cvt_pk_bf16_f32 v71, v62, v63
    s_nop 1
    v_mfma_f32_16x16x32_bf16 v[72:75], v[88:91], v[68:71], 0
    s_nop 0
    v_exp_f32 v64, v64
    v_mfma_f32_16x16x32_bf16 v[76:79], v[92:95], v[68:71], 0
    v_exp_f32 v65, v65
    v_mfma_f32_16x16x32_bf16 v[80:83], v[48:51], v[68:71], 0
    v_cvt_pk_bf16_f32 v52, v64, v65
    s_nop 1
    v_mfma_f32_16x16x16_bf16 v[72:75], v[112:113], v[52:53], v[72:75]
    ds_read_b128 v[32:35], v124 offset:6144
    v_mfma_f32_16x16x16_bf16 v[76:79], v[114:115], v[52:53], v[76:79]
    ds_read_b128 v[36:39], v124 offset:7168
    v_mfma_f32_16x16x16_bf16 v[80:83], v[48:49], v[52:53], v[80:83]
L_norm_20:
    s_mov_b64 vcc, s[36:37]
    v_mov_b32 v122, v122
    v_mov_b32 v122, v122
    v_mov_b32 v122, v122
    v_cndmask_b32_dpp v76, v72, v76, vcc quad_perm:[2,3,2,3] row_mask:0xf bank_mask:0xf
    v_cndmask_b32_dpp v77, v73, v77, vcc quad_perm:[2,3,2,3] row_mask:0xf bank_mask:0xf
    v_cndmask_b32_dpp v78, v74, v78, vcc quad_perm:[2,3,2,3] row_mask:0xf bank_mask:0xf
    v_cndmask_b32_dpp v79, v75, v79, vcc quad_perm:[2,3,2,3] row_mask:0xf bank_mask:0xf
    v_rcp_f32_dpp v84, v80 quad_perm:[2,3,2,3] row_mask:0xf bank_mask:0xf
    s_nop 0
    v_pk_mul_f32 v[76:77], v[76:77], v[84:85] op_sel_hi:[1,0]
    v_pk_mul_f32 v[78:79], v[78:79], v[84:85] op_sel_hi:[1,0]
    v_cvt_pk_bf16_f32 v72, v76, v77
    v_cvt_pk_bf16_f32 v73, v78, v79
    ds_write_b64 v122, v[72:73] offset:20480
    v_max_f32_dpp v86, v80, v84 quad_perm:[2,3,2,3] row_mask:0xf bank_mask:0xf
    v_mov_b32_dpp v60, v72 quad_perm:[0,1,0,1] row_mask:0xf bank_mask:0xf
    v_mov_b32_dpp v61, v73 quad_perm:[0,1,0,1] row_mask:0xf bank_mask:0xf
    v_cmp_lt_f32 vcc, s35, v86
    v_mov_b32_dpp v62, v72 quad_perm:[2,3,2,3] row_mask:0xf bank_mask:0xf
    v_mov_b32_dpp v63, v73 quad_perm:[2,3,2,3] row_mask:0xf bank_mask:0xf
    s_nop 1
    v_smfmac_f32_16x16x64_bf16 v[96:99], v[60:63], v[192:199], v116
    s_cbranch_vccnz L_smax_21
    v_smfmac_f32_16x16x64_bf16 v[100:103], v[60:63], v[224:231], v116
    s_waitcnt lgkmcnt(0)
    s_barrier
    ds_read_b128 v[92:95], v127 offset:20992
    ds_read_b128 v[80:83], v127 offset:21504
    ds_read_b128 v[84:87], v127 offset:22016
    v_smfmac_f32_16x16x64_bf16 v[104:107], v[60:63], v[0:7], v116
    ds_read_b128 v[40:43], v124 offset:34816
    v_smfmac_f32_16x16x64_bf16 v[108:111], v[60:63], v[8:15], v116
    ds_read_b128 v[56:59], v124 offset:36864
    s_waitcnt lgkmcnt(4)
    v_smfmac_f32_16x16x64_bf16 v[96:99], v[92:95], v[200:207], v116
    s_waitcnt lgkmcnt(3)
    v_smfmac_f32_16x16x64_bf16 v[96:99], v[80:83], v[208:215], v116
    ds_read_b128 v[44:47], v124 offset:35840
    s_waitcnt lgkmcnt(3)
    v_smfmac_f32_16x16x64_bf16 v[96:99], v[84:87], v[216:223], v116
    ds_read_b128 v[68:71], v124 offset:39936
    v_smfmac_f32_16x16x64_bf16 v[100:103], v[92:95], v[232:239], v116
    ds_read_b128 v[64:67], v124 offset:38912
    v_smfmac_f32_16x16x64_bf16 v[100:103], v[80:83], v[240:247], v116
    ds_read_b128 v[60:63], v124 offset:37888
    v_cvt_pk_bf16_f32 v72, v96, v98
    v_smfmac_f32_16x16x64_bf16 v[100:103], v[84:87], v[248:255], v116
    v_and_or_b32 v72, v72, -2, s33
    v_smfmac_f32_16x16x64_bf16 v[104:107], v[92:95], v[16:23], v116
    v_cvt_pk_bf16_f32 v74, v97, v99
    v_smfmac_f32_16x16x64_bf16 v[104:107], v[80:83], v[24:31], v116
    v_cvt_pk_bf16_f32 v73, v100, v102
    v_cvt_pk_bf16_f32 v75, v101, v103
    v_smfmac_f32_16x16x64_bf16 v[104:107], v[84:87], v[32:39], v116
    buffer_store_dwordx4 v[72:75], v118, s[8:11], s25 offen
    s_waitcnt lgkmcnt(3)
    v_smfmac_f32_16x16x64_bf16 v[108:111], v[92:95], v[40:47], v116
    s_waitcnt lgkmcnt(0)
    v_smfmac_f32_16x16x64_bf16 v[108:111], v[80:83], v[56:63], v116
    v_cvt_pk_bf16_f32 v76, v104, v106
    v_smfmac_f32_16x16x64_bf16 v[108:111], v[84:87], v[64:71], v116
    v_and_or_b32 v76, v76, -2, s33
    v_cvt_pk_bf16_f32 v78, v105, v107
    v_mov_b32 v122, v122
    v_mov_b32 v122, v122
    v_mov_b32 v122, v122
    v_mov_b32 v122, v122
    v_mov_b32 v122, v122
    v_mov_b32 v122, v122
    v_cvt_pk_bf16_f32 v77, v108, v110
    v_cvt_pk_bf16_f32 v79, v109, v111
    buffer_store_dwordx4 v[76:79], v118, s[8:11], s26 offen
    s_add_u32 s30, s30, 0x40000
    s_add_u32 s31, s31, 0x40000
    s_add_u32 s32, s32, 0x20000
    s_add_u32 s23, s24, 0
    s_add_u32 s48, s23, 4096
    s_xor_b32 s25, s25, 0x0
    s_xor_b32 s26, s26, 0x0
    s_mov_b32 s35, 0x49800000
    v_mov_b32 v126, s22
    s_add_u32 s22, s22, 1
    v_mov_b32 v32, 0
    v_mov_b32 v33, 0
    v_mov_b32 v34, 0
    v_mov_b32 v35, 0
    v_mov_b32 v36, 0
    v_mov_b32 v37, 0
    v_mov_b32 v38, 0
    v_mov_b32 v39, 0
    v_mov_b32 v40, 0
    v_mov_b32 v41, 0
    v_mov_b32 v42, 0
    v_mov_b32 v43, 0
    v_mov_b32 v44, 0
    v_mov_b32 v45, 0
    v_mov_b32 v46, 0
    v_mov_b32 v47, 0
    v_mov_b32 v48, 0
    v_mov_b32 v49, 0
    v_mov_b32 v50, 0
    v_mov_b32 v51, 0
    v_mov_b32 v52, 0
    v_mov_b32 v53, 0
    v_mov_b32 v54, 0
    v_mov_b32 v55, 0
    ds_read_b128 v[80:83], v123
    ds_read_b128 v[84:87], v123 offset:1024
    ds_read_b128 v[56:59], v123 offset:2048
    ds_read_b128 v[60:63], v123 offset:3072
    ds_read_b128 v[64:67], v123 offset:32768
    ds_read_b128 v[68:71], v123 offset:33792
    ds_read_b128 v[72:75], v123 offset:34816
    ds_read_b128 v[76:79], v123 offset:35840
    ds_read_b128 v[88:91], v123 offset:4096
    ds_read_b128 v[92:95], v123 offset:5120
    ds_read_b128 v[96:99], v123 offset:6144
    ds_read_b128 v[100:103], v123 offset:7168
    ds_read_b128 v[104:107], v123 offset:36864
    ds_read_b128 v[108:111], v123 offset:37888
    ds_read_b128 v[24:27], v123 offset:38912
    ds_read_b128 v[28:31], v123 offset:39936
    s_add_u32 s24, s24, 8192
    s_bitset0_b32 s24, 15
    s_xor_b32 s55, s24, 16384
    s_xor_b32 s29, s29, 0x0
    s_xor_b32 s53, s29, 1024
    s_bfe_u32 s33, s22, 0x10000
    s_add_u32 s40, s22, 5
    s_lshr_b32 s40, s40, 2
    s_min_u32 s40, s40, 16
    s_bfm_b32 s58, s40, 0
    s_waitcnt vmcnt(5)
    v_cmp_eq_u32 vcc, 0, v125
    s_nop 0
    s_and_b64 vcc, vcc, s[58:59]
    s_cbranch_scc1 L_kvw_22
L_kvb_23:
    v_mov_b32 v15, 0
    s_nop 2
    v_mov_b32 v15, 0
    s_nop 2
    v_mov_b32 v15, 0
    s_nop 2
    v_mov_b32 v15, 0
    s_nop 2
    v_mov_b32 v15, 0
    s_nop 2
    v_mov_b32 v15, 0
    s_nop 2
    v_mov_b32 v15, 0
    s_nop 2
    v_mov_b32 v15, 0
    s_nop 2
    v_mov_b32 v15, 0
    s_nop 2
    v_mov_b32 v15, 0
    s_nop 2
    v_mov_b32 v15, 0
    s_nop 2
    v_mov_b32 v15, 0
    s_nop 2
    v_mov_b32 v15, 0
    s_nop 2
    v_mov_b32 v15, 0
    s_nop 2
    v_mov_b32 v15, 0
    s_nop 2
    v_mov_b32 v15, 0
    s_nop 2
    v_mov_b32 v15, 0
    s_nop 2
    v_mov_b32 v15, 0
    s_nop 2
    v_mov_b32 v15, 0
    s_nop 2
    v_mov_b32 v15, 0
    s_nop 2
    v_mov_b32 v15, 0
    s_nop 2
    v_mov_b32 v15, 0
    s_nop 2
    v_mov_b32 v15, 0
    s_nop 2
    v_mov_b32 v15, 0
    s_nop 2
    v_mov_b32 v15, 0
    s_nop 2
    v_mov_b32 v15, 0
    s_nop 2
    v_mov_b32 v15, 0
    s_nop 2
    v_mov_b32 v15, 0
    s_nop 2
    v_mov_b32 v15, 0
    s_nop 2
    v_mov_b32 v15, 0
    s_nop 2
    v_mov_b32 v15, 0
    s_nop 2
    s_waitcnt lgkmcnt(0)
    s_branch L_chain_top0_f
.p2align 6
L_chain_top1_f:
    buffer_load_dwordx4 v[0:3], v117, s[8:11], s23 offen nt
    v_mov_b32 v15, 0
    v_mov_b32 v15, 0
    v_mov_b32 v15, 0
    v_mov_b32 v15, 0
    v_mov_b32 v15, 0
    v_mov_b32 v15, 0
    v_mov_b32 v15, 0
    v_mov_b32 v15, 0
    v_mov_b32 v15, 0
    v_mov_b32 v15, 0
    v_mov_b32 v15, 0
    v_mov_b32 v15, 0
    v_mov_b32 v15, 0
    v_mov_b32 v15, 0
    v_mov_b32 v15, 0
    v_mov_b32 v15, 0
    buffer_load_dwordx4 v[0:3], v117, s[8:11], s23 offen sc1
    v_mov_b32 v15, 0
    v_mov_b32 v15, 0
    v_mov_b32 v15, 0
    v_mov_b32 v15, 0
    v_mov_b32 v15, 0
    v_mov_b32 v15, 0
    v_mov_b32 v15, 0
    v_mov_b32 v15, 0
    v_mov_b32 v15, 0
    v_mov_b32 v15, 0
    v_mov_b32 v15, 0
    v_mov_b32 v15, 0
    v_mov_b32 v15, 0
    v_mov_b32 v15, 0
    v_mov_b32 v15, 0
    v_mov_b32 v15, 0
L_mret_24:
    buffer_load_dwordx4 v[0:3], v117, s[8:11], s23 offen sc1
    s_add_u32 s45, s45, 1
    s_cmp_lt_u32 s45, 0x10000
    s_cselect_b32 s56, -2, -1
    s_nop 3
    v_mov_b32 v32, 0
    v_mov_b32 v33, 0
    v_mov_b32 v34, 0
    v_mov_b32 v35, 0
    s_waitcnt vmcnt(2)
    v_max3_u32 v15, v0, v1, v2
    v_max_u32 v15, v15, v3
    v_cmp_lt_u32 vcc, s56, v15
    v_smfmac_f32_16x16x64_bf16 v[32:35], v[0:3], v[80:87], v116
    s_cbranch_vccnz L_mret_24
    ds_write_b128 v117, v[0:3] offset:1024
    v_smfmac_f32_16x16x64_bf16 v[36:39], v[0:3], v[56:63], v116
    buffer_load_dwordx4 v[4:7], v117, s[8:11], s48 offen nt
    v_smfmac_f32_16x16x64_bf16 v[40:43], v[0:3], v[64:71], v116
    buffer_load_dwordx4 v117, s[8:11], s48 offen nt lds
    s_mov_b32 m0, 10240
    v_smfmac_f32_16x16x64_bf16 v[44:47], v[0:3], v[72:79], v116
    s_waitcnt lgkmcnt(0)
    s_barrier
    ds_read_b128 v[8:11], v117
    v_smfmac_f32_16x16x64_bf16 v[48:51], v[0:3], a[192:199], v116
    ds_read_b128 v[16:19], v117 offset:3072
    ds_read_b128 v[20:23], v117 offset:2048
    v_smfmac_f32_16x16x64_bf16 v[52:55], v[0:3], a[200:207], v116
    ds_read_b128 v[80:83], v117 offset:14336
    s_waitcnt lgkmcnt(3)
    v_smfmac_f32_16x16x64_bf16 v[32:35], v[8:11], a[0:7], v116
    ds_read_b128 v[84:87], v117 offset:15360
    v_smfmac_f32_16x16x64_bf16 v[36:39], v[8:11], a[8:15], v116
    ds_read_b128 v[56:59], v117 offset:8192
    s_waitcnt lgkmcnt(4)
    v_smfmac_f32_16x16x64_bf16 v[32:35], v[16:19], a[32:39], v116
    ds_read_b128 v[60:63], v117 offset:9216
    v_smfmac_f32_16x16x64_bf16 v[36:39], v[16:19], a[40:47], v116
    buffer_store_dwordx4 v[112:115], v117, s[8:11], s32 offen sc1
    s_waitcnt lgkmcnt(4)
    v_smfmac_f32_16x16x64_bf16 v[32:35], v[20:23], a[64:71], v116
    ds_read_b128 v[64:67], v117 offset:10240
    v_smfmac_f32_16x16x64_bf16 v[36:39], v[20:23], a[72:79], v116
    ds_read_b128 v[68:71], v117 offset:11264
    v_smfmac_f32_16x16x64_bf16 v[40:43], v[8:11], a[96:103], v116
    ds_read_b128 v[72:75], v117 offset:12288
    v_smfmac_f32_16x16x64_bf16 v[40:43], v[16:19], a[128:135], v116
    ds_read_b128 v[76:79], v117 offset:13312
    v_smfmac_f32_16x16x64_bf16 v[40:43], v[20:23], a[160:167], v116
    s_waitcnt vmcnt(2)
    v_max3_u32 v15, v4, v5, v6
    v_smfmac_f32_16x16x64_bf16 v[44:47], v[8:11], a[104:111], v116
    v_max_u32 v15, v15, v7
    v_smfmac_f32_16x16x64_bf16 v[44:47], v[16:19], a[136:143], v116
    s_waitcnt vmcnt(1) lgkmcnt(0)
    v_cmp_lt_u32 vcc, s56, v15
    v_smfmac_f32_16x16x64_bf16 v[44:47], v[20:23], a[168:175], v116
    s_cbranch_vccnz L_mret_25
L_mgo_26:
    v_smfmac_f32_16x16x64_bf16 v[44:47], v[4:7], v[24:31], v116
    s_barrier
    ds_read_b128 v[12:15], v117 offset:4096
    v_smfmac_f32_16x16x64_bf16 v[32:35], v[4:7], v[88:95], v116
    ds_read_b128 v[24:27], v117 offset:7168
    v_smfmac_f32_16x16x64_bf16 v[36:39], v[4:7], v[96:103], v116
    ds_read_b128 v[28:31], v117 offset:6144
    v_smfmac_f32_16x16x64_bf16 v[40:43], v[4:7], v[104:111], v116
    ds_read_b128 v[88:91], v117 offset:26624
    s_waitcnt lgkmcnt(3)
    v_smfmac_f32_16x16x64_bf16 v[32:35], v[12:15], a[16:23], v116
    ds_read_b128 v[92:95], v117 offset:27648
    s_waitcnt lgkmcnt(3)
    v_smfmac_f32_16x16x64_bf16 v[32:35], v[24:27], a[48:55], v116
    buffer_load_dwordx4 v117, s[8:11], s30 offen lds
    s_waitcnt lgkmcnt(2)
    v_smfmac_f32_16x16x64_bf16 v[32:35], v[28:31], a[80:87], v116
    ds_read_b128 v[96:99], v117 offset:23552
    v_smfmac_f32_16x16x64_bf16 v[36:39], v[12:15], a[24:31], v116
    ds_read_b128 v[100:103], v117 offset:23552
    v_smfmac_f32_16x16x64_bf16 v[36:39], v[24:27], a[56:63], v116
    buffer_load_dwordx4 v117, s[8:11], s30 offen offset:1024 lds
    s_add_u32 m0, s52, 0x6000
    v_add_f32 v32, v32, v34
    v_smfmac_f32_16x16x64_bf16 v[36:39], v[28:31], a[88:95], v116
    ds_read_b128 v[104:107], v117 offset:23552
    v_add_f32 v33, v33, v35
    v_smfmac_f32_16x16x64_bf16 v[40:43], v[12:15], a[112:119], v116
    ds_read_b128 v[108:111], v117 offset:23552
    v_mul_f32 v32, s34, v32
    v_smfmac_f32_16x16x64_bf16 v[40:43], v[24:27], a[144:151], v116
    buffer_load_dword v125, v119, s[8:11], s28 offen sc1
    v_mul_f32 v33, s34, v33
    v_smfmac_f32_16x16x64_bf16 v[40:43], v[28:31], a[176:183], v116
    ds_read_b128 v[0:3], v124
    v_add_f32 v36, v36, v38
    v_smfmac_f32_16x16x64_bf16 v[48:51], v[4:7], a[208:215], v116
    v_add_f32 v37, v37, v39
    v_smfmac_f32_16x16x64_bf16 v[52:55], v[4:7], a[216:223], v116
    s_waitcnt lgkmcnt(5)
    buffer_load_dwordx4 v117, s[8:11], s31 offen lds
    v_mul_f32 v36, s34, v36
    v_smfmac_f32_16x16x64_bf16 v[44:47], v[12:15], a[120:127], v116
    ds_read_b128 v[4:7], v124 offset:1024
    v_mul_f32 v37, s34, v37
    v_smfmac_f32_16x16x64_bf16 v[44:47], v[24:27], a[152:159], v116
    v_cvt_pk_bf16_f32 v34, v32, v36
    v_smfmac_f32_16x16x64_bf16 v[44:47], v[28:31], a[184:191], v116
    buffer_load_dwordx4 v117, s[8:11], s31 offen offset:1024 lds
    s_mov_b32 m0, 5120
    v_cvt_pk_bf16_f32 v35, v33, v37
    v_add_f32 v40, v40, v42
    v_smfmac_f32_16x16x64_bf16 v[48:51], v[8:11], a[224:231], v116
    ds_write2_b32 v120, v34, v35 offset0:32 offset1:48
    v_add_f32 v41, v41, v43
    v_smfmac_f32_16x16x64_bf16 v[52:55], v[8:11], a[232:239], v116
    v_add_f32 v44, v44, v46
    v_add_f32 v45, v45, v47
    v_cvt_pk_bf16_f32 v113, v40, v44
    v_cvt_pk_bf16_f32 v115, v41, v45
    v_smfmac_f32_16x16x64_bf16 v[48:51], v[12:15], a[240:247], v116
    ds_write2_b32 v120, v113, v115 offset0:0 offset1:16
    v_smfmac_f32_16x16x64_bf16 v[52:55], v[12:15], a[248:255], v116
    s_cmp_eq_u32 s22, 63
    s_cbranch_scc1 L_chain_last_f
    v_smfmac_f32_16x16x64_bf16 v[48:51], v[16:19], v[128:135], v116
    v_smfmac_f32_16x16x64_bf16 v[48:51], v[20:23], v[160:167], v116
    v_smfmac_f32_16x16x64_bf16 v[48:51], v[24:27], v[144:151], v116
    s_waitcnt lgkmcnt(0)
    s_barrier
    v_smfmac_f32_16x16x64_bf16 v[48:51], v[28:31], v[176:183], v116
    ds_read_b128 v[32:35], v121 offset:16384
    ds_read_b128 v[36:39], v121 offset:17408
    v_smfmac_f32_16x16x64_bf16 v[52:55], v[16:19], v[136:143], v116
    ds_read_b128 v[40:43], v121 offset:18432
    ds_read_b128 v[44:47], v121 offset:19456
    v_smfmac_f32_16x16x64_bf16 v[52:55], v[20:23], v[168:175], v116
    ds_read_b128 v[8:11], v124 offset:32768
    v_add_f32 v48, v48, v50
    v_smfmac_f32_16x16x64_bf16 v[52:55], v[24:27], v[152:159], v116
    ds_read_b128 v[12:15], v124 offset:33792
    v_add_f32 v49, v49, v51
    v_smfmac_f32_16x16x64_bf16 v[52:55], v[28:31], v[184:191], v116
    s_waitcnt lgkmcnt(5)
    v_cvt_pk_bf16_f32 v112, v48, v49
    v_mfma_f32_16x16x32_bf16 v[56:59], v[56:59], v[32:35], 0
    s_waitcnt lgkmcnt(4)
    v_mov_b32 v48, s50
    v_mov_b32 v49, s50
    v_mfma_f32_16x16x32_bf16 v[56:59], v[60:63], v[36:39], v[56:59]
    ds_read_b128 v[16:19], v124 offset:2048
    s_waitcnt lgkmcnt(4)
    v_mov_b32 v50, s50
    v_mov_b32 v51, s50
    v_mfma_f32_16x16x32_bf16 v[56:59], v[64:67], v[40:43], v[56:59]
    ds_read_b128 v[20:23], v124 offset:3072
    s_waitcnt lgkmcnt(4)
    v_add_f32 v52, v52, v54
    v_mfma_f32_16x16x32_bf16 v[56:59], v[68:71], v[44:47], v[56:59]
    ds_read_b128 v[24:27], v124 offset:4096
    v_add_f32 v53, v53, v55
    v_mfma_f32_16x16x32_bf16 v[60:63], v[72:75], v[32:35], 0
    ds_read_b128 v[28:31], v124 offset:5120
    v_cvt_pk_bf16_f32 v114, v52, v53
    v_mov_b32 v53, 0
    v_mfma_f32_16x16x32_bf16 v[60:63], v[76:79], v[36:39], v[60:63]
    v_exp_f32 v56, v56
    v_mfma_f32_16x16x32_bf16 v[60:63], v[80:83], v[40:43], v[60:63]
    v_exp_f32 v57, v57
    v_mfma_f32_16x16x32_bf16 v[60:63], v[84:87], v[44:47], v[60:63]
    v_exp_f32 v58, v58
    v_mfma_f32_16x16x32_bf16 v[64:67], v[32:35], v[32:35], 0
    v_exp_f32 v59, v59
    v_cvt_pk_bf16_f32 v68, v56, v57
    v_mfma_f32_16x16x32_bf16 v[64:67], v[36:39], v[36:39], v[64:67]
    v_exp_f32 v60, v60
    v_cvt_pk_bf16_f32 v69, v58, v59
    v_mfma_f32_16x16x32_bf16 v[64:67], v[40:43], v[40:43], v[64:67]
    v_exp_f32 v61, v61
    v_mfma_f32_16x16x32_bf16 v[64:67], v[44:47], v[44:47], v[64:67]
    v_exp_f32 v62, v62
    v_exp_f32 v63, v63
    v_cvt_pk_bf16_f32 v70, v60, v61
    v_cvt_pk_bf16_f32 v71, v62, v63
    s_nop 1
    v_mfma_f32_16x16x32_bf16 v[72:75], v[88:91], v[68:71], 0
    s_nop 0
    v_exp_f32 v64, v64
    v_mfma_f32_16x16x32_bf16 v[76:79], v[92:95], v[68:71], 0
    v_exp_f32 v65, v65
    v_mfma_f32_16x16x32_bf16 v[80:83], v[48:51], v[68:71], 0
    v_cvt_pk_bf16_f32 v52, v64, v65
    s_nop 1
    v_mfma_f32_16x16x16_bf16 v[72:75], v[112:113], v[52:53], v[72:75]
    ds_read_b128 v[32:35], v124 offset:6144
    v_mfma_f32_16x16x16_bf16 v[76:79], v[114:115], v[52:53], v[76:79]
    ds_read_b128 v[36:39], v124 offset:7168
    v_mfma_f32_16x16x16_bf16 v[80:83], v[48:49], v[52:53], v[80:83]
L_norm_27:
    s_mov_b64 vcc, s[36:37]
    v_mov_b32 v122, v122
    v_mov_b32 v122, v122
    v_mov_b32 v122, v122
    v_cndmask_b32_dpp v76, v72, v76, vcc quad_perm:[2,3,2,3] row_mask:0xf bank_mask:0xf
    v_cndmask_b32_dpp v77, v73, v77, vcc quad_perm:[2,3,2,3] row_mask:0xf bank_mask:0xf
    v_cndmask_b32_dpp v78, v74, v78, vcc quad_perm:[2,3,2,3] row_mask:0xf bank_mask:0xf
    v_cndmask_b32_dpp v79, v75, v79, vcc quad_perm:[2,3,2,3] row_mask:0xf bank_mask:0xf
    v_rcp_f32_dpp v84, v80 quad_perm:[2,3,2,3] row_mask:0xf bank_mask:0xf
    s_nop 0
    v_pk_mul_f32 v[76:77], v[76:77], v[84:85] op_sel_hi:[1,0]
    v_pk_mul_f32 v[78:79], v[78:79], v[84:85] op_sel_hi:[1,0]
    v_cvt_pk_bf16_f32 v72, v76, v77
    v_cvt_pk_bf16_f32 v73, v78, v79
    ds_write_b64 v122, v[72:73] offset:20992
    v_max_f32_dpp v86, v80, v84 quad_perm:[2,3,2,3] row_mask:0xf bank_mask:0xf
    v_mov_b32_dpp v60, v72 quad_perm:[0,1,0,1] row_mask:0xf bank_mask:0xf
    v_mov_b32_dpp v61, v73 quad_perm:[0,1,0,1] row_mask:0xf bank_mask:0xf
    v_cmp_lt_f32 vcc, s35, v86
    v_mov_b32_dpp v62, v72 quad_perm:[2,3,2,3] row_mask:0xf bank_mask:0xf
    v_mov_b32_dpp v63, v73 quad_perm:[2,3,2,3] row_mask:0xf bank_mask:0xf
    s_nop 1
    v_smfmac_f32_16x16x64_bf16 v[96:99], v[60:63], v[192:199], v116
    s_cbranch_vccnz L_smax_28
    v_smfmac_f32_16x16x64_bf16 v[100:103], v[60:63], v[224:231], v116
    s_waitcnt lgkmcnt(0)
    s_barrier
    ds_read_b128 v[92:95], v127 offset:20480
    ds_read_b128 v[80:83], v127 offset:22016
    ds_read_b128 v[84:87], v127 offset:21504
    v_smfmac_f32_16x16x64_bf16 v[104:107], v[60:63], v[0:7], v116
    ds_read_b128 v[40:43], v124 offset:34816
    v_smfmac_f32_16x16x64_bf16 v[108:111], v[60:63], v[8:15], v116
    ds_read_b128 v[56:59], v124 offset:36864
    s_waitcnt lgkmcnt(4)
    v_smfmac_f32_16x16x64_bf16 v[96:99], v[92:95], v[200:207], v116
    s_waitcnt lgkmcnt(3)
    v_smfmac_f32_16x16x64_bf16 v[96:99], v[80:83], v[208:215], v116
    ds_read_b128 v[44:47], v124 offset:35840
    s_waitcnt lgkmcnt(3)
    v_smfmac_f32_16x16x64_bf16 v[96:99], v[84:87], v[216:223], v116
    ds_read_b128 v[68:71], v124 offset:39936
    v_smfmac_f32_16x16x64_bf16 v[100:103], v[92:95], v[232:239], v116
    ds_read_b128 v[64:67], v124 offset:38912
    v_smfmac_f32_16x16x64_bf16 v[100:103], v[80:83], v[240:247], v116
    ds_read_b128 v[60:63], v124 offset:37888
    v_cvt_pk_bf16_f32 v72, v96, v98
    v_smfmac_f32_16x16x64_bf16 v[100:103], v[84:87], v[248:255], v116
    v_and_or_b32 v72, v72, -2, s33
    v_smfmac_f32_16x16x64_bf16 v[104:107], v[92:95], v[16:23], v116
    v_cvt_pk_bf16_f32 v74, v97, v99
    v_smfmac_f32_16x16x64_bf16 v[104:107], v[80:83], v[24:31], v116
    v_cvt_pk_bf16_f32 v73, v100, v102
    v_cvt_pk_bf16_f32 v75, v101, v103
    v_smfmac_f32_16x16x64_bf16 v[104:107], v[84:87], v[32:39], v116
    buffer_store_dwordx4 v[72:75], v118, s[8:11], s25 offen
    s_waitcnt lgkmcnt(3)
    v_smfmac_f32_16x16x64_bf16 v[108:111], v[92:95], v[40:47], v116
    s_waitcnt lgkmcnt(0)
    v_smfmac_f32_16x16x64_bf16 v[108:111], v[80:83], v[56:63], v116
    v_cvt_pk_bf16_f32 v76, v104, v106
    v_smfmac_f32_16x16x64_bf16 v[108:111], v[84:87], v[64:71], v116
    v_and_or_b32 v76, v76, -2, s33
    v_cvt_pk_bf16_f32 v78, v105, v107
    v_mov_b32 v122, v122
    v_mov_b32 v122, v122
    v_mov_b32 v122, v122
    v_mov_b32 v122, v122
    v_mov_b32 v122, v122
    v_mov_b32 v122, v122
    v_cvt_pk_bf16_f32 v77, v108, v110
    v_cvt_pk_bf16_f32 v79, v109, v111
    buffer_store_dwordx4 v[76:79], v118, s[8:11], s26 offen
    s_add_u32 s30, s30, 0x40000
    s_add_u32 s31, s31, 0x40000
    s_add_u32 s32, s32, 0x20000
    s_add_u32 s23, s24, 1024
    s_add_u32 s48, s23, 4096
    s_xor_b32 s25, s25, 0x0
    s_xor_b32 s26, s26, 0x0
    s_mov_b32 s35, 0x49800000
    s_add_u32 s22, s22, 1
    v_mov_b32 v32, 0
    v_mov_b32 v33, 0
    v_mov_b32 v34, 0
    v_mov_b32 v35, 0
    v_mov_b32 v36, 0
    v_mov_b32 v37, 0
    v_mov_b32 v38, 0
    v_mov_b32 v39, 0
    v_mov_b32 v40, 0
    v_mov_b32 v41, 0
    v_mov_b32 v42, 0
    v_mov_b32 v43, 0
    v_mov_b32 v44, 0
    v_mov_b32 v45, 0
    v_mov_b32 v46, 0
    v_mov_b32 v47, 0
    v_mov_b32 v48, 0
    v_mov_b32 v49, 0
    v_mov_b32 v50, 0
    v_mov_b32 v51, 0
    v_mov_b32 v52, 0
    v_mov_b32 v53, 0
    v_mov_b32 v54, 0
    v_mov_b32 v55, 0
    ds_read_b128 v[80:83], v123
    ds_read_b128 v[84:87], v123 offset:1024
    ds_read_b128 v[56:59], v123 offset:2048
    ds_read_b128 v[60:63], v123 offset:3072
    ds_read_b128 v[64:67], v123 offset:32768
    ds_read_b128 v[68:71], v123 offset:33792
    ds_read_b128 v[72:75], v123 offset:34816
    ds_read_b128 v[76:79], v123 offset:35840
    ds_read_b128 v[88:91], v123 offset:4096
    ds_read_b128 v[92:95], v123 offset:5120
    ds_read_b128 v[96:99], v123 offset:6144
    ds_read_b128 v[100:103], v123 offset:7168
    ds_read_b128 v[104:107], v123 offset:36864
    ds_read_b128 v[108:111], v123 offset:37888
    ds_read_b128 v[24:27], v123 offset:38912
    ds_read_b128 v[28:31], v123 offset:39936
    s_add_u32 s24, s24, 8192
    s_bitset0_b32 s24, 15
    s_xor_b32 s55, s24, 16384
    s_xor_b32 s29, s29, 0x0
    s_xor_b32 s53, s29, 1024
    s_bfe_u32 s33, s22, 0x10000
    s_add_u32 s40, s22, 5
    s_lshr_b32 s40, s40, 2
    s_min_u32 s40, s40, 16
    s_bfm_b32 s58, s40, 0
    s_waitcnt vmcnt(4)
    v_cmp_eq_u32 vcc, 0, v125
    s_nop 0
    s_and_b64 vcc, vcc, s[58:59]
    s_cbranch_scc1 L_kvw_29
L_kvb_30:
    v_mov_b32 v15, 0
    s_nop 2
    v_mov_b32 v15, 0
    s_nop 2
    v_mov_b32 v15, 0
    s_nop 2
    v_mov_b32 v15, 0
    s_nop 2
    v_mov_b32 v15, 0
    s_nop 2
    v_mov_b32 v15, 0
    s_nop 2
    v_mov_b32 v15, 0
    s_nop 2
    v_mov_b32 v15, 0
    s_nop 2
    v_mov_b32 v15, 0
    s_nop 2
    v_mov_b32 v15, 0
    s_nop 2
    v_mov_b32 v15, 0
    s_nop 2
    v_mov_b32 v15, 0
    s_nop 2
    v_mov_b32 v15, 0
    s_nop 2
    v_mov_b32 v15, 0
    s_nop 2
    v_mov_b32 v15, 0
    s_nop 2
    v_mov_b32 v15, 0
    s_nop 2
    v_mov_b32 v15, 0
    s_nop 2
    v_mov_b32 v15, 0
    s_nop 2
    v_mov_b32 v15, 0
    s_nop 2
    v_mov_b32 v15, 0
    s_nop 2
    v_mov_b32 v15, 0
    s_nop 2
    v_mov_b32 v15, 0
    s_nop 2
    v_mov_b32 v15, 0
    s_nop 2
    v_mov_b32 v15, 0
    s_nop 2
    v_mov_b32 v15, 0
    s_nop 2
    v_mov_b32 v15, 0
    s_nop 2
    v_mov_b32 v15, 0
    s_nop 2
    v_mov_b32 v15, 0
    s_nop 2
    v_mov_b32 v15, 0
    s_nop 2
    v_mov_b32 v15, 0
    s_nop 2
    v_mov_b32 v15, 0
    s_nop 2
    s_waitcnt lgkmcnt(0)
    s_branch L_chain_top1_f
.p2align 6
L_chain_top2_f:
    buffer_load_dwordx4 v[0:3], v117, s[8:11], s23 offen nt
    v_mov_b32 v48, 0
    v_mov_b32 v49, 0
    v_mov_b32 v50, 0
    v_mov_b32 v51, 0
    v_mov_b32 v52, 0
    v_mov_b32 v53, 0
    v_mov_b32 v15, 0
    v_mov_b32 v15, 0
    v_mov_b32 v15, 0
    v_mov_b32 v15, 0
    v_mov_b32 v15, 0
    v_mov_b32 v15, 0
    v_mov_b32 v15, 0
    v_mov_b32 v15, 0
    v_mov_b32 v15, 0
    v_mov_b32 v15, 0
    buffer_load_dwordx4 v[0:3], v117, s[8:11], s23 offen sc1
    s_waitcnt vmcnt(3)
    v_mov_b32 v36, 0
    v_mov_b32 v37, 0
    v_mov_b32 v38, 0
    v_mov_b32 v39, 0
    v_mov_b32 v40, 0
    v_mov_b32 v41, 0
    v_mov_b32 v42, 0
    v_mov_b32 v43, 0
    v_mov_b32 v44, 0
    v_mov_b32 v45, 0
    v_mov_b32 v46, 0
    v_mov_b32 v47, 0
    v_mov_b32 v15, 0
    v_mov_b32 v15, 0
    v_mov_b32 v15, 0
    v_mov_b32 v15, 0
L_mret_31:
    buffer_load_dwordx4 v[0:3], v117, s[8:11], s23 offen sc1
    s_add_u32 s45, s45, 1
    s_cmp_lt_u32 s45, 0x10000
    s_cselect_b32 s56, -2, -1
    s_nop 3
    v_mov_b32 v32, 0
    v_mov_b32 v33, 0
    v_mov_b32 v34, 0
    v_mov_b32 v35, 0
    s_waitcnt vmcnt(2)
    v_max3_u32 v15, v0, v1, v2
    v_max_u32 v15, v15, v3
    v_cmp_lt_u32 vcc, s56, v15
    v_smfmac_f32_16x16x64_bf16 v[32:35], v[0:3], v[80:87], v116
    s_cbranch_vccnz L_mret_31
    ds_write_b128 v117, v[0:3] offset:2048
    v_smfmac_f32_16x16x64_bf16 v[36:39], v[0:3], v[56:63], v116
    buffer_load_dwordx4 v[4:7], v117, s[8:11], s48 offen nt
    v_smfmac_f32_16x16x64_bf16 v[40:43], v[0:3], v[64:71], v116
    buffer_load_dwordx4 v117, s[8:11], s48 offen nt lds
    s_mov_b32 m0, 12288
    v_smfmac_f32_16x16x64_bf16 v[44:47], v[0:3], v[72:79], v116
    s_waitcnt lgkmcnt(0)
    s_barrier
    ds_read_b128 v[8:11], v117 offset:3072
    v_smfmac_f32_16x16x64_bf16 v[48:51], v[0:3], a[192:199], v116
    ds_read_b128 v[16:19], v117
    ds_read_b128 v[20:23], v117 offset:1024
    v_smfmac_f32_16x16x64_bf16 v[52:55], v[0:3], a[200:207], v116
    ds_read_b128 v[80:83], v117 offset:14336
    s_waitcnt lgkmcnt(3)
    v_smfmac_f32_16x16x64_bf16 v[32:35], v[8:11], a[0:7], v116
    ds_read_b128 v[84:87], v117 offset:15360
    v_smfmac_f32_16x16x64_bf16 v[36:39], v[8:11], a[8:15], v116
    ds_read_b128 v[56:59], v117 offset:8192
    s_waitcnt lgkmcnt(4)
    v_smfmac_f32_16x16x64_bf16 v[32:35], v[16:19], a[32:39], v116
    ds_read_b128 v[60:63], v117 offset:9216
    v_smfmac_f32_16x16x64_bf16 v[36:39], v[16:19], a[40:47], v116
    ds_read_b128 v[64:67], v117 offset:10240
    s_waitcnt lgkmcnt(5)
    v_smfmac_f32_16x16x64_bf16 v[32:35], v[20:23], a[64:71], v116
    ds_read_b128 v[68:71], v117 offset:11264
    v_smfmac_f32_16x16x64_bf16 v[36:39], v[20:23], a[72:79], v116
    buffer_store_dwordx4 v[112:115], v117, s[8:11], s32 offen sc1
    v_smfmac_f32_16x16x64_bf16 v[40:43], v[8:11], a[96:103], v116
    ds_read_b128 v[72:75], v117 offset:12288
    v_smfmac_f32_16x16x64_bf16 v[40:43], v[16:19], a[128:135], v116
    ds_read_b128 v[76:79], v117 offset:13312
    v_smfmac_f32_16x16x64_bf16 v[40:43], v[20:23], a[160:167], v116
    s_waitcnt vmcnt(2)
    v_max3_u32 v15, v4, v5, v6
    v_smfmac_f32_16x16x64_bf16 v[44:47], v[8:11], a[104:111], v116
    v_max_u32 v15, v15, v7
    v_smfmac_f32_16x16x64_bf16 v[44:47], v[16:19], a[136:143], v116
    s_waitcnt vmcnt(1) lgkmcnt(0)
    v_cmp_lt_u32 vcc, s56, v15
    v_smfmac_f32_16x16x64_bf16 v[44:47], v[20:23], a[168:175], v116
    s_cbranch_vccnz L_mret_32
L_mgo_33:
    v_smfmac_f32_16x16x64_bf16 v[44:47], v[4:7], v[24:31], v116
    s_barrier
    ds_read_b128 v[12:15], v117 offset:7168
    v_smfmac_f32_16x16x64_bf16 v[32:35], v[4:7], v[88:95], v116
    ds_read_b128 v[24:27], v117 offset:4096
    v_smfmac_f32_16x16x64_bf16 v[36:39], v[4:7], v[96:103], v116
    ds_read_b128 v[28:31], v117 offset:5120
    v_smfmac_f32_16x16x64_bf16 v[40:43], v[4:7], v[104:111], v116
    ds_read_b128 v[88:91], v117 offset:28672
    s_waitcnt lgkmcnt(3)
    v_smfmac_f32_16x16x64_bf16 v[32:35], v[12:15], a[16:23], v116
    ds_read_b128 v[92:95], v117 offset:29696
    s_waitcnt lgkmcnt(3)
    v_smfmac_f32_16x16x64_bf16 v[32:35], v[24:27], a[48:55], v116
    buffer_load_dwordx4 v117, s[8:11], s30 offen lds
    s_waitcnt lgkmcnt(2)
    v_smfmac_f32_16x16x64_bf16 v[32:35], v[28:31], a[80:87], v116
    ds_read_b128 v[96:99], v117 offset:23552
    v_smfmac_f32_16x16x64_bf16 v[36:39], v[12:15], a[24:31], v116
    ds_read_b128 v[100:103], v117 offset:23552
    v_smfmac_f32_16x16x64_bf16 v[36:39], v[24:27], a[56:63], v116
    buffer_load_dwordx4 v117, s[8:11], s30 offen offset:1024 lds
    s_add_u32 m0, s52, 0x6000
    v_add_f32 v32, v32, v34
    v_smfmac_f32_16x16x64_bf16 v[36:39], v[28:31], a[88:95], v116
    ds_read_b128 v[104:107], v117 offset:23552
    v_add_f32 v33, v33, v35
    v_smfmac_f32_16x16x64_bf16 v[40:43], v[12:15], a[112:119], v116
    ds_read_b128 v[108:111], v117 offset:23552
    v_mul_f32 v32, s34, v32
    v_smfmac_f32_16x16x64_bf16 v[40:43], v[24:27], a[144:151], v116
    s_waitcnt lgkmcnt(4)
    buffer_load_dwordx4 v117, s[8:11], s31 offen lds
    v_mul_f32 v33, s34, v33
    v_smfmac_f32_16x16x64_bf16 v[40:43], v[28:31], a[176:183], v116
    ds_read_b128 v[0:3], v124
    v_add_f32 v36, v36, v38
    v_smfmac_f32_16x16x64_bf16 v[48:51], v[4:7], a[208:215], v116
    v_add_f32 v37, v37, v39
    v_smfmac_f32_16x16x64_bf16 v[52:55], v[4:7], a[216:223], v116
    buffer_load_dwordx4 v117, s[8:11], s31 offen offset:1024 lds
    s_mov_b32 m0, 6144
    v_mul_f32 v36, s34, v36
    v_smfmac_f32_16x16x64_bf16 v[44:47], v[12:15], a[120:127], v116
    ds_read_b128 v[4:7], v124 offset:1024
    v_mul_f32 v37, s34, v37
    v_smfmac_f32_16x16x64_bf16 v[44:47], v[24:27], a[152:159], v116
    v_cvt_pk_bf16_f32 v34, v32, v36
    v_smfmac_f32_16x16x64_bf16 v[44:47], v[28:31], a[184:191], v116
    v_cvt_pk_bf16_f32 v35, v33, v37
    v_add_f32 v40, v40, v42
    v_smfmac_f32_16x16x64_bf16 v[48:51], v[8:11], a[224:231], v116
    ds_write2_b32 v120, v34, v35 offset0:32 offset1:48
    v_add_f32 v41, v41, v43
    v_smfmac_f32_16x16x64_bf16 v[52:55], v[8:11], a[232:239], v116
    v_add_f32 v44, v44, v46
    v_add_f32 v45, v45, v47
    v_cvt_pk_bf16_f32 v113, v40, v44
    v_cvt_pk_bf16_f32 v115, v41, v45
    v_smfmac_f32_16x16x64_bf16 v[48:51], v[12:15], a[240:247], v116
    ds_write2_b32 v120, v113, v115 offset0:0 offset1:16
    v_smfmac_f32_16x16x64_bf16 v[52:55], v[12:15], a[248:255], v116
    s_cmp_eq_u32 s22, 63
    s_cbranch_scc1 L_chain_last_f
    v_smfmac_f32_16x16x64_bf16 v[48:51], v[16:19], v[128:135], v116
    buffer_store_dword v126, v119, s[8:11], s55 offen
    v_smfmac_f32_16x16x64_bf16 v[48:51], v[20:23], v[160:167], v116
    v_smfmac_f32_16x16x64_bf16 v[48:51], v[24:27], v[144:151], v116
    s_waitcnt lgkmcnt(0)
    s_barrier
    v_smfmac_f32_16x16x64_bf16 v[48:51], v[28:31], v[176:183], v116
    ds_read_b128 v[32:35], v121 offset:16384
    ds_read_b128 v[36:39], v121 offset:17408
    v_smfmac_f32_16x16x64_bf16 v[52:55], v[16:19], v[136:143], v116
    ds_read_b128 v[40:43], v121 offset:18432
    ds_read_b128 v[44:47], v121 offset:19456
    v_smfmac_f32_16x16x64_bf16 v[52:55], v[20:23], v[168:175], v116
    ds_read_b128 v[8:11], v124 offset:32768
    v_add_f32 v48, v48, v50
    v_smfmac_f32_16x16x64_bf16 v[52:55], v[24:27], v[152:159], v116
    ds_read_b128 v[12:15], v124 offset:33792
    v_add_f32 v49, v49, v51
    v_smfmac_f32_16x16x64_bf16 v[52:55], v[28:31], v[184:191], v116
    s_waitcnt lgkmcnt(5)
    v_cvt_pk_bf16_f32 v112, v48, v49
    v_mfma_f32_16x16x32_bf16 v[56:59], v[56:59], v[32:35], 0
    s_waitcnt lgkmcnt(4)
    v_mov_b32 v48, s50
    v_mov_b32 v49, s50
    v_mfma_f32_16x16x32_bf16 v[56:59], v[60:63], v[36:39], v[56:59]
    ds_read_b128 v[16:19], v124 offset:2048
    s_waitcnt lgkmcnt(4)
    v_mov_b32 v50, s50
    v_mov_b32 v51, s50
    v_mfma_f32_16x16x32_bf16 v[56:59], v[64:67], v[40:43], v[56:59]
    ds_read_b128 v[20:23], v124 offset:3072
    s_waitcnt lgkmcnt(4)
    v_add_f32 v52, v52, v54
    v_mfma_f32_16x16x32_bf16 v[56:59], v[68:71], v[44:47], v[56:59]
    ds_read_b128 v[24:27], v124 offset:4096
    v_add_f32 v53, v53, v55
    v_mfma_f32_16x16x32_bf16 v[60:63], v[72:75], v[32:35], 0
    ds_read_b128 v[28:31], v124 offset:5120
    v_cvt_pk_bf16_f32 v114, v52, v53
    v_mov_b32 v53, 0
    v_mfma_f32_16x16x32_bf16 v[60:63], v[76:79], v[36:39], v[60:63]
    v_exp_f32 v56, v56
    v_mfma_f32_16x16x32_bf16 v[60:63], v[80:83], v[40:43], v[60:63]
    v_exp_f32 v57, v57
    v_mfma_f32_16x16x32_bf16 v[60:63], v[84:87], v[44:47], v[60:63]
    v_exp_f32 v58, v58
    v_mfma_f32_16x16x32_bf16 v[64:67], v[32:35], v[32:35], 0
    v_exp_f32 v59, v59
    v_cvt_pk_bf16_f32 v68, v56, v57
    v_mfma_f32_16x16x32_bf16 v[64:67], v[36:39], v[36:39], v[64:67]
    v_exp_f32 v60, v60
    v_cvt_pk_bf16_f32 v69, v58, v59
    v_mfma_f32_16x16x32_bf16 v[64:67], v[40:43], v[40:43], v[64:67]
    v_exp_f32 v61, v61
    v_mfma_f32_16x16x32_bf16 v[64:67], v[44:47], v[44:47], v[64:67]
    v_exp_f32 v62, v62
    v_exp_f32 v63, v63
    v_cvt_pk_bf16_f32 v70, v60, v61
    v_cvt_pk_bf16_f32 v71, v62, v63
    s_nop 1
    v_mfma_f32_16x16x32_bf16 v[72:75], v[88:91], v[68:71], 0
    s_nop 0
    v_exp_f32 v64, v64
    v_mfma_f32_16x16x32_bf16 v[76:79], v[92:95], v[68:71], 0
    v_exp_f32 v65, v65
    v_mfma_f32_16x16x32_bf16 v[80:83], v[48:51], v[68:71], 0
    v_cvt_pk_bf16_f32 v52, v64, v65
    s_nop 1
    v_mfma_f32_16x16x16_bf16 v[72:75], v[112:113], v[52:53], v[72:75]
    ds_read_b128 v[32:35], v124 offset:6144
    v_mfma_f32_16x16x16_bf16 v[76:79], v[114:115], v[52:53], v[76:79]
    ds_read_b128 v[36:39], v124 offset:7168
    v_mfma_f32_16x16x16_bf16 v[80:83], v[48:49], v[52:53], v[80:83]
L_norm_34:
    s_mov_b64 vcc, s[36:37]
    v_mov_b32 v122, v122
    v_mov_b32 v122, v122
    v_mov_b32 v122, v122
    v_cndmask_b32_dpp v76, v72, v76, vcc quad_perm:[2,3,2,3] row_mask:0xf bank_mask:0xf
    v_cndmask_b32_dpp v77, v73, v77, vcc quad_perm:[2,3,2,3] row_mask:0xf bank_mask:0xf
    v_cndmask_b32_dpp v78, v74, v78, vcc quad_perm:[2,3,2,3] row_mask:0xf bank_mask:0xf
    v_cndmask_b32_dpp v79, v75, v79, vcc quad_perm:[2,3,2,3] row_mask:0xf bank_mask:0xf
    v_rcp_f32_dpp v84, v80 quad_perm:[2,3,2,3] row_mask:0xf bank_mask:0xf
    s_nop 0
    v_pk_mul_f32 v[76:77], v[76:77], v[84:85] op_sel_hi:[1,0]
    v_pk_mul_f32 v[78:79], v[78:79], v[84:85] op_sel_hi:[1,0]
    v_cvt_pk_bf16_f32 v72, v76, v77
    v_cvt_pk_bf16_f32 v73, v78, v79
    ds_write_b64 v122, v[72:73] offset:21504
    v_max_f32_dpp v86, v80, v84 quad_perm:[2,3,2,3] row_mask:0xf bank_mask:0xf
    v_mov_b32_dpp v60, v72 quad_perm:[0,1,0,1] row_mask:0xf bank_mask:0xf
    v_mov_b32_dpp v61, v73 quad_perm:[0,1,0,1] row_mask:0xf bank_mask:0xf
    v_cmp_lt_f32 vcc, s35, v86
    v_mov_b32_dpp v62, v72 quad_perm:[2,3,2,3] row_mask:0xf bank_mask:0xf
    v_mov_b32_dpp v63, v73 quad_perm:[2,3,2,3] row_mask:0xf bank_mask:0xf
    s_nop 1
    v_smfmac_f32_16x16x64_bf16 v[96:99], v[60:63], v[192:199], v116
    s_cbranch_vccnz L_smax_35
    v_smfmac_f32_16x16x64_bf16 v[100:103], v[60:63], v[224:231], v116
    s_waitcnt lgkmcnt(0)
    s_barrier
    ds_read_b128 v[92:95], v127 offset:22016
    ds_read_b128 v[80:83], v127 offset:20480
    ds_read_b128 v[84:87], v127 offset:20992
    v_smfmac_f32_16x16x64_bf16 v[104:107], v[60:63], v[0:7], v116
    ds_read_b128 v[40:43], v124 offset:34816
    v_smfmac_f32_16x16x64_bf16 v[108:111], v[60:63], v[8:15], v116
    ds_read_b128 v[56:59], v124 offset:36864
    s_waitcnt lgkmcnt(4)
    v_smfmac_f32_16x16x64_bf16 v[96:99], v[92:95], v[200:207], v116
    s_waitcnt lgkmcnt(3)
    v_smfmac_f32_16x16x64_bf16 v[96:99], v[80:83], v[208:215], v116
    ds_read_b128 v[44:47], v124 offset:35840
    s_waitcnt lgkmcnt(3)
    v_smfmac_f32_16x16x64_bf16 v[96:99], v[84:87], v[216:223], v116
    ds_read_b128 v[68:71], v124 offset:39936
    v_smfmac_f32_16x16x64_bf16 v[100:103], v[92:95], v[232:239], v116
    ds_read_b128 v[64:67], v124 offset:38912
    v_smfmac_f32_16x16x64_bf16 v[100:103], v[80:83], v[240:247], v116
    ds_read_b128 v[60:63], v124 offset:37888
    v_cvt_pk_bf16_f32 v72, v96, v98
    v_smfmac_f32_16x16x64_bf16 v[100:103], v[84:87], v[248:255], v116
    v_and_or_b32 v72, v72, -2, s33
    v_smfmac_f32_16x16x64_bf16 v[104:107], v[92:95], v[16:23], v116
    v_cvt_pk_bf16_f32 v74, v97, v99
    v_smfmac_f32_16x16x64_bf16 v[104:107], v[80:83], v[24:31], v116
    v_cvt_pk_bf16_f32 v73, v100, v102
    v_cvt_pk_bf16_f32 v75, v101, v103
    v_smfmac_f32_16x16x64_bf16 v[104:107], v[84:87], v[32:39], v116
    buffer_store_dwordx4 v[72:75], v118, s[8:11], s25 offen
    s_waitcnt lgkmcnt(3)
    v_smfmac_f32_16x16x64_bf16 v[108:111], v[92:95], v[40:47], v116
    s_waitcnt lgkmcnt(0)
    v_smfmac_f32_16x16x64_bf16 v[108:111], v[80:83], v[56:63], v116
    v_cvt_pk_bf16_f32 v76, v104, v106
    v_smfmac_f32_16x16x64_bf16 v[108:111], v[84:87], v[64:71], v116
    v_and_or_b32 v76, v76, -2, s33
    v_cvt_pk_bf16_f32 v78, v105, v107
    v_mov_b32 v122, v122
    v_mov_b32 v122, v122
    v_mov_b32 v122, v122
    v_mov_b32 v122, v122
    v_mov_b32 v122, v122
    v_mov_b32 v122, v122
    v_cvt_pk_bf16_f32 v77, v108, v110
    v_cvt_pk_bf16_f32 v79, v109, v111
    buffer_store_dwordx4 v[76:79], v118, s[8:11], s26 offen
    ds_read_b128 v[80:83], v123
    ds_read_b128 v[84:87], v123 offset:1024
    ds_read_b128 v[56:59], v123 offset:2048
    ds_read_b128 v[60:63], v123 offset:3072
    ds_read_b128 v[64:67], v123 offset:32768
    ds_read_b128 v[68:71], v123 offset:33792
    ds_read_b128 v[72:75], v123 offset:34816
    ds_read_b128 v[76:79], v123 offset:35840
    ds_read_b128 v[88:91], v123 offset:4096
    ds_read_b128 v[92:95], v123 offset:5120
    ds_read_b128 v[96:99], v123 offset:6144
    ds_read_b128 v[100:103], v123 offset:7168
    ds_read_b128 v[104:107], v123 offset:36864
    ds_read_b128 v[108:111], v123 offset:37888
    ds_read_b128 v[24:27], v123 offset:38912
    ds_read_b128 v[28:31], v123 offset:39936
    s_add_u32 s30, s30, 0x40000
    s_add_u32 s31, s31, 0x40000
    s_add_u32 s32, s32, 0x20000
    s_add_u32 s23, s24, 2048
    s_add_u32 s48, s23, 4096
    s_xor_b32 s25, s25, 0x0
    s_xor_b32 s26, s26, 0x0
    s_mov_b32 s35, 0x49800000
    s_add_u32 s22, s22, 1
    v_cndmask_b32 v12, 0, v125, s[68:69]
    v_cndmask_b32 v13, 0, v125, s[70:71]
    v_cndmask_b32 v14, 0, v125, s[72:73]
    v_cndmask_b32 v15, 0, v125, s[74:75]
    v_mov_b32 v54, 0
    v_mov_b32 v55, 0
    v_mov_b32 v52, 0
    v_mov_b32 v52, 0
    v_mov_b32 v52, 0
    v_mov_b32 v52, 0
    v_mov_b32 v52, 0
    v_mov_b32 v52, 0
    v_mov_b32 v52, 0
    v_mov_b32 v52, 0
    v_mov_b32 v52, 0
    v_mov_b32 v52, 0
    v_mov_b32 v52, 0
    v_mov_b32 v52, 0
    v_mov_b32 v52, 0
    v_mov_b32 v52, 0
    v_mov_b32 v52, 0
    v_mov_b32 v52, 0
    v_mov_b32 v52, 0
    v_mov_b32 v52, 0
    v_mov_b32 v52, 0
    buffer_load_dwordx4 v[4:7], v117, s[8:11], s29 offen sc1
    buffer_load_dwordx4 v[8:11], v117, s[8:11], s53 offen sc1
    buffer_load_dwordx4 v[16:19], v117, s[8:11], s29 offen offset:2048 sc1
    buffer_load_dwordx4 v[20:23], v117, s[8:11], s53 offen offset:2048 sc1
    v_mov_b32 v52, 0
    v_mov_b32 v52, 0
    v_mov_b32 v52, 0
    v_mov_b32 v52, 0
    v_mov_b32 v52, 0
    v_mov_b32 v52, 0
    v_mov_b32 v52, 0
    v_mov_b32 v52, 0
    v_mov_b32 v52, 0
    v_mov_b32 v52, 0
    v_mov_b32 v52, 0
    v_mov_b32 v52, 0
    v_mov_b32 v52, 0
    v_mov_b32 v52, 0
    v_mov_b32 v52, 0
    v_mov_b32 v52, 0
    v_mov_b32 v52, 0
    v_mov_b32 v52, 0
    v_mov_b32 v52, 0
    v_mov_b32 v52, 0
    v_mov_b32 v52, 0
    v_mov_b32 v52, 0
    v_mov_b32 v52, 0
    v_mov_b32 v52, 0
    v_mov_b32 v52, 0
    v_mov_b32 v52, 0
    v_mov_b32 v52, 0
    v_mov_b32 v52, 0
    v_mov_b32 v52, 0
    v_mov_b32 v52, 0
    v_mov_b32 v52, 0
    v_mov_b32 v52, 0
    v_mov_b32 v52, 0
    v_mov_b32 v52, 0
    v_mov_b32 v52, 0
    v_mov_b32 v52, 0
    v_mov_b32 v52, 0
    v_mov_b32 v52, 0
    v_mov_b32 v52, 0
    v_mov_b32 v52, 0
    buffer_load_dwordx4 v[32:35], v117, s[8:11], s29 offen sc1
    buffer_load_dwordx4 v[36:39], v117, s[8:11], s53 offen sc1
    buffer_load_dwordx4 v[40:43], v117, s[8:11], s29 offen offset:2048 sc1
    buffer_load_dwordx4 v[44:47], v117, s[8:11], s53 offen offset:2048 sc1
    v_mov_b32 v52, 0
L_rl_36:
    s_waitcnt vmcnt(7)
    v_mfma_f32_16x16x32_bf16 v[48:51], v[4:7], v[12:15], 0
    v_xor_b32 v52, s33, v4
    s_waitcnt vmcnt(6)
    v_mfma_f32_16x16x32_bf16 v[48:51], v[8:11], v[12:15], v[48:51]
    v_xor_b32 v53, s33, v8
    v_or_b32 v52, v52, v53
    s_waitcnt vmcnt(5)
    v_mfma_f32_16x16x32_bf16 v[48:51], v[16:19], v[12:15], v[48:51]
    v_xor_b32 v53, s33, v16
    v_or_b32 v52, v52, v53
    s_waitcnt vmcnt(4)
    v_mfma_f32_16x16x32_bf16 v[48:51], v[20:23], v[12:15], v[48:51]
    v_xor_b32 v53, s33, v20
    v_or_b32 v52, v52, v53
    v_and_b32 v52, 1, v52
    v_cmp_ne_u32 vcc, 0, v52
    s_cbranch_vccnz L_rslow_37
L_rgo_38:
    s_nop 2
    v_permlane32_swap_b32 v48, v50
    v_permlane32_swap_b32 v49, v51
    v_pk_add_f32 v[48:49], v[48:49], v[50:51]
    s_mov_b64 exec, s[38:39]
    v_cvt_pk_bf16_f32 v12, v48, v49
    v_min_u32 v12, 0xfffffffe, v12
    buffer_store_dword v12, v119, s[8:11], s24 offen
    s_mov_b64 exec, -1
    s_add_u32 s24, s24, 8192
    s_bitset0_b32 s24, 15
    s_xor_b32 s55, s24, 16384
    s_xor_b32 s29, s29, 0x0
    s_xor_b32 s53, s29, 1024
    s_bfe_u32 s33, s22, 0x10000
    s_waitcnt lgkmcnt(0)
    s_branch L_chain_top2_f
.p2align 6
L_chain_top3_f:
    buffer_load_dwordx4 v[0:3], v117, s[8:11], s23 offen nt
    v_mov_b32 v48, 0
    v_mov_b32 v49, 0
    v_mov_b32 v50, 0
    v_mov_b32 v51, 0
    v_mov_b32 v52, 0
    v_mov_b32 v53, 0
    v_mov_b32 v15, 0
    v_mov_b32 v15, 0
    v_mov_b32 v15, 0
    v_mov_b32 v15, 0
    v_mov_b32 v15, 0
    v_mov_b32 v15, 0
    v_mov_b32 v15, 0
    v_mov_b32 v15, 0
    v_mov_b32 v15, 0
    v_mov_b32 v15, 0
    buffer_load_dwordx4 v[0:3], v117, s[8:11], s23 offen sc1
    s_waitcnt vmcnt(3)
    v_mov_b32 v36, 0
    v_mov_b32 v37, 0
    v_mov_b32 v38, 0
    v_mov_b32 v39, 0
    v_mov_b32 v40, 0
    v_mov_b32 v41, 0
    v_mov_b32 v42, 0
    v_mov_b32 v43, 0
    v_mov_b32 v44, 0
    v_mov_b32 v45, 0
    v_mov_b32 v46, 0
    v_mov_b32 v47, 0
    v_mov_b32 v15, 0
    v_mov_b32 v15, 0
    v_mov_b32 v15, 0
    v_mov_b32 v15, 0
L_mret_39:
    buffer_load_dwordx4 v[0:3], v117, s[8:11], s23 offen sc1
    s_add_u32 s45, s45, 1
    s_cmp_lt_u32 s45, 0x10000
    s_cselect_b32 s56, -2, -1
    s_nop 3
    v_mov_b32 v32, 0
    v_mov_b32 v33, 0
    v_mov_b32 v34, 0
    v_mov_b32 v35, 0
    s_waitcnt vmcnt(2)
    v_max3_u32 v15, v0, v1, v2
    v_max_u32 v15, v15, v3
    v_cmp_lt_u32 vcc, s56, v15
    v_smfmac_f32_16x16x64_bf16 v[32:35], v[0:3], v[80:87], v116
    s_cbranch_vccnz L_mret_39
    ds_write_b128 v117, v[0:3] offset:3072
    v_smfmac_f32_16x16x64_bf16 v[36:39], v[0:3], v[56:63], v116
    buffer_load_dwordx4 v[4:7], v117, s[8:11], s48 offen nt
    v_smfmac_f32_16x16x64_bf16 v[40:43], v[0:3], v[64:71], v116
    buffer_load_dwordx4 v117, s[8:11], s48 offen nt lds
    s_mov_b32 m0, 14336
    v_smfmac_f32_16x16x64_bf16 v[44:47], v[0:3], v[72:79], v116
    s_waitcnt lgkmcnt(0)
    s_barrier
    ds_read_b128 v[8:11], v117 offset:2048
    v_smfmac_f32_16x16x64_bf16 v[48:51], v[0:3], a[192:199], v116
    ds_read_b128 v[16:19], v117 offset:1024
    ds_read_b128 v[20:23], v117
    v_smfmac_f32_16x16x64_bf16 v[52:55], v[0:3], a[200:207], v116
    ds_read_b128 v[80:83], v117 offset:14336
    s_waitcnt lgkmcnt(3)
    v_smfmac_f32_16x16x64_bf16 v[32:35], v[8:11], a[0:7], v116
    ds_read_b128 v[84:87], v117 offset:15360
    v_smfmac_f32_16x16x64_bf16 v[36:39], v[8:11], a[8:15], v116
    ds_read_b128 v[56:59], v117 offset:8192
    s_waitcnt lgkmcnt(4)
    v_smfmac_f32_16x16x64_bf16 v[32:35], v[16:19], a[32:39], v116
    ds_read_b128 v[60:63], v117 offset:9216
    v_smfmac_f32_16x16x64_bf16 v[36:39], v[16:19], a[40:47], v116
    ds_read_b128 v[64:67], v117 offset:10240
    s_waitcnt lgkmcnt(5)
    v_smfmac_f32_16x16x64_bf16 v[32:35], v[20:23], a[64:71], v116
    ds_read_b128 v[68:71], v117 offset:11264
    v_smfmac_f32_16x16x64_bf16 v[36:39], v[20:23], a[72:79], v116
    ds_read_b128 v[72:75], v117 offset:12288
    v_smfmac_f32_16x16x64_bf16 v[40:43], v[8:11], a[96:103], v116
    ds_read_b128 v[76:79], v117 offset:13312
    v_smfmac_f32_16x16x64_bf16 v[40:43], v[16:19], a[128:135], v116
    buffer_store_dwordx4 v[112:115], v117, s[8:11], s32 offen sc1
    v_smfmac_f32_16x16x64_bf16 v[40:43], v[20:23], a[160:167], v116
    s_waitcnt vmcnt(2)
    v_max3_u32 v15, v4, v5, v6
    v_smfmac_f32_16x16x64_bf16 v[44:47], v[8:11], a[104:111], v116
    v_max_u32 v15, v15, v7
    v_smfmac_f32_16x16x64_bf16 v[44:47], v[16:19], a[136:143], v116
    s_waitcnt vmcnt(1) lgkmcnt(0)
    v_cmp_lt_u32 vcc, s56, v15
    v_smfmac_f32_16x16x64_bf16 v[44:47], v[20:23], a[168:175], v116
    s_cbranch_vccnz L_mret_40
L_mgo_41:
    v_smfmac_f32_16x16x64_bf16 v[44:47], v[4:7], v[24:31], v116
    s_barrier
    ds_read_b128 v[12:15], v117 offset:6144
    v_smfmac_f32_16x16x64_bf16 v[32:35], v[4:7], v[88:95], v116
    ds_read_b128 v[24:27], v117 offset:5120
    v_smfmac_f32_16x16x64_bf16 v[36:39], v[4:7], v[96:103], v116
    ds_read_b128 v[28:31], v117 offset:4096
    v_smfmac_f32_16x16x64_bf16 v[40:43], v[4:7], v[104:111], v116
    ds_read_b128 v[88:91], v117 offset:30720
    s_waitcnt lgkmcnt(3)
    v_smfmac_f32_16x16x64_bf16 v[32:35], v[12:15], a[16:23], v116
    ds_read_b128 v[92:95], v117 offset:31744
    s_waitcnt lgkmcnt(3)
    v_smfmac_f32_16x16x64_bf16 v[32:35], v[24:27], a[48:55], v116
    ds_read_b128 v[96:99], v117 offset:23552
    s_waitcnt lgkmcnt(3)
    v_smfmac_f32_16x16x64_bf16 v[32:35], v[28:31], a[80:87], v116
    buffer_load_dwordx4 v117, s[8:11], s30 offen lds
    v_smfmac_f32_16x16x64_bf16 v[36:39], v[12:15], a[24:31], v116
    ds_read_b128 v[100:103], v117 offset:23552
    v_smfmac_f32_16x16x64_bf16 v[36:39], v[24:27], a[56:63], v116
    ds_read_b128 v[104:107], v117 offset:23552
    v_add_f32 v32, v32, v34
    v_smfmac_f32_16x16x64_bf16 v[36:39], v[28:31], a[88:95], v116
    buffer_load_dwordx4 v117, s[8:11], s30 offen offset:1024 lds
    s_add_u32 m0, s52, 0x6000
    v_add_f32 v33, v33, v35
    v_smfmac_f32_16x16x64_bf16 v[40:43], v[12:15], a[112:119], v116
    ds_read_b128 v[108:111], v117 offset:23552
    v_mul_f32 v32, s34, v32
    v_smfmac_f32_16x16x64_bf16 v[40:43], v[24:27], a[144:151], v116
    ds_read_b128 v[0:3], v124
    v_mul_f32 v33, s34, v33
    v_smfmac_f32_16x16x64_bf16 v[40:43], v[28:31], a[176:183], v116
    s_waitcnt lgkmcnt(5)
    buffer_load_dwordx4 v117, s[8:11], s31 offen lds
    v_add_f32 v36, v36, v38
    v_smfmac_f32_16x16x64_bf16 v[48:51], v[4:7], a[208:215], v116
    v_add_f32 v37, v37, v39
    v_smfmac_f32_16x16x64_bf16 v[52:55], v[4:7], a[216:223], v116
    ds_read_b128 v[4:7], v124 offset:1024
    v_mul_f32 v36, s34, v36
    v_smfmac_f32_16x16x64_bf16 v[44:47], v[12:15], a[120:127], v116
    buffer_load_dwordx4 v117, s[8:11], s31 offen offset:1024 lds
    s_mov_b32 m0, 7168
    v_mul_f32 v37, s34, v37
    v_smfmac_f32_16x16x64_bf16 v[44:47], v[24:27], a[152:159], v116
    v_cvt_pk_bf16_f32 v34, v32, v36
    v_smfmac_f32_16x16x64_bf16 v[44:47], v[28:31], a[184:191], v116
    v_cvt_pk_bf16_f32 v35, v33, v37
    v_add_f32 v40, v40, v42
    v_smfmac_f32_16x16x64_bf16 v[48:51], v[8:11], a[224:231], v116
    ds_write2_b32 v120, v34, v35 offset0:32 offset1:48
    v_add_f32 v41, v41, v43
    v_smfmac_f32_16x16x64_bf16 v[52:55], v[8:11], a[232:239], v116
    v_add_f32 v44, v44, v46
    v_add_f32 v45, v45, v47
    v_cvt_pk_bf16_f32 v113, v40, v44
    v_cvt_pk_bf16_f32 v115, v41, v45
    v_smfmac_f32_16x16x64_bf16 v[48:51], v[12:15], a[240:247], v116
    ds_write2_b32 v120, v113, v115 offset0:0 offset1:16
    v_smfmac_f32_16x16x64_bf16 v[52:55], v[12:15], a[248:255], v116
    s_cmp_eq_u32 s22, 63
    s_cbranch_scc1 L_chain_last_f
    v_smfmac_f32_16x16x64_bf16 v[48:51], v[16:19], v[128:135], v116
    v_smfmac_f32_16x16x64_bf16 v[48:51], v[20:23], v[160:167], v116
    buffer_store_dword v126, v119, s[8:11], s55 offen
    v_smfmac_f32_16x16x64_bf16 v[48:51], v[24:27], v[144:151], v116
    s_waitcnt lgkmcnt(0)
    s_barrier
    v_smfmac_f32_16x16x64_bf16 v[48:51], v[28:31], v[176:183], v116
    ds_read_b128 v[32:35], v121 offset:16384
    ds_read_b128 v[36:39], v121 offset:17408
    v_smfmac_f32_16x16x64_bf16 v[52:55], v[16:19], v[136:143], v116
    ds_read_b128 v[40:43], v121 offset:18432
    ds_read_b128 v[44:47], v121 offset:19456
    v_smfmac_f32_16x16x64_bf16 v[52:55], v[20:23], v[168:175], v116
    ds_read_b128 v[8:11], v124 offset:32768
    v_add_f32 v48, v48, v50
    v_smfmac_f32_16x16x64_bf16 v[52:55], v[24:27], v[152:159], v116
    ds_read_b128 v[12:15], v124 offset:33792
    v_add_f32 v49, v49, v51
    v_smfmac_f32_16x16x64_bf16 v[52:55], v[28:31], v[184:191], v116
    s_waitcnt lgkmcnt(5)
    v_cvt_pk_bf16_f32 v112, v48, v49
    v_mfma_f32_16x16x32_bf16 v[56:59], v[56:59], v[32:35], 0
    s_waitcnt lgkmcnt(4)
    v_mov_b32 v48, s50
    v_mov_b32 v49, s50
    v_mfma_f32_16x16x32_bf16 v[56:59], v[60:63], v[36:39], v[56:59]
    ds_read_b128 v[16:19], v124 offset:2048
    s_waitcnt lgkmcnt(4)
    v_mov_b32 v50, s50
    v_mov_b32 v51, s50
    v_mfma_f32_16x16x32_bf16 v[56:59], v[64:67], v[40:43], v[56:59]
    ds_read_b128 v[20:23], v124 offset:3072
    s_waitcnt lgkmcnt(4)
    v_add_f32 v52, v52, v54
    v_mfma_f32_16x16x32_bf16 v[56:59], v[68:71], v[44:47], v[56:59]
    ds_read_b128 v[24:27], v124 offset:4096
    v_add_f32 v53, v53, v55
    v_mfma_f32_16x16x32_bf16 v[60:63], v[72:75], v[32:35], 0
    ds_read_b128 v[28:31], v124 offset:5120
    v_cvt_pk_bf16_f32 v114, v52, v53
    v_mov_b32 v53, 0
    v_mfma_f32_16x16x32_bf16 v[60:63], v[76:79], v[36:39], v[60:63]
    v_exp_f32 v56, v56
    v_mfma_f32_16x16x32_bf16 v[60:63], v[80:83], v[40:43], v[60:63]
    v_exp_f32 v57, v57
    v_mfma_f32_16x16x32_bf16 v[60:63], v[84:87], v[44:47], v[60:63]
    v_exp_f32 v58, v58
    v_mfma_f32_16x16x32_bf16 v[64:67], v[32:35], v[32:35], 0
    v_exp_f32 v59, v59
    v_cvt_pk_bf16_f32 v68, v56, v57
    v_mfma_f32_16x16x32_bf16 v[64:67], v[36:39], v[36:39], v[64:67]
    v_exp_f32 v60, v60
    v_cvt_pk_bf16_f32 v69, v58, v59
    v_mfma_f32_16x16x32_bf16 v[64:67], v[40:43], v[40:43], v[64:67]
    v_exp_f32 v61, v61
    v_mfma_f32_16x16x32_bf16 v[64:67], v[44:47], v[44:47], v[64:67]
    v_exp_f32 v62, v62
    v_exp_f32 v63, v63
    v_cvt_pk_bf16_f32 v70, v60, v61
    v_cvt_pk_bf16_f32 v71, v62, v63
    s_nop 1
    v_mfma_f32_16x16x32_bf16 v[72:75], v[88:91], v[68:71], 0
    s_nop 0
    v_exp_f32 v64, v64
    v_mfma_f32_16x16x32_bf16 v[76:79], v[92:95], v[68:71], 0
    v_exp_f32 v65, v65
    v_mfma_f32_16x16x32_bf16 v[80:83], v[48:51], v[68:71], 0
    v_cvt_pk_bf16_f32 v52, v64, v65
    s_nop 1
    v_mfma_f32_16x16x16_bf16 v[72:75], v[112:113], v[52:53], v[72:75]
    ds_read_b128 v[32:35], v124 offset:6144
    v_mfma_f32_16x16x16_bf16 v[76:79], v[114:115], v[52:53], v[76:79]
    ds_read_b128 v[36:39], v124 offset:7168
    v_mfma_f32_16x16x16_bf16 v[80:83], v[48:49], v[52:53], v[80:83]
L_norm_42:
    s_mov_b64 vcc, s[36:37]
    v_mov_b32 v122, v122
    v_mov_b32 v122, v122
    v_mov_b32 v122, v122
    v_cndmask_b32_dpp v76, v72, v76, vcc quad_perm:[2,3,2,3] row_mask:0xf bank_mask:0xf
    v_cndmask_b32_dpp v77, v73, v77, vcc quad_perm:[2,3,2,3] row_mask:0xf bank_mask:0xf
    v_cndmask_b32_dpp v78, v74, v78, vcc quad_perm:[2,3,2,3] row_mask:0xf bank_mask:0xf
    v_cndmask_b32_dpp v79, v75, v79, vcc quad_perm:[2,3,2,3] row_mask:0xf bank_mask:0xf
    v_rcp_f32_dpp v84, v80 quad_perm:[2,3,2,3] row_mask:0xf bank_mask:0xf
    s_nop 0
    v_pk_mul_f32 v[76:77], v[76:77], v[84:85] op_sel_hi:[1,0]
    v_pk_mul_f32 v[78:79], v[78:79], v[84:85] op_sel_hi:[1,0]
    v_cvt_pk_bf16_f32 v72, v76, v77
    v_cvt_pk_bf16_f32 v73, v78, v79
    ds_write_b64 v122, v[72:73] offset:22016
    v_max_f32_dpp v86, v80, v84 quad_perm:[2,3,2,3] row_mask:0xf bank_mask:0xf
    v_mov_b32_dpp v60, v72 quad_perm:[0,1,0,1] row_mask:0xf bank_mask:0xf
    v_mov_b32_dpp v61, v73 quad_perm:[0,1,0,1] row_mask:0xf bank_mask:0xf
    v_cmp_lt_f32 vcc, s35, v86
    v_mov_b32_dpp v62, v72 quad_perm:[2,3,2,3] row_mask:0xf bank_mask:0xf
    v_mov_b32_dpp v63, v73 quad_perm:[2,3,2,3] row_mask:0xf bank_mask:0xf
    s_nop 1
    v_smfmac_f32_16x16x64_bf16 v[96:99], v[60:63], v[192:199], v116
    s_cbranch_vccnz L_smax_43
    v_smfmac_f32_16x16x64_bf16 v[100:103], v[60:63], v[224:231], v116
    s_waitcnt lgkmcnt(0)
    s_barrier
    ds_read_b128 v[92:95], v127 offset:21504
    ds_read_b128 v[80:83], v127 offset:20992
    ds_read_b128 v[84:87], v127 offset:20480
    v_smfmac_f32_16x16x64_bf16 v[104:107], v[60:63], v[0:7], v116
    ds_read_b128 v[40:43], v124 offset:34816
    v_smfmac_f32_16x16x64_bf16 v[108:111], v[60:63], v[8:15], v116
    ds_read_b128 v[56:59], v124 offset:36864
    s_waitcnt lgkmcnt(4)
    v_smfmac_f32_16x16x64_bf16 v[96:99], v[92:95], v[200:207], v116
    s_waitcnt lgkmcnt(3)
    v_smfmac_f32_16x16x64_bf16 v[96:99], v[80:83], v[208:215], v116
    ds_read_b128 v[44:47], v124 offset:35840
    s_waitcnt lgkmcnt(3)
    v_smfmac_f32_16x16x64_bf16 v[96:99], v[84:87], v[216:223], v116
    ds_read_b128 v[68:71], v124 offset:39936
    v_smfmac_f32_16x16x64_bf16 v[100:103], v[92:95], v[232:239], v116
    ds_read_b128 v[64:67], v124 offset:38912
    v_smfmac_f32_16x16x64_bf16 v[100:103], v[80:83], v[240:247], v116
    ds_read_b128 v[60:63], v124 offset:37888
    v_cvt_pk_bf16_f32 v72, v96, v98
    v_smfmac_f32_16x16x64_bf16 v[100:103], v[84:87], v[248:255], v116
    v_and_or_b32 v72, v72, -2, s33
    v_smfmac_f32_16x16x64_bf16 v[104:107], v[92:95], v[16:23], v116
    v_cvt_pk_bf16_f32 v74, v97, v99
    v_smfmac_f32_16x16x64_bf16 v[104:107], v[80:83], v[24:31], v116
    v_cvt_pk_bf16_f32 v73, v100, v102
    v_cvt_pk_bf16_f32 v75, v101, v103
    v_smfmac_f32_16x16x64_bf16 v[104:107], v[84:87], v[32:39], v116
    buffer_store_dwordx4 v[72:75], v118, s[8:11], s25 offen
    s_waitcnt lgkmcnt(3)
    v_smfmac_f32_16x16x64_bf16 v[108:111], v[92:95], v[40:47], v116
    s_waitcnt lgkmcnt(0)
    v_smfmac_f32_16x16x64_bf16 v[108:111], v[80:83], v[56:63], v116
    v_cvt_pk_bf16_f32 v76, v104, v106
    v_smfmac_f32_16x16x64_bf16 v[108:111], v[84:87], v[64:71], v116
    v_and_or_b32 v76, v76, -2, s33
    v_cvt_pk_bf16_f32 v78, v105, v107
    v_mov_b32 v122, v122
    v_mov_b32 v122, v122
    v_mov_b32 v122, v122
    v_mov_b32 v122, v122
    v_mov_b32 v122, v122
    v_mov_b32 v122, v122
    v_cvt_pk_bf16_f32 v77, v108, v110
    v_cvt_pk_bf16_f32 v79, v109, v111
    buffer_store_dwordx4 v[76:79], v118, s[8:11], s26 offen
    ds_read_b128 v[80:83], v123
    ds_read_b128 v[84:87], v123 offset:1024
    ds_read_b128 v[56:59], v123 offset:2048
    ds_read_b128 v[60:63], v123 offset:3072
    ds_read_b128 v[64:67], v123 offset:32768
    ds_read_b128 v[68:71], v123 offset:33792
    ds_read_b128 v[72:75], v123 offset:34816
    ds_read_b128 v[76:79], v123 offset:35840
    ds_read_b128 v[88:91], v123 offset:4096
    ds_read_b128 v[92:95], v123 offset:5120
    ds_read_b128 v[96:99], v123 offset:6144
    ds_read_b128 v[100:103], v123 offset:7168
    ds_read_b128 v[104:107], v123 offset:36864
    ds_read_b128 v[108:111], v123 offset:37888
    ds_read_b128 v[24:27], v123 offset:38912
    ds_read_b128 v[28:31], v123 offset:39936
    s_add_u32 s30, s30, 0x40000
    s_add_u32 s31, s31, 0x40000
    s_add_u32 s32, s32, 0x20000
    s_add_u32 s23, s24, 3072
    s_add_u32 s48, s23, 4096
    s_xor_b32 s25, s25, 0x0
    s_xor_b32 s26, s26, 0x0
    s_mov_b32 s35, 0x49800000
    s_add_u32 s22, s22, 1
    v_cndmask_b32 v12, 0, v125, s[68:69]
    v_cndmask_b32 v13, 0, v125, s[70:71]
    v_cndmask_b32 v14, 0, v125, s[72:73]
    v_cndmask_b32 v15, 0, v125, s[74:75]
    v_mov_b32 v54, 0
    v_mov_b32 v55, 0
    v_mov_b32 v52, 0
    v_mov_b32 v52, 0
    v_mov_b32 v52, 0
    v_mov_b32 v52, 0
    v_mov_b32 v52, 0
    v_mov_b32 v52, 0
    v_mov_b32 v52, 0
    v_mov_b32 v52, 0
    v_mov_b32 v52, 0
    v_mov_b32 v52, 0
    v_mov_b32 v52, 0
    v_mov_b32 v52, 0
    v_mov_b32 v52, 0
    v_mov_b32 v52, 0
    v_mov_b32 v52, 0
    v_mov_b32 v52, 0
    v_mov_b32 v52, 0
    v_mov_b32 v52, 0
    v_mov_b32 v52, 0
    v_mov_b32 v52, 0
    v_mov_b32 v52, 0
    v_mov_b32 v52, 0
    v_mov_b32 v52, 0
    v_mov_b32 v52, 0
    v_mov_b32 v52, 0
    v_mov_b32 v52, 0
    v_mov_b32 v52, 0
    v_mov_b32 v52, 0
    v_mov_b32 v52, 0
    v_mov_b32 v52, 0
    v_mov_b32 v52, 0
    v_mov_b32 v52, 0
    v_mov_b32 v52, 0
    v_mov_b32 v52, 0
    v_mov_b32 v52, 0
    v_mov_b32 v52, 0
    v_mov_b32 v52, 0
    v_mov_b32 v52, 0
    v_mov_b32 v52, 0
    v_mov_b32 v52, 0
    v_mov_b32 v52, 0
    v_mov_b32 v52, 0
    v_mov_b32 v52, 0
    v_mov_b32 v52, 0
    v_mov_b32 v52, 0
    v_mov_b32 v52, 0
    v_mov_b32 v52, 0
    v_mov_b32 v52, 0
    v_mov_b32 v52, 0
    buffer_load_dwordx4 v[4:7], v117, s[8:11], s29 offen sc1
    buffer_load_dwordx4 v[8:11], v117, s[8:11], s53 offen sc1
    buffer_load_dwordx4 v[16:19], v117, s[8:11], s29 offen offset:2048 sc1
    buffer_load_dwordx4 v[20:23], v117, s[8:11], s53 offen offset:2048 sc1
    v_mov_b32 v52, 0
    v_mov_b32 v52, 0
    v_mov_b32 v52, 0
    v_mov_b32 v52, 0
    v_mov_b32 v52, 0
    v_mov_b32 v52, 0
    v_mov_b32 v52, 0
    v_mov_b32 v52, 0
    v_mov_b32 v52, 0
    v_mov_b32 v52, 0
    v_mov_b32 v52, 0
    v_mov_b32 v52, 0
    v_mov_b32 v52, 0
    v_mov_b32 v52, 0
    v_mov_b32 v52, 0
    v_mov_b32 v52, 0
    v_mov_b32 v52, 0
    v_mov_b32 v52, 0
    v_mov_b32 v52, 0
    v_mov_b32 v52, 0
    v_mov_b32 v52, 0
    v_mov_b32 v52, 0
    v_mov_b32 v52, 0
    v_mov_b32 v52, 0
    v_mov_b32 v52, 0
    v_mov_b32 v52, 0
    v_mov_b32 v52, 0
    v_mov_b32 v52, 0
    v_mov_b32 v52, 0
    v_mov_b32 v52, 0
    buffer_load_dwordx4 v[32:35], v117, s[8:11], s29 offen sc1
    buffer_load_dwordx4 v[36:39], v117, s[8:11], s53 offen sc1
    buffer_load_dwordx4 v[40:43], v117, s[8:11], s29 offen offset:2048 sc1
    buffer_load_dwordx4 v[44:47], v117, s[8:11], s53 offen offset:2048 sc1
    v_mov_b32 v52, 0
L_rl_44:
    s_waitcnt vmcnt(7)
    v_mfma_f32_16x16x32_bf16 v[48:51], v[4:7], v[12:15], 0
    v_xor_b32 v52, s33, v4
    s_waitcnt vmcnt(6)
    v_mfma_f32_16x16x32_bf16 v[48:51], v[8:11], v[12:15], v[48:51]
    v_xor_b32 v53, s33, v8
    v_or_b32 v52, v52, v53
    s_waitcnt vmcnt(5)
    v_mfma_f32_16x16x32_bf16 v[48:51], v[16:19], v[12:15], v[48:51]
    v_xor_b32 v53, s33, v16
    v_or_b32 v52, v52, v53
    s_waitcnt vmcnt(4)
    v_mfma_f32_16x16x32_bf16 v[48:51], v[20:23], v[12:15], v[48:51]
    v_xor_b32 v53, s33, v20
    v_or_b32 v52, v52, v53
    v_and_b32 v52, 1, v52
    v_cmp_ne_u32 vcc, 0, v52
    s_cbranch_vccnz L_rslow_45
L_rgo_46:
    s_nop 2
    v_permlane32_swap_b32 v48, v50
    v_permlane32_swap_b32 v49, v51
    v_pk_add_f32 v[48:49], v[48:49], v[50:51]
    s_mov_b64 exec, s[38:39]
    v_cvt_pk_bf16_f32 v12, v48, v49
    v_min_u32 v12, 0xfffffffe, v12
    buffer_store_dword v12, v119, s[8:11], s24 offen
    s_mov_b64 exec, -1
    s_add_u32 s24, s24, 8192
    s_bitset0_b32 s24, 15
    s_xor_b32 s55, s24, 16384
    s_xor_b32 s29, s29, 0x0
    s_xor_b32 s53, s29, 1024
    s_bfe_u32 s33, s22, 0x10000
    s_waitcnt lgkmcnt(0)
    s_branch L_chain_top3_f
L_chain_last_f:
    s_nop 1
    v_smfmac_f32_16x16x64_bf16 v[48:51], v[16:19], v[128:135], v116
    v_smfmac_f32_16x16x64_bf16 v[48:51], v[20:23], v[160:167], v116
    v_smfmac_f32_16x16x64_bf16 v[48:51], v[24:27], v[144:151], v116
    v_smfmac_f32_16x16x64_bf16 v[48:51], v[28:31], v[176:183], v116
    v_smfmac_f32_16x16x64_bf16 v[52:55], v[16:19], v[136:143], v116
    v_smfmac_f32_16x16x64_bf16 v[52:55], v[20:23], v[168:175], v116
    v_smfmac_f32_16x16x64_bf16 v[52:55], v[24:27], v[152:159], v116
    v_smfmac_f32_16x16x64_bf16 v[52:55], v[28:31], v[184:191], v116
    v_add_f32 v48, v48, v50
    v_add_f32 v49, v49, v51
    v_cvt_pk_bf16_f32 v112, v48, v49
    s_nop 4
    v_add_f32 v52, v52, v54
    v_add_f32 v53, v53, v55
    v_cvt_pk_bf16_f32 v114, v52, v53
    s_add_u32 s32, s32, 0x20000
    buffer_store_dwordx4 v[112:115], v117, s[8:11], s32 offen sc1
    v_mov_b32 v94, 64
    s_waitcnt vmcnt(0) lgkmcnt(0)
    s_barrier
    s_mov_b64 exec, 1
    buffer_store_dword v94, off, s[8:11], s44 sc1
    s_mov_b64 exec, -1
    s_endpgm
L_mret_18:
    s_mov_b32 s43, m0
    s_mov_b32 m0, 4096
    buffer_load_dwordx4 v[4:7], v117, s[8:11], s48 offen sc1
    buffer_load_dwordx4 v117, s[8:11], s48 offen sc1 lds
    s_mov_b32 m0, 8192
    s_mov_b32 m0, s43
    s_waitcnt vmcnt(0)
    v_max3_u32 v15, v4, v5, v6
    v_max_u32 v15, v15, v7
    v_cmp_lt_u32 vcc, s56, v15
    s_add_u32 s47, s47, 1
    s_add_u32 s49, s49, 1
    s_cmp_ge_u32 s49, 0x10000
    s_cbranch_scc1 L_mgo_19
    s_cbranch_vccnz L_mret_18
    s_branch L_mgo_19
L_smax_21:
    s_add_u32 s47, s47, 1
    s_mov_b32 s35, 0x7f800000
    s_waitcnt lgkmcnt(0)
    s_sub_u32 s43, s30, 0x40000
    s_add_u32 s40, s43, 4096
    s_nop 7
    buffer_load_dwordx4 v[56:59], v117, s[8:11], s43 offen
    buffer_load_dwordx4 v[60:63], v117, s[8:11], s43 offen offset:1024
    buffer_load_dwordx4 v[64:67], v117, s[8:11], s43 offen offset:2048
    buffer_load_dwordx4 v[68:71], v117, s[8:11], s43 offen offset:3072
    buffer_load_dwordx4 v[72:75], v117, s[8:11], s40 offen
    buffer_load_dwordx4 v[76:79], v117, s[8:11], s40 offen offset:1024
    buffer_load_dwordx4 v[80:83], v117, s[8:11], s40 offen offset:2048
    buffer_load_dwordx4 v[84:87], v117, s[8:11], s40 offen offset:3072
    ds_read_b128 v[32:35], v121 offset:16384
    ds_read_b128 v[36:39], v121 offset:17408
    ds_read_b128 v[40:43], v121 offset:18432
    ds_read_b128 v[44:47], v121 offset:19456
    v_mov_b32 v96, 0
    v_mov_b32 v97, 0
    v_mov_b32 v98, 0
    v_mov_b32 v99, 0
    v_mov_b32 v100, 0
    v_mov_b32 v101, 0
    v_mov_b32 v102, 0
    v_mov_b32 v103, 0
    v_mov_b32 v104, 0
    v_mov_b32 v105, 0
    v_mov_b32 v106, 0
    v_mov_b32 v107, 0
    v_mov_b32 v108, 0
    v_mov_b32 v109, 0
    v_mov_b32 v110, 0
    v_mov_b32 v111, 0
    s_waitcnt vmcnt(0) lgkmcnt(0)
    v_mfma_f32_16x16x32_bf16 v[56:59], v[56:59], v[32:35], 0
    v_mfma_f32_16x16x32_bf16 v[56:59], v[60:63], v[36:39], v[56:59]
    v_mfma_f32_16x16x32_bf16 v[56:59], v[64:67], v[40:43], v[56:59]
    v_mfma_f32_16x16x32_bf16 v[56:59], v[68:71], v[44:47], v[56:59]
    v_mfma_f32_16x16x32_bf16 v[60:63], v[72:75], v[32:35], 0
    v_mfma_f32_16x16x32_bf16 v[60:63], v[76:79], v[36:39], v[60:63]
    v_mfma_f32_16x16x32_bf16 v[60:63], v[80:83], v[40:43], v[60:63]
    v_mfma_f32_16x16x32_bf16 v[60:63], v[84:87], v[44:47], v[60:63]
    v_mfma_f32_16x16x32_bf16 v[64:67], v[32:35], v[32:35], 0
    v_mfma_f32_16x16x32_bf16 v[64:67], v[36:39], v[36:39], v[64:67]
    v_mfma_f32_16x16x32_bf16 v[64:67], v[40:43], v[40:43], v[64:67]
    v_mfma_f32_16x16x32_bf16 v[64:67], v[44:47], v[44:47], v[64:67]
    v_max3_f32 v84, v56, v57, v58
    v_max3_f32 v84, v84, v59, v60
    v_max3_f32 v84, v84, v61, v62
    s_nop 4
    v_max3_f32 v84, v84, v63, v64
    v_max_f32 v84, v84, v65
    v_mov_b32 v85, v84
    s_nop 1
    v_permlane32_swap_b32 v85, v84
    v_max_f32 v84, v85, v84
    v_mov_b32 v85, v84
    s_nop 1
    v_permlane16_swap_b32 v85, v84
    v_max_f32 v84, v85, v84
    v_sub_f32 v56, v56, v84
    v_sub_f32 v57, v57, v84
    v_sub_f32 v58, v58, v84
    v_sub_f32 v59, v59, v84
    v_sub_f32 v60, v60, v84
    v_sub_f32 v61, v61, v84
    v_sub_f32 v62, v62, v84
    v_sub_f32 v63, v63, v84
    v_sub_f32 v64, v64, v84
    v_sub_f32 v65, v65, v84
    v_exp_f32 v56, v56
    v_exp_f32 v57, v57
    v_exp_f32 v58, v58
    v_exp_f32 v59, v59
    v_exp_f32 v60, v60
    v_exp_f32 v61, v61
    v_exp_f32 v62, v62
    v_exp_f32 v63, v63
    v_exp_f32 v64, v64
    v_exp_f32 v65, v65
    v_cvt_pk_bf16_f32 v68, v56, v57
    v_cvt_pk_bf16_f32 v69, v58, v59
    v_cvt_pk_bf16_f32 v70, v60, v61
    v_cvt_pk_bf16_f32 v71, v62, v63
    v_cvt_pk_bf16_f32 v52, v64, v65
    s_nop 0
    v_mfma_f32_16x16x32_bf16 v[72:75], v[88:91], v[68:71], 0
    v_mfma_f32_16x16x32_bf16 v[76:79], v[92:95], v[68:71], 0
    v_mfma_f32_16x16x32_bf16 v[80:83], v[48:51], v[68:71], 0
    v_mfma_f32_16x16x16_bf16 v[72:75], v[112:113], v[52:53], v[72:75]
    v_mfma_f32_16x16x16_bf16 v[76:79], v[114:115], v[52:53], v[76:79]
    v_mfma_f32_16x16x16_bf16 v[80:83], v[48:49], v[52:53], v[80:83]
    ds_read_b128 v[32:35], v124 offset:6144
    ds_read_b128 v[36:39], v124 offset:7168
    ds_read_b128 v[40:43], v124 offset:34816
    ds_read_b128 v[44:47], v124 offset:35840
    ds_read_b128 v[56:59], v124 offset:36864
    ds_read_b128 v[64:67], v124 offset:38912
    ds_read_b128 v[68:71], v124 offset:39936
    s_waitcnt lgkmcnt(0)
    s_branch L_norm_20
L_kvw_22:
    s_add_u32 s47, s47, 1
    s_add_u32 s49, s49, 1
    s_cmp_ge_u32 s49, 0x10000
    s_cbranch_scc1 L_kvb_23
    s_sleep 4
    buffer_load_dword v125, v119, s[8:11], s28 offen sc1
    s_waitcnt vmcnt(0)
    v_cmp_eq_u32 vcc, 0, v125
    s_nop 0
    s_and_b64 vcc, vcc, s[58:59]
    s_cbranch_scc1 L_kvw_22
    s_branch L_kvb_23
L_mret_25:
    s_mov_b32 s43, m0
    s_mov_b32 m0, 5120
    buffer_load_dwordx4 v[4:7], v117, s[8:11], s48 offen sc1
    buffer_load_dwordx4 v117, s[8:11], s48 offen sc1 lds
    s_mov_b32 m0, 10240
    s_mov_b32 m0, s43
    s_waitcnt vmcnt(0)
    v_max3_u32 v15, v4, v5, v6
    v_max_u32 v15, v15, v7
    v_cmp_lt_u32 vcc, s56, v15
    s_add_u32 s47, s47, 1
    s_add_u32 s49, s49, 1
    s_cmp_ge_u32 s49, 0x10000
    s_cbranch_scc1 L_mgo_26
    s_cbranch_vccnz L_mret_25
    s_branch L_mgo_26
L_smax_28:
    s_add_u32 s47, s47, 1
    s_mov_b32 s35, 0x7f800000
    s_waitcnt lgkmcnt(0)
    s_sub_u32 s43, s30, 0x40800
    s_add_u32 s40, s43, 4096
    s_nop 7
    buffer_load_dwordx4 v[56:59], v117, s[8:11], s43 offen
    buffer_load_dwordx4 v[60:63], v117, s[8:11], s43 offen offset:1024
    buffer_load_dwordx4 v[64:67], v117, s[8:11], s43 offen offset:2048
    buffer_load_dwordx4 v[68:71], v117, s[8:11], s43 offen offset:3072
    buffer_load_dwordx4 v[72:75], v117, s[8:11], s40 offen
    buffer_load_dwordx4 v[76:79], v117, s[8:11], s40 offen offset:1024
    buffer_load_dwordx4 v[80:83], v117, s[8:11], s40 offen offset:2048
    buffer_load_dwordx4 v[84:87], v117, s[8:11], s40 offen offset:3072
    ds_read_b128 v[32:35], v121 offset:16384
    ds_read_b128 v[36:39], v121 offset:17408
    ds_read_b128 v[40:43], v121 offset:18432
    ds_read_b128 v[44:47], v121 offset:19456
    v_mov_b32 v96, 0
    v_mov_b32 v97, 0
    v_mov_b32 v98, 0
    v_mov_b32 v99, 0
    v_mov_b32 v100, 0
    v_mov_b32 v101, 0
    v_mov_b32 v102, 0
    v_mov_b32 v103, 0
    v_mov_b32 v104, 0
    v_mov_b32 v105, 0
    v_mov_b32 v106, 0
    v_mov_b32 v107, 0
    v_mov_b32 v108, 0
    v_mov_b32 v109, 0
    v_mov_b32 v110, 0
    v_mov_b32 v111, 0
    s_waitcnt vmcnt(0) lgkmcnt(0)
    v_mfma_f32_16x16x32_bf16 v[56:59], v[56:59], v[32:35], 0
    v_mfma_f32_16x16x32_bf16 v[56:59], v[60:63], v[36:39], v[56:59]
    v_mfma_f32_16x16x32_bf16 v[56:59], v[64:67], v[40:43], v[56:59]
    v_mfma_f32_16x16x32_bf16 v[56:59], v[68:71], v[44:47], v[56:59]
    v_mfma_f32_16x16x32_bf16 v[60:63], v[72:75], v[32:35], 0
    v_mfma_f32_16x16x32_bf16 v[60:63], v[76:79], v[36:39], v[60:63]
    v_mfma_f32_16x16x32_bf16 v[60:63], v[80:83], v[40:43], v[60:63]
    v_mfma_f32_16x16x32_bf16 v[60:63], v[84:87], v[44:47], v[60:63]
    v_mfma_f32_16x16x32_bf16 v[64:67], v[32:35], v[32:35], 0
    v_mfma_f32_16x16x32_bf16 v[64:67], v[36:39], v[36:39], v[64:67]
    v_mfma_f32_16x16x32_bf16 v[64:67], v[40:43], v[40:43], v[64:67]
    v_mfma_f32_16x16x32_bf16 v[64:67], v[44:47], v[44:47], v[64:67]
    v_max3_f32 v84, v56, v57, v58
    v_max3_f32 v84, v84, v59, v60
    v_max3_f32 v84, v84, v61, v62
    s_nop 4
    v_max3_f32 v84, v84, v63, v64
    v_max_f32 v84, v84, v65
    v_mov_b32 v85, v84
    s_nop 1
    v_permlane32_swap_b32 v85, v84
    v_max_f32 v84, v85, v84
    v_mov_b32 v85, v84
    s_nop 1
    v_permlane16_swap_b32 v85, v84
    v_max_f32 v84, v85, v84
    v_sub_f32 v56, v56, v84
    v_sub_f32 v57, v57, v84
    v_sub_f32 v58, v58, v84
    v_sub_f32 v59, v59, v84
    v_sub_f32 v60, v60, v84
    v_sub_f32 v61, v61, v84
    v_sub_f32 v62, v62, v84
    v_sub_f32 v63, v63, v84
    v_sub_f32 v64, v64, v84
    v_sub_f32 v65, v65, v84
    v_exp_f32 v56, v56
    v_exp_f32 v57, v57
    v_exp_f32 v58, v58
    v_exp_f32 v59, v59
    v_exp_f32 v60, v60
    v_exp_f32 v61, v61
    v_exp_f32 v62, v62
    v_exp_f32 v63, v63
    v_exp_f32 v64, v64
    v_exp_f32 v65, v65
    v_cvt_pk_bf16_f32 v68, v56, v57
    v_cvt_pk_bf16_f32 v69, v58, v59
    v_cvt_pk_bf16_f32 v70, v60, v61
    v_cvt_pk_bf16_f32 v71, v62, v63
    v_cvt_pk_bf16_f32 v52, v64, v65
    s_nop 0
    v_mfma_f32_16x16x32_bf16 v[72:75], v[88:91], v[68:71], 0
    v_mfma_f32_16x16x32_bf16 v[76:79], v[92:95], v[68:71], 0
    v_mfma_f32_16x16x32_bf16 v[80:83], v[48:51], v[68:71], 0
    v_mfma_f32_16x16x16_bf16 v[72:75], v[112:113], v[52:53], v[72:75]
    v_mfma_f32_16x16x16_bf16 v[76:79], v[114:115], v[52:53], v[76:79]
    v_mfma_f32_16x16x16_bf16 v[80:83], v[48:49], v[52:53], v[80:83]
    ds_read_b128 v[32:35], v124 offset:6144
    ds_read_b128 v[36:39], v124 offset:7168
    ds_read_b128 v[40:43], v124 offset:34816
    ds_read_b128 v[44:47], v124 offset:35840
    ds_read_b128 v[56:59], v124 offset:36864
    ds_read_b128 v[64:67], v124 offset:38912
    ds_read_b128 v[68:71], v124 offset:39936
    s_waitcnt lgkmcnt(0)
    s_branch L_norm_27
L_kvw_29:
    s_add_u32 s47, s47, 1
    s_add_u32 s49, s49, 1
    s_cmp_ge_u32 s49, 0x10000
    s_cbranch_scc1 L_kvb_30
    s_sleep 4
    buffer_load_dword v125, v119, s[8:11], s28 offen sc1
    s_waitcnt vmcnt(0)
    v_cmp_eq_u32 vcc, 0, v125
    s_nop 0
    s_and_b64 vcc, vcc, s[58:59]
    s_cbranch_scc1 L_kvw_29
    s_branch L_kvb_30
L_mret_32:
    s_mov_b32 s43, m0
    s_mov_b32 m0, 6144
    buffer_load_dwordx4 v[4:7], v117, s[8:11], s48 offen sc1
    buffer_load_dwordx4 v117, s[8:11], s48 offen sc1 lds
    s_mov_b32 m0, 12288
    s_mov_b32 m0, s43
    s_waitcnt vmcnt(0)
    v_max3_u32 v15, v4, v5, v6
    v_max_u32 v15, v15, v7
    v_cmp_lt_u32 vcc, s56, v15
    s_add_u32 s47, s47, 1
    s_add_u32 s49, s49, 1
    s_cmp_ge_u32 s49, 0x10000
    s_cbranch_scc1 L_mgo_33
    s_cbranch_vccnz L_mret_32
    s_branch L_mgo_33
L_smax_35:
    s_add_u32 s47, s47, 1
    s_mov_b32 s35, 0x7f800000
    s_waitcnt lgkmcnt(0)
    s_sub_u32 s43, s30, 0x41000
    s_add_u32 s40, s43, 4096
    s_nop 7
    buffer_load_dwordx4 v[56:59], v117, s[8:11], s43 offen
    buffer_load_dwordx4 v[60:63], v117, s[8:11], s43 offen offset:1024
    buffer_load_dwordx4 v[64:67], v117, s[8:11], s43 offen offset:2048
    buffer_load_dwordx4 v[68:71], v117, s[8:11], s43 offen offset:3072
    buffer_load_dwordx4 v[72:75], v117, s[8:11], s40 offen
    buffer_load_dwordx4 v[76:79], v117, s[8:11], s40 offen offset:1024
    buffer_load_dwordx4 v[80:83], v117, s[8:11], s40 offen offset:2048
    buffer_load_dwordx4 v[84:87], v117, s[8:11], s40 offen offset:3072
    ds_read_b128 v[32:35], v121 offset:16384
    ds_read_b128 v[36:39], v121 offset:17408
    ds_read_b128 v[40:43], v121 offset:18432
    ds_read_b128 v[44:47], v121 offset:19456
    v_mov_b32 v96, 0
    v_mov_b32 v97, 0
    v_mov_b32 v98, 0
    v_mov_b32 v99, 0
    v_mov_b32 v100, 0
    v_mov_b32 v101, 0
    v_mov_b32 v102, 0
    v_mov_b32 v103, 0
    v_mov_b32 v104, 0
    v_mov_b32 v105, 0
    v_mov_b32 v106, 0
    v_mov_b32 v107, 0
    v_mov_b32 v108, 0
    v_mov_b32 v109, 0
    v_mov_b32 v110, 0
    v_mov_b32 v111, 0
    s_waitcnt vmcnt(0) lgkmcnt(0)
    v_mfma_f32_16x16x32_bf16 v[56:59], v[56:59], v[32:35], 0
    v_mfma_f32_16x16x32_bf16 v[56:59], v[60:63], v[36:39], v[56:59]
    v_mfma_f32_16x16x32_bf16 v[56:59], v[64:67], v[40:43], v[56:59]
    v_mfma_f32_16x16x32_bf16 v[56:59], v[68:71], v[44:47], v[56:59]
    v_mfma_f32_16x16x32_bf16 v[60:63], v[72:75], v[32:35], 0
    v_mfma_f32_16x16x32_bf16 v[60:63], v[76:79], v[36:39], v[60:63]
    v_mfma_f32_16x16x32_bf16 v[60:63], v[80:83], v[40:43], v[60:63]
    v_mfma_f32_16x16x32_bf16 v[60:63], v[84:87], v[44:47], v[60:63]
    v_mfma_f32_16x16x32_bf16 v[64:67], v[32:35], v[32:35], 0
    v_mfma_f32_16x16x32_bf16 v[64:67], v[36:39], v[36:39], v[64:67]
    v_mfma_f32_16x16x32_bf16 v[64:67], v[40:43], v[40:43], v[64:67]
    v_mfma_f32_16x16x32_bf16 v[64:67], v[44:47], v[44:47], v[64:67]
    v_max3_f32 v84, v56, v57, v58
    v_max3_f32 v84, v84, v59, v60
    v_max3_f32 v84, v84, v61, v62
    s_nop 4
    v_max3_f32 v84, v84, v63, v64
    v_max_f32 v84, v84, v65
    v_mov_b32 v85, v84
    s_nop 1
    v_permlane32_swap_b32 v85, v84
    v_max_f32 v84, v85, v84
    v_mov_b32 v85, v84
    s_nop 1
    v_permlane16_swap_b32 v85, v84
    v_max_f32 v84, v85, v84
    v_sub_f32 v56, v56, v84
    v_sub_f32 v57, v57, v84
    v_sub_f32 v58, v58, v84
    v_sub_f32 v59, v59, v84
    v_sub_f32 v60, v60, v84
    v_sub_f32 v61, v61, v84
    v_sub_f32 v62, v62, v84
    v_sub_f32 v63, v63, v84
    v_sub_f32 v64, v64, v84
    v_sub_f32 v65, v65, v84
    v_exp_f32 v56, v56
    v_exp_f32 v57, v57
    v_exp_f32 v58, v58
    v_exp_f32 v59, v59
    v_exp_f32 v60, v60
    v_exp_f32 v61, v61
    v_exp_f32 v62, v62
    v_exp_f32 v63, v63
    v_exp_f32 v64, v64
    v_exp_f32 v65, v65
    v_cvt_pk_bf16_f32 v68, v56, v57
    v_cvt_pk_bf16_f32 v69, v58, v59
    v_cvt_pk_bf16_f32 v70, v60, v61
    v_cvt_pk_bf16_f32 v71, v62, v63
    v_cvt_pk_bf16_f32 v52, v64, v65
    s_nop 0
    v_mfma_f32_16x16x32_bf16 v[72:75], v[88:91], v[68:71], 0
    v_mfma_f32_16x16x32_bf16 v[76:79], v[92:95], v[68:71], 0
    v_mfma_f32_16x16x32_bf16 v[80:83], v[48:51], v[68:71], 0
    v_mfma_f32_16x16x16_bf16 v[72:75], v[112:113], v[52:53], v[72:75]
    v_mfma_f32_16x16x16_bf16 v[76:79], v[114:115], v[52:53], v[76:79]
    v_mfma_f32_16x16x16_bf16 v[80:83], v[48:49], v[52:53], v[80:83]
    ds_read_b128 v[32:35], v124 offset:6144
    ds_read_b128 v[36:39], v124 offset:7168
    ds_read_b128 v[40:43], v124 offset:34816
    ds_read_b128 v[44:47], v124 offset:35840
    ds_read_b128 v[56:59], v124 offset:36864
    ds_read_b128 v[64:67], v124 offset:38912
    ds_read_b128 v[68:71], v124 offset:39936
    s_waitcnt lgkmcnt(0)
    s_branch L_norm_34
L_rslow_37:
    buffer_load_dwordx4 v[4:7], v117, s[8:11], s29 offen sc1
    buffer_load_dwordx4 v[8:11], v117, s[8:11], s53 offen sc1
    buffer_load_dwordx4 v[16:19], v117, s[8:11], s29 offen offset:2048 sc1
    buffer_load_dwordx4 v[20:23], v117, s[8:11], s53 offen offset:2048 sc1
    s_add_u32 s46, s46, 1
    s_add_u32 s49, s49, 1
    s_cmp_ge_u32 s49, 0x10000
    s_cbranch_scc1 L_rgo_38
    s_waitcnt vmcnt(7)
    v_mfma_f32_16x16x32_bf16 v[48:51], v[32:35], v[12:15], 0
    v_xor_b32 v52, s33, v32
    s_waitcnt vmcnt(6)
    v_mfma_f32_16x16x32_bf16 v[48:51], v[36:39], v[12:15], v[48:51]
    v_xor_b32 v53, s33, v36
    v_or_b32 v52, v52, v53
    s_waitcnt vmcnt(5)
    v_mfma_f32_16x16x32_bf16 v[48:51], v[40:43], v[12:15], v[48:51]
    v_xor_b32 v53, s33, v40
    v_or_b32 v52, v52, v53
    s_waitcnt vmcnt(4)
    v_mfma_f32_16x16x32_bf16 v[48:51], v[44:47], v[12:15], v[48:51]
    v_xor_b32 v53, s33, v44
    v_or_b32 v52, v52, v53
    v_and_b32 v52, 1, v52
    v_cmp_ne_u32 vcc, 0, v52
    s_cbranch_vccz L_rgo_38
    buffer_load_dwordx4 v[32:35], v117, s[8:11], s29 offen sc1
    buffer_load_dwordx4 v[36:39], v117, s[8:11], s53 offen sc1
    buffer_load_dwordx4 v[40:43], v117, s[8:11], s29 offen offset:2048 sc1
    buffer_load_dwordx4 v[44:47], v117, s[8:11], s53 offen offset:2048 sc1
    s_add_u32 s46, s46, 1
    s_branch L_rl_36
L_mret_40:
    s_mov_b32 s43, m0
    s_mov_b32 m0, 7168
    buffer_load_dwordx4 v[4:7], v117, s[8:11], s48 offen sc1
    buffer_load_dwordx4 v117, s[8:11], s48 offen sc1 lds
    s_mov_b32 m0, 14336
    s_mov_b32 m0, s43
    s_waitcnt vmcnt(0)
    v_max3_u32 v15, v4, v5, v6
    v_max_u32 v15, v15, v7
    v_cmp_lt_u32 vcc, s56, v15
    s_add_u32 s47, s47, 1
    s_add_u32 s49, s49, 1
    s_cmp_ge_u32 s49, 0x10000
    s_cbranch_scc1 L_mgo_41
    s_cbranch_vccnz L_mret_40
    s_branch L_mgo_41
L_smax_43:
    s_add_u32 s47, s47, 1
    s_mov_b32 s35, 0x7f800000
    s_waitcnt lgkmcnt(0)
    s_sub_u32 s43, s30, 0x41800
    s_add_u32 s40, s43, 4096
    s_nop 7
    buffer_load_dwordx4 v[56:59], v117, s[8:11], s43 offen
    buffer_load_dwordx4 v[60:63], v117, s[8:11], s43 offen offset:1024
    buffer_load_dwordx4 v[64:67], v117, s[8:11], s43 offen offset:2048
    buffer_load_dwordx4 v[68:71], v117, s[8:11], s43 offen offset:3072
    buffer_load_dwordx4 v[72:75], v117, s[8:11], s40 offen
    buffer_load_dwordx4 v[76:79], v117, s[8:11], s40 offen offset:1024
    buffer_load_dwordx4 v[80:83], v117, s[8:11], s40 offen offset:2048
    buffer_load_dwordx4 v[84:87], v117, s[8:11], s40 offen offset:3072
    ds_read_b128 v[32:35], v121 offset:16384
    ds_read_b128 v[36:39], v121 offset:17408
    ds_read_b128 v[40:43], v121 offset:18432
    ds_read_b128 v[44:47], v121 offset:19456
    v_mov_b32 v96, 0
    v_mov_b32 v97, 0
    v_mov_b32 v98, 0
    v_mov_b32 v99, 0
    v_mov_b32 v100, 0
    v_mov_b32 v101, 0
    v_mov_b32 v102, 0
    v_mov_b32 v103, 0
    v_mov_b32 v104, 0
    v_mov_b32 v105, 0
    v_mov_b32 v106, 0
    v_mov_b32 v107, 0
    v_mov_b32 v108, 0
    v_mov_b32 v109, 0
    v_mov_b32 v110, 0
    v_mov_b32 v111, 0
    s_waitcnt vmcnt(0) lgkmcnt(0)
    v_mfma_f32_16x16x32_bf16 v[56:59], v[56:59], v[32:35], 0
    v_mfma_f32_16x16x32_bf16 v[56:59], v[60:63], v[36:39], v[56:59]
    v_mfma_f32_16x16x32_bf16 v[56:59], v[64:67], v[40:43], v[56:59]
    v_mfma_f32_16x16x32_bf16 v[56:59], v[68:71], v[44:47], v[56:59]
    v_mfma_f32_16x16x32_bf16 v[60:63], v[72:75], v[32:35], 0
    v_mfma_f32_16x16x32_bf16 v[60:63], v[76:79], v[36:39], v[60:63]
    v_mfma_f32_16x16x32_bf16 v[60:63], v[80:83], v[40:43], v[60:63]
    v_mfma_f32_16x16x32_bf16 v[60:63], v[84:87], v[44:47], v[60:63]
    v_mfma_f32_16x16x32_bf16 v[64:67], v[32:35], v[32:35], 0
    v_mfma_f32_16x16x32_bf16 v[64:67], v[36:39], v[36:39], v[64:67]
    v_mfma_f32_16x16x32_bf16 v[64:67], v[40:43], v[40:43], v[64:67]
    v_mfma_f32_16x16x32_bf16 v[64:67], v[44:47], v[44:47], v[64:67]
    v_max3_f32 v84, v56, v57, v58
    v_max3_f32 v84, v84, v59, v60
    v_max3_f32 v84, v84, v61, v62
    s_nop 4
    v_max3_f32 v84, v84, v63, v64
    v_max_f32 v84, v84, v65
    v_mov_b32 v85, v84
    s_nop 1
    v_permlane32_swap_b32 v85, v84
    v_max_f32 v84, v85, v84
    v_mov_b32 v85, v84
    s_nop 1
    v_permlane16_swap_b32 v85, v84
    v_max_f32 v84, v85, v84
    v_sub_f32 v56, v56, v84
    v_sub_f32 v57, v57, v84
    v_sub_f32 v58, v58, v84
    v_sub_f32 v59, v59, v84
    v_sub_f32 v60, v60, v84
    v_sub_f32 v61, v61, v84
    v_sub_f32 v62, v62, v84
    v_sub_f32 v63, v63, v84
    v_sub_f32 v64, v64, v84
    v_sub_f32 v65, v65, v84
    v_exp_f32 v56, v56
    v_exp_f32 v57, v57
    v_exp_f32 v58, v58
    v_exp_f32 v59, v59
    v_exp_f32 v60, v60
    v_exp_f32 v61, v61
    v_exp_f32 v62, v62
    v_exp_f32 v63, v63
    v_exp_f32 v64, v64
    v_exp_f32 v65, v65
    v_cvt_pk_bf16_f32 v68, v56, v57
    v_cvt_pk_bf16_f32 v69, v58, v59
    v_cvt_pk_bf16_f32 v70, v60, v61
    v_cvt_pk_bf16_f32 v71, v62, v63
    v_cvt_pk_bf16_f32 v52, v64, v65
    s_nop 0
    v_mfma_f32_16x16x32_bf16 v[72:75], v[88:91], v[68:71], 0
    v_mfma_f32_16x16x32_bf16 v[76:79], v[92:95], v[68:71], 0
    v_mfma_f32_16x16x32_bf16 v[80:83], v[48:51], v[68:71], 0
    v_mfma_f32_16x16x16_bf16 v[72:75], v[112:113], v[52:53], v[72:75]
    v_mfma_f32_16x16x16_bf16 v[76:79], v[114:115], v[52:53], v[76:79]
    v_mfma_f32_16x16x16_bf16 v[80:83], v[48:49], v[52:53], v[80:83]
    ds_read_b128 v[32:35], v124 offset:6144
    ds_read_b128 v[36:39], v124 offset:7168
    ds_read_b128 v[40:43], v124 offset:34816
    ds_read_b128 v[44:47], v124 offset:35840
    ds_read_b128 v[56:59], v124 offset:36864
    ds_read_b128 v[64:67], v124 offset:38912
    ds_read_b128 v[68:71], v124 offset:39936
    s_waitcnt lgkmcnt(0)
    s_branch L_norm_42
L_rslow_45:
    buffer_load_dwordx4 v[4:7], v117, s[8:11], s29 offen sc1
    buffer_load_dwordx4 v[8:11], v117, s[8:11], s53 offen sc1
    buffer_load_dwordx4 v[16:19], v117, s[8:11], s29 offen offset:2048 sc1
    buffer_load_dwordx4 v[20:23], v117, s[8:11], s53 offen offset:2048 sc1
    s_add_u32 s46, s46, 1
    s_add_u32 s49, s49, 1
    s_cmp_ge_u32 s49, 0x10000
    s_cbranch_scc1 L_rgo_46
    s_waitcnt vmcnt(7)
    v_mfma_f32_16x16x32_bf16 v[48:51], v[32:35], v[12:15], 0
    v_xor_b32 v52, s33, v32
    s_waitcnt vmcnt(6)
    v_mfma_f32_16x16x32_bf16 v[48:51], v[36:39], v[12:15], v[48:51]
    v_xor_b32 v53, s33, v36
    v_or_b32 v52, v52, v53
    s_waitcnt vmcnt(5)
    v_mfma_f32_16x16x32_bf16 v[48:51], v[40:43], v[12:15], v[48:51]
    v_xor_b32 v53, s33, v40
    v_or_b32 v52, v52, v53
    s_waitcnt vmcnt(4)
    v_mfma_f32_16x16x32_bf16 v[48:51], v[44:47], v[12:15], v[48:51]
    v_xor_b32 v53, s33, v44
    v_or_b32 v52, v52, v53
    v_and_b32 v52, 1, v52
    v_cmp_ne_u32 vcc, 0, v52
    s_cbranch_vccz L_rgo_46
    buffer_load_dwordx4 v[32:35], v117, s[8:11], s29 offen sc1
    buffer_load_dwordx4 v[36:39], v117, s[8:11], s53 offen sc1
    buffer_load_dwordx4 v[40:43], v117, s[8:11], s29 offen offset:2048 sc1
    buffer_load_dwordx4 v[44:47], v117, s[8:11], s53 offen offset:2048 sc1
    s_add_u32 s46, s46, 1
    s_branch L_rl_44
L_zero:
    s_waitcnt lgkmcnt(0)
    s_and_b32 s9, s9, 0xffff
    s_mov_b32 s10, 0x10000000
    s_mov_b32 s11, 0x20000
    s_and_b32 s93, s93, 0xffff
    s_mov_b32 s94, 0x100
    s_mov_b32 s95, 0x20000
    s_mov_b32 s87, 0
    s_cmp_lg_u32 s86, 0
    s_cbranch_scc1 L_reg_47
    s_lshl_b32 s97, s84, 4
    s_lshl_b32 s96, 1, s85
    v_mov_b32 v250, s96
    v_mov_b32 v251, 256
    s_mov_b64 exec, 1
    buffer_atomic_add_x2 v[250:251], off, s[92:95], s97 offset:64
    s_mov_b64 exec, -1
    s_mov_b32 s86, 1
L_reg_47:
    v_mov_b32 v4, 0
    v_mov_b32 v5, 0
    v_mov_b32 v6, 0
    v_mov_b32 v7, 0
    v_lshlrev_b32 v1, 4, v0
    s_mov_b32 s97, 0x0
    buffer_store_dwordx4 v[4:7], v1, s[8:11], s97 offen sc1
    s_mov_b32 s97, 0x1000
    buffer_store_dwordx4 v[4:7], v1, s[8:11], s97 offen sc1
    s_mov_b32 s97, 0x2000
    buffer_store_dwordx4 v[4:7], v1, s[8:11], s97 offen sc1
    s_mov_b32 s97, 0x3000
    buffer_store_dwordx4 v[4:7], v1, s[8:11], s97 offen sc1
    s_mov_b32 s97, 0x4000
    buffer_store_dwordx4 v[4:7], v1, s[8:11], s97 offen sc1
    s_mov_b32 s97, 0x5000
    buffer_store_dwordx4 v[4:7], v1, s[8:11], s97 offen sc1
    s_mov_b32 s97, 0x6000
    buffer_store_dwordx4 v[4:7], v1, s[8:11], s97 offen sc1
    s_mov_b32 s97, 0x7000
    buffer_store_dwordx4 v[4:7], v1, s[8:11], s97 offen sc1
    s_mov_b32 s97, 0x8000
    buffer_store_dwordx4 v[4:7], v1, s[8:11], s97 offen sc1
    s_mov_b32 s97, 0x9000
    buffer_store_dwordx4 v[4:7], v1, s[8:11], s97 offen sc1
    s_mov_b32 s97, 0xa000
    buffer_store_dwordx4 v[4:7], v1, s[8:11], s97 offen sc1
    s_waitcnt vmcnt(0)
    s_barrier
    s_cmp_lg_u32 s100, 0
    s_cbranch_scc1 L_flag_48
    v_mov_b32 v2, 1
    s_mov_b64 exec, 1
    buffer_store_dword v2, off, s[92:95], 40 sc1
    s_mov_b64 exec, -1
L_flag_48:
    s_cmp_lg_u32 s100, 0
    s_cbranch_scc1 L_noz
    s_mov_b64 exec, 0xff
    s_mov_b32 s96, 0
L_count:
    buffer_load_dwordx2 v[2:3], v1, s[92:95], 0 offen offset:64 sc1
    s_waitcnt vmcnt(0)
    v_cmp_le_u32 vcc, 8192, v3
    v_add_u32 v2, 1, v2
    v_xor_b32 v3, 8192, v3
    v_or_b32 v2, v2, v3
    s_mov_b32 s4, vcc_lo
    v_cmp_eq_u32 vcc, 0, v2
    v_mov_b32 v2, 1
    s_nop 1
    s_cmp_eq_u32 vcc_lo, 0xff
    s_cbranch_scc1 L_propose
    v_mov_b32 v2, 2
    s_andn2_b32 s4, s4, vcc_lo
    s_cbranch_scc1 L_propose
    s_sleep 2
    s_add_u32 s96, s96, 1
    s_cmp_lt_u32 s96, 0x100
    s_cbranch_scc1 L_count
L_propose:
    v_mov_b32 v3, 0
    s_mov_b64 exec, 1
    buffer_atomic_cmpswap v[2:3], off, s[92:95], 0 offset:36
    s_mov_b64 exec, -1
    s_branch L_noz
L_fallback:
    s_mov_b32 s87, 2
    s_waitcnt vmcnt(0) lgkmcnt(0)
    s_barrier
    v_mbcnt_lo_u32_b32 v0, -1, 0
    v_mbcnt_hi_u32_b32 v0, -1, v0
    s_lshl_b32 s96, s100, 6
    v_add_u32 v0, s96, v0
    s_mov_b32 s97, 44
    s_cmp_lg_u32 s100, 0
    s_cbranch_scc1 L_at_49
    s_mov_b64 exec, 1
    v_mov_b32 v2, 1
    buffer_atomic_add v2, off, s[92:95], s97 sc0
    s_mov_b64 exec, -1
L_at_49:
    s_cmp_lg_u32 s100, 0
    s_cbranch_scc1 L_at2_50
    s_mov_b64 exec, 1
    v_mov_b32 v1, 8
    s_waitcnt vmcnt(0)
    ds_write_b32 v1, v2
    s_waitcnt lgkmcnt(0)
    s_mov_b64 exec, -1
L_at2_50:
    s_barrier
    v_mov_b32 v1, 8
    ds_read_b32 v2, v1
    s_waitcnt lgkmcnt(0)
    v_readfirstlane_b32 s85, v2
    s_barrier
    s_sub_u32 s101, s85, 32
    s_cmp_ge_u32 s85, 32
    s_cbranch_scc1 L_bulk
    s_mov_b32 s20, s85
    v_lshrrev_b32 v4, 6, v0
    s_nop 0
    v_readfirstlane_b32 s21, v4
    v_and_b32 v1, 63, v0
    v_lshrrev_b32 v2, 4, v1
    v_and_b32 v3, 15, v1
    v_lshrrev_b32 v6, 2, v3
    v_lshlrev_b32 v117, 4, v1
    s_lshl_b32 s51, s21, 10
    s_lshl_b32 s52, s21, 11
    s_load_dwordx8 s[60:67], s[0:1], 16
    s_mov_b32 s14, 0x400000
    s_mov_b32 s15, 0x20000
    s_lshl_b32 s41, s20, 8
    s_lshl_b32 s42, s20, 17
    s_lshr_b32 s43, s21, 1
    s_lshl_b32 s43, s43, 2
    v_or_b32 v5, s43, v2
    v_lshlrev_b32 v5, 1, v5
    v_xor_b32 v5, v5, v3
    v_lshrrev_b32 v14, 2, v5
    v_and_b32 v14, 2, v14
    v_lshlrev_b32 v5, 4, v5
    s_lshl_b32 s43, s21, 4
    v_add_u32 v4, s43, v2
    v_lshl_add_u32 v8, v4, 13, v5
    s_waitcnt lgkmcnt(0)
    s_mov_b32 s16, s92
    s_mov_b32 s17, s93
    s_mov_b32 s18, s94
    s_mov_b32 s19, s95
    s_mov_b32 s88, s20
    s_mov_b32 s12, s60
    s_and_b32 s13, s61, 0xffff
    v_xor_b32 v15, 0, v14
    v_lshl_add_u32 v15, v15, 15, v8
    s_add_u32 s43, s41, 0x0
    s_add_u32 m0, s51, 0x8000
    s_nop 0
    buffer_load_dwordx4 v15, s[12:15], s43 offen lds
    s_add_u32 s43, s41, 0x8000
    s_add_u32 m0, s51, 0x9000
    s_nop 0
    buffer_load_dwordx4 v15, s[12:15], s43 offen lds
    s_add_u32 s43, s41, 0x100000
    s_add_u32 m0, s51, 0xa000
    s_nop 0
    buffer_load_dwordx4 v15, s[12:15], s43 offen lds
    s_add_u32 s43, s41, 0x108000
    s_add_u32 m0, s51, 0xb000
    s_nop 0
    buffer_load_dwordx4 v15, s[12:15], s43 offen lds
    s_add_u32 s43, s41, 0x200000
    s_add_u32 m0, s51, 0xc000
    s_nop 0
    buffer_load_dwordx4 v15, s[12:15], s43 offen lds
    s_add_u32 s43, s41, 0x208000
    s_add_u32 m0, s51, 0xd000
    s_nop 0
    buffer_load_dwordx4 v15, s[12:15], s43 offen lds
    s_add_u32 s43, s41, 0x300000
    s_add_u32 m0, s51, 0xe000
    s_nop 0
    buffer_load_dwordx4 v15, s[12:15], s43 offen lds
    s_add_u32 s43, s41, 0x308000
    s_add_u32 m0, s51, 0xf000
    s_nop 0
    buffer_load_dwordx4 v15, s[12:15], s43 offen lds
    v_xor_b32 v15, 2, v14
    v_lshl_add_u32 v15, v15, 15, v8
    s_add_u32 s43, s41, 0x0
    s_add_u32 m0, s51, 0x10000
    s_nop 0
    buffer_load_dwordx4 v15, s[12:15], s43 offen lds
    s_add_u32 s43, s41, 0x8000
    s_add_u32 m0, s51, 0x11000
    s_nop 0
    buffer_load_dwordx4 v15, s[12:15], s43 offen lds
    s_add_u32 s43, s41, 0x100000
    s_add_u32 m0, s51, 0x12000
    s_nop 0
    buffer_load_dwordx4 v15, s[12:15], s43 offen lds
    s_add_u32 s43, s41, 0x108000
    s_add_u32 m0, s51, 0x13000
    s_nop 0
    buffer_load_dwordx4 v15, s[12:15], s43 offen lds
    s_add_u32 s43, s41, 0x200000
    s_add_u32 m0, s51, 0x14000
    s_nop 0
    buffer_load_dwordx4 v15, s[12:15], s43 offen lds
    s_add_u32 s43, s41, 0x208000
    s_add_u32 m0, s51, 0x15000
    s_nop 0
    buffer_load_dwordx4 v15, s[12:15], s43 offen lds
    s_add_u32 s43, s41, 0x300000
    s_add_u32 m0, s51, 0x16000
    s_nop 0
    buffer_load_dwordx4 v15, s[12:15], s43 offen lds
    s_add_u32 s43, s41, 0x308000
    s_add_u32 m0, s51, 0x17000
    s_nop 0
    buffer_load_dwordx4 v15, s[12:15], s43 offen lds
    v_xor_b32 v15, 0, v14
    v_lshl_add_u32 v15, v15, 15, v8
    s_add_u32 s43, s41, 0x80000
    s_add_u32 m0, s51, 0x18000
    s_nop 0
    buffer_load_dwordx4 v15, s[12:15], s43 offen lds
    s_add_u32 s43, s41, 0x88000
    s_add_u32 m0, s51, 0x19000
    s_nop 0
    buffer_load_dwordx4 v15, s[12:15], s43 offen lds
    s_add_u32 s43, s41, 0x180000
    s_add_u32 m0, s51, 0x1a000
    s_nop 0
    buffer_load_dwordx4 v15, s[12:15], s43 offen lds
    s_add_u32 s43, s41, 0x188000
    s_add_u32 m0, s51, 0x1b000
    s_nop 0
    buffer_load_dwordx4 v15, s[12:15], s43 offen lds
    v_and_b32 v4, 2, v3
    v_cmp_ne_u32 vcc, 0, v4
    v_mov_b32 v4, 0x4444
    v_mov_b32 v5, 0xeeee
    v_cndmask_b32 v116, v4, v5, vcc
    v_lshrrev_b32 v5, 1, v2
    v_lshl_add_u32 v4, v6, 3, v5
    s_lshl_b32 s43, s21, 1
    v_add_u32 v4, s43, v4
    v_add_u32 v5, s20, v4
    v_and_b32 v5, 31, v5
    v_lshl_add_u32 v4, v4, 6, v5
    v_and_b32 v5, 1, v2
    v_lshl_add_u32 v4, v4, 1, v5
    v_and_b32 v5, 3, v3
    v_lshl_add_u32 v4, v4, 2, v5
    v_lshlrev_b32 v118, 4, v4
    v_and_b32 v4, 1, v2
    v_lshlrev_b32 v4, 2, v4
    v_and_b32 v7, 2, v2
    v_add_u32 v4, v4, v7
    v_and_b32 v7, 1, v6
    v_add_u32 v4, v4, v7
    v_lshl_add_u32 v4, v4, 2, v5
    v_lshlrev_b32 v4, 2, v4
    s_and_b32 s43, s21, 1
    s_lshl_b32 s43, s43, 12
    s_lshl_b32 s40, s20, 7
    s_add_u32 s43, s43, s40
    v_add_u32 v119, s43, v4
    v_sub_u32 v7, 0, v2
    v_and_b32 v7, 3, v7
    v_xor_b32 v7, v7, v6
    v_lshl_add_u32 v4, v2, 4, v7
    v_and_b32 v5, 3, v3
    v_lshl_add_u32 v4, v4, 2, v5
    s_add_u32 s43, s51, 16384
    v_lshl_add_u32 v120, v4, 2, s43
    v_sub_u32 v7, 0, v6
    v_and_b32 v7, 3, v7
    v_xor_b32 v7, v7, v2
    v_lshl_add_u32 v4, v3, 2, v7
    v_lshlrev_b32 v121, 4, v4
    v_and_b32 v5, 1, v3
    v_lshl_add_u32 v4, v6, 1, v5
    v_lshl_add_u32 v4, v2, 3, v4
    v_lshlrev_b32 v127, 4, v4
    v_and_or_b32 v122, v116, 8, v127
    s_lshl_b32 s43, s21, 13
    s_add_u32 s43, s43, 32768
    v_add_u32 v123, s43, v117
    v_add_u32 v124, 0x10000, v123
    s_mov_b32 s36, 0xcccccccc
    s_mov_b32 s37, 0xcccccccc
    s_mov_b32 s38, 0x00ff00ff
    s_mov_b32 s39, 0x00ff00ff
    s_mov_b32 s34, 0x3e0293ee
    s_mov_b32 s35, 0x49800000
    s_mov_b32 s50, 0x3f803f80
    v_and_b32 v5, 1, v2
    v_or_b32 v5, 0, v5
    v_xor_b32 v5, v5, v6
    v_and_b32 v7, 2, v5
    v_add_u32 v5, v5, v7
    v_lshlrev_b32 v5, 6, v5
    v_and_b32 v7, 3, v3
    v_lshl_add_u32 v7, v7, 4, v5
    s_lshl_b32 s43, s21, 2
    v_add_u32 v4, s43, v2
    v_lshl_add_u32 v10, v4, 10, v7
    v_and_b32 v5, 1, v2
    v_or_b32 v5, 2, v5
    v_xor_b32 v5, v5, v6
    v_and_b32 v7, 2, v5
    v_add_u32 v5, v5, v7
    v_lshlrev_b32 v5, 6, v5
    v_and_b32 v7, 3, v3
    v_lshl_add_u32 v7, v7, 4, v5
    s_lshl_b32 s43, s21, 2
    v_add_u32 v4, s43, v2
    v_lshl_add_u32 v9, v4, 10, v7
    v_and_b32 v5, 1, v2
    v_lshl_add_u32 v4, v5, 3, v6
    v_lshrrev_b32 v7, 1, v2
    v_lshl_add_u32 v4, v7, 5, v4
    v_lshlrev_b32 v4, 8, v4
    v_lshl_or_b32 v5, v5, 2, v6
    v_lshlrev_b32 v5, 5, v5
    s_lshl_b32 s43, s21, 6
    v_xor_b32 v5, s43, v5
    v_add_u32 v4, v4, v5
    v_and_b32 v5, 3, v3
    v_lshl_add_u32 v4, v5, 3, v4
    v_add_u32 v11, 32768, v4
    s_and_b32 s43, s21, 1
    s_lshl_b32 s43, s43, 12
    v_add_u32 v11, s43, v11
    v_and_b32 v5, 1, v2
    v_lshlrev_b32 v4, 4, v5
    v_lshl_add_u32 v4, v7, 2, v4
    v_and_b32 v7, 1, v6
    v_add_u32 v4, v4, v7
    s_lshl_b32 s43, s21, 5
    v_add_u32 v4, s43, v4
    v_lshlrev_b32 v4, 8, v4
    v_lshl_or_b32 v5, v5, 1, v7
    s_lshl_b32 s43, s21, 1
    s_and_b32 s43, s43, 3
    v_xor_b32 v5, s43, v5
    v_lshl_add_u32 v4, v5, 6, v4
    v_lshrrev_b32 v5, 1, v6
    v_lshl_add_u32 v4, v5, 5, v4
    v_and_b32 v5, 3, v3
    v_lshl_add_u32 v4, v5, 3, v4
    v_add_u32 v12, 32768, v4
    v_mov_b32 v16, -1
    v_mov_b32 v17, -1
    v_mov_b32 v18, -1
    v_mov_b32 v19, -1
    s_lshl_b32 s43, s20, 13
    s_add_u32 s43, s43, 0x7100000
    s_and_b32 s40, s21, 1
    s_lshl_b32 s40, s40, 12
    s_add_u32 s29, s43, s40
    s_add_u32 s43, s43, s52
    s_xor_b32 s40, s43, 0x0
    buffer_store_dwordx4 v[16:19], v117, s[8:11], s43 offen sc1
    buffer_store_dwordx4 v[16:19], v117, s[8:11], s43 offen offset:1024 sc1
    s_mov_b32 s43, 0x7012000
    buffer_store_dword v16, v119, s[8:11], s43 offen sc1
    s_mov_b32 s43, 0x7014000
    buffer_store_dword v16, v119, s[8:11], s43 offen sc1
    s_mov_b32 s43, 0x7016000
    buffer_store_dword v16, v119, s[8:11], s43 offen sc1
    s_load_dwordx2 s[4:5], s[0:1], 8
    s_waitcnt lgkmcnt(0)
    s_and_b32 s5, s5, 0xffff
    s_mov_b32 s6, 8192
    s_mov_b32 s7, 0x20000
    v_and_b32 v20, 1, v2
    v_and_b32 v21, 1, v6
    v_lshl_add_u32 v20, v20, 1, v21
    v_lshlrev_b32 v20, 9, v20
    v_and_b32 v21, 3, v3
    v_lshl_add_u32 v20, v21, 4, v20
    v_and_b32 v21, 2, v2
    v_add_u32 v20, v20, v21
    s_and_b32 s43, s20, 1
    s_lshl_b32 s43, s43, 11
    s_bfe_u32 s40, s20, 0x20001
    s_lshl_b32 s40, s40, 7
    s_add_u32 s43, s43, s40
    s_and_b32 s40, s21, 1
    s_lshl_b32 s40, s40, 6
    s_add_u32 s43, s43, s40
    s_lshr_b32 s40, s20, 3
    s_lshl_b32 s40, s40, 2
    s_add_u32 s43, s43, s40
    v_add_u32 v20, s43, v20
    v_lshlrev_b32 v20, 1, v20
    buffer_load_dword v21, v20, s[4:7], 0 offen
    s_mov_b32 s57, 0
    s_lshl_b32 s43, s20, 13
    s_add_u32 s43, s43, s52
    s_add_u32 s30, s43, 0x1000000
    s_add_u32 s31, s43, 0x2000000
    s_lshr_b32 s43, s43, 1
    s_add_u32 s32, s43, 0x220000
    s_waitcnt vmcnt(18)
    s_barrier
    v_xor_b32 v13, 0x0, v11
    v_add_u32 v13, 0x0, v13
    ds_read_b64_tr_b16 v[80:81], v13
    ds_read_b64_tr_b16 v[82:83], v13 offset:1024
    ds_read_b64_tr_b16 v[84:85], v13 offset:16384
    ds_read_b64_tr_b16 v[86:87], v13 offset:17408
    v_xor_b32 v13, 0x20, v11
    v_add_u32 v13, 0x0, v13
    ds_read_b64_tr_b16 v[56:57], v13
    ds_read_b64_tr_b16 v[58:59], v13 offset:1024
    ds_read_b64_tr_b16 v[60:61], v13 offset:16384
    ds_read_b64_tr_b16 v[62:63], v13 offset:17408
    v_xor_b32 v13, 0x1000, v11
    v_add_u32 v13, 0x0, v13
    ds_read_b64_tr_b16 a[0:1], v13
    ds_read_b64_tr_b16 a[2:3], v13 offset:1024
    ds_read_b64_tr_b16 a[4:5], v13 offset:16384
    ds_read_b64_tr_b16 a[6:7], v13 offset:17408
    v_xor_b32 v13, 0x1020, v11
    v_add_u32 v13, 0x0, v13
    ds_read_b64_tr_b16 a[8:9], v13
    ds_read_b64_tr_b16 a[10:11], v13 offset:1024
    ds_read_b64_tr_b16 a[12:13], v13 offset:16384
    ds_read_b64_tr_b16 a[14:15], v13 offset:17408
    s_waitcnt lgkmcnt(0)
    s_barrier
    s_add_u32 s43, s41, 0x280000
    s_add_u32 m0, s51, 0x1c000
    s_nop 0
    buffer_load_dwordx4 v15, s[12:15], s43 offen lds
    s_add_u32 s43, s41, 0x288000
    s_add_u32 m0, s51, 0x1d000
    s_nop 0
    buffer_load_dwordx4 v15, s[12:15], s43 offen lds
    s_add_u32 s43, s41, 0x380000
    s_add_u32 m0, s51, 0x1e000
    s_nop 0
    buffer_load_dwordx4 v15, s[12:15], s43 offen lds
    s_add_u32 s43, s41, 0x388000
    s_add_u32 m0, s51, 0x1f000
    s_nop 0
    buffer_load_dwordx4 v15, s[12:15], s43 offen lds
    v_xor_b32 v15, 2, v14
    v_lshl_add_u32 v15, v15, 15, v8
    s_add_u32 s43, s41, 0x80000
    s_add_u32 m0, s51, 0x20000
    s_nop 0
    buffer_load_dwordx4 v15, s[12:15], s43 offen lds
    s_add_u32 s43, s41, 0x88000
    s_add_u32 m0, s51, 0x21000
    s_nop 0
    buffer_load_dwordx4 v15, s[12:15], s43 offen lds
    s_add_u32 s43, s41, 0x180000
    s_add_u32 m0, s51, 0x22000
    s_nop 0
    buffer_load_dwordx4 v15, s[12:15], s43 offen lds
    s_add_u32 s43, s41, 0x188000
    s_add_u32 m0, s51, 0x23000
    s_nop 0
    buffer_load_dwordx4 v15, s[12:15], s43 offen lds
    s_waitcnt vmcnt(18)
    s_barrier
    v_xor_b32 v13, 0x0, v11
    v_add_u32 v13, 0x8000, v13
    ds_read_b64_tr_b16 a[32:33], v13
    ds_read_b64_tr_b16 a[34:35], v13 offset:1024
    ds_read_b64_tr_b16 a[36:37], v13 offset:16384
    ds_read_b64_tr_b16 a[38:39], v13 offset:17408
    v_xor_b32 v13, 0x20, v11
    v_add_u32 v13, 0x8000, v13
    ds_read_b64_tr_b16 a[40:41], v13
    ds_read_b64_tr_b16 a[42:43], v13 offset:1024
    ds_read_b64_tr_b16 a[44:45], v13 offset:16384
    ds_read_b64_tr_b16 a[46:47], v13 offset:17408
    v_xor_b32 v13, 0x1000, v11
    v_add_u32 v13, 0x8000, v13
    ds_read_b64_tr_b16 a[64:65], v13
    ds_read_b64_tr_b16 a[66:67], v13 offset:1024
    ds_read_b64_tr_b16 a[68:69], v13 offset:16384
    ds_read_b64_tr_b16 a[70:71], v13 offset:17408
    v_xor_b32 v13, 0x1020, v11
    v_add_u32 v13, 0x8000, v13
    ds_read_b64_tr_b16 a[72:73], v13
    ds_read_b64_tr_b16 a[74:75], v13 offset:1024
    ds_read_b64_tr_b16 a[76:77], v13 offset:16384
    ds_read_b64_tr_b16 a[78:79], v13 offset:17408
    s_waitcnt lgkmcnt(0)
    s_barrier
    s_add_u32 s43, s41, 0x280000
    s_add_u32 m0, s51, 0x24000
    s_nop 0
    buffer_load_dwordx4 v15, s[12:15], s43 offen lds
    s_add_u32 s43, s41, 0x288000
    s_add_u32 m0, s51, 0x25000
    s_nop 0
    buffer_load_dwordx4 v15, s[12:15], s43 offen lds
    s_add_u32 s43, s41, 0x380000
    s_add_u32 m0, s51, 0x26000
    s_nop 0
    buffer_load_dwordx4 v15, s[12:15], s43 offen lds
    s_add_u32 s43, s41, 0x388000
    s_add_u32 m0, s51, 0x27000
    s_nop 0
    buffer_load_dwordx4 v15, s[12:15], s43 offen lds
    s_mov_b32 s12, s62
    s_and_b32 s13, s63, 0xffff
    v_xor_b32 v15, 0, v14
    v_lshl_add_u32 v15, v15, 15, v8
    s_add_u32 s43, s41, 0x0
    s_add_u32 m0, s51, 0x8000
    s_nop 0
    buffer_load_dwordx4 v15, s[12:15], s43 offen lds
    s_add_u32 s43, s41, 0x8000
    s_add_u32 m0, s51, 0x9000
    s_nop 0
    buffer_load_dwordx4 v15, s[12:15], s43 offen lds
    s_add_u32 s43, s41, 0x100000
    s_add_u32 m0, s51, 0xa000
    s_nop 0
    buffer_load_dwordx4 v15, s[12:15], s43 offen lds
    s_add_u32 s43, s41, 0x108000
    s_add_u32 m0, s51, 0xb000
    s_nop 0
    buffer_load_dwordx4 v15, s[12:15], s43 offen lds
    s_waitcnt vmcnt(12)
    s_barrier
    v_xor_b32 v13, 0x0, v11
    v_add_u32 v13, 0x10000, v13
    ds_read_b64_tr_b16 v[88:89], v13
    ds_read_b64_tr_b16 v[90:91], v13 offset:1024
    ds_read_b64_tr_b16 v[92:93], v13 offset:16384
    ds_read_b64_tr_b16 v[94:95], v13 offset:17408
    v_xor_b32 v13, 0x20, v11
    v_add_u32 v13, 0x10000, v13
    ds_read_b64_tr_b16 v[96:97], v13
    ds_read_b64_tr_b16 v[98:99], v13 offset:1024
    ds_read_b64_tr_b16 v[100:101], v13 offset:16384
    ds_read_b64_tr_b16 v[102:103], v13 offset:17408
    v_xor_b32 v13, 0x1000, v11
    v_add_u32 v13, 0x10000, v13
    ds_read_b64_tr_b16 a[16:17], v13
    ds_read_b64_tr_b16 a[18:19], v13 offset:1024
    ds_read_b64_tr_b16 a[20:21], v13 offset:16384
    ds_read_b64_tr_b16 a[22:23], v13 offset:17408
    v_xor_b32 v13, 0x1020, v11
    v_add_u32 v13, 0x10000, v13
    ds_read_b64_tr_b16 a[24:25], v13
    ds_read_b64_tr_b16 a[26:27], v13 offset:1024
    ds_read_b64_tr_b16 a[28:29], v13 offset:16384
    ds_read_b64_tr_b16 a[30:31], v13 offset:17408
    s_waitcnt lgkmcnt(0)
    s_barrier
    s_add_u32 s43, s41, 0x200000
    s_add_u32 m0, s51, 0xc000
    s_nop 0
    buffer_load_dwordx4 v15, s[12:15], s43 offen lds
    s_add_u32 s43, s41, 0x208000
    s_add_u32 m0, s51, 0xd000
    s_nop 0
    buffer_load_dwordx4 v15, s[12:15], s43 offen lds
    s_add_u32 s43, s41, 0x300000
    s_add_u32 m0, s51, 0xe000
    s_nop 0
    buffer_load_dwordx4 v15, s[12:15], s43 offen lds
    s_add_u32 s43, s41, 0x308000
    s_add_u32 m0, s51, 0xf000
    s_nop 0
    buffer_load_dwordx4 v15, s[12:15], s43 offen lds
    v_xor_b32 v15, 2, v14
    v_lshl_add_u32 v15, v15, 15, v8
    s_add_u32 s43, s41, 0x0
    s_add_u32 m0, s51, 0x10000
    s_nop 0
    buffer_load_dwordx4 v15, s[12:15], s43 offen lds
    s_add_u32 s43, s41, 0x8000
    s_add_u32 m0, s51, 0x11000
    s_nop 0
    buffer_load_dwordx4 v15, s[12:15], s43 offen lds
    s_add_u32 s43, s41, 0x100000
    s_add_u32 m0, s51, 0x12000
    s_nop 0
    buffer_load_dwordx4 v15, s[12:15], s43 offen lds
    s_add_u32 s43, s41, 0x108000
    s_add_u32 m0, s51, 0x13000
    s_nop 0
    buffer_load_dwordx4 v15, s[12:15], s43 offen lds
    s_waitcnt vmcnt(12)
    s_barrier
    v_xor_b32 v13, 0x0, v11
    v_add_u32 v13, 0x18000, v13
    ds_read_b64_tr_b16 a[48:49], v13
    ds_read_b64_tr_b16 a[50:51], v13 offset:1024
    ds_read_b64_tr_b16 a[52:53], v13 offset:16384
    ds_read_b64_tr_b16 a[54:55], v13 offset:17408
    v_xor_b32 v13, 0x20, v11
    v_add_u32 v13, 0x18000, v13
    ds_read_b64_tr_b16 a[56:57], v13
    ds_read_b64_tr_b16 a[58:59], v13 offset:1024
    ds_read_b64_tr_b16 a[60:61], v13 offset:16384
    ds_read_b64_tr_b16 a[62:63], v13 offset:17408
    v_xor_b32 v13, 0x1000, v11
    v_add_u32 v13, 0x18000, v13
    ds_read_b64_tr_b16 a[80:81], v13
    ds_read_b64_tr_b16 a[82:83], v13 offset:1024
    ds_read_b64_tr_b16 a[84:85], v13 offset:16384
    ds_read_b64_tr_b16 a[86:87], v13 offset:17408
    v_xor_b32 v13, 0x1020, v11
    v_add_u32 v13, 0x18000, v13
    ds_read_b64_tr_b16 a[88:89], v13
    ds_read_b64_tr_b16 a[90:91], v13 offset:1024
    ds_read_b64_tr_b16 a[92:93], v13 offset:16384
    ds_read_b64_tr_b16 a[94:95], v13 offset:17408
    s_waitcnt lgkmcnt(0)
    s_barrier
    s_add_u32 s43, s41, 0x200000
    s_add_u32 m0, s51, 0x14000
    s_nop 0
    buffer_load_dwordx4 v15, s[12:15], s43 offen lds
    s_add_u32 s43, s41, 0x208000
    s_add_u32 m0, s51, 0x15000
    s_nop 0
    buffer_load_dwordx4 v15, s[12:15], s43 offen lds
    s_add_u32 s43, s41, 0x300000
    s_add_u32 m0, s51, 0x16000
    s_nop 0
    buffer_load_dwordx4 v15, s[12:15], s43 offen lds
    s_add_u32 s43, s41, 0x308000
    s_add_u32 m0, s51, 0x17000
    s_nop 0
    buffer_load_dwordx4 v15, s[12:15], s43 offen lds
    v_xor_b32 v15, 0, v14
    v_lshl_add_u32 v15, v15, 15, v8
    s_add_u32 s43, s41, 0x80000
    s_add_u32 m0, s51, 0x18000
    s_nop 0
    buffer_load_dwordx4 v15, s[12:15], s43 offen lds
    s_add_u32 s43, s41, 0x88000
    s_add_u32 m0, s51, 0x19000
    s_nop 0
    buffer_load_dwordx4 v15, s[12:15], s43 offen lds
    s_add_u32 s43, s41, 0x180000
    s_add_u32 m0, s51, 0x1a000
    s_nop 0
    buffer_load_dwordx4 v15, s[12:15], s43 offen lds
    s_add_u32 s43, s41, 0x188000
    s_add_u32 m0, s51, 0x1b000
    s_nop 0
    buffer_load_dwordx4 v15, s[12:15], s43 offen lds
    s_waitcnt vmcnt(12)
    v_min_u32 v21, 0xfffffffe, v21
    s_mov_b32 s43, 0x7010000
    s_mov_b64 exec, s[38:39]
    buffer_store_dword v21, v119, s[8:11], s43 offen sc1
    s_mov_b64 exec, -1
    s_barrier
    v_xor_b32 v13, 0x0, v11
    v_add_u32 v13, 0x0, v13
    ds_read_b64_tr_b16 v[64:65], v13
    ds_read_b64_tr_b16 v[66:67], v13 offset:1024
    ds_read_b64_tr_b16 v[68:69], v13 offset:16384
    ds_read_b64_tr_b16 v[70:71], v13 offset:17408
    v_xor_b32 v13, 0x20, v11
    v_add_u32 v13, 0x0, v13
    ds_read_b64_tr_b16 v[72:73], v13
    ds_read_b64_tr_b16 v[74:75], v13 offset:1024
    ds_read_b64_tr_b16 v[76:77], v13 offset:16384
    ds_read_b64_tr_b16 v[78:79], v13 offset:17408
    v_xor_b32 v13, 0x1000, v11
    v_add_u32 v13, 0x0, v13
    ds_read_b64_tr_b16 a[96:97], v13
    ds_read_b64_tr_b16 a[98:99], v13 offset:1024
    ds_read_b64_tr_b16 a[100:101], v13 offset:16384
    ds_read_b64_tr_b16 a[102:103], v13 offset:17408
    v_xor_b32 v13, 0x1020, v11
    v_add_u32 v13, 0x0, v13
    ds_read_b64_tr_b16 a[104:105], v13
    ds_read_b64_tr_b16 a[106:107], v13 offset:1024
    ds_read_b64_tr_b16 a[108:109], v13 offset:16384
    ds_read_b64_tr_b16 a[110:111], v13 offset:17408
    s_waitcnt lgkmcnt(0)
    s_barrier
    s_add_u32 s43, s41, 0x280000
    s_add_u32 m0, s51, 0x1c000
    s_nop 0
    buffer_load_dwordx4 v15, s[12:15], s43 offen lds
    s_add_u32 s43, s41, 0x288000
    s_add_u32 m0, s51, 0x1d000
    s_nop 0
    buffer_load_dwordx4 v15, s[12:15], s43 offen lds
    s_add_u32 s43, s41, 0x380000
    s_add_u32 m0, s51, 0x1e000
    s_nop 0
    buffer_load_dwordx4 v15, s[12:15], s43 offen lds
    s_add_u32 s43, s41, 0x388000
    s_add_u32 m0, s51, 0x1f000
    s_nop 0
    buffer_load_dwordx4 v15, s[12:15], s43 offen lds
    v_xor_b32 v15, 2, v14
    v_lshl_add_u32 v15, v15, 15, v8
    s_add_u32 s43, s41, 0x80000
    s_add_u32 m0, s51, 0x20000
    s_nop 0
    buffer_load_dwordx4 v15, s[12:15], s43 offen lds
    s_add_u32 s43, s41, 0x88000
    s_add_u32 m0, s51, 0x21000
    s_nop 0
    buffer_load_dwordx4 v15, s[12:15], s43 offen lds
    s_add_u32 s43, s41, 0x180000
    s_add_u32 m0, s51, 0x22000
    s_nop 0
    buffer_load_dwordx4 v15, s[12:15], s43 offen lds
    s_add_u32 s43, s41, 0x188000
    s_add_u32 m0, s51, 0x23000
    s_nop 0
    buffer_load_dwordx4 v15, s[12:15], s43 offen lds
    s_waitcnt vmcnt(12)
    s_barrier
    v_xor_b32 v13, 0x0, v11
    v_add_u32 v13, 0x8000, v13
    ds_read_b64_tr_b16 a[128:129], v13
    ds_read_b64_tr_b16 a[130:131], v13 offset:1024
    ds_read_b64_tr_b16 a[132:133], v13 offset:16384
    ds_read_b64_tr_b16 a[134:135], v13 offset:17408
    v_xor_b32 v13, 0x20, v11
    v_add_u32 v13, 0x8000, v13
    ds_read_b64_tr_b16 a[136:137], v13
    ds_read_b64_tr_b16 a[138:139], v13 offset:1024
    ds_read_b64_tr_b16 a[140:141], v13 offset:16384
    ds_read_b64_tr_b16 a[142:143], v13 offset:17408
    v_xor_b32 v13, 0x1000, v11
    v_add_u32 v13, 0x8000, v13
    ds_read_b64_tr_b16 a[160:161], v13
    ds_read_b64_tr_b16 a[162:163], v13 offset:1024
    ds_read_b64_tr_b16 a[164:165], v13 offset:16384
    ds_read_b64_tr_b16 a[166:167], v13 offset:17408
    v_xor_b32 v13, 0x1020, v11
    v_add_u32 v13, 0x8000, v13
    ds_read_b64_tr_b16 a[168:169], v13
    ds_read_b64_tr_b16 a[170:171], v13 offset:1024
    ds_read_b64_tr_b16 a[172:173], v13 offset:16384
    ds_read_b64_tr_b16 a[174:175], v13 offset:17408
    s_waitcnt lgkmcnt(0)
    s_barrier
    s_add_u32 s43, s41, 0x280000
    s_add_u32 m0, s51, 0x24000
    s_nop 0
    buffer_load_dwordx4 v15, s[12:15], s43 offen lds
    s_add_u32 s43, s41, 0x288000
    s_add_u32 m0, s51, 0x25000
    s_nop 0
    buffer_load_dwordx4 v15, s[12:15], s43 offen lds
    s_add_u32 s43, s41, 0x380000
    s_add_u32 m0, s51, 0x26000
    s_nop 0
    buffer_load_dwordx4 v15, s[12:15], s43 offen lds
    s_add_u32 s43, s41, 0x388000
    s_add_u32 m0, s51, 0x27000
    s_nop 0
    buffer_load_dwordx4 v15, s[12:15], s43 offen lds
    s_mov_b32 s12, s64
    s_and_b32 s13, s65, 0xffff
    v_xor_b32 v15, 0, v14
    v_lshl_add_u32 v15, v15, 15, v8
    s_add_u32 s43, s41, 0x0
    s_add_u32 m0, s51, 0x8000
    s_nop 0
    buffer_load_dwordx4 v15, s[12:15], s43 offen lds
    s_add_u32 s43, s41, 0x8000
    s_add_u32 m0, s51, 0x9000
    s_nop 0
    buffer_load_dwordx4 v15, s[12:15], s43 offen lds
    s_add_u32 s43, s41, 0x100000
    s_add_u32 m0, s51, 0xa000
    s_nop 0
    buffer_load_dwordx4 v15, s[12:15], s43 offen lds
    s_add_u32 s43, s41, 0x108000
    s_add_u32 m0, s51, 0xb000
    s_nop 0
    buffer_load_dwordx4 v15, s[12:15], s43 offen lds
    s_waitcnt vmcnt(12)
    s_barrier
    v_xor_b32 v13, 0x0, v11
    v_add_u32 v13, 0x10000, v13
    ds_read_b64_tr_b16 v[104:105], v13
    ds_read_b64_tr_b16 v[106:107], v13 offset:1024
    ds_read_b64_tr_b16 v[108:109], v13 offset:16384
    ds_read_b64_tr_b16 v[110:111], v13 offset:17408
    v_xor_b32 v13, 0x20, v11
    v_add_u32 v13, 0x10000, v13
    ds_read_b64_tr_b16 v[32:33], v13
    ds_read_b64_tr_b16 v[34:35], v13 offset:1024
    ds_read_b64_tr_b16 v[36:37], v13 offset:16384
    ds_read_b64_tr_b16 v[38:39], v13 offset:17408
    v_xor_b32 v13, 0x1000, v11
    v_add_u32 v13, 0x10000, v13
    ds_read_b64_tr_b16 a[112:113], v13
    ds_read_b64_tr_b16 a[114:115], v13 offset:1024
    ds_read_b64_tr_b16 a[116:117], v13 offset:16384
    ds_read_b64_tr_b16 a[118:119], v13 offset:17408
    v_xor_b32 v13, 0x1020, v11
    v_add_u32 v13, 0x10000, v13
    ds_read_b64_tr_b16 a[120:121], v13
    ds_read_b64_tr_b16 a[122:123], v13 offset:1024
    ds_read_b64_tr_b16 a[124:125], v13 offset:16384
    ds_read_b64_tr_b16 a[126:127], v13 offset:17408
    s_waitcnt lgkmcnt(0)
    s_barrier
    s_add_u32 s43, s41, 0x200000
    s_add_u32 m0, s51, 0xc000
    s_nop 0
    buffer_load_dwordx4 v15, s[12:15], s43 offen lds
    s_add_u32 s43, s41, 0x208000
    s_add_u32 m0, s51, 0xd000
    s_nop 0
    buffer_load_dwordx4 v15, s[12:15], s43 offen lds
    s_add_u32 s43, s41, 0x300000
    s_add_u32 m0, s51, 0xe000
    s_nop 0
    buffer_load_dwordx4 v15, s[12:15], s43 offen lds
    s_add_u32 s43, s41, 0x308000
    s_add_u32 m0, s51, 0xf000
    s_nop 0
    buffer_load_dwordx4 v15, s[12:15], s43 offen lds
    v_xor_b32 v15, 2, v14
    v_lshl_add_u32 v15, v15, 15, v8
    s_add_u32 s43, s41, 0x0
    s_add_u32 m0, s51, 0x10000
    s_nop 0
    buffer_load_dwordx4 v15, s[12:15], s43 offen lds
    s_add_u32 s43, s41, 0x8000
    s_add_u32 m0, s51, 0x11000
    s_nop 0
    buffer_load_dwordx4 v15, s[12:15], s43 offen lds
    s_add_u32 s43, s41, 0x100000
    s_add_u32 m0, s51, 0x12000
    s_nop 0
    buffer_load_dwordx4 v15, s[12:15], s43 offen lds
    s_add_u32 s43, s41, 0x108000
    s_add_u32 m0, s51, 0x13000
    s_nop 0
    buffer_load_dwordx4 v15, s[12:15], s43 offen lds
    s_waitcnt vmcnt(12)
    s_barrier
    v_xor_b32 v13, 0x0, v11
    v_add_u32 v13, 0x18000, v13
    ds_read_b64_tr_b16 a[144:145], v13
    ds_read_b64_tr_b16 a[146:147], v13 offset:1024
    ds_read_b64_tr_b16 a[148:149], v13 offset:16384
    ds_read_b64_tr_b16 a[150:151], v13 offset:17408
    v_xor_b32 v13, 0x20, v11
    v_add_u32 v13, 0x18000, v13
    ds_read_b64_tr_b16 a[152:153], v13
    ds_read_b64_tr_b16 a[154:155], v13 offset:1024
    ds_read_b64_tr_b16 a[156:157], v13 offset:16384
    ds_read_b64_tr_b16 a[158:159], v13 offset:17408
    v_xor_b32 v13, 0x1000, v11
    v_add_u32 v13, 0x18000, v13
    ds_read_b64_tr_b16 a[176:177], v13
    ds_read_b64_tr_b16 a[178:179], v13 offset:1024
    ds_read_b64_tr_b16 a[180:181], v13 offset:16384
    ds_read_b64_tr_b16 a[182:183], v13 offset:17408
    v_xor_b32 v13, 0x1020, v11
    v_add_u32 v13, 0x18000, v13
    ds_read_b64_tr_b16 a[184:185], v13
    ds_read_b64_tr_b16 a[186:187], v13 offset:1024
    ds_read_b64_tr_b16 a[188:189], v13 offset:16384
    ds_read_b64_tr_b16 a[190:191], v13 offset:17408
    s_waitcnt lgkmcnt(0)
    s_barrier
    s_add_u32 s43, s41, 0x200000
    s_add_u32 m0, s51, 0x14000
    s_nop 0
    buffer_load_dwordx4 v15, s[12:15], s43 offen lds
    s_add_u32 s43, s41, 0x208000
    s_add_u32 m0, s51, 0x15000
    s_nop 0
    buffer_load_dwordx4 v15, s[12:15], s43 offen lds
    s_add_u32 s43, s41, 0x300000
    s_add_u32 m0, s51, 0x16000
    s_nop 0
    buffer_load_dwordx4 v15, s[12:15], s43 offen lds
    s_add_u32 s43, s41, 0x308000
    s_add_u32 m0, s51, 0x17000
    s_nop 0
    buffer_load_dwordx4 v15, s[12:15], s43 offen lds
    s_mov_b32 s12, s66
    s_and_b32 s13, s67, 0xffff
    s_add_u32 s43, s42, 0x80
    s_add_u32 m0, s51, 0x18000
    s_nop 0
    buffer_load_dwordx4 v10, s[12:15], s43 offen lds
    s_add_u32 s43, s42, 0x4080
    s_add_u32 m0, s51, 0x19000
    s_nop 0
    buffer_load_dwordx4 v9, s[12:15], s43 offen lds
    s_add_u32 s43, s42, 0x8080
    s_add_u32 m0, s51, 0x1a000
    s_nop 0
    buffer_load_dwordx4 v10, s[12:15], s43 offen lds
    s_add_u32 s43, s42, 0xc080
    s_add_u32 m0, s51, 0x1b000
    s_nop 0
    buffer_load_dwordx4 v9, s[12:15], s43 offen lds
    s_waitcnt vmcnt(12)
    s_barrier
    v_xor_b32 v13, 0x0, v11
    v_add_u32 v13, 0x0, v13
    ds_read_b64_tr_b16 a[192:193], v13
    ds_read_b64_tr_b16 a[194:195], v13 offset:1024
    ds_read_b64_tr_b16 a[196:197], v13 offset:16384
    ds_read_b64_tr_b16 a[198:199], v13 offset:17408
    v_xor_b32 v13, 0x20, v11
    v_add_u32 v13, 0x0, v13
    ds_read_b64_tr_b16 a[200:201], v13
    ds_read_b64_tr_b16 a[202:203], v13 offset:1024
    ds_read_b64_tr_b16 a[204:205], v13 offset:16384
    ds_read_b64_tr_b16 a[206:207], v13 offset:17408
    v_xor_b32 v13, 0x1000, v11
    v_add_u32 v13, 0x0, v13
    ds_read_b64_tr_b16 a[224:225], v13
    ds_read_b64_tr_b16 a[226:227], v13 offset:1024
    ds_read_b64_tr_b16 a[228:229], v13 offset:16384
    ds_read_b64_tr_b16 a[230:231], v13 offset:17408
    v_xor_b32 v13, 0x1020, v11
    v_add_u32 v13, 0x0, v13
    ds_read_b64_tr_b16 a[232:233], v13
    ds_read_b64_tr_b16 a[234:235], v13 offset:1024
    ds_read_b64_tr_b16 a[236:237], v13 offset:16384
    ds_read_b64_tr_b16 a[238:239], v13 offset:17408
    s_waitcnt lgkmcnt(0)
    s_barrier
    s_add_u32 s43, s42, 0x10280
    s_add_u32 m0, s51, 0x1c000
    s_nop 0
    buffer_load_dwordx4 v10, s[12:15], s43 offen lds
    s_add_u32 s43, s42, 0x14280
    s_add_u32 m0, s51, 0x1d000
    s_nop 0
    buffer_load_dwordx4 v9, s[12:15], s43 offen lds
    s_add_u32 s43, s42, 0x18280
    s_add_u32 m0, s51, 0x1e000
    s_nop 0
    buffer_load_dwordx4 v10, s[12:15], s43 offen lds
    s_add_u32 s43, s42, 0x1c280
    s_add_u32 m0, s51, 0x1f000
    s_nop 0
    buffer_load_dwordx4 v9, s[12:15], s43 offen lds
    s_add_u32 s43, s42, 0x10080
    s_add_u32 m0, s51, 0x20000
    s_nop 0
    buffer_load_dwordx4 v10, s[12:15], s43 offen lds
    s_add_u32 s43, s42, 0x14080
    s_add_u32 m0, s51, 0x21000
    s_nop 0
    buffer_load_dwordx4 v9, s[12:15], s43 offen lds
    s_add_u32 s43, s42, 0x18080
    s_add_u32 m0, s51, 0x22000
    s_nop 0
    buffer_load_dwordx4 v10, s[12:15], s43 offen lds
    s_add_u32 s43, s42, 0x1c080
    s_add_u32 m0, s51, 0x23000
    s_nop 0
    buffer_load_dwordx4 v9, s[12:15], s43 offen lds
    s_waitcnt vmcnt(12)
    s_barrier
    s_cmp_lg_u32 s21, 0
    s_cbranch_scc1 L_arr_51
    v_mov_b32 v23, 1
    s_mov_b64 exec, 1
    buffer_atomic_add v23, off, s[16:19], 0 offset:8
    s_mov_b64 exec, -1
L_arr_51:
    v_xor_b32 v13, 0x0, v11
    v_add_u32 v13, 0x8000, v13
    ds_read_b64_tr_b16 v[128:129], v13
    ds_read_b64_tr_b16 v[130:131], v13 offset:1024
    ds_read_b64_tr_b16 v[132:133], v13 offset:16384
    ds_read_b64_tr_b16 v[134:135], v13 offset:17408
    v_xor_b32 v13, 0x20, v11
    v_add_u32 v13, 0x8000, v13
    ds_read_b64_tr_b16 v[136:137], v13
    ds_read_b64_tr_b16 v[138:139], v13 offset:1024
    ds_read_b64_tr_b16 v[140:141], v13 offset:16384
    ds_read_b64_tr_b16 v[142:143], v13 offset:17408
    v_xor_b32 v13, 0x1000, v11
    v_add_u32 v13, 0x8000, v13
    ds_read_b64_tr_b16 v[160:161], v13
    ds_read_b64_tr_b16 v[162:163], v13 offset:1024
    ds_read_b64_tr_b16 v[164:165], v13 offset:16384
    ds_read_b64_tr_b16 v[166:167], v13 offset:17408
    v_xor_b32 v13, 0x1020, v11
    v_add_u32 v13, 0x8000, v13
    ds_read_b64_tr_b16 v[168:169], v13
    ds_read_b64_tr_b16 v[170:171], v13 offset:1024
    ds_read_b64_tr_b16 v[172:173], v13 offset:16384
    ds_read_b64_tr_b16 v[174:175], v13 offset:17408
    s_waitcnt lgkmcnt(0)
    s_barrier
    s_add_u32 s43, s42, 0x280
    s_add_u32 m0, s51, 0x24000
    s_nop 0
    buffer_load_dwordx4 v10, s[12:15], s43 offen lds
    s_add_u32 s43, s42, 0x4280
    s_add_u32 m0, s51, 0x25000
    s_nop 0
    buffer_load_dwordx4 v9, s[12:15], s43 offen lds
    s_add_u32 s43, s42, 0x8280
    s_add_u32 m0, s51, 0x26000
    s_nop 0
    buffer_load_dwordx4 v10, s[12:15], s43 offen lds
    s_add_u32 s43, s42, 0xc280
    s_add_u32 m0, s51, 0x27000
    s_nop 0
    buffer_load_dwordx4 v9, s[12:15], s43 offen lds
    s_mov_b32 s12, s64
    s_and_b32 s13, s65, 0xffff
    v_xor_b32 v15, 0, v14
    v_lshl_add_u32 v15, v15, 15, v8
    s_add_u32 s43, s41, 0x80000
    s_add_u32 m0, s51, 0x8000
    s_nop 0
    buffer_load_dwordx4 v15, s[12:15], s43 offen lds
    s_add_u32 s43, s41, 0x88000
    s_add_u32 m0, s51, 0x9000
    s_nop 0
    buffer_load_dwordx4 v15, s[12:15], s43 offen lds
    s_add_u32 s43, s41, 0x180000
    s_add_u32 m0, s51, 0xa000
    s_nop 0
    buffer_load_dwordx4 v15, s[12:15], s43 offen lds
    s_add_u32 s43, s41, 0x188000
    s_add_u32 m0, s51, 0xb000
    s_nop 0
    buffer_load_dwordx4 v15, s[12:15], s43 offen lds
    s_waitcnt vmcnt(12)
    s_barrier
    v_xor_b32 v13, 0x0, v12
    v_add_u32 v13, 0x10000, v13
    ds_read_b64_tr_b16 v[192:193], v13
    ds_read_b64_tr_b16 v[194:195], v13 offset:512
    ds_read_b64_tr_b16 v[196:197], v13 offset:2048
    ds_read_b64_tr_b16 v[198:199], v13 offset:2560
    v_xor_b32 v13, 0x2000, v12
    v_add_u32 v13, 0x10000, v13
    ds_read_b64_tr_b16 v[200:201], v13
    ds_read_b64_tr_b16 v[202:203], v13 offset:512
    ds_read_b64_tr_b16 v[204:205], v13 offset:2048
    ds_read_b64_tr_b16 v[206:207], v13 offset:2560
    v_xor_b32 v13, 0x40, v12
    v_add_u32 v13, 0x10000, v13
    ds_read_b64_tr_b16 v[224:225], v13
    ds_read_b64_tr_b16 v[226:227], v13 offset:512
    ds_read_b64_tr_b16 v[228:229], v13 offset:2048
    ds_read_b64_tr_b16 v[230:231], v13 offset:2560
    v_xor_b32 v13, 0x2040, v12
    v_add_u32 v13, 0x10000, v13
    ds_read_b64_tr_b16 v[232:233], v13
    ds_read_b64_tr_b16 v[234:235], v13 offset:512
    ds_read_b64_tr_b16 v[236:237], v13 offset:2048
    ds_read_b64_tr_b16 v[238:239], v13 offset:2560
    s_waitcnt lgkmcnt(0)
    s_barrier
    s_add_u32 s43, s41, 0x280000
    s_add_u32 m0, s51, 0xc000
    s_nop 0
    buffer_load_dwordx4 v15, s[12:15], s43 offen lds
    s_add_u32 s43, s41, 0x288000
    s_add_u32 m0, s51, 0xd000
    s_nop 0
    buffer_load_dwordx4 v15, s[12:15], s43 offen lds
    s_add_u32 s43, s41, 0x380000
    s_add_u32 m0, s51, 0xe000
    s_nop 0
    buffer_load_dwordx4 v15, s[12:15], s43 offen lds
    s_add_u32 s43, s41, 0x388000
    s_add_u32 m0, s51, 0xf000
    s_nop 0
    buffer_load_dwordx4 v15, s[12:15], s43 offen lds
    v_xor_b32 v15, 2, v14
    v_lshl_add_u32 v15, v15, 15, v8
    s_add_u32 s43, s41, 0x80000
    s_add_u32 m0, s51, 0x10000
    s_nop 0
    buffer_load_dwordx4 v15, s[12:15], s43 offen lds
    s_add_u32 s43, s41, 0x88000
    s_add_u32 m0, s51, 0x11000
    s_nop 0
    buffer_load_dwordx4 v15, s[12:15], s43 offen lds
    s_add_u32 s43, s41, 0x180000
    s_add_u32 m0, s51, 0x12000
    s_nop 0
    buffer_load_dwordx4 v15, s[12:15], s43 offen lds
    s_add_u32 s43, s41, 0x188000
    s_add_u32 m0, s51, 0x13000
    s_nop 0
    buffer_load_dwordx4 v15, s[12:15], s43 offen lds
    s_waitcnt vmcnt(12)
    s_barrier
    v_xor_b32 v13, 0x0, v12
    v_add_u32 v13, 0x18000, v13
    ds_read_b64_tr_b16 v[208:209], v13
    ds_read_b64_tr_b16 v[210:211], v13 offset:512
    ds_read_b64_tr_b16 v[212:213], v13 offset:2048
    ds_read_b64_tr_b16 v[214:215], v13 offset:2560
    v_xor_b32 v13, 0x2000, v12
    v_add_u32 v13, 0x18000, v13
    ds_read_b64_tr_b16 v[216:217], v13
    ds_read_b64_tr_b16 v[218:219], v13 offset:512
    ds_read_b64_tr_b16 v[220:221], v13 offset:2048
    ds_read_b64_tr_b16 v[222:223], v13 offset:2560
    v_xor_b32 v13, 0x40, v12
    v_add_u32 v13, 0x18000, v13
    ds_read_b64_tr_b16 v[240:241], v13
    ds_read_b64_tr_b16 v[242:243], v13 offset:512
    ds_read_b64_tr_b16 v[244:245], v13 offset:2048
    ds_read_b64_tr_b16 v[246:247], v13 offset:2560
    v_xor_b32 v13, 0x2040, v12
    v_add_u32 v13, 0x18000, v13
    ds_read_b64_tr_b16 v[248:249], v13
    ds_read_b64_tr_b16 v[250:251], v13 offset:512
    ds_read_b64_tr_b16 v[252:253], v13 offset:2048
    ds_read_b64_tr_b16 v[254:255], v13 offset:2560
    s_waitcnt lgkmcnt(0)
    s_barrier
    s_add_u32 s43, s41, 0x280000
    s_add_u32 m0, s51, 0x14000
    s_nop 0
    buffer_load_dwordx4 v15, s[12:15], s43 offen lds
    s_add_u32 s43, s41, 0x288000
    s_add_u32 m0, s51, 0x15000
    s_nop 0
    buffer_load_dwordx4 v15, s[12:15], s43 offen lds
    s_add_u32 s43, s41, 0x380000
    s_add_u32 m0, s51, 0x16000
    s_nop 0
    buffer_load_dwordx4 v15, s[12:15], s43 offen lds
    s_add_u32 s43, s41, 0x388000
    s_add_u32 m0, s51, 0x17000
    s_nop 0
    buffer_load_dwordx4 v15, s[12:15], s43 offen lds
    ds_write_b128 v124, v[192:195]
    ds_write_b128 v124, v[196:199] offset:1024
    ds_write_b128 v124, v[200:203] offset:2048
    ds_write_b128 v124, v[204:207] offset:3072
    ds_write_b128 v124, v[208:211] offset:4096
    ds_write_b128 v124, v[212:215] offset:5120
    ds_write_b128 v124, v[216:219] offset:6144
    ds_write_b128 v124, v[220:223] offset:7168
    ds_write_b128 v124, v[224:227] offset:32768
    ds_write_b128 v124, v[228:231] offset:33792
    ds_write_b128 v124, v[232:235] offset:34816
    ds_write_b128 v124, v[236:239] offset:35840
    ds_write_b128 v124, v[240:243] offset:36864
    ds_write_b128 v124, v[244:247] offset:37888
    ds_write_b128 v124, v[248:251] offset:38912
    ds_write_b128 v124, v[252:255] offset:39936
    s_waitcnt vmcnt(8)
    s_barrier
    v_xor_b32 v13, 0x0, v11
    v_add_u32 v13, 0x0, v13
    ds_read_b64_tr_b16 a[208:209], v13
    ds_read_b64_tr_b16 a[210:211], v13 offset:1024
    ds_read_b64_tr_b16 a[212:213], v13 offset:16384
    ds_read_b64_tr_b16 a[214:215], v13 offset:17408
    v_xor_b32 v13, 0x20, v11
    v_add_u32 v13, 0x0, v13
    ds_read_b64_tr_b16 a[216:217], v13
    ds_read_b64_tr_b16 a[218:219], v13 offset:1024
    ds_read_b64_tr_b16 a[220:221], v13 offset:16384
    ds_read_b64_tr_b16 a[222:223], v13 offset:17408
    v_xor_b32 v13, 0x1000, v11
    v_add_u32 v13, 0x0, v13
    ds_read_b64_tr_b16 a[240:241], v13
    ds_read_b64_tr_b16 a[242:243], v13 offset:1024
    ds_read_b64_tr_b16 a[244:245], v13 offset:16384
    ds_read_b64_tr_b16 a[246:247], v13 offset:17408
    v_xor_b32 v13, 0x1020, v11
    v_add_u32 v13, 0x0, v13
    ds_read_b64_tr_b16 a[248:249], v13
    ds_read_b64_tr_b16 a[250:251], v13 offset:1024
    ds_read_b64_tr_b16 a[252:253], v13 offset:16384
    ds_read_b64_tr_b16 a[254:255], v13 offset:17408
    s_waitcnt lgkmcnt(0)
    s_barrier
    s_mov_b32 s12, s66
    s_and_b32 s13, s67, 0xffff
    s_add_u32 s43, s42, 0x0
    s_add_u32 m0, s51, 0x8000
    s_nop 0
    buffer_load_dwordx4 v10, s[12:15], s43 offen lds
    s_add_u32 s43, s42, 0x4000
    s_add_u32 m0, s51, 0x9000
    s_nop 0
    buffer_load_dwordx4 v9, s[12:15], s43 offen lds
    s_add_u32 s43, s42, 0x8000
    s_add_u32 m0, s51, 0xa000
    s_nop 0
    buffer_load_dwordx4 v10, s[12:15], s43 offen lds
    s_add_u32 s43, s42, 0xc000
    s_add_u32 m0, s51, 0xb000
    s_nop 0
    buffer_load_dwordx4 v9, s[12:15], s43 offen lds
    s_add_u32 s43, s42, 0x10200
    s_add_u32 m0, s51, 0xc000
    s_nop 0
    buffer_load_dwordx4 v10, s[12:15], s43 offen lds
    s_add_u32 s43, s42, 0x14200
    s_add_u32 m0, s51, 0xd000
    s_nop 0
    buffer_load_dwordx4 v9, s[12:15], s43 offen lds
    s_add_u32 s43, s42, 0x18200
    s_add_u32 m0, s51, 0xe000
    s_nop 0
    buffer_load_dwordx4 v10, s[12:15], s43 offen lds
    s_add_u32 s43, s42, 0x1c200
    s_add_u32 m0, s51, 0xf000
    s_nop 0
    buffer_load_dwordx4 v9, s[12:15], s43 offen lds
    s_waitcnt vmcnt(8)
    s_barrier
    v_xor_b32 v13, 0x0, v11
    v_add_u32 v13, 0x8000, v13
    ds_read_b64_tr_b16 v[144:145], v13
    ds_read_b64_tr_b16 v[146:147], v13 offset:1024
    ds_read_b64_tr_b16 v[148:149], v13 offset:16384
    ds_read_b64_tr_b16 v[150:151], v13 offset:17408
    v_xor_b32 v13, 0x20, v11
    v_add_u32 v13, 0x8000, v13
    ds_read_b64_tr_b16 v[152:153], v13
    ds_read_b64_tr_b16 v[154:155], v13 offset:1024
    ds_read_b64_tr_b16 v[156:157], v13 offset:16384
    ds_read_b64_tr_b16 v[158:159], v13 offset:17408
    v_xor_b32 v13, 0x1000, v11
    v_add_u32 v13, 0x8000, v13
    ds_read_b64_tr_b16 v[176:177], v13
    ds_read_b64_tr_b16 v[178:179], v13 offset:1024
    ds_read_b64_tr_b16 v[180:181], v13 offset:16384
    ds_read_b64_tr_b16 v[182:183], v13 offset:17408
    v_xor_b32 v13, 0x1020, v11
    v_add_u32 v13, 0x8000, v13
    ds_read_b64_tr_b16 v[184:185], v13
    ds_read_b64_tr_b16 v[186:187], v13 offset:1024
    ds_read_b64_tr_b16 v[188:189], v13 offset:16384
    ds_read_b64_tr_b16 v[190:191], v13 offset:17408
    s_waitcnt lgkmcnt(0)
    s_barrier
    s_add_u32 s43, s42, 0x10000
    s_add_u32 m0, s51, 0x10000
    s_nop 0
    buffer_load_dwordx4 v10, s[12:15], s43 offen lds
    s_add_u32 s43, s42, 0x14000
    s_add_u32 m0, s51, 0x11000
    s_nop 0
    buffer_load_dwordx4 v9, s[12:15], s43 offen lds
    s_add_u32 s43, s42, 0x18000
    s_add_u32 m0, s51, 0x12000
    s_nop 0
    buffer_load_dwordx4 v10, s[12:15], s43 offen lds
    s_add_u32 s43, s42, 0x1c000
    s_add_u32 m0, s51, 0x13000
    s_nop 0
    buffer_load_dwordx4 v9, s[12:15], s43 offen lds
    s_add_u32 s43, s42, 0x200
    s_add_u32 m0, s51, 0x14000
    s_nop 0
    buffer_load_dwordx4 v10, s[12:15], s43 offen lds
    s_add_u32 s43, s42, 0x4200
    s_add_u32 m0, s51, 0x15000
    s_nop 0
    buffer_load_dwordx4 v9, s[12:15], s43 offen lds
    s_add_u32 s43, s42, 0x8200
    s_add_u32 m0, s51, 0x16000
    s_nop 0
    buffer_load_dwordx4 v10, s[12:15], s43 offen lds
    s_add_u32 s43, s42, 0xc200
    s_add_u32 m0, s51, 0x17000
    s_nop 0
    buffer_load_dwordx4 v9, s[12:15], s43 offen lds
    s_waitcnt vmcnt(8)
    s_barrier
    v_xor_b32 v13, 0x0, v12
    v_add_u32 v13, 0x0, v13
    ds_read_b64_tr_b16 v[192:193], v13
    ds_read_b64_tr_b16 v[194:195], v13 offset:512
    ds_read_b64_tr_b16 v[196:197], v13 offset:2048
    ds_read_b64_tr_b16 v[198:199], v13 offset:2560
    v_xor_b32 v13, 0x2000, v12
    v_add_u32 v13, 0x0, v13
    ds_read_b64_tr_b16 v[200:201], v13
    ds_read_b64_tr_b16 v[202:203], v13 offset:512
    ds_read_b64_tr_b16 v[204:205], v13 offset:2048
    ds_read_b64_tr_b16 v[206:207], v13 offset:2560
    v_xor_b32 v13, 0x40, v12
    v_add_u32 v13, 0x0, v13
    ds_read_b64_tr_b16 v[224:225], v13
    ds_read_b64_tr_b16 v[226:227], v13 offset:512
    ds_read_b64_tr_b16 v[228:229], v13 offset:2048
    ds_read_b64_tr_b16 v[230:231], v13 offset:2560
    v_xor_b32 v13, 0x2040, v12
    v_add_u32 v13, 0x0, v13
    ds_read_b64_tr_b16 v[232:233], v13
    ds_read_b64_tr_b16 v[234:235], v13 offset:512
    ds_read_b64_tr_b16 v[236:237], v13 offset:2048
    ds_read_b64_tr_b16 v[238:239], v13 offset:2560
    s_lshr_b32 s43, s20, 1
    s_lshl_b32 s43, s43, 7
    s_and_b32 s40, s20, 1
    s_lshl_b32 s40, s40, 4
    s_add_u32 s43, s43, s40
    s_add_u32 s44, s43, 0x1000
    s_cmp_eq_u32 s21, 0
    s_cselect_b32 s44, s44, 0x7ff00000
    s_mov_b32 s22, 0
    s_mov_b32 s33, 0
    s_xor_b32 s53, s29, 1024
    s_add_u32 s23, s51, 0x7010000
    s_add_u32 s48, s23, 4096
    s_mov_b32 s24, 0x7012000
    s_add_u32 s55, s24, 16384
    s_mov_b32 s25, 0x7100000
    s_mov_b32 s26, 0x7101000
    v_mov_b32 v112, 0
    v_mov_b32 v113, 0
    v_mov_b32 v114, 0
    v_mov_b32 v115, 0
    ds_write_b128 v117, v[112:115] offset:22528
    ds_write_b128 v117, v[112:115] offset:23552
    s_cmp_lg_u32 s21, 0
    s_cselect_b32 s40, -1, 0
    v_mov_b32 v126, s40
    v_bfe_u32 v1, v117, 4, 1
    v_lshlrev_b32 v1, 4, v1
    s_movk_i32 s43, 0x3f80
    v_lshlrev_b32 v125, v1, s43
    v_bfe_u32 v1, v117, 5, 3
    v_cmp_eq_u32 s[68:69], 0, v1
    v_cmp_eq_u32 s[70:71], 1, v1
    v_cmp_eq_u32 s[72:73], 2, v1
    v_cmp_eq_u32 s[74:75], 3, v1
    v_mov_b32 v40, 0
    v_mov_b32 v41, 0
    v_mov_b32 v42, 0
    v_mov_b32 v43, 0
    v_mov_b32 v44, 0
    v_mov_b32 v45, 0
    v_mov_b32 v46, 0
    v_mov_b32 v47, 0
    v_mov_b32 v48, 0
    v_mov_b32 v49, 0
    v_mov_b32 v50, 0
    v_mov_b32 v51, 0
    v_mov_b32 v52, 0
    v_mov_b32 v53, 0
    v_mov_b32 v54, 0
    v_mov_b32 v55, 0
    s_mov_b32 s45, 0
    s_mov_b32 s46, 0
    s_mov_b32 s47, 0
    s_mov_b32 s76, 0
    s_and_b32 s43, s21, 1
    s_lshl_b32 s43, s43, 5
    s_add_u32 s43, s43, s20
    s_lshl_b32 s43, s43, 6
    s_add_u32 s28, s43, 0x2000
    s_mov_b32 s59, 0
    s_waitcnt vmcnt(0) lgkmcnt(0)
    s_barrier
    v_xor_b32 v13, 0x0, v12
    v_add_u32 v13, 0x8000, v13
    ds_read_b64_tr_b16 v[208:209], v13
    ds_read_b64_tr_b16 v[210:211], v13 offset:512
    ds_read_b64_tr_b16 v[212:213], v13 offset:2048
    ds_read_b64_tr_b16 v[214:215], v13 offset:2560
    v_xor_b32 v13, 0x2000, v12
    v_add_u32 v13, 0x8000, v13
    ds_read_b64_tr_b16 v[216:217], v13
    ds_read_b64_tr_b16 v[218:219], v13 offset:512
    ds_read_b64_tr_b16 v[220:221], v13 offset:2048
    ds_read_b64_tr_b16 v[222:223], v13 offset:2560
    v_xor_b32 v13, 0x40, v12
    v_add_u32 v13, 0x8000, v13
    ds_read_b64_tr_b16 v[240:241], v13
    ds_read_b64_tr_b16 v[242:243], v13 offset:512
    ds_read_b64_tr_b16 v[244:245], v13 offset:2048
    ds_read_b64_tr_b16 v[246:247], v13 offset:2560
    v_xor_b32 v13, 0x2040, v12
    v_add_u32 v13, 0x8000, v13
    ds_read_b64_tr_b16 v[248:249], v13
    ds_read_b64_tr_b16 v[250:251], v13 offset:512
    ds_read_b64_tr_b16 v[252:253], v13 offset:2048
    ds_read_b64_tr_b16 v[254:255], v13 offset:2560
    ds_write_b128 v123, v[80:83]
    ds_write_b128 v123, v[84:87] offset:1024
    ds_write_b128 v123, v[56:59] offset:2048
    ds_write_b128 v123, v[60:63] offset:3072
    ds_write_b128 v123, v[88:91] offset:4096
    ds_write_b128 v123, v[92:95] offset:5120
    ds_write_b128 v123, v[96:99] offset:6144
    ds_write_b128 v123, v[100:103] offset:7168
    s_cmp_eq_u32 s57, 1
    s_cbranch_scc1 L_started_52
    v_lshrrev_b32 v1, 4, v117
    v_and_b32 v2, 15, v1
    v_lshrrev_b32 v1, 4, v1
    v_lshlrev_b32 v1, 11, v1
    v_lshl_add_u32 v1, v2, 2, v1
    s_lshl_b32 s43, s20, 6
    s_add_u32 s43, s43, 0x2000
    s_mov_b32 exec_lo, 0x10001
    s_mov_b32 exec_hi, 0
    s_mov_b32 s96, 0
L_poll_53:
    buffer_load_dword v2, v1, s[8:11], s43 offen sc1
    s_waitcnt vmcnt(0)
    v_cmp_gt_u32 vcc, 1, v2
    s_cbranch_vccz L_polld_54
    s_sleep 8
    s_add_u32 s96, s96, 1
    s_cmp_lt_u32 s96, 0x10000
    s_cbranch_scc1 L_poll_53
L_polld_54:
    s_mov_b64 exec, -1
    s_add_u32 m0, s52, 8192
    s_nop 0
    buffer_load_dwordx4 v117, s[8:11], s30 offen lds
    buffer_load_dwordx4 v117, s[8:11], s30 offen offset:1024 lds
    s_add_u32 m0, s52, 0x6000
    s_nop 0
    buffer_load_dwordx4 v117, s[8:11], s31 offen lds
    buffer_load_dwordx4 v117, s[8:11], s31 offen offset:1024 lds
    s_mov_b32 s49, 0
L_cb_poll_56:
    buffer_load_dword v3, off, s[16:19], 0 offset:8 sc1
    s_waitcnt vmcnt(0)
    v_readfirstlane_b32 s43, v3
    s_nop 0
    s_cmp_ge_u32 s43, 32
    s_cbranch_scc1 L_started_52
    s_sleep 8
    s_add_u32 s49, s49, 1
    s_cmp_lt_u32 s49, 0x40000
    s_cbranch_scc1 L_cb_poll_56
L_started_52:
    v_lshrrev_b32 v1, 2, v117
    s_cmp_lt_u32 s21, 2
    s_cselect_b64 vcc, -1, 0
    v_cndmask_b32 v119, v119, v1, vcc
    s_add_u32 m0, s51, 4096
    v_mov_b32 v24, v32
    v_mov_b32 v25, v33
    v_mov_b32 v26, v34
    v_mov_b32 v27, v35
    v_mov_b32 v28, v36
    v_mov_b32 v29, v37
    v_mov_b32 v30, v38
    v_mov_b32 v31, v39
    s_add_u32 s30, s30, 0x40000
    s_add_u32 s31, s31, 0x40000
    s_mov_b32 s49, 0
    s_waitcnt vmcnt(0) lgkmcnt(0)
    s_barrier
    ds_write_b128 v123, v[64:67] offset:32768
    ds_write_b128 v123, v[68:71] offset:33792
    ds_write_b128 v123, v[72:75] offset:34816
    ds_write_b128 v123, v[76:79] offset:35840
    ds_write_b128 v123, v[104:107] offset:36864
    ds_write_b128 v123, v[108:111] offset:37888
    ds_write_b128 v123, v[32:35] offset:38912
    ds_write_b128 v123, v[36:39] offset:39936
    v_mov_b32 v32, 0
    v_mov_b32 v33, 0
    v_mov_b32 v34, 0
    v_mov_b32 v35, 0
    v_mov_b32 v36, 0
    v_mov_b32 v37, 0
    v_mov_b32 v38, 0
    v_mov_b32 v39, 0
    s_nop 4
    s_cmp_eq_u32 s21, 1
    s_cbranch_scc1 L_chain_top1_s
    s_cmp_eq_u32 s21, 2
    s_cbranch_scc1 L_chain_top2_s
    s_cmp_eq_u32 s21, 3
    s_cbranch_scc1 L_chain_top3_s
.p2align 6
L_chain_top0_s:
    buffer_load_dwordx4 v[0:3], v117, s[8:11], s23 offen sc1
    v_mov_b32 v15, 0
    v_mov_b32 v15, 0
    v_mov_b32 v15, 0
    v_mov_b32 v15, 0
    v_mov_b32 v15, 0
    v_mov_b32 v15, 0
    v_mov_b32 v15, 0
    v_mov_b32 v15, 0
    v_mov_b32 v15, 0
    v_mov_b32 v15, 0
    v_mov_b32 v15, 0
    v_mov_b32 v15, 0
    v_mov_b32 v15, 0
    v_mov_b32 v15, 0
    v_mov_b32 v15, 0
    v_mov_b32 v15, 0
    buffer_load_dwordx4 v[0:3], v117, s[8:11], s23 offen sc1
    v_mov_b32 v15, 0
    v_mov_b32 v15, 0
    v_mov_b32 v15, 0
    v_mov_b32 v15, 0
    v_mov_b32 v15, 0
    v_mov_b32 v15, 0
    v_mov_b32 v15, 0
    v_mov_b32 v15, 0
    v_mov_b32 v15, 0
    v_mov_b32 v15, 0
    v_mov_b32 v15, 0
    v_mov_b32 v15, 0
    v_mov_b32 v15, 0
    v_mov_b32 v15, 0
    v_mov_b32 v15, 0
    v_mov_b32 v15, 0
L_mret_58:
    buffer_load_dwordx4 v[0:3], v117, s[8:11], s23 offen sc1
    s_add_u32 s45, s45, 1
    s_cmp_lt_u32 s45, 0x10000
    s_cselect_b32 s56, -2, -1
    s_nop 3
    v_mov_b32 v32, 0
    v_mov_b32 v33, 0
    v_mov_b32 v34, 0
    v_mov_b32 v35, 0
    s_waitcnt vmcnt(2)
    v_max3_u32 v15, v0, v1, v2
    v_max_u32 v15, v15, v3
    v_cmp_lt_u32 vcc, s56, v15
    v_smfmac_f32_16x16x64_bf16 v[32:35], v[0:3], v[80:87], v116
    s_cbranch_vccnz L_mret_58
    ds_write_b128 v117, v[0:3]
    v_smfmac_f32_16x16x64_bf16 v[36:39], v[0:3], v[56:63], v116
    buffer_load_dwordx4 v[4:7], v117, s[8:11], s48 offen sc1
    v_smfmac_f32_16x16x64_bf16 v[40:43], v[0:3], v[64:71], v116
    buffer_load_dwordx4 v117, s[8:11], s48 offen sc1 lds
    s_mov_b32 m0, 8192
    v_smfmac_f32_16x16x64_bf16 v[44:47], v[0:3], v[72:79], v116
    s_waitcnt lgkmcnt(0)
    s_barrier
    ds_read_b128 v[8:11], v117 offset:1024
    v_smfmac_f32_16x16x64_bf16 v[48:51], v[0:3], a[192:199], v116
    ds_read_b128 v[16:19], v117 offset:2048
    ds_read_b128 v[20:23], v117 offset:3072
    v_smfmac_f32_16x16x64_bf16 v[52:55], v[0:3], a[200:207], v116
    ds_read_b128 v[80:83], v117 offset:14336
    s_waitcnt lgkmcnt(3)
    v_smfmac_f32_16x16x64_bf16 v[32:35], v[8:11], a[0:7], v116
    ds_read_b128 v[84:87], v117 offset:15360
    v_smfmac_f32_16x16x64_bf16 v[36:39], v[8:11], a[8:15], v116
    buffer_store_dwordx4 v[112:115], v117, s[8:11], s32 offen sc1
    s_waitcnt lgkmcnt(3)
    v_smfmac_f32_16x16x64_bf16 v[32:35], v[16:19], a[32:39], v116
    ds_read_b128 v[56:59], v117 offset:8192
    v_smfmac_f32_16x16x64_bf16 v[36:39], v[16:19], a[40:47], v116
    ds_read_b128 v[60:63], v117 offset:9216
    s_waitcnt lgkmcnt(4)
    v_smfmac_f32_16x16x64_bf16 v[32:35], v[20:23], a[64:71], v116
    ds_read_b128 v[64:67], v117 offset:10240
    v_smfmac_f32_16x16x64_bf16 v[36:39], v[20:23], a[72:79], v116
    ds_read_b128 v[68:71], v117 offset:11264
    v_smfmac_f32_16x16x64_bf16 v[40:43], v[8:11], a[96:103], v116
    ds_read_b128 v[72:75], v117 offset:12288
    v_smfmac_f32_16x16x64_bf16 v[40:43], v[16:19], a[128:135], v116
    ds_read_b128 v[76:79], v117 offset:13312
    v_smfmac_f32_16x16x64_bf16 v[40:43], v[20:23], a[160:167], v116
    s_waitcnt vmcnt(2)
    v_max3_u32 v15, v4, v5, v6
    v_smfmac_f32_16x16x64_bf16 v[44:47], v[8:11], a[104:111], v116
    v_max_u32 v15, v15, v7
    v_smfmac_f32_16x16x64_bf16 v[44:47], v[16:19], a[136:143], v116
    s_waitcnt vmcnt(1) lgkmcnt(0)
    v_cmp_lt_u32 vcc, s56, v15
    v_smfmac_f32_16x16x64_bf16 v[44:47], v[20:23], a[168:175], v116
    s_cbranch_vccnz L_mret_59
L_mgo_60:
    v_smfmac_f32_16x16x64_bf16 v[44:47], v[4:7], v[24:31], v116
    s_barrier
    ds_read_b128 v[12:15], v117 offset:5120
    v_smfmac_f32_16x16x64_bf16 v[32:35], v[4:7], v[88:95], v116
    ds_read_b128 v[24:27], v117 offset:6144
    v_smfmac_f32_16x16x64_bf16 v[36:39], v[4:7], v[96:103], v116
    ds_read_b128 v[28:31], v117 offset:7168
    v_smfmac_f32_16x16x64_bf16 v[40:43], v[4:7], v[104:111], v116
    ds_read_b128 v[88:91], v117 offset:24576
    s_waitcnt lgkmcnt(3)
    v_smfmac_f32_16x16x64_bf16 v[32:35], v[12:15], a[16:23], v116
    ds_read_b128 v[92:95], v117 offset:25600
    s_waitcnt lgkmcnt(3)
    v_smfmac_f32_16x16x64_bf16 v[32:35], v[24:27], a[48:55], v116
    buffer_load_dwordx4 v117, s[8:11], s30 offen lds
    s_waitcnt lgkmcnt(2)
    v_smfmac_f32_16x16x64_bf16 v[32:35], v[28:31], a[80:87], v116
    ds_read_b128 v[96:99], v117 offset:23552
    v_smfmac_f32_16x16x64_bf16 v[36:39], v[12:15], a[24:31], v116
    ds_read_b128 v[100:103], v117 offset:23552
    v_smfmac_f32_16x16x64_bf16 v[36:39], v[24:27], a[56:63], v116
    buffer_load_dwordx4 v117, s[8:11], s30 offen offset:1024 lds
    s_add_u32 m0, s52, 0x6000
    v_add_f32 v32, v32, v34
    v_smfmac_f32_16x16x64_bf16 v[36:39], v[28:31], a[88:95], v116
    ds_read_b128 v[104:107], v117 offset:23552
    v_add_f32 v33, v33, v35
    v_smfmac_f32_16x16x64_bf16 v[40:43], v[12:15], a[112:119], v116
    ds_read_b128 v[108:111], v117 offset:23552
    v_mul_f32 v32, s34, v32
    v_smfmac_f32_16x16x64_bf16 v[40:43], v[24:27], a[144:151], v116
    buffer_load_dword v125, v119, s[8:11], s28 offen sc1
    v_mul_f32 v33, s34, v33
    v_smfmac_f32_16x16x64_bf16 v[40:43], v[28:31], a[176:183], v116
    ds_read_b128 v[0:3], v124
    v_add_f32 v36, v36, v38
    v_smfmac_f32_16x16x64_bf16 v[48:51], v[4:7], a[208:215], v116
    v_add_f32 v37, v37, v39
    v_smfmac_f32_16x16x64_bf16 v[52:55], v[4:7], a[216:223], v116
    s_waitcnt lgkmcnt(5)
    buffer_load_dwordx4 v117, s[8:11], s31 offen lds
    v_mul_f32 v36, s34, v36
    v_smfmac_f32_16x16x64_bf16 v[44:47], v[12:15], a[120:127], v116
    ds_read_b128 v[4:7], v124 offset:1024
    v_mul_f32 v37, s34, v37
    v_smfmac_f32_16x16x64_bf16 v[44:47], v[24:27], a[152:159], v116
    v_cvt_pk_bf16_f32 v34, v32, v36
    v_smfmac_f32_16x16x64_bf16 v[44:47], v[28:31], a[184:191], v116
    buffer_load_dwordx4 v117, s[8:11], s31 offen offset:1024 lds
    s_mov_b32 m0, 4096
    v_cvt_pk_bf16_f32 v35, v33, v37
    v_add_f32 v40, v40, v42
    v_smfmac_f32_16x16x64_bf16 v[48:51], v[8:11], a[224:231], v116
    ds_write2_b32 v120, v34, v35 offset0:32 offset1:48
    v_add_f32 v41, v41, v43
    v_smfmac_f32_16x16x64_bf16 v[52:55], v[8:11], a[232:239], v116
    v_add_f32 v44, v44, v46
    v_add_f32 v45, v45, v47
    v_cvt_pk_bf16_f32 v113, v40, v44
    v_cvt_pk_bf16_f32 v115, v41, v45
    v_smfmac_f32_16x16x64_bf16 v[48:51], v[12:15], a[240:247], v116
    ds_write2_b32 v120, v113, v115 offset0:0 offset1:16
    v_smfmac_f32_16x16x64_bf16 v[52:55], v[12:15], a[248:255], v116
    s_cmp_eq_u32 s22, 63
    s_cbranch_scc1 L_chain_last_s
    buffer_store_dword v126, off, s[8:11], s44 sc1
    v_smfmac_f32_16x16x64_bf16 v[48:51], v[16:19], v[128:135], v116
    v_smfmac_f32_16x16x64_bf16 v[48:51], v[20:23], v[160:167], v116
    v_smfmac_f32_16x16x64_bf16 v[48:51], v[24:27], v[144:151], v116
    s_waitcnt lgkmcnt(0)
    s_barrier
    v_smfmac_f32_16x16x64_bf16 v[48:51], v[28:31], v[176:183], v116
    ds_read_b128 v[32:35], v121 offset:16384
    ds_read_b128 v[36:39], v121 offset:17408
    v_smfmac_f32_16x16x64_bf16 v[52:55], v[16:19], v[136:143], v116
    ds_read_b128 v[40:43], v121 offset:18432
    ds_read_b128 v[44:47], v121 offset:19456
    v_smfmac_f32_16x16x64_bf16 v[52:55], v[20:23], v[168:175], v116
    ds_read_b128 v[8:11], v124 offset:32768
    v_add_f32 v48, v48, v50
    v_smfmac_f32_16x16x64_bf16 v[52:55], v[24:27], v[152:159], v116
    ds_read_b128 v[12:15], v124 offset:33792
    v_add_f32 v49, v49, v51
    v_smfmac_f32_16x16x64_bf16 v[52:55], v[28:31], v[184:191], v116
    s_waitcnt lgkmcnt(5)
    v_cvt_pk_bf16_f32 v112, v48, v49
    v_mfma_f32_16x16x32_bf16 v[56:59], v[56:59], v[32:35], 0
    s_waitcnt lgkmcnt(4)
    v_mov_b32 v48, s50
    v_mov_b32 v49, s50
    v_mfma_f32_16x16x32_bf16 v[56:59], v[60:63], v[36:39], v[56:59]
    ds_read_b128 v[16:19], v124 offset:2048
    s_waitcnt lgkmcnt(4)
    v_mov_b32 v50, s50
    v_mov_b32 v51, s50
    v_mfma_f32_16x16x32_bf16 v[56:59], v[64:67], v[40:43], v[56:59]
    ds_read_b128 v[20:23], v124 offset:3072
    s_waitcnt lgkmcnt(4)
    v_add_f32 v52, v52, v54
    v_mfma_f32_16x16x32_bf16 v[56:59], v[68:71], v[44:47], v[56:59]
    ds_read_b128 v[24:27], v124 offset:4096
    v_add_f32 v53, v53, v55
    v_mfma_f32_16x16x32_bf16 v[60:63], v[72:75], v[32:35], 0
    ds_read_b128 v[28:31], v124 offset:5120
    v_cvt_pk_bf16_f32 v114, v52, v53
    v_mov_b32 v53, 0
    v_mfma_f32_16x16x32_bf16 v[60:63], v[76:79], v[36:39], v[60:63]
    v_exp_f32 v56, v56
    v_mfma_f32_16x16x32_bf16 v[60:63], v[80:83], v[40:43], v[60:63]
    v_exp_f32 v57, v57
    v_mfma_f32_16x16x32_bf16 v[60:63], v[84:87], v[44:47], v[60:63]
    v_exp_f32 v58, v58
    v_mfma_f32_16x16x32_bf16 v[64:67], v[32:35], v[32:35], 0
    v_exp_f32 v59, v59
    v_cvt_pk_bf16_f32 v68, v56, v57
    v_mfma_f32_16x16x32_bf16 v[64:67], v[36:39], v[36:39], v[64:67]
    v_exp_f32 v60, v60
    v_cvt_pk_bf16_f32 v69, v58, v59
    v_mfma_f32_16x16x32_bf16 v[64:67], v[40:43], v[40:43], v[64:67]
    v_exp_f32 v61, v61
    v_mfma_f32_16x16x32_bf16 v[64:67], v[44:47], v[44:47], v[64:67]
    v_exp_f32 v62, v62
    v_exp_f32 v63, v63
    v_cvt_pk_bf16_f32 v70, v60, v61
    v_cvt_pk_bf16_f32 v71, v62, v63
    s_nop 1
    v_mfma_f32_16x16x32_bf16 v[72:75], v[88:91], v[68:71], 0
    s_nop 0
    v_exp_f32 v64, v64
    v_mfma_f32_16x16x32_bf16 v[76:79], v[92:95], v[68:71], 0
    v_exp_f32 v65, v65
    v_mfma_f32_16x16x32_bf16 v[80:83], v[48:51], v[68:71], 0
    v_cvt_pk_bf16_f32 v52, v64, v65
    s_nop 1
    v_mfma_f32_16x16x16_bf16 v[72:75], v[112:113], v[52:53], v[72:75]
    ds_read_b128 v[32:35], v124 offset:6144
    v_mfma_f32_16x16x16_bf16 v[76:79], v[114:115], v[52:53], v[76:79]
    ds_read_b128 v[36:39], v124 offset:7168
    v_mfma_f32_16x16x16_bf16 v[80:83], v[48:49], v[52:53], v[80:83]
L_norm_61:
    s_mov_b64 vcc, s[36:37]
    v_mov_b32 v122, v122
    v_mov_b32 v122, v122
    v_mov_b32 v122, v122
    v_cndmask_b32_dpp v76, v72, v76, vcc quad_perm:[2,3,2,3] row_mask:0xf bank_mask:0xf
    v_cndmask_b32_dpp v77, v73, v77, vcc quad_perm:[2,3,2,3] row_mask:0xf bank_mask:0xf
    v_cndmask_b32_dpp v78, v74, v78, vcc quad_perm:[2,3,2,3] row_mask:0xf bank_mask:0xf
    v_cndmask_b32_dpp v79, v75, v79, vcc quad_perm:[2,3,2,3] row_mask:0xf bank_mask:0xf
    v_rcp_f32_dpp v84, v80 quad_perm:[2,3,2,3] row_mask:0xf bank_mask:0xf
    s_nop 0
    v_pk_mul_f32 v[76:77], v[76:77], v[84:85] op_sel_hi:[1,0]
    v_pk_mul_f32 v[78:79], v[78:79], v[84:85] op_sel_hi:[1,0]
    v_cvt_pk_bf16_f32 v72, v76, v77
    v_cvt_pk_bf16_f32 v73, v78, v79
    ds_write_b64 v122, v[72:73] offset:20480
    v_max_f32_dpp v86, v80, v84 quad_perm:[2,3,2,3] row_mask:0xf bank_mask:0xf
    v_mov_b32_dpp v60, v72 quad_perm:[0,1,0,1] row_mask:0xf bank_mask:0xf
    v_mov_b32_dpp v61, v73 quad_perm:[0,1,0,1] row_mask:0xf bank_mask:0xf
    v_cmp_lt_f32 vcc, s35, v86
    v_mov_b32_dpp v62, v72 quad_perm:[2,3,2,3] row_mask:0xf bank_mask:0xf
    v_mov_b32_dpp v63, v73 quad_perm:[2,3,2,3] row_mask:0xf bank_mask:0xf
    s_nop 1
    v_smfmac_f32_16x16x64_bf16 v[96:99], v[60:63], v[192:199], v116
    s_cbranch_vccnz L_smax_62
    v_smfmac_f32_16x16x64_bf16 v[100:103], v[60:63], v[224:231], v116
    s_waitcnt lgkmcnt(0)
    s_barrier
    ds_read_b128 v[92:95], v127 offset:20992
    ds_read_b128 v[80:83], v127 offset:21504
    ds_read_b128 v[84:87], v127 offset:22016
    v_smfmac_f32_16x16x64_bf16 v[104:107], v[60:63], v[0:7], v116
    ds_read_b128 v[40:43], v124 offset:34816
    v_smfmac_f32_16x16x64_bf16 v[108:111], v[60:63], v[8:15], v116
    ds_read_b128 v[56:59], v124 offset:36864
    s_waitcnt lgkmcnt(4)
    v_smfmac_f32_16x16x64_bf16 v[96:99], v[92:95], v[200:207], v116
    s_waitcnt lgkmcnt(3)
    v_smfmac_f32_16x16x64_bf16 v[96:99], v[80:83], v[208:215], v116
    ds_read_b128 v[44:47], v124 offset:35840
    s_waitcnt lgkmcnt(3)
    v_smfmac_f32_16x16x64_bf16 v[96:99], v[84:87], v[216:223], v116
    ds_read_b128 v[68:71], v124 offset:39936
    v_smfmac_f32_16x16x64_bf16 v[100:103], v[92:95], v[232:239], v116
    ds_read_b128 v[64:67], v124 offset:38912
    v_smfmac_f32_16x16x64_bf16 v[100:103], v[80:83], v[240:247], v116
    ds_read_b128 v[60:63], v124 offset:37888
    v_cvt_pk_bf16_f32 v72, v96, v98
    v_smfmac_f32_16x16x64_bf16 v[100:103], v[84:87], v[248:255], v116
    v_and_or_b32 v72, v72, -2, s33
    v_smfmac_f32_16x16x64_bf16 v[104:107], v[92:95], v[16:23], v116
    v_cvt_pk_bf16_f32 v74, v97, v99
    v_smfmac_f32_16x16x64_bf16 v[104:107], v[80:83], v[24:31], v116
    v_cvt_pk_bf16_f32 v73, v100, v102
    v_cvt_pk_bf16_f32 v75, v101, v103
    v_smfmac_f32_16x16x64_bf16 v[104:107], v[84:87], v[32:39], v116
    buffer_store_dwordx4 v[72:75], v118, s[8:11], s25 offen sc1
    s_waitcnt lgkmcnt(3)
    v_smfmac_f32_16x16x64_bf16 v[108:111], v[92:95], v[40:47], v116
    s_waitcnt lgkmcnt(0)
    v_smfmac_f32_16x16x64_bf16 v[108:111], v[80:83], v[56:63], v116
    v_cvt_pk_bf16_f32 v76, v104, v106
    v_smfmac_f32_16x16x64_bf16 v[108:111], v[84:87], v[64:71], v116
    v_and_or_b32 v76, v76, -2, s33
    v_cvt_pk_bf16_f32 v78, v105, v107
    v_mov_b32 v122, v122
    v_mov_b32 v122, v122
    v_mov_b32 v122, v122
    v_mov_b32 v122, v122
    v_mov_b32 v122, v122
    v_mov_b32 v122, v122
    v_cvt_pk_bf16_f32 v77, v108, v110
    v_cvt_pk_bf16_f32 v79, v109, v111
    buffer_store_dwordx4 v[76:79], v118, s[8:11], s26 offen sc1
    s_add_u32 s30, s30, 0x40000
    s_add_u32 s31, s31, 0x40000
    s_add_u32 s32, s32, 0x20000
    s_add_u32 s23, s24, 0
    s_add_u32 s48, s23, 4096
    s_xor_b32 s25, s25, 0x0
    s_xor_b32 s26, s26, 0x0
    s_mov_b32 s35, 0x49800000
    v_mov_b32 v126, s22
    s_add_u32 s22, s22, 1
    v_mov_b32 v32, 0
    v_mov_b32 v33, 0
    v_mov_b32 v34, 0
    v_mov_b32 v35, 0
    v_mov_b32 v36, 0
    v_mov_b32 v37, 0
    v_mov_b32 v38, 0
    v_mov_b32 v39, 0
    v_mov_b32 v40, 0
    v_mov_b32 v41, 0
    v_mov_b32 v42, 0
    v_mov_b32 v43, 0
    v_mov_b32 v44, 0
    v_mov_b32 v45, 0
    v_mov_b32 v46, 0
    v_mov_b32 v47, 0
    v_mov_b32 v48, 0
    v_mov_b32 v49, 0
    v_mov_b32 v50, 0
    v_mov_b32 v51, 0
    v_mov_b32 v52, 0
    v_mov_b32 v53, 0
    v_mov_b32 v54, 0
    v_mov_b32 v55, 0
    ds_read_b128 v[80:83], v123
    ds_read_b128 v[84:87], v123 offset:1024
    ds_read_b128 v[56:59], v123 offset:2048
    ds_read_b128 v[60:63], v123 offset:3072
    ds_read_b128 v[64:67], v123 offset:32768
    ds_read_b128 v[68:71], v123 offset:33792
    ds_read_b128 v[72:75], v123 offset:34816
    ds_read_b128 v[76:79], v123 offset:35840
    ds_read_b128 v[88:91], v123 offset:4096
    ds_read_b128 v[92:95], v123 offset:5120
    ds_read_b128 v[96:99], v123 offset:6144
    ds_read_b128 v[100:103], v123 offset:7168
    ds_read_b128 v[104:107], v123 offset:36864
    ds_read_b128 v[108:111], v123 offset:37888
    ds_read_b128 v[24:27], v123 offset:38912
    ds_read_b128 v[28:31], v123 offset:39936
    s_add_u32 s24, s24, 8192
    s_bitset0_b32 s24, 15
    s_xor_b32 s55, s24, 16384
    s_xor_b32 s29, s29, 0x0
    s_xor_b32 s53, s29, 1024
    s_bfe_u32 s33, s22, 0x10000
    s_add_u32 s40, s22, 5
    s_lshr_b32 s40, s40, 2
    s_min_u32 s40, s40, 16
    s_bfm_b32 s58, s40, 0
    s_waitcnt vmcnt(5)
    v_cmp_eq_u32 vcc, 0, v125
    s_nop 0
    s_and_b64 vcc, vcc, s[58:59]
    s_cbranch_scc1 L_kvw_63
L_kvb_64:
    v_mov_b32 v15, 0
    s_nop 2
    v_mov_b32 v15, 0
    s_nop 2
    v_mov_b32 v15, 0
    s_nop 2
    v_mov_b32 v15, 0
    s_nop 2
    v_mov_b32 v15, 0
    s_nop 2
    v_mov_b32 v15, 0
    s_nop 2
    v_mov_b32 v15, 0
    s_nop 2
    v_mov_b32 v15, 0
    s_nop 2
    v_mov_b32 v15, 0
    s_nop 2
    v_mov_b32 v15, 0
    s_nop 2
    v_mov_b32 v15, 0
    s_nop 2
    v_mov_b32 v15, 0
    s_nop 2
    v_mov_b32 v15, 0
    s_nop 2
    v_mov_b32 v15, 0
    s_nop 2
    v_mov_b32 v15, 0
    s_nop 2
    v_mov_b32 v15, 0
    s_nop 2
    v_mov_b32 v15, 0
    s_nop 2
    v_mov_b32 v15, 0
    s_nop 2
    v_mov_b32 v15, 0
    s_nop 2
    v_mov_b32 v15, 0
    s_nop 2
    v_mov_b32 v15, 0
    s_nop 2
    v_mov_b32 v15, 0
    s_nop 2
    v_mov_b32 v15, 0
    s_nop 2
    v_mov_b32 v15, 0
    s_nop 2
    v_mov_b32 v15, 0
    s_nop 2
    v_mov_b32 v15, 0
    s_nop 2
    v_mov_b32 v15, 0
    s_nop 2
    v_mov_b32 v15, 0
    s_nop 2
    v_mov_b32 v15, 0
    s_nop 2
    v_mov_b32 v15, 0
    s_nop 2
    v_mov_b32 v15, 0
    s_nop 2
    s_waitcnt lgkmcnt(0)
    s_branch L_chain_top0_s
.p2align 6
L_chain_top1_s:
    buffer_load_dwordx4 v[0:3], v117, s[8:11], s23 offen sc1
    v_mov_b32 v15, 0
    v_mov_b32 v15, 0
    v_mov_b32 v15, 0
    v_mov_b32 v15, 0
    v_mov_b32 v15, 0
    v_mov_b32 v15, 0
    v_mov_b32 v15, 0
    v_mov_b32 v15, 0
    v_mov_b32 v15, 0
    v_mov_b32 v15, 0
    v_mov_b32 v15, 0
    v_mov_b32 v15, 0
    v_mov_b32 v15, 0
    v_mov_b32 v15, 0
    v_mov_b32 v15, 0
    v_mov_b32 v15, 0
    buffer_load_dwordx4 v[0:3], v117, s[8:11], s23 offen sc1
    v_mov_b32 v15, 0
    v_mov_b32 v15, 0
    v_mov_b32 v15, 0
    v_mov_b32 v15, 0
    v_mov_b32 v15, 0
    v_mov_b32 v15, 0
    v_mov_b32 v15, 0
    v_mov_b32 v15, 0
    v_mov_b32 v15, 0
    v_mov_b32 v15, 0
    v_mov_b32 v15, 0
    v_mov_b32 v15, 0
    v_mov_b32 v15, 0
    v_mov_b32 v15, 0
    v_mov_b32 v15, 0
    v_mov_b32 v15, 0
L_mret_65:
    buffer_load_dwordx4 v[0:3], v117, s[8:11], s23 offen sc1
    s_add_u32 s45, s45, 1
    s_cmp_lt_u32 s45, 0x10000
    s_cselect_b32 s56, -2, -1
    s_nop 3
    v_mov_b32 v32, 0
    v_mov_b32 v33, 0
    v_mov_b32 v34, 0
    v_mov_b32 v35, 0
    s_waitcnt vmcnt(2)
    v_max3_u32 v15, v0, v1, v2
    v_max_u32 v15, v15, v3
    v_cmp_lt_u32 vcc, s56, v15
    v_smfmac_f32_16x16x64_bf16 v[32:35], v[0:3], v[80:87], v116
    s_cbranch_vccnz L_mret_65
    ds_write_b128 v117, v[0:3] offset:1024
    v_smfmac_f32_16x16x64_bf16 v[36:39], v[0:3], v[56:63], v116
    buffer_load_dwordx4 v[4:7], v117, s[8:11], s48 offen sc1
    v_smfmac_f32_16x16x64_bf16 v[40:43], v[0:3], v[64:71], v116
    buffer_load_dwordx4 v117, s[8:11], s48 offen sc1 lds
    s_mov_b32 m0, 10240
    v_smfmac_f32_16x16x64_bf16 v[44:47], v[0:3], v[72:79], v116
    s_waitcnt lgkmcnt(0)
    s_barrier
    ds_read_b128 v[8:11], v117
    v_smfmac_f32_16x16x64_bf16 v[48:51], v[0:3], a[192:199], v116
    ds_read_b128 v[16:19], v117 offset:3072
    ds_read_b128 v[20:23], v117 offset:2048
    v_smfmac_f32_16x16x64_bf16 v[52:55], v[0:3], a[200:207], v116
    ds_read_b128 v[80:83], v117 offset:14336
    s_waitcnt lgkmcnt(3)
    v_smfmac_f32_16x16x64_bf16 v[32:35], v[8:11], a[0:7], v116
    ds_read_b128 v[84:87], v117 offset:15360
    v_smfmac_f32_16x16x64_bf16 v[36:39], v[8:11], a[8:15], v116
    ds_read_b128 v[56:59], v117 offset:8192
    s_waitcnt lgkmcnt(4)
    v_smfmac_f32_16x16x64_bf16 v[32:35], v[16:19], a[32:39], v116
    ds_read_b128 v[60:63], v117 offset:9216
    v_smfmac_f32_16x16x64_bf16 v[36:39], v[16:19], a[40:47], v116
    buffer_store_dwordx4 v[112:115], v117, s[8:11], s32 offen sc1
    s_waitcnt lgkmcnt(4)
    v_smfmac_f32_16x16x64_bf16 v[32:35], v[20:23], a[64:71], v116
    ds_read_b128 v[64:67], v117 offset:10240
    v_smfmac_f32_16x16x64_bf16 v[36:39], v[20:23], a[72:79], v116
    ds_read_b128 v[68:71], v117 offset:11264
    v_smfmac_f32_16x16x64_bf16 v[40:43], v[8:11], a[96:103], v116
    ds_read_b128 v[72:75], v117 offset:12288
    v_smfmac_f32_16x16x64_bf16 v[40:43], v[16:19], a[128:135], v116
    ds_read_b128 v[76:79], v117 offset:13312
    v_smfmac_f32_16x16x64_bf16 v[40:43], v[20:23], a[160:167], v116
    s_waitcnt vmcnt(2)
    v_max3_u32 v15, v4, v5, v6
    v_smfmac_f32_16x16x64_bf16 v[44:47], v[8:11], a[104:111], v116
    v_max_u32 v15, v15, v7
    v_smfmac_f32_16x16x64_bf16 v[44:47], v[16:19], a[136:143], v116
    s_waitcnt vmcnt(1) lgkmcnt(0)
    v_cmp_lt_u32 vcc, s56, v15
    v_smfmac_f32_16x16x64_bf16 v[44:47], v[20:23], a[168:175], v116
    s_cbranch_vccnz L_mret_66
L_mgo_67:
    v_smfmac_f32_16x16x64_bf16 v[44:47], v[4:7], v[24:31], v116
    s_barrier
    ds_read_b128 v[12:15], v117 offset:4096
    v_smfmac_f32_16x16x64_bf16 v[32:35], v[4:7], v[88:95], v116
    ds_read_b128 v[24:27], v117 offset:7168
    v_smfmac_f32_16x16x64_bf16 v[36:39], v[4:7], v[96:103], v116
    ds_read_b128 v[28:31], v117 offset:6144
    v_smfmac_f32_16x16x64_bf16 v[40:43], v[4:7], v[104:111], v116
    ds_read_b128 v[88:91], v117 offset:26624
    s_waitcnt lgkmcnt(3)
    v_smfmac_f32_16x16x64_bf16 v[32:35], v[12:15], a[16:23], v116
    ds_read_b128 v[92:95], v117 offset:27648
    s_waitcnt lgkmcnt(3)
    v_smfmac_f32_16x16x64_bf16 v[32:35], v[24:27], a[48:55], v116
    buffer_load_dwordx4 v117, s[8:11], s30 offen lds
    s_waitcnt lgkmcnt(2)
    v_smfmac_f32_16x16x64_bf16 v[32:35], v[28:31], a[80:87], v116
    ds_read_b128 v[96:99], v117 offset:23552
    v_smfmac_f32_16x16x64_bf16 v[36:39], v[12:15], a[24:31], v116
    ds_read_b128 v[100:103], v117 offset:23552
    v_smfmac_f32_16x16x64_bf16 v[36:39], v[24:27], a[56:63], v116
    buffer_load_dwordx4 v117, s[8:11], s30 offen offset:1024 lds
    s_add_u32 m0, s52, 0x6000
    v_add_f32 v32, v32, v34
    v_smfmac_f32_16x16x64_bf16 v[36:39], v[28:31], a[88:95], v116
    ds_read_b128 v[104:107], v117 offset:23552
    v_add_f32 v33, v33, v35
    v_smfmac_f32_16x16x64_bf16 v[40:43], v[12:15], a[112:119], v116
    ds_read_b128 v[108:111], v117 offset:23552
    v_mul_f32 v32, s34, v32
    v_smfmac_f32_16x16x64_bf16 v[40:43], v[24:27], a[144:151], v116
    buffer_load_dword v125, v119, s[8:11], s28 offen sc1
    v_mul_f32 v33, s34, v33
    v_smfmac_f32_16x16x64_bf16 v[40:43], v[28:31], a[176:183], v116
    ds_read_b128 v[0:3], v124
    v_add_f32 v36, v36, v38
    v_smfmac_f32_16x16x64_bf16 v[48:51], v[4:7], a[208:215], v116
    v_add_f32 v37, v37, v39
    v_smfmac_f32_16x16x64_bf16 v[52:55], v[4:7], a[216:223], v116
    s_waitcnt lgkmcnt(5)
    buffer_load_dwordx4 v117, s[8:11], s31 offen lds
    v_mul_f32 v36, s34, v36
    v_smfmac_f32_16x16x64_bf16 v[44:47], v[12:15], a[120:127], v116
    ds_read_b128 v[4:7], v124 offset:1024
    v_mul_f32 v37, s34, v37
    v_smfmac_f32_16x16x64_bf16 v[44:47], v[24:27], a[152:159], v116
    v_cvt_pk_bf16_f32 v34, v32, v36
    v_smfmac_f32_16x16x64_bf16 v[44:47], v[28:31], a[184:191], v116
    buffer_load_dwordx4 v117, s[8:11], s31 offen offset:1024 lds
    s_mov_b32 m0, 5120
    v_cvt_pk_bf16_f32 v35, v33, v37
    v_add_f32 v40, v40, v42
    v_smfmac_f32_16x16x64_bf16 v[48:51], v[8:11], a[224:231], v116
    ds_write2_b32 v120, v34, v35 offset0:32 offset1:48
    v_add_f32 v41, v41, v43
    v_smfmac_f32_16x16x64_bf16 v[52:55], v[8:11], a[232:239], v116
    v_add_f32 v44, v44, v46
    v_add_f32 v45, v45, v47
    v_cvt_pk_bf16_f32 v113, v40, v44
    v_cvt_pk_bf16_f32 v115, v41, v45
    v_smfmac_f32_16x16x64_bf16 v[48:51], v[12:15], a[240:247], v116
    ds_write2_b32 v120, v113, v115 offset0:0 offset1:16
    v_smfmac_f32_16x16x64_bf16 v[52:55], v[12:15], a[248:255], v116
    s_cmp_eq_u32 s22, 63
    s_cbranch_scc1 L_chain_last_s
    v_smfmac_f32_16x16x64_bf16 v[48:51], v[16:19], v[128:135], v116
    v_smfmac_f32_16x16x64_bf16 v[48:51], v[20:23], v[160:167], v116
    v_smfmac_f32_16x16x64_bf16 v[48:51], v[24:27], v[144:151], v116
    s_waitcnt lgkmcnt(0)
    s_barrier
    v_smfmac_f32_16x16x64_bf16 v[48:51], v[28:31], v[176:183], v116
    ds_read_b128 v[32:35], v121 offset:16384
    ds_read_b128 v[36:39], v121 offset:17408
    v_smfmac_f32_16x16x64_bf16 v[52:55], v[16:19], v[136:143], v116
    ds_read_b128 v[40:43], v121 offset:18432
    ds_read_b128 v[44:47], v121 offset:19456
    v_smfmac_f32_16x16x64_bf16 v[52:55], v[20:23], v[168:175], v116
    ds_read_b128 v[8:11], v124 offset:32768
    v_add_f32 v48, v48, v50
    v_smfmac_f32_16x16x64_bf16 v[52:55], v[24:27], v[152:159], v116
    ds_read_b128 v[12:15], v124 offset:33792
    v_add_f32 v49, v49, v51
    v_smfmac_f32_16x16x64_bf16 v[52:55], v[28:31], v[184:191], v116
    s_waitcnt lgkmcnt(5)
    v_cvt_pk_bf16_f32 v112, v48, v49
    v_mfma_f32_16x16x32_bf16 v[56:59], v[56:59], v[32:35], 0
    s_waitcnt lgkmcnt(4)
    v_mov_b32 v48, s50
    v_mov_b32 v49, s50
    v_mfma_f32_16x16x32_bf16 v[56:59], v[60:63], v[36:39], v[56:59]
    ds_read_b128 v[16:19], v124 offset:2048
    s_waitcnt lgkmcnt(4)
    v_mov_b32 v50, s50
    v_mov_b32 v51, s50
    v_mfma_f32_16x16x32_bf16 v[56:59], v[64:67], v[40:43], v[56:59]
    ds_read_b128 v[20:23], v124 offset:3072
    s_waitcnt lgkmcnt(4)
    v_add_f32 v52, v52, v54
    v_mfma_f32_16x16x32_bf16 v[56:59], v[68:71], v[44:47], v[56:59]
    ds_read_b128 v[24:27], v124 offset:4096
    v_add_f32 v53, v53, v55
    v_mfma_f32_16x16x32_bf16 v[60:63], v[72:75], v[32:35], 0
    ds_read_b128 v[28:31], v124 offset:5120
    v_cvt_pk_bf16_f32 v114, v52, v53
    v_mov_b32 v53, 0
    v_mfma_f32_16x16x32_bf16 v[60:63], v[76:79], v[36:39], v[60:63]
    v_exp_f32 v56, v56
    v_mfma_f32_16x16x32_bf16 v[60:63], v[80:83], v[40:43], v[60:63]
    v_exp_f32 v57, v57
    v_mfma_f32_16x16x32_bf16 v[60:63], v[84:87], v[44:47], v[60:63]
    v_exp_f32 v58, v58
    v_mfma_f32_16x16x32_bf16 v[64:67], v[32:35], v[32:35], 0
    v_exp_f32 v59, v59
    v_cvt_pk_bf16_f32 v68, v56, v57
    v_mfma_f32_16x16x32_bf16 v[64:67], v[36:39], v[36:39], v[64:67]
    v_exp_f32 v60, v60
    v_cvt_pk_bf16_f32 v69, v58, v59
    v_mfma_f32_16x16x32_bf16 v[64:67], v[40:43], v[40:43], v[64:67]
    v_exp_f32 v61, v61
    v_mfma_f32_16x16x32_bf16 v[64:67], v[44:47], v[44:47], v[64:67]
    v_exp_f32 v62, v62
    v_exp_f32 v63, v63
    v_cvt_pk_bf16_f32 v70, v60, v61
    v_cvt_pk_bf16_f32 v71, v62, v63
    s_nop 1
    v_mfma_f32_16x16x32_bf16 v[72:75], v[88:91], v[68:71], 0
    s_nop 0
    v_exp_f32 v64, v64
    v_mfma_f32_16x16x32_bf16 v[76:79], v[92:95], v[68:71], 0
    v_exp_f32 v65, v65
    v_mfma_f32_16x16x32_bf16 v[80:83], v[48:51], v[68:71], 0
    v_cvt_pk_bf16_f32 v52, v64, v65
    s_nop 1
    v_mfma_f32_16x16x16_bf16 v[72:75], v[112:113], v[52:53], v[72:75]
    ds_read_b128 v[32:35], v124 offset:6144
    v_mfma_f32_16x16x16_bf16 v[76:79], v[114:115], v[52:53], v[76:79]
    ds_read_b128 v[36:39], v124 offset:7168
    v_mfma_f32_16x16x16_bf16 v[80:83], v[48:49], v[52:53], v[80:83]
L_norm_68:
    s_mov_b64 vcc, s[36:37]
    v_mov_b32 v122, v122
    v_mov_b32 v122, v122
    v_mov_b32 v122, v122
    v_cndmask_b32_dpp v76, v72, v76, vcc quad_perm:[2,3,2,3] row_mask:0xf bank_mask:0xf
    v_cndmask_b32_dpp v77, v73, v77, vcc quad_perm:[2,3,2,3] row_mask:0xf bank_mask:0xf
    v_cndmask_b32_dpp v78, v74, v78, vcc quad_perm:[2,3,2,3] row_mask:0xf bank_mask:0xf
    v_cndmask_b32_dpp v79, v75, v79, vcc quad_perm:[2,3,2,3] row_mask:0xf bank_mask:0xf
    v_rcp_f32_dpp v84, v80 quad_perm:[2,3,2,3] row_mask:0xf bank_mask:0xf
    s_nop 0
    v_pk_mul_f32 v[76:77], v[76:77], v[84:85] op_sel_hi:[1,0]
    v_pk_mul_f32 v[78:79], v[78:79], v[84:85] op_sel_hi:[1,0]
    v_cvt_pk_bf16_f32 v72, v76, v77
    v_cvt_pk_bf16_f32 v73, v78, v79
    ds_write_b64 v122, v[72:73] offset:20992
    v_max_f32_dpp v86, v80, v84 quad_perm:[2,3,2,3] row_mask:0xf bank_mask:0xf
    v_mov_b32_dpp v60, v72 quad_perm:[0,1,0,1] row_mask:0xf bank_mask:0xf
    v_mov_b32_dpp v61, v73 quad_perm:[0,1,0,1] row_mask:0xf bank_mask:0xf
    v_cmp_lt_f32 vcc, s35, v86
    v_mov_b32_dpp v62, v72 quad_perm:[2,3,2,3] row_mask:0xf bank_mask:0xf
    v_mov_b32_dpp v63, v73 quad_perm:[2,3,2,3] row_mask:0xf bank_mask:0xf
    s_nop 1
    v_smfmac_f32_16x16x64_bf16 v[96:99], v[60:63], v[192:199], v116
    s_cbranch_vccnz L_smax_69
    v_smfmac_f32_16x16x64_bf16 v[100:103], v[60:63], v[224:231], v116
    s_waitcnt lgkmcnt(0)
    s_barrier
    ds_read_b128 v[92:95], v127 offset:20480
    ds_read_b128 v[80:83], v127 offset:22016
    ds_read_b128 v[84:87], v127 offset:21504
    v_smfmac_f32_16x16x64_bf16 v[104:107], v[60:63], v[0:7], v116
    ds_read_b128 v[40:43], v124 offset:34816
    v_smfmac_f32_16x16x64_bf16 v[108:111], v[60:63], v[8:15], v116
    ds_read_b128 v[56:59], v124 offset:36864
    s_waitcnt lgkmcnt(4)
    v_smfmac_f32_16x16x64_bf16 v[96:99], v[92:95], v[200:207], v116
    s_waitcnt lgkmcnt(3)
    v_smfmac_f32_16x16x64_bf16 v[96:99], v[80:83], v[208:215], v116
    ds_read_b128 v[44:47], v124 offset:35840
    s_waitcnt lgkmcnt(3)
    v_smfmac_f32_16x16x64_bf16 v[96:99], v[84:87], v[216:223], v116
    ds_read_b128 v[68:71], v124 offset:39936
    v_smfmac_f32_16x16x64_bf16 v[100:103], v[92:95], v[232:239], v116
    ds_read_b128 v[64:67], v124 offset:38912
    v_smfmac_f32_16x16x64_bf16 v[100:103], v[80:83], v[240:247], v116
    ds_read_b128 v[60:63], v124 offset:37888
    v_cvt_pk_bf16_f32 v72, v96, v98
    v_smfmac_f32_16x16x64_bf16 v[100:103], v[84:87], v[248:255], v116
    v_and_or_b32 v72, v72, -2, s33
    v_smfmac_f32_16x16x64_bf16 v[104:107], v[92:95], v[16:23], v116
    v_cvt_pk_bf16_f32 v74, v97, v99
    v_smfmac_f32_16x16x64_bf16 v[104:107], v[80:83], v[24:31], v116
    v_cvt_pk_bf16_f32 v73, v100, v102
    v_cvt_pk_bf16_f32 v75, v101, v103
    v_smfmac_f32_16x16x64_bf16 v[104:107], v[84:87], v[32:39], v116
    buffer_store_dwordx4 v[72:75], v118, s[8:11], s25 offen sc1
    s_waitcnt lgkmcnt(3)
    v_smfmac_f32_16x16x64_bf16 v[108:111], v[92:95], v[40:47], v116
    s_waitcnt lgkmcnt(0)
    v_smfmac_f32_16x16x64_bf16 v[108:111], v[80:83], v[56:63], v116
    v_cvt_pk_bf16_f32 v76, v104, v106
    v_smfmac_f32_16x16x64_bf16 v[108:111], v[84:87], v[64:71], v116
    v_and_or_b32 v76, v76, -2, s33
    v_cvt_pk_bf16_f32 v78, v105, v107
    v_mov_b32 v122, v122
    v_mov_b32 v122, v122
    v_mov_b32 v122, v122
    v_mov_b32 v122, v122
    v_mov_b32 v122, v122
    v_mov_b32 v122, v122
    v_cvt_pk_bf16_f32 v77, v108, v110
    v_cvt_pk_bf16_f32 v79, v109, v111
    buffer_store_dwordx4 v[76:79], v118, s[8:11], s26 offen sc1
    s_add_u32 s30, s30, 0x40000
    s_add_u32 s31, s31, 0x40000
    s_add_u32 s32, s32, 0x20000
    s_add_u32 s23, s24, 1024
    s_add_u32 s48, s23, 4096
    s_xor_b32 s25, s25, 0x0
    s_xor_b32 s26, s26, 0x0
    s_mov_b32 s35, 0x49800000
    s_add_u32 s22, s22, 1
    v_mov_b32 v32, 0
    v_mov_b32 v33, 0
    v_mov_b32 v34, 0
    v_mov_b32 v35, 0
    v_mov_b32 v36, 0
    v_mov_b32 v37, 0
    v_mov_b32 v38, 0
    v_mov_b32 v39, 0
    v_mov_b32 v40, 0
    v_mov_b32 v41, 0
    v_mov_b32 v42, 0
    v_mov_b32 v43, 0
    v_mov_b32 v44, 0
    v_mov_b32 v45, 0
    v_mov_b32 v46, 0
    v_mov_b32 v47, 0
    v_mov_b32 v48, 0
    v_mov_b32 v49, 0
    v_mov_b32 v50, 0
    v_mov_b32 v51, 0
    v_mov_b32 v52, 0
    v_mov_b32 v53, 0
    v_mov_b32 v54, 0
    v_mov_b32 v55, 0
    ds_read_b128 v[80:83], v123
    ds_read_b128 v[84:87], v123 offset:1024
    ds_read_b128 v[56:59], v123 offset:2048
    ds_read_b128 v[60:63], v123 offset:3072
    ds_read_b128 v[64:67], v123 offset:32768
    ds_read_b128 v[68:71], v123 offset:33792
    ds_read_b128 v[72:75], v123 offset:34816
    ds_read_b128 v[76:79], v123 offset:35840
    ds_read_b128 v[88:91], v123 offset:4096
    ds_read_b128 v[92:95], v123 offset:5120
    ds_read_b128 v[96:99], v123 offset:6144
    ds_read_b128 v[100:103], v123 offset:7168
    ds_read_b128 v[104:107], v123 offset:36864
    ds_read_b128 v[108:111], v123 offset:37888
    ds_read_b128 v[24:27], v123 offset:38912
    ds_read_b128 v[28:31], v123 offset:39936
    s_add_u32 s24, s24, 8192
    s_bitset0_b32 s24, 15
    s_xor_b32 s55, s24, 16384
    s_xor_b32 s29, s29, 0x0
    s_xor_b32 s53, s29, 1024
    s_bfe_u32 s33, s22, 0x10000
    s_add_u32 s40, s22, 5
    s_lshr_b32 s40, s40, 2
    s_min_u32 s40, s40, 16
    s_bfm_b32 s58, s40, 0
    s_waitcnt vmcnt(4)
    v_cmp_eq_u32 vcc, 0, v125
    s_nop 0
    s_and_b64 vcc, vcc, s[58:59]
    s_cbranch_scc1 L_kvw_70
L_kvb_71:
    v_mov_b32 v15, 0
    s_nop 2
    v_mov_b32 v15, 0
    s_nop 2
    v_mov_b32 v15, 0
    s_nop 2
    v_mov_b32 v15, 0
    s_nop 2
    v_mov_b32 v15, 0
    s_nop 2
    v_mov_b32 v15, 0
    s_nop 2
    v_mov_b32 v15, 0
    s_nop 2
    v_mov_b32 v15, 0
    s_nop 2
    v_mov_b32 v15, 0
    s_nop 2
    v_mov_b32 v15, 0
    s_nop 2
    v_mov_b32 v15, 0
    s_nop 2
    v_mov_b32 v15, 0
    s_nop 2
    v_mov_b32 v15, 0
    s_nop 2
    v_mov_b32 v15, 0
    s_nop 2
    v_mov_b32 v15, 0
    s_nop 2
    v_mov_b32 v15, 0
    s_nop 2
    v_mov_b32 v15, 0
    s_nop 2
    v_mov_b32 v15, 0
    s_nop 2
    v_mov_b32 v15, 0
    s_nop 2
    v_mov_b32 v15, 0
    s_nop 2
    v_mov_b32 v15, 0
    s_nop 2
    v_mov_b32 v15, 0
    s_nop 2
    v_mov_b32 v15, 0
    s_nop 2
    v_mov_b32 v15, 0
    s_nop 2
    v_mov_b32 v15, 0
    s_nop 2
    v_mov_b32 v15, 0
    s_nop 2
    v_mov_b32 v15, 0
    s_nop 2
    v_mov_b32 v15, 0
    s_nop 2
    v_mov_b32 v15, 0
    s_nop 2
    v_mov_b32 v15, 0
    s_nop 2
    v_mov_b32 v15, 0
    s_nop 2
    s_waitcnt lgkmcnt(0)
    s_branch L_chain_top1_s
.p2align 6
L_chain_top2_s:
    buffer_load_dwordx4 v[0:3], v117, s[8:11], s23 offen sc1
    v_mov_b32 v48, 0
    v_mov_b32 v49, 0
    v_mov_b32 v50, 0
    v_mov_b32 v51, 0
    v_mov_b32 v52, 0
    v_mov_b32 v53, 0
    v_mov_b32 v15, 0
    v_mov_b32 v15, 0
    v_mov_b32 v15, 0
    v_mov_b32 v15, 0
    v_mov_b32 v15, 0
    v_mov_b32 v15, 0
    v_mov_b32 v15, 0
    v_mov_b32 v15, 0
    v_mov_b32 v15, 0
    v_mov_b32 v15, 0
    buffer_load_dwordx4 v[0:3], v117, s[8:11], s23 offen sc1
    s_waitcnt vmcnt(3)
    v_mov_b32 v36, 0
    v_mov_b32 v37, 0
    v_mov_b32 v38, 0
    v_mov_b32 v39, 0
    v_mov_b32 v40, 0
    v_mov_b32 v41, 0
    v_mov_b32 v42, 0
    v_mov_b32 v43, 0
    v_mov_b32 v44, 0
    v_mov_b32 v45, 0
    v_mov_b32 v46, 0
    v_mov_b32 v47, 0
    v_mov_b32 v15, 0
    v_mov_b32 v15, 0
    v_mov_b32 v15, 0
    v_mov_b32 v15, 0
L_mret_72:
    buffer_load_dwordx4 v[0:3], v117, s[8:11], s23 offen sc1
    s_add_u32 s45, s45, 1
    s_cmp_lt_u32 s45, 0x10000
    s_cselect_b32 s56, -2, -1
    s_nop 3
    v_mov_b32 v32, 0
    v_mov_b32 v33, 0
    v_mov_b32 v34, 0
    v_mov_b32 v35, 0
    s_waitcnt vmcnt(2)
    v_max3_u32 v15, v0, v1, v2
    v_max_u32 v15, v15, v3
    v_cmp_lt_u32 vcc, s56, v15
    v_smfmac_f32_16x16x64_bf16 v[32:35], v[0:3], v[80:87], v116
    s_cbranch_vccnz L_mret_72
    ds_write_b128 v117, v[0:3] offset:2048
    v_smfmac_f32_16x16x64_bf16 v[36:39], v[0:3], v[56:63], v116
    buffer_load_dwordx4 v[4:7], v117, s[8:11], s48 offen sc1
    v_smfmac_f32_16x16x64_bf16 v[40:43], v[0:3], v[64:71], v116
    buffer_load_dwordx4 v117, s[8:11], s48 offen sc1 lds
    s_mov_b32 m0, 12288
    v_smfmac_f32_16x16x64_bf16 v[44:47], v[0:3], v[72:79], v116
    s_waitcnt lgkmcnt(0)
    s_barrier
    ds_read_b128 v[8:11], v117 offset:3072
    v_smfmac_f32_16x16x64_bf16 v[48:51], v[0:3], a[192:199], v116
    ds_read_b128 v[16:19], v117
    ds_read_b128 v[20:23], v117 offset:1024
    v_smfmac_f32_16x16x64_bf16 v[52:55], v[0:3], a[200:207], v116
    ds_read_b128 v[80:83], v117 offset:14336
    s_waitcnt lgkmcnt(3)
    v_smfmac_f32_16x16x64_bf16 v[32:35], v[8:11], a[0:7], v116
    ds_read_b128 v[84:87], v117 offset:15360
    v_smfmac_f32_16x16x64_bf16 v[36:39], v[8:11], a[8:15], v116
    ds_read_b128 v[56:59], v117 offset:8192
    s_waitcnt lgkmcnt(4)
    v_smfmac_f32_16x16x64_bf16 v[32:35], v[16:19], a[32:39], v116
    ds_read_b128 v[60:63], v117 offset:9216
    v_smfmac_f32_16x16x64_bf16 v[36:39], v[16:19], a[40:47], v116
    ds_read_b128 v[64:67], v117 offset:10240
    s_waitcnt lgkmcnt(5)
    v_smfmac_f32_16x16x64_bf16 v[32:35], v[20:23], a[64:71], v116
    ds_read_b128 v[68:71], v117 offset:11264
    v_smfmac_f32_16x16x64_bf16 v[36:39], v[20:23], a[72:79], v116
    buffer_store_dwordx4 v[112:115], v117, s[8:11], s32 offen sc1
    v_smfmac_f32_16x16x64_bf16 v[40:43], v[8:11], a[96:103], v116
    ds_read_b128 v[72:75], v117 offset:12288
    v_smfmac_f32_16x16x64_bf16 v[40:43], v[16:19], a[128:135], v116
    ds_read_b128 v[76:79], v117 offset:13312
    v_smfmac_f32_16x16x64_bf16 v[40:43], v[20:23], a[160:167], v116
    s_waitcnt vmcnt(2)
    v_max3_u32 v15, v4, v5, v6
    v_smfmac_f32_16x16x64_bf16 v[44:47], v[8:11], a[104:111], v116
    v_max_u32 v15, v15, v7
    v_smfmac_f32_16x16x64_bf16 v[44:47], v[16:19], a[136:143], v116
    s_waitcnt vmcnt(1) lgkmcnt(0)
    v_cmp_lt_u32 vcc, s56, v15
    v_smfmac_f32_16x16x64_bf16 v[44:47], v[20:23], a[168:175], v116
    s_cbranch_vccnz L_mret_73
L_mgo_74:
    v_smfmac_f32_16x16x64_bf16 v[44:47], v[4:7], v[24:31], v116
    s_barrier
    ds_read_b128 v[12:15], v117 offset:7168
    v_smfmac_f32_16x16x64_bf16 v[32:35], v[4:7], v[88:95], v116
    ds_read_b128 v[24:27], v117 offset:4096
    v_smfmac_f32_16x16x64_bf16 v[36:39], v[4:7], v[96:103], v116
    ds_read_b128 v[28:31], v117 offset:5120
    v_smfmac_f32_16x16x64_bf16 v[40:43], v[4:7], v[104:111], v116
    ds_read_b128 v[88:91], v117 offset:28672
    s_waitcnt lgkmcnt(3)
    v_smfmac_f32_16x16x64_bf16 v[32:35], v[12:15], a[16:23], v116
    ds_read_b128 v[92:95], v117 offset:29696
    s_waitcnt lgkmcnt(3)
    v_smfmac_f32_16x16x64_bf16 v[32:35], v[24:27], a[48:55], v116
    buffer_load_dwordx4 v117, s[8:11], s30 offen lds
    s_waitcnt lgkmcnt(2)
    v_smfmac_f32_16x16x64_bf16 v[32:35], v[28:31], a[80:87], v116
    ds_read_b128 v[96:99], v117 offset:23552
    v_smfmac_f32_16x16x64_bf16 v[36:39], v[12:15], a[24:31], v116
    ds_read_b128 v[100:103], v117 offset:23552
    v_smfmac_f32_16x16x64_bf16 v[36:39], v[24:27], a[56:63], v116
    buffer_load_dwordx4 v117, s[8:11], s30 offen offset:1024 lds
    s_add_u32 m0, s52, 0x6000
    v_add_f32 v32, v32, v34
    v_smfmac_f32_16x16x64_bf16 v[36:39], v[28:31], a[88:95], v116
    ds_read_b128 v[104:107], v117 offset:23552
    v_add_f32 v33, v33, v35
    v_smfmac_f32_16x16x64_bf16 v[40:43], v[12:15], a[112:119], v116
    ds_read_b128 v[108:111], v117 offset:23552
    v_mul_f32 v32, s34, v32
    v_smfmac_f32_16x16x64_bf16 v[40:43], v[24:27], a[144:151], v116
    s_waitcnt lgkmcnt(4)
    buffer_load_dwordx4 v117, s[8:11], s31 offen lds
    v_mul_f32 v33, s34, v33
    v_smfmac_f32_16x16x64_bf16 v[40:43], v[28:31], a[176:183], v116
    ds_read_b128 v[0:3], v124
    v_add_f32 v36, v36, v38
    v_smfmac_f32_16x16x64_bf16 v[48:51], v[4:7], a[208:215], v116
    v_add_f32 v37, v37, v39
    v_smfmac_f32_16x16x64_bf16 v[52:55], v[4:7], a[216:223], v116
    buffer_load_dwordx4 v117, s[8:11], s31 offen offset:1024 lds
    s_mov_b32 m0, 6144
    v_mul_f32 v36, s34, v36
    v_smfmac_f32_16x16x64_bf16 v[44:47], v[12:15], a[120:127], v116
    ds_read_b128 v[4:7], v124 offset:1024
    v_mul_f32 v37, s34, v37
    v_smfmac_f32_16x16x64_bf16 v[44:47], v[24:27], a[152:159], v116
    v_cvt_pk_bf16_f32 v34, v32, v36
    v_smfmac_f32_16x16x64_bf16 v[44:47], v[28:31], a[184:191], v116
    v_cvt_pk_bf16_f32 v35, v33, v37
    v_add_f32 v40, v40, v42
    v_smfmac_f32_16x16x64_bf16 v[48:51], v[8:11], a[224:231], v116
    ds_write2_b32 v120, v34, v35 offset0:32 offset1:48
    v_add_f32 v41, v41, v43
    v_smfmac_f32_16x16x64_bf16 v[52:55], v[8:11], a[232:239], v116
    v_add_f32 v44, v44, v46
    v_add_f32 v45, v45, v47
    v_cvt_pk_bf16_f32 v113, v40, v44
    v_cvt_pk_bf16_f32 v115, v41, v45
    v_smfmac_f32_16x16x64_bf16 v[48:51], v[12:15], a[240:247], v116
    ds_write2_b32 v120, v113, v115 offset0:0 offset1:16
    v_smfmac_f32_16x16x64_bf16 v[52:55], v[12:15], a[248:255], v116
    s_cmp_eq_u32 s22, 63
    s_cbranch_scc1 L_chain_last_s
    v_smfmac_f32_16x16x64_bf16 v[48:51], v[16:19], v[128:135], v116
    buffer_store_dword v126, v119, s[8:11], s55 offen sc1
    v_smfmac_f32_16x16x64_bf16 v[48:51], v[20:23], v[160:167], v116
    v_smfmac_f32_16x16x64_bf16 v[48:51], v[24:27], v[144:151], v116
    s_waitcnt lgkmcnt(0)
    s_barrier
    v_smfmac_f32_16x16x64_bf16 v[48:51], v[28:31], v[176:183], v116
    ds_read_b128 v[32:35], v121 offset:16384
    ds_read_b128 v[36:39], v121 offset:17408
    v_smfmac_f32_16x16x64_bf16 v[52:55], v[16:19], v[136:143], v116
    ds_read_b128 v[40:43], v121 offset:18432
    ds_read_b128 v[44:47], v121 offset:19456
    v_smfmac_f32_16x16x64_bf16 v[52:55], v[20:23], v[168:175], v116
    ds_read_b128 v[8:11], v124 offset:32768
    v_add_f32 v48, v48, v50
    v_smfmac_f32_16x16x64_bf16 v[52:55], v[24:27], v[152:159], v116
    ds_read_b128 v[12:15], v124 offset:33792
    v_add_f32 v49, v49, v51
    v_smfmac_f32_16x16x64_bf16 v[52:55], v[28:31], v[184:191], v116
    s_waitcnt lgkmcnt(5)
    v_cvt_pk_bf16_f32 v112, v48, v49
    v_mfma_f32_16x16x32_bf16 v[56:59], v[56:59], v[32:35], 0
    s_waitcnt lgkmcnt(4)
    v_mov_b32 v48, s50
    v_mov_b32 v49, s50
    v_mfma_f32_16x16x32_bf16 v[56:59], v[60:63], v[36:39], v[56:59]
    ds_read_b128 v[16:19], v124 offset:2048
    s_waitcnt lgkmcnt(4)
    v_mov_b32 v50, s50
    v_mov_b32 v51, s50
    v_mfma_f32_16x16x32_bf16 v[56:59], v[64:67], v[40:43], v[56:59]
    ds_read_b128 v[20:23], v124 offset:3072
    s_waitcnt lgkmcnt(4)
    v_add_f32 v52, v52, v54
    v_mfma_f32_16x16x32_bf16 v[56:59], v[68:71], v[44:47], v[56:59]
    ds_read_b128 v[24:27], v124 offset:4096
    v_add_f32 v53, v53, v55
    v_mfma_f32_16x16x32_bf16 v[60:63], v[72:75], v[32:35], 0
    ds_read_b128 v[28:31], v124 offset:5120
    v_cvt_pk_bf16_f32 v114, v52, v53
    v_mov_b32 v53, 0
    v_mfma_f32_16x16x32_bf16 v[60:63], v[76:79], v[36:39], v[60:63]
    v_exp_f32 v56, v56
    v_mfma_f32_16x16x32_bf16 v[60:63], v[80:83], v[40:43], v[60:63]
    v_exp_f32 v57, v57
    v_mfma_f32_16x16x32_bf16 v[60:63], v[84:87], v[44:47], v[60:63]
    v_exp_f32 v58, v58
    v_mfma_f32_16x16x32_bf16 v[64:67], v[32:35], v[32:35], 0
    v_exp_f32 v59, v59
    v_cvt_pk_bf16_f32 v68, v56, v57
    v_mfma_f32_16x16x32_bf16 v[64:67], v[36:39], v[36:39], v[64:67]
    v_exp_f32 v60, v60
    v_cvt_pk_bf16_f32 v69, v58, v59
    v_mfma_f32_16x16x32_bf16 v[64:67], v[40:43], v[40:43], v[64:67]
    v_exp_f32 v61, v61
    v_mfma_f32_16x16x32_bf16 v[64:67], v[44:47], v[44:47], v[64:67]
    v_exp_f32 v62, v62
    v_exp_f32 v63, v63
    v_cvt_pk_bf16_f32 v70, v60, v61
    v_cvt_pk_bf16_f32 v71, v62, v63
    s_nop 1
    v_mfma_f32_16x16x32_bf16 v[72:75], v[88:91], v[68:71], 0
    s_nop 0
    v_exp_f32 v64, v64
    v_mfma_f32_16x16x32_bf16 v[76:79], v[92:95], v[68:71], 0
    v_exp_f32 v65, v65
    v_mfma_f32_16x16x32_bf16 v[80:83], v[48:51], v[68:71], 0
    v_cvt_pk_bf16_f32 v52, v64, v65
    s_nop 1
    v_mfma_f32_16x16x16_bf16 v[72:75], v[112:113], v[52:53], v[72:75]
    ds_read_b128 v[32:35], v124 offset:6144
    v_mfma_f32_16x16x16_bf16 v[76:79], v[114:115], v[52:53], v[76:79]
    ds_read_b128 v[36:39], v124 offset:7168
    v_mfma_f32_16x16x16_bf16 v[80:83], v[48:49], v[52:53], v[80:83]
L_norm_75:
    s_mov_b64 vcc, s[36:37]
    v_mov_b32 v122, v122
    v_mov_b32 v122, v122
    v_mov_b32 v122, v122
    v_cndmask_b32_dpp v76, v72, v76, vcc quad_perm:[2,3,2,3] row_mask:0xf bank_mask:0xf
    v_cndmask_b32_dpp v77, v73, v77, vcc quad_perm:[2,3,2,3] row_mask:0xf bank_mask:0xf
    v_cndmask_b32_dpp v78, v74, v78, vcc quad_perm:[2,3,2,3] row_mask:0xf bank_mask:0xf
    v_cndmask_b32_dpp v79, v75, v79, vcc quad_perm:[2,3,2,3] row_mask:0xf bank_mask:0xf
    v_rcp_f32_dpp v84, v80 quad_perm:[2,3,2,3] row_mask:0xf bank_mask:0xf
    s_nop 0
    v_pk_mul_f32 v[76:77], v[76:77], v[84:85] op_sel_hi:[1,0]
    v_pk_mul_f32 v[78:79], v[78:79], v[84:85] op_sel_hi:[1,0]
    v_cvt_pk_bf16_f32 v72, v76, v77
    v_cvt_pk_bf16_f32 v73, v78, v79
    ds_write_b64 v122, v[72:73] offset:21504
    v_max_f32_dpp v86, v80, v84 quad_perm:[2,3,2,3] row_mask:0xf bank_mask:0xf
    v_mov_b32_dpp v60, v72 quad_perm:[0,1,0,1] row_mask:0xf bank_mask:0xf
    v_mov_b32_dpp v61, v73 quad_perm:[0,1,0,1] row_mask:0xf bank_mask:0xf
    v_cmp_lt_f32 vcc, s35, v86
    v_mov_b32_dpp v62, v72 quad_perm:[2,3,2,3] row_mask:0xf bank_mask:0xf
    v_mov_b32_dpp v63, v73 quad_perm:[2,3,2,3] row_mask:0xf bank_mask:0xf
    s_nop 1
    v_smfmac_f32_16x16x64_bf16 v[96:99], v[60:63], v[192:199], v116
    s_cbranch_vccnz L_smax_76
    v_smfmac_f32_16x16x64_bf16 v[100:103], v[60:63], v[224:231], v116
    s_waitcnt lgkmcnt(0)
    s_barrier
    ds_read_b128 v[92:95], v127 offset:22016
    ds_read_b128 v[80:83], v127 offset:20480
    ds_read_b128 v[84:87], v127 offset:20992
    v_smfmac_f32_16x16x64_bf16 v[104:107], v[60:63], v[0:7], v116
    ds_read_b128 v[40:43], v124 offset:34816
    v_smfmac_f32_16x16x64_bf16 v[108:111], v[60:63], v[8:15], v116
    ds_read_b128 v[56:59], v124 offset:36864
    s_waitcnt lgkmcnt(4)
    v_smfmac_f32_16x16x64_bf16 v[96:99], v[92:95], v[200:207], v116
    s_waitcnt lgkmcnt(3)
    v_smfmac_f32_16x16x64_bf16 v[96:99], v[80:83], v[208:215], v116
    ds_read_b128 v[44:47], v124 offset:35840
    s_waitcnt lgkmcnt(3)
    v_smfmac_f32_16x16x64_bf16 v[96:99], v[84:87], v[216:223], v116
    ds_read_b128 v[68:71], v124 offset:39936
    v_smfmac_f32_16x16x64_bf16 v[100:103], v[92:95], v[232:239], v116
    ds_read_b128 v[64:67], v124 offset:38912
    v_smfmac_f32_16x16x64_bf16 v[100:103], v[80:83], v[240:247], v116
    ds_read_b128 v[60:63], v124 offset:37888
    v_cvt_pk_bf16_f32 v72, v96, v98
    v_smfmac_f32_16x16x64_bf16 v[100:103], v[84:87], v[248:255], v116
    v_and_or_b32 v72, v72, -2, s33
    v_smfmac_f32_16x16x64_bf16 v[104:107], v[92:95], v[16:23], v116
    v_cvt_pk_bf16_f32 v74, v97, v99
    v_smfmac_f32_16x16x64_bf16 v[104:107], v[80:83], v[24:31], v116
    v_cvt_pk_bf16_f32 v73, v100, v102
    v_cvt_pk_bf16_f32 v75, v101, v103
    v_smfmac_f32_16x16x64_bf16 v[104:107], v[84:87], v[32:39], v116
    buffer_store_dwordx4 v[72:75], v118, s[8:11], s25 offen sc1
    s_waitcnt lgkmcnt(3)
    v_smfmac_f32_16x16x64_bf16 v[108:111], v[92:95], v[40:47], v116
    s_waitcnt lgkmcnt(0)
    v_smfmac_f32_16x16x64_bf16 v[108:111], v[80:83], v[56:63], v116
    v_cvt_pk_bf16_f32 v76, v104, v106
    v_smfmac_f32_16x16x64_bf16 v[108:111], v[84:87], v[64:71], v116
    v_and_or_b32 v76, v76, -2, s33
    v_cvt_pk_bf16_f32 v78, v105, v107
    v_mov_b32 v122, v122
    v_mov_b32 v122, v122
    v_mov_b32 v122, v122
    v_mov_b32 v122, v122
    v_mov_b32 v122, v122
    v_mov_b32 v122, v122
    v_cvt_pk_bf16_f32 v77, v108, v110
    v_cvt_pk_bf16_f32 v79, v109, v111
    buffer_store_dwordx4 v[76:79], v118, s[8:11], s26 offen sc1
    ds_read_b128 v[80:83], v123
    ds_read_b128 v[84:87], v123 offset:1024
    ds_read_b128 v[56:59], v123 offset:2048
    ds_read_b128 v[60:63], v123 offset:3072
    ds_read_b128 v[64:67], v123 offset:32768
    ds_read_b128 v[68:71], v123 offset:33792
    ds_read_b128 v[72:75], v123 offset:34816
    ds_read_b128 v[76:79], v123 offset:35840
    ds_read_b128 v[88:91], v123 offset:4096
    ds_read_b128 v[92:95], v123 offset:5120
    ds_read_b128 v[96:99], v123 offset:6144
    ds_read_b128 v[100:103], v123 offset:7168
    ds_read_b128 v[104:107], v123 offset:36864
    ds_read_b128 v[108:111], v123 offset:37888
    ds_read_b128 v[24:27], v123 offset:38912
    ds_read_b128 v[28:31], v123 offset:39936
    s_add_u32 s30, s30, 0x40000
    s_add_u32 s31, s31, 0x40000
    s_add_u32 s32, s32, 0x20000
    s_add_u32 s23, s24, 2048
    s_add_u32 s48, s23, 4096
    s_xor_b32 s25, s25, 0x0
    s_xor_b32 s26, s26, 0x0
    s_mov_b32 s35, 0x49800000
    s_add_u32 s22, s22, 1
    v_cndmask_b32 v12, 0, v125, s[68:69]
    v_cndmask_b32 v13, 0, v125, s[70:71]
    v_cndmask_b32 v14, 0, v125, s[72:73]
    v_cndmask_b32 v15, 0, v125, s[74:75]
    v_mov_b32 v54, 0
    v_mov_b32 v55, 0
    v_mov_b32 v52, 0
    v_mov_b32 v52, 0
    v_mov_b32 v52, 0
    v_mov_b32 v52, 0
    v_mov_b32 v52, 0
    v_mov_b32 v52, 0
    v_mov_b32 v52, 0
    v_mov_b32 v52, 0
    v_mov_b32 v52, 0
    v_mov_b32 v52, 0
    v_mov_b32 v52, 0
    v_mov_b32 v52, 0
    v_mov_b32 v52, 0
    v_mov_b32 v52, 0
    v_mov_b32 v52, 0
    v_mov_b32 v52, 0
    v_mov_b32 v52, 0
    v_mov_b32 v52, 0
    v_mov_b32 v52, 0
    buffer_load_dwordx4 v[4:7], v117, s[8:11], s29 offen sc1
    buffer_load_dwordx4 v[8:11], v117, s[8:11], s53 offen sc1
    buffer_load_dwordx4 v[16:19], v117, s[8:11], s29 offen offset:2048 sc1
    buffer_load_dwordx4 v[20:23], v117, s[8:11], s53 offen offset:2048 sc1
    v_mov_b32 v52, 0
    v_mov_b32 v52, 0
    v_mov_b32 v52, 0
    v_mov_b32 v52, 0
    v_mov_b32 v52, 0
    v_mov_b32 v52, 0
    v_mov_b32 v52, 0
    v_mov_b32 v52, 0
    v_mov_b32 v52, 0
    v_mov_b32 v52, 0
    v_mov_b32 v52, 0
    v_mov_b32 v52, 0
    v_mov_b32 v52, 0
    v_mov_b32 v52, 0
    v_mov_b32 v52, 0
    v_mov_b32 v52, 0
    v_mov_b32 v52, 0
    v_mov_b32 v52, 0
    v_mov_b32 v52, 0
    v_mov_b32 v52, 0
    v_mov_b32 v52, 0
    v_mov_b32 v52, 0
    v_mov_b32 v52, 0
    v_mov_b32 v52, 0
    v_mov_b32 v52, 0
    v_mov_b32 v52, 0
    v_mov_b32 v52, 0
    v_mov_b32 v52, 0
    v_mov_b32 v52, 0
    v_mov_b32 v52, 0
    v_mov_b32 v52, 0
    v_mov_b32 v52, 0
    v_mov_b32 v52, 0
    v_mov_b32 v52, 0
    v_mov_b32 v52, 0
    v_mov_b32 v52, 0
    v_mov_b32 v52, 0
    v_mov_b32 v52, 0
    v_mov_b32 v52, 0
    v_mov_b32 v52, 0
    buffer_load_dwordx4 v[32:35], v117, s[8:11], s29 offen sc1
    buffer_load_dwordx4 v[36:39], v117, s[8:11], s53 offen sc1
    buffer_load_dwordx4 v[40:43], v117, s[8:11], s29 offen offset:2048 sc1
    buffer_load_dwordx4 v[44:47], v117, s[8:11], s53 offen offset:2048 sc1
    v_mov_b32 v52, 0
L_rl_77:
    s_waitcnt vmcnt(7)
    v_mfma_f32_16x16x32_bf16 v[48:51], v[4:7], v[12:15], 0
    v_xor_b32 v52, s33, v4
    s_waitcnt vmcnt(6)
    v_mfma_f32_16x16x32_bf16 v[48:51], v[8:11], v[12:15], v[48:51]
    v_xor_b32 v53, s33, v8
    v_or_b32 v52, v52, v53
    s_waitcnt vmcnt(5)
    v_mfma_f32_16x16x32_bf16 v[48:51], v[16:19], v[12:15], v[48:51]
    v_xor_b32 v53, s33, v16
    v_or_b32 v52, v52, v53
    s_waitcnt vmcnt(4)
    v_mfma_f32_16x16x32_bf16 v[48:51], v[20:23], v[12:15], v[48:51]
    v_xor_b32 v53, s33, v20
    v_or_b32 v52, v52, v53
    v_and_b32 v52, 1, v52
    v_cmp_ne_u32 vcc, 0, v52
    s_cbranch_vccnz L_rslow_78
L_rgo_79:
    s_nop 2
    v_permlane32_swap_b32 v48, v50
    v_permlane32_swap_b32 v49, v51
    v_pk_add_f32 v[48:49], v[48:49], v[50:51]
    s_mov_b64 exec, s[38:39]
    v_cvt_pk_bf16_f32 v12, v48, v49
    v_min_u32 v12, 0xfffffffe, v12
    buffer_store_dword v12, v119, s[8:11], s24 offen sc1
    s_mov_b64 exec, -1
    s_add_u32 s24, s24, 8192
    s_bitset0_b32 s24, 15
    s_xor_b32 s55, s24, 16384
    s_xor_b32 s29, s29, 0x0
    s_xor_b32 s53, s29, 1024
    s_bfe_u32 s33, s22, 0x10000
    s_waitcnt lgkmcnt(0)
    s_branch L_chain_top2_s
.p2align 6
L_chain_top3_s:
    buffer_load_dwordx4 v[0:3], v117, s[8:11], s23 offen sc1
    v_mov_b32 v48, 0
    v_mov_b32 v49, 0
    v_mov_b32 v50, 0
    v_mov_b32 v51, 0
    v_mov_b32 v52, 0
    v_mov_b32 v53, 0
    v_mov_b32 v15, 0
    v_mov_b32 v15, 0
    v_mov_b32 v15, 0
    v_mov_b32 v15, 0
    v_mov_b32 v15, 0
    v_mov_b32 v15, 0
    v_mov_b32 v15, 0
    v_mov_b32 v15, 0
    v_mov_b32 v15, 0
    v_mov_b32 v15, 0
    buffer_load_dwordx4 v[0:3], v117, s[8:11], s23 offen sc1
    s_waitcnt vmcnt(3)
    v_mov_b32 v36, 0
    v_mov_b32 v37, 0
    v_mov_b32 v38, 0
    v_mov_b32 v39, 0
    v_mov_b32 v40, 0
    v_mov_b32 v41, 0
    v_mov_b32 v42, 0
    v_mov_b32 v43, 0
    v_mov_b32 v44, 0
    v_mov_b32 v45, 0
    v_mov_b32 v46, 0
    v_mov_b32 v47, 0
    v_mov_b32 v15, 0
    v_mov_b32 v15, 0
    v_mov_b32 v15, 0
    v_mov_b32 v15, 0
L_mret_80:
    buffer_load_dwordx4 v[0:3], v117, s[8:11], s23 offen sc1
    s_add_u32 s45, s45, 1
    s_cmp_lt_u32 s45, 0x10000
    s_cselect_b32 s56, -2, -1
    s_nop 3
    v_mov_b32 v32, 0
    v_mov_b32 v33, 0
    v_mov_b32 v34, 0
    v_mov_b32 v35, 0
    s_waitcnt vmcnt(2)
    v_max3_u32 v15, v0, v1, v2
    v_max_u32 v15, v15, v3
    v_cmp_lt_u32 vcc, s56, v15
    v_smfmac_f32_16x16x64_bf16 v[32:35], v[0:3], v[80:87], v116
    s_cbranch_vccnz L_mret_80
    ds_write_b128 v117, v[0:3] offset:3072
    v_smfmac_f32_16x16x64_bf16 v[36:39], v[0:3], v[56:63], v116
    buffer_load_dwordx4 v[4:7], v117, s[8:11], s48 offen sc1
    v_smfmac_f32_16x16x64_bf16 v[40:43], v[0:3], v[64:71], v116
    buffer_load_dwordx4 v117, s[8:11], s48 offen sc1 lds
    s_mov_b32 m0, 14336
    v_smfmac_f32_16x16x64_bf16 v[44:47], v[0:3], v[72:79], v116
    s_waitcnt lgkmcnt(0)
    s_barrier
    ds_read_b128 v[8:11], v117 offset:2048
    v_smfmac_f32_16x16x64_bf16 v[48:51], v[0:3], a[192:199], v116
    ds_read_b128 v[16:19], v117 offset:1024
    ds_read_b128 v[20:23], v117
    v_smfmac_f32_16x16x64_bf16 v[52:55], v[0:3], a[200:207], v116
    ds_read_b128 v[80:83], v117 offset:14336
    s_waitcnt lgkmcnt(3)
    v_smfmac_f32_16x16x64_bf16 v[32:35], v[8:11], a[0:7], v116
    ds_read_b128 v[84:87], v117 offset:15360
    v_smfmac_f32_16x16x64_bf16 v[36:39], v[8:11], a[8:15], v116
    ds_read_b128 v[56:59], v117 offset:8192
    s_waitcnt lgkmcnt(4)
    v_smfmac_f32_16x16x64_bf16 v[32:35], v[16:19], a[32:39], v116
    ds_read_b128 v[60:63], v117 offset:9216
    v_smfmac_f32_16x16x64_bf16 v[36:39], v[16:19], a[40:47], v116
    ds_read_b128 v[64:67], v117 offset:10240
    s_waitcnt lgkmcnt(5)
    v_smfmac_f32_16x16x64_bf16 v[32:35], v[20:23], a[64:71], v116
    ds_read_b128 v[68:71], v117 offset:11264
    v_smfmac_f32_16x16x64_bf16 v[36:39], v[20:23], a[72:79], v116
    ds_read_b128 v[72:75], v117 offset:12288
    v_smfmac_f32_16x16x64_bf16 v[40:43], v[8:11], a[96:103], v116
    ds_read_b128 v[76:79], v117 offset:13312
    v_smfmac_f32_16x16x64_bf16 v[40:43], v[16:19], a[128:135], v116
    buffer_store_dwordx4 v[112:115], v117, s[8:11], s32 offen sc1
    v_smfmac_f32_16x16x64_bf16 v[40:43], v[20:23], a[160:167], v116
    s_waitcnt vmcnt(2)
    v_max3_u32 v15, v4, v5, v6
    v_smfmac_f32_16x16x64_bf16 v[44:47], v[8:11], a[104:111], v116
    v_max_u32 v15, v15, v7
    v_smfmac_f32_16x16x64_bf16 v[44:47], v[16:19], a[136:143], v116
    s_waitcnt vmcnt(1) lgkmcnt(0)
    v_cmp_lt_u32 vcc, s56, v15
    v_smfmac_f32_16x16x64_bf16 v[44:47], v[20:23], a[168:175], v116
    s_cbranch_vccnz L_mret_81
L_mgo_82:
    v_smfmac_f32_16x16x64_bf16 v[44:47], v[4:7], v[24:31], v116
    s_barrier
    ds_read_b128 v[12:15], v117 offset:6144
    v_smfmac_f32_16x16x64_bf16 v[32:35], v[4:7], v[88:95], v116
    ds_read_b128 v[24:27], v117 offset:5120
    v_smfmac_f32_16x16x64_bf16 v[36:39], v[4:7], v[96:103], v116
    ds_read_b128 v[28:31], v117 offset:4096
    v_smfmac_f32_16x16x64_bf16 v[40:43], v[4:7], v[104:111], v116
    ds_read_b128 v[88:91], v117 offset:30720
    s_waitcnt lgkmcnt(3)
    v_smfmac_f32_16x16x64_bf16 v[32:35], v[12:15], a[16:23], v116
    ds_read_b128 v[92:95], v117 offset:31744
    s_waitcnt lgkmcnt(3)
    v_smfmac_f32_16x16x64_bf16 v[32:35], v[24:27], a[48:55], v116
    ds_read_b128 v[96:99], v117 offset:23552
    s_waitcnt lgkmcnt(3)
    v_smfmac_f32_16x16x64_bf16 v[32:35], v[28:31], a[80:87], v116
    buffer_load_dwordx4 v117, s[8:11], s30 offen lds
    v_smfmac_f32_16x16x64_bf16 v[36:39], v[12:15], a[24:31], v116
    ds_read_b128 v[100:103], v117 offset:23552
    v_smfmac_f32_16x16x64_bf16 v[36:39], v[24:27], a[56:63], v116
    ds_read_b128 v[104:107], v117 offset:23552
    v_add_f32 v32, v32, v34
    v_smfmac_f32_16x16x64_bf16 v[36:39], v[28:31], a[88:95], v116
    buffer_load_dwordx4 v117, s[8:11], s30 offen offset:1024 lds
    s_add_u32 m0, s52, 0x6000
    v_add_f32 v33, v33, v35
    v_smfmac_f32_16x16x64_bf16 v[40:43], v[12:15], a[112:119], v116
    ds_read_b128 v[108:111], v117 offset:23552
    v_mul_f32 v32, s34, v32
    v_smfmac_f32_16x16x64_bf16 v[40:43], v[24:27], a[144:151], v116
    ds_read_b128 v[0:3], v124
    v_mul_f32 v33, s34, v33
    v_smfmac_f32_16x16x64_bf16 v[40:43], v[28:31], a[176:183], v116
    s_waitcnt lgkmcnt(5)
    buffer_load_dwordx4 v117, s[8:11], s31 offen lds
    v_add_f32 v36, v36, v38
    v_smfmac_f32_16x16x64_bf16 v[48:51], v[4:7], a[208:215], v116
    v_add_f32 v37, v37, v39
    v_smfmac_f32_16x16x64_bf16 v[52:55], v[4:7], a[216:223], v116
    ds_read_b128 v[4:7], v124 offset:1024
    v_mul_f32 v36, s34, v36
    v_smfmac_f32_16x16x64_bf16 v[44:47], v[12:15], a[120:127], v116
    buffer_load_dwordx4 v117, s[8:11], s31 offen offset:1024 lds
    s_mov_b32 m0, 7168
    v_mul_f32 v37, s34, v37
    v_smfmac_f32_16x16x64_bf16 v[44:47], v[24:27], a[152:159], v116
    v_cvt_pk_bf16_f32 v34, v32, v36
    v_smfmac_f32_16x16x64_bf16 v[44:47], v[28:31], a[184:191], v116
    v_cvt_pk_bf16_f32 v35, v33, v37
    v_add_f32 v40, v40, v42
    v_smfmac_f32_16x16x64_bf16 v[48:51], v[8:11], a[224:231], v116
    ds_write2_b32 v120, v34, v35 offset0:32 offset1:48
    v_add_f32 v41, v41, v43
    v_smfmac_f32_16x16x64_bf16 v[52:55], v[8:11], a[232:239], v116
    v_add_f32 v44, v44, v46
    v_add_f32 v45, v45, v47
    v_cvt_pk_bf16_f32 v113, v40, v44
    v_cvt_pk_bf16_f32 v115, v41, v45
    v_smfmac_f32_16x16x64_bf16 v[48:51], v[12:15], a[240:247], v116
    ds_write2_b32 v120, v113, v115 offset0:0 offset1:16
    v_smfmac_f32_16x16x64_bf16 v[52:55], v[12:15], a[248:255], v116
    s_cmp_eq_u32 s22, 63
    s_cbranch_scc1 L_chain_last_s
    v_smfmac_f32_16x16x64_bf16 v[48:51], v[16:19], v[128:135], v116
    v_smfmac_f32_16x16x64_bf16 v[48:51], v[20:23], v[160:167], v116
    buffer_store_dword v126, v119, s[8:11], s55 offen sc1
    v_smfmac_f32_16x16x64_bf16 v[48:51], v[24:27], v[144:151], v116
    s_waitcnt lgkmcnt(0)
    s_barrier
    v_smfmac_f32_16x16x64_bf16 v[48:51], v[28:31], v[176:183], v116
    ds_read_b128 v[32:35], v121 offset:16384
    ds_read_b128 v[36:39], v121 offset:17408
    v_smfmac_f32_16x16x64_bf16 v[52:55], v[16:19], v[136:143], v116
    ds_read_b128 v[40:43], v121 offset:18432
    ds_read_b128 v[44:47], v121 offset:19456
    v_smfmac_f32_16x16x64_bf16 v[52:55], v[20:23], v[168:175], v116
    ds_read_b128 v[8:11], v124 offset:32768
    v_add_f32 v48, v48, v50
    v_smfmac_f32_16x16x64_bf16 v[52:55], v[24:27], v[152:159], v116
    ds_read_b128 v[12:15], v124 offset:33792
    v_add_f32 v49, v49, v51
    v_smfmac_f32_16x16x64_bf16 v[52:55], v[28:31], v[184:191], v116
    s_waitcnt lgkmcnt(5)
    v_cvt_pk_bf16_f32 v112, v48, v49
    v_mfma_f32_16x16x32_bf16 v[56:59], v[56:59], v[32:35], 0
    s_waitcnt lgkmcnt(4)
    v_mov_b32 v48, s50
    v_mov_b32 v49, s50
    v_mfma_f32_16x16x32_bf16 v[56:59], v[60:63], v[36:39], v[56:59]
    ds_read_b128 v[16:19], v124 offset:2048
    s_waitcnt lgkmcnt(4)
    v_mov_b32 v50, s50
    v_mov_b32 v51, s50
    v_mfma_f32_16x16x32_bf16 v[56:59], v[64:67], v[40:43], v[56:59]
    ds_read_b128 v[20:23], v124 offset:3072
    s_waitcnt lgkmcnt(4)
    v_add_f32 v52, v52, v54
    v_mfma_f32_16x16x32_bf16 v[56:59], v[68:71], v[44:47], v[56:59]
    ds_read_b128 v[24:27], v124 offset:4096
    v_add_f32 v53, v53, v55
    v_mfma_f32_16x16x32_bf16 v[60:63], v[72:75], v[32:35], 0
    ds_read_b128 v[28:31], v124 offset:5120
    v_cvt_pk_bf16_f32 v114, v52, v53
    v_mov_b32 v53, 0
    v_mfma_f32_16x16x32_bf16 v[60:63], v[76:79], v[36:39], v[60:63]
    v_exp_f32 v56, v56
    v_mfma_f32_16x16x32_bf16 v[60:63], v[80:83], v[40:43], v[60:63]
    v_exp_f32 v57, v57
    v_mfma_f32_16x16x32_bf16 v[60:63], v[84:87], v[44:47], v[60:63]
    v_exp_f32 v58, v58
    v_mfma_f32_16x16x32_bf16 v[64:67], v[32:35], v[32:35], 0
    v_exp_f32 v59, v59
    v_cvt_pk_bf16_f32 v68, v56, v57
    v_mfma_f32_16x16x32_bf16 v[64:67], v[36:39], v[36:39], v[64:67]
    v_exp_f32 v60, v60
    v_cvt_pk_bf16_f32 v69, v58, v59
    v_mfma_f32_16x16x32_bf16 v[64:67], v[40:43], v[40:43], v[64:67]
    v_exp_f32 v61, v61
    v_mfma_f32_16x16x32_bf16 v[64:67], v[44:47], v[44:47], v[64:67]
    v_exp_f32 v62, v62
    v_exp_f32 v63, v63
    v_cvt_pk_bf16_f32 v70, v60, v61
    v_cvt_pk_bf16_f32 v71, v62, v63
    s_nop 1
    v_mfma_f32_16x16x32_bf16 v[72:75], v[88:91], v[68:71], 0
    s_nop 0
    v_exp_f32 v64, v64
    v_mfma_f32_16x16x32_bf16 v[76:79], v[92:95], v[68:71], 0
    v_exp_f32 v65, v65
    v_mfma_f32_16x16x32_bf16 v[80:83], v[48:51], v[68:71], 0
    v_cvt_pk_bf16_f32 v52, v64, v65
    s_nop 1
    v_mfma_f32_16x16x16_bf16 v[72:75], v[112:113], v[52:53], v[72:75]
    ds_read_b128 v[32:35], v124 offset:6144
    v_mfma_f32_16x16x16_bf16 v[76:79], v[114:115], v[52:53], v[76:79]
    ds_read_b128 v[36:39], v124 offset:7168
    v_mfma_f32_16x16x16_bf16 v[80:83], v[48:49], v[52:53], v[80:83]
L_norm_83:
    s_mov_b64 vcc, s[36:37]
    v_mov_b32 v122, v122
    v_mov_b32 v122, v122
    v_mov_b32 v122, v122
    v_cndmask_b32_dpp v76, v72, v76, vcc quad_perm:[2,3,2,3] row_mask:0xf bank_mask:0xf
    v_cndmask_b32_dpp v77, v73, v77, vcc quad_perm:[2,3,2,3] row_mask:0xf bank_mask:0xf
    v_cndmask_b32_dpp v78, v74, v78, vcc quad_perm:[2,3,2,3] row_mask:0xf bank_mask:0xf
    v_cndmask_b32_dpp v79, v75, v79, vcc quad_perm:[2,3,2,3] row_mask:0xf bank_mask:0xf
    v_rcp_f32_dpp v84, v80 quad_perm:[2,3,2,3] row_mask:0xf bank_mask:0xf
    s_nop 0
    v_pk_mul_f32 v[76:77], v[76:77], v[84:85] op_sel_hi:[1,0]
    v_pk_mul_f32 v[78:79], v[78:79], v[84:85] op_sel_hi:[1,0]
    v_cvt_pk_bf16_f32 v72, v76, v77
    v_cvt_pk_bf16_f32 v73, v78, v79
    ds_write_b64 v122, v[72:73] offset:22016
    v_max_f32_dpp v86, v80, v84 quad_perm:[2,3,2,3] row_mask:0xf bank_mask:0xf
    v_mov_b32_dpp v60, v72 quad_perm:[0,1,0,1] row_mask:0xf bank_mask:0xf
    v_mov_b32_dpp v61, v73 quad_perm:[0,1,0,1] row_mask:0xf bank_mask:0xf
    v_cmp_lt_f32 vcc, s35, v86
    v_mov_b32_dpp v62, v72 quad_perm:[2,3,2,3] row_mask:0xf bank_mask:0xf
    v_mov_b32_dpp v63, v73 quad_perm:[2,3,2,3] row_mask:0xf bank_mask:0xf
    s_nop 1
    v_smfmac_f32_16x16x64_bf16 v[96:99], v[60:63], v[192:199], v116
    s_cbranch_vccnz L_smax_84
    v_smfmac_f32_16x16x64_bf16 v[100:103], v[60:63], v[224:231], v116
    s_waitcnt lgkmcnt(0)
    s_barrier
    ds_read_b128 v[92:95], v127 offset:21504
    ds_read_b128 v[80:83], v127 offset:20992
    ds_read_b128 v[84:87], v127 offset:20480
    v_smfmac_f32_16x16x64_bf16 v[104:107], v[60:63], v[0:7], v116
    ds_read_b128 v[40:43], v124 offset:34816
    v_smfmac_f32_16x16x64_bf16 v[108:111], v[60:63], v[8:15], v116
    ds_read_b128 v[56:59], v124 offset:36864
    s_waitcnt lgkmcnt(4)
    v_smfmac_f32_16x16x64_bf16 v[96:99], v[92:95], v[200:207], v116
    s_waitcnt lgkmcnt(3)
    v_smfmac_f32_16x16x64_bf16 v[96:99], v[80:83], v[208:215], v116
    ds_read_b128 v[44:47], v124 offset:35840
    s_waitcnt lgkmcnt(3)
    v_smfmac_f32_16x16x64_bf16 v[96:99], v[84:87], v[216:223], v116
    ds_read_b128 v[68:71], v124 offset:39936
    v_smfmac_f32_16x16x64_bf16 v[100:103], v[92:95], v[232:239], v116
    ds_read_b128 v[64:67], v124 offset:38912
    v_smfmac_f32_16x16x64_bf16 v[100:103], v[80:83], v[240:247], v116
    ds_read_b128 v[60:63], v124 offset:37888
    v_cvt_pk_bf16_f32 v72, v96, v98
    v_smfmac_f32_16x16x64_bf16 v[100:103], v[84:87], v[248:255], v116
    v_and_or_b32 v72, v72, -2, s33
    v_smfmac_f32_16x16x64_bf16 v[104:107], v[92:95], v[16:23], v116
    v_cvt_pk_bf16_f32 v74, v97, v99
    v_smfmac_f32_16x16x64_bf16 v[104:107], v[80:83], v[24:31], v116
    v_cvt_pk_bf16_f32 v73, v100, v102
    v_cvt_pk_bf16_f32 v75, v101, v103
    v_smfmac_f32_16x16x64_bf16 v[104:107], v[84:87], v[32:39], v116
    buffer_store_dwordx4 v[72:75], v118, s[8:11], s25 offen sc1
    s_waitcnt lgkmcnt(3)
    v_smfmac_f32_16x16x64_bf16 v[108:111], v[92:95], v[40:47], v116
    s_waitcnt lgkmcnt(0)
    v_smfmac_f32_16x16x64_bf16 v[108:111], v[80:83], v[56:63], v116
    v_cvt_pk_bf16_f32 v76, v104, v106
    v_smfmac_f32_16x16x64_bf16 v[108:111], v[84:87], v[64:71], v116
    v_and_or_b32 v76, v76, -2, s33
    v_cvt_pk_bf16_f32 v78, v105, v107
    v_mov_b32 v122, v122
    v_mov_b32 v122, v122
    v_mov_b32 v122, v122
    v_mov_b32 v122, v122
    v_mov_b32 v122, v122
    v_mov_b32 v122, v122
    v_cvt_pk_bf16_f32 v77, v108, v110
    v_cvt_pk_bf16_f32 v79, v109, v111
    buffer_store_dwordx4 v[76:79], v118, s[8:11], s26 offen sc1
    ds_read_b128 v[80:83], v123
    ds_read_b128 v[84:87], v123 offset:1024
    ds_read_b128 v[56:59], v123 offset:2048
    ds_read_b128 v[60:63], v123 offset:3072
    ds_read_b128 v[64:67], v123 offset:32768
    ds_read_b128 v[68:71], v123 offset:33792
    ds_read_b128 v[72:75], v123 offset:34816
    ds_read_b128 v[76:79], v123 offset:35840
    ds_read_b128 v[88:91], v123 offset:4096
    ds_read_b128 v[92:95], v123 offset:5120
    ds_read_b128 v[96:99], v123 offset:6144
    ds_read_b128 v[100:103], v123 offset:7168
    ds_read_b128 v[104:107], v123 offset:36864
    ds_read_b128 v[108:111], v123 offset:37888
    ds_read_b128 v[24:27], v123 offset:38912
    ds_read_b128 v[28:31], v123 offset:39936
    s_add_u32 s30, s30, 0x40000
    s_add_u32 s31, s31, 0x40000
    s_add_u32 s32, s32, 0x20000
    s_add_u32 s23, s24, 3072
    s_add_u32 s48, s23, 4096
    s_xor_b32 s25, s25, 0x0
    s_xor_b32 s26, s26, 0x0
    s_mov_b32 s35, 0x49800000
    s_add_u32 s22, s22, 1
    v_cndmask_b32 v12, 0, v125, s[68:69]
    v_cndmask_b32 v13, 0, v125, s[70:71]
    v_cndmask_b32 v14, 0, v125, s[72:73]
    v_cndmask_b32 v15, 0, v125, s[74:75]
    v_mov_b32 v54, 0
    v_mov_b32 v55, 0
    v_mov_b32 v52, 0
    v_mov_b32 v52, 0
    v_mov_b32 v52, 0
    v_mov_b32 v52, 0
    v_mov_b32 v52, 0
    v_mov_b32 v52, 0
    v_mov_b32 v52, 0
    v_mov_b32 v52, 0
    v_mov_b32 v52, 0
    v_mov_b32 v52, 0
    v_mov_b32 v52, 0
    v_mov_b32 v52, 0
    v_mov_b32 v52, 0
    v_mov_b32 v52, 0
    v_mov_b32 v52, 0
    v_mov_b32 v52, 0
    v_mov_b32 v52, 0
    v_mov_b32 v52, 0
    v_mov_b32 v52, 0
    v_mov_b32 v52, 0
    v_mov_b32 v52, 0
    v_mov_b32 v52, 0
    v_mov_b32 v52, 0
    v_mov_b32 v52, 0
    v_mov_b32 v52, 0
    v_mov_b32 v52, 0
    v_mov_b32 v52, 0
    v_mov_b32 v52, 0
    v_mov_b32 v52, 0
    v_mov_b32 v52, 0
    v_mov_b32 v52, 0
    v_mov_b32 v52, 0
    v_mov_b32 v52, 0
    v_mov_b32 v52, 0
    v_mov_b32 v52, 0
    v_mov_b32 v52, 0
    v_mov_b32 v52, 0
    v_mov_b32 v52, 0
    v_mov_b32 v52, 0
    v_mov_b32 v52, 0
    v_mov_b32 v52, 0
    v_mov_b32 v52, 0
    v_mov_b32 v52, 0
    v_mov_b32 v52, 0
    v_mov_b32 v52, 0
    v_mov_b32 v52, 0
    v_mov_b32 v52, 0
    v_mov_b32 v52, 0
    v_mov_b32 v52, 0
    buffer_load_dwordx4 v[4:7], v117, s[8:11], s29 offen sc1
    buffer_load_dwordx4 v[8:11], v117, s[8:11], s53 offen sc1
    buffer_load_dwordx4 v[16:19], v117, s[8:11], s29 offen offset:2048 sc1
    buffer_load_dwordx4 v[20:23], v117, s[8:11], s53 offen offset:2048 sc1
    v_mov_b32 v52, 0
    v_mov_b32 v52, 0
    v_mov_b32 v52, 0
    v_mov_b32 v52, 0
    v_mov_b32 v52, 0
    v_mov_b32 v52, 0
    v_mov_b32 v52, 0
    v_mov_b32 v52, 0
    v_mov_b32 v52, 0
    v_mov_b32 v52, 0
    v_mov_b32 v52, 0
    v_mov_b32 v52, 0
    v_mov_b32 v52, 0
    v_mov_b32 v52, 0
    v_mov_b32 v52, 0
    v_mov_b32 v52, 0
    v_mov_b32 v52, 0
    v_mov_b32 v52, 0
    v_mov_b32 v52, 0
    v_mov_b32 v52, 0
    v_mov_b32 v52, 0
    v_mov_b32 v52, 0
    v_mov_b32 v52, 0
    v_mov_b32 v52, 0
    v_mov_b32 v52, 0
    v_mov_b32 v52, 0
    v_mov_b32 v52, 0
    v_mov_b32 v52, 0
    v_mov_b32 v52, 0
    v_mov_b32 v52, 0
    buffer_load_dwordx4 v[32:35], v117, s[8:11], s29 offen sc1
    buffer_load_dwordx4 v[36:39], v117, s[8:11], s53 offen sc1
    buffer_load_dwordx4 v[40:43], v117, s[8:11], s29 offen offset:2048 sc1
    buffer_load_dwordx4 v[44:47], v117, s[8:11], s53 offen offset:2048 sc1
    v_mov_b32 v52, 0
L_rl_85:
    s_waitcnt vmcnt(7)
    v_mfma_f32_16x16x32_bf16 v[48:51], v[4:7], v[12:15], 0
    v_xor_b32 v52, s33, v4
    s_waitcnt vmcnt(6)
    v_mfma_f32_16x16x32_bf16 v[48:51], v[8:11], v[12:15], v[48:51]
    v_xor_b32 v53, s33, v8
    v_or_b32 v52, v52, v53
    s_waitcnt vmcnt(5)
    v_mfma_f32_16x16x32_bf16 v[48:51], v[16:19], v[12:15], v[48:51]
    v_xor_b32 v53, s33, v16
    v_or_b32 v52, v52, v53
    s_waitcnt vmcnt(4)
    v_mfma_f32_16x16x32_bf16 v[48:51], v[20:23], v[12:15], v[48:51]
    v_xor_b32 v53, s33, v20
    v_or_b32 v52, v52, v53
    v_and_b32 v52, 1, v52
    v_cmp_ne_u32 vcc, 0, v52
    s_cbranch_vccnz L_rslow_86
L_rgo_87:
    s_nop 2
    v_permlane32_swap_b32 v48, v50
    v_permlane32_swap_b32 v49, v51
    v_pk_add_f32 v[48:49], v[48:49], v[50:51]
    s_mov_b64 exec, s[38:39]
    v_cvt_pk_bf16_f32 v12, v48, v49
    v_min_u32 v12, 0xfffffffe, v12
    buffer_store_dword v12, v119, s[8:11], s24 offen sc1
    s_mov_b64 exec, -1
    s_add_u32 s24, s24, 8192
    s_bitset0_b32 s24, 15
    s_xor_b32 s55, s24, 16384
    s_xor_b32 s29, s29, 0x0
    s_xor_b32 s53, s29, 1024
    s_bfe_u32 s33, s22, 0x10000
    s_waitcnt lgkmcnt(0)
    s_branch L_chain_top3_s
L_chain_last_s:
    s_nop 1
    v_smfmac_f32_16x16x64_bf16 v[48:51], v[16:19], v[128:135], v116
    v_smfmac_f32_16x16x64_bf16 v[48:51], v[20:23], v[160:167], v116
    v_smfmac_f32_16x16x64_bf16 v[48:51], v[24:27], v[144:151], v116
    v_smfmac_f32_16x16x64_bf16 v[48:51], v[28:31], v[176:183], v116
    v_smfmac_f32_16x16x64_bf16 v[52:55], v[16:19], v[136:143], v116
    v_smfmac_f32_16x16x64_bf16 v[52:55], v[20:23], v[168:175], v116
    v_smfmac_f32_16x16x64_bf16 v[52:55], v[24:27], v[152:159], v116
    v_smfmac_f32_16x16x64_bf16 v[52:55], v[28:31], v[184:191], v116
    v_add_f32 v48, v48, v50
    v_add_f32 v49, v49, v51
    v_cvt_pk_bf16_f32 v112, v48, v49
    s_nop 4
    v_add_f32 v52, v52, v54
    v_add_f32 v53, v53, v55
    v_cvt_pk_bf16_f32 v114, v52, v53
    s_add_u32 s32, s32, 0x20000
    buffer_store_dwordx4 v[112:115], v117, s[8:11], s32 offen sc1
    v_mov_b32 v94, 64
    s_waitcnt vmcnt(0) lgkmcnt(0)
    s_barrier
    s_mov_b64 exec, 1
    buffer_store_dword v94, off, s[8:11], s44 sc1
    s_mov_b64 exec, -1
    s_endpgm
L_mret_59:
    s_mov_b32 s43, m0
    s_mov_b32 m0, 4096
    buffer_load_dwordx4 v[4:7], v117, s[8:11], s48 offen sc1
    buffer_load_dwordx4 v117, s[8:11], s48 offen sc1 lds
    s_mov_b32 m0, 8192
    s_mov_b32 m0, s43
    s_waitcnt vmcnt(0)
    v_max3_u32 v15, v4, v5, v6
    v_max_u32 v15, v15, v7
    v_cmp_lt_u32 vcc, s56, v15
    s_add_u32 s47, s47, 1
    s_add_u32 s49, s49, 1
    s_cmp_ge_u32 s49, 0x10000
    s_cbranch_scc1 L_mgo_60
    s_cbranch_vccnz L_mret_59
    s_branch L_mgo_60
L_smax_62:
    s_add_u32 s47, s47, 1
    s_mov_b32 s35, 0x7f800000
    s_waitcnt lgkmcnt(0)
    s_sub_u32 s43, s30, 0x40000
    s_add_u32 s40, s43, 4096
    s_nop 7
    buffer_load_dwordx4 v[56:59], v117, s[8:11], s43 offen
    buffer_load_dwordx4 v[60:63], v117, s[8:11], s43 offen offset:1024
    buffer_load_dwordx4 v[64:67], v117, s[8:11], s43 offen offset:2048
    buffer_load_dwordx4 v[68:71], v117, s[8:11], s43 offen offset:3072
    buffer_load_dwordx4 v[72:75], v117, s[8:11], s40 offen
    buffer_load_dwordx4 v[76:79], v117, s[8:11], s40 offen offset:1024
    buffer_load_dwordx4 v[80:83], v117, s[8:11], s40 offen offset:2048
    buffer_load_dwordx4 v[84:87], v117, s[8:11], s40 offen offset:3072
    ds_read_b128 v[32:35], v121 offset:16384
    ds_read_b128 v[36:39], v121 offset:17408
    ds_read_b128 v[40:43], v121 offset:18432
    ds_read_b128 v[44:47], v121 offset:19456
    v_mov_b32 v96, 0
    v_mov_b32 v97, 0
    v_mov_b32 v98, 0
    v_mov_b32 v99, 0
    v_mov_b32 v100, 0
    v_mov_b32 v101, 0
    v_mov_b32 v102, 0
    v_mov_b32 v103, 0
    v_mov_b32 v104, 0
    v_mov_b32 v105, 0
    v_mov_b32 v106, 0
    v_mov_b32 v107, 0
    v_mov_b32 v108, 0
    v_mov_b32 v109, 0
    v_mov_b32 v110, 0
    v_mov_b32 v111, 0
    s_waitcnt vmcnt(0) lgkmcnt(0)
    v_mfma_f32_16x16x32_bf16 v[56:59], v[56:59], v[32:35], 0
    v_mfma_f32_16x16x32_bf16 v[56:59], v[60:63], v[36:39], v[56:59]
    v_mfma_f32_16x16x32_bf16 v[56:59], v[64:67], v[40:43], v[56:59]
    v_mfma_f32_16x16x32_bf16 v[56:59], v[68:71], v[44:47], v[56:59]
    v_mfma_f32_16x16x32_bf16 v[60:63], v[72:75], v[32:35], 0
    v_mfma_f32_16x16x32_bf16 v[60:63], v[76:79], v[36:39], v[60:63]
    v_mfma_f32_16x16x32_bf16 v[60:63], v[80:83], v[40:43], v[60:63]
    v_mfma_f32_16x16x32_bf16 v[60:63], v[84:87], v[44:47], v[60:63]
    v_mfma_f32_16x16x32_bf16 v[64:67], v[32:35], v[32:35], 0
    v_mfma_f32_16x16x32_bf16 v[64:67], v[36:39], v[36:39], v[64:67]
    v_mfma_f32_16x16x32_bf16 v[64:67], v[40:43], v[40:43], v[64:67]
    v_mfma_f32_16x16x32_bf16 v[64:67], v[44:47], v[44:47], v[64:67]
    v_max3_f32 v84, v56, v57, v58
    v_max3_f32 v84, v84, v59, v60
    v_max3_f32 v84, v84, v61, v62
    s_nop 4
    v_max3_f32 v84, v84, v63, v64
    v_max_f32 v84, v84, v65
    v_mov_b32 v85, v84
    s_nop 1
    v_permlane32_swap_b32 v85, v84
    v_max_f32 v84, v85, v84
    v_mov_b32 v85, v84
    s_nop 1
    v_permlane16_swap_b32 v85, v84
    v_max_f32 v84, v85, v84
    v_sub_f32 v56, v56, v84
    v_sub_f32 v57, v57, v84
    v_sub_f32 v58, v58, v84
    v_sub_f32 v59, v59, v84
    v_sub_f32 v60, v60, v84
    v_sub_f32 v61, v61, v84
    v_sub_f32 v62, v62, v84
    v_sub_f32 v63, v63, v84
    v_sub_f32 v64, v64, v84
    v_sub_f32 v65, v65, v84
    v_exp_f32 v56, v56
    v_exp_f32 v57, v57
    v_exp_f32 v58, v58
    v_exp_f32 v59, v59
    v_exp_f32 v60, v60
    v_exp_f32 v61, v61
    v_exp_f32 v62, v62
    v_exp_f32 v63, v63
    v_exp_f32 v64, v64
    v_exp_f32 v65, v65
    v_cvt_pk_bf16_f32 v68, v56, v57
    v_cvt_pk_bf16_f32 v69, v58, v59
    v_cvt_pk_bf16_f32 v70, v60, v61
    v_cvt_pk_bf16_f32 v71, v62, v63
    v_cvt_pk_bf16_f32 v52, v64, v65
    s_nop 0
    v_mfma_f32_16x16x32_bf16 v[72:75], v[88:91], v[68:71], 0
    v_mfma_f32_16x16x32_bf16 v[76:79], v[92:95], v[68:71], 0
    v_mfma_f32_16x16x32_bf16 v[80:83], v[48:51], v[68:71], 0
    v_mfma_f32_16x16x16_bf16 v[72:75], v[112:113], v[52:53], v[72:75]
    v_mfma_f32_16x16x16_bf16 v[76:79], v[114:115], v[52:53], v[76:79]
    v_mfma_f32_16x16x16_bf16 v[80:83], v[48:49], v[52:53], v[80:83]
    ds_read_b128 v[32:35], v124 offset:6144
    ds_read_b128 v[36:39], v124 offset:7168
    ds_read_b128 v[40:43], v124 offset:34816
    ds_read_b128 v[44:47], v124 offset:35840
    ds_read_b128 v[56:59], v124 offset:36864
    ds_read_b128 v[64:67], v124 offset:38912
    ds_read_b128 v[68:71], v124 offset:39936
    s_waitcnt lgkmcnt(0)
    s_branch L_norm_61
L_kvw_63:
    s_add_u32 s47, s47, 1
    s_add_u32 s49, s49, 1
    s_cmp_ge_u32 s49, 0x10000
    s_cbranch_scc1 L_kvb_64
    s_sleep 4
    buffer_load_dword v125, v119, s[8:11], s28 offen sc1
    s_waitcnt vmcnt(0)
    v_cmp_eq_u32 vcc, 0, v125
    s_nop 0
    s_and_b64 vcc, vcc, s[58:59]
    s_cbranch_scc1 L_kvw_63
    s_branch L_kvb_64
L_mret_66:
    s_mov_b32 s43, m0
    s_mov_b32 m0, 5120
    buffer_load_dwordx4 v[4:7], v117, s[8:11], s48 offen sc1
    buffer_load_dwordx4 v117, s[8:11], s48 offen sc1 lds
    s_mov_b32 m0, 10240
    s_mov_b32 m0, s43
    s_waitcnt vmcnt(0)
    v_max3_u32 v15, v4, v5, v6
    v_max_u32 v15, v15, v7
    v_cmp_lt_u32 vcc, s56, v15
    s_add_u32 s47, s47, 1
    s_add_u32 s49, s49, 1
    s_cmp_ge_u32 s49, 0x10000
    s_cbranch_scc1 L_mgo_67
    s_cbranch_vccnz L_mret_66
    s_branch L_mgo_67
L_smax_69:
    s_add_u32 s47, s47, 1
    s_mov_b32 s35, 0x7f800000
    s_waitcnt lgkmcnt(0)
    s_sub_u32 s43, s30, 0x40800
    s_add_u32 s40, s43, 4096
    s_nop 7
    buffer_load_dwordx4 v[56:59], v117, s[8:11], s43 offen
    buffer_load_dwordx4 v[60:63], v117, s[8:11], s43 offen offset:1024
    buffer_load_dwordx4 v[64:67], v117, s[8:11], s43 offen offset:2048
    buffer_load_dwordx4 v[68:71], v117, s[8:11], s43 offen offset:3072
    buffer_load_dwordx4 v[72:75], v117, s[8:11], s40 offen
    buffer_load_dwordx4 v[76:79], v117, s[8:11], s40 offen offset:1024
    buffer_load_dwordx4 v[80:83], v117, s[8:11], s40 offen offset:2048
    buffer_load_dwordx4 v[84:87], v117, s[8:11], s40 offen offset:3072
    ds_read_b128 v[32:35], v121 offset:16384
    ds_read_b128 v[36:39], v121 offset:17408
    ds_read_b128 v[40:43], v121 offset:18432
    ds_read_b128 v[44:47], v121 offset:19456
    v_mov_b32 v96, 0
    v_mov_b32 v97, 0
    v_mov_b32 v98, 0
    v_mov_b32 v99, 0
    v_mov_b32 v100, 0
    v_mov_b32 v101, 0
    v_mov_b32 v102, 0
    v_mov_b32 v103, 0
    v_mov_b32 v104, 0
    v_mov_b32 v105, 0
    v_mov_b32 v106, 0
    v_mov_b32 v107, 0
    v_mov_b32 v108, 0
    v_mov_b32 v109, 0
    v_mov_b32 v110, 0
    v_mov_b32 v111, 0
    s_waitcnt vmcnt(0) lgkmcnt(0)
    v_mfma_f32_16x16x32_bf16 v[56:59], v[56:59], v[32:35], 0
    v_mfma_f32_16x16x32_bf16 v[56:59], v[60:63], v[36:39], v[56:59]
    v_mfma_f32_16x16x32_bf16 v[56:59], v[64:67], v[40:43], v[56:59]
    v_mfma_f32_16x16x32_bf16 v[56:59], v[68:71], v[44:47], v[56:59]
    v_mfma_f32_16x16x32_bf16 v[60:63], v[72:75], v[32:35], 0
    v_mfma_f32_16x16x32_bf16 v[60:63], v[76:79], v[36:39], v[60:63]
    v_mfma_f32_16x16x32_bf16 v[60:63], v[80:83], v[40:43], v[60:63]
    v_mfma_f32_16x16x32_bf16 v[60:63], v[84:87], v[44:47], v[60:63]
    v_mfma_f32_16x16x32_bf16 v[64:67], v[32:35], v[32:35], 0
    v_mfma_f32_16x16x32_bf16 v[64:67], v[36:39], v[36:39], v[64:67]
    v_mfma_f32_16x16x32_bf16 v[64:67], v[40:43], v[40:43], v[64:67]
    v_mfma_f32_16x16x32_bf16 v[64:67], v[44:47], v[44:47], v[64:67]
    v_max3_f32 v84, v56, v57, v58
    v_max3_f32 v84, v84, v59, v60
    v_max3_f32 v84, v84, v61, v62
    s_nop 4
    v_max3_f32 v84, v84, v63, v64
    v_max_f32 v84, v84, v65
    v_mov_b32 v85, v84
    s_nop 1
    v_permlane32_swap_b32 v85, v84
    v_max_f32 v84, v85, v84
    v_mov_b32 v85, v84
    s_nop 1
    v_permlane16_swap_b32 v85, v84
    v_max_f32 v84, v85, v84
    v_sub_f32 v56, v56, v84
    v_sub_f32 v57, v57, v84
    v_sub_f32 v58, v58, v84
    v_sub_f32 v59, v59, v84
    v_sub_f32 v60, v60, v84
    v_sub_f32 v61, v61, v84
    v_sub_f32 v62, v62, v84
    v_sub_f32 v63, v63, v84
    v_sub_f32 v64, v64, v84
    v_sub_f32 v65, v65, v84
    v_exp_f32 v56, v56
    v_exp_f32 v57, v57
    v_exp_f32 v58, v58
    v_exp_f32 v59, v59
    v_exp_f32 v60, v60
    v_exp_f32 v61, v61
    v_exp_f32 v62, v62
    v_exp_f32 v63, v63
    v_exp_f32 v64, v64
    v_exp_f32 v65, v65
    v_cvt_pk_bf16_f32 v68, v56, v57
    v_cvt_pk_bf16_f32 v69, v58, v59
    v_cvt_pk_bf16_f32 v70, v60, v61
    v_cvt_pk_bf16_f32 v71, v62, v63
    v_cvt_pk_bf16_f32 v52, v64, v65
    s_nop 0
    v_mfma_f32_16x16x32_bf16 v[72:75], v[88:91], v[68:71], 0
    v_mfma_f32_16x16x32_bf16 v[76:79], v[92:95], v[68:71], 0
    v_mfma_f32_16x16x32_bf16 v[80:83], v[48:51], v[68:71], 0
    v_mfma_f32_16x16x16_bf16 v[72:75], v[112:113], v[52:53], v[72:75]
    v_mfma_f32_16x16x16_bf16 v[76:79], v[114:115], v[52:53], v[76:79]
    v_mfma_f32_16x16x16_bf16 v[80:83], v[48:49], v[52:53], v[80:83]
    ds_read_b128 v[32:35], v124 offset:6144
    ds_read_b128 v[36:39], v124 offset:7168
    ds_read_b128 v[40:43], v124 offset:34816
    ds_read_b128 v[44:47], v124 offset:35840
    ds_read_b128 v[56:59], v124 offset:36864
    ds_read_b128 v[64:67], v124 offset:38912
    ds_read_b128 v[68:71], v124 offset:39936
    s_waitcnt lgkmcnt(0)
    s_branch L_norm_68
L_kvw_70:
    s_add_u32 s47, s47, 1
    s_add_u32 s49, s49, 1
    s_cmp_ge_u32 s49, 0x10000
    s_cbranch_scc1 L_kvb_71
    s_sleep 4
    buffer_load_dword v125, v119, s[8:11], s28 offen sc1
    s_waitcnt vmcnt(0)
    v_cmp_eq_u32 vcc, 0, v125
    s_nop 0
    s_and_b64 vcc, vcc, s[58:59]
    s_cbranch_scc1 L_kvw_70
    s_branch L_kvb_71
L_mret_73:
    s_mov_b32 s43, m0
    s_mov_b32 m0, 6144
    buffer_load_dwordx4 v[4:7], v117, s[8:11], s48 offen sc1
    buffer_load_dwordx4 v117, s[8:11], s48 offen sc1 lds
    s_mov_b32 m0, 12288
    s_mov_b32 m0, s43
    s_waitcnt vmcnt(0)
    v_max3_u32 v15, v4, v5, v6
    v_max_u32 v15, v15, v7
    v_cmp_lt_u32 vcc, s56, v15
    s_add_u32 s47, s47, 1
    s_add_u32 s49, s49, 1
    s_cmp_ge_u32 s49, 0x10000
    s_cbranch_scc1 L_mgo_74
    s_cbranch_vccnz L_mret_73
    s_branch L_mgo_74
L_smax_76:
    s_add_u32 s47, s47, 1
    s_mov_b32 s35, 0x7f800000
    s_waitcnt lgkmcnt(0)
    s_sub_u32 s43, s30, 0x41000
    s_add_u32 s40, s43, 4096
    s_nop 7
    buffer_load_dwordx4 v[56:59], v117, s[8:11], s43 offen
    buffer_load_dwordx4 v[60:63], v117, s[8:11], s43 offen offset:1024
    buffer_load_dwordx4 v[64:67], v117, s[8:11], s43 offen offset:2048
    buffer_load_dwordx4 v[68:71], v117, s[8:11], s43 offen offset:3072
    buffer_load_dwordx4 v[72:75], v117, s[8:11], s40 offen
    buffer_load_dwordx4 v[76:79], v117, s[8:11], s40 offen offset:1024
    buffer_load_dwordx4 v[80:83], v117, s[8:11], s40 offen offset:2048
    buffer_load_dwordx4 v[84:87], v117, s[8:11], s40 offen offset:3072
    ds_read_b128 v[32:35], v121 offset:16384
    ds_read_b128 v[36:39], v121 offset:17408
    ds_read_b128 v[40:43], v121 offset:18432
    ds_read_b128 v[44:47], v121 offset:19456
    v_mov_b32 v96, 0
    v_mov_b32 v97, 0
    v_mov_b32 v98, 0
    v_mov_b32 v99, 0
    v_mov_b32 v100, 0
    v_mov_b32 v101, 0
    v_mov_b32 v102, 0
    v_mov_b32 v103, 0
    v_mov_b32 v104, 0
    v_mov_b32 v105, 0
    v_mov_b32 v106, 0
    v_mov_b32 v107, 0
    v_mov_b32 v108, 0
    v_mov_b32 v109, 0
    v_mov_b32 v110, 0
    v_mov_b32 v111, 0
    s_waitcnt vmcnt(0) lgkmcnt(0)
    v_mfma_f32_16x16x32_bf16 v[56:59], v[56:59], v[32:35], 0
    v_mfma_f32_16x16x32_bf16 v[56:59], v[60:63], v[36:39], v[56:59]
    v_mfma_f32_16x16x32_bf16 v[56:59], v[64:67], v[40:43], v[56:59]
    v_mfma_f32_16x16x32_bf16 v[56:59], v[68:71], v[44:47], v[56:59]
    v_mfma_f32_16x16x32_bf16 v[60:63], v[72:75], v[32:35], 0
    v_mfma_f32_16x16x32_bf16 v[60:63], v[76:79], v[36:39], v[60:63]
    v_mfma_f32_16x16x32_bf16 v[60:63], v[80:83], v[40:43], v[60:63]
    v_mfma_f32_16x16x32_bf16 v[60:63], v[84:87], v[44:47], v[60:63]
    v_mfma_f32_16x16x32_bf16 v[64:67], v[32:35], v[32:35], 0
    v_mfma_f32_16x16x32_bf16 v[64:67], v[36:39], v[36:39], v[64:67]
    v_mfma_f32_16x16x32_bf16 v[64:67], v[40:43], v[40:43], v[64:67]
    v_mfma_f32_16x16x32_bf16 v[64:67], v[44:47], v[44:47], v[64:67]
    v_max3_f32 v84, v56, v57, v58
    v_max3_f32 v84, v84, v59, v60
    v_max3_f32 v84, v84, v61, v62
    s_nop 4
    v_max3_f32 v84, v84, v63, v64
    v_max_f32 v84, v84, v65
    v_mov_b32 v85, v84
    s_nop 1
    v_permlane32_swap_b32 v85, v84
    v_max_f32 v84, v85, v84
    v_mov_b32 v85, v84
    s_nop 1
    v_permlane16_swap_b32 v85, v84
    v_max_f32 v84, v85, v84
    v_sub_f32 v56, v56, v84
    v_sub_f32 v57, v57, v84
    v_sub_f32 v58, v58, v84
    v_sub_f32 v59, v59, v84
    v_sub_f32 v60, v60, v84
    v_sub_f32 v61, v61, v84
    v_sub_f32 v62, v62, v84
    v_sub_f32 v63, v63, v84
    v_sub_f32 v64, v64, v84
    v_sub_f32 v65, v65, v84
    v_exp_f32 v56, v56
    v_exp_f32 v57, v57
    v_exp_f32 v58, v58
    v_exp_f32 v59, v59
    v_exp_f32 v60, v60
    v_exp_f32 v61, v61
    v_exp_f32 v62, v62
    v_exp_f32 v63, v63
    v_exp_f32 v64, v64
    v_exp_f32 v65, v65
    v_cvt_pk_bf16_f32 v68, v56, v57
    v_cvt_pk_bf16_f32 v69, v58, v59
    v_cvt_pk_bf16_f32 v70, v60, v61
    v_cvt_pk_bf16_f32 v71, v62, v63
    v_cvt_pk_bf16_f32 v52, v64, v65
    s_nop 0
    v_mfma_f32_16x16x32_bf16 v[72:75], v[88:91], v[68:71], 0
    v_mfma_f32_16x16x32_bf16 v[76:79], v[92:95], v[68:71], 0
    v_mfma_f32_16x16x32_bf16 v[80:83], v[48:51], v[68:71], 0
    v_mfma_f32_16x16x16_bf16 v[72:75], v[112:113], v[52:53], v[72:75]
    v_mfma_f32_16x16x16_bf16 v[76:79], v[114:115], v[52:53], v[76:79]
    v_mfma_f32_16x16x16_bf16 v[80:83], v[48:49], v[52:53], v[80:83]
    ds_read_b128 v[32:35], v124 offset:6144
    ds_read_b128 v[36:39], v124 offset:7168
    ds_read_b128 v[40:43], v124 offset:34816
    ds_read_b128 v[44:47], v124 offset:35840
    ds_read_b128 v[56:59], v124 offset:36864
    ds_read_b128 v[64:67], v124 offset:38912
    ds_read_b128 v[68:71], v124 offset:39936
    s_waitcnt lgkmcnt(0)
    s_branch L_norm_75
L_rslow_78:
    buffer_load_dwordx4 v[4:7], v117, s[8:11], s29 offen sc1
    buffer_load_dwordx4 v[8:11], v117, s[8:11], s53 offen sc1
    buffer_load_dwordx4 v[16:19], v117, s[8:11], s29 offen offset:2048 sc1
    buffer_load_dwordx4 v[20:23], v117, s[8:11], s53 offen offset:2048 sc1
    s_add_u32 s46, s46, 1
    s_add_u32 s49, s49, 1
    s_cmp_ge_u32 s49, 0x10000
    s_cbranch_scc1 L_rgo_79
    s_waitcnt vmcnt(7)
    v_mfma_f32_16x16x32_bf16 v[48:51], v[32:35], v[12:15], 0
    v_xor_b32 v52, s33, v32
    s_waitcnt vmcnt(6)
    v_mfma_f32_16x16x32_bf16 v[48:51], v[36:39], v[12:15], v[48:51]
    v_xor_b32 v53, s33, v36
    v_or_b32 v52, v52, v53
    s_waitcnt vmcnt(5)
    v_mfma_f32_16x16x32_bf16 v[48:51], v[40:43], v[12:15], v[48:51]
    v_xor_b32 v53, s33, v40
    v_or_b32 v52, v52, v53
    s_waitcnt vmcnt(4)
    v_mfma_f32_16x16x32_bf16 v[48:51], v[44:47], v[12:15], v[48:51]
    v_xor_b32 v53, s33, v44
    v_or_b32 v52, v52, v53
    v_and_b32 v52, 1, v52
    v_cmp_ne_u32 vcc, 0, v52
    s_cbranch_vccz L_rgo_79
    buffer_load_dwordx4 v[32:35], v117, s[8:11], s29 offen sc1
    buffer_load_dwordx4 v[36:39], v117, s[8:11], s53 offen sc1
    buffer_load_dwordx4 v[40:43], v117, s[8:11], s29 offen offset:2048 sc1
    buffer_load_dwordx4 v[44:47], v117, s[8:11], s53 offen offset:2048 sc1
    s_add_u32 s46, s46, 1
    s_branch L_rl_77
L_mret_81:
    s_mov_b32 s43, m0
    s_mov_b32 m0, 7168
    buffer_load_dwordx4 v[4:7], v117, s[8:11], s48 offen sc1
    buffer_load_dwordx4 v117, s[8:11], s48 offen sc1 lds
    s_mov_b32 m0, 14336
    s_mov_b32 m0, s43
    s_waitcnt vmcnt(0)
    v_max3_u32 v15, v4, v5, v6
    v_max_u32 v15, v15, v7
    v_cmp_lt_u32 vcc, s56, v15
    s_add_u32 s47, s47, 1
    s_add_u32 s49, s49, 1
    s_cmp_ge_u32 s49, 0x10000
    s_cbranch_scc1 L_mgo_82
    s_cbranch_vccnz L_mret_81
    s_branch L_mgo_82
L_smax_84:
    s_add_u32 s47, s47, 1
    s_mov_b32 s35, 0x7f800000
    s_waitcnt lgkmcnt(0)
    s_sub_u32 s43, s30, 0x41800
    s_add_u32 s40, s43, 4096
    s_nop 7
    buffer_load_dwordx4 v[56:59], v117, s[8:11], s43 offen
    buffer_load_dwordx4 v[60:63], v117, s[8:11], s43 offen offset:1024
    buffer_load_dwordx4 v[64:67], v117, s[8:11], s43 offen offset:2048
    buffer_load_dwordx4 v[68:71], v117, s[8:11], s43 offen offset:3072
    buffer_load_dwordx4 v[72:75], v117, s[8:11], s40 offen
    buffer_load_dwordx4 v[76:79], v117, s[8:11], s40 offen offset:1024
    buffer_load_dwordx4 v[80:83], v117, s[8:11], s40 offen offset:2048
    buffer_load_dwordx4 v[84:87], v117, s[8:11], s40 offen offset:3072
    ds_read_b128 v[32:35], v121 offset:16384
    ds_read_b128 v[36:39], v121 offset:17408
    ds_read_b128 v[40:43], v121 offset:18432
    ds_read_b128 v[44:47], v121 offset:19456
    v_mov_b32 v96, 0
    v_mov_b32 v97, 0
    v_mov_b32 v98, 0
    v_mov_b32 v99, 0
    v_mov_b32 v100, 0
    v_mov_b32 v101, 0
    v_mov_b32 v102, 0
    v_mov_b32 v103, 0
    v_mov_b32 v104, 0
    v_mov_b32 v105, 0
    v_mov_b32 v106, 0
    v_mov_b32 v107, 0
    v_mov_b32 v108, 0
    v_mov_b32 v109, 0
    v_mov_b32 v110, 0
    v_mov_b32 v111, 0
    s_waitcnt vmcnt(0) lgkmcnt(0)
    v_mfma_f32_16x16x32_bf16 v[56:59], v[56:59], v[32:35], 0
    v_mfma_f32_16x16x32_bf16 v[56:59], v[60:63], v[36:39], v[56:59]
    v_mfma_f32_16x16x32_bf16 v[56:59], v[64:67], v[40:43], v[56:59]
    v_mfma_f32_16x16x32_bf16 v[56:59], v[68:71], v[44:47], v[56:59]
    v_mfma_f32_16x16x32_bf16 v[60:63], v[72:75], v[32:35], 0
    v_mfma_f32_16x16x32_bf16 v[60:63], v[76:79], v[36:39], v[60:63]
    v_mfma_f32_16x16x32_bf16 v[60:63], v[80:83], v[40:43], v[60:63]
    v_mfma_f32_16x16x32_bf16 v[60:63], v[84:87], v[44:47], v[60:63]
    v_mfma_f32_16x16x32_bf16 v[64:67], v[32:35], v[32:35], 0
    v_mfma_f32_16x16x32_bf16 v[64:67], v[36:39], v[36:39], v[64:67]
    v_mfma_f32_16x16x32_bf16 v[64:67], v[40:43], v[40:43], v[64:67]
    v_mfma_f32_16x16x32_bf16 v[64:67], v[44:47], v[44:47], v[64:67]
    v_max3_f32 v84, v56, v57, v58
    v_max3_f32 v84, v84, v59, v60
    v_max3_f32 v84, v84, v61, v62
    s_nop 4
    v_max3_f32 v84, v84, v63, v64
    v_max_f32 v84, v84, v65
    v_mov_b32 v85, v84
    s_nop 1
    v_permlane32_swap_b32 v85, v84
    v_max_f32 v84, v85, v84
    v_mov_b32 v85, v84
    s_nop 1
    v_permlane16_swap_b32 v85, v84
    v_max_f32 v84, v85, v84
    v_sub_f32 v56, v56, v84
    v_sub_f32 v57, v57, v84
    v_sub_f32 v58, v58, v84
    v_sub_f32 v59, v59, v84
    v_sub_f32 v60, v60, v84
    v_sub_f32 v61, v61, v84
    v_sub_f32 v62, v62, v84
    v_sub_f32 v63, v63, v84
    v_sub_f32 v64, v64, v84
    v_sub_f32 v65, v65, v84
    v_exp_f32 v56, v56
    v_exp_f32 v57, v57
    v_exp_f32 v58, v58
    v_exp_f32 v59, v59
    v_exp_f32 v60, v60
    v_exp_f32 v61, v61
    v_exp_f32 v62, v62
    v_exp_f32 v63, v63
    v_exp_f32 v64, v64
    v_exp_f32 v65, v65
    v_cvt_pk_bf16_f32 v68, v56, v57
    v_cvt_pk_bf16_f32 v69, v58, v59
    v_cvt_pk_bf16_f32 v70, v60, v61
    v_cvt_pk_bf16_f32 v71, v62, v63
    v_cvt_pk_bf16_f32 v52, v64, v65
    s_nop 0
    v_mfma_f32_16x16x32_bf16 v[72:75], v[88:91], v[68:71], 0
    v_mfma_f32_16x16x32_bf16 v[76:79], v[92:95], v[68:71], 0
    v_mfma_f32_16x16x32_bf16 v[80:83], v[48:51], v[68:71], 0
    v_mfma_f32_16x16x16_bf16 v[72:75], v[112:113], v[52:53], v[72:75]
    v_mfma_f32_16x16x16_bf16 v[76:79], v[114:115], v[52:53], v[76:79]
    v_mfma_f32_16x16x16_bf16 v[80:83], v[48:49], v[52:53], v[80:83]
    ds_read_b128 v[32:35], v124 offset:6144
    ds_read_b128 v[36:39], v124 offset:7168
    ds_read_b128 v[40:43], v124 offset:34816
    ds_read_b128 v[44:47], v124 offset:35840
    ds_read_b128 v[56:59], v124 offset:36864
    ds_read_b128 v[64:67], v124 offset:38912
    ds_read_b128 v[68:71], v124 offset:39936
    s_waitcnt lgkmcnt(0)
    s_branch L_norm_83
L_rslow_86:
    buffer_load_dwordx4 v[4:7], v117, s[8:11], s29 offen sc1
    buffer_load_dwordx4 v[8:11], v117, s[8:11], s53 offen sc1
    buffer_load_dwordx4 v[16:19], v117, s[8:11], s29 offen offset:2048 sc1
    buffer_load_dwordx4 v[20:23], v117, s[8:11], s53 offen offset:2048 sc1
    s_add_u32 s46, s46, 1
    s_add_u32 s49, s49, 1
    s_cmp_ge_u32 s49, 0x10000
    s_cbranch_scc1 L_rgo_87
    s_waitcnt vmcnt(7)
    v_mfma_f32_16x16x32_bf16 v[48:51], v[32:35], v[12:15], 0
    v_xor_b32 v52, s33, v32
    s_waitcnt vmcnt(6)
    v_mfma_f32_16x16x32_bf16 v[48:51], v[36:39], v[12:15], v[48:51]
    v_xor_b32 v53, s33, v36
    v_or_b32 v52, v52, v53
    s_waitcnt vmcnt(5)
    v_mfma_f32_16x16x32_bf16 v[48:51], v[40:43], v[12:15], v[48:51]
    v_xor_b32 v53, s33, v40
    v_or_b32 v52, v52, v53
    s_waitcnt vmcnt(4)
    v_mfma_f32_16x16x32_bf16 v[48:51], v[44:47], v[12:15], v[48:51]
    v_xor_b32 v53, s33, v44
    v_or_b32 v52, v52, v53
    v_and_b32 v52, 1, v52
    v_cmp_ne_u32 vcc, 0, v52
    s_cbranch_vccz L_rgo_87
    buffer_load_dwordx4 v[32:35], v117, s[8:11], s29 offen sc1
    buffer_load_dwordx4 v[36:39], v117, s[8:11], s53 offen sc1
    buffer_load_dwordx4 v[40:43], v117, s[8:11], s29 offen offset:2048 sc1
    buffer_load_dwordx4 v[44:47], v117, s[8:11], s53 offen offset:2048 sc1
    s_add_u32 s46, s46, 1
    s_branch L_rl_85
L_bulk:
    s_load_dwordx8 s[60:67], s[0:1], 16
    s_load_dwordx2 s[12:13], s[0:1], 0
    s_waitcnt lgkmcnt(0)
    s_branch L_bulk2
.p2align 7
L_other:
    s_sub_u32 s101, s84, 1
    s_lshl_b32 s101, s101, 5
    s_add_u32 s101, s101, s85
    s_cmp_ge_u32 s85, 2
    s_cbranch_scc1 L_nobc
    v_lshlrev_b32 v1, 6, v0
    s_lshl_b32 s96, s85, 14
    s_getpc_b64 s[4:5]
L_pc_88:
    s_add_u32 s4, s4, L_bulk2-L_pc_88
    s_addc_u32 s5, s5, 0
    v_add_u32 v1, s96, v1
    v_min_u32 v1, L_code_end-L_bulk2-4, v1
    global_load_dword v255, v1, s[4:5]
L_nobc:
    s_waitcnt lgkmcnt(0)
    s_and_b32 s9, s9, 0xffff
    s_mov_b32 s10, 0x10000000
    s_mov_b32 s11, 0x20000
    s_and_b32 s93, s93, 0xffff
    s_mov_b32 s94, 0x100
    s_mov_b32 s95, 0x20000
    s_mov_b32 s87, 0
    s_cmp_lg_u32 s86, 0
    s_cbranch_scc1 L_reg_89
    s_lshl_b32 s97, s84, 4
    s_lshl_b32 s96, 1, s85
    v_mov_b32 v250, s96
    v_mov_b32 v251, 256
    s_mov_b64 exec, 1
    buffer_atomic_add_x2 v[250:251], off, s[92:95], s97 offset:64
    s_mov_b64 exec, -1
    s_mov_b32 s86, 1
L_reg_89:
L_bulk2:
    s_add_u32 s88, s101, 32
    s_mov_b32 s41, 0
    s_lshr_b32 s20, s101, 6
    s_and_b32 s22, s101, 63
    s_cmp_ge_u32 s101, 192
    s_cselect_b32 s37, 32, 1000
L_p1go:
    s_mov_b32 s40, 0
    s_mov_b32 s80, 0
    s_mov_b32 s23, 0
L_p1_pass:
    v_mbcnt_lo_u32_b32 v0, -1, 0
    v_mbcnt_hi_u32_b32 v0, -1, v0
    s_lshl_b32 s96, s100, 6
    v_add_u32 v0, s96, v0
    s_and_b32 s13, s13, 0xffff
    s_mov_b32 s14, 0x200000
    s_mov_b32 s15, 0x20000
    v_lshrrev_b32 v147, 6, v0
    s_nop 0
    v_readfirstlane_b32 s21, v147
    v_and_b32 v144, 63, v0
    v_lshrrev_b32 v145, 4, v144
    v_and_b32 v146, 15, v144
    v_lshrrev_b32 v149, 2, v146
    v_lshlrev_b32 v137, 4, v144
    s_lshl_b32 s29, s21, 10
    s_lshl_b32 s26, s20, 7
    s_lshl_b32 s27, s21, 5
    s_add_u32 s26, s26, s27
    v_add_u32 v147, s26, v146
    v_lshlrev_b32 v147, 10, v147
    v_lshl_add_u32 v139, v145, 4, v147
    s_mov_b32 s26, 0x0
    buffer_load_dwordx4 v[0:3], v139, s[12:15], s26 offen
    buffer_load_dwordx4 v[4:7], v139, s[12:15], s26 offen offset:64
    buffer_load_dwordx4 v[8:11], v139, s[12:15], s26 offen offset:128
    buffer_load_dwordx4 v[12:15], v139, s[12:15], s26 offen offset:192
    buffer_load_dwordx4 v[16:19], v139, s[12:15], s26 offen offset:256
    buffer_load_dwordx4 v[20:23], v139, s[12:15], s26 offen offset:320
    buffer_load_dwordx4 v[24:27], v139, s[12:15], s26 offen offset:384
    buffer_load_dwordx4 v[28:31], v139, s[12:15], s26 offen offset:448
    buffer_load_dwordx4 v[32:35], v139, s[12:15], s26 offen offset:512
    buffer_load_dwordx4 v[36:39], v139, s[12:15], s26 offen offset:576
    buffer_load_dwordx4 v[40:43], v139, s[12:15], s26 offen offset:640
    buffer_load_dwordx4 v[44:47], v139, s[12:15], s26 offen offset:704
    buffer_load_dwordx4 v[48:51], v139, s[12:15], s26 offen offset:768
    buffer_load_dwordx4 v[52:55], v139, s[12:15], s26 offen offset:832
    buffer_load_dwordx4 v[56:59], v139, s[12:15], s26 offen offset:896
    buffer_load_dwordx4 v[60:63], v139, s[12:15], s26 offen offset:960
    s_mov_b32 s26, 0x4000
    buffer_load_dwordx4 v[64:67], v139, s[12:15], s26 offen
    buffer_load_dwordx4 v[68:71], v139, s[12:15], s26 offen offset:64
    buffer_load_dwordx4 v[72:75], v139, s[12:15], s26 offen offset:128
    buffer_load_dwordx4 v[76:79], v139, s[12:15], s26 offen offset:192
    buffer_load_dwordx4 v[80:83], v139, s[12:15], s26 offen offset:256
    buffer_load_dwordx4 v[84:87], v139, s[12:15], s26 offen offset:320
    buffer_load_dwordx4 v[88:91], v139, s[12:15], s26 offen offset:384
    buffer_load_dwordx4 v[92:95], v139, s[12:15], s26 offen offset:448
    buffer_load_dwordx4 v[96:99], v139, s[12:15], s26 offen offset:512
    buffer_load_dwordx4 v[100:103], v139, s[12:15], s26 offen offset:576
    buffer_load_dwordx4 v[104:107], v139, s[12:15], s26 offen offset:640
    buffer_load_dwordx4 v[108:111], v139, s[12:15], s26 offen offset:704
    buffer_load_dwordx4 v[112:115], v139, s[12:15], s26 offen offset:768
    buffer_load_dwordx4 v[116:119], v139, s[12:15], s26 offen offset:832
    buffer_load_dwordx4 v[120:123], v139, s[12:15], s26 offen offset:896
    buffer_load_dwordx4 v[124:127], v139, s[12:15], s26 offen offset:960
    s_lshr_b32 s26, s21, 1
    s_lshl_b32 s26, s26, 2
    v_or_b32 v148, s26, v145
    v_lshlrev_b32 v148, 1, v148
    v_xor_b32 v148, v148, v146
    v_lshlrev_b32 v148, 4, v148
    s_lshl_b32 s26, s21, 2
    v_add_u32 v147, s26, v145
    v_lshl_add_u32 v136, v147, 13, v148
    v_lshl_add_u32 v147, v145, 3, v149
    v_lshlrev_b32 v147, 8, v147
    v_and_b32 v148, 1, v145
    v_lshl_or_b32 v148, v148, 2, v149
    v_lshl_add_u32 v147, v148, 5, v147
    v_and_b32 v148, 3, v146
    v_lshl_add_u32 v128, v148, 3, v147
    v_xor_b32 v129, 32, v128
    v_xor_b32 v130, 64, v128
    v_xor_b32 v131, 96, v128
    v_xor_b32 v132, 128, v128
    v_xor_b32 v133, 160, v128
    v_xor_b32 v134, 192, v128
    v_xor_b32 v135, 224, v128
    s_mov_b32 s19, 0x20000
    s_mov_b32 s38, s22
    s_mov_b32 s39, s22
    v_mov_b32 v158, 0x3f803f80
    s_lshr_b32 s26, s39, 5
    s_cmp_eq_u32 s26, 0
    s_cselect_b64 s[16:17], s[62:63], s[60:61]
    s_cmp_eq_u32 s26, 1
    s_cselect_b64 s[16:17], s[64:65], s[16:17]
    s_and_b32 s17, s17, 0xffff
    s_cmp_lt_u32 s39, 96
    s_cselect_b32 s18, 0x400000, 0
    s_and_b32 s24, s39, 31
    s_lshl_b32 s24, s24, 8
    s_waitcnt vmcnt(16)
    v_pk_mov_b32 v[150:151], 0, 0
    v_pk_mov_b32 v[152:153], 0, 0
    v_dot2_f32_bf16 v150, v0, v158, v150
    v_dot2_f32_bf16 v152, v0, v0, v152
    v_dot2_f32_bf16 v151, v1, v158, v151
    v_dot2_f32_bf16 v153, v1, v1, v153
    v_dot2_f32_bf16 v150, v2, v158, v150
    v_dot2_f32_bf16 v152, v2, v2, v152
    v_dot2_f32_bf16 v151, v3, v158, v151
    v_dot2_f32_bf16 v153, v3, v3, v153
    v_dot2_f32_bf16 v150, v4, v158, v150
    v_dot2_f32_bf16 v152, v4, v4, v152
    v_dot2_f32_bf16 v151, v5, v158, v151
    v_dot2_f32_bf16 v153, v5, v5, v153
    v_dot2_f32_bf16 v150, v6, v158, v150
    v_dot2_f32_bf16 v152, v6, v6, v152
    v_dot2_f32_bf16 v151, v7, v158, v151
    v_dot2_f32_bf16 v153, v7, v7, v153
    v_dot2_f32_bf16 v150, v8, v158, v150
    v_dot2_f32_bf16 v152, v8, v8, v152
    v_dot2_f32_bf16 v151, v9, v158, v151
    v_dot2_f32_bf16 v153, v9, v9, v153
    v_dot2_f32_bf16 v150, v10, v158, v150
    v_dot2_f32_bf16 v152, v10, v10, v152
    v_dot2_f32_bf16 v151, v11, v158, v151
    v_dot2_f32_bf16 v153, v11, v11, v153
    v_dot2_f32_bf16 v150, v12, v158, v150
    v_dot2_f32_bf16 v152, v12, v12, v152
    v_dot2_f32_bf16 v151, v13, v158, v151
    v_dot2_f32_bf16 v153, v13, v13, v153
    v_dot2_f32_bf16 v150, v14, v158, v150
    v_dot2_f32_bf16 v152, v14, v14, v152
    v_dot2_f32_bf16 v151, v15, v158, v151
    v_dot2_f32_bf16 v153, v15, v15, v153
    v_dot2_f32_bf16 v150, v16, v158, v150
    v_dot2_f32_bf16 v152, v16, v16, v152
    v_dot2_f32_bf16 v151, v17, v158, v151
    v_dot2_f32_bf16 v153, v17, v17, v153
    v_dot2_f32_bf16 v150, v18, v158, v150
    v_dot2_f32_bf16 v152, v18, v18, v152
    v_dot2_f32_bf16 v151, v19, v158, v151
    v_dot2_f32_bf16 v153, v19, v19, v153
    v_dot2_f32_bf16 v150, v20, v158, v150
    v_dot2_f32_bf16 v152, v20, v20, v152
    v_dot2_f32_bf16 v151, v21, v158, v151
    v_dot2_f32_bf16 v153, v21, v21, v153
    v_dot2_f32_bf16 v150, v22, v158, v150
    v_dot2_f32_bf16 v152, v22, v22, v152
    v_dot2_f32_bf16 v151, v23, v158, v151
    v_dot2_f32_bf16 v153, v23, v23, v153
    v_dot2_f32_bf16 v150, v24, v158, v150
    v_dot2_f32_bf16 v152, v24, v24, v152
    v_dot2_f32_bf16 v151, v25, v158, v151
    v_dot2_f32_bf16 v153, v25, v25, v153
    v_dot2_f32_bf16 v150, v26, v158, v150
    v_dot2_f32_bf16 v152, v26, v26, v152
    v_dot2_f32_bf16 v151, v27, v158, v151
    v_dot2_f32_bf16 v153, v27, v27, v153
    v_dot2_f32_bf16 v150, v28, v158, v150
    v_dot2_f32_bf16 v152, v28, v28, v152
    v_dot2_f32_bf16 v151, v29, v158, v151
    v_dot2_f32_bf16 v153, v29, v29, v153
    v_dot2_f32_bf16 v150, v30, v158, v150
    v_dot2_f32_bf16 v152, v30, v30, v152
    v_dot2_f32_bf16 v151, v31, v158, v151
    v_dot2_f32_bf16 v153, v31, v31, v153
    v_dot2_f32_bf16 v150, v32, v158, v150
    v_dot2_f32_bf16 v152, v32, v32, v152
    v_dot2_f32_bf16 v151, v33, v158, v151
    v_dot2_f32_bf16 v153, v33, v33, v153
    v_dot2_f32_bf16 v150, v34, v158, v150
    v_dot2_f32_bf16 v152, v34, v34, v152
    v_dot2_f32_bf16 v151, v35, v158, v151
    v_dot2_f32_bf16 v153, v35, v35, v153
    v_dot2_f32_bf16 v150, v36, v158, v150
    v_dot2_f32_bf16 v152, v36, v36, v152
    v_dot2_f32_bf16 v151, v37, v158, v151
    v_dot2_f32_bf16 v153, v37, v37, v153
    v_dot2_f32_bf16 v150, v38, v158, v150
    v_dot2_f32_bf16 v152, v38, v38, v152
    v_dot2_f32_bf16 v151, v39, v158, v151
    v_dot2_f32_bf16 v153, v39, v39, v153
    v_dot2_f32_bf16 v150, v40, v158, v150
    v_dot2_f32_bf16 v152, v40, v40, v152
    v_dot2_f32_bf16 v151, v41, v158, v151
    v_dot2_f32_bf16 v153, v41, v41, v153
    v_dot2_f32_bf16 v150, v42, v158, v150
    v_dot2_f32_bf16 v152, v42, v42, v152
    v_dot2_f32_bf16 v151, v43, v158, v151
    v_dot2_f32_bf16 v153, v43, v43, v153
    v_dot2_f32_bf16 v150, v44, v158, v150
    v_dot2_f32_bf16 v152, v44, v44, v152
    v_dot2_f32_bf16 v151, v45, v158, v151
    v_dot2_f32_bf16 v153, v45, v45, v153
    v_dot2_f32_bf16 v150, v46, v158, v150
    v_dot2_f32_bf16 v152, v46, v46, v152
    v_dot2_f32_bf16 v151, v47, v158, v151
    v_dot2_f32_bf16 v153, v47, v47, v153
    v_dot2_f32_bf16 v150, v48, v158, v150
    v_dot2_f32_bf16 v152, v48, v48, v152
    v_dot2_f32_bf16 v151, v49, v158, v151
    v_dot2_f32_bf16 v153, v49, v49, v153
    s_add_u32 s26, s24, 0x0
    s_add_u32 m0, s29, 0x0
    s_nop 0
    buffer_load_dwordx4 v136, s[16:19], s26 offen lds
    v_dot2_f32_bf16 v150, v50, v158, v150
    v_dot2_f32_bf16 v152, v50, v50, v152
    v_dot2_f32_bf16 v151, v51, v158, v151
    v_dot2_f32_bf16 v153, v51, v51, v153
    v_dot2_f32_bf16 v150, v52, v158, v150
    v_dot2_f32_bf16 v152, v52, v52, v152
    v_dot2_f32_bf16 v151, v53, v158, v151
    v_dot2_f32_bf16 v153, v53, v53, v153
    v_dot2_f32_bf16 v150, v54, v158, v150
    v_dot2_f32_bf16 v152, v54, v54, v152
    v_dot2_f32_bf16 v151, v55, v158, v151
    v_dot2_f32_bf16 v153, v55, v55, v153
    v_dot2_f32_bf16 v150, v56, v158, v150
    v_dot2_f32_bf16 v152, v56, v56, v152
    v_dot2_f32_bf16 v151, v57, v158, v151
    v_dot2_f32_bf16 v153, v57, v57, v153
    v_dot2_f32_bf16 v150, v58, v158, v150
    v_dot2_f32_bf16 v152, v58, v58, v152
    v_dot2_f32_bf16 v151, v59, v158, v151
    v_dot2_f32_bf16 v153, v59, v59, v153
    v_dot2_f32_bf16 v150, v60, v158, v150
    v_dot2_f32_bf16 v152, v60, v60, v152
    v_dot2_f32_bf16 v151, v61, v158, v151
    v_dot2_f32_bf16 v153, v61, v61, v153
    v_dot2_f32_bf16 v150, v62, v158, v150
    v_dot2_f32_bf16 v152, v62, v62, v152
    v_dot2_f32_bf16 v151, v63, v158, v151
    v_dot2_f32_bf16 v153, v63, v63, v153
    s_nop 1
    v_add_f32 v150, v150, v151
    v_add_f32 v152, v152, v153
    v_mov_b32 v157, v150
    s_nop 1
    v_permlane32_swap_b32 v157, v150
    v_add_f32 v150, v157, v150
    v_mov_b32 v157, v150
    s_nop 1
    v_permlane16_swap_b32 v157, v150
    v_add_f32 v150, v157, v150
    v_mov_b32 v157, v152
    s_nop 1
    v_permlane32_swap_b32 v157, v152
    v_add_f32 v152, v157, v152
    v_mov_b32 v157, v152
    s_nop 1
    v_permlane16_swap_b32 v157, v152
    v_add_f32 v152, v157, v152
    v_mul_f32 v150, 0x3b000000, v150
    v_cvt_pk_bf16_f32 v154, v150, v150
    v_and_b32 v154, 0xffff0000, v154
    v_sub_f32 v156, v150, v154
    v_mul_f32 v157, v150, v150
    v_mul_f32 v152, 0x3b000000, v152
    v_sub_f32 v152, v152, v157
    v_max_f32 v152, 0, v152
    v_cvt_pk_bf16_f32 v152, v152, v152
    v_and_b32 v152, 0xffff0000, v152
    v_add_f32 v152, 0x3727c5ac, v152
    v_cvt_pk_bf16_f32 v152, v152, v152
    v_and_b32 v152, 0xffff0000, v152
    v_sqrt_f32 v152, v152
    s_nop 0
    v_cvt_pk_bf16_f32 v152, v152, v152
    v_and_b32 v152, 0xffff0000, v152
    v_rcp_f32 v152, v152
    v_lshlrev_b32 v160, 16, v0
    v_and_b32 v161, 0xffff0000, v0
    v_lshlrev_b32 v162, 16, v1
    v_and_b32 v163, 0xffff0000, v1
    v_lshlrev_b32 v164, 16, v2
    v_and_b32 v165, 0xffff0000, v2
    v_lshlrev_b32 v166, 16, v3
    v_and_b32 v167, 0xffff0000, v3
    v_lshlrev_b32 v168, 16, v4
    v_and_b32 v169, 0xffff0000, v4
    v_lshlrev_b32 v170, 16, v5
    v_and_b32 v171, 0xffff0000, v5
    v_lshlrev_b32 v172, 16, v6
    v_and_b32 v173, 0xffff0000, v6
    v_lshlrev_b32 v174, 16, v7
    v_and_b32 v175, 0xffff0000, v7
    v_pk_add_f32 v[160:161], v[160:161], v[154:155] op_sel_hi:[1,0] neg_lo:[0,1] neg_hi:[0,1]
    v_pk_add_f32 v[162:163], v[162:163], v[154:155] op_sel_hi:[1,0] neg_lo:[0,1] neg_hi:[0,1]
    v_pk_add_f32 v[164:165], v[164:165], v[154:155] op_sel_hi:[1,0] neg_lo:[0,1] neg_hi:[0,1]
    v_pk_add_f32 v[166:167], v[166:167], v[154:155] op_sel_hi:[1,0] neg_lo:[0,1] neg_hi:[0,1]
    v_pk_add_f32 v[168:169], v[168:169], v[154:155] op_sel_hi:[1,0] neg_lo:[0,1] neg_hi:[0,1]
    v_pk_add_f32 v[170:171], v[170:171], v[154:155] op_sel_hi:[1,0] neg_lo:[0,1] neg_hi:[0,1]
    s_add_u32 s26, s24, 0x20000
    s_add_u32 m0, s29, 0x1000
    s_nop 0
    buffer_load_dwordx4 v136, s[16:19], s26 offen lds
    v_pk_add_f32 v[172:173], v[172:173], v[154:155] op_sel_hi:[1,0] neg_lo:[0,1] neg_hi:[0,1]
    v_pk_add_f32 v[174:175], v[174:175], v[154:155] op_sel_hi:[1,0] neg_lo:[0,1] neg_hi:[0,1]
    v_cvt_pk_bf16_f32 v0, v160, v161
    v_cvt_pk_bf16_f32 v1, v162, v163
    v_cvt_pk_bf16_f32 v2, v164, v165
    v_cvt_pk_bf16_f32 v3, v166, v167
    v_cvt_pk_bf16_f32 v4, v168, v169
    v_cvt_pk_bf16_f32 v5, v170, v171
    v_cvt_pk_bf16_f32 v6, v172, v173
    v_cvt_pk_bf16_f32 v7, v174, v175
    v_lshlrev_b32 v160, 16, v0
    v_and_b32 v161, 0xffff0000, v0
    v_lshlrev_b32 v162, 16, v1
    v_and_b32 v163, 0xffff0000, v1
    v_lshlrev_b32 v164, 16, v2
    v_and_b32 v165, 0xffff0000, v2
    v_lshlrev_b32 v166, 16, v3
    v_and_b32 v167, 0xffff0000, v3
    v_lshlrev_b32 v168, 16, v4
    v_and_b32 v169, 0xffff0000, v4
    v_lshlrev_b32 v170, 16, v5
    v_and_b32 v171, 0xffff0000, v5
    v_lshlrev_b32 v172, 16, v6
    v_and_b32 v173, 0xffff0000, v6
    v_lshlrev_b32 v174, 16, v7
    v_and_b32 v175, 0xffff0000, v7
    v_pk_mul_f32 v[160:161], v[160:161], v[152:153] op_sel_hi:[1,0]
    v_pk_mul_f32 v[162:163], v[162:163], v[152:153] op_sel_hi:[1,0]
    v_pk_mul_f32 v[164:165], v[164:165], v[152:153] op_sel_hi:[1,0]
    v_pk_mul_f32 v[166:167], v[166:167], v[152:153] op_sel_hi:[1,0]
    v_pk_mul_f32 v[168:169], v[168:169], v[152:153] op_sel_hi:[1,0]
    v_pk_mul_f32 v[170:171], v[170:171], v[152:153] op_sel_hi:[1,0]
    v_pk_mul_f32 v[172:173], v[172:173], v[152:153] op_sel_hi:[1,0]
    v_pk_mul_f32 v[174:175], v[174:175], v[152:153] op_sel_hi:[1,0]
    v_cvt_pk_bf16_f32 v160, v160, v161
    v_cvt_pk_bf16_f32 v162, v162, v163
    v_cvt_pk_bf16_f32 v164, v164, v165
    v_cvt_pk_bf16_f32 v166, v166, v167
    v_cvt_pk_bf16_f32 v168, v168, v169
    v_cvt_pk_bf16_f32 v170, v170, v171
    v_cvt_pk_bf16_f32 v172, v172, v173
    v_cvt_pk_bf16_f32 v174, v174, v175
    v_accvgpr_write_b32 a0, v160
    v_accvgpr_write_b32 a1, v162
    v_accvgpr_write_b32 a2, v164
    v_accvgpr_write_b32 a3, v166
    v_accvgpr_write_b32 a4, v168
    v_accvgpr_write_b32 a5, v170
    v_accvgpr_write_b32 a6, v172
    v_accvgpr_write_b32 a7, v174
    s_add_u32 s26, s24, 0x40000
    s_add_u32 m0, s29, 0x2000
    s_nop 0
    buffer_load_dwordx4 v136, s[16:19], s26 offen lds
    v_lshlrev_b32 v160, 16, v8
    v_and_b32 v161, 0xffff0000, v8
    v_lshlrev_b32 v162, 16, v9
    v_and_b32 v163, 0xffff0000, v9
    v_lshlrev_b32 v164, 16, v10
    v_and_b32 v165, 0xffff0000, v10
    v_lshlrev_b32 v166, 16, v11
    v_and_b32 v167, 0xffff0000, v11
    v_lshlrev_b32 v168, 16, v12
    v_and_b32 v169, 0xffff0000, v12
    v_lshlrev_b32 v170, 16, v13
    v_and_b32 v171, 0xffff0000, v13
    v_lshlrev_b32 v172, 16, v14
    v_and_b32 v173, 0xffff0000, v14
    v_lshlrev_b32 v174, 16, v15
    v_and_b32 v175, 0xffff0000, v15
    v_pk_add_f32 v[160:161], v[160:161], v[154:155] op_sel_hi:[1,0] neg_lo:[0,1] neg_hi:[0,1]
    v_pk_add_f32 v[162:163], v[162:163], v[154:155] op_sel_hi:[1,0] neg_lo:[0,1] neg_hi:[0,1]
    v_pk_add_f32 v[164:165], v[164:165], v[154:155] op_sel_hi:[1,0] neg_lo:[0,1] neg_hi:[0,1]
    v_pk_add_f32 v[166:167], v[166:167], v[154:155] op_sel_hi:[1,0] neg_lo:[0,1] neg_hi:[0,1]
    v_pk_add_f32 v[168:169], v[168:169], v[154:155] op_sel_hi:[1,0] neg_lo:[0,1] neg_hi:[0,1]
    v_pk_add_f32 v[170:171], v[170:171], v[154:155] op_sel_hi:[1,0] neg_lo:[0,1] neg_hi:[0,1]
    v_pk_add_f32 v[172:173], v[172:173], v[154:155] op_sel_hi:[1,0] neg_lo:[0,1] neg_hi:[0,1]
    v_pk_add_f32 v[174:175], v[174:175], v[154:155] op_sel_hi:[1,0] neg_lo:[0,1] neg_hi:[0,1]
    v_cvt_pk_bf16_f32 v8, v160, v161
    v_cvt_pk_bf16_f32 v9, v162, v163
    v_cvt_pk_bf16_f32 v10, v164, v165
    v_cvt_pk_bf16_f32 v11, v166, v167
    v_cvt_pk_bf16_f32 v12, v168, v169
    v_cvt_pk_bf16_f32 v13, v170, v171
    v_cvt_pk_bf16_f32 v14, v172, v173
    v_cvt_pk_bf16_f32 v15, v174, v175
    v_lshlrev_b32 v160, 16, v8
    v_and_b32 v161, 0xffff0000, v8
    v_lshlrev_b32 v162, 16, v9
    v_and_b32 v163, 0xffff0000, v9
    v_lshlrev_b32 v164, 16, v10
    v_and_b32 v165, 0xffff0000, v10
    v_lshlrev_b32 v166, 16, v11
    v_and_b32 v167, 0xffff0000, v11
    v_lshlrev_b32 v168, 16, v12
    v_and_b32 v169, 0xffff0000, v12
    v_lshlrev_b32 v170, 16, v13
    v_and_b32 v171, 0xffff0000, v13
    v_lshlrev_b32 v172, 16, v14
    v_and_b32 v173, 0xffff0000, v14
    v_lshlrev_b32 v174, 16, v15
    v_and_b32 v175, 0xffff0000, v15
    v_pk_mul_f32 v[160:161], v[160:161], v[152:153] op_sel_hi:[1,0]
    v_pk_mul_f32 v[162:163], v[162:163], v[152:153] op_sel_hi:[1,0]
    s_add_u32 s26, s24, 0x60000
    s_add_u32 m0, s29, 0x3000
    s_nop 0
    buffer_load_dwordx4 v136, s[16:19], s26 offen lds
    v_pk_mul_f32 v[164:165], v[164:165], v[152:153] op_sel_hi:[1,0]
    v_pk_mul_f32 v[166:167], v[166:167], v[152:153] op_sel_hi:[1,0]
    v_pk_mul_f32 v[168:169], v[168:169], v[152:153] op_sel_hi:[1,0]
    v_pk_mul_f32 v[170:171], v[170:171], v[152:153] op_sel_hi:[1,0]
    v_pk_mul_f32 v[172:173], v[172:173], v[152:153] op_sel_hi:[1,0]
    v_pk_mul_f32 v[174:175], v[174:175], v[152:153] op_sel_hi:[1,0]
    v_cvt_pk_bf16_f32 v160, v160, v161
    v_cvt_pk_bf16_f32 v162, v162, v163
    v_cvt_pk_bf16_f32 v164, v164, v165
    v_cvt_pk_bf16_f32 v166, v166, v167
    v_cvt_pk_bf16_f32 v168, v168, v169
    v_cvt_pk_bf16_f32 v170, v170, v171
    v_cvt_pk_bf16_f32 v172, v172, v173
    v_cvt_pk_bf16_f32 v174, v174, v175
    v_accvgpr_write_b32 a8, v160
    v_accvgpr_write_b32 a9, v162
    v_accvgpr_write_b32 a10, v164
    v_accvgpr_write_b32 a11, v166
    v_accvgpr_write_b32 a12, v168
    v_accvgpr_write_b32 a13, v170
    v_accvgpr_write_b32 a14, v172
    v_accvgpr_write_b32 a15, v174
    v_lshlrev_b32 v160, 16, v16
    v_and_b32 v161, 0xffff0000, v16
    v_lshlrev_b32 v162, 16, v17
    v_and_b32 v163, 0xffff0000, v17
    v_lshlrev_b32 v164, 16, v18
    v_and_b32 v165, 0xffff0000, v18
    v_lshlrev_b32 v166, 16, v19
    v_and_b32 v167, 0xffff0000, v19
    v_lshlrev_b32 v168, 16, v20
    v_and_b32 v169, 0xffff0000, v20
    v_lshlrev_b32 v170, 16, v21
    v_and_b32 v171, 0xffff0000, v21
    v_lshlrev_b32 v172, 16, v22
    v_and_b32 v173, 0xffff0000, v22
    v_lshlrev_b32 v174, 16, v23
    v_and_b32 v175, 0xffff0000, v23
    v_pk_add_f32 v[160:161], v[160:161], v[154:155] op_sel_hi:[1,0] neg_lo:[0,1] neg_hi:[0,1]
    v_pk_add_f32 v[162:163], v[162:163], v[154:155] op_sel_hi:[1,0] neg_lo:[0,1] neg_hi:[0,1]
    v_pk_add_f32 v[164:165], v[164:165], v[154:155] op_sel_hi:[1,0] neg_lo:[0,1] neg_hi:[0,1]
    v_pk_add_f32 v[166:167], v[166:167], v[154:155] op_sel_hi:[1,0] neg_lo:[0,1] neg_hi:[0,1]
    v_pk_add_f32 v[168:169], v[168:169], v[154:155] op_sel_hi:[1,0] neg_lo:[0,1] neg_hi:[0,1]
    v_pk_add_f32 v[170:171], v[170:171], v[154:155] op_sel_hi:[1,0] neg_lo:[0,1] neg_hi:[0,1]
    v_pk_add_f32 v[172:173], v[172:173], v[154:155] op_sel_hi:[1,0] neg_lo:[0,1] neg_hi:[0,1]
    v_pk_add_f32 v[174:175], v[174:175], v[154:155] op_sel_hi:[1,0] neg_lo:[0,1] neg_hi:[0,1]
    v_cvt_pk_bf16_f32 v16, v160, v161
    v_cvt_pk_bf16_f32 v17, v162, v163
    v_cvt_pk_bf16_f32 v18, v164, v165
    v_cvt_pk_bf16_f32 v19, v166, v167
    s_add_u32 s26, s24, 0x80000
    s_add_u32 m0, s29, 0x4000
    s_nop 0
    buffer_load_dwordx4 v136, s[16:19], s26 offen lds
    v_cvt_pk_bf16_f32 v20, v168, v169
    v_cvt_pk_bf16_f32 v21, v170, v171
    v_cvt_pk_bf16_f32 v22, v172, v173
    v_cvt_pk_bf16_f32 v23, v174, v175
    v_lshlrev_b32 v160, 16, v16
    v_and_b32 v161, 0xffff0000, v16
    v_lshlrev_b32 v162, 16, v17
    v_and_b32 v163, 0xffff0000, v17
    v_lshlrev_b32 v164, 16, v18
    v_and_b32 v165, 0xffff0000, v18
    v_lshlrev_b32 v166, 16, v19
    v_and_b32 v167, 0xffff0000, v19
    v_lshlrev_b32 v168, 16, v20
    v_and_b32 v169, 0xffff0000, v20
    v_lshlrev_b32 v170, 16, v21
    v_and_b32 v171, 0xffff0000, v21
    v_lshlrev_b32 v172, 16, v22
    v_and_b32 v173, 0xffff0000, v22
    v_lshlrev_b32 v174, 16, v23
    v_and_b32 v175, 0xffff0000, v23
    v_pk_mul_f32 v[160:161], v[160:161], v[152:153] op_sel_hi:[1,0]
    v_pk_mul_f32 v[162:163], v[162:163], v[152:153] op_sel_hi:[1,0]
    v_pk_mul_f32 v[164:165], v[164:165], v[152:153] op_sel_hi:[1,0]
    v_pk_mul_f32 v[166:167], v[166:167], v[152:153] op_sel_hi:[1,0]
    v_pk_mul_f32 v[168:169], v[168:169], v[152:153] op_sel_hi:[1,0]
    v_pk_mul_f32 v[170:171], v[170:171], v[152:153] op_sel_hi:[1,0]
    v_pk_mul_f32 v[172:173], v[172:173], v[152:153] op_sel_hi:[1,0]
    v_pk_mul_f32 v[174:175], v[174:175], v[152:153] op_sel_hi:[1,0]
    v_cvt_pk_bf16_f32 v160, v160, v161
    v_cvt_pk_bf16_f32 v162, v162, v163
    v_cvt_pk_bf16_f32 v164, v164, v165
    v_cvt_pk_bf16_f32 v166, v166, v167
    v_cvt_pk_bf16_f32 v168, v168, v169
    v_cvt_pk_bf16_f32 v170, v170, v171
    v_cvt_pk_bf16_f32 v172, v172, v173
    v_cvt_pk_bf16_f32 v174, v174, v175
    v_accvgpr_write_b32 a16, v160
    v_accvgpr_write_b32 a17, v162
    v_accvgpr_write_b32 a18, v164
    v_accvgpr_write_b32 a19, v166
    v_accvgpr_write_b32 a20, v168
    v_accvgpr_write_b32 a21, v170
    v_accvgpr_write_b32 a22, v172
    v_accvgpr_write_b32 a23, v174
    v_lshlrev_b32 v160, 16, v24
    v_and_b32 v161, 0xffff0000, v24
    v_lshlrev_b32 v162, 16, v25
    v_and_b32 v163, 0xffff0000, v25
    v_lshlrev_b32 v164, 16, v26
    v_and_b32 v165, 0xffff0000, v26
    s_add_u32 s26, s24, 0xa0000
    s_add_u32 m0, s29, 0x5000
    s_nop 0
    buffer_load_dwordx4 v136, s[16:19], s26 offen lds
    v_lshlrev_b32 v166, 16, v27
    v_and_b32 v167, 0xffff0000, v27
    v_lshlrev_b32 v168, 16, v28
    v_and_b32 v169, 0xffff0000, v28
    v_lshlrev_b32 v170, 16, v29
    v_and_b32 v171, 0xffff0000, v29
    v_lshlrev_b32 v172, 16, v30
    v_and_b32 v173, 0xffff0000, v30
    v_lshlrev_b32 v174, 16, v31
    v_and_b32 v175, 0xffff0000, v31
    v_pk_add_f32 v[160:161], v[160:161], v[154:155] op_sel_hi:[1,0] neg_lo:[0,1] neg_hi:[0,1]
    v_pk_add_f32 v[162:163], v[162:163], v[154:155] op_sel_hi:[1,0] neg_lo:[0,1] neg_hi:[0,1]
    v_pk_add_f32 v[164:165], v[164:165], v[154:155] op_sel_hi:[1,0] neg_lo:[0,1] neg_hi:[0,1]
    v_pk_add_f32 v[166:167], v[166:167], v[154:155] op_sel_hi:[1,0] neg_lo:[0,1] neg_hi:[0,1]
    v_pk_add_f32 v[168:169], v[168:169], v[154:155] op_sel_hi:[1,0] neg_lo:[0,1] neg_hi:[0,1]
    v_pk_add_f32 v[170:171], v[170:171], v[154:155] op_sel_hi:[1,0] neg_lo:[0,1] neg_hi:[0,1]
    v_pk_add_f32 v[172:173], v[172:173], v[154:155] op_sel_hi:[1,0] neg_lo:[0,1] neg_hi:[0,1]
    v_pk_add_f32 v[174:175], v[174:175], v[154:155] op_sel_hi:[1,0] neg_lo:[0,1] neg_hi:[0,1]
    v_cvt_pk_bf16_f32 v24, v160, v161
    v_cvt_pk_bf16_f32 v25, v162, v163
    v_cvt_pk_bf16_f32 v26, v164, v165
    v_cvt_pk_bf16_f32 v27, v166, v167
    v_cvt_pk_bf16_f32 v28, v168, v169
    v_cvt_pk_bf16_f32 v29, v170, v171
    v_cvt_pk_bf16_f32 v30, v172, v173
    v_cvt_pk_bf16_f32 v31, v174, v175
    v_lshlrev_b32 v160, 16, v24
    v_and_b32 v161, 0xffff0000, v24
    v_lshlrev_b32 v162, 16, v25
    v_and_b32 v163, 0xffff0000, v25
    v_lshlrev_b32 v164, 16, v26
    v_and_b32 v165, 0xffff0000, v26
    v_lshlrev_b32 v166, 16, v27
    v_and_b32 v167, 0xffff0000, v27
    v_lshlrev_b32 v168, 16, v28
    v_and_b32 v169, 0xffff0000, v28
    v_lshlrev_b32 v170, 16, v29
    v_and_b32 v171, 0xffff0000, v29
    v_lshlrev_b32 v172, 16, v30
    v_and_b32 v173, 0xffff0000, v30
    v_lshlrev_b32 v174, 16, v31
    v_and_b32 v175, 0xffff0000, v31
    v_pk_mul_f32 v[160:161], v[160:161], v[152:153] op_sel_hi:[1,0]
    v_pk_mul_f32 v[162:163], v[162:163], v[152:153] op_sel_hi:[1,0]
    v_pk_mul_f32 v[164:165], v[164:165], v[152:153] op_sel_hi:[1,0]
    v_pk_mul_f32 v[166:167], v[166:167], v[152:153] op_sel_hi:[1,0]
    v_pk_mul_f32 v[168:169], v[168:169], v[152:153] op_sel_hi:[1,0]
    v_pk_mul_f32 v[170:171], v[170:171], v[152:153] op_sel_hi:[1,0]
    v_pk_mul_f32 v[172:173], v[172:173], v[152:153] op_sel_hi:[1,0]
    v_pk_mul_f32 v[174:175], v[174:175], v[152:153] op_sel_hi:[1,0]
    s_add_u32 s26, s24, 0xc0000
    s_add_u32 m0, s29, 0x6000
    s_nop 0
    buffer_load_dwordx4 v136, s[16:19], s26 offen lds
    v_cvt_pk_bf16_f32 v160, v160, v161
    v_cvt_pk_bf16_f32 v162, v162, v163
    v_cvt_pk_bf16_f32 v164, v164, v165
    v_cvt_pk_bf16_f32 v166, v166, v167
    v_cvt_pk_bf16_f32 v168, v168, v169
    v_cvt_pk_bf16_f32 v170, v170, v171
    v_cvt_pk_bf16_f32 v172, v172, v173
    v_cvt_pk_bf16_f32 v174, v174, v175
    v_accvgpr_write_b32 a24, v160
    v_accvgpr_write_b32 a25, v162
    v_accvgpr_write_b32 a26, v164
    v_accvgpr_write_b32 a27, v166
    v_accvgpr_write_b32 a28, v168
    v_accvgpr_write_b32 a29, v170
    v_accvgpr_write_b32 a30, v172
    v_accvgpr_write_b32 a31, v174
    v_lshlrev_b32 v160, 16, v32
    v_and_b32 v161, 0xffff0000, v32
    v_lshlrev_b32 v162, 16, v33
    v_and_b32 v163, 0xffff0000, v33
    v_lshlrev_b32 v164, 16, v34
    v_and_b32 v165, 0xffff0000, v34
    v_lshlrev_b32 v166, 16, v35
    v_and_b32 v167, 0xffff0000, v35
    v_lshlrev_b32 v168, 16, v36
    v_and_b32 v169, 0xffff0000, v36
    v_lshlrev_b32 v170, 16, v37
    v_and_b32 v171, 0xffff0000, v37
    v_lshlrev_b32 v172, 16, v38
    v_and_b32 v173, 0xffff0000, v38
    v_lshlrev_b32 v174, 16, v39
    v_and_b32 v175, 0xffff0000, v39
    v_pk_add_f32 v[160:161], v[160:161], v[154:155] op_sel_hi:[1,0] neg_lo:[0,1] neg_hi:[0,1]
    v_pk_add_f32 v[162:163], v[162:163], v[154:155] op_sel_hi:[1,0] neg_lo:[0,1] neg_hi:[0,1]
    v_pk_add_f32 v[164:165], v[164:165], v[154:155] op_sel_hi:[1,0] neg_lo:[0,1] neg_hi:[0,1]
    v_pk_add_f32 v[166:167], v[166:167], v[154:155] op_sel_hi:[1,0] neg_lo:[0,1] neg_hi:[0,1]
    v_pk_add_f32 v[168:169], v[168:169], v[154:155] op_sel_hi:[1,0] neg_lo:[0,1] neg_hi:[0,1]
    v_pk_add_f32 v[170:171], v[170:171], v[154:155] op_sel_hi:[1,0] neg_lo:[0,1] neg_hi:[0,1]
    v_pk_add_f32 v[172:173], v[172:173], v[154:155] op_sel_hi:[1,0] neg_lo:[0,1] neg_hi:[0,1]
    v_pk_add_f32 v[174:175], v[174:175], v[154:155] op_sel_hi:[1,0] neg_lo:[0,1] neg_hi:[0,1]
    v_cvt_pk_bf16_f32 v32, v160, v161
    v_cvt_pk_bf16_f32 v33, v162, v163
    v_cvt_pk_bf16_f32 v34, v164, v165
    v_cvt_pk_bf16_f32 v35, v166, v167
    v_cvt_pk_bf16_f32 v36, v168, v169
    v_cvt_pk_bf16_f32 v37, v170, v171
    v_cvt_pk_bf16_f32 v38, v172, v173
    v_cvt_pk_bf16_f32 v39, v174, v175
    v_lshlrev_b32 v160, 16, v32
    v_and_b32 v161, 0xffff0000, v32
    s_add_u32 s26, s24, 0xe0000
    s_add_u32 m0, s29, 0x7000
    s_nop 0
    buffer_load_dwordx4 v136, s[16:19], s26 offen lds
    v_lshlrev_b32 v162, 16, v33
    v_and_b32 v163, 0xffff0000, v33
    v_lshlrev_b32 v164, 16, v34
    v_and_b32 v165, 0xffff0000, v34
    v_lshlrev_b32 v166, 16, v35
    v_and_b32 v167, 0xffff0000, v35
    v_lshlrev_b32 v168, 16, v36
    v_and_b32 v169, 0xffff0000, v36
    v_lshlrev_b32 v170, 16, v37
    v_and_b32 v171, 0xffff0000, v37
    v_lshlrev_b32 v172, 16, v38
    v_and_b32 v173, 0xffff0000, v38
    v_lshlrev_b32 v174, 16, v39
    v_and_b32 v175, 0xffff0000, v39
    v_pk_mul_f32 v[160:161], v[160:161], v[152:153] op_sel_hi:[1,0]
    v_pk_mul_f32 v[162:163], v[162:163], v[152:153] op_sel_hi:[1,0]
    v_pk_mul_f32 v[164:165], v[164:165], v[152:153] op_sel_hi:[1,0]
    v_pk_mul_f32 v[166:167], v[166:167], v[152:153] op_sel_hi:[1,0]
    v_pk_mul_f32 v[168:169], v[168:169], v[152:153] op_sel_hi:[1,0]
    v_pk_mul_f32 v[170:171], v[170:171], v[152:153] op_sel_hi:[1,0]
    v_pk_mul_f32 v[172:173], v[172:173], v[152:153] op_sel_hi:[1,0]
    v_pk_mul_f32 v[174:175], v[174:175], v[152:153] op_sel_hi:[1,0]
    v_cvt_pk_bf16_f32 v160, v160, v161
    v_cvt_pk_bf16_f32 v162, v162, v163
    v_cvt_pk_bf16_f32 v164, v164, v165
    v_cvt_pk_bf16_f32 v166, v166, v167
    v_cvt_pk_bf16_f32 v168, v168, v169
    v_cvt_pk_bf16_f32 v170, v170, v171
    v_cvt_pk_bf16_f32 v172, v172, v173
    v_cvt_pk_bf16_f32 v174, v174, v175
    v_accvgpr_write_b32 a32, v160
    v_accvgpr_write_b32 a33, v162
    v_accvgpr_write_b32 a34, v164
    v_accvgpr_write_b32 a35, v166
    v_accvgpr_write_b32 a36, v168
    v_accvgpr_write_b32 a37, v170
    v_accvgpr_write_b32 a38, v172
    v_accvgpr_write_b32 a39, v174
    v_lshlrev_b32 v160, 16, v40
    v_and_b32 v161, 0xffff0000, v40
    v_lshlrev_b32 v162, 16, v41
    v_and_b32 v163, 0xffff0000, v41
    v_lshlrev_b32 v164, 16, v42
    v_and_b32 v165, 0xffff0000, v42
    v_lshlrev_b32 v166, 16, v43
    v_and_b32 v167, 0xffff0000, v43
    v_lshlrev_b32 v168, 16, v44
    v_and_b32 v169, 0xffff0000, v44
    v_lshlrev_b32 v170, 16, v45
    v_and_b32 v171, 0xffff0000, v45
    s_add_u32 s26, s24, 0x100000
    s_add_u32 m0, s29, 0x8000
    s_nop 0
    buffer_load_dwordx4 v136, s[16:19], s26 offen lds
    v_lshlrev_b32 v172, 16, v46
    v_and_b32 v173, 0xffff0000, v46
    v_lshlrev_b32 v174, 16, v47
    v_and_b32 v175, 0xffff0000, v47
    v_pk_add_f32 v[160:161], v[160:161], v[154:155] op_sel_hi:[1,0] neg_lo:[0,1] neg_hi:[0,1]
    v_pk_add_f32 v[162:163], v[162:163], v[154:155] op_sel_hi:[1,0] neg_lo:[0,1] neg_hi:[0,1]
    v_pk_add_f32 v[164:165], v[164:165], v[154:155] op_sel_hi:[1,0] neg_lo:[0,1] neg_hi:[0,1]
    v_pk_add_f32 v[166:167], v[166:167], v[154:155] op_sel_hi:[1,0] neg_lo:[0,1] neg_hi:[0,1]
    v_pk_add_f32 v[168:169], v[168:169], v[154:155] op_sel_hi:[1,0] neg_lo:[0,1] neg_hi:[0,1]
    v_pk_add_f32 v[170:171], v[170:171], v[154:155] op_sel_hi:[1,0] neg_lo:[0,1] neg_hi:[0,1]
    v_pk_add_f32 v[172:173], v[172:173], v[154:155] op_sel_hi:[1,0] neg_lo:[0,1] neg_hi:[0,1]
    v_pk_add_f32 v[174:175], v[174:175], v[154:155] op_sel_hi:[1,0] neg_lo:[0,1] neg_hi:[0,1]
    v_cvt_pk_bf16_f32 v40, v160, v161
    v_cvt_pk_bf16_f32 v41, v162, v163
    v_cvt_pk_bf16_f32 v42, v164, v165
    v_cvt_pk_bf16_f32 v43, v166, v167
    v_cvt_pk_bf16_f32 v44, v168, v169
    v_cvt_pk_bf16_f32 v45, v170, v171
    v_cvt_pk_bf16_f32 v46, v172, v173
    v_cvt_pk_bf16_f32 v47, v174, v175
    v_lshlrev_b32 v160, 16, v40
    v_and_b32 v161, 0xffff0000, v40
    v_lshlrev_b32 v162, 16, v41
    v_and_b32 v163, 0xffff0000, v41
    v_lshlrev_b32 v164, 16, v42
    v_and_b32 v165, 0xffff0000, v42
    v_lshlrev_b32 v166, 16, v43
    v_and_b32 v167, 0xffff0000, v43
    v_lshlrev_b32 v168, 16, v44
    v_and_b32 v169, 0xffff0000, v44
    v_lshlrev_b32 v170, 16, v45
    v_and_b32 v171, 0xffff0000, v45
    v_lshlrev_b32 v172, 16, v46
    v_and_b32 v173, 0xffff0000, v46
    v_lshlrev_b32 v174, 16, v47
    v_and_b32 v175, 0xffff0000, v47
    v_pk_mul_f32 v[160:161], v[160:161], v[152:153] op_sel_hi:[1,0]
    v_pk_mul_f32 v[162:163], v[162:163], v[152:153] op_sel_hi:[1,0]
    v_pk_mul_f32 v[164:165], v[164:165], v[152:153] op_sel_hi:[1,0]
    v_pk_mul_f32 v[166:167], v[166:167], v[152:153] op_sel_hi:[1,0]
    v_pk_mul_f32 v[168:169], v[168:169], v[152:153] op_sel_hi:[1,0]
    v_pk_mul_f32 v[170:171], v[170:171], v[152:153] op_sel_hi:[1,0]
    v_pk_mul_f32 v[172:173], v[172:173], v[152:153] op_sel_hi:[1,0]
    v_pk_mul_f32 v[174:175], v[174:175], v[152:153] op_sel_hi:[1,0]
    v_cvt_pk_bf16_f32 v160, v160, v161
    v_cvt_pk_bf16_f32 v162, v162, v163
    v_cvt_pk_bf16_f32 v164, v164, v165
    v_cvt_pk_bf16_f32 v166, v166, v167
    v_cvt_pk_bf16_f32 v168, v168, v169
    v_cvt_pk_bf16_f32 v170, v170, v171
    s_add_u32 s26, s24, 0x120000
    s_add_u32 m0, s29, 0x9000
    s_nop 0
    buffer_load_dwordx4 v136, s[16:19], s26 offen lds
    v_cvt_pk_bf16_f32 v172, v172, v173
    v_cvt_pk_bf16_f32 v174, v174, v175
    v_accvgpr_write_b32 a40, v160
    v_accvgpr_write_b32 a41, v162
    v_accvgpr_write_b32 a42, v164
    v_accvgpr_write_b32 a43, v166
    v_accvgpr_write_b32 a44, v168
    v_accvgpr_write_b32 a45, v170
    v_accvgpr_write_b32 a46, v172
    v_accvgpr_write_b32 a47, v174
    v_lshlrev_b32 v160, 16, v48
    v_and_b32 v161, 0xffff0000, v48
    v_lshlrev_b32 v162, 16, v49
    v_and_b32 v163, 0xffff0000, v49
    v_lshlrev_b32 v164, 16, v50
    v_and_b32 v165, 0xffff0000, v50
    v_lshlrev_b32 v166, 16, v51
    v_and_b32 v167, 0xffff0000, v51
    v_lshlrev_b32 v168, 16, v52
    v_and_b32 v169, 0xffff0000, v52
    v_lshlrev_b32 v170, 16, v53
    v_and_b32 v171, 0xffff0000, v53
    v_lshlrev_b32 v172, 16, v54
    v_and_b32 v173, 0xffff0000, v54
    v_lshlrev_b32 v174, 16, v55
    v_and_b32 v175, 0xffff0000, v55
    v_pk_add_f32 v[160:161], v[160:161], v[154:155] op_sel_hi:[1,0] neg_lo:[0,1] neg_hi:[0,1]
    v_pk_add_f32 v[162:163], v[162:163], v[154:155] op_sel_hi:[1,0] neg_lo:[0,1] neg_hi:[0,1]
    v_pk_add_f32 v[164:165], v[164:165], v[154:155] op_sel_hi:[1,0] neg_lo:[0,1] neg_hi:[0,1]
    v_pk_add_f32 v[166:167], v[166:167], v[154:155] op_sel_hi:[1,0] neg_lo:[0,1] neg_hi:[0,1]
    v_pk_add_f32 v[168:169], v[168:169], v[154:155] op_sel_hi:[1,0] neg_lo:[0,1] neg_hi:[0,1]
    v_pk_add_f32 v[170:171], v[170:171], v[154:155] op_sel_hi:[1,0] neg_lo:[0,1] neg_hi:[0,1]
    v_pk_add_f32 v[172:173], v[172:173], v[154:155] op_sel_hi:[1,0] neg_lo:[0,1] neg_hi:[0,1]
    v_pk_add_f32 v[174:175], v[174:175], v[154:155] op_sel_hi:[1,0] neg_lo:[0,1] neg_hi:[0,1]
    v_cvt_pk_bf16_f32 v48, v160, v161
    v_cvt_pk_bf16_f32 v49, v162, v163
    v_cvt_pk_bf16_f32 v50, v164, v165
    v_cvt_pk_bf16_f32 v51, v166, v167
    v_cvt_pk_bf16_f32 v52, v168, v169
    v_cvt_pk_bf16_f32 v53, v170, v171
    v_cvt_pk_bf16_f32 v54, v172, v173
    v_cvt_pk_bf16_f32 v55, v174, v175
    v_lshlrev_b32 v160, 16, v48
    v_and_b32 v161, 0xffff0000, v48
    v_lshlrev_b32 v162, 16, v49
    v_and_b32 v163, 0xffff0000, v49
    v_lshlrev_b32 v164, 16, v50
    v_and_b32 v165, 0xffff0000, v50
    v_lshlrev_b32 v166, 16, v51
    v_and_b32 v167, 0xffff0000, v51
    s_add_u32 s26, s24, 0x140000
    s_add_u32 m0, s29, 0xa000
    s_nop 0
    buffer_load_dwordx4 v136, s[16:19], s26 offen lds
    v_lshlrev_b32 v168, 16, v52
    v_and_b32 v169, 0xffff0000, v52
    v_lshlrev_b32 v170, 16, v53
    v_and_b32 v171, 0xffff0000, v53
    v_lshlrev_b32 v172, 16, v54
    v_and_b32 v173, 0xffff0000, v54
    v_lshlrev_b32 v174, 16, v55
    v_and_b32 v175, 0xffff0000, v55
    v_pk_mul_f32 v[160:161], v[160:161], v[152:153] op_sel_hi:[1,0]
    v_pk_mul_f32 v[162:163], v[162:163], v[152:153] op_sel_hi:[1,0]
    v_pk_mul_f32 v[164:165], v[164:165], v[152:153] op_sel_hi:[1,0]
    v_pk_mul_f32 v[166:167], v[166:167], v[152:153] op_sel_hi:[1,0]
    v_pk_mul_f32 v[168:169], v[168:169], v[152:153] op_sel_hi:[1,0]
    v_pk_mul_f32 v[170:171], v[170:171], v[152:153] op_sel_hi:[1,0]
    v_pk_mul_f32 v[172:173], v[172:173], v[152:153] op_sel_hi:[1,0]
    v_pk_mul_f32 v[174:175], v[174:175], v[152:153] op_sel_hi:[1,0]
    v_cvt_pk_bf16_f32 v160, v160, v161
    v_cvt_pk_bf16_f32 v162, v162, v163
    v_cvt_pk_bf16_f32 v164, v164, v165
    v_cvt_pk_bf16_f32 v166, v166, v167
    v_cvt_pk_bf16_f32 v168, v168, v169
    v_cvt_pk_bf16_f32 v170, v170, v171
    v_cvt_pk_bf16_f32 v172, v172, v173
    v_cvt_pk_bf16_f32 v174, v174, v175
    v_accvgpr_write_b32 a48, v160
    v_accvgpr_write_b32 a49, v162
    v_accvgpr_write_b32 a50, v164
    v_accvgpr_write_b32 a51, v166
    v_accvgpr_write_b32 a52, v168
    v_accvgpr_write_b32 a53, v170
    v_accvgpr_write_b32 a54, v172
    v_accvgpr_write_b32 a55, v174
    v_lshlrev_b32 v160, 16, v56
    v_and_b32 v161, 0xffff0000, v56
    v_lshlrev_b32 v162, 16, v57
    v_and_b32 v163, 0xffff0000, v57
    v_lshlrev_b32 v164, 16, v58
    v_and_b32 v165, 0xffff0000, v58
    v_lshlrev_b32 v166, 16, v59
    v_and_b32 v167, 0xffff0000, v59
    v_lshlrev_b32 v168, 16, v60
    v_and_b32 v169, 0xffff0000, v60
    v_lshlrev_b32 v170, 16, v61
    v_and_b32 v171, 0xffff0000, v61
    v_lshlrev_b32 v172, 16, v62
    v_and_b32 v173, 0xffff0000, v62
    v_lshlrev_b32 v174, 16, v63
    v_and_b32 v175, 0xffff0000, v63
    v_pk_add_f32 v[160:161], v[160:161], v[154:155] op_sel_hi:[1,0] neg_lo:[0,1] neg_hi:[0,1]
    v_pk_add_f32 v[162:163], v[162:163], v[154:155] op_sel_hi:[1,0] neg_lo:[0,1] neg_hi:[0,1]
    s_add_u32 s26, s24, 0x160000
    s_add_u32 m0, s29, 0xb000
    s_nop 0
    buffer_load_dwordx4 v136, s[16:19], s26 offen lds
    v_pk_add_f32 v[164:165], v[164:165], v[154:155] op_sel_hi:[1,0] neg_lo:[0,1] neg_hi:[0,1]
    v_pk_add_f32 v[166:167], v[166:167], v[154:155] op_sel_hi:[1,0] neg_lo:[0,1] neg_hi:[0,1]
    v_pk_add_f32 v[168:169], v[168:169], v[154:155] op_sel_hi:[1,0] neg_lo:[0,1] neg_hi:[0,1]
    v_pk_add_f32 v[170:171], v[170:171], v[154:155] op_sel_hi:[1,0] neg_lo:[0,1] neg_hi:[0,1]
    v_pk_add_f32 v[172:173], v[172:173], v[154:155] op_sel_hi:[1,0] neg_lo:[0,1] neg_hi:[0,1]
    v_pk_add_f32 v[174:175], v[174:175], v[154:155] op_sel_hi:[1,0] neg_lo:[0,1] neg_hi:[0,1]
    v_cvt_pk_bf16_f32 v56, v160, v161
    v_cvt_pk_bf16_f32 v57, v162, v163
    v_cvt_pk_bf16_f32 v58, v164, v165
    v_cvt_pk_bf16_f32 v59, v166, v167
    v_cvt_pk_bf16_f32 v60, v168, v169
    v_cvt_pk_bf16_f32 v61, v170, v171
    v_cvt_pk_bf16_f32 v62, v172, v173
    v_cvt_pk_bf16_f32 v63, v174, v175
    v_lshlrev_b32 v160, 16, v56
    v_and_b32 v161, 0xffff0000, v56
    v_lshlrev_b32 v162, 16, v57
    v_and_b32 v163, 0xffff0000, v57
    v_lshlrev_b32 v164, 16, v58
    v_and_b32 v165, 0xffff0000, v58
    v_lshlrev_b32 v166, 16, v59
    v_and_b32 v167, 0xffff0000, v59
    v_lshlrev_b32 v168, 16, v60
    v_and_b32 v169, 0xffff0000, v60
    v_lshlrev_b32 v170, 16, v61
    v_and_b32 v171, 0xffff0000, v61
    v_lshlrev_b32 v172, 16, v62
    v_and_b32 v173, 0xffff0000, v62
    v_lshlrev_b32 v174, 16, v63
    v_and_b32 v175, 0xffff0000, v63
    v_pk_mul_f32 v[160:161], v[160:161], v[152:153] op_sel_hi:[1,0]
    v_pk_mul_f32 v[162:163], v[162:163], v[152:153] op_sel_hi:[1,0]
    v_pk_mul_f32 v[164:165], v[164:165], v[152:153] op_sel_hi:[1,0]
    v_pk_mul_f32 v[166:167], v[166:167], v[152:153] op_sel_hi:[1,0]
    v_pk_mul_f32 v[168:169], v[168:169], v[152:153] op_sel_hi:[1,0]
    v_pk_mul_f32 v[170:171], v[170:171], v[152:153] op_sel_hi:[1,0]
    v_pk_mul_f32 v[172:173], v[172:173], v[152:153] op_sel_hi:[1,0]
    v_pk_mul_f32 v[174:175], v[174:175], v[152:153] op_sel_hi:[1,0]
    v_cvt_pk_bf16_f32 v160, v160, v161
    v_cvt_pk_bf16_f32 v162, v162, v163
    v_cvt_pk_bf16_f32 v164, v164, v165
    v_cvt_pk_bf16_f32 v166, v166, v167
    v_cvt_pk_bf16_f32 v168, v168, v169
    v_cvt_pk_bf16_f32 v170, v170, v171
    v_cvt_pk_bf16_f32 v172, v172, v173
    v_cvt_pk_bf16_f32 v174, v174, v175
    v_accvgpr_write_b32 a56, v160
    v_accvgpr_write_b32 a57, v162
    v_accvgpr_write_b32 a58, v164
    v_accvgpr_write_b32 a59, v166
    s_add_u32 s26, s24, 0x180000
    s_add_u32 m0, s29, 0xc000
    s_nop 0
    buffer_load_dwordx4 v136, s[16:19], s26 offen lds
    v_accvgpr_write_b32 a60, v168
    v_accvgpr_write_b32 a61, v170
    v_accvgpr_write_b32 a62, v172
    v_accvgpr_write_b32 a63, v174
    s_waitcnt vmcnt(13)
    v_pk_mov_b32 v[150:151], 0, 0
    v_pk_mov_b32 v[152:153], 0, 0
    v_dot2_f32_bf16 v150, v64, v158, v150
    v_dot2_f32_bf16 v152, v64, v64, v152
    v_dot2_f32_bf16 v151, v65, v158, v151
    v_dot2_f32_bf16 v153, v65, v65, v153
    v_dot2_f32_bf16 v150, v66, v158, v150
    v_dot2_f32_bf16 v152, v66, v66, v152
    v_dot2_f32_bf16 v151, v67, v158, v151
    v_dot2_f32_bf16 v153, v67, v67, v153
    v_dot2_f32_bf16 v150, v68, v158, v150
    v_dot2_f32_bf16 v152, v68, v68, v152
    v_dot2_f32_bf16 v151, v69, v158, v151
    v_dot2_f32_bf16 v153, v69, v69, v153
    v_dot2_f32_bf16 v150, v70, v158, v150
    v_dot2_f32_bf16 v152, v70, v70, v152
    v_dot2_f32_bf16 v151, v71, v158, v151
    v_dot2_f32_bf16 v153, v71, v71, v153
    v_dot2_f32_bf16 v150, v72, v158, v150
    v_dot2_f32_bf16 v152, v72, v72, v152
    v_dot2_f32_bf16 v151, v73, v158, v151
    v_dot2_f32_bf16 v153, v73, v73, v153
    v_dot2_f32_bf16 v150, v74, v158, v150
    v_dot2_f32_bf16 v152, v74, v74, v152
    v_dot2_f32_bf16 v151, v75, v158, v151
    v_dot2_f32_bf16 v153, v75, v75, v153
    v_dot2_f32_bf16 v150, v76, v158, v150
    v_dot2_f32_bf16 v152, v76, v76, v152
    v_dot2_f32_bf16 v151, v77, v158, v151
    v_dot2_f32_bf16 v153, v77, v77, v153
    v_dot2_f32_bf16 v150, v78, v158, v150
    v_dot2_f32_bf16 v152, v78, v78, v152
    v_dot2_f32_bf16 v151, v79, v158, v151
    v_dot2_f32_bf16 v153, v79, v79, v153
    v_dot2_f32_bf16 v150, v80, v158, v150
    v_dot2_f32_bf16 v152, v80, v80, v152
    v_dot2_f32_bf16 v151, v81, v158, v151
    v_dot2_f32_bf16 v153, v81, v81, v153
    v_dot2_f32_bf16 v150, v82, v158, v150
    v_dot2_f32_bf16 v152, v82, v82, v152
    v_dot2_f32_bf16 v151, v83, v158, v151
    v_dot2_f32_bf16 v153, v83, v83, v153
    v_dot2_f32_bf16 v150, v84, v158, v150
    v_dot2_f32_bf16 v152, v84, v84, v152
    v_dot2_f32_bf16 v151, v85, v158, v151
    v_dot2_f32_bf16 v153, v85, v85, v153
    v_dot2_f32_bf16 v150, v86, v158, v150
    v_dot2_f32_bf16 v152, v86, v86, v152
    s_add_u32 s26, s24, 0x1a0000
    s_add_u32 m0, s29, 0xd000
    s_nop 0
    buffer_load_dwordx4 v136, s[16:19], s26 offen lds
    v_dot2_f32_bf16 v151, v87, v158, v151
    v_dot2_f32_bf16 v153, v87, v87, v153
    v_dot2_f32_bf16 v150, v88, v158, v150
    v_dot2_f32_bf16 v152, v88, v88, v152
    v_dot2_f32_bf16 v151, v89, v158, v151
    v_dot2_f32_bf16 v153, v89, v89, v153
    v_dot2_f32_bf16 v150, v90, v158, v150
    v_dot2_f32_bf16 v152, v90, v90, v152
    v_dot2_f32_bf16 v151, v91, v158, v151
    v_dot2_f32_bf16 v153, v91, v91, v153
    v_dot2_f32_bf16 v150, v92, v158, v150
    v_dot2_f32_bf16 v152, v92, v92, v152
    v_dot2_f32_bf16 v151, v93, v158, v151
    v_dot2_f32_bf16 v153, v93, v93, v153
    v_dot2_f32_bf16 v150, v94, v158, v150
    v_dot2_f32_bf16 v152, v94, v94, v152
    v_dot2_f32_bf16 v151, v95, v158, v151
    v_dot2_f32_bf16 v153, v95, v95, v153
    v_dot2_f32_bf16 v150, v96, v158, v150
    v_dot2_f32_bf16 v152, v96, v96, v152
    v_dot2_f32_bf16 v151, v97, v158, v151
    v_dot2_f32_bf16 v153, v97, v97, v153
    v_dot2_f32_bf16 v150, v98, v158, v150
    v_dot2_f32_bf16 v152, v98, v98, v152
    v_dot2_f32_bf16 v151, v99, v158, v151
    v_dot2_f32_bf16 v153, v99, v99, v153
    v_dot2_f32_bf16 v150, v100, v158, v150
    v_dot2_f32_bf16 v152, v100, v100, v152
    v_dot2_f32_bf16 v151, v101, v158, v151
    v_dot2_f32_bf16 v153, v101, v101, v153
    v_dot2_f32_bf16 v150, v102, v158, v150
    v_dot2_f32_bf16 v152, v102, v102, v152
    v_dot2_f32_bf16 v151, v103, v158, v151
    v_dot2_f32_bf16 v153, v103, v103, v153
    v_dot2_f32_bf16 v150, v104, v158, v150
    v_dot2_f32_bf16 v152, v104, v104, v152
    v_dot2_f32_bf16 v151, v105, v158, v151
    v_dot2_f32_bf16 v153, v105, v105, v153
    v_dot2_f32_bf16 v150, v106, v158, v150
    v_dot2_f32_bf16 v152, v106, v106, v152
    v_dot2_f32_bf16 v151, v107, v158, v151
    v_dot2_f32_bf16 v153, v107, v107, v153
    v_dot2_f32_bf16 v150, v108, v158, v150
    v_dot2_f32_bf16 v152, v108, v108, v152
    v_dot2_f32_bf16 v151, v109, v158, v151
    v_dot2_f32_bf16 v153, v109, v109, v153
    v_dot2_f32_bf16 v150, v110, v158, v150
    v_dot2_f32_bf16 v152, v110, v110, v152
    v_dot2_f32_bf16 v151, v111, v158, v151
    v_dot2_f32_bf16 v153, v111, v111, v153
    s_add_u32 s26, s24, 0x1c0000
    s_add_u32 m0, s29, 0xe000
    s_nop 0
    buffer_load_dwordx4 v136, s[16:19], s26 offen lds
    v_dot2_f32_bf16 v150, v112, v158, v150
    v_dot2_f32_bf16 v152, v112, v112, v152
    v_dot2_f32_bf16 v151, v113, v158, v151
    v_dot2_f32_bf16 v153, v113, v113, v153
    v_dot2_f32_bf16 v150, v114, v158, v150
    v_dot2_f32_bf16 v152, v114, v114, v152
    v_dot2_f32_bf16 v151, v115, v158, v151
    v_dot2_f32_bf16 v153, v115, v115, v153
    v_dot2_f32_bf16 v150, v116, v158, v150
    v_dot2_f32_bf16 v152, v116, v116, v152
    v_dot2_f32_bf16 v151, v117, v158, v151
    v_dot2_f32_bf16 v153, v117, v117, v153
    v_dot2_f32_bf16 v150, v118, v158, v150
    v_dot2_f32_bf16 v152, v118, v118, v152
    v_dot2_f32_bf16 v151, v119, v158, v151
    v_dot2_f32_bf16 v153, v119, v119, v153
    v_dot2_f32_bf16 v150, v120, v158, v150
    v_dot2_f32_bf16 v152, v120, v120, v152
    v_dot2_f32_bf16 v151, v121, v158, v151
    v_dot2_f32_bf16 v153, v121, v121, v153
    v_dot2_f32_bf16 v150, v122, v158, v150
    v_dot2_f32_bf16 v152, v122, v122, v152
    v_dot2_f32_bf16 v151, v123, v158, v151
    v_dot2_f32_bf16 v153, v123, v123, v153
    v_dot2_f32_bf16 v150, v124, v158, v150
    v_dot2_f32_bf16 v152, v124, v124, v152
    v_dot2_f32_bf16 v151, v125, v158, v151
    v_dot2_f32_bf16 v153, v125, v125, v153
    v_dot2_f32_bf16 v150, v126, v158, v150
    v_dot2_f32_bf16 v152, v126, v126, v152
    v_dot2_f32_bf16 v151, v127, v158, v151
    v_dot2_f32_bf16 v153, v127, v127, v153
    s_nop 1
    v_add_f32 v150, v150, v151
    v_add_f32 v152, v152, v153
    v_mov_b32 v157, v150
    s_nop 1
    v_permlane32_swap_b32 v157, v150
    v_add_f32 v150, v157, v150
    v_mov_b32 v157, v150
    s_nop 1
    v_permlane16_swap_b32 v157, v150
    v_add_f32 v150, v157, v150
    v_mov_b32 v157, v152
    s_nop 1
    v_permlane32_swap_b32 v157, v152
    v_add_f32 v152, v157, v152
    v_mov_b32 v157, v152
    s_nop 1
    v_permlane16_swap_b32 v157, v152
    v_add_f32 v152, v157, v152
    v_mul_f32 v150, 0x3b000000, v150
    v_cvt_pk_bf16_f32 v154, v150, v150
    v_and_b32 v154, 0xffff0000, v154
    v_sub_f32 v156, v150, v154
    v_mul_f32 v157, v150, v150
    v_mul_f32 v152, 0x3b000000, v152
    v_sub_f32 v152, v152, v157
    v_max_f32 v152, 0, v152
    v_cvt_pk_bf16_f32 v152, v152, v152
    v_and_b32 v152, 0xffff0000, v152
    v_add_f32 v152, 0x3727c5ac, v152
    v_cvt_pk_bf16_f32 v152, v152, v152
    v_and_b32 v152, 0xffff0000, v152
    v_sqrt_f32 v152, v152
    s_nop 0
    v_cvt_pk_bf16_f32 v152, v152, v152
    v_and_b32 v152, 0xffff0000, v152
    v_rcp_f32 v152, v152
    v_lshlrev_b32 v160, 16, v64
    v_and_b32 v161, 0xffff0000, v64
    v_lshlrev_b32 v162, 16, v65
    v_and_b32 v163, 0xffff0000, v65
    v_lshlrev_b32 v164, 16, v66
    v_and_b32 v165, 0xffff0000, v66
    v_lshlrev_b32 v166, 16, v67
    v_and_b32 v167, 0xffff0000, v67
    v_lshlrev_b32 v168, 16, v68
    v_and_b32 v169, 0xffff0000, v68
    v_lshlrev_b32 v170, 16, v69
    v_and_b32 v171, 0xffff0000, v69
    v_lshlrev_b32 v172, 16, v70
    v_and_b32 v173, 0xffff0000, v70
    v_lshlrev_b32 v174, 16, v71
    v_and_b32 v175, 0xffff0000, v71
    v_pk_add_f32 v[160:161], v[160:161], v[154:155] op_sel_hi:[1,0] neg_lo:[0,1] neg_hi:[0,1]
    v_pk_add_f32 v[162:163], v[162:163], v[154:155] op_sel_hi:[1,0] neg_lo:[0,1] neg_hi:[0,1]
    s_add_u32 s26, s24, 0x1e0000
    s_add_u32 m0, s29, 0xf000
    s_nop 0
    buffer_load_dwordx4 v136, s[16:19], s26 offen lds
    v_pk_add_f32 v[164:165], v[164:165], v[154:155] op_sel_hi:[1,0] neg_lo:[0,1] neg_hi:[0,1]
    v_pk_add_f32 v[166:167], v[166:167], v[154:155] op_sel_hi:[1,0] neg_lo:[0,1] neg_hi:[0,1]
    v_pk_add_f32 v[168:169], v[168:169], v[154:155] op_sel_hi:[1,0] neg_lo:[0,1] neg_hi:[0,1]
    v_pk_add_f32 v[170:171], v[170:171], v[154:155] op_sel_hi:[1,0] neg_lo:[0,1] neg_hi:[0,1]
    v_pk_add_f32 v[172:173], v[172:173], v[154:155] op_sel_hi:[1,0] neg_lo:[0,1] neg_hi:[0,1]
    v_pk_add_f32 v[174:175], v[174:175], v[154:155] op_sel_hi:[1,0] neg_lo:[0,1] neg_hi:[0,1]
    v_cvt_pk_bf16_f32 v64, v160, v161
    v_cvt_pk_bf16_f32 v65, v162, v163
    v_cvt_pk_bf16_f32 v66, v164, v165
    v_cvt_pk_bf16_f32 v67, v166, v167
    v_cvt_pk_bf16_f32 v68, v168, v169
    v_cvt_pk_bf16_f32 v69, v170, v171
    v_cvt_pk_bf16_f32 v70, v172, v173
    v_cvt_pk_bf16_f32 v71, v174, v175
    v_lshlrev_b32 v160, 16, v64
    v_and_b32 v161, 0xffff0000, v64
    v_lshlrev_b32 v162, 16, v65
    v_and_b32 v163, 0xffff0000, v65
    v_lshlrev_b32 v164, 16, v66
    v_and_b32 v165, 0xffff0000, v66
    v_lshlrev_b32 v166, 16, v67
    v_and_b32 v167, 0xffff0000, v67
    v_lshlrev_b32 v168, 16, v68
    v_and_b32 v169, 0xffff0000, v68
    v_lshlrev_b32 v170, 16, v69
    v_and_b32 v171, 0xffff0000, v69
    v_lshlrev_b32 v172, 16, v70
    v_and_b32 v173, 0xffff0000, v70
    v_lshlrev_b32 v174, 16, v71
    v_and_b32 v175, 0xffff0000, v71
    v_pk_mul_f32 v[160:161], v[160:161], v[152:153] op_sel_hi:[1,0]
    v_pk_mul_f32 v[162:163], v[162:163], v[152:153] op_sel_hi:[1,0]
    v_pk_mul_f32 v[164:165], v[164:165], v[152:153] op_sel_hi:[1,0]
    v_pk_mul_f32 v[166:167], v[166:167], v[152:153] op_sel_hi:[1,0]
    v_pk_mul_f32 v[168:169], v[168:169], v[152:153] op_sel_hi:[1,0]
    v_pk_mul_f32 v[170:171], v[170:171], v[152:153] op_sel_hi:[1,0]
    v_pk_mul_f32 v[172:173], v[172:173], v[152:153] op_sel_hi:[1,0]
    v_pk_mul_f32 v[174:175], v[174:175], v[152:153] op_sel_hi:[1,0]
    v_cvt_pk_bf16_f32 v160, v160, v161
    v_cvt_pk_bf16_f32 v162, v162, v163
    v_cvt_pk_bf16_f32 v164, v164, v165
    v_cvt_pk_bf16_f32 v166, v166, v167
    v_cvt_pk_bf16_f32 v168, v168, v169
    v_cvt_pk_bf16_f32 v170, v170, v171
    v_cvt_pk_bf16_f32 v172, v172, v173
    v_cvt_pk_bf16_f32 v174, v174, v175
    v_accvgpr_write_b32 a64, v160
    v_accvgpr_write_b32 a65, v162
    v_accvgpr_write_b32 a66, v164
    v_accvgpr_write_b32 a67, v166
    s_add_u32 s26, s24, 0x200000
    s_add_u32 m0, s29, 0x10000
    s_nop 0
    buffer_load_dwordx4 v136, s[16:19], s26 offen lds
    v_accvgpr_write_b32 a68, v168
    v_accvgpr_write_b32 a69, v170
    v_accvgpr_write_b32 a70, v172
    v_accvgpr_write_b32 a71, v174
    v_lshlrev_b32 v160, 16, v72
    v_and_b32 v161, 0xffff0000, v72
    v_lshlrev_b32 v162, 16, v73
    v_and_b32 v163, 0xffff0000, v73
    v_lshlrev_b32 v164, 16, v74
    v_and_b32 v165, 0xffff0000, v74
    v_lshlrev_b32 v166, 16, v75
    v_and_b32 v167, 0xffff0000, v75
    v_lshlrev_b32 v168, 16, v76
    v_and_b32 v169, 0xffff0000, v76
    v_lshlrev_b32 v170, 16, v77
    v_and_b32 v171, 0xffff0000, v77
    v_lshlrev_b32 v172, 16, v78
    v_and_b32 v173, 0xffff0000, v78
    v_lshlrev_b32 v174, 16, v79
    v_and_b32 v175, 0xffff0000, v79
    v_pk_add_f32 v[160:161], v[160:161], v[154:155] op_sel_hi:[1,0] neg_lo:[0,1] neg_hi:[0,1]
    v_pk_add_f32 v[162:163], v[162:163], v[154:155] op_sel_hi:[1,0] neg_lo:[0,1] neg_hi:[0,1]
    v_pk_add_f32 v[164:165], v[164:165], v[154:155] op_sel_hi:[1,0] neg_lo:[0,1] neg_hi:[0,1]
    v_pk_add_f32 v[166:167], v[166:167], v[154:155] op_sel_hi:[1,0] neg_lo:[0,1] neg_hi:[0,1]
    v_pk_add_f32 v[168:169], v[168:169], v[154:155] op_sel_hi:[1,0] neg_lo:[0,1] neg_hi:[0,1]
    v_pk_add_f32 v[170:171], v[170:171], v[154:155] op_sel_hi:[1,0] neg_lo:[0,1] neg_hi:[0,1]
    v_pk_add_f32 v[172:173], v[172:173], v[154:155] op_sel_hi:[1,0] neg_lo:[0,1] neg_hi:[0,1]
    v_pk_add_f32 v[174:175], v[174:175], v[154:155] op_sel_hi:[1,0] neg_lo:[0,1] neg_hi:[0,1]
    v_cvt_pk_bf16_f32 v72, v160, v161
    v_cvt_pk_bf16_f32 v73, v162, v163
    v_cvt_pk_bf16_f32 v74, v164, v165
    v_cvt_pk_bf16_f32 v75, v166, v167
    v_cvt_pk_bf16_f32 v76, v168, v169
    v_cvt_pk_bf16_f32 v77, v170, v171
    v_cvt_pk_bf16_f32 v78, v172, v173
    v_cvt_pk_bf16_f32 v79, v174, v175
    v_lshlrev_b32 v160, 16, v72
    v_and_b32 v161, 0xffff0000, v72
    v_lshlrev_b32 v162, 16, v73
    v_and_b32 v163, 0xffff0000, v73
    v_lshlrev_b32 v164, 16, v74
    v_and_b32 v165, 0xffff0000, v74
    v_lshlrev_b32 v166, 16, v75
    v_and_b32 v167, 0xffff0000, v75
    v_lshlrev_b32 v168, 16, v76
    v_and_b32 v169, 0xffff0000, v76
    v_lshlrev_b32 v170, 16, v77
    v_and_b32 v171, 0xffff0000, v77
    v_lshlrev_b32 v172, 16, v78
    v_and_b32 v173, 0xffff0000, v78
    s_add_u32 s26, s24, 0x220000
    s_add_u32 m0, s29, 0x11000
    s_nop 0
    buffer_load_dwordx4 v136, s[16:19], s26 offen lds
    v_lshlrev_b32 v174, 16, v79
    v_and_b32 v175, 0xffff0000, v79
    v_pk_mul_f32 v[160:161], v[160:161], v[152:153] op_sel_hi:[1,0]
    v_pk_mul_f32 v[162:163], v[162:163], v[152:153] op_sel_hi:[1,0]
    v_pk_mul_f32 v[164:165], v[164:165], v[152:153] op_sel_hi:[1,0]
    v_pk_mul_f32 v[166:167], v[166:167], v[152:153] op_sel_hi:[1,0]
    v_pk_mul_f32 v[168:169], v[168:169], v[152:153] op_sel_hi:[1,0]
    v_pk_mul_f32 v[170:171], v[170:171], v[152:153] op_sel_hi:[1,0]
    v_pk_mul_f32 v[172:173], v[172:173], v[152:153] op_sel_hi:[1,0]
    v_pk_mul_f32 v[174:175], v[174:175], v[152:153] op_sel_hi:[1,0]
    v_cvt_pk_bf16_f32 v160, v160, v161
    v_cvt_pk_bf16_f32 v162, v162, v163
    v_cvt_pk_bf16_f32 v164, v164, v165
    v_cvt_pk_bf16_f32 v166, v166, v167
    v_cvt_pk_bf16_f32 v168, v168, v169
    v_cvt_pk_bf16_f32 v170, v170, v171
    v_cvt_pk_bf16_f32 v172, v172, v173
    v_cvt_pk_bf16_f32 v174, v174, v175
    v_accvgpr_write_b32 a72, v160
    v_accvgpr_write_b32 a73, v162
    v_accvgpr_write_b32 a74, v164
    v_accvgpr_write_b32 a75, v166
    v_accvgpr_write_b32 a76, v168
    v_accvgpr_write_b32 a77, v170
    v_accvgpr_write_b32 a78, v172
    v_accvgpr_write_b32 a79, v174
    v_lshlrev_b32 v160, 16, v80
    v_and_b32 v161, 0xffff0000, v80
    v_lshlrev_b32 v162, 16, v81
    v_and_b32 v163, 0xffff0000, v81
    v_lshlrev_b32 v164, 16, v82
    v_and_b32 v165, 0xffff0000, v82
    v_lshlrev_b32 v166, 16, v83
    v_and_b32 v167, 0xffff0000, v83
    v_lshlrev_b32 v168, 16, v84
    v_and_b32 v169, 0xffff0000, v84
    v_lshlrev_b32 v170, 16, v85
    v_and_b32 v171, 0xffff0000, v85
    v_lshlrev_b32 v172, 16, v86
    v_and_b32 v173, 0xffff0000, v86
    v_lshlrev_b32 v174, 16, v87
    v_and_b32 v175, 0xffff0000, v87
    v_pk_add_f32 v[160:161], v[160:161], v[154:155] op_sel_hi:[1,0] neg_lo:[0,1] neg_hi:[0,1]
    v_pk_add_f32 v[162:163], v[162:163], v[154:155] op_sel_hi:[1,0] neg_lo:[0,1] neg_hi:[0,1]
    v_pk_add_f32 v[164:165], v[164:165], v[154:155] op_sel_hi:[1,0] neg_lo:[0,1] neg_hi:[0,1]
    v_pk_add_f32 v[166:167], v[166:167], v[154:155] op_sel_hi:[1,0] neg_lo:[0,1] neg_hi:[0,1]
    v_pk_add_f32 v[168:169], v[168:169], v[154:155] op_sel_hi:[1,0] neg_lo:[0,1] neg_hi:[0,1]
    v_pk_add_f32 v[170:171], v[170:171], v[154:155] op_sel_hi:[1,0] neg_lo:[0,1] neg_hi:[0,1]
    v_pk_add_f32 v[172:173], v[172:173], v[154:155] op_sel_hi:[1,0] neg_lo:[0,1] neg_hi:[0,1]
    v_pk_add_f32 v[174:175], v[174:175], v[154:155] op_sel_hi:[1,0] neg_lo:[0,1] neg_hi:[0,1]
    s_add_u32 s26, s24, 0x240000
    s_add_u32 m0, s29, 0x12000
    s_nop 0
    buffer_load_dwordx4 v136, s[16:19], s26 offen lds
    v_cvt_pk_bf16_f32 v80, v160, v161
    v_cvt_pk_bf16_f32 v81, v162, v163
    v_cvt_pk_bf16_f32 v82, v164, v165
    v_cvt_pk_bf16_f32 v83, v166, v167
    v_cvt_pk_bf16_f32 v84, v168, v169
    v_cvt_pk_bf16_f32 v85, v170, v171
    v_cvt_pk_bf16_f32 v86, v172, v173
    v_cvt_pk_bf16_f32 v87, v174, v175
    v_lshlrev_b32 v160, 16, v80
    v_and_b32 v161, 0xffff0000, v80
    v_lshlrev_b32 v162, 16, v81
    v_and_b32 v163, 0xffff0000, v81
    v_lshlrev_b32 v164, 16, v82
    v_and_b32 v165, 0xffff0000, v82
    v_lshlrev_b32 v166, 16, v83
    v_and_b32 v167, 0xffff0000, v83
    v_lshlrev_b32 v168, 16, v84
    v_and_b32 v169, 0xffff0000, v84
    v_lshlrev_b32 v170, 16, v85
    v_and_b32 v171, 0xffff0000, v85
    v_lshlrev_b32 v172, 16, v86
    v_and_b32 v173, 0xffff0000, v86
    v_lshlrev_b32 v174, 16, v87
    v_and_b32 v175, 0xffff0000, v87
    v_pk_mul_f32 v[160:161], v[160:161], v[152:153] op_sel_hi:[1,0]
    v_pk_mul_f32 v[162:163], v[162:163], v[152:153] op_sel_hi:[1,0]
    v_pk_mul_f32 v[164:165], v[164:165], v[152:153] op_sel_hi:[1,0]
    v_pk_mul_f32 v[166:167], v[166:167], v[152:153] op_sel_hi:[1,0]
    v_pk_mul_f32 v[168:169], v[168:169], v[152:153] op_sel_hi:[1,0]
    v_pk_mul_f32 v[170:171], v[170:171], v[152:153] op_sel_hi:[1,0]
    v_pk_mul_f32 v[172:173], v[172:173], v[152:153] op_sel_hi:[1,0]
    v_pk_mul_f32 v[174:175], v[174:175], v[152:153] op_sel_hi:[1,0]
    v_cvt_pk_bf16_f32 v160, v160, v161
    v_cvt_pk_bf16_f32 v162, v162, v163
    v_cvt_pk_bf16_f32 v164, v164, v165
    v_cvt_pk_bf16_f32 v166, v166, v167
    v_cvt_pk_bf16_f32 v168, v168, v169
    v_cvt_pk_bf16_f32 v170, v170, v171
    v_cvt_pk_bf16_f32 v172, v172, v173
    v_cvt_pk_bf16_f32 v174, v174, v175
    v_accvgpr_write_b32 a80, v160
    v_accvgpr_write_b32 a81, v162
    v_accvgpr_write_b32 a82, v164
    v_accvgpr_write_b32 a83, v166
    v_accvgpr_write_b32 a84, v168
    v_accvgpr_write_b32 a85, v170
    v_accvgpr_write_b32 a86, v172
    v_accvgpr_write_b32 a87, v174
    v_lshlrev_b32 v160, 16, v88
    v_and_b32 v161, 0xffff0000, v88
    s_add_u32 s26, s24, 0x260000
    s_add_u32 m0, s29, 0x13000
    s_nop 0
    buffer_load_dwordx4 v136, s[16:19], s26 offen lds
    v_lshlrev_b32 v162, 16, v89
    v_and_b32 v163, 0xffff0000, v89
    v_lshlrev_b32 v164, 16, v90
    v_and_b32 v165, 0xffff0000, v90
    v_lshlrev_b32 v166, 16, v91
    v_and_b32 v167, 0xffff0000, v91
    v_lshlrev_b32 v168, 16, v92
    v_and_b32 v169, 0xffff0000, v92
    v_lshlrev_b32 v170, 16, v93
    v_and_b32 v171, 0xffff0000, v93
    v_lshlrev_b32 v172, 16, v94
    v_and_b32 v173, 0xffff0000, v94
    v_lshlrev_b32 v174, 16, v95
    v_and_b32 v175, 0xffff0000, v95
    v_pk_add_f32 v[160:161], v[160:161], v[154:155] op_sel_hi:[1,0] neg_lo:[0,1] neg_hi:[0,1]
    v_pk_add_f32 v[162:163], v[162:163], v[154:155] op_sel_hi:[1,0] neg_lo:[0,1] neg_hi:[0,1]
    v_pk_add_f32 v[164:165], v[164:165], v[154:155] op_sel_hi:[1,0] neg_lo:[0,1] neg_hi:[0,1]
    v_pk_add_f32 v[166:167], v[166:167], v[154:155] op_sel_hi:[1,0] neg_lo:[0,1] neg_hi:[0,1]
    v_pk_add_f32 v[168:169], v[168:169], v[154:155] op_sel_hi:[1,0] neg_lo:[0,1] neg_hi:[0,1]
    v_pk_add_f32 v[170:171], v[170:171], v[154:155] op_sel_hi:[1,0] neg_lo:[0,1] neg_hi:[0,1]
    v_pk_add_f32 v[172:173], v[172:173], v[154:155] op_sel_hi:[1,0] neg_lo:[0,1] neg_hi:[0,1]
    v_pk_add_f32 v[174:175], v[174:175], v[154:155] op_sel_hi:[1,0] neg_lo:[0,1] neg_hi:[0,1]
    v_cvt_pk_bf16_f32 v88, v160, v161
    v_cvt_pk_bf16_f32 v89, v162, v163
    v_cvt_pk_bf16_f32 v90, v164, v165
    v_cvt_pk_bf16_f32 v91, v166, v167
    v_cvt_pk_bf16_f32 v92, v168, v169
    v_cvt_pk_bf16_f32 v93, v170, v171
    v_cvt_pk_bf16_f32 v94, v172, v173
    v_cvt_pk_bf16_f32 v95, v174, v175
    v_lshlrev_b32 v160, 16, v88
    v_and_b32 v161, 0xffff0000, v88
    v_lshlrev_b32 v162, 16, v89
    v_and_b32 v163, 0xffff0000, v89
    v_lshlrev_b32 v164, 16, v90
    v_and_b32 v165, 0xffff0000, v90
    v_lshlrev_b32 v166, 16, v91
    v_and_b32 v167, 0xffff0000, v91
    v_lshlrev_b32 v168, 16, v92
    v_and_b32 v169, 0xffff0000, v92
    v_lshlrev_b32 v170, 16, v93
    v_and_b32 v171, 0xffff0000, v93
    v_lshlrev_b32 v172, 16, v94
    v_and_b32 v173, 0xffff0000, v94
    v_lshlrev_b32 v174, 16, v95
    v_and_b32 v175, 0xffff0000, v95
    v_pk_mul_f32 v[160:161], v[160:161], v[152:153] op_sel_hi:[1,0]
    v_pk_mul_f32 v[162:163], v[162:163], v[152:153] op_sel_hi:[1,0]
    v_pk_mul_f32 v[164:165], v[164:165], v[152:153] op_sel_hi:[1,0]
    v_pk_mul_f32 v[166:167], v[166:167], v[152:153] op_sel_hi:[1,0]
    s_add_u32 s26, s24, 0x280000
    s_add_u32 m0, s29, 0x14000
    s_nop 0
    buffer_load_dwordx4 v136, s[16:19], s26 offen lds
    v_pk_mul_f32 v[168:169], v[168:169], v[152:153] op_sel_hi:[1,0]
    v_pk_mul_f32 v[170:171], v[170:171], v[152:153] op_sel_hi:[1,0]
    v_pk_mul_f32 v[172:173], v[172:173], v[152:153] op_sel_hi:[1,0]
    v_pk_mul_f32 v[174:175], v[174:175], v[152:153] op_sel_hi:[1,0]
    v_cvt_pk_bf16_f32 v160, v160, v161
    v_cvt_pk_bf16_f32 v162, v162, v163
    v_cvt_pk_bf16_f32 v164, v164, v165
    v_cvt_pk_bf16_f32 v166, v166, v167
    v_cvt_pk_bf16_f32 v168, v168, v169
    v_cvt_pk_bf16_f32 v170, v170, v171
    v_cvt_pk_bf16_f32 v172, v172, v173
    v_cvt_pk_bf16_f32 v174, v174, v175
    v_accvgpr_write_b32 a88, v160
    v_accvgpr_write_b32 a89, v162
    v_accvgpr_write_b32 a90, v164
    v_accvgpr_write_b32 a91, v166
    v_accvgpr_write_b32 a92, v168
    v_accvgpr_write_b32 a93, v170
    v_accvgpr_write_b32 a94, v172
    v_accvgpr_write_b32 a95, v174
    v_lshlrev_b32 v160, 16, v96
    v_and_b32 v161, 0xffff0000, v96
    v_lshlrev_b32 v162, 16, v97
    v_and_b32 v163, 0xffff0000, v97
    v_lshlrev_b32 v164, 16, v98
    v_and_b32 v165, 0xffff0000, v98
    v_lshlrev_b32 v166, 16, v99
    v_and_b32 v167, 0xffff0000, v99
    v_lshlrev_b32 v168, 16, v100
    v_and_b32 v169, 0xffff0000, v100
    v_lshlrev_b32 v170, 16, v101
    v_and_b32 v171, 0xffff0000, v101
    v_lshlrev_b32 v172, 16, v102
    v_and_b32 v173, 0xffff0000, v102
    v_lshlrev_b32 v174, 16, v103
    v_and_b32 v175, 0xffff0000, v103
    v_pk_add_f32 v[160:161], v[160:161], v[154:155] op_sel_hi:[1,0] neg_lo:[0,1] neg_hi:[0,1]
    v_pk_add_f32 v[162:163], v[162:163], v[154:155] op_sel_hi:[1,0] neg_lo:[0,1] neg_hi:[0,1]
    v_pk_add_f32 v[164:165], v[164:165], v[154:155] op_sel_hi:[1,0] neg_lo:[0,1] neg_hi:[0,1]
    v_pk_add_f32 v[166:167], v[166:167], v[154:155] op_sel_hi:[1,0] neg_lo:[0,1] neg_hi:[0,1]
    v_pk_add_f32 v[168:169], v[168:169], v[154:155] op_sel_hi:[1,0] neg_lo:[0,1] neg_hi:[0,1]
    v_pk_add_f32 v[170:171], v[170:171], v[154:155] op_sel_hi:[1,0] neg_lo:[0,1] neg_hi:[0,1]
    v_pk_add_f32 v[172:173], v[172:173], v[154:155] op_sel_hi:[1,0] neg_lo:[0,1] neg_hi:[0,1]
    v_pk_add_f32 v[174:175], v[174:175], v[154:155] op_sel_hi:[1,0] neg_lo:[0,1] neg_hi:[0,1]
    v_cvt_pk_bf16_f32 v96, v160, v161
    v_cvt_pk_bf16_f32 v97, v162, v163
    v_cvt_pk_bf16_f32 v98, v164, v165
    v_cvt_pk_bf16_f32 v99, v166, v167
    v_cvt_pk_bf16_f32 v100, v168, v169
    v_cvt_pk_bf16_f32 v101, v170, v171
    s_add_u32 s26, s24, 0x2a0000
    s_add_u32 m0, s29, 0x15000
    s_nop 0
    buffer_load_dwordx4 v136, s[16:19], s26 offen lds
    v_cvt_pk_bf16_f32 v102, v172, v173
    v_cvt_pk_bf16_f32 v103, v174, v175
    v_lshlrev_b32 v160, 16, v96
    v_and_b32 v161, 0xffff0000, v96
    v_lshlrev_b32 v162, 16, v97
    v_and_b32 v163, 0xffff0000, v97
    v_lshlrev_b32 v164, 16, v98
    v_and_b32 v165, 0xffff0000, v98
    v_lshlrev_b32 v166, 16, v99
    v_and_b32 v167, 0xffff0000, v99
    v_lshlrev_b32 v168, 16, v100
    v_and_b32 v169, 0xffff0000, v100
    v_lshlrev_b32 v170, 16, v101
    v_and_b32 v171, 0xffff0000, v101
    v_lshlrev_b32 v172, 16, v102
    v_and_b32 v173, 0xffff0000, v102
    v_lshlrev_b32 v174, 16, v103
    v_and_b32 v175, 0xffff0000, v103
    v_pk_mul_f32 v[160:161], v[160:161], v[152:153] op_sel_hi:[1,0]
    v_pk_mul_f32 v[162:163], v[162:163], v[152:153] op_sel_hi:[1,0]
    v_pk_mul_f32 v[164:165], v[164:165], v[152:153] op_sel_hi:[1,0]
    v_pk_mul_f32 v[166:167], v[166:167], v[152:153] op_sel_hi:[1,0]
    v_pk_mul_f32 v[168:169], v[168:169], v[152:153] op_sel_hi:[1,0]
    v_pk_mul_f32 v[170:171], v[170:171], v[152:153] op_sel_hi:[1,0]
    v_pk_mul_f32 v[172:173], v[172:173], v[152:153] op_sel_hi:[1,0]
    v_pk_mul_f32 v[174:175], v[174:175], v[152:153] op_sel_hi:[1,0]
    v_cvt_pk_bf16_f32 v160, v160, v161
    v_cvt_pk_bf16_f32 v162, v162, v163
    v_cvt_pk_bf16_f32 v164, v164, v165
    v_cvt_pk_bf16_f32 v166, v166, v167
    v_cvt_pk_bf16_f32 v168, v168, v169
    v_cvt_pk_bf16_f32 v170, v170, v171
    v_cvt_pk_bf16_f32 v172, v172, v173
    v_cvt_pk_bf16_f32 v174, v174, v175
    v_accvgpr_write_b32 a96, v160
    v_accvgpr_write_b32 a97, v162
    v_accvgpr_write_b32 a98, v164
    v_accvgpr_write_b32 a99, v166
    v_accvgpr_write_b32 a100, v168
    v_accvgpr_write_b32 a101, v170
    v_accvgpr_write_b32 a102, v172
    v_accvgpr_write_b32 a103, v174
    v_lshlrev_b32 v160, 16, v104
    v_and_b32 v161, 0xffff0000, v104
    v_lshlrev_b32 v162, 16, v105
    v_and_b32 v163, 0xffff0000, v105
    v_lshlrev_b32 v164, 16, v106
    v_and_b32 v165, 0xffff0000, v106
    v_lshlrev_b32 v166, 16, v107
    v_and_b32 v167, 0xffff0000, v107
    s_add_u32 s26, s24, 0x2c0000
    s_add_u32 m0, s29, 0x16000
    s_nop 0
    buffer_load_dwordx4 v136, s[16:19], s26 offen lds
    v_lshlrev_b32 v168, 16, v108
    v_and_b32 v169, 0xffff0000, v108
    v_lshlrev_b32 v170, 16, v109
    v_and_b32 v171, 0xffff0000, v109
    v_lshlrev_b32 v172, 16, v110
    v_and_b32 v173, 0xffff0000, v110
    v_lshlrev_b32 v174, 16, v111
    v_and_b32 v175, 0xffff0000, v111
    v_pk_add_f32 v[160:161], v[160:161], v[154:155] op_sel_hi:[1,0] neg_lo:[0,1] neg_hi:[0,1]
    v_pk_add_f32 v[162:163], v[162:163], v[154:155] op_sel_hi:[1,0] neg_lo:[0,1] neg_hi:[0,1]
    v_pk_add_f32 v[164:165], v[164:165], v[154:155] op_sel_hi:[1,0] neg_lo:[0,1] neg_hi:[0,1]
    v_pk_add_f32 v[166:167], v[166:167], v[154:155] op_sel_hi:[1,0] neg_lo:[0,1] neg_hi:[0,1]
    v_pk_add_f32 v[168:169], v[168:169], v[154:155] op_sel_hi:[1,0] neg_lo:[0,1] neg_hi:[0,1]
    v_pk_add_f32 v[170:171], v[170:171], v[154:155] op_sel_hi:[1,0] neg_lo:[0,1] neg_hi:[0,1]
    v_pk_add_f32 v[172:173], v[172:173], v[154:155] op_sel_hi:[1,0] neg_lo:[0,1] neg_hi:[0,1]
    v_pk_add_f32 v[174:175], v[174:175], v[154:155] op_sel_hi:[1,0] neg_lo:[0,1] neg_hi:[0,1]
    v_cvt_pk_bf16_f32 v104, v160, v161
    v_cvt_pk_bf16_f32 v105, v162, v163
    v_cvt_pk_bf16_f32 v106, v164, v165
    v_cvt_pk_bf16_f32 v107, v166, v167
    v_cvt_pk_bf16_f32 v108, v168, v169
    v_cvt_pk_bf16_f32 v109, v170, v171
    v_cvt_pk_bf16_f32 v110, v172, v173
    v_cvt_pk_bf16_f32 v111, v174, v175
    v_lshlrev_b32 v160, 16, v104
    v_and_b32 v161, 0xffff0000, v104
    v_lshlrev_b32 v162, 16, v105
    v_and_b32 v163, 0xffff0000, v105
    v_lshlrev_b32 v164, 16, v106
    v_and_b32 v165, 0xffff0000, v106
    v_lshlrev_b32 v166, 16, v107
    v_and_b32 v167, 0xffff0000, v107
    v_lshlrev_b32 v168, 16, v108
    v_and_b32 v169, 0xffff0000, v108
    v_lshlrev_b32 v170, 16, v109
    v_and_b32 v171, 0xffff0000, v109
    v_lshlrev_b32 v172, 16, v110
    v_and_b32 v173, 0xffff0000, v110
    v_lshlrev_b32 v174, 16, v111
    v_and_b32 v175, 0xffff0000, v111
    v_pk_mul_f32 v[160:161], v[160:161], v[152:153] op_sel_hi:[1,0]
    v_pk_mul_f32 v[162:163], v[162:163], v[152:153] op_sel_hi:[1,0]
    v_pk_mul_f32 v[164:165], v[164:165], v[152:153] op_sel_hi:[1,0]
    v_pk_mul_f32 v[166:167], v[166:167], v[152:153] op_sel_hi:[1,0]
    v_pk_mul_f32 v[168:169], v[168:169], v[152:153] op_sel_hi:[1,0]
    v_pk_mul_f32 v[170:171], v[170:171], v[152:153] op_sel_hi:[1,0]
    v_pk_mul_f32 v[172:173], v[172:173], v[152:153] op_sel_hi:[1,0]
    v_pk_mul_f32 v[174:175], v[174:175], v[152:153] op_sel_hi:[1,0]
    v_cvt_pk_bf16_f32 v160, v160, v161
    v_cvt_pk_bf16_f32 v162, v162, v163
    s_add_u32 s26, s24, 0x2e0000
    s_add_u32 m0, s29, 0x17000
    s_nop 0
    buffer_load_dwordx4 v136, s[16:19], s26 offen lds
    v_cvt_pk_bf16_f32 v164, v164, v165
    v_cvt_pk_bf16_f32 v166, v166, v167
    v_cvt_pk_bf16_f32 v168, v168, v169
    v_cvt_pk_bf16_f32 v170, v170, v171
    v_cvt_pk_bf16_f32 v172, v172, v173
    v_cvt_pk_bf16_f32 v174, v174, v175
    v_accvgpr_write_b32 a104, v160
    v_accvgpr_write_b32 a105, v162
    v_accvgpr_write_b32 a106, v164
    v_accvgpr_write_b32 a107, v166
    v_accvgpr_write_b32 a108, v168
    v_accvgpr_write_b32 a109, v170
    v_accvgpr_write_b32 a110, v172
    v_accvgpr_write_b32 a111, v174
    v_lshlrev_b32 v160, 16, v112
    v_and_b32 v161, 0xffff0000, v112
    v_lshlrev_b32 v162, 16, v113
    v_and_b32 v163, 0xffff0000, v113
    v_lshlrev_b32 v164, 16, v114
    v_and_b32 v165, 0xffff0000, v114
    v_lshlrev_b32 v166, 16, v115
    v_and_b32 v167, 0xffff0000, v115
    v_lshlrev_b32 v168, 16, v116
    v_and_b32 v169, 0xffff0000, v116
    v_lshlrev_b32 v170, 16, v117
    v_and_b32 v171, 0xffff0000, v117
    v_lshlrev_b32 v172, 16, v118
    v_and_b32 v173, 0xffff0000, v118
    v_lshlrev_b32 v174, 16, v119
    v_and_b32 v175, 0xffff0000, v119
    v_pk_add_f32 v[160:161], v[160:161], v[154:155] op_sel_hi:[1,0] neg_lo:[0,1] neg_hi:[0,1]
    v_pk_add_f32 v[162:163], v[162:163], v[154:155] op_sel_hi:[1,0] neg_lo:[0,1] neg_hi:[0,1]
    v_pk_add_f32 v[164:165], v[164:165], v[154:155] op_sel_hi:[1,0] neg_lo:[0,1] neg_hi:[0,1]
    v_pk_add_f32 v[166:167], v[166:167], v[154:155] op_sel_hi:[1,0] neg_lo:[0,1] neg_hi:[0,1]
    v_pk_add_f32 v[168:169], v[168:169], v[154:155] op_sel_hi:[1,0] neg_lo:[0,1] neg_hi:[0,1]
    v_pk_add_f32 v[170:171], v[170:171], v[154:155] op_sel_hi:[1,0] neg_lo:[0,1] neg_hi:[0,1]
    v_pk_add_f32 v[172:173], v[172:173], v[154:155] op_sel_hi:[1,0] neg_lo:[0,1] neg_hi:[0,1]
    v_pk_add_f32 v[174:175], v[174:175], v[154:155] op_sel_hi:[1,0] neg_lo:[0,1] neg_hi:[0,1]
    v_cvt_pk_bf16_f32 v112, v160, v161
    v_cvt_pk_bf16_f32 v113, v162, v163
    v_cvt_pk_bf16_f32 v114, v164, v165
    v_cvt_pk_bf16_f32 v115, v166, v167
    v_cvt_pk_bf16_f32 v116, v168, v169
    v_cvt_pk_bf16_f32 v117, v170, v171
    v_cvt_pk_bf16_f32 v118, v172, v173
    v_cvt_pk_bf16_f32 v119, v174, v175
    v_lshlrev_b32 v160, 16, v112
    v_and_b32 v161, 0xffff0000, v112
    v_lshlrev_b32 v162, 16, v113
    v_and_b32 v163, 0xffff0000, v113
    v_lshlrev_b32 v138, 2, v137
    v_lshlrev_b32 v138, 3, v137
    s_sub_u32 s26, s101, 96
    s_lshl_b32 s26, s26, 2
    s_add_u32 s26, s26, s21
    s_min_u32 s26, s26, 512
    s_lshl_b32 s26, s26, 13
    s_cmp_eq_u32 s41, 0
    s_cselect_b32 s6, 0x400000, 0
    s_mov_b32 s7, 0x20000
    s_mov_b32 s4, s66
    s_and_b32 s5, s67, 0xffff
    buffer_load_dword v143, v138, s[4:7], s26 offen
    v_lshlrev_b32 v164, 16, v114
    v_and_b32 v165, 0xffff0000, v114
    v_lshlrev_b32 v166, 16, v115
    v_and_b32 v167, 0xffff0000, v115
    v_lshlrev_b32 v168, 16, v116
    v_and_b32 v169, 0xffff0000, v116
    v_lshlrev_b32 v170, 16, v117
    v_and_b32 v171, 0xffff0000, v117
    v_lshlrev_b32 v172, 16, v118
    v_and_b32 v173, 0xffff0000, v118
    v_lshlrev_b32 v174, 16, v119
    v_and_b32 v175, 0xffff0000, v119
    v_pk_mul_f32 v[160:161], v[160:161], v[152:153] op_sel_hi:[1,0]
    v_pk_mul_f32 v[162:163], v[162:163], v[152:153] op_sel_hi:[1,0]
    v_pk_mul_f32 v[164:165], v[164:165], v[152:153] op_sel_hi:[1,0]
    v_pk_mul_f32 v[166:167], v[166:167], v[152:153] op_sel_hi:[1,0]
    v_pk_mul_f32 v[168:169], v[168:169], v[152:153] op_sel_hi:[1,0]
    v_pk_mul_f32 v[170:171], v[170:171], v[152:153] op_sel_hi:[1,0]
    v_pk_mul_f32 v[172:173], v[172:173], v[152:153] op_sel_hi:[1,0]
    v_pk_mul_f32 v[174:175], v[174:175], v[152:153] op_sel_hi:[1,0]
    v_cvt_pk_bf16_f32 v160, v160, v161
    v_cvt_pk_bf16_f32 v162, v162, v163
    v_cvt_pk_bf16_f32 v164, v164, v165
    v_cvt_pk_bf16_f32 v166, v166, v167
    v_cvt_pk_bf16_f32 v168, v168, v169
    v_cvt_pk_bf16_f32 v170, v170, v171
    v_cvt_pk_bf16_f32 v172, v172, v173
    v_cvt_pk_bf16_f32 v174, v174, v175
    v_accvgpr_write_b32 a112, v160
    v_accvgpr_write_b32 a113, v162
    v_accvgpr_write_b32 a114, v164
    v_accvgpr_write_b32 a115, v166
    v_accvgpr_write_b32 a116, v168
    v_accvgpr_write_b32 a117, v170
    v_accvgpr_write_b32 a118, v172
    v_accvgpr_write_b32 a119, v174
    v_lshlrev_b32 v160, 16, v120
    v_and_b32 v161, 0xffff0000, v120
    v_lshlrev_b32 v162, 16, v121
    v_and_b32 v163, 0xffff0000, v121
    v_lshlrev_b32 v164, 16, v122
    v_and_b32 v165, 0xffff0000, v122
    v_lshlrev_b32 v166, 16, v123
    v_and_b32 v167, 0xffff0000, v123
    v_lshlrev_b32 v168, 16, v124
    v_and_b32 v169, 0xffff0000, v124
    v_lshlrev_b32 v170, 16, v125
    v_and_b32 v171, 0xffff0000, v125
    v_lshlrev_b32 v172, 16, v126
    v_and_b32 v173, 0xffff0000, v126
    v_lshlrev_b32 v174, 16, v127
    v_and_b32 v175, 0xffff0000, v127
    v_pk_add_f32 v[160:161], v[160:161], v[154:155] op_sel_hi:[1,0] neg_lo:[0,1] neg_hi:[0,1]
    v_pk_add_f32 v[162:163], v[162:163], v[154:155] op_sel_hi:[1,0] neg_lo:[0,1] neg_hi:[0,1]
    v_pk_add_f32 v[164:165], v[164:165], v[154:155] op_sel_hi:[1,0] neg_lo:[0,1] neg_hi:[0,1]
    v_pk_add_f32 v[166:167], v[166:167], v[154:155] op_sel_hi:[1,0] neg_lo:[0,1] neg_hi:[0,1]
    v_pk_add_f32 v[168:169], v[168:169], v[154:155] op_sel_hi:[1,0] neg_lo:[0,1] neg_hi:[0,1]
    v_pk_add_f32 v[170:171], v[170:171], v[154:155] op_sel_hi:[1,0] neg_lo:[0,1] neg_hi:[0,1]
    v_pk_add_f32 v[172:173], v[172:173], v[154:155] op_sel_hi:[1,0] neg_lo:[0,1] neg_hi:[0,1]
    v_pk_add_f32 v[174:175], v[174:175], v[154:155] op_sel_hi:[1,0] neg_lo:[0,1] neg_hi:[0,1]
    v_cvt_pk_bf16_f32 v120, v160, v161
    v_cvt_pk_bf16_f32 v121, v162, v163
    v_cvt_pk_bf16_f32 v122, v164, v165
    v_cvt_pk_bf16_f32 v123, v166, v167
    v_cvt_pk_bf16_f32 v124, v168, v169
    v_cvt_pk_bf16_f32 v125, v170, v171
    v_cvt_pk_bf16_f32 v126, v172, v173
    v_cvt_pk_bf16_f32 v127, v174, v175
    v_lshlrev_b32 v160, 16, v120
    v_and_b32 v161, 0xffff0000, v120
    v_lshlrev_b32 v162, 16, v121
    v_and_b32 v163, 0xffff0000, v121
    v_lshlrev_b32 v164, 16, v122
    v_and_b32 v165, 0xffff0000, v122
    v_lshlrev_b32 v166, 16, v123
    v_and_b32 v167, 0xffff0000, v123
    v_lshlrev_b32 v168, 16, v124
    v_and_b32 v169, 0xffff0000, v124
    v_lshlrev_b32 v170, 16, v125
    v_and_b32 v171, 0xffff0000, v125
    v_lshlrev_b32 v172, 16, v126
    v_and_b32 v173, 0xffff0000, v126
    v_lshlrev_b32 v174, 16, v127
    v_and_b32 v175, 0xffff0000, v127
    v_pk_mul_f32 v[160:161], v[160:161], v[152:153] op_sel_hi:[1,0]
    v_pk_mul_f32 v[162:163], v[162:163], v[152:153] op_sel_hi:[1,0]
    v_pk_mul_f32 v[164:165], v[164:165], v[152:153] op_sel_hi:[1,0]
    v_pk_mul_f32 v[166:167], v[166:167], v[152:153] op_sel_hi:[1,0]
    v_pk_mul_f32 v[168:169], v[168:169], v[152:153] op_sel_hi:[1,0]
    v_pk_mul_f32 v[170:171], v[170:171], v[152:153] op_sel_hi:[1,0]
    v_pk_mul_f32 v[172:173], v[172:173], v[152:153] op_sel_hi:[1,0]
    v_pk_mul_f32 v[174:175], v[174:175], v[152:153] op_sel_hi:[1,0]
    v_cvt_pk_bf16_f32 v160, v160, v161
    v_cvt_pk_bf16_f32 v162, v162, v163
    v_cvt_pk_bf16_f32 v164, v164, v165
    v_cvt_pk_bf16_f32 v166, v166, v167
    v_cvt_pk_bf16_f32 v168, v168, v169
    v_cvt_pk_bf16_f32 v170, v170, v171
    v_cvt_pk_bf16_f32 v172, v172, v173
    v_cvt_pk_bf16_f32 v174, v174, v175
    v_accvgpr_write_b32 a120, v160
    v_accvgpr_write_b32 a121, v162
    v_accvgpr_write_b32 a122, v164
    v_accvgpr_write_b32 a123, v166
    v_accvgpr_write_b32 a124, v168
    v_accvgpr_write_b32 a125, v170
    v_accvgpr_write_b32 a126, v172
    v_accvgpr_write_b32 a127, v174
    buffer_load_dwordx2 v[140:141], off, s[92:95], 0 offset:36 sc1
    s_nop 3
L_p1_unit:
    s_cmp_ge_u32 s38, 96
    s_cbranch_scc1 L_p1_end
    s_lshr_b32 s26, s38, 5
    s_add_u32 s27, s26, 1
    s_lshl_b32 s25, s27, 24
    s_lshl_b32 s27, s20, 2
    s_add_u32 s27, s27, s21
    s_lshl_b32 s27, s27, 5
    s_and_b32 s28, s38, 31
    s_add_u32 s27, s27, s28
    s_lshl_b32 s27, s27, 13
    s_add_u32 s25, s25, s27
    s_lshr_b32 s26, s38, 5
    s_cmp_eq_u32 s26, 1
    s_cbranch_scc1 L_p1_v
    s_waitcnt vmcnt(16)
    s_barrier
    ds_read_b64_tr_b16 v[64:65], v128
    ds_read_b64_tr_b16 v[66:67], v128 offset:1024
    ds_read_b64_tr_b16 v[68:69], v129
    ds_read_b64_tr_b16 v[70:71], v129 offset:1024
    ds_read_b64_tr_b16 v[72:73], v130
    ds_read_b64_tr_b16 v[74:75], v130 offset:1024
    ds_read_b64_tr_b16 v[76:77], v131
    ds_read_b64_tr_b16 v[78:79], v131 offset:1024
    ds_read_b64_tr_b16 v[80:81], v132
    ds_read_b64_tr_b16 v[82:83], v132 offset:1024
    ds_read_b64_tr_b16 v[84:85], v133
    ds_read_b64_tr_b16 v[86:87], v133 offset:1024
    ds_read_b64_tr_b16 v[88:89], v134
    ds_read_b64_tr_b16 v[90:91], v134 offset:1024
    s_waitcnt lgkmcnt(12)
    v_mfma_f32_16x16x32_bf16 v[0:3], v[64:67], a[0:3], 0
    ds_read_b64_tr_b16 v[92:93], v135
    v_mfma_f32_16x16x32_bf16 v[4:7], v[64:67], a[64:67], 0
    ds_read_b64_tr_b16 v[94:95], v135 offset:1024
    s_add_u32 s26, s24, 0x300000
    s_add_u32 m0, s29, 0x18000
    s_nop 0
    buffer_load_dwordx4 v136, s[16:19], s26 offen lds
    s_waitcnt lgkmcnt(12)
    v_mfma_f32_16x16x32_bf16 v[8:11], v[68:71], a[0:3], 0
    ds_read_b64_tr_b16 v[96:97], v128 offset:8192
    v_mfma_f32_16x16x32_bf16 v[12:15], v[68:71], a[64:67], 0
    ds_read_b64_tr_b16 v[98:99], v128 offset:9216
    s_add_u32 s26, s24, 0x320000
    s_add_u32 m0, s29, 0x19000
    s_nop 0
    buffer_load_dwordx4 v136, s[16:19], s26 offen lds
    s_waitcnt lgkmcnt(12)
    v_mfma_f32_16x16x32_bf16 v[16:19], v[72:75], a[0:3], 0
    ds_read_b64_tr_b16 v[100:101], v129 offset:8192
    v_mfma_f32_16x16x32_bf16 v[20:23], v[72:75], a[64:67], 0
    ds_read_b64_tr_b16 v[102:103], v129 offset:9216
    s_add_u32 s26, s24, 0x340000
    s_add_u32 m0, s29, 0x1a000
    s_nop 0
    buffer_load_dwordx4 v136, s[16:19], s26 offen lds
    s_waitcnt lgkmcnt(12)
    v_mfma_f32_16x16x32_bf16 v[24:27], v[76:79], a[0:3], 0
    ds_read_b64_tr_b16 v[104:105], v130 offset:8192
    v_mfma_f32_16x16x32_bf16 v[28:31], v[76:79], a[64:67], 0
    ds_read_b64_tr_b16 v[106:107], v130 offset:9216
    s_add_u32 s26, s24, 0x360000
    s_add_u32 m0, s29, 0x1b000
    s_nop 0
    buffer_load_dwordx4 v136, s[16:19], s26 offen lds
    s_waitcnt lgkmcnt(12)
    v_mfma_f32_16x16x32_bf16 v[32:35], v[80:83], a[0:3], 0
    ds_read_b64_tr_b16 v[108:109], v131 offset:8192
    v_mfma_f32_16x16x32_bf16 v[36:39], v[80:83], a[64:67], 0
    ds_read_b64_tr_b16 v[110:111], v131 offset:9216
    s_add_u32 s26, s24, 0x380000
    s_add_u32 m0, s29, 0x1c000
    s_nop 0
    buffer_load_dwordx4 v136, s[16:19], s26 offen lds
    s_waitcnt lgkmcnt(12)
    v_mfma_f32_16x16x32_bf16 v[40:43], v[84:87], a[0:3], 0
    ds_read_b64_tr_b16 v[112:113], v132 offset:8192
    v_mfma_f32_16x16x32_bf16 v[44:47], v[84:87], a[64:67], 0
    ds_read_b64_tr_b16 v[114:115], v132 offset:9216
    s_add_u32 s26, s24, 0x3a0000
    s_add_u32 m0, s29, 0x1d000
    s_nop 0
    buffer_load_dwordx4 v136, s[16:19], s26 offen lds
    s_waitcnt lgkmcnt(12)
    v_mfma_f32_16x16x32_bf16 v[48:51], v[88:91], a[0:3], 0
    ds_read_b64_tr_b16 v[116:117], v133 offset:8192
    v_mfma_f32_16x16x32_bf16 v[52:55], v[88:91], a[64:67], 0
    ds_read_b64_tr_b16 v[118:119], v133 offset:9216
    s_add_u32 s26, s24, 0x3c0000
    s_add_u32 m0, s29, 0x1e000
    s_nop 0
    buffer_load_dwordx4 v136, s[16:19], s26 offen lds
    s_waitcnt lgkmcnt(12)
    v_mfma_f32_16x16x32_bf16 v[56:59], v[92:95], a[0:3], 0
    ds_read_b64_tr_b16 v[120:121], v134 offset:8192
    v_mfma_f32_16x16x32_bf16 v[60:63], v[92:95], a[64:67], 0
    ds_read_b64_tr_b16 v[122:123], v134 offset:9216
    s_add_u32 s26, s24, 0x3e0000
    s_add_u32 m0, s29, 0x1f000
    s_nop 0
    buffer_load_dwordx4 v136, s[16:19], s26 offen lds
    s_waitcnt lgkmcnt(12)
    v_mfma_f32_16x16x32_bf16 v[0:3], v[96:99], a[4:7], v[0:3]
    ds_read_b64_tr_b16 v[124:125], v135 offset:8192
    v_mfma_f32_16x16x32_bf16 v[4:7], v[96:99], a[68:71], v[4:7]
    ds_read_b64_tr_b16 v[126:127], v135 offset:9216
    s_waitcnt lgkmcnt(12)
    v_mfma_f32_16x16x32_bf16 v[8:11], v[100:103], a[4:7], v[8:11]
    ds_read_b64_tr_b16 v[64:65], v128 offset:16384
    v_mfma_f32_16x16x32_bf16 v[12:15], v[100:103], a[68:71], v[12:15]
    ds_read_b64_tr_b16 v[66:67], v128 offset:17408
    s_waitcnt lgkmcnt(12)
    v_mfma_f32_16x16x32_bf16 v[16:19], v[104:107], a[4:7], v[16:19]
    ds_read_b64_tr_b16 v[68:69], v129 offset:16384
    v_mfma_f32_16x16x32_bf16 v[20:23], v[104:107], a[68:71], v[20:23]
    ds_read_b64_tr_b16 v[70:71], v129 offset:17408
    s_waitcnt lgkmcnt(12)
    v_mfma_f32_16x16x32_bf16 v[24:27], v[108:111], a[4:7], v[24:27]
    ds_read_b64_tr_b16 v[72:73], v130 offset:16384
    v_mfma_f32_16x16x32_bf16 v[28:31], v[108:111], a[68:71], v[28:31]
    ds_read_b64_tr_b16 v[74:75], v130 offset:17408
    s_waitcnt lgkmcnt(12)
    v_mfma_f32_16x16x32_bf16 v[32:35], v[112:115], a[4:7], v[32:35]
    ds_read_b64_tr_b16 v[76:77], v131 offset:16384
    v_mfma_f32_16x16x32_bf16 v[36:39], v[112:115], a[68:71], v[36:39]
    ds_read_b64_tr_b16 v[78:79], v131 offset:17408
    s_waitcnt lgkmcnt(12)
    v_mfma_f32_16x16x32_bf16 v[40:43], v[116:119], a[4:7], v[40:43]
    ds_read_b64_tr_b16 v[80:81], v132 offset:16384
    v_mfma_f32_16x16x32_bf16 v[44:47], v[116:119], a[68:71], v[44:47]
    ds_read_b64_tr_b16 v[82:83], v132 offset:17408
    s_waitcnt lgkmcnt(12)
    v_mfma_f32_16x16x32_bf16 v[48:51], v[120:123], a[4:7], v[48:51]
    ds_read_b64_tr_b16 v[84:85], v133 offset:16384
    v_mfma_f32_16x16x32_bf16 v[52:55], v[120:123], a[68:71], v[52:55]
    ds_read_b64_tr_b16 v[86:87], v133 offset:17408
    s_waitcnt lgkmcnt(12)
    v_mfma_f32_16x16x32_bf16 v[56:59], v[124:127], a[4:7], v[56:59]
    ds_read_b64_tr_b16 v[88:89], v134 offset:16384
    v_mfma_f32_16x16x32_bf16 v[60:63], v[124:127], a[68:71], v[60:63]
    ds_read_b64_tr_b16 v[90:91], v134 offset:17408
    s_waitcnt lgkmcnt(12)
    v_mfma_f32_16x16x32_bf16 v[0:3], v[64:67], a[8:11], v[0:3]
    ds_read_b64_tr_b16 v[92:93], v135 offset:16384
    v_mfma_f32_16x16x32_bf16 v[4:7], v[64:67], a[72:75], v[4:7]
    ds_read_b64_tr_b16 v[94:95], v135 offset:17408
    s_waitcnt lgkmcnt(12)
    v_mfma_f32_16x16x32_bf16 v[8:11], v[68:71], a[8:11], v[8:11]
    ds_read_b64_tr_b16 v[96:97], v128 offset:24576
    v_mfma_f32_16x16x32_bf16 v[12:15], v[68:71], a[72:75], v[12:15]
    ds_read_b64_tr_b16 v[98:99], v128 offset:25600
    s_waitcnt lgkmcnt(12)
    v_mfma_f32_16x16x32_bf16 v[16:19], v[72:75], a[8:11], v[16:19]
    ds_read_b64_tr_b16 v[100:101], v129 offset:24576
    v_mfma_f32_16x16x32_bf16 v[20:23], v[72:75], a[72:75], v[20:23]
    ds_read_b64_tr_b16 v[102:103], v129 offset:25600
    s_waitcnt lgkmcnt(12)
    v_mfma_f32_16x16x32_bf16 v[24:27], v[76:79], a[8:11], v[24:27]
    ds_read_b64_tr_b16 v[104:105], v130 offset:24576
    v_mfma_f32_16x16x32_bf16 v[28:31], v[76:79], a[72:75], v[28:31]
    ds_read_b64_tr_b16 v[106:107], v130 offset:25600
    s_waitcnt lgkmcnt(12)
    v_mfma_f32_16x16x32_bf16 v[32:35], v[80:83], a[8:11], v[32:35]
    ds_read_b64_tr_b16 v[108:109], v131 offset:24576
    v_mfma_f32_16x16x32_bf16 v[36:39], v[80:83], a[72:75], v[36:39]
    ds_read_b64_tr_b16 v[110:111], v131 offset:25600
    s_waitcnt lgkmcnt(12)
    v_mfma_f32_16x16x32_bf16 v[40:43], v[84:87], a[8:11], v[40:43]
    ds_read_b64_tr_b16 v[112:113], v132 offset:24576
    v_mfma_f32_16x16x32_bf16 v[44:47], v[84:87], a[72:75], v[44:47]
    ds_read_b64_tr_b16 v[114:115], v132 offset:25600
    s_waitcnt lgkmcnt(12)
    v_mfma_f32_16x16x32_bf16 v[48:51], v[88:91], a[8:11], v[48:51]
    ds_read_b64_tr_b16 v[116:117], v133 offset:24576
    v_mfma_f32_16x16x32_bf16 v[52:55], v[88:91], a[72:75], v[52:55]
    ds_read_b64_tr_b16 v[118:119], v133 offset:25600
    s_waitcnt lgkmcnt(12)
    v_mfma_f32_16x16x32_bf16 v[56:59], v[92:95], a[8:11], v[56:59]
    ds_read_b64_tr_b16 v[120:121], v134 offset:24576
    v_mfma_f32_16x16x32_bf16 v[60:63], v[92:95], a[72:75], v[60:63]
    ds_read_b64_tr_b16 v[122:123], v134 offset:25600
    s_waitcnt lgkmcnt(12)
    v_mfma_f32_16x16x32_bf16 v[0:3], v[96:99], a[12:15], v[0:3]
    ds_read_b64_tr_b16 v[124:125], v135 offset:24576
    v_mfma_f32_16x16x32_bf16 v[4:7], v[96:99], a[76:79], v[4:7]
    ds_read_b64_tr_b16 v[126:127], v135 offset:25600
    s_waitcnt lgkmcnt(12)
    v_mfma_f32_16x16x32_bf16 v[8:11], v[100:103], a[12:15], v[8:11]
    v_mfma_f32_16x16x32_bf16 v[12:15], v[100:103], a[76:79], v[12:15]
    s_waitcnt lgkmcnt(10)
    v_mfma_f32_16x16x32_bf16 v[16:19], v[104:107], a[12:15], v[16:19]
    v_mfma_f32_16x16x32_bf16 v[20:23], v[104:107], a[76:79], v[20:23]
    s_waitcnt lgkmcnt(8)
    v_mfma_f32_16x16x32_bf16 v[24:27], v[108:111], a[12:15], v[24:27]
    v_mfma_f32_16x16x32_bf16 v[28:31], v[108:111], a[76:79], v[28:31]
    s_waitcnt lgkmcnt(6)
    v_mfma_f32_16x16x32_bf16 v[32:35], v[112:115], a[12:15], v[32:35]
    v_mfma_f32_16x16x32_bf16 v[36:39], v[112:115], a[76:79], v[36:39]
    s_waitcnt lgkmcnt(4)
    v_mfma_f32_16x16x32_bf16 v[40:43], v[116:119], a[12:15], v[40:43]
    v_mfma_f32_16x16x32_bf16 v[44:47], v[116:119], a[76:79], v[44:47]
    s_waitcnt lgkmcnt(2)
    v_mfma_f32_16x16x32_bf16 v[48:51], v[120:123], a[12:15], v[48:51]
    v_mfma_f32_16x16x32_bf16 v[52:55], v[120:123], a[76:79], v[52:55]
    s_waitcnt lgkmcnt(0)
    v_mfma_f32_16x16x32_bf16 v[56:59], v[124:127], a[12:15], v[56:59]
    v_mfma_f32_16x16x32_bf16 v[60:63], v[124:127], a[76:79], v[60:63]
    s_waitcnt vmcnt(16)
    s_barrier
    ds_read_b64_tr_b16 v[64:65], v128 offset:32768
    ds_read_b64_tr_b16 v[66:67], v128 offset:33792
    ds_read_b64_tr_b16 v[68:69], v129 offset:32768
    ds_read_b64_tr_b16 v[70:71], v129 offset:33792
    ds_read_b64_tr_b16 v[72:73], v130 offset:32768
    ds_read_b64_tr_b16 v[74:75], v130 offset:33792
    ds_read_b64_tr_b16 v[76:77], v131 offset:32768
    ds_read_b64_tr_b16 v[78:79], v131 offset:33792
    ds_read_b64_tr_b16 v[80:81], v132 offset:32768
    ds_read_b64_tr_b16 v[82:83], v132 offset:33792
    ds_read_b64_tr_b16 v[84:85], v133 offset:32768
    ds_read_b64_tr_b16 v[86:87], v133 offset:33792
    ds_read_b64_tr_b16 v[88:89], v134 offset:32768
    ds_read_b64_tr_b16 v[90:91], v134 offset:33792
    s_add_u32 s39, s39, s37
    s_lshr_b32 s26, s39, 5
    s_cmp_eq_u32 s26, 0
    s_cselect_b64 s[16:17], s[62:63], s[60:61]
    s_cmp_eq_u32 s26, 1
    s_cselect_b64 s[16:17], s[64:65], s[16:17]
    s_and_b32 s17, s17, 0xffff
    s_cmp_lt_u32 s39, 96
    s_cselect_b32 s18, 0x400000, 0
    s_and_b32 s24, s39, 31
    s_lshl_b32 s24, s24, 8
    s_waitcnt lgkmcnt(12)
    v_mfma_f32_16x16x32_bf16 v[0:3], v[64:67], a[16:19], v[0:3]
    ds_read_b64_tr_b16 v[92:93], v135 offset:32768
    v_mfma_f32_16x16x32_bf16 v[4:7], v[64:67], a[80:83], v[4:7]
    ds_read_b64_tr_b16 v[94:95], v135 offset:33792
    s_add_u32 s26, s24, 0x0
    s_add_u32 m0, s29, 0x0
    s_nop 0
    buffer_load_dwordx4 v136, s[16:19], s26 offen lds
    s_waitcnt lgkmcnt(12)
    v_mfma_f32_16x16x32_bf16 v[8:11], v[68:71], a[16:19], v[8:11]
    ds_read_b64_tr_b16 v[96:97], v128 offset:40960
    v_mfma_f32_16x16x32_bf16 v[12:15], v[68:71], a[80:83], v[12:15]
    ds_read_b64_tr_b16 v[98:99], v128 offset:41984
    s_add_u32 s26, s24, 0x20000
    s_add_u32 m0, s29, 0x1000
    s_nop 0
    buffer_load_dwordx4 v136, s[16:19], s26 offen lds
    s_waitcnt lgkmcnt(12)
    v_mfma_f32_16x16x32_bf16 v[16:19], v[72:75], a[16:19], v[16:19]
    ds_read_b64_tr_b16 v[100:101], v129 offset:40960
    v_mfma_f32_16x16x32_bf16 v[20:23], v[72:75], a[80:83], v[20:23]
    ds_read_b64_tr_b16 v[102:103], v129 offset:41984
    s_add_u32 s26, s24, 0x40000
    s_add_u32 m0, s29, 0x2000
    s_nop 0
    buffer_load_dwordx4 v136, s[16:19], s26 offen lds
    s_waitcnt lgkmcnt(12)
    v_mfma_f32_16x16x32_bf16 v[24:27], v[76:79], a[16:19], v[24:27]
    ds_read_b64_tr_b16 v[104:105], v130 offset:40960
    v_mfma_f32_16x16x32_bf16 v[28:31], v[76:79], a[80:83], v[28:31]
    ds_read_b64_tr_b16 v[106:107], v130 offset:41984
    s_add_u32 s26, s24, 0x60000
    s_add_u32 m0, s29, 0x3000
    s_nop 0
    buffer_load_dwordx4 v136, s[16:19], s26 offen lds
    s_waitcnt lgkmcnt(12)
    v_mfma_f32_16x16x32_bf16 v[32:35], v[80:83], a[16:19], v[32:35]
    ds_read_b64_tr_b16 v[108:109], v131 offset:40960
    v_mfma_f32_16x16x32_bf16 v[36:39], v[80:83], a[80:83], v[36:39]
    ds_read_b64_tr_b16 v[110:111], v131 offset:41984
    s_add_u32 s26, s24, 0x80000
    s_add_u32 m0, s29, 0x4000
    s_nop 0
    buffer_load_dwordx4 v136, s[16:19], s26 offen lds
    s_waitcnt lgkmcnt(12)
    v_mfma_f32_16x16x32_bf16 v[40:43], v[84:87], a[16:19], v[40:43]
    ds_read_b64_tr_b16 v[112:113], v132 offset:40960
    v_mfma_f32_16x16x32_bf16 v[44:47], v[84:87], a[80:83], v[44:47]
    ds_read_b64_tr_b16 v[114:115], v132 offset:41984
    s_add_u32 s26, s24, 0xa0000
    s_add_u32 m0, s29, 0x5000
    s_nop 0
    buffer_load_dwordx4 v136, s[16:19], s26 offen lds
    s_waitcnt lgkmcnt(12)
    v_mfma_f32_16x16x32_bf16 v[48:51], v[88:91], a[16:19], v[48:51]
    ds_read_b64_tr_b16 v[116:117], v133 offset:40960
    v_mfma_f32_16x16x32_bf16 v[52:55], v[88:91], a[80:83], v[52:55]
    ds_read_b64_tr_b16 v[118:119], v133 offset:41984
    s_add_u32 s26, s24, 0xc0000
    s_add_u32 m0, s29, 0x6000
    s_nop 0
    buffer_load_dwordx4 v136, s[16:19], s26 offen lds
    s_waitcnt lgkmcnt(12)
    v_mfma_f32_16x16x32_bf16 v[56:59], v[92:95], a[16:19], v[56:59]
    ds_read_b64_tr_b16 v[120:121], v134 offset:40960
    v_mfma_f32_16x16x32_bf16 v[60:63], v[92:95], a[80:83], v[60:63]
    ds_read_b64_tr_b16 v[122:123], v134 offset:41984
    s_add_u32 s26, s24, 0xe0000
    s_add_u32 m0, s29, 0x7000
    s_nop 0
    buffer_load_dwordx4 v136, s[16:19], s26 offen lds
    s_waitcnt lgkmcnt(12)
    v_mfma_f32_16x16x32_bf16 v[0:3], v[96:99], a[20:23], v[0:3]
    ds_read_b64_tr_b16 v[124:125], v135 offset:40960
    v_mfma_f32_16x16x32_bf16 v[4:7], v[96:99], a[84:87], v[4:7]
    ds_read_b64_tr_b16 v[126:127], v135 offset:41984
    s_waitcnt lgkmcnt(12)
    v_mfma_f32_16x16x32_bf16 v[8:11], v[100:103], a[20:23], v[8:11]
    ds_read_b64_tr_b16 v[64:65], v128 offset:49152
    v_mfma_f32_16x16x32_bf16 v[12:15], v[100:103], a[84:87], v[12:15]
    ds_read_b64_tr_b16 v[66:67], v128 offset:50176
    s_waitcnt lgkmcnt(12)
    v_mfma_f32_16x16x32_bf16 v[16:19], v[104:107], a[20:23], v[16:19]
    ds_read_b64_tr_b16 v[68:69], v129 offset:49152
    v_mfma_f32_16x16x32_bf16 v[20:23], v[104:107], a[84:87], v[20:23]
    ds_read_b64_tr_b16 v[70:71], v129 offset:50176
    s_waitcnt lgkmcnt(12)
    v_mfma_f32_16x16x32_bf16 v[24:27], v[108:111], a[20:23], v[24:27]
    ds_read_b64_tr_b16 v[72:73], v130 offset:49152
    v_mfma_f32_16x16x32_bf16 v[28:31], v[108:111], a[84:87], v[28:31]
    ds_read_b64_tr_b16 v[74:75], v130 offset:50176
    s_waitcnt lgkmcnt(12)
    v_mfma_f32_16x16x32_bf16 v[32:35], v[112:115], a[20:23], v[32:35]
    ds_read_b64_tr_b16 v[76:77], v131 offset:49152
    v_mfma_f32_16x16x32_bf16 v[36:39], v[112:115], a[84:87], v[36:39]
    ds_read_b64_tr_b16 v[78:79], v131 offset:50176
    s_waitcnt lgkmcnt(12)
    v_mfma_f32_16x16x32_bf16 v[40:43], v[116:119], a[20:23], v[40:43]
    ds_read_b64_tr_b16 v[80:81], v132 offset:49152
    v_mfma_f32_16x16x32_bf16 v[44:47], v[116:119], a[84:87], v[44:47]
    ds_read_b64_tr_b16 v[82:83], v132 offset:50176
    s_waitcnt lgkmcnt(12)
    v_mfma_f32_16x16x32_bf16 v[48:51], v[120:123], a[20:23], v[48:51]
    ds_read_b64_tr_b16 v[84:85], v133 offset:49152
    v_mfma_f32_16x16x32_bf16 v[52:55], v[120:123], a[84:87], v[52:55]
    ds_read_b64_tr_b16 v[86:87], v133 offset:50176
    s_waitcnt lgkmcnt(12)
    v_mfma_f32_16x16x32_bf16 v[56:59], v[124:127], a[20:23], v[56:59]
    ds_read_b64_tr_b16 v[88:89], v134 offset:49152
    v_mfma_f32_16x16x32_bf16 v[60:63], v[124:127], a[84:87], v[60:63]
    ds_read_b64_tr_b16 v[90:91], v134 offset:50176
    s_waitcnt lgkmcnt(12)
    v_mfma_f32_16x16x32_bf16 v[0:3], v[64:67], a[24:27], v[0:3]
    ds_read_b64_tr_b16 v[92:93], v135 offset:49152
    v_mfma_f32_16x16x32_bf16 v[4:7], v[64:67], a[88:91], v[4:7]
    ds_read_b64_tr_b16 v[94:95], v135 offset:50176
    s_waitcnt lgkmcnt(12)
    v_mfma_f32_16x16x32_bf16 v[8:11], v[68:71], a[24:27], v[8:11]
    ds_read_b64_tr_b16 v[96:97], v128 offset:57344
    v_mfma_f32_16x16x32_bf16 v[12:15], v[68:71], a[88:91], v[12:15]
    ds_read_b64_tr_b16 v[98:99], v128 offset:58368
    s_waitcnt lgkmcnt(12)
    v_mfma_f32_16x16x32_bf16 v[16:19], v[72:75], a[24:27], v[16:19]
    ds_read_b64_tr_b16 v[100:101], v129 offset:57344
    v_mfma_f32_16x16x32_bf16 v[20:23], v[72:75], a[88:91], v[20:23]
    ds_read_b64_tr_b16 v[102:103], v129 offset:58368
    s_waitcnt lgkmcnt(12)
    v_mfma_f32_16x16x32_bf16 v[24:27], v[76:79], a[24:27], v[24:27]
    ds_read_b64_tr_b16 v[104:105], v130 offset:57344
    v_mfma_f32_16x16x32_bf16 v[28:31], v[76:79], a[88:91], v[28:31]
    ds_read_b64_tr_b16 v[106:107], v130 offset:58368
    s_waitcnt lgkmcnt(12)
    v_mfma_f32_16x16x32_bf16 v[32:35], v[80:83], a[24:27], v[32:35]
    ds_read_b64_tr_b16 v[108:109], v131 offset:57344
    v_mfma_f32_16x16x32_bf16 v[36:39], v[80:83], a[88:91], v[36:39]
    ds_read_b64_tr_b16 v[110:111], v131 offset:58368
    s_waitcnt lgkmcnt(12)
    v_mfma_f32_16x16x32_bf16 v[40:43], v[84:87], a[24:27], v[40:43]
    ds_read_b64_tr_b16 v[112:113], v132 offset:57344
    v_mfma_f32_16x16x32_bf16 v[44:47], v[84:87], a[88:91], v[44:47]
    ds_read_b64_tr_b16 v[114:115], v132 offset:58368
    s_waitcnt lgkmcnt(12)
    v_mfma_f32_16x16x32_bf16 v[48:51], v[88:91], a[24:27], v[48:51]
    ds_read_b64_tr_b16 v[116:117], v133 offset:57344
    v_mfma_f32_16x16x32_bf16 v[52:55], v[88:91], a[88:91], v[52:55]
    ds_read_b64_tr_b16 v[118:119], v133 offset:58368
    s_waitcnt lgkmcnt(12)
    v_mfma_f32_16x16x32_bf16 v[56:59], v[92:95], a[24:27], v[56:59]
    ds_read_b64_tr_b16 v[120:121], v134 offset:57344
    v_mfma_f32_16x16x32_bf16 v[60:63], v[92:95], a[88:91], v[60:63]
    ds_read_b64_tr_b16 v[122:123], v134 offset:58368
    s_waitcnt lgkmcnt(12)
    v_mfma_f32_16x16x32_bf16 v[0:3], v[96:99], a[28:31], v[0:3]
    ds_read_b64_tr_b16 v[124:125], v135 offset:57344
    v_mfma_f32_16x16x32_bf16 v[4:7], v[96:99], a[92:95], v[4:7]
    ds_read_b64_tr_b16 v[126:127], v135 offset:58368
    s_waitcnt lgkmcnt(12)
    v_mfma_f32_16x16x32_bf16 v[8:11], v[100:103], a[28:31], v[8:11]
    v_mfma_f32_16x16x32_bf16 v[12:15], v[100:103], a[92:95], v[12:15]
    s_waitcnt lgkmcnt(10)
    v_mfma_f32_16x16x32_bf16 v[16:19], v[104:107], a[28:31], v[16:19]
    v_mfma_f32_16x16x32_bf16 v[20:23], v[104:107], a[92:95], v[20:23]
    s_waitcnt lgkmcnt(8)
    v_mfma_f32_16x16x32_bf16 v[24:27], v[108:111], a[28:31], v[24:27]
    v_mfma_f32_16x16x32_bf16 v[28:31], v[108:111], a[92:95], v[28:31]
    s_waitcnt lgkmcnt(6)
    v_mfma_f32_16x16x32_bf16 v[32:35], v[112:115], a[28:31], v[32:35]
    v_mfma_f32_16x16x32_bf16 v[36:39], v[112:115], a[92:95], v[36:39]
    s_waitcnt lgkmcnt(4)
    v_mfma_f32_16x16x32_bf16 v[40:43], v[116:119], a[28:31], v[40:43]
    v_mfma_f32_16x16x32_bf16 v[44:47], v[116:119], a[92:95], v[44:47]
    s_waitcnt lgkmcnt(2)
    v_mfma_f32_16x16x32_bf16 v[48:51], v[120:123], a[28:31], v[48:51]
    v_mfma_f32_16x16x32_bf16 v[52:55], v[120:123], a[92:95], v[52:55]
    s_waitcnt lgkmcnt(0)
    v_mfma_f32_16x16x32_bf16 v[56:59], v[124:127], a[28:31], v[56:59]
    v_mfma_f32_16x16x32_bf16 v[60:63], v[124:127], a[92:95], v[60:63]
    v_xor_b32 v128, 0x10000, v128
    v_xor_b32 v129, 0x10000, v129
    v_xor_b32 v130, 0x10000, v130
    v_xor_b32 v131, 0x10000, v131
    v_xor_b32 v132, 0x10000, v132
    v_xor_b32 v133, 0x10000, v133
    v_xor_b32 v134, 0x10000, v134
    v_xor_b32 v135, 0x10000, v135
    s_waitcnt vmcnt(16)
    s_barrier
    ds_read_b64_tr_b16 v[64:65], v128
    ds_read_b64_tr_b16 v[66:67], v128 offset:1024
    ds_read_b64_tr_b16 v[68:69], v129
    ds_read_b64_tr_b16 v[70:71], v129 offset:1024
    ds_read_b64_tr_b16 v[72:73], v130
    ds_read_b64_tr_b16 v[74:75], v130 offset:1024
    ds_read_b64_tr_b16 v[76:77], v131
    ds_read_b64_tr_b16 v[78:79], v131 offset:1024
    ds_read_b64_tr_b16 v[80:81], v132
    ds_read_b64_tr_b16 v[82:83], v132 offset:1024
    ds_read_b64_tr_b16 v[84:85], v133
    ds_read_b64_tr_b16 v[86:87], v133 offset:1024
    ds_read_b64_tr_b16 v[88:89], v134
    ds_read_b64_tr_b16 v[90:91], v134 offset:1024
    s_cmp_eq_u32 s40, 0
    s_cbranch_scc1 L_nopf_90
    s_cmp_lg_u32 s87, 0
    s_cbranch_scc1 L_modeok_91
    v_readfirstlane_b32 s96, v140
    v_readfirstlane_b32 s97, v141
    s_nop 0
    s_cmp_lg_u32 s97, 0
    s_cselect_b32 s87, s96, 0
    s_cmp_eq_u32 s87, 1
    s_cbranch_scc1 L_modeok_91
    s_mov_b32 s96, 0
L_mode_92:
    buffer_load_dwordx2 v[140:141], off, s[92:95], 0 offset:36 sc1
    s_waitcnt vmcnt(0)
    v_readfirstlane_b32 s87, v140
    v_readfirstlane_b32 s97, v141
    s_nop 0
    s_min_u32 s97, s97, s87
    s_cmp_lg_u32 s97, 0
    s_cbranch_scc1 L_moded_93
    s_sleep 4
    s_add_u32 s96, s96, 1
    s_cmp_lg_u32 s96, 0x100
    s_cbranch_scc1 L_modef_94
    v_mov_b32 v140, 2
    v_mov_b32 v141, 0
    s_mov_b64 exec, 1
    buffer_atomic_cmpswap v[140:141], off, s[92:95], 0 offset:36
    s_mov_b64 exec, -1
L_modef_94:
    s_cmp_lt_u32 s96, 0x10000
    s_cbranch_scc1 L_mode_92
L_moded_93:
    s_cmp_lg_u32 s87, 1
    s_cbranch_scc1 L_fallback
L_modeok_91:
    s_cmp_lg_u32 s100, 0
    s_cbranch_scc1 L_flag_95
    v_mov_b32 v138, 1
    s_mov_b64 exec, 1
    buffer_store_dword v138, off, s[8:11], s40 sc1
    s_mov_b64 exec, -1
L_flag_95:
    s_mov_b32 s40, 0
L_nopf_90:
    s_waitcnt lgkmcnt(12)
    v_mfma_f32_16x16x32_bf16 v[0:3], v[64:67], a[32:35], v[0:3]
    ds_read_b64_tr_b16 v[92:93], v135
    v_mfma_f32_16x16x32_bf16 v[4:7], v[64:67], a[96:99], v[4:7]
    ds_read_b64_tr_b16 v[94:95], v135 offset:1024
    s_add_u32 s26, s24, 0x100000
    s_add_u32 m0, s29, 0x8000
    s_nop 0
    buffer_load_dwordx4 v136, s[16:19], s26 offen lds
    s_waitcnt lgkmcnt(12)
    v_mfma_f32_16x16x32_bf16 v[8:11], v[68:71], a[32:35], v[8:11]
    ds_read_b64_tr_b16 v[96:97], v128 offset:8192
    v_mfma_f32_16x16x32_bf16 v[12:15], v[68:71], a[96:99], v[12:15]
    ds_read_b64_tr_b16 v[98:99], v128 offset:9216
    s_add_u32 s26, s24, 0x120000
    s_add_u32 m0, s29, 0x9000
    s_nop 0
    buffer_load_dwordx4 v136, s[16:19], s26 offen lds
    s_waitcnt lgkmcnt(12)
    v_mfma_f32_16x16x32_bf16 v[16:19], v[72:75], a[32:35], v[16:19]
    ds_read_b64_tr_b16 v[100:101], v129 offset:8192
    v_mfma_f32_16x16x32_bf16 v[20:23], v[72:75], a[96:99], v[20:23]
    ds_read_b64_tr_b16 v[102:103], v129 offset:9216
    s_add_u32 s26, s24, 0x140000
    s_add_u32 m0, s29, 0xa000
    s_nop 0
    buffer_load_dwordx4 v136, s[16:19], s26 offen lds
    s_waitcnt lgkmcnt(12)
    v_mfma_f32_16x16x32_bf16 v[24:27], v[76:79], a[32:35], v[24:27]
    ds_read_b64_tr_b16 v[104:105], v130 offset:8192
    v_mfma_f32_16x16x32_bf16 v[28:31], v[76:79], a[96:99], v[28:31]
    ds_read_b64_tr_b16 v[106:107], v130 offset:9216
    s_add_u32 s26, s24, 0x160000
    s_add_u32 m0, s29, 0xb000
    s_nop 0
    buffer_load_dwordx4 v136, s[16:19], s26 offen lds
    s_waitcnt lgkmcnt(12)
    v_mfma_f32_16x16x32_bf16 v[32:35], v[80:83], a[32:35], v[32:35]
    ds_read_b64_tr_b16 v[108:109], v131 offset:8192
    v_mfma_f32_16x16x32_bf16 v[36:39], v[80:83], a[96:99], v[36:39]
    ds_read_b64_tr_b16 v[110:111], v131 offset:9216
    s_add_u32 s26, s24, 0x180000
    s_add_u32 m0, s29, 0xc000
    s_nop 0
    buffer_load_dwordx4 v136, s[16:19], s26 offen lds
    s_waitcnt lgkmcnt(12)
    v_mfma_f32_16x16x32_bf16 v[40:43], v[84:87], a[32:35], v[40:43]
    ds_read_b64_tr_b16 v[112:113], v132 offset:8192
    v_mfma_f32_16x16x32_bf16 v[44:47], v[84:87], a[96:99], v[44:47]
    ds_read_b64_tr_b16 v[114:115], v132 offset:9216
    s_add_u32 s26, s24, 0x1a0000
    s_add_u32 m0, s29, 0xd000
    s_nop 0
    buffer_load_dwordx4 v136, s[16:19], s26 offen lds
    s_waitcnt lgkmcnt(12)
    v_mfma_f32_16x16x32_bf16 v[48:51], v[88:91], a[32:35], v[48:51]
    ds_read_b64_tr_b16 v[116:117], v133 offset:8192
    v_mfma_f32_16x16x32_bf16 v[52:55], v[88:91], a[96:99], v[52:55]
    ds_read_b64_tr_b16 v[118:119], v133 offset:9216
    s_add_u32 s26, s24, 0x1c0000
    s_add_u32 m0, s29, 0xe000
    s_nop 0
    buffer_load_dwordx4 v136, s[16:19], s26 offen lds
    s_waitcnt lgkmcnt(12)
    v_mfma_f32_16x16x32_bf16 v[56:59], v[92:95], a[32:35], v[56:59]
    ds_read_b64_tr_b16 v[120:121], v134 offset:8192
    v_mfma_f32_16x16x32_bf16 v[60:63], v[92:95], a[96:99], v[60:63]
    ds_read_b64_tr_b16 v[122:123], v134 offset:9216
    s_add_u32 s26, s24, 0x1e0000
    s_add_u32 m0, s29, 0xf000
    s_nop 0
    buffer_load_dwordx4 v136, s[16:19], s26 offen lds
    s_waitcnt lgkmcnt(12)
    v_mfma_f32_16x16x32_bf16 v[0:3], v[96:99], a[36:39], v[0:3]
    ds_read_b64_tr_b16 v[124:125], v135 offset:8192
    v_mfma_f32_16x16x32_bf16 v[4:7], v[96:99], a[100:103], v[4:7]
    ds_read_b64_tr_b16 v[126:127], v135 offset:9216
    s_waitcnt lgkmcnt(12)
    v_mfma_f32_16x16x32_bf16 v[8:11], v[100:103], a[36:39], v[8:11]
    ds_read_b64_tr_b16 v[64:65], v128 offset:16384
    v_mfma_f32_16x16x32_bf16 v[12:15], v[100:103], a[100:103], v[12:15]
    ds_read_b64_tr_b16 v[66:67], v128 offset:17408
    s_waitcnt lgkmcnt(12)
    v_mfma_f32_16x16x32_bf16 v[16:19], v[104:107], a[36:39], v[16:19]
    ds_read_b64_tr_b16 v[68:69], v129 offset:16384
    v_mfma_f32_16x16x32_bf16 v[20:23], v[104:107], a[100:103], v[20:23]
    ds_read_b64_tr_b16 v[70:71], v129 offset:17408
    s_waitcnt lgkmcnt(12)
    v_mfma_f32_16x16x32_bf16 v[24:27], v[108:111], a[36:39], v[24:27]
    ds_read_b64_tr_b16 v[72:73], v130 offset:16384
    v_mfma_f32_16x16x32_bf16 v[28:31], v[108:111], a[100:103], v[28:31]
    ds_read_b64_tr_b16 v[74:75], v130 offset:17408
    s_waitcnt lgkmcnt(12)
    v_mfma_f32_16x16x32_bf16 v[32:35], v[112:115], a[36:39], v[32:35]
    ds_read_b64_tr_b16 v[76:77], v131 offset:16384
    v_mfma_f32_16x16x32_bf16 v[36:39], v[112:115], a[100:103], v[36:39]
    ds_read_b64_tr_b16 v[78:79], v131 offset:17408
    s_waitcnt lgkmcnt(12)
    v_mfma_f32_16x16x32_bf16 v[40:43], v[116:119], a[36:39], v[40:43]
    ds_read_b64_tr_b16 v[80:81], v132 offset:16384
    v_mfma_f32_16x16x32_bf16 v[44:47], v[116:119], a[100:103], v[44:47]
    ds_read_b64_tr_b16 v[82:83], v132 offset:17408
    s_waitcnt lgkmcnt(12)
    v_mfma_f32_16x16x32_bf16 v[48:51], v[120:123], a[36:39], v[48:51]
    ds_read_b64_tr_b16 v[84:85], v133 offset:16384
    v_mfma_f32_16x16x32_bf16 v[52:55], v[120:123], a[100:103], v[52:55]
    ds_read_b64_tr_b16 v[86:87], v133 offset:17408
    s_waitcnt lgkmcnt(12)
    v_mfma_f32_16x16x32_bf16 v[56:59], v[124:127], a[36:39], v[56:59]
    ds_read_b64_tr_b16 v[88:89], v134 offset:16384
    v_mfma_f32_16x16x32_bf16 v[60:63], v[124:127], a[100:103], v[60:63]
    ds_read_b64_tr_b16 v[90:91], v134 offset:17408
    s_waitcnt lgkmcnt(12)
    v_mfma_f32_16x16x32_bf16 v[0:3], v[64:67], a[40:43], v[0:3]
    ds_read_b64_tr_b16 v[92:93], v135 offset:16384
    v_mfma_f32_16x16x32_bf16 v[4:7], v[64:67], a[104:107], v[4:7]
    ds_read_b64_tr_b16 v[94:95], v135 offset:17408
    s_waitcnt lgkmcnt(12)
    v_mfma_f32_16x16x32_bf16 v[8:11], v[68:71], a[40:43], v[8:11]
    ds_read_b64_tr_b16 v[96:97], v128 offset:24576
    v_mfma_f32_16x16x32_bf16 v[12:15], v[68:71], a[104:107], v[12:15]
    ds_read_b64_tr_b16 v[98:99], v128 offset:25600
    s_waitcnt lgkmcnt(12)
    v_mfma_f32_16x16x32_bf16 v[16:19], v[72:75], a[40:43], v[16:19]
    ds_read_b64_tr_b16 v[100:101], v129 offset:24576
    v_mfma_f32_16x16x32_bf16 v[20:23], v[72:75], a[104:107], v[20:23]
    ds_read_b64_tr_b16 v[102:103], v129 offset:25600
    s_waitcnt lgkmcnt(12)
    v_mfma_f32_16x16x32_bf16 v[24:27], v[76:79], a[40:43], v[24:27]
    ds_read_b64_tr_b16 v[104:105], v130 offset:24576
    v_mfma_f32_16x16x32_bf16 v[28:31], v[76:79], a[104:107], v[28:31]
    ds_read_b64_tr_b16 v[106:107], v130 offset:25600
    s_waitcnt lgkmcnt(12)
    v_mfma_f32_16x16x32_bf16 v[32:35], v[80:83], a[40:43], v[32:35]
    ds_read_b64_tr_b16 v[108:109], v131 offset:24576
    v_mfma_f32_16x16x32_bf16 v[36:39], v[80:83], a[104:107], v[36:39]
    ds_read_b64_tr_b16 v[110:111], v131 offset:25600
    s_waitcnt lgkmcnt(12)
    v_mfma_f32_16x16x32_bf16 v[40:43], v[84:87], a[40:43], v[40:43]
    ds_read_b64_tr_b16 v[112:113], v132 offset:24576
    v_mfma_f32_16x16x32_bf16 v[44:47], v[84:87], a[104:107], v[44:47]
    ds_read_b64_tr_b16 v[114:115], v132 offset:25600
    s_waitcnt lgkmcnt(12)
    v_mfma_f32_16x16x32_bf16 v[48:51], v[88:91], a[40:43], v[48:51]
    ds_read_b64_tr_b16 v[116:117], v133 offset:24576
    v_mfma_f32_16x16x32_bf16 v[52:55], v[88:91], a[104:107], v[52:55]
    ds_read_b64_tr_b16 v[118:119], v133 offset:25600
    s_waitcnt lgkmcnt(12)
    v_mfma_f32_16x16x32_bf16 v[56:59], v[92:95], a[40:43], v[56:59]
    ds_read_b64_tr_b16 v[120:121], v134 offset:24576
    v_mfma_f32_16x16x32_bf16 v[60:63], v[92:95], a[104:107], v[60:63]
    ds_read_b64_tr_b16 v[122:123], v134 offset:25600
    s_waitcnt lgkmcnt(12)
    v_mfma_f32_16x16x32_bf16 v[0:3], v[96:99], a[44:47], v[0:3]
    ds_read_b64_tr_b16 v[124:125], v135 offset:24576
    v_mfma_f32_16x16x32_bf16 v[4:7], v[96:99], a[108:111], v[4:7]
    ds_read_b64_tr_b16 v[126:127], v135 offset:25600
    s_waitcnt lgkmcnt(12)
    v_mfma_f32_16x16x32_bf16 v[8:11], v[100:103], a[44:47], v[8:11]
    v_mfma_f32_16x16x32_bf16 v[12:15], v[100:103], a[108:111], v[12:15]
    s_waitcnt lgkmcnt(10)
    v_mfma_f32_16x16x32_bf16 v[16:19], v[104:107], a[44:47], v[16:19]
    v_mfma_f32_16x16x32_bf16 v[20:23], v[104:107], a[108:111], v[20:23]
    s_waitcnt lgkmcnt(8)
    v_mfma_f32_16x16x32_bf16 v[24:27], v[108:111], a[44:47], v[24:27]
    v_mfma_f32_16x16x32_bf16 v[28:31], v[108:111], a[108:111], v[28:31]
    s_waitcnt lgkmcnt(6)
    v_mfma_f32_16x16x32_bf16 v[32:35], v[112:115], a[44:47], v[32:35]
    v_mfma_f32_16x16x32_bf16 v[36:39], v[112:115], a[108:111], v[36:39]
    s_waitcnt lgkmcnt(4)
    v_mfma_f32_16x16x32_bf16 v[40:43], v[116:119], a[44:47], v[40:43]
    v_mfma_f32_16x16x32_bf16 v[44:47], v[116:119], a[108:111], v[44:47]
    s_waitcnt lgkmcnt(2)
    v_mfma_f32_16x16x32_bf16 v[48:51], v[120:123], a[44:47], v[48:51]
    v_mfma_f32_16x16x32_bf16 v[52:55], v[120:123], a[108:111], v[52:55]
    s_waitcnt lgkmcnt(0)
    v_mfma_f32_16x16x32_bf16 v[56:59], v[124:127], a[44:47], v[56:59]
    v_mfma_f32_16x16x32_bf16 v[60:63], v[124:127], a[108:111], v[60:63]
    s_waitcnt vmcnt(16)
    s_barrier
    ds_read_b64_tr_b16 v[64:65], v128 offset:32768
    ds_read_b64_tr_b16 v[66:67], v128 offset:33792
    ds_read_b64_tr_b16 v[68:69], v129 offset:32768
    ds_read_b64_tr_b16 v[70:71], v129 offset:33792
    ds_read_b64_tr_b16 v[72:73], v130 offset:32768
    ds_read_b64_tr_b16 v[74:75], v130 offset:33792
    ds_read_b64_tr_b16 v[76:77], v131 offset:32768
    ds_read_b64_tr_b16 v[78:79], v131 offset:33792
    ds_read_b64_tr_b16 v[80:81], v132 offset:32768
    ds_read_b64_tr_b16 v[82:83], v132 offset:33792
    ds_read_b64_tr_b16 v[84:85], v133 offset:32768
    ds_read_b64_tr_b16 v[86:87], v133 offset:33792
    ds_read_b64_tr_b16 v[88:89], v134 offset:32768
    ds_read_b64_tr_b16 v[90:91], v134 offset:33792
    s_waitcnt lgkmcnt(12)
    v_mfma_f32_16x16x32_bf16 v[0:3], v[64:67], a[48:51], v[0:3]
    ds_read_b64_tr_b16 v[92:93], v135 offset:32768
    v_mfma_f32_16x16x32_bf16 v[4:7], v[64:67], a[112:115], v[4:7]
    ds_read_b64_tr_b16 v[94:95], v135 offset:33792
    s_add_u32 s26, s24, 0x200000
    s_add_u32 m0, s29, 0x10000
    s_nop 0
    buffer_load_dwordx4 v136, s[16:19], s26 offen lds
    s_waitcnt lgkmcnt(12)
    v_mfma_f32_16x16x32_bf16 v[8:11], v[68:71], a[48:51], v[8:11]
    ds_read_b64_tr_b16 v[96:97], v128 offset:40960
    v_mfma_f32_16x16x32_bf16 v[12:15], v[68:71], a[112:115], v[12:15]
    ds_read_b64_tr_b16 v[98:99], v128 offset:41984
    s_add_u32 s26, s24, 0x220000
    s_add_u32 m0, s29, 0x11000
    s_nop 0
    buffer_load_dwordx4 v136, s[16:19], s26 offen lds
    s_waitcnt lgkmcnt(12)
    v_mfma_f32_16x16x32_bf16 v[16:19], v[72:75], a[48:51], v[16:19]
    ds_read_b64_tr_b16 v[100:101], v129 offset:40960
    v_mfma_f32_16x16x32_bf16 v[20:23], v[72:75], a[112:115], v[20:23]
    ds_read_b64_tr_b16 v[102:103], v129 offset:41984
    s_add_u32 s26, s24, 0x240000
    s_add_u32 m0, s29, 0x12000
    s_nop 0
    buffer_load_dwordx4 v136, s[16:19], s26 offen lds
    s_waitcnt lgkmcnt(12)
    v_mfma_f32_16x16x32_bf16 v[24:27], v[76:79], a[48:51], v[24:27]
    ds_read_b64_tr_b16 v[104:105], v130 offset:40960
    v_mfma_f32_16x16x32_bf16 v[28:31], v[76:79], a[112:115], v[28:31]
    ds_read_b64_tr_b16 v[106:107], v130 offset:41984
    s_add_u32 s26, s24, 0x260000
    s_add_u32 m0, s29, 0x13000
    s_nop 0
    buffer_load_dwordx4 v136, s[16:19], s26 offen lds
    s_waitcnt lgkmcnt(12)
    v_mfma_f32_16x16x32_bf16 v[32:35], v[80:83], a[48:51], v[32:35]
    ds_read_b64_tr_b16 v[108:109], v131 offset:40960
    v_mfma_f32_16x16x32_bf16 v[36:39], v[80:83], a[112:115], v[36:39]
    ds_read_b64_tr_b16 v[110:111], v131 offset:41984
    s_add_u32 s26, s24, 0x280000
    s_add_u32 m0, s29, 0x14000
    s_nop 0
    buffer_load_dwordx4 v136, s[16:19], s26 offen lds
    s_waitcnt lgkmcnt(12)
    v_mfma_f32_16x16x32_bf16 v[40:43], v[84:87], a[48:51], v[40:43]
    ds_read_b64_tr_b16 v[112:113], v132 offset:40960
    v_mfma_f32_16x16x32_bf16 v[44:47], v[84:87], a[112:115], v[44:47]
    ds_read_b64_tr_b16 v[114:115], v132 offset:41984
    s_add_u32 s26, s24, 0x2a0000
    s_add_u32 m0, s29, 0x15000
    s_nop 0
    buffer_load_dwordx4 v136, s[16:19], s26 offen lds
    s_waitcnt lgkmcnt(12)
    v_mfma_f32_16x16x32_bf16 v[48:51], v[88:91], a[48:51], v[48:51]
    ds_read_b64_tr_b16 v[116:117], v133 offset:40960
    v_mfma_f32_16x16x32_bf16 v[52:55], v[88:91], a[112:115], v[52:55]
    ds_read_b64_tr_b16 v[118:119], v133 offset:41984
    s_add_u32 s26, s24, 0x2c0000
    s_add_u32 m0, s29, 0x16000
    s_nop 0
    buffer_load_dwordx4 v136, s[16:19], s26 offen lds
    s_waitcnt lgkmcnt(12)
    v_mfma_f32_16x16x32_bf16 v[56:59], v[92:95], a[48:51], v[56:59]
    ds_read_b64_tr_b16 v[120:121], v134 offset:40960
    v_mfma_f32_16x16x32_bf16 v[60:63], v[92:95], a[112:115], v[60:63]
    ds_read_b64_tr_b16 v[122:123], v134 offset:41984
    s_add_u32 s26, s24, 0x2e0000
    s_add_u32 m0, s29, 0x17000
    s_nop 0
    buffer_load_dwordx4 v136, s[16:19], s26 offen lds
    s_waitcnt lgkmcnt(12)
    v_mfma_f32_16x16x32_bf16 v[0:3], v[96:99], a[52:55], v[0:3]
    ds_read_b64_tr_b16 v[124:125], v135 offset:40960
    v_mfma_f32_16x16x32_bf16 v[4:7], v[96:99], a[116:119], v[4:7]
    ds_read_b64_tr_b16 v[126:127], v135 offset:41984
    s_waitcnt lgkmcnt(12)
    v_mfma_f32_16x16x32_bf16 v[8:11], v[100:103], a[52:55], v[8:11]
    ds_read_b64_tr_b16 v[64:65], v128 offset:49152
    v_mfma_f32_16x16x32_bf16 v[12:15], v[100:103], a[116:119], v[12:15]
    ds_read_b64_tr_b16 v[66:67], v128 offset:50176
    s_waitcnt lgkmcnt(12)
    v_mfma_f32_16x16x32_bf16 v[16:19], v[104:107], a[52:55], v[16:19]
    ds_read_b64_tr_b16 v[68:69], v129 offset:49152
    v_mfma_f32_16x16x32_bf16 v[20:23], v[104:107], a[116:119], v[20:23]
    ds_read_b64_tr_b16 v[70:71], v129 offset:50176
    s_waitcnt lgkmcnt(12)
    v_mfma_f32_16x16x32_bf16 v[24:27], v[108:111], a[52:55], v[24:27]
    ds_read_b64_tr_b16 v[72:73], v130 offset:49152
    v_mfma_f32_16x16x32_bf16 v[28:31], v[108:111], a[116:119], v[28:31]
    ds_read_b64_tr_b16 v[74:75], v130 offset:50176
    s_waitcnt lgkmcnt(12)
    v_mfma_f32_16x16x32_bf16 v[32:35], v[112:115], a[52:55], v[32:35]
    ds_read_b64_tr_b16 v[76:77], v131 offset:49152
    v_mfma_f32_16x16x32_bf16 v[36:39], v[112:115], a[116:119], v[36:39]
    ds_read_b64_tr_b16 v[78:79], v131 offset:50176
    s_waitcnt lgkmcnt(12)
    v_mfma_f32_16x16x32_bf16 v[40:43], v[116:119], a[52:55], v[40:43]
    ds_read_b64_tr_b16 v[80:81], v132 offset:49152
    v_mfma_f32_16x16x32_bf16 v[44:47], v[116:119], a[116:119], v[44:47]
    ds_read_b64_tr_b16 v[82:83], v132 offset:50176
    s_waitcnt lgkmcnt(12)
    v_mfma_f32_16x16x32_bf16 v[48:51], v[120:123], a[52:55], v[48:51]
    ds_read_b64_tr_b16 v[84:85], v133 offset:49152
    v_mfma_f32_16x16x32_bf16 v[52:55], v[120:123], a[116:119], v[52:55]
    ds_read_b64_tr_b16 v[86:87], v133 offset:50176
    s_waitcnt lgkmcnt(12)
    v_mfma_f32_16x16x32_bf16 v[56:59], v[124:127], a[52:55], v[56:59]
    ds_read_b64_tr_b16 v[88:89], v134 offset:49152
    v_mfma_f32_16x16x32_bf16 v[60:63], v[124:127], a[116:119], v[60:63]
    ds_read_b64_tr_b16 v[90:91], v134 offset:50176
    s_waitcnt lgkmcnt(12)
    v_mfma_f32_16x16x32_bf16 v[0:3], v[64:67], a[56:59], v[0:3]
    ds_read_b64_tr_b16 v[92:93], v135 offset:49152
    v_mfma_f32_16x16x32_bf16 v[4:7], v[64:67], a[120:123], v[4:7]
    ds_read_b64_tr_b16 v[94:95], v135 offset:50176
    s_waitcnt lgkmcnt(12)
    v_mfma_f32_16x16x32_bf16 v[8:11], v[68:71], a[56:59], v[8:11]
    ds_read_b64_tr_b16 v[96:97], v128 offset:57344
    v_mfma_f32_16x16x32_bf16 v[12:15], v[68:71], a[120:123], v[12:15]
    ds_read_b64_tr_b16 v[98:99], v128 offset:58368
    s_waitcnt lgkmcnt(12)
    v_mfma_f32_16x16x32_bf16 v[16:19], v[72:75], a[56:59], v[16:19]
    ds_read_b64_tr_b16 v[100:101], v129 offset:57344
    v_mfma_f32_16x16x32_bf16 v[20:23], v[72:75], a[120:123], v[20:23]
    ds_read_b64_tr_b16 v[102:103], v129 offset:58368
    s_waitcnt lgkmcnt(12)
    v_mfma_f32_16x16x32_bf16 v[24:27], v[76:79], a[56:59], v[24:27]
    ds_read_b64_tr_b16 v[104:105], v130 offset:57344
    v_mfma_f32_16x16x32_bf16 v[28:31], v[76:79], a[120:123], v[28:31]
    ds_read_b64_tr_b16 v[106:107], v130 offset:58368
    s_waitcnt lgkmcnt(12)
    v_mfma_f32_16x16x32_bf16 v[32:35], v[80:83], a[56:59], v[32:35]
    ds_read_b64_tr_b16 v[108:109], v131 offset:57344
    v_mfma_f32_16x16x32_bf16 v[36:39], v[80:83], a[120:123], v[36:39]
    ds_read_b64_tr_b16 v[110:111], v131 offset:58368
    s_waitcnt lgkmcnt(12)
    v_mfma_f32_16x16x32_bf16 v[40:43], v[84:87], a[56:59], v[40:43]
    ds_read_b64_tr_b16 v[112:113], v132 offset:57344
    v_mfma_f32_16x16x32_bf16 v[44:47], v[84:87], a[120:123], v[44:47]
    ds_read_b64_tr_b16 v[114:115], v132 offset:58368
    s_waitcnt lgkmcnt(12)
    v_mfma_f32_16x16x32_bf16 v[48:51], v[88:91], a[56:59], v[48:51]
    ds_read_b64_tr_b16 v[116:117], v133 offset:57344
    v_mfma_f32_16x16x32_bf16 v[52:55], v[88:91], a[120:123], v[52:55]
    ds_read_b64_tr_b16 v[118:119], v133 offset:58368
    s_waitcnt lgkmcnt(12)
    v_mfma_f32_16x16x32_bf16 v[56:59], v[92:95], a[56:59], v[56:59]
    ds_read_b64_tr_b16 v[120:121], v134 offset:57344
    v_mfma_f32_16x16x32_bf16 v[60:63], v[92:95], a[120:123], v[60:63]
    ds_read_b64_tr_b16 v[122:123], v134 offset:58368
    s_waitcnt lgkmcnt(12)
    v_mfma_f32_16x16x32_bf16 v[0:3], v[96:99], a[60:63], v[0:3]
    ds_read_b64_tr_b16 v[124:125], v135 offset:57344
    v_mfma_f32_16x16x32_bf16 v[4:7], v[96:99], a[124:127], v[4:7]
    ds_read_b64_tr_b16 v[126:127], v135 offset:58368
    s_waitcnt lgkmcnt(12)
    v_mfma_f32_16x16x32_bf16 v[8:11], v[100:103], a[60:63], v[8:11]
    v_mfma_f32_16x16x32_bf16 v[12:15], v[100:103], a[124:127], v[12:15]
    s_waitcnt lgkmcnt(10)
    v_mfma_f32_16x16x32_bf16 v[16:19], v[104:107], a[60:63], v[16:19]
    v_mfma_f32_16x16x32_bf16 v[20:23], v[104:107], a[124:127], v[20:23]
    s_waitcnt lgkmcnt(8)
    v_mfma_f32_16x16x32_bf16 v[24:27], v[108:111], a[60:63], v[24:27]
    v_mfma_f32_16x16x32_bf16 v[28:31], v[108:111], a[124:127], v[28:31]
    s_waitcnt lgkmcnt(6)
    v_mfma_f32_16x16x32_bf16 v[32:35], v[112:115], a[60:63], v[32:35]
    v_mfma_f32_16x16x32_bf16 v[36:39], v[112:115], a[124:127], v[36:39]
    s_waitcnt lgkmcnt(4)
    v_mfma_f32_16x16x32_bf16 v[40:43], v[116:119], a[60:63], v[40:43]
    v_mfma_f32_16x16x32_bf16 v[44:47], v[116:119], a[124:127], v[44:47]
    s_waitcnt lgkmcnt(2)
    v_mfma_f32_16x16x32_bf16 v[48:51], v[120:123], a[60:63], v[48:51]
    v_mfma_f32_16x16x32_bf16 v[52:55], v[120:123], a[124:127], v[52:55]
    s_waitcnt lgkmcnt(0)
    v_mfma_f32_16x16x32_bf16 v[56:59], v[124:127], a[60:63], v[56:59]
    v_mfma_f32_16x16x32_bf16 v[60:63], v[124:127], a[124:127], v[60:63]
    v_xor_b32 v128, 0x10000, v128
    v_xor_b32 v129, 0x10000, v129
    v_xor_b32 v130, 0x10000, v130
    v_xor_b32 v131, 0x10000, v131
    v_xor_b32 v132, 0x10000, v132
    v_xor_b32 v133, 0x10000, v133
    v_xor_b32 v134, 0x10000, v134
    v_xor_b32 v135, 0x10000, v135
    v_cvt_pk_bf16_f32 v144, v0, v8
    v_cvt_pk_bf16_f32 v145, v1, v9
    v_cvt_pk_bf16_f32 v146, v2, v10
    v_cvt_pk_bf16_f32 v147, v3, v11
    buffer_store_dwordx4 v[144:147], v137, s[8:11], s25 offen sc1
    v_cvt_pk_bf16_f32 v148, v16, v24
    v_cvt_pk_bf16_f32 v149, v17, v25
    v_cvt_pk_bf16_f32 v150, v18, v26
    v_cvt_pk_bf16_f32 v151, v19, v27
    buffer_store_dwordx4 v[148:151], v137, s[8:11], s25 offen offset:1024 sc1
    v_cvt_pk_bf16_f32 v152, v32, v40
    v_cvt_pk_bf16_f32 v153, v33, v41
    v_cvt_pk_bf16_f32 v154, v34, v42
    v_cvt_pk_bf16_f32 v155, v35, v43
    buffer_store_dwordx4 v[152:155], v137, s[8:11], s25 offen offset:2048 sc1
    v_cvt_pk_bf16_f32 v156, v48, v56
    v_cvt_pk_bf16_f32 v157, v49, v57
    v_cvt_pk_bf16_f32 v158, v50, v58
    v_cvt_pk_bf16_f32 v159, v51, v59
    buffer_store_dwordx4 v[156:159], v137, s[8:11], s25 offen offset:3072 sc1
    v_cvt_pk_bf16_f32 v144, v4, v12
    v_cvt_pk_bf16_f32 v145, v5, v13
    v_cvt_pk_bf16_f32 v146, v6, v14
    v_cvt_pk_bf16_f32 v147, v7, v15
    s_add_u32 s25, s25, 4096
    buffer_store_dwordx4 v[144:147], v137, s[8:11], s25 offen sc1
    v_cvt_pk_bf16_f32 v148, v20, v28
    v_cvt_pk_bf16_f32 v149, v21, v29
    v_cvt_pk_bf16_f32 v150, v22, v30
    v_cvt_pk_bf16_f32 v151, v23, v31
    buffer_store_dwordx4 v[148:151], v137, s[8:11], s25 offen offset:1024 sc1
    v_cvt_pk_bf16_f32 v152, v36, v44
    v_cvt_pk_bf16_f32 v153, v37, v45
    v_cvt_pk_bf16_f32 v154, v38, v46
    v_cvt_pk_bf16_f32 v155, v39, v47
    buffer_store_dwordx4 v[152:155], v137, s[8:11], s25 offen offset:2048 sc1
    v_cvt_pk_bf16_f32 v156, v52, v60
    v_cvt_pk_bf16_f32 v157, v53, v61
    v_cvt_pk_bf16_f32 v158, v54, v62
    v_cvt_pk_bf16_f32 v159, v55, v63
    buffer_store_dwordx4 v[156:159], v137, s[8:11], s25 offen offset:3072 sc1
    s_branch L_p1_next
L_p1_v:
    s_waitcnt vmcnt(16)
    s_barrier
    ds_read_b64_tr_b16 v[64:65], v128
    ds_read_b64_tr_b16 v[66:67], v128 offset:1024
    ds_read_b64_tr_b16 v[68:69], v129
    ds_read_b64_tr_b16 v[70:71], v129 offset:1024
    ds_read_b64_tr_b16 v[72:73], v130
    ds_read_b64_tr_b16 v[74:75], v130 offset:1024
    ds_read_b64_tr_b16 v[76:77], v131
    ds_read_b64_tr_b16 v[78:79], v131 offset:1024
    ds_read_b64_tr_b16 v[80:81], v132
    ds_read_b64_tr_b16 v[82:83], v132 offset:1024
    ds_read_b64_tr_b16 v[84:85], v133
    ds_read_b64_tr_b16 v[86:87], v133 offset:1024
    ds_read_b64_tr_b16 v[88:89], v134
    ds_read_b64_tr_b16 v[90:91], v134 offset:1024
    s_waitcnt lgkmcnt(12)
    v_mfma_f32_16x16x32_bf16 v[0:3], a[0:3], v[64:67], 0
    ds_read_b64_tr_b16 v[92:93], v135
    v_mfma_f32_16x16x32_bf16 v[4:7], a[64:67], v[64:67], 0
    ds_read_b64_tr_b16 v[94:95], v135 offset:1024
    s_add_u32 s26, s24, 0x300000
    s_add_u32 m0, s29, 0x18000
    s_nop 0
    buffer_load_dwordx4 v136, s[16:19], s26 offen lds
    s_waitcnt lgkmcnt(12)
    v_mfma_f32_16x16x32_bf16 v[8:11], a[0:3], v[68:71], 0
    ds_read_b64_tr_b16 v[96:97], v128 offset:8192
    v_mfma_f32_16x16x32_bf16 v[12:15], a[64:67], v[68:71], 0
    ds_read_b64_tr_b16 v[98:99], v128 offset:9216
    s_add_u32 s26, s24, 0x320000
    s_add_u32 m0, s29, 0x19000
    s_nop 0
    buffer_load_dwordx4 v136, s[16:19], s26 offen lds
    s_waitcnt lgkmcnt(12)
    v_mfma_f32_16x16x32_bf16 v[16:19], a[0:3], v[72:75], 0
    ds_read_b64_tr_b16 v[100:101], v129 offset:8192
    v_mfma_f32_16x16x32_bf16 v[20:23], a[64:67], v[72:75], 0
    ds_read_b64_tr_b16 v[102:103], v129 offset:9216
    s_add_u32 s26, s24, 0x340000
    s_add_u32 m0, s29, 0x1a000
    s_nop 0
    buffer_load_dwordx4 v136, s[16:19], s26 offen lds
    s_waitcnt lgkmcnt(12)
    v_mfma_f32_16x16x32_bf16 v[24:27], a[0:3], v[76:79], 0
    ds_read_b64_tr_b16 v[104:105], v130 offset:8192
    v_mfma_f32_16x16x32_bf16 v[28:31], a[64:67], v[76:79], 0
    ds_read_b64_tr_b16 v[106:107], v130 offset:9216
    s_add_u32 s26, s24, 0x360000
    s_add_u32 m0, s29, 0x1b000
    s_nop 0
    buffer_load_dwordx4 v136, s[16:19], s26 offen lds
    s_waitcnt lgkmcnt(12)
    v_mfma_f32_16x16x32_bf16 v[32:35], a[0:3], v[80:83], 0
    ds_read_b64_tr_b16 v[108:109], v131 offset:8192
    v_mfma_f32_16x16x32_bf16 v[36:39], a[64:67], v[80:83], 0
    ds_read_b64_tr_b16 v[110:111], v131 offset:9216
    s_add_u32 s26, s24, 0x380000
    s_add_u32 m0, s29, 0x1c000
    s_nop 0
    buffer_load_dwordx4 v136, s[16:19], s26 offen lds
    s_waitcnt lgkmcnt(12)
    v_mfma_f32_16x16x32_bf16 v[40:43], a[0:3], v[84:87], 0
    ds_read_b64_tr_b16 v[112:113], v132 offset:8192
    v_mfma_f32_16x16x32_bf16 v[44:47], a[64:67], v[84:87], 0
    ds_read_b64_tr_b16 v[114:115], v132 offset:9216
    s_add_u32 s26, s24, 0x3a0000
    s_add_u32 m0, s29, 0x1d000
    s_nop 0
    buffer_load_dwordx4 v136, s[16:19], s26 offen lds
    s_waitcnt lgkmcnt(12)
    v_mfma_f32_16x16x32_bf16 v[48:51], a[0:3], v[88:91], 0
    ds_read_b64_tr_b16 v[116:117], v133 offset:8192
    v_mfma_f32_16x16x32_bf16 v[52:55], a[64:67], v[88:91], 0
    ds_read_b64_tr_b16 v[118:119], v133 offset:9216
    s_add_u32 s26, s24, 0x3c0000
    s_add_u32 m0, s29, 0x1e000
    s_nop 0
    buffer_load_dwordx4 v136, s[16:19], s26 offen lds
    s_waitcnt lgkmcnt(12)
    v_mfma_f32_16x16x32_bf16 v[56:59], a[0:3], v[92:95], 0
    ds_read_b64_tr_b16 v[120:121], v134 offset:8192
    v_mfma_f32_16x16x32_bf16 v[60:63], a[64:67], v[92:95], 0
    ds_read_b64_tr_b16 v[122:123], v134 offset:9216
    s_add_u32 s26, s24, 0x3e0000
    s_add_u32 m0, s29, 0x1f000
    s_nop 0
    buffer_load_dwordx4 v136, s[16:19], s26 offen lds
    s_waitcnt lgkmcnt(12)
    v_mfma_f32_16x16x32_bf16 v[0:3], a[4:7], v[96:99], v[0:3]
    ds_read_b64_tr_b16 v[124:125], v135 offset:8192
    v_mfma_f32_16x16x32_bf16 v[4:7], a[68:71], v[96:99], v[4:7]
    ds_read_b64_tr_b16 v[126:127], v135 offset:9216
    s_waitcnt lgkmcnt(12)
    v_mfma_f32_16x16x32_bf16 v[8:11], a[4:7], v[100:103], v[8:11]
    ds_read_b64_tr_b16 v[64:65], v128 offset:16384
    v_mfma_f32_16x16x32_bf16 v[12:15], a[68:71], v[100:103], v[12:15]
    ds_read_b64_tr_b16 v[66:67], v128 offset:17408
    s_waitcnt lgkmcnt(12)
    v_mfma_f32_16x16x32_bf16 v[16:19], a[4:7], v[104:107], v[16:19]
    ds_read_b64_tr_b16 v[68:69], v129 offset:16384
    v_mfma_f32_16x16x32_bf16 v[20:23], a[68:71], v[104:107], v[20:23]
    ds_read_b64_tr_b16 v[70:71], v129 offset:17408
    s_waitcnt lgkmcnt(12)
    v_mfma_f32_16x16x32_bf16 v[24:27], a[4:7], v[108:111], v[24:27]
    ds_read_b64_tr_b16 v[72:73], v130 offset:16384
    v_mfma_f32_16x16x32_bf16 v[28:31], a[68:71], v[108:111], v[28:31]
    ds_read_b64_tr_b16 v[74:75], v130 offset:17408
    s_waitcnt lgkmcnt(12)
    v_mfma_f32_16x16x32_bf16 v[32:35], a[4:7], v[112:115], v[32:35]
    ds_read_b64_tr_b16 v[76:77], v131 offset:16384
    v_mfma_f32_16x16x32_bf16 v[36:39], a[68:71], v[112:115], v[36:39]
    ds_read_b64_tr_b16 v[78:79], v131 offset:17408
    s_waitcnt lgkmcnt(12)
    v_mfma_f32_16x16x32_bf16 v[40:43], a[4:7], v[116:119], v[40:43]
    ds_read_b64_tr_b16 v[80:81], v132 offset:16384
    v_mfma_f32_16x16x32_bf16 v[44:47], a[68:71], v[116:119], v[44:47]
    ds_read_b64_tr_b16 v[82:83], v132 offset:17408
    s_waitcnt lgkmcnt(12)
    v_mfma_f32_16x16x32_bf16 v[48:51], a[4:7], v[120:123], v[48:51]
    ds_read_b64_tr_b16 v[84:85], v133 offset:16384
    v_mfma_f32_16x16x32_bf16 v[52:55], a[68:71], v[120:123], v[52:55]
    ds_read_b64_tr_b16 v[86:87], v133 offset:17408
    s_waitcnt lgkmcnt(12)
    v_mfma_f32_16x16x32_bf16 v[56:59], a[4:7], v[124:127], v[56:59]
    ds_read_b64_tr_b16 v[88:89], v134 offset:16384
    v_mfma_f32_16x16x32_bf16 v[60:63], a[68:71], v[124:127], v[60:63]
    ds_read_b64_tr_b16 v[90:91], v134 offset:17408
    s_waitcnt lgkmcnt(12)
    v_mfma_f32_16x16x32_bf16 v[0:3], a[8:11], v[64:67], v[0:3]
    ds_read_b64_tr_b16 v[92:93], v135 offset:16384
    v_mfma_f32_16x16x32_bf16 v[4:7], a[72:75], v[64:67], v[4:7]
    ds_read_b64_tr_b16 v[94:95], v135 offset:17408
    s_waitcnt lgkmcnt(12)
    v_mfma_f32_16x16x32_bf16 v[8:11], a[8:11], v[68:71], v[8:11]
    ds_read_b64_tr_b16 v[96:97], v128 offset:24576
    v_mfma_f32_16x16x32_bf16 v[12:15], a[72:75], v[68:71], v[12:15]
    ds_read_b64_tr_b16 v[98:99], v128 offset:25600
    s_waitcnt lgkmcnt(12)
    v_mfma_f32_16x16x32_bf16 v[16:19], a[8:11], v[72:75], v[16:19]
    ds_read_b64_tr_b16 v[100:101], v129 offset:24576
    v_mfma_f32_16x16x32_bf16 v[20:23], a[72:75], v[72:75], v[20:23]
    ds_read_b64_tr_b16 v[102:103], v129 offset:25600
    s_waitcnt lgkmcnt(12)
    v_mfma_f32_16x16x32_bf16 v[24:27], a[8:11], v[76:79], v[24:27]
    ds_read_b64_tr_b16 v[104:105], v130 offset:24576
    v_mfma_f32_16x16x32_bf16 v[28:31], a[72:75], v[76:79], v[28:31]
    ds_read_b64_tr_b16 v[106:107], v130 offset:25600
    s_waitcnt lgkmcnt(12)
    v_mfma_f32_16x16x32_bf16 v[32:35], a[8:11], v[80:83], v[32:35]
    ds_read_b64_tr_b16 v[108:109], v131 offset:24576
    v_mfma_f32_16x16x32_bf16 v[36:39], a[72:75], v[80:83], v[36:39]
    ds_read_b64_tr_b16 v[110:111], v131 offset:25600
    s_waitcnt lgkmcnt(12)
    v_mfma_f32_16x16x32_bf16 v[40:43], a[8:11], v[84:87], v[40:43]
    ds_read_b64_tr_b16 v[112:113], v132 offset:24576
    v_mfma_f32_16x16x32_bf16 v[44:47], a[72:75], v[84:87], v[44:47]
    ds_read_b64_tr_b16 v[114:115], v132 offset:25600
    s_waitcnt lgkmcnt(12)
    v_mfma_f32_16x16x32_bf16 v[48:51], a[8:11], v[88:91], v[48:51]
    ds_read_b64_tr_b16 v[116:117], v133 offset:24576
    v_mfma_f32_16x16x32_bf16 v[52:55], a[72:75], v[88:91], v[52:55]
    ds_read_b64_tr_b16 v[118:119], v133 offset:25600
    s_waitcnt lgkmcnt(12)
    v_mfma_f32_16x16x32_bf16 v[56:59], a[8:11], v[92:95], v[56:59]
    ds_read_b64_tr_b16 v[120:121], v134 offset:24576
    v_mfma_f32_16x16x32_bf16 v[60:63], a[72:75], v[92:95], v[60:63]
    ds_read_b64_tr_b16 v[122:123], v134 offset:25600
    s_waitcnt lgkmcnt(12)
    v_mfma_f32_16x16x32_bf16 v[0:3], a[12:15], v[96:99], v[0:3]
    ds_read_b64_tr_b16 v[124:125], v135 offset:24576
    v_mfma_f32_16x16x32_bf16 v[4:7], a[76:79], v[96:99], v[4:7]
    ds_read_b64_tr_b16 v[126:127], v135 offset:25600
    s_waitcnt lgkmcnt(12)
    v_mfma_f32_16x16x32_bf16 v[8:11], a[12:15], v[100:103], v[8:11]
    v_mfma_f32_16x16x32_bf16 v[12:15], a[76:79], v[100:103], v[12:15]
    s_waitcnt lgkmcnt(10)
    v_mfma_f32_16x16x32_bf16 v[16:19], a[12:15], v[104:107], v[16:19]
    v_mfma_f32_16x16x32_bf16 v[20:23], a[76:79], v[104:107], v[20:23]
    s_waitcnt lgkmcnt(8)
    v_mfma_f32_16x16x32_bf16 v[24:27], a[12:15], v[108:111], v[24:27]
    v_mfma_f32_16x16x32_bf16 v[28:31], a[76:79], v[108:111], v[28:31]
    s_waitcnt lgkmcnt(6)
    v_mfma_f32_16x16x32_bf16 v[32:35], a[12:15], v[112:115], v[32:35]
    v_mfma_f32_16x16x32_bf16 v[36:39], a[76:79], v[112:115], v[36:39]
    s_waitcnt lgkmcnt(4)
    v_mfma_f32_16x16x32_bf16 v[40:43], a[12:15], v[116:119], v[40:43]
    v_mfma_f32_16x16x32_bf16 v[44:47], a[76:79], v[116:119], v[44:47]
    s_waitcnt lgkmcnt(2)
    v_mfma_f32_16x16x32_bf16 v[48:51], a[12:15], v[120:123], v[48:51]
    v_mfma_f32_16x16x32_bf16 v[52:55], a[76:79], v[120:123], v[52:55]
    s_waitcnt lgkmcnt(0)
    v_mfma_f32_16x16x32_bf16 v[56:59], a[12:15], v[124:127], v[56:59]
    v_mfma_f32_16x16x32_bf16 v[60:63], a[76:79], v[124:127], v[60:63]
    s_waitcnt vmcnt(16)
    s_barrier
    ds_read_b64_tr_b16 v[64:65], v128 offset:32768
    ds_read_b64_tr_b16 v[66:67], v128 offset:33792
    ds_read_b64_tr_b16 v[68:69], v129 offset:32768
    ds_read_b64_tr_b16 v[70:71], v129 offset:33792
    ds_read_b64_tr_b16 v[72:73], v130 offset:32768
    ds_read_b64_tr_b16 v[74:75], v130 offset:33792
    ds_read_b64_tr_b16 v[76:77], v131 offset:32768
    ds_read_b64_tr_b16 v[78:79], v131 offset:33792
    ds_read_b64_tr_b16 v[80:81], v132 offset:32768
    ds_read_b64_tr_b16 v[82:83], v132 offset:33792
    ds_read_b64_tr_b16 v[84:85], v133 offset:32768
    ds_read_b64_tr_b16 v[86:87], v133 offset:33792
    ds_read_b64_tr_b16 v[88:89], v134 offset:32768
    ds_read_b64_tr_b16 v[90:91], v134 offset:33792
    s_add_u32 s39, s39, s37
    s_lshr_b32 s26, s39, 5
    s_cmp_eq_u32 s26, 0
    s_cselect_b64 s[16:17], s[62:63], s[60:61]
    s_cmp_eq_u32 s26, 1
    s_cselect_b64 s[16:17], s[64:65], s[16:17]
    s_and_b32 s17, s17, 0xffff
    s_cmp_lt_u32 s39, 96
    s_cselect_b32 s18, 0x400000, 0
    s_and_b32 s24, s39, 31
    s_lshl_b32 s24, s24, 8
    s_waitcnt lgkmcnt(12)
    v_mfma_f32_16x16x32_bf16 v[0:3], a[16:19], v[64:67], v[0:3]
    ds_read_b64_tr_b16 v[92:93], v135 offset:32768
    v_mfma_f32_16x16x32_bf16 v[4:7], a[80:83], v[64:67], v[4:7]
    ds_read_b64_tr_b16 v[94:95], v135 offset:33792
    s_add_u32 s26, s24, 0x0
    s_add_u32 m0, s29, 0x0
    s_nop 0
    buffer_load_dwordx4 v136, s[16:19], s26 offen lds
    s_waitcnt lgkmcnt(12)
    v_mfma_f32_16x16x32_bf16 v[8:11], a[16:19], v[68:71], v[8:11]
    ds_read_b64_tr_b16 v[96:97], v128 offset:40960
    v_mfma_f32_16x16x32_bf16 v[12:15], a[80:83], v[68:71], v[12:15]
    ds_read_b64_tr_b16 v[98:99], v128 offset:41984
    s_add_u32 s26, s24, 0x20000
    s_add_u32 m0, s29, 0x1000
    s_nop 0
    buffer_load_dwordx4 v136, s[16:19], s26 offen lds
    s_waitcnt lgkmcnt(12)
    v_mfma_f32_16x16x32_bf16 v[16:19], a[16:19], v[72:75], v[16:19]
    ds_read_b64_tr_b16 v[100:101], v129 offset:40960
    v_mfma_f32_16x16x32_bf16 v[20:23], a[80:83], v[72:75], v[20:23]
    ds_read_b64_tr_b16 v[102:103], v129 offset:41984
    s_add_u32 s26, s24, 0x40000
    s_add_u32 m0, s29, 0x2000
    s_nop 0
    buffer_load_dwordx4 v136, s[16:19], s26 offen lds
    s_waitcnt lgkmcnt(12)
    v_mfma_f32_16x16x32_bf16 v[24:27], a[16:19], v[76:79], v[24:27]
    ds_read_b64_tr_b16 v[104:105], v130 offset:40960
    v_mfma_f32_16x16x32_bf16 v[28:31], a[80:83], v[76:79], v[28:31]
    ds_read_b64_tr_b16 v[106:107], v130 offset:41984
    s_add_u32 s26, s24, 0x60000
    s_add_u32 m0, s29, 0x3000
    s_nop 0
    buffer_load_dwordx4 v136, s[16:19], s26 offen lds
    s_waitcnt lgkmcnt(12)
    v_mfma_f32_16x16x32_bf16 v[32:35], a[16:19], v[80:83], v[32:35]
    ds_read_b64_tr_b16 v[108:109], v131 offset:40960
    v_mfma_f32_16x16x32_bf16 v[36:39], a[80:83], v[80:83], v[36:39]
    ds_read_b64_tr_b16 v[110:111], v131 offset:41984
    s_add_u32 s26, s24, 0x80000
    s_add_u32 m0, s29, 0x4000
    s_nop 0
    buffer_load_dwordx4 v136, s[16:19], s26 offen lds
    s_waitcnt lgkmcnt(12)
    v_mfma_f32_16x16x32_bf16 v[40:43], a[16:19], v[84:87], v[40:43]
    ds_read_b64_tr_b16 v[112:113], v132 offset:40960
    v_mfma_f32_16x16x32_bf16 v[44:47], a[80:83], v[84:87], v[44:47]
    ds_read_b64_tr_b16 v[114:115], v132 offset:41984
    s_add_u32 s26, s24, 0xa0000
    s_add_u32 m0, s29, 0x5000
    s_nop 0
    buffer_load_dwordx4 v136, s[16:19], s26 offen lds
    s_waitcnt lgkmcnt(12)
    v_mfma_f32_16x16x32_bf16 v[48:51], a[16:19], v[88:91], v[48:51]
    ds_read_b64_tr_b16 v[116:117], v133 offset:40960
    v_mfma_f32_16x16x32_bf16 v[52:55], a[80:83], v[88:91], v[52:55]
    ds_read_b64_tr_b16 v[118:119], v133 offset:41984
    s_add_u32 s26, s24, 0xc0000
    s_add_u32 m0, s29, 0x6000
    s_nop 0
    buffer_load_dwordx4 v136, s[16:19], s26 offen lds
    s_waitcnt lgkmcnt(12)
    v_mfma_f32_16x16x32_bf16 v[56:59], a[16:19], v[92:95], v[56:59]
    ds_read_b64_tr_b16 v[120:121], v134 offset:40960
    v_mfma_f32_16x16x32_bf16 v[60:63], a[80:83], v[92:95], v[60:63]
    ds_read_b64_tr_b16 v[122:123], v134 offset:41984
    s_add_u32 s26, s24, 0xe0000
    s_add_u32 m0, s29, 0x7000
    s_nop 0
    buffer_load_dwordx4 v136, s[16:19], s26 offen lds
    s_waitcnt lgkmcnt(12)
    v_mfma_f32_16x16x32_bf16 v[0:3], a[20:23], v[96:99], v[0:3]
    ds_read_b64_tr_b16 v[124:125], v135 offset:40960
    v_mfma_f32_16x16x32_bf16 v[4:7], a[84:87], v[96:99], v[4:7]
    ds_read_b64_tr_b16 v[126:127], v135 offset:41984
    s_waitcnt lgkmcnt(12)
    v_mfma_f32_16x16x32_bf16 v[8:11], a[20:23], v[100:103], v[8:11]
    ds_read_b64_tr_b16 v[64:65], v128 offset:49152
    v_mfma_f32_16x16x32_bf16 v[12:15], a[84:87], v[100:103], v[12:15]
    ds_read_b64_tr_b16 v[66:67], v128 offset:50176
    s_waitcnt lgkmcnt(12)
    v_mfma_f32_16x16x32_bf16 v[16:19], a[20:23], v[104:107], v[16:19]
    ds_read_b64_tr_b16 v[68:69], v129 offset:49152
    v_mfma_f32_16x16x32_bf16 v[20:23], a[84:87], v[104:107], v[20:23]
    ds_read_b64_tr_b16 v[70:71], v129 offset:50176
    s_waitcnt lgkmcnt(12)
    v_mfma_f32_16x16x32_bf16 v[24:27], a[20:23], v[108:111], v[24:27]
    ds_read_b64_tr_b16 v[72:73], v130 offset:49152
    v_mfma_f32_16x16x32_bf16 v[28:31], a[84:87], v[108:111], v[28:31]
    ds_read_b64_tr_b16 v[74:75], v130 offset:50176
    s_waitcnt lgkmcnt(12)
    v_mfma_f32_16x16x32_bf16 v[32:35], a[20:23], v[112:115], v[32:35]
    ds_read_b64_tr_b16 v[76:77], v131 offset:49152
    v_mfma_f32_16x16x32_bf16 v[36:39], a[84:87], v[112:115], v[36:39]
    ds_read_b64_tr_b16 v[78:79], v131 offset:50176
    s_waitcnt lgkmcnt(12)
    v_mfma_f32_16x16x32_bf16 v[40:43], a[20:23], v[116:119], v[40:43]
    ds_read_b64_tr_b16 v[80:81], v132 offset:49152
    v_mfma_f32_16x16x32_bf16 v[44:47], a[84:87], v[116:119], v[44:47]
    ds_read_b64_tr_b16 v[82:83], v132 offset:50176
    s_waitcnt lgkmcnt(12)
    v_mfma_f32_16x16x32_bf16 v[48:51], a[20:23], v[120:123], v[48:51]
    ds_read_b64_tr_b16 v[84:85], v133 offset:49152
    v_mfma_f32_16x16x32_bf16 v[52:55], a[84:87], v[120:123], v[52:55]
    ds_read_b64_tr_b16 v[86:87], v133 offset:50176
    s_waitcnt lgkmcnt(12)
    v_mfma_f32_16x16x32_bf16 v[56:59], a[20:23], v[124:127], v[56:59]
    ds_read_b64_tr_b16 v[88:89], v134 offset:49152
    v_mfma_f32_16x16x32_bf16 v[60:63], a[84:87], v[124:127], v[60:63]
    ds_read_b64_tr_b16 v[90:91], v134 offset:50176
    s_waitcnt lgkmcnt(12)
    v_mfma_f32_16x16x32_bf16 v[0:3], a[24:27], v[64:67], v[0:3]
    ds_read_b64_tr_b16 v[92:93], v135 offset:49152
    v_mfma_f32_16x16x32_bf16 v[4:7], a[88:91], v[64:67], v[4:7]
    ds_read_b64_tr_b16 v[94:95], v135 offset:50176
    s_waitcnt lgkmcnt(12)
    v_mfma_f32_16x16x32_bf16 v[8:11], a[24:27], v[68:71], v[8:11]
    ds_read_b64_tr_b16 v[96:97], v128 offset:57344
    v_mfma_f32_16x16x32_bf16 v[12:15], a[88:91], v[68:71], v[12:15]
    ds_read_b64_tr_b16 v[98:99], v128 offset:58368
    s_waitcnt lgkmcnt(12)
    v_mfma_f32_16x16x32_bf16 v[16:19], a[24:27], v[72:75], v[16:19]
    ds_read_b64_tr_b16 v[100:101], v129 offset:57344
    v_mfma_f32_16x16x32_bf16 v[20:23], a[88:91], v[72:75], v[20:23]
    ds_read_b64_tr_b16 v[102:103], v129 offset:58368
    s_waitcnt lgkmcnt(12)
    v_mfma_f32_16x16x32_bf16 v[24:27], a[24:27], v[76:79], v[24:27]
    ds_read_b64_tr_b16 v[104:105], v130 offset:57344
    v_mfma_f32_16x16x32_bf16 v[28:31], a[88:91], v[76:79], v[28:31]
    ds_read_b64_tr_b16 v[106:107], v130 offset:58368
    s_waitcnt lgkmcnt(12)
    v_mfma_f32_16x16x32_bf16 v[32:35], a[24:27], v[80:83], v[32:35]
    ds_read_b64_tr_b16 v[108:109], v131 offset:57344
    v_mfma_f32_16x16x32_bf16 v[36:39], a[88:91], v[80:83], v[36:39]
    ds_read_b64_tr_b16 v[110:111], v131 offset:58368
    s_waitcnt lgkmcnt(12)
    v_mfma_f32_16x16x32_bf16 v[40:43], a[24:27], v[84:87], v[40:43]
    ds_read_b64_tr_b16 v[112:113], v132 offset:57344
    v_mfma_f32_16x16x32_bf16 v[44:47], a[88:91], v[84:87], v[44:47]
    ds_read_b64_tr_b16 v[114:115], v132 offset:58368
    s_waitcnt lgkmcnt(12)
    v_mfma_f32_16x16x32_bf16 v[48:51], a[24:27], v[88:91], v[48:51]
    ds_read_b64_tr_b16 v[116:117], v133 offset:57344
    v_mfma_f32_16x16x32_bf16 v[52:55], a[88:91], v[88:91], v[52:55]
    ds_read_b64_tr_b16 v[118:119], v133 offset:58368
    s_waitcnt lgkmcnt(12)
    v_mfma_f32_16x16x32_bf16 v[56:59], a[24:27], v[92:95], v[56:59]
    ds_read_b64_tr_b16 v[120:121], v134 offset:57344
    v_mfma_f32_16x16x32_bf16 v[60:63], a[88:91], v[92:95], v[60:63]
    ds_read_b64_tr_b16 v[122:123], v134 offset:58368
    s_waitcnt lgkmcnt(12)
    v_mfma_f32_16x16x32_bf16 v[0:3], a[28:31], v[96:99], v[0:3]
    ds_read_b64_tr_b16 v[124:125], v135 offset:57344
    v_mfma_f32_16x16x32_bf16 v[4:7], a[92:95], v[96:99], v[4:7]
    ds_read_b64_tr_b16 v[126:127], v135 offset:58368
    s_waitcnt lgkmcnt(12)
    v_mfma_f32_16x16x32_bf16 v[8:11], a[28:31], v[100:103], v[8:11]
    v_mfma_f32_16x16x32_bf16 v[12:15], a[92:95], v[100:103], v[12:15]
    s_waitcnt lgkmcnt(10)
    v_mfma_f32_16x16x32_bf16 v[16:19], a[28:31], v[104:107], v[16:19]
    v_mfma_f32_16x16x32_bf16 v[20:23], a[92:95], v[104:107], v[20:23]
    s_waitcnt lgkmcnt(8)
    v_mfma_f32_16x16x32_bf16 v[24:27], a[28:31], v[108:111], v[24:27]
    v_mfma_f32_16x16x32_bf16 v[28:31], a[92:95], v[108:111], v[28:31]
    s_waitcnt lgkmcnt(6)
    v_mfma_f32_16x16x32_bf16 v[32:35], a[28:31], v[112:115], v[32:35]
    v_mfma_f32_16x16x32_bf16 v[36:39], a[92:95], v[112:115], v[36:39]
    s_waitcnt lgkmcnt(4)
    v_mfma_f32_16x16x32_bf16 v[40:43], a[28:31], v[116:119], v[40:43]
    v_mfma_f32_16x16x32_bf16 v[44:47], a[92:95], v[116:119], v[44:47]
    s_waitcnt lgkmcnt(2)
    v_mfma_f32_16x16x32_bf16 v[48:51], a[28:31], v[120:123], v[48:51]
    v_mfma_f32_16x16x32_bf16 v[52:55], a[92:95], v[120:123], v[52:55]
    s_waitcnt lgkmcnt(0)
    v_mfma_f32_16x16x32_bf16 v[56:59], a[28:31], v[124:127], v[56:59]
    v_mfma_f32_16x16x32_bf16 v[60:63], a[92:95], v[124:127], v[60:63]
    v_xor_b32 v128, 0x10000, v128
    v_xor_b32 v129, 0x10000, v129
    v_xor_b32 v130, 0x10000, v130
    v_xor_b32 v131, 0x10000, v131
    v_xor_b32 v132, 0x10000, v132
    v_xor_b32 v133, 0x10000, v133
    v_xor_b32 v134, 0x10000, v134
    v_xor_b32 v135, 0x10000, v135
    s_waitcnt vmcnt(16)
    s_barrier
    ds_read_b64_tr_b16 v[64:65], v128
    ds_read_b64_tr_b16 v[66:67], v128 offset:1024
    ds_read_b64_tr_b16 v[68:69], v129
    ds_read_b64_tr_b16 v[70:71], v129 offset:1024
    ds_read_b64_tr_b16 v[72:73], v130
    ds_read_b64_tr_b16 v[74:75], v130 offset:1024
    ds_read_b64_tr_b16 v[76:77], v131
    ds_read_b64_tr_b16 v[78:79], v131 offset:1024
    ds_read_b64_tr_b16 v[80:81], v132
    ds_read_b64_tr_b16 v[82:83], v132 offset:1024
    ds_read_b64_tr_b16 v[84:85], v133
    ds_read_b64_tr_b16 v[86:87], v133 offset:1024
    ds_read_b64_tr_b16 v[88:89], v134
    ds_read_b64_tr_b16 v[90:91], v134 offset:1024
    s_cmp_eq_u32 s40, 0
    s_cbranch_scc1 L_nopf_96
    s_cmp_lg_u32 s87, 0
    s_cbranch_scc1 L_modeok_97
    v_readfirstlane_b32 s96, v140
    v_readfirstlane_b32 s97, v141
    s_nop 0
    s_cmp_lg_u32 s97, 0
    s_cselect_b32 s87, s96, 0
    s_cmp_eq_u32 s87, 1
    s_cbranch_scc1 L_modeok_97
    s_mov_b32 s96, 0
L_mode_98:
    buffer_load_dwordx2 v[140:141], off, s[92:95], 0 offset:36 sc1
    s_waitcnt vmcnt(0)
    v_readfirstlane_b32 s87, v140
    v_readfirstlane_b32 s97, v141
    s_nop 0
    s_min_u32 s97, s97, s87
    s_cmp_lg_u32 s97, 0
    s_cbranch_scc1 L_moded_99
    s_sleep 4
    s_add_u32 s96, s96, 1
    s_cmp_lg_u32 s96, 0x100
    s_cbranch_scc1 L_modef_100
    v_mov_b32 v140, 2
    v_mov_b32 v141, 0
    s_mov_b64 exec, 1
    buffer_atomic_cmpswap v[140:141], off, s[92:95], 0 offset:36
    s_mov_b64 exec, -1
L_modef_100:
    s_cmp_lt_u32 s96, 0x10000
    s_cbranch_scc1 L_mode_98
L_moded_99:
    s_cmp_lg_u32 s87, 1
    s_cbranch_scc1 L_fallback
L_modeok_97:
    s_cmp_lg_u32 s100, 0
    s_cbranch_scc1 L_flag_101
    v_mov_b32 v138, 1
    s_mov_b64 exec, 1
    buffer_store_dword v138, off, s[8:11], s40 sc1
    s_mov_b64 exec, -1
L_flag_101:
    s_mov_b32 s40, 0
L_nopf_96:
    s_waitcnt lgkmcnt(12)
    v_mfma_f32_16x16x32_bf16 v[0:3], a[32:35], v[64:67], v[0:3]
    ds_read_b64_tr_b16 v[92:93], v135
    v_mfma_f32_16x16x32_bf16 v[4:7], a[96:99], v[64:67], v[4:7]
    ds_read_b64_tr_b16 v[94:95], v135 offset:1024
    s_add_u32 s26, s24, 0x100000
    s_add_u32 m0, s29, 0x8000
    s_nop 0
    buffer_load_dwordx4 v136, s[16:19], s26 offen lds
    s_waitcnt lgkmcnt(12)
    v_mfma_f32_16x16x32_bf16 v[8:11], a[32:35], v[68:71], v[8:11]
    ds_read_b64_tr_b16 v[96:97], v128 offset:8192
    v_mfma_f32_16x16x32_bf16 v[12:15], a[96:99], v[68:71], v[12:15]
    ds_read_b64_tr_b16 v[98:99], v128 offset:9216
    s_add_u32 s26, s24, 0x120000
    s_add_u32 m0, s29, 0x9000
    s_nop 0
    buffer_load_dwordx4 v136, s[16:19], s26 offen lds
    s_waitcnt lgkmcnt(12)
    v_mfma_f32_16x16x32_bf16 v[16:19], a[32:35], v[72:75], v[16:19]
    ds_read_b64_tr_b16 v[100:101], v129 offset:8192
    v_mfma_f32_16x16x32_bf16 v[20:23], a[96:99], v[72:75], v[20:23]
    ds_read_b64_tr_b16 v[102:103], v129 offset:9216
    s_add_u32 s26, s24, 0x140000
    s_add_u32 m0, s29, 0xa000
    s_nop 0
    buffer_load_dwordx4 v136, s[16:19], s26 offen lds
    s_waitcnt lgkmcnt(12)
    v_mfma_f32_16x16x32_bf16 v[24:27], a[32:35], v[76:79], v[24:27]
    ds_read_b64_tr_b16 v[104:105], v130 offset:8192
    v_mfma_f32_16x16x32_bf16 v[28:31], a[96:99], v[76:79], v[28:31]
    ds_read_b64_tr_b16 v[106:107], v130 offset:9216
    s_add_u32 s26, s24, 0x160000
    s_add_u32 m0, s29, 0xb000
    s_nop 0
    buffer_load_dwordx4 v136, s[16:19], s26 offen lds
    s_waitcnt lgkmcnt(12)
    v_mfma_f32_16x16x32_bf16 v[32:35], a[32:35], v[80:83], v[32:35]
    ds_read_b64_tr_b16 v[108:109], v131 offset:8192
    v_mfma_f32_16x16x32_bf16 v[36:39], a[96:99], v[80:83], v[36:39]
    ds_read_b64_tr_b16 v[110:111], v131 offset:9216
    s_add_u32 s26, s24, 0x180000
    s_add_u32 m0, s29, 0xc000
    s_nop 0
    buffer_load_dwordx4 v136, s[16:19], s26 offen lds
    s_waitcnt lgkmcnt(12)
    v_mfma_f32_16x16x32_bf16 v[40:43], a[32:35], v[84:87], v[40:43]
    ds_read_b64_tr_b16 v[112:113], v132 offset:8192
    v_mfma_f32_16x16x32_bf16 v[44:47], a[96:99], v[84:87], v[44:47]
    ds_read_b64_tr_b16 v[114:115], v132 offset:9216
    s_add_u32 s26, s24, 0x1a0000
    s_add_u32 m0, s29, 0xd000
    s_nop 0
    buffer_load_dwordx4 v136, s[16:19], s26 offen lds
    s_waitcnt lgkmcnt(12)
    v_mfma_f32_16x16x32_bf16 v[48:51], a[32:35], v[88:91], v[48:51]
    ds_read_b64_tr_b16 v[116:117], v133 offset:8192
    v_mfma_f32_16x16x32_bf16 v[52:55], a[96:99], v[88:91], v[52:55]
    ds_read_b64_tr_b16 v[118:119], v133 offset:9216
    s_add_u32 s26, s24, 0x1c0000
    s_add_u32 m0, s29, 0xe000
    s_nop 0
    buffer_load_dwordx4 v136, s[16:19], s26 offen lds
    s_waitcnt lgkmcnt(12)
    v_mfma_f32_16x16x32_bf16 v[56:59], a[32:35], v[92:95], v[56:59]
    ds_read_b64_tr_b16 v[120:121], v134 offset:8192
    v_mfma_f32_16x16x32_bf16 v[60:63], a[96:99], v[92:95], v[60:63]
    ds_read_b64_tr_b16 v[122:123], v134 offset:9216
    s_add_u32 s26, s24, 0x1e0000
    s_add_u32 m0, s29, 0xf000
    s_nop 0
    buffer_load_dwordx4 v136, s[16:19], s26 offen lds
    s_waitcnt lgkmcnt(12)
    v_mfma_f32_16x16x32_bf16 v[0:3], a[36:39], v[96:99], v[0:3]
    ds_read_b64_tr_b16 v[124:125], v135 offset:8192
    v_mfma_f32_16x16x32_bf16 v[4:7], a[100:103], v[96:99], v[4:7]
    ds_read_b64_tr_b16 v[126:127], v135 offset:9216
    s_waitcnt lgkmcnt(12)
    v_mfma_f32_16x16x32_bf16 v[8:11], a[36:39], v[100:103], v[8:11]
    ds_read_b64_tr_b16 v[64:65], v128 offset:16384
    v_mfma_f32_16x16x32_bf16 v[12:15], a[100:103], v[100:103], v[12:15]
    ds_read_b64_tr_b16 v[66:67], v128 offset:17408
    s_waitcnt lgkmcnt(12)
    v_mfma_f32_16x16x32_bf16 v[16:19], a[36:39], v[104:107], v[16:19]
    ds_read_b64_tr_b16 v[68:69], v129 offset:16384
    v_mfma_f32_16x16x32_bf16 v[20:23], a[100:103], v[104:107], v[20:23]
    ds_read_b64_tr_b16 v[70:71], v129 offset:17408
    s_waitcnt lgkmcnt(12)
    v_mfma_f32_16x16x32_bf16 v[24:27], a[36:39], v[108:111], v[24:27]
    ds_read_b64_tr_b16 v[72:73], v130 offset:16384
    v_mfma_f32_16x16x32_bf16 v[28:31], a[100:103], v[108:111], v[28:31]
    ds_read_b64_tr_b16 v[74:75], v130 offset:17408
    s_waitcnt lgkmcnt(12)
    v_mfma_f32_16x16x32_bf16 v[32:35], a[36:39], v[112:115], v[32:35]
    ds_read_b64_tr_b16 v[76:77], v131 offset:16384
    v_mfma_f32_16x16x32_bf16 v[36:39], a[100:103], v[112:115], v[36:39]
    ds_read_b64_tr_b16 v[78:79], v131 offset:17408
    s_waitcnt lgkmcnt(12)
    v_mfma_f32_16x16x32_bf16 v[40:43], a[36:39], v[116:119], v[40:43]
    ds_read_b64_tr_b16 v[80:81], v132 offset:16384
    v_mfma_f32_16x16x32_bf16 v[44:47], a[100:103], v[116:119], v[44:47]
    ds_read_b64_tr_b16 v[82:83], v132 offset:17408
    s_waitcnt lgkmcnt(12)
    v_mfma_f32_16x16x32_bf16 v[48:51], a[36:39], v[120:123], v[48:51]
    ds_read_b64_tr_b16 v[84:85], v133 offset:16384
    v_mfma_f32_16x16x32_bf16 v[52:55], a[100:103], v[120:123], v[52:55]
    ds_read_b64_tr_b16 v[86:87], v133 offset:17408
    s_waitcnt lgkmcnt(12)
    v_mfma_f32_16x16x32_bf16 v[56:59], a[36:39], v[124:127], v[56:59]
    ds_read_b64_tr_b16 v[88:89], v134 offset:16384
    v_mfma_f32_16x16x32_bf16 v[60:63], a[100:103], v[124:127], v[60:63]
    ds_read_b64_tr_b16 v[90:91], v134 offset:17408
    s_waitcnt lgkmcnt(12)
    v_mfma_f32_16x16x32_bf16 v[0:3], a[40:43], v[64:67], v[0:3]
    ds_read_b64_tr_b16 v[92:93], v135 offset:16384
    v_mfma_f32_16x16x32_bf16 v[4:7], a[104:107], v[64:67], v[4:7]
    ds_read_b64_tr_b16 v[94:95], v135 offset:17408
    s_waitcnt lgkmcnt(12)
    v_mfma_f32_16x16x32_bf16 v[8:11], a[40:43], v[68:71], v[8:11]
    ds_read_b64_tr_b16 v[96:97], v128 offset:24576
    v_mfma_f32_16x16x32_bf16 v[12:15], a[104:107], v[68:71], v[12:15]
    ds_read_b64_tr_b16 v[98:99], v128 offset:25600
    s_waitcnt lgkmcnt(12)
    v_mfma_f32_16x16x32_bf16 v[16:19], a[40:43], v[72:75], v[16:19]
    ds_read_b64_tr_b16 v[100:101], v129 offset:24576
    v_mfma_f32_16x16x32_bf16 v[20:23], a[104:107], v[72:75], v[20:23]
    ds_read_b64_tr_b16 v[102:103], v129 offset:25600
    s_waitcnt lgkmcnt(12)
    v_mfma_f32_16x16x32_bf16 v[24:27], a[40:43], v[76:79], v[24:27]
    ds_read_b64_tr_b16 v[104:105], v130 offset:24576
    v_mfma_f32_16x16x32_bf16 v[28:31], a[104:107], v[76:79], v[28:31]
    ds_read_b64_tr_b16 v[106:107], v130 offset:25600
    s_waitcnt lgkmcnt(12)
    v_mfma_f32_16x16x32_bf16 v[32:35], a[40:43], v[80:83], v[32:35]
    ds_read_b64_tr_b16 v[108:109], v131 offset:24576
    v_mfma_f32_16x16x32_bf16 v[36:39], a[104:107], v[80:83], v[36:39]
    ds_read_b64_tr_b16 v[110:111], v131 offset:25600
    s_waitcnt lgkmcnt(12)
    v_mfma_f32_16x16x32_bf16 v[40:43], a[40:43], v[84:87], v[40:43]
    ds_read_b64_tr_b16 v[112:113], v132 offset:24576
    v_mfma_f32_16x16x32_bf16 v[44:47], a[104:107], v[84:87], v[44:47]
    ds_read_b64_tr_b16 v[114:115], v132 offset:25600
    s_waitcnt lgkmcnt(12)
    v_mfma_f32_16x16x32_bf16 v[48:51], a[40:43], v[88:91], v[48:51]
    ds_read_b64_tr_b16 v[116:117], v133 offset:24576
    v_mfma_f32_16x16x32_bf16 v[52:55], a[104:107], v[88:91], v[52:55]
    ds_read_b64_tr_b16 v[118:119], v133 offset:25600
    s_waitcnt lgkmcnt(12)
    v_mfma_f32_16x16x32_bf16 v[56:59], a[40:43], v[92:95], v[56:59]
    ds_read_b64_tr_b16 v[120:121], v134 offset:24576
    v_mfma_f32_16x16x32_bf16 v[60:63], a[104:107], v[92:95], v[60:63]
    ds_read_b64_tr_b16 v[122:123], v134 offset:25600
    s_waitcnt lgkmcnt(12)
    v_mfma_f32_16x16x32_bf16 v[0:3], a[44:47], v[96:99], v[0:3]
    ds_read_b64_tr_b16 v[124:125], v135 offset:24576
    v_mfma_f32_16x16x32_bf16 v[4:7], a[108:111], v[96:99], v[4:7]
    ds_read_b64_tr_b16 v[126:127], v135 offset:25600
    s_waitcnt lgkmcnt(12)
    v_mfma_f32_16x16x32_bf16 v[8:11], a[44:47], v[100:103], v[8:11]
    v_mfma_f32_16x16x32_bf16 v[12:15], a[108:111], v[100:103], v[12:15]
    s_waitcnt lgkmcnt(10)
    v_mfma_f32_16x16x32_bf16 v[16:19], a[44:47], v[104:107], v[16:19]
    v_mfma_f32_16x16x32_bf16 v[20:23], a[108:111], v[104:107], v[20:23]
    s_waitcnt lgkmcnt(8)
    v_mfma_f32_16x16x32_bf16 v[24:27], a[44:47], v[108:111], v[24:27]
    v_mfma_f32_16x16x32_bf16 v[28:31], a[108:111], v[108:111], v[28:31]
    s_waitcnt lgkmcnt(6)
    v_mfma_f32_16x16x32_bf16 v[32:35], a[44:47], v[112:115], v[32:35]
    v_mfma_f32_16x16x32_bf16 v[36:39], a[108:111], v[112:115], v[36:39]
    s_waitcnt lgkmcnt(4)
    v_mfma_f32_16x16x32_bf16 v[40:43], a[44:47], v[116:119], v[40:43]
    v_mfma_f32_16x16x32_bf16 v[44:47], a[108:111], v[116:119], v[44:47]
    s_waitcnt lgkmcnt(2)
    v_mfma_f32_16x16x32_bf16 v[48:51], a[44:47], v[120:123], v[48:51]
    v_mfma_f32_16x16x32_bf16 v[52:55], a[108:111], v[120:123], v[52:55]
    s_waitcnt lgkmcnt(0)
    v_mfma_f32_16x16x32_bf16 v[56:59], a[44:47], v[124:127], v[56:59]
    v_mfma_f32_16x16x32_bf16 v[60:63], a[108:111], v[124:127], v[60:63]
    s_waitcnt vmcnt(16)
    s_barrier
    ds_read_b64_tr_b16 v[64:65], v128 offset:32768
    ds_read_b64_tr_b16 v[66:67], v128 offset:33792
    ds_read_b64_tr_b16 v[68:69], v129 offset:32768
    ds_read_b64_tr_b16 v[70:71], v129 offset:33792
    ds_read_b64_tr_b16 v[72:73], v130 offset:32768
    ds_read_b64_tr_b16 v[74:75], v130 offset:33792
    ds_read_b64_tr_b16 v[76:77], v131 offset:32768
    ds_read_b64_tr_b16 v[78:79], v131 offset:33792
    ds_read_b64_tr_b16 v[80:81], v132 offset:32768
    ds_read_b64_tr_b16 v[82:83], v132 offset:33792
    ds_read_b64_tr_b16 v[84:85], v133 offset:32768
    ds_read_b64_tr_b16 v[86:87], v133 offset:33792
    ds_read_b64_tr_b16 v[88:89], v134 offset:32768
    ds_read_b64_tr_b16 v[90:91], v134 offset:33792
    s_waitcnt lgkmcnt(12)
    v_mfma_f32_16x16x32_bf16 v[0:3], a[48:51], v[64:67], v[0:3]
    ds_read_b64_tr_b16 v[92:93], v135 offset:32768
    v_mfma_f32_16x16x32_bf16 v[4:7], a[112:115], v[64:67], v[4:7]
    ds_read_b64_tr_b16 v[94:95], v135 offset:33792
    s_add_u32 s26, s24, 0x200000
    s_add_u32 m0, s29, 0x10000
    s_nop 0
    buffer_load_dwordx4 v136, s[16:19], s26 offen lds
    s_waitcnt lgkmcnt(12)
    v_mfma_f32_16x16x32_bf16 v[8:11], a[48:51], v[68:71], v[8:11]
    ds_read_b64_tr_b16 v[96:97], v128 offset:40960
    v_mfma_f32_16x16x32_bf16 v[12:15], a[112:115], v[68:71], v[12:15]
    ds_read_b64_tr_b16 v[98:99], v128 offset:41984
    s_add_u32 s26, s24, 0x220000
    s_add_u32 m0, s29, 0x11000
    s_nop 0
    buffer_load_dwordx4 v136, s[16:19], s26 offen lds
    s_waitcnt lgkmcnt(12)
    v_mfma_f32_16x16x32_bf16 v[16:19], a[48:51], v[72:75], v[16:19]
    ds_read_b64_tr_b16 v[100:101], v129 offset:40960
    v_mfma_f32_16x16x32_bf16 v[20:23], a[112:115], v[72:75], v[20:23]
    ds_read_b64_tr_b16 v[102:103], v129 offset:41984
    s_add_u32 s26, s24, 0x240000
    s_add_u32 m0, s29, 0x12000
    s_nop 0
    buffer_load_dwordx4 v136, s[16:19], s26 offen lds
    s_waitcnt lgkmcnt(12)
    v_mfma_f32_16x16x32_bf16 v[24:27], a[48:51], v[76:79], v[24:27]
    ds_read_b64_tr_b16 v[104:105], v130 offset:40960
    v_mfma_f32_16x16x32_bf16 v[28:31], a[112:115], v[76:79], v[28:31]
    ds_read_b64_tr_b16 v[106:107], v130 offset:41984
    s_add_u32 s26, s24, 0x260000
    s_add_u32 m0, s29, 0x13000
    s_nop 0
    buffer_load_dwordx4 v136, s[16:19], s26 offen lds
    s_waitcnt lgkmcnt(12)
    v_mfma_f32_16x16x32_bf16 v[32:35], a[48:51], v[80:83], v[32:35]
    ds_read_b64_tr_b16 v[108:109], v131 offset:40960
    v_mfma_f32_16x16x32_bf16 v[36:39], a[112:115], v[80:83], v[36:39]
    ds_read_b64_tr_b16 v[110:111], v131 offset:41984
    s_add_u32 s26, s24, 0x280000
    s_add_u32 m0, s29, 0x14000
    s_nop 0
    buffer_load_dwordx4 v136, s[16:19], s26 offen lds
    s_waitcnt lgkmcnt(12)
    v_mfma_f32_16x16x32_bf16 v[40:43], a[48:51], v[84:87], v[40:43]
    ds_read_b64_tr_b16 v[112:113], v132 offset:40960
    v_mfma_f32_16x16x32_bf16 v[44:47], a[112:115], v[84:87], v[44:47]
    ds_read_b64_tr_b16 v[114:115], v132 offset:41984
    s_add_u32 s26, s24, 0x2a0000
    s_add_u32 m0, s29, 0x15000
    s_nop 0
    buffer_load_dwordx4 v136, s[16:19], s26 offen lds
    s_waitcnt lgkmcnt(12)
    v_mfma_f32_16x16x32_bf16 v[48:51], a[48:51], v[88:91], v[48:51]
    ds_read_b64_tr_b16 v[116:117], v133 offset:40960
    v_mfma_f32_16x16x32_bf16 v[52:55], a[112:115], v[88:91], v[52:55]
    ds_read_b64_tr_b16 v[118:119], v133 offset:41984
    s_add_u32 s26, s24, 0x2c0000
    s_add_u32 m0, s29, 0x16000
    s_nop 0
    buffer_load_dwordx4 v136, s[16:19], s26 offen lds
    s_waitcnt lgkmcnt(12)
    v_mfma_f32_16x16x32_bf16 v[56:59], a[48:51], v[92:95], v[56:59]
    ds_read_b64_tr_b16 v[120:121], v134 offset:40960
    v_mfma_f32_16x16x32_bf16 v[60:63], a[112:115], v[92:95], v[60:63]
    ds_read_b64_tr_b16 v[122:123], v134 offset:41984
    s_add_u32 s26, s24, 0x2e0000
    s_add_u32 m0, s29, 0x17000
    s_nop 0
    buffer_load_dwordx4 v136, s[16:19], s26 offen lds
    s_waitcnt lgkmcnt(12)
    v_mfma_f32_16x16x32_bf16 v[0:3], a[52:55], v[96:99], v[0:3]
    ds_read_b64_tr_b16 v[124:125], v135 offset:40960
    v_mfma_f32_16x16x32_bf16 v[4:7], a[116:119], v[96:99], v[4:7]
    ds_read_b64_tr_b16 v[126:127], v135 offset:41984
    s_waitcnt lgkmcnt(12)
    v_mfma_f32_16x16x32_bf16 v[8:11], a[52:55], v[100:103], v[8:11]
    ds_read_b64_tr_b16 v[64:65], v128 offset:49152
    v_mfma_f32_16x16x32_bf16 v[12:15], a[116:119], v[100:103], v[12:15]
    ds_read_b64_tr_b16 v[66:67], v128 offset:50176
    s_waitcnt lgkmcnt(12)
    v_mfma_f32_16x16x32_bf16 v[16:19], a[52:55], v[104:107], v[16:19]
    ds_read_b64_tr_b16 v[68:69], v129 offset:49152
    v_mfma_f32_16x16x32_bf16 v[20:23], a[116:119], v[104:107], v[20:23]
    ds_read_b64_tr_b16 v[70:71], v129 offset:50176
    s_waitcnt lgkmcnt(12)
    v_mfma_f32_16x16x32_bf16 v[24:27], a[52:55], v[108:111], v[24:27]
    ds_read_b64_tr_b16 v[72:73], v130 offset:49152
    v_mfma_f32_16x16x32_bf16 v[28:31], a[116:119], v[108:111], v[28:31]
    ds_read_b64_tr_b16 v[74:75], v130 offset:50176
    s_waitcnt lgkmcnt(12)
    v_mfma_f32_16x16x32_bf16 v[32:35], a[52:55], v[112:115], v[32:35]
    ds_read_b64_tr_b16 v[76:77], v131 offset:49152
    v_mfma_f32_16x16x32_bf16 v[36:39], a[116:119], v[112:115], v[36:39]
    ds_read_b64_tr_b16 v[78:79], v131 offset:50176
    s_waitcnt lgkmcnt(12)
    v_mfma_f32_16x16x32_bf16 v[40:43], a[52:55], v[116:119], v[40:43]
    ds_read_b64_tr_b16 v[80:81], v132 offset:49152
    v_mfma_f32_16x16x32_bf16 v[44:47], a[116:119], v[116:119], v[44:47]
    ds_read_b64_tr_b16 v[82:83], v132 offset:50176
    s_waitcnt lgkmcnt(12)
    v_mfma_f32_16x16x32_bf16 v[48:51], a[52:55], v[120:123], v[48:51]
    ds_read_b64_tr_b16 v[84:85], v133 offset:49152
    v_mfma_f32_16x16x32_bf16 v[52:55], a[116:119], v[120:123], v[52:55]
    ds_read_b64_tr_b16 v[86:87], v133 offset:50176
    s_waitcnt lgkmcnt(12)
    v_mfma_f32_16x16x32_bf16 v[56:59], a[52:55], v[124:127], v[56:59]
    ds_read_b64_tr_b16 v[88:89], v134 offset:49152
    v_mfma_f32_16x16x32_bf16 v[60:63], a[116:119], v[124:127], v[60:63]
    ds_read_b64_tr_b16 v[90:91], v134 offset:50176
    s_waitcnt lgkmcnt(12)
    v_mfma_f32_16x16x32_bf16 v[0:3], a[56:59], v[64:67], v[0:3]
    ds_read_b64_tr_b16 v[92:93], v135 offset:49152
    v_mfma_f32_16x16x32_bf16 v[4:7], a[120:123], v[64:67], v[4:7]
    ds_read_b64_tr_b16 v[94:95], v135 offset:50176
    s_waitcnt lgkmcnt(12)
    v_mfma_f32_16x16x32_bf16 v[8:11], a[56:59], v[68:71], v[8:11]
    ds_read_b64_tr_b16 v[96:97], v128 offset:57344
    v_mfma_f32_16x16x32_bf16 v[12:15], a[120:123], v[68:71], v[12:15]
    ds_read_b64_tr_b16 v[98:99], v128 offset:58368
    s_waitcnt lgkmcnt(12)
    v_mfma_f32_16x16x32_bf16 v[16:19], a[56:59], v[72:75], v[16:19]
    ds_read_b64_tr_b16 v[100:101], v129 offset:57344
    v_mfma_f32_16x16x32_bf16 v[20:23], a[120:123], v[72:75], v[20:23]
    ds_read_b64_tr_b16 v[102:103], v129 offset:58368
    s_waitcnt lgkmcnt(12)
    v_mfma_f32_16x16x32_bf16 v[24:27], a[56:59], v[76:79], v[24:27]
    ds_read_b64_tr_b16 v[104:105], v130 offset:57344
    v_mfma_f32_16x16x32_bf16 v[28:31], a[120:123], v[76:79], v[28:31]
    ds_read_b64_tr_b16 v[106:107], v130 offset:58368
    s_waitcnt lgkmcnt(12)
    v_mfma_f32_16x16x32_bf16 v[32:35], a[56:59], v[80:83], v[32:35]
    ds_read_b64_tr_b16 v[108:109], v131 offset:57344
    v_mfma_f32_16x16x32_bf16 v[36:39], a[120:123], v[80:83], v[36:39]
    ds_read_b64_tr_b16 v[110:111], v131 offset:58368
    s_waitcnt lgkmcnt(12)
    v_mfma_f32_16x16x32_bf16 v[40:43], a[56:59], v[84:87], v[40:43]
    ds_read_b64_tr_b16 v[112:113], v132 offset:57344
    v_mfma_f32_16x16x32_bf16 v[44:47], a[120:123], v[84:87], v[44:47]
    ds_read_b64_tr_b16 v[114:115], v132 offset:58368
    s_waitcnt lgkmcnt(12)
    v_mfma_f32_16x16x32_bf16 v[48:51], a[56:59], v[88:91], v[48:51]
    ds_read_b64_tr_b16 v[116:117], v133 offset:57344
    v_mfma_f32_16x16x32_bf16 v[52:55], a[120:123], v[88:91], v[52:55]
    ds_read_b64_tr_b16 v[118:119], v133 offset:58368
    s_waitcnt lgkmcnt(12)
    v_mfma_f32_16x16x32_bf16 v[56:59], a[56:59], v[92:95], v[56:59]
    ds_read_b64_tr_b16 v[120:121], v134 offset:57344
    v_mfma_f32_16x16x32_bf16 v[60:63], a[120:123], v[92:95], v[60:63]
    ds_read_b64_tr_b16 v[122:123], v134 offset:58368
    s_waitcnt lgkmcnt(12)
    v_mfma_f32_16x16x32_bf16 v[0:3], a[60:63], v[96:99], v[0:3]
    ds_read_b64_tr_b16 v[124:125], v135 offset:57344
    v_mfma_f32_16x16x32_bf16 v[4:7], a[124:127], v[96:99], v[4:7]
    ds_read_b64_tr_b16 v[126:127], v135 offset:58368
    s_waitcnt lgkmcnt(12)
    v_mfma_f32_16x16x32_bf16 v[8:11], a[60:63], v[100:103], v[8:11]
    v_mfma_f32_16x16x32_bf16 v[12:15], a[124:127], v[100:103], v[12:15]
    s_waitcnt lgkmcnt(10)
    v_mfma_f32_16x16x32_bf16 v[16:19], a[60:63], v[104:107], v[16:19]
    v_mfma_f32_16x16x32_bf16 v[20:23], a[124:127], v[104:107], v[20:23]
    s_waitcnt lgkmcnt(8)
    v_mfma_f32_16x16x32_bf16 v[24:27], a[60:63], v[108:111], v[24:27]
    v_mfma_f32_16x16x32_bf16 v[28:31], a[124:127], v[108:111], v[28:31]
    s_waitcnt lgkmcnt(6)
    v_mfma_f32_16x16x32_bf16 v[32:35], a[60:63], v[112:115], v[32:35]
    v_mfma_f32_16x16x32_bf16 v[36:39], a[124:127], v[112:115], v[36:39]
    s_waitcnt lgkmcnt(4)
    v_mfma_f32_16x16x32_bf16 v[40:43], a[60:63], v[116:119], v[40:43]
    v_mfma_f32_16x16x32_bf16 v[44:47], a[124:127], v[116:119], v[44:47]
    s_waitcnt lgkmcnt(2)
    v_mfma_f32_16x16x32_bf16 v[48:51], a[60:63], v[120:123], v[48:51]
    v_mfma_f32_16x16x32_bf16 v[52:55], a[124:127], v[120:123], v[52:55]
    s_waitcnt lgkmcnt(0)
    v_mfma_f32_16x16x32_bf16 v[56:59], a[60:63], v[124:127], v[56:59]
    v_mfma_f32_16x16x32_bf16 v[60:63], a[124:127], v[124:127], v[60:63]
    v_xor_b32 v128, 0x10000, v128
    v_xor_b32 v129, 0x10000, v129
    v_xor_b32 v130, 0x10000, v130
    v_xor_b32 v131, 0x10000, v131
    v_xor_b32 v132, 0x10000, v132
    v_xor_b32 v133, 0x10000, v133
    v_xor_b32 v134, 0x10000, v134
    v_xor_b32 v135, 0x10000, v135
    v_cvt_pk_bf16_f32 v144, v0, v1
    v_cvt_pk_bf16_f32 v145, v2, v3
    v_cvt_pk_bf16_f32 v146, v4, v5
    v_cvt_pk_bf16_f32 v147, v6, v7
    buffer_store_dwordx4 v[144:147], v137, s[8:11], s25 offen sc1
    v_cvt_pk_bf16_f32 v148, v8, v9
    v_cvt_pk_bf16_f32 v149, v10, v11
    v_cvt_pk_bf16_f32 v150, v12, v13
    v_cvt_pk_bf16_f32 v151, v14, v15
    buffer_store_dwordx4 v[148:151], v137, s[8:11], s25 offen offset:1024 sc1
    v_cvt_pk_bf16_f32 v152, v16, v17
    v_cvt_pk_bf16_f32 v153, v18, v19
    v_cvt_pk_bf16_f32 v154, v20, v21
    v_cvt_pk_bf16_f32 v155, v22, v23
    buffer_store_dwordx4 v[152:155], v137, s[8:11], s25 offen offset:2048 sc1
    v_cvt_pk_bf16_f32 v156, v24, v25
    v_cvt_pk_bf16_f32 v157, v26, v27
    v_cvt_pk_bf16_f32 v158, v28, v29
    v_cvt_pk_bf16_f32 v159, v30, v31
    buffer_store_dwordx4 v[156:159], v137, s[8:11], s25 offen offset:3072 sc1
    v_cvt_pk_bf16_f32 v144, v32, v33
    v_cvt_pk_bf16_f32 v145, v34, v35
    v_cvt_pk_bf16_f32 v146, v36, v37
    v_cvt_pk_bf16_f32 v147, v38, v39
    s_add_u32 s25, s25, 4096
    buffer_store_dwordx4 v[144:147], v137, s[8:11], s25 offen sc1
    v_cvt_pk_bf16_f32 v148, v40, v41
    v_cvt_pk_bf16_f32 v149, v42, v43
    v_cvt_pk_bf16_f32 v150, v44, v45
    v_cvt_pk_bf16_f32 v151, v46, v47
    buffer_store_dwordx4 v[148:151], v137, s[8:11], s25 offen offset:1024 sc1
    v_cvt_pk_bf16_f32 v152, v48, v49
    v_cvt_pk_bf16_f32 v153, v50, v51
    v_cvt_pk_bf16_f32 v154, v52, v53
    v_cvt_pk_bf16_f32 v155, v54, v55
    buffer_store_dwordx4 v[152:155], v137, s[8:11], s25 offen offset:2048 sc1
    v_cvt_pk_bf16_f32 v156, v56, v57
    v_cvt_pk_bf16_f32 v157, v58, v59
    v_cvt_pk_bf16_f32 v158, v60, v61
    v_cvt_pk_bf16_f32 v159, v62, v63
    buffer_store_dwordx4 v[156:159], v137, s[8:11], s25 offen offset:3072 sc1
    s_cmp_lg_u32 s20, 15
    s_cbranch_scc1 L_p1_next
    v_mov_b32 v0, -1
    v_mov_b32 v1, -1
    v_mov_b32 v2, -1
    v_mov_b32 v3, -1
    s_sub_u32 s26, s25, 0x2001000
    s_lshr_b32 s26, s26, 1
    s_add_u32 s26, s26, 0x240000
    buffer_store_dwordx4 v[0:3], v137, s[8:11], s26 offen sc1
    buffer_store_dwordx4 v[0:3], v137, s[8:11], s26 offen offset:1024 sc1
    buffer_store_dwordx4 v[0:3], v137, s[8:11], s26 offen offset:2048 sc1
    buffer_store_dwordx4 v[0:3], v137, s[8:11], s26 offen offset:3072 sc1
    s_nop 1
L_p1_next:
    s_add_u32 s80, s80, 1
    s_lshl_b32 s40, s38, 4
    s_add_u32 s40, s40, s20
    s_lshl_b32 s40, s40, 2
    s_add_u32 s40, s40, 0x2000
    s_sub_u32 s44, s25, 4095
    s_add_u32 s38, s38, s37
    s_branch L_p1_unit
L_p1_end:
    s_waitcnt vmcnt(0)
    s_barrier
    s_cmp_eq_u32 s40, 0
    s_cbranch_scc1 L_nopf_102
    s_cmp_lg_u32 s87, 0
    s_cbranch_scc1 L_modeok_103
    v_readfirstlane_b32 s96, v140
    v_readfirstlane_b32 s97, v141
    s_nop 0
    s_cmp_lg_u32 s97, 0
    s_cselect_b32 s87, s96, 0
    s_cmp_eq_u32 s87, 1
    s_cbranch_scc1 L_modeok_103
    s_mov_b32 s96, 0
L_mode_104:
    buffer_load_dwordx2 v[140:141], off, s[92:95], 0 offset:36 sc1
    s_waitcnt vmcnt(0)
    v_readfirstlane_b32 s87, v140
    v_readfirstlane_b32 s97, v141
    s_nop 0
    s_min_u32 s97, s97, s87
    s_cmp_lg_u32 s97, 0
    s_cbranch_scc1 L_moded_105
    s_sleep 4
    s_add_u32 s96, s96, 1
    s_cmp_lg_u32 s96, 0x100
    s_cbranch_scc1 L_modef_106
    v_mov_b32 v140, 2
    v_mov_b32 v141, 0
    s_mov_b64 exec, 1
    buffer_atomic_cmpswap v[140:141], off, s[92:95], 0 offset:36
    s_mov_b64 exec, -1
L_modef_106:
    s_cmp_lt_u32 s96, 0x10000
    s_cbranch_scc1 L_mode_104
L_moded_105:
    s_cmp_lg_u32 s87, 1
    s_cbranch_scc1 L_fallback
L_modeok_103:
    s_cmp_lg_u32 s100, 0
    s_cbranch_scc1 L_flag_107
    v_mov_b32 v138, 1
    s_mov_b64 exec, 1
    buffer_store_dword v138, off, s[8:11], s40 sc1
    s_mov_b64 exec, -1
L_flag_107:
    s_mov_b32 s40, 0
L_nopf_102:
    s_cmp_lg_u32 s41, 0
    s_cbranch_scc1 L_p1done
    s_mov_b32 s41, 1
    s_mul_i32 s22, s101, 171
    s_lshr_b32 s22, s22, 11
    s_mul_i32 s26, s22, 12
    s_sub_u32 s20, s101, s26
    s_add_u32 s20, s20, 4
    s_mul_i32 s27, s101, 683
    s_lshr_b32 s27, s27, 11
    s_mul_i32 s26, s27, 3
    s_sub_u32 s26, s101, s26
    s_cmp_eq_u32 s26, 2
    s_cselect_b32 s28, 10, 11
    s_cmp_ge_u32 s101, 192
    s_cselect_b32 s20, s26, s20
    s_cselect_b32 s22, s27, s22
    s_cselect_b32 s37, s28, 16
    s_branch L_p1_pass
L_p1done:
    v_mbcnt_lo_u32_b32 v0, -1, 0
    v_mbcnt_hi_u32_b32 v0, -1, v0
    s_lshl_b32 s96, s100, 6
    v_add_u32 v0, s96, v0
    s_and_b32 s20, s101, 15
    s_lshr_b32 s22, s101, 4
    s_mov_b32 s23, 14
    v_mov_b32 v1, 0
    s_lshl_b32 s24, s20, 7
    s_add_u32 s24, s24, 0x1000
    s_mul_i32 s25, s22, 14
    s_lshr_b32 s25, s25, 4
    s_add_u32 s25, s25, 12
    s_cmp_lg_u32 s100, 0
    s_cbranch_scc1 L_polls_110
    s_mov_b32 exec_lo, 0x1
    s_mov_b32 exec_hi, 0
    s_mov_b32 s96, 0
L_poll_108:
    buffer_load_dword v2, v1, s[8:11], s24 offen sc1
    s_waitcnt vmcnt(0)
    v_cmp_gt_u32 vcc, s25, v2
    s_cbranch_vccz L_polld_109
    v_readfirstlane_b32 s97, v2
    s_nop 0
    s_sub_u32 s97, s25, s97
    s_cmp_lt_i32 s97, 3
    s_cbranch_scc1 L_near_111
    s_sleep 40
    s_cmp_lt_i32 s97, 5
    s_cbranch_scc1 L_near_111
    s_sleep 100
L_near_111:
    s_sleep 4
    s_add_u32 s96, s96, 1
    s_cmp_lt_u32 s96, 0x10000
    s_cbranch_scc1 L_poll_108
L_polld_109:
    s_mov_b64 exec, -1
L_polls_110:
    s_barrier
    s_load_dwordx2 s[12:13], s[0:1], 40
    s_waitcnt lgkmcnt(0)
    s_and_b32 s13, s13, 0xffff
    s_mov_b32 s14, 0x400000
    s_mov_b32 s15, 0x20000
    v_lshrrev_b32 v4, 6, v0
    s_nop 0
    v_readfirstlane_b32 s21, v4
    v_and_b32 v1, 63, v0
    v_lshrrev_b32 v2, 4, v1
    v_and_b32 v3, 15, v1
    v_lshrrev_b32 v6, 2, v3
    v_lshlrev_b32 v240, 4, v1
    v_lshlrev_b32 v241, 3, v1
    s_lshl_b32 s27, s21, 10
    s_lshl_b32 s24, s21, 5
    v_xor_b32 v4, s24, v240
    v_add_u32 v8, s27, v4
    v_xor_b32 v9, 128, v8
    v_lshl_add_u32 v4, v2, 2, v6
    v_and_b32 v5, 7, v4
    v_lshlrev_b32 v4, 10, v4
    v_lshl_add_u32 v4, v5, 5, v4
    v_and_b32 v5, 3, v3
    v_lshlrev_b32 v5, 4, v5
    v_xor_b32 v4, v5, v4
    s_lshl_b32 s24, s21, 8
    v_add_u32 v10, s24, v4
    s_lshl_b32 s25, s20, 18
    s_add_u32 s24, s25, 0x0
    s_add_u32 m0, s27, 0x0
    s_nop 0
    buffer_load_dwordx4 v8, s[12:15], s24 offen lds
    s_add_u32 s24, s25, 0x1000
    s_add_u32 m0, s27, 0x1000
    s_nop 0
    buffer_load_dwordx4 v9, s[12:15], s24 offen lds
    s_add_u32 s24, s25, 0x2000
    s_add_u32 m0, s27, 0x2000
    s_nop 0
    buffer_load_dwordx4 v8, s[12:15], s24 offen lds
    s_add_u32 s24, s25, 0x3000
    s_add_u32 m0, s27, 0x3000
    s_nop 0
    buffer_load_dwordx4 v9, s[12:15], s24 offen lds
    s_add_u32 s24, s25, 0x4000
    s_add_u32 m0, s27, 0x4000
    s_nop 0
    buffer_load_dwordx4 v8, s[12:15], s24 offen lds
    s_add_u32 s24, s25, 0x5000
    s_add_u32 m0, s27, 0x5000
    s_nop 0
    buffer_load_dwordx4 v9, s[12:15], s24 offen lds
    s_add_u32 s24, s25, 0x6000
    s_add_u32 m0, s27, 0x6000
    s_nop 0
    buffer_load_dwordx4 v8, s[12:15], s24 offen lds
    s_add_u32 s24, s25, 0x7000
    s_add_u32 m0, s27, 0x7000
    s_nop 0
    buffer_load_dwordx4 v9, s[12:15], s24 offen lds
    s_add_u32 s24, s25, 0x8000
    s_add_u32 m0, s27, 0x8000
    s_nop 0
    buffer_load_dwordx4 v8, s[12:15], s24 offen lds
    s_add_u32 s24, s25, 0x9000
    s_add_u32 m0, s27, 0x9000
    s_nop 0
    buffer_load_dwordx4 v9, s[12:15], s24 offen lds
    s_add_u32 s24, s25, 0xa000
    s_add_u32 m0, s27, 0xa000
    s_nop 0
    buffer_load_dwordx4 v8, s[12:15], s24 offen lds
    s_add_u32 s24, s25, 0xb000
    s_add_u32 m0, s27, 0xb000
    s_nop 0
    buffer_load_dwordx4 v9, s[12:15], s24 offen lds
    s_add_u32 s24, s25, 0xc000
    s_add_u32 m0, s27, 0xc000
    s_nop 0
    buffer_load_dwordx4 v8, s[12:15], s24 offen lds
    s_add_u32 s24, s25, 0xd000
    s_add_u32 m0, s27, 0xd000
    s_nop 0
    buffer_load_dwordx4 v9, s[12:15], s24 offen lds
    s_add_u32 s24, s25, 0xe000
    s_add_u32 m0, s27, 0xe000
    s_nop 0
    buffer_load_dwordx4 v8, s[12:15], s24 offen lds
    s_add_u32 s24, s25, 0xf000
    s_add_u32 m0, s27, 0xf000
    s_nop 0
    buffer_load_dwordx4 v9, s[12:15], s24 offen lds
    s_add_u32 s24, s25, 0x10000
    s_add_u32 m0, s27, 0x10000
    s_nop 0
    buffer_load_dwordx4 v8, s[12:15], s24 offen lds
    s_add_u32 s24, s25, 0x11000
    s_add_u32 m0, s27, 0x11000
    s_nop 0
    buffer_load_dwordx4 v9, s[12:15], s24 offen lds
    s_add_u32 s24, s25, 0x12000
    s_add_u32 m0, s27, 0x12000
    s_nop 0
    buffer_load_dwordx4 v8, s[12:15], s24 offen lds
    s_add_u32 s24, s25, 0x13000
    s_add_u32 m0, s27, 0x13000
    s_nop 0
    buffer_load_dwordx4 v9, s[12:15], s24 offen lds
    s_add_u32 s24, s25, 0x14000
    s_add_u32 m0, s27, 0x14000
    s_nop 0
    buffer_load_dwordx4 v8, s[12:15], s24 offen lds
    s_add_u32 s24, s25, 0x15000
    s_add_u32 m0, s27, 0x15000
    s_nop 0
    buffer_load_dwordx4 v9, s[12:15], s24 offen lds
    s_add_u32 s24, s25, 0x16000
    s_add_u32 m0, s27, 0x16000
    s_nop 0
    buffer_load_dwordx4 v8, s[12:15], s24 offen lds
    s_add_u32 s24, s25, 0x17000
    s_add_u32 m0, s27, 0x17000
    s_nop 0
    buffer_load_dwordx4 v9, s[12:15], s24 offen lds
    s_add_u32 s24, s25, 0x18000
    s_add_u32 m0, s27, 0x18000
    s_nop 0
    buffer_load_dwordx4 v8, s[12:15], s24 offen lds
    s_add_u32 s24, s25, 0x19000
    s_add_u32 m0, s27, 0x19000
    s_nop 0
    buffer_load_dwordx4 v9, s[12:15], s24 offen lds
    s_add_u32 s24, s25, 0x1a000
    s_add_u32 m0, s27, 0x1a000
    s_nop 0
    buffer_load_dwordx4 v8, s[12:15], s24 offen lds
    s_add_u32 s24, s25, 0x1b000
    s_add_u32 m0, s27, 0x1b000
    s_nop 0
    buffer_load_dwordx4 v9, s[12:15], s24 offen lds
    s_add_u32 s24, s25, 0x1c000
    s_add_u32 m0, s27, 0x1c000
    s_nop 0
    buffer_load_dwordx4 v8, s[12:15], s24 offen lds
    s_add_u32 s24, s25, 0x1d000
    s_add_u32 m0, s27, 0x1d000
    s_nop 0
    buffer_load_dwordx4 v9, s[12:15], s24 offen lds
    s_add_u32 s24, s25, 0x1e000
    s_add_u32 m0, s27, 0x1e000
    s_nop 0
    buffer_load_dwordx4 v8, s[12:15], s24 offen lds
    s_add_u32 s24, s25, 0x1f000
    s_add_u32 m0, s27, 0x1f000
    s_nop 0
    buffer_load_dwordx4 v9, s[12:15], s24 offen lds
    s_waitcnt vmcnt(0)
    s_barrier
    v_xor_b32 v11, 0x0, v10
    ds_read_b64_tr_b16 a[0:1], v11
    ds_read_b64_tr_b16 a[2:3], v11 offset:16384
    ds_read_b64_tr_b16 a[32:33], v11 offset:32768
    ds_read_b64_tr_b16 a[34:35], v11 offset:49152
    v_xor_b32 v11, 0x8, v10
    ds_read_b64_tr_b16 a[4:5], v11
    ds_read_b64_tr_b16 a[6:7], v11 offset:16384
    ds_read_b64_tr_b16 a[36:37], v11 offset:32768
    ds_read_b64_tr_b16 a[38:39], v11 offset:49152
    s_waitcnt lgkmcnt(0)
    v_xor_b32 v11, 0x40, v10
    ds_read_b64_tr_b16 a[8:9], v11
    ds_read_b64_tr_b16 a[10:11], v11 offset:16384
    ds_read_b64_tr_b16 a[40:41], v11 offset:32768
    ds_read_b64_tr_b16 a[42:43], v11 offset:49152
    v_xor_b32 v11, 0x48, v10
    ds_read_b64_tr_b16 a[12:13], v11
    ds_read_b64_tr_b16 a[14:15], v11 offset:16384
    ds_read_b64_tr_b16 a[44:45], v11 offset:32768
    ds_read_b64_tr_b16 a[46:47], v11 offset:49152
    s_waitcnt lgkmcnt(0)
    v_xor_b32 v11, 0x80, v10
    ds_read_b64_tr_b16 a[16:17], v11
    ds_read_b64_tr_b16 a[18:19], v11 offset:16384
    ds_read_b64_tr_b16 a[48:49], v11 offset:32768
    ds_read_b64_tr_b16 a[50:51], v11 offset:49152
    v_xor_b32 v11, 0x88, v10
    ds_read_b64_tr_b16 a[20:21], v11
    ds_read_b64_tr_b16 a[22:23], v11 offset:16384
    ds_read_b64_tr_b16 a[52:53], v11 offset:32768
    ds_read_b64_tr_b16 a[54:55], v11 offset:49152
    s_waitcnt lgkmcnt(0)
    v_xor_b32 v11, 0xc0, v10
    ds_read_b64_tr_b16 a[24:25], v11
    ds_read_b64_tr_b16 a[26:27], v11 offset:16384
    ds_read_b64_tr_b16 a[56:57], v11 offset:32768
    ds_read_b64_tr_b16 a[58:59], v11 offset:49152
    v_xor_b32 v11, 0xc8, v10
    ds_read_b64_tr_b16 a[28:29], v11
    ds_read_b64_tr_b16 a[30:31], v11 offset:16384
    ds_read_b64_tr_b16 a[60:61], v11 offset:32768
    ds_read_b64_tr_b16 a[62:63], v11 offset:49152
    s_waitcnt lgkmcnt(0)
    v_xor_b32 v11, 0x10000, v10
    ds_read_b64_tr_b16 a[64:65], v11
    ds_read_b64_tr_b16 a[66:67], v11 offset:16384
    ds_read_b64_tr_b16 a[96:97], v11 offset:32768
    ds_read_b64_tr_b16 a[98:99], v11 offset:49152
    v_xor_b32 v11, 0x10008, v10
    ds_read_b64_tr_b16 a[68:69], v11
    ds_read_b64_tr_b16 a[70:71], v11 offset:16384
    ds_read_b64_tr_b16 a[100:101], v11 offset:32768
    ds_read_b64_tr_b16 a[102:103], v11 offset:49152
    s_waitcnt lgkmcnt(0)
    v_xor_b32 v11, 0x10040, v10
    ds_read_b64_tr_b16 a[72:73], v11
    ds_read_b64_tr_b16 a[74:75], v11 offset:16384
    ds_read_b64_tr_b16 a[104:105], v11 offset:32768
    ds_read_b64_tr_b16 a[106:107], v11 offset:49152
    v_xor_b32 v11, 0x10048, v10
    ds_read_b64_tr_b16 a[76:77], v11
    ds_read_b64_tr_b16 a[78:79], v11 offset:16384
    ds_read_b64_tr_b16 a[108:109], v11 offset:32768
    ds_read_b64_tr_b16 a[110:111], v11 offset:49152
    s_waitcnt lgkmcnt(0)
    v_xor_b32 v11, 0x10080, v10
    ds_read_b64_tr_b16 a[80:81], v11
    ds_read_b64_tr_b16 a[82:83], v11 offset:16384
    ds_read_b64_tr_b16 a[112:113], v11 offset:32768
    ds_read_b64_tr_b16 a[114:115], v11 offset:49152
    v_xor_b32 v11, 0x10088, v10
    ds_read_b64_tr_b16 a[84:85], v11
    ds_read_b64_tr_b16 a[86:87], v11 offset:16384
    ds_read_b64_tr_b16 a[116:117], v11 offset:32768
    ds_read_b64_tr_b16 a[118:119], v11 offset:49152
    s_waitcnt lgkmcnt(0)
    v_xor_b32 v11, 0x100c0, v10
    ds_read_b64_tr_b16 a[88:89], v11
    ds_read_b64_tr_b16 a[90:91], v11 offset:16384
    ds_read_b64_tr_b16 a[120:121], v11 offset:32768
    ds_read_b64_tr_b16 a[122:123], v11 offset:49152
    v_xor_b32 v11, 0x100c8, v10
    ds_read_b64_tr_b16 a[92:93], v11
    ds_read_b64_tr_b16 a[94:95], v11 offset:16384
    ds_read_b64_tr_b16 a[124:125], v11 offset:32768
    ds_read_b64_tr_b16 a[126:127], v11 offset:49152
    s_waitcnt lgkmcnt(0)
    s_barrier
    s_lshl_b32 s25, s20, 18
    s_add_u32 s24, s25, 0x20000
    s_add_u32 m0, s27, 0x0
    s_nop 0
    buffer_load_dwordx4 v8, s[12:15], s24 offen lds
    s_add_u32 s24, s25, 0x21000
    s_add_u32 m0, s27, 0x1000
    s_nop 0
    buffer_load_dwordx4 v9, s[12:15], s24 offen lds
    s_add_u32 s24, s25, 0x22000
    s_add_u32 m0, s27, 0x2000
    s_nop 0
    buffer_load_dwordx4 v8, s[12:15], s24 offen lds
    s_add_u32 s24, s25, 0x23000
    s_add_u32 m0, s27, 0x3000
    s_nop 0
    buffer_load_dwordx4 v9, s[12:15], s24 offen lds
    s_add_u32 s24, s25, 0x24000
    s_add_u32 m0, s27, 0x4000
    s_nop 0
    buffer_load_dwordx4 v8, s[12:15], s24 offen lds
    s_add_u32 s24, s25, 0x25000
    s_add_u32 m0, s27, 0x5000
    s_nop 0
    buffer_load_dwordx4 v9, s[12:15], s24 offen lds
    s_add_u32 s24, s25, 0x26000
    s_add_u32 m0, s27, 0x6000
    s_nop 0
    buffer_load_dwordx4 v8, s[12:15], s24 offen lds
    s_add_u32 s24, s25, 0x27000
    s_add_u32 m0, s27, 0x7000
    s_nop 0
    buffer_load_dwordx4 v9, s[12:15], s24 offen lds
    s_add_u32 s24, s25, 0x28000
    s_add_u32 m0, s27, 0x8000
    s_nop 0
    buffer_load_dwordx4 v8, s[12:15], s24 offen lds
    s_add_u32 s24, s25, 0x29000
    s_add_u32 m0, s27, 0x9000
    s_nop 0
    buffer_load_dwordx4 v9, s[12:15], s24 offen lds
    s_add_u32 s24, s25, 0x2a000
    s_add_u32 m0, s27, 0xa000
    s_nop 0
    buffer_load_dwordx4 v8, s[12:15], s24 offen lds
    s_add_u32 s24, s25, 0x2b000
    s_add_u32 m0, s27, 0xb000
    s_nop 0
    buffer_load_dwordx4 v9, s[12:15], s24 offen lds
    s_add_u32 s24, s25, 0x2c000
    s_add_u32 m0, s27, 0xc000
    s_nop 0
    buffer_load_dwordx4 v8, s[12:15], s24 offen lds
    s_add_u32 s24, s25, 0x2d000
    s_add_u32 m0, s27, 0xd000
    s_nop 0
    buffer_load_dwordx4 v9, s[12:15], s24 offen lds
    s_add_u32 s24, s25, 0x2e000
    s_add_u32 m0, s27, 0xe000
    s_nop 0
    buffer_load_dwordx4 v8, s[12:15], s24 offen lds
    s_add_u32 s24, s25, 0x2f000
    s_add_u32 m0, s27, 0xf000
    s_nop 0
    buffer_load_dwordx4 v9, s[12:15], s24 offen lds
    s_add_u32 s24, s25, 0x30000
    s_add_u32 m0, s27, 0x10000
    s_nop 0
    buffer_load_dwordx4 v8, s[12:15], s24 offen lds
    s_add_u32 s24, s25, 0x31000
    s_add_u32 m0, s27, 0x11000
    s_nop 0
    buffer_load_dwordx4 v9, s[12:15], s24 offen lds
    s_add_u32 s24, s25, 0x32000
    s_add_u32 m0, s27, 0x12000
    s_nop 0
    buffer_load_dwordx4 v8, s[12:15], s24 offen lds
    s_add_u32 s24, s25, 0x33000
    s_add_u32 m0, s27, 0x13000
    s_nop 0
    buffer_load_dwordx4 v9, s[12:15], s24 offen lds
    s_add_u32 s24, s25, 0x34000
    s_add_u32 m0, s27, 0x14000
    s_nop 0
    buffer_load_dwordx4 v8, s[12:15], s24 offen lds
    s_add_u32 s24, s25, 0x35000
    s_add_u32 m0, s27, 0x15000
    s_nop 0
    buffer_load_dwordx4 v9, s[12:15], s24 offen lds
    s_add_u32 s24, s25, 0x36000
    s_add_u32 m0, s27, 0x16000
    s_nop 0
    buffer_load_dwordx4 v8, s[12:15], s24 offen lds
    s_add_u32 s24, s25, 0x37000
    s_add_u32 m0, s27, 0x17000
    s_nop 0
    buffer_load_dwordx4 v9, s[12:15], s24 offen lds
    s_add_u32 s24, s25, 0x38000
    s_add_u32 m0, s27, 0x18000
    s_nop 0
    buffer_load_dwordx4 v8, s[12:15], s24 offen lds
    s_add_u32 s24, s25, 0x39000
    s_add_u32 m0, s27, 0x19000
    s_nop 0
    buffer_load_dwordx4 v9, s[12:15], s24 offen lds
    s_add_u32 s24, s25, 0x3a000
    s_add_u32 m0, s27, 0x1a000
    s_nop 0
    buffer_load_dwordx4 v8, s[12:15], s24 offen lds
    s_add_u32 s24, s25, 0x3b000
    s_add_u32 m0, s27, 0x1b000
    s_nop 0
    buffer_load_dwordx4 v9, s[12:15], s24 offen lds
    s_add_u32 s24, s25, 0x3c000
    s_add_u32 m0, s27, 0x1c000
    s_nop 0
    buffer_load_dwordx4 v8, s[12:15], s24 offen lds
    s_add_u32 s24, s25, 0x3d000
    s_add_u32 m0, s27, 0x1d000
    s_nop 0
    buffer_load_dwordx4 v9, s[12:15], s24 offen lds
    s_add_u32 s24, s25, 0x3e000
    s_add_u32 m0, s27, 0x1e000
    s_nop 0
    buffer_load_dwordx4 v8, s[12:15], s24 offen lds
    s_add_u32 s24, s25, 0x3f000
    s_add_u32 m0, s27, 0x1f000
    s_nop 0
    buffer_load_dwordx4 v9, s[12:15], s24 offen lds
    s_waitcnt vmcnt(0)
    s_barrier
    v_xor_b32 v11, 0x0, v10
    ds_read_b64_tr_b16 a[128:129], v11
    ds_read_b64_tr_b16 a[130:131], v11 offset:16384
    ds_read_b64_tr_b16 a[160:161], v11 offset:32768
    ds_read_b64_tr_b16 a[162:163], v11 offset:49152
    v_xor_b32 v11, 0x8, v10
    ds_read_b64_tr_b16 a[132:133], v11
    ds_read_b64_tr_b16 a[134:135], v11 offset:16384
    ds_read_b64_tr_b16 a[164:165], v11 offset:32768
    ds_read_b64_tr_b16 a[166:167], v11 offset:49152
    s_waitcnt lgkmcnt(0)
    v_xor_b32 v11, 0x40, v10
    ds_read_b64_tr_b16 a[136:137], v11
    ds_read_b64_tr_b16 a[138:139], v11 offset:16384
    ds_read_b64_tr_b16 a[168:169], v11 offset:32768
    ds_read_b64_tr_b16 a[170:171], v11 offset:49152
    v_xor_b32 v11, 0x48, v10
    ds_read_b64_tr_b16 a[140:141], v11
    ds_read_b64_tr_b16 a[142:143], v11 offset:16384
    ds_read_b64_tr_b16 a[172:173], v11 offset:32768
    ds_read_b64_tr_b16 a[174:175], v11 offset:49152
    s_waitcnt lgkmcnt(0)
    v_xor_b32 v11, 0x80, v10
    ds_read_b64_tr_b16 a[144:145], v11
    ds_read_b64_tr_b16 a[146:147], v11 offset:16384
    ds_read_b64_tr_b16 a[176:177], v11 offset:32768
    ds_read_b64_tr_b16 a[178:179], v11 offset:49152
    v_xor_b32 v11, 0x88, v10
    ds_read_b64_tr_b16 a[148:149], v11
    ds_read_b64_tr_b16 a[150:151], v11 offset:16384
    ds_read_b64_tr_b16 a[180:181], v11 offset:32768
    ds_read_b64_tr_b16 a[182:183], v11 offset:49152
    s_waitcnt lgkmcnt(0)
    v_xor_b32 v11, 0xc0, v10
    ds_read_b64_tr_b16 a[152:153], v11
    ds_read_b64_tr_b16 a[154:155], v11 offset:16384
    ds_read_b64_tr_b16 a[184:185], v11 offset:32768
    ds_read_b64_tr_b16 a[186:187], v11 offset:49152
    v_xor_b32 v11, 0xc8, v10
    ds_read_b64_tr_b16 a[156:157], v11
    ds_read_b64_tr_b16 a[158:159], v11 offset:16384
    ds_read_b64_tr_b16 a[188:189], v11 offset:32768
    ds_read_b64_tr_b16 a[190:191], v11 offset:49152
    s_waitcnt lgkmcnt(0)
    v_xor_b32 v11, 0x10000, v10
    ds_read_b64_tr_b16 a[192:193], v11
    ds_read_b64_tr_b16 a[194:195], v11 offset:16384
    ds_read_b64_tr_b16 a[224:225], v11 offset:32768
    ds_read_b64_tr_b16 a[226:227], v11 offset:49152
    v_xor_b32 v11, 0x10008, v10
    ds_read_b64_tr_b16 a[196:197], v11
    ds_read_b64_tr_b16 a[198:199], v11 offset:16384
    ds_read_b64_tr_b16 a[228:229], v11 offset:32768
    ds_read_b64_tr_b16 a[230:231], v11 offset:49152
    s_waitcnt lgkmcnt(0)
    v_xor_b32 v11, 0x10040, v10
    ds_read_b64_tr_b16 a[200:201], v11
    ds_read_b64_tr_b16 a[202:203], v11 offset:16384
    ds_read_b64_tr_b16 a[232:233], v11 offset:32768
    ds_read_b64_tr_b16 a[234:235], v11 offset:49152
    v_xor_b32 v11, 0x10048, v10
    ds_read_b64_tr_b16 a[204:205], v11
    ds_read_b64_tr_b16 a[206:207], v11 offset:16384
    ds_read_b64_tr_b16 a[236:237], v11 offset:32768
    ds_read_b64_tr_b16 a[238:239], v11 offset:49152
    s_waitcnt lgkmcnt(0)
    v_xor_b32 v11, 0x10080, v10
    ds_read_b64_tr_b16 a[208:209], v11
    ds_read_b64_tr_b16 a[210:211], v11 offset:16384
    ds_read_b64_tr_b16 a[240:241], v11 offset:32768
    ds_read_b64_tr_b16 a[242:243], v11 offset:49152
    v_xor_b32 v11, 0x10088, v10
    ds_read_b64_tr_b16 a[212:213], v11
    ds_read_b64_tr_b16 a[214:215], v11 offset:16384
    ds_read_b64_tr_b16 a[244:245], v11 offset:32768
    ds_read_b64_tr_b16 a[246:247], v11 offset:49152
    s_waitcnt lgkmcnt(0)
    v_xor_b32 v11, 0x100c0, v10
    ds_read_b64_tr_b16 a[216:217], v11
    ds_read_b64_tr_b16 a[218:219], v11 offset:16384
    ds_read_b64_tr_b16 a[248:249], v11 offset:32768
    ds_read_b64_tr_b16 a[250:251], v11 offset:49152
    v_xor_b32 v11, 0x100c8, v10
    ds_read_b64_tr_b16 a[220:221], v11
    ds_read_b64_tr_b16 a[222:223], v11 offset:16384
    ds_read_b64_tr_b16 a[252:253], v11 offset:32768
    ds_read_b64_tr_b16 a[254:255], v11 offset:49152
    s_waitcnt lgkmcnt(0)
    s_barrier
    s_and_b32 s24, s21, 1
    s_lshl_b32 s24, s24, 4
    v_add_u32 v4, s24, v3
    v_lshlrev_b32 v5, 2, v2
    v_sub_u32 v4, v4, v5
    v_cmp_le_i32 s[30:31], 0, v4
    v_cmp_le_i32 s[32:33], 1, v4
    v_cmp_le_i32 s[34:35], 2, v4
    v_cmp_le_i32 s[36:37], 3, v4
    v_cmp_le_i32 s[38:39], 16, v4
    v_cmp_le_i32 s[40:41], 17, v4
    v_cmp_le_i32 s[42:43], 18, v4
    v_cmp_le_i32 s[44:45], 19, v4
    s_mov_b32 s28, 0x3e0293ee
    s_mov_b32 s29, 0x3e0293ee
    s_mov_b32 s53, 0xff000000
    v_mov_b32 v136, 0x3f803f80
    v_mov_b32 v137, 0x3f803f80
    v_mov_b32 v138, 0x3f803f80
    v_mov_b32 v139, 0x3f803f80
    v_lshlrev_b32 v4, 10, v3
    v_lshl_add_u32 v4, v2, 4, v4
    s_lshl_b32 s24, s21, 8
    v_add_u32 v242, s24, v4
    s_lshl_b32 s24, s21, 12
    v_add_u32 v243, s24, v240
    v_mov_b32 v244, v240
    s_add_u32 s24, s24, 0x22000
    v_xor_b32 v7, v2, v6
    v_lshl_add_u32 v4, v2, 4, v7
    v_and_b32 v5, 3, v3
    v_lshl_add_u32 v4, v4, 2, v5
    v_lshl_add_u32 v253, v4, 2, s24
    v_lshl_add_u32 v4, v3, 2, v7
    v_lshl_add_u32 v254, v4, 4, s24
    s_load_dwordx2 s[12:13], s[0:1], 0
    s_waitcnt lgkmcnt(0)
    s_and_b32 s13, s13, 0xffff
    s_mov_b32 s14, 0x200000
    s_mov_b32 s15, 0x20000
    s_load_dwordx2 s[16:17], s[0:1], 96
    s_waitcnt lgkmcnt(0)
    s_and_b32 s17, s17, 0xffff
    s_mov_b32 s18, 0x200000
    s_mov_b32 s19, 0x20000
    s_load_dwordx2 s[56:57], s[0:1], 64
    s_waitcnt lgkmcnt(0)
    s_and_b32 s57, s57, 0xffff
    s_mov_b32 s58, 0x400
    s_mov_b32 s59, 0x20000
    v_and_b32 v100, 63, v0
    v_lshlrev_b32 v240, 4, v100
    buffer_load_dwordx4 v[236:239], v240, s[56:59], 0 offen
    s_mov_b32 s65, 0x3f80
    s_mov_b32 s66, 0x3f800000
    s_waitcnt vmcnt(0)
    s_sub_u32 s67, s101, 128
    s_cmp_ge_u32 s67, 56
    s_cbranch_scc1 L_nostage_112
L_nostage_112:
    v_lshrrev_b32 v246, 2, v240
    s_lshl_b32 s24, s20, 7
    s_add_u32 s24, s24, 0x2000
    s_cmp_lg_u32 s100, 0
    s_cbranch_scc1 L_polls_115
    s_mov_b32 exec_lo, 0xffffffff
    s_mov_b32 exec_hi, 0
    s_mov_b32 s96, 0
L_poll_113:
    buffer_load_dword v247, v246, s[8:11], s24 offen sc1
    s_waitcnt vmcnt(0)
    v_cmp_gt_u32 vcc, 1, v247
    s_cbranch_vccz L_polld_114
    s_sleep 32
    s_add_u32 s96, s96, 1
    s_cmp_lt_u32 s96, 0x10000
    s_cbranch_scc1 L_poll_113
L_polld_114:
    s_mov_b64 exec, -1
L_polls_115:
    s_barrier
    s_lshl_b32 s24, s20, 7
    s_add_u32 s24, s24, 0x2800
    s_cmp_lg_u32 s100, 0
    s_cbranch_scc1 L_polls_118
    s_mov_b32 exec_lo, 0xffffffff
    s_mov_b32 exec_hi, 0
    s_mov_b32 s96, 0
L_poll_116:
    buffer_load_dword v247, v246, s[8:11], s24 offen sc1
    s_waitcnt vmcnt(0)
    v_cmp_gt_u32 vcc, 1, v247
    s_cbranch_vccz L_polld_117
    s_sleep 32
    s_add_u32 s96, s96, 1
    s_cmp_lt_u32 s96, 0x10000
    s_cbranch_scc1 L_poll_116
L_polld_117:
    s_mov_b64 exec, -1
L_polls_118:
    s_barrier
    s_lshl_b32 s24, s20, 7
    s_add_u32 s24, s24, 0x3000
    s_cmp_lg_u32 s100, 0
    s_cbranch_scc1 L_polls_121
    s_mov_b32 exec_lo, 0xffffffff
    s_mov_b32 exec_hi, 0
    s_mov_b32 s96, 0
L_poll_119:
    buffer_load_dword v247, v246, s[8:11], s24 offen sc1
    s_waitcnt vmcnt(0)
    v_cmp_gt_u32 vcc, 1, v247
    s_cbranch_vccz L_polld_120
    s_sleep 32
    s_add_u32 s96, s96, 1
    s_cmp_lt_u32 s96, 0x10000
    s_cbranch_scc1 L_poll_119
L_polld_120:
    s_mov_b64 exec, -1
L_polls_121:
    s_barrier
    s_mov_b32 s80, 0
    s_mov_b32 s82, 0
    v_add_u32 v105, 0x8000, v240
    v_add_u32 v106, 0x10000, v240
    v_add_u32 v107, 0x18000, v240
    s_lshl_b32 s24, s21, 12
    s_add_u32 s24, s24, 0x22000
    v_add_u32 v109, s24, v240
    s_nop 4
L_p2_seg:
    s_cmp_ge_u32 s22, 64
    s_cbranch_scc1 L_p2_end
    v_lshrrev_b32 v246, 2, v240
    s_lshl_b32 s24, s20, 7
    s_add_u32 s24, s24, 0x1000
    s_mul_i32 s25, s22, 10
    s_lshr_b32 s25, s25, 4
    s_add_u32 s25, s25, 17
    s_cmp_lg_u32 s100, 0
    s_cbranch_scc1 L_polls_124
    s_mov_b32 exec_lo, 0x1
    s_mov_b32 exec_hi, 0
    s_mov_b32 s96, 0
L_poll_122:
    buffer_load_dword v247, v246, s[8:11], s24 offen sc1
    s_waitcnt vmcnt(0)
    v_cmp_gt_u32 vcc, s25, v247
    s_cbranch_vccz L_polld_123
    v_readfirstlane_b32 s97, v247
    s_nop 0
    s_sub_u32 s97, s25, s97
    s_cmp_lt_i32 s97, 3
    s_cbranch_scc1 L_near_125
    s_sleep 40
    s_cmp_lt_i32 s97, 5
    s_cbranch_scc1 L_near_125
    s_sleep 100
L_near_125:
    s_sleep 4
    s_add_u32 s96, s96, 1
    s_cmp_lt_u32 s96, 0x10000
    s_cbranch_scc1 L_poll_122
L_polld_123:
    s_mov_b64 exec, -1
L_polls_124:
    s_barrier
    s_cmp_ge_u32 s67, 56
    s_cbranch_scc1 L_nostage_126
    v_mbcnt_lo_u32_b32 v0, -1, 0
    v_mbcnt_hi_u32_b32 v0, -1, v0
    s_lshl_b32 s96, s100, 6
    v_add_u32 v0, s96, v0
    v_lshrrev_b32 v2, 6, v0
    s_nop 0
    v_readfirstlane_b32 s68, v2
    v_and_b32 v1, 63, v0
    s_lshl_b32 s73, s68, 10
    v_lshrrev_b32 v2, 2, v1
    s_lshl_b32 s71, s68, 4
    v_add_u32 v2, s71, v2
    s_movk_i32 s71, 3584
    v_mul_lo_u32 v2, v2, s71
    v_and_b32 v3, 3, v1
    v_lshl_add_u32 v4, v3, 4, v2
    s_cmp_lg_u32 s80, 0
    s_cbranch_scc1 L_part_127
    s_load_dwordx2 s[76:77], s[0:1], 72
    s_waitcnt lgkmcnt(0)
    s_and_b32 s77, s77, 0xffff
    s_mov_b32 s78, 0x1c0000
    s_mov_b32 s79, 0x20000
    s_lshl_b32 s71, s67, 6
    s_add_u32 s71, s71, 0x0
    s_add_u32 m0, s73, 0x8000
    s_nop 0
    buffer_load_dwordx4 v4, s[76:79], s71 offen lds
    s_lshl_b32 s71, s67, 6
    s_add_u32 s71, s71, 0x38000
    s_add_u32 m0, s73, 0x9000
    s_nop 0
    buffer_load_dwordx4 v4, s[76:79], s71 offen lds
    s_lshl_b32 s71, s67, 6
    s_add_u32 s71, s71, 0x70000
    s_add_u32 m0, s73, 0xa000
    s_nop 0
    buffer_load_dwordx4 v4, s[76:79], s71 offen lds
    s_lshl_b32 s71, s67, 6
    s_add_u32 s71, s71, 0xa8000
    s_add_u32 m0, s73, 0xb000
    s_nop 0
    buffer_load_dwordx4 v4, s[76:79], s71 offen lds
    s_lshl_b32 s71, s67, 6
    s_add_u32 s71, s71, 0xe0000
    s_add_u32 m0, s73, 0xc000
    s_nop 0
    buffer_load_dwordx4 v4, s[76:79], s71 offen lds
    s_lshl_b32 s71, s67, 6
    s_add_u32 s71, s71, 0x118000
    s_add_u32 m0, s73, 0xd000
    s_nop 0
    buffer_load_dwordx4 v4, s[76:79], s71 offen lds
    s_lshl_b32 s71, s67, 6
    s_add_u32 s71, s71, 0x150000
    s_add_u32 m0, s73, 0xe000
    s_nop 0
    buffer_load_dwordx4 v4, s[76:79], s71 offen lds
    s_lshl_b32 s71, s67, 6
    s_add_u32 s71, s71, 0x188000
    s_add_u32 m0, s73, 0xf000
    s_nop 0
    buffer_load_dwordx4 v4, s[76:79], s71 offen lds
L_part_127:
    s_cmp_lg_u32 s80, 4
    s_cbranch_scc1 L_part_128
    s_load_dwordx2 s[76:77], s[0:1], 80
    s_waitcnt lgkmcnt(0)
    s_and_b32 s77, s77, 0xffff
    s_mov_b32 s78, 0x1c0000
    s_mov_b32 s79, 0x20000
    s_lshl_b32 s71, s67, 6
    s_add_u32 s71, s71, 0x0
    s_add_u32 m0, s73, 0x10000
    s_nop 0
    buffer_load_dwordx4 v4, s[76:79], s71 offen lds
    s_lshl_b32 s71, s67, 6
    s_add_u32 s71, s71, 0x38000
    s_add_u32 m0, s73, 0x11000
    s_nop 0
    buffer_load_dwordx4 v4, s[76:79], s71 offen lds
    s_lshl_b32 s71, s67, 6
    s_add_u32 s71, s71, 0x70000
    s_add_u32 m0, s73, 0x12000
    s_nop 0
    buffer_load_dwordx4 v4, s[76:79], s71 offen lds
    s_lshl_b32 s71, s67, 6
    s_add_u32 s71, s71, 0xa8000
    s_add_u32 m0, s73, 0x13000
    s_nop 0
    buffer_load_dwordx4 v4, s[76:79], s71 offen lds
    s_lshl_b32 s71, s67, 6
    s_add_u32 s71, s71, 0xe0000
    s_add_u32 m0, s73, 0x14000
    s_nop 0
    buffer_load_dwordx4 v4, s[76:79], s71 offen lds
    s_lshl_b32 s71, s67, 6
    s_add_u32 s71, s71, 0x118000
    s_add_u32 m0, s73, 0x15000
    s_nop 0
    buffer_load_dwordx4 v4, s[76:79], s71 offen lds
    s_lshl_b32 s71, s67, 6
    s_add_u32 s71, s71, 0x150000
    s_add_u32 m0, s73, 0x16000
    s_nop 0
    buffer_load_dwordx4 v4, s[76:79], s71 offen lds
    s_lshl_b32 s71, s67, 6
    s_add_u32 s71, s71, 0x188000
    s_add_u32 m0, s73, 0x17000
    s_nop 0
    buffer_load_dwordx4 v4, s[76:79], s71 offen lds
L_part_128:
    s_cmp_lg_u32 s80, 8
    s_cbranch_scc1 L_part_129
    s_load_dwordx2 s[76:77], s[0:1], 88
    s_waitcnt lgkmcnt(0)
    s_and_b32 s77, s77, 0xffff
    s_mov_b32 s78, 0x1c0000
    s_mov_b32 s79, 0x20000
    v_lshlrev_b32 v5, 4, v1
    v_add_u32 v5, s73, v5
    s_lshl_b32 s71, s67, 15
    s_add_u32 s71, s71, 0
    s_add_u32 m0, s73, 0x18000
    s_nop 0
    buffer_load_dwordx4 v5, s[76:79], s71 offen lds
    s_lshl_b32 s71, s67, 15
    s_add_u32 s71, s71, 4096
    s_add_u32 m0, s73, 0x19000
    s_nop 0
    buffer_load_dwordx4 v5, s[76:79], s71 offen lds
    s_lshl_b32 s71, s67, 15
    s_add_u32 s71, s71, 8192
    s_add_u32 m0, s73, 0x1a000
    s_nop 0
    buffer_load_dwordx4 v5, s[76:79], s71 offen lds
    s_lshl_b32 s71, s67, 15
    s_add_u32 s71, s71, 12288
    s_add_u32 m0, s73, 0x1b000
    s_nop 0
    buffer_load_dwordx4 v5, s[76:79], s71 offen lds
    s_lshl_b32 s71, s67, 15
    s_add_u32 s71, s71, 16384
    s_add_u32 m0, s73, 0x1c000
    s_nop 0
    buffer_load_dwordx4 v5, s[76:79], s71 offen lds
    s_lshl_b32 s71, s67, 15
    s_add_u32 s71, s71, 20480
    s_add_u32 m0, s73, 0x1d000
    s_nop 0
    buffer_load_dwordx4 v5, s[76:79], s71 offen lds
    s_lshl_b32 s71, s67, 15
    s_add_u32 s71, s71, 24576
    s_add_u32 m0, s73, 0x1e000
    s_nop 0
    buffer_load_dwordx4 v5, s[76:79], s71 offen lds
    s_lshl_b32 s71, s67, 15
    s_add_u32 s71, s71, 28672
    s_add_u32 m0, s73, 0x1f000
    s_nop 0
    buffer_load_dwordx4 v5, s[76:79], s71 offen lds
L_part_129:
L_nostage_126:
    s_lshl_b32 s24, s22, 5
    s_lshl_b32 s25, s20, 1
    s_add_u32 s24, s24, s25
    s_lshr_b32 s25, s21, 1
    s_add_u32 s24, s24, s25
    s_lshl_b32 s25, s24, 13
    s_add_u32 s47, s25, 0x1000000
    s_add_u32 s54, s47, 4096
    s_add_u32 s48, s25, 0x2000000
    s_add_u32 s55, s48, 4096
    s_and_b32 s26, s21, 1
    s_lshl_b32 s26, s26, 12
    s_add_u32 s46, s25, s26
    s_add_u32 s46, s46, 0x3000000
    s_lshl_b32 s25, s24, 12
    s_add_u32 s49, s25, 0x240000
    s_lshl_b32 s24, s22, 4
    s_add_u32 s24, s24, s20
    s_lshl_b32 s24, s24, 15
    s_add_u32 s51, s24, 0x4000000
    s_cmp_ge_u32 s22, 60
    s_cselect_b32 s81, 1, 0
    s_lshl_b32 s60, s20, 1
    s_lshr_b32 s24, s100, 1
    s_add_u32 s60, s60, s24
    s_cmp_ge_u32 s22, 62
    s_cselect_b32 s24, 1, 0
    s_max_u32 s82, s82, s24
    s_lshl_b32 s24, s82, 3
    s_and_b32 s24, s24, 16
    s_add_u32 s24, s24, s20
    s_cmp_lg_u32 s82, 0
    s_cselect_b32 s60, s24, s60
    s_cselect_b32 s61, 0, 0x20000
    s_cselect_b32 s24, 17, 18
    s_lshl_b32 s50, s100, s24
    s_and_b32 s50, s50, 0x60000
    s_lshl_b32 s24, s60, 10
    s_add_u32 s50, s50, s24
    s_lshl_b32 s24, s22, 19
    s_add_u32 s50, s50, s24
    s_add_u32 s50, s50, 0x4000000
    s_add_u32 s61, s61, s50
    s_and_b32 s24, s82, 2
    s_lshl_b32 s24, s24, 13
    s_add_u32 s51, s51, s24
    s_lshl_b32 s24, s22, 5
    s_add_u32 s60, s60, s24
    s_lshl_b32 s64, s60, 10
    buffer_load_dwordx4 v[96:99], v240, s[12:15], s64 offen
    s_lshl_b32 s52, s22, 6
    s_add_u32 s52, s52, 0x4000
    s_lshl_b32 s24, s22, 7
    s_and_b32 s25, s82, 2
    s_lshl_b32 s25, s25, 7
    s_add_u32 s24, s24, s25
    s_add_u32 s24, s24, 0x6a00
    s_cmp_lg_u32 s81, 0
    s_cselect_b32 s52, s24, s52
    s_cmp_ge_u32 s22, 61
    s_cselect_b32 s83, s87, 0
    s_and_b32 s83, s83, 1
    s_cbranch_scc0 L_notouch_130
    buffer_load_dword v245, off, s[8:11], s52 sc1
    s_cmp_lg_u32 s82, 0
    s_cselect_b32 s25, 2, 3
    v_lshlrev_b32 v246, s25, v240
    s_lshl_b32 s24, s27, s25
    s_add_u32 s24, s24, s51
    buffer_load_dword v245, v246, s[8:11], s24 offen sc1
    s_cmp_eq_u32 s82, 0
    s_cbranch_scc1 L_notouch_130
    s_mov_b32 s83, 3
    v_mov_b32 v140, -1
    v_mov_b32 v141, -1
    v_mov_b32 v142, -1
    v_mov_b32 v143, -1
    s_waitcnt vmcnt(0)
    s_barrier
    buffer_store_dwordx4 v[140:143], v242, s[8:11], s51 offen
    buffer_store_dwordx4 v[140:143], v242, s[8:11], s51 offen offset:64
    buffer_store_dwordx4 v[140:143], v242, s[8:11], s51 offen offset:128
    buffer_store_dwordx4 v[140:143], v242, s[8:11], s51 offen offset:192
L_notouch_130:
    buffer_load_dwordx4 v[0:3], v240, s[8:11], s46 offen
    buffer_load_dwordx4 v[4:7], v240, s[8:11], s46 offen offset:1024
    buffer_load_dwordx4 v[8:11], v240, s[8:11], s46 offen offset:2048
    buffer_load_dwordx4 v[12:15], v240, s[8:11], s46 offen offset:3072
    buffer_load_dwordx4 v[16:19], v240, s[8:11], s47 offen
    buffer_load_dwordx4 v[20:23], v240, s[8:11], s47 offen offset:1024
    buffer_load_dwordx4 v[24:27], v240, s[8:11], s47 offen offset:2048
    buffer_load_dwordx4 v[28:31], v240, s[8:11], s47 offen offset:3072
    buffer_load_dwordx4 v[32:35], v240, s[8:11], s54 offen
    buffer_load_dwordx4 v[36:39], v240, s[8:11], s54 offen offset:1024
    buffer_load_dwordx4 v[40:43], v240, s[8:11], s54 offen offset:2048
    buffer_load_dwordx4 v[44:47], v240, s[8:11], s54 offen offset:3072
    buffer_load_dwordx4 v[64:67], v240, s[8:11], s48 offen
    buffer_load_dwordx4 v[68:71], v240, s[8:11], s48 offen offset:1024
    buffer_load_dwordx4 v[72:75], v240, s[8:11], s48 offen offset:2048
    buffer_load_dwordx4 v[76:79], v240, s[8:11], s48 offen offset:3072
    buffer_load_dwordx4 v[80:83], v240, s[8:11], s55 offen
    buffer_load_dwordx4 v[84:87], v240, s[8:11], s55 offen offset:1024
    buffer_load_dwordx4 v[88:91], v240, s[8:11], s55 offen offset:2048
    buffer_load_dwordx4 v[92:95], v240, s[8:11], s55 offen offset:3072
    s_waitcnt vmcnt(8)
    v_mfma_f32_16x16x32_bf16 v[116:119], v[16:19], v[0:3], 0
    v_mfma_f32_16x16x32_bf16 v[116:119], v[20:23], v[4:7], v[116:119]
    v_mfma_f32_16x16x32_bf16 v[116:119], v[24:27], v[8:11], v[116:119]
    v_mfma_f32_16x16x32_bf16 v[116:119], v[28:31], v[12:15], v[116:119]
    v_mfma_f32_16x16x32_bf16 v[120:123], v[32:35], v[0:3], 0
    v_mfma_f32_16x16x32_bf16 v[120:123], v[36:39], v[4:7], v[120:123]
    v_mfma_f32_16x16x32_bf16 v[120:123], v[40:43], v[8:11], v[120:123]
    v_mfma_f32_16x16x32_bf16 v[120:123], v[44:47], v[12:15], v[120:123]
    v_mov_b32 v247, s53
    v_cndmask_b32 v116, v247, v116, s[30:31]
    v_cndmask_b32 v117, v247, v117, s[32:33]
    v_cndmask_b32 v118, v247, v118, s[34:35]
    v_cndmask_b32 v119, v247, v119, s[36:37]
    s_nop 2
    v_cndmask_b32 v120, v247, v120, s[38:39]
    v_cndmask_b32 v121, v247, v121, s[40:41]
    v_cndmask_b32 v122, v247, v122, s[42:43]
    v_cndmask_b32 v123, v247, v123, s[44:45]
    v_max3_f32 v246, v116, v117, v118
    v_max3_f32 v246, v246, v119, v120
    v_max3_f32 v246, v246, v121, v122
    v_max_f32 v246, v246, v123
    v_mov_b32 v247, v246
    s_nop 1
    v_permlane32_swap_b32 v247, v246
    v_max_f32 v246, v247, v246
    v_mov_b32 v247, v246
    s_nop 1
    v_permlane16_swap_b32 v247, v246
    v_max_f32 v246, v247, v246
    v_mul_f32 v248, s28, v246
    v_pk_fma_f32 v[116:117], v[116:117], s[28:29], v[248:249] op_sel_hi:[1,1,0] neg_lo:[0,0,1] neg_hi:[0,0,1]
    v_pk_fma_f32 v[118:119], v[118:119], s[28:29], v[248:249] op_sel_hi:[1,1,0] neg_lo:[0,0,1] neg_hi:[0,0,1]
    v_pk_fma_f32 v[120:121], v[120:121], s[28:29], v[248:249] op_sel_hi:[1,1,0] neg_lo:[0,0,1] neg_hi:[0,0,1]
    v_pk_fma_f32 v[122:123], v[122:123], s[28:29], v[248:249] op_sel_hi:[1,1,0] neg_lo:[0,0,1] neg_hi:[0,0,1]
    v_exp_f32 v116, v116
    v_exp_f32 v117, v117
    v_exp_f32 v118, v118
    v_exp_f32 v119, v119
    v_exp_f32 v120, v120
    v_exp_f32 v121, v121
    v_exp_f32 v122, v122
    v_exp_f32 v123, v123
    v_cvt_pk_bf16_f32 v124, v116, v117
    v_cvt_pk_bf16_f32 v125, v118, v119
    v_cvt_pk_bf16_f32 v126, v120, v121
    v_cvt_pk_bf16_f32 v127, v122, v123
    v_mov_b32 v129, 0
    s_nop 0
    v_mfma_f32_16x16x32_bf16 v[132:135], v[136:139], v[124:127], 0
    s_waitcnt vmcnt(7)
    v_mfma_f32_16x16x32_bf16 v[140:143], v[64:67], v[124:127], 0
    s_waitcnt vmcnt(6)
    v_mfma_f32_16x16x32_bf16 v[144:147], v[68:71], v[124:127], 0
    s_waitcnt vmcnt(5)
    v_mfma_f32_16x16x32_bf16 v[148:151], v[72:75], v[124:127], 0
    s_waitcnt vmcnt(4)
    v_mfma_f32_16x16x32_bf16 v[152:155], v[76:79], v[124:127], 0
    s_waitcnt vmcnt(3)
    v_mfma_f32_16x16x32_bf16 v[156:159], v[80:83], v[124:127], 0
    s_waitcnt vmcnt(2)
    v_mfma_f32_16x16x32_bf16 v[160:163], v[84:87], v[124:127], 0
    s_waitcnt vmcnt(1)
    v_mfma_f32_16x16x32_bf16 v[164:167], v[88:91], v[124:127], 0
    s_waitcnt vmcnt(0)
    v_mfma_f32_16x16x32_bf16 v[168:171], v[92:95], v[124:127], 0
    v_lshrrev_b32 v246, 2, v240
    s_lshl_b32 s24, s20, 7
    s_add_u32 s24, s24, 0x1000
    s_add_u32 s25, s22, 1
    s_sub_u32 s26, s22, 1
    s_min_u32 s26, s26, 61
    s_cmp_lg_u32 s81, 0
    s_cselect_b32 s25, s26, s25
    s_cmp_lg_u32 s100, 0
    s_cbranch_scc1 L_polls_133
    s_mov_b32 exec_lo, 0x11
    s_mov_b32 exec_hi, 0
    s_mov_b32 s96, 0
L_poll_131:
    buffer_load_dword v247, v246, s[8:11], s24 offen sc1
    s_waitcnt vmcnt(0)
    v_cmp_gt_u32 vcc, s25, v247
    s_cbranch_vccz L_polld_132
    v_readfirstlane_b32 s97, v247
    s_nop 0
    s_sub_u32 s97, s25, s97
    s_cmp_lt_i32 s97, 3
    s_cbranch_scc1 L_near_134
    s_sleep 40
    s_cmp_lt_i32 s97, 5
    s_cbranch_scc1 L_near_134
    s_sleep 100
L_near_134:
    s_sleep 4
    s_add_u32 s96, s96, 1
    s_cmp_lt_u32 s96, 0x10000
    s_cbranch_scc1 L_poll_131
L_polld_132:
    s_mov_b64 exec, -1
L_polls_133:
    s_barrier
    s_cmp_eq_u32 s81, 0
    s_cbranch_scc1 L_kmf_136
    s_cmp_lg_u32 s83, 3
    s_cbranch_scc1 L_noinit_138
    s_lshl_b32 s26, s20, 2
    s_add_u32 s26, s26, s52
    s_cmp_lg_u32 s100, 0
    s_cbranch_scc1 L_flag_139
    v_mov_b32 v246, 1
    s_mov_b64 exec, 1
    buffer_store_dword v246, off, s[8:11], s26
    s_mov_b64 exec, -1
L_flag_139:
L_noinit_138:
    s_lshr_b32 s26, s21, 1
    s_lshl_b32 s26, s26, 4
    s_add_u32 s24, s24, s26
    s_mov_b32 s96, 0
    buffer_load_dword v245, off, s[8:11], s24 sc1
    buffer_load_dwordx4 v[220:223], v240, s[8:11], s49 offen sc1
    buffer_load_dwordx4 v[224:227], v240, s[8:11], s49 offen offset:1024 sc1
    buffer_load_dwordx4 v[228:231], v240, s[8:11], s49 offen offset:2048 sc1
    buffer_load_dwordx4 v[232:235], v240, s[8:11], s49 offen offset:3072 sc1
    s_sleep 14
L_kmp_135:
    buffer_load_dword v245, off, s[8:11], s24 sc1
    buffer_load_dwordx4 v[220:223], v240, s[8:11], s49 offen sc1
    buffer_load_dwordx4 v[224:227], v240, s[8:11], s49 offen offset:1024 sc1
    buffer_load_dwordx4 v[228:231], v240, s[8:11], s49 offen offset:2048 sc1
    buffer_load_dwordx4 v[232:235], v240, s[8:11], s49 offen offset:3072 sc1
    s_add_u32 s96, s96, 1
    s_waitcnt vmcnt(5)
    v_max3_u32 v246, v220, v221, v222
    v_max3_u32 v246, v246, v223, v224
    v_max3_u32 v246, v246, v225, v226
    v_max3_u32 v246, v246, v227, v228
    v_max3_u32 v246, v246, v229, v230
    v_max3_u32 v246, v246, v231, v232
    v_max3_u32 v246, v246, v233, v234
    v_max_u32 v246, v246, v235
    v_cmp_eq_u32 vcc, -1, v246
    v_readfirstlane_b32 s26, v245
    s_cbranch_vccz L_kmo_137
    s_cmp_gt_u32 s26, s22
    s_cbranch_scc1 L_kmf_136
    s_cmp_lt_u32 s96, 0x10000
    s_cbranch_scc1 L_kmp_135
L_kmf_136:
    buffer_load_dwordx4 v[220:223], v240, s[8:11], s49 offen sc1
    buffer_load_dwordx4 v[224:227], v240, s[8:11], s49 offen offset:1024 sc1
    buffer_load_dwordx4 v[228:231], v240, s[8:11], s49 offen offset:2048 sc1
    buffer_load_dwordx4 v[232:235], v240, s[8:11], s49 offen offset:3072 sc1
    s_waitcnt vmcnt(0)
L_kmo_137:
    ds_write_b32 v253, v221
    ds_write_b32 v253, v223 offset:64
    ds_write_b32 v253, v225 offset:1024
    ds_write_b32 v253, v227 offset:1088
    ds_write_b32 v253, v229 offset:2048
    ds_write_b32 v253, v231 offset:2112
    ds_write_b32 v253, v233 offset:3072
    ds_write_b32 v253, v235 offset:3136
    ds_read_b128 v[48:51], v254
    ds_read_b128 v[52:55], v254 offset:1024
    ds_read_b128 v[56:59], v254 offset:2048
    ds_read_b128 v[60:63], v254 offset:3072
    s_cmp_lg_u32 s83, 3
    s_cbranch_scc1 L_noside_140
    s_mov_b32 s62, 0x8f00
    buffer_load_dword v104, off, s[8:11], s62 sc1
    v_bfe_u32 v108, v240, 2, 6
    buffer_load_dword v108, v108, s[8:11], s52 offen sc1
L_noside_140:
    s_waitcnt lgkmcnt(3)
    v_mfma_f32_16x16x32_bf16 v[112:115], v[48:51], v[0:3], 0
    s_waitcnt lgkmcnt(2)
    v_mfma_f32_16x16x32_bf16 v[112:115], v[52:55], v[4:7], v[112:115]
    s_waitcnt lgkmcnt(1)
    v_mfma_f32_16x16x32_bf16 v[112:115], v[56:59], v[8:11], v[112:115]
    s_waitcnt lgkmcnt(0)
    v_mfma_f32_16x16x32_bf16 v[112:115], v[60:63], v[12:15], v[112:115]
    s_nop 7
    v_pk_fma_f32 v[114:115], v[112:113], s[28:29], v[248:249] op_sel_hi:[1,1,0] neg_lo:[0,0,1] neg_hi:[0,0,1]
    v_max_f32 v246, v114, v115
    v_cmp_lt_f32 vcc, 0x42200000, v246
    s_cbranch_vccnz L_redo_141
L_redone_142:
    v_exp_f32 v114, v114
    v_exp_f32 v115, v115
    s_nop 0
    v_cvt_pk_bf16_f32 v128, v114, v115
    s_nop 1
    v_mfma_f32_16x16x16_bf16 v[132:135], v[136:137], v[128:129], v[132:135]
    v_mfma_f32_16x16x16_bf16 v[140:143], v[220:221], v[128:129], v[140:143]
    v_mfma_f32_16x16x16_bf16 v[144:147], v[222:223], v[128:129], v[144:147]
    v_mfma_f32_16x16x16_bf16 v[148:151], v[224:225], v[128:129], v[148:151]
    v_rcp_f32 v250, v132
    v_mfma_f32_16x16x16_bf16 v[152:155], v[226:227], v[128:129], v[152:155]
    v_mul_f32 v140, v250, v140
    v_mul_f32 v141, v250, v141
    v_mfma_f32_16x16x16_bf16 v[156:159], v[228:229], v[128:129], v[156:159]
    v_mul_f32 v142, v250, v142
    v_mul_f32 v143, v250, v143
    v_mfma_f32_16x16x16_bf16 v[160:163], v[230:231], v[128:129], v[160:163]
    v_cvt_pk_bf16_f32 v140, v140, v141
    v_cvt_pk_bf16_f32 v141, v142, v143
    v_mfma_f32_16x16x16_bf16 v[164:167], v[232:233], v[128:129], v[164:167]
    v_mul_f32 v144, v250, v144
    v_mul_f32 v145, v250, v145
    v_mfma_f32_16x16x16_bf16 v[168:171], v[234:235], v[128:129], v[168:171]
    v_mul_f32 v146, v250, v146
    v_mul_f32 v147, v250, v147
    v_cvt_pk_bf16_f32 v142, v144, v145
    v_cvt_pk_bf16_f32 v143, v146, v147
    ds_write_b128 v243, v[140:143]
    v_pk_mul_f32 v[148:149], v[148:149], v[250:251] op_sel_hi:[1,0]
    v_pk_mul_f32 v[150:151], v[150:151], v[250:251] op_sel_hi:[1,0]
    v_cvt_pk_bf16_f32 v144, v148, v149
    v_cvt_pk_bf16_f32 v145, v150, v151
    v_pk_mul_f32 v[152:153], v[152:153], v[250:251] op_sel_hi:[1,0]
    v_pk_mul_f32 v[154:155], v[154:155], v[250:251] op_sel_hi:[1,0]
    v_cvt_pk_bf16_f32 v146, v152, v153
    v_cvt_pk_bf16_f32 v147, v154, v155
    ds_write_b128 v243, v[144:147] offset:1024
    v_pk_mul_f32 v[156:157], v[156:157], v[250:251] op_sel_hi:[1,0]
    v_pk_mul_f32 v[158:159], v[158:159], v[250:251] op_sel_hi:[1,0]
    v_cvt_pk_bf16_f32 v148, v156, v157
    v_cvt_pk_bf16_f32 v149, v158, v159
    v_pk_mul_f32 v[160:161], v[160:161], v[250:251] op_sel_hi:[1,0]
    v_pk_mul_f32 v[162:163], v[162:163], v[250:251] op_sel_hi:[1,0]
    v_cvt_pk_bf16_f32 v150, v160, v161
    v_cvt_pk_bf16_f32 v151, v162, v163
    ds_write_b128 v243, v[148:151] offset:2048
    v_pk_mul_f32 v[164:165], v[164:165], v[250:251] op_sel_hi:[1,0]
    v_pk_mul_f32 v[166:167], v[166:167], v[250:251] op_sel_hi:[1,0]
    v_cvt_pk_bf16_f32 v152, v164, v165
    v_cvt_pk_bf16_f32 v153, v166, v167
    v_pk_mul_f32 v[168:169], v[168:169], v[250:251] op_sel_hi:[1,0]
    v_pk_mul_f32 v[170:171], v[170:171], v[250:251] op_sel_hi:[1,0]
    v_cvt_pk_bf16_f32 v154, v168, v169
    v_cvt_pk_bf16_f32 v155, v170, v171
    ds_write_b128 v243, v[152:155] offset:3072
    s_waitcnt lgkmcnt(0)
    s_barrier
    s_lshr_b32 s25, s82, 1
    s_lshl_b32 s24, s25, 12
    v_add_u32 v246, s24, v244
    ds_read_b128 v[0:3], v246
    ds_read_b128 v[4:7], v246 offset:1024
    ds_read_b128 v[8:11], v246 offset:2048
    ds_read_b128 v[12:15], v246 offset:3072
    ds_read_b128 v[32:35], v246 offset:8192
    ds_read_b128 v[36:39], v246 offset:9216
    ds_read_b128 v[40:43], v246 offset:10240
    ds_read_b128 v[44:47], v246 offset:11264
    v_xor_b32 v243, 0x4000, v243
    s_waitcnt lgkmcnt(7)
    v_mfma_f32_16x16x32_bf16 v[172:175], a[0:3], v[0:3], 0
    v_mfma_f32_16x16x32_bf16 v[176:179], a[4:7], v[0:3], 0
    s_waitcnt lgkmcnt(6)
    v_mfma_f32_16x16x32_bf16 v[172:175], a[32:35], v[4:7], v[172:175]
    v_mfma_f32_16x16x32_bf16 v[176:179], a[36:39], v[4:7], v[176:179]
    s_waitcnt lgkmcnt(5)
    v_mfma_f32_16x16x32_bf16 v[172:175], a[64:67], v[8:11], v[172:175]
    v_mfma_f32_16x16x32_bf16 v[176:179], a[68:71], v[8:11], v[176:179]
    s_waitcnt lgkmcnt(4)
    v_mfma_f32_16x16x32_bf16 v[172:175], a[96:99], v[12:15], v[172:175]
    v_mfma_f32_16x16x32_bf16 v[176:179], a[100:103], v[12:15], v[176:179]
    s_waitcnt lgkmcnt(3)
    v_mfma_f32_16x16x32_bf16 v[172:175], a[128:131], v[32:35], v[172:175]
    v_mfma_f32_16x16x32_bf16 v[176:179], a[132:135], v[32:35], v[176:179]
    s_waitcnt lgkmcnt(2)
    v_mfma_f32_16x16x32_bf16 v[172:175], a[160:163], v[36:39], v[172:175]
    v_mfma_f32_16x16x32_bf16 v[176:179], a[164:167], v[36:39], v[176:179]
    s_waitcnt lgkmcnt(1)
    v_mfma_f32_16x16x32_bf16 v[172:175], a[192:195], v[40:43], v[172:175]
    v_mfma_f32_16x16x32_bf16 v[176:179], a[196:199], v[40:43], v[176:179]
    s_waitcnt lgkmcnt(0)
    v_mfma_f32_16x16x32_bf16 v[172:175], a[224:227], v[44:47], v[172:175]
    v_mfma_f32_16x16x32_bf16 v[176:179], a[228:231], v[44:47], v[176:179]
    v_mfma_f32_16x16x32_bf16 v[180:183], a[8:11], v[0:3], 0
    v_mfma_f32_16x16x32_bf16 v[184:187], a[12:15], v[0:3], 0
    ds_read_b128 v[16:19], v244 offset:4096
    v_mfma_f32_16x16x32_bf16 v[180:183], a[40:43], v[4:7], v[180:183]
    v_mfma_f32_16x16x32_bf16 v[184:187], a[44:47], v[4:7], v[184:187]
    ds_read_b128 v[20:23], v244 offset:5120
    v_cvt_pk_bf16_f32 v140, v172, v173
    v_cvt_pk_bf16_f32 v141, v174, v175
    v_cvt_pk_bf16_f32 v142, v176, v177
    v_cvt_pk_bf16_f32 v143, v178, v179
    v_min_u32 v140, 0xfffffffe, v140
    s_add_u32 s24, s51, 0
    s_cmp_lg_u32 s83, 0
    s_cbranch_scc1 L_near_145
    buffer_store_dwordx4 v[140:143], v242, s[8:11], s24 offen sc1
    s_branch L_far_146
L_near_145:
    buffer_store_dwordx4 v[140:143], v242, s[8:11], s24 offen
L_far_146:
    v_mfma_f32_16x16x32_bf16 v[180:183], a[72:75], v[8:11], v[180:183]
    v_mfma_f32_16x16x32_bf16 v[184:187], a[76:79], v[8:11], v[184:187]
    ds_read_b128 v[24:27], v244 offset:6144
    v_mfma_f32_16x16x32_bf16 v[180:183], a[104:107], v[12:15], v[180:183]
    v_mfma_f32_16x16x32_bf16 v[184:187], a[108:111], v[12:15], v[184:187]
    ds_read_b128 v[28:31], v244 offset:7168
    v_mfma_f32_16x16x32_bf16 v[180:183], a[136:139], v[32:35], v[180:183]
    v_mfma_f32_16x16x32_bf16 v[184:187], a[140:143], v[32:35], v[184:187]
    ds_read_b128 v[48:51], v244 offset:12288
    v_mfma_f32_16x16x32_bf16 v[180:183], a[168:171], v[36:39], v[180:183]
    v_mfma_f32_16x16x32_bf16 v[184:187], a[172:175], v[36:39], v[184:187]
    ds_read_b128 v[52:55], v244 offset:13312
    v_mfma_f32_16x16x32_bf16 v[180:183], a[200:203], v[40:43], v[180:183]
    v_mfma_f32_16x16x32_bf16 v[184:187], a[204:207], v[40:43], v[184:187]
    ds_read_b128 v[56:59], v244 offset:14336
    v_mfma_f32_16x16x32_bf16 v[180:183], a[232:235], v[44:47], v[180:183]
    v_mfma_f32_16x16x32_bf16 v[184:187], a[236:239], v[44:47], v[184:187]
    ds_read_b128 v[60:63], v244 offset:15360
    v_mfma_f32_16x16x32_bf16 v[188:191], a[16:19], v[0:3], 0
    v_mfma_f32_16x16x32_bf16 v[192:195], a[20:23], v[0:3], 0
    v_mfma_f32_16x16x32_bf16 v[188:191], a[48:51], v[4:7], v[188:191]
    v_mfma_f32_16x16x32_bf16 v[192:195], a[52:55], v[4:7], v[192:195]
    v_cvt_pk_bf16_f32 v144, v180, v181
    v_cvt_pk_bf16_f32 v145, v182, v183
    v_cvt_pk_bf16_f32 v146, v184, v185
    v_cvt_pk_bf16_f32 v147, v186, v187
    v_min_u32 v144, 0xfffffffe, v144
    s_cmp_lg_u32 s83, 0
    s_cbranch_scc1 L_near_147
    buffer_store_dwordx4 v[144:147], v242, s[8:11], s24 offen offset:64 sc1
    s_branch L_far_148
L_near_147:
    buffer_store_dwordx4 v[144:147], v242, s[8:11], s24 offen offset:64
L_far_148:
    v_mfma_f32_16x16x32_bf16 v[188:191], a[80:83], v[8:11], v[188:191]
    v_mfma_f32_16x16x32_bf16 v[192:195], a[84:87], v[8:11], v[192:195]
    v_mfma_f32_16x16x32_bf16 v[188:191], a[112:115], v[12:15], v[188:191]
    v_mfma_f32_16x16x32_bf16 v[192:195], a[116:119], v[12:15], v[192:195]
    v_mfma_f32_16x16x32_bf16 v[188:191], a[144:147], v[32:35], v[188:191]
    v_mfma_f32_16x16x32_bf16 v[192:195], a[148:151], v[32:35], v[192:195]
    v_mfma_f32_16x16x32_bf16 v[188:191], a[176:179], v[36:39], v[188:191]
    v_mfma_f32_16x16x32_bf16 v[192:195], a[180:183], v[36:39], v[192:195]
    v_mfma_f32_16x16x32_bf16 v[188:191], a[208:211], v[40:43], v[188:191]
    v_mfma_f32_16x16x32_bf16 v[192:195], a[212:215], v[40:43], v[192:195]
    v_mfma_f32_16x16x32_bf16 v[188:191], a[240:243], v[44:47], v[188:191]
    v_mfma_f32_16x16x32_bf16 v[192:195], a[244:247], v[44:47], v[192:195]
    v_mfma_f32_16x16x32_bf16 v[196:199], a[24:27], v[0:3], 0
    v_mfma_f32_16x16x32_bf16 v[200:203], a[28:31], v[0:3], 0
    v_mfma_f32_16x16x32_bf16 v[196:199], a[56:59], v[4:7], v[196:199]
    v_mfma_f32_16x16x32_bf16 v[200:203], a[60:63], v[4:7], v[200:203]
    v_cvt_pk_bf16_f32 v148, v188, v189
    v_cvt_pk_bf16_f32 v149, v190, v191
    v_cvt_pk_bf16_f32 v150, v192, v193
    v_cvt_pk_bf16_f32 v151, v194, v195
    v_min_u32 v148, 0xfffffffe, v148
    s_cmp_lg_u32 s83, 0
    s_cbranch_scc1 L_near_149
    buffer_store_dwordx4 v[148:151], v242, s[8:11], s24 offen offset:128 sc1
    s_branch L_far_150
L_near_149:
    buffer_store_dwordx4 v[148:151], v242, s[8:11], s24 offen offset:128
L_far_150:
    v_mfma_f32_16x16x32_bf16 v[196:199], a[88:91], v[8:11], v[196:199]
    v_mfma_f32_16x16x32_bf16 v[200:203], a[92:95], v[8:11], v[200:203]
    v_mfma_f32_16x16x32_bf16 v[196:199], a[120:123], v[12:15], v[196:199]
    v_mfma_f32_16x16x32_bf16 v[200:203], a[124:127], v[12:15], v[200:203]
    v_mfma_f32_16x16x32_bf16 v[196:199], a[152:155], v[32:35], v[196:199]
    v_mfma_f32_16x16x32_bf16 v[200:203], a[156:159], v[32:35], v[200:203]
    v_mfma_f32_16x16x32_bf16 v[196:199], a[184:187], v[36:39], v[196:199]
    v_mfma_f32_16x16x32_bf16 v[200:203], a[188:191], v[36:39], v[200:203]
    v_mfma_f32_16x16x32_bf16 v[196:199], a[216:219], v[40:43], v[196:199]
    v_mfma_f32_16x16x32_bf16 v[200:203], a[220:223], v[40:43], v[200:203]
    v_mfma_f32_16x16x32_bf16 v[196:199], a[248:251], v[44:47], v[196:199]
    v_mfma_f32_16x16x32_bf16 v[200:203], a[252:255], v[44:47], v[200:203]
    v_xor_b32 v244, 0x4000, v244
    s_cmp_lg_u32 s82, 0
    s_cbranch_scc1 L_half_143
    s_waitcnt lgkmcnt(0)
    v_mfma_f32_16x16x32_bf16 v[204:207], a[0:3], v[16:19], 0
    v_mfma_f32_16x16x32_bf16 v[208:211], a[4:7], v[16:19], 0
    v_mfma_f32_16x16x32_bf16 v[204:207], a[32:35], v[20:23], v[204:207]
    v_mfma_f32_16x16x32_bf16 v[208:211], a[36:39], v[20:23], v[208:211]
    v_cvt_pk_bf16_f32 v152, v196, v197
    v_cvt_pk_bf16_f32 v153, v198, v199
    v_cvt_pk_bf16_f32 v154, v200, v201
    v_cvt_pk_bf16_f32 v155, v202, v203
    v_min_u32 v152, 0xfffffffe, v152
    s_cmp_lg_u32 s83, 0
    s_cbranch_scc1 L_near_151
    buffer_store_dwordx4 v[152:155], v242, s[8:11], s24 offen offset:192 sc1
    s_branch L_far_152
L_near_151:
    buffer_store_dwordx4 v[152:155], v242, s[8:11], s24 offen offset:192
L_far_152:
    v_mfma_f32_16x16x32_bf16 v[204:207], a[64:67], v[24:27], v[204:207]
    v_mfma_f32_16x16x32_bf16 v[208:211], a[68:71], v[24:27], v[208:211]
    v_mfma_f32_16x16x32_bf16 v[204:207], a[96:99], v[28:31], v[204:207]
    v_mfma_f32_16x16x32_bf16 v[208:211], a[100:103], v[28:31], v[208:211]
    v_mfma_f32_16x16x32_bf16 v[204:207], a[128:131], v[48:51], v[204:207]
    v_mfma_f32_16x16x32_bf16 v[208:211], a[132:135], v[48:51], v[208:211]
    v_mfma_f32_16x16x32_bf16 v[204:207], a[160:163], v[52:55], v[204:207]
    v_mfma_f32_16x16x32_bf16 v[208:211], a[164:167], v[52:55], v[208:211]
    v_mfma_f32_16x16x32_bf16 v[204:207], a[192:195], v[56:59], v[204:207]
    v_mfma_f32_16x16x32_bf16 v[208:211], a[196:199], v[56:59], v[208:211]
    v_mfma_f32_16x16x32_bf16 v[204:207], a[224:227], v[60:63], v[204:207]
    v_mfma_f32_16x16x32_bf16 v[208:211], a[228:231], v[60:63], v[208:211]
    v_mfma_f32_16x16x32_bf16 v[212:215], a[8:11], v[16:19], 0
    v_mfma_f32_16x16x32_bf16 v[216:219], a[12:15], v[16:19], 0
    v_mfma_f32_16x16x32_bf16 v[212:215], a[40:43], v[20:23], v[212:215]
    v_mfma_f32_16x16x32_bf16 v[216:219], a[44:47], v[20:23], v[216:219]
    v_cvt_pk_bf16_f32 v140, v204, v205
    v_cvt_pk_bf16_f32 v141, v206, v207
    v_cvt_pk_bf16_f32 v142, v208, v209
    v_cvt_pk_bf16_f32 v143, v210, v211
    v_min_u32 v140, 0xfffffffe, v140
    s_add_u32 s24, s51, 16384
    s_cmp_lg_u32 s83, 0
    s_cbranch_scc1 L_near_153
    buffer_store_dwordx4 v[140:143], v242, s[8:11], s24 offen sc1
    s_branch L_far_154
L_near_153:
    buffer_store_dwordx4 v[140:143], v242, s[8:11], s24 offen
L_far_154:
    v_mfma_f32_16x16x32_bf16 v[212:215], a[72:75], v[24:27], v[212:215]
    v_mfma_f32_16x16x32_bf16 v[216:219], a[76:79], v[24:27], v[216:219]
    v_mfma_f32_16x16x32_bf16 v[212:215], a[104:107], v[28:31], v[212:215]
    v_mfma_f32_16x16x32_bf16 v[216:219], a[108:111], v[28:31], v[216:219]
    v_mfma_f32_16x16x32_bf16 v[212:215], a[136:139], v[48:51], v[212:215]
    v_mfma_f32_16x16x32_bf16 v[216:219], a[140:143], v[48:51], v[216:219]
    v_mfma_f32_16x16x32_bf16 v[212:215], a[168:171], v[52:55], v[212:215]
    v_mfma_f32_16x16x32_bf16 v[216:219], a[172:175], v[52:55], v[216:219]
    v_mfma_f32_16x16x32_bf16 v[212:215], a[200:203], v[56:59], v[212:215]
    v_mfma_f32_16x16x32_bf16 v[216:219], a[204:207], v[56:59], v[216:219]
    v_mfma_f32_16x16x32_bf16 v[212:215], a[232:235], v[60:63], v[212:215]
    v_mfma_f32_16x16x32_bf16 v[216:219], a[236:239], v[60:63], v[216:219]
    s_waitcnt vmcnt(5)
    v_mfma_f32_16x16x32_bf16 v[220:223], a[16:19], v[16:19], 0
    v_mfma_f32_16x16x32_bf16 v[224:227], a[20:23], v[16:19], 0
    v_mfma_f32_16x16x32_bf16 v[220:223], a[48:51], v[20:23], v[220:223]
    v_mfma_f32_16x16x32_bf16 v[224:227], a[52:55], v[20:23], v[224:227]
    v_cvt_pk_bf16_f32 v144, v212, v213
    v_cvt_pk_bf16_f32 v145, v214, v215
    v_cvt_pk_bf16_f32 v146, v216, v217
    v_cvt_pk_bf16_f32 v147, v218, v219
    v_min_u32 v144, 0xfffffffe, v144
    s_cmp_lg_u32 s83, 0
    s_cbranch_scc1 L_near_155
    buffer_store_dwordx4 v[144:147], v242, s[8:11], s24 offen offset:64 sc1
    s_branch L_far_156
L_near_155:
    buffer_store_dwordx4 v[144:147], v242, s[8:11], s24 offen offset:64
L_far_156:
    v_mfma_f32_16x16x32_bf16 v[220:223], a[80:83], v[24:27], v[220:223]
    v_mfma_f32_16x16x32_bf16 v[224:227], a[84:87], v[24:27], v[224:227]
    v_mfma_f32_16x16x32_bf16 v[220:223], a[112:115], v[28:31], v[220:223]
    v_mfma_f32_16x16x32_bf16 v[224:227], a[116:119], v[28:31], v[224:227]
    v_mfma_f32_16x16x32_bf16 v[220:223], a[144:147], v[48:51], v[220:223]
    v_mfma_f32_16x16x32_bf16 v[224:227], a[148:151], v[48:51], v[224:227]
    v_mfma_f32_16x16x32_bf16 v[220:223], a[176:179], v[52:55], v[220:223]
    v_mfma_f32_16x16x32_bf16 v[224:227], a[180:183], v[52:55], v[224:227]
    v_mfma_f32_16x16x32_bf16 v[220:223], a[208:211], v[56:59], v[220:223]
    v_mfma_f32_16x16x32_bf16 v[224:227], a[212:215], v[56:59], v[224:227]
    v_mfma_f32_16x16x32_bf16 v[220:223], a[240:243], v[60:63], v[220:223]
    v_mfma_f32_16x16x32_bf16 v[224:227], a[244:247], v[60:63], v[224:227]
    v_mfma_f32_16x16x32_bf16 v[228:231], a[24:27], v[16:19], 0
    v_mfma_f32_16x16x32_bf16 v[232:235], a[28:31], v[16:19], 0
    v_mfma_f32_16x16x32_bf16 v[228:231], a[56:59], v[20:23], v[228:231]
    v_mfma_f32_16x16x32_bf16 v[232:235], a[60:63], v[20:23], v[232:235]
    v_cvt_pk_bf16_f32 v148, v220, v221
    v_cvt_pk_bf16_f32 v149, v222, v223
    v_cvt_pk_bf16_f32 v150, v224, v225
    v_cvt_pk_bf16_f32 v151, v226, v227
    v_min_u32 v148, 0xfffffffe, v148
    s_cmp_lg_u32 s83, 0
    s_cbranch_scc1 L_near_157
    buffer_store_dwordx4 v[148:151], v242, s[8:11], s24 offen offset:128 sc1
    s_branch L_far_158
L_near_157:
    buffer_store_dwordx4 v[148:151], v242, s[8:11], s24 offen offset:128
L_far_158:
    v_mfma_f32_16x16x32_bf16 v[228:231], a[88:91], v[24:27], v[228:231]
    v_mfma_f32_16x16x32_bf16 v[232:235], a[92:95], v[24:27], v[232:235]
    v_mfma_f32_16x16x32_bf16 v[228:231], a[120:123], v[28:31], v[228:231]
    v_mfma_f32_16x16x32_bf16 v[232:235], a[124:127], v[28:31], v[232:235]
    v_mfma_f32_16x16x32_bf16 v[228:231], a[152:155], v[48:51], v[228:231]
    v_mfma_f32_16x16x32_bf16 v[232:235], a[156:159], v[48:51], v[232:235]
    v_mfma_f32_16x16x32_bf16 v[228:231], a[184:187], v[52:55], v[228:231]
    v_mfma_f32_16x16x32_bf16 v[232:235], a[188:191], v[52:55], v[232:235]
    v_mfma_f32_16x16x32_bf16 v[228:231], a[216:219], v[56:59], v[228:231]
    v_mfma_f32_16x16x32_bf16 v[232:235], a[220:223], v[56:59], v[232:235]
    v_mfma_f32_16x16x32_bf16 v[228:231], a[248:251], v[60:63], v[228:231]
    v_mfma_f32_16x16x32_bf16 v[232:235], a[252:255], v[60:63], v[232:235]
    s_nop 3
    v_cvt_pk_bf16_f32 v152, v228, v229
    v_cvt_pk_bf16_f32 v153, v230, v231
    s_nop 1
    v_cvt_pk_bf16_f32 v154, v232, v233
    v_cvt_pk_bf16_f32 v155, v234, v235
    v_min_u32 v152, 0xfffffffe, v152
    s_cmp_lg_u32 s83, 0
    s_cbranch_scc1 L_near_159
    buffer_store_dwordx4 v[152:155], v242, s[8:11], s24 offen offset:192 sc1
    s_branch L_far_160
L_near_159:
    buffer_store_dwordx4 v[152:155], v242, s[8:11], s24 offen offset:192
L_far_160:
    s_branch L_proj_144
L_half_143:
    s_nop 7
    v_cvt_pk_bf16_f32 v152, v196, v197
    v_cvt_pk_bf16_f32 v153, v198, v199
    v_cvt_pk_bf16_f32 v154, v200, v201
    v_cvt_pk_bf16_f32 v155, v202, v203
    v_min_u32 v152, 0xfffffffe, v152
    s_cmp_lg_u32 s83, 0
    s_cbranch_scc1 L_near_161
    buffer_store_dwordx4 v[152:155], v242, s[8:11], s24 offen offset:192 sc1
    s_branch L_far_162
L_near_161:
    buffer_store_dwordx4 v[152:155], v242, s[8:11], s24 offen offset:192
L_far_162:
    s_waitcnt lgkmcnt(0)
L_proj_144:
    s_cmp_lg_u32 s83, 3
    s_cbranch_scc1 L_flags_165
    s_waitcnt vmcnt(4)
    v_cmp_eq_u32 vcc, 0, v108
    s_cbranch_vccz L_parts_163
    v_lshrrev_b32 v246, 2, v240
    s_mov_b32 exec_lo, 0xffff
    s_mov_b32 exec_hi, 0
    s_mov_b32 s96, 0
L_poll_166:
    buffer_load_dword v247, v246, s[8:11], s52 offen sc1
    s_waitcnt vmcnt(0)
    v_cmp_gt_u32 vcc, 1, v247
    s_cbranch_vccz L_polld_167
    s_sleep 1
    s_add_u32 s96, s96, 1
    s_cmp_lt_u32 s96, 0x10000
    s_cbranch_scc1 L_poll_166
L_polld_167:
    s_mov_b64 exec, -1
    s_branch L_parts_163
L_flags_165:
    s_mov_b32 s62, 0x8f00
    buffer_load_dword v104, off, s[8:11], s62 sc1
    s_waitcnt vmcnt(0)
    s_barrier
    s_lshl_b32 s26, s20, 2
    s_add_u32 s26, s26, s52
    s_cmp_lg_u32 s100, 0
    s_cbranch_scc1 L_flag_169
    v_mov_b32 v246, 1
    s_mov_b64 exec, 1
    s_cmp_lg_u32 s83, 0
    s_cbranch_scc1 L_near_170
    buffer_store_dword v246, off, s[8:11], s26 sc1
    s_branch L_far_171
L_near_170:
    buffer_store_dword v246, off, s[8:11], s26
L_far_171:
    s_mov_b64 exec, -1
L_flag_169:
    v_lshrrev_b32 v246, 2, v240
    s_cmp_lg_u32 s100, 0
    s_cbranch_scc1 L_polls_174
    s_mov_b32 exec_lo, 0xffff
    s_mov_b32 exec_hi, 0
    s_mov_b32 s96, 0
L_poll_172:
    buffer_load_dword v247, v246, s[8:11], s52 offen sc1
    s_waitcnt vmcnt(0)
    v_cmp_gt_u32 vcc, 1, v247
    s_cbranch_vccz L_polld_173
    s_sleep 1
    s_add_u32 s96, s96, 1
    s_cmp_lt_u32 s96, 0x10000
    s_cbranch_scc1 L_poll_172
L_polld_173:
    s_mov_b64 exec, -1
L_polls_174:
    s_barrier
L_parts_163:
    s_cmp_lg_u32 s83, 0
    s_cbranch_scc1 L_near_181
    buffer_load_dwordx4 v[48:51], v240, s[8:11], s50 offen
    buffer_load_dwordx4 v[52:55], v105, s[8:11], s50 offen
    buffer_load_dwordx4 v[56:59], v106, s[8:11], s50 offen
    buffer_load_dwordx4 v[60:63], v107, s[8:11], s50 offen
    s_branch L_far_182
L_near_181:
    buffer_load_dwordx4 v[48:51], v240, s[8:11], s50 offen sc1
    buffer_load_dwordx4 v[52:55], v105, s[8:11], s50 offen sc1
    buffer_load_dwordx4 v[56:59], v106, s[8:11], s50 offen sc1
    buffer_load_dwordx4 v[60:63], v107, s[8:11], s50 offen sc1
L_far_182:
    v_mov_b32 v68, 0
    v_mov_b32 v69, 0
    v_mov_b32 v70, 0
    v_mov_b32 v71, 0
    v_mov_b32 v72, 0
    v_mov_b32 v73, 0
    v_mov_b32 v74, 0
    v_mov_b32 v75, 0
    s_mov_b32 s96, 0
L_gp_176:
    s_cmp_lg_u32 s83, 0
    s_cbranch_scc1 L_near_183
    buffer_load_dwordx4 v[32:35], v240, s[8:11], s61 offen
    buffer_load_dwordx4 v[36:39], v105, s[8:11], s61 offen
    buffer_load_dwordx4 v[40:43], v106, s[8:11], s61 offen
    buffer_load_dwordx4 v[44:47], v107, s[8:11], s61 offen
    s_branch L_far_184
L_near_183:
    buffer_load_dwordx4 v[32:35], v240, s[8:11], s61 offen sc1
    buffer_load_dwordx4 v[36:39], v105, s[8:11], s61 offen sc1
    buffer_load_dwordx4 v[40:43], v106, s[8:11], s61 offen sc1
    buffer_load_dwordx4 v[44:47], v107, s[8:11], s61 offen sc1
L_far_184:
    s_waitcnt vmcnt(4)
    v_max3_u32 v246, v48, v52, v56
    v_max_u32 v246, v246, v60
    v_cmp_eq_u32 vcc, -1, v246
    s_cbranch_vccz L_gb_177
    buffer_load_dwordx4 v[48:51], v240, s[8:11], s50 offen sc1
    buffer_load_dwordx4 v[52:55], v105, s[8:11], s50 offen sc1
    buffer_load_dwordx4 v[56:59], v106, s[8:11], s50 offen sc1
    buffer_load_dwordx4 v[60:63], v107, s[8:11], s50 offen sc1
    s_waitcnt vmcnt(4)
    v_max3_u32 v246, v32, v36, v40
    v_max_u32 v246, v246, v44
    v_cmp_eq_u32 vcc, -1, v246
    s_add_u32 s96, s96, 1
    s_cbranch_vccz L_ga_178
    s_cmp_lt_u32 s96, 0x10000
    s_cbranch_scc1 L_gp_176
L_gb_177:
    v_dot2_f32_bf16 v68, v48, s65, v68
    v_dot2_f32_bf16 v69, v48, s66, v69
    v_dot2_f32_bf16 v70, v49, s65, v70
    v_dot2_f32_bf16 v71, v49, s66, v71
    v_dot2_f32_bf16 v72, v50, s65, v72
    v_dot2_f32_bf16 v73, v50, s66, v73
    v_dot2_f32_bf16 v74, v51, s65, v74
    v_dot2_f32_bf16 v75, v51, s66, v75
    v_dot2_f32_bf16 v68, v52, s65, v68
    v_dot2_f32_bf16 v69, v52, s66, v69
    v_dot2_f32_bf16 v70, v53, s65, v70
    v_dot2_f32_bf16 v71, v53, s66, v71
    v_dot2_f32_bf16 v72, v54, s65, v72
    v_dot2_f32_bf16 v73, v54, s66, v73
    v_dot2_f32_bf16 v74, v55, s65, v74
    v_dot2_f32_bf16 v75, v55, s66, v75
    v_dot2_f32_bf16 v68, v56, s65, v68
    v_dot2_f32_bf16 v69, v56, s66, v69
    v_dot2_f32_bf16 v70, v57, s65, v70
    v_dot2_f32_bf16 v71, v57, s66, v71
    v_dot2_f32_bf16 v72, v58, s65, v72
    v_dot2_f32_bf16 v73, v58, s66, v73
    v_dot2_f32_bf16 v74, v59, s65, v74
    v_dot2_f32_bf16 v75, v59, s66, v75
    v_dot2_f32_bf16 v68, v60, s65, v68
    v_dot2_f32_bf16 v69, v60, s66, v69
    v_dot2_f32_bf16 v70, v61, s65, v70
    v_dot2_f32_bf16 v71, v61, s66, v71
    v_dot2_f32_bf16 v72, v62, s65, v72
    v_dot2_f32_bf16 v73, v62, s66, v73
    v_dot2_f32_bf16 v74, v63, s65, v74
    v_dot2_f32_bf16 v75, v63, s66, v75
    s_cmp_lg_u32 s82, 0
    s_cbranch_scc1 L_gd_179
    s_waitcnt vmcnt(0)
L_ga_178:
    v_dot2_f32_bf16 v68, v32, s65, v68
    v_dot2_f32_bf16 v69, v32, s66, v69
    v_dot2_f32_bf16 v70, v33, s65, v70
    v_dot2_f32_bf16 v71, v33, s66, v71
    v_dot2_f32_bf16 v72, v34, s65, v72
    v_dot2_f32_bf16 v73, v34, s66, v73
    v_dot2_f32_bf16 v74, v35, s65, v74
    v_dot2_f32_bf16 v75, v35, s66, v75
    v_dot2_f32_bf16 v68, v36, s65, v68
    v_dot2_f32_bf16 v69, v36, s66, v69
    v_dot2_f32_bf16 v70, v37, s65, v70
    v_dot2_f32_bf16 v71, v37, s66, v71
    v_dot2_f32_bf16 v72, v38, s65, v72
    v_dot2_f32_bf16 v73, v38, s66, v73
    v_dot2_f32_bf16 v74, v39, s65, v74
    v_dot2_f32_bf16 v75, v39, s66, v75
    v_dot2_f32_bf16 v68, v40, s65, v68
    v_dot2_f32_bf16 v69, v40, s66, v69
    v_dot2_f32_bf16 v70, v41, s65, v70
    v_dot2_f32_bf16 v71, v41, s66, v71
    v_dot2_f32_bf16 v72, v42, s65, v72
    v_dot2_f32_bf16 v73, v42, s66, v73
    v_dot2_f32_bf16 v74, v43, s65, v74
    v_dot2_f32_bf16 v75, v43, s66, v75
    v_dot2_f32_bf16 v68, v44, s65, v68
    v_dot2_f32_bf16 v69, v44, s66, v69
    v_dot2_f32_bf16 v70, v45, s65, v70
    v_dot2_f32_bf16 v71, v45, s66, v71
    v_dot2_f32_bf16 v72, v46, s65, v72
    v_dot2_f32_bf16 v73, v46, s66, v73
    v_dot2_f32_bf16 v74, v47, s65, v74
    v_dot2_f32_bf16 v75, v47, s66, v75
L_gd_179:
    s_nop 2
    ds_write_b128 v109, v[68:71]
    ds_write_b128 v109, v[72:75] offset:1024
    s_cmp_lg_u32 s82, 0
    s_cselect_b32 s24, 3, 1
    s_and_b32 s24, s24, s100
    s_waitcnt lgkmcnt(0)
    s_barrier
    s_cbranch_scc1 L_nofin_175
    ds_read_b128 v[112:115], v109 offset:4096
    ds_read_b128 v[116:119], v109 offset:5120
    s_cmp_eq_u32 s82, 0
    s_cbranch_scc1 L_g1_180
    ds_read_b128 v[120:123], v109 offset:8192
    ds_read_b128 v[124:127], v109 offset:9216
    ds_read_b128 v[128:131], v109 offset:12288
    ds_read_b128 v[132:135], v109 offset:13312
    s_waitcnt lgkmcnt(0)
    v_pk_add_f32 v[120:121], v[120:121], v[128:129]
    v_pk_add_f32 v[122:123], v[122:123], v[130:131]
    v_pk_add_f32 v[124:125], v[124:125], v[132:133]
    v_pk_add_f32 v[126:127], v[126:127], v[134:135]
    v_pk_add_f32 v[112:113], v[112:113], v[120:121]
    v_pk_add_f32 v[114:115], v[114:115], v[122:123]
    v_pk_add_f32 v[116:117], v[116:117], v[124:125]
    v_pk_add_f32 v[118:119], v[118:119], v[126:127]
L_g1_180:
    s_waitcnt lgkmcnt(0)
    v_pk_add_f32 v[68:69], v[68:69], v[112:113]
    v_pk_add_f32 v[70:71], v[70:71], v[114:115]
    v_pk_add_f32 v[72:73], v[72:73], v[116:117]
    v_pk_add_f32 v[74:75], v[74:75], v[118:119]
    v_cvt_pk_bf16_f32 v0, v68, v69
    v_cvt_pk_bf16_f32 v1, v70, v71
    v_cvt_pk_bf16_f32 v2, v72, v73
    v_cvt_pk_bf16_f32 v3, v74, v75
    v_lshlrev_b32 v68, 16, v0
    v_and_b32 v69, 0xffff0000, v0
    v_lshlrev_b32 v76, 16, v96
    v_and_b32 v77, 0xffff0000, v96
    v_lshlrev_b32 v70, 16, v1
    v_and_b32 v71, 0xffff0000, v1
    v_lshlrev_b32 v78, 16, v97
    v_and_b32 v79, 0xffff0000, v97
    v_lshlrev_b32 v72, 16, v2
    v_and_b32 v73, 0xffff0000, v2
    v_lshlrev_b32 v80, 16, v98
    v_and_b32 v81, 0xffff0000, v98
    v_lshlrev_b32 v74, 16, v3
    v_and_b32 v75, 0xffff0000, v3
    v_lshlrev_b32 v82, 16, v99
    v_and_b32 v83, 0xffff0000, v99
    v_pk_add_f32 v[68:69], v[68:69], v[76:77]
    v_pk_add_f32 v[70:71], v[70:71], v[78:79]
    v_pk_add_f32 v[72:73], v[72:73], v[80:81]
    v_pk_add_f32 v[74:75], v[74:75], v[82:83]
    v_cvt_pk_bf16_f32 v4, v68, v69
    v_cvt_pk_bf16_f32 v5, v70, v71
    v_cvt_pk_bf16_f32 v6, v72, v73
    v_cvt_pk_bf16_f32 v7, v74, v75
    v_lshlrev_b32 v68, 16, v4
    v_and_b32 v69, 0xffff0000, v4
    v_lshlrev_b32 v70, 16, v5
    v_and_b32 v71, 0xffff0000, v5
    v_lshlrev_b32 v72, 16, v6
    v_and_b32 v73, 0xffff0000, v6
    v_lshlrev_b32 v74, 16, v7
    v_and_b32 v75, 0xffff0000, v7
    v_add_f32 v84, v68, v69
    v_add_f32 v84, v84, v70
    v_add_f32 v84, v84, v71
    v_add_f32 v84, v84, v72
    v_add_f32 v84, v84, v73
    v_add_f32 v84, v84, v74
    v_add_f32 v84, v84, v75
    s_nop 1
    v_add_f32_dpp v84, v84, v84 row_ror:1 row_mask:0xf bank_mask:0xf
    s_nop 1
    v_add_f32_dpp v84, v84, v84 row_ror:2 row_mask:0xf bank_mask:0xf
    s_nop 1
    v_add_f32_dpp v84, v84, v84 row_ror:4 row_mask:0xf bank_mask:0xf
    s_nop 1
    v_add_f32_dpp v84, v84, v84 row_ror:8 row_mask:0xf bank_mask:0xf
    v_mov_b32 v85, v84
    s_nop 1
    v_permlane32_swap_b32 v85, v84
    v_add_f32 v84, v85, v84
    v_mov_b32 v85, v84
    s_nop 1
    v_permlane16_swap_b32 v85, v84
    v_add_f32 v84, v85, v84
    v_mul_f32 v84, 0x3b000000, v84
    v_cvt_pk_bf16_f32 v86, v84, v84
    v_and_b32 v86, 0xffff0000, v86
    v_sub_f32 v87, v84, v86
    v_sub_f32 v76, v68, v86
    v_sub_f32 v77, v69, v86
    v_sub_f32 v78, v70, v86
    v_sub_f32 v79, v71, v86
    v_sub_f32 v80, v72, v86
    v_sub_f32 v81, v73, v86
    v_sub_f32 v82, v74, v86
    v_sub_f32 v83, v75, v86
    v_mul_f32 v100, v76, v76
    v_fmac_f32 v100, v77, v77
    v_fmac_f32 v100, v78, v78
    v_fmac_f32 v100, v79, v79
    v_fmac_f32 v100, v80, v80
    v_fmac_f32 v100, v81, v81
    v_fmac_f32 v100, v82, v82
    v_fmac_f32 v100, v83, v83
    s_nop 1
    v_add_f32_dpp v100, v100, v100 row_ror:1 row_mask:0xf bank_mask:0xf
    s_nop 1
    v_add_f32_dpp v100, v100, v100 row_ror:2 row_mask:0xf bank_mask:0xf
    s_nop 1
    v_add_f32_dpp v100, v100, v100 row_ror:4 row_mask:0xf bank_mask:0xf
    s_nop 1
    v_add_f32_dpp v100, v100, v100 row_ror:8 row_mask:0xf bank_mask:0xf
    v_mov_b32 v85, v100
    s_nop 1
    v_permlane32_swap_b32 v85, v100
    v_add_f32 v100, v85, v100
    v_mov_b32 v85, v100
    s_nop 1
    v_permlane16_swap_b32 v85, v100
    v_add_f32 v100, v85, v100
    v_mul_f32 v85, v87, v87
    v_mul_f32 v100, 0x3b000000, v100
    v_sub_f32 v100, v100, v85
    v_max_f32 v100, 0, v100
    v_cvt_pk_bf16_f32 v100, v100, v100
    v_and_b32 v100, 0xffff0000, v100
    v_add_f32 v100, 0x3727c5ac, v100
    v_cvt_pk_bf16_f32 v100, v100, v100
    v_and_b32 v100, 0xffff0000, v100
    v_sqrt_f32 v100, v100
    s_nop 0
    v_cvt_pk_bf16_f32 v100, v100, v100
    v_and_b32 v100, 0xffff0000, v100
    v_rcp_f32 v100, v100
    v_cvt_pk_bf16_f32 v8, v76, v77
    v_cvt_pk_bf16_f32 v9, v78, v79
    v_cvt_pk_bf16_f32 v10, v80, v81
    v_cvt_pk_bf16_f32 v11, v82, v83
    v_lshlrev_b32 v76, 16, v8
    v_and_b32 v77, 0xffff0000, v8
    v_lshlrev_b32 v78, 16, v9
    v_and_b32 v79, 0xffff0000, v9
    v_lshlrev_b32 v80, 16, v10
    v_and_b32 v81, 0xffff0000, v10
    v_lshlrev_b32 v82, 16, v11
    v_and_b32 v83, 0xffff0000, v11
    v_mul_f32 v76, v100, v76
    v_mul_f32 v77, v100, v77
    v_mul_f32 v78, v100, v78
    v_mul_f32 v79, v100, v79
    v_mul_f32 v80, v100, v80
    v_mul_f32 v81, v100, v81
    v_mul_f32 v82, v100, v82
    v_mul_f32 v83, v100, v83
    v_cvt_pk_bf16_f32 v8, v76, v77
    v_cvt_pk_bf16_f32 v9, v78, v79
    v_cvt_pk_bf16_f32 v10, v80, v81
    v_cvt_pk_bf16_f32 v11, v82, v83
    v_lshlrev_b32 v76, 16, v8
    v_and_b32 v77, 0xffff0000, v8
    v_lshlrev_b32 v78, 16, v9
    v_and_b32 v79, 0xffff0000, v9
    v_lshlrev_b32 v80, 16, v10
    v_and_b32 v81, 0xffff0000, v10
    v_lshlrev_b32 v82, 16, v11
    v_and_b32 v83, 0xffff0000, v11
    v_lshlrev_b32 v88, 16, v236
    v_and_b32 v89, 0xffff0000, v236
    v_lshlrev_b32 v90, 16, v237
    v_and_b32 v91, 0xffff0000, v237
    v_lshlrev_b32 v92, 16, v238
    v_and_b32 v93, 0xffff0000, v238
    v_lshlrev_b32 v94, 16, v239
    v_and_b32 v95, 0xffff0000, v239
    v_mul_f32 v84, v76, v88
    v_fmac_f32 v84, v77, v89
    v_fmac_f32 v84, v78, v90
    v_fmac_f32 v84, v79, v91
    v_fmac_f32 v84, v80, v92
    v_fmac_f32 v84, v81, v93
    v_fmac_f32 v84, v82, v94
    v_fmac_f32 v84, v83, v95
    s_nop 1
    v_add_f32_dpp v84, v84, v84 row_ror:1 row_mask:0xf bank_mask:0xf
    s_nop 1
    v_add_f32_dpp v84, v84, v84 row_ror:2 row_mask:0xf bank_mask:0xf
    s_nop 1
    v_add_f32_dpp v84, v84, v84 row_ror:4 row_mask:0xf bank_mask:0xf
    s_nop 1
    v_add_f32_dpp v84, v84, v84 row_ror:8 row_mask:0xf bank_mask:0xf
    v_mov_b32 v85, v84
    s_nop 1
    v_permlane32_swap_b32 v85, v84
    v_add_f32 v84, v85, v84
    v_mov_b32 v85, v84
    s_nop 1
    v_permlane16_swap_b32 v85, v84
    v_add_f32 v84, v85, v84
    v_cvt_pk_bf16_f32 v84, v84, v84
    v_and_b32 v84, 0xffff0000, v84
    v_ashrrev_i32 v85, 31, v84
    v_or_b32 v85, 0x80000000, v85
    v_xor_b32 v84, v84, v85
    v_and_b32 v84, 0xffff0000, v84
    s_sub_u32 s62, 0x87ff, s60
    v_or_b32 v84, s62, v84
    s_lshl_b32 s62, s60, 2
    s_mov_b64 exec, 1
    s_add_u32 s63, s62, 0x6f00
    s_lshl_b32 s96, s60, 7
    s_add_u32 s96, s96, 0xfffcb000
    s_cmp_ge_u32 s60, 1984
    s_cselect_b32 s63, s96, s63
    s_cmp_ge_u32 s60, 1792
    s_cselect_b32 s63, s63, 0x7ff00000
    buffer_store_dword v84, off, s[8:11], s63 sc1
    s_mov_b64 exec, -1
    v_pk_add_f32 v[68:69], v[68:69], v[76:77]
    v_pk_add_f32 v[70:71], v[70:71], v[78:79]
    v_pk_add_f32 v[72:73], v[72:73], v[80:81]
    v_pk_add_f32 v[74:75], v[74:75], v[82:83]
    v_cvt_pk_bf16_f32 v12, v68, v69
    v_cvt_pk_bf16_f32 v13, v70, v71
    v_cvt_pk_bf16_f32 v14, v72, v73
    v_cvt_pk_bf16_f32 v15, v74, v75
    buffer_store_dwordx4 v[12:15], v240, s[16:19], s64 offen sc1
    s_mov_b64 exec, 1
    v_cmp_ge_u32 vcc, v104, v84
    s_cselect_b32 s63, 1, 0
    s_and_b32 s63, s63, vcc_lo
    s_cbranch_scc1 L_nokey_185
    s_mov_b64 exec, -1
    s_add_u32 s63, s64, 0x6000000
    buffer_store_dwordx4 v[4:7], v240, s[8:11], s63 offen sc1
    s_add_u32 s63, s64, 0x6200000
    buffer_store_dwordx4 v[8:11], v240, s[8:11], s63 offen sc1
    s_mov_b64 exec, 1
    s_add_u32 s62, s62, 0x6000
    s_waitcnt vmcnt(0)
    buffer_store_dword v84, off, s[8:11], s62 sc1
L_nokey_185:
    s_mov_b64 exec, -1
L_nofin_175:
    s_add_u32 s80, s80, 4
    s_add_u32 s22, s22, s23
    s_sub_u32 s24, s22, 68
    s_cmp_lt_u32 s24, 2
    s_cselect_b32 s82, 2, 0
    s_cselect_b32 s24, 6, 0
    s_sub_u32 s22, s22, s24
    s_branch L_p2_seg
L_redo_141:
    v_mfma_f32_16x16x32_bf16 v[116:119], v[16:19], v[0:3], 0
    v_mfma_f32_16x16x32_bf16 v[116:119], v[20:23], v[4:7], v[116:119]
    v_mfma_f32_16x16x32_bf16 v[116:119], v[24:27], v[8:11], v[116:119]
    v_mfma_f32_16x16x32_bf16 v[116:119], v[28:31], v[12:15], v[116:119]
    v_mfma_f32_16x16x32_bf16 v[120:123], v[32:35], v[0:3], 0
    v_mfma_f32_16x16x32_bf16 v[120:123], v[36:39], v[4:7], v[120:123]
    v_mfma_f32_16x16x32_bf16 v[120:123], v[40:43], v[8:11], v[120:123]
    v_mfma_f32_16x16x32_bf16 v[120:123], v[44:47], v[12:15], v[120:123]
    v_mov_b32 v247, s53
    v_cndmask_b32 v116, v247, v116, s[30:31]
    v_cndmask_b32 v117, v247, v117, s[32:33]
    v_cndmask_b32 v118, v247, v118, s[34:35]
    v_cndmask_b32 v119, v247, v119, s[36:37]
    s_nop 2
    v_cndmask_b32 v120, v247, v120, s[38:39]
    v_cndmask_b32 v121, v247, v121, s[40:41]
    v_cndmask_b32 v122, v247, v122, s[42:43]
    v_cndmask_b32 v123, v247, v123, s[44:45]
    v_max3_f32 v246, v116, v117, v118
    v_max3_f32 v246, v246, v119, v120
    v_max3_f32 v246, v246, v121, v122
    v_max_f32 v246, v246, v123
    v_max3_f32 v246, v246, v112, v113
    v_mov_b32 v247, v246
    s_nop 1
    v_permlane32_swap_b32 v247, v246
    v_max_f32 v246, v247, v246
    v_mov_b32 v247, v246
    s_nop 1
    v_permlane16_swap_b32 v247, v246
    v_max_f32 v246, v247, v246
    v_mul_f32 v248, s28, v246
    v_pk_fma_f32 v[116:117], v[116:117], s[28:29], v[248:249] op_sel_hi:[1,1,0] neg_lo:[0,0,1] neg_hi:[0,0,1]
    v_pk_fma_f32 v[118:119], v[118:119], s[28:29], v[248:249] op_sel_hi:[1,1,0] neg_lo:[0,0,1] neg_hi:[0,0,1]
    v_pk_fma_f32 v[120:121], v[120:121], s[28:29], v[248:249] op_sel_hi:[1,1,0] neg_lo:[0,0,1] neg_hi:[0,0,1]
    v_pk_fma_f32 v[122:123], v[122:123], s[28:29], v[248:249] op_sel_hi:[1,1,0] neg_lo:[0,0,1] neg_hi:[0,0,1]
    v_exp_f32 v116, v116
    v_exp_f32 v117, v117
    v_exp_f32 v118, v118
    v_exp_f32 v119, v119
    v_exp_f32 v120, v120
    v_exp_f32 v121, v121
    v_exp_f32 v122, v122
    v_exp_f32 v123, v123
    v_cvt_pk_bf16_f32 v124, v116, v117
    v_cvt_pk_bf16_f32 v125, v118, v119
    v_cvt_pk_bf16_f32 v126, v120, v121
    v_cvt_pk_bf16_f32 v127, v122, v123
    v_mov_b32 v129, 0
    s_nop 0
    v_mfma_f32_16x16x32_bf16 v[132:135], v[136:139], v[124:127], 0
    v_mfma_f32_16x16x32_bf16 v[140:143], v[64:67], v[124:127], 0
    v_mfma_f32_16x16x32_bf16 v[144:147], v[68:71], v[124:127], 0
    v_mfma_f32_16x16x32_bf16 v[148:151], v[72:75], v[124:127], 0
    v_mfma_f32_16x16x32_bf16 v[152:155], v[76:79], v[124:127], 0
    v_mfma_f32_16x16x32_bf16 v[156:159], v[80:83], v[124:127], 0
    v_mfma_f32_16x16x32_bf16 v[160:163], v[84:87], v[124:127], 0
    v_mfma_f32_16x16x32_bf16 v[164:167], v[88:91], v[124:127], 0
    v_mfma_f32_16x16x32_bf16 v[168:171], v[92:95], v[124:127], 0
    v_pk_fma_f32 v[114:115], v[112:113], s[28:29], v[248:249] op_sel_hi:[1,1,0] neg_lo:[0,0,1] neg_hi:[0,0,1]
    s_nop 6
    s_branch L_redone_142
L_p2_end:
    s_cmp_ge_u32 s67, 56
    s_cbranch_scc1 L_exit
    s_mov_b32 s74, 0
    s_mov_b32 s75, 0
    v_mov_b32 v202, 0x7ffffff0
    v_mbcnt_lo_u32_b32 v0, -1, 0
    v_mbcnt_hi_u32_b32 v0, -1, v0
    s_lshl_b32 s96, s100, 6
    v_add_u32 v0, s96, v0
    v_lshlrev_b32 v1, 6, v0
    s_getpc_b64 s[70:71]
L_pc_186:
    s_add_u32 s70, s70, L_ffn_round-L_pc_186
    s_addc_u32 s71, s71, 0
    v_min_u32 v1, L_code_end-L_ffn_round-4, v1
    global_load_dword v3, v1, s[70:71]
    v_mov_b32 v1, 0
    s_and_b32 s71, s101, 15
    s_lshl_b32 s71, s71, 7
    s_add_u32 s71, s71, 0x1000
    s_mov_b32 s72, 57
    s_cmp_lg_u32 s100, 0
    s_cbranch_scc1 L_polls_189
    s_mov_b32 exec_lo, 0x1
    s_mov_b32 exec_hi, 0
    s_mov_b32 s96, 0
L_poll_187:
    buffer_load_dword v2, v1, s[8:11], s71 offen sc1
    s_waitcnt vmcnt(0)
    v_cmp_gt_u32 vcc, s72, v2
    s_cbranch_vccz L_polld_188
    v_readfirstlane_b32 s97, v2
    s_nop 0
    s_sub_u32 s97, s72, s97
    s_cmp_lt_i32 s97, 3
    s_cbranch_scc1 L_near_190
    s_sleep 40
    s_cmp_lt_i32 s97, 5
    s_cbranch_scc1 L_near_190
    s_sleep 100
L_near_190:
    s_sleep 16
    s_add_u32 s96, s96, 1
    s_cmp_lt_u32 s96, 0x10000
    s_cbranch_scc1 L_poll_187
L_polld_188:
    s_mov_b64 exec, -1
L_polls_189:
    s_barrier
L_ffn_round:
    v_mbcnt_lo_u32_b32 v0, -1, 0
    v_mbcnt_hi_u32_b32 v0, -1, v0
    s_lshl_b32 s96, s100, 6
    v_add_u32 v0, s96, v0
    s_cmp_lg_u32 s75, 0
    s_cbranch_scc1 L_ffn_re
    v_lshlrev_b32 v30, 5, v0
    s_mov_b32 s69, 0x6000
    v_cmp_le_u32 vcc, 224, v0
    v_mov_b32 v29, s75
    v_add_u32 v29, -1, v29
    v_cndmask_b32 v19, 0, v29, vcc
    s_mov_b32 s70, 0
L_kpoll_191:
    buffer_load_dwordx4 v[20:23], v30, s[8:11], s69 offen sc1
    buffer_load_dwordx4 v[24:27], v30, s[8:11], s69 offen offset:16 sc1
    s_waitcnt vmcnt(0)
    v_min3_u32 v28, v20, v21, v22
    v_min3_u32 v28, v28, v23, v24
    v_min3_u32 v28, v28, v25, v26
    v_min_u32 v28, v28, v27
    v_or_b32 v28, v28, v19
    v_cmp_eq_u32 vcc, 0, v28
    s_cbranch_vccz L_kpolld_192
    s_sleep 6
    s_add_u32 s70, s70, 1
    s_cmp_lt_u32 s70, 0x10000
    s_cbranch_scc1 L_kpoll_191
L_kpolld_192:
    v_bfi_b32 v20, v19, 0, v20
    v_bfi_b32 v21, v19, 0, v21
    v_bfi_b32 v22, v19, 0, v22
    v_bfi_b32 v23, v19, 0, v23
    v_bfi_b32 v24, v19, 0, v24
    v_bfi_b32 v25, v19, 0, v25
    v_bfi_b32 v26, v19, 0, v26
    v_bfi_b32 v27, v19, 0, v27
    v_lshrrev_b32 v30, 6, v0
    v_lshlrev_b32 v30, 2, v30
    v_add_u32 v30, 0x20400, v30
    v_mov_b32 v31, 0x20400
    s_waitcnt vmcnt(0)
    v_max3_u32 v28, v20, v21, v22
    v_max3_u32 v28, v28, v23, v24
    v_max3_u32 v28, v28, v25, v26
    v_max_u32 v28, v28, v27
    s_nop 1
    v_max_u32_dpp v28, v28, v28 row_ror:1 row_mask:0xf bank_mask:0xf
    s_nop 1
    v_max_u32_dpp v28, v28, v28 row_ror:2 row_mask:0xf bank_mask:0xf
    s_nop 1
    v_max_u32_dpp v28, v28, v28 row_ror:4 row_mask:0xf bank_mask:0xf
    s_nop 1
    v_max_u32_dpp v28, v28, v28 row_ror:8 row_mask:0xf bank_mask:0xf
    v_mov_b32 v29, v28
    s_nop 1
    v_permlane32_swap_b32 v29, v28
    v_max_u32 v28, v29, v28
    v_mov_b32 v29, v28
    s_nop 1
    v_permlane16_swap_b32 v29, v28
    v_max_u32 v28, v29, v28
    ds_write_b32 v30, v28
    s_waitcnt lgkmcnt(0)
    s_barrier
    ds_read_b128 v[16:19], v31
    s_waitcnt lgkmcnt(0)
    v_max3_u32 v28, v16, v17, v18
    v_max_u32 v28, v28, v19
    s_nop 0
    v_readfirstlane_b32 s69, v28
    s_nop 1
    v_cmp_ne_u32 vcc, s69, v20
    s_nop 1
    v_cndmask_b32 v20, 0, v20, vcc
    v_cmp_ne_u32 vcc, s69, v21
    s_nop 1
    v_cndmask_b32 v21, 0, v21, vcc
    v_cmp_ne_u32 vcc, s69, v22
    s_nop 1
    v_cndmask_b32 v22, 0, v22, vcc
    v_cmp_ne_u32 vcc, s69, v23
    s_nop 1
    v_cndmask_b32 v23, 0, v23, vcc
    v_cmp_ne_u32 vcc, s69, v24
    s_nop 1
    v_cndmask_b32 v24, 0, v24, vcc
    v_cmp_ne_u32 vcc, s69, v25
    s_nop 1
    v_cndmask_b32 v25, 0, v25, vcc
    v_cmp_ne_u32 vcc, s69, v26
    s_nop 1
    v_cndmask_b32 v26, 0, v26, vcc
    v_cmp_ne_u32 vcc, s69, v27
    s_nop 1
    v_cndmask_b32 v27, 0, v27, vcc
    v_max3_u32 v28, v20, v21, v22
    v_max3_u32 v28, v28, v23, v24
    v_max3_u32 v28, v28, v25, v26
    v_max_u32 v28, v28, v27
    s_nop 1
    v_max_u32_dpp v28, v28, v28 row_ror:1 row_mask:0xf bank_mask:0xf
    s_nop 1
    v_max_u32_dpp v28, v28, v28 row_ror:2 row_mask:0xf bank_mask:0xf
    s_nop 1
    v_max_u32_dpp v28, v28, v28 row_ror:4 row_mask:0xf bank_mask:0xf
    s_nop 1
    v_max_u32_dpp v28, v28, v28 row_ror:8 row_mask:0xf bank_mask:0xf
    v_mov_b32 v29, v28
    s_nop 1
    v_permlane32_swap_b32 v29, v28
    v_max_u32 v28, v29, v28
    v_mov_b32 v29, v28
    s_nop 1
    v_permlane16_swap_b32 v29, v28
    v_max_u32 v28, v29, v28
    ds_write_b32 v30, v28 offset:16
    s_waitcnt lgkmcnt(0)
    s_barrier
    ds_read_b128 v[16:19], v31 offset:16
    s_waitcnt lgkmcnt(0)
    v_max3_u32 v28, v16, v17, v18
    v_max_u32 v28, v28, v19
    s_nop 0
    v_readfirstlane_b32 s70, v28
    s_barrier
    s_cmp_lg_u32 s67, 55
    s_cbranch_scc1 L_ffn_sel
    s_mov_b32 s71, 0x8f00
    s_cmp_lg_u32 s100, 0
    s_cbranch_scc1 L_flag_193
    v_mov_b32 v2, s70
    s_mov_b64 exec, 1
    buffer_store_dword v2, off, s[8:11], s71 sc1
    s_mov_b64 exec, -1
L_flag_193:
    s_branch L_ffn_sel
L_ffn_re:
    v_mul_u32_u24 v30, 12, v0
    v_lshlrev_b32 v31, 7, v0
    v_add_u32 v31, 0x500, v31
    v_mov_b32 v29, 0x20400
    s_cmp_lg_u32 s100, 0
    s_cbranch_scc1 L_rselw_197
    s_mov_b32 s71, 0x8b00
    s_mov_b32 s72, 0
L_rsel_194:
    buffer_load_dword v23, v31, s[8:11], s71 offen sc1
    buffer_load_dwordx3 v[20:22], v30, s[8:11], s71 offen sc1
    s_waitcnt vmcnt(0)
    v_min3_u32 v28, v20, v21, v22
    v_min_u32 v28, v28, v23
    v_cmp_eq_u32 vcc, 0, v28
    s_cbranch_vccz L_rseld_195
    s_sleep 1
    s_add_u32 s72, s72, 1
    s_cmp_lt_u32 s72, 0x10000
    s_cbranch_scc1 L_rsel_194
L_rseld_195:
    v_max3_u32 v28, v20, v21, v22
    v_max_u32 v28, v28, v23
    v_cmp_lt_u32 vcc, s70, v28
    s_cbranch_vccz L_rsele_196
    s_mov_b32 s71, 0x7c00
    v_lshlrev_b32 v31, 2, v0
    v_add_u32 v31, 768, v31
L_rack_198:
    buffer_load_dword v27, v31, s[8:11], s71 offen sc1
    buffer_load_dwordx3 v[24:26], v30, s[8:11], s71 offen sc1
    s_add_u32 s72, s72, 1
    s_waitcnt vmcnt(0)
    v_sub_u32 v24, v20, v24
    v_sub_u32 v25, v21, v25
    v_sub_u32 v26, v22, v26
    v_sub_u32 v27, v23, v27
    v_max3_u32 v28, v24, v25, v26
    v_max_u32 v28, v28, v27
    v_cmp_lt_u32 vcc, s70, v28
    s_cbranch_vccz L_rackd_199
    s_cmp_lt_u32 s72, 0x10000
    s_cbranch_scc1 L_rack_198
L_rackd_199:
    v_max3_u32 v28, v20, v21, v22
    v_max_u32 v28, v28, v23
    s_nop 1
    v_max_u32_dpp v28, v28, v28 row_ror:1 row_mask:0xf bank_mask:0xf
    s_nop 1
    v_max_u32_dpp v28, v28, v28 row_ror:2 row_mask:0xf bank_mask:0xf
    s_nop 1
    v_max_u32_dpp v28, v28, v28 row_ror:4 row_mask:0xf bank_mask:0xf
    s_nop 1
    v_max_u32_dpp v28, v28, v28 row_ror:8 row_mask:0xf bank_mask:0xf
    v_mov_b32 v29, v28
    s_nop 1
    v_permlane32_swap_b32 v29, v28
    v_max_u32 v28, v29, v28
    v_mov_b32 v29, v28
    s_nop 1
    v_permlane16_swap_b32 v29, v28
    v_max_u32 v28, v29, v28
    s_nop 0
    v_readfirstlane_b32 s71, v28
    s_nop 1
    v_cmp_ne_u32 vcc, s71, v20
    s_nop 1
    v_cndmask_b32 v20, 0, v20, vcc
    v_cmp_ne_u32 vcc, s71, v21
    s_nop 1
    v_cndmask_b32 v21, 0, v21, vcc
    v_cmp_ne_u32 vcc, s71, v22
    s_nop 1
    v_cndmask_b32 v22, 0, v22, vcc
    v_cmp_ne_u32 vcc, s71, v23
    s_nop 1
    v_cndmask_b32 v23, 0, v23, vcc
    v_max3_u32 v28, v20, v21, v22
    v_max_u32 v28, v28, v23
    s_nop 1
    v_max_u32_dpp v28, v28, v28 row_ror:1 row_mask:0xf bank_mask:0xf
    s_nop 1
    v_max_u32_dpp v28, v28, v28 row_ror:2 row_mask:0xf bank_mask:0xf
    s_nop 1
    v_max_u32_dpp v28, v28, v28 row_ror:4 row_mask:0xf bank_mask:0xf
    s_nop 1
    v_max_u32_dpp v28, v28, v28 row_ror:8 row_mask:0xf bank_mask:0xf
    v_mov_b32 v29, v28
    s_nop 1
    v_permlane32_swap_b32 v29, v28
    v_max_u32 v28, v29, v28
    v_mov_b32 v29, v28
    s_nop 1
    v_permlane16_swap_b32 v29, v28
    v_max_u32 v28, v29, v28
    s_nop 0
    v_readfirstlane_b32 s72, v28
    s_nop 0
    s_max_u32 s70, s70, s72
    s_min_u32 s72, s71, s69
    s_max_u32 s70, s70, s72
    s_max_u32 s69, s69, s71
    v_mov_b32 v29, 0x20400
L_rsele_196:
    v_mov_b32 v20, s69
    v_mov_b32 v21, s70
    ds_write_b64 v29, v[20:21]
    s_waitcnt lgkmcnt(0)
L_rselw_197:
    s_barrier
    ds_read_b64 v[20:21], v29
    s_waitcnt lgkmcnt(0)
    v_readfirstlane_b32 s69, v20
    v_readfirstlane_b32 s70, v21
    s_nop 3
L_ffn_sel:
    s_and_b32 s71, s69, 2047
    s_lshl_b32 s71, s71, 11
    s_and_b32 s72, s70, 2047
    s_or_b32 s71, s71, s72
    s_add_u32 s71, s71, 1
    s_cmp_eq_u32 s71, s74
    s_cbranch_scc1 L_ffn_same
    s_mov_b32 s74, s71
    s_mov_b32 exec_lo, 0xff
    s_mov_b32 exec_hi, 0
    buffer_store_dwordx2 v[204:205], v202, s[16:19], 0 offen sc1
    s_mov_b64 exec, -1
    v_and_b32 v1, 63, v0
    v_lshrrev_b32 v2, 4, v1
    v_and_b32 v3, 15, v1
    v_lshrrev_b32 v6, 2, v3
    s_and_b32 s71, s69, 2047
    s_sub_u32 s71, 2047, s71
    s_and_b32 s72, s70, 2047
    s_sub_u32 s72, 2047, s72
    v_and_b32 v4, 1, v3
    v_cmp_eq_u32 vcc, 0, v4
    v_mov_b32 v4, s71
    v_mov_b32 v5, s72
    v_cndmask_b32 v4, v5, v4, vcc
    v_lshlrev_b32 v4, 10, v4
    v_lshl_add_u32 v4, v2, 4, v4
    s_mov_b32 s71, 0x6200000
    buffer_load_dwordx4 v[32:35], v4, s[8:11], s71 offen
    buffer_load_dwordx4 v[36:39], v4, s[8:11], s71 offen offset:64
    buffer_load_dwordx4 v[40:43], v4, s[8:11], s71 offen offset:128
    buffer_load_dwordx4 v[44:47], v4, s[8:11], s71 offen offset:192
    buffer_load_dwordx4 v[48:51], v4, s[8:11], s71 offen offset:256
    buffer_load_dwordx4 v[52:55], v4, s[8:11], s71 offen offset:320
    buffer_load_dwordx4 v[56:59], v4, s[8:11], s71 offen offset:384
    buffer_load_dwordx4 v[60:63], v4, s[8:11], s71 offen offset:448
    buffer_load_dwordx4 v[64:67], v4, s[8:11], s71 offen offset:512
    buffer_load_dwordx4 v[68:71], v4, s[8:11], s71 offen offset:576
    buffer_load_dwordx4 v[72:75], v4, s[8:11], s71 offen offset:640
    buffer_load_dwordx4 v[76:79], v4, s[8:11], s71 offen offset:704
    buffer_load_dwordx4 v[80:83], v4, s[8:11], s71 offen offset:768
    buffer_load_dwordx4 v[84:87], v4, s[8:11], s71 offen offset:832
    buffer_load_dwordx4 v[88:91], v4, s[8:11], s71 offen offset:896
    buffer_load_dwordx4 v[92:95], v4, s[8:11], s71 offen offset:960
    v_lshl_add_u32 v4, v2, 3, v6
    v_lshlrev_b32 v4, 6, v4
    v_and_b32 v5, 3, v3
    v_lshl_add_u32 v4, v5, 3, v4
    s_lshr_b32 s71, s68, 1
    s_lshl_b32 s71, s71, 15
    s_and_b32 s72, s68, 1
    s_lshl_b32 s72, s72, 5
    s_add_u32 s71, s71, s72
    s_add_u32 s71, s71, 0x8000
    v_add_u32 v7, s71, v4
    ds_read_b64_tr_b16 v[96:97], v7
    ds_read_b64_tr_b16 v[98:99], v7 offset:256
    ds_read_b64_tr_b16 v[100:101], v7 offset:2048
    ds_read_b64_tr_b16 v[102:103], v7 offset:2304
    ds_read_b64_tr_b16 v[104:105], v7 offset:4096
    ds_read_b64_tr_b16 v[106:107], v7 offset:4352
    ds_read_b64_tr_b16 v[108:109], v7 offset:6144
    ds_read_b64_tr_b16 v[110:111], v7 offset:6400
    s_waitcnt lgkmcnt(0)
    ds_read_b64_tr_b16 v[112:113], v7 offset:8192
    ds_read_b64_tr_b16 v[114:115], v7 offset:8448
    ds_read_b64_tr_b16 v[116:117], v7 offset:10240
    ds_read_b64_tr_b16 v[118:119], v7 offset:10496
    ds_read_b64_tr_b16 v[120:121], v7 offset:12288
    ds_read_b64_tr_b16 v[122:123], v7 offset:12544
    ds_read_b64_tr_b16 v[124:125], v7 offset:14336
    ds_read_b64_tr_b16 v[126:127], v7 offset:14592
    s_waitcnt lgkmcnt(0)
    ds_read_b64_tr_b16 v[128:129], v7 offset:16384
    ds_read_b64_tr_b16 v[130:131], v7 offset:16640
    ds_read_b64_tr_b16 v[132:133], v7 offset:18432
    ds_read_b64_tr_b16 v[134:135], v7 offset:18688
    ds_read_b64_tr_b16 v[136:137], v7 offset:20480
    ds_read_b64_tr_b16 v[138:139], v7 offset:20736
    ds_read_b64_tr_b16 v[140:141], v7 offset:22528
    ds_read_b64_tr_b16 v[142:143], v7 offset:22784
    s_waitcnt lgkmcnt(0)
    ds_read_b64_tr_b16 v[144:145], v7 offset:24576
    ds_read_b64_tr_b16 v[146:147], v7 offset:24832
    ds_read_b64_tr_b16 v[148:149], v7 offset:26624
    ds_read_b64_tr_b16 v[150:151], v7 offset:26880
    ds_read_b64_tr_b16 v[152:153], v7 offset:28672
    ds_read_b64_tr_b16 v[154:155], v7 offset:28928
    ds_read_b64_tr_b16 v[156:157], v7 offset:30720
    ds_read_b64_tr_b16 v[158:159], v7 offset:30976
    s_waitcnt lgkmcnt(0)
    s_waitcnt vmcnt(0)
    v_mfma_f32_16x16x32_bf16 v[8:11], v[32:35], v[96:99], 0
    v_mfma_f32_16x16x32_bf16 v[8:11], v[36:39], v[100:103], v[8:11]
    v_mfma_f32_16x16x32_bf16 v[8:11], v[40:43], v[104:107], v[8:11]
    v_mfma_f32_16x16x32_bf16 v[8:11], v[44:47], v[108:111], v[8:11]
    v_mfma_f32_16x16x32_bf16 v[8:11], v[48:51], v[112:115], v[8:11]
    v_mfma_f32_16x16x32_bf16 v[8:11], v[52:55], v[116:119], v[8:11]
    v_mfma_f32_16x16x32_bf16 v[8:11], v[56:59], v[120:123], v[8:11]
    v_mfma_f32_16x16x32_bf16 v[8:11], v[60:63], v[124:127], v[8:11]
    v_mfma_f32_16x16x32_bf16 v[8:11], v[64:67], v[128:131], v[8:11]
    v_mfma_f32_16x16x32_bf16 v[8:11], v[68:71], v[132:135], v[8:11]
    v_mfma_f32_16x16x32_bf16 v[8:11], v[72:75], v[136:139], v[8:11]
    v_mfma_f32_16x16x32_bf16 v[8:11], v[76:79], v[140:143], v[8:11]
    v_mfma_f32_16x16x32_bf16 v[8:11], v[80:83], v[144:147], v[8:11]
    v_mfma_f32_16x16x32_bf16 v[8:11], v[84:87], v[148:151], v[8:11]
    v_mfma_f32_16x16x32_bf16 v[8:11], v[88:91], v[152:155], v[8:11]
    v_mfma_f32_16x16x32_bf16 v[8:11], v[92:95], v[156:159], v[8:11]
    s_nop 7
    v_cvt_pk_bf16_f32 v8, v8, v8
    v_and_b32 v8, 0xffff0000, v8
    v_cvt_pk_bf16_f32 v9, v9, v9
    v_and_b32 v9, 0xffff0000, v9
    s_cmp_ge_u32 s68, 2
    s_cbranch_scc1 L_ffn_up_200
    v_mul_f32 v13, 0xbfb8aa3b, v8
    v_exp_f32 v13, v13
    s_nop 0
    v_add_f32 v13, 1.0, v13
    v_rcp_f32 v12, v13
    s_nop 0
    v_mul_f32 v8, v12, v8
    v_cvt_pk_bf16_f32 v8, v8, v8
    v_and_b32 v8, 0xffff0000, v8
    v_mul_f32 v13, 0xbfb8aa3b, v9
    v_exp_f32 v13, v13
    s_nop 0
    v_add_f32 v13, 1.0, v13
    v_rcp_f32 v12, v13
    s_nop 0
    v_mul_f32 v9, v12, v9
    v_cvt_pk_bf16_f32 v9, v9, v9
    v_and_b32 v9, 0xffff0000, v9
    s_nop 4
L_ffn_up_200:
    s_lshr_b32 s71, s68, 1
    s_lshl_b32 s71, s71, 8
    s_and_b32 s72, s68, 1
    s_lshl_b32 s72, s72, 6
    s_add_u32 s71, s71, s72
    s_add_u32 s71, s71, 0x20000
    v_lshlrev_b32 v4, 2, v3
    v_add_u32 v4, s71, v4
    ds_write_b32 v4, v8
    ds_write_b32 v4, v9 offset:128
    s_waitcnt lgkmcnt(0)
    s_barrier
    v_and_b32 v4, 1, v3
    v_lshlrev_b32 v4, 7, v4
    v_lshl_add_u32 v4, v2, 5, v4
    v_add_u32 v4, 0x20000, v4
    ds_read_b128 v[32:35], v4
    ds_read_b128 v[36:39], v4 offset:16
    ds_read_b128 v[40:43], v4 offset:256
    ds_read_b128 v[44:47], v4 offset:272
    v_lshl_add_u32 v5, v2, 3, v6
    v_lshlrev_b32 v5, 10, v5
    v_and_b32 v7, 3, v3
    v_lshl_add_u32 v5, v7, 3, v5
    s_lshl_b32 s71, s68, 8
    s_add_u32 s71, s71, 0x18000
    v_add_u32 v7, s71, v5
    s_waitcnt lgkmcnt(0)
    ds_read_b64_tr_b16 v[96:97], v7
    ds_read_b64_tr_b16 v[98:99], v7 offset:4096
    ds_read_b64_tr_b16 v[100:101], v7 offset:32
    ds_read_b64_tr_b16 v[102:103], v7 offset:4128
    ds_read_b64_tr_b16 v[104:105], v7 offset:64
    ds_read_b64_tr_b16 v[106:107], v7 offset:4160
    ds_read_b64_tr_b16 v[108:109], v7 offset:96
    ds_read_b64_tr_b16 v[110:111], v7 offset:4192
    s_waitcnt lgkmcnt(0)
    ds_read_b64_tr_b16 v[112:113], v7 offset:128
    ds_read_b64_tr_b16 v[114:115], v7 offset:4224
    ds_read_b64_tr_b16 v[116:117], v7 offset:160
    ds_read_b64_tr_b16 v[118:119], v7 offset:4256
    ds_read_b64_tr_b16 v[120:121], v7 offset:192
    ds_read_b64_tr_b16 v[122:123], v7 offset:4288
    ds_read_b64_tr_b16 v[124:125], v7 offset:224
    ds_read_b64_tr_b16 v[126:127], v7 offset:4320
    v_mul_f32 v32, v32, v40
    v_mul_f32 v33, v33, v41
    v_mul_f32 v34, v34, v42
    v_mul_f32 v35, v35, v43
    v_mul_f32 v36, v36, v44
    v_mul_f32 v37, v37, v45
    v_mul_f32 v38, v38, v46
    v_mul_f32 v39, v39, v47
    v_cvt_pk_bf16_f32 v48, v32, v33
    v_cvt_pk_bf16_f32 v49, v34, v35
    v_cvt_pk_bf16_f32 v50, v36, v37
    v_cvt_pk_bf16_f32 v51, v38, v39
    s_waitcnt lgkmcnt(0)
    s_nop 0
    v_mfma_f32_16x16x32_bf16 v[56:59], v[48:51], v[96:99], 0
    v_mfma_f32_16x16x32_bf16 v[60:63], v[48:51], v[100:103], 0
    v_mfma_f32_16x16x32_bf16 v[64:67], v[48:51], v[104:107], 0
    v_mfma_f32_16x16x32_bf16 v[68:71], v[48:51], v[108:111], 0
    v_mfma_f32_16x16x32_bf16 v[72:75], v[48:51], v[112:115], 0
    v_mfma_f32_16x16x32_bf16 v[76:79], v[48:51], v[116:119], 0
    v_mfma_f32_16x16x32_bf16 v[80:83], v[48:51], v[120:123], 0
    v_mfma_f32_16x16x32_bf16 v[84:87], v[48:51], v[124:127], 0
    v_cmp_eq_u32 vcc, 0, v2
    v_lshlrev_b32 v4, 11, v2
    v_lshl_add_u32 v4, v3, 2, v4
    s_lshl_b32 s71, s67, 12
    s_lshl_b32 s72, s68, 9
    s_add_u32 s71, s71, s72
    s_add_u32 s71, s71, 0x6410000
    v_cndmask_b32 v56, v57, v56, vcc
    v_cndmask_b32 v60, v61, v60, vcc
    v_cndmask_b32 v64, v65, v64, vcc
    v_cndmask_b32 v68, v69, v68, vcc
    v_cndmask_b32 v72, v73, v72, vcc
    v_cndmask_b32 v76, v77, v76, vcc
    v_cndmask_b32 v80, v81, v80, vcc
    v_cndmask_b32 v84, v85, v84, vcc
    s_mov_b32 exec_hi, 0
    buffer_store_dword v56, v4, s[8:11], s71 offen sc1
    buffer_store_dword v60, v4, s[8:11], s71 offen offset:64 sc1
    buffer_store_dword v64, v4, s[8:11], s71 offen offset:128 sc1
    buffer_store_dword v68, v4, s[8:11], s71 offen offset:192 sc1
    buffer_store_dword v72, v4, s[8:11], s71 offen offset:256 sc1
    buffer_store_dword v76, v4, s[8:11], s71 offen offset:320 sc1
    buffer_store_dword v80, v4, s[8:11], s71 offen offset:384 sc1
    buffer_store_dword v84, v4, s[8:11], s71 offen offset:448 sc1
    s_mov_b64 exec, -1
    s_waitcnt vmcnt(0)
    s_barrier
    s_lshl_b32 s71, s67, 2
    s_lshl_b32 s72, s75, 8
    s_add_u32 s71, s71, s72
    s_add_u32 s71, s71, 0x8000
    s_cmp_lg_u32 s100, 0
    s_cbranch_scc1 L_flag_201
    v_mov_b32 v2, s74
    s_mov_b64 exec, 1
    buffer_store_dword v2, off, s[8:11], s71 sc1
    s_mov_b64 exec, -1
L_flag_201:
    s_cmp_ge_u32 s67, 8
    s_cbranch_scc1 L_ffn_same
    s_load_dwordx2 s[16:17], s[0:1], 96
    s_waitcnt lgkmcnt(0)
    s_and_b32 s17, s17, 0xffff
    s_mov_b32 s18, 0x200000
    s_mov_b32 s19, 0x20000
    v_and_b32 v3, 63, v0
    s_cmp_lt_u32 s100, 2
    s_cselect_b32 s71, s69, s70
    v_mov_b32 v5, s71
    s_and_b32 s71, s71, 2047
    s_sub_u32 s71, 2047, s71
    s_lshl_b32 s71, s71, 10
    s_lshl_b32 s72, s67, 1
    s_and_b32 s96, s100, 1
    s_add_u32 s72, s72, s96
    s_lshl_b32 s96, s72, 6
    s_add_u32 s71, s71, s96
    v_and_b32 v4, 7, v3
    v_lshlrev_b32 v6, 3, v4
    v_add_u32 v6, s71, v6
    v_lshrrev_b32 v7, 3, v3
    v_lshlrev_b32 v7, 12, v7
    v_lshl_add_u32 v7, v4, 4, v7
    s_lshl_b32 s72, s72, 7
    s_lshr_b32 s96, s100, 1
    s_lshl_b32 s96, s96, 11
    s_add_u32 s72, s72, s96
    v_add_u32 v7, s72, v7
    s_mov_b32 s71, 0x6000000
    s_mov_b32 s72, 0x6200000
    buffer_load_dwordx2 v[8:9], v6, s[8:11], s71 offen sc1
    buffer_load_dwordx2 v[10:11], v6, s[8:11], s72 offen sc1
    v_and_b32 v5, 0xffff0000, v5
    v_ashrrev_i32 v4, 31, v5
    v_not_b32 v4, v4
    v_or_b32 v4, 0x80000000, v4
    v_xor_b32 v5, v5, v4
    v_and_b32 v5, 0xffff0000, v5
    v_mul_f32 v23, 0xbfb8aa3b, v5
    v_exp_f32 v23, v23
    s_nop 0
    v_add_f32 v23, 1.0, v23
    v_rcp_f32 v22, v23
    s_nop 0
    v_cvt_pk_bf16_f32 v22, v22, v22
    v_and_b32 v22, 0xffff0000, v22
    v_lshlrev_b32 v1, 2, v0
    s_lshl_b32 s71, s75, 8
    s_add_u32 s71, s71, 0x8000
    s_cmp_lg_u32 s100, 0
    s_cbranch_scc1 L_polls_204
    s_mov_b32 exec_hi, 0xffffff
    s_mov_b32 s96, 0
L_poll_202:
    buffer_load_dword v2, v1, s[8:11], s71 offen sc1
    s_waitcnt vmcnt(0)
    v_cmp_ne_u32 vcc, s74, v2
    s_cbranch_vccz L_polld_203
    s_sleep 2
    s_add_u32 s96, s96, 1
    s_cmp_lt_u32 s96, 0x10000
    s_cbranch_scc1 L_poll_202
L_polld_203:
    s_mov_b64 exec, -1
L_polls_204:
    s_barrier
    s_mov_b32 s71, 0x6410000
    buffer_load_dwordx4 v[32:35], v7, s[8:11], s71 offen sc1
    s_add_u32 s71, s71, 32768
    buffer_load_dwordx4 v[36:39], v7, s[8:11], s71 offen sc1
    s_add_u32 s71, s71, 32768
    buffer_load_dwordx4 v[40:43], v7, s[8:11], s71 offen sc1
    s_add_u32 s71, s71, 32768
    buffer_load_dwordx4 v[44:47], v7, s[8:11], s71 offen sc1
    s_add_u32 s71, s71, 32768
    buffer_load_dwordx4 v[48:51], v7, s[8:11], s71 offen sc1
    s_add_u32 s71, s71, 32768
    buffer_load_dwordx4 v[52:55], v7, s[8:11], s71 offen sc1
    s_add_u32 s71, s71, 32768
    buffer_load_dwordx4 v[56:59], v7, s[8:11], s71 offen sc1
    s_add_u32 s71, s71, 32768
    s_waitcnt vmcnt(7)
    v_lshlrev_b32 v12, 16, v8
    v_and_b32 v13, 0xffff0000, v8
    v_lshlrev_b32 v16, 16, v10
    v_and_b32 v17, 0xffff0000, v10
    v_lshlrev_b32 v14, 16, v9
    v_and_b32 v15, 0xffff0000, v9
    v_lshlrev_b32 v18, 16, v11
    v_and_b32 v19, 0xffff0000, v11
    s_waitcnt vmcnt(0)
    v_pk_add_f32 v[32:33], v[32:33], v[36:37]
    v_pk_add_f32 v[34:35], v[34:35], v[38:39]
    v_pk_add_f32 v[32:33], v[32:33], v[40:41]
    v_pk_add_f32 v[34:35], v[34:35], v[42:43]
    v_pk_add_f32 v[32:33], v[32:33], v[44:45]
    v_pk_add_f32 v[34:35], v[34:35], v[46:47]
    v_pk_add_f32 v[32:33], v[32:33], v[48:49]
    v_pk_add_f32 v[34:35], v[34:35], v[50:51]
    v_pk_add_f32 v[32:33], v[32:33], v[52:53]
    v_pk_add_f32 v[34:35], v[34:35], v[54:55]
    v_pk_add_f32 v[32:33], v[32:33], v[56:57]
    v_pk_add_f32 v[34:35], v[34:35], v[58:59]
    s_nop 0
    v_add_f32_dpp v32, v32, v32 row_ror:8 row_mask:0xf bank_mask:0xf
    v_add_f32_dpp v33, v33, v33 row_ror:8 row_mask:0xf bank_mask:0xf
    v_add_f32_dpp v34, v34, v34 row_ror:8 row_mask:0xf bank_mask:0xf
    v_add_f32_dpp v35, v35, v35 row_ror:8 row_mask:0xf bank_mask:0xf
    v_mov_b32 v24, v32
    s_nop 1
    v_permlane32_swap_b32 v24, v32
    v_add_f32 v32, v24, v32
    v_mov_b32 v24, v32
    s_nop 1
    v_permlane16_swap_b32 v24, v32
    v_add_f32 v32, v24, v32
    v_mov_b32 v24, v33
    s_nop 1
    v_permlane32_swap_b32 v24, v33
    v_add_f32 v33, v24, v33
    v_mov_b32 v24, v33
    s_nop 1
    v_permlane16_swap_b32 v24, v33
    v_add_f32 v33, v24, v33
    v_mov_b32 v24, v34
    s_nop 1
    v_permlane32_swap_b32 v24, v34
    v_add_f32 v34, v24, v34
    v_mov_b32 v24, v34
    s_nop 1
    v_permlane16_swap_b32 v24, v34
    v_add_f32 v34, v24, v34
    v_mov_b32 v24, v35
    s_nop 1
    v_permlane32_swap_b32 v24, v35
    v_add_f32 v35, v24, v35
    v_mov_b32 v24, v35
    s_nop 1
    v_permlane16_swap_b32 v24, v35
    v_add_f32 v35, v24, v35
    v_cvt_pk_bf16_f32 v32, v32, v32
    v_and_b32 v32, 0xffff0000, v32
    v_mul_f32 v32, v22, v32
    v_cvt_pk_bf16_f32 v32, v32, v32
    v_and_b32 v32, 0xffff0000, v32
    v_add_f32 v32, v16, v32
    v_cvt_pk_bf16_f32 v32, v32, v32
    v_and_b32 v32, 0xffff0000, v32
    v_add_f32 v32, v12, v32
    v_cvt_pk_bf16_f32 v33, v33, v33
    v_and_b32 v33, 0xffff0000, v33
    v_mul_f32 v33, v22, v33
    v_cvt_pk_bf16_f32 v33, v33, v33
    v_and_b32 v33, 0xffff0000, v33
    v_add_f32 v33, v17, v33
    v_cvt_pk_bf16_f32 v33, v33, v33
    v_and_b32 v33, 0xffff0000, v33
    v_add_f32 v33, v13, v33
    v_cvt_pk_bf16_f32 v34, v34, v34
    v_and_b32 v34, 0xffff0000, v34
    v_mul_f32 v34, v22, v34
    v_cvt_pk_bf16_f32 v34, v34, v34
    v_and_b32 v34, 0xffff0000, v34
    v_add_f32 v34, v18, v34
    v_cvt_pk_bf16_f32 v34, v34, v34
    v_and_b32 v34, 0xffff0000, v34
    v_add_f32 v34, v14, v34
    v_cvt_pk_bf16_f32 v35, v35, v35
    v_and_b32 v35, 0xffff0000, v35
    v_mul_f32 v35, v22, v35
    v_cvt_pk_bf16_f32 v35, v35, v35
    v_and_b32 v35, 0xffff0000, v35
    v_add_f32 v35, v19, v35
    v_cvt_pk_bf16_f32 v35, v35, v35
    v_and_b32 v35, 0xffff0000, v35
    v_add_f32 v35, v15, v35
    v_cvt_pk_bf16_f32 v200, v32, v33
    v_cvt_pk_bf16_f32 v201, v34, v35
    v_mov_b32 v202, v6
    v_pk_add_f32 v[12:13], v[12:13], v[16:17]
    v_cvt_pk_bf16_f32 v204, v12, v13
    v_pk_add_f32 v[14:15], v[14:15], v[18:19]
    v_cvt_pk_bf16_f32 v205, v14, v15
    s_mov_b32 exec_lo, 0xff
    s_mov_b32 exec_hi, 0
    buffer_store_dwordx2 v[200:201], v202, s[16:19], 0 offen sc1
    s_mov_b64 exec, -1
L_ffn_same:
    s_add_u32 s75, s75, 1
    s_cmp_lt_u32 s75, 2
    s_cbranch_scc1 L_ffn_round
    s_cmp_ge_u32 s67, 8
    s_cbranch_scc1 L_exit
    s_waitcnt vmcnt(0)
L_exit:
    s_endpgm
L_code_end:
.section .rodata,"a"
.p2align 6
.amdhsa_kernel sequential_preLN__memory_aug_recurrent_mem_tr__moe_arch_mod__prompt_kernel
  .amdhsa_next_free_vgpr 512
  .amdhsa_next_free_sgpr 102
  .amdhsa_accum_offset 256
  .amdhsa_group_segment_fixed_size 0
  .amdhsa_kernarg_size 120
  .amdhsa_user_sgpr_count 2
  .amdhsa_user_sgpr_kernarg_segment_ptr 1
  .amdhsa_system_sgpr_workgroup_id_x 1
  .amdhsa_float_denorm_mode_32 3
.end_amdhsa_kernel
```

```asm
; @launch grid=(256,1,1) block=(256,1,1) lds=163840
.amdgcn_target "amdgcn-amd-amdhsa--gfx950"
.text
.globl sequential_preLN__memory_aug_recurrent_mem_tr__moe_arch_mod__prompt_kernel
.p2align 8
.type sequential_preLN__memory_aug_recurrent_mem_tr__moe_arch_mod__prompt_kernel,@function
sequential_preLN__memory_aug_recurrent_mem_tr__moe_arch_mod__prompt_kernel:
    s_cmp_ge_u32 s2, 256
    s_cbranch_scc1 L_exit
    s_load_dwordx2 s[8:9], s[0:1], 112
    s_load_dwordx2 s[92:93], s[0:1], 104
    s_load_dwordx8 s[60:67], s[0:1], 16
    s_load_dwordx2 s[12:13], s[0:1], 0
    v_lshrrev_b32 v1, 6, v0
    s_nop 0
    v_readfirstlane_b32 s100, v1
    s_getreg_b32 s84, hwreg(HW_REG_XCC_ID)
    s_and_b32 s84, s84, 7
    s_lshr_b32 s85, s2, 3
    s_mov_b32 s86, s100
    s_cmp_eq_u32 s2, 7
    s_cbranch_scc1 L_zero
L_noz:
    s_cmp_lg_u32 s84, 0
    s_cbranch_scc1 L_other
    s_xor_b32 s20, s85, 0
    v_lshrrev_b32 v4, 6, v0
    s_nop 0
    v_readfirstlane_b32 s21, v4
    v_and_b32 v1, 63, v0
    v_lshrrev_b32 v2, 4, v1
    v_and_b32 v3, 15, v1
    v_lshrrev_b32 v6, 2, v3
    v_lshlrev_b32 v117, 4, v1
    s_lshl_b32 s51, s21, 10
    s_lshl_b32 s52, s21, 11
    s_mov_b32 s14, 0x400000
    s_mov_b32 s15, 0x20000
    s_lshl_b32 s41, s20, 8
    s_lshl_b32 s42, s20, 17
    s_lshr_b32 s43, s21, 1
    s_lshl_b32 s43, s43, 2
    v_or_b32 v5, s43, v2
    v_lshlrev_b32 v5, 1, v5
    v_xor_b32 v5, v5, v3
    v_lshrrev_b32 v14, 2, v5
    v_and_b32 v14, 2, v14
    v_lshlrev_b32 v5, 4, v5
    s_lshl_b32 s43, s21, 4
    v_add_u32 v4, s43, v2
    v_lshl_add_u32 v8, v4, 13, v5
    s_cmp_lg_u32 s20, 27
    s_cbranch_scc1 L_nocc_1
    v_lshlrev_b32 v25, 3, v117
    s_lshl_b32 s43, s21, 13
    s_getpc_b64 s[4:5]
L_pc_2:
    s_add_u32 s4, s4, L_nocc_1-L_pc_2
    s_addc_u32 s5, s5, 0
    v_add_u32 v25, s43, v25
    v_min_u32 v25, L_code_end-L_nocc_1-4, v25
    global_load_dword v29, v25, s[4:5]
L_nocc_1:
    v_mul_u32_u24 v22, 57, v0
    v_lshrrev_b32 v22, 11, v22
    v_mul_u32_u24 v23, 36, v22
    v_sub_u32 v23, v0, v23
    v_and_b32 v25, 3, v23
    v_and_or_b32 v23, v23, 60, 1
    v_min_u32 v23, 31, v23
    v_lshl_add_u32 v23, v23, 2, v25
    v_lshlrev_b32 v31, 6, v23
    s_add_u32 s43, s20, 2
    s_lshr_b32 s43, s43, 2
    s_sub_u32 s43, s20, s43
    s_mul_i32 s43, s43, 7
    v_add_u32 v22, s43, v22
    s_waitcnt lgkmcnt(0)
    s_mov_b32 s4, s60
    s_and_b32 s5, s61, 0xffff
    s_lshr_b32 s6, 0x5ddddddd, s20
    s_and_b32 s6, s6, 1
    s_lshl_b32 s6, s6, 22
    s_mov_b32 s7, 0x20000
    v_add_u32 v23, 0, v22
    v_and_b32 v25, 448, v23
    v_add_u32 v23, v23, v25
    v_lshl_add_u32 v23, v23, 13, v31
    s_mov_b32 s43, 0x80000
    buffer_load_dword v30, v23, s[4:7], s43 offen
    s_mov_b32 s4, s60
    s_and_b32 s5, s61, 0xffff
    s_lshr_b32 s6, 0x5ddddddd, s20
    s_and_b32 s6, s6, 1
    s_lshl_b32 s6, s6, 22
    s_mov_b32 s7, 0x20000
    v_add_u32 v23, 161, v22
    v_and_b32 v25, 448, v23
    v_add_u32 v23, v23, v25
    v_lshl_add_u32 v23, v23, 13, v31
    s_mov_b32 s43, 0x80000
    buffer_load_dword v30, v23, s[4:7], s43 offen
    s_and_b32 s9, s9, 0xffff
    s_mov_b32 s10, 0x10000000
    s_mov_b32 s11, 0x20000
    s_and_b32 s93, s93, 0xffff
    s_mov_b32 s94, 0x100
    s_mov_b32 s95, 0x20000
    s_mov_b32 s87, 0
    s_cmp_lg_u32 s86, 0
    s_cbranch_scc1 L_reg_3
    s_lshl_b32 s97, s84, 4
    s_lshl_b32 s96, 1, s85
    v_mov_b32 v250, s96
    v_mov_b32 v251, 256
    s_mov_b64 exec, 1
    buffer_atomic_add_x2 v[250:251], off, s[92:95], s97 offset:64
    s_mov_b64 exec, -1
    s_mov_b32 s86, 1
L_reg_3:
    s_mov_b32 s16, s92
    s_mov_b32 s17, s93
    s_mov_b32 s18, s94
    s_mov_b32 s19, s95
    s_mov_b32 s88, s20
    s_mov_b32 s12, s60
    s_and_b32 s13, s61, 0xffff
    v_xor_b32 v15, 0, v14
    v_lshl_add_u32 v15, v15, 15, v8
    s_add_u32 s43, s41, 0x0
    s_add_u32 m0, s51, 0x8000
    s_nop 0
    buffer_load_dwordx4 v15, s[12:15], s43 offen nt lds
    s_add_u32 s43, s41, 0x8000
    s_add_u32 m0, s51, 0x9000
    s_nop 0
    buffer_load_dwordx4 v15, s[12:15], s43 offen nt lds
    s_add_u32 s43, s41, 0x100000
    s_add_u32 m0, s51, 0xa000
    s_nop 0
    buffer_load_dwordx4 v15, s[12:15], s43 offen nt lds
    s_add_u32 s43, s41, 0x108000
    s_add_u32 m0, s51, 0xb000
    s_nop 0
    buffer_load_dwordx4 v15, s[12:15], s43 offen nt lds
    s_add_u32 s43, s41, 0x200000
    s_add_u32 m0, s51, 0xc000
    s_nop 0
    buffer_load_dwordx4 v15, s[12:15], s43 offen nt lds
    s_add_u32 s43, s41, 0x208000
    s_add_u32 m0, s51, 0xd000
    s_nop 0
    buffer_load_dwordx4 v15, s[12:15], s43 offen nt lds
    s_add_u32 s43, s41, 0x300000
    s_add_u32 m0, s51, 0xe000
    s_nop 0
    buffer_load_dwordx4 v15, s[12:15], s43 offen nt lds
    s_add_u32 s43, s41, 0x308000
    s_add_u32 m0, s51, 0xf000
    s_nop 0
    buffer_load_dwordx4 v15, s[12:15], s43 offen nt lds
    v_xor_b32 v15, 2, v14
    v_lshl_add_u32 v15, v15, 15, v8
    s_add_u32 s43, s41, 0x0
    s_add_u32 m0, s51, 0x10000
    s_nop 0
    buffer_load_dwordx4 v15, s[12:15], s43 offen nt lds
    s_add_u32 s43, s41, 0x8000
    s_add_u32 m0, s51, 0x11000
    s_nop 0
    buffer_load_dwordx4 v15, s[12:15], s43 offen nt lds
    s_add_u32 s43, s41, 0x100000
    s_add_u32 m0, s51, 0x12000
    s_nop 0
    buffer_load_dwordx4 v15, s[12:15], s43 offen nt lds
    s_add_u32 s43, s41, 0x108000
    s_add_u32 m0, s51, 0x13000
    s_nop 0
    buffer_load_dwordx4 v15, s[12:15], s43 offen nt lds
    s_add_u32 s43, s41, 0x200000
    s_add_u32 m0, s51, 0x14000
    s_nop 0
    buffer_load_dwordx4 v15, s[12:15], s43 offen nt lds
    s_add_u32 s43, s41, 0x208000
    s_add_u32 m0, s51, 0x15000
    s_nop 0
    buffer_load_dwordx4 v15, s[12:15], s43 offen nt lds
    s_add_u32 s43, s41, 0x300000
    s_add_u32 m0, s51, 0x16000
    s_nop 0
    buffer_load_dwordx4 v15, s[12:15], s43 offen nt lds
    s_add_u32 s43, s41, 0x308000
    s_add_u32 m0, s51, 0x17000
    s_nop 0
    buffer_load_dwordx4 v15, s[12:15], s43 offen nt lds
    v_xor_b32 v15, 0, v14
    v_lshl_add_u32 v15, v15, 15, v8
    s_add_u32 s43, s41, 0x80000
    s_add_u32 m0, s51, 0x18000
    s_nop 0
    buffer_load_dwordx4 v15, s[12:15], s43 offen nt lds
    s_add_u32 s43, s41, 0x88000
    s_add_u32 m0, s51, 0x19000
    s_nop 0
    buffer_load_dwordx4 v15, s[12:15], s43 offen nt lds
    s_add_u32 s43, s41, 0x180000
    s_add_u32 m0, s51, 0x1a000
    s_nop 0
    buffer_load_dwordx4 v15, s[12:15], s43 offen nt lds
    s_add_u32 s43, s41, 0x188000
    s_add_u32 m0, s51, 0x1b000
    s_nop 0
    buffer_load_dwordx4 v15, s[12:15], s43 offen nt lds
    v_and_b32 v4, 2, v3
    v_cmp_ne_u32 vcc, 0, v4
    v_mov_b32 v4, 0x4444
    v_mov_b32 v5, 0xeeee
    v_cndmask_b32 v116, v4, v5, vcc
    v_lshrrev_b32 v5, 1, v2
    v_lshl_add_u32 v4, v6, 3, v5
    s_lshl_b32 s43, s21, 1
    v_add_u32 v4, s43, v4
    v_add_u32 v5, s20, v4
    v_and_b32 v5, 31, v5
    v_lshl_add_u32 v4, v4, 6, v5
    v_and_b32 v5, 1, v2
    v_lshl_add_u32 v4, v4, 1, v5
    v_and_b32 v5, 3, v3
    v_lshl_add_u32 v4, v4, 2, v5
    v_lshlrev_b32 v118, 4, v4
    v_and_b32 v4, 1, v2
    v_lshlrev_b32 v4, 2, v4
    v_and_b32 v7, 2, v2
    v_add_u32 v4, v4, v7
    v_and_b32 v7, 1, v6
    v_add_u32 v4, v4, v7
    v_lshl_add_u32 v4, v4, 2, v5
    v_lshlrev_b32 v4, 2, v4
    s_and_b32 s43, s21, 1
    s_lshl_b32 s43, s43, 12
    s_lshl_b32 s40, s20, 7
    s_add_u32 s43, s43, s40
    v_add_u32 v119, s43, v4
    v_sub_u32 v7, 0, v2
    v_and_b32 v7, 3, v7
    v_xor_b32 v7, v7, v6
    v_lshl_add_u32 v4, v2, 4, v7
    v_and_b32 v5, 3, v3
    v_lshl_add_u32 v4, v4, 2, v5
    s_add_u32 s43, s51, 16384
    v_lshl_add_u32 v120, v4, 2, s43
    v_sub_u32 v7, 0, v6
    v_and_b32 v7, 3, v7
    v_xor_b32 v7, v7, v2
    v_lshl_add_u32 v4, v3, 2, v7
    v_lshlrev_b32 v121, 4, v4
    v_and_b32 v5, 1, v3
    v_lshl_add_u32 v4, v6, 1, v5
    v_lshl_add_u32 v4, v2, 3, v4
    v_lshlrev_b32 v127, 4, v4
    v_and_or_b32 v122, v116, 8, v127
    s_lshl_b32 s43, s21, 13
    s_add_u32 s43, s43, 32768
    v_add_u32 v123, s43, v117
    v_add_u32 v124, 0x10000, v123
    s_mov_b32 s36, 0xcccccccc
    s_mov_b32 s37, 0xcccccccc
    s_mov_b32 s38, 0x00ff00ff
    s_mov_b32 s39, 0x00ff00ff
    s_mov_b32 s34, 0x3e0293ee
    s_mov_b32 s35, 0x49800000
    s_mov_b32 s50, 0x3f803f80
    v_and_b32 v5, 1, v2
    v_or_b32 v5, 0, v5
    v_xor_b32 v5, v5, v6
    v_and_b32 v7, 2, v5
    v_add_u32 v5, v5, v7
    v_lshlrev_b32 v5, 6, v5
    v_and_b32 v7, 3, v3
    v_lshl_add_u32 v7, v7, 4, v5
    s_lshl_b32 s43, s21, 2
    v_add_u32 v4, s43, v2
    v_lshl_add_u32 v10, v4, 10, v7
    v_and_b32 v5, 1, v2
    v_or_b32 v5, 2, v5
    v_xor_b32 v5, v5, v6
    v_and_b32 v7, 2, v5
    v_add_u32 v5, v5, v7
    v_lshlrev_b32 v5, 6, v5
    v_and_b32 v7, 3, v3
    v_lshl_add_u32 v7, v7, 4, v5
    s_lshl_b32 s43, s21, 2
    v_add_u32 v4, s43, v2
    v_lshl_add_u32 v9, v4, 10, v7
    v_and_b32 v5, 1, v2
    v_lshl_add_u32 v4, v5, 3, v6
    v_lshrrev_b32 v7, 1, v2
    v_lshl_add_u32 v4, v7, 5, v4
    v_lshlrev_b32 v4, 8, v4
    v_lshl_or_b32 v5, v5, 2, v6
    v_lshlrev_b32 v5, 5, v5
    s_lshl_b32 s43, s21, 6
    v_xor_b32 v5, s43, v5
    v_add_u32 v4, v4, v5
    v_and_b32 v5, 3, v3
    v_lshl_add_u32 v4, v5, 3, v4
    v_add_u32 v11, 32768, v4
    s_and_b32 s43, s21, 1
    s_lshl_b32 s43, s43, 12
    v_add_u32 v11, s43, v11
    v_and_b32 v5, 1, v2
    v_lshlrev_b32 v4, 4, v5
    v_lshl_add_u32 v4, v7, 2, v4
    v_and_b32 v7, 1, v6
    v_add_u32 v4, v4, v7
    s_lshl_b32 s43, s21, 5
    v_add_u32 v4, s43, v4
    v_lshlrev_b32 v4, 8, v4
    v_lshl_or_b32 v5, v5, 1, v7
    s_lshl_b32 s43, s21, 1
    s_and_b32 s43, s43, 3
    v_xor_b32 v5, s43, v5
    v_lshl_add_u32 v4, v5, 6, v4
    v_lshrrev_b32 v5, 1, v6
    v_lshl_add_u32 v4, v5, 5, v4
    v_and_b32 v5, 3, v3
    v_lshl_add_u32 v4, v5, 3, v4
    v_add_u32 v12, 32768, v4
    v_mul_u32_u24 v4, 0x0, v2
    v_lshl_add_u32 v4, v3, 7, v4
    s_lshl_b32 s43, s20, 13
    s_add_u32 s43, s43, s52
    s_add_u32 s43, s43, 0xf0000
    v_add_u32 v4, s43, v4
    v_and_b32 v5, 3, v3
    v_lshl_add_u32 v5, v5, 13, v119
    v_cmp_gt_u32 vcc, 2, v2
    s_nop 1
    v_cndmask_b32 v7, v5, v4, vcc
    v_mov_b32 v16, -1
    v_mov_b32 v17, -1
    v_mov_b32 v18, -1
    v_mov_b32 v19, -1
    s_lshl_b32 s43, s20, 13
    s_add_u32 s43, s43, 0x100000
    s_and_b32 s40, s21, 1
    s_lshl_b32 s40, s40, 12
    s_add_u32 s29, s43, s40
    s_add_u32 s43, s43, s52
    s_xor_b32 s40, s43, 0x0
    buffer_store_dwordx4 v[16:19], v117, s[8:11], s43 offen
    buffer_store_dwordx4 v[16:19], v117, s[8:11], s43 offen offset:1024
    s_mov_b32 s43, 0x12000
    buffer_store_dword v16, v119, s[8:11], s43 offen
    s_mov_b32 s43, 0x14000
    buffer_store_dword v16, v119, s[8:11], s43 offen
    s_mov_b32 s43, 0x16000
    buffer_store_dword v16, v119, s[8:11], s43 offen
    s_load_dwordx2 s[4:5], s[0:1], 8
    s_waitcnt lgkmcnt(0)
    s_and_b32 s5, s5, 0xffff
    s_mov_b32 s6, 8192
    s_mov_b32 s7, 0x20000
    v_and_b32 v20, 1, v2
    v_and_b32 v21, 1, v6
    v_lshl_add_u32 v20, v20, 1, v21
    v_lshlrev_b32 v20, 9, v20
    v_and_b32 v21, 3, v3
    v_lshl_add_u32 v20, v21, 4, v20
    v_and_b32 v21, 2, v2
    v_add_u32 v20, v20, v21
    s_and_b32 s43, s20, 1
    s_lshl_b32 s43, s43, 11
    s_bfe_u32 s40, s20, 0x20001
    s_lshl_b32 s40, s40, 7
    s_add_u32 s43, s43, s40
    s_and_b32 s40, s21, 1
    s_lshl_b32 s40, s40, 6
    s_add_u32 s43, s43, s40
    s_lshr_b32 s40, s20, 3
    s_lshl_b32 s40, s40, 2
    s_add_u32 s43, s43, s40
    v_add_u32 v20, s43, v20
    v_lshlrev_b32 v20, 1, v20
    buffer_load_dword v21, v20, s[4:7], 0 offen
    s_mov_b32 s57, 0
    s_lshl_b32 s43, s20, 13
    s_add_u32 s43, s43, s52
    s_add_u32 s30, s43, 0x1000000
    s_add_u32 s31, s43, 0x2000000
    s_lshr_b32 s43, s43, 1
    s_add_u32 s32, s43, 0x220000
    s_waitcnt vmcnt(18)
    s_barrier
    v_xor_b32 v13, 0x0, v11
    v_add_u32 v13, 0x0, v13
    ds_read_b64_tr_b16 v[80:81], v13
    ds_read_b64_tr_b16 v[82:83], v13 offset:1024
    ds_read_b64_tr_b16 v[84:85], v13 offset:16384
    ds_read_b64_tr_b16 v[86:87], v13 offset:17408
    v_xor_b32 v13, 0x20, v11
    v_add_u32 v13, 0x0, v13
    ds_read_b64_tr_b16 v[56:57], v13
    ds_read_b64_tr_b16 v[58:59], v13 offset:1024
    ds_read_b64_tr_b16 v[60:61], v13 offset:16384
    ds_read_b64_tr_b16 v[62:63], v13 offset:17408
    v_xor_b32 v13, 0x1000, v11
    v_add_u32 v13, 0x0, v13
    ds_read_b64_tr_b16 a[0:1], v13
    ds_read_b64_tr_b16 a[2:3], v13 offset:1024
    ds_read_b64_tr_b16 a[4:5], v13 offset:16384
    ds_read_b64_tr_b16 a[6:7], v13 offset:17408
    v_xor_b32 v13, 0x1020, v11
    v_add_u32 v13, 0x0, v13
    ds_read_b64_tr_b16 a[8:9], v13
    ds_read_b64_tr_b16 a[10:11], v13 offset:1024
    ds_read_b64_tr_b16 a[12:13], v13 offset:16384
    ds_read_b64_tr_b16 a[14:15], v13 offset:17408
    s_waitcnt lgkmcnt(0)
    s_barrier
    s_mov_b32 s4, s62
    s_and_b32 s5, s63, 0xffff
    s_lshr_b32 s6, 0x5ddddddd, s20
    s_and_b32 s6, s6, 1
    s_lshl_b32 s6, s6, 22
    s_mov_b32 s7, 0x20000
    v_add_u32 v23, 0, v22
    v_and_b32 v25, 448, v23
    v_add_u32 v23, v23, v25
    v_lshl_add_u32 v23, v23, 13, v31
    s_mov_b32 s43, 0x0
    buffer_load_dword v30, v23, s[4:7], s43 offen
    s_add_u32 s43, s41, 0x280000
    s_add_u32 m0, s51, 0x1c000
    s_nop 0
    buffer_load_dwordx4 v15, s[12:15], s43 offen nt lds
    s_add_u32 s43, s41, 0x288000
    s_add_u32 m0, s51, 0x1d000
    s_nop 0
    buffer_load_dwordx4 v15, s[12:15], s43 offen nt lds
    s_add_u32 s43, s41, 0x380000
    s_add_u32 m0, s51, 0x1e000
    s_nop 0
    buffer_load_dwordx4 v15, s[12:15], s43 offen nt lds
    s_add_u32 s43, s41, 0x388000
    s_add_u32 m0, s51, 0x1f000
    s_nop 0
    buffer_load_dwordx4 v15, s[12:15], s43 offen nt lds
    v_xor_b32 v15, 2, v14
    v_lshl_add_u32 v15, v15, 15, v8
    s_add_u32 s43, s41, 0x80000
    s_add_u32 m0, s51, 0x20000
    s_nop 0
    buffer_load_dwordx4 v15, s[12:15], s43 offen nt lds
    s_add_u32 s43, s41, 0x88000
    s_add_u32 m0, s51, 0x21000
    s_nop 0
    buffer_load_dwordx4 v15, s[12:15], s43 offen nt lds
    s_add_u32 s43, s41, 0x180000
    s_add_u32 m0, s51, 0x22000
    s_nop 0
    buffer_load_dwordx4 v15, s[12:15], s43 offen nt lds
    s_add_u32 s43, s41, 0x188000
    s_add_u32 m0, s51, 0x23000
    s_nop 0
    buffer_load_dwordx4 v15, s[12:15], s43 offen nt lds
    s_waitcnt vmcnt(19)
    s_barrier
    v_xor_b32 v13, 0x0, v11
    v_add_u32 v13, 0x8000, v13
    ds_read_b64_tr_b16 a[32:33], v13
    ds_read_b64_tr_b16 a[34:35], v13 offset:1024
    ds_read_b64_tr_b16 a[36:37], v13 offset:16384
    ds_read_b64_tr_b16 a[38:39], v13 offset:17408
    v_xor_b32 v13, 0x20, v11
    v_add_u32 v13, 0x8000, v13
    ds_read_b64_tr_b16 a[40:41], v13
    ds_read_b64_tr_b16 a[42:43], v13 offset:1024
    ds_read_b64_tr_b16 a[44:45], v13 offset:16384
    ds_read_b64_tr_b16 a[46:47], v13 offset:17408
    v_xor_b32 v13, 0x1000, v11
    v_add_u32 v13, 0x8000, v13
    ds_read_b64_tr_b16 a[64:65], v13
    ds_read_b64_tr_b16 a[66:67], v13 offset:1024
    ds_read_b64_tr_b16 a[68:69], v13 offset:16384
    ds_read_b64_tr_b16 a[70:71], v13 offset:17408
    v_xor_b32 v13, 0x1020, v11
    v_add_u32 v13, 0x8000, v13
    ds_read_b64_tr_b16 a[72:73], v13
    ds_read_b64_tr_b16 a[74:75], v13 offset:1024
    ds_read_b64_tr_b16 a[76:77], v13 offset:16384
    ds_read_b64_tr_b16 a[78:79], v13 offset:17408
    s_waitcnt lgkmcnt(0)
    s_barrier
    s_add_u32 s43, s41, 0x280000
    s_add_u32 m0, s51, 0x24000
    s_nop 0
    buffer_load_dwordx4 v15, s[12:15], s43 offen nt lds
    s_add_u32 s43, s41, 0x288000
    s_add_u32 m0, s51, 0x25000
    s_nop 0
    buffer_load_dwordx4 v15, s[12:15], s43 offen nt lds
    s_add_u32 s43, s41, 0x380000
    s_add_u32 m0, s51, 0x26000
    s_nop 0
    buffer_load_dwordx4 v15, s[12:15], s43 offen nt lds
    s_add_u32 s43, s41, 0x388000
    s_add_u32 m0, s51, 0x27000
    s_nop 0
    buffer_load_dwordx4 v15, s[12:15], s43 offen nt lds
    s_mov_b32 s12, s62
    s_and_b32 s13, s63, 0xffff
    v_xor_b32 v15, 0, v14
    v_lshl_add_u32 v15, v15, 15, v8
    s_add_u32 s43, s41, 0x0
    s_add_u32 m0, s51, 0x8000
    s_nop 0
    buffer_load_dwordx4 v15, s[12:15], s43 offen nt lds
    s_add_u32 s43, s41, 0x8000
    s_add_u32 m0, s51, 0x9000
    s_nop 0
    buffer_load_dwordx4 v15, s[12:15], s43 offen nt lds
    s_add_u32 s43, s41, 0x100000
    s_add_u32 m0, s51, 0xa000
    s_nop 0
    buffer_load_dwordx4 v15, s[12:15], s43 offen nt lds
    s_add_u32 s43, s41, 0x108000
    s_add_u32 m0, s51, 0xb000
    s_nop 0
    buffer_load_dwordx4 v15, s[12:15], s43 offen nt lds
    s_waitcnt vmcnt(12)
    s_barrier
    v_xor_b32 v13, 0x0, v11
    v_add_u32 v13, 0x10000, v13
    ds_read_b64_tr_b16 v[88:89], v13
    ds_read_b64_tr_b16 v[90:91], v13 offset:1024
    ds_read_b64_tr_b16 v[92:93], v13 offset:16384
    ds_read_b64_tr_b16 v[94:95], v13 offset:17408
    v_xor_b32 v13, 0x20, v11
    v_add_u32 v13, 0x10000, v13
    ds_read_b64_tr_b16 v[96:97], v13
    ds_read_b64_tr_b16 v[98:99], v13 offset:1024
    ds_read_b64_tr_b16 v[100:101], v13 offset:16384
    ds_read_b64_tr_b16 v[102:103], v13 offset:17408
    v_xor_b32 v13, 0x1000, v11
    v_add_u32 v13, 0x10000, v13
    ds_read_b64_tr_b16 a[16:17], v13
    ds_read_b64_tr_b16 a[18:19], v13 offset:1024
    ds_read_b64_tr_b16 a[20:21], v13 offset:16384
    ds_read_b64_tr_b16 a[22:23], v13 offset:17408
    v_xor_b32 v13, 0x1020, v11
    v_add_u32 v13, 0x10000, v13
    ds_read_b64_tr_b16 a[24:25], v13
    ds_read_b64_tr_b16 a[26:27], v13 offset:1024
    ds_read_b64_tr_b16 a[28:29], v13 offset:16384
    ds_read_b64_tr_b16 a[30:31], v13 offset:17408
    s_waitcnt lgkmcnt(0)
    s_barrier
    s_add_u32 s43, s41, 0x200000
    s_add_u32 m0, s51, 0xc000
    s_nop 0
    buffer_load_dwordx4 v15, s[12:15], s43 offen nt lds
    s_add_u32 s43, s41, 0x208000
    s_add_u32 m0, s51, 0xd000
    s_nop 0
    buffer_load_dwordx4 v15, s[12:15], s43 offen nt lds
    s_add_u32 s43, s41, 0x300000
    s_add_u32 m0, s51, 0xe000
    s_nop 0
    buffer_load_dwordx4 v15, s[12:15], s43 offen nt lds
    s_add_u32 s43, s41, 0x308000
    s_add_u32 m0, s51, 0xf000
    s_nop 0
    buffer_load_dwordx4 v15, s[12:15], s43 offen nt lds
    v_xor_b32 v15, 2, v14
    v_lshl_add_u32 v15, v15, 15, v8
    s_add_u32 s43, s41, 0x0
    s_add_u32 m0, s51, 0x10000
    s_nop 0
    buffer_load_dwordx4 v15, s[12:15], s43 offen nt lds
    s_add_u32 s43, s41, 0x8000
    s_add_u32 m0, s51, 0x11000
    s_nop 0
    buffer_load_dwordx4 v15, s[12:15], s43 offen nt lds
    s_add_u32 s43, s41, 0x100000
    s_add_u32 m0, s51, 0x12000
    s_nop 0
    buffer_load_dwordx4 v15, s[12:15], s43 offen nt lds
    s_add_u32 s43, s41, 0x108000
    s_add_u32 m0, s51, 0x13000
    s_nop 0
    buffer_load_dwordx4 v15, s[12:15], s43 offen nt lds
    s_waitcnt vmcnt(12)
    s_barrier
    v_xor_b32 v13, 0x0, v11
    v_add_u32 v13, 0x18000, v13
    ds_read_b64_tr_b16 a[48:49], v13
    ds_read_b64_tr_b16 a[50:51], v13 offset:1024
    ds_read_b64_tr_b16 a[52:53], v13 offset:16384
    ds_read_b64_tr_b16 a[54:55], v13 offset:17408
    v_xor_b32 v13, 0x20, v11
    v_add_u32 v13, 0x18000, v13
    ds_read_b64_tr_b16 a[56:57], v13
    ds_read_b64_tr_b16 a[58:59], v13 offset:1024
    ds_read_b64_tr_b16 a[60:61], v13 offset:16384
    ds_read_b64_tr_b16 a[62:63], v13 offset:17408
    v_xor_b32 v13, 0x1000, v11
    v_add_u32 v13, 0x18000, v13
    ds_read_b64_tr_b16 a[80:81], v13
    ds_read_b64_tr_b16 a[82:83], v13 offset:1024
    ds_read_b64_tr_b16 a[84:85], v13 offset:16384
    ds_read_b64_tr_b16 a[86:87], v13 offset:17408
    v_xor_b32 v13, 0x1020, v11
    v_add_u32 v13, 0x18000, v13
    ds_read_b64_tr_b16 a[88:89], v13
    ds_read_b64_tr_b16 a[90:91], v13 offset:1024
    ds_read_b64_tr_b16 a[92:93], v13 offset:16384
    ds_read_b64_tr_b16 a[94:95], v13 offset:17408
    s_waitcnt lgkmcnt(0)
    s_barrier
    s_add_u32 s43, s41, 0x200000
    s_add_u32 m0, s51, 0x14000
    s_nop 0
    buffer_load_dwordx4 v15, s[12:15], s43 offen nt lds
    s_add_u32 s43, s41, 0x208000
    s_add_u32 m0, s51, 0x15000
    s_nop 0
    buffer_load_dwordx4 v15, s[12:15], s43 offen nt lds
    s_add_u32 s43, s41, 0x300000
    s_add_u32 m0, s51, 0x16000
    s_nop 0
    buffer_load_dwordx4 v15, s[12:15], s43 offen nt lds
    s_add_u32 s43, s41, 0x308000
    s_add_u32 m0, s51, 0x17000
    s_nop 0
    buffer_load_dwordx4 v15, s[12:15], s43 offen nt lds
    v_xor_b32 v15, 0, v14
    v_lshl_add_u32 v15, v15, 15, v8
    s_add_u32 s43, s41, 0x80000
    s_add_u32 m0, s51, 0x18000
    s_nop 0
    buffer_load_dwordx4 v15, s[12:15], s43 offen nt lds
    s_add_u32 s43, s41, 0x88000
    s_add_u32 m0, s51, 0x19000
    s_nop 0
    buffer_load_dwordx4 v15, s[12:15], s43 offen nt lds
    s_add_u32 s43, s41, 0x180000
    s_add_u32 m0, s51, 0x1a000
    s_nop 0
    buffer_load_dwordx4 v15, s[12:15], s43 offen nt lds
    s_add_u32 s43, s41, 0x188000
    s_add_u32 m0, s51, 0x1b000
    s_nop 0
    buffer_load_dwordx4 v15, s[12:15], s43 offen nt lds
    s_waitcnt vmcnt(12)
    v_min_u32 v21, 0xfffffffe, v21
    s_mov_b32 s43, 0x10000
    s_mov_b64 exec, s[38:39]
    buffer_store_dword v21, v119, s[8:11], s43 offen
    s_mov_b64 exec, -1
    s_barrier
    v_xor_b32 v13, 0x0, v11
    v_add_u32 v13, 0x0, v13
    ds_read_b64_tr_b16 v[64:65], v13
    ds_read_b64_tr_b16 v[66:67], v13 offset:1024
    ds_read_b64_tr_b16 v[68:69], v13 offset:16384
    ds_read_b64_tr_b16 v[70:71], v13 offset:17408
    v_xor_b32 v13, 0x20, v11
    v_add_u32 v13, 0x0, v13
    ds_read_b64_tr_b16 v[72:73], v13
    ds_read_b64_tr_b16 v[74:75], v13 offset:1024
    ds_read_b64_tr_b16 v[76:77], v13 offset:16384
    ds_read_b64_tr_b16 v[78:79], v13 offset:17408
    v_xor_b32 v13, 0x1000, v11
    v_add_u32 v13, 0x0, v13
    ds_read_b64_tr_b16 a[96:97], v13
    ds_read_b64_tr_b16 a[98:99], v13 offset:1024
    ds_read_b64_tr_b16 a[100:101], v13 offset:16384
    ds_read_b64_tr_b16 a[102:103], v13 offset:17408
    v_xor_b32 v13, 0x1020, v11
    v_add_u32 v13, 0x0, v13
    ds_read_b64_tr_b16 a[104:105], v13
    ds_read_b64_tr_b16 a[106:107], v13 offset:1024
    ds_read_b64_tr_b16 a[108:109], v13 offset:16384
    ds_read_b64_tr_b16 a[110:111], v13 offset:17408
    s_waitcnt lgkmcnt(0)
    s_barrier
    s_add_u32 s43, s41, 0x280000
    s_add_u32 m0, s51, 0x1c000
    s_nop 0
    buffer_load_dwordx4 v15, s[12:15], s43 offen nt lds
    s_add_u32 s43, s41, 0x288000
    s_add_u32 m0, s51, 0x1d000
    s_nop 0
    buffer_load_dwordx4 v15, s[12:15], s43 offen nt lds
    s_add_u32 s43, s41, 0x380000
    s_add_u32 m0, s51, 0x1e000
    s_nop 0
    buffer_load_dwordx4 v15, s[12:15], s43 offen nt lds
    s_add_u32 s43, s41, 0x388000
    s_add_u32 m0, s51, 0x1f000
    s_nop 0
    buffer_load_dwordx4 v15, s[12:15], s43 offen nt lds
    v_xor_b32 v15, 2, v14
    v_lshl_add_u32 v15, v15, 15, v8
    s_add_u32 s43, s41, 0x80000
    s_add_u32 m0, s51, 0x20000
    s_nop 0
    buffer_load_dwordx4 v15, s[12:15], s43 offen nt lds
    s_add_u32 s43, s41, 0x88000
    s_add_u32 m0, s51, 0x21000
    s_nop 0
    buffer_load_dwordx4 v15, s[12:15], s43 offen nt lds
    s_add_u32 s43, s41, 0x180000
    s_add_u32 m0, s51, 0x22000
    s_nop 0
    buffer_load_dwordx4 v15, s[12:15], s43 offen nt lds
    s_add_u32 s43, s41, 0x188000
    s_add_u32 m0, s51, 0x23000
    s_nop 0
    buffer_load_dwordx4 v15, s[12:15], s43 offen nt lds
    s_waitcnt vmcnt(12)
    s_barrier
    v_xor_b32 v13, 0x0, v11
    v_add_u32 v13, 0x8000, v13
    ds_read_b64_tr_b16 a[128:129], v13
    ds_read_b64_tr_b16 a[130:131], v13 offset:1024
    ds_read_b64_tr_b16 a[132:133], v13 offset:16384
    ds_read_b64_tr_b16 a[134:135], v13 offset:17408
    v_xor_b32 v13, 0x20, v11
    v_add_u32 v13, 0x8000, v13
    ds_read_b64_tr_b16 a[136:137], v13
    ds_read_b64_tr_b16 a[138:139], v13 offset:1024
    ds_read_b64_tr_b16 a[140:141], v13 offset:16384
    ds_read_b64_tr_b16 a[142:143], v13 offset:17408
    v_xor_b32 v13, 0x1000, v11
    v_add_u32 v13, 0x8000, v13
    ds_read_b64_tr_b16 a[160:161], v13
    ds_read_b64_tr_b16 a[162:163], v13 offset:1024
    ds_read_b64_tr_b16 a[164:165], v13 offset:16384
    ds_read_b64_tr_b16 a[166:167], v13 offset:17408
    v_xor_b32 v13, 0x1020, v11
    v_add_u32 v13, 0x8000, v13
    ds_read_b64_tr_b16 a[168:169], v13
    ds_read_b64_tr_b16 a[170:171], v13 offset:1024
    ds_read_b64_tr_b16 a[172:173], v13 offset:16384
    ds_read_b64_tr_b16 a[174:175], v13 offset:17408
    s_waitcnt lgkmcnt(0)
    s_barrier
    buffer_load_dwordx2 v[26:27], off, s[16:19], 0 offset:36 sc1
    s_add_u32 s43, s41, 0x280000
    s_add_u32 m0, s51, 0x24000
    s_nop 0
    buffer_load_dwordx4 v15, s[12:15], s43 offen nt lds
    s_add_u32 s43, s41, 0x288000
    s_add_u32 m0, s51, 0x25000
    s_nop 0
    buffer_load_dwordx4 v15, s[12:15], s43 offen nt lds
    s_add_u32 s43, s41, 0x380000
    s_add_u32 m0, s51, 0x26000
    s_nop 0
    buffer_load_dwordx4 v15, s[12:15], s43 offen nt lds
    s_add_u32 s43, s41, 0x388000
    s_add_u32 m0, s51, 0x27000
    s_nop 0
    buffer_load_dwordx4 v15, s[12:15], s43 offen nt lds
    s_mov_b32 s12, s64
    s_and_b32 s13, s65, 0xffff
    v_xor_b32 v15, 0, v14
    v_lshl_add_u32 v15, v15, 15, v8
    s_add_u32 s43, s41, 0x0
    s_add_u32 m0, s51, 0x8000
    s_nop 0
    buffer_load_dwordx4 v15, s[12:15], s43 offen lds
    s_add_u32 s43, s41, 0x8000
    s_add_u32 m0, s51, 0x9000
    s_nop 0
    buffer_load_dwordx4 v15, s[12:15], s43 offen lds
    s_add_u32 s43, s41, 0x100000
    s_add_u32 m0, s51, 0xa000
    s_nop 0
    buffer_load_dwordx4 v15, s[12:15], s43 offen lds
    s_add_u32 s43, s41, 0x108000
    s_add_u32 m0, s51, 0xb000
    s_nop 0
    buffer_load_dwordx4 v15, s[12:15], s43 offen lds
    s_waitcnt vmcnt(13)
    s_barrier
    v_xor_b32 v13, 0x0, v11
    v_add_u32 v13, 0x10000, v13
    ds_read_b64_tr_b16 v[104:105], v13
    ds_read_b64_tr_b16 v[106:107], v13 offset:1024
    ds_read_b64_tr_b16 v[108:109], v13 offset:16384
    ds_read_b64_tr_b16 v[110:111], v13 offset:17408
    v_xor_b32 v13, 0x20, v11
    v_add_u32 v13, 0x10000, v13
    ds_read_b64_tr_b16 v[32:33], v13
    ds_read_b64_tr_b16 v[34:35], v13 offset:1024
    ds_read_b64_tr_b16 v[36:37], v13 offset:16384
    ds_read_b64_tr_b16 v[38:39], v13 offset:17408
    v_xor_b32 v13, 0x1000, v11
    v_add_u32 v13, 0x10000, v13
    ds_read_b64_tr_b16 a[112:113], v13
    ds_read_b64_tr_b16 a[114:115], v13 offset:1024
    ds_read_b64_tr_b16 a[116:117], v13 offset:16384
    ds_read_b64_tr_b16 a[118:119], v13 offset:17408
    v_xor_b32 v13, 0x1020, v11
    v_add_u32 v13, 0x10000, v13
    ds_read_b64_tr_b16 a[120:121], v13
    ds_read_b64_tr_b16 a[122:123], v13 offset:1024
    ds_read_b64_tr_b16 a[124:125], v13 offset:16384
    ds_read_b64_tr_b16 a[126:127], v13 offset:17408
    s_waitcnt lgkmcnt(0)
    s_barrier
    s_add_u32 s43, s41, 0x200000
    s_add_u32 m0, s51, 0xc000
    s_nop 0
    buffer_load_dwordx4 v15, s[12:15], s43 offen lds
    s_add_u32 s43, s41, 0x208000
    s_add_u32 m0, s51, 0xd000
    s_nop 0
    buffer_load_dwordx4 v15, s[12:15], s43 offen lds
    s_add_u32 s43, s41, 0x300000
    s_add_u32 m0, s51, 0xe000
    s_nop 0
    buffer_load_dwordx4 v15, s[12:15], s43 offen lds
    s_add_u32 s43, s41, 0x308000
    s_add_u32 m0, s51, 0xf000
    s_nop 0
    buffer_load_dwordx4 v15, s[12:15], s43 offen lds
    v_xor_b32 v15, 2, v14
    v_lshl_add_u32 v15, v15, 15, v8
    s_add_u32 s43, s41, 0x0
    s_add_u32 m0, s51, 0x10000
    s_nop 0
    buffer_load_dwordx4 v15, s[12:15], s43 offen lds
    s_add_u32 s43, s41, 0x8000
    s_add_u32 m0, s51, 0x11000
    s_nop 0
    buffer_load_dwordx4 v15, s[12:15], s43 offen lds
    s_add_u32 s43, s41, 0x100000
    s_add_u32 m0, s51, 0x12000
    s_nop 0
    buffer_load_dwordx4 v15, s[12:15], s43 offen lds
    s_add_u32 s43, s41, 0x108000
    s_add_u32 m0, s51, 0x13000
    s_nop 0
    buffer_load_dwordx4 v15, s[12:15], s43 offen lds
    s_waitcnt vmcnt(12)
    s_barrier
    v_xor_b32 v13, 0x0, v11
    v_add_u32 v13, 0x18000, v13
    ds_read_b64_tr_b16 a[144:145], v13
    ds_read_b64_tr_b16 a[146:147], v13 offset:1024
    ds_read_b64_tr_b16 a[148:149], v13 offset:16384
    ds_read_b64_tr_b16 a[150:151], v13 offset:17408
    v_xor_b32 v13, 0x20, v11
    v_add_u32 v13, 0x18000, v13
    ds_read_b64_tr_b16 a[152:153], v13
    ds_read_b64_tr_b16 a[154:155], v13 offset:1024
    ds_read_b64_tr_b16 a[156:157], v13 offset:16384
    ds_read_b64_tr_b16 a[158:159], v13 offset:17408
    v_xor_b32 v13, 0x1000, v11
    v_add_u32 v13, 0x18000, v13
    ds_read_b64_tr_b16 a[176:177], v13
    ds_read_b64_tr_b16 a[178:179], v13 offset:1024
    ds_read_b64_tr_b16 a[180:181], v13 offset:16384
    ds_read_b64_tr_b16 a[182:183], v13 offset:17408
    v_xor_b32 v13, 0x1020, v11
    v_add_u32 v13, 0x18000, v13
    ds_read_b64_tr_b16 a[184:185], v13
    ds_read_b64_tr_b16 a[186:187], v13 offset:1024
    ds_read_b64_tr_b16 a[188:189], v13 offset:16384
    ds_read_b64_tr_b16 a[190:191], v13 offset:17408
    s_waitcnt lgkmcnt(0)
    s_barrier
    s_add_u32 s43, s41, 0x200000
    s_add_u32 m0, s51, 0x14000
    s_nop 0
    buffer_load_dwordx4 v15, s[12:15], s43 offen lds
    s_add_u32 s43, s41, 0x208000
    s_add_u32 m0, s51, 0x15000
    s_nop 0
    buffer_load_dwordx4 v15, s[12:15], s43 offen lds
    s_add_u32 s43, s41, 0x300000
    s_add_u32 m0, s51, 0x16000
    s_nop 0
    buffer_load_dwordx4 v15, s[12:15], s43 offen lds
    s_add_u32 s43, s41, 0x308000
    s_add_u32 m0, s51, 0x17000
    s_nop 0
    buffer_load_dwordx4 v15, s[12:15], s43 offen lds
    s_mov_b32 s12, s66
    s_and_b32 s13, s67, 0xffff
    s_add_u32 s43, s42, 0x80
    s_add_u32 m0, s51, 0x18000
    s_nop 0
    buffer_load_dwordx4 v10, s[12:15], s43 offen lds
    s_add_u32 s43, s42, 0x4080
    s_add_u32 m0, s51, 0x19000
    s_nop 0
    buffer_load_dwordx4 v9, s[12:15], s43 offen lds
    s_add_u32 s43, s42, 0x8080
    s_add_u32 m0, s51, 0x1a000
    s_nop 0
    buffer_load_dwordx4 v10, s[12:15], s43 offen lds
    s_add_u32 s43, s42, 0xc080
    s_add_u32 m0, s51, 0x1b000
    s_nop 0
    buffer_load_dwordx4 v9, s[12:15], s43 offen lds
    s_waitcnt vmcnt(12)
    s_barrier
    v_xor_b32 v13, 0x0, v11
    v_add_u32 v13, 0x0, v13
    ds_read_b64_tr_b16 a[192:193], v13
    ds_read_b64_tr_b16 a[194:195], v13 offset:1024
    ds_read_b64_tr_b16 a[196:197], v13 offset:16384
    ds_read_b64_tr_b16 a[198:199], v13 offset:17408
    v_xor_b32 v13, 0x20, v11
    v_add_u32 v13, 0x0, v13
    ds_read_b64_tr_b16 a[200:201], v13
    ds_read_b64_tr_b16 a[202:203], v13 offset:1024
    ds_read_b64_tr_b16 a[204:205], v13 offset:16384
    ds_read_b64_tr_b16 a[206:207], v13 offset:17408
    v_xor_b32 v13, 0x1000, v11
    v_add_u32 v13, 0x0, v13
    ds_read_b64_tr_b16 a[224:225], v13
    ds_read_b64_tr_b16 a[226:227], v13 offset:1024
    ds_read_b64_tr_b16 a[228:229], v13 offset:16384
    ds_read_b64_tr_b16 a[230:231], v13 offset:17408
    v_xor_b32 v13, 0x1020, v11
    v_add_u32 v13, 0x0, v13
    ds_read_b64_tr_b16 a[232:233], v13
    ds_read_b64_tr_b16 a[234:235], v13 offset:1024
    ds_read_b64_tr_b16 a[236:237], v13 offset:16384
    ds_read_b64_tr_b16 a[238:239], v13 offset:17408
    s_waitcnt lgkmcnt(0)
    s_barrier
    s_add_u32 s43, s42, 0x10280
    s_add_u32 m0, s51, 0x1c000
    s_nop 0
    buffer_load_dwordx4 v10, s[12:15], s43 offen lds
    s_add_u32 s43, s42, 0x14280
    s_add_u32 m0, s51, 0x1d000
    s_nop 0
    buffer_load_dwordx4 v9, s[12:15], s43 offen lds
    s_add_u32 s43, s42, 0x18280
    s_add_u32 m0, s51, 0x1e000
    s_nop 0
    buffer_load_dwordx4 v10, s[12:15], s43 offen lds
    s_add_u32 s43, s42, 0x1c280
    s_add_u32 m0, s51, 0x1f000
    s_nop 0
    buffer_load_dwordx4 v9, s[12:15], s43 offen lds
    s_add_u32 s43, s42, 0x10080
    s_add_u32 m0, s51, 0x20000
    s_nop 0
    buffer_load_dwordx4 v10, s[12:15], s43 offen lds
    s_add_u32 s43, s42, 0x14080
    s_add_u32 m0, s51, 0x21000
    s_nop 0
    buffer_load_dwordx4 v9, s[12:15], s43 offen lds
    s_add_u32 s43, s42, 0x18080
    s_add_u32 m0, s51, 0x22000
    s_nop 0
    buffer_load_dwordx4 v10, s[12:15], s43 offen lds
    s_add_u32 s43, s42, 0x1c080
    s_add_u32 m0, s51, 0x23000
    s_nop 0
    buffer_load_dwordx4 v9, s[12:15], s43 offen lds
    s_waitcnt vmcnt(12)
    v_readfirstlane_b32 s57, v26
    v_readfirstlane_b32 s43, v27
    s_nop 0
    s_cmp_lg_u32 s43, 0
    s_cselect_b32 s57, s57, 0
    s_barrier
    s_cmp_lg_u32 s21, 0
    s_cbranch_scc1 L_arr_4
    v_mov_b32 v23, 1
    s_mov_b64 exec, 1
    buffer_atomic_add v23, off, s[16:19], 0 offset:4
    s_mov_b64 exec, -1
L_arr_4:
    v_xor_b32 v13, 0x0, v11
    v_add_u32 v13, 0x8000, v13
    ds_read_b64_tr_b16 v[128:129], v13
    ds_read_b64_tr_b16 v[130:131], v13 offset:1024
    ds_read_b64_tr_b16 v[132:133], v13 offset:16384
    ds_read_b64_tr_b16 v[134:135], v13 offset:17408
    v_xor_b32 v13, 0x20, v11
    v_add_u32 v13, 0x8000, v13
    ds_read_b64_tr_b16 v[136:137], v13
    ds_read_b64_tr_b16 v[138:139], v13 offset:1024
    ds_read_b64_tr_b16 v[140:141], v13 offset:16384
    ds_read_b64_tr_b16 v[142:143], v13 offset:17408
    v_xor_b32 v13, 0x1000, v11
    v_add_u32 v13, 0x8000, v13
    ds_read_b64_tr_b16 v[160:161], v13
    ds_read_b64_tr_b16 v[162:163], v13 offset:1024
    ds_read_b64_tr_b16 v[164:165], v13 offset:16384
    ds_read_b64_tr_b16 v[166:167], v13 offset:17408
    v_xor_b32 v13, 0x1020, v11
    v_add_u32 v13, 0x8000, v13
    ds_read_b64_tr_b16 v[168:169], v13
    ds_read_b64_tr_b16 v[170:171], v13 offset:1024
    ds_read_b64_tr_b16 v[172:173], v13 offset:16384
    ds_read_b64_tr_b16 v[174:175], v13 offset:17408
    s_waitcnt lgkmcnt(0)
    s_barrier
    s_add_u32 s43, s42, 0x280
    s_add_u32 m0, s51, 0x24000
    s_nop 0
    buffer_load_dwordx4 v10, s[12:15], s43 offen lds
    s_add_u32 s43, s42, 0x4280
    s_add_u32 m0, s51, 0x25000
    s_nop 0
    buffer_load_dwordx4 v9, s[12:15], s43 offen lds
    s_add_u32 s43, s42, 0x8280
    s_add_u32 m0, s51, 0x26000
    s_nop 0
    buffer_load_dwordx4 v10, s[12:15], s43 offen lds
    s_add_u32 s43, s42, 0xc280
    s_add_u32 m0, s51, 0x27000
    s_nop 0
    buffer_load_dwordx4 v9, s[12:15], s43 offen lds
    s_mov_b32 s12, s64
    s_and_b32 s13, s65, 0xffff
    v_xor_b32 v15, 0, v14
    v_lshl_add_u32 v15, v15, 15, v8
    s_add_u32 s43, s41, 0x80000
    s_add_u32 m0, s51, 0x8000
    s_nop 0
    buffer_load_dwordx4 v15, s[12:15], s43 offen lds
    s_add_u32 s43, s41, 0x88000
    s_add_u32 m0, s51, 0x9000
    s_nop 0
    buffer_load_dwordx4 v15, s[12:15], s43 offen lds
    s_add_u32 s43, s41, 0x180000
    s_add_u32 m0, s51, 0xa000
    s_nop 0
    buffer_load_dwordx4 v15, s[12:15], s43 offen lds
    s_add_u32 s43, s41, 0x188000
    s_add_u32 m0, s51, 0xb000
    s_nop 0
    buffer_load_dwordx4 v15, s[12:15], s43 offen lds
    s_waitcnt vmcnt(12)
    s_barrier
    v_xor_b32 v13, 0x0, v12
    v_add_u32 v13, 0x10000, v13
    ds_read_b64_tr_b16 v[192:193], v13
    ds_read_b64_tr_b16 v[194:195], v13 offset:512
    ds_read_b64_tr_b16 v[196:197], v13 offset:2048
    ds_read_b64_tr_b16 v[198:199], v13 offset:2560
    v_xor_b32 v13, 0x2000, v12
    v_add_u32 v13, 0x10000, v13
    ds_read_b64_tr_b16 v[200:201], v13
    ds_read_b64_tr_b16 v[202:203], v13 offset:512
    ds_read_b64_tr_b16 v[204:205], v13 offset:2048
    ds_read_b64_tr_b16 v[206:207], v13 offset:2560
    v_xor_b32 v13, 0x40, v12
    v_add_u32 v13, 0x10000, v13
    ds_read_b64_tr_b16 v[224:225], v13
    ds_read_b64_tr_b16 v[226:227], v13 offset:512
    ds_read_b64_tr_b16 v[228:229], v13 offset:2048
    ds_read_b64_tr_b16 v[230:231], v13 offset:2560
    v_xor_b32 v13, 0x2040, v12
    v_add_u32 v13, 0x10000, v13
    ds_read_b64_tr_b16 v[232:233], v13
    ds_read_b64_tr_b16 v[234:235], v13 offset:512
    ds_read_b64_tr_b16 v[236:237], v13 offset:2048
    ds_read_b64_tr_b16 v[238:239], v13 offset:2560
    s_waitcnt lgkmcnt(0)
    s_barrier
    s_add_u32 s43, s41, 0x280000
    s_add_u32 m0, s51, 0xc000
    s_nop 0
    buffer_load_dwordx4 v15, s[12:15], s43 offen lds
    s_add_u32 s43, s41, 0x288000
    s_add_u32 m0, s51, 0xd000
    s_nop 0
    buffer_load_dwordx4 v15, s[12:15], s43 offen lds
    s_add_u32 s43, s41, 0x380000
    s_add_u32 m0, s51, 0xe000
    s_nop 0
    buffer_load_dwordx4 v15, s[12:15], s43 offen lds
    s_add_u32 s43, s41, 0x388000
    s_add_u32 m0, s51, 0xf000
    s_nop 0
    buffer_load_dwordx4 v15, s[12:15], s43 offen lds
    v_xor_b32 v15, 2, v14
    v_lshl_add_u32 v15, v15, 15, v8
    s_add_u32 s43, s41, 0x80000
    s_add_u32 m0, s51, 0x10000
    s_nop 0
    buffer_load_dwordx4 v15, s[12:15], s43 offen lds
    s_add_u32 s43, s41, 0x88000
    s_add_u32 m0, s51, 0x11000
    s_nop 0
    buffer_load_dwordx4 v15, s[12:15], s43 offen lds
    s_add_u32 s43, s41, 0x180000
    s_add_u32 m0, s51, 0x12000
    s_nop 0
    buffer_load_dwordx4 v15, s[12:15], s43 offen lds
    s_add_u32 s43, s41, 0x188000
    s_add_u32 m0, s51, 0x13000
    s_nop 0
    buffer_load_dwordx4 v15, s[12:15], s43 offen lds
    s_waitcnt vmcnt(12)
    s_barrier
    v_xor_b32 v13, 0x0, v12
    v_add_u32 v13, 0x18000, v13
    ds_read_b64_tr_b16 v[208:209], v13
    ds_read_b64_tr_b16 v[210:211], v13 offset:512
    ds_read_b64_tr_b16 v[212:213], v13 offset:2048
    ds_read_b64_tr_b16 v[214:215], v13 offset:2560
    v_xor_b32 v13, 0x2000, v12
    v_add_u32 v13, 0x18000, v13
    ds_read_b64_tr_b16 v[216:217], v13
    ds_read_b64_tr_b16 v[218:219], v13 offset:512
    ds_read_b64_tr_b16 v[220:221], v13 offset:2048
    ds_read_b64_tr_b16 v[222:223], v13 offset:2560
    v_xor_b32 v13, 0x40, v12
    v_add_u32 v13, 0x18000, v13
    ds_read_b64_tr_b16 v[240:241], v13
    ds_read_b64_tr_b16 v[242:243], v13 offset:512
    ds_read_b64_tr_b16 v[244:245], v13 offset:2048
    ds_read_b64_tr_b16 v[246:247], v13 offset:2560
    v_xor_b32 v13, 0x2040, v12
    v_add_u32 v13, 0x18000, v13
    ds_read_b64_tr_b16 v[248:249], v13
    ds_read_b64_tr_b16 v[250:251], v13 offset:512
    ds_read_b64_tr_b16 v[252:253], v13 offset:2048
    ds_read_b64_tr_b16 v[254:255], v13 offset:2560
    s_waitcnt lgkmcnt(0)
    s_barrier
    s_add_u32 s43, s41, 0x280000
    s_add_u32 m0, s51, 0x14000
    s_nop 0
    buffer_load_dwordx4 v15, s[12:15], s43 offen lds
    s_add_u32 s43, s41, 0x288000
    s_add_u32 m0, s51, 0x15000
    s_nop 0
    buffer_load_dwordx4 v15, s[12:15], s43 offen lds
    s_add_u32 s43, s41, 0x380000
    s_add_u32 m0, s51, 0x16000
    s_nop 0
    buffer_load_dwordx4 v15, s[12:15], s43 offen lds
    s_add_u32 s43, s41, 0x388000
    s_add_u32 m0, s51, 0x17000
    s_nop 0
    buffer_load_dwordx4 v15, s[12:15], s43 offen lds
    ds_write_b128 v124, v[192:195]
    ds_write_b128 v124, v[196:199] offset:1024
    ds_write_b128 v124, v[200:203] offset:2048
    ds_write_b128 v124, v[204:207] offset:3072
    ds_write_b128 v124, v[208:211] offset:4096
    ds_write_b128 v124, v[212:215] offset:5120
    ds_write_b128 v124, v[216:219] offset:6144
    ds_write_b128 v124, v[220:223] offset:7168
    ds_write_b128 v124, v[224:227] offset:32768
    ds_write_b128 v124, v[228:231] offset:33792
    ds_write_b128 v124, v[232:235] offset:34816
    ds_write_b128 v124, v[236:239] offset:35840
    ds_write_b128 v124, v[240:243] offset:36864
    ds_write_b128 v124, v[244:247] offset:37888
    ds_write_b128 v124, v[248:251] offset:38912
    ds_write_b128 v124, v[252:255] offset:39936
    s_waitcnt vmcnt(8)
    s_barrier
    v_xor_b32 v13, 0x0, v11
    v_add_u32 v13, 0x0, v13
    ds_read_b64_tr_b16 a[208:209], v13
    ds_read_b64_tr_b16 a[210:211], v13 offset:1024
    ds_read_b64_tr_b16 a[212:213], v13 offset:16384
    ds_read_b64_tr_b16 a[214:215], v13 offset:17408
    v_xor_b32 v13, 0x20, v11
    v_add_u32 v13, 0x0, v13
    ds_read_b64_tr_b16 a[216:217], v13
    ds_read_b64_tr_b16 a[218:219], v13 offset:1024
    ds_read_b64_tr_b16 a[220:221], v13 offset:16384
    ds_read_b64_tr_b16 a[222:223], v13 offset:17408
    v_xor_b32 v13, 0x1000, v11
    v_add_u32 v13, 0x0, v13
    ds_read_b64_tr_b16 a[240:241], v13
    ds_read_b64_tr_b16 a[242:243], v13 offset:1024
    ds_read_b64_tr_b16 a[244:245], v13 offset:16384
    ds_read_b64_tr_b16 a[246:247], v13 offset:17408
    v_xor_b32 v13, 0x1020, v11
    v_add_u32 v13, 0x0, v13
    ds_read_b64_tr_b16 a[248:249], v13
    ds_read_b64_tr_b16 a[250:251], v13 offset:1024
    ds_read_b64_tr_b16 a[252:253], v13 offset:16384
    ds_read_b64_tr_b16 a[254:255], v13 offset:17408
    s_waitcnt lgkmcnt(0)
    s_barrier
    s_mov_b32 s43, 0x10000
    buffer_load_dword v30, v7, s[8:11], s43 offen sc1
    s_cmp_lg_u32 s20, 28
    s_cbranch_scc1 L_nocc_5
    v_lshlrev_b32 v25, 2, v117
    s_lshl_b32 s43, s21, 12
    s_getpc_b64 s[4:5]
L_pc_6:
    s_add_u32 s4, s4, L_nocc_5-L_pc_6
    s_addc_u32 s5, s5, 0
    v_add_u32 v25, s43, v25
    v_min_u32 v25, L_code_end-L_nocc_5-4, v25
    global_load_dword v29, v25, s[4:5]
L_nocc_5:
L_chain_warm:
    s_mov_b32 s12, s66
    s_and_b32 s13, s67, 0xffff
    s_add_u32 s43, s42, 0x0
    s_add_u32 m0, s51, 0x8000
    s_nop 0
    buffer_load_dwordx4 v10, s[12:15], s43 offen lds
    s_add_u32 s43, s42, 0x4000
    s_add_u32 m0, s51, 0x9000
    s_nop 0
    buffer_load_dwordx4 v9, s[12:15], s43 offen lds
    s_add_u32 s43, s42, 0x8000
    s_add_u32 m0, s51, 0xa000
    s_nop 0
    buffer_load_dwordx4 v10, s[12:15], s43 offen lds
    s_add_u32 s43, s42, 0xc000
    s_add_u32 m0, s51, 0xb000
    s_nop 0
    buffer_load_dwordx4 v9, s[12:15], s43 offen lds
    s_add_u32 s43, s42, 0x10200
    s_add_u32 m0, s51, 0xc000
    s_nop 0
    buffer_load_dwordx4 v10, s[12:15], s43 offen lds
    s_add_u32 s43, s42, 0x14200
    s_add_u32 m0, s51, 0xd000
    s_nop 0
    buffer_load_dwordx4 v9, s[12:15], s43 offen lds
    s_add_u32 s43, s42, 0x18200
    s_add_u32 m0, s51, 0xe000
    s_nop 0
    buffer_load_dwordx4 v10, s[12:15], s43 offen lds
    s_add_u32 s43, s42, 0x1c200
    s_add_u32 m0, s51, 0xf000
    s_nop 0
    buffer_load_dwordx4 v9, s[12:15], s43 offen lds
    s_waitcnt vmcnt(9)
    s_barrier
    v_xor_b32 v13, 0x0, v11
    v_add_u32 v13, 0x8000, v13
    ds_read_b64_tr_b16 v[144:145], v13
    ds_read_b64_tr_b16 v[146:147], v13 offset:1024
    ds_read_b64_tr_b16 v[148:149], v13 offset:16384
    ds_read_b64_tr_b16 v[150:151], v13 offset:17408
    v_xor_b32 v13, 0x20, v11
    v_add_u32 v13, 0x8000, v13
    ds_read_b64_tr_b16 v[152:153], v13
    ds_read_b64_tr_b16 v[154:155], v13 offset:1024
    ds_read_b64_tr_b16 v[156:157], v13 offset:16384
    ds_read_b64_tr_b16 v[158:159], v13 offset:17408
    v_xor_b32 v13, 0x1000, v11
    v_add_u32 v13, 0x8000, v13
    ds_read_b64_tr_b16 v[176:177], v13
    ds_read_b64_tr_b16 v[178:179], v13 offset:1024
    ds_read_b64_tr_b16 v[180:181], v13 offset:16384
    ds_read_b64_tr_b16 v[182:183], v13 offset:17408
    v_xor_b32 v13, 0x1020, v11
    v_add_u32 v13, 0x8000, v13
    ds_read_b64_tr_b16 v[184:185], v13
    ds_read_b64_tr_b16 v[186:187], v13 offset:1024
    ds_read_b64_tr_b16 v[188:189], v13 offset:16384
    ds_read_b64_tr_b16 v[190:191], v13 offset:17408
    s_waitcnt lgkmcnt(0)
    s_barrier
    s_add_u32 s43, s42, 0x10000
    s_add_u32 m0, s51, 0x10000
    s_nop 0
    buffer_load_dwordx4 v10, s[12:15], s43 offen lds
    s_add_u32 s43, s42, 0x14000
    s_add_u32 m0, s51, 0x11000
    s_nop 0
    buffer_load_dwordx4 v9, s[12:15], s43 offen lds
    s_add_u32 s43, s42, 0x18000
    s_add_u32 m0, s51, 0x12000
    s_nop 0
    buffer_load_dwordx4 v10, s[12:15], s43 offen lds
    s_add_u32 s43, s42, 0x1c000
    s_add_u32 m0, s51, 0x13000
    s_nop 0
    buffer_load_dwordx4 v9, s[12:15], s43 offen lds
    s_add_u32 s43, s42, 0x200
    s_add_u32 m0, s51, 0x14000
    s_nop 0
    buffer_load_dwordx4 v10, s[12:15], s43 offen lds
    s_add_u32 s43, s42, 0x4200
    s_add_u32 m0, s51, 0x15000
    s_nop 0
    buffer_load_dwordx4 v9, s[12:15], s43 offen lds
    s_add_u32 s43, s42, 0x8200
    s_add_u32 m0, s51, 0x16000
    s_nop 0
    buffer_load_dwordx4 v10, s[12:15], s43 offen lds
    s_add_u32 s43, s42, 0xc200
    s_add_u32 m0, s51, 0x17000
    s_nop 0
    buffer_load_dwordx4 v9, s[12:15], s43 offen lds
    v_lshlrev_b32 v26, 3, v117
    v_and_b32 v26, 2048, v26
    s_lshl_b32 s43, s20, 6
    s_add_u32 s43, s43, 0x2000
    buffer_load_dword v26, v26, s[8:11], s43 offen sc1
    buffer_load_dword v27, off, s[16:19], 0 offset:4 sc1
    s_waitcnt vmcnt(10)
    v_min_u32 v21, 0xfffffffe, v21
    s_mov_b32 s43, 0x10000
    s_mov_b64 exec, s[38:39]
    buffer_store_dword v21, v119, s[8:11], s43 offen
    s_mov_b64 exec, -1
    v_mov_b32 v16, -1
    v_mov_b32 v17, -1
    v_mov_b32 v18, -1
    v_mov_b32 v19, -1
    s_lshl_b32 s43, s20, 13
    s_add_u32 s43, s43, 0x100000
    s_and_b32 s40, s21, 1
    s_lshl_b32 s40, s40, 12
    s_add_u32 s29, s43, s40
    s_add_u32 s43, s43, s52
    s_xor_b32 s40, s43, 0x0
    s_mov_b32 s43, 0x12000
    buffer_store_dword v16, v119, s[8:11], s43 offen
    s_mov_b32 s43, 0x14000
    buffer_store_dword v16, v119, s[8:11], s43 offen
    s_mov_b32 s43, 0x16000
    buffer_store_dword v16, v119, s[8:11], s43 offen
    s_barrier
    v_xor_b32 v13, 0x0, v12
    v_add_u32 v13, 0x0, v13
    ds_read_b64_tr_b16 v[192:193], v13
    ds_read_b64_tr_b16 v[194:195], v13 offset:512
    ds_read_b64_tr_b16 v[196:197], v13 offset:2048
    ds_read_b64_tr_b16 v[198:199], v13 offset:2560
    v_xor_b32 v13, 0x2000, v12
    v_add_u32 v13, 0x0, v13
    ds_read_b64_tr_b16 v[200:201], v13
    ds_read_b64_tr_b16 v[202:203], v13 offset:512
    ds_read_b64_tr_b16 v[204:205], v13 offset:2048
    ds_read_b64_tr_b16 v[206:207], v13 offset:2560
    v_xor_b32 v13, 0x40, v12
    v_add_u32 v13, 0x0, v13
    ds_read_b64_tr_b16 v[224:225], v13
    ds_read_b64_tr_b16 v[226:227], v13 offset:512
    ds_read_b64_tr_b16 v[228:229], v13 offset:2048
    ds_read_b64_tr_b16 v[230:231], v13 offset:2560
    v_xor_b32 v13, 0x2040, v12
    v_add_u32 v13, 0x0, v13
    ds_read_b64_tr_b16 v[232:233], v13
    ds_read_b64_tr_b16 v[234:235], v13 offset:512
    ds_read_b64_tr_b16 v[236:237], v13 offset:2048
    ds_read_b64_tr_b16 v[238:239], v13 offset:2560
    s_lshr_b32 s43, s20, 1
    s_lshl_b32 s43, s43, 7
    s_and_b32 s40, s20, 1
    s_lshl_b32 s40, s40, 4
    s_add_u32 s43, s43, s40
    s_add_u32 s44, s43, 0x1000
    s_cmp_eq_u32 s21, 0
    s_cselect_b32 s44, s44, 0x7ff00000
    s_mov_b32 s22, 0
    s_mov_b32 s33, 0
    s_xor_b32 s53, s29, 1024
    s_add_u32 s23, s51, 0x10000
    s_add_u32 s48, s23, 4096
    s_mov_b32 s24, 0x12000
    s_add_u32 s55, s24, 16384
    s_mov_b32 s25, 0x100000
    s_mov_b32 s26, 0x101000
    v_mov_b32 v112, 0
    v_mov_b32 v113, 0
    v_mov_b32 v114, 0
    v_mov_b32 v115, 0
    ds_write_b128 v117, v[112:115] offset:22528
    ds_write_b128 v117, v[112:115] offset:23552
    s_cmp_lg_u32 s21, 0
    s_cselect_b32 s40, -1, 0
    v_mov_b32 v126, s40
    v_bfe_u32 v1, v117, 4, 1
    v_lshlrev_b32 v1, 4, v1
    s_movk_i32 s43, 0x3f80
    v_lshlrev_b32 v125, v1, s43
    v_bfe_u32 v1, v117, 5, 3
    v_cmp_eq_u32 s[68:69], 0, v1
    v_cmp_eq_u32 s[70:71], 1, v1
    v_cmp_eq_u32 s[72:73], 2, v1
    v_cmp_eq_u32 s[74:75], 3, v1
    v_mov_b32 v40, 0
    v_mov_b32 v41, 0
    v_mov_b32 v42, 0
    v_mov_b32 v43, 0
    v_mov_b32 v44, 0
    v_mov_b32 v45, 0
    v_mov_b32 v46, 0
    v_mov_b32 v47, 0
    v_mov_b32 v48, 0
    v_mov_b32 v49, 0
    v_mov_b32 v50, 0
    v_mov_b32 v51, 0
    v_mov_b32 v52, 0
    v_mov_b32 v53, 0
    v_mov_b32 v54, 0
    v_mov_b32 v55, 0
    s_mov_b32 s45, 0
    s_mov_b32 s46, 0
    s_mov_b32 s47, 0
    s_mov_b32 s76, 0
    s_and_b32 s43, s21, 1
    s_lshl_b32 s43, s43, 5
    s_add_u32 s43, s43, s20
    s_lshl_b32 s43, s43, 6
    s_add_u32 s28, s43, 0x2000
    s_mov_b32 s59, 0
    s_waitcnt vmcnt(4) lgkmcnt(0)
    v_readlane_b32 s43, v26, 0
    v_readlane_b32 s40, v26, 16
    s_nop 0
    s_min_u32 s43, s43, s40
    s_cmp_lg_u32 s43, 0
    s_cselect_b32 s57, s57, 0
    v_readfirstlane_b32 s43, v27
    s_nop 0
    s_cmp_ge_u32 s43, 32
    s_cselect_b32 s57, s57, 0
    s_cmp_lg_u32 s57, 1
    s_cbranch_scc1 L_nokv_7
    s_add_u32 m0, s52, 8192
    s_nop 0
    buffer_load_dwordx4 v117, s[8:11], s30 offen lds
    buffer_load_dwordx4 v117, s[8:11], s30 offen offset:1024 lds
    s_add_u32 m0, s52, 0x6000
    s_nop 0
    buffer_load_dwordx4 v117, s[8:11], s31 offen lds
    buffer_load_dwordx4 v117, s[8:11], s31 offen offset:1024 lds
L_nokv_7:
    s_barrier
    v_xor_b32 v13, 0x0, v12
    v_add_u32 v13, 0x8000, v13
    ds_read_b64_tr_b16 v[208:209], v13
    ds_read_b64_tr_b16 v[210:211], v13 offset:512
    ds_read_b64_tr_b16 v[212:213], v13 offset:2048
    ds_read_b64_tr_b16 v[214:215], v13 offset:2560
    v_xor_b32 v13, 0x2000, v12
    v_add_u32 v13, 0x8000, v13
    ds_read_b64_tr_b16 v[216:217], v13
    ds_read_b64_tr_b16 v[218:219], v13 offset:512
    ds_read_b64_tr_b16 v[220:221], v13 offset:2048
    ds_read_b64_tr_b16 v[222:223], v13 offset:2560
    v_xor_b32 v13, 0x40, v12
    v_add_u32 v13, 0x8000, v13
    ds_read_b64_tr_b16 v[240:241], v13
    ds_read_b64_tr_b16 v[242:243], v13 offset:512
    ds_read_b64_tr_b16 v[244:245], v13 offset:2048
    ds_read_b64_tr_b16 v[246:247], v13 offset:2560
    v_xor_b32 v13, 0x2040, v12
    v_add_u32 v13, 0x8000, v13
    ds_read_b64_tr_b16 v[248:249], v13
    ds_read_b64_tr_b16 v[250:251], v13 offset:512
    ds_read_b64_tr_b16 v[252:253], v13 offset:2048
    ds_read_b64_tr_b16 v[254:255], v13 offset:2560
    ds_write_b128 v123, v[80:83]
    ds_write_b128 v123, v[84:87] offset:1024
    ds_write_b128 v123, v[56:59] offset:2048
    ds_write_b128 v123, v[60:63] offset:3072
    ds_write_b128 v123, v[88:91] offset:4096
    ds_write_b128 v123, v[92:95] offset:5120
    ds_write_b128 v123, v[96:99] offset:6144
    ds_write_b128 v123, v[100:103] offset:7168
    s_cmp_eq_u32 s57, 1
    s_cbranch_scc1 L_started_8
    s_mov_b32 s96, 0
L_mode_9:
    buffer_load_dwordx2 v[2:3], off, s[92:95], 0 offset:36 sc1
    s_waitcnt vmcnt(0)
    v_readfirstlane_b32 s87, v2
    v_readfirstlane_b32 s97, v3
    s_nop 0
    s_min_u32 s97, s97, s87
    s_cmp_lg_u32 s97, 0
    s_cbranch_scc1 L_moded_10
    s_sleep 4
    s_add_u32 s96, s96, 1
    s_cmp_lg_u32 s96, 0x100
    s_cbranch_scc1 L_modef_11
    v_mov_b32 v2, 2
    v_mov_b32 v3, 0
    s_mov_b64 exec, 1
    buffer_atomic_cmpswap v[2:3], off, s[92:95], 0 offset:36
    s_mov_b64 exec, -1
L_modef_11:
    s_cmp_lt_u32 s96, 0x10000
    s_cbranch_scc1 L_mode_9
L_moded_10:
    s_cmp_lg_u32 s87, 1
    s_cbranch_scc1 L_fallback
    v_lshrrev_b32 v1, 4, v117
    v_and_b32 v2, 15, v1
    v_lshrrev_b32 v1, 4, v1
    v_lshlrev_b32 v1, 11, v1
    v_lshl_add_u32 v1, v2, 2, v1
    s_lshl_b32 s43, s20, 6
    s_add_u32 s43, s43, 0x2000
    s_mov_b32 exec_lo, 0x10001
    s_mov_b32 exec_hi, 0
    s_mov_b32 s96, 0
L_poll_12:
    buffer_load_dword v2, v1, s[8:11], s43 offen sc1
    s_waitcnt vmcnt(0)
    v_cmp_gt_u32 vcc, 1, v2
    s_cbranch_vccz L_polld_13
    s_sleep 8
    s_add_u32 s96, s96, 1
    s_cmp_lt_u32 s96, 0x10000
    s_cbranch_scc1 L_poll_12
L_polld_13:
    s_mov_b64 exec, -1
    s_add_u32 m0, s52, 8192
    s_nop 0
    buffer_load_dwordx4 v117, s[8:11], s30 offen lds
    buffer_load_dwordx4 v117, s[8:11], s30 offen offset:1024 lds
    s_add_u32 m0, s52, 0x6000
    s_nop 0
    buffer_load_dwordx4 v117, s[8:11], s31 offen lds
    buffer_load_dwordx4 v117, s[8:11], s31 offen offset:1024 lds
    s_mov_b32 s49, 0
L_cb_poll_15:
    buffer_load_dword v3, off, s[16:19], 0 offset:4 sc1
    s_waitcnt vmcnt(0)
    v_readfirstlane_b32 s43, v3
    s_nop 0
    s_cmp_ge_u32 s43, 32
    s_cbranch_scc1 L_started_8
    s_sleep 8
    s_add_u32 s49, s49, 1
    s_cmp_lt_u32 s49, 0x40000
    s_cbranch_scc1 L_cb_poll_15
L_started_8:
    v_lshrrev_b32 v1, 2, v117
    s_cmp_lt_u32 s21, 2
    s_cselect_b64 vcc, -1, 0
    v_cndmask_b32 v119, v119, v1, vcc
    s_add_u32 m0, s51, 4096
    v_mov_b32 v24, v32
    v_mov_b32 v25, v33
    v_mov_b32 v26, v34
    v_mov_b32 v27, v35
    v_mov_b32 v28, v36
    v_mov_b32 v29, v37
    v_mov_b32 v30, v38
    v_mov_b32 v31, v39
    s_add_u32 s30, s30, 0x40000
    s_add_u32 s31, s31, 0x40000
    s_mov_b32 s49, 0
    s_waitcnt vmcnt(0) lgkmcnt(0)
    s_barrier
    ds_write_b128 v123, v[64:67] offset:32768
    ds_write_b128 v123, v[68:71] offset:33792
    ds_write_b128 v123, v[72:75] offset:34816
    ds_write_b128 v123, v[76:79] offset:35840
    ds_write_b128 v123, v[104:107] offset:36864
    ds_write_b128 v123, v[108:111] offset:37888
    ds_write_b128 v123, v[32:35] offset:38912
    ds_write_b128 v123, v[36:39] offset:39936
    v_mov_b32 v32, 0
    v_mov_b32 v33, 0
    v_mov_b32 v34, 0
    v_mov_b32 v35, 0
    v_mov_b32 v36, 0
    v_mov_b32 v37, 0
    v_mov_b32 v38, 0
    v_mov_b32 v39, 0
    s_nop 4
    s_cmp_eq_u32 s21, 1
    s_cbranch_scc1 L_chain_top1_f
    s_cmp_eq_u32 s21, 2
    s_cbranch_scc1 L_chain_top2_f
    s_cmp_eq_u32 s21, 3
    s_cbranch_scc1 L_chain_top3_f
.p2align 6
L_chain_top0_f:
    buffer_load_dwordx4 v[0:3], v117, s[8:11], s23 offen nt
    v_mov_b32 v15, 0
    v_mov_b32 v15, 0
    v_mov_b32 v15, 0
    v_mov_b32 v15, 0
    v_mov_b32 v15, 0
    v_mov_b32 v15, 0
    v_mov_b32 v15, 0
    v_mov_b32 v15, 0
    v_mov_b32 v15, 0
    v_mov_b32 v15, 0
    v_mov_b32 v15, 0
    v_mov_b32 v15, 0
    v_mov_b32 v15, 0
    v_mov_b32 v15, 0
    v_mov_b32 v15, 0
    v_mov_b32 v15, 0
    buffer_load_dwordx4 v[0:3], v117, s[8:11], s23 offen sc1
    v_mov_b32 v15, 0
    v_mov_b32 v15, 0
    v_mov_b32 v15, 0
    v_mov_b32 v15, 0
    v_mov_b32 v15, 0
    v_mov_b32 v15, 0
    v_mov_b32 v15, 0
    v_mov_b32 v15, 0
    v_mov_b32 v15, 0
    v_mov_b32 v15, 0
    v_mov_b32 v15, 0
    v_mov_b32 v15, 0
    v_mov_b32 v15, 0
    v_mov_b32 v15, 0
    v_mov_b32 v15, 0
    v_mov_b32 v15, 0
L_mret_17:
    buffer_load_dwordx4 v[0:3], v117, s[8:11], s23 offen sc1
    s_add_u32 s45, s45, 1
    s_cmp_lt_u32 s45, 0x10000
    s_cselect_b32 s56, -2, -1
    s_nop 3
    v_mov_b32 v32, 0
    v_mov_b32 v33, 0
    v_mov_b32 v34, 0
    v_mov_b32 v35, 0
    s_waitcnt vmcnt(2)
    v_max3_u32 v15, v0, v1, v2
    v_max_u32 v15, v15, v3
    v_cmp_lt_u32 vcc, s56, v15
    v_smfmac_f32_16x16x64_bf16 v[32:35], v[0:3], v[80:87], v116
    s_cbranch_vccnz L_mret_17
    ds_write_b128 v117, v[0:3]
    v_smfmac_f32_16x16x64_bf16 v[36:39], v[0:3], v[56:63], v116
    buffer_load_dwordx4 v[4:7], v117, s[8:11], s48 offen nt
    v_smfmac_f32_16x16x64_bf16 v[40:43], v[0:3], v[64:71], v116
    buffer_load_dwordx4 v117, s[8:11], s48 offen nt lds
    s_mov_b32 m0, 8192
    v_smfmac_f32_16x16x64_bf16 v[44:47], v[0:3], v[72:79], v116
    s_waitcnt lgkmcnt(0)
    s_barrier
    ds_read_b128 v[8:11], v117 offset:1024
    v_smfmac_f32_16x16x64_bf16 v[48:51], v[0:3], a[192:199], v116
    ds_read_b128 v[16:19], v117 offset:2048
    ds_read_b128 v[20:23], v117 offset:3072
    v_smfmac_f32_16x16x64_bf16 v[52:55], v[0:3], a[200:207], v116
    ds_read_b128 v[80:83], v117 offset:14336
    s_waitcnt lgkmcnt(3)
    v_smfmac_f32_16x16x64_bf16 v[32:35], v[8:11], a[0:7], v116
    ds_read_b128 v[84:87], v117 offset:15360
    v_smfmac_f32_16x16x64_bf16 v[36:39], v[8:11], a[8:15], v116
    buffer_store_dwordx4 v[112:115], v117, s[8:11], s32 offen sc1
    s_waitcnt lgkmcnt(3)
    v_smfmac_f32_16x16x64_bf16 v[32:35], v[16:19], a[32:39], v116
    ds_read_b128 v[56:59], v117 offset:8192
    v_smfmac_f32_16x16x64_bf16 v[36:39], v[16:19], a[40:47], v116
    ds_read_b128 v[60:63], v117 offset:9216
    s_waitcnt lgkmcnt(4)
    v_smfmac_f32_16x16x64_bf16 v[32:35], v[20:23], a[64:71], v116
    ds_read_b128 v[64:67], v117 offset:10240
    v_smfmac_f32_16x16x64_bf16 v[36:39], v[20:23], a[72:79], v116
    ds_read_b128 v[68:71], v117 offset:11264
    v_smfmac_f32_16x16x64_bf16 v[40:43], v[8:11], a[96:103], v116
    ds_read_b128 v[72:75], v117 offset:12288
    v_smfmac_f32_16x16x64_bf16 v[40:43], v[16:19], a[128:135], v116
    ds_read_b128 v[76:79], v117 offset:13312
    v_smfmac_f32_16x16x64_bf16 v[40:43], v[20:23], a[160:167], v116
    s_waitcnt vmcnt(2)
    v_max3_u32 v15, v4, v5, v6
    v_smfmac_f32_16x16x64_bf16 v[44:47], v[8:11], a[104:111], v116
    v_max_u32 v15, v15, v7
    v_smfmac_f32_16x16x64_bf16 v[44:47], v[16:19], a[136:143], v116
    s_waitcnt vmcnt(1) lgkmcnt(0)
    v_cmp_lt_u32 vcc, s56, v15
    v_smfmac_f32_16x16x64_bf16 v[44:47], v[20:23], a[168:175], v116
    s_cbranch_vccnz L_mret_18
L_mgo_19:
    v_smfmac_f32_16x16x64_bf16 v[44:47], v[4:7], v[24:31], v116
    s_barrier
    ds_read_b128 v[12:15], v117 offset:5120
    v_smfmac_f32_16x16x64_bf16 v[32:35], v[4:7], v[88:95], v116
    ds_read_b128 v[24:27], v117 offset:6144
    v_smfmac_f32_16x16x64_bf16 v[36:39], v[4:7], v[96:103], v116
    ds_read_b128 v[28:31], v117 offset:7168
    v_smfmac_f32_16x16x64_bf16 v[40:43], v[4:7], v[104:111], v116
    ds_read_b128 v[88:91], v117 offset:24576
    s_waitcnt lgkmcnt(3)
    v_smfmac_f32_16x16x64_bf16 v[32:35], v[12:15], a[16:23], v116
    ds_read_b128 v[92:95], v117 offset:25600
    s_waitcnt lgkmcnt(3)
    v_smfmac_f32_16x16x64_bf16 v[32:35], v[24:27], a[48:55], v116
    buffer_load_dwordx4 v117, s[8:11], s30 offen lds
    s_waitcnt lgkmcnt(2)
    v_smfmac_f32_16x16x64_bf16 v[32:35], v[28:31], a[80:87], v116
    ds_read_b128 v[96:99], v117 offset:23552
    v_smfmac_f32_16x16x64_bf16 v[36:39], v[12:15], a[24:31], v116
    ds_read_b128 v[100:103], v117 offset:23552
    v_smfmac_f32_16x16x64_bf16 v[36:39], v[24:27], a[56:63], v116
    buffer_load_dwordx4 v117, s[8:11], s30 offen offset:1024 lds
    s_add_u32 m0, s52, 0x6000
    v_add_f32 v32, v32, v34
    v_smfmac_f32_16x16x64_bf16 v[36:39], v[28:31], a[88:95], v116
    ds_read_b128 v[104:107], v117 offset:23552
    v_add_f32 v33, v33, v35
    v_smfmac_f32_16x16x64_bf16 v[40:43], v[12:15], a[112:119], v116
    ds_read_b128 v[108:111], v117 offset:23552
    v_mul_f32 v32, s34, v32
    v_smfmac_f32_16x16x64_bf16 v[40:43], v[24:27], a[144:151], v116
    buffer_load_dword v125, v119, s[8:11], s28 offen sc1
    v_mul_f32 v33, s34, v33
    v_smfmac_f32_16x16x64_bf16 v[40:43], v[28:31], a[176:183], v116
    ds_read_b128 v[0:3], v124
    v_add_f32 v36, v36, v38
    v_smfmac_f32_16x16x64_bf16 v[48:51], v[4:7], a[208:215], v116
    v_add_f32 v37, v37, v39
    v_smfmac_f32_16x16x64_bf16 v[52:55], v[4:7], a[216:223], v116
    s_waitcnt lgkmcnt(5)
    buffer_load_dwordx4 v117, s[8:11], s31 offen lds
    v_mul_f32 v36, s34, v36
    v_smfmac_f32_16x16x64_bf16 v[44:47], v[12:15], a[120:127], v116
    ds_read_b128 v[4:7], v124 offset:1024
    v_mul_f32 v37, s34, v37
    v_smfmac_f32_16x16x64_bf16 v[44:47], v[24:27], a[152:159], v116
    v_cvt_pk_bf16_f32 v34, v32, v36
    v_smfmac_f32_16x16x64_bf16 v[44:47], v[28:31], a[184:191], v116
    buffer_load_dwordx4 v117, s[8:11], s31 offen offset:1024 lds
    s_mov_b32 m0, 4096
    v_cvt_pk_bf16_f32 v35, v33, v37
    v_add_f32 v40, v40, v42
    v_smfmac_f32_16x16x64_bf16 v[48:51], v[8:11], a[224:231], v116
    ds_write2_b32 v120, v34, v35 offset0:32 offset1:48
    v_add_f32 v41, v41, v43
    v_smfmac_f32_16x16x64_bf16 v[52:55], v[8:11], a[232:239], v116
    v_add_f32 v44, v44, v46
    v_add_f32 v45, v45, v47
    v_cvt_pk_bf16_f32 v113, v40, v44
    v_cvt_pk_bf16_f32 v115, v41, v45
    v_smfmac_f32_16x16x64_bf16 v[48:51], v[12:15], a[240:247], v116
    ds_write2_b32 v120, v113, v115 offset0:0 offset1:16
    v_smfmac_f32_16x16x64_bf16 v[52:55], v[12:15], a[248:255], v116
    s_cmp_eq_u32 s22, 63
    s_cbranch_scc1 L_chain_last_f
    buffer_store_dword v126, off, s[8:11], s44 sc1
    v_smfmac_f32_16x16x64_bf16 v[48:51], v[16:19], v[128:135], v116
    v_smfmac_f32_16x16x64_bf16 v[48:51], v[20:23], v[160:167], v116
    v_smfmac_f32_16x16x64_bf16 v[48:51], v[24:27], v[144:151], v116
    s_waitcnt lgkmcnt(0)
    s_barrier
    v_smfmac_f32_16x16x64_bf16 v[48:51], v[28:31], v[176:183], v116
    ds_read_b128 v[32:35], v121 offset:16384
    ds_read_b128 v[36:39], v121 offset:17408
    v_smfmac_f32_16x16x64_bf16 v[52:55], v[16:19], v[136:143], v116
    ds_read_b128 v[40:43], v121 offset:18432
    ds_read_b128 v[44:47], v121 offset:19456
    v_smfmac_f32_16x16x64_bf16 v[52:55], v[20:23], v[168:175], v116
    ds_read_b128 v[8:11], v124 offset:32768
    v_add_f32 v48, v48, v50
    v_smfmac_f32_16x16x64_bf16 v[52:55], v[24:27], v[152:159], v116
    ds_read_b128 v[12:15], v124 offset:33792
    v_add_f32 v49, v49, v51
    v_smfmac_f32_16x16x64_bf16 v[52:55], v[28:31], v[184:191], v116
    s_waitcnt lgkmcnt(5)
    v_cvt_pk_bf16_f32 v112, v48, v49
    v_mfma_f32_16x16x32_bf16 v[56:59], v[56:59], v[32:35], 0
    s_waitcnt lgkmcnt(4)
    v_mov_b32 v48, s50
    v_mov_b32 v49, s50
    v_mfma_f32_16x16x32_bf16 v[56:59], v[60:63], v[36:39], v[56:59]
    ds_read_b128 v[16:19], v124 offset:2048
    s_waitcnt lgkmcnt(4)
    v_mov_b32 v50, s50
    v_mov_b32 v51, s50
    v_mfma_f32_16x16x32_bf16 v[56:59], v[64:67], v[40:43], v[56:59]
    ds_read_b128 v[20:23], v124 offset:3072
    s_waitcnt lgkmcnt(4)
    v_add_f32 v52, v52, v54
    v_mfma_f32_16x16x32_bf16 v[56:59], v[68:71], v[44:47], v[56:59]
    ds_read_b128 v[24:27], v124 offset:4096
    v_add_f32 v53, v53, v55
    v_mfma_f32_16x16x32_bf16 v[60:63], v[72:75], v[32:35], 0
    ds_read_b128 v[28:31], v124 offset:5120
    v_cvt_pk_bf16_f32 v114, v52, v53
    v_mov_b32 v53, 0
    v_mfma_f32_16x16x32_bf16 v[60:63], v[76:79], v[36:39], v[60:63]
    v_exp_f32 v56, v56
    v_mfma_f32_16x16x32_bf16 v[60:63], v[80:83], v[40:43], v[60:63]
    v_exp_f32 v57, v57
    v_mfma_f32_16x16x32_bf16 v[60:63], v[84:87], v[44:47], v[60:63]
    v_exp_f32 v58, v58
    v_mfma_f32_16x16x32_bf16 v[64:67], v[32:35], v[32:35], 0
    v_exp_f32 v59, v59
    v_cvt_pk_bf16_f32 v68, v56, v57
    v_mfma_f32_16x16x32_bf16 v[64:67], v[36:39], v[36:39], v[64:67]
    v_exp_f32 v60, v60
    v_cvt_pk_bf16_f32 v69, v58, v59
    v_mfma_f32_16x16x32_bf16 v[64:67], v[40:43], v[40:43], v[64:67]
    v_exp_f32 v61, v61
    v_mfma_f32_16x16x32_bf16 v[64:67], v[44:47], v[44:47], v[64:67]
    v_exp_f32 v62, v62
    v_exp_f32 v63, v63
    v_cvt_pk_bf16_f32 v70, v60, v61
    v_cvt_pk_bf16_f32 v71, v62, v63
    s_nop 1
    v_mfma_f32_16x16x32_bf16 v[72:75], v[88:91], v[68:71], 0
    s_nop 0
    v_exp_f32 v64, v64
    v_mfma_f32_16x16x32_bf16 v[76:79], v[92:95], v[68:71], 0
    v_exp_f32 v65, v65
    v_mfma_f32_16x16x32_bf16 v[80:83], v[48:51], v[68:71], 0
    v_cvt_pk_bf16_f32 v52, v64, v65
    s_nop 1
    v_mfma_f32_16x16x16_bf16 v[72:75], v[112:113], v[52:53], v[72:75]
    ds_read_b128 v[32:35], v124 offset:6144
    v_mfma_f32_16x16x16_bf16 v[76:79], v[114:115], v[52:53], v[76:79]
    ds_read_b128 v[36:39], v124 offset:7168
    v_mfma_f32_16x16x16_bf16 v[80:83], v[48:49], v[52:53], v[80:83]
L_norm_20:
    s_mov_b64 vcc, s[36:37]
    v_mov_b32 v122, v122
    v_mov_b32 v122, v122
    v_mov_b32 v122, v122
    v_cndmask_b32_dpp v76, v72, v76, vcc quad_perm:[2,3,2,3] row_mask:0xf bank_mask:0xf
    v_cndmask_b32_dpp v77, v73, v77, vcc quad_perm:[2,3,2,3] row_mask:0xf bank_mask:0xf
    v_cndmask_b32_dpp v78, v74, v78, vcc quad_perm:[2,3,2,3] row_mask:0xf bank_mask:0xf
    v_cndmask_b32_dpp v79, v75, v79, vcc quad_perm:[2,3,2,3] row_mask:0xf bank_mask:0xf
    v_rcp_f32_dpp v84, v80 quad_perm:[2,3,2,3] row_mask:0xf bank_mask:0xf
    s_nop 0
    v_pk_mul_f32 v[76:77], v[76:77], v[84:85] op_sel_hi:[1,0]
    v_pk_mul_f32 v[78:79], v[78:79], v[84:85] op_sel_hi:[1,0]
    v_cvt_pk_bf16_f32 v72, v76, v77
    v_cvt_pk_bf16_f32 v73, v78, v79
    ds_write_b64 v122, v[72:73] offset:20480
    v_max_f32_dpp v86, v80, v84 quad_perm:[2,3,2,3] row_mask:0xf bank_mask:0xf
    v_mov_b32_dpp v60, v72 quad_perm:[0,1,0,1] row_mask:0xf bank_mask:0xf
    v_mov_b32_dpp v61, v73 quad_perm:[0,1,0,1] row_mask:0xf bank_mask:0xf
    v_cmp_lt_f32 vcc, s35, v86
    v_mov_b32_dpp v62, v72 quad_perm:[2,3,2,3] row_mask:0xf bank_mask:0xf
    v_mov_b32_dpp v63, v73 quad_perm:[2,3,2,3] row_mask:0xf bank_mask:0xf
    s_nop 1
    v_smfmac_f32_16x16x64_bf16 v[96:99], v[60:63], v[192:199], v116
    s_cbranch_vccnz L_smax_21
    v_smfmac_f32_16x16x64_bf16 v[100:103], v[60:63], v[224:231], v116
    s_waitcnt lgkmcnt(0)
    s_barrier
    ds_read_b128 v[92:95], v127 offset:20992
    ds_read_b128 v[80:83], v127 offset:21504
    ds_read_b128 v[84:87], v127 offset:22016
    v_smfmac_f32_16x16x64_bf16 v[104:107], v[60:63], v[0:7], v116
    ds_read_b128 v[40:43], v124 offset:34816
    v_smfmac_f32_16x16x64_bf16 v[108:111], v[60:63], v[8:15], v116
    ds_read_b128 v[56:59], v124 offset:36864
    s_waitcnt lgkmcnt(4)
    v_smfmac_f32_16x16x64_bf16 v[96:99], v[92:95], v[200:207], v116
    s_waitcnt lgkmcnt(3)
    v_smfmac_f32_16x16x64_bf16 v[96:99], v[80:83], v[208:215], v116
    ds_read_b128 v[44:47], v124 offset:35840
    s_waitcnt lgkmcnt(3)
    v_smfmac_f32_16x16x64_bf16 v[96:99], v[84:87], v[216:223], v116
    ds_read_b128 v[68:71], v124 offset:39936
    v_smfmac_f32_16x16x64_bf16 v[100:103], v[92:95], v[232:239], v116
    ds_read_b128 v[64:67], v124 offset:38912
    v_smfmac_f32_16x16x64_bf16 v[100:103], v[80:83], v[240:247], v116
    ds_read_b128 v[60:63], v124 offset:37888
    v_cvt_pk_bf16_f32 v72, v96, v98
    v_smfmac_f32_16x16x64_bf16 v[100:103], v[84:87], v[248:255], v116
    v_and_or_b32 v72, v72, -2, s33
    v_smfmac_f32_16x16x64_bf16 v[104:107], v[92:95], v[16:23], v116
    v_cvt_pk_bf16_f32 v74, v97, v99
    v_smfmac_f32_16x16x64_bf16 v[104:107], v[80:83], v[24:31], v116
    v_cvt_pk_bf16_f32 v73, v100, v102
    v_cvt_pk_bf16_f32 v75, v101, v103
    v_smfmac_f32_16x16x64_bf16 v[104:107], v[84:87], v[32:39], v116
    buffer_store_dwordx4 v[72:75], v118, s[8:11], s25 offen
    s_waitcnt lgkmcnt(3)
    v_smfmac_f32_16x16x64_bf16 v[108:111], v[92:95], v[40:47], v116
    s_waitcnt lgkmcnt(0)
    v_smfmac_f32_16x16x64_bf16 v[108:111], v[80:83], v[56:63], v116
    v_cvt_pk_bf16_f32 v76, v104, v106
    v_smfmac_f32_16x16x64_bf16 v[108:111], v[84:87], v[64:71], v116
    v_and_or_b32 v76, v76, -2, s33
    v_cvt_pk_bf16_f32 v78, v105, v107
    v_mov_b32 v122, v122
    v_mov_b32 v122, v122
    v_mov_b32 v122, v122
    v_mov_b32 v122, v122
    v_mov_b32 v122, v122
    v_mov_b32 v122, v122
    v_cvt_pk_bf16_f32 v77, v108, v110
    v_cvt_pk_bf16_f32 v79, v109, v111
    buffer_store_dwordx4 v[76:79], v118, s[8:11], s26 offen
    s_add_u32 s30, s30, 0x40000
    s_add_u32 s31, s31, 0x40000
    s_add_u32 s32, s32, 0x20000
    s_add_u32 s23, s24, 0
    s_add_u32 s48, s23, 4096
    s_xor_b32 s25, s25, 0x0
    s_xor_b32 s26, s26, 0x0
    s_mov_b32 s35, 0x49800000
    v_mov_b32 v126, s22
    s_add_u32 s22, s22, 1
    v_mov_b32 v32, 0
    v_mov_b32 v33, 0
    v_mov_b32 v34, 0
    v_mov_b32 v35, 0
    v_mov_b32 v36, 0
    v_mov_b32 v37, 0
    v_mov_b32 v38, 0
    v_mov_b32 v39, 0
    v_mov_b32 v40, 0
    v_mov_b32 v41, 0
    v_mov_b32 v42, 0
    v_mov_b32 v43, 0
    v_mov_b32 v44, 0
    v_mov_b32 v45, 0
    v_mov_b32 v46, 0
    v_mov_b32 v47, 0
    v_mov_b32 v48, 0
    v_mov_b32 v49, 0
    v_mov_b32 v50, 0
    v_mov_b32 v51, 0
    v_mov_b32 v52, 0
    v_mov_b32 v53, 0
    v_mov_b32 v54, 0
    v_mov_b32 v55, 0
    ds_read_b128 v[80:83], v123
    ds_read_b128 v[84:87], v123 offset:1024
    ds_read_b128 v[56:59], v123 offset:2048
    ds_read_b128 v[60:63], v123 offset:3072
    ds_read_b128 v[64:67], v123 offset:32768
    ds_read_b128 v[68:71], v123 offset:33792
    ds_read_b128 v[72:75], v123 offset:34816
    ds_read_b128 v[76:79], v123 offset:35840
    ds_read_b128 v[88:91], v123 offset:4096
    ds_read_b128 v[92:95], v123 offset:5120
    ds_read_b128 v[96:99], v123 offset:6144
    ds_read_b128 v[100:103], v123 offset:7168
    ds_read_b128 v[104:107], v123 offset:36864
    ds_read_b128 v[108:111], v123 offset:37888
    ds_read_b128 v[24:27], v123 offset:38912
    ds_read_b128 v[28:31], v123 offset:39936
    s_add_u32 s24, s24, 8192
    s_bitset0_b32 s24, 15
    s_xor_b32 s55, s24, 16384
    s_xor_b32 s29, s29, 0x0
    s_xor_b32 s53, s29, 1024
    s_bfe_u32 s33, s22, 0x10000
    s_add_u32 s40, s22, 5
    s_lshr_b32 s40, s40, 2
    s_min_u32 s40, s40, 16
    s_bfm_b32 s58, s40, 0
    s_waitcnt vmcnt(5)
    v_cmp_eq_u32 vcc, 0, v125
    s_nop 0
    s_and_b64 vcc, vcc, s[58:59]
    s_cbranch_scc1 L_kvw_22
L_kvb_23:
    v_mov_b32 v15, 0
    s_nop 2
    v_mov_b32 v15, 0
    s_nop 2
    v_mov_b32 v15, 0
    s_nop 2
    v_mov_b32 v15, 0
    s_nop 2
    v_mov_b32 v15, 0
    s_nop 2
    v_mov_b32 v15, 0
    s_nop 2
    v_mov_b32 v15, 0
    s_nop 2
    v_mov_b32 v15, 0
    s_nop 2
    v_mov_b32 v15, 0
    s_nop 2
    v_mov_b32 v15, 0
    s_nop 2
    v_mov_b32 v15, 0
    s_nop 2
    v_mov_b32 v15, 0
    s_nop 2
    v_mov_b32 v15, 0
    s_nop 2
    v_mov_b32 v15, 0
    s_nop 2
    v_mov_b32 v15, 0
    s_nop 2
    v_mov_b32 v15, 0
    s_nop 2
    v_mov_b32 v15, 0
    s_nop 2
    v_mov_b32 v15, 0
    s_nop 2
    v_mov_b32 v15, 0
    s_nop 2
    v_mov_b32 v15, 0
    s_nop 2
    v_mov_b32 v15, 0
    s_nop 2
    v_mov_b32 v15, 0
    s_nop 2
    v_mov_b32 v15, 0
    s_nop 2
    v_mov_b32 v15, 0
    s_nop 2
    v_mov_b32 v15, 0
    s_nop 2
    v_mov_b32 v15, 0
    s_nop 2
    v_mov_b32 v15, 0
    s_nop 2
    v_mov_b32 v15, 0
    s_nop 2
    v_mov_b32 v15, 0
    s_nop 2
    v_mov_b32 v15, 0
    s_nop 2
    v_mov_b32 v15, 0
    s_nop 2
    s_waitcnt lgkmcnt(0)
    s_branch L_chain_top0_f
.p2align 6
L_chain_top1_f:
    buffer_load_dwordx4 v[0:3], v117, s[8:11], s23 offen nt
    v_mov_b32 v15, 0
    v_mov_b32 v15, 0
    v_mov_b32 v15, 0
    v_mov_b32 v15, 0
    v_mov_b32 v15, 0
    v_mov_b32 v15, 0
    v_mov_b32 v15, 0
    v_mov_b32 v15, 0
    v_mov_b32 v15, 0
    v_mov_b32 v15, 0
    v_mov_b32 v15, 0
    v_mov_b32 v15, 0
    v_mov_b32 v15, 0
    v_mov_b32 v15, 0
    v_mov_b32 v15, 0
    v_mov_b32 v15, 0
    buffer_load_dwordx4 v[0:3], v117, s[8:11], s23 offen sc1
    v_mov_b32 v15, 0
    v_mov_b32 v15, 0
    v_mov_b32 v15, 0
    v_mov_b32 v15, 0
    v_mov_b32 v15, 0
    v_mov_b32 v15, 0
    v_mov_b32 v15, 0
    v_mov_b32 v15, 0
    v_mov_b32 v15, 0
    v_mov_b32 v15, 0
    v_mov_b32 v15, 0
    v_mov_b32 v15, 0
    v_mov_b32 v15, 0
    v_mov_b32 v15, 0
    v_mov_b32 v15, 0
    v_mov_b32 v15, 0
L_mret_24:
    buffer_load_dwordx4 v[0:3], v117, s[8:11], s23 offen sc1
    s_add_u32 s45, s45, 1
    s_cmp_lt_u32 s45, 0x10000
    s_cselect_b32 s56, -2, -1
    s_nop 3
    v_mov_b32 v32, 0
    v_mov_b32 v33, 0
    v_mov_b32 v34, 0
    v_mov_b32 v35, 0
    s_waitcnt vmcnt(2)
    v_max3_u32 v15, v0, v1, v2
    v_max_u32 v15, v15, v3
    v_cmp_lt_u32 vcc, s56, v15
    v_smfmac_f32_16x16x64_bf16 v[32:35], v[0:3], v[80:87], v116
    s_cbranch_vccnz L_mret_24
    ds_write_b128 v117, v[0:3] offset:1024
    v_smfmac_f32_16x16x64_bf16 v[36:39], v[0:3], v[56:63], v116
    buffer_load_dwordx4 v[4:7], v117, s[8:11], s48 offen nt
    v_smfmac_f32_16x16x64_bf16 v[40:43], v[0:3], v[64:71], v116
    buffer_load_dwordx4 v117, s[8:11], s48 offen nt lds
    s_mov_b32 m0, 10240
    v_smfmac_f32_16x16x64_bf16 v[44:47], v[0:3], v[72:79], v116
    s_waitcnt lgkmcnt(0)
    s_barrier
    ds_read_b128 v[8:11], v117
    v_smfmac_f32_16x16x64_bf16 v[48:51], v[0:3], a[192:199], v116
    ds_read_b128 v[16:19], v117 offset:3072
    ds_read_b128 v[20:23], v117 offset:2048
    v_smfmac_f32_16x16x64_bf16 v[52:55], v[0:3], a[200:207], v116
    ds_read_b128 v[80:83], v117 offset:14336
    s_waitcnt lgkmcnt(3)
    v_smfmac_f32_16x16x64_bf16 v[32:35], v[8:11], a[0:7], v116
    ds_read_b128 v[84:87], v117 offset:15360
    v_smfmac_f32_16x16x64_bf16 v[36:39], v[8:11], a[8:15], v116
    ds_read_b128 v[56:59], v117 offset:8192
    s_waitcnt lgkmcnt(4)
    v_smfmac_f32_16x16x64_bf16 v[32:35], v[16:19], a[32:39], v116
    ds_read_b128 v[60:63], v117 offset:9216
    v_smfmac_f32_16x16x64_bf16 v[36:39], v[16:19], a[40:47], v116
    buffer_store_dwordx4 v[112:115], v117, s[8:11], s32 offen sc1
    s_waitcnt lgkmcnt(4)
    v_smfmac_f32_16x16x64_bf16 v[32:35], v[20:23], a[64:71], v116
    ds_read_b128 v[64:67], v117 offset:10240
    v_smfmac_f32_16x16x64_bf16 v[36:39], v[20:23], a[72:79], v116
    ds_read_b128 v[68:71], v117 offset:11264
    v_smfmac_f32_16x16x64_bf16 v[40:43], v[8:11], a[96:103], v116
    ds_read_b128 v[72:75], v117 offset:12288
    v_smfmac_f32_16x16x64_bf16 v[40:43], v[16:19], a[128:135], v116
    ds_read_b128 v[76:79], v117 offset:13312
    v_smfmac_f32_16x16x64_bf16 v[40:43], v[20:23], a[160:167], v116
    s_waitcnt vmcnt(2)
    v_max3_u32 v15, v4, v5, v6
    v_smfmac_f32_16x16x64_bf16 v[44:47], v[8:11], a[104:111], v116
    v_max_u32 v15, v15, v7
    v_smfmac_f32_16x16x64_bf16 v[44:47], v[16:19], a[136:143], v116
    s_waitcnt vmcnt(1) lgkmcnt(0)
    v_cmp_lt_u32 vcc, s56, v15
    v_smfmac_f32_16x16x64_bf16 v[44:47], v[20:23], a[168:175], v116
    s_cbranch_vccnz L_mret_25
L_mgo_26:
    v_smfmac_f32_16x16x64_bf16 v[44:47], v[4:7], v[24:31], v116
    s_barrier
    ds_read_b128 v[12:15], v117 offset:4096
    v_smfmac_f32_16x16x64_bf16 v[32:35], v[4:7], v[88:95], v116
    ds_read_b128 v[24:27], v117 offset:7168
    v_smfmac_f32_16x16x64_bf16 v[36:39], v[4:7], v[96:103], v116
    ds_read_b128 v[28:31], v117 offset:6144
    v_smfmac_f32_16x16x64_bf16 v[40:43], v[4:7], v[104:111], v116
    ds_read_b128 v[88:91], v117 offset:26624
    s_waitcnt lgkmcnt(3)
    v_smfmac_f32_16x16x64_bf16 v[32:35], v[12:15], a[16:23], v116
    ds_read_b128 v[92:95], v117 offset:27648
    s_waitcnt lgkmcnt(3)
    v_smfmac_f32_16x16x64_bf16 v[32:35], v[24:27], a[48:55], v116
    buffer_load_dwordx4 v117, s[8:11], s30 offen lds
    s_waitcnt lgkmcnt(2)
    v_smfmac_f32_16x16x64_bf16 v[32:35], v[28:31], a[80:87], v116
    ds_read_b128 v[96:99], v117 offset:23552
    v_smfmac_f32_16x16x64_bf16 v[36:39], v[12:15], a[24:31], v116
    ds_read_b128 v[100:103], v117 offset:23552
    v_smfmac_f32_16x16x64_bf16 v[36:39], v[24:27], a[56:63], v116
    buffer_load_dwordx4 v117, s[8:11], s30 offen offset:1024 lds
    s_add_u32 m0, s52, 0x6000
    v_add_f32 v32, v32, v34
    v_smfmac_f32_16x16x64_bf16 v[36:39], v[28:31], a[88:95], v116
    ds_read_b128 v[104:107], v117 offset:23552
    v_add_f32 v33, v33, v35
    v_smfmac_f32_16x16x64_bf16 v[40:43], v[12:15], a[112:119], v116
    ds_read_b128 v[108:111], v117 offset:23552
    v_mul_f32 v32, s34, v32
    v_smfmac_f32_16x16x64_bf16 v[40:43], v[24:27], a[144:151], v116
    buffer_load_dword v125, v119, s[8:11], s28 offen sc1
    v_mul_f32 v33, s34, v33
    v_smfmac_f32_16x16x64_bf16 v[40:43], v[28:31], a[176:183], v116
    ds_read_b128 v[0:3], v124
    v_add_f32 v36, v36, v38
    v_smfmac_f32_16x16x64_bf16 v[48:51], v[4:7], a[208:215], v116
    v_add_f32 v37, v37, v39
    v_smfmac_f32_16x16x64_bf16 v[52:55], v[4:7], a[216:223], v116
    s_waitcnt lgkmcnt(5)
    buffer_load_dwordx4 v117, s[8:11], s31 offen lds
    v_mul_f32 v36, s34, v36
    v_smfmac_f32_16x16x64_bf16 v[44:47], v[12:15], a[120:127], v116
    ds_read_b128 v[4:7], v124 offset:1024
    v_mul_f32 v37, s34, v37
    v_smfmac_f32_16x16x64_bf16 v[44:47], v[24:27], a[152:159], v116
    v_cvt_pk_bf16_f32 v34, v32, v36
    v_smfmac_f32_16x16x64_bf16 v[44:47], v[28:31], a[184:191], v116
    buffer_load_dwordx4 v117, s[8:11], s31 offen offset:1024 lds
    s_mov_b32 m0, 5120
    v_cvt_pk_bf16_f32 v35, v33, v37
    v_add_f32 v40, v40, v42
    v_smfmac_f32_16x16x64_bf16 v[48:51], v[8:11], a[224:231], v116
    ds_write2_b32 v120, v34, v35 offset0:32 offset1:48
    v_add_f32 v41, v41, v43
    v_smfmac_f32_16x16x64_bf16 v[52:55], v[8:11], a[232:239], v116
    v_add_f32 v44, v44, v46
    v_add_f32 v45, v45, v47
    v_cvt_pk_bf16_f32 v113, v40, v44
    v_cvt_pk_bf16_f32 v115, v41, v45
    v_smfmac_f32_16x16x64_bf16 v[48:51], v[12:15], a[240:247], v116
    ds_write2_b32 v120, v113, v115 offset0:0 offset1:16
    v_smfmac_f32_16x16x64_bf16 v[52:55], v[12:15], a[248:255], v116
    s_cmp_eq_u32 s22, 63
    s_cbranch_scc1 L_chain_last_f
    v_smfmac_f32_16x16x64_bf16 v[48:51], v[16:19], v[128:135], v116
    v_smfmac_f32_16x16x64_bf16 v[48:51], v[20:23], v[160:167], v116
    v_smfmac_f32_16x16x64_bf16 v[48:51], v[24:27], v[144:151], v116
    s_waitcnt lgkmcnt(0)
    s_barrier
    v_smfmac_f32_16x16x64_bf16 v[48:51], v[28:31], v[176:183], v116
    ds_read_b128 v[32:35], v121 offset:16384
    ds_read_b128 v[36:39], v121 offset:17408
    v_smfmac_f32_16x16x64_bf16 v[52:55], v[16:19], v[136:143], v116
    ds_read_b128 v[40:43], v121 offset:18432
    ds_read_b128 v[44:47], v121 offset:19456
    v_smfmac_f32_16x16x64_bf16 v[52:55], v[20:23], v[168:175], v116
    ds_read_b128 v[8:11], v124 offset:32768
    v_add_f32 v48, v48, v50
    v_smfmac_f32_16x16x64_bf16 v[52:55], v[24:27], v[152:159], v116
    ds_read_b128 v[12:15], v124 offset:33792
    v_add_f32 v49, v49, v51
    v_smfmac_f32_16x16x64_bf16 v[52:55], v[28:31], v[184:191], v116
    s_waitcnt lgkmcnt(5)
    v_cvt_pk_bf16_f32 v112, v48, v49
    v_mfma_f32_16x16x32_bf16 v[56:59], v[56:59], v[32:35], 0
    s_waitcnt lgkmcnt(4)
    v_mov_b32 v48, s50
    v_mov_b32 v49, s50
    v_mfma_f32_16x16x32_bf16 v[56:59], v[60:63], v[36:39], v[56:59]
    ds_read_b128 v[16:19], v124 offset:2048
    s_waitcnt lgkmcnt(4)
    v_mov_b32 v50, s50
    v_mov_b32 v51, s50
    v_mfma_f32_16x16x32_bf16 v[56:59], v[64:67], v[40:43], v[56:59]
    ds_read_b128 v[20:23], v124 offset:3072
    s_waitcnt lgkmcnt(4)
    v_add_f32 v52, v52, v54
    v_mfma_f32_16x16x32_bf16 v[56:59], v[68:71], v[44:47], v[56:59]
    ds_read_b128 v[24:27], v124 offset:4096
    v_add_f32 v53, v53, v55
    v_mfma_f32_16x16x32_bf16 v[60:63], v[72:75], v[32:35], 0
    ds_read_b128 v[28:31], v124 offset:5120
    v_cvt_pk_bf16_f32 v114, v52, v53
    v_mov_b32 v53, 0
    v_mfma_f32_16x16x32_bf16 v[60:63], v[76:79], v[36:39], v[60:63]
    v_exp_f32 v56, v56
    v_mfma_f32_16x16x32_bf16 v[60:63], v[80:83], v[40:43], v[60:63]
    v_exp_f32 v57, v57
    v_mfma_f32_16x16x32_bf16 v[60:63], v[84:87], v[44:47], v[60:63]
    v_exp_f32 v58, v58
    v_mfma_f32_16x16x32_bf16 v[64:67], v[32:35], v[32:35], 0
    v_exp_f32 v59, v59
    v_cvt_pk_bf16_f32 v68, v56, v57
    v_mfma_f32_16x16x32_bf16 v[64:67], v[36:39], v[36:39], v[64:67]
    v_exp_f32 v60, v60
    v_cvt_pk_bf16_f32 v69, v58, v59
    v_mfma_f32_16x16x32_bf16 v[64:67], v[40:43], v[40:43], v[64:67]
    v_exp_f32 v61, v61
    v_mfma_f32_16x16x32_bf16 v[64:67], v[44:47], v[44:47], v[64:67]
    v_exp_f32 v62, v62
    v_exp_f32 v63, v63
    v_cvt_pk_bf16_f32 v70, v60, v61
    v_cvt_pk_bf16_f32 v71, v62, v63
    s_nop 1
    v_mfma_f32_16x16x32_bf16 v[72:75], v[88:91], v[68:71], 0
    s_nop 0
    v_exp_f32 v64, v64
    v_mfma_f32_16x16x32_bf16 v[76:79], v[92:95], v[68:71], 0
    v_exp_f32 v65, v65
    v_mfma_f32_16x16x32_bf16 v[80:83], v[48:51], v[68:71], 0
    v_cvt_pk_bf16_f32 v52, v64, v65
    s_nop 1
    v_mfma_f32_16x16x16_bf16 v[72:75], v[112:113], v[52:53], v[72:75]
    ds_read_b128 v[32:35], v124 offset:6144
    v_mfma_f32_16x16x16_bf16 v[76:79], v[114:115], v[52:53], v[76:79]
    ds_read_b128 v[36:39], v124 offset:7168
    v_mfma_f32_16x16x16_bf16 v[80:83], v[48:49], v[52:53], v[80:83]
L_norm_27:
    s_mov_b64 vcc, s[36:37]
    v_mov_b32 v122, v122
    v_mov_b32 v122, v122
    v_mov_b32 v122, v122
    v_cndmask_b32_dpp v76, v72, v76, vcc quad_perm:[2,3,2,3] row_mask:0xf bank_mask:0xf
    v_cndmask_b32_dpp v77, v73, v77, vcc quad_perm:[2,3,2,3] row_mask:0xf bank_mask:0xf
    v_cndmask_b32_dpp v78, v74, v78, vcc quad_perm:[2,3,2,3] row_mask:0xf bank_mask:0xf
    v_cndmask_b32_dpp v79, v75, v79, vcc quad_perm:[2,3,2,3] row_mask:0xf bank_mask:0xf
    v_rcp_f32_dpp v84, v80 quad_perm:[2,3,2,3] row_mask:0xf bank_mask:0xf
    s_nop 0
    v_pk_mul_f32 v[76:77], v[76:77], v[84:85] op_sel_hi:[1,0]
    v_pk_mul_f32 v[78:79], v[78:79], v[84:85] op_sel_hi:[1,0]
    v_cvt_pk_bf16_f32 v72, v76, v77
    v_cvt_pk_bf16_f32 v73, v78, v79
    ds_write_b64 v122, v[72:73] offset:20992
    v_max_f32_dpp v86, v80, v84 quad_perm:[2,3,2,3] row_mask:0xf bank_mask:0xf
    v_mov_b32_dpp v60, v72 quad_perm:[0,1,0,1] row_mask:0xf bank_mask:0xf
    v_mov_b32_dpp v61, v73 quad_perm:[0,1,0,1] row_mask:0xf bank_mask:0xf
    v_cmp_lt_f32 vcc, s35, v86
    v_mov_b32_dpp v62, v72 quad_perm:[2,3,2,3] row_mask:0xf bank_mask:0xf
    v_mov_b32_dpp v63, v73 quad_perm:[2,3,2,3] row_mask:0xf bank_mask:0xf
    s_nop 1
    v_smfmac_f32_16x16x64_bf16 v[96:99], v[60:63], v[192:199], v116
    s_cbranch_vccnz L_smax_28
    v_smfmac_f32_16x16x64_bf16 v[100:103], v[60:63], v[224:231], v116
    s_waitcnt lgkmcnt(0)
    s_barrier
    ds_read_b128 v[92:95], v127 offset:20480
    ds_read_b128 v[80:83], v127 offset:22016
    ds_read_b128 v[84:87], v127 offset:21504
    v_smfmac_f32_16x16x64_bf16 v[104:107], v[60:63], v[0:7], v116
    ds_read_b128 v[40:43], v124 offset:34816
    v_smfmac_f32_16x16x64_bf16 v[108:111], v[60:63], v[8:15], v116
    ds_read_b128 v[56:59], v124 offset:36864
    s_waitcnt lgkmcnt(4)
    v_smfmac_f32_16x16x64_bf16 v[96:99], v[92:95], v[200:207], v116
    s_waitcnt lgkmcnt(3)
    v_smfmac_f32_16x16x64_bf16 v[96:99], v[80:83], v[208:215], v116
    ds_read_b128 v[44:47], v124 offset:35840
    s_waitcnt lgkmcnt(3)
    v_smfmac_f32_16x16x64_bf16 v[96:99], v[84:87], v[216:223], v116
    ds_read_b128 v[68:71], v124 offset:39936
    v_smfmac_f32_16x16x64_bf16 v[100:103], v[92:95], v[232:239], v116
    ds_read_b128 v[64:67], v124 offset:38912
    v_smfmac_f32_16x16x64_bf16 v[100:103], v[80:83], v[240:247], v116
    ds_read_b128 v[60:63], v124 offset:37888
    v_cvt_pk_bf16_f32 v72, v96, v98
    v_smfmac_f32_16x16x64_bf16 v[100:103], v[84:87], v[248:255], v116
    v_and_or_b32 v72, v72, -2, s33
    v_smfmac_f32_16x16x64_bf16 v[104:107], v[92:95], v[16:23], v116
    v_cvt_pk_bf16_f32 v74, v97, v99
    v_smfmac_f32_16x16x64_bf16 v[104:107], v[80:83], v[24:31], v116
    v_cvt_pk_bf16_f32 v73, v100, v102
    v_cvt_pk_bf16_f32 v75, v101, v103
    v_smfmac_f32_16x16x64_bf16 v[104:107], v[84:87], v[32:39], v116
    buffer_store_dwordx4 v[72:75], v118, s[8:11], s25 offen
    s_waitcnt lgkmcnt(3)
    v_smfmac_f32_16x16x64_bf16 v[108:111], v[92:95], v[40:47], v116
    s_waitcnt lgkmcnt(0)
    v_smfmac_f32_16x16x64_bf16 v[108:111], v[80:83], v[56:63], v116
    v_cvt_pk_bf16_f32 v76, v104, v106
    v_smfmac_f32_16x16x64_bf16 v[108:111], v[84:87], v[64:71], v116
    v_and_or_b32 v76, v76, -2, s33
    v_cvt_pk_bf16_f32 v78, v105, v107
    v_mov_b32 v122, v122
    v_mov_b32 v122, v122
    v_mov_b32 v122, v122
    v_mov_b32 v122, v122
    v_mov_b32 v122, v122
    v_mov_b32 v122, v122
    v_cvt_pk_bf16_f32 v77, v108, v110
    v_cvt_pk_bf16_f32 v79, v109, v111
    buffer_store_dwordx4 v[76:79], v118, s[8:11], s26 offen
    s_add_u32 s30, s30, 0x40000
    s_add_u32 s31, s31, 0x40000
    s_add_u32 s32, s32, 0x20000
    s_add_u32 s23, s24, 1024
    s_add_u32 s48, s23, 4096
    s_xor_b32 s25, s25, 0x0
    s_xor_b32 s26, s26, 0x0
    s_mov_b32 s35, 0x49800000
    s_add_u32 s22, s22, 1
    v_mov_b32 v32, 0
    v_mov_b32 v33, 0
    v_mov_b32 v34, 0
    v_mov_b32 v35, 0
    v_mov_b32 v36, 0
    v_mov_b32 v37, 0
    v_mov_b32 v38, 0
    v_mov_b32 v39, 0
    v_mov_b32 v40, 0
    v_mov_b32 v41, 0
    v_mov_b32 v42, 0
    v_mov_b32 v43, 0
    v_mov_b32 v44, 0
    v_mov_b32 v45, 0
    v_mov_b32 v46, 0
    v_mov_b32 v47, 0
    v_mov_b32 v48, 0
    v_mov_b32 v49, 0
    v_mov_b32 v50, 0
    v_mov_b32 v51, 0
    v_mov_b32 v52, 0
    v_mov_b32 v53, 0
    v_mov_b32 v54, 0
    v_mov_b32 v55, 0
    ds_read_b128 v[80:83], v123
    ds_read_b128 v[84:87], v123 offset:1024
    ds_read_b128 v[56:59], v123 offset:2048
    ds_read_b128 v[60:63], v123 offset:3072
    ds_read_b128 v[64:67], v123 offset:32768
    ds_read_b128 v[68:71], v123 offset:33792
    ds_read_b128 v[72:75], v123 offset:34816
    ds_read_b128 v[76:79], v123 offset:35840
    ds_read_b128 v[88:91], v123 offset:4096
    ds_read_b128 v[92:95], v123 offset:5120
    ds_read_b128 v[96:99], v123 offset:6144
    ds_read_b128 v[100:103], v123 offset:7168
    ds_read_b128 v[104:107], v123 offset:36864
    ds_read_b128 v[108:111], v123 offset:37888
    ds_read_b128 v[24:27], v123 offset:38912
    ds_read_b128 v[28:31], v123 offset:39936
    s_add_u32 s24, s24, 8192
    s_bitset0_b32 s24, 15
    s_xor_b32 s55, s24, 16384
    s_xor_b32 s29, s29, 0x0
    s_xor_b32 s53, s29, 1024
    s_bfe_u32 s33, s22, 0x10000
    s_add_u32 s40, s22, 5
    s_lshr_b32 s40, s40, 2
    s_min_u32 s40, s40, 16
    s_bfm_b32 s58, s40, 0
    s_waitcnt vmcnt(4)
    v_cmp_eq_u32 vcc, 0, v125
    s_nop 0
    s_and_b64 vcc, vcc, s[58:59]
    s_cbranch_scc1 L_kvw_29
L_kvb_30:
    v_mov_b32 v15, 0
    s_nop 2
    v_mov_b32 v15, 0
    s_nop 2
    v_mov_b32 v15, 0
    s_nop 2
    v_mov_b32 v15, 0
    s_nop 2
    v_mov_b32 v15, 0
    s_nop 2
    v_mov_b32 v15, 0
    s_nop 2
    v_mov_b32 v15, 0
    s_nop 2
    v_mov_b32 v15, 0
    s_nop 2
    v_mov_b32 v15, 0
    s_nop 2
    v_mov_b32 v15, 0
    s_nop 2
    v_mov_b32 v15, 0
    s_nop 2
    v_mov_b32 v15, 0
    s_nop 2
    v_mov_b32 v15, 0
    s_nop 2
    v_mov_b32 v15, 0
    s_nop 2
    v_mov_b32 v15, 0
    s_nop 2
    v_mov_b32 v15, 0
    s_nop 2
    v_mov_b32 v15, 0
    s_nop 2
    v_mov_b32 v15, 0
    s_nop 2
    v_mov_b32 v15, 0
    s_nop 2
    v_mov_b32 v15, 0
    s_nop 2
    v_mov_b32 v15, 0
    s_nop 2
    v_mov_b32 v15, 0
    s_nop 2
    v_mov_b32 v15, 0
    s_nop 2
    v_mov_b32 v15, 0
    s_nop 2
    v_mov_b32 v15, 0
    s_nop 2
    v_mov_b32 v15, 0
    s_nop 2
    v_mov_b32 v15, 0
    s_nop 2
    v_mov_b32 v15, 0
    s_nop 2
    v_mov_b32 v15, 0
    s_nop 2
    v_mov_b32 v15, 0
    s_nop 2
    v_mov_b32 v15, 0
    s_nop 2
    s_waitcnt lgkmcnt(0)
    s_branch L_chain_top1_f
.p2align 6
L_chain_top2_f:
    buffer_load_dwordx4 v[0:3], v117, s[8:11], s23 offen nt
    v_mov_b32 v48, 0
    v_mov_b32 v49, 0
    v_mov_b32 v50, 0
    v_mov_b32 v51, 0
    v_mov_b32 v52, 0
    v_mov_b32 v53, 0
    v_mov_b32 v15, 0
    v_mov_b32 v15, 0
    v_mov_b32 v15, 0
    v_mov_b32 v15, 0
    v_mov_b32 v15, 0
    v_mov_b32 v15, 0
    v_mov_b32 v15, 0
    v_mov_b32 v15, 0
    v_mov_b32 v15, 0
    v_mov_b32 v15, 0
    buffer_load_dwordx4 v[0:3], v117, s[8:11], s23 offen sc1
    s_waitcnt vmcnt(3)
    v_mov_b32 v36, 0
    v_mov_b32 v37, 0
    v_mov_b32 v38, 0
    v_mov_b32 v39, 0
    v_mov_b32 v40, 0
    v_mov_b32 v41, 0
    v_mov_b32 v42, 0
    v_mov_b32 v43, 0
    v_mov_b32 v44, 0
    v_mov_b32 v45, 0
    v_mov_b32 v46, 0
    v_mov_b32 v47, 0
    v_mov_b32 v15, 0
    v_mov_b32 v15, 0
    v_mov_b32 v15, 0
    v_mov_b32 v15, 0
L_mret_31:
    buffer_load_dwordx4 v[0:3], v117, s[8:11], s23 offen sc1
    s_add_u32 s45, s45, 1
    s_cmp_lt_u32 s45, 0x10000
    s_cselect_b32 s56, -2, -1
    s_nop 3
    v_mov_b32 v32, 0
    v_mov_b32 v33, 0
    v_mov_b32 v34, 0
    v_mov_b32 v35, 0
    s_waitcnt vmcnt(2)
    v_max3_u32 v15, v0, v1, v2
    v_max_u32 v15, v15, v3
    v_cmp_lt_u32 vcc, s56, v15
    v_smfmac_f32_16x16x64_bf16 v[32:35], v[0:3], v[80:87], v116
    s_cbranch_vccnz L_mret_31
    ds_write_b128 v117, v[0:3] offset:2048
    v_smfmac_f32_16x16x64_bf16 v[36:39], v[0:3], v[56:63], v116
    buffer_load_dwordx4 v[4:7], v117, s[8:11], s48 offen nt
    v_smfmac_f32_16x16x64_bf16 v[40:43], v[0:3], v[64:71], v116
    buffer_load_dwordx4 v117, s[8:11], s48 offen nt lds
    s_mov_b32 m0, 12288
    v_smfmac_f32_16x16x64_bf16 v[44:47], v[0:3], v[72:79], v116
    s_waitcnt lgkmcnt(0)
    s_barrier
    ds_read_b128 v[8:11], v117 offset:3072
    v_smfmac_f32_16x16x64_bf16 v[48:51], v[0:3], a[192:199], v116
    ds_read_b128 v[16:19], v117
    ds_read_b128 v[20:23], v117 offset:1024
    v_smfmac_f32_16x16x64_bf16 v[52:55], v[0:3], a[200:207], v116
    ds_read_b128 v[80:83], v117 offset:14336
    s_waitcnt lgkmcnt(3)
    v_smfmac_f32_16x16x64_bf16 v[32:35], v[8:11], a[0:7], v116
    ds_read_b128 v[84:87], v117 offset:15360
    v_smfmac_f32_16x16x64_bf16 v[36:39], v[8:11], a[8:15], v116
    ds_read_b128 v[56:59], v117 offset:8192
    s_waitcnt lgkmcnt(4)
    v_smfmac_f32_16x16x64_bf16 v[32:35], v[16:19], a[32:39], v116
    ds_read_b128 v[60:63], v117 offset:9216
    v_smfmac_f32_16x16x64_bf16 v[36:39], v[16:19], a[40:47], v116
    ds_read_b128 v[64:67], v117 offset:10240
    s_waitcnt lgkmcnt(5)
    v_smfmac_f32_16x16x64_bf16 v[32:35], v[20:23], a[64:71], v116
    ds_read_b128 v[68:71], v117 offset:11264
    v_smfmac_f32_16x16x64_bf16 v[36:39], v[20:23], a[72:79], v116
    buffer_store_dwordx4 v[112:115], v117, s[8:11], s32 offen sc1
    v_smfmac_f32_16x16x64_bf16 v[40:43], v[8:11], a[96:103], v116
    ds_read_b128 v[72:75], v117 offset:12288
    v_smfmac_f32_16x16x64_bf16 v[40:43], v[16:19], a[128:135], v116
    ds_read_b128 v[76:79], v117 offset:13312
    v_smfmac_f32_16x16x64_bf16 v[40:43], v[20:23], a[160:167], v116
    s_waitcnt vmcnt(2)
    v_max3_u32 v15, v4, v5, v6
    v_smfmac_f32_16x16x64_bf16 v[44:47], v[8:11], a[104:111], v116
    v_max_u32 v15, v15, v7
    v_smfmac_f32_16x16x64_bf16 v[44:47], v[16:19], a[136:143], v116
    s_waitcnt vmcnt(1) lgkmcnt(0)
    v_cmp_lt_u32 vcc, s56, v15
    v_smfmac_f32_16x16x64_bf16 v[44:47], v[20:23], a[168:175], v116
    s_cbranch_vccnz L_mret_32
L_mgo_33:
    v_smfmac_f32_16x16x64_bf16 v[44:47], v[4:7], v[24:31], v116
    s_barrier
    ds_read_b128 v[12:15], v117 offset:7168
    v_smfmac_f32_16x16x64_bf16 v[32:35], v[4:7], v[88:95], v116
    ds_read_b128 v[24:27], v117 offset:4096
    v_smfmac_f32_16x16x64_bf16 v[36:39], v[4:7], v[96:103], v116
    ds_read_b128 v[28:31], v117 offset:5120
    v_smfmac_f32_16x16x64_bf16 v[40:43], v[4:7], v[104:111], v116
    ds_read_b128 v[88:91], v117 offset:28672
    s_waitcnt lgkmcnt(3)
    v_smfmac_f32_16x16x64_bf16 v[32:35], v[12:15], a[16:23], v116
    ds_read_b128 v[92:95], v117 offset:29696
    s_waitcnt lgkmcnt(3)
    v_smfmac_f32_16x16x64_bf16 v[32:35], v[24:27], a[48:55], v116
    buffer_load_dwordx4 v117, s[8:11], s30 offen lds
    s_waitcnt lgkmcnt(2)
    v_smfmac_f32_16x16x64_bf16 v[32:35], v[28:31], a[80:87], v116
    ds_read_b128 v[96:99], v117 offset:23552
    v_smfmac_f32_16x16x64_bf16 v[36:39], v[12:15], a[24:31], v116
    ds_read_b128 v[100:103], v117 offset:23552
    v_smfmac_f32_16x16x64_bf16 v[36:39], v[24:27], a[56:63], v116
    buffer_load_dwordx4 v117, s[8:11], s30 offen offset:1024 lds
    s_add_u32 m0, s52, 0x6000
    v_add_f32 v32, v32, v34
    v_smfmac_f32_16x16x64_bf16 v[36:39], v[28:31], a[88:95], v116
    ds_read_b128 v[104:107], v117 offset:23552
    v_add_f32 v33, v33, v35
    v_smfmac_f32_16x16x64_bf16 v[40:43], v[12:15], a[112:119], v116
    ds_read_b128 v[108:111], v117 offset:23552
    v_mul_f32 v32, s34, v32
    v_smfmac_f32_16x16x64_bf16 v[40:43], v[24:27], a[144:151], v116
    s_waitcnt lgkmcnt(4)
    buffer_load_dwordx4 v117, s[8:11], s31 offen lds
    v_mul_f32 v33, s34, v33
    v_smfmac_f32_16x16x64_bf16 v[40:43], v[28:31], a[176:183], v116
    ds_read_b128 v[0:3], v124
    v_add_f32 v36, v36, v38
    v_smfmac_f32_16x16x64_bf16 v[48:51], v[4:7], a[208:215], v116
    v_add_f32 v37, v37, v39
    v_smfmac_f32_16x16x64_bf16 v[52:55], v[4:7], a[216:223], v116
    buffer_load_dwordx4 v117, s[8:11], s31 offen offset:1024 lds
    s_mov_b32 m0, 6144
    v_mul_f32 v36, s34, v36
    v_smfmac_f32_16x16x64_bf16 v[44:47], v[12:15], a[120:127], v116
    ds_read_b128 v[4:7], v124 offset:1024
    v_mul_f32 v37, s34, v37
    v_smfmac_f32_16x16x64_bf16 v[44:47], v[24:27], a[152:159], v116
    v_cvt_pk_bf16_f32 v34, v32, v36
    v_smfmac_f32_16x16x64_bf16 v[44:47], v[28:31], a[184:191], v116
    v_cvt_pk_bf16_f32 v35, v33, v37
    v_add_f32 v40, v40, v42
    v_smfmac_f32_16x16x64_bf16 v[48:51], v[8:11], a[224:231], v116
    ds_write2_b32 v120, v34, v35 offset0:32 offset1:48
    v_add_f32 v41, v41, v43
    v_smfmac_f32_16x16x64_bf16 v[52:55], v[8:11], a[232:239], v116
    v_add_f32 v44, v44, v46
    v_add_f32 v45, v45, v47
    v_cvt_pk_bf16_f32 v113, v40, v44
    v_cvt_pk_bf16_f32 v115, v41, v45
    v_smfmac_f32_16x16x64_bf16 v[48:51], v[12:15], a[240:247], v116
    ds_write2_b32 v120, v113, v115 offset0:0 offset1:16
    v_smfmac_f32_16x16x64_bf16 v[52:55], v[12:15], a[248:255], v116
    s_cmp_eq_u32 s22, 63
    s_cbranch_scc1 L_chain_last_f
    v_smfmac_f32_16x16x64_bf16 v[48:51], v[16:19], v[128:135], v116
    buffer_store_dword v126, v119, s[8:11], s55 offen
    v_smfmac_f32_16x16x64_bf16 v[48:51], v[20:23], v[160:167], v116
    v_smfmac_f32_16x16x64_bf16 v[48:51], v[24:27], v[144:151], v116
    s_waitcnt lgkmcnt(0)
    s_barrier
    v_smfmac_f32_16x16x64_bf16 v[48:51], v[28:31], v[176:183], v116
    ds_read_b128 v[32:35], v121 offset:16384
    ds_read_b128 v[36:39], v121 offset:17408
    v_smfmac_f32_16x16x64_bf16 v[52:55], v[16:19], v[136:143], v116
    ds_read_b128 v[40:43], v121 offset:18432
    ds_read_b128 v[44:47], v121 offset:19456
    v_smfmac_f32_16x16x64_bf16 v[52:55], v[20:23], v[168:175], v116
    ds_read_b128 v[8:11], v124 offset:32768
    v_add_f32 v48, v48, v50
    v_smfmac_f32_16x16x64_bf16 v[52:55], v[24:27], v[152:159], v116
    ds_read_b128 v[12:15], v124 offset:33792
    v_add_f32 v49, v49, v51
    v_smfmac_f32_16x16x64_bf16 v[52:55], v[28:31], v[184:191], v116
    s_waitcnt lgkmcnt(5)
    v_cvt_pk_bf16_f32 v112, v48, v49
    v_mfma_f32_16x16x32_bf16 v[56:59], v[56:59], v[32:35], 0
    s_waitcnt lgkmcnt(4)
    v_mov_b32 v48, s50
    v_mov_b32 v49, s50
    v_mfma_f32_16x16x32_bf16 v[56:59], v[60:63], v[36:39], v[56:59]
    ds_read_b128 v[16:19], v124 offset:2048
    s_waitcnt lgkmcnt(4)
    v_mov_b32 v50, s50
    v_mov_b32 v51, s50
    v_mfma_f32_16x16x32_bf16 v[56:59], v[64:67], v[40:43], v[56:59]
    ds_read_b128 v[20:23], v124 offset:3072
    s_waitcnt lgkmcnt(4)
    v_add_f32 v52, v52, v54
    v_mfma_f32_16x16x32_bf16 v[56:59], v[68:71], v[44:47], v[56:59]
    ds_read_b128 v[24:27], v124 offset:4096
    v_add_f32 v53, v53, v55
    v_mfma_f32_16x16x32_bf16 v[60:63], v[72:75], v[32:35], 0
    ds_read_b128 v[28:31], v124 offset:5120
    v_cvt_pk_bf16_f32 v114, v52, v53
    v_mov_b32 v53, 0
    v_mfma_f32_16x16x32_bf16 v[60:63], v[76:79], v[36:39], v[60:63]
    v_exp_f32 v56, v56
    v_mfma_f32_16x16x32_bf16 v[60:63], v[80:83], v[40:43], v[60:63]
    v_exp_f32 v57, v57
    v_mfma_f32_16x16x32_bf16 v[60:63], v[84:87], v[44:47], v[60:63]
    v_exp_f32 v58, v58
    v_mfma_f32_16x16x32_bf16 v[64:67], v[32:35], v[32:35], 0
    v_exp_f32 v59, v59
    v_cvt_pk_bf16_f32 v68, v56, v57
    v_mfma_f32_16x16x32_bf16 v[64:67], v[36:39], v[36:39], v[64:67]
    v_exp_f32 v60, v60
    v_cvt_pk_bf16_f32 v69, v58, v59
    v_mfma_f32_16x16x32_bf16 v[64:67], v[40:43], v[40:43], v[64:67]
    v_exp_f32 v61, v61
    v_mfma_f32_16x16x32_bf16 v[64:67], v[44:47], v[44:47], v[64:67]
    v_exp_f32 v62, v62
    v_exp_f32 v63, v63
    v_cvt_pk_bf16_f32 v70, v60, v61
    v_cvt_pk_bf16_f32 v71, v62, v63
    s_nop 1
    v_mfma_f32_16x16x32_bf16 v[72:75], v[88:91], v[68:71], 0
    s_nop 0
    v_exp_f32 v64, v64
    v_mfma_f32_16x16x32_bf16 v[76:79], v[92:95], v[68:71], 0
    v_exp_f32 v65, v65
    v_mfma_f32_16x16x32_bf16 v[80:83], v[48:51], v[68:71], 0
    v_cvt_pk_bf16_f32 v52, v64, v65
    s_nop 1
    v_mfma_f32_16x16x16_bf16 v[72:75], v[112:113], v[52:53], v[72:75]
    ds_read_b128 v[32:35], v124 offset:6144
    v_mfma_f32_16x16x16_bf16 v[76:79], v[114:115], v[52:53], v[76:79]
    ds_read_b128 v[36:39], v124 offset:7168
    v_mfma_f32_16x16x16_bf16 v[80:83], v[48:49], v[52:53], v[80:83]
L_norm_34:
    s_mov_b64 vcc, s[36:37]
    v_mov_b32 v122, v122
    v_mov_b32 v122, v122
    v_mov_b32 v122, v122
    v_cndmask_b32_dpp v76, v72, v76, vcc quad_perm:[2,3,2,3] row_mask:0xf bank_mask:0xf
    v_cndmask_b32_dpp v77, v73, v77, vcc quad_perm:[2,3,2,3] row_mask:0xf bank_mask:0xf
    v_cndmask_b32_dpp v78, v74, v78, vcc quad_perm:[2,3,2,3] row_mask:0xf bank_mask:0xf
    v_cndmask_b32_dpp v79, v75, v79, vcc quad_perm:[2,3,2,3] row_mask:0xf bank_mask:0xf
    v_rcp_f32_dpp v84, v80 quad_perm:[2,3,2,3] row_mask:0xf bank_mask:0xf
    s_nop 0
    v_pk_mul_f32 v[76:77], v[76:77], v[84:85] op_sel_hi:[1,0]
    v_pk_mul_f32 v[78:79], v[78:79], v[84:85] op_sel_hi:[1,0]
    v_cvt_pk_bf16_f32 v72, v76, v77
    v_cvt_pk_bf16_f32 v73, v78, v79
    ds_write_b64 v122, v[72:73] offset:21504
    v_max_f32_dpp v86, v80, v84 quad_perm:[2,3,2,3] row_mask:0xf bank_mask:0xf
    v_mov_b32_dpp v60, v72 quad_perm:[0,1,0,1] row_mask:0xf bank_mask:0xf
    v_mov_b32_dpp v61, v73 quad_perm:[0,1,0,1] row_mask:0xf bank_mask:0xf
    v_cmp_lt_f32 vcc, s35, v86
    v_mov_b32_dpp v62, v72 quad_perm:[2,3,2,3] row_mask:0xf bank_mask:0xf
    v_mov_b32_dpp v63, v73 quad_perm:[2,3,2,3] row_mask:0xf bank_mask:0xf
    s_nop 1
    v_smfmac_f32_16x16x64_bf16 v[96:99], v[60:63], v[192:199], v116
    s_cbranch_vccnz L_smax_35
    v_smfmac_f32_16x16x64_bf16 v[100:103], v[60:63], v[224:231], v116
    s_waitcnt lgkmcnt(0)
    s_barrier
    ds_read_b128 v[92:95], v127 offset:22016
    ds_read_b128 v[80:83], v127 offset:20480
    ds_read_b128 v[84:87], v127 offset:20992
    v_smfmac_f32_16x16x64_bf16 v[104:107], v[60:63], v[0:7], v116
    ds_read_b128 v[40:43], v124 offset:34816
    v_smfmac_f32_16x16x64_bf16 v[108:111], v[60:63], v[8:15], v116
    ds_read_b128 v[56:59], v124 offset:36864
    s_waitcnt lgkmcnt(4)
    v_smfmac_f32_16x16x64_bf16 v[96:99], v[92:95], v[200:207], v116
    s_waitcnt lgkmcnt(3)
    v_smfmac_f32_16x16x64_bf16 v[96:99], v[80:83], v[208:215], v116
    ds_read_b128 v[44:47], v124 offset:35840
    s_waitcnt lgkmcnt(3)
    v_smfmac_f32_16x16x64_bf16 v[96:99], v[84:87], v[216:223], v116
    ds_read_b128 v[68:71], v124 offset:39936
    v_smfmac_f32_16x16x64_bf16 v[100:103], v[92:95], v[232:239], v116
    ds_read_b128 v[64:67], v124 offset:38912
    v_smfmac_f32_16x16x64_bf16 v[100:103], v[80:83], v[240:247], v116
    ds_read_b128 v[60:63], v124 offset:37888
    v_cvt_pk_bf16_f32 v72, v96, v98
    v_smfmac_f32_16x16x64_bf16 v[100:103], v[84:87], v[248:255], v116
    v_and_or_b32 v72, v72, -2, s33
    v_smfmac_f32_16x16x64_bf16 v[104:107], v[92:95], v[16:23], v116
    v_cvt_pk_bf16_f32 v74, v97, v99
    v_smfmac_f32_16x16x64_bf16 v[104:107], v[80:83], v[24:31], v116
    v_cvt_pk_bf16_f32 v73, v100, v102
    v_cvt_pk_bf16_f32 v75, v101, v103
    v_smfmac_f32_16x16x64_bf16 v[104:107], v[84:87], v[32:39], v116
    buffer_store_dwordx4 v[72:75], v118, s[8:11], s25 offen
    s_waitcnt lgkmcnt(3)
    v_smfmac_f32_16x16x64_bf16 v[108:111], v[92:95], v[40:47], v116
    s_waitcnt lgkmcnt(0)
    v_smfmac_f32_16x16x64_bf16 v[108:111], v[80:83], v[56:63], v116
    v_cvt_pk_bf16_f32 v76, v104, v106
    v_smfmac_f32_16x16x64_bf16 v[108:111], v[84:87], v[64:71], v116
    v_and_or_b32 v76, v76, -2, s33
    v_cvt_pk_bf16_f32 v78, v105, v107
    v_mov_b32 v122, v122
    v_mov_b32 v122, v122
    v_mov_b32 v122, v122
    v_mov_b32 v122, v122
    v_mov_b32 v122, v122
    v_mov_b32 v122, v122
    v_cvt_pk_bf16_f32 v77, v108, v110
    v_cvt_pk_bf16_f32 v79, v109, v111
    buffer_store_dwordx4 v[76:79], v118, s[8:11], s26 offen
    ds_read_b128 v[80:83], v123
    ds_read_b128 v[84:87], v123 offset:1024
    ds_read_b128 v[56:59], v123 offset:2048
    ds_read_b128 v[60:63], v123 offset:3072
    ds_read_b128 v[64:67], v123 offset:32768
    ds_read_b128 v[68:71], v123 offset:33792
    ds_read_b128 v[72:75], v123 offset:34816
    ds_read_b128 v[76:79], v123 offset:35840
    ds_read_b128 v[88:91], v123 offset:4096
    ds_read_b128 v[92:95], v123 offset:5120
    ds_read_b128 v[96:99], v123 offset:6144
    ds_read_b128 v[100:103], v123 offset:7168
    ds_read_b128 v[104:107], v123 offset:36864
    ds_read_b128 v[108:111], v123 offset:37888
    ds_read_b128 v[24:27], v123 offset:38912
    ds_read_b128 v[28:31], v123 offset:39936
    s_add_u32 s30, s30, 0x40000
    s_add_u32 s31, s31, 0x40000
    s_add_u32 s32, s32, 0x20000
    s_add_u32 s23, s24, 2048
    s_add_u32 s48, s23, 4096
    s_xor_b32 s25, s25, 0x0
    s_xor_b32 s26, s26, 0x0
    s_mov_b32 s35, 0x49800000
    s_add_u32 s22, s22, 1
    v_cndmask_b32 v12, 0, v125, s[68:69]
    v_cndmask_b32 v13, 0, v125, s[70:71]
    v_cndmask_b32 v14, 0, v125, s[72:73]
    v_cndmask_b32 v15, 0, v125, s[74:75]
    v_mov_b32 v54, 0
    v_mov_b32 v55, 0
    v_mov_b32 v52, 0
    v_mov_b32 v52, 0
    v_mov_b32 v52, 0
    v_mov_b32 v52, 0
    v_mov_b32 v52, 0
    v_mov_b32 v52, 0
    v_mov_b32 v52, 0
    v_mov_b32 v52, 0
    v_mov_b32 v52, 0
    v_mov_b32 v52, 0
    v_mov_b32 v52, 0
    v_mov_b32 v52, 0
    v_mov_b32 v52, 0
    v_mov_b32 v52, 0
    v_mov_b32 v52, 0
    v_mov_b32 v52, 0
    v_mov_b32 v52, 0
    v_mov_b32 v52, 0
    v_mov_b32 v52, 0
    buffer_load_dwordx4 v[4:7], v117, s[8:11], s29 offen sc1
    buffer_load_dwordx4 v[8:11], v117, s[8:11], s53 offen sc1
    buffer_load_dwordx4 v[16:19], v117, s[8:11], s29 offen offset:2048 sc1
    buffer_load_dwordx4 v[20:23], v117, s[8:11], s53 offen offset:2048 sc1
    v_mov_b32 v52, 0
    v_mov_b32 v52, 0
    v_mov_b32 v52, 0
    v_mov_b32 v52, 0
    v_mov_b32 v52, 0
    v_mov_b32 v52, 0
    v_mov_b32 v52, 0
    v_mov_b32 v52, 0
    v_mov_b32 v52, 0
    v_mov_b32 v52, 0
    v_mov_b32 v52, 0
    v_mov_b32 v52, 0
    v_mov_b32 v52, 0
    v_mov_b32 v52, 0
    v_mov_b32 v52, 0
    v_mov_b32 v52, 0
    v_mov_b32 v52, 0
    v_mov_b32 v52, 0
    v_mov_b32 v52, 0
    v_mov_b32 v52, 0
    v_mov_b32 v52, 0
    v_mov_b32 v52, 0
    v_mov_b32 v52, 0
    v_mov_b32 v52, 0
    v_mov_b32 v52, 0
    v_mov_b32 v52, 0
    v_mov_b32 v52, 0
    v_mov_b32 v52, 0
    v_mov_b32 v52, 0
    v_mov_b32 v52, 0
    v_mov_b32 v52, 0
    v_mov_b32 v52, 0
    v_mov_b32 v52, 0
    v_mov_b32 v52, 0
    v_mov_b32 v52, 0
    v_mov_b32 v52, 0
    v_mov_b32 v52, 0
    v_mov_b32 v52, 0
    v_mov_b32 v52, 0
    v_mov_b32 v52, 0
    buffer_load_dwordx4 v[32:35], v117, s[8:11], s29 offen sc1
    buffer_load_dwordx4 v[36:39], v117, s[8:11], s53 offen sc1
    buffer_load_dwordx4 v[40:43], v117, s[8:11], s29 offen offset:2048 sc1
    buffer_load_dwordx4 v[44:47], v117, s[8:11], s53 offen offset:2048 sc1
    v_mov_b32 v52, 0
L_rl_36:
    s_waitcnt vmcnt(7)
    v_mfma_f32_16x16x32_bf16 v[48:51], v[4:7], v[12:15], 0
    v_xor_b32 v52, s33, v4
    s_waitcnt vmcnt(6)
    v_mfma_f32_16x16x32_bf16 v[48:51], v[8:11], v[12:15], v[48:51]
    v_xor_b32 v53, s33, v8
    v_or_b32 v52, v52, v53
    s_waitcnt vmcnt(5)
    v_mfma_f32_16x16x32_bf16 v[48:51], v[16:19], v[12:15], v[48:51]
    v_xor_b32 v53, s33, v16
    v_or_b32 v52, v52, v53
    s_waitcnt vmcnt(4)
    v_mfma_f32_16x16x32_bf16 v[48:51], v[20:23], v[12:15], v[48:51]
    v_xor_b32 v53, s33, v20
    v_or_b32 v52, v52, v53
    v_and_b32 v52, 1, v52
    v_cmp_ne_u32 vcc, 0, v52
    s_cbranch_vccnz L_rslow_37
L_rgo_38:
    s_nop 2
    v_permlane32_swap_b32 v48, v50
    v_permlane32_swap_b32 v49, v51
    v_pk_add_f32 v[48:49], v[48:49], v[50:51]
    s_mov_b64 exec, s[38:39]
    v_cvt_pk_bf16_f32 v12, v48, v49
    v_min_u32 v12, 0xfffffffe, v12
    buffer_store_dword v12, v119, s[8:11], s24 offen
    s_mov_b64 exec, -1
    s_add_u32 s24, s24, 8192
    s_bitset0_b32 s24, 15
    s_xor_b32 s55, s24, 16384
    s_xor_b32 s29, s29, 0x0
    s_xor_b32 s53, s29, 1024
    s_bfe_u32 s33, s22, 0x10000
    s_waitcnt lgkmcnt(0)
    s_branch L_chain_top2_f
.p2align 6
L_chain_top3_f:
    buffer_load_dwordx4 v[0:3], v117, s[8:11], s23 offen nt
    v_mov_b32 v48, 0
    v_mov_b32 v49, 0
    v_mov_b32 v50, 0
    v_mov_b32 v51, 0
    v_mov_b32 v52, 0
    v_mov_b32 v53, 0
    v_mov_b32 v15, 0
    v_mov_b32 v15, 0
    v_mov_b32 v15, 0
    v_mov_b32 v15, 0
    v_mov_b32 v15, 0
    v_mov_b32 v15, 0
    v_mov_b32 v15, 0
    v_mov_b32 v15, 0
    v_mov_b32 v15, 0
    v_mov_b32 v15, 0
    buffer_load_dwordx4 v[0:3], v117, s[8:11], s23 offen sc1
    s_waitcnt vmcnt(3)
    v_mov_b32 v36, 0
    v_mov_b32 v37, 0
    v_mov_b32 v38, 0
    v_mov_b32 v39, 0
    v_mov_b32 v40, 0
    v_mov_b32 v41, 0
    v_mov_b32 v42, 0
    v_mov_b32 v43, 0
    v_mov_b32 v44, 0
    v_mov_b32 v45, 0
    v_mov_b32 v46, 0
    v_mov_b32 v47, 0
    v_mov_b32 v15, 0
    v_mov_b32 v15, 0
    v_mov_b32 v15, 0
    v_mov_b32 v15, 0
L_mret_39:
    buffer_load_dwordx4 v[0:3], v117, s[8:11], s23 offen sc1
    s_add_u32 s45, s45, 1
    s_cmp_lt_u32 s45, 0x10000
    s_cselect_b32 s56, -2, -1
    s_nop 3
    v_mov_b32 v32, 0
    v_mov_b32 v33, 0
    v_mov_b32 v34, 0
    v_mov_b32 v35, 0
    s_waitcnt vmcnt(2)
    v_max3_u32 v15, v0, v1, v2
    v_max_u32 v15, v15, v3
    v_cmp_lt_u32 vcc, s56, v15
    v_smfmac_f32_16x16x64_bf16 v[32:35], v[0:3], v[80:87], v116
    s_cbranch_vccnz L_mret_39
    ds_write_b128 v117, v[0:3] offset:3072
    v_smfmac_f32_16x16x64_bf16 v[36:39], v[0:3], v[56:63], v116
    buffer_load_dwordx4 v[4:7], v117, s[8:11], s48 offen nt
    v_smfmac_f32_16x16x64_bf16 v[40:43], v[0:3], v[64:71], v116
    buffer_load_dwordx4 v117, s[8:11], s48 offen nt lds
    s_mov_b32 m0, 14336
    v_smfmac_f32_16x16x64_bf16 v[44:47], v[0:3], v[72:79], v116
    s_waitcnt lgkmcnt(0)
    s_barrier
    ds_read_b128 v[8:11], v117 offset:2048
    v_smfmac_f32_16x16x64_bf16 v[48:51], v[0:3], a[192:199], v116
    ds_read_b128 v[16:19], v117 offset:1024
    ds_read_b128 v[20:23], v117
    v_smfmac_f32_16x16x64_bf16 v[52:55], v[0:3], a[200:207], v116
    ds_read_b128 v[80:83], v117 offset:14336
    s_waitcnt lgkmcnt(3)
    v_smfmac_f32_16x16x64_bf16 v[32:35], v[8:11], a[0:7], v116
    ds_read_b128 v[84:87], v117 offset:15360
    v_smfmac_f32_16x16x64_bf16 v[36:39], v[8:11], a[8:15], v116
    ds_read_b128 v[56:59], v117 offset:8192
    s_waitcnt lgkmcnt(4)
    v_smfmac_f32_16x16x64_bf16 v[32:35], v[16:19], a[32:39], v116
    ds_read_b128 v[60:63], v117 offset:9216
    v_smfmac_f32_16x16x64_bf16 v[36:39], v[16:19], a[40:47], v116
    ds_read_b128 v[64:67], v117 offset:10240
    s_waitcnt lgkmcnt(5)
    v_smfmac_f32_16x16x64_bf16 v[32:35], v[20:23], a[64:71], v116
    ds_read_b128 v[68:71], v117 offset:11264
    v_smfmac_f32_16x16x64_bf16 v[36:39], v[20:23], a[72:79], v116
    ds_read_b128 v[72:75], v117 offset:12288
    v_smfmac_f32_16x16x64_bf16 v[40:43], v[8:11], a[96:103], v116
    ds_read_b128 v[76:79], v117 offset:13312
    v_smfmac_f32_16x16x64_bf16 v[40:43], v[16:19], a[128:135], v116
    buffer_store_dwordx4 v[112:115], v117, s[8:11], s32 offen sc1
    v_smfmac_f32_16x16x64_bf16 v[40:43], v[20:23], a[160:167], v116
    s_waitcnt vmcnt(2)
    v_max3_u32 v15, v4, v5, v6
    v_smfmac_f32_16x16x64_bf16 v[44:47], v[8:11], a[104:111], v116
    v_max_u32 v15, v15, v7
    v_smfmac_f32_16x16x64_bf16 v[44:47], v[16:19], a[136:143], v116
    s_waitcnt vmcnt(1) lgkmcnt(0)
    v_cmp_lt_u32 vcc, s56, v15
    v_smfmac_f32_16x16x64_bf16 v[44:47], v[20:23], a[168:175], v116
    s_cbranch_vccnz L_mret_40
L_mgo_41:
    v_smfmac_f32_16x16x64_bf16 v[44:47], v[4:7], v[24:31], v116
    s_barrier
    ds_read_b128 v[12:15], v117 offset:6144
    v_smfmac_f32_16x16x64_bf16 v[32:35], v[4:7], v[88:95], v116
    ds_read_b128 v[24:27], v117 offset:5120
    v_smfmac_f32_16x16x64_bf16 v[36:39], v[4:7], v[96:103], v116
    ds_read_b128 v[28:31], v117 offset:4096
    v_smfmac_f32_16x16x64_bf16 v[40:43], v[4:7], v[104:111], v116
    ds_read_b128 v[88:91], v117 offset:30720
    s_waitcnt lgkmcnt(3)
    v_smfmac_f32_16x16x64_bf16 v[32:35], v[12:15], a[16:23], v116
    ds_read_b128 v[92:95], v117 offset:31744
    s_waitcnt lgkmcnt(3)
    v_smfmac_f32_16x16x64_bf16 v[32:35], v[24:27], a[48:55], v116
    ds_read_b128 v[96:99], v117 offset:23552
    s_waitcnt lgkmcnt(3)
    v_smfmac_f32_16x16x64_bf16 v[32:35], v[28:31], a[80:87], v116
    buffer_load_dwordx4 v117, s[8:11], s30 offen lds
    v_smfmac_f32_16x16x64_bf16 v[36:39], v[12:15], a[24:31], v116
    ds_read_b128 v[100:103], v117 offset:23552
    v_smfmac_f32_16x16x64_bf16 v[36:39], v[24:27], a[56:63], v116
    ds_read_b128 v[104:107], v117 offset:23552
    v_add_f32 v32, v32, v34
    v_smfmac_f32_16x16x64_bf16 v[36:39], v[28:31], a[88:95], v116
    buffer_load_dwordx4 v117, s[8:11], s30 offen offset:1024 lds
    s_add_u32 m0, s52, 0x6000
    v_add_f32 v33, v33, v35
    v_smfmac_f32_16x16x64_bf16 v[40:43], v[12:15], a[112:119], v116
    ds_read_b128 v[108:111], v117 offset:23552
    v_mul_f32 v32, s34, v32
    v_smfmac_f32_16x16x64_bf16 v[40:43], v[24:27], a[144:151], v116
    ds_read_b128 v[0:3], v124
    v_mul_f32 v33, s34, v33
    v_smfmac_f32_16x16x64_bf16 v[40:43], v[28:31], a[176:183], v116
    s_waitcnt lgkmcnt(5)
    buffer_load_dwordx4 v117, s[8:11], s31 offen lds
    v_add_f32 v36, v36, v38
    v_smfmac_f32_16x16x64_bf16 v[48:51], v[4:7], a[208:215], v116
    v_add_f32 v37, v37, v39
    v_smfmac_f32_16x16x64_bf16 v[52:55], v[4:7], a[216:223], v116
    ds_read_b128 v[4:7], v124 offset:1024
    v_mul_f32 v36, s34, v36
    v_smfmac_f32_16x16x64_bf16 v[44:47], v[12:15], a[120:127], v116
    buffer_load_dwordx4 v117, s[8:11], s31 offen offset:1024 lds
    s_mov_b32 m0, 7168
    v_mul_f32 v37, s34, v37
    v_smfmac_f32_16x16x64_bf16 v[44:47], v[24:27], a[152:159], v116
    v_cvt_pk_bf16_f32 v34, v32, v36
    v_smfmac_f32_16x16x64_bf16 v[44:47], v[28:31], a[184:191], v116
    v_cvt_pk_bf16_f32 v35, v33, v37
    v_add_f32 v40, v40, v42
    v_smfmac_f32_16x16x64_bf16 v[48:51], v[8:11], a[224:231], v116
    ds_write2_b32 v120, v34, v35 offset0:32 offset1:48
    v_add_f32 v41, v41, v43
    v_smfmac_f32_16x16x64_bf16 v[52:55], v[8:11], a[232:239], v116
    v_add_f32 v44, v44, v46
    v_add_f32 v45, v45, v47
    v_cvt_pk_bf16_f32 v113, v40, v44
    v_cvt_pk_bf16_f32 v115, v41, v45
    v_smfmac_f32_16x16x64_bf16 v[48:51], v[12:15], a[240:247], v116
    ds_write2_b32 v120, v113, v115 offset0:0 offset1:16
    v_smfmac_f32_16x16x64_bf16 v[52:55], v[12:15], a[248:255], v116
    s_cmp_eq_u32 s22, 63
    s_cbranch_scc1 L_chain_last_f
    v_smfmac_f32_16x16x64_bf16 v[48:51], v[16:19], v[128:135], v116
    v_smfmac_f32_16x16x64_bf16 v[48:51], v[20:23], v[160:167], v116
    buffer_store_dword v126, v119, s[8:11], s55 offen
    v_smfmac_f32_16x16x64_bf16 v[48:51], v[24:27], v[144:151], v116
    s_waitcnt lgkmcnt(0)
    s_barrier
    v_smfmac_f32_16x16x64_bf16 v[48:51], v[28:31], v[176:183], v116
    ds_read_b128 v[32:35], v121 offset:16384
    ds_read_b128 v[36:39], v121 offset:17408
    v_smfmac_f32_16x16x64_bf16 v[52:55], v[16:19], v[136:143], v116
    ds_read_b128 v[40:43], v121 offset:18432
    ds_read_b128 v[44:47], v121 offset:19456
    v_smfmac_f32_16x16x64_bf16 v[52:55], v[20:23], v[168:175], v116
    ds_read_b128 v[8:11], v124 offset:32768
    v_add_f32 v48, v48, v50
    v_smfmac_f32_16x16x64_bf16 v[52:55], v[24:27], v[152:159], v116
    ds_read_b128 v[12:15], v124 offset:33792
    v_add_f32 v49, v49, v51
    v_smfmac_f32_16x16x64_bf16 v[52:55], v[28:31], v[184:191], v116
    s_waitcnt lgkmcnt(5)
    v_cvt_pk_bf16_f32 v112, v48, v49
    v_mfma_f32_16x16x32_bf16 v[56:59], v[56:59], v[32:35], 0
    s_waitcnt lgkmcnt(4)
    v_mov_b32 v48, s50
    v_mov_b32 v49, s50
    v_mfma_f32_16x16x32_bf16 v[56:59], v[60:63], v[36:39], v[56:59]
    ds_read_b128 v[16:19], v124 offset:2048
    s_waitcnt lgkmcnt(4)
    v_mov_b32 v50, s50
    v_mov_b32 v51, s50
    v_mfma_f32_16x16x32_bf16 v[56:59], v[64:67], v[40:43], v[56:59]
    ds_read_b128 v[20:23], v124 offset:3072
    s_waitcnt lgkmcnt(4)
    v_add_f32 v52, v52, v54
    v_mfma_f32_16x16x32_bf16 v[56:59], v[68:71], v[44:47], v[56:59]
    ds_read_b128 v[24:27], v124 offset:4096
    v_add_f32 v53, v53, v55
    v_mfma_f32_16x16x32_bf16 v[60:63], v[72:75], v[32:35], 0
    ds_read_b128 v[28:31], v124 offset:5120
    v_cvt_pk_bf16_f32 v114, v52, v53
    v_mov_b32 v53, 0
    v_mfma_f32_16x16x32_bf16 v[60:63], v[76:79], v[36:39], v[60:63]
    v_exp_f32 v56, v56
    v_mfma_f32_16x16x32_bf16 v[60:63], v[80:83], v[40:43], v[60:63]
    v_exp_f32 v57, v57
    v_mfma_f32_16x16x32_bf16 v[60:63], v[84:87], v[44:47], v[60:63]
    v_exp_f32 v58, v58
    v_mfma_f32_16x16x32_bf16 v[64:67], v[32:35], v[32:35], 0
    v_exp_f32 v59, v59
    v_cvt_pk_bf16_f32 v68, v56, v57
    v_mfma_f32_16x16x32_bf16 v[64:67], v[36:39], v[36:39], v[64:67]
    v_exp_f32 v60, v60
    v_cvt_pk_bf16_f32 v69, v58, v59
    v_mfma_f32_16x16x32_bf16 v[64:67], v[40:43], v[40:43], v[64:67]
    v_exp_f32 v61, v61
    v_mfma_f32_16x16x32_bf16 v[64:67], v[44:47], v[44:47], v[64:67]
    v_exp_f32 v62, v62
    v_exp_f32 v63, v63
    v_cvt_pk_bf16_f32 v70, v60, v61
    v_cvt_pk_bf16_f32 v71, v62, v63
    s_nop 1
    v_mfma_f32_16x16x32_bf16 v[72:75], v[88:91], v[68:71], 0
    s_nop 0
    v_exp_f32 v64, v64
    v_mfma_f32_16x16x32_bf16 v[76:79], v[92:95], v[68:71], 0
    v_exp_f32 v65, v65
    v_mfma_f32_16x16x32_bf16 v[80:83], v[48:51], v[68:71], 0
    v_cvt_pk_bf16_f32 v52, v64, v65
    s_nop 1
    v_mfma_f32_16x16x16_bf16 v[72:75], v[112:113], v[52:53], v[72:75]
    ds_read_b128 v[32:35], v124 offset:6144
    v_mfma_f32_16x16x16_bf16 v[76:79], v[114:115], v[52:53], v[76:79]
    ds_read_b128 v[36:39], v124 offset:7168
    v_mfma_f32_16x16x16_bf16 v[80:83], v[48:49], v[52:53], v[80:83]
L_norm_42:
    s_mov_b64 vcc, s[36:37]
    v_mov_b32 v122, v122
    v_mov_b32 v122, v122
    v_mov_b32 v122, v122
    v_cndmask_b32_dpp v76, v72, v76, vcc quad_perm:[2,3,2,3] row_mask:0xf bank_mask:0xf
    v_cndmask_b32_dpp v77, v73, v77, vcc quad_perm:[2,3,2,3] row_mask:0xf bank_mask:0xf
    v_cndmask_b32_dpp v78, v74, v78, vcc quad_perm:[2,3,2,3] row_mask:0xf bank_mask:0xf
    v_cndmask_b32_dpp v79, v75, v79, vcc quad_perm:[2,3,2,3] row_mask:0xf bank_mask:0xf
    v_rcp_f32_dpp v84, v80 quad_perm:[2,3,2,3] row_mask:0xf bank_mask:0xf
    s_nop 0
    v_pk_mul_f32 v[76:77], v[76:77], v[84:85] op_sel_hi:[1,0]
    v_pk_mul_f32 v[78:79], v[78:79], v[84:85] op_sel_hi:[1,0]
    v_cvt_pk_bf16_f32 v72, v76, v77
    v_cvt_pk_bf16_f32 v73, v78, v79
    ds_write_b64 v122, v[72:73] offset:22016
    v_max_f32_dpp v86, v80, v84 quad_perm:[2,3,2,3] row_mask:0xf bank_mask:0xf
    v_mov_b32_dpp v60, v72 quad_perm:[0,1,0,1] row_mask:0xf bank_mask:0xf
    v_mov_b32_dpp v61, v73 quad_perm:[0,1,0,1] row_mask:0xf bank_mask:0xf
    v_cmp_lt_f32 vcc, s35, v86
    v_mov_b32_dpp v62, v72 quad_perm:[2,3,2,3] row_mask:0xf bank_mask:0xf
    v_mov_b32_dpp v63, v73 quad_perm:[2,3,2,3] row_mask:0xf bank_mask:0xf
    s_nop 1
    v_smfmac_f32_16x16x64_bf16 v[96:99], v[60:63], v[192:199], v116
    s_cbranch_vccnz L_smax_43
    v_smfmac_f32_16x16x64_bf16 v[100:103], v[60:63], v[224:231], v116
    s_waitcnt lgkmcnt(0)
    s_barrier
    ds_read_b128 v[92:95], v127 offset:21504
    ds_read_b128 v[80:83], v127 offset:20992
    ds_read_b128 v[84:87], v127 offset:20480
    v_smfmac_f32_16x16x64_bf16 v[104:107], v[60:63], v[0:7], v116
    ds_read_b128 v[40:43], v124 offset:34816
    v_smfmac_f32_16x16x64_bf16 v[108:111], v[60:63], v[8:15], v116
    ds_read_b128 v[56:59], v124 offset:36864
    s_waitcnt lgkmcnt(4)
    v_smfmac_f32_16x16x64_bf16 v[96:99], v[92:95], v[200:207], v116
    s_waitcnt lgkmcnt(3)
    v_smfmac_f32_16x16x64_bf16 v[96:99], v[80:83], v[208:215], v116
    ds_read_b128 v[44:47], v124 offset:35840
    s_waitcnt lgkmcnt(3)
    v_smfmac_f32_16x16x64_bf16 v[96:99], v[84:87], v[216:223], v116
    ds_read_b128 v[68:71], v124 offset:39936
    v_smfmac_f32_16x16x64_bf16 v[100:103], v[92:95], v[232:239], v116
    ds_read_b128 v[64:67], v124 offset:38912
    v_smfmac_f32_16x16x64_bf16 v[100:103], v[80:83], v[240:247], v116
    ds_read_b128 v[60:63], v124 offset:37888
    v_cvt_pk_bf16_f32 v72, v96, v98
    v_smfmac_f32_16x16x64_bf16 v[100:103], v[84:87], v[248:255], v116
    v_and_or_b32 v72, v72, -2, s33
    v_smfmac_f32_16x16x64_bf16 v[104:107], v[92:95], v[16:23], v116
    v_cvt_pk_bf16_f32 v74, v97, v99
    v_smfmac_f32_16x16x64_bf16 v[104:107], v[80:83], v[24:31], v116
    v_cvt_pk_bf16_f32 v73, v100, v102
    v_cvt_pk_bf16_f32 v75, v101, v103
    v_smfmac_f32_16x16x64_bf16 v[104:107], v[84:87], v[32:39], v116
    buffer_store_dwordx4 v[72:75], v118, s[8:11], s25 offen
    s_waitcnt lgkmcnt(3)
    v_smfmac_f32_16x16x64_bf16 v[108:111], v[92:95], v[40:47], v116
    s_waitcnt lgkmcnt(0)
    v_smfmac_f32_16x16x64_bf16 v[108:111], v[80:83], v[56:63], v116
    v_cvt_pk_bf16_f32 v76, v104, v106
    v_smfmac_f32_16x16x64_bf16 v[108:111], v[84:87], v[64:71], v116
    v_and_or_b32 v76, v76, -2, s33
    v_cvt_pk_bf16_f32 v78, v105, v107
    v_mov_b32 v122, v122
    v_mov_b32 v122, v122
    v_mov_b32 v122, v122
    v_mov_b32 v122, v122
    v_mov_b32 v122, v122
    v_mov_b32 v122, v122
    v_cvt_pk_bf16_f32 v77, v108, v110
    v_cvt_pk_bf16_f32 v79, v109, v111
    buffer_store_dwordx4 v[76:79], v118, s[8:11], s26 offen
    ds_read_b128 v[80:83], v123
    ds_read_b128 v[84:87], v123 offset:1024
    ds_read_b128 v[56:59], v123 offset:2048
    ds_read_b128 v[60:63], v123 offset:3072
    ds_read_b128 v[64:67], v123 offset:32768
    ds_read_b128 v[68:71], v123 offset:33792
    ds_read_b128 v[72:75], v123 offset:34816
    ds_read_b128 v[76:79], v123 offset:35840
    ds_read_b128 v[88:91], v123 offset:4096
    ds_read_b128 v[92:95], v123 offset:5120
    ds_read_b128 v[96:99], v123 offset:6144
    ds_read_b128 v[100:103], v123 offset:7168
    ds_read_b128 v[104:107], v123 offset:36864
    ds_read_b128 v[108:111], v123 offset:37888
    ds_read_b128 v[24:27], v123 offset:38912
    ds_read_b128 v[28:31], v123 offset:39936
    s_add_u32 s30, s30, 0x40000
    s_add_u32 s31, s31, 0x40000
    s_add_u32 s32, s32, 0x20000
    s_add_u32 s23, s24, 3072
    s_add_u32 s48, s23, 4096
    s_xor_b32 s25, s25, 0x0
    s_xor_b32 s26, s26, 0x0
    s_mov_b32 s35, 0x49800000
    s_add_u32 s22, s22, 1
    v_cndmask_b32 v12, 0, v125, s[68:69]
    v_cndmask_b32 v13, 0, v125, s[70:71]
    v_cndmask_b32 v14, 0, v125, s[72:73]
    v_cndmask_b32 v15, 0, v125, s[74:75]
    v_mov_b32 v54, 0
    v_mov_b32 v55, 0
    v_mov_b32 v52, 0
    v_mov_b32 v52, 0
    v_mov_b32 v52, 0
    v_mov_b32 v52, 0
    v_mov_b32 v52, 0
    v_mov_b32 v52, 0
    v_mov_b32 v52, 0
    v_mov_b32 v52, 0
    v_mov_b32 v52, 0
    v_mov_b32 v52, 0
    v_mov_b32 v52, 0
    v_mov_b32 v52, 0
    v_mov_b32 v52, 0
    v_mov_b32 v52, 0
    v_mov_b32 v52, 0
    v_mov_b32 v52, 0
    v_mov_b32 v52, 0
    v_mov_b32 v52, 0
    v_mov_b32 v52, 0
    v_mov_b32 v52, 0
    v_mov_b32 v52, 0
    v_mov_b32 v52, 0
    v_mov_b32 v52, 0
    v_mov_b32 v52, 0
    v_mov_b32 v52, 0
    v_mov_b32 v52, 0
    v_mov_b32 v52, 0
    v_mov_b32 v52, 0
    v_mov_b32 v52, 0
    v_mov_b32 v52, 0
    v_mov_b32 v52, 0
    v_mov_b32 v52, 0
    v_mov_b32 v52, 0
    v_mov_b32 v52, 0
    v_mov_b32 v52, 0
    v_mov_b32 v52, 0
    v_mov_b32 v52, 0
    v_mov_b32 v52, 0
    v_mov_b32 v52, 0
    v_mov_b32 v52, 0
    v_mov_b32 v52, 0
    v_mov_b32 v52, 0
    v_mov_b32 v52, 0
    v_mov_b32 v52, 0
    v_mov_b32 v52, 0
    v_mov_b32 v52, 0
    v_mov_b32 v52, 0
    v_mov_b32 v52, 0
    v_mov_b32 v52, 0
    buffer_load_dwordx4 v[4:7], v117, s[8:11], s29 offen sc1
    buffer_load_dwordx4 v[8:11], v117, s[8:11], s53 offen sc1
    buffer_load_dwordx4 v[16:19], v117, s[8:11], s29 offen offset:2048 sc1
    buffer_load_dwordx4 v[20:23], v117, s[8:11], s53 offen offset:2048 sc1
    v_mov_b32 v52, 0
    v_mov_b32 v52, 0
    v_mov_b32 v52, 0
    v_mov_b32 v52, 0
    v_mov_b32 v52, 0
    v_mov_b32 v52, 0
    v_mov_b32 v52, 0
    v_mov_b32 v52, 0
    v_mov_b32 v52, 0
    v_mov_b32 v52, 0
    v_mov_b32 v52, 0
    v_mov_b32 v52, 0
    v_mov_b32 v52, 0
    v_mov_b32 v52, 0
    v_mov_b32 v52, 0
    v_mov_b32 v52, 0
    v_mov_b32 v52, 0
    v_mov_b32 v52, 0
    v_mov_b32 v52, 0
    v_mov_b32 v52, 0
    v_mov_b32 v52, 0
    v_mov_b32 v52, 0
    v_mov_b32 v52, 0
    v_mov_b32 v52, 0
    v_mov_b32 v52, 0
    v_mov_b32 v52, 0
    v_mov_b32 v52, 0
    v_mov_b32 v52, 0
    v_mov_b32 v52, 0
    v_mov_b32 v52, 0
    buffer_load_dwordx4 v[32:35], v117, s[8:11], s29 offen sc1
    buffer_load_dwordx4 v[36:39], v117, s[8:11], s53 offen sc1
    buffer_load_dwordx4 v[40:43], v117, s[8:11], s29 offen offset:2048 sc1
    buffer_load_dwordx4 v[44:47], v117, s[8:11], s53 offen offset:2048 sc1
    v_mov_b32 v52, 0
L_rl_44:
    s_waitcnt vmcnt(7)
    v_mfma_f32_16x16x32_bf16 v[48:51], v[4:7], v[12:15], 0
    v_xor_b32 v52, s33, v4
    s_waitcnt vmcnt(6)
    v_mfma_f32_16x16x32_bf16 v[48:51], v[8:11], v[12:15], v[48:51]
    v_xor_b32 v53, s33, v8
    v_or_b32 v52, v52, v53
    s_waitcnt vmcnt(5)
    v_mfma_f32_16x16x32_bf16 v[48:51], v[16:19], v[12:15], v[48:51]
    v_xor_b32 v53, s33, v16
    v_or_b32 v52, v52, v53
    s_waitcnt vmcnt(4)
    v_mfma_f32_16x16x32_bf16 v[48:51], v[20:23], v[12:15], v[48:51]
    v_xor_b32 v53, s33, v20
    v_or_b32 v52, v52, v53
    v_and_b32 v52, 1, v52
    v_cmp_ne_u32 vcc, 0, v52
    s_cbranch_vccnz L_rslow_45
L_rgo_46:
    s_nop 2
    v_permlane32_swap_b32 v48, v50
    v_permlane32_swap_b32 v49, v51
    v_pk_add_f32 v[48:49], v[48:49], v[50:51]
    s_mov_b64 exec, s[38:39]
    v_cvt_pk_bf16_f32 v12, v48, v49
    v_min_u32 v12, 0xfffffffe, v12
    buffer_store_dword v12, v119, s[8:11], s24 offen
    s_mov_b64 exec, -1
    s_add_u32 s24, s24, 8192
    s_bitset0_b32 s24, 15
    s_xor_b32 s55, s24, 16384
    s_xor_b32 s29, s29, 0x0
    s_xor_b32 s53, s29, 1024
    s_bfe_u32 s33, s22, 0x10000
    s_waitcnt lgkmcnt(0)
    s_branch L_chain_top3_f
L_chain_last_f:
    s_nop 1
    v_smfmac_f32_16x16x64_bf16 v[48:51], v[16:19], v[128:135], v116
    v_smfmac_f32_16x16x64_bf16 v[48:51], v[20:23], v[160:167], v116
    v_smfmac_f32_16x16x64_bf16 v[48:51], v[24:27], v[144:151], v116
    v_smfmac_f32_16x16x64_bf16 v[48:51], v[28:31], v[176:183], v116
    v_smfmac_f32_16x16x64_bf16 v[52:55], v[16:19], v[136:143], v116
    v_smfmac_f32_16x16x64_bf16 v[52:55], v[20:23], v[168:175], v116
    v_smfmac_f32_16x16x64_bf16 v[52:55], v[24:27], v[152:159], v116
    v_smfmac_f32_16x16x64_bf16 v[52:55], v[28:31], v[184:191], v116
    v_add_f32 v48, v48, v50
    v_add_f32 v49, v49, v51
    v_cvt_pk_bf16_f32 v112, v48, v49
    s_nop 4
    v_add_f32 v52, v52, v54
    v_add_f32 v53, v53, v55
    v_cvt_pk_bf16_f32 v114, v52, v53
    s_add_u32 s32, s32, 0x20000
    buffer_store_dwordx4 v[112:115], v117, s[8:11], s32 offen sc1
    v_mov_b32 v94, 64
    s_waitcnt vmcnt(0) lgkmcnt(0)
    s_barrier
    s_mov_b64 exec, 1
    buffer_store_dword v94, off, s[8:11], s44 sc1
    s_mov_b64 exec, -1
    s_endpgm
L_mret_18:
    s_mov_b32 s43, m0
    s_mov_b32 m0, 4096
    buffer_load_dwordx4 v[4:7], v117, s[8:11], s48 offen sc1
    buffer_load_dwordx4 v117, s[8:11], s48 offen sc1 lds
    s_mov_b32 m0, 8192
    s_mov_b32 m0, s43
    s_waitcnt vmcnt(0)
    v_max3_u32 v15, v4, v5, v6
    v_max_u32 v15, v15, v7
    v_cmp_lt_u32 vcc, s56, v15
    s_add_u32 s47, s47, 1
    s_add_u32 s49, s49, 1
    s_cmp_ge_u32 s49, 0x10000
    s_cbranch_scc1 L_mgo_19
    s_cbranch_vccnz L_mret_18
    s_branch L_mgo_19
L_smax_21:
    s_add_u32 s47, s47, 1
    s_mov_b32 s35, 0x7f800000
    s_waitcnt lgkmcnt(0)
    s_sub_u32 s43, s30, 0x40000
    s_add_u32 s40, s43, 4096
    s_nop 7
    buffer_load_dwordx4 v[56:59], v117, s[8:11], s43 offen
    buffer_load_dwordx4 v[60:63], v117, s[8:11], s43 offen offset:1024
    buffer_load_dwordx4 v[64:67], v117, s[8:11], s43 offen offset:2048
    buffer_load_dwordx4 v[68:71], v117, s[8:11], s43 offen offset:3072
    buffer_load_dwordx4 v[72:75], v117, s[8:11], s40 offen
    buffer_load_dwordx4 v[76:79], v117, s[8:11], s40 offen offset:1024
    buffer_load_dwordx4 v[80:83], v117, s[8:11], s40 offen offset:2048
    buffer_load_dwordx4 v[84:87], v117, s[8:11], s40 offen offset:3072
    ds_read_b128 v[32:35], v121 offset:16384
    ds_read_b128 v[36:39], v121 offset:17408
    ds_read_b128 v[40:43], v121 offset:18432
    ds_read_b128 v[44:47], v121 offset:19456
    v_mov_b32 v96, 0
    v_mov_b32 v97, 0
    v_mov_b32 v98, 0
    v_mov_b32 v99, 0
    v_mov_b32 v100, 0
    v_mov_b32 v101, 0
    v_mov_b32 v102, 0
    v_mov_b32 v103, 0
    v_mov_b32 v104, 0
    v_mov_b32 v105, 0
    v_mov_b32 v106, 0
    v_mov_b32 v107, 0
    v_mov_b32 v108, 0
    v_mov_b32 v109, 0
    v_mov_b32 v110, 0
    v_mov_b32 v111, 0
    s_waitcnt vmcnt(0) lgkmcnt(0)
    v_mfma_f32_16x16x32_bf16 v[56:59], v[56:59], v[32:35], 0
    v_mfma_f32_16x16x32_bf16 v[56:59], v[60:63], v[36:39], v[56:59]
    v_mfma_f32_16x16x32_bf16 v[56:59], v[64:67], v[40:43], v[56:59]
    v_mfma_f32_16x16x32_bf16 v[56:59], v[68:71], v[44:47], v[56:59]
    v_mfma_f32_16x16x32_bf16 v[60:63], v[72:75], v[32:35], 0
    v_mfma_f32_16x16x32_bf16 v[60:63], v[76:79], v[36:39], v[60:63]
    v_mfma_f32_16x16x32_bf16 v[60:63], v[80:83], v[40:43], v[60:63]
    v_mfma_f32_16x16x32_bf16 v[60:63], v[84:87], v[44:47], v[60:63]
    v_mfma_f32_16x16x32_bf16 v[64:67], v[32:35], v[32:35], 0
    v_mfma_f32_16x16x32_bf16 v[64:67], v[36:39], v[36:39], v[64:67]
    v_mfma_f32_16x16x32_bf16 v[64:67], v[40:43], v[40:43], v[64:67]
    v_mfma_f32_16x16x32_bf16 v[64:67], v[44:47], v[44:47], v[64:67]
    v_max3_f32 v84, v56, v57, v58
    v_max3_f32 v84, v84, v59, v60
    v_max3_f32 v84, v84, v61, v62
    s_nop 4
    v_max3_f32 v84, v84, v63, v64
    v_max_f32 v84, v84, v65
    v_mov_b32 v85, v84
    s_nop 1
    v_permlane32_swap_b32 v85, v84
    v_max_f32 v84, v85, v84
    v_mov_b32 v85, v84
    s_nop 1
    v_permlane16_swap_b32 v85, v84
    v_max_f32 v84, v85, v84
    v_sub_f32 v56, v56, v84
    v_sub_f32 v57, v57, v84
    v_sub_f32 v58, v58, v84
    v_sub_f32 v59, v59, v84
    v_sub_f32 v60, v60, v84
    v_sub_f32 v61, v61, v84
    v_sub_f32 v62, v62, v84
    v_sub_f32 v63, v63, v84
    v_sub_f32 v64, v64, v84
    v_sub_f32 v65, v65, v84
    v_exp_f32 v56, v56
    v_exp_f32 v57, v57
    v_exp_f32 v58, v58
    v_exp_f32 v59, v59
    v_exp_f32 v60, v60
    v_exp_f32 v61, v61
    v_exp_f32 v62, v62
    v_exp_f32 v63, v63
    v_exp_f32 v64, v64
    v_exp_f32 v65, v65
    v_cvt_pk_bf16_f32 v68, v56, v57
    v_cvt_pk_bf16_f32 v69, v58, v59
    v_cvt_pk_bf16_f32 v70, v60, v61
    v_cvt_pk_bf16_f32 v71, v62, v63
    v_cvt_pk_bf16_f32 v52, v64, v65
    s_nop 0
    v_mfma_f32_16x16x32_bf16 v[72:75], v[88:91], v[68:71], 0
    v_mfma_f32_16x16x32_bf16 v[76:79], v[92:95], v[68:71], 0
    v_mfma_f32_16x16x32_bf16 v[80:83], v[48:51], v[68:71], 0
    v_mfma_f32_16x16x16_bf16 v[72:75], v[112:113], v[52:53], v[72:75]
    v_mfma_f32_16x16x16_bf16 v[76:79], v[114:115], v[52:53], v[76:79]
    v_mfma_f32_16x16x16_bf16 v[80:83], v[48:49], v[52:53], v[80:83]
    ds_read_b128 v[32:35], v124 offset:6144
    ds_read_b128 v[36:39], v124 offset:7168
    ds_read_b128 v[40:43], v124 offset:34816
    ds_read_b128 v[44:47], v124 offset:35840
    ds_read_b128 v[56:59], v124 offset:36864
    ds_read_b128 v[64:67], v124 offset:38912
    ds_read_b128 v[68:71], v124 offset:39936
    s_waitcnt lgkmcnt(0)
    s_branch L_norm_20
L_kvw_22:
    s_add_u32 s47, s47, 1
    s_add_u32 s49, s49, 1
    s_cmp_ge_u32 s49, 0x10000
    s_cbranch_scc1 L_kvb_23
    s_sleep 4
    buffer_load_dword v125, v119, s[8:11], s28 offen sc1
    s_waitcnt vmcnt(0)
    v_cmp_eq_u32 vcc, 0, v125
    s_nop 0
    s_and_b64 vcc, vcc, s[58:59]
    s_cbranch_scc1 L_kvw_22
    s_branch L_kvb_23
L_mret_25:
    s_mov_b32 s43, m0
    s_mov_b32 m0, 5120
    buffer_load_dwordx4 v[4:7], v117, s[8:11], s48 offen sc1
    buffer_load_dwordx4 v117, s[8:11], s48 offen sc1 lds
    s_mov_b32 m0, 10240
    s_mov_b32 m0, s43
    s_waitcnt vmcnt(0)
    v_max3_u32 v15, v4, v5, v6
    v_max_u32 v15, v15, v7
    v_cmp_lt_u32 vcc, s56, v15
    s_add_u32 s47, s47, 1
    s_add_u32 s49, s49, 1
    s_cmp_ge_u32 s49, 0x10000
    s_cbranch_scc1 L_mgo_26
    s_cbranch_vccnz L_mret_25
    s_branch L_mgo_26
L_smax_28:
    s_add_u32 s47, s47, 1
    s_mov_b32 s35, 0x7f800000
    s_waitcnt lgkmcnt(0)
    s_sub_u32 s43, s30, 0x40800
    s_add_u32 s40, s43, 4096
    s_nop 7
    buffer_load_dwordx4 v[56:59], v117, s[8:11], s43 offen
    buffer_load_dwordx4 v[60:63], v117, s[8:11], s43 offen offset:1024
    buffer_load_dwordx4 v[64:67], v117, s[8:11], s43 offen offset:2048
    buffer_load_dwordx4 v[68:71], v117, s[8:11], s43 offen offset:3072
    buffer_load_dwordx4 v[72:75], v117, s[8:11], s40 offen
    buffer_load_dwordx4 v[76:79], v117, s[8:11], s40 offen offset:1024
    buffer_load_dwordx4 v[80:83], v117, s[8:11], s40 offen offset:2048
    buffer_load_dwordx4 v[84:87], v117, s[8:11], s40 offen offset:3072
    ds_read_b128 v[32:35], v121 offset:16384
    ds_read_b128 v[36:39], v121 offset:17408
    ds_read_b128 v[40:43], v121 offset:18432
    ds_read_b128 v[44:47], v121 offset:19456
    v_mov_b32 v96, 0
    v_mov_b32 v97, 0
    v_mov_b32 v98, 0
    v_mov_b32 v99, 0
    v_mov_b32 v100, 0
    v_mov_b32 v101, 0
    v_mov_b32 v102, 0
    v_mov_b32 v103, 0
    v_mov_b32 v104, 0
    v_mov_b32 v105, 0
    v_mov_b32 v106, 0
    v_mov_b32 v107, 0
    v_mov_b32 v108, 0
    v_mov_b32 v109, 0
    v_mov_b32 v110, 0
    v_mov_b32 v111, 0
    s_waitcnt vmcnt(0) lgkmcnt(0)
    v_mfma_f32_16x16x32_bf16 v[56:59], v[56:59], v[32:35], 0
    v_mfma_f32_16x16x32_bf16 v[56:59], v[60:63], v[36:39], v[56:59]
    v_mfma_f32_16x16x32_bf16 v[56:59], v[64:67], v[40:43], v[56:59]
    v_mfma_f32_16x16x32_bf16 v[56:59], v[68:71], v[44:47], v[56:59]
    v_mfma_f32_16x16x32_bf16 v[60:63], v[72:75], v[32:35], 0
    v_mfma_f32_16x16x32_bf16 v[60:63], v[76:79], v[36:39], v[60:63]
    v_mfma_f32_16x16x32_bf16 v[60:63], v[80:83], v[40:43], v[60:63]
    v_mfma_f32_16x16x32_bf16 v[60:63], v[84:87], v[44:47], v[60:63]
    v_mfma_f32_16x16x32_bf16 v[64:67], v[32:35], v[32:35], 0
    v_mfma_f32_16x16x32_bf16 v[64:67], v[36:39], v[36:39], v[64:67]
    v_mfma_f32_16x16x32_bf16 v[64:67], v[40:43], v[40:43], v[64:67]
    v_mfma_f32_16x16x32_bf16 v[64:67], v[44:47], v[44:47], v[64:67]
    v_max3_f32 v84, v56, v57, v58
    v_max3_f32 v84, v84, v59, v60
    v_max3_f32 v84, v84, v61, v62
    s_nop 4
    v_max3_f32 v84, v84, v63, v64
    v_max_f32 v84, v84, v65
    v_mov_b32 v85, v84
    s_nop 1
    v_permlane32_swap_b32 v85, v84
    v_max_f32 v84, v85, v84
    v_mov_b32 v85, v84
    s_nop 1
    v_permlane16_swap_b32 v85, v84
    v_max_f32 v84, v85, v84
    v_sub_f32 v56, v56, v84
    v_sub_f32 v57, v57, v84
    v_sub_f32 v58, v58, v84
    v_sub_f32 v59, v59, v84
    v_sub_f32 v60, v60, v84
    v_sub_f32 v61, v61, v84
    v_sub_f32 v62, v62, v84
    v_sub_f32 v63, v63, v84
    v_sub_f32 v64, v64, v84
    v_sub_f32 v65, v65, v84
    v_exp_f32 v56, v56
    v_exp_f32 v57, v57
    v_exp_f32 v58, v58
    v_exp_f32 v59, v59
    v_exp_f32 v60, v60
    v_exp_f32 v61, v61
    v_exp_f32 v62, v62
    v_exp_f32 v63, v63
    v_exp_f32 v64, v64
    v_exp_f32 v65, v65
    v_cvt_pk_bf16_f32 v68, v56, v57
    v_cvt_pk_bf16_f32 v69, v58, v59
    v_cvt_pk_bf16_f32 v70, v60, v61
    v_cvt_pk_bf16_f32 v71, v62, v63
    v_cvt_pk_bf16_f32 v52, v64, v65
    s_nop 0
    v_mfma_f32_16x16x32_bf16 v[72:75], v[88:91], v[68:71], 0
    v_mfma_f32_16x16x32_bf16 v[76:79], v[92:95], v[68:71], 0
    v_mfma_f32_16x16x32_bf16 v[80:83], v[48:51], v[68:71], 0
    v_mfma_f32_16x16x16_bf16 v[72:75], v[112:113], v[52:53], v[72:75]
    v_mfma_f32_16x16x16_bf16 v[76:79], v[114:115], v[52:53], v[76:79]
    v_mfma_f32_16x16x16_bf16 v[80:83], v[48:49], v[52:53], v[80:83]
    ds_read_b128 v[32:35], v124 offset:6144
    ds_read_b128 v[36:39], v124 offset:7168
    ds_read_b128 v[40:43], v124 offset:34816
    ds_read_b128 v[44:47], v124 offset:35840
    ds_read_b128 v[56:59], v124 offset:36864
    ds_read_b128 v[64:67], v124 offset:38912
    ds_read_b128 v[68:71], v124 offset:39936
    s_waitcnt lgkmcnt(0)
    s_branch L_norm_27
L_kvw_29:
    s_add_u32 s47, s47, 1
    s_add_u32 s49, s49, 1
    s_cmp_ge_u32 s49, 0x10000
    s_cbranch_scc1 L_kvb_30
    s_sleep 4
    buffer_load_dword v125, v119, s[8:11], s28 offen sc1
    s_waitcnt vmcnt(0)
    v_cmp_eq_u32 vcc, 0, v125
    s_nop 0
    s_and_b64 vcc, vcc, s[58:59]
    s_cbranch_scc1 L_kvw_29
    s_branch L_kvb_30
L_mret_32:
    s_mov_b32 s43, m0
    s_mov_b32 m0, 6144
    buffer_load_dwordx4 v[4:7], v117, s[8:11], s48 offen sc1
    buffer_load_dwordx4 v117, s[8:11], s48 offen sc1 lds
    s_mov_b32 m0, 12288
    s_mov_b32 m0, s43
    s_waitcnt vmcnt(0)
    v_max3_u32 v15, v4, v5, v6
    v_max_u32 v15, v15, v7
    v_cmp_lt_u32 vcc, s56, v15
    s_add_u32 s47, s47, 1
    s_add_u32 s49, s49, 1
    s_cmp_ge_u32 s49, 0x10000
    s_cbranch_scc1 L_mgo_33
    s_cbranch_vccnz L_mret_32
    s_branch L_mgo_33
L_smax_35:
    s_add_u32 s47, s47, 1
    s_mov_b32 s35, 0x7f800000
    s_waitcnt lgkmcnt(0)
    s_sub_u32 s43, s30, 0x41000
    s_add_u32 s40, s43, 4096
    s_nop 7
    buffer_load_dwordx4 v[56:59], v117, s[8:11], s43 offen
    buffer_load_dwordx4 v[60:63], v117, s[8:11], s43 offen offset:1024
    buffer_load_dwordx4 v[64:67], v117, s[8:11], s43 offen offset:2048
    buffer_load_dwordx4 v[68:71], v117, s[8:11], s43 offen offset:3072
    buffer_load_dwordx4 v[72:75], v117, s[8:11], s40 offen
    buffer_load_dwordx4 v[76:79], v117, s[8:11], s40 offen offset:1024
    buffer_load_dwordx4 v[80:83], v117, s[8:11], s40 offen offset:2048
    buffer_load_dwordx4 v[84:87], v117, s[8:11], s40 offen offset:3072
    ds_read_b128 v[32:35], v121 offset:16384
    ds_read_b128 v[36:39], v121 offset:17408
    ds_read_b128 v[40:43], v121 offset:18432
    ds_read_b128 v[44:47], v121 offset:19456
    v_mov_b32 v96, 0
    v_mov_b32 v97, 0
    v_mov_b32 v98, 0
    v_mov_b32 v99, 0
    v_mov_b32 v100, 0
    v_mov_b32 v101, 0
    v_mov_b32 v102, 0
    v_mov_b32 v103, 0
    v_mov_b32 v104, 0
    v_mov_b32 v105, 0
    v_mov_b32 v106, 0
    v_mov_b32 v107, 0
    v_mov_b32 v108, 0
    v_mov_b32 v109, 0
    v_mov_b32 v110, 0
    v_mov_b32 v111, 0
    s_waitcnt vmcnt(0) lgkmcnt(0)
    v_mfma_f32_16x16x32_bf16 v[56:59], v[56:59], v[32:35], 0
    v_mfma_f32_16x16x32_bf16 v[56:59], v[60:63], v[36:39], v[56:59]
    v_mfma_f32_16x16x32_bf16 v[56:59], v[64:67], v[40:43], v[56:59]
    v_mfma_f32_16x16x32_bf16 v[56:59], v[68:71], v[44:47], v[56:59]
    v_mfma_f32_16x16x32_bf16 v[60:63], v[72:75], v[32:35], 0
    v_mfma_f32_16x16x32_bf16 v[60:63], v[76:79], v[36:39], v[60:63]
    v_mfma_f32_16x16x32_bf16 v[60:63], v[80:83], v[40:43], v[60:63]
    v_mfma_f32_16x16x32_bf16 v[60:63], v[84:87], v[44:47], v[60:63]
    v_mfma_f32_16x16x32_bf16 v[64:67], v[32:35], v[32:35], 0
    v_mfma_f32_16x16x32_bf16 v[64:67], v[36:39], v[36:39], v[64:67]
    v_mfma_f32_16x16x32_bf16 v[64:67], v[40:43], v[40:43], v[64:67]
    v_mfma_f32_16x16x32_bf16 v[64:67], v[44:47], v[44:47], v[64:67]
    v_max3_f32 v84, v56, v57, v58
    v_max3_f32 v84, v84, v59, v60
    v_max3_f32 v84, v84, v61, v62
    s_nop 4
    v_max3_f32 v84, v84, v63, v64
    v_max_f32 v84, v84, v65
    v_mov_b32 v85, v84
    s_nop 1
    v_permlane32_swap_b32 v85, v84
    v_max_f32 v84, v85, v84
    v_mov_b32 v85, v84
    s_nop 1
    v_permlane16_swap_b32 v85, v84
    v_max_f32 v84, v85, v84
    v_sub_f32 v56, v56, v84
    v_sub_f32 v57, v57, v84
    v_sub_f32 v58, v58, v84
    v_sub_f32 v59, v59, v84
    v_sub_f32 v60, v60, v84
    v_sub_f32 v61, v61, v84
    v_sub_f32 v62, v62, v84
    v_sub_f32 v63, v63, v84
    v_sub_f32 v64, v64, v84
    v_sub_f32 v65, v65, v84
    v_exp_f32 v56, v56
    v_exp_f32 v57, v57
    v_exp_f32 v58, v58
    v_exp_f32 v59, v59
    v_exp_f32 v60, v60
    v_exp_f32 v61, v61
    v_exp_f32 v62, v62
    v_exp_f32 v63, v63
    v_exp_f32 v64, v64
    v_exp_f32 v65, v65
    v_cvt_pk_bf16_f32 v68, v56, v57
    v_cvt_pk_bf16_f32 v69, v58, v59
    v_cvt_pk_bf16_f32 v70, v60, v61
    v_cvt_pk_bf16_f32 v71, v62, v63
    v_cvt_pk_bf16_f32 v52, v64, v65
    s_nop 0
    v_mfma_f32_16x16x32_bf16 v[72:75], v[88:91], v[68:71], 0
    v_mfma_f32_16x16x32_bf16 v[76:79], v[92:95], v[68:71], 0
    v_mfma_f32_16x16x32_bf16 v[80:83], v[48:51], v[68:71], 0
    v_mfma_f32_16x16x16_bf16 v[72:75], v[112:113], v[52:53], v[72:75]
    v_mfma_f32_16x16x16_bf16 v[76:79], v[114:115], v[52:53], v[76:79]
    v_mfma_f32_16x16x16_bf16 v[80:83], v[48:49], v[52:53], v[80:83]
    ds_read_b128 v[32:35], v124 offset:6144
    ds_read_b128 v[36:39], v124 offset:7168
    ds_read_b128 v[40:43], v124 offset:34816
    ds_read_b128 v[44:47], v124 offset:35840
    ds_read_b128 v[56:59], v124 offset:36864
    ds_read_b128 v[64:67], v124 offset:38912
    ds_read_b128 v[68:71], v124 offset:39936
    s_waitcnt lgkmcnt(0)
    s_branch L_norm_34
L_rslow_37:
    buffer_load_dwordx4 v[4:7], v117, s[8:11], s29 offen sc1
    buffer_load_dwordx4 v[8:11], v117, s[8:11], s53 offen sc1
    buffer_load_dwordx4 v[16:19], v117, s[8:11], s29 offen offset:2048 sc1
    buffer_load_dwordx4 v[20:23], v117, s[8:11], s53 offen offset:2048 sc1
    s_add_u32 s46, s46, 1
    s_add_u32 s49, s49, 1
    s_cmp_ge_u32 s49, 0x10000
    s_cbranch_scc1 L_rgo_38
    s_waitcnt vmcnt(7)
    v_mfma_f32_16x16x32_bf16 v[48:51], v[32:35], v[12:15], 0
    v_xor_b32 v52, s33, v32
    s_waitcnt vmcnt(6)
    v_mfma_f32_16x16x32_bf16 v[48:51], v[36:39], v[12:15], v[48:51]
    v_xor_b32 v53, s33, v36
    v_or_b32 v52, v52, v53
    s_waitcnt vmcnt(5)
    v_mfma_f32_16x16x32_bf16 v[48:51], v[40:43], v[12:15], v[48:51]
    v_xor_b32 v53, s33, v40
    v_or_b32 v52, v52, v53
    s_waitcnt vmcnt(4)
    v_mfma_f32_16x16x32_bf16 v[48:51], v[44:47], v[12:15], v[48:51]
    v_xor_b32 v53, s33, v44
    v_or_b32 v52, v52, v53
    v_and_b32 v52, 1, v52
    v_cmp_ne_u32 vcc, 0, v52
    s_cbranch_vccz L_rgo_38
    buffer_load_dwordx4 v[32:35], v117, s[8:11], s29 offen sc1
    buffer_load_dwordx4 v[36:39], v117, s[8:11], s53 offen sc1
    buffer_load_dwordx4 v[40:43], v117, s[8:11], s29 offen offset:2048 sc1
    buffer_load_dwordx4 v[44:47], v117, s[8:11], s53 offen offset:2048 sc1
    s_add_u32 s46, s46, 1
    s_branch L_rl_36
L_mret_40:
    s_mov_b32 s43, m0
    s_mov_b32 m0, 7168
    buffer_load_dwordx4 v[4:7], v117, s[8:11], s48 offen sc1
    buffer_load_dwordx4 v117, s[8:11], s48 offen sc1 lds
    s_mov_b32 m0, 14336
    s_mov_b32 m0, s43
    s_waitcnt vmcnt(0)
    v_max3_u32 v15, v4, v5, v6
    v_max_u32 v15, v15, v7
    v_cmp_lt_u32 vcc, s56, v15
    s_add_u32 s47, s47, 1
    s_add_u32 s49, s49, 1
    s_cmp_ge_u32 s49, 0x10000
    s_cbranch_scc1 L_mgo_41
    s_cbranch_vccnz L_mret_40
    s_branch L_mgo_41
L_smax_43:
    s_add_u32 s47, s47, 1
    s_mov_b32 s35, 0x7f800000
    s_waitcnt lgkmcnt(0)
    s_sub_u32 s43, s30, 0x41800
    s_add_u32 s40, s43, 4096
    s_nop 7
    buffer_load_dwordx4 v[56:59], v117, s[8:11], s43 offen
    buffer_load_dwordx4 v[60:63], v117, s[8:11], s43 offen offset:1024
    buffer_load_dwordx4 v[64:67], v117, s[8:11], s43 offen offset:2048
    buffer_load_dwordx4 v[68:71], v117, s[8:11], s43 offen offset:3072
    buffer_load_dwordx4 v[72:75], v117, s[8:11], s40 offen
    buffer_load_dwordx4 v[76:79], v117, s[8:11], s40 offen offset:1024
    buffer_load_dwordx4 v[80:83], v117, s[8:11], s40 offen offset:2048
    buffer_load_dwordx4 v[84:87], v117, s[8:11], s40 offen offset:3072
    ds_read_b128 v[32:35], v121 offset:16384
    ds_read_b128 v[36:39], v121 offset:17408
    ds_read_b128 v[40:43], v121 offset:18432
    ds_read_b128 v[44:47], v121 offset:19456
    v_mov_b32 v96, 0
    v_mov_b32 v97, 0
    v_mov_b32 v98, 0
    v_mov_b32 v99, 0
    v_mov_b32 v100, 0
    v_mov_b32 v101, 0
    v_mov_b32 v102, 0
    v_mov_b32 v103, 0
    v_mov_b32 v104, 0
    v_mov_b32 v105, 0
    v_mov_b32 v106, 0
    v_mov_b32 v107, 0
    v_mov_b32 v108, 0
    v_mov_b32 v109, 0
    v_mov_b32 v110, 0
    v_mov_b32 v111, 0
    s_waitcnt vmcnt(0) lgkmcnt(0)
    v_mfma_f32_16x16x32_bf16 v[56:59], v[56:59], v[32:35], 0
    v_mfma_f32_16x16x32_bf16 v[56:59], v[60:63], v[36:39], v[56:59]
    v_mfma_f32_16x16x32_bf16 v[56:59], v[64:67], v[40:43], v[56:59]
    v_mfma_f32_16x16x32_bf16 v[56:59], v[68:71], v[44:47], v[56:59]
    v_mfma_f32_16x16x32_bf16 v[60:63], v[72:75], v[32:35], 0
    v_mfma_f32_16x16x32_bf16 v[60:63], v[76:79], v[36:39], v[60:63]
    v_mfma_f32_16x16x32_bf16 v[60:63], v[80:83], v[40:43], v[60:63]
    v_mfma_f32_16x16x32_bf16 v[60:63], v[84:87], v[44:47], v[60:63]
    v_mfma_f32_16x16x32_bf16 v[64:67], v[32:35], v[32:35], 0
    v_mfma_f32_16x16x32_bf16 v[64:67], v[36:39], v[36:39], v[64:67]
    v_mfma_f32_16x16x32_bf16 v[64:67], v[40:43], v[40:43], v[64:67]
    v_mfma_f32_16x16x32_bf16 v[64:67], v[44:47], v[44:47], v[64:67]
    v_max3_f32 v84, v56, v57, v58
    v_max3_f32 v84, v84, v59, v60
    v_max3_f32 v84, v84, v61, v62
    s_nop 4
    v_max3_f32 v84, v84, v63, v64
    v_max_f32 v84, v84, v65
    v_mov_b32 v85, v84
    s_nop 1
    v_permlane32_swap_b32 v85, v84
    v_max_f32 v84, v85, v84
    v_mov_b32 v85, v84
    s_nop 1
    v_permlane16_swap_b32 v85, v84
    v_max_f32 v84, v85, v84
    v_sub_f32 v56, v56, v84
    v_sub_f32 v57, v57, v84
    v_sub_f32 v58, v58, v84
    v_sub_f32 v59, v59, v84
    v_sub_f32 v60, v60, v84
    v_sub_f32 v61, v61, v84
    v_sub_f32 v62, v62, v84
    v_sub_f32 v63, v63, v84
    v_sub_f32 v64, v64, v84
    v_sub_f32 v65, v65, v84
    v_exp_f32 v56, v56
    v_exp_f32 v57, v57
    v_exp_f32 v58, v58
    v_exp_f32 v59, v59
    v_exp_f32 v60, v60
    v_exp_f32 v61, v61
    v_exp_f32 v62, v62
    v_exp_f32 v63, v63
    v_exp_f32 v64, v64
    v_exp_f32 v65, v65
    v_cvt_pk_bf16_f32 v68, v56, v57
    v_cvt_pk_bf16_f32 v69, v58, v59
    v_cvt_pk_bf16_f32 v70, v60, v61
    v_cvt_pk_bf16_f32 v71, v62, v63
    v_cvt_pk_bf16_f32 v52, v64, v65
    s_nop 0
    v_mfma_f32_16x16x32_bf16 v[72:75], v[88:91], v[68:71], 0
    v_mfma_f32_16x16x32_bf16 v[76:79], v[92:95], v[68:71], 0
    v_mfma_f32_16x16x32_bf16 v[80:83], v[48:51], v[68:71], 0
    v_mfma_f32_16x16x16_bf16 v[72:75], v[112:113], v[52:53], v[72:75]
    v_mfma_f32_16x16x16_bf16 v[76:79], v[114:115], v[52:53], v[76:79]
    v_mfma_f32_16x16x16_bf16 v[80:83], v[48:49], v[52:53], v[80:83]
    ds_read_b128 v[32:35], v124 offset:6144
    ds_read_b128 v[36:39], v124 offset:7168
    ds_read_b128 v[40:43], v124 offset:34816
    ds_read_b128 v[44:47], v124 offset:35840
    ds_read_b128 v[56:59], v124 offset:36864
    ds_read_b128 v[64:67], v124 offset:38912
    ds_read_b128 v[68:71], v124 offset:39936
    s_waitcnt lgkmcnt(0)
    s_branch L_norm_42
L_rslow_45:
    buffer_load_dwordx4 v[4:7], v117, s[8:11], s29 offen sc1
    buffer_load_dwordx4 v[8:11], v117, s[8:11], s53 offen sc1
    buffer_load_dwordx4 v[16:19], v117, s[8:11], s29 offen offset:2048 sc1
    buffer_load_dwordx4 v[20:23], v117, s[8:11], s53 offen offset:2048 sc1
    s_add_u32 s46, s46, 1
    s_add_u32 s49, s49, 1
    s_cmp_ge_u32 s49, 0x10000
    s_cbranch_scc1 L_rgo_46
    s_waitcnt vmcnt(7)
    v_mfma_f32_16x16x32_bf16 v[48:51], v[32:35], v[12:15], 0
    v_xor_b32 v52, s33, v32
    s_waitcnt vmcnt(6)
    v_mfma_f32_16x16x32_bf16 v[48:51], v[36:39], v[12:15], v[48:51]
    v_xor_b32 v53, s33, v36
    v_or_b32 v52, v52, v53
    s_waitcnt vmcnt(5)
    v_mfma_f32_16x16x32_bf16 v[48:51], v[40:43], v[12:15], v[48:51]
    v_xor_b32 v53, s33, v40
    v_or_b32 v52, v52, v53
    s_waitcnt vmcnt(4)
    v_mfma_f32_16x16x32_bf16 v[48:51], v[44:47], v[12:15], v[48:51]
    v_xor_b32 v53, s33, v44
    v_or_b32 v52, v52, v53
    v_and_b32 v52, 1, v52
    v_cmp_ne_u32 vcc, 0, v52
    s_cbranch_vccz L_rgo_46
    buffer_load_dwordx4 v[32:35], v117, s[8:11], s29 offen sc1
    buffer_load_dwordx4 v[36:39], v117, s[8:11], s53 offen sc1
    buffer_load_dwordx4 v[40:43], v117, s[8:11], s29 offen offset:2048 sc1
    buffer_load_dwordx4 v[44:47], v117, s[8:11], s53 offen offset:2048 sc1
    s_add_u32 s46, s46, 1
    s_branch L_rl_44
L_zero:
    s_waitcnt lgkmcnt(0)
    s_and_b32 s9, s9, 0xffff
    s_mov_b32 s10, 0x10000000
    s_mov_b32 s11, 0x20000
    s_and_b32 s93, s93, 0xffff
    s_mov_b32 s94, 0x100
    s_mov_b32 s95, 0x20000
    s_mov_b32 s87, 0
    s_cmp_lg_u32 s86, 0
    s_cbranch_scc1 L_reg_47
    s_lshl_b32 s97, s84, 4
    s_lshl_b32 s96, 1, s85
    v_mov_b32 v250, s96
    v_mov_b32 v251, 256
    s_mov_b64 exec, 1
    buffer_atomic_add_x2 v[250:251], off, s[92:95], s97 offset:64
    s_mov_b64 exec, -1
    s_mov_b32 s86, 1
L_reg_47:
    v_mov_b32 v4, 0
    v_mov_b32 v5, 0
    v_mov_b32 v6, 0
    v_mov_b32 v7, 0
    v_lshlrev_b32 v1, 4, v0
    s_mov_b32 s97, 0x0
    buffer_store_dwordx4 v[4:7], v1, s[8:11], s97 offen sc1
    s_mov_b32 s97, 0x1000
    buffer_store_dwordx4 v[4:7], v1, s[8:11], s97 offen sc1
    s_mov_b32 s97, 0x2000
    buffer_store_dwordx4 v[4:7], v1, s[8:11], s97 offen sc1
    s_mov_b32 s97, 0x3000
    buffer_store_dwordx4 v[4:7], v1, s[8:11], s97 offen sc1
    s_mov_b32 s97, 0x4000
    buffer_store_dwordx4 v[4:7], v1, s[8:11], s97 offen sc1
    s_mov_b32 s97, 0x5000
    buffer_store_dwordx4 v[4:7], v1, s[8:11], s97 offen sc1
    s_mov_b32 s97, 0x6000
    buffer_store_dwordx4 v[4:7], v1, s[8:11], s97 offen sc1
    s_mov_b32 s97, 0x7000
    buffer_store_dwordx4 v[4:7], v1, s[8:11], s97 offen sc1
    s_mov_b32 s97, 0x8000
    buffer_store_dwordx4 v[4:7], v1, s[8:11], s97 offen sc1
    s_mov_b32 s97, 0x9000
    buffer_store_dwordx4 v[4:7], v1, s[8:11], s97 offen sc1
    s_mov_b32 s97, 0xa000
    buffer_store_dwordx4 v[4:7], v1, s[8:11], s97 offen sc1
    s_waitcnt vmcnt(0)
    s_barrier
    s_cmp_lg_u32 s100, 0
    s_cbranch_scc1 L_flag_48
    v_mov_b32 v2, 1
    s_mov_b64 exec, 1
    buffer_store_dword v2, off, s[92:95], 40 sc1
    s_mov_b64 exec, -1
L_flag_48:
    s_cmp_lg_u32 s100, 0
    s_cbranch_scc1 L_noz
    s_mov_b64 exec, 0xff
    s_mov_b32 s96, 0
L_count:
    buffer_load_dwordx2 v[2:3], v1, s[92:95], 0 offen offset:64 sc1
    s_waitcnt vmcnt(0)
    v_cmp_le_u32 vcc, 8192, v3
    v_add_u32 v2, 1, v2
    v_xor_b32 v3, 8192, v3
    v_or_b32 v2, v2, v3
    s_mov_b32 s4, vcc_lo
    v_cmp_eq_u32 vcc, 0, v2
    v_mov_b32 v2, 1
    s_nop 1
    s_cmp_eq_u32 vcc_lo, 0xff
    s_cbranch_scc1 L_propose
    v_mov_b32 v2, 2
    s_andn2_b32 s4, s4, vcc_lo
    s_cbranch_scc1 L_propose
    s_sleep 2
    s_add_u32 s96, s96, 1
    s_cmp_lt_u32 s96, 0x100
    s_cbranch_scc1 L_count
L_propose:
    v_mov_b32 v3, 0
    s_mov_b64 exec, 1
    buffer_atomic_cmpswap v[2:3], off, s[92:95], 0 offset:36
    s_mov_b64 exec, -1
    s_branch L_noz
L_fallback:
    s_mov_b32 s87, 2
    s_waitcnt vmcnt(0) lgkmcnt(0)
    s_barrier
    v_mbcnt_lo_u32_b32 v0, -1, 0
    v_mbcnt_hi_u32_b32 v0, -1, v0
    s_lshl_b32 s96, s100, 6
    v_add_u32 v0, s96, v0
    s_mov_b32 s97, 44
    s_cmp_lg_u32 s100, 0
    s_cbranch_scc1 L_at_49
    s_mov_b64 exec, 1
    v_mov_b32 v2, 1
    buffer_atomic_add v2, off, s[92:95], s97 sc0
    s_mov_b64 exec, -1
L_at_49:
    s_cmp_lg_u32 s100, 0
    s_cbranch_scc1 L_at2_50
    s_mov_b64 exec, 1
    v_mov_b32 v1, 8
    s_waitcnt vmcnt(0)
    ds_write_b32 v1, v2
    s_waitcnt lgkmcnt(0)
    s_mov_b64 exec, -1
L_at2_50:
    s_barrier
    v_mov_b32 v1, 8
    ds_read_b32 v2, v1
    s_waitcnt lgkmcnt(0)
    v_readfirstlane_b32 s85, v2
    s_barrier
    s_sub_u32 s101, s85, 32
    s_cmp_ge_u32 s85, 32
    s_cbranch_scc1 L_bulk
    s_mov_b32 s20, s85
    v_lshrrev_b32 v4, 6, v0
    s_nop 0
    v_readfirstlane_b32 s21, v4
    v_and_b32 v1, 63, v0
    v_lshrrev_b32 v2, 4, v1
    v_and_b32 v3, 15, v1
    v_lshrrev_b32 v6, 2, v3
    v_lshlrev_b32 v117, 4, v1
    s_lshl_b32 s51, s21, 10
    s_lshl_b32 s52, s21, 11
    s_load_dwordx8 s[60:67], s[0:1], 16
    s_mov_b32 s14, 0x400000
    s_mov_b32 s15, 0x20000
    s_lshl_b32 s41, s20, 8
    s_lshl_b32 s42, s20, 17
    s_lshr_b32 s43, s21, 1
    s_lshl_b32 s43, s43, 2
    v_or_b32 v5, s43, v2
    v_lshlrev_b32 v5, 1, v5
    v_xor_b32 v5, v5, v3
    v_lshrrev_b32 v14, 2, v5
    v_and_b32 v14, 2, v14
    v_lshlrev_b32 v5, 4, v5
    s_lshl_b32 s43, s21, 4
    v_add_u32 v4, s43, v2
    v_lshl_add_u32 v8, v4, 13, v5
    s_waitcnt lgkmcnt(0)
    s_mov_b32 s16, s92
    s_mov_b32 s17, s93
    s_mov_b32 s18, s94
    s_mov_b32 s19, s95
    s_mov_b32 s88, s20
    s_mov_b32 s12, s60
    s_and_b32 s13, s61, 0xffff
    v_xor_b32 v15, 0, v14
    v_lshl_add_u32 v15, v15, 15, v8
    s_add_u32 s43, s41, 0x0
    s_add_u32 m0, s51, 0x8000
    s_nop 0
    buffer_load_dwordx4 v15, s[12:15], s43 offen nt lds
    s_add_u32 s43, s41, 0x8000
    s_add_u32 m0, s51, 0x9000
    s_nop 0
    buffer_load_dwordx4 v15, s[12:15], s43 offen nt lds
    s_add_u32 s43, s41, 0x100000
    s_add_u32 m0, s51, 0xa000
    s_nop 0
    buffer_load_dwordx4 v15, s[12:15], s43 offen nt lds
    s_add_u32 s43, s41, 0x108000
    s_add_u32 m0, s51, 0xb000
    s_nop 0
    buffer_load_dwordx4 v15, s[12:15], s43 offen nt lds
    s_add_u32 s43, s41, 0x200000
    s_add_u32 m0, s51, 0xc000
    s_nop 0
    buffer_load_dwordx4 v15, s[12:15], s43 offen nt lds
    s_add_u32 s43, s41, 0x208000
    s_add_u32 m0, s51, 0xd000
    s_nop 0
    buffer_load_dwordx4 v15, s[12:15], s43 offen nt lds
    s_add_u32 s43, s41, 0x300000
    s_add_u32 m0, s51, 0xe000
    s_nop 0
    buffer_load_dwordx4 v15, s[12:15], s43 offen nt lds
    s_add_u32 s43, s41, 0x308000
    s_add_u32 m0, s51, 0xf000
    s_nop 0
    buffer_load_dwordx4 v15, s[12:15], s43 offen nt lds
    v_xor_b32 v15, 2, v14
    v_lshl_add_u32 v15, v15, 15, v8
    s_add_u32 s43, s41, 0x0
    s_add_u32 m0, s51, 0x10000
    s_nop 0
    buffer_load_dwordx4 v15, s[12:15], s43 offen nt lds
    s_add_u32 s43, s41, 0x8000
    s_add_u32 m0, s51, 0x11000
    s_nop 0
    buffer_load_dwordx4 v15, s[12:15], s43 offen nt lds
    s_add_u32 s43, s41, 0x100000
    s_add_u32 m0, s51, 0x12000
    s_nop 0
    buffer_load_dwordx4 v15, s[12:15], s43 offen nt lds
    s_add_u32 s43, s41, 0x108000
    s_add_u32 m0, s51, 0x13000
    s_nop 0
    buffer_load_dwordx4 v15, s[12:15], s43 offen nt lds
    s_add_u32 s43, s41, 0x200000
    s_add_u32 m0, s51, 0x14000
    s_nop 0
    buffer_load_dwordx4 v15, s[12:15], s43 offen nt lds
    s_add_u32 s43, s41, 0x208000
    s_add_u32 m0, s51, 0x15000
    s_nop 0
    buffer_load_dwordx4 v15, s[12:15], s43 offen nt lds
    s_add_u32 s43, s41, 0x300000
    s_add_u32 m0, s51, 0x16000
    s_nop 0
    buffer_load_dwordx4 v15, s[12:15], s43 offen nt lds
    s_add_u32 s43, s41, 0x308000
    s_add_u32 m0, s51, 0x17000
    s_nop 0
    buffer_load_dwordx4 v15, s[12:15], s43 offen nt lds
    v_xor_b32 v15, 0, v14
    v_lshl_add_u32 v15, v15, 15, v8
    s_add_u32 s43, s41, 0x80000
    s_add_u32 m0, s51, 0x18000
    s_nop 0
    buffer_load_dwordx4 v15, s[12:15], s43 offen nt lds
    s_add_u32 s43, s41, 0x88000
    s_add_u32 m0, s51, 0x19000
    s_nop 0
    buffer_load_dwordx4 v15, s[12:15], s43 offen nt lds
    s_add_u32 s43, s41, 0x180000
    s_add_u32 m0, s51, 0x1a000
    s_nop 0
    buffer_load_dwordx4 v15, s[12:15], s43 offen nt lds
    s_add_u32 s43, s41, 0x188000
    s_add_u32 m0, s51, 0x1b000
    s_nop 0
    buffer_load_dwordx4 v15, s[12:15], s43 offen nt lds
    v_and_b32 v4, 2, v3
    v_cmp_ne_u32 vcc, 0, v4
    v_mov_b32 v4, 0x4444
    v_mov_b32 v5, 0xeeee
    v_cndmask_b32 v116, v4, v5, vcc
    v_lshrrev_b32 v5, 1, v2
    v_lshl_add_u32 v4, v6, 3, v5
    s_lshl_b32 s43, s21, 1
    v_add_u32 v4, s43, v4
    v_add_u32 v5, s20, v4
    v_and_b32 v5, 31, v5
    v_lshl_add_u32 v4, v4, 6, v5
    v_and_b32 v5, 1, v2
    v_lshl_add_u32 v4, v4, 1, v5
    v_and_b32 v5, 3, v3
    v_lshl_add_u32 v4, v4, 2, v5
    v_lshlrev_b32 v118, 4, v4
    v_and_b32 v4, 1, v2
    v_lshlrev_b32 v4, 2, v4
    v_and_b32 v7, 2, v2
    v_add_u32 v4, v4, v7
    v_and_b32 v7, 1, v6
    v_add_u32 v4, v4, v7
    v_lshl_add_u32 v4, v4, 2, v5
    v_lshlrev_b32 v4, 2, v4
    s_and_b32 s43, s21, 1
    s_lshl_b32 s43, s43, 12
    s_lshl_b32 s40, s20, 7
    s_add_u32 s43, s43, s40
    v_add_u32 v119, s43, v4
    v_sub_u32 v7, 0, v2
    v_and_b32 v7, 3, v7
    v_xor_b32 v7, v7, v6
    v_lshl_add_u32 v4, v2, 4, v7
    v_and_b32 v5, 3, v3
    v_lshl_add_u32 v4, v4, 2, v5
    s_add_u32 s43, s51, 16384
    v_lshl_add_u32 v120, v4, 2, s43
    v_sub_u32 v7, 0, v6
    v_and_b32 v7, 3, v7
    v_xor_b32 v7, v7, v2
    v_lshl_add_u32 v4, v3, 2, v7
    v_lshlrev_b32 v121, 4, v4
    v_and_b32 v5, 1, v3
    v_lshl_add_u32 v4, v6, 1, v5
    v_lshl_add_u32 v4, v2, 3, v4
    v_lshlrev_b32 v127, 4, v4
    v_and_or_b32 v122, v116, 8, v127
    s_lshl_b32 s43, s21, 13
    s_add_u32 s43, s43, 32768
    v_add_u32 v123, s43, v117
    v_add_u32 v124, 0x10000, v123
    s_mov_b32 s36, 0xcccccccc
    s_mov_b32 s37, 0xcccccccc
    s_mov_b32 s38, 0x00ff00ff
    s_mov_b32 s39, 0x00ff00ff
    s_mov_b32 s34, 0x3e0293ee
    s_mov_b32 s35, 0x49800000
    s_mov_b32 s50, 0x3f803f80
    v_and_b32 v5, 1, v2
    v_or_b32 v5, 0, v5
    v_xor_b32 v5, v5, v6
    v_and_b32 v7, 2, v5
    v_add_u32 v5, v5, v7
    v_lshlrev_b32 v5, 6, v5
    v_and_b32 v7, 3, v3
    v_lshl_add_u32 v7, v7, 4, v5
    s_lshl_b32 s43, s21, 2
    v_add_u32 v4, s43, v2
    v_lshl_add_u32 v10, v4, 10, v7
    v_and_b32 v5, 1, v2
    v_or_b32 v5, 2, v5
    v_xor_b32 v5, v5, v6
    v_and_b32 v7, 2, v5
    v_add_u32 v5, v5, v7
    v_lshlrev_b32 v5, 6, v5
    v_and_b32 v7, 3, v3
    v_lshl_add_u32 v7, v7, 4, v5
    s_lshl_b32 s43, s21, 2
    v_add_u32 v4, s43, v2
    v_lshl_add_u32 v9, v4, 10, v7
    v_and_b32 v5, 1, v2
    v_lshl_add_u32 v4, v5, 3, v6
    v_lshrrev_b32 v7, 1, v2
    v_lshl_add_u32 v4, v7, 5, v4
    v_lshlrev_b32 v4, 8, v4
    v_lshl_or_b32 v5, v5, 2, v6
    v_lshlrev_b32 v5, 5, v5
    s_lshl_b32 s43, s21, 6
    v_xor_b32 v5, s43, v5
    v_add_u32 v4, v4, v5
    v_and_b32 v5, 3, v3
    v_lshl_add_u32 v4, v5, 3, v4
    v_add_u32 v11, 32768, v4
    s_and_b32 s43, s21, 1
    s_lshl_b32 s43, s43, 12
    v_add_u32 v11, s43, v11
    v_and_b32 v5, 1, v2
    v_lshlrev_b32 v4, 4, v5
    v_lshl_add_u32 v4, v7, 2, v4
    v_and_b32 v7, 1, v6
    v_add_u32 v4, v4, v7
    s_lshl_b32 s43, s21, 5
    v_add_u32 v4, s43, v4
    v_lshlrev_b32 v4, 8, v4
    v_lshl_or_b32 v5, v5, 1, v7
    s_lshl_b32 s43, s21, 1
    s_and_b32 s43, s43, 3
    v_xor_b32 v5, s43, v5
    v_lshl_add_u32 v4, v5, 6, v4
    v_lshrrev_b32 v5, 1, v6
    v_lshl_add_u32 v4, v5, 5, v4
    v_and_b32 v5, 3, v3
    v_lshl_add_u32 v4, v5, 3, v4
    v_add_u32 v12, 32768, v4
    v_mov_b32 v16, -1
    v_mov_b32 v17, -1
    v_mov_b32 v18, -1
    v_mov_b32 v19, -1
    s_lshl_b32 s43, s20, 13
    s_add_u32 s43, s43, 0x7100000
    s_and_b32 s40, s21, 1
    s_lshl_b32 s40, s40, 12
    s_add_u32 s29, s43, s40
    s_add_u32 s43, s43, s52
    s_xor_b32 s40, s43, 0x0
    buffer_store_dwordx4 v[16:19], v117, s[8:11], s43 offen sc1
    buffer_store_dwordx4 v[16:19], v117, s[8:11], s43 offen offset:1024 sc1
    s_mov_b32 s43, 0x7012000
    buffer_store_dword v16, v119, s[8:11], s43 offen sc1
    s_mov_b32 s43, 0x7014000
    buffer_store_dword v16, v119, s[8:11], s43 offen sc1
    s_mov_b32 s43, 0x7016000
    buffer_store_dword v16, v119, s[8:11], s43 offen sc1
    s_load_dwordx2 s[4:5], s[0:1], 8
    s_waitcnt lgkmcnt(0)
    s_and_b32 s5, s5, 0xffff
    s_mov_b32 s6, 8192
    s_mov_b32 s7, 0x20000
    v_and_b32 v20, 1, v2
    v_and_b32 v21, 1, v6
    v_lshl_add_u32 v20, v20, 1, v21
    v_lshlrev_b32 v20, 9, v20
    v_and_b32 v21, 3, v3
    v_lshl_add_u32 v20, v21, 4, v20
    v_and_b32 v21, 2, v2
    v_add_u32 v20, v20, v21
    s_and_b32 s43, s20, 1
    s_lshl_b32 s43, s43, 11
    s_bfe_u32 s40, s20, 0x20001
    s_lshl_b32 s40, s40, 7
    s_add_u32 s43, s43, s40
    s_and_b32 s40, s21, 1
    s_lshl_b32 s40, s40, 6
    s_add_u32 s43, s43, s40
    s_lshr_b32 s40, s20, 3
    s_lshl_b32 s40, s40, 2
    s_add_u32 s43, s43, s40
    v_add_u32 v20, s43, v20
    v_lshlrev_b32 v20, 1, v20
    buffer_load_dword v21, v20, s[4:7], 0 offen
    s_mov_b32 s57, 0
    s_lshl_b32 s43, s20, 13
    s_add_u32 s43, s43, s52
    s_add_u32 s30, s43, 0x1000000
    s_add_u32 s31, s43, 0x2000000
    s_lshr_b32 s43, s43, 1
    s_add_u32 s32, s43, 0x220000
    s_waitcnt vmcnt(18)
    s_barrier
    v_xor_b32 v13, 0x0, v11
    v_add_u32 v13, 0x0, v13
    ds_read_b64_tr_b16 v[80:81], v13
    ds_read_b64_tr_b16 v[82:83], v13 offset:1024
    ds_read_b64_tr_b16 v[84:85], v13 offset:16384
    ds_read_b64_tr_b16 v[86:87], v13 offset:17408
    v_xor_b32 v13, 0x20, v11
    v_add_u32 v13, 0x0, v13
    ds_read_b64_tr_b16 v[56:57], v13
    ds_read_b64_tr_b16 v[58:59], v13 offset:1024
    ds_read_b64_tr_b16 v[60:61], v13 offset:16384
    ds_read_b64_tr_b16 v[62:63], v13 offset:17408
    v_xor_b32 v13, 0x1000, v11
    v_add_u32 v13, 0x0, v13
    ds_read_b64_tr_b16 a[0:1], v13
    ds_read_b64_tr_b16 a[2:3], v13 offset:1024
    ds_read_b64_tr_b16 a[4:5], v13 offset:16384
    ds_read_b64_tr_b16 a[6:7], v13 offset:17408
    v_xor_b32 v13, 0x1020, v11
    v_add_u32 v13, 0x0, v13
    ds_read_b64_tr_b16 a[8:9], v13
    ds_read_b64_tr_b16 a[10:11], v13 offset:1024
    ds_read_b64_tr_b16 a[12:13], v13 offset:16384
    ds_read_b64_tr_b16 a[14:15], v13 offset:17408
    s_waitcnt lgkmcnt(0)
    s_barrier
    s_add_u32 s43, s41, 0x280000
    s_add_u32 m0, s51, 0x1c000
    s_nop 0
    buffer_load_dwordx4 v15, s[12:15], s43 offen nt lds
    s_add_u32 s43, s41, 0x288000
    s_add_u32 m0, s51, 0x1d000
    s_nop 0
    buffer_load_dwordx4 v15, s[12:15], s43 offen nt lds
    s_add_u32 s43, s41, 0x380000
    s_add_u32 m0, s51, 0x1e000
    s_nop 0
    buffer_load_dwordx4 v15, s[12:15], s43 offen nt lds
    s_add_u32 s43, s41, 0x388000
    s_add_u32 m0, s51, 0x1f000
    s_nop 0
    buffer_load_dwordx4 v15, s[12:15], s43 offen nt lds
    v_xor_b32 v15, 2, v14
    v_lshl_add_u32 v15, v15, 15, v8
    s_add_u32 s43, s41, 0x80000
    s_add_u32 m0, s51, 0x20000
    s_nop 0
    buffer_load_dwordx4 v15, s[12:15], s43 offen nt lds
    s_add_u32 s43, s41, 0x88000
    s_add_u32 m0, s51, 0x21000
    s_nop 0
    buffer_load_dwordx4 v15, s[12:15], s43 offen nt lds
    s_add_u32 s43, s41, 0x180000
    s_add_u32 m0, s51, 0x22000
    s_nop 0
    buffer_load_dwordx4 v15, s[12:15], s43 offen nt lds
    s_add_u32 s43, s41, 0x188000
    s_add_u32 m0, s51, 0x23000
    s_nop 0
    buffer_load_dwordx4 v15, s[12:15], s43 offen nt lds
    s_waitcnt vmcnt(18)
    s_barrier
    v_xor_b32 v13, 0x0, v11
    v_add_u32 v13, 0x8000, v13
    ds_read_b64_tr_b16 a[32:33], v13
    ds_read_b64_tr_b16 a[34:35], v13 offset:1024
    ds_read_b64_tr_b16 a[36:37], v13 offset:16384
    ds_read_b64_tr_b16 a[38:39], v13 offset:17408
    v_xor_b32 v13, 0x20, v11
    v_add_u32 v13, 0x8000, v13
    ds_read_b64_tr_b16 a[40:41], v13
    ds_read_b64_tr_b16 a[42:43], v13 offset:1024
    ds_read_b64_tr_b16 a[44:45], v13 offset:16384
    ds_read_b64_tr_b16 a[46:47], v13 offset:17408
    v_xor_b32 v13, 0x1000, v11
    v_add_u32 v13, 0x8000, v13
    ds_read_b64_tr_b16 a[64:65], v13
    ds_read_b64_tr_b16 a[66:67], v13 offset:1024
    ds_read_b64_tr_b16 a[68:69], v13 offset:16384
    ds_read_b64_tr_b16 a[70:71], v13 offset:17408
    v_xor_b32 v13, 0x1020, v11
    v_add_u32 v13, 0x8000, v13
    ds_read_b64_tr_b16 a[72:73], v13
    ds_read_b64_tr_b16 a[74:75], v13 offset:1024
    ds_read_b64_tr_b16 a[76:77], v13 offset:16384
    ds_read_b64_tr_b16 a[78:79], v13 offset:17408
    s_waitcnt lgkmcnt(0)
    s_barrier
    s_add_u32 s43, s41, 0x280000
    s_add_u32 m0, s51, 0x24000
    s_nop 0
    buffer_load_dwordx4 v15, s[12:15], s43 offen nt lds
    s_add_u32 s43, s41, 0x288000
    s_add_u32 m0, s51, 0x25000
    s_nop 0
    buffer_load_dwordx4 v15, s[12:15], s43 offen nt lds
    s_add_u32 s43, s41, 0x380000
    s_add_u32 m0, s51, 0x26000
    s_nop 0
    buffer_load_dwordx4 v15, s[12:15], s43 offen nt lds
    s_add_u32 s43, s41, 0x388000
    s_add_u32 m0, s51, 0x27000
    s_nop 0
    buffer_load_dwordx4 v15, s[12:15], s43 offen nt lds
    s_mov_b32 s12, s62
    s_and_b32 s13, s63, 0xffff
    v_xor_b32 v15, 0, v14
    v_lshl_add_u32 v15, v15, 15, v8
    s_add_u32 s43, s41, 0x0
    s_add_u32 m0, s51, 0x8000
    s_nop 0
    buffer_load_dwordx4 v15, s[12:15], s43 offen nt lds
    s_add_u32 s43, s41, 0x8000
    s_add_u32 m0, s51, 0x9000
    s_nop 0
    buffer_load_dwordx4 v15, s[12:15], s43 offen nt lds
    s_add_u32 s43, s41, 0x100000
    s_add_u32 m0, s51, 0xa000
    s_nop 0
    buffer_load_dwordx4 v15, s[12:15], s43 offen nt lds
    s_add_u32 s43, s41, 0x108000
    s_add_u32 m0, s51, 0xb000
    s_nop 0
    buffer_load_dwordx4 v15, s[12:15], s43 offen nt lds
    s_waitcnt vmcnt(12)
    s_barrier
    v_xor_b32 v13, 0x0, v11
    v_add_u32 v13, 0x10000, v13
    ds_read_b64_tr_b16 v[88:89], v13
    ds_read_b64_tr_b16 v[90:91], v13 offset:1024
    ds_read_b64_tr_b16 v[92:93], v13 offset:16384
    ds_read_b64_tr_b16 v[94:95], v13 offset:17408
    v_xor_b32 v13, 0x20, v11
    v_add_u32 v13, 0x10000, v13
    ds_read_b64_tr_b16 v[96:97], v13
    ds_read_b64_tr_b16 v[98:99], v13 offset:1024
    ds_read_b64_tr_b16 v[100:101], v13 offset:16384
    ds_read_b64_tr_b16 v[102:103], v13 offset:17408
    v_xor_b32 v13, 0x1000, v11
    v_add_u32 v13, 0x10000, v13
    ds_read_b64_tr_b16 a[16:17], v13
    ds_read_b64_tr_b16 a[18:19], v13 offset:1024
    ds_read_b64_tr_b16 a[20:21], v13 offset:16384
    ds_read_b64_tr_b16 a[22:23], v13 offset:17408
    v_xor_b32 v13, 0x1020, v11
    v_add_u32 v13, 0x10000, v13
    ds_read_b64_tr_b16 a[24:25], v13
    ds_read_b64_tr_b16 a[26:27], v13 offset:1024
    ds_read_b64_tr_b16 a[28:29], v13 offset:16384
    ds_read_b64_tr_b16 a[30:31], v13 offset:17408
    s_waitcnt lgkmcnt(0)
    s_barrier
    s_add_u32 s43, s41, 0x200000
    s_add_u32 m0, s51, 0xc000
    s_nop 0
    buffer_load_dwordx4 v15, s[12:15], s43 offen nt lds
    s_add_u32 s43, s41, 0x208000
    s_add_u32 m0, s51, 0xd000
    s_nop 0
    buffer_load_dwordx4 v15, s[12:15], s43 offen nt lds
    s_add_u32 s43, s41, 0x300000
    s_add_u32 m0, s51, 0xe000
    s_nop 0
    buffer_load_dwordx4 v15, s[12:15], s43 offen nt lds
    s_add_u32 s43, s41, 0x308000
    s_add_u32 m0, s51, 0xf000
    s_nop 0
    buffer_load_dwordx4 v15, s[12:15], s43 offen nt lds
    v_xor_b32 v15, 2, v14
    v_lshl_add_u32 v15, v15, 15, v8
    s_add_u32 s43, s41, 0x0
    s_add_u32 m0, s51, 0x10000
    s_nop 0
    buffer_load_dwordx4 v15, s[12:15], s43 offen nt lds
    s_add_u32 s43, s41, 0x8000
    s_add_u32 m0, s51, 0x11000
    s_nop 0
    buffer_load_dwordx4 v15, s[12:15], s43 offen nt lds
    s_add_u32 s43, s41, 0x100000
    s_add_u32 m0, s51, 0x12000
    s_nop 0
    buffer_load_dwordx4 v15, s[12:15], s43 offen nt lds
    s_add_u32 s43, s41, 0x108000
    s_add_u32 m0, s51, 0x13000
    s_nop 0
    buffer_load_dwordx4 v15, s[12:15], s43 offen nt lds
    s_waitcnt vmcnt(12)
    s_barrier
    v_xor_b32 v13, 0x0, v11
    v_add_u32 v13, 0x18000, v13
    ds_read_b64_tr_b16 a[48:49], v13
    ds_read_b64_tr_b16 a[50:51], v13 offset:1024
    ds_read_b64_tr_b16 a[52:53], v13 offset:16384
    ds_read_b64_tr_b16 a[54:55], v13 offset:17408
    v_xor_b32 v13, 0x20, v11
    v_add_u32 v13, 0x18000, v13
    ds_read_b64_tr_b16 a[56:57], v13
    ds_read_b64_tr_b16 a[58:59], v13 offset:1024
    ds_read_b64_tr_b16 a[60:61], v13 offset:16384
    ds_read_b64_tr_b16 a[62:63], v13 offset:17408
    v_xor_b32 v13, 0x1000, v11
    v_add_u32 v13, 0x18000, v13
    ds_read_b64_tr_b16 a[80:81], v13
    ds_read_b64_tr_b16 a[82:83], v13 offset:1024
    ds_read_b64_tr_b16 a[84:85], v13 offset:16384
    ds_read_b64_tr_b16 a[86:87], v13 offset:17408
    v_xor_b32 v13, 0x1020, v11
    v_add_u32 v13, 0x18000, v13
    ds_read_b64_tr_b16 a[88:89], v13
    ds_read_b64_tr_b16 a[90:91], v13 offset:1024
    ds_read_b64_tr_b16 a[92:93], v13 offset:16384
    ds_read_b64_tr_b16 a[94:95], v13 offset:17408
    s_waitcnt lgkmcnt(0)
    s_barrier
    s_add_u32 s43, s41, 0x200000
    s_add_u32 m0, s51, 0x14000
    s_nop 0
    buffer_load_dwordx4 v15, s[12:15], s43 offen nt lds
    s_add_u32 s43, s41, 0x208000
    s_add_u32 m0, s51, 0x15000
    s_nop 0
    buffer_load_dwordx4 v15, s[12:15], s43 offen nt lds
    s_add_u32 s43, s41, 0x300000
    s_add_u32 m0, s51, 0x16000
    s_nop 0
    buffer_load_dwordx4 v15, s[12:15], s43 offen nt lds
    s_add_u32 s43, s41, 0x308000
    s_add_u32 m0, s51, 0x17000
    s_nop 0
    buffer_load_dwordx4 v15, s[12:15], s43 offen nt lds
    v_xor_b32 v15, 0, v14
    v_lshl_add_u32 v15, v15, 15, v8
    s_add_u32 s43, s41, 0x80000
    s_add_u32 m0, s51, 0x18000
    s_nop 0
    buffer_load_dwordx4 v15, s[12:15], s43 offen nt lds
    s_add_u32 s43, s41, 0x88000
    s_add_u32 m0, s51, 0x19000
    s_nop 0
    buffer_load_dwordx4 v15, s[12:15], s43 offen nt lds
    s_add_u32 s43, s41, 0x180000
    s_add_u32 m0, s51, 0x1a000
    s_nop 0
    buffer_load_dwordx4 v15, s[12:15], s43 offen nt lds
    s_add_u32 s43, s41, 0x188000
    s_add_u32 m0, s51, 0x1b000
    s_nop 0
    buffer_load_dwordx4 v15, s[12:15], s43 offen nt lds
    s_waitcnt vmcnt(12)
    v_min_u32 v21, 0xfffffffe, v21
    s_mov_b32 s43, 0x7010000
    s_mov_b64 exec, s[38:39]
    buffer_store_dword v21, v119, s[8:11], s43 offen sc1
    s_mov_b64 exec, -1
    s_barrier
    v_xor_b32 v13, 0x0, v11
    v_add_u32 v13, 0x0, v13
    ds_read_b64_tr_b16 v[64:65], v13
    ds_read_b64_tr_b16 v[66:67], v13 offset:1024
    ds_read_b64_tr_b16 v[68:69], v13 offset:16384
    ds_read_b64_tr_b16 v[70:71], v13 offset:17408
    v_xor_b32 v13, 0x20, v11
    v_add_u32 v13, 0x0, v13
    ds_read_b64_tr_b16 v[72:73], v13
    ds_read_b64_tr_b16 v[74:75], v13 offset:1024
    ds_read_b64_tr_b16 v[76:77], v13 offset:16384
    ds_read_b64_tr_b16 v[78:79], v13 offset:17408
    v_xor_b32 v13, 0x1000, v11
    v_add_u32 v13, 0x0, v13
    ds_read_b64_tr_b16 a[96:97], v13
    ds_read_b64_tr_b16 a[98:99], v13 offset:1024
    ds_read_b64_tr_b16 a[100:101], v13 offset:16384
    ds_read_b64_tr_b16 a[102:103], v13 offset:17408
    v_xor_b32 v13, 0x1020, v11
    v_add_u32 v13, 0x0, v13
    ds_read_b64_tr_b16 a[104:105], v13
    ds_read_b64_tr_b16 a[106:107], v13 offset:1024
    ds_read_b64_tr_b16 a[108:109], v13 offset:16384
    ds_read_b64_tr_b16 a[110:111], v13 offset:17408
    s_waitcnt lgkmcnt(0)
    s_barrier
    s_add_u32 s43, s41, 0x280000
    s_add_u32 m0, s51, 0x1c000
    s_nop 0
    buffer_load_dwordx4 v15, s[12:15], s43 offen nt lds
    s_add_u32 s43, s41, 0x288000
    s_add_u32 m0, s51, 0x1d000
    s_nop 0
    buffer_load_dwordx4 v15, s[12:15], s43 offen nt lds
    s_add_u32 s43, s41, 0x380000
    s_add_u32 m0, s51, 0x1e000
    s_nop 0
    buffer_load_dwordx4 v15, s[12:15], s43 offen nt lds
    s_add_u32 s43, s41, 0x388000
    s_add_u32 m0, s51, 0x1f000
    s_nop 0
    buffer_load_dwordx4 v15, s[12:15], s43 offen nt lds
    v_xor_b32 v15, 2, v14
    v_lshl_add_u32 v15, v15, 15, v8
    s_add_u32 s43, s41, 0x80000
    s_add_u32 m0, s51, 0x20000
    s_nop 0
    buffer_load_dwordx4 v15, s[12:15], s43 offen nt lds
    s_add_u32 s43, s41, 0x88000
    s_add_u32 m0, s51, 0x21000
    s_nop 0
    buffer_load_dwordx4 v15, s[12:15], s43 offen nt lds
    s_add_u32 s43, s41, 0x180000
    s_add_u32 m0, s51, 0x22000
    s_nop 0
    buffer_load_dwordx4 v15, s[12:15], s43 offen nt lds
    s_add_u32 s43, s41, 0x188000
    s_add_u32 m0, s51, 0x23000
    s_nop 0
    buffer_load_dwordx4 v15, s[12:15], s43 offen nt lds
    s_waitcnt vmcnt(12)
    s_barrier
    v_xor_b32 v13, 0x0, v11
    v_add_u32 v13, 0x8000, v13
    ds_read_b64_tr_b16 a[128:129], v13
    ds_read_b64_tr_b16 a[130:131], v13 offset:1024
    ds_read_b64_tr_b16 a[132:133], v13 offset:16384
    ds_read_b64_tr_b16 a[134:135], v13 offset:17408
    v_xor_b32 v13, 0x20, v11
    v_add_u32 v13, 0x8000, v13
    ds_read_b64_tr_b16 a[136:137], v13
    ds_read_b64_tr_b16 a[138:139], v13 offset:1024
    ds_read_b64_tr_b16 a[140:141], v13 offset:16384
    ds_read_b64_tr_b16 a[142:143], v13 offset:17408
    v_xor_b32 v13, 0x1000, v11
    v_add_u32 v13, 0x8000, v13
    ds_read_b64_tr_b16 a[160:161], v13
    ds_read_b64_tr_b16 a[162:163], v13 offset:1024
    ds_read_b64_tr_b16 a[164:165], v13 offset:16384
    ds_read_b64_tr_b16 a[166:167], v13 offset:17408
    v_xor_b32 v13, 0x1020, v11
    v_add_u32 v13, 0x8000, v13
    ds_read_b64_tr_b16 a[168:169], v13
    ds_read_b64_tr_b16 a[170:171], v13 offset:1024
    ds_read_b64_tr_b16 a[172:173], v13 offset:16384
    ds_read_b64_tr_b16 a[174:175], v13 offset:17408
    s_waitcnt lgkmcnt(0)
    s_barrier
    s_add_u32 s43, s41, 0x280000
    s_add_u32 m0, s51, 0x24000
    s_nop 0
    buffer_load_dwordx4 v15, s[12:15], s43 offen nt lds
    s_add_u32 s43, s41, 0x288000
    s_add_u32 m0, s51, 0x25000
    s_nop 0
    buffer_load_dwordx4 v15, s[12:15], s43 offen nt lds
    s_add_u32 s43, s41, 0x380000
    s_add_u32 m0, s51, 0x26000
    s_nop 0
    buffer_load_dwordx4 v15, s[12:15], s43 offen nt lds
    s_add_u32 s43, s41, 0x388000
    s_add_u32 m0, s51, 0x27000
    s_nop 0
    buffer_load_dwordx4 v15, s[12:15], s43 offen nt lds
    s_mov_b32 s12, s64
    s_and_b32 s13, s65, 0xffff
    v_xor_b32 v15, 0, v14
    v_lshl_add_u32 v15, v15, 15, v8
    s_add_u32 s43, s41, 0x0
    s_add_u32 m0, s51, 0x8000
    s_nop 0
    buffer_load_dwordx4 v15, s[12:15], s43 offen lds
    s_add_u32 s43, s41, 0x8000
    s_add_u32 m0, s51, 0x9000
    s_nop 0
    buffer_load_dwordx4 v15, s[12:15], s43 offen lds
    s_add_u32 s43, s41, 0x100000
    s_add_u32 m0, s51, 0xa000
    s_nop 0
    buffer_load_dwordx4 v15, s[12:15], s43 offen lds
    s_add_u32 s43, s41, 0x108000
    s_add_u32 m0, s51, 0xb000
    s_nop 0
    buffer_load_dwordx4 v15, s[12:15], s43 offen lds
    s_waitcnt vmcnt(12)
    s_barrier
    v_xor_b32 v13, 0x0, v11
    v_add_u32 v13, 0x10000, v13
    ds_read_b64_tr_b16 v[104:105], v13
    ds_read_b64_tr_b16 v[106:107], v13 offset:1024
    ds_read_b64_tr_b16 v[108:109], v13 offset:16384
    ds_read_b64_tr_b16 v[110:111], v13 offset:17408
    v_xor_b32 v13, 0x20, v11
    v_add_u32 v13, 0x10000, v13
    ds_read_b64_tr_b16 v[32:33], v13
    ds_read_b64_tr_b16 v[34:35], v13 offset:1024
    ds_read_b64_tr_b16 v[36:37], v13 offset:16384
    ds_read_b64_tr_b16 v[38:39], v13 offset:17408
    v_xor_b32 v13, 0x1000, v11
    v_add_u32 v13, 0x10000, v13
    ds_read_b64_tr_b16 a[112:113], v13
    ds_read_b64_tr_b16 a[114:115], v13 offset:1024
    ds_read_b64_tr_b16 a[116:117], v13 offset:16384
    ds_read_b64_tr_b16 a[118:119], v13 offset:17408
    v_xor_b32 v13, 0x1020, v11
    v_add_u32 v13, 0x10000, v13
    ds_read_b64_tr_b16 a[120:121], v13
    ds_read_b64_tr_b16 a[122:123], v13 offset:1024
    ds_read_b64_tr_b16 a[124:125], v13 offset:16384
    ds_read_b64_tr_b16 a[126:127], v13 offset:17408
    s_waitcnt lgkmcnt(0)
    s_barrier
    s_add_u32 s43, s41, 0x200000
    s_add_u32 m0, s51, 0xc000
    s_nop 0
    buffer_load_dwordx4 v15, s[12:15], s43 offen lds
    s_add_u32 s43, s41, 0x208000
    s_add_u32 m0, s51, 0xd000
    s_nop 0
    buffer_load_dwordx4 v15, s[12:15], s43 offen lds
    s_add_u32 s43, s41, 0x300000
    s_add_u32 m0, s51, 0xe000
    s_nop 0
    buffer_load_dwordx4 v15, s[12:15], s43 offen lds
    s_add_u32 s43, s41, 0x308000
    s_add_u32 m0, s51, 0xf000
    s_nop 0
    buffer_load_dwordx4 v15, s[12:15], s43 offen lds
    v_xor_b32 v15, 2, v14
    v_lshl_add_u32 v15, v15, 15, v8
    s_add_u32 s43, s41, 0x0
    s_add_u32 m0, s51, 0x10000
    s_nop 0
    buffer_load_dwordx4 v15, s[12:15], s43 offen lds
    s_add_u32 s43, s41, 0x8000
    s_add_u32 m0, s51, 0x11000
    s_nop 0
    buffer_load_dwordx4 v15, s[12:15], s43 offen lds
    s_add_u32 s43, s41, 0x100000
    s_add_u32 m0, s51, 0x12000
    s_nop 0
    buffer_load_dwordx4 v15, s[12:15], s43 offen lds
    s_add_u32 s43, s41, 0x108000
    s_add_u32 m0, s51, 0x13000
    s_nop 0
    buffer_load_dwordx4 v15, s[12:15], s43 offen lds
    s_waitcnt vmcnt(12)
    s_barrier
    v_xor_b32 v13, 0x0, v11
    v_add_u32 v13, 0x18000, v13
    ds_read_b64_tr_b16 a[144:145], v13
    ds_read_b64_tr_b16 a[146:147], v13 offset:1024
    ds_read_b64_tr_b16 a[148:149], v13 offset:16384
    ds_read_b64_tr_b16 a[150:151], v13 offset:17408
    v_xor_b32 v13, 0x20, v11
    v_add_u32 v13, 0x18000, v13
    ds_read_b64_tr_b16 a[152:153], v13
    ds_read_b64_tr_b16 a[154:155], v13 offset:1024
    ds_read_b64_tr_b16 a[156:157], v13 offset:16384
    ds_read_b64_tr_b16 a[158:159], v13 offset:17408
    v_xor_b32 v13, 0x1000, v11
    v_add_u32 v13, 0x18000, v13
    ds_read_b64_tr_b16 a[176:177], v13
    ds_read_b64_tr_b16 a[178:179], v13 offset:1024
    ds_read_b64_tr_b16 a[180:181], v13 offset:16384
    ds_read_b64_tr_b16 a[182:183], v13 offset:17408
    v_xor_b32 v13, 0x1020, v11
    v_add_u32 v13, 0x18000, v13
    ds_read_b64_tr_b16 a[184:185], v13
    ds_read_b64_tr_b16 a[186:187], v13 offset:1024
    ds_read_b64_tr_b16 a[188:189], v13 offset:16384
    ds_read_b64_tr_b16 a[190:191], v13 offset:17408
    s_waitcnt lgkmcnt(0)
    s_barrier
    s_add_u32 s43, s41, 0x200000
    s_add_u32 m0, s51, 0x14000
    s_nop 0
    buffer_load_dwordx4 v15, s[12:15], s43 offen lds
    s_add_u32 s43, s41, 0x208000
    s_add_u32 m0, s51, 0x15000
    s_nop 0
    buffer_load_dwordx4 v15, s[12:15], s43 offen lds
    s_add_u32 s43, s41, 0x300000
    s_add_u32 m0, s51, 0x16000
    s_nop 0
    buffer_load_dwordx4 v15, s[12:15], s43 offen lds
    s_add_u32 s43, s41, 0x308000
    s_add_u32 m0, s51, 0x17000
    s_nop 0
    buffer_load_dwordx4 v15, s[12:15], s43 offen lds
    s_mov_b32 s12, s66
    s_and_b32 s13, s67, 0xffff
    s_add_u32 s43, s42, 0x80
    s_add_u32 m0, s51, 0x18000
    s_nop 0
    buffer_load_dwordx4 v10, s[12:15], s43 offen lds
    s_add_u32 s43, s42, 0x4080
    s_add_u32 m0, s51, 0x19000
    s_nop 0
    buffer_load_dwordx4 v9, s[12:15], s43 offen lds
    s_add_u32 s43, s42, 0x8080
    s_add_u32 m0, s51, 0x1a000
    s_nop 0
    buffer_load_dwordx4 v10, s[12:15], s43 offen lds
    s_add_u32 s43, s42, 0xc080
    s_add_u32 m0, s51, 0x1b000
    s_nop 0
    buffer_load_dwordx4 v9, s[12:15], s43 offen lds
    s_waitcnt vmcnt(12)
    s_barrier
    v_xor_b32 v13, 0x0, v11
    v_add_u32 v13, 0x0, v13
    ds_read_b64_tr_b16 a[192:193], v13
    ds_read_b64_tr_b16 a[194:195], v13 offset:1024
    ds_read_b64_tr_b16 a[196:197], v13 offset:16384
    ds_read_b64_tr_b16 a[198:199], v13 offset:17408
    v_xor_b32 v13, 0x20, v11
    v_add_u32 v13, 0x0, v13
    ds_read_b64_tr_b16 a[200:201], v13
    ds_read_b64_tr_b16 a[202:203], v13 offset:1024
    ds_read_b64_tr_b16 a[204:205], v13 offset:16384
    ds_read_b64_tr_b16 a[206:207], v13 offset:17408
    v_xor_b32 v13, 0x1000, v11
    v_add_u32 v13, 0x0, v13
    ds_read_b64_tr_b16 a[224:225], v13
    ds_read_b64_tr_b16 a[226:227], v13 offset:1024
    ds_read_b64_tr_b16 a[228:229], v13 offset:16384
    ds_read_b64_tr_b16 a[230:231], v13 offset:17408
    v_xor_b32 v13, 0x1020, v11
    v_add_u32 v13, 0x0, v13
    ds_read_b64_tr_b16 a[232:233], v13
    ds_read_b64_tr_b16 a[234:235], v13 offset:1024
    ds_read_b64_tr_b16 a[236:237], v13 offset:16384
    ds_read_b64_tr_b16 a[238:239], v13 offset:17408
    s_waitcnt lgkmcnt(0)
    s_barrier
    s_add_u32 s43, s42, 0x10280
    s_add_u32 m0, s51, 0x1c000
    s_nop 0
    buffer_load_dwordx4 v10, s[12:15], s43 offen lds
    s_add_u32 s43, s42, 0x14280
    s_add_u32 m0, s51, 0x1d000
    s_nop 0
    buffer_load_dwordx4 v9, s[12:15], s43 offen lds
    s_add_u32 s43, s42, 0x18280
    s_add_u32 m0, s51, 0x1e000
    s_nop 0
    buffer_load_dwordx4 v10, s[12:15], s43 offen lds
    s_add_u32 s43, s42, 0x1c280
    s_add_u32 m0, s51, 0x1f000
    s_nop 0
    buffer_load_dwordx4 v9, s[12:15], s43 offen lds
    s_add_u32 s43, s42, 0x10080
    s_add_u32 m0, s51, 0x20000
    s_nop 0
    buffer_load_dwordx4 v10, s[12:15], s43 offen lds
    s_add_u32 s43, s42, 0x14080
    s_add_u32 m0, s51, 0x21000
    s_nop 0
    buffer_load_dwordx4 v9, s[12:15], s43 offen lds
    s_add_u32 s43, s42, 0x18080
    s_add_u32 m0, s51, 0x22000
    s_nop 0
    buffer_load_dwordx4 v10, s[12:15], s43 offen lds
    s_add_u32 s43, s42, 0x1c080
    s_add_u32 m0, s51, 0x23000
    s_nop 0
    buffer_load_dwordx4 v9, s[12:15], s43 offen lds
    s_waitcnt vmcnt(12)
    s_barrier
    s_cmp_lg_u32 s21, 0
    s_cbranch_scc1 L_arr_51
    v_mov_b32 v23, 1
    s_mov_b64 exec, 1
    buffer_atomic_add v23, off, s[16:19], 0 offset:8
    s_mov_b64 exec, -1
L_arr_51:
    v_xor_b32 v13, 0x0, v11
    v_add_u32 v13, 0x8000, v13
    ds_read_b64_tr_b16 v[128:129], v13
    ds_read_b64_tr_b16 v[130:131], v13 offset:1024
    ds_read_b64_tr_b16 v[132:133], v13 offset:16384
    ds_read_b64_tr_b16 v[134:135], v13 offset:17408
    v_xor_b32 v13, 0x20, v11
    v_add_u32 v13, 0x8000, v13
    ds_read_b64_tr_b16 v[136:137], v13
    ds_read_b64_tr_b16 v[138:139], v13 offset:1024
    ds_read_b64_tr_b16 v[140:141], v13 offset:16384
    ds_read_b64_tr_b16 v[142:143], v13 offset:17408
    v_xor_b32 v13, 0x1000, v11
    v_add_u32 v13, 0x8000, v13
    ds_read_b64_tr_b16 v[160:161], v13
    ds_read_b64_tr_b16 v[162:163], v13 offset:1024
    ds_read_b64_tr_b16 v[164:165], v13 offset:16384
    ds_read_b64_tr_b16 v[166:167], v13 offset:17408
    v_xor_b32 v13, 0x1020, v11
    v_add_u32 v13, 0x8000, v13
    ds_read_b64_tr_b16 v[168:169], v13
    ds_read_b64_tr_b16 v[170:171], v13 offset:1024
    ds_read_b64_tr_b16 v[172:173], v13 offset:16384
    ds_read_b64_tr_b16 v[174:175], v13 offset:17408
    s_waitcnt lgkmcnt(0)
    s_barrier
    s_add_u32 s43, s42, 0x280
    s_add_u32 m0, s51, 0x24000
    s_nop 0
    buffer_load_dwordx4 v10, s[12:15], s43 offen lds
    s_add_u32 s43, s42, 0x4280
    s_add_u32 m0, s51, 0x25000
    s_nop 0
    buffer_load_dwordx4 v9, s[12:15], s43 offen lds
    s_add_u32 s43, s42, 0x8280
    s_add_u32 m0, s51, 0x26000
    s_nop 0
    buffer_load_dwordx4 v10, s[12:15], s43 offen lds
    s_add_u32 s43, s42, 0xc280
    s_add_u32 m0, s51, 0x27000
    s_nop 0
    buffer_load_dwordx4 v9, s[12:15], s43 offen lds
    s_mov_b32 s12, s64
    s_and_b32 s13, s65, 0xffff
    v_xor_b32 v15, 0, v14
    v_lshl_add_u32 v15, v15, 15, v8
    s_add_u32 s43, s41, 0x80000
    s_add_u32 m0, s51, 0x8000
    s_nop 0
    buffer_load_dwordx4 v15, s[12:15], s43 offen lds
    s_add_u32 s43, s41, 0x88000
    s_add_u32 m0, s51, 0x9000
    s_nop 0
    buffer_load_dwordx4 v15, s[12:15], s43 offen lds
    s_add_u32 s43, s41, 0x180000
    s_add_u32 m0, s51, 0xa000
    s_nop 0
    buffer_load_dwordx4 v15, s[12:15], s43 offen lds
    s_add_u32 s43, s41, 0x188000
    s_add_u32 m0, s51, 0xb000
    s_nop 0
    buffer_load_dwordx4 v15, s[12:15], s43 offen lds
    s_waitcnt vmcnt(12)
    s_barrier
    v_xor_b32 v13, 0x0, v12
    v_add_u32 v13, 0x10000, v13
    ds_read_b64_tr_b16 v[192:193], v13
    ds_read_b64_tr_b16 v[194:195], v13 offset:512
    ds_read_b64_tr_b16 v[196:197], v13 offset:2048
    ds_read_b64_tr_b16 v[198:199], v13 offset:2560
    v_xor_b32 v13, 0x2000, v12
    v_add_u32 v13, 0x10000, v13
    ds_read_b64_tr_b16 v[200:201], v13
    ds_read_b64_tr_b16 v[202:203], v13 offset:512
    ds_read_b64_tr_b16 v[204:205], v13 offset:2048
    ds_read_b64_tr_b16 v[206:207], v13 offset:2560
    v_xor_b32 v13, 0x40, v12
    v_add_u32 v13, 0x10000, v13
    ds_read_b64_tr_b16 v[224:225], v13
    ds_read_b64_tr_b16 v[226:227], v13 offset:512
    ds_read_b64_tr_b16 v[228:229], v13 offset:2048
    ds_read_b64_tr_b16 v[230:231], v13 offset:2560
    v_xor_b32 v13, 0x2040, v12
    v_add_u32 v13, 0x10000, v13
    ds_read_b64_tr_b16 v[232:233], v13
    ds_read_b64_tr_b16 v[234:235], v13 offset:512
    ds_read_b64_tr_b16 v[236:237], v13 offset:2048
    ds_read_b64_tr_b16 v[238:239], v13 offset:2560
    s_waitcnt lgkmcnt(0)
    s_barrier
    s_add_u32 s43, s41, 0x280000
    s_add_u32 m0, s51, 0xc000
    s_nop 0
    buffer_load_dwordx4 v15, s[12:15], s43 offen lds
    s_add_u32 s43, s41, 0x288000
    s_add_u32 m0, s51, 0xd000
    s_nop 0
    buffer_load_dwordx4 v15, s[12:15], s43 offen lds
    s_add_u32 s43, s41, 0x380000
    s_add_u32 m0, s51, 0xe000
    s_nop 0
    buffer_load_dwordx4 v15, s[12:15], s43 offen lds
    s_add_u32 s43, s41, 0x388000
    s_add_u32 m0, s51, 0xf000
    s_nop 0
    buffer_load_dwordx4 v15, s[12:15], s43 offen lds
    v_xor_b32 v15, 2, v14
    v_lshl_add_u32 v15, v15, 15, v8
    s_add_u32 s43, s41, 0x80000
    s_add_u32 m0, s51, 0x10000
    s_nop 0
    buffer_load_dwordx4 v15, s[12:15], s43 offen lds
    s_add_u32 s43, s41, 0x88000
    s_add_u32 m0, s51, 0x11000
    s_nop 0
    buffer_load_dwordx4 v15, s[12:15], s43 offen lds
    s_add_u32 s43, s41, 0x180000
    s_add_u32 m0, s51, 0x12000
    s_nop 0
    buffer_load_dwordx4 v15, s[12:15], s43 offen lds
    s_add_u32 s43, s41, 0x188000
    s_add_u32 m0, s51, 0x13000
    s_nop 0
    buffer_load_dwordx4 v15, s[12:15], s43 offen lds
    s_waitcnt vmcnt(12)
    s_barrier
    v_xor_b32 v13, 0x0, v12
    v_add_u32 v13, 0x18000, v13
    ds_read_b64_tr_b16 v[208:209], v13
    ds_read_b64_tr_b16 v[210:211], v13 offset:512
    ds_read_b64_tr_b16 v[212:213], v13 offset:2048
    ds_read_b64_tr_b16 v[214:215], v13 offset:2560
    v_xor_b32 v13, 0x2000, v12
    v_add_u32 v13, 0x18000, v13
    ds_read_b64_tr_b16 v[216:217], v13
    ds_read_b64_tr_b16 v[218:219], v13 offset:512
    ds_read_b64_tr_b16 v[220:221], v13 offset:2048
    ds_read_b64_tr_b16 v[222:223], v13 offset:2560
    v_xor_b32 v13, 0x40, v12
    v_add_u32 v13, 0x18000, v13
    ds_read_b64_tr_b16 v[240:241], v13
    ds_read_b64_tr_b16 v[242:243], v13 offset:512
    ds_read_b64_tr_b16 v[244:245], v13 offset:2048
    ds_read_b64_tr_b16 v[246:247], v13 offset:2560
    v_xor_b32 v13, 0x2040, v12
    v_add_u32 v13, 0x18000, v13
    ds_read_b64_tr_b16 v[248:249], v13
    ds_read_b64_tr_b16 v[250:251], v13 offset:512
    ds_read_b64_tr_b16 v[252:253], v13 offset:2048
    ds_read_b64_tr_b16 v[254:255], v13 offset:2560
    s_waitcnt lgkmcnt(0)
    s_barrier
    s_add_u32 s43, s41, 0x280000
    s_add_u32 m0, s51, 0x14000
    s_nop 0
    buffer_load_dwordx4 v15, s[12:15], s43 offen lds
    s_add_u32 s43, s41, 0x288000
    s_add_u32 m0, s51, 0x15000
    s_nop 0
    buffer_load_dwordx4 v15, s[12:15], s43 offen lds
    s_add_u32 s43, s41, 0x380000
    s_add_u32 m0, s51, 0x16000
    s_nop 0
    buffer_load_dwordx4 v15, s[12:15], s43 offen lds
    s_add_u32 s43, s41, 0x388000
    s_add_u32 m0, s51, 0x17000
    s_nop 0
    buffer_load_dwordx4 v15, s[12:15], s43 offen lds
    ds_write_b128 v124, v[192:195]
    ds_write_b128 v124, v[196:199] offset:1024
    ds_write_b128 v124, v[200:203] offset:2048
    ds_write_b128 v124, v[204:207] offset:3072
    ds_write_b128 v124, v[208:211] offset:4096
    ds_write_b128 v124, v[212:215] offset:5120
    ds_write_b128 v124, v[216:219] offset:6144
    ds_write_b128 v124, v[220:223] offset:7168
    ds_write_b128 v124, v[224:227] offset:32768
    ds_write_b128 v124, v[228:231] offset:33792
    ds_write_b128 v124, v[232:235] offset:34816
    ds_write_b128 v124, v[236:239] offset:35840
    ds_write_b128 v124, v[240:243] offset:36864
    ds_write_b128 v124, v[244:247] offset:37888
    ds_write_b128 v124, v[248:251] offset:38912
    ds_write_b128 v124, v[252:255] offset:39936
    s_waitcnt vmcnt(8)
    s_barrier
    v_xor_b32 v13, 0x0, v11
    v_add_u32 v13, 0x0, v13
    ds_read_b64_tr_b16 a[208:209], v13
    ds_read_b64_tr_b16 a[210:211], v13 offset:1024
    ds_read_b64_tr_b16 a[212:213], v13 offset:16384
    ds_read_b64_tr_b16 a[214:215], v13 offset:17408
    v_xor_b32 v13, 0x20, v11
    v_add_u32 v13, 0x0, v13
    ds_read_b64_tr_b16 a[216:217], v13
    ds_read_b64_tr_b16 a[218:219], v13 offset:1024
    ds_read_b64_tr_b16 a[220:221], v13 offset:16384
    ds_read_b64_tr_b16 a[222:223], v13 offset:17408
    v_xor_b32 v13, 0x1000, v11
    v_add_u32 v13, 0x0, v13
    ds_read_b64_tr_b16 a[240:241], v13
    ds_read_b64_tr_b16 a[242:243], v13 offset:1024
    ds_read_b64_tr_b16 a[244:245], v13 offset:16384
    ds_read_b64_tr_b16 a[246:247], v13 offset:17408
    v_xor_b32 v13, 0x1020, v11
    v_add_u32 v13, 0x0, v13
    ds_read_b64_tr_b16 a[248:249], v13
    ds_read_b64_tr_b16 a[250:251], v13 offset:1024
    ds_read_b64_tr_b16 a[252:253], v13 offset:16384
    ds_read_b64_tr_b16 a[254:255], v13 offset:17408
    s_waitcnt lgkmcnt(0)
    s_barrier
    s_mov_b32 s12, s66
    s_and_b32 s13, s67, 0xffff
    s_add_u32 s43, s42, 0x0
    s_add_u32 m0, s51, 0x8000
    s_nop 0
    buffer_load_dwordx4 v10, s[12:15], s43 offen lds
    s_add_u32 s43, s42, 0x4000
    s_add_u32 m0, s51, 0x9000
    s_nop 0
    buffer_load_dwordx4 v9, s[12:15], s43 offen lds
    s_add_u32 s43, s42, 0x8000
    s_add_u32 m0, s51, 0xa000
    s_nop 0
    buffer_load_dwordx4 v10, s[12:15], s43 offen lds
    s_add_u32 s43, s42, 0xc000
    s_add_u32 m0, s51, 0xb000
    s_nop 0
    buffer_load_dwordx4 v9, s[12:15], s43 offen lds
    s_add_u32 s43, s42, 0x10200
    s_add_u32 m0, s51, 0xc000
    s_nop 0
    buffer_load_dwordx4 v10, s[12:15], s43 offen lds
    s_add_u32 s43, s42, 0x14200
    s_add_u32 m0, s51, 0xd000
    s_nop 0
    buffer_load_dwordx4 v9, s[12:15], s43 offen lds
    s_add_u32 s43, s42, 0x18200
    s_add_u32 m0, s51, 0xe000
    s_nop 0
    buffer_load_dwordx4 v10, s[12:15], s43 offen lds
    s_add_u32 s43, s42, 0x1c200
    s_add_u32 m0, s51, 0xf000
    s_nop 0
    buffer_load_dwordx4 v9, s[12:15], s43 offen lds
    s_waitcnt vmcnt(8)
    s_barrier
    v_xor_b32 v13, 0x0, v11
    v_add_u32 v13, 0x8000, v13
    ds_read_b64_tr_b16 v[144:145], v13
    ds_read_b64_tr_b16 v[146:147], v13 offset:1024
    ds_read_b64_tr_b16 v[148:149], v13 offset:16384
    ds_read_b64_tr_b16 v[150:151], v13 offset:17408
    v_xor_b32 v13, 0x20, v11
    v_add_u32 v13, 0x8000, v13
    ds_read_b64_tr_b16 v[152:153], v13
    ds_read_b64_tr_b16 v[154:155], v13 offset:1024
    ds_read_b64_tr_b16 v[156:157], v13 offset:16384
    ds_read_b64_tr_b16 v[158:159], v13 offset:17408
    v_xor_b32 v13, 0x1000, v11
    v_add_u32 v13, 0x8000, v13
    ds_read_b64_tr_b16 v[176:177], v13
    ds_read_b64_tr_b16 v[178:179], v13 offset:1024
    ds_read_b64_tr_b16 v[180:181], v13 offset:16384
    ds_read_b64_tr_b16 v[182:183], v13 offset:17408
    v_xor_b32 v13, 0x1020, v11
    v_add_u32 v13, 0x8000, v13
    ds_read_b64_tr_b16 v[184:185], v13
    ds_read_b64_tr_b16 v[186:187], v13 offset:1024
    ds_read_b64_tr_b16 v[188:189], v13 offset:16384
    ds_read_b64_tr_b16 v[190:191], v13 offset:17408
    s_waitcnt lgkmcnt(0)
    s_barrier
    s_add_u32 s43, s42, 0x10000
    s_add_u32 m0, s51, 0x10000
    s_nop 0
    buffer_load_dwordx4 v10, s[12:15], s43 offen lds
    s_add_u32 s43, s42, 0x14000
    s_add_u32 m0, s51, 0x11000
    s_nop 0
    buffer_load_dwordx4 v9, s[12:15], s43 offen lds
    s_add_u32 s43, s42, 0x18000
    s_add_u32 m0, s51, 0x12000
    s_nop 0
    buffer_load_dwordx4 v10, s[12:15], s43 offen lds
    s_add_u32 s43, s42, 0x1c000
    s_add_u32 m0, s51, 0x13000
    s_nop 0
    buffer_load_dwordx4 v9, s[12:15], s43 offen lds
    s_add_u32 s43, s42, 0x200
    s_add_u32 m0, s51, 0x14000
    s_nop 0
    buffer_load_dwordx4 v10, s[12:15], s43 offen lds
    s_add_u32 s43, s42, 0x4200
    s_add_u32 m0, s51, 0x15000
    s_nop 0
    buffer_load_dwordx4 v9, s[12:15], s43 offen lds
    s_add_u32 s43, s42, 0x8200
    s_add_u32 m0, s51, 0x16000
    s_nop 0
    buffer_load_dwordx4 v10, s[12:15], s43 offen lds
    s_add_u32 s43, s42, 0xc200
    s_add_u32 m0, s51, 0x17000
    s_nop 0
    buffer_load_dwordx4 v9, s[12:15], s43 offen lds
    s_waitcnt vmcnt(8)
    s_barrier
    v_xor_b32 v13, 0x0, v12
    v_add_u32 v13, 0x0, v13
    ds_read_b64_tr_b16 v[192:193], v13
    ds_read_b64_tr_b16 v[194:195], v13 offset:512
    ds_read_b64_tr_b16 v[196:197], v13 offset:2048
    ds_read_b64_tr_b16 v[198:199], v13 offset:2560
    v_xor_b32 v13, 0x2000, v12
    v_add_u32 v13, 0x0, v13
    ds_read_b64_tr_b16 v[200:201], v13
    ds_read_b64_tr_b16 v[202:203], v13 offset:512
    ds_read_b64_tr_b16 v[204:205], v13 offset:2048
    ds_read_b64_tr_b16 v[206:207], v13 offset:2560
    v_xor_b32 v13, 0x40, v12
    v_add_u32 v13, 0x0, v13
    ds_read_b64_tr_b16 v[224:225], v13
    ds_read_b64_tr_b16 v[226:227], v13 offset:512
    ds_read_b64_tr_b16 v[228:229], v13 offset:2048
    ds_read_b64_tr_b16 v[230:231], v13 offset:2560
    v_xor_b32 v13, 0x2040, v12
    v_add_u32 v13, 0x0, v13
    ds_read_b64_tr_b16 v[232:233], v13
    ds_read_b64_tr_b16 v[234:235], v13 offset:512
    ds_read_b64_tr_b16 v[236:237], v13 offset:2048
    ds_read_b64_tr_b16 v[238:239], v13 offset:2560
    s_lshr_b32 s43, s20, 1
    s_lshl_b32 s43, s43, 7
    s_and_b32 s40, s20, 1
    s_lshl_b32 s40, s40, 4
    s_add_u32 s43, s43, s40
    s_add_u32 s44, s43, 0x1000
    s_cmp_eq_u32 s21, 0
    s_cselect_b32 s44, s44, 0x7ff00000
    s_mov_b32 s22, 0
    s_mov_b32 s33, 0
    s_xor_b32 s53, s29, 1024
    s_add_u32 s23, s51, 0x7010000
    s_add_u32 s48, s23, 4096
    s_mov_b32 s24, 0x7012000
    s_add_u32 s55, s24, 16384
    s_mov_b32 s25, 0x7100000
    s_mov_b32 s26, 0x7101000
    v_mov_b32 v112, 0
    v_mov_b32 v113, 0
    v_mov_b32 v114, 0
    v_mov_b32 v115, 0
    ds_write_b128 v117, v[112:115] offset:22528
    ds_write_b128 v117, v[112:115] offset:23552
    s_cmp_lg_u32 s21, 0
    s_cselect_b32 s40, -1, 0
    v_mov_b32 v126, s40
    v_bfe_u32 v1, v117, 4, 1
    v_lshlrev_b32 v1, 4, v1
    s_movk_i32 s43, 0x3f80
    v_lshlrev_b32 v125, v1, s43
    v_bfe_u32 v1, v117, 5, 3
    v_cmp_eq_u32 s[68:69], 0, v1
    v_cmp_eq_u32 s[70:71], 1, v1
    v_cmp_eq_u32 s[72:73], 2, v1
    v_cmp_eq_u32 s[74:75], 3, v1
    v_mov_b32 v40, 0
    v_mov_b32 v41, 0
    v_mov_b32 v42, 0
    v_mov_b32 v43, 0
    v_mov_b32 v44, 0
    v_mov_b32 v45, 0
    v_mov_b32 v46, 0
    v_mov_b32 v47, 0
    v_mov_b32 v48, 0
    v_mov_b32 v49, 0
    v_mov_b32 v50, 0
    v_mov_b32 v51, 0
    v_mov_b32 v52, 0
    v_mov_b32 v53, 0
    v_mov_b32 v54, 0
    v_mov_b32 v55, 0
    s_mov_b32 s45, 0
    s_mov_b32 s46, 0
    s_mov_b32 s47, 0
    s_mov_b32 s76, 0
    s_and_b32 s43, s21, 1
    s_lshl_b32 s43, s43, 5
    s_add_u32 s43, s43, s20
    s_lshl_b32 s43, s43, 6
    s_add_u32 s28, s43, 0x2000
    s_mov_b32 s59, 0
    s_waitcnt vmcnt(0) lgkmcnt(0)
    s_barrier
    v_xor_b32 v13, 0x0, v12
    v_add_u32 v13, 0x8000, v13
    ds_read_b64_tr_b16 v[208:209], v13
    ds_read_b64_tr_b16 v[210:211], v13 offset:512
    ds_read_b64_tr_b16 v[212:213], v13 offset:2048
    ds_read_b64_tr_b16 v[214:215], v13 offset:2560
    v_xor_b32 v13, 0x2000, v12
    v_add_u32 v13, 0x8000, v13
    ds_read_b64_tr_b16 v[216:217], v13
    ds_read_b64_tr_b16 v[218:219], v13 offset:512
    ds_read_b64_tr_b16 v[220:221], v13 offset:2048
    ds_read_b64_tr_b16 v[222:223], v13 offset:2560
    v_xor_b32 v13, 0x40, v12
    v_add_u32 v13, 0x8000, v13
    ds_read_b64_tr_b16 v[240:241], v13
    ds_read_b64_tr_b16 v[242:243], v13 offset:512
    ds_read_b64_tr_b16 v[244:245], v13 offset:2048
    ds_read_b64_tr_b16 v[246:247], v13 offset:2560
    v_xor_b32 v13, 0x2040, v12
    v_add_u32 v13, 0x8000, v13
    ds_read_b64_tr_b16 v[248:249], v13
    ds_read_b64_tr_b16 v[250:251], v13 offset:512
    ds_read_b64_tr_b16 v[252:253], v13 offset:2048
    ds_read_b64_tr_b16 v[254:255], v13 offset:2560
    ds_write_b128 v123, v[80:83]
    ds_write_b128 v123, v[84:87] offset:1024
    ds_write_b128 v123, v[56:59] offset:2048
    ds_write_b128 v123, v[60:63] offset:3072
    ds_write_b128 v123, v[88:91] offset:4096
    ds_write_b128 v123, v[92:95] offset:5120
    ds_write_b128 v123, v[96:99] offset:6144
    ds_write_b128 v123, v[100:103] offset:7168
    s_cmp_eq_u32 s57, 1
    s_cbranch_scc1 L_started_52
    v_lshrrev_b32 v1, 4, v117
    v_and_b32 v2, 15, v1
    v_lshrrev_b32 v1, 4, v1
    v_lshlrev_b32 v1, 11, v1
    v_lshl_add_u32 v1, v2, 2, v1
    s_lshl_b32 s43, s20, 6
    s_add_u32 s43, s43, 0x2000
    s_mov_b32 exec_lo, 0x10001
    s_mov_b32 exec_hi, 0
    s_mov_b32 s96, 0
L_poll_53:
    buffer_load_dword v2, v1, s[8:11], s43 offen sc1
    s_waitcnt vmcnt(0)
    v_cmp_gt_u32 vcc, 1, v2
    s_cbranch_vccz L_polld_54
    s_sleep 8
    s_add_u32 s96, s96, 1
    s_cmp_lt_u32 s96, 0x10000
    s_cbranch_scc1 L_poll_53
L_polld_54:
    s_mov_b64 exec, -1
    s_add_u32 m0, s52, 8192
    s_nop 0
    buffer_load_dwordx4 v117, s[8:11], s30 offen lds
    buffer_load_dwordx4 v117, s[8:11], s30 offen offset:1024 lds
    s_add_u32 m0, s52, 0x6000
    s_nop 0
    buffer_load_dwordx4 v117, s[8:11], s31 offen lds
    buffer_load_dwordx4 v117, s[8:11], s31 offen offset:1024 lds
    s_mov_b32 s49, 0
L_cb_poll_56:
    buffer_load_dword v3, off, s[16:19], 0 offset:8 sc1
    s_waitcnt vmcnt(0)
    v_readfirstlane_b32 s43, v3
    s_nop 0
    s_cmp_ge_u32 s43, 32
    s_cbranch_scc1 L_started_52
    s_sleep 8
    s_add_u32 s49, s49, 1
    s_cmp_lt_u32 s49, 0x40000
    s_cbranch_scc1 L_cb_poll_56
L_started_52:
    v_lshrrev_b32 v1, 2, v117
    s_cmp_lt_u32 s21, 2
    s_cselect_b64 vcc, -1, 0
    v_cndmask_b32 v119, v119, v1, vcc
    s_add_u32 m0, s51, 4096
    v_mov_b32 v24, v32
    v_mov_b32 v25, v33
    v_mov_b32 v26, v34
    v_mov_b32 v27, v35
    v_mov_b32 v28, v36
    v_mov_b32 v29, v37
    v_mov_b32 v30, v38
    v_mov_b32 v31, v39
    s_add_u32 s30, s30, 0x40000
    s_add_u32 s31, s31, 0x40000
    s_mov_b32 s49, 0
    s_waitcnt vmcnt(0) lgkmcnt(0)
    s_barrier
    ds_write_b128 v123, v[64:67] offset:32768
    ds_write_b128 v123, v[68:71] offset:33792
    ds_write_b128 v123, v[72:75] offset:34816
    ds_write_b128 v123, v[76:79] offset:35840
    ds_write_b128 v123, v[104:107] offset:36864
    ds_write_b128 v123, v[108:111] offset:37888
    ds_write_b128 v123, v[32:35] offset:38912
    ds_write_b128 v123, v[36:39] offset:39936
    v_mov_b32 v32, 0
    v_mov_b32 v33, 0
    v_mov_b32 v34, 0
    v_mov_b32 v35, 0
    v_mov_b32 v36, 0
    v_mov_b32 v37, 0
    v_mov_b32 v38, 0
    v_mov_b32 v39, 0
    s_nop 4
    s_cmp_eq_u32 s21, 1
    s_cbranch_scc1 L_chain_top1_s
    s_cmp_eq_u32 s21, 2
    s_cbranch_scc1 L_chain_top2_s
    s_cmp_eq_u32 s21, 3
    s_cbranch_scc1 L_chain_top3_s
.p2align 6
L_chain_top0_s:
    buffer_load_dwordx4 v[0:3], v117, s[8:11], s23 offen sc1
    v_mov_b32 v15, 0
    v_mov_b32 v15, 0
    v_mov_b32 v15, 0
    v_mov_b32 v15, 0
    v_mov_b32 v15, 0
    v_mov_b32 v15, 0
    v_mov_b32 v15, 0
    v_mov_b32 v15, 0
    v_mov_b32 v15, 0
    v_mov_b32 v15, 0
    v_mov_b32 v15, 0
    v_mov_b32 v15, 0
    v_mov_b32 v15, 0
    v_mov_b32 v15, 0
    v_mov_b32 v15, 0
    v_mov_b32 v15, 0
    buffer_load_dwordx4 v[0:3], v117, s[8:11], s23 offen sc1
    v_mov_b32 v15, 0
    v_mov_b32 v15, 0
    v_mov_b32 v15, 0
    v_mov_b32 v15, 0
    v_mov_b32 v15, 0
    v_mov_b32 v15, 0
    v_mov_b32 v15, 0
    v_mov_b32 v15, 0
    v_mov_b32 v15, 0
    v_mov_b32 v15, 0
    v_mov_b32 v15, 0
    v_mov_b32 v15, 0
    v_mov_b32 v15, 0
    v_mov_b32 v15, 0
    v_mov_b32 v15, 0
    v_mov_b32 v15, 0
L_mret_58:
    buffer_load_dwordx4 v[0:3], v117, s[8:11], s23 offen sc1
    s_add_u32 s45, s45, 1
    s_cmp_lt_u32 s45, 0x10000
    s_cselect_b32 s56, -2, -1
    s_nop 3
    v_mov_b32 v32, 0
    v_mov_b32 v33, 0
    v_mov_b32 v34, 0
    v_mov_b32 v35, 0
    s_waitcnt vmcnt(2)
    v_max3_u32 v15, v0, v1, v2
    v_max_u32 v15, v15, v3
    v_cmp_lt_u32 vcc, s56, v15
    v_smfmac_f32_16x16x64_bf16 v[32:35], v[0:3], v[80:87], v116
    s_cbranch_vccnz L_mret_58
    ds_write_b128 v117, v[0:3]
    v_smfmac_f32_16x16x64_bf16 v[36:39], v[0:3], v[56:63], v116
    buffer_load_dwordx4 v[4:7], v117, s[8:11], s48 offen sc1
    v_smfmac_f32_16x16x64_bf16 v[40:43], v[0:3], v[64:71], v116
    buffer_load_dwordx4 v117, s[8:11], s48 offen sc1 lds
    s_mov_b32 m0, 8192
    v_smfmac_f32_16x16x64_bf16 v[44:47], v[0:3], v[72:79], v116
    s_waitcnt lgkmcnt(0)
    s_barrier
    ds_read_b128 v[8:11], v117 offset:1024
    v_smfmac_f32_16x16x64_bf16 v[48:51], v[0:3], a[192:199], v116
    ds_read_b128 v[16:19], v117 offset:2048
    ds_read_b128 v[20:23], v117 offset:3072
    v_smfmac_f32_16x16x64_bf16 v[52:55], v[0:3], a[200:207], v116
    ds_read_b128 v[80:83], v117 offset:14336
    s_waitcnt lgkmcnt(3)
    v_smfmac_f32_16x16x64_bf16 v[32:35], v[8:11], a[0:7], v116
    ds_read_b128 v[84:87], v117 offset:15360
    v_smfmac_f32_16x16x64_bf16 v[36:39], v[8:11], a[8:15], v116
    buffer_store_dwordx4 v[112:115], v117, s[8:11], s32 offen sc1
    s_waitcnt lgkmcnt(3)
    v_smfmac_f32_16x16x64_bf16 v[32:35], v[16:19], a[32:39], v116
    ds_read_b128 v[56:59], v117 offset:8192
    v_smfmac_f32_16x16x64_bf16 v[36:39], v[16:19], a[40:47], v116
    ds_read_b128 v[60:63], v117 offset:9216
    s_waitcnt lgkmcnt(4)
    v_smfmac_f32_16x16x64_bf16 v[32:35], v[20:23], a[64:71], v116
    ds_read_b128 v[64:67], v117 offset:10240
    v_smfmac_f32_16x16x64_bf16 v[36:39], v[20:23], a[72:79], v116
    ds_read_b128 v[68:71], v117 offset:11264
    v_smfmac_f32_16x16x64_bf16 v[40:43], v[8:11], a[96:103], v116
    ds_read_b128 v[72:75], v117 offset:12288
    v_smfmac_f32_16x16x64_bf16 v[40:43], v[16:19], a[128:135], v116
    ds_read_b128 v[76:79], v117 offset:13312
    v_smfmac_f32_16x16x64_bf16 v[40:43], v[20:23], a[160:167], v116
    s_waitcnt vmcnt(2)
    v_max3_u32 v15, v4, v5, v6
    v_smfmac_f32_16x16x64_bf16 v[44:47], v[8:11], a[104:111], v116
    v_max_u32 v15, v15, v7
    v_smfmac_f32_16x16x64_bf16 v[44:47], v[16:19], a[136:143], v116
    s_waitcnt vmcnt(1) lgkmcnt(0)
    v_cmp_lt_u32 vcc, s56, v15
    v_smfmac_f32_16x16x64_bf16 v[44:47], v[20:23], a[168:175], v116
    s_cbranch_vccnz L_mret_59
L_mgo_60:
    v_smfmac_f32_16x16x64_bf16 v[44:47], v[4:7], v[24:31], v116
    s_barrier
    ds_read_b128 v[12:15], v117 offset:5120
    v_smfmac_f32_16x16x64_bf16 v[32:35], v[4:7], v[88:95], v116
    ds_read_b128 v[24:27], v117 offset:6144
    v_smfmac_f32_16x16x64_bf16 v[36:39], v[4:7], v[96:103], v116
    ds_read_b128 v[28:31], v117 offset:7168
    v_smfmac_f32_16x16x64_bf16 v[40:43], v[4:7], v[104:111], v116
    ds_read_b128 v[88:91], v117 offset:24576
    s_waitcnt lgkmcnt(3)
    v_smfmac_f32_16x16x64_bf16 v[32:35], v[12:15], a[16:23], v116
    ds_read_b128 v[92:95], v117 offset:25600
    s_waitcnt lgkmcnt(3)
    v_smfmac_f32_16x16x64_bf16 v[32:35], v[24:27], a[48:55], v116
    buffer_load_dwordx4 v117, s[8:11], s30 offen lds
    s_waitcnt lgkmcnt(2)
    v_smfmac_f32_16x16x64_bf16 v[32:35], v[28:31], a[80:87], v116
    ds_read_b128 v[96:99], v117 offset:23552
    v_smfmac_f32_16x16x64_bf16 v[36:39], v[12:15], a[24:31], v116
    ds_read_b128 v[100:103], v117 offset:23552
    v_smfmac_f32_16x16x64_bf16 v[36:39], v[24:27], a[56:63], v116
    buffer_load_dwordx4 v117, s[8:11], s30 offen offset:1024 lds
    s_add_u32 m0, s52, 0x6000
    v_add_f32 v32, v32, v34
    v_smfmac_f32_16x16x64_bf16 v[36:39], v[28:31], a[88:95], v116
    ds_read_b128 v[104:107], v117 offset:23552
    v_add_f32 v33, v33, v35
    v_smfmac_f32_16x16x64_bf16 v[40:43], v[12:15], a[112:119], v116
    ds_read_b128 v[108:111], v117 offset:23552
    v_mul_f32 v32, s34, v32
    v_smfmac_f32_16x16x64_bf16 v[40:43], v[24:27], a[144:151], v116
    buffer_load_dword v125, v119, s[8:11], s28 offen sc1
    v_mul_f32 v33, s34, v33
    v_smfmac_f32_16x16x64_bf16 v[40:43], v[28:31], a[176:183], v116
    ds_read_b128 v[0:3], v124
    v_add_f32 v36, v36, v38
    v_smfmac_f32_16x16x64_bf16 v[48:51], v[4:7], a[208:215], v116
    v_add_f32 v37, v37, v39
    v_smfmac_f32_16x16x64_bf16 v[52:55], v[4:7], a[216:223], v116
    s_waitcnt lgkmcnt(5)
    buffer_load_dwordx4 v117, s[8:11], s31 offen lds
    v_mul_f32 v36, s34, v36
    v_smfmac_f32_16x16x64_bf16 v[44:47], v[12:15], a[120:127], v116
    ds_read_b128 v[4:7], v124 offset:1024
    v_mul_f32 v37, s34, v37
    v_smfmac_f32_16x16x64_bf16 v[44:47], v[24:27], a[152:159], v116
    v_cvt_pk_bf16_f32 v34, v32, v36
    v_smfmac_f32_16x16x64_bf16 v[44:47], v[28:31], a[184:191], v116
    buffer_load_dwordx4 v117, s[8:11], s31 offen offset:1024 lds
    s_mov_b32 m0, 4096
    v_cvt_pk_bf16_f32 v35, v33, v37
    v_add_f32 v40, v40, v42
    v_smfmac_f32_16x16x64_bf16 v[48:51], v[8:11], a[224:231], v116
    ds_write2_b32 v120, v34, v35 offset0:32 offset1:48
    v_add_f32 v41, v41, v43
    v_smfmac_f32_16x16x64_bf16 v[52:55], v[8:11], a[232:239], v116
    v_add_f32 v44, v44, v46
    v_add_f32 v45, v45, v47
    v_cvt_pk_bf16_f32 v113, v40, v44
    v_cvt_pk_bf16_f32 v115, v41, v45
    v_smfmac_f32_16x16x64_bf16 v[48:51], v[12:15], a[240:247], v116
    ds_write2_b32 v120, v113, v115 offset0:0 offset1:16
    v_smfmac_f32_16x16x64_bf16 v[52:55], v[12:15], a[248:255], v116
    s_cmp_eq_u32 s22, 63
    s_cbranch_scc1 L_chain_last_s
    buffer_store_dword v126, off, s[8:11], s44 sc1
    v_smfmac_f32_16x16x64_bf16 v[48:51], v[16:19], v[128:135], v116
    v_smfmac_f32_16x16x64_bf16 v[48:51], v[20:23], v[160:167], v116
    v_smfmac_f32_16x16x64_bf16 v[48:51], v[24:27], v[144:151], v116
    s_waitcnt lgkmcnt(0)
    s_barrier
    v_smfmac_f32_16x16x64_bf16 v[48:51], v[28:31], v[176:183], v116
    ds_read_b128 v[32:35], v121 offset:16384
    ds_read_b128 v[36:39], v121 offset:17408
    v_smfmac_f32_16x16x64_bf16 v[52:55], v[16:19], v[136:143], v116
    ds_read_b128 v[40:43], v121 offset:18432
    ds_read_b128 v[44:47], v121 offset:19456
    v_smfmac_f32_16x16x64_bf16 v[52:55], v[20:23], v[168:175], v116
    ds_read_b128 v[8:11], v124 offset:32768
    v_add_f32 v48, v48, v50
    v_smfmac_f32_16x16x64_bf16 v[52:55], v[24:27], v[152:159], v116
    ds_read_b128 v[12:15], v124 offset:33792
    v_add_f32 v49, v49, v51
    v_smfmac_f32_16x16x64_bf16 v[52:55], v[28:31], v[184:191], v116
    s_waitcnt lgkmcnt(5)
    v_cvt_pk_bf16_f32 v112, v48, v49
    v_mfma_f32_16x16x32_bf16 v[56:59], v[56:59], v[32:35], 0
    s_waitcnt lgkmcnt(4)
    v_mov_b32 v48, s50
    v_mov_b32 v49, s50
    v_mfma_f32_16x16x32_bf16 v[56:59], v[60:63], v[36:39], v[56:59]
    ds_read_b128 v[16:19], v124 offset:2048
    s_waitcnt lgkmcnt(4)
    v_mov_b32 v50, s50
    v_mov_b32 v51, s50
    v_mfma_f32_16x16x32_bf16 v[56:59], v[64:67], v[40:43], v[56:59]
    ds_read_b128 v[20:23], v124 offset:3072
    s_waitcnt lgkmcnt(4)
    v_add_f32 v52, v52, v54
    v_mfma_f32_16x16x32_bf16 v[56:59], v[68:71], v[44:47], v[56:59]
    ds_read_b128 v[24:27], v124 offset:4096
    v_add_f32 v53, v53, v55
    v_mfma_f32_16x16x32_bf16 v[60:63], v[72:75], v[32:35], 0
    ds_read_b128 v[28:31], v124 offset:5120
    v_cvt_pk_bf16_f32 v114, v52, v53
    v_mov_b32 v53, 0
    v_mfma_f32_16x16x32_bf16 v[60:63], v[76:79], v[36:39], v[60:63]
    v_exp_f32 v56, v56
    v_mfma_f32_16x16x32_bf16 v[60:63], v[80:83], v[40:43], v[60:63]
    v_exp_f32 v57, v57
    v_mfma_f32_16x16x32_bf16 v[60:63], v[84:87], v[44:47], v[60:63]
    v_exp_f32 v58, v58
    v_mfma_f32_16x16x32_bf16 v[64:67], v[32:35], v[32:35], 0
    v_exp_f32 v59, v59
    v_cvt_pk_bf16_f32 v68, v56, v57
    v_mfma_f32_16x16x32_bf16 v[64:67], v[36:39], v[36:39], v[64:67]
    v_exp_f32 v60, v60
    v_cvt_pk_bf16_f32 v69, v58, v59
    v_mfma_f32_16x16x32_bf16 v[64:67], v[40:43], v[40:43], v[64:67]
    v_exp_f32 v61, v61
    v_mfma_f32_16x16x32_bf16 v[64:67], v[44:47], v[44:47], v[64:67]
    v_exp_f32 v62, v62
    v_exp_f32 v63, v63
    v_cvt_pk_bf16_f32 v70, v60, v61
    v_cvt_pk_bf16_f32 v71, v62, v63
    s_nop 1
    v_mfma_f32_16x16x32_bf16 v[72:75], v[88:91], v[68:71], 0
    s_nop 0
    v_exp_f32 v64, v64
    v_mfma_f32_16x16x32_bf16 v[76:79], v[92:95], v[68:71], 0
    v_exp_f32 v65, v65
    v_mfma_f32_16x16x32_bf16 v[80:83], v[48:51], v[68:71], 0
    v_cvt_pk_bf16_f32 v52, v64, v65
    s_nop 1
    v_mfma_f32_16x16x16_bf16 v[72:75], v[112:113], v[52:53], v[72:75]
    ds_read_b128 v[32:35], v124 offset:6144
    v_mfma_f32_16x16x16_bf16 v[76:79], v[114:115], v[52:53], v[76:79]
    ds_read_b128 v[36:39], v124 offset:7168
    v_mfma_f32_16x16x16_bf16 v[80:83], v[48:49], v[52:53], v[80:83]
L_norm_61:
    s_mov_b64 vcc, s[36:37]
    v_mov_b32 v122, v122
    v_mov_b32 v122, v122
    v_mov_b32 v122, v122
    v_cndmask_b32_dpp v76, v72, v76, vcc quad_perm:[2,3,2,3] row_mask:0xf bank_mask:0xf
    v_cndmask_b32_dpp v77, v73, v77, vcc quad_perm:[2,3,2,3] row_mask:0xf bank_mask:0xf
    v_cndmask_b32_dpp v78, v74, v78, vcc quad_perm:[2,3,2,3] row_mask:0xf bank_mask:0xf
    v_cndmask_b32_dpp v79, v75, v79, vcc quad_perm:[2,3,2,3] row_mask:0xf bank_mask:0xf
    v_rcp_f32_dpp v84, v80 quad_perm:[2,3,2,3] row_mask:0xf bank_mask:0xf
    s_nop 0
    v_pk_mul_f32 v[76:77], v[76:77], v[84:85] op_sel_hi:[1,0]
    v_pk_mul_f32 v[78:79], v[78:79], v[84:85] op_sel_hi:[1,0]
    v_cvt_pk_bf16_f32 v72, v76, v77
    v_cvt_pk_bf16_f32 v73, v78, v79
    ds_write_b64 v122, v[72:73] offset:20480
    v_max_f32_dpp v86, v80, v84 quad_perm:[2,3,2,3] row_mask:0xf bank_mask:0xf
    v_mov_b32_dpp v60, v72 quad_perm:[0,1,0,1] row_mask:0xf bank_mask:0xf
    v_mov_b32_dpp v61, v73 quad_perm:[0,1,0,1] row_mask:0xf bank_mask:0xf
    v_cmp_lt_f32 vcc, s35, v86
    v_mov_b32_dpp v62, v72 quad_perm:[2,3,2,3] row_mask:0xf bank_mask:0xf
    v_mov_b32_dpp v63, v73 quad_perm:[2,3,2,3] row_mask:0xf bank_mask:0xf
    s_nop 1
    v_smfmac_f32_16x16x64_bf16 v[96:99], v[60:63], v[192:199], v116
    s_cbranch_vccnz L_smax_62
    v_smfmac_f32_16x16x64_bf16 v[100:103], v[60:63], v[224:231], v116
    s_waitcnt lgkmcnt(0)
    s_barrier
    ds_read_b128 v[92:95], v127 offset:20992
    ds_read_b128 v[80:83], v127 offset:21504
    ds_read_b128 v[84:87], v127 offset:22016
    v_smfmac_f32_16x16x64_bf16 v[104:107], v[60:63], v[0:7], v116
    ds_read_b128 v[40:43], v124 offset:34816
    v_smfmac_f32_16x16x64_bf16 v[108:111], v[60:63], v[8:15], v116
    ds_read_b128 v[56:59], v124 offset:36864
    s_waitcnt lgkmcnt(4)
    v_smfmac_f32_16x16x64_bf16 v[96:99], v[92:95], v[200:207], v116
    s_waitcnt lgkmcnt(3)
    v_smfmac_f32_16x16x64_bf16 v[96:99], v[80:83], v[208:215], v116
    ds_read_b128 v[44:47], v124 offset:35840
    s_waitcnt lgkmcnt(3)
    v_smfmac_f32_16x16x64_bf16 v[96:99], v[84:87], v[216:223], v116
    ds_read_b128 v[68:71], v124 offset:39936
    v_smfmac_f32_16x16x64_bf16 v[100:103], v[92:95], v[232:239], v116
    ds_read_b128 v[64:67], v124 offset:38912
    v_smfmac_f32_16x16x64_bf16 v[100:103], v[80:83], v[240:247], v116
    ds_read_b128 v[60:63], v124 offset:37888
    v_cvt_pk_bf16_f32 v72, v96, v98
    v_smfmac_f32_16x16x64_bf16 v[100:103], v[84:87], v[248:255], v116
    v_and_or_b32 v72, v72, -2, s33
    v_smfmac_f32_16x16x64_bf16 v[104:107], v[92:95], v[16:23], v116
    v_cvt_pk_bf16_f32 v74, v97, v99
    v_smfmac_f32_16x16x64_bf16 v[104:107], v[80:83], v[24:31], v116
    v_cvt_pk_bf16_f32 v73, v100, v102
    v_cvt_pk_bf16_f32 v75, v101, v103
    v_smfmac_f32_16x16x64_bf16 v[104:107], v[84:87], v[32:39], v116
    buffer_store_dwordx4 v[72:75], v118, s[8:11], s25 offen sc1
    s_waitcnt lgkmcnt(3)
    v_smfmac_f32_16x16x64_bf16 v[108:111], v[92:95], v[40:47], v116
    s_waitcnt lgkmcnt(0)
    v_smfmac_f32_16x16x64_bf16 v[108:111], v[80:83], v[56:63], v116
    v_cvt_pk_bf16_f32 v76, v104, v106
    v_smfmac_f32_16x16x64_bf16 v[108:111], v[84:87], v[64:71], v116
    v_and_or_b32 v76, v76, -2, s33
    v_cvt_pk_bf16_f32 v78, v105, v107
    v_mov_b32 v122, v122
    v_mov_b32 v122, v122
    v_mov_b32 v122, v122
    v_mov_b32 v122, v122
    v_mov_b32 v122, v122
    v_mov_b32 v122, v122
    v_cvt_pk_bf16_f32 v77, v108, v110
    v_cvt_pk_bf16_f32 v79, v109, v111
    buffer_store_dwordx4 v[76:79], v118, s[8:11], s26 offen sc1
    s_add_u32 s30, s30, 0x40000
    s_add_u32 s31, s31, 0x40000
    s_add_u32 s32, s32, 0x20000
    s_add_u32 s23, s24, 0
    s_add_u32 s48, s23, 4096
    s_xor_b32 s25, s25, 0x0
    s_xor_b32 s26, s26, 0x0
    s_mov_b32 s35, 0x49800000
    v_mov_b32 v126, s22
    s_add_u32 s22, s22, 1
    v_mov_b32 v32, 0
    v_mov_b32 v33, 0
    v_mov_b32 v34, 0
    v_mov_b32 v35, 0
    v_mov_b32 v36, 0
    v_mov_b32 v37, 0
    v_mov_b32 v38, 0
    v_mov_b32 v39, 0
    v_mov_b32 v40, 0
    v_mov_b32 v41, 0
    v_mov_b32 v42, 0
    v_mov_b32 v43, 0
    v_mov_b32 v44, 0
    v_mov_b32 v45, 0
    v_mov_b32 v46, 0
    v_mov_b32 v47, 0
    v_mov_b32 v48, 0
    v_mov_b32 v49, 0
    v_mov_b32 v50, 0
    v_mov_b32 v51, 0
    v_mov_b32 v52, 0
    v_mov_b32 v53, 0
    v_mov_b32 v54, 0
    v_mov_b32 v55, 0
    ds_read_b128 v[80:83], v123
    ds_read_b128 v[84:87], v123 offset:1024
    ds_read_b128 v[56:59], v123 offset:2048
    ds_read_b128 v[60:63], v123 offset:3072
    ds_read_b128 v[64:67], v123 offset:32768
    ds_read_b128 v[68:71], v123 offset:33792
    ds_read_b128 v[72:75], v123 offset:34816
    ds_read_b128 v[76:79], v123 offset:35840
    ds_read_b128 v[88:91], v123 offset:4096
    ds_read_b128 v[92:95], v123 offset:5120
    ds_read_b128 v[96:99], v123 offset:6144
    ds_read_b128 v[100:103], v123 offset:7168
    ds_read_b128 v[104:107], v123 offset:36864
    ds_read_b128 v[108:111], v123 offset:37888
    ds_read_b128 v[24:27], v123 offset:38912
    ds_read_b128 v[28:31], v123 offset:39936
    s_add_u32 s24, s24, 8192
    s_bitset0_b32 s24, 15
    s_xor_b32 s55, s24, 16384
    s_xor_b32 s29, s29, 0x0
    s_xor_b32 s53, s29, 1024
    s_bfe_u32 s33, s22, 0x10000
    s_add_u32 s40, s22, 5
    s_lshr_b32 s40, s40, 2
    s_min_u32 s40, s40, 16
    s_bfm_b32 s58, s40, 0
    s_waitcnt vmcnt(5)
    v_cmp_eq_u32 vcc, 0, v125
    s_nop 0
    s_and_b64 vcc, vcc, s[58:59]
    s_cbranch_scc1 L_kvw_63
L_kvb_64:
    v_mov_b32 v15, 0
    s_nop 2
    v_mov_b32 v15, 0
    s_nop 2
    v_mov_b32 v15, 0
    s_nop 2
    v_mov_b32 v15, 0
    s_nop 2
    v_mov_b32 v15, 0
    s_nop 2
    v_mov_b32 v15, 0
    s_nop 2
    v_mov_b32 v15, 0
    s_nop 2
    v_mov_b32 v15, 0
    s_nop 2
    v_mov_b32 v15, 0
    s_nop 2
    v_mov_b32 v15, 0
    s_nop 2
    v_mov_b32 v15, 0
    s_nop 2
    v_mov_b32 v15, 0
    s_nop 2
    v_mov_b32 v15, 0
    s_nop 2
    v_mov_b32 v15, 0
    s_nop 2
    v_mov_b32 v15, 0
    s_nop 2
    v_mov_b32 v15, 0
    s_nop 2
    v_mov_b32 v15, 0
    s_nop 2
    v_mov_b32 v15, 0
    s_nop 2
    v_mov_b32 v15, 0
    s_nop 2
    v_mov_b32 v15, 0
    s_nop 2
    v_mov_b32 v15, 0
    s_nop 2
    v_mov_b32 v15, 0
    s_nop 2
    v_mov_b32 v15, 0
    s_nop 2
    v_mov_b32 v15, 0
    s_nop 2
    v_mov_b32 v15, 0
    s_nop 2
    v_mov_b32 v15, 0
    s_nop 2
    v_mov_b32 v15, 0
    s_nop 2
    v_mov_b32 v15, 0
    s_nop 2
    v_mov_b32 v15, 0
    s_nop 2
    v_mov_b32 v15, 0
    s_nop 2
    v_mov_b32 v15, 0
    s_nop 2
    s_waitcnt lgkmcnt(0)
    s_branch L_chain_top0_s
.p2align 6
L_chain_top1_s:
    buffer_load_dwordx4 v[0:3], v117, s[8:11], s23 offen sc1
    v_mov_b32 v15, 0
    v_mov_b32 v15, 0
    v_mov_b32 v15, 0
    v_mov_b32 v15, 0
    v_mov_b32 v15, 0
    v_mov_b32 v15, 0
    v_mov_b32 v15, 0
    v_mov_b32 v15, 0
    v_mov_b32 v15, 0
    v_mov_b32 v15, 0
    v_mov_b32 v15, 0
    v_mov_b32 v15, 0
    v_mov_b32 v15, 0
    v_mov_b32 v15, 0
    v_mov_b32 v15, 0
    v_mov_b32 v15, 0
    buffer_load_dwordx4 v[0:3], v117, s[8:11], s23 offen sc1
    v_mov_b32 v15, 0
    v_mov_b32 v15, 0
    v_mov_b32 v15, 0
    v_mov_b32 v15, 0
    v_mov_b32 v15, 0
    v_mov_b32 v15, 0
    v_mov_b32 v15, 0
    v_mov_b32 v15, 0
    v_mov_b32 v15, 0
    v_mov_b32 v15, 0
    v_mov_b32 v15, 0
    v_mov_b32 v15, 0
    v_mov_b32 v15, 0
    v_mov_b32 v15, 0
    v_mov_b32 v15, 0
    v_mov_b32 v15, 0
L_mret_65:
    buffer_load_dwordx4 v[0:3], v117, s[8:11], s23 offen sc1
    s_add_u32 s45, s45, 1
    s_cmp_lt_u32 s45, 0x10000
    s_cselect_b32 s56, -2, -1
    s_nop 3
    v_mov_b32 v32, 0
    v_mov_b32 v33, 0
    v_mov_b32 v34, 0
    v_mov_b32 v35, 0
    s_waitcnt vmcnt(2)
    v_max3_u32 v15, v0, v1, v2
    v_max_u32 v15, v15, v3
    v_cmp_lt_u32 vcc, s56, v15
    v_smfmac_f32_16x16x64_bf16 v[32:35], v[0:3], v[80:87], v116
    s_cbranch_vccnz L_mret_65
    ds_write_b128 v117, v[0:3] offset:1024
    v_smfmac_f32_16x16x64_bf16 v[36:39], v[0:3], v[56:63], v116
    buffer_load_dwordx4 v[4:7], v117, s[8:11], s48 offen sc1
    v_smfmac_f32_16x16x64_bf16 v[40:43], v[0:3], v[64:71], v116
    buffer_load_dwordx4 v117, s[8:11], s48 offen sc1 lds
    s_mov_b32 m0, 10240
    v_smfmac_f32_16x16x64_bf16 v[44:47], v[0:3], v[72:79], v116
    s_waitcnt lgkmcnt(0)
    s_barrier
    ds_read_b128 v[8:11], v117
    v_smfmac_f32_16x16x64_bf16 v[48:51], v[0:3], a[192:199], v116
    ds_read_b128 v[16:19], v117 offset:3072
    ds_read_b128 v[20:23], v117 offset:2048
    v_smfmac_f32_16x16x64_bf16 v[52:55], v[0:3], a[200:207], v116
    ds_read_b128 v[80:83], v117 offset:14336
    s_waitcnt lgkmcnt(3)
    v_smfmac_f32_16x16x64_bf16 v[32:35], v[8:11], a[0:7], v116
    ds_read_b128 v[84:87], v117 offset:15360
    v_smfmac_f32_16x16x64_bf16 v[36:39], v[8:11], a[8:15], v116
    ds_read_b128 v[56:59], v117 offset:8192
    s_waitcnt lgkmcnt(4)
    v_smfmac_f32_16x16x64_bf16 v[32:35], v[16:19], a[32:39], v116
    ds_read_b128 v[60:63], v117 offset:9216
    v_smfmac_f32_16x16x64_bf16 v[36:39], v[16:19], a[40:47], v116
    buffer_store_dwordx4 v[112:115], v117, s[8:11], s32 offen sc1
    s_waitcnt lgkmcnt(4)
    v_smfmac_f32_16x16x64_bf16 v[32:35], v[20:23], a[64:71], v116
    ds_read_b128 v[64:67], v117 offset:10240
    v_smfmac_f32_16x16x64_bf16 v[36:39], v[20:23], a[72:79], v116
    ds_read_b128 v[68:71], v117 offset:11264
    v_smfmac_f32_16x16x64_bf16 v[40:43], v[8:11], a[96:103], v116
    ds_read_b128 v[72:75], v117 offset:12288
    v_smfmac_f32_16x16x64_bf16 v[40:43], v[16:19], a[128:135], v116
    ds_read_b128 v[76:79], v117 offset:13312
    v_smfmac_f32_16x16x64_bf16 v[40:43], v[20:23], a[160:167], v116
    s_waitcnt vmcnt(2)
    v_max3_u32 v15, v4, v5, v6
    v_smfmac_f32_16x16x64_bf16 v[44:47], v[8:11], a[104:111], v116
    v_max_u32 v15, v15, v7
    v_smfmac_f32_16x16x64_bf16 v[44:47], v[16:19], a[136:143], v116
    s_waitcnt vmcnt(1) lgkmcnt(0)
    v_cmp_lt_u32 vcc, s56, v15
    v_smfmac_f32_16x16x64_bf16 v[44:47], v[20:23], a[168:175], v116
    s_cbranch_vccnz L_mret_66
L_mgo_67:
    v_smfmac_f32_16x16x64_bf16 v[44:47], v[4:7], v[24:31], v116
    s_barrier
    ds_read_b128 v[12:15], v117 offset:4096
    v_smfmac_f32_16x16x64_bf16 v[32:35], v[4:7], v[88:95], v116
    ds_read_b128 v[24:27], v117 offset:7168
    v_smfmac_f32_16x16x64_bf16 v[36:39], v[4:7], v[96:103], v116
    ds_read_b128 v[28:31], v117 offset:6144
    v_smfmac_f32_16x16x64_bf16 v[40:43], v[4:7], v[104:111], v116
    ds_read_b128 v[88:91], v117 offset:26624
    s_waitcnt lgkmcnt(3)
    v_smfmac_f32_16x16x64_bf16 v[32:35], v[12:15], a[16:23], v116
    ds_read_b128 v[92:95], v117 offset:27648
    s_waitcnt lgkmcnt(3)
    v_smfmac_f32_16x16x64_bf16 v[32:35], v[24:27], a[48:55], v116
    buffer_load_dwordx4 v117, s[8:11], s30 offen lds
    s_waitcnt lgkmcnt(2)
    v_smfmac_f32_16x16x64_bf16 v[32:35], v[28:31], a[80:87], v116
    ds_read_b128 v[96:99], v117 offset:23552
    v_smfmac_f32_16x16x64_bf16 v[36:39], v[12:15], a[24:31], v116
    ds_read_b128 v[100:103], v117 offset:23552
    v_smfmac_f32_16x16x64_bf16 v[36:39], v[24:27], a[56:63], v116
    buffer_load_dwordx4 v117, s[8:11], s30 offen offset:1024 lds
    s_add_u32 m0, s52, 0x6000
    v_add_f32 v32, v32, v34
    v_smfmac_f32_16x16x64_bf16 v[36:39], v[28:31], a[88:95], v116
    ds_read_b128 v[104:107], v117 offset:23552
    v_add_f32 v33, v33, v35
    v_smfmac_f32_16x16x64_bf16 v[40:43], v[12:15], a[112:119], v116
    ds_read_b128 v[108:111], v117 offset:23552
    v_mul_f32 v32, s34, v32
    v_smfmac_f32_16x16x64_bf16 v[40:43], v[24:27], a[144:151], v116
    buffer_load_dword v125, v119, s[8:11], s28 offen sc1
    v_mul_f32 v33, s34, v33
    v_smfmac_f32_16x16x64_bf16 v[40:43], v[28:31], a[176:183], v116
    ds_read_b128 v[0:3], v124
    v_add_f32 v36, v36, v38
    v_smfmac_f32_16x16x64_bf16 v[48:51], v[4:7], a[208:215], v116
    v_add_f32 v37, v37, v39
    v_smfmac_f32_16x16x64_bf16 v[52:55], v[4:7], a[216:223], v116
    s_waitcnt lgkmcnt(5)
    buffer_load_dwordx4 v117, s[8:11], s31 offen lds
    v_mul_f32 v36, s34, v36
    v_smfmac_f32_16x16x64_bf16 v[44:47], v[12:15], a[120:127], v116
    ds_read_b128 v[4:7], v124 offset:1024
    v_mul_f32 v37, s34, v37
    v_smfmac_f32_16x16x64_bf16 v[44:47], v[24:27], a[152:159], v116
    v_cvt_pk_bf16_f32 v34, v32, v36
    v_smfmac_f32_16x16x64_bf16 v[44:47], v[28:31], a[184:191], v116
    buffer_load_dwordx4 v117, s[8:11], s31 offen offset:1024 lds
    s_mov_b32 m0, 5120
    v_cvt_pk_bf16_f32 v35, v33, v37
    v_add_f32 v40, v40, v42
    v_smfmac_f32_16x16x64_bf16 v[48:51], v[8:11], a[224:231], v116
    ds_write2_b32 v120, v34, v35 offset0:32 offset1:48
    v_add_f32 v41, v41, v43
    v_smfmac_f32_16x16x64_bf16 v[52:55], v[8:11], a[232:239], v116
    v_add_f32 v44, v44, v46
    v_add_f32 v45, v45, v47
    v_cvt_pk_bf16_f32 v113, v40, v44
    v_cvt_pk_bf16_f32 v115, v41, v45
    v_smfmac_f32_16x16x64_bf16 v[48:51], v[12:15], a[240:247], v116
    ds_write2_b32 v120, v113, v115 offset0:0 offset1:16
    v_smfmac_f32_16x16x64_bf16 v[52:55], v[12:15], a[248:255], v116
    s_cmp_eq_u32 s22, 63
    s_cbranch_scc1 L_chain_last_s
    v_smfmac_f32_16x16x64_bf16 v[48:51], v[16:19], v[128:135], v116
    v_smfmac_f32_16x16x64_bf16 v[48:51], v[20:23], v[160:167], v116
    v_smfmac_f32_16x16x64_bf16 v[48:51], v[24:27], v[144:151], v116
    s_waitcnt lgkmcnt(0)
    s_barrier
    v_smfmac_f32_16x16x64_bf16 v[48:51], v[28:31], v[176:183], v116
    ds_read_b128 v[32:35], v121 offset:16384
    ds_read_b128 v[36:39], v121 offset:17408
    v_smfmac_f32_16x16x64_bf16 v[52:55], v[16:19], v[136:143], v116
    ds_read_b128 v[40:43], v121 offset:18432
    ds_read_b128 v[44:47], v121 offset:19456
    v_smfmac_f32_16x16x64_bf16 v[52:55], v[20:23], v[168:175], v116
    ds_read_b128 v[8:11], v124 offset:32768
    v_add_f32 v48, v48, v50
    v_smfmac_f32_16x16x64_bf16 v[52:55], v[24:27], v[152:159], v116
    ds_read_b128 v[12:15], v124 offset:33792
    v_add_f32 v49, v49, v51
    v_smfmac_f32_16x16x64_bf16 v[52:55], v[28:31], v[184:191], v116
    s_waitcnt lgkmcnt(5)
    v_cvt_pk_bf16_f32 v112, v48, v49
    v_mfma_f32_16x16x32_bf16 v[56:59], v[56:59], v[32:35], 0
    s_waitcnt lgkmcnt(4)
    v_mov_b32 v48, s50
    v_mov_b32 v49, s50
    v_mfma_f32_16x16x32_bf16 v[56:59], v[60:63], v[36:39], v[56:59]
    ds_read_b128 v[16:19], v124 offset:2048
    s_waitcnt lgkmcnt(4)
    v_mov_b32 v50, s50
    v_mov_b32 v51, s50
    v_mfma_f32_16x16x32_bf16 v[56:59], v[64:67], v[40:43], v[56:59]
    ds_read_b128 v[20:23], v124 offset:3072
    s_waitcnt lgkmcnt(4)
    v_add_f32 v52, v52, v54
    v_mfma_f32_16x16x32_bf16 v[56:59], v[68:71], v[44:47], v[56:59]
    ds_read_b128 v[24:27], v124 offset:4096
    v_add_f32 v53, v53, v55
    v_mfma_f32_16x16x32_bf16 v[60:63], v[72:75], v[32:35], 0
    ds_read_b128 v[28:31], v124 offset:5120
    v_cvt_pk_bf16_f32 v114, v52, v53
    v_mov_b32 v53, 0
    v_mfma_f32_16x16x32_bf16 v[60:63], v[76:79], v[36:39], v[60:63]
    v_exp_f32 v56, v56
    v_mfma_f32_16x16x32_bf16 v[60:63], v[80:83], v[40:43], v[60:63]
    v_exp_f32 v57, v57
    v_mfma_f32_16x16x32_bf16 v[60:63], v[84:87], v[44:47], v[60:63]
    v_exp_f32 v58, v58
    v_mfma_f32_16x16x32_bf16 v[64:67], v[32:35], v[32:35], 0
    v_exp_f32 v59, v59
    v_cvt_pk_bf16_f32 v68, v56, v57
    v_mfma_f32_16x16x32_bf16 v[64:67], v[36:39], v[36:39], v[64:67]
    v_exp_f32 v60, v60
    v_cvt_pk_bf16_f32 v69, v58, v59
    v_mfma_f32_16x16x32_bf16 v[64:67], v[40:43], v[40:43], v[64:67]
    v_exp_f32 v61, v61
    v_mfma_f32_16x16x32_bf16 v[64:67], v[44:47], v[44:47], v[64:67]
    v_exp_f32 v62, v62
    v_exp_f32 v63, v63
    v_cvt_pk_bf16_f32 v70, v60, v61
    v_cvt_pk_bf16_f32 v71, v62, v63
    s_nop 1
    v_mfma_f32_16x16x32_bf16 v[72:75], v[88:91], v[68:71], 0
    s_nop 0
    v_exp_f32 v64, v64
    v_mfma_f32_16x16x32_bf16 v[76:79], v[92:95], v[68:71], 0
    v_exp_f32 v65, v65
    v_mfma_f32_16x16x32_bf16 v[80:83], v[48:51], v[68:71], 0
    v_cvt_pk_bf16_f32 v52, v64, v65
    s_nop 1
    v_mfma_f32_16x16x16_bf16 v[72:75], v[112:113], v[52:53], v[72:75]
    ds_read_b128 v[32:35], v124 offset:6144
    v_mfma_f32_16x16x16_bf16 v[76:79], v[114:115], v[52:53], v[76:79]
    ds_read_b128 v[36:39], v124 offset:7168
    v_mfma_f32_16x16x16_bf16 v[80:83], v[48:49], v[52:53], v[80:83]
L_norm_68:
    s_mov_b64 vcc, s[36:37]
    v_mov_b32 v122, v122
    v_mov_b32 v122, v122
    v_mov_b32 v122, v122
    v_cndmask_b32_dpp v76, v72, v76, vcc quad_perm:[2,3,2,3] row_mask:0xf bank_mask:0xf
    v_cndmask_b32_dpp v77, v73, v77, vcc quad_perm:[2,3,2,3] row_mask:0xf bank_mask:0xf
    v_cndmask_b32_dpp v78, v74, v78, vcc quad_perm:[2,3,2,3] row_mask:0xf bank_mask:0xf
    v_cndmask_b32_dpp v79, v75, v79, vcc quad_perm:[2,3,2,3] row_mask:0xf bank_mask:0xf
    v_rcp_f32_dpp v84, v80 quad_perm:[2,3,2,3] row_mask:0xf bank_mask:0xf
    s_nop 0
    v_pk_mul_f32 v[76:77], v[76:77], v[84:85] op_sel_hi:[1,0]
    v_pk_mul_f32 v[78:79], v[78:79], v[84:85] op_sel_hi:[1,0]
    v_cvt_pk_bf16_f32 v72, v76, v77
    v_cvt_pk_bf16_f32 v73, v78, v79
    ds_write_b64 v122, v[72:73] offset:20992
    v_max_f32_dpp v86, v80, v84 quad_perm:[2,3,2,3] row_mask:0xf bank_mask:0xf
    v_mov_b32_dpp v60, v72 quad_perm:[0,1,0,1] row_mask:0xf bank_mask:0xf
    v_mov_b32_dpp v61, v73 quad_perm:[0,1,0,1] row_mask:0xf bank_mask:0xf
    v_cmp_lt_f32 vcc, s35, v86
    v_mov_b32_dpp v62, v72 quad_perm:[2,3,2,3] row_mask:0xf bank_mask:0xf
    v_mov_b32_dpp v63, v73 quad_perm:[2,3,2,3] row_mask:0xf bank_mask:0xf
    s_nop 1
    v_smfmac_f32_16x16x64_bf16 v[96:99], v[60:63], v[192:199], v116
    s_cbranch_vccnz L_smax_69
    v_smfmac_f32_16x16x64_bf16 v[100:103], v[60:63], v[224:231], v116
    s_waitcnt lgkmcnt(0)
    s_barrier
    ds_read_b128 v[92:95], v127 offset:20480
    ds_read_b128 v[80:83], v127 offset:22016
    ds_read_b128 v[84:87], v127 offset:21504
    v_smfmac_f32_16x16x64_bf16 v[104:107], v[60:63], v[0:7], v116
    ds_read_b128 v[40:43], v124 offset:34816
    v_smfmac_f32_16x16x64_bf16 v[108:111], v[60:63], v[8:15], v116
    ds_read_b128 v[56:59], v124 offset:36864
    s_waitcnt lgkmcnt(4)
    v_smfmac_f32_16x16x64_bf16 v[96:99], v[92:95], v[200:207], v116
    s_waitcnt lgkmcnt(3)
    v_smfmac_f32_16x16x64_bf16 v[96:99], v[80:83], v[208:215], v116
    ds_read_b128 v[44:47], v124 offset:35840
    s_waitcnt lgkmcnt(3)
    v_smfmac_f32_16x16x64_bf16 v[96:99], v[84:87], v[216:223], v116
    ds_read_b128 v[68:71], v124 offset:39936
    v_smfmac_f32_16x16x64_bf16 v[100:103], v[92:95], v[232:239], v116
    ds_read_b128 v[64:67], v124 offset:38912
    v_smfmac_f32_16x16x64_bf16 v[100:103], v[80:83], v[240:247], v116
    ds_read_b128 v[60:63], v124 offset:37888
    v_cvt_pk_bf16_f32 v72, v96, v98
    v_smfmac_f32_16x16x64_bf16 v[100:103], v[84:87], v[248:255], v116
    v_and_or_b32 v72, v72, -2, s33
    v_smfmac_f32_16x16x64_bf16 v[104:107], v[92:95], v[16:23], v116
    v_cvt_pk_bf16_f32 v74, v97, v99
    v_smfmac_f32_16x16x64_bf16 v[104:107], v[80:83], v[24:31], v116
    v_cvt_pk_bf16_f32 v73, v100, v102
    v_cvt_pk_bf16_f32 v75, v101, v103
    v_smfmac_f32_16x16x64_bf16 v[104:107], v[84:87], v[32:39], v116
    buffer_store_dwordx4 v[72:75], v118, s[8:11], s25 offen sc1
    s_waitcnt lgkmcnt(3)
    v_smfmac_f32_16x16x64_bf16 v[108:111], v[92:95], v[40:47], v116
    s_waitcnt lgkmcnt(0)
    v_smfmac_f32_16x16x64_bf16 v[108:111], v[80:83], v[56:63], v116
    v_cvt_pk_bf16_f32 v76, v104, v106
    v_smfmac_f32_16x16x64_bf16 v[108:111], v[84:87], v[64:71], v116
    v_and_or_b32 v76, v76, -2, s33
    v_cvt_pk_bf16_f32 v78, v105, v107
    v_mov_b32 v122, v122
    v_mov_b32 v122, v122
    v_mov_b32 v122, v122
    v_mov_b32 v122, v122
    v_mov_b32 v122, v122
    v_mov_b32 v122, v122
    v_cvt_pk_bf16_f32 v77, v108, v110
    v_cvt_pk_bf16_f32 v79, v109, v111
    buffer_store_dwordx4 v[76:79], v118, s[8:11], s26 offen sc1
    s_add_u32 s30, s30, 0x40000
    s_add_u32 s31, s31, 0x40000
    s_add_u32 s32, s32, 0x20000
    s_add_u32 s23, s24, 1024
    s_add_u32 s48, s23, 4096
    s_xor_b32 s25, s25, 0x0
    s_xor_b32 s26, s26, 0x0
    s_mov_b32 s35, 0x49800000
    s_add_u32 s22, s22, 1
    v_mov_b32 v32, 0
    v_mov_b32 v33, 0
    v_mov_b32 v34, 0
    v_mov_b32 v35, 0
    v_mov_b32 v36, 0
    v_mov_b32 v37, 0
    v_mov_b32 v38, 0
    v_mov_b32 v39, 0
    v_mov_b32 v40, 0
    v_mov_b32 v41, 0
    v_mov_b32 v42, 0
    v_mov_b32 v43, 0
    v_mov_b32 v44, 0
    v_mov_b32 v45, 0
    v_mov_b32 v46, 0
    v_mov_b32 v47, 0
    v_mov_b32 v48, 0
    v_mov_b32 v49, 0
    v_mov_b32 v50, 0
    v_mov_b32 v51, 0
    v_mov_b32 v52, 0
    v_mov_b32 v53, 0
    v_mov_b32 v54, 0
    v_mov_b32 v55, 0
    ds_read_b128 v[80:83], v123
    ds_read_b128 v[84:87], v123 offset:1024
    ds_read_b128 v[56:59], v123 offset:2048
    ds_read_b128 v[60:63], v123 offset:3072
    ds_read_b128 v[64:67], v123 offset:32768
    ds_read_b128 v[68:71], v123 offset:33792
    ds_read_b128 v[72:75], v123 offset:34816
    ds_read_b128 v[76:79], v123 offset:35840
    ds_read_b128 v[88:91], v123 offset:4096
    ds_read_b128 v[92:95], v123 offset:5120
    ds_read_b128 v[96:99], v123 offset:6144
    ds_read_b128 v[100:103], v123 offset:7168
    ds_read_b128 v[104:107], v123 offset:36864
    ds_read_b128 v[108:111], v123 offset:37888
    ds_read_b128 v[24:27], v123 offset:38912
    ds_read_b128 v[28:31], v123 offset:39936
    s_add_u32 s24, s24, 8192
    s_bitset0_b32 s24, 15
    s_xor_b32 s55, s24, 16384
    s_xor_b32 s29, s29, 0x0
    s_xor_b32 s53, s29, 1024
    s_bfe_u32 s33, s22, 0x10000
    s_add_u32 s40, s22, 5
    s_lshr_b32 s40, s40, 2
    s_min_u32 s40, s40, 16
    s_bfm_b32 s58, s40, 0
    s_waitcnt vmcnt(4)
    v_cmp_eq_u32 vcc, 0, v125
    s_nop 0
    s_and_b64 vcc, vcc, s[58:59]
    s_cbranch_scc1 L_kvw_70
L_kvb_71:
    v_mov_b32 v15, 0
    s_nop 2
    v_mov_b32 v15, 0
    s_nop 2
    v_mov_b32 v15, 0
    s_nop 2
    v_mov_b32 v15, 0
    s_nop 2
    v_mov_b32 v15, 0
    s_nop 2
    v_mov_b32 v15, 0
    s_nop 2
    v_mov_b32 v15, 0
    s_nop 2
    v_mov_b32 v15, 0
    s_nop 2
    v_mov_b32 v15, 0
    s_nop 2
    v_mov_b32 v15, 0
    s_nop 2
    v_mov_b32 v15, 0
    s_nop 2
    v_mov_b32 v15, 0
    s_nop 2
    v_mov_b32 v15, 0
    s_nop 2
    v_mov_b32 v15, 0
    s_nop 2
    v_mov_b32 v15, 0
    s_nop 2
    v_mov_b32 v15, 0
    s_nop 2
    v_mov_b32 v15, 0
    s_nop 2
    v_mov_b32 v15, 0
    s_nop 2
    v_mov_b32 v15, 0
    s_nop 2
    v_mov_b32 v15, 0
    s_nop 2
    v_mov_b32 v15, 0
    s_nop 2
    v_mov_b32 v15, 0
    s_nop 2
    v_mov_b32 v15, 0
    s_nop 2
    v_mov_b32 v15, 0
    s_nop 2
    v_mov_b32 v15, 0
    s_nop 2
    v_mov_b32 v15, 0
    s_nop 2
    v_mov_b32 v15, 0
    s_nop 2
    v_mov_b32 v15, 0
    s_nop 2
    v_mov_b32 v15, 0
    s_nop 2
    v_mov_b32 v15, 0
    s_nop 2
    v_mov_b32 v15, 0
    s_nop 2
    s_waitcnt lgkmcnt(0)
    s_branch L_chain_top1_s
.p2align 6
L_chain_top2_s:
    buffer_load_dwordx4 v[0:3], v117, s[8:11], s23 offen sc1
    v_mov_b32 v48, 0
    v_mov_b32 v49, 0
    v_mov_b32 v50, 0
    v_mov_b32 v51, 0
    v_mov_b32 v52, 0
    v_mov_b32 v53, 0
    v_mov_b32 v15, 0
    v_mov_b32 v15, 0
    v_mov_b32 v15, 0
    v_mov_b32 v15, 0
    v_mov_b32 v15, 0
    v_mov_b32 v15, 0
    v_mov_b32 v15, 0
    v_mov_b32 v15, 0
    v_mov_b32 v15, 0
    v_mov_b32 v15, 0
    buffer_load_dwordx4 v[0:3], v117, s[8:11], s23 offen sc1
    s_waitcnt vmcnt(3)
    v_mov_b32 v36, 0
    v_mov_b32 v37, 0
    v_mov_b32 v38, 0
    v_mov_b32 v39, 0
    v_mov_b32 v40, 0
    v_mov_b32 v41, 0
    v_mov_b32 v42, 0
    v_mov_b32 v43, 0
    v_mov_b32 v44, 0
    v_mov_b32 v45, 0
    v_mov_b32 v46, 0
    v_mov_b32 v47, 0
    v_mov_b32 v15, 0
    v_mov_b32 v15, 0
    v_mov_b32 v15, 0
    v_mov_b32 v15, 0
L_mret_72:
    buffer_load_dwordx4 v[0:3], v117, s[8:11], s23 offen sc1
    s_add_u32 s45, s45, 1
    s_cmp_lt_u32 s45, 0x10000
    s_cselect_b32 s56, -2, -1
    s_nop 3
    v_mov_b32 v32, 0
    v_mov_b32 v33, 0
    v_mov_b32 v34, 0
    v_mov_b32 v35, 0
    s_waitcnt vmcnt(2)
    v_max3_u32 v15, v0, v1, v2
    v_max_u32 v15, v15, v3
    v_cmp_lt_u32 vcc, s56, v15
    v_smfmac_f32_16x16x64_bf16 v[32:35], v[0:3], v[80:87], v116
    s_cbranch_vccnz L_mret_72
    ds_write_b128 v117, v[0:3] offset:2048
    v_smfmac_f32_16x16x64_bf16 v[36:39], v[0:3], v[56:63], v116
    buffer_load_dwordx4 v[4:7], v117, s[8:11], s48 offen sc1
    v_smfmac_f32_16x16x64_bf16 v[40:43], v[0:3], v[64:71], v116
    buffer_load_dwordx4 v117, s[8:11], s48 offen sc1 lds
    s_mov_b32 m0, 12288
    v_smfmac_f32_16x16x64_bf16 v[44:47], v[0:3], v[72:79], v116
    s_waitcnt lgkmcnt(0)
    s_barrier
    ds_read_b128 v[8:11], v117 offset:3072
    v_smfmac_f32_16x16x64_bf16 v[48:51], v[0:3], a[192:199], v116
    ds_read_b128 v[16:19], v117
    ds_read_b128 v[20:23], v117 offset:1024
    v_smfmac_f32_16x16x64_bf16 v[52:55], v[0:3], a[200:207], v116
    ds_read_b128 v[80:83], v117 offset:14336
    s_waitcnt lgkmcnt(3)
    v_smfmac_f32_16x16x64_bf16 v[32:35], v[8:11], a[0:7], v116
    ds_read_b128 v[84:87], v117 offset:15360
    v_smfmac_f32_16x16x64_bf16 v[36:39], v[8:11], a[8:15], v116
    ds_read_b128 v[56:59], v117 offset:8192
    s_waitcnt lgkmcnt(4)
    v_smfmac_f32_16x16x64_bf16 v[32:35], v[16:19], a[32:39], v116
    ds_read_b128 v[60:63], v117 offset:9216
    v_smfmac_f32_16x16x64_bf16 v[36:39], v[16:19], a[40:47], v116
    ds_read_b128 v[64:67], v117 offset:10240
    s_waitcnt lgkmcnt(5)
    v_smfmac_f32_16x16x64_bf16 v[32:35], v[20:23], a[64:71], v116
    ds_read_b128 v[68:71], v117 offset:11264
    v_smfmac_f32_16x16x64_bf16 v[36:39], v[20:23], a[72:79], v116
    buffer_store_dwordx4 v[112:115], v117, s[8:11], s32 offen sc1
    v_smfmac_f32_16x16x64_bf16 v[40:43], v[8:11], a[96:103], v116
    ds_read_b128 v[72:75], v117 offset:12288
    v_smfmac_f32_16x16x64_bf16 v[40:43], v[16:19], a[128:135], v116
    ds_read_b128 v[76:79], v117 offset:13312
    v_smfmac_f32_16x16x64_bf16 v[40:43], v[20:23], a[160:167], v116
    s_waitcnt vmcnt(2)
    v_max3_u32 v15, v4, v5, v6
    v_smfmac_f32_16x16x64_bf16 v[44:47], v[8:11], a[104:111], v116
    v_max_u32 v15, v15, v7
    v_smfmac_f32_16x16x64_bf16 v[44:47], v[16:19], a[136:143], v116
    s_waitcnt vmcnt(1) lgkmcnt(0)
    v_cmp_lt_u32 vcc, s56, v15
    v_smfmac_f32_16x16x64_bf16 v[44:47], v[20:23], a[168:175], v116
    s_cbranch_vccnz L_mret_73
L_mgo_74:
    v_smfmac_f32_16x16x64_bf16 v[44:47], v[4:7], v[24:31], v116
    s_barrier
    ds_read_b128 v[12:15], v117 offset:7168
    v_smfmac_f32_16x16x64_bf16 v[32:35], v[4:7], v[88:95], v116
    ds_read_b128 v[24:27], v117 offset:4096
    v_smfmac_f32_16x16x64_bf16 v[36:39], v[4:7], v[96:103], v116
    ds_read_b128 v[28:31], v117 offset:5120
    v_smfmac_f32_16x16x64_bf16 v[40:43], v[4:7], v[104:111], v116
    ds_read_b128 v[88:91], v117 offset:28672
    s_waitcnt lgkmcnt(3)
    v_smfmac_f32_16x16x64_bf16 v[32:35], v[12:15], a[16:23], v116
    ds_read_b128 v[92:95], v117 offset:29696
    s_waitcnt lgkmcnt(3)
    v_smfmac_f32_16x16x64_bf16 v[32:35], v[24:27], a[48:55], v116
    buffer_load_dwordx4 v117, s[8:11], s30 offen lds
    s_waitcnt lgkmcnt(2)
    v_smfmac_f32_16x16x64_bf16 v[32:35], v[28:31], a[80:87], v116
    ds_read_b128 v[96:99], v117 offset:23552
    v_smfmac_f32_16x16x64_bf16 v[36:39], v[12:15], a[24:31], v116
    ds_read_b128 v[100:103], v117 offset:23552
    v_smfmac_f32_16x16x64_bf16 v[36:39], v[24:27], a[56:63], v116
    buffer_load_dwordx4 v117, s[8:11], s30 offen offset:1024 lds
    s_add_u32 m0, s52, 0x6000
    v_add_f32 v32, v32, v34
    v_smfmac_f32_16x16x64_bf16 v[36:39], v[28:31], a[88:95], v116
    ds_read_b128 v[104:107], v117 offset:23552
    v_add_f32 v33, v33, v35
    v_smfmac_f32_16x16x64_bf16 v[40:43], v[12:15], a[112:119], v116
    ds_read_b128 v[108:111], v117 offset:23552
    v_mul_f32 v32, s34, v32
    v_smfmac_f32_16x16x64_bf16 v[40:43], v[24:27], a[144:151], v116
    s_waitcnt lgkmcnt(4)
    buffer_load_dwordx4 v117, s[8:11], s31 offen lds
    v_mul_f32 v33, s34, v33
    v_smfmac_f32_16x16x64_bf16 v[40:43], v[28:31], a[176:183], v116
    ds_read_b128 v[0:3], v124
    v_add_f32 v36, v36, v38
    v_smfmac_f32_16x16x64_bf16 v[48:51], v[4:7], a[208:215], v116
    v_add_f32 v37, v37, v39
    v_smfmac_f32_16x16x64_bf16 v[52:55], v[4:7], a[216:223], v116
    buffer_load_dwordx4 v117, s[8:11], s31 offen offset:1024 lds
    s_mov_b32 m0, 6144
    v_mul_f32 v36, s34, v36
    v_smfmac_f32_16x16x64_bf16 v[44:47], v[12:15], a[120:127], v116
    ds_read_b128 v[4:7], v124 offset:1024
    v_mul_f32 v37, s34, v37
    v_smfmac_f32_16x16x64_bf16 v[44:47], v[24:27], a[152:159], v116
    v_cvt_pk_bf16_f32 v34, v32, v36
    v_smfmac_f32_16x16x64_bf16 v[44:47], v[28:31], a[184:191], v116
    v_cvt_pk_bf16_f32 v35, v33, v37
    v_add_f32 v40, v40, v42
    v_smfmac_f32_16x16x64_bf16 v[48:51], v[8:11], a[224:231], v116
    ds_write2_b32 v120, v34, v35 offset0:32 offset1:48
    v_add_f32 v41, v41, v43
    v_smfmac_f32_16x16x64_bf16 v[52:55], v[8:11], a[232:239], v116
    v_add_f32 v44, v44, v46
    v_add_f32 v45, v45, v47
    v_cvt_pk_bf16_f32 v113, v40, v44
    v_cvt_pk_bf16_f32 v115, v41, v45
    v_smfmac_f32_16x16x64_bf16 v[48:51], v[12:15], a[240:247], v116
    ds_write2_b32 v120, v113, v115 offset0:0 offset1:16
    v_smfmac_f32_16x16x64_bf16 v[52:55], v[12:15], a[248:255], v116
    s_cmp_eq_u32 s22, 63
    s_cbranch_scc1 L_chain_last_s
    v_smfmac_f32_16x16x64_bf16 v[48:51], v[16:19], v[128:135], v116
    buffer_store_dword v126, v119, s[8:11], s55 offen sc1
    v_smfmac_f32_16x16x64_bf16 v[48:51], v[20:23], v[160:167], v116
    v_smfmac_f32_16x16x64_bf16 v[48:51], v[24:27], v[144:151], v116
    s_waitcnt lgkmcnt(0)
    s_barrier
    v_smfmac_f32_16x16x64_bf16 v[48:51], v[28:31], v[176:183], v116
    ds_read_b128 v[32:35], v121 offset:16384
    ds_read_b128 v[36:39], v121 offset:17408
    v_smfmac_f32_16x16x64_bf16 v[52:55], v[16:19], v[136:143], v116
    ds_read_b128 v[40:43], v121 offset:18432
    ds_read_b128 v[44:47], v121 offset:19456
    v_smfmac_f32_16x16x64_bf16 v[52:55], v[20:23], v[168:175], v116
    ds_read_b128 v[8:11], v124 offset:32768
    v_add_f32 v48, v48, v50
    v_smfmac_f32_16x16x64_bf16 v[52:55], v[24:27], v[152:159], v116
    ds_read_b128 v[12:15], v124 offset:33792
    v_add_f32 v49, v49, v51
    v_smfmac_f32_16x16x64_bf16 v[52:55], v[28:31], v[184:191], v116
    s_waitcnt lgkmcnt(5)
    v_cvt_pk_bf16_f32 v112, v48, v49
    v_mfma_f32_16x16x32_bf16 v[56:59], v[56:59], v[32:35], 0
    s_waitcnt lgkmcnt(4)
    v_mov_b32 v48, s50
    v_mov_b32 v49, s50
    v_mfma_f32_16x16x32_bf16 v[56:59], v[60:63], v[36:39], v[56:59]
    ds_read_b128 v[16:19], v124 offset:2048
    s_waitcnt lgkmcnt(4)
    v_mov_b32 v50, s50
    v_mov_b32 v51, s50
    v_mfma_f32_16x16x32_bf16 v[56:59], v[64:67], v[40:43], v[56:59]
    ds_read_b128 v[20:23], v124 offset:3072
    s_waitcnt lgkmcnt(4)
    v_add_f32 v52, v52, v54
    v_mfma_f32_16x16x32_bf16 v[56:59], v[68:71], v[44:47], v[56:59]
    ds_read_b128 v[24:27], v124 offset:4096
    v_add_f32 v53, v53, v55
    v_mfma_f32_16x16x32_bf16 v[60:63], v[72:75], v[32:35], 0
    ds_read_b128 v[28:31], v124 offset:5120
    v_cvt_pk_bf16_f32 v114, v52, v53
    v_mov_b32 v53, 0
    v_mfma_f32_16x16x32_bf16 v[60:63], v[76:79], v[36:39], v[60:63]
    v_exp_f32 v56, v56
    v_mfma_f32_16x16x32_bf16 v[60:63], v[80:83], v[40:43], v[60:63]
    v_exp_f32 v57, v57
    v_mfma_f32_16x16x32_bf16 v[60:63], v[84:87], v[44:47], v[60:63]
    v_exp_f32 v58, v58
    v_mfma_f32_16x16x32_bf16 v[64:67], v[32:35], v[32:35], 0
    v_exp_f32 v59, v59
    v_cvt_pk_bf16_f32 v68, v56, v57
    v_mfma_f32_16x16x32_bf16 v[64:67], v[36:39], v[36:39], v[64:67]
    v_exp_f32 v60, v60
    v_cvt_pk_bf16_f32 v69, v58, v59
    v_mfma_f32_16x16x32_bf16 v[64:67], v[40:43], v[40:43], v[64:67]
    v_exp_f32 v61, v61
    v_mfma_f32_16x16x32_bf16 v[64:67], v[44:47], v[44:47], v[64:67]
    v_exp_f32 v62, v62
    v_exp_f32 v63, v63
    v_cvt_pk_bf16_f32 v70, v60, v61
    v_cvt_pk_bf16_f32 v71, v62, v63
    s_nop 1
    v_mfma_f32_16x16x32_bf16 v[72:75], v[88:91], v[68:71], 0
    s_nop 0
    v_exp_f32 v64, v64
    v_mfma_f32_16x16x32_bf16 v[76:79], v[92:95], v[68:71], 0
    v_exp_f32 v65, v65
    v_mfma_f32_16x16x32_bf16 v[80:83], v[48:51], v[68:71], 0
    v_cvt_pk_bf16_f32 v52, v64, v65
    s_nop 1
    v_mfma_f32_16x16x16_bf16 v[72:75], v[112:113], v[52:53], v[72:75]
    ds_read_b128 v[32:35], v124 offset:6144
    v_mfma_f32_16x16x16_bf16 v[76:79], v[114:115], v[52:53], v[76:79]
    ds_read_b128 v[36:39], v124 offset:7168
    v_mfma_f32_16x16x16_bf16 v[80:83], v[48:49], v[52:53], v[80:83]
L_norm_75:
    s_mov_b64 vcc, s[36:37]
    v_mov_b32 v122, v122
    v_mov_b32 v122, v122
    v_mov_b32 v122, v122
    v_cndmask_b32_dpp v76, v72, v76, vcc quad_perm:[2,3,2,3] row_mask:0xf bank_mask:0xf
    v_cndmask_b32_dpp v77, v73, v77, vcc quad_perm:[2,3,2,3] row_mask:0xf bank_mask:0xf
    v_cndmask_b32_dpp v78, v74, v78, vcc quad_perm:[2,3,2,3] row_mask:0xf bank_mask:0xf
    v_cndmask_b32_dpp v79, v75, v79, vcc quad_perm:[2,3,2,3] row_mask:0xf bank_mask:0xf
    v_rcp_f32_dpp v84, v80 quad_perm:[2,3,2,3] row_mask:0xf bank_mask:0xf
    s_nop 0
    v_pk_mul_f32 v[76:77], v[76:77], v[84:85] op_sel_hi:[1,0]
    v_pk_mul_f32 v[78:79], v[78:79], v[84:85] op_sel_hi:[1,0]
    v_cvt_pk_bf16_f32 v72, v76, v77
    v_cvt_pk_bf16_f32 v73, v78, v79
    ds_write_b64 v122, v[72:73] offset:21504
    v_max_f32_dpp v86, v80, v84 quad_perm:[2,3,2,3] row_mask:0xf bank_mask:0xf
    v_mov_b32_dpp v60, v72 quad_perm:[0,1,0,1] row_mask:0xf bank_mask:0xf
    v_mov_b32_dpp v61, v73 quad_perm:[0,1,0,1] row_mask:0xf bank_mask:0xf
    v_cmp_lt_f32 vcc, s35, v86
    v_mov_b32_dpp v62, v72 quad_perm:[2,3,2,3] row_mask:0xf bank_mask:0xf
    v_mov_b32_dpp v63, v73 quad_perm:[2,3,2,3] row_mask:0xf bank_mask:0xf
    s_nop 1
    v_smfmac_f32_16x16x64_bf16 v[96:99], v[60:63], v[192:199], v116
    s_cbranch_vccnz L_smax_76
    v_smfmac_f32_16x16x64_bf16 v[100:103], v[60:63], v[224:231], v116
    s_waitcnt lgkmcnt(0)
    s_barrier
    ds_read_b128 v[92:95], v127 offset:22016
    ds_read_b128 v[80:83], v127 offset:20480
    ds_read_b128 v[84:87], v127 offset:20992
    v_smfmac_f32_16x16x64_bf16 v[104:107], v[60:63], v[0:7], v116
    ds_read_b128 v[40:43], v124 offset:34816
    v_smfmac_f32_16x16x64_bf16 v[108:111], v[60:63], v[8:15], v116
    ds_read_b128 v[56:59], v124 offset:36864
    s_waitcnt lgkmcnt(4)
    v_smfmac_f32_16x16x64_bf16 v[96:99], v[92:95], v[200:207], v116
    s_waitcnt lgkmcnt(3)
    v_smfmac_f32_16x16x64_bf16 v[96:99], v[80:83], v[208:215], v116
    ds_read_b128 v[44:47], v124 offset:35840
    s_waitcnt lgkmcnt(3)
    v_smfmac_f32_16x16x64_bf16 v[96:99], v[84:87], v[216:223], v116
    ds_read_b128 v[68:71], v124 offset:39936
    v_smfmac_f32_16x16x64_bf16 v[100:103], v[92:95], v[232:239], v116
    ds_read_b128 v[64:67], v124 offset:38912
    v_smfmac_f32_16x16x64_bf16 v[100:103], v[80:83], v[240:247], v116
    ds_read_b128 v[60:63], v124 offset:37888
    v_cvt_pk_bf16_f32 v72, v96, v98
    v_smfmac_f32_16x16x64_bf16 v[100:103], v[84:87], v[248:255], v116
    v_and_or_b32 v72, v72, -2, s33
    v_smfmac_f32_16x16x64_bf16 v[104:107], v[92:95], v[16:23], v116
    v_cvt_pk_bf16_f32 v74, v97, v99
    v_smfmac_f32_16x16x64_bf16 v[104:107], v[80:83], v[24:31], v116
    v_cvt_pk_bf16_f32 v73, v100, v102
    v_cvt_pk_bf16_f32 v75, v101, v103
    v_smfmac_f32_16x16x64_bf16 v[104:107], v[84:87], v[32:39], v116
    buffer_store_dwordx4 v[72:75], v118, s[8:11], s25 offen sc1
    s_waitcnt lgkmcnt(3)
    v_smfmac_f32_16x16x64_bf16 v[108:111], v[92:95], v[40:47], v116
    s_waitcnt lgkmcnt(0)
    v_smfmac_f32_16x16x64_bf16 v[108:111], v[80:83], v[56:63], v116
    v_cvt_pk_bf16_f32 v76, v104, v106
    v_smfmac_f32_16x16x64_bf16 v[108:111], v[84:87], v[64:71], v116
    v_and_or_b32 v76, v76, -2, s33
    v_cvt_pk_bf16_f32 v78, v105, v107
    v_mov_b32 v122, v122
    v_mov_b32 v122, v122
    v_mov_b32 v122, v122
    v_mov_b32 v122, v122
    v_mov_b32 v122, v122
    v_mov_b32 v122, v122
    v_cvt_pk_bf16_f32 v77, v108, v110
    v_cvt_pk_bf16_f32 v79, v109, v111
    buffer_store_dwordx4 v[76:79], v118, s[8:11], s26 offen sc1
    ds_read_b128 v[80:83], v123
    ds_read_b128 v[84:87], v123 offset:1024
    ds_read_b128 v[56:59], v123 offset:2048
    ds_read_b128 v[60:63], v123 offset:3072
    ds_read_b128 v[64:67], v123 offset:32768
    ds_read_b128 v[68:71], v123 offset:33792
    ds_read_b128 v[72:75], v123 offset:34816
    ds_read_b128 v[76:79], v123 offset:35840
    ds_read_b128 v[88:91], v123 offset:4096
    ds_read_b128 v[92:95], v123 offset:5120
    ds_read_b128 v[96:99], v123 offset:6144
    ds_read_b128 v[100:103], v123 offset:7168
    ds_read_b128 v[104:107], v123 offset:36864
    ds_read_b128 v[108:111], v123 offset:37888
    ds_read_b128 v[24:27], v123 offset:38912
    ds_read_b128 v[28:31], v123 offset:39936
    s_add_u32 s30, s30, 0x40000
    s_add_u32 s31, s31, 0x40000
    s_add_u32 s32, s32, 0x20000
    s_add_u32 s23, s24, 2048
    s_add_u32 s48, s23, 4096
    s_xor_b32 s25, s25, 0x0
    s_xor_b32 s26, s26, 0x0
    s_mov_b32 s35, 0x49800000
    s_add_u32 s22, s22, 1
    v_cndmask_b32 v12, 0, v125, s[68:69]
    v_cndmask_b32 v13, 0, v125, s[70:71]
    v_cndmask_b32 v14, 0, v125, s[72:73]
    v_cndmask_b32 v15, 0, v125, s[74:75]
    v_mov_b32 v54, 0
    v_mov_b32 v55, 0
    v_mov_b32 v52, 0
    v_mov_b32 v52, 0
    v_mov_b32 v52, 0
    v_mov_b32 v52, 0
    v_mov_b32 v52, 0
    v_mov_b32 v52, 0
    v_mov_b32 v52, 0
    v_mov_b32 v52, 0
    v_mov_b32 v52, 0
    v_mov_b32 v52, 0
    v_mov_b32 v52, 0
    v_mov_b32 v52, 0
    v_mov_b32 v52, 0
    v_mov_b32 v52, 0
    v_mov_b32 v52, 0
    v_mov_b32 v52, 0
    v_mov_b32 v52, 0
    v_mov_b32 v52, 0
    v_mov_b32 v52, 0
    buffer_load_dwordx4 v[4:7], v117, s[8:11], s29 offen sc1
    buffer_load_dwordx4 v[8:11], v117, s[8:11], s53 offen sc1
    buffer_load_dwordx4 v[16:19], v117, s[8:11], s29 offen offset:2048 sc1
    buffer_load_dwordx4 v[20:23], v117, s[8:11], s53 offen offset:2048 sc1
    v_mov_b32 v52, 0
    v_mov_b32 v52, 0
    v_mov_b32 v52, 0
    v_mov_b32 v52, 0
    v_mov_b32 v52, 0
    v_mov_b32 v52, 0
    v_mov_b32 v52, 0
    v_mov_b32 v52, 0
    v_mov_b32 v52, 0
    v_mov_b32 v52, 0
    v_mov_b32 v52, 0
    v_mov_b32 v52, 0
    v_mov_b32 v52, 0
    v_mov_b32 v52, 0
    v_mov_b32 v52, 0
    v_mov_b32 v52, 0
    v_mov_b32 v52, 0
    v_mov_b32 v52, 0
    v_mov_b32 v52, 0
    v_mov_b32 v52, 0
    v_mov_b32 v52, 0
    v_mov_b32 v52, 0
    v_mov_b32 v52, 0
    v_mov_b32 v52, 0
    v_mov_b32 v52, 0
    v_mov_b32 v52, 0
    v_mov_b32 v52, 0
    v_mov_b32 v52, 0
    v_mov_b32 v52, 0
    v_mov_b32 v52, 0
    v_mov_b32 v52, 0
    v_mov_b32 v52, 0
    v_mov_b32 v52, 0
    v_mov_b32 v52, 0
    v_mov_b32 v52, 0
    v_mov_b32 v52, 0
    v_mov_b32 v52, 0
    v_mov_b32 v52, 0
    v_mov_b32 v52, 0
    v_mov_b32 v52, 0
    buffer_load_dwordx4 v[32:35], v117, s[8:11], s29 offen sc1
    buffer_load_dwordx4 v[36:39], v117, s[8:11], s53 offen sc1
    buffer_load_dwordx4 v[40:43], v117, s[8:11], s29 offen offset:2048 sc1
    buffer_load_dwordx4 v[44:47], v117, s[8:11], s53 offen offset:2048 sc1
    v_mov_b32 v52, 0
L_rl_77:
    s_waitcnt vmcnt(7)
    v_mfma_f32_16x16x32_bf16 v[48:51], v[4:7], v[12:15], 0
    v_xor_b32 v52, s33, v4
    s_waitcnt vmcnt(6)
    v_mfma_f32_16x16x32_bf16 v[48:51], v[8:11], v[12:15], v[48:51]
    v_xor_b32 v53, s33, v8
    v_or_b32 v52, v52, v53
    s_waitcnt vmcnt(5)
    v_mfma_f32_16x16x32_bf16 v[48:51], v[16:19], v[12:15], v[48:51]
    v_xor_b32 v53, s33, v16
    v_or_b32 v52, v52, v53
    s_waitcnt vmcnt(4)
    v_mfma_f32_16x16x32_bf16 v[48:51], v[20:23], v[12:15], v[48:51]
    v_xor_b32 v53, s33, v20
    v_or_b32 v52, v52, v53
    v_and_b32 v52, 1, v52
    v_cmp_ne_u32 vcc, 0, v52
    s_cbranch_vccnz L_rslow_78
L_rgo_79:
    s_nop 2
    v_permlane32_swap_b32 v48, v50
    v_permlane32_swap_b32 v49, v51
    v_pk_add_f32 v[48:49], v[48:49], v[50:51]
    s_mov_b64 exec, s[38:39]
    v_cvt_pk_bf16_f32 v12, v48, v49
    v_min_u32 v12, 0xfffffffe, v12
    buffer_store_dword v12, v119, s[8:11], s24 offen sc1
    s_mov_b64 exec, -1
    s_add_u32 s24, s24, 8192
    s_bitset0_b32 s24, 15
    s_xor_b32 s55, s24, 16384
    s_xor_b32 s29, s29, 0x0
    s_xor_b32 s53, s29, 1024
    s_bfe_u32 s33, s22, 0x10000
    s_waitcnt lgkmcnt(0)
    s_branch L_chain_top2_s
.p2align 6
L_chain_top3_s:
    buffer_load_dwordx4 v[0:3], v117, s[8:11], s23 offen sc1
    v_mov_b32 v48, 0
    v_mov_b32 v49, 0
    v_mov_b32 v50, 0
    v_mov_b32 v51, 0
    v_mov_b32 v52, 0
    v_mov_b32 v53, 0
    v_mov_b32 v15, 0
    v_mov_b32 v15, 0
    v_mov_b32 v15, 0
    v_mov_b32 v15, 0
    v_mov_b32 v15, 0
    v_mov_b32 v15, 0
    v_mov_b32 v15, 0
    v_mov_b32 v15, 0
    v_mov_b32 v15, 0
    v_mov_b32 v15, 0
    buffer_load_dwordx4 v[0:3], v117, s[8:11], s23 offen sc1
    s_waitcnt vmcnt(3)
    v_mov_b32 v36, 0
    v_mov_b32 v37, 0
    v_mov_b32 v38, 0
    v_mov_b32 v39, 0
    v_mov_b32 v40, 0
    v_mov_b32 v41, 0
    v_mov_b32 v42, 0
    v_mov_b32 v43, 0
    v_mov_b32 v44, 0
    v_mov_b32 v45, 0
    v_mov_b32 v46, 0
    v_mov_b32 v47, 0
    v_mov_b32 v15, 0
    v_mov_b32 v15, 0
    v_mov_b32 v15, 0
    v_mov_b32 v15, 0
L_mret_80:
    buffer_load_dwordx4 v[0:3], v117, s[8:11], s23 offen sc1
    s_add_u32 s45, s45, 1
    s_cmp_lt_u32 s45, 0x10000
    s_cselect_b32 s56, -2, -1
    s_nop 3
    v_mov_b32 v32, 0
    v_mov_b32 v33, 0
    v_mov_b32 v34, 0
    v_mov_b32 v35, 0
    s_waitcnt vmcnt(2)
    v_max3_u32 v15, v0, v1, v2
    v_max_u32 v15, v15, v3
    v_cmp_lt_u32 vcc, s56, v15
    v_smfmac_f32_16x16x64_bf16 v[32:35], v[0:3], v[80:87], v116
    s_cbranch_vccnz L_mret_80
    ds_write_b128 v117, v[0:3] offset:3072
    v_smfmac_f32_16x16x64_bf16 v[36:39], v[0:3], v[56:63], v116
    buffer_load_dwordx4 v[4:7], v117, s[8:11], s48 offen sc1
    v_smfmac_f32_16x16x64_bf16 v[40:43], v[0:3], v[64:71], v116
    buffer_load_dwordx4 v117, s[8:11], s48 offen sc1 lds
    s_mov_b32 m0, 14336
    v_smfmac_f32_16x16x64_bf16 v[44:47], v[0:3], v[72:79], v116
    s_waitcnt lgkmcnt(0)
    s_barrier
    ds_read_b128 v[8:11], v117 offset:2048
    v_smfmac_f32_16x16x64_bf16 v[48:51], v[0:3], a[192:199], v116
    ds_read_b128 v[16:19], v117 offset:1024
    ds_read_b128 v[20:23], v117
    v_smfmac_f32_16x16x64_bf16 v[52:55], v[0:3], a[200:207], v116
    ds_read_b128 v[80:83], v117 offset:14336
    s_waitcnt lgkmcnt(3)
    v_smfmac_f32_16x16x64_bf16 v[32:35], v[8:11], a[0:7], v116
    ds_read_b128 v[84:87], v117 offset:15360
    v_smfmac_f32_16x16x64_bf16 v[36:39], v[8:11], a[8:15], v116
    ds_read_b128 v[56:59], v117 offset:8192
    s_waitcnt lgkmcnt(4)
    v_smfmac_f32_16x16x64_bf16 v[32:35], v[16:19], a[32:39], v116
    ds_read_b128 v[60:63], v117 offset:9216
    v_smfmac_f32_16x16x64_bf16 v[36:39], v[16:19], a[40:47], v116
    ds_read_b128 v[64:67], v117 offset:10240
    s_waitcnt lgkmcnt(5)
    v_smfmac_f32_16x16x64_bf16 v[32:35], v[20:23], a[64:71], v116
    ds_read_b128 v[68:71], v117 offset:11264
    v_smfmac_f32_16x16x64_bf16 v[36:39], v[20:23], a[72:79], v116
    ds_read_b128 v[72:75], v117 offset:12288
    v_smfmac_f32_16x16x64_bf16 v[40:43], v[8:11], a[96:103], v116
    ds_read_b128 v[76:79], v117 offset:13312
    v_smfmac_f32_16x16x64_bf16 v[40:43], v[16:19], a[128:135], v116
    buffer_store_dwordx4 v[112:115], v117, s[8:11], s32 offen sc1
    v_smfmac_f32_16x16x64_bf16 v[40:43], v[20:23], a[160:167], v116
    s_waitcnt vmcnt(2)
    v_max3_u32 v15, v4, v5, v6
    v_smfmac_f32_16x16x64_bf16 v[44:47], v[8:11], a[104:111], v116
    v_max_u32 v15, v15, v7
    v_smfmac_f32_16x16x64_bf16 v[44:47], v[16:19], a[136:143], v116
    s_waitcnt vmcnt(1) lgkmcnt(0)
    v_cmp_lt_u32 vcc, s56, v15
    v_smfmac_f32_16x16x64_bf16 v[44:47], v[20:23], a[168:175], v116
    s_cbranch_vccnz L_mret_81
L_mgo_82:
    v_smfmac_f32_16x16x64_bf16 v[44:47], v[4:7], v[24:31], v116
    s_barrier
    ds_read_b128 v[12:15], v117 offset:6144
    v_smfmac_f32_16x16x64_bf16 v[32:35], v[4:7], v[88:95], v116
    ds_read_b128 v[24:27], v117 offset:5120
    v_smfmac_f32_16x16x64_bf16 v[36:39], v[4:7], v[96:103], v116
    ds_read_b128 v[28:31], v117 offset:4096
    v_smfmac_f32_16x16x64_bf16 v[40:43], v[4:7], v[104:111], v116
    ds_read_b128 v[88:91], v117 offset:30720
    s_waitcnt lgkmcnt(3)
    v_smfmac_f32_16x16x64_bf16 v[32:35], v[12:15], a[16:23], v116
    ds_read_b128 v[92:95], v117 offset:31744
    s_waitcnt lgkmcnt(3)
    v_smfmac_f32_16x16x64_bf16 v[32:35], v[24:27], a[48:55], v116
    ds_read_b128 v[96:99], v117 offset:23552
    s_waitcnt lgkmcnt(3)
    v_smfmac_f32_16x16x64_bf16 v[32:35], v[28:31], a[80:87], v116
    buffer_load_dwordx4 v117, s[8:11], s30 offen lds
    v_smfmac_f32_16x16x64_bf16 v[36:39], v[12:15], a[24:31], v116
    ds_read_b128 v[100:103], v117 offset:23552
    v_smfmac_f32_16x16x64_bf16 v[36:39], v[24:27], a[56:63], v116
    ds_read_b128 v[104:107], v117 offset:23552
    v_add_f32 v32, v32, v34
    v_smfmac_f32_16x16x64_bf16 v[36:39], v[28:31], a[88:95], v116
    buffer_load_dwordx4 v117, s[8:11], s30 offen offset:1024 lds
    s_add_u32 m0, s52, 0x6000
    v_add_f32 v33, v33, v35
    v_smfmac_f32_16x16x64_bf16 v[40:43], v[12:15], a[112:119], v116
    ds_read_b128 v[108:111], v117 offset:23552
    v_mul_f32 v32, s34, v32
    v_smfmac_f32_16x16x64_bf16 v[40:43], v[24:27], a[144:151], v116
    ds_read_b128 v[0:3], v124
    v_mul_f32 v33, s34, v33
    v_smfmac_f32_16x16x64_bf16 v[40:43], v[28:31], a[176:183], v116
    s_waitcnt lgkmcnt(5)
    buffer_load_dwordx4 v117, s[8:11], s31 offen lds
    v_add_f32 v36, v36, v38
    v_smfmac_f32_16x16x64_bf16 v[48:51], v[4:7], a[208:215], v116
    v_add_f32 v37, v37, v39
    v_smfmac_f32_16x16x64_bf16 v[52:55], v[4:7], a[216:223], v116
    ds_read_b128 v[4:7], v124 offset:1024
    v_mul_f32 v36, s34, v36
    v_smfmac_f32_16x16x64_bf16 v[44:47], v[12:15], a[120:127], v116
    buffer_load_dwordx4 v117, s[8:11], s31 offen offset:1024 lds
    s_mov_b32 m0, 7168
    v_mul_f32 v37, s34, v37
    v_smfmac_f32_16x16x64_bf16 v[44:47], v[24:27], a[152:159], v116
    v_cvt_pk_bf16_f32 v34, v32, v36
    v_smfmac_f32_16x16x64_bf16 v[44:47], v[28:31], a[184:191], v116
    v_cvt_pk_bf16_f32 v35, v33, v37
    v_add_f32 v40, v40, v42
    v_smfmac_f32_16x16x64_bf16 v[48:51], v[8:11], a[224:231], v116
    ds_write2_b32 v120, v34, v35 offset0:32 offset1:48
    v_add_f32 v41, v41, v43
    v_smfmac_f32_16x16x64_bf16 v[52:55], v[8:11], a[232:239], v116
    v_add_f32 v44, v44, v46
    v_add_f32 v45, v45, v47
    v_cvt_pk_bf16_f32 v113, v40, v44
    v_cvt_pk_bf16_f32 v115, v41, v45
    v_smfmac_f32_16x16x64_bf16 v[48:51], v[12:15], a[240:247], v116
    ds_write2_b32 v120, v113, v115 offset0:0 offset1:16
    v_smfmac_f32_16x16x64_bf16 v[52:55], v[12:15], a[248:255], v116
    s_cmp_eq_u32 s22, 63
    s_cbranch_scc1 L_chain_last_s
    v_smfmac_f32_16x16x64_bf16 v[48:51], v[16:19], v[128:135], v116
    v_smfmac_f32_16x16x64_bf16 v[48:51], v[20:23], v[160:167], v116
    buffer_store_dword v126, v119, s[8:11], s55 offen sc1
    v_smfmac_f32_16x16x64_bf16 v[48:51], v[24:27], v[144:151], v116
    s_waitcnt lgkmcnt(0)
    s_barrier
    v_smfmac_f32_16x16x64_bf16 v[48:51], v[28:31], v[176:183], v116
    ds_read_b128 v[32:35], v121 offset:16384
    ds_read_b128 v[36:39], v121 offset:17408
    v_smfmac_f32_16x16x64_bf16 v[52:55], v[16:19], v[136:143], v116
    ds_read_b128 v[40:43], v121 offset:18432
    ds_read_b128 v[44:47], v121 offset:19456
    v_smfmac_f32_16x16x64_bf16 v[52:55], v[20:23], v[168:175], v116
    ds_read_b128 v[8:11], v124 offset:32768
    v_add_f32 v48, v48, v50
    v_smfmac_f32_16x16x64_bf16 v[52:55], v[24:27], v[152:159], v116
    ds_read_b128 v[12:15], v124 offset:33792
    v_add_f32 v49, v49, v51
    v_smfmac_f32_16x16x64_bf16 v[52:55], v[28:31], v[184:191], v116
    s_waitcnt lgkmcnt(5)
    v_cvt_pk_bf16_f32 v112, v48, v49
    v_mfma_f32_16x16x32_bf16 v[56:59], v[56:59], v[32:35], 0
    s_waitcnt lgkmcnt(4)
    v_mov_b32 v48, s50
    v_mov_b32 v49, s50
    v_mfma_f32_16x16x32_bf16 v[56:59], v[60:63], v[36:39], v[56:59]
    ds_read_b128 v[16:19], v124 offset:2048
    s_waitcnt lgkmcnt(4)
    v_mov_b32 v50, s50
    v_mov_b32 v51, s50
    v_mfma_f32_16x16x32_bf16 v[56:59], v[64:67], v[40:43], v[56:59]
    ds_read_b128 v[20:23], v124 offset:3072
    s_waitcnt lgkmcnt(4)
    v_add_f32 v52, v52, v54
    v_mfma_f32_16x16x32_bf16 v[56:59], v[68:71], v[44:47], v[56:59]
    ds_read_b128 v[24:27], v124 offset:4096
    v_add_f32 v53, v53, v55
    v_mfma_f32_16x16x32_bf16 v[60:63], v[72:75], v[32:35], 0
    ds_read_b128 v[28:31], v124 offset:5120
    v_cvt_pk_bf16_f32 v114, v52, v53
    v_mov_b32 v53, 0
    v_mfma_f32_16x16x32_bf16 v[60:63], v[76:79], v[36:39], v[60:63]
    v_exp_f32 v56, v56
    v_mfma_f32_16x16x32_bf16 v[60:63], v[80:83], v[40:43], v[60:63]
    v_exp_f32 v57, v57
    v_mfma_f32_16x16x32_bf16 v[60:63], v[84:87], v[44:47], v[60:63]
    v_exp_f32 v58, v58
    v_mfma_f32_16x16x32_bf16 v[64:67], v[32:35], v[32:35], 0
    v_exp_f32 v59, v59
    v_cvt_pk_bf16_f32 v68, v56, v57
    v_mfma_f32_16x16x32_bf16 v[64:67], v[36:39], v[36:39], v[64:67]
    v_exp_f32 v60, v60
    v_cvt_pk_bf16_f32 v69, v58, v59
    v_mfma_f32_16x16x32_bf16 v[64:67], v[40:43], v[40:43], v[64:67]
    v_exp_f32 v61, v61
    v_mfma_f32_16x16x32_bf16 v[64:67], v[44:47], v[44:47], v[64:67]
    v_exp_f32 v62, v62
    v_exp_f32 v63, v63
    v_cvt_pk_bf16_f32 v70, v60, v61
    v_cvt_pk_bf16_f32 v71, v62, v63
    s_nop 1
    v_mfma_f32_16x16x32_bf16 v[72:75], v[88:91], v[68:71], 0
    s_nop 0
    v_exp_f32 v64, v64
    v_mfma_f32_16x16x32_bf16 v[76:79], v[92:95], v[68:71], 0
    v_exp_f32 v65, v65
    v_mfma_f32_16x16x32_bf16 v[80:83], v[48:51], v[68:71], 0
    v_cvt_pk_bf16_f32 v52, v64, v65
    s_nop 1
    v_mfma_f32_16x16x16_bf16 v[72:75], v[112:113], v[52:53], v[72:75]
    ds_read_b128 v[32:35], v124 offset:6144
    v_mfma_f32_16x16x16_bf16 v[76:79], v[114:115], v[52:53], v[76:79]
    ds_read_b128 v[36:39], v124 offset:7168
    v_mfma_f32_16x16x16_bf16 v[80:83], v[48:49], v[52:53], v[80:83]
L_norm_83:
    s_mov_b64 vcc, s[36:37]
    v_mov_b32 v122, v122
    v_mov_b32 v122, v122
    v_mov_b32 v122, v122
    v_cndmask_b32_dpp v76, v72, v76, vcc quad_perm:[2,3,2,3] row_mask:0xf bank_mask:0xf
    v_cndmask_b32_dpp v77, v73, v77, vcc quad_perm:[2,3,2,3] row_mask:0xf bank_mask:0xf
    v_cndmask_b32_dpp v78, v74, v78, vcc quad_perm:[2,3,2,3] row_mask:0xf bank_mask:0xf
    v_cndmask_b32_dpp v79, v75, v79, vcc quad_perm:[2,3,2,3] row_mask:0xf bank_mask:0xf
    v_rcp_f32_dpp v84, v80 quad_perm:[2,3,2,3] row_mask:0xf bank_mask:0xf
    s_nop 0
    v_pk_mul_f32 v[76:77], v[76:77], v[84:85] op_sel_hi:[1,0]
    v_pk_mul_f32 v[78:79], v[78:79], v[84:85] op_sel_hi:[1,0]
    v_cvt_pk_bf16_f32 v72, v76, v77
    v_cvt_pk_bf16_f32 v73, v78, v79
    ds_write_b64 v122, v[72:73] offset:22016
    v_max_f32_dpp v86, v80, v84 quad_perm:[2,3,2,3] row_mask:0xf bank_mask:0xf
    v_mov_b32_dpp v60, v72 quad_perm:[0,1,0,1] row_mask:0xf bank_mask:0xf
    v_mov_b32_dpp v61, v73 quad_perm:[0,1,0,1] row_mask:0xf bank_mask:0xf
    v_cmp_lt_f32 vcc, s35, v86
    v_mov_b32_dpp v62, v72 quad_perm:[2,3,2,3] row_mask:0xf bank_mask:0xf
    v_mov_b32_dpp v63, v73 quad_perm:[2,3,2,3] row_mask:0xf bank_mask:0xf
    s_nop 1
    v_smfmac_f32_16x16x64_bf16 v[96:99], v[60:63], v[192:199], v116
    s_cbranch_vccnz L_smax_84
    v_smfmac_f32_16x16x64_bf16 v[100:103], v[60:63], v[224:231], v116
    s_waitcnt lgkmcnt(0)
    s_barrier
    ds_read_b128 v[92:95], v127 offset:21504
    ds_read_b128 v[80:83], v127 offset:20992
    ds_read_b128 v[84:87], v127 offset:20480
    v_smfmac_f32_16x16x64_bf16 v[104:107], v[60:63], v[0:7], v116
    ds_read_b128 v[40:43], v124 offset:34816
    v_smfmac_f32_16x16x64_bf16 v[108:111], v[60:63], v[8:15], v116
    ds_read_b128 v[56:59], v124 offset:36864
    s_waitcnt lgkmcnt(4)
    v_smfmac_f32_16x16x64_bf16 v[96:99], v[92:95], v[200:207], v116
    s_waitcnt lgkmcnt(3)
    v_smfmac_f32_16x16x64_bf16 v[96:99], v[80:83], v[208:215], v116
    ds_read_b128 v[44:47], v124 offset:35840
    s_waitcnt lgkmcnt(3)
    v_smfmac_f32_16x16x64_bf16 v[96:99], v[84:87], v[216:223], v116
    ds_read_b128 v[68:71], v124 offset:39936
    v_smfmac_f32_16x16x64_bf16 v[100:103], v[92:95], v[232:239], v116
    ds_read_b128 v[64:67], v124 offset:38912
    v_smfmac_f32_16x16x64_bf16 v[100:103], v[80:83], v[240:247], v116
    ds_read_b128 v[60:63], v124 offset:37888
    v_cvt_pk_bf16_f32 v72, v96, v98
    v_smfmac_f32_16x16x64_bf16 v[100:103], v[84:87], v[248:255], v116
    v_and_or_b32 v72, v72, -2, s33
    v_smfmac_f32_16x16x64_bf16 v[104:107], v[92:95], v[16:23], v116
    v_cvt_pk_bf16_f32 v74, v97, v99
    v_smfmac_f32_16x16x64_bf16 v[104:107], v[80:83], v[24:31], v116
    v_cvt_pk_bf16_f32 v73, v100, v102
    v_cvt_pk_bf16_f32 v75, v101, v103
    v_smfmac_f32_16x16x64_bf16 v[104:107], v[84:87], v[32:39], v116
    buffer_store_dwordx4 v[72:75], v118, s[8:11], s25 offen sc1
    s_waitcnt lgkmcnt(3)
    v_smfmac_f32_16x16x64_bf16 v[108:111], v[92:95], v[40:47], v116
    s_waitcnt lgkmcnt(0)
    v_smfmac_f32_16x16x64_bf16 v[108:111], v[80:83], v[56:63], v116
    v_cvt_pk_bf16_f32 v76, v104, v106
    v_smfmac_f32_16x16x64_bf16 v[108:111], v[84:87], v[64:71], v116
    v_and_or_b32 v76, v76, -2, s33
    v_cvt_pk_bf16_f32 v78, v105, v107
    v_mov_b32 v122, v122
    v_mov_b32 v122, v122
    v_mov_b32 v122, v122
    v_mov_b32 v122, v122
    v_mov_b32 v122, v122
    v_mov_b32 v122, v122
    v_cvt_pk_bf16_f32 v77, v108, v110
    v_cvt_pk_bf16_f32 v79, v109, v111
    buffer_store_dwordx4 v[76:79], v118, s[8:11], s26 offen sc1
    ds_read_b128 v[80:83], v123
    ds_read_b128 v[84:87], v123 offset:1024
    ds_read_b128 v[56:59], v123 offset:2048
    ds_read_b128 v[60:63], v123 offset:3072
    ds_read_b128 v[64:67], v123 offset:32768
    ds_read_b128 v[68:71], v123 offset:33792
    ds_read_b128 v[72:75], v123 offset:34816
    ds_read_b128 v[76:79], v123 offset:35840
    ds_read_b128 v[88:91], v123 offset:4096
    ds_read_b128 v[92:95], v123 offset:5120
    ds_read_b128 v[96:99], v123 offset:6144
    ds_read_b128 v[100:103], v123 offset:7168
    ds_read_b128 v[104:107], v123 offset:36864
    ds_read_b128 v[108:111], v123 offset:37888
    ds_read_b128 v[24:27], v123 offset:38912
    ds_read_b128 v[28:31], v123 offset:39936
    s_add_u32 s30, s30, 0x40000
    s_add_u32 s31, s31, 0x40000
    s_add_u32 s32, s32, 0x20000
    s_add_u32 s23, s24, 3072
    s_add_u32 s48, s23, 4096
    s_xor_b32 s25, s25, 0x0
    s_xor_b32 s26, s26, 0x0
    s_mov_b32 s35, 0x49800000
    s_add_u32 s22, s22, 1
    v_cndmask_b32 v12, 0, v125, s[68:69]
    v_cndmask_b32 v13, 0, v125, s[70:71]
    v_cndmask_b32 v14, 0, v125, s[72:73]
    v_cndmask_b32 v15, 0, v125, s[74:75]
    v_mov_b32 v54, 0
    v_mov_b32 v55, 0
    v_mov_b32 v52, 0
    v_mov_b32 v52, 0
    v_mov_b32 v52, 0
    v_mov_b32 v52, 0
    v_mov_b32 v52, 0
    v_mov_b32 v52, 0
    v_mov_b32 v52, 0
    v_mov_b32 v52, 0
    v_mov_b32 v52, 0
    v_mov_b32 v52, 0
    v_mov_b32 v52, 0
    v_mov_b32 v52, 0
    v_mov_b32 v52, 0
    v_mov_b32 v52, 0
    v_mov_b32 v52, 0
    v_mov_b32 v52, 0
    v_mov_b32 v52, 0
    v_mov_b32 v52, 0
    v_mov_b32 v52, 0
    v_mov_b32 v52, 0
    v_mov_b32 v52, 0
    v_mov_b32 v52, 0
    v_mov_b32 v52, 0
    v_mov_b32 v52, 0
    v_mov_b32 v52, 0
    v_mov_b32 v52, 0
    v_mov_b32 v52, 0
    v_mov_b32 v52, 0
    v_mov_b32 v52, 0
    v_mov_b32 v52, 0
    v_mov_b32 v52, 0
    v_mov_b32 v52, 0
    v_mov_b32 v52, 0
    v_mov_b32 v52, 0
    v_mov_b32 v52, 0
    v_mov_b32 v52, 0
    v_mov_b32 v52, 0
    v_mov_b32 v52, 0
    v_mov_b32 v52, 0
    v_mov_b32 v52, 0
    v_mov_b32 v52, 0
    v_mov_b32 v52, 0
    v_mov_b32 v52, 0
    v_mov_b32 v52, 0
    v_mov_b32 v52, 0
    v_mov_b32 v52, 0
    v_mov_b32 v52, 0
    v_mov_b32 v52, 0
    v_mov_b32 v52, 0
    buffer_load_dwordx4 v[4:7], v117, s[8:11], s29 offen sc1
    buffer_load_dwordx4 v[8:11], v117, s[8:11], s53 offen sc1
    buffer_load_dwordx4 v[16:19], v117, s[8:11], s29 offen offset:2048 sc1
    buffer_load_dwordx4 v[20:23], v117, s[8:11], s53 offen offset:2048 sc1
    v_mov_b32 v52, 0
    v_mov_b32 v52, 0
    v_mov_b32 v52, 0
    v_mov_b32 v52, 0
    v_mov_b32 v52, 0
    v_mov_b32 v52, 0
    v_mov_b32 v52, 0
    v_mov_b32 v52, 0
    v_mov_b32 v52, 0
    v_mov_b32 v52, 0
    v_mov_b32 v52, 0
    v_mov_b32 v52, 0
    v_mov_b32 v52, 0
    v_mov_b32 v52, 0
    v_mov_b32 v52, 0
    v_mov_b32 v52, 0
    v_mov_b32 v52, 0
    v_mov_b32 v52, 0
    v_mov_b32 v52, 0
    v_mov_b32 v52, 0
    v_mov_b32 v52, 0
    v_mov_b32 v52, 0
    v_mov_b32 v52, 0
    v_mov_b32 v52, 0
    v_mov_b32 v52, 0
    v_mov_b32 v52, 0
    v_mov_b32 v52, 0
    v_mov_b32 v52, 0
    v_mov_b32 v52, 0
    v_mov_b32 v52, 0
    buffer_load_dwordx4 v[32:35], v117, s[8:11], s29 offen sc1
    buffer_load_dwordx4 v[36:39], v117, s[8:11], s53 offen sc1
    buffer_load_dwordx4 v[40:43], v117, s[8:11], s29 offen offset:2048 sc1
    buffer_load_dwordx4 v[44:47], v117, s[8:11], s53 offen offset:2048 sc1
    v_mov_b32 v52, 0
L_rl_85:
    s_waitcnt vmcnt(7)
    v_mfma_f32_16x16x32_bf16 v[48:51], v[4:7], v[12:15], 0
    v_xor_b32 v52, s33, v4
    s_waitcnt vmcnt(6)
    v_mfma_f32_16x16x32_bf16 v[48:51], v[8:11], v[12:15], v[48:51]
    v_xor_b32 v53, s33, v8
    v_or_b32 v52, v52, v53
    s_waitcnt vmcnt(5)
    v_mfma_f32_16x16x32_bf16 v[48:51], v[16:19], v[12:15], v[48:51]
    v_xor_b32 v53, s33, v16
    v_or_b32 v52, v52, v53
    s_waitcnt vmcnt(4)
    v_mfma_f32_16x16x32_bf16 v[48:51], v[20:23], v[12:15], v[48:51]
    v_xor_b32 v53, s33, v20
    v_or_b32 v52, v52, v53
    v_and_b32 v52, 1, v52
    v_cmp_ne_u32 vcc, 0, v52
    s_cbranch_vccnz L_rslow_86
L_rgo_87:
    s_nop 2
    v_permlane32_swap_b32 v48, v50
    v_permlane32_swap_b32 v49, v51
    v_pk_add_f32 v[48:49], v[48:49], v[50:51]
    s_mov_b64 exec, s[38:39]
    v_cvt_pk_bf16_f32 v12, v48, v49
    v_min_u32 v12, 0xfffffffe, v12
    buffer_store_dword v12, v119, s[8:11], s24 offen sc1
    s_mov_b64 exec, -1
    s_add_u32 s24, s24, 8192
    s_bitset0_b32 s24, 15
    s_xor_b32 s55, s24, 16384
    s_xor_b32 s29, s29, 0x0
    s_xor_b32 s53, s29, 1024
    s_bfe_u32 s33, s22, 0x10000
    s_waitcnt lgkmcnt(0)
    s_branch L_chain_top3_s
L_chain_last_s:
    s_nop 1
    v_smfmac_f32_16x16x64_bf16 v[48:51], v[16:19], v[128:135], v116
    v_smfmac_f32_16x16x64_bf16 v[48:51], v[20:23], v[160:167], v116
    v_smfmac_f32_16x16x64_bf16 v[48:51], v[24:27], v[144:151], v116
    v_smfmac_f32_16x16x64_bf16 v[48:51], v[28:31], v[176:183], v116
    v_smfmac_f32_16x16x64_bf16 v[52:55], v[16:19], v[136:143], v116
    v_smfmac_f32_16x16x64_bf16 v[52:55], v[20:23], v[168:175], v116
    v_smfmac_f32_16x16x64_bf16 v[52:55], v[24:27], v[152:159], v116
    v_smfmac_f32_16x16x64_bf16 v[52:55], v[28:31], v[184:191], v116
    v_add_f32 v48, v48, v50
    v_add_f32 v49, v49, v51
    v_cvt_pk_bf16_f32 v112, v48, v49
    s_nop 4
    v_add_f32 v52, v52, v54
    v_add_f32 v53, v53, v55
    v_cvt_pk_bf16_f32 v114, v52, v53
    s_add_u32 s32, s32, 0x20000
    buffer_store_dwordx4 v[112:115], v117, s[8:11], s32 offen sc1
    v_mov_b32 v94, 64
    s_waitcnt vmcnt(0) lgkmcnt(0)
    s_barrier
    s_mov_b64 exec, 1
    buffer_store_dword v94, off, s[8:11], s44 sc1
    s_mov_b64 exec, -1
    s_endpgm
L_mret_59:
    s_mov_b32 s43, m0
    s_mov_b32 m0, 4096
    buffer_load_dwordx4 v[4:7], v117, s[8:11], s48 offen sc1
    buffer_load_dwordx4 v117, s[8:11], s48 offen sc1 lds
    s_mov_b32 m0, 8192
    s_mov_b32 m0, s43
    s_waitcnt vmcnt(0)
    v_max3_u32 v15, v4, v5, v6
    v_max_u32 v15, v15, v7
    v_cmp_lt_u32 vcc, s56, v15
    s_add_u32 s47, s47, 1
    s_add_u32 s49, s49, 1
    s_cmp_ge_u32 s49, 0x10000
    s_cbranch_scc1 L_mgo_60
    s_cbranch_vccnz L_mret_59
    s_branch L_mgo_60
L_smax_62:
    s_add_u32 s47, s47, 1
    s_mov_b32 s35, 0x7f800000
    s_waitcnt lgkmcnt(0)
    s_sub_u32 s43, s30, 0x40000
    s_add_u32 s40, s43, 4096
    s_nop 7
    buffer_load_dwordx4 v[56:59], v117, s[8:11], s43 offen
    buffer_load_dwordx4 v[60:63], v117, s[8:11], s43 offen offset:1024
    buffer_load_dwordx4 v[64:67], v117, s[8:11], s43 offen offset:2048
    buffer_load_dwordx4 v[68:71], v117, s[8:11], s43 offen offset:3072
    buffer_load_dwordx4 v[72:75], v117, s[8:11], s40 offen
    buffer_load_dwordx4 v[76:79], v117, s[8:11], s40 offen offset:1024
    buffer_load_dwordx4 v[80:83], v117, s[8:11], s40 offen offset:2048
    buffer_load_dwordx4 v[84:87], v117, s[8:11], s40 offen offset:3072
    ds_read_b128 v[32:35], v121 offset:16384
    ds_read_b128 v[36:39], v121 offset:17408
    ds_read_b128 v[40:43], v121 offset:18432
    ds_read_b128 v[44:47], v121 offset:19456
    v_mov_b32 v96, 0
    v_mov_b32 v97, 0
    v_mov_b32 v98, 0
    v_mov_b32 v99, 0
    v_mov_b32 v100, 0
    v_mov_b32 v101, 0
    v_mov_b32 v102, 0
    v_mov_b32 v103, 0
    v_mov_b32 v104, 0
    v_mov_b32 v105, 0
    v_mov_b32 v106, 0
    v_mov_b32 v107, 0
    v_mov_b32 v108, 0
    v_mov_b32 v109, 0
    v_mov_b32 v110, 0
    v_mov_b32 v111, 0
    s_waitcnt vmcnt(0) lgkmcnt(0)
    v_mfma_f32_16x16x32_bf16 v[56:59], v[56:59], v[32:35], 0
    v_mfma_f32_16x16x32_bf16 v[56:59], v[60:63], v[36:39], v[56:59]
    v_mfma_f32_16x16x32_bf16 v[56:59], v[64:67], v[40:43], v[56:59]
    v_mfma_f32_16x16x32_bf16 v[56:59], v[68:71], v[44:47], v[56:59]
    v_mfma_f32_16x16x32_bf16 v[60:63], v[72:75], v[32:35], 0
    v_mfma_f32_16x16x32_bf16 v[60:63], v[76:79], v[36:39], v[60:63]
    v_mfma_f32_16x16x32_bf16 v[60:63], v[80:83], v[40:43], v[60:63]
    v_mfma_f32_16x16x32_bf16 v[60:63], v[84:87], v[44:47], v[60:63]
    v_mfma_f32_16x16x32_bf16 v[64:67], v[32:35], v[32:35], 0
    v_mfma_f32_16x16x32_bf16 v[64:67], v[36:39], v[36:39], v[64:67]
    v_mfma_f32_16x16x32_bf16 v[64:67], v[40:43], v[40:43], v[64:67]
    v_mfma_f32_16x16x32_bf16 v[64:67], v[44:47], v[44:47], v[64:67]
    v_max3_f32 v84, v56, v57, v58
    v_max3_f32 v84, v84, v59, v60
    v_max3_f32 v84, v84, v61, v62
    s_nop 4
    v_max3_f32 v84, v84, v63, v64
    v_max_f32 v84, v84, v65
    v_mov_b32 v85, v84
    s_nop 1
    v_permlane32_swap_b32 v85, v84
    v_max_f32 v84, v85, v84
    v_mov_b32 v85, v84
    s_nop 1
    v_permlane16_swap_b32 v85, v84
    v_max_f32 v84, v85, v84
    v_sub_f32 v56, v56, v84
    v_sub_f32 v57, v57, v84
    v_sub_f32 v58, v58, v84
    v_sub_f32 v59, v59, v84
    v_sub_f32 v60, v60, v84
    v_sub_f32 v61, v61, v84
    v_sub_f32 v62, v62, v84
    v_sub_f32 v63, v63, v84
    v_sub_f32 v64, v64, v84
    v_sub_f32 v65, v65, v84
    v_exp_f32 v56, v56
    v_exp_f32 v57, v57
    v_exp_f32 v58, v58
    v_exp_f32 v59, v59
    v_exp_f32 v60, v60
    v_exp_f32 v61, v61
    v_exp_f32 v62, v62
    v_exp_f32 v63, v63
    v_exp_f32 v64, v64
    v_exp_f32 v65, v65
    v_cvt_pk_bf16_f32 v68, v56, v57
    v_cvt_pk_bf16_f32 v69, v58, v59
    v_cvt_pk_bf16_f32 v70, v60, v61
    v_cvt_pk_bf16_f32 v71, v62, v63
    v_cvt_pk_bf16_f32 v52, v64, v65
    s_nop 0
    v_mfma_f32_16x16x32_bf16 v[72:75], v[88:91], v[68:71], 0
    v_mfma_f32_16x16x32_bf16 v[76:79], v[92:95], v[68:71], 0
    v_mfma_f32_16x16x32_bf16 v[80:83], v[48:51], v[68:71], 0
    v_mfma_f32_16x16x16_bf16 v[72:75], v[112:113], v[52:53], v[72:75]
    v_mfma_f32_16x16x16_bf16 v[76:79], v[114:115], v[52:53], v[76:79]
    v_mfma_f32_16x16x16_bf16 v[80:83], v[48:49], v[52:53], v[80:83]
    ds_read_b128 v[32:35], v124 offset:6144
    ds_read_b128 v[36:39], v124 offset:7168
    ds_read_b128 v[40:43], v124 offset:34816
    ds_read_b128 v[44:47], v124 offset:35840
    ds_read_b128 v[56:59], v124 offset:36864
    ds_read_b128 v[64:67], v124 offset:38912
    ds_read_b128 v[68:71], v124 offset:39936
    s_waitcnt lgkmcnt(0)
    s_branch L_norm_61
L_kvw_63:
    s_add_u32 s47, s47, 1
    s_add_u32 s49, s49, 1
    s_cmp_ge_u32 s49, 0x10000
    s_cbranch_scc1 L_kvb_64
    s_sleep 4
    buffer_load_dword v125, v119, s[8:11], s28 offen sc1
    s_waitcnt vmcnt(0)
    v_cmp_eq_u32 vcc, 0, v125
    s_nop 0
    s_and_b64 vcc, vcc, s[58:59]
    s_cbranch_scc1 L_kvw_63
    s_branch L_kvb_64
L_mret_66:
    s_mov_b32 s43, m0
    s_mov_b32 m0, 5120
    buffer_load_dwordx4 v[4:7], v117, s[8:11], s48 offen sc1
    buffer_load_dwordx4 v117, s[8:11], s48 offen sc1 lds
    s_mov_b32 m0, 10240
    s_mov_b32 m0, s43
    s_waitcnt vmcnt(0)
    v_max3_u32 v15, v4, v5, v6
    v_max_u32 v15, v15, v7
    v_cmp_lt_u32 vcc, s56, v15
    s_add_u32 s47, s47, 1
    s_add_u32 s49, s49, 1
    s_cmp_ge_u32 s49, 0x10000
    s_cbranch_scc1 L_mgo_67
    s_cbranch_vccnz L_mret_66
    s_branch L_mgo_67
L_smax_69:
    s_add_u32 s47, s47, 1
    s_mov_b32 s35, 0x7f800000
    s_waitcnt lgkmcnt(0)
    s_sub_u32 s43, s30, 0x40800
    s_add_u32 s40, s43, 4096
    s_nop 7
    buffer_load_dwordx4 v[56:59], v117, s[8:11], s43 offen
    buffer_load_dwordx4 v[60:63], v117, s[8:11], s43 offen offset:1024
    buffer_load_dwordx4 v[64:67], v117, s[8:11], s43 offen offset:2048
    buffer_load_dwordx4 v[68:71], v117, s[8:11], s43 offen offset:3072
    buffer_load_dwordx4 v[72:75], v117, s[8:11], s40 offen
    buffer_load_dwordx4 v[76:79], v117, s[8:11], s40 offen offset:1024
    buffer_load_dwordx4 v[80:83], v117, s[8:11], s40 offen offset:2048
    buffer_load_dwordx4 v[84:87], v117, s[8:11], s40 offen offset:3072
    ds_read_b128 v[32:35], v121 offset:16384
    ds_read_b128 v[36:39], v121 offset:17408
    ds_read_b128 v[40:43], v121 offset:18432
    ds_read_b128 v[44:47], v121 offset:19456
    v_mov_b32 v96, 0
    v_mov_b32 v97, 0
    v_mov_b32 v98, 0
    v_mov_b32 v99, 0
    v_mov_b32 v100, 0
    v_mov_b32 v101, 0
    v_mov_b32 v102, 0
    v_mov_b32 v103, 0
    v_mov_b32 v104, 0
    v_mov_b32 v105, 0
    v_mov_b32 v106, 0
    v_mov_b32 v107, 0
    v_mov_b32 v108, 0
    v_mov_b32 v109, 0
    v_mov_b32 v110, 0
    v_mov_b32 v111, 0
    s_waitcnt vmcnt(0) lgkmcnt(0)
    v_mfma_f32_16x16x32_bf16 v[56:59], v[56:59], v[32:35], 0
    v_mfma_f32_16x16x32_bf16 v[56:59], v[60:63], v[36:39], v[56:59]
    v_mfma_f32_16x16x32_bf16 v[56:59], v[64:67], v[40:43], v[56:59]
    v_mfma_f32_16x16x32_bf16 v[56:59], v[68:71], v[44:47], v[56:59]
    v_mfma_f32_16x16x32_bf16 v[60:63], v[72:75], v[32:35], 0
    v_mfma_f32_16x16x32_bf16 v[60:63], v[76:79], v[36:39], v[60:63]
    v_mfma_f32_16x16x32_bf16 v[60:63], v[80:83], v[40:43], v[60:63]
    v_mfma_f32_16x16x32_bf16 v[60:63], v[84:87], v[44:47], v[60:63]
    v_mfma_f32_16x16x32_bf16 v[64:67], v[32:35], v[32:35], 0
    v_mfma_f32_16x16x32_bf16 v[64:67], v[36:39], v[36:39], v[64:67]
    v_mfma_f32_16x16x32_bf16 v[64:67], v[40:43], v[40:43], v[64:67]
    v_mfma_f32_16x16x32_bf16 v[64:67], v[44:47], v[44:47], v[64:67]
    v_max3_f32 v84, v56, v57, v58
    v_max3_f32 v84, v84, v59, v60
    v_max3_f32 v84, v84, v61, v62
    s_nop 4
    v_max3_f32 v84, v84, v63, v64
    v_max_f32 v84, v84, v65
    v_mov_b32 v85, v84
    s_nop 1
    v_permlane32_swap_b32 v85, v84
    v_max_f32 v84, v85, v84
    v_mov_b32 v85, v84
    s_nop 1
    v_permlane16_swap_b32 v85, v84
    v_max_f32 v84, v85, v84
    v_sub_f32 v56, v56, v84
    v_sub_f32 v57, v57, v84
    v_sub_f32 v58, v58, v84
    v_sub_f32 v59, v59, v84
    v_sub_f32 v60, v60, v84
    v_sub_f32 v61, v61, v84
    v_sub_f32 v62, v62, v84
    v_sub_f32 v63, v63, v84
    v_sub_f32 v64, v64, v84
    v_sub_f32 v65, v65, v84
    v_exp_f32 v56, v56
    v_exp_f32 v57, v57
    v_exp_f32 v58, v58
    v_exp_f32 v59, v59
    v_exp_f32 v60, v60
    v_exp_f32 v61, v61
    v_exp_f32 v62, v62
    v_exp_f32 v63, v63
    v_exp_f32 v64, v64
    v_exp_f32 v65, v65
    v_cvt_pk_bf16_f32 v68, v56, v57
    v_cvt_pk_bf16_f32 v69, v58, v59
    v_cvt_pk_bf16_f32 v70, v60, v61
    v_cvt_pk_bf16_f32 v71, v62, v63
    v_cvt_pk_bf16_f32 v52, v64, v65
    s_nop 0
    v_mfma_f32_16x16x32_bf16 v[72:75], v[88:91], v[68:71], 0
    v_mfma_f32_16x16x32_bf16 v[76:79], v[92:95], v[68:71], 0
    v_mfma_f32_16x16x32_bf16 v[80:83], v[48:51], v[68:71], 0
    v_mfma_f32_16x16x16_bf16 v[72:75], v[112:113], v[52:53], v[72:75]
    v_mfma_f32_16x16x16_bf16 v[76:79], v[114:115], v[52:53], v[76:79]
    v_mfma_f32_16x16x16_bf16 v[80:83], v[48:49], v[52:53], v[80:83]
    ds_read_b128 v[32:35], v124 offset:6144
    ds_read_b128 v[36:39], v124 offset:7168
    ds_read_b128 v[40:43], v124 offset:34816
    ds_read_b128 v[44:47], v124 offset:35840
    ds_read_b128 v[56:59], v124 offset:36864
    ds_read_b128 v[64:67], v124 offset:38912
    ds_read_b128 v[68:71], v124 offset:39936
    s_waitcnt lgkmcnt(0)
    s_branch L_norm_68
L_kvw_70:
    s_add_u32 s47, s47, 1
    s_add_u32 s49, s49, 1
    s_cmp_ge_u32 s49, 0x10000
    s_cbranch_scc1 L_kvb_71
    s_sleep 4
    buffer_load_dword v125, v119, s[8:11], s28 offen sc1
    s_waitcnt vmcnt(0)
    v_cmp_eq_u32 vcc, 0, v125
    s_nop 0
    s_and_b64 vcc, vcc, s[58:59]
    s_cbranch_scc1 L_kvw_70
    s_branch L_kvb_71
L_mret_73:
    s_mov_b32 s43, m0
    s_mov_b32 m0, 6144
    buffer_load_dwordx4 v[4:7], v117, s[8:11], s48 offen sc1
    buffer_load_dwordx4 v117, s[8:11], s48 offen sc1 lds
    s_mov_b32 m0, 12288
    s_mov_b32 m0, s43
    s_waitcnt vmcnt(0)
    v_max3_u32 v15, v4, v5, v6
    v_max_u32 v15, v15, v7
    v_cmp_lt_u32 vcc, s56, v15
    s_add_u32 s47, s47, 1
    s_add_u32 s49, s49, 1
    s_cmp_ge_u32 s49, 0x10000
    s_cbranch_scc1 L_mgo_74
    s_cbranch_vccnz L_mret_73
    s_branch L_mgo_74
L_smax_76:
    s_add_u32 s47, s47, 1
    s_mov_b32 s35, 0x7f800000
    s_waitcnt lgkmcnt(0)
    s_sub_u32 s43, s30, 0x41000
    s_add_u32 s40, s43, 4096
    s_nop 7
    buffer_load_dwordx4 v[56:59], v117, s[8:11], s43 offen
    buffer_load_dwordx4 v[60:63], v117, s[8:11], s43 offen offset:1024
    buffer_load_dwordx4 v[64:67], v117, s[8:11], s43 offen offset:2048
    buffer_load_dwordx4 v[68:71], v117, s[8:11], s43 offen offset:3072
    buffer_load_dwordx4 v[72:75], v117, s[8:11], s40 offen
    buffer_load_dwordx4 v[76:79], v117, s[8:11], s40 offen offset:1024
    buffer_load_dwordx4 v[80:83], v117, s[8:11], s40 offen offset:2048
    buffer_load_dwordx4 v[84:87], v117, s[8:11], s40 offen offset:3072
    ds_read_b128 v[32:35], v121 offset:16384
    ds_read_b128 v[36:39], v121 offset:17408
    ds_read_b128 v[40:43], v121 offset:18432
    ds_read_b128 v[44:47], v121 offset:19456
    v_mov_b32 v96, 0
    v_mov_b32 v97, 0
    v_mov_b32 v98, 0
    v_mov_b32 v99, 0
    v_mov_b32 v100, 0
    v_mov_b32 v101, 0
    v_mov_b32 v102, 0
    v_mov_b32 v103, 0
    v_mov_b32 v104, 0
    v_mov_b32 v105, 0
    v_mov_b32 v106, 0
    v_mov_b32 v107, 0
    v_mov_b32 v108, 0
    v_mov_b32 v109, 0
    v_mov_b32 v110, 0
    v_mov_b32 v111, 0
    s_waitcnt vmcnt(0) lgkmcnt(0)
    v_mfma_f32_16x16x32_bf16 v[56:59], v[56:59], v[32:35], 0
    v_mfma_f32_16x16x32_bf16 v[56:59], v[60:63], v[36:39], v[56:59]
    v_mfma_f32_16x16x32_bf16 v[56:59], v[64:67], v[40:43], v[56:59]
    v_mfma_f32_16x16x32_bf16 v[56:59], v[68:71], v[44:47], v[56:59]
    v_mfma_f32_16x16x32_bf16 v[60:63], v[72:75], v[32:35], 0
    v_mfma_f32_16x16x32_bf16 v[60:63], v[76:79], v[36:39], v[60:63]
    v_mfma_f32_16x16x32_bf16 v[60:63], v[80:83], v[40:43], v[60:63]
    v_mfma_f32_16x16x32_bf16 v[60:63], v[84:87], v[44:47], v[60:63]
    v_mfma_f32_16x16x32_bf16 v[64:67], v[32:35], v[32:35], 0
    v_mfma_f32_16x16x32_bf16 v[64:67], v[36:39], v[36:39], v[64:67]
    v_mfma_f32_16x16x32_bf16 v[64:67], v[40:43], v[40:43], v[64:67]
    v_mfma_f32_16x16x32_bf16 v[64:67], v[44:47], v[44:47], v[64:67]
    v_max3_f32 v84, v56, v57, v58
    v_max3_f32 v84, v84, v59, v60
    v_max3_f32 v84, v84, v61, v62
    s_nop 4
    v_max3_f32 v84, v84, v63, v64
    v_max_f32 v84, v84, v65
    v_mov_b32 v85, v84
    s_nop 1
    v_permlane32_swap_b32 v85, v84
    v_max_f32 v84, v85, v84
    v_mov_b32 v85, v84
    s_nop 1
    v_permlane16_swap_b32 v85, v84
    v_max_f32 v84, v85, v84
    v_sub_f32 v56, v56, v84
    v_sub_f32 v57, v57, v84
    v_sub_f32 v58, v58, v84
    v_sub_f32 v59, v59, v84
    v_sub_f32 v60, v60, v84
    v_sub_f32 v61, v61, v84
    v_sub_f32 v62, v62, v84
    v_sub_f32 v63, v63, v84
    v_sub_f32 v64, v64, v84
    v_sub_f32 v65, v65, v84
    v_exp_f32 v56, v56
    v_exp_f32 v57, v57
    v_exp_f32 v58, v58
    v_exp_f32 v59, v59
    v_exp_f32 v60, v60
    v_exp_f32 v61, v61
    v_exp_f32 v62, v62
    v_exp_f32 v63, v63
    v_exp_f32 v64, v64
    v_exp_f32 v65, v65
    v_cvt_pk_bf16_f32 v68, v56, v57
    v_cvt_pk_bf16_f32 v69, v58, v59
    v_cvt_pk_bf16_f32 v70, v60, v61
    v_cvt_pk_bf16_f32 v71, v62, v63
    v_cvt_pk_bf16_f32 v52, v64, v65
    s_nop 0
    v_mfma_f32_16x16x32_bf16 v[72:75], v[88:91], v[68:71], 0
    v_mfma_f32_16x16x32_bf16 v[76:79], v[92:95], v[68:71], 0
    v_mfma_f32_16x16x32_bf16 v[80:83], v[48:51], v[68:71], 0
    v_mfma_f32_16x16x16_bf16 v[72:75], v[112:113], v[52:53], v[72:75]
    v_mfma_f32_16x16x16_bf16 v[76:79], v[114:115], v[52:53], v[76:79]
    v_mfma_f32_16x16x16_bf16 v[80:83], v[48:49], v[52:53], v[80:83]
    ds_read_b128 v[32:35], v124 offset:6144
    ds_read_b128 v[36:39], v124 offset:7168
    ds_read_b128 v[40:43], v124 offset:34816
    ds_read_b128 v[44:47], v124 offset:35840
    ds_read_b128 v[56:59], v124 offset:36864
    ds_read_b128 v[64:67], v124 offset:38912
    ds_read_b128 v[68:71], v124 offset:39936
    s_waitcnt lgkmcnt(0)
    s_branch L_norm_75
L_rslow_78:
    buffer_load_dwordx4 v[4:7], v117, s[8:11], s29 offen sc1
    buffer_load_dwordx4 v[8:11], v117, s[8:11], s53 offen sc1
    buffer_load_dwordx4 v[16:19], v117, s[8:11], s29 offen offset:2048 sc1
    buffer_load_dwordx4 v[20:23], v117, s[8:11], s53 offen offset:2048 sc1
    s_add_u32 s46, s46, 1
    s_add_u32 s49, s49, 1
    s_cmp_ge_u32 s49, 0x10000
    s_cbranch_scc1 L_rgo_79
    s_waitcnt vmcnt(7)
    v_mfma_f32_16x16x32_bf16 v[48:51], v[32:35], v[12:15], 0
    v_xor_b32 v52, s33, v32
    s_waitcnt vmcnt(6)
    v_mfma_f32_16x16x32_bf16 v[48:51], v[36:39], v[12:15], v[48:51]
    v_xor_b32 v53, s33, v36
    v_or_b32 v52, v52, v53
    s_waitcnt vmcnt(5)
    v_mfma_f32_16x16x32_bf16 v[48:51], v[40:43], v[12:15], v[48:51]
    v_xor_b32 v53, s33, v40
    v_or_b32 v52, v52, v53
    s_waitcnt vmcnt(4)
    v_mfma_f32_16x16x32_bf16 v[48:51], v[44:47], v[12:15], v[48:51]
    v_xor_b32 v53, s33, v44
    v_or_b32 v52, v52, v53
    v_and_b32 v52, 1, v52
    v_cmp_ne_u32 vcc, 0, v52
    s_cbranch_vccz L_rgo_79
    buffer_load_dwordx4 v[32:35], v117, s[8:11], s29 offen sc1
    buffer_load_dwordx4 v[36:39], v117, s[8:11], s53 offen sc1
    buffer_load_dwordx4 v[40:43], v117, s[8:11], s29 offen offset:2048 sc1
    buffer_load_dwordx4 v[44:47], v117, s[8:11], s53 offen offset:2048 sc1
    s_add_u32 s46, s46, 1
    s_branch L_rl_77
L_mret_81:
    s_mov_b32 s43, m0
    s_mov_b32 m0, 7168
    buffer_load_dwordx4 v[4:7], v117, s[8:11], s48 offen sc1
    buffer_load_dwordx4 v117, s[8:11], s48 offen sc1 lds
    s_mov_b32 m0, 14336
    s_mov_b32 m0, s43
    s_waitcnt vmcnt(0)
    v_max3_u32 v15, v4, v5, v6
    v_max_u32 v15, v15, v7
    v_cmp_lt_u32 vcc, s56, v15
    s_add_u32 s47, s47, 1
    s_add_u32 s49, s49, 1
    s_cmp_ge_u32 s49, 0x10000
    s_cbranch_scc1 L_mgo_82
    s_cbranch_vccnz L_mret_81
    s_branch L_mgo_82
L_smax_84:
    s_add_u32 s47, s47, 1
    s_mov_b32 s35, 0x7f800000
    s_waitcnt lgkmcnt(0)
    s_sub_u32 s43, s30, 0x41800
    s_add_u32 s40, s43, 4096
    s_nop 7
    buffer_load_dwordx4 v[56:59], v117, s[8:11], s43 offen
    buffer_load_dwordx4 v[60:63], v117, s[8:11], s43 offen offset:1024
    buffer_load_dwordx4 v[64:67], v117, s[8:11], s43 offen offset:2048
    buffer_load_dwordx4 v[68:71], v117, s[8:11], s43 offen offset:3072
    buffer_load_dwordx4 v[72:75], v117, s[8:11], s40 offen
    buffer_load_dwordx4 v[76:79], v117, s[8:11], s40 offen offset:1024
    buffer_load_dwordx4 v[80:83], v117, s[8:11], s40 offen offset:2048
    buffer_load_dwordx4 v[84:87], v117, s[8:11], s40 offen offset:3072
    ds_read_b128 v[32:35], v121 offset:16384
    ds_read_b128 v[36:39], v121 offset:17408
    ds_read_b128 v[40:43], v121 offset:18432
    ds_read_b128 v[44:47], v121 offset:19456
    v_mov_b32 v96, 0
    v_mov_b32 v97, 0
    v_mov_b32 v98, 0
    v_mov_b32 v99, 0
    v_mov_b32 v100, 0
    v_mov_b32 v101, 0
    v_mov_b32 v102, 0
    v_mov_b32 v103, 0
    v_mov_b32 v104, 0
    v_mov_b32 v105, 0
    v_mov_b32 v106, 0
    v_mov_b32 v107, 0
    v_mov_b32 v108, 0
    v_mov_b32 v109, 0
    v_mov_b32 v110, 0
    v_mov_b32 v111, 0
    s_waitcnt vmcnt(0) lgkmcnt(0)
    v_mfma_f32_16x16x32_bf16 v[56:59], v[56:59], v[32:35], 0
    v_mfma_f32_16x16x32_bf16 v[56:59], v[60:63], v[36:39], v[56:59]
    v_mfma_f32_16x16x32_bf16 v[56:59], v[64:67], v[40:43], v[56:59]
    v_mfma_f32_16x16x32_bf16 v[56:59], v[68:71], v[44:47], v[56:59]
    v_mfma_f32_16x16x32_bf16 v[60:63], v[72:75], v[32:35], 0
    v_mfma_f32_16x16x32_bf16 v[60:63], v[76:79], v[36:39], v[60:63]
    v_mfma_f32_16x16x32_bf16 v[60:63], v[80:83], v[40:43], v[60:63]
    v_mfma_f32_16x16x32_bf16 v[60:63], v[84:87], v[44:47], v[60:63]
    v_mfma_f32_16x16x32_bf16 v[64:67], v[32:35], v[32:35], 0
    v_mfma_f32_16x16x32_bf16 v[64:67], v[36:39], v[36:39], v[64:67]
    v_mfma_f32_16x16x32_bf16 v[64:67], v[40:43], v[40:43], v[64:67]
    v_mfma_f32_16x16x32_bf16 v[64:67], v[44:47], v[44:47], v[64:67]
    v_max3_f32 v84, v56, v57, v58
    v_max3_f32 v84, v84, v59, v60
    v_max3_f32 v84, v84, v61, v62
    s_nop 4
    v_max3_f32 v84, v84, v63, v64
    v_max_f32 v84, v84, v65
    v_mov_b32 v85, v84
    s_nop 1
    v_permlane32_swap_b32 v85, v84
    v_max_f32 v84, v85, v84
    v_mov_b32 v85, v84
    s_nop 1
    v_permlane16_swap_b32 v85, v84
    v_max_f32 v84, v85, v84
    v_sub_f32 v56, v56, v84
    v_sub_f32 v57, v57, v84
    v_sub_f32 v58, v58, v84
    v_sub_f32 v59, v59, v84
    v_sub_f32 v60, v60, v84
    v_sub_f32 v61, v61, v84
    v_sub_f32 v62, v62, v84
    v_sub_f32 v63, v63, v84
    v_sub_f32 v64, v64, v84
    v_sub_f32 v65, v65, v84
    v_exp_f32 v56, v56
    v_exp_f32 v57, v57
    v_exp_f32 v58, v58
    v_exp_f32 v59, v59
    v_exp_f32 v60, v60
    v_exp_f32 v61, v61
    v_exp_f32 v62, v62
    v_exp_f32 v63, v63
    v_exp_f32 v64, v64
    v_exp_f32 v65, v65
    v_cvt_pk_bf16_f32 v68, v56, v57
    v_cvt_pk_bf16_f32 v69, v58, v59
    v_cvt_pk_bf16_f32 v70, v60, v61
    v_cvt_pk_bf16_f32 v71, v62, v63
    v_cvt_pk_bf16_f32 v52, v64, v65
    s_nop 0
    v_mfma_f32_16x16x32_bf16 v[72:75], v[88:91], v[68:71], 0
    v_mfma_f32_16x16x32_bf16 v[76:79], v[92:95], v[68:71], 0
    v_mfma_f32_16x16x32_bf16 v[80:83], v[48:51], v[68:71], 0
    v_mfma_f32_16x16x16_bf16 v[72:75], v[112:113], v[52:53], v[72:75]
    v_mfma_f32_16x16x16_bf16 v[76:79], v[114:115], v[52:53], v[76:79]
    v_mfma_f32_16x16x16_bf16 v[80:83], v[48:49], v[52:53], v[80:83]
    ds_read_b128 v[32:35], v124 offset:6144
    ds_read_b128 v[36:39], v124 offset:7168
    ds_read_b128 v[40:43], v124 offset:34816
    ds_read_b128 v[44:47], v124 offset:35840
    ds_read_b128 v[56:59], v124 offset:36864
    ds_read_b128 v[64:67], v124 offset:38912
    ds_read_b128 v[68:71], v124 offset:39936
    s_waitcnt lgkmcnt(0)
    s_branch L_norm_83
L_rslow_86:
    buffer_load_dwordx4 v[4:7], v117, s[8:11], s29 offen sc1
    buffer_load_dwordx4 v[8:11], v117, s[8:11], s53 offen sc1
    buffer_load_dwordx4 v[16:19], v117, s[8:11], s29 offen offset:2048 sc1
    buffer_load_dwordx4 v[20:23], v117, s[8:11], s53 offen offset:2048 sc1
    s_add_u32 s46, s46, 1
    s_add_u32 s49, s49, 1
    s_cmp_ge_u32 s49, 0x10000
    s_cbranch_scc1 L_rgo_87
    s_waitcnt vmcnt(7)
    v_mfma_f32_16x16x32_bf16 v[48:51], v[32:35], v[12:15], 0
    v_xor_b32 v52, s33, v32
    s_waitcnt vmcnt(6)
    v_mfma_f32_16x16x32_bf16 v[48:51], v[36:39], v[12:15], v[48:51]
    v_xor_b32 v53, s33, v36
    v_or_b32 v52, v52, v53
    s_waitcnt vmcnt(5)
    v_mfma_f32_16x16x32_bf16 v[48:51], v[40:43], v[12:15], v[48:51]
    v_xor_b32 v53, s33, v40
    v_or_b32 v52, v52, v53
    s_waitcnt vmcnt(4)
    v_mfma_f32_16x16x32_bf16 v[48:51], v[44:47], v[12:15], v[48:51]
    v_xor_b32 v53, s33, v44
    v_or_b32 v52, v52, v53
    v_and_b32 v52, 1, v52
    v_cmp_ne_u32 vcc, 0, v52
    s_cbranch_vccz L_rgo_87
    buffer_load_dwordx4 v[32:35], v117, s[8:11], s29 offen sc1
    buffer_load_dwordx4 v[36:39], v117, s[8:11], s53 offen sc1
    buffer_load_dwordx4 v[40:43], v117, s[8:11], s29 offen offset:2048 sc1
    buffer_load_dwordx4 v[44:47], v117, s[8:11], s53 offen offset:2048 sc1
    s_add_u32 s46, s46, 1
    s_branch L_rl_85
L_bulk:
    s_load_dwordx8 s[60:67], s[0:1], 16
    s_load_dwordx2 s[12:13], s[0:1], 0
    s_waitcnt lgkmcnt(0)
    s_branch L_bulk2
.p2align 7
L_other:
    s_sub_u32 s101, s84, 1
    s_lshl_b32 s101, s101, 5
    s_add_u32 s101, s101, s85
    s_cmp_ge_u32 s85, 2
    s_cbranch_scc1 L_nobc
    v_lshlrev_b32 v1, 6, v0
    s_lshl_b32 s96, s85, 14
    s_getpc_b64 s[4:5]
L_pc_88:
    s_add_u32 s4, s4, L_bulk2-L_pc_88
    s_addc_u32 s5, s5, 0
    v_add_u32 v1, s96, v1
    v_min_u32 v1, L_code_end-L_bulk2-4, v1
    global_load_dword v255, v1, s[4:5]
L_nobc:
    s_waitcnt lgkmcnt(0)
    s_and_b32 s9, s9, 0xffff
    s_mov_b32 s10, 0x10000000
    s_mov_b32 s11, 0x20000
    s_and_b32 s93, s93, 0xffff
    s_mov_b32 s94, 0x100
    s_mov_b32 s95, 0x20000
    s_mov_b32 s87, 0
    s_cmp_lg_u32 s86, 0
    s_cbranch_scc1 L_reg_89
    s_lshl_b32 s97, s84, 4
    s_lshl_b32 s96, 1, s85
    v_mov_b32 v250, s96
    v_mov_b32 v251, 256
    s_mov_b64 exec, 1
    buffer_atomic_add_x2 v[250:251], off, s[92:95], s97 offset:64
    s_mov_b64 exec, -1
    s_mov_b32 s86, 1
L_reg_89:
L_bulk2:
    s_add_u32 s88, s101, 32
    s_mov_b32 s41, 0
    s_lshr_b32 s20, s101, 6
    s_and_b32 s22, s101, 63
    s_cmp_ge_u32 s101, 192
    s_cselect_b32 s37, 32, 1000
L_p1go:
    s_mov_b32 s40, 0
    s_mov_b32 s80, 0
    s_mov_b32 s23, 0
L_p1_pass:
    v_mbcnt_lo_u32_b32 v0, -1, 0
    v_mbcnt_hi_u32_b32 v0, -1, v0
    s_lshl_b32 s96, s100, 6
    v_add_u32 v0, s96, v0
    s_and_b32 s13, s13, 0xffff
    s_mov_b32 s14, 0x200000
    s_mov_b32 s15, 0x20000
    v_lshrrev_b32 v147, 6, v0
    s_nop 0
    v_readfirstlane_b32 s21, v147
    v_and_b32 v144, 63, v0
    v_lshrrev_b32 v145, 4, v144
    v_and_b32 v146, 15, v144
    v_lshrrev_b32 v149, 2, v146
    v_lshlrev_b32 v137, 4, v144
    s_lshl_b32 s29, s21, 10
    s_lshl_b32 s26, s20, 7
    s_lshl_b32 s27, s21, 5
    s_add_u32 s26, s26, s27
    v_add_u32 v147, s26, v146
    v_lshlrev_b32 v147, 10, v147
    v_lshl_add_u32 v139, v145, 4, v147
    s_mov_b32 s26, 0x0
    buffer_load_dwordx4 v[0:3], v139, s[12:15], s26 offen
    buffer_load_dwordx4 v[4:7], v139, s[12:15], s26 offen offset:64
    buffer_load_dwordx4 v[8:11], v139, s[12:15], s26 offen offset:128
    buffer_load_dwordx4 v[12:15], v139, s[12:15], s26 offen offset:192
    buffer_load_dwordx4 v[16:19], v139, s[12:15], s26 offen offset:256
    buffer_load_dwordx4 v[20:23], v139, s[12:15], s26 offen offset:320
    buffer_load_dwordx4 v[24:27], v139, s[12:15], s26 offen offset:384
    buffer_load_dwordx4 v[28:31], v139, s[12:15], s26 offen offset:448
    buffer_load_dwordx4 v[32:35], v139, s[12:15], s26 offen offset:512
    buffer_load_dwordx4 v[36:39], v139, s[12:15], s26 offen offset:576
    buffer_load_dwordx4 v[40:43], v139, s[12:15], s26 offen offset:640
    buffer_load_dwordx4 v[44:47], v139, s[12:15], s26 offen offset:704
    buffer_load_dwordx4 v[48:51], v139, s[12:15], s26 offen offset:768
    buffer_load_dwordx4 v[52:55], v139, s[12:15], s26 offen offset:832
    buffer_load_dwordx4 v[56:59], v139, s[12:15], s26 offen offset:896
    buffer_load_dwordx4 v[60:63], v139, s[12:15], s26 offen offset:960
    s_mov_b32 s26, 0x4000
    buffer_load_dwordx4 v[64:67], v139, s[12:15], s26 offen
    buffer_load_dwordx4 v[68:71], v139, s[12:15], s26 offen offset:64
    buffer_load_dwordx4 v[72:75], v139, s[12:15], s26 offen offset:128
    buffer_load_dwordx4 v[76:79], v139, s[12:15], s26 offen offset:192
    buffer_load_dwordx4 v[80:83], v139, s[12:15], s26 offen offset:256
    buffer_load_dwordx4 v[84:87], v139, s[12:15], s26 offen offset:320
    buffer_load_dwordx4 v[88:91], v139, s[12:15], s26 offen offset:384
    buffer_load_dwordx4 v[92:95], v139, s[12:15], s26 offen offset:448
    buffer_load_dwordx4 v[96:99], v139, s[12:15], s26 offen offset:512
    buffer_load_dwordx4 v[100:103], v139, s[12:15], s26 offen offset:576
    buffer_load_dwordx4 v[104:107], v139, s[12:15], s26 offen offset:640
    buffer_load_dwordx4 v[108:111], v139, s[12:15], s26 offen offset:704
    buffer_load_dwordx4 v[112:115], v139, s[12:15], s26 offen offset:768
    buffer_load_dwordx4 v[116:119], v139, s[12:15], s26 offen offset:832
    buffer_load_dwordx4 v[120:123], v139, s[12:15], s26 offen offset:896
    buffer_load_dwordx4 v[124:127], v139, s[12:15], s26 offen offset:960
    s_lshr_b32 s26, s21, 1
    s_lshl_b32 s26, s26, 2
    v_or_b32 v148, s26, v145
    v_lshlrev_b32 v148, 1, v148
    v_xor_b32 v148, v148, v146
    v_lshlrev_b32 v148, 4, v148
    s_lshl_b32 s26, s21, 2
    v_add_u32 v147, s26, v145
    v_lshl_add_u32 v136, v147, 13, v148
    v_lshl_add_u32 v147, v145, 3, v149
    v_lshlrev_b32 v147, 8, v147
    v_and_b32 v148, 1, v145
    v_lshl_or_b32 v148, v148, 2, v149
    v_lshl_add_u32 v147, v148, 5, v147
    v_and_b32 v148, 3, v146
    v_lshl_add_u32 v128, v148, 3, v147
    v_xor_b32 v129, 32, v128
    v_xor_b32 v130, 64, v128
    v_xor_b32 v131, 96, v128
    v_xor_b32 v132, 128, v128
    v_xor_b32 v133, 160, v128
    v_xor_b32 v134, 192, v128
    v_xor_b32 v135, 224, v128
    s_mov_b32 s19, 0x20000
    s_mov_b32 s38, s22
    s_mov_b32 s39, s22
    v_mov_b32 v158, 0x3f803f80
    s_lshr_b32 s26, s39, 5
    s_cmp_eq_u32 s26, 0
    s_cselect_b64 s[16:17], s[62:63], s[60:61]
    s_cmp_eq_u32 s26, 1
    s_cselect_b64 s[16:17], s[64:65], s[16:17]
    s_and_b32 s17, s17, 0xffff
    s_cmp_lt_u32 s39, 96
    s_cselect_b32 s18, 0x400000, 0
    s_and_b32 s24, s39, 31
    s_lshl_b32 s24, s24, 8
    s_waitcnt vmcnt(16)
    v_pk_mov_b32 v[150:151], 0, 0
    v_pk_mov_b32 v[152:153], 0, 0
    v_dot2_f32_bf16 v150, v0, v158, v150
    v_dot2_f32_bf16 v152, v0, v0, v152
    v_dot2_f32_bf16 v151, v1, v158, v151
    v_dot2_f32_bf16 v153, v1, v1, v153
    v_dot2_f32_bf16 v150, v2, v158, v150
    v_dot2_f32_bf16 v152, v2, v2, v152
    v_dot2_f32_bf16 v151, v3, v158, v151
    v_dot2_f32_bf16 v153, v3, v3, v153
    v_dot2_f32_bf16 v150, v4, v158, v150
    v_dot2_f32_bf16 v152, v4, v4, v152
    v_dot2_f32_bf16 v151, v5, v158, v151
    v_dot2_f32_bf16 v153, v5, v5, v153
    v_dot2_f32_bf16 v150, v6, v158, v150
    v_dot2_f32_bf16 v152, v6, v6, v152
    v_dot2_f32_bf16 v151, v7, v158, v151
    v_dot2_f32_bf16 v153, v7, v7, v153
    v_dot2_f32_bf16 v150, v8, v158, v150
    v_dot2_f32_bf16 v152, v8, v8, v152
    v_dot2_f32_bf16 v151, v9, v158, v151
    v_dot2_f32_bf16 v153, v9, v9, v153
    v_dot2_f32_bf16 v150, v10, v158, v150
    v_dot2_f32_bf16 v152, v10, v10, v152
    v_dot2_f32_bf16 v151, v11, v158, v151
    v_dot2_f32_bf16 v153, v11, v11, v153
    v_dot2_f32_bf16 v150, v12, v158, v150
    v_dot2_f32_bf16 v152, v12, v12, v152
    v_dot2_f32_bf16 v151, v13, v158, v151
    v_dot2_f32_bf16 v153, v13, v13, v153
    v_dot2_f32_bf16 v150, v14, v158, v150
    v_dot2_f32_bf16 v152, v14, v14, v152
    v_dot2_f32_bf16 v151, v15, v158, v151
    v_dot2_f32_bf16 v153, v15, v15, v153
    v_dot2_f32_bf16 v150, v16, v158, v150
    v_dot2_f32_bf16 v152, v16, v16, v152
    v_dot2_f32_bf16 v151, v17, v158, v151
    v_dot2_f32_bf16 v153, v17, v17, v153
    v_dot2_f32_bf16 v150, v18, v158, v150
    v_dot2_f32_bf16 v152, v18, v18, v152
    v_dot2_f32_bf16 v151, v19, v158, v151
    v_dot2_f32_bf16 v153, v19, v19, v153
    v_dot2_f32_bf16 v150, v20, v158, v150
    v_dot2_f32_bf16 v152, v20, v20, v152
    v_dot2_f32_bf16 v151, v21, v158, v151
    v_dot2_f32_bf16 v153, v21, v21, v153
    v_dot2_f32_bf16 v150, v22, v158, v150
    v_dot2_f32_bf16 v152, v22, v22, v152
    v_dot2_f32_bf16 v151, v23, v158, v151
    v_dot2_f32_bf16 v153, v23, v23, v153
    v_dot2_f32_bf16 v150, v24, v158, v150
    v_dot2_f32_bf16 v152, v24, v24, v152
    v_dot2_f32_bf16 v151, v25, v158, v151
    v_dot2_f32_bf16 v153, v25, v25, v153
    v_dot2_f32_bf16 v150, v26, v158, v150
    v_dot2_f32_bf16 v152, v26, v26, v152
    v_dot2_f32_bf16 v151, v27, v158, v151
    v_dot2_f32_bf16 v153, v27, v27, v153
    v_dot2_f32_bf16 v150, v28, v158, v150
    v_dot2_f32_bf16 v152, v28, v28, v152
    v_dot2_f32_bf16 v151, v29, v158, v151
    v_dot2_f32_bf16 v153, v29, v29, v153
    v_dot2_f32_bf16 v150, v30, v158, v150
    v_dot2_f32_bf16 v152, v30, v30, v152
    v_dot2_f32_bf16 v151, v31, v158, v151
    v_dot2_f32_bf16 v153, v31, v31, v153
    v_dot2_f32_bf16 v150, v32, v158, v150
    v_dot2_f32_bf16 v152, v32, v32, v152
    v_dot2_f32_bf16 v151, v33, v158, v151
    v_dot2_f32_bf16 v153, v33, v33, v153
    v_dot2_f32_bf16 v150, v34, v158, v150
    v_dot2_f32_bf16 v152, v34, v34, v152
    v_dot2_f32_bf16 v151, v35, v158, v151
    v_dot2_f32_bf16 v153, v35, v35, v153
    v_dot2_f32_bf16 v150, v36, v158, v150
    v_dot2_f32_bf16 v152, v36, v36, v152
    v_dot2_f32_bf16 v151, v37, v158, v151
    v_dot2_f32_bf16 v153, v37, v37, v153
    v_dot2_f32_bf16 v150, v38, v158, v150
    v_dot2_f32_bf16 v152, v38, v38, v152
    v_dot2_f32_bf16 v151, v39, v158, v151
    v_dot2_f32_bf16 v153, v39, v39, v153
    v_dot2_f32_bf16 v150, v40, v158, v150
    v_dot2_f32_bf16 v152, v40, v40, v152
    v_dot2_f32_bf16 v151, v41, v158, v151
    v_dot2_f32_bf16 v153, v41, v41, v153
    v_dot2_f32_bf16 v150, v42, v158, v150
    v_dot2_f32_bf16 v152, v42, v42, v152
    v_dot2_f32_bf16 v151, v43, v158, v151
    v_dot2_f32_bf16 v153, v43, v43, v153
    v_dot2_f32_bf16 v150, v44, v158, v150
    v_dot2_f32_bf16 v152, v44, v44, v152
    v_dot2_f32_bf16 v151, v45, v158, v151
    v_dot2_f32_bf16 v153, v45, v45, v153
    v_dot2_f32_bf16 v150, v46, v158, v150
    v_dot2_f32_bf16 v152, v46, v46, v152
    v_dot2_f32_bf16 v151, v47, v158, v151
    v_dot2_f32_bf16 v153, v47, v47, v153
    v_dot2_f32_bf16 v150, v48, v158, v150
    v_dot2_f32_bf16 v152, v48, v48, v152
    v_dot2_f32_bf16 v151, v49, v158, v151
    v_dot2_f32_bf16 v153, v49, v49, v153
    s_add_u32 s26, s24, 0x0
    s_add_u32 m0, s29, 0x0
    s_nop 0
    buffer_load_dwordx4 v136, s[16:19], s26 offen lds
    v_dot2_f32_bf16 v150, v50, v158, v150
    v_dot2_f32_bf16 v152, v50, v50, v152
    v_dot2_f32_bf16 v151, v51, v158, v151
    v_dot2_f32_bf16 v153, v51, v51, v153
    v_dot2_f32_bf16 v150, v52, v158, v150
    v_dot2_f32_bf16 v152, v52, v52, v152
    v_dot2_f32_bf16 v151, v53, v158, v151
    v_dot2_f32_bf16 v153, v53, v53, v153
    v_dot2_f32_bf16 v150, v54, v158, v150
    v_dot2_f32_bf16 v152, v54, v54, v152
    v_dot2_f32_bf16 v151, v55, v158, v151
    v_dot2_f32_bf16 v153, v55, v55, v153
    v_dot2_f32_bf16 v150, v56, v158, v150
    v_dot2_f32_bf16 v152, v56, v56, v152
    v_dot2_f32_bf16 v151, v57, v158, v151
    v_dot2_f32_bf16 v153, v57, v57, v153
    v_dot2_f32_bf16 v150, v58, v158, v150
    v_dot2_f32_bf16 v152, v58, v58, v152
    v_dot2_f32_bf16 v151, v59, v158, v151
    v_dot2_f32_bf16 v153, v59, v59, v153
    v_dot2_f32_bf16 v150, v60, v158, v150
    v_dot2_f32_bf16 v152, v60, v60, v152
    v_dot2_f32_bf16 v151, v61, v158, v151
    v_dot2_f32_bf16 v153, v61, v61, v153
    v_dot2_f32_bf16 v150, v62, v158, v150
    v_dot2_f32_bf16 v152, v62, v62, v152
    v_dot2_f32_bf16 v151, v63, v158, v151
    v_dot2_f32_bf16 v153, v63, v63, v153
    s_nop 1
    v_add_f32 v150, v150, v151
    v_add_f32 v152, v152, v153
    v_mov_b32 v157, v150
    s_nop 1
    v_permlane32_swap_b32 v157, v150
    v_add_f32 v150, v157, v150
    v_mov_b32 v157, v150
    s_nop 1
    v_permlane16_swap_b32 v157, v150
    v_add_f32 v150, v157, v150
    v_mov_b32 v157, v152
    s_nop 1
    v_permlane32_swap_b32 v157, v152
    v_add_f32 v152, v157, v152
    v_mov_b32 v157, v152
    s_nop 1
    v_permlane16_swap_b32 v157, v152
    v_add_f32 v152, v157, v152
    v_mul_f32 v150, 0x3b000000, v150
    v_cvt_pk_bf16_f32 v154, v150, v150
    v_and_b32 v154, 0xffff0000, v154
    v_sub_f32 v156, v150, v154
    v_mul_f32 v157, v150, v150
    v_mul_f32 v152, 0x3b000000, v152
    v_sub_f32 v152, v152, v157
    v_max_f32 v152, 0, v152
    v_cvt_pk_bf16_f32 v152, v152, v152
    v_and_b32 v152, 0xffff0000, v152
    v_add_f32 v152, 0x3727c5ac, v152
    v_cvt_pk_bf16_f32 v152, v152, v152
    v_and_b32 v152, 0xffff0000, v152
    v_sqrt_f32 v152, v152
    s_nop 0
    v_cvt_pk_bf16_f32 v152, v152, v152
    v_and_b32 v152, 0xffff0000, v152
    v_rcp_f32 v152, v152
    v_lshlrev_b32 v160, 16, v0
    v_and_b32 v161, 0xffff0000, v0
    v_lshlrev_b32 v162, 16, v1
    v_and_b32 v163, 0xffff0000, v1
    v_lshlrev_b32 v164, 16, v2
    v_and_b32 v165, 0xffff0000, v2
    v_lshlrev_b32 v166, 16, v3
    v_and_b32 v167, 0xffff0000, v3
    v_lshlrev_b32 v168, 16, v4
    v_and_b32 v169, 0xffff0000, v4
    v_lshlrev_b32 v170, 16, v5
    v_and_b32 v171, 0xffff0000, v5
    v_lshlrev_b32 v172, 16, v6
    v_and_b32 v173, 0xffff0000, v6
    v_lshlrev_b32 v174, 16, v7
    v_and_b32 v175, 0xffff0000, v7
    v_pk_add_f32 v[160:161], v[160:161], v[154:155] op_sel_hi:[1,0] neg_lo:[0,1] neg_hi:[0,1]
    v_pk_add_f32 v[162:163], v[162:163], v[154:155] op_sel_hi:[1,0] neg_lo:[0,1] neg_hi:[0,1]
    v_pk_add_f32 v[164:165], v[164:165], v[154:155] op_sel_hi:[1,0] neg_lo:[0,1] neg_hi:[0,1]
    v_pk_add_f32 v[166:167], v[166:167], v[154:155] op_sel_hi:[1,0] neg_lo:[0,1] neg_hi:[0,1]
    v_pk_add_f32 v[168:169], v[168:169], v[154:155] op_sel_hi:[1,0] neg_lo:[0,1] neg_hi:[0,1]
    v_pk_add_f32 v[170:171], v[170:171], v[154:155] op_sel_hi:[1,0] neg_lo:[0,1] neg_hi:[0,1]
    s_add_u32 s26, s24, 0x20000
    s_add_u32 m0, s29, 0x1000
    s_nop 0
    buffer_load_dwordx4 v136, s[16:19], s26 offen lds
    v_pk_add_f32 v[172:173], v[172:173], v[154:155] op_sel_hi:[1,0] neg_lo:[0,1] neg_hi:[0,1]
    v_pk_add_f32 v[174:175], v[174:175], v[154:155] op_sel_hi:[1,0] neg_lo:[0,1] neg_hi:[0,1]
    v_cvt_pk_bf16_f32 v0, v160, v161
    v_cvt_pk_bf16_f32 v1, v162, v163
    v_cvt_pk_bf16_f32 v2, v164, v165
    v_cvt_pk_bf16_f32 v3, v166, v167
    v_cvt_pk_bf16_f32 v4, v168, v169
    v_cvt_pk_bf16_f32 v5, v170, v171
    v_cvt_pk_bf16_f32 v6, v172, v173
    v_cvt_pk_bf16_f32 v7, v174, v175
    v_lshlrev_b32 v160, 16, v0
    v_and_b32 v161, 0xffff0000, v0
    v_lshlrev_b32 v162, 16, v1
    v_and_b32 v163, 0xffff0000, v1
    v_lshlrev_b32 v164, 16, v2
    v_and_b32 v165, 0xffff0000, v2
    v_lshlrev_b32 v166, 16, v3
    v_and_b32 v167, 0xffff0000, v3
    v_lshlrev_b32 v168, 16, v4
    v_and_b32 v169, 0xffff0000, v4
    v_lshlrev_b32 v170, 16, v5
    v_and_b32 v171, 0xffff0000, v5
    v_lshlrev_b32 v172, 16, v6
    v_and_b32 v173, 0xffff0000, v6
    v_lshlrev_b32 v174, 16, v7
    v_and_b32 v175, 0xffff0000, v7
    v_pk_mul_f32 v[160:161], v[160:161], v[152:153] op_sel_hi:[1,0]
    v_pk_mul_f32 v[162:163], v[162:163], v[152:153] op_sel_hi:[1,0]
    v_pk_mul_f32 v[164:165], v[164:165], v[152:153] op_sel_hi:[1,0]
    v_pk_mul_f32 v[166:167], v[166:167], v[152:153] op_sel_hi:[1,0]
    v_pk_mul_f32 v[168:169], v[168:169], v[152:153] op_sel_hi:[1,0]
    v_pk_mul_f32 v[170:171], v[170:171], v[152:153] op_sel_hi:[1,0]
    v_pk_mul_f32 v[172:173], v[172:173], v[152:153] op_sel_hi:[1,0]
    v_pk_mul_f32 v[174:175], v[174:175], v[152:153] op_sel_hi:[1,0]
    v_cvt_pk_bf16_f32 v160, v160, v161
    v_cvt_pk_bf16_f32 v162, v162, v163
    v_cvt_pk_bf16_f32 v164, v164, v165
    v_cvt_pk_bf16_f32 v166, v166, v167
    v_cvt_pk_bf16_f32 v168, v168, v169
    v_cvt_pk_bf16_f32 v170, v170, v171
    v_cvt_pk_bf16_f32 v172, v172, v173
    v_cvt_pk_bf16_f32 v174, v174, v175
    v_accvgpr_write_b32 a0, v160
    v_accvgpr_write_b32 a1, v162
    v_accvgpr_write_b32 a2, v164
    v_accvgpr_write_b32 a3, v166
    v_accvgpr_write_b32 a4, v168
    v_accvgpr_write_b32 a5, v170
    v_accvgpr_write_b32 a6, v172
    v_accvgpr_write_b32 a7, v174
    s_add_u32 s26, s24, 0x40000
    s_add_u32 m0, s29, 0x2000
    s_nop 0
    buffer_load_dwordx4 v136, s[16:19], s26 offen lds
    v_lshlrev_b32 v160, 16, v8
    v_and_b32 v161, 0xffff0000, v8
    v_lshlrev_b32 v162, 16, v9
    v_and_b32 v163, 0xffff0000, v9
    v_lshlrev_b32 v164, 16, v10
    v_and_b32 v165, 0xffff0000, v10
    v_lshlrev_b32 v166, 16, v11
    v_and_b32 v167, 0xffff0000, v11
    v_lshlrev_b32 v168, 16, v12
    v_and_b32 v169, 0xffff0000, v12
    v_lshlrev_b32 v170, 16, v13
    v_and_b32 v171, 0xffff0000, v13
    v_lshlrev_b32 v172, 16, v14
    v_and_b32 v173, 0xffff0000, v14
    v_lshlrev_b32 v174, 16, v15
    v_and_b32 v175, 0xffff0000, v15
    v_pk_add_f32 v[160:161], v[160:161], v[154:155] op_sel_hi:[1,0] neg_lo:[0,1] neg_hi:[0,1]
    v_pk_add_f32 v[162:163], v[162:163], v[154:155] op_sel_hi:[1,0] neg_lo:[0,1] neg_hi:[0,1]
    v_pk_add_f32 v[164:165], v[164:165], v[154:155] op_sel_hi:[1,0] neg_lo:[0,1] neg_hi:[0,1]
    v_pk_add_f32 v[166:167], v[166:167], v[154:155] op_sel_hi:[1,0] neg_lo:[0,1] neg_hi:[0,1]
    v_pk_add_f32 v[168:169], v[168:169], v[154:155] op_sel_hi:[1,0] neg_lo:[0,1] neg_hi:[0,1]
    v_pk_add_f32 v[170:171], v[170:171], v[154:155] op_sel_hi:[1,0] neg_lo:[0,1] neg_hi:[0,1]
    v_pk_add_f32 v[172:173], v[172:173], v[154:155] op_sel_hi:[1,0] neg_lo:[0,1] neg_hi:[0,1]
    v_pk_add_f32 v[174:175], v[174:175], v[154:155] op_sel_hi:[1,0] neg_lo:[0,1] neg_hi:[0,1]
    v_cvt_pk_bf16_f32 v8, v160, v161
    v_cvt_pk_bf16_f32 v9, v162, v163
    v_cvt_pk_bf16_f32 v10, v164, v165
    v_cvt_pk_bf16_f32 v11, v166, v167
    v_cvt_pk_bf16_f32 v12, v168, v169
    v_cvt_pk_bf16_f32 v13, v170, v171
    v_cvt_pk_bf16_f32 v14, v172, v173
    v_cvt_pk_bf16_f32 v15, v174, v175
    v_lshlrev_b32 v160, 16, v8
    v_and_b32 v161, 0xffff0000, v8
    v_lshlrev_b32 v162, 16, v9
    v_and_b32 v163, 0xffff0000, v9
    v_lshlrev_b32 v164, 16, v10
    v_and_b32 v165, 0xffff0000, v10
    v_lshlrev_b32 v166, 16, v11
    v_and_b32 v167, 0xffff0000, v11
    v_lshlrev_b32 v168, 16, v12
    v_and_b32 v169, 0xffff0000, v12
    v_lshlrev_b32 v170, 16, v13
    v_and_b32 v171, 0xffff0000, v13
    v_lshlrev_b32 v172, 16, v14
    v_and_b32 v173, 0xffff0000, v14
    v_lshlrev_b32 v174, 16, v15
    v_and_b32 v175, 0xffff0000, v15
    v_pk_mul_f32 v[160:161], v[160:161], v[152:153] op_sel_hi:[1,0]
    v_pk_mul_f32 v[162:163], v[162:163], v[152:153] op_sel_hi:[1,0]
    s_add_u32 s26, s24, 0x60000
    s_add_u32 m0, s29, 0x3000
    s_nop 0
    buffer_load_dwordx4 v136, s[16:19], s26 offen lds
    v_pk_mul_f32 v[164:165], v[164:165], v[152:153] op_sel_hi:[1,0]
    v_pk_mul_f32 v[166:167], v[166:167], v[152:153] op_sel_hi:[1,0]
    v_pk_mul_f32 v[168:169], v[168:169], v[152:153] op_sel_hi:[1,0]
    v_pk_mul_f32 v[170:171], v[170:171], v[152:153] op_sel_hi:[1,0]
    v_pk_mul_f32 v[172:173], v[172:173], v[152:153] op_sel_hi:[1,0]
    v_pk_mul_f32 v[174:175], v[174:175], v[152:153] op_sel_hi:[1,0]
    v_cvt_pk_bf16_f32 v160, v160, v161
    v_cvt_pk_bf16_f32 v162, v162, v163
    v_cvt_pk_bf16_f32 v164, v164, v165
    v_cvt_pk_bf16_f32 v166, v166, v167
    v_cvt_pk_bf16_f32 v168, v168, v169
    v_cvt_pk_bf16_f32 v170, v170, v171
    v_cvt_pk_bf16_f32 v172, v172, v173
    v_cvt_pk_bf16_f32 v174, v174, v175
    v_accvgpr_write_b32 a8, v160
    v_accvgpr_write_b32 a9, v162
    v_accvgpr_write_b32 a10, v164
    v_accvgpr_write_b32 a11, v166
    v_accvgpr_write_b32 a12, v168
    v_accvgpr_write_b32 a13, v170
    v_accvgpr_write_b32 a14, v172
    v_accvgpr_write_b32 a15, v174
    v_lshlrev_b32 v160, 16, v16
    v_and_b32 v161, 0xffff0000, v16
    v_lshlrev_b32 v162, 16, v17
    v_and_b32 v163, 0xffff0000, v17
    v_lshlrev_b32 v164, 16, v18
    v_and_b32 v165, 0xffff0000, v18
    v_lshlrev_b32 v166, 16, v19
    v_and_b32 v167, 0xffff0000, v19
    v_lshlrev_b32 v168, 16, v20
    v_and_b32 v169, 0xffff0000, v20
    v_lshlrev_b32 v170, 16, v21
    v_and_b32 v171, 0xffff0000, v21
    v_lshlrev_b32 v172, 16, v22
    v_and_b32 v173, 0xffff0000, v22
    v_lshlrev_b32 v174, 16, v23
    v_and_b32 v175, 0xffff0000, v23
    v_pk_add_f32 v[160:161], v[160:161], v[154:155] op_sel_hi:[1,0] neg_lo:[0,1] neg_hi:[0,1]
    v_pk_add_f32 v[162:163], v[162:163], v[154:155] op_sel_hi:[1,0] neg_lo:[0,1] neg_hi:[0,1]
    v_pk_add_f32 v[164:165], v[164:165], v[154:155] op_sel_hi:[1,0] neg_lo:[0,1] neg_hi:[0,1]
    v_pk_add_f32 v[166:167], v[166:167], v[154:155] op_sel_hi:[1,0] neg_lo:[0,1] neg_hi:[0,1]
    v_pk_add_f32 v[168:169], v[168:169], v[154:155] op_sel_hi:[1,0] neg_lo:[0,1] neg_hi:[0,1]
    v_pk_add_f32 v[170:171], v[170:171], v[154:155] op_sel_hi:[1,0] neg_lo:[0,1] neg_hi:[0,1]
    v_pk_add_f32 v[172:173], v[172:173], v[154:155] op_sel_hi:[1,0] neg_lo:[0,1] neg_hi:[0,1]
    v_pk_add_f32 v[174:175], v[174:175], v[154:155] op_sel_hi:[1,0] neg_lo:[0,1] neg_hi:[0,1]
    v_cvt_pk_bf16_f32 v16, v160, v161
    v_cvt_pk_bf16_f32 v17, v162, v163
    v_cvt_pk_bf16_f32 v18, v164, v165
    v_cvt_pk_bf16_f32 v19, v166, v167
    s_add_u32 s26, s24, 0x80000
    s_add_u32 m0, s29, 0x4000
    s_nop 0
    buffer_load_dwordx4 v136, s[16:19], s26 offen lds
    v_cvt_pk_bf16_f32 v20, v168, v169
    v_cvt_pk_bf16_f32 v21, v170, v171
    v_cvt_pk_bf16_f32 v22, v172, v173
    v_cvt_pk_bf16_f32 v23, v174, v175
    v_lshlrev_b32 v160, 16, v16
    v_and_b32 v161, 0xffff0000, v16
    v_lshlrev_b32 v162, 16, v17
    v_and_b32 v163, 0xffff0000, v17
    v_lshlrev_b32 v164, 16, v18
    v_and_b32 v165, 0xffff0000, v18
    v_lshlrev_b32 v166, 16, v19
    v_and_b32 v167, 0xffff0000, v19
    v_lshlrev_b32 v168, 16, v20
    v_and_b32 v169, 0xffff0000, v20
    v_lshlrev_b32 v170, 16, v21
    v_and_b32 v171, 0xffff0000, v21
    v_lshlrev_b32 v172, 16, v22
    v_and_b32 v173, 0xffff0000, v22
    v_lshlrev_b32 v174, 16, v23
    v_and_b32 v175, 0xffff0000, v23
    v_pk_mul_f32 v[160:161], v[160:161], v[152:153] op_sel_hi:[1,0]
    v_pk_mul_f32 v[162:163], v[162:163], v[152:153] op_sel_hi:[1,0]
    v_pk_mul_f32 v[164:165], v[164:165], v[152:153] op_sel_hi:[1,0]
    v_pk_mul_f32 v[166:167], v[166:167], v[152:153] op_sel_hi:[1,0]
    v_pk_mul_f32 v[168:169], v[168:169], v[152:153] op_sel_hi:[1,0]
    v_pk_mul_f32 v[170:171], v[170:171], v[152:153] op_sel_hi:[1,0]
    v_pk_mul_f32 v[172:173], v[172:173], v[152:153] op_sel_hi:[1,0]
    v_pk_mul_f32 v[174:175], v[174:175], v[152:153] op_sel_hi:[1,0]
    v_cvt_pk_bf16_f32 v160, v160, v161
    v_cvt_pk_bf16_f32 v162, v162, v163
    v_cvt_pk_bf16_f32 v164, v164, v165
    v_cvt_pk_bf16_f32 v166, v166, v167
    v_cvt_pk_bf16_f32 v168, v168, v169
    v_cvt_pk_bf16_f32 v170, v170, v171
    v_cvt_pk_bf16_f32 v172, v172, v173
    v_cvt_pk_bf16_f32 v174, v174, v175
    v_accvgpr_write_b32 a16, v160
    v_accvgpr_write_b32 a17, v162
    v_accvgpr_write_b32 a18, v164
    v_accvgpr_write_b32 a19, v166
    v_accvgpr_write_b32 a20, v168
    v_accvgpr_write_b32 a21, v170
    v_accvgpr_write_b32 a22, v172
    v_accvgpr_write_b32 a23, v174
    v_lshlrev_b32 v160, 16, v24
    v_and_b32 v161, 0xffff0000, v24
    v_lshlrev_b32 v162, 16, v25
    v_and_b32 v163, 0xffff0000, v25
    v_lshlrev_b32 v164, 16, v26
    v_and_b32 v165, 0xffff0000, v26
    s_add_u32 s26, s24, 0xa0000
    s_add_u32 m0, s29, 0x5000
    s_nop 0
    buffer_load_dwordx4 v136, s[16:19], s26 offen lds
    v_lshlrev_b32 v166, 16, v27
    v_and_b32 v167, 0xffff0000, v27
    v_lshlrev_b32 v168, 16, v28
    v_and_b32 v169, 0xffff0000, v28
    v_lshlrev_b32 v170, 16, v29
    v_and_b32 v171, 0xffff0000, v29
    v_lshlrev_b32 v172, 16, v30
    v_and_b32 v173, 0xffff0000, v30
    v_lshlrev_b32 v174, 16, v31
    v_and_b32 v175, 0xffff0000, v31
    v_pk_add_f32 v[160:161], v[160:161], v[154:155] op_sel_hi:[1,0] neg_lo:[0,1] neg_hi:[0,1]
    v_pk_add_f32 v[162:163], v[162:163], v[154:155] op_sel_hi:[1,0] neg_lo:[0,1] neg_hi:[0,1]
    v_pk_add_f32 v[164:165], v[164:165], v[154:155] op_sel_hi:[1,0] neg_lo:[0,1] neg_hi:[0,1]
    v_pk_add_f32 v[166:167], v[166:167], v[154:155] op_sel_hi:[1,0] neg_lo:[0,1] neg_hi:[0,1]
    v_pk_add_f32 v[168:169], v[168:169], v[154:155] op_sel_hi:[1,0] neg_lo:[0,1] neg_hi:[0,1]
    v_pk_add_f32 v[170:171], v[170:171], v[154:155] op_sel_hi:[1,0] neg_lo:[0,1] neg_hi:[0,1]
    v_pk_add_f32 v[172:173], v[172:173], v[154:155] op_sel_hi:[1,0] neg_lo:[0,1] neg_hi:[0,1]
    v_pk_add_f32 v[174:175], v[174:175], v[154:155] op_sel_hi:[1,0] neg_lo:[0,1] neg_hi:[0,1]
    v_cvt_pk_bf16_f32 v24, v160, v161
    v_cvt_pk_bf16_f32 v25, v162, v163
    v_cvt_pk_bf16_f32 v26, v164, v165
    v_cvt_pk_bf16_f32 v27, v166, v167
    v_cvt_pk_bf16_f32 v28, v168, v169
    v_cvt_pk_bf16_f32 v29, v170, v171
    v_cvt_pk_bf16_f32 v30, v172, v173
    v_cvt_pk_bf16_f32 v31, v174, v175
    v_lshlrev_b32 v160, 16, v24
    v_and_b32 v161, 0xffff0000, v24
    v_lshlrev_b32 v162, 16, v25
    v_and_b32 v163, 0xffff0000, v25
    v_lshlrev_b32 v164, 16, v26
    v_and_b32 v165, 0xffff0000, v26
    v_lshlrev_b32 v166, 16, v27
    v_and_b32 v167, 0xffff0000, v27
    v_lshlrev_b32 v168, 16, v28
    v_and_b32 v169, 0xffff0000, v28
    v_lshlrev_b32 v170, 16, v29
    v_and_b32 v171, 0xffff0000, v29
    v_lshlrev_b32 v172, 16, v30
    v_and_b32 v173, 0xffff0000, v30
    v_lshlrev_b32 v174, 16, v31
    v_and_b32 v175, 0xffff0000, v31
    v_pk_mul_f32 v[160:161], v[160:161], v[152:153] op_sel_hi:[1,0]
    v_pk_mul_f32 v[162:163], v[162:163], v[152:153] op_sel_hi:[1,0]
    v_pk_mul_f32 v[164:165], v[164:165], v[152:153] op_sel_hi:[1,0]
    v_pk_mul_f32 v[166:167], v[166:167], v[152:153] op_sel_hi:[1,0]
    v_pk_mul_f32 v[168:169], v[168:169], v[152:153] op_sel_hi:[1,0]
    v_pk_mul_f32 v[170:171], v[170:171], v[152:153] op_sel_hi:[1,0]
    v_pk_mul_f32 v[172:173], v[172:173], v[152:153] op_sel_hi:[1,0]
    v_pk_mul_f32 v[174:175], v[174:175], v[152:153] op_sel_hi:[1,0]
    s_add_u32 s26, s24, 0xc0000
    s_add_u32 m0, s29, 0x6000
    s_nop 0
    buffer_load_dwordx4 v136, s[16:19], s26 offen lds
    v_cvt_pk_bf16_f32 v160, v160, v161
    v_cvt_pk_bf16_f32 v162, v162, v163
    v_cvt_pk_bf16_f32 v164, v164, v165
    v_cvt_pk_bf16_f32 v166, v166, v167
    v_cvt_pk_bf16_f32 v168, v168, v169
    v_cvt_pk_bf16_f32 v170, v170, v171
    v_cvt_pk_bf16_f32 v172, v172, v173
    v_cvt_pk_bf16_f32 v174, v174, v175
    v_accvgpr_write_b32 a24, v160
    v_accvgpr_write_b32 a25, v162
    v_accvgpr_write_b32 a26, v164
    v_accvgpr_write_b32 a27, v166
    v_accvgpr_write_b32 a28, v168
    v_accvgpr_write_b32 a29, v170
    v_accvgpr_write_b32 a30, v172
    v_accvgpr_write_b32 a31, v174
    v_lshlrev_b32 v160, 16, v32
    v_and_b32 v161, 0xffff0000, v32
    v_lshlrev_b32 v162, 16, v33
    v_and_b32 v163, 0xffff0000, v33
    v_lshlrev_b32 v164, 16, v34
    v_and_b32 v165, 0xffff0000, v34
    v_lshlrev_b32 v166, 16, v35
    v_and_b32 v167, 0xffff0000, v35
    v_lshlrev_b32 v168, 16, v36
    v_and_b32 v169, 0xffff0000, v36
    v_lshlrev_b32 v170, 16, v37
    v_and_b32 v171, 0xffff0000, v37
    v_lshlrev_b32 v172, 16, v38
    v_and_b32 v173, 0xffff0000, v38
    v_lshlrev_b32 v174, 16, v39
    v_and_b32 v175, 0xffff0000, v39
    v_pk_add_f32 v[160:161], v[160:161], v[154:155] op_sel_hi:[1,0] neg_lo:[0,1] neg_hi:[0,1]
    v_pk_add_f32 v[162:163], v[162:163], v[154:155] op_sel_hi:[1,0] neg_lo:[0,1] neg_hi:[0,1]
    v_pk_add_f32 v[164:165], v[164:165], v[154:155] op_sel_hi:[1,0] neg_lo:[0,1] neg_hi:[0,1]
    v_pk_add_f32 v[166:167], v[166:167], v[154:155] op_sel_hi:[1,0] neg_lo:[0,1] neg_hi:[0,1]
    v_pk_add_f32 v[168:169], v[168:169], v[154:155] op_sel_hi:[1,0] neg_lo:[0,1] neg_hi:[0,1]
    v_pk_add_f32 v[170:171], v[170:171], v[154:155] op_sel_hi:[1,0] neg_lo:[0,1] neg_hi:[0,1]
    v_pk_add_f32 v[172:173], v[172:173], v[154:155] op_sel_hi:[1,0] neg_lo:[0,1] neg_hi:[0,1]
    v_pk_add_f32 v[174:175], v[174:175], v[154:155] op_sel_hi:[1,0] neg_lo:[0,1] neg_hi:[0,1]
    v_cvt_pk_bf16_f32 v32, v160, v161
    v_cvt_pk_bf16_f32 v33, v162, v163
    v_cvt_pk_bf16_f32 v34, v164, v165
    v_cvt_pk_bf16_f32 v35, v166, v167
    v_cvt_pk_bf16_f32 v36, v168, v169
    v_cvt_pk_bf16_f32 v37, v170, v171
    v_cvt_pk_bf16_f32 v38, v172, v173
    v_cvt_pk_bf16_f32 v39, v174, v175
    v_lshlrev_b32 v160, 16, v32
    v_and_b32 v161, 0xffff0000, v32
    s_add_u32 s26, s24, 0xe0000
    s_add_u32 m0, s29, 0x7000
    s_nop 0
    buffer_load_dwordx4 v136, s[16:19], s26 offen lds
    v_lshlrev_b32 v162, 16, v33
    v_and_b32 v163, 0xffff0000, v33
    v_lshlrev_b32 v164, 16, v34
    v_and_b32 v165, 0xffff0000, v34
    v_lshlrev_b32 v166, 16, v35
    v_and_b32 v167, 0xffff0000, v35
    v_lshlrev_b32 v168, 16, v36
    v_and_b32 v169, 0xffff0000, v36
    v_lshlrev_b32 v170, 16, v37
    v_and_b32 v171, 0xffff0000, v37
    v_lshlrev_b32 v172, 16, v38
    v_and_b32 v173, 0xffff0000, v38
    v_lshlrev_b32 v174, 16, v39
    v_and_b32 v175, 0xffff0000, v39
    v_pk_mul_f32 v[160:161], v[160:161], v[152:153] op_sel_hi:[1,0]
    v_pk_mul_f32 v[162:163], v[162:163], v[152:153] op_sel_hi:[1,0]
    v_pk_mul_f32 v[164:165], v[164:165], v[152:153] op_sel_hi:[1,0]
    v_pk_mul_f32 v[166:167], v[166:167], v[152:153] op_sel_hi:[1,0]
    v_pk_mul_f32 v[168:169], v[168:169], v[152:153] op_sel_hi:[1,0]
    v_pk_mul_f32 v[170:171], v[170:171], v[152:153] op_sel_hi:[1,0]
    v_pk_mul_f32 v[172:173], v[172:173], v[152:153] op_sel_hi:[1,0]
    v_pk_mul_f32 v[174:175], v[174:175], v[152:153] op_sel_hi:[1,0]
    v_cvt_pk_bf16_f32 v160, v160, v161
    v_cvt_pk_bf16_f32 v162, v162, v163
    v_cvt_pk_bf16_f32 v164, v164, v165
    v_cvt_pk_bf16_f32 v166, v166, v167
    v_cvt_pk_bf16_f32 v168, v168, v169
    v_cvt_pk_bf16_f32 v170, v170, v171
    v_cvt_pk_bf16_f32 v172, v172, v173
    v_cvt_pk_bf16_f32 v174, v174, v175
    v_accvgpr_write_b32 a32, v160
    v_accvgpr_write_b32 a33, v162
    v_accvgpr_write_b32 a34, v164
    v_accvgpr_write_b32 a35, v166
    v_accvgpr_write_b32 a36, v168
    v_accvgpr_write_b32 a37, v170
    v_accvgpr_write_b32 a38, v172
    v_accvgpr_write_b32 a39, v174
    v_lshlrev_b32 v160, 16, v40
    v_and_b32 v161, 0xffff0000, v40
    v_lshlrev_b32 v162, 16, v41
    v_and_b32 v163, 0xffff0000, v41
    v_lshlrev_b32 v164, 16, v42
    v_and_b32 v165, 0xffff0000, v42
    v_lshlrev_b32 v166, 16, v43
    v_and_b32 v167, 0xffff0000, v43
    v_lshlrev_b32 v168, 16, v44
    v_and_b32 v169, 0xffff0000, v44
    v_lshlrev_b32 v170, 16, v45
    v_and_b32 v171, 0xffff0000, v45
    s_add_u32 s26, s24, 0x100000
    s_add_u32 m0, s29, 0x8000
    s_nop 0
    buffer_load_dwordx4 v136, s[16:19], s26 offen lds
    v_lshlrev_b32 v172, 16, v46
    v_and_b32 v173, 0xffff0000, v46
    v_lshlrev_b32 v174, 16, v47
    v_and_b32 v175, 0xffff0000, v47
    v_pk_add_f32 v[160:161], v[160:161], v[154:155] op_sel_hi:[1,0] neg_lo:[0,1] neg_hi:[0,1]
    v_pk_add_f32 v[162:163], v[162:163], v[154:155] op_sel_hi:[1,0] neg_lo:[0,1] neg_hi:[0,1]
    v_pk_add_f32 v[164:165], v[164:165], v[154:155] op_sel_hi:[1,0] neg_lo:[0,1] neg_hi:[0,1]
    v_pk_add_f32 v[166:167], v[166:167], v[154:155] op_sel_hi:[1,0] neg_lo:[0,1] neg_hi:[0,1]
    v_pk_add_f32 v[168:169], v[168:169], v[154:155] op_sel_hi:[1,0] neg_lo:[0,1] neg_hi:[0,1]
    v_pk_add_f32 v[170:171], v[170:171], v[154:155] op_sel_hi:[1,0] neg_lo:[0,1] neg_hi:[0,1]
    v_pk_add_f32 v[172:173], v[172:173], v[154:155] op_sel_hi:[1,0] neg_lo:[0,1] neg_hi:[0,1]
    v_pk_add_f32 v[174:175], v[174:175], v[154:155] op_sel_hi:[1,0] neg_lo:[0,1] neg_hi:[0,1]
    v_cvt_pk_bf16_f32 v40, v160, v161
    v_cvt_pk_bf16_f32 v41, v162, v163
    v_cvt_pk_bf16_f32 v42, v164, v165
    v_cvt_pk_bf16_f32 v43, v166, v167
    v_cvt_pk_bf16_f32 v44, v168, v169
    v_cvt_pk_bf16_f32 v45, v170, v171
    v_cvt_pk_bf16_f32 v46, v172, v173
    v_cvt_pk_bf16_f32 v47, v174, v175
    v_lshlrev_b32 v160, 16, v40
    v_and_b32 v161, 0xffff0000, v40
    v_lshlrev_b32 v162, 16, v41
    v_and_b32 v163, 0xffff0000, v41
    v_lshlrev_b32 v164, 16, v42
    v_and_b32 v165, 0xffff0000, v42
    v_lshlrev_b32 v166, 16, v43
    v_and_b32 v167, 0xffff0000, v43
    v_lshlrev_b32 v168, 16, v44
    v_and_b32 v169, 0xffff0000, v44
    v_lshlrev_b32 v170, 16, v45
    v_and_b32 v171, 0xffff0000, v45
    v_lshlrev_b32 v172, 16, v46
    v_and_b32 v173, 0xffff0000, v46
    v_lshlrev_b32 v174, 16, v47
    v_and_b32 v175, 0xffff0000, v47
    v_pk_mul_f32 v[160:161], v[160:161], v[152:153] op_sel_hi:[1,0]
    v_pk_mul_f32 v[162:163], v[162:163], v[152:153] op_sel_hi:[1,0]
    v_pk_mul_f32 v[164:165], v[164:165], v[152:153] op_sel_hi:[1,0]
    v_pk_mul_f32 v[166:167], v[166:167], v[152:153] op_sel_hi:[1,0]
    v_pk_mul_f32 v[168:169], v[168:169], v[152:153] op_sel_hi:[1,0]
    v_pk_mul_f32 v[170:171], v[170:171], v[152:153] op_sel_hi:[1,0]
    v_pk_mul_f32 v[172:173], v[172:173], v[152:153] op_sel_hi:[1,0]
    v_pk_mul_f32 v[174:175], v[174:175], v[152:153] op_sel_hi:[1,0]
    v_cvt_pk_bf16_f32 v160, v160, v161
    v_cvt_pk_bf16_f32 v162, v162, v163
    v_cvt_pk_bf16_f32 v164, v164, v165
    v_cvt_pk_bf16_f32 v166, v166, v167
    v_cvt_pk_bf16_f32 v168, v168, v169
    v_cvt_pk_bf16_f32 v170, v170, v171
    s_add_u32 s26, s24, 0x120000
    s_add_u32 m0, s29, 0x9000
    s_nop 0
    buffer_load_dwordx4 v136, s[16:19], s26 offen lds
    v_cvt_pk_bf16_f32 v172, v172, v173
    v_cvt_pk_bf16_f32 v174, v174, v175
    v_accvgpr_write_b32 a40, v160
    v_accvgpr_write_b32 a41, v162
    v_accvgpr_write_b32 a42, v164
    v_accvgpr_write_b32 a43, v166
    v_accvgpr_write_b32 a44, v168
    v_accvgpr_write_b32 a45, v170
    v_accvgpr_write_b32 a46, v172
    v_accvgpr_write_b32 a47, v174
    v_lshlrev_b32 v160, 16, v48
    v_and_b32 v161, 0xffff0000, v48
    v_lshlrev_b32 v162, 16, v49
    v_and_b32 v163, 0xffff0000, v49
    v_lshlrev_b32 v164, 16, v50
    v_and_b32 v165, 0xffff0000, v50
    v_lshlrev_b32 v166, 16, v51
    v_and_b32 v167, 0xffff0000, v51
    v_lshlrev_b32 v168, 16, v52
    v_and_b32 v169, 0xffff0000, v52
    v_lshlrev_b32 v170, 16, v53
    v_and_b32 v171, 0xffff0000, v53
    v_lshlrev_b32 v172, 16, v54
    v_and_b32 v173, 0xffff0000, v54
    v_lshlrev_b32 v174, 16, v55
    v_and_b32 v175, 0xffff0000, v55
    v_pk_add_f32 v[160:161], v[160:161], v[154:155] op_sel_hi:[1,0] neg_lo:[0,1] neg_hi:[0,1]
    v_pk_add_f32 v[162:163], v[162:163], v[154:155] op_sel_hi:[1,0] neg_lo:[0,1] neg_hi:[0,1]
    v_pk_add_f32 v[164:165], v[164:165], v[154:155] op_sel_hi:[1,0] neg_lo:[0,1] neg_hi:[0,1]
    v_pk_add_f32 v[166:167], v[166:167], v[154:155] op_sel_hi:[1,0] neg_lo:[0,1] neg_hi:[0,1]
    v_pk_add_f32 v[168:169], v[168:169], v[154:155] op_sel_hi:[1,0] neg_lo:[0,1] neg_hi:[0,1]
    v_pk_add_f32 v[170:171], v[170:171], v[154:155] op_sel_hi:[1,0] neg_lo:[0,1] neg_hi:[0,1]
    v_pk_add_f32 v[172:173], v[172:173], v[154:155] op_sel_hi:[1,0] neg_lo:[0,1] neg_hi:[0,1]
    v_pk_add_f32 v[174:175], v[174:175], v[154:155] op_sel_hi:[1,0] neg_lo:[0,1] neg_hi:[0,1]
    v_cvt_pk_bf16_f32 v48, v160, v161
    v_cvt_pk_bf16_f32 v49, v162, v163
    v_cvt_pk_bf16_f32 v50, v164, v165
    v_cvt_pk_bf16_f32 v51, v166, v167
    v_cvt_pk_bf16_f32 v52, v168, v169
    v_cvt_pk_bf16_f32 v53, v170, v171
    v_cvt_pk_bf16_f32 v54, v172, v173
    v_cvt_pk_bf16_f32 v55, v174, v175
    v_lshlrev_b32 v160, 16, v48
    v_and_b32 v161, 0xffff0000, v48
    v_lshlrev_b32 v162, 16, v49
    v_and_b32 v163, 0xffff0000, v49
    v_lshlrev_b32 v164, 16, v50
    v_and_b32 v165, 0xffff0000, v50
    v_lshlrev_b32 v166, 16, v51
    v_and_b32 v167, 0xffff0000, v51
    s_add_u32 s26, s24, 0x140000
    s_add_u32 m0, s29, 0xa000
    s_nop 0
    buffer_load_dwordx4 v136, s[16:19], s26 offen lds
    v_lshlrev_b32 v168, 16, v52
    v_and_b32 v169, 0xffff0000, v52
    v_lshlrev_b32 v170, 16, v53
    v_and_b32 v171, 0xffff0000, v53
    v_lshlrev_b32 v172, 16, v54
    v_and_b32 v173, 0xffff0000, v54
    v_lshlrev_b32 v174, 16, v55
    v_and_b32 v175, 0xffff0000, v55
    v_pk_mul_f32 v[160:161], v[160:161], v[152:153] op_sel_hi:[1,0]
    v_pk_mul_f32 v[162:163], v[162:163], v[152:153] op_sel_hi:[1,0]
    v_pk_mul_f32 v[164:165], v[164:165], v[152:153] op_sel_hi:[1,0]
    v_pk_mul_f32 v[166:167], v[166:167], v[152:153] op_sel_hi:[1,0]
    v_pk_mul_f32 v[168:169], v[168:169], v[152:153] op_sel_hi:[1,0]
    v_pk_mul_f32 v[170:171], v[170:171], v[152:153] op_sel_hi:[1,0]
    v_pk_mul_f32 v[172:173], v[172:173], v[152:153] op_sel_hi:[1,0]
    v_pk_mul_f32 v[174:175], v[174:175], v[152:153] op_sel_hi:[1,0]
    v_cvt_pk_bf16_f32 v160, v160, v161
    v_cvt_pk_bf16_f32 v162, v162, v163
    v_cvt_pk_bf16_f32 v164, v164, v165
    v_cvt_pk_bf16_f32 v166, v166, v167
    v_cvt_pk_bf16_f32 v168, v168, v169
    v_cvt_pk_bf16_f32 v170, v170, v171
    v_cvt_pk_bf16_f32 v172, v172, v173
    v_cvt_pk_bf16_f32 v174, v174, v175
    v_accvgpr_write_b32 a48, v160
    v_accvgpr_write_b32 a49, v162
    v_accvgpr_write_b32 a50, v164
    v_accvgpr_write_b32 a51, v166
    v_accvgpr_write_b32 a52, v168
    v_accvgpr_write_b32 a53, v170
    v_accvgpr_write_b32 a54, v172
    v_accvgpr_write_b32 a55, v174
    v_lshlrev_b32 v160, 16, v56
    v_and_b32 v161, 0xffff0000, v56
    v_lshlrev_b32 v162, 16, v57
    v_and_b32 v163, 0xffff0000, v57
    v_lshlrev_b32 v164, 16, v58
    v_and_b32 v165, 0xffff0000, v58
    v_lshlrev_b32 v166, 16, v59
    v_and_b32 v167, 0xffff0000, v59
    v_lshlrev_b32 v168, 16, v60
    v_and_b32 v169, 0xffff0000, v60
    v_lshlrev_b32 v170, 16, v61
    v_and_b32 v171, 0xffff0000, v61
    v_lshlrev_b32 v172, 16, v62
    v_and_b32 v173, 0xffff0000, v62
    v_lshlrev_b32 v174, 16, v63
    v_and_b32 v175, 0xffff0000, v63
    v_pk_add_f32 v[160:161], v[160:161], v[154:155] op_sel_hi:[1,0] neg_lo:[0,1] neg_hi:[0,1]
    v_pk_add_f32 v[162:163], v[162:163], v[154:155] op_sel_hi:[1,0] neg_lo:[0,1] neg_hi:[0,1]
    s_add_u32 s26, s24, 0x160000
    s_add_u32 m0, s29, 0xb000
    s_nop 0
    buffer_load_dwordx4 v136, s[16:19], s26 offen lds
    v_pk_add_f32 v[164:165], v[164:165], v[154:155] op_sel_hi:[1,0] neg_lo:[0,1] neg_hi:[0,1]
    v_pk_add_f32 v[166:167], v[166:167], v[154:155] op_sel_hi:[1,0] neg_lo:[0,1] neg_hi:[0,1]
    v_pk_add_f32 v[168:169], v[168:169], v[154:155] op_sel_hi:[1,0] neg_lo:[0,1] neg_hi:[0,1]
    v_pk_add_f32 v[170:171], v[170:171], v[154:155] op_sel_hi:[1,0] neg_lo:[0,1] neg_hi:[0,1]
    v_pk_add_f32 v[172:173], v[172:173], v[154:155] op_sel_hi:[1,0] neg_lo:[0,1] neg_hi:[0,1]
    v_pk_add_f32 v[174:175], v[174:175], v[154:155] op_sel_hi:[1,0] neg_lo:[0,1] neg_hi:[0,1]
    v_cvt_pk_bf16_f32 v56, v160, v161
    v_cvt_pk_bf16_f32 v57, v162, v163
    v_cvt_pk_bf16_f32 v58, v164, v165
    v_cvt_pk_bf16_f32 v59, v166, v167
    v_cvt_pk_bf16_f32 v60, v168, v169
    v_cvt_pk_bf16_f32 v61, v170, v171
    v_cvt_pk_bf16_f32 v62, v172, v173
    v_cvt_pk_bf16_f32 v63, v174, v175
    v_lshlrev_b32 v160, 16, v56
    v_and_b32 v161, 0xffff0000, v56
    v_lshlrev_b32 v162, 16, v57
    v_and_b32 v163, 0xffff0000, v57
    v_lshlrev_b32 v164, 16, v58
    v_and_b32 v165, 0xffff0000, v58
    v_lshlrev_b32 v166, 16, v59
    v_and_b32 v167, 0xffff0000, v59
    v_lshlrev_b32 v168, 16, v60
    v_and_b32 v169, 0xffff0000, v60
    v_lshlrev_b32 v170, 16, v61
    v_and_b32 v171, 0xffff0000, v61
    v_lshlrev_b32 v172, 16, v62
    v_and_b32 v173, 0xffff0000, v62
    v_lshlrev_b32 v174, 16, v63
    v_and_b32 v175, 0xffff0000, v63
    v_pk_mul_f32 v[160:161], v[160:161], v[152:153] op_sel_hi:[1,0]
    v_pk_mul_f32 v[162:163], v[162:163], v[152:153] op_sel_hi:[1,0]
    v_pk_mul_f32 v[164:165], v[164:165], v[152:153] op_sel_hi:[1,0]
    v_pk_mul_f32 v[166:167], v[166:167], v[152:153] op_sel_hi:[1,0]
    v_pk_mul_f32 v[168:169], v[168:169], v[152:153] op_sel_hi:[1,0]
    v_pk_mul_f32 v[170:171], v[170:171], v[152:153] op_sel_hi:[1,0]
    v_pk_mul_f32 v[172:173], v[172:173], v[152:153] op_sel_hi:[1,0]
    v_pk_mul_f32 v[174:175], v[174:175], v[152:153] op_sel_hi:[1,0]
    v_cvt_pk_bf16_f32 v160, v160, v161
    v_cvt_pk_bf16_f32 v162, v162, v163
    v_cvt_pk_bf16_f32 v164, v164, v165
    v_cvt_pk_bf16_f32 v166, v166, v167
    v_cvt_pk_bf16_f32 v168, v168, v169
    v_cvt_pk_bf16_f32 v170, v170, v171
    v_cvt_pk_bf16_f32 v172, v172, v173
    v_cvt_pk_bf16_f32 v174, v174, v175
    v_accvgpr_write_b32 a56, v160
    v_accvgpr_write_b32 a57, v162
    v_accvgpr_write_b32 a58, v164
    v_accvgpr_write_b32 a59, v166
    s_add_u32 s26, s24, 0x180000
    s_add_u32 m0, s29, 0xc000
    s_nop 0
    buffer_load_dwordx4 v136, s[16:19], s26 offen lds
    v_accvgpr_write_b32 a60, v168
    v_accvgpr_write_b32 a61, v170
    v_accvgpr_write_b32 a62, v172
    v_accvgpr_write_b32 a63, v174
    s_waitcnt vmcnt(13)
    v_pk_mov_b32 v[150:151], 0, 0
    v_pk_mov_b32 v[152:153], 0, 0
    v_dot2_f32_bf16 v150, v64, v158, v150
    v_dot2_f32_bf16 v152, v64, v64, v152
    v_dot2_f32_bf16 v151, v65, v158, v151
    v_dot2_f32_bf16 v153, v65, v65, v153
    v_dot2_f32_bf16 v150, v66, v158, v150
    v_dot2_f32_bf16 v152, v66, v66, v152
    v_dot2_f32_bf16 v151, v67, v158, v151
    v_dot2_f32_bf16 v153, v67, v67, v153
    v_dot2_f32_bf16 v150, v68, v158, v150
    v_dot2_f32_bf16 v152, v68, v68, v152
    v_dot2_f32_bf16 v151, v69, v158, v151
    v_dot2_f32_bf16 v153, v69, v69, v153
    v_dot2_f32_bf16 v150, v70, v158, v150
    v_dot2_f32_bf16 v152, v70, v70, v152
    v_dot2_f32_bf16 v151, v71, v158, v151
    v_dot2_f32_bf16 v153, v71, v71, v153
    v_dot2_f32_bf16 v150, v72, v158, v150
    v_dot2_f32_bf16 v152, v72, v72, v152
    v_dot2_f32_bf16 v151, v73, v158, v151
    v_dot2_f32_bf16 v153, v73, v73, v153
    v_dot2_f32_bf16 v150, v74, v158, v150
    v_dot2_f32_bf16 v152, v74, v74, v152
    v_dot2_f32_bf16 v151, v75, v158, v151
    v_dot2_f32_bf16 v153, v75, v75, v153
    v_dot2_f32_bf16 v150, v76, v158, v150
    v_dot2_f32_bf16 v152, v76, v76, v152
    v_dot2_f32_bf16 v151, v77, v158, v151
    v_dot2_f32_bf16 v153, v77, v77, v153
    v_dot2_f32_bf16 v150, v78, v158, v150
    v_dot2_f32_bf16 v152, v78, v78, v152
    v_dot2_f32_bf16 v151, v79, v158, v151
    v_dot2_f32_bf16 v153, v79, v79, v153
    v_dot2_f32_bf16 v150, v80, v158, v150
    v_dot2_f32_bf16 v152, v80, v80, v152
    v_dot2_f32_bf16 v151, v81, v158, v151
    v_dot2_f32_bf16 v153, v81, v81, v153
    v_dot2_f32_bf16 v150, v82, v158, v150
    v_dot2_f32_bf16 v152, v82, v82, v152
    v_dot2_f32_bf16 v151, v83, v158, v151
    v_dot2_f32_bf16 v153, v83, v83, v153
    v_dot2_f32_bf16 v150, v84, v158, v150
    v_dot2_f32_bf16 v152, v84, v84, v152
    v_dot2_f32_bf16 v151, v85, v158, v151
    v_dot2_f32_bf16 v153, v85, v85, v153
    v_dot2_f32_bf16 v150, v86, v158, v150
    v_dot2_f32_bf16 v152, v86, v86, v152
    s_add_u32 s26, s24, 0x1a0000
    s_add_u32 m0, s29, 0xd000
    s_nop 0
    buffer_load_dwordx4 v136, s[16:19], s26 offen lds
    v_dot2_f32_bf16 v151, v87, v158, v151
    v_dot2_f32_bf16 v153, v87, v87, v153
    v_dot2_f32_bf16 v150, v88, v158, v150
    v_dot2_f32_bf16 v152, v88, v88, v152
    v_dot2_f32_bf16 v151, v89, v158, v151
    v_dot2_f32_bf16 v153, v89, v89, v153
    v_dot2_f32_bf16 v150, v90, v158, v150
    v_dot2_f32_bf16 v152, v90, v90, v152
    v_dot2_f32_bf16 v151, v91, v158, v151
    v_dot2_f32_bf16 v153, v91, v91, v153
    v_dot2_f32_bf16 v150, v92, v158, v150
    v_dot2_f32_bf16 v152, v92, v92, v152
    v_dot2_f32_bf16 v151, v93, v158, v151
    v_dot2_f32_bf16 v153, v93, v93, v153
    v_dot2_f32_bf16 v150, v94, v158, v150
    v_dot2_f32_bf16 v152, v94, v94, v152
    v_dot2_f32_bf16 v151, v95, v158, v151
    v_dot2_f32_bf16 v153, v95, v95, v153
    v_dot2_f32_bf16 v150, v96, v158, v150
    v_dot2_f32_bf16 v152, v96, v96, v152
    v_dot2_f32_bf16 v151, v97, v158, v151
    v_dot2_f32_bf16 v153, v97, v97, v153
    v_dot2_f32_bf16 v150, v98, v158, v150
    v_dot2_f32_bf16 v152, v98, v98, v152
    v_dot2_f32_bf16 v151, v99, v158, v151
    v_dot2_f32_bf16 v153, v99, v99, v153
    v_dot2_f32_bf16 v150, v100, v158, v150
    v_dot2_f32_bf16 v152, v100, v100, v152
    v_dot2_f32_bf16 v151, v101, v158, v151
    v_dot2_f32_bf16 v153, v101, v101, v153
    v_dot2_f32_bf16 v150, v102, v158, v150
    v_dot2_f32_bf16 v152, v102, v102, v152
    v_dot2_f32_bf16 v151, v103, v158, v151
    v_dot2_f32_bf16 v153, v103, v103, v153
    v_dot2_f32_bf16 v150, v104, v158, v150
    v_dot2_f32_bf16 v152, v104, v104, v152
    v_dot2_f32_bf16 v151, v105, v158, v151
    v_dot2_f32_bf16 v153, v105, v105, v153
    v_dot2_f32_bf16 v150, v106, v158, v150
    v_dot2_f32_bf16 v152, v106, v106, v152
    v_dot2_f32_bf16 v151, v107, v158, v151
    v_dot2_f32_bf16 v153, v107, v107, v153
    v_dot2_f32_bf16 v150, v108, v158, v150
    v_dot2_f32_bf16 v152, v108, v108, v152
    v_dot2_f32_bf16 v151, v109, v158, v151
    v_dot2_f32_bf16 v153, v109, v109, v153
    v_dot2_f32_bf16 v150, v110, v158, v150
    v_dot2_f32_bf16 v152, v110, v110, v152
    v_dot2_f32_bf16 v151, v111, v158, v151
    v_dot2_f32_bf16 v153, v111, v111, v153
    s_add_u32 s26, s24, 0x1c0000
    s_add_u32 m0, s29, 0xe000
    s_nop 0
    buffer_load_dwordx4 v136, s[16:19], s26 offen lds
    v_dot2_f32_bf16 v150, v112, v158, v150
    v_dot2_f32_bf16 v152, v112, v112, v152
    v_dot2_f32_bf16 v151, v113, v158, v151
    v_dot2_f32_bf16 v153, v113, v113, v153
    v_dot2_f32_bf16 v150, v114, v158, v150
    v_dot2_f32_bf16 v152, v114, v114, v152
    v_dot2_f32_bf16 v151, v115, v158, v151
    v_dot2_f32_bf16 v153, v115, v115, v153
    v_dot2_f32_bf16 v150, v116, v158, v150
    v_dot2_f32_bf16 v152, v116, v116, v152
    v_dot2_f32_bf16 v151, v117, v158, v151
    v_dot2_f32_bf16 v153, v117, v117, v153
    v_dot2_f32_bf16 v150, v118, v158, v150
    v_dot2_f32_bf16 v152, v118, v118, v152
    v_dot2_f32_bf16 v151, v119, v158, v151
    v_dot2_f32_bf16 v153, v119, v119, v153
    v_dot2_f32_bf16 v150, v120, v158, v150
    v_dot2_f32_bf16 v152, v120, v120, v152
    v_dot2_f32_bf16 v151, v121, v158, v151
    v_dot2_f32_bf16 v153, v121, v121, v153
    v_dot2_f32_bf16 v150, v122, v158, v150
    v_dot2_f32_bf16 v152, v122, v122, v152
    v_dot2_f32_bf16 v151, v123, v158, v151
    v_dot2_f32_bf16 v153, v123, v123, v153
    v_dot2_f32_bf16 v150, v124, v158, v150
    v_dot2_f32_bf16 v152, v124, v124, v152
    v_dot2_f32_bf16 v151, v125, v158, v151
    v_dot2_f32_bf16 v153, v125, v125, v153
    v_dot2_f32_bf16 v150, v126, v158, v150
    v_dot2_f32_bf16 v152, v126, v126, v152
    v_dot2_f32_bf16 v151, v127, v158, v151
    v_dot2_f32_bf16 v153, v127, v127, v153
    s_nop 1
    v_add_f32 v150, v150, v151
    v_add_f32 v152, v152, v153
    v_mov_b32 v157, v150
    s_nop 1
    v_permlane32_swap_b32 v157, v150
    v_add_f32 v150, v157, v150
    v_mov_b32 v157, v150
    s_nop 1
    v_permlane16_swap_b32 v157, v150
    v_add_f32 v150, v157, v150
    v_mov_b32 v157, v152
    s_nop 1
    v_permlane32_swap_b32 v157, v152
    v_add_f32 v152, v157, v152
    v_mov_b32 v157, v152
    s_nop 1
    v_permlane16_swap_b32 v157, v152
    v_add_f32 v152, v157, v152
    v_mul_f32 v150, 0x3b000000, v150
    v_cvt_pk_bf16_f32 v154, v150, v150
    v_and_b32 v154, 0xffff0000, v154
    v_sub_f32 v156, v150, v154
    v_mul_f32 v157, v150, v150
    v_mul_f32 v152, 0x3b000000, v152
    v_sub_f32 v152, v152, v157
    v_max_f32 v152, 0, v152
    v_cvt_pk_bf16_f32 v152, v152, v152
    v_and_b32 v152, 0xffff0000, v152
    v_add_f32 v152, 0x3727c5ac, v152
    v_cvt_pk_bf16_f32 v152, v152, v152
    v_and_b32 v152, 0xffff0000, v152
    v_sqrt_f32 v152, v152
    s_nop 0
    v_cvt_pk_bf16_f32 v152, v152, v152
    v_and_b32 v152, 0xffff0000, v152
    v_rcp_f32 v152, v152
    v_lshlrev_b32 v160, 16, v64
    v_and_b32 v161, 0xffff0000, v64
    v_lshlrev_b32 v162, 16, v65
    v_and_b32 v163, 0xffff0000, v65
    v_lshlrev_b32 v164, 16, v66
    v_and_b32 v165, 0xffff0000, v66
    v_lshlrev_b32 v166, 16, v67
    v_and_b32 v167, 0xffff0000, v67
    v_lshlrev_b32 v168, 16, v68
    v_and_b32 v169, 0xffff0000, v68
    v_lshlrev_b32 v170, 16, v69
    v_and_b32 v171, 0xffff0000, v69
    v_lshlrev_b32 v172, 16, v70
    v_and_b32 v173, 0xffff0000, v70
    v_lshlrev_b32 v174, 16, v71
    v_and_b32 v175, 0xffff0000, v71
    v_pk_add_f32 v[160:161], v[160:161], v[154:155] op_sel_hi:[1,0] neg_lo:[0,1] neg_hi:[0,1]
    v_pk_add_f32 v[162:163], v[162:163], v[154:155] op_sel_hi:[1,0] neg_lo:[0,1] neg_hi:[0,1]
    s_add_u32 s26, s24, 0x1e0000
    s_add_u32 m0, s29, 0xf000
    s_nop 0
    buffer_load_dwordx4 v136, s[16:19], s26 offen lds
    v_pk_add_f32 v[164:165], v[164:165], v[154:155] op_sel_hi:[1,0] neg_lo:[0,1] neg_hi:[0,1]
    v_pk_add_f32 v[166:167], v[166:167], v[154:155] op_sel_hi:[1,0] neg_lo:[0,1] neg_hi:[0,1]
    v_pk_add_f32 v[168:169], v[168:169], v[154:155] op_sel_hi:[1,0] neg_lo:[0,1] neg_hi:[0,1]
    v_pk_add_f32 v[170:171], v[170:171], v[154:155] op_sel_hi:[1,0] neg_lo:[0,1] neg_hi:[0,1]
    v_pk_add_f32 v[172:173], v[172:173], v[154:155] op_sel_hi:[1,0] neg_lo:[0,1] neg_hi:[0,1]
    v_pk_add_f32 v[174:175], v[174:175], v[154:155] op_sel_hi:[1,0] neg_lo:[0,1] neg_hi:[0,1]
    v_cvt_pk_bf16_f32 v64, v160, v161
    v_cvt_pk_bf16_f32 v65, v162, v163
    v_cvt_pk_bf16_f32 v66, v164, v165
    v_cvt_pk_bf16_f32 v67, v166, v167
    v_cvt_pk_bf16_f32 v68, v168, v169
    v_cvt_pk_bf16_f32 v69, v170, v171
    v_cvt_pk_bf16_f32 v70, v172, v173
    v_cvt_pk_bf16_f32 v71, v174, v175
    v_lshlrev_b32 v160, 16, v64
    v_and_b32 v161, 0xffff0000, v64
    v_lshlrev_b32 v162, 16, v65
    v_and_b32 v163, 0xffff0000, v65
    v_lshlrev_b32 v164, 16, v66
    v_and_b32 v165, 0xffff0000, v66
    v_lshlrev_b32 v166, 16, v67
    v_and_b32 v167, 0xffff0000, v67
    v_lshlrev_b32 v168, 16, v68
    v_and_b32 v169, 0xffff0000, v68
    v_lshlrev_b32 v170, 16, v69
    v_and_b32 v171, 0xffff0000, v69
    v_lshlrev_b32 v172, 16, v70
    v_and_b32 v173, 0xffff0000, v70
    v_lshlrev_b32 v174, 16, v71
    v_and_b32 v175, 0xffff0000, v71
    v_pk_mul_f32 v[160:161], v[160:161], v[152:153] op_sel_hi:[1,0]
    v_pk_mul_f32 v[162:163], v[162:163], v[152:153] op_sel_hi:[1,0]
    v_pk_mul_f32 v[164:165], v[164:165], v[152:153] op_sel_hi:[1,0]
    v_pk_mul_f32 v[166:167], v[166:167], v[152:153] op_sel_hi:[1,0]
    v_pk_mul_f32 v[168:169], v[168:169], v[152:153] op_sel_hi:[1,0]
    v_pk_mul_f32 v[170:171], v[170:171], v[152:153] op_sel_hi:[1,0]
    v_pk_mul_f32 v[172:173], v[172:173], v[152:153] op_sel_hi:[1,0]
    v_pk_mul_f32 v[174:175], v[174:175], v[152:153] op_sel_hi:[1,0]
    v_cvt_pk_bf16_f32 v160, v160, v161
    v_cvt_pk_bf16_f32 v162, v162, v163
    v_cvt_pk_bf16_f32 v164, v164, v165
    v_cvt_pk_bf16_f32 v166, v166, v167
    v_cvt_pk_bf16_f32 v168, v168, v169
    v_cvt_pk_bf16_f32 v170, v170, v171
    v_cvt_pk_bf16_f32 v172, v172, v173
    v_cvt_pk_bf16_f32 v174, v174, v175
    v_accvgpr_write_b32 a64, v160
    v_accvgpr_write_b32 a65, v162
    v_accvgpr_write_b32 a66, v164
    v_accvgpr_write_b32 a67, v166
    s_add_u32 s26, s24, 0x200000
    s_add_u32 m0, s29, 0x10000
    s_nop 0
    buffer_load_dwordx4 v136, s[16:19], s26 offen lds
    v_accvgpr_write_b32 a68, v168
    v_accvgpr_write_b32 a69, v170
    v_accvgpr_write_b32 a70, v172
    v_accvgpr_write_b32 a71, v174
    v_lshlrev_b32 v160, 16, v72
    v_and_b32 v161, 0xffff0000, v72
    v_lshlrev_b32 v162, 16, v73
    v_and_b32 v163, 0xffff0000, v73
    v_lshlrev_b32 v164, 16, v74
    v_and_b32 v165, 0xffff0000, v74
    v_lshlrev_b32 v166, 16, v75
    v_and_b32 v167, 0xffff0000, v75
    v_lshlrev_b32 v168, 16, v76
    v_and_b32 v169, 0xffff0000, v76
    v_lshlrev_b32 v170, 16, v77
    v_and_b32 v171, 0xffff0000, v77
    v_lshlrev_b32 v172, 16, v78
    v_and_b32 v173, 0xffff0000, v78
    v_lshlrev_b32 v174, 16, v79
    v_and_b32 v175, 0xffff0000, v79
    v_pk_add_f32 v[160:161], v[160:161], v[154:155] op_sel_hi:[1,0] neg_lo:[0,1] neg_hi:[0,1]
    v_pk_add_f32 v[162:163], v[162:163], v[154:155] op_sel_hi:[1,0] neg_lo:[0,1] neg_hi:[0,1]
    v_pk_add_f32 v[164:165], v[164:165], v[154:155] op_sel_hi:[1,0] neg_lo:[0,1] neg_hi:[0,1]
    v_pk_add_f32 v[166:167], v[166:167], v[154:155] op_sel_hi:[1,0] neg_lo:[0,1] neg_hi:[0,1]
    v_pk_add_f32 v[168:169], v[168:169], v[154:155] op_sel_hi:[1,0] neg_lo:[0,1] neg_hi:[0,1]
    v_pk_add_f32 v[170:171], v[170:171], v[154:155] op_sel_hi:[1,0] neg_lo:[0,1] neg_hi:[0,1]
    v_pk_add_f32 v[172:173], v[172:173], v[154:155] op_sel_hi:[1,0] neg_lo:[0,1] neg_hi:[0,1]
    v_pk_add_f32 v[174:175], v[174:175], v[154:155] op_sel_hi:[1,0] neg_lo:[0,1] neg_hi:[0,1]
    v_cvt_pk_bf16_f32 v72, v160, v161
    v_cvt_pk_bf16_f32 v73, v162, v163
    v_cvt_pk_bf16_f32 v74, v164, v165
    v_cvt_pk_bf16_f32 v75, v166, v167
    v_cvt_pk_bf16_f32 v76, v168, v169
    v_cvt_pk_bf16_f32 v77, v170, v171
    v_cvt_pk_bf16_f32 v78, v172, v173
    v_cvt_pk_bf16_f32 v79, v174, v175
    v_lshlrev_b32 v160, 16, v72
    v_and_b32 v161, 0xffff0000, v72
    v_lshlrev_b32 v162, 16, v73
    v_and_b32 v163, 0xffff0000, v73
    v_lshlrev_b32 v164, 16, v74
    v_and_b32 v165, 0xffff0000, v74
    v_lshlrev_b32 v166, 16, v75
    v_and_b32 v167, 0xffff0000, v75
    v_lshlrev_b32 v168, 16, v76
    v_and_b32 v169, 0xffff0000, v76
    v_lshlrev_b32 v170, 16, v77
    v_and_b32 v171, 0xffff0000, v77
    v_lshlrev_b32 v172, 16, v78
    v_and_b32 v173, 0xffff0000, v78
    s_add_u32 s26, s24, 0x220000
    s_add_u32 m0, s29, 0x11000
    s_nop 0
    buffer_load_dwordx4 v136, s[16:19], s26 offen lds
    v_lshlrev_b32 v174, 16, v79
    v_and_b32 v175, 0xffff0000, v79
    v_pk_mul_f32 v[160:161], v[160:161], v[152:153] op_sel_hi:[1,0]
    v_pk_mul_f32 v[162:163], v[162:163], v[152:153] op_sel_hi:[1,0]
    v_pk_mul_f32 v[164:165], v[164:165], v[152:153] op_sel_hi:[1,0]
    v_pk_mul_f32 v[166:167], v[166:167], v[152:153] op_sel_hi:[1,0]
    v_pk_mul_f32 v[168:169], v[168:169], v[152:153] op_sel_hi:[1,0]
    v_pk_mul_f32 v[170:171], v[170:171], v[152:153] op_sel_hi:[1,0]
    v_pk_mul_f32 v[172:173], v[172:173], v[152:153] op_sel_hi:[1,0]
    v_pk_mul_f32 v[174:175], v[174:175], v[152:153] op_sel_hi:[1,0]
    v_cvt_pk_bf16_f32 v160, v160, v161
    v_cvt_pk_bf16_f32 v162, v162, v163
    v_cvt_pk_bf16_f32 v164, v164, v165
    v_cvt_pk_bf16_f32 v166, v166, v167
    v_cvt_pk_bf16_f32 v168, v168, v169
    v_cvt_pk_bf16_f32 v170, v170, v171
    v_cvt_pk_bf16_f32 v172, v172, v173
    v_cvt_pk_bf16_f32 v174, v174, v175
    v_accvgpr_write_b32 a72, v160
    v_accvgpr_write_b32 a73, v162
    v_accvgpr_write_b32 a74, v164
    v_accvgpr_write_b32 a75, v166
    v_accvgpr_write_b32 a76, v168
    v_accvgpr_write_b32 a77, v170
    v_accvgpr_write_b32 a78, v172
    v_accvgpr_write_b32 a79, v174
    v_lshlrev_b32 v160, 16, v80
    v_and_b32 v161, 0xffff0000, v80
    v_lshlrev_b32 v162, 16, v81
    v_and_b32 v163, 0xffff0000, v81
    v_lshlrev_b32 v164, 16, v82
    v_and_b32 v165, 0xffff0000, v82
    v_lshlrev_b32 v166, 16, v83
    v_and_b32 v167, 0xffff0000, v83
    v_lshlrev_b32 v168, 16, v84
    v_and_b32 v169, 0xffff0000, v84
    v_lshlrev_b32 v170, 16, v85
    v_and_b32 v171, 0xffff0000, v85
    v_lshlrev_b32 v172, 16, v86
    v_and_b32 v173, 0xffff0000, v86
    v_lshlrev_b32 v174, 16, v87
    v_and_b32 v175, 0xffff0000, v87
    v_pk_add_f32 v[160:161], v[160:161], v[154:155] op_sel_hi:[1,0] neg_lo:[0,1] neg_hi:[0,1]
    v_pk_add_f32 v[162:163], v[162:163], v[154:155] op_sel_hi:[1,0] neg_lo:[0,1] neg_hi:[0,1]
    v_pk_add_f32 v[164:165], v[164:165], v[154:155] op_sel_hi:[1,0] neg_lo:[0,1] neg_hi:[0,1]
    v_pk_add_f32 v[166:167], v[166:167], v[154:155] op_sel_hi:[1,0] neg_lo:[0,1] neg_hi:[0,1]
    v_pk_add_f32 v[168:169], v[168:169], v[154:155] op_sel_hi:[1,0] neg_lo:[0,1] neg_hi:[0,1]
    v_pk_add_f32 v[170:171], v[170:171], v[154:155] op_sel_hi:[1,0] neg_lo:[0,1] neg_hi:[0,1]
    v_pk_add_f32 v[172:173], v[172:173], v[154:155] op_sel_hi:[1,0] neg_lo:[0,1] neg_hi:[0,1]
    v_pk_add_f32 v[174:175], v[174:175], v[154:155] op_sel_hi:[1,0] neg_lo:[0,1] neg_hi:[0,1]
    s_add_u32 s26, s24, 0x240000
    s_add_u32 m0, s29, 0x12000
    s_nop 0
    buffer_load_dwordx4 v136, s[16:19], s26 offen lds
    v_cvt_pk_bf16_f32 v80, v160, v161
    v_cvt_pk_bf16_f32 v81, v162, v163
    v_cvt_pk_bf16_f32 v82, v164, v165
    v_cvt_pk_bf16_f32 v83, v166, v167
    v_cvt_pk_bf16_f32 v84, v168, v169
    v_cvt_pk_bf16_f32 v85, v170, v171
    v_cvt_pk_bf16_f32 v86, v172, v173
    v_cvt_pk_bf16_f32 v87, v174, v175
    v_lshlrev_b32 v160, 16, v80
    v_and_b32 v161, 0xffff0000, v80
    v_lshlrev_b32 v162, 16, v81
    v_and_b32 v163, 0xffff0000, v81
    v_lshlrev_b32 v164, 16, v82
    v_and_b32 v165, 0xffff0000, v82
    v_lshlrev_b32 v166, 16, v83
    v_and_b32 v167, 0xffff0000, v83
    v_lshlrev_b32 v168, 16, v84
    v_and_b32 v169, 0xffff0000, v84
    v_lshlrev_b32 v170, 16, v85
    v_and_b32 v171, 0xffff0000, v85
    v_lshlrev_b32 v172, 16, v86
    v_and_b32 v173, 0xffff0000, v86
    v_lshlrev_b32 v174, 16, v87
    v_and_b32 v175, 0xffff0000, v87
    v_pk_mul_f32 v[160:161], v[160:161], v[152:153] op_sel_hi:[1,0]
    v_pk_mul_f32 v[162:163], v[162:163], v[152:153] op_sel_hi:[1,0]
    v_pk_mul_f32 v[164:165], v[164:165], v[152:153] op_sel_hi:[1,0]
    v_pk_mul_f32 v[166:167], v[166:167], v[152:153] op_sel_hi:[1,0]
    v_pk_mul_f32 v[168:169], v[168:169], v[152:153] op_sel_hi:[1,0]
    v_pk_mul_f32 v[170:171], v[170:171], v[152:153] op_sel_hi:[1,0]
    v_pk_mul_f32 v[172:173], v[172:173], v[152:153] op_sel_hi:[1,0]
    v_pk_mul_f32 v[174:175], v[174:175], v[152:153] op_sel_hi:[1,0]
    v_cvt_pk_bf16_f32 v160, v160, v161
    v_cvt_pk_bf16_f32 v162, v162, v163
    v_cvt_pk_bf16_f32 v164, v164, v165
    v_cvt_pk_bf16_f32 v166, v166, v167
    v_cvt_pk_bf16_f32 v168, v168, v169
    v_cvt_pk_bf16_f32 v170, v170, v171
    v_cvt_pk_bf16_f32 v172, v172, v173
    v_cvt_pk_bf16_f32 v174, v174, v175
    v_accvgpr_write_b32 a80, v160
    v_accvgpr_write_b32 a81, v162
    v_accvgpr_write_b32 a82, v164
    v_accvgpr_write_b32 a83, v166
    v_accvgpr_write_b32 a84, v168
    v_accvgpr_write_b32 a85, v170
    v_accvgpr_write_b32 a86, v172
    v_accvgpr_write_b32 a87, v174
    v_lshlrev_b32 v160, 16, v88
    v_and_b32 v161, 0xffff0000, v88
    s_add_u32 s26, s24, 0x260000
    s_add_u32 m0, s29, 0x13000
    s_nop 0
    buffer_load_dwordx4 v136, s[16:19], s26 offen lds
    v_lshlrev_b32 v162, 16, v89
    v_and_b32 v163, 0xffff0000, v89
    v_lshlrev_b32 v164, 16, v90
    v_and_b32 v165, 0xffff0000, v90
    v_lshlrev_b32 v166, 16, v91
    v_and_b32 v167, 0xffff0000, v91
    v_lshlrev_b32 v168, 16, v92
    v_and_b32 v169, 0xffff0000, v92
    v_lshlrev_b32 v170, 16, v93
    v_and_b32 v171, 0xffff0000, v93
    v_lshlrev_b32 v172, 16, v94
    v_and_b32 v173, 0xffff0000, v94
    v_lshlrev_b32 v174, 16, v95
    v_and_b32 v175, 0xffff0000, v95
    v_pk_add_f32 v[160:161], v[160:161], v[154:155] op_sel_hi:[1,0] neg_lo:[0,1] neg_hi:[0,1]
    v_pk_add_f32 v[162:163], v[162:163], v[154:155] op_sel_hi:[1,0] neg_lo:[0,1] neg_hi:[0,1]
    v_pk_add_f32 v[164:165], v[164:165], v[154:155] op_sel_hi:[1,0] neg_lo:[0,1] neg_hi:[0,1]
    v_pk_add_f32 v[166:167], v[166:167], v[154:155] op_sel_hi:[1,0] neg_lo:[0,1] neg_hi:[0,1]
    v_pk_add_f32 v[168:169], v[168:169], v[154:155] op_sel_hi:[1,0] neg_lo:[0,1] neg_hi:[0,1]
    v_pk_add_f32 v[170:171], v[170:171], v[154:155] op_sel_hi:[1,0] neg_lo:[0,1] neg_hi:[0,1]
    v_pk_add_f32 v[172:173], v[172:173], v[154:155] op_sel_hi:[1,0] neg_lo:[0,1] neg_hi:[0,1]
    v_pk_add_f32 v[174:175], v[174:175], v[154:155] op_sel_hi:[1,0] neg_lo:[0,1] neg_hi:[0,1]
    v_cvt_pk_bf16_f32 v88, v160, v161
    v_cvt_pk_bf16_f32 v89, v162, v163
    v_cvt_pk_bf16_f32 v90, v164, v165
    v_cvt_pk_bf16_f32 v91, v166, v167
    v_cvt_pk_bf16_f32 v92, v168, v169
    v_cvt_pk_bf16_f32 v93, v170, v171
    v_cvt_pk_bf16_f32 v94, v172, v173
    v_cvt_pk_bf16_f32 v95, v174, v175
    v_lshlrev_b32 v160, 16, v88
    v_and_b32 v161, 0xffff0000, v88
    v_lshlrev_b32 v162, 16, v89
    v_and_b32 v163, 0xffff0000, v89
    v_lshlrev_b32 v164, 16, v90
    v_and_b32 v165, 0xffff0000, v90
    v_lshlrev_b32 v166, 16, v91
    v_and_b32 v167, 0xffff0000, v91
    v_lshlrev_b32 v168, 16, v92
    v_and_b32 v169, 0xffff0000, v92
    v_lshlrev_b32 v170, 16, v93
    v_and_b32 v171, 0xffff0000, v93
    v_lshlrev_b32 v172, 16, v94
    v_and_b32 v173, 0xffff0000, v94
    v_lshlrev_b32 v174, 16, v95
    v_and_b32 v175, 0xffff0000, v95
    v_pk_mul_f32 v[160:161], v[160:161], v[152:153] op_sel_hi:[1,0]
    v_pk_mul_f32 v[162:163], v[162:163], v[152:153] op_sel_hi:[1,0]
    v_pk_mul_f32 v[164:165], v[164:165], v[152:153] op_sel_hi:[1,0]
    v_pk_mul_f32 v[166:167], v[166:167], v[152:153] op_sel_hi:[1,0]
    s_add_u32 s26, s24, 0x280000
    s_add_u32 m0, s29, 0x14000
    s_nop 0
    buffer_load_dwordx4 v136, s[16:19], s26 offen lds
    v_pk_mul_f32 v[168:169], v[168:169], v[152:153] op_sel_hi:[1,0]
    v_pk_mul_f32 v[170:171], v[170:171], v[152:153] op_sel_hi:[1,0]
    v_pk_mul_f32 v[172:173], v[172:173], v[152:153] op_sel_hi:[1,0]
    v_pk_mul_f32 v[174:175], v[174:175], v[152:153] op_sel_hi:[1,0]
    v_cvt_pk_bf16_f32 v160, v160, v161
    v_cvt_pk_bf16_f32 v162, v162, v163
    v_cvt_pk_bf16_f32 v164, v164, v165
    v_cvt_pk_bf16_f32 v166, v166, v167
    v_cvt_pk_bf16_f32 v168, v168, v169
    v_cvt_pk_bf16_f32 v170, v170, v171
    v_cvt_pk_bf16_f32 v172, v172, v173
    v_cvt_pk_bf16_f32 v174, v174, v175
    v_accvgpr_write_b32 a88, v160
    v_accvgpr_write_b32 a89, v162
    v_accvgpr_write_b32 a90, v164
    v_accvgpr_write_b32 a91, v166
    v_accvgpr_write_b32 a92, v168
    v_accvgpr_write_b32 a93, v170
    v_accvgpr_write_b32 a94, v172
    v_accvgpr_write_b32 a95, v174
    v_lshlrev_b32 v160, 16, v96
    v_and_b32 v161, 0xffff0000, v96
    v_lshlrev_b32 v162, 16, v97
    v_and_b32 v163, 0xffff0000, v97
    v_lshlrev_b32 v164, 16, v98
    v_and_b32 v165, 0xffff0000, v98
    v_lshlrev_b32 v166, 16, v99
    v_and_b32 v167, 0xffff0000, v99
    v_lshlrev_b32 v168, 16, v100
    v_and_b32 v169, 0xffff0000, v100
    v_lshlrev_b32 v170, 16, v101
    v_and_b32 v171, 0xffff0000, v101
    v_lshlrev_b32 v172, 16, v102
    v_and_b32 v173, 0xffff0000, v102
    v_lshlrev_b32 v174, 16, v103
    v_and_b32 v175, 0xffff0000, v103
    v_pk_add_f32 v[160:161], v[160:161], v[154:155] op_sel_hi:[1,0] neg_lo:[0,1] neg_hi:[0,1]
    v_pk_add_f32 v[162:163], v[162:163], v[154:155] op_sel_hi:[1,0] neg_lo:[0,1] neg_hi:[0,1]
    v_pk_add_f32 v[164:165], v[164:165], v[154:155] op_sel_hi:[1,0] neg_lo:[0,1] neg_hi:[0,1]
    v_pk_add_f32 v[166:167], v[166:167], v[154:155] op_sel_hi:[1,0] neg_lo:[0,1] neg_hi:[0,1]
    v_pk_add_f32 v[168:169], v[168:169], v[154:155] op_sel_hi:[1,0] neg_lo:[0,1] neg_hi:[0,1]
    v_pk_add_f32 v[170:171], v[170:171], v[154:155] op_sel_hi:[1,0] neg_lo:[0,1] neg_hi:[0,1]
    v_pk_add_f32 v[172:173], v[172:173], v[154:155] op_sel_hi:[1,0] neg_lo:[0,1] neg_hi:[0,1]
    v_pk_add_f32 v[174:175], v[174:175], v[154:155] op_sel_hi:[1,0] neg_lo:[0,1] neg_hi:[0,1]
    v_cvt_pk_bf16_f32 v96, v160, v161
    v_cvt_pk_bf16_f32 v97, v162, v163
    v_cvt_pk_bf16_f32 v98, v164, v165
    v_cvt_pk_bf16_f32 v99, v166, v167
    v_cvt_pk_bf16_f32 v100, v168, v169
    v_cvt_pk_bf16_f32 v101, v170, v171
    s_add_u32 s26, s24, 0x2a0000
    s_add_u32 m0, s29, 0x15000
    s_nop 0
    buffer_load_dwordx4 v136, s[16:19], s26 offen lds
    v_cvt_pk_bf16_f32 v102, v172, v173
    v_cvt_pk_bf16_f32 v103, v174, v175
    v_lshlrev_b32 v160, 16, v96
    v_and_b32 v161, 0xffff0000, v96
    v_lshlrev_b32 v162, 16, v97
    v_and_b32 v163, 0xffff0000, v97
    v_lshlrev_b32 v164, 16, v98
    v_and_b32 v165, 0xffff0000, v98
    v_lshlrev_b32 v166, 16, v99
    v_and_b32 v167, 0xffff0000, v99
    v_lshlrev_b32 v168, 16, v100
    v_and_b32 v169, 0xffff0000, v100
    v_lshlrev_b32 v170, 16, v101
    v_and_b32 v171, 0xffff0000, v101
    v_lshlrev_b32 v172, 16, v102
    v_and_b32 v173, 0xffff0000, v102
    v_lshlrev_b32 v174, 16, v103
    v_and_b32 v175, 0xffff0000, v103
    v_pk_mul_f32 v[160:161], v[160:161], v[152:153] op_sel_hi:[1,0]
    v_pk_mul_f32 v[162:163], v[162:163], v[152:153] op_sel_hi:[1,0]
    v_pk_mul_f32 v[164:165], v[164:165], v[152:153] op_sel_hi:[1,0]
    v_pk_mul_f32 v[166:167], v[166:167], v[152:153] op_sel_hi:[1,0]
    v_pk_mul_f32 v[168:169], v[168:169], v[152:153] op_sel_hi:[1,0]
    v_pk_mul_f32 v[170:171], v[170:171], v[152:153] op_sel_hi:[1,0]
    v_pk_mul_f32 v[172:173], v[172:173], v[152:153] op_sel_hi:[1,0]
    v_pk_mul_f32 v[174:175], v[174:175], v[152:153] op_sel_hi:[1,0]
    v_cvt_pk_bf16_f32 v160, v160, v161
    v_cvt_pk_bf16_f32 v162, v162, v163
    v_cvt_pk_bf16_f32 v164, v164, v165
    v_cvt_pk_bf16_f32 v166, v166, v167
    v_cvt_pk_bf16_f32 v168, v168, v169
    v_cvt_pk_bf16_f32 v170, v170, v171
    v_cvt_pk_bf16_f32 v172, v172, v173
    v_cvt_pk_bf16_f32 v174, v174, v175
    v_accvgpr_write_b32 a96, v160
    v_accvgpr_write_b32 a97, v162
    v_accvgpr_write_b32 a98, v164
    v_accvgpr_write_b32 a99, v166
    v_accvgpr_write_b32 a100, v168
    v_accvgpr_write_b32 a101, v170
    v_accvgpr_write_b32 a102, v172
    v_accvgpr_write_b32 a103, v174
    v_lshlrev_b32 v160, 16, v104
    v_and_b32 v161, 0xffff0000, v104
    v_lshlrev_b32 v162, 16, v105
    v_and_b32 v163, 0xffff0000, v105
    v_lshlrev_b32 v164, 16, v106
    v_and_b32 v165, 0xffff0000, v106
    v_lshlrev_b32 v166, 16, v107
    v_and_b32 v167, 0xffff0000, v107
    s_add_u32 s26, s24, 0x2c0000
    s_add_u32 m0, s29, 0x16000
    s_nop 0
    buffer_load_dwordx4 v136, s[16:19], s26 offen lds
    v_lshlrev_b32 v168, 16, v108
    v_and_b32 v169, 0xffff0000, v108
    v_lshlrev_b32 v170, 16, v109
    v_and_b32 v171, 0xffff0000, v109
    v_lshlrev_b32 v172, 16, v110
    v_and_b32 v173, 0xffff0000, v110
    v_lshlrev_b32 v174, 16, v111
    v_and_b32 v175, 0xffff0000, v111
    v_pk_add_f32 v[160:161], v[160:161], v[154:155] op_sel_hi:[1,0] neg_lo:[0,1] neg_hi:[0,1]
    v_pk_add_f32 v[162:163], v[162:163], v[154:155] op_sel_hi:[1,0] neg_lo:[0,1] neg_hi:[0,1]
    v_pk_add_f32 v[164:165], v[164:165], v[154:155] op_sel_hi:[1,0] neg_lo:[0,1] neg_hi:[0,1]
    v_pk_add_f32 v[166:167], v[166:167], v[154:155] op_sel_hi:[1,0] neg_lo:[0,1] neg_hi:[0,1]
    v_pk_add_f32 v[168:169], v[168:169], v[154:155] op_sel_hi:[1,0] neg_lo:[0,1] neg_hi:[0,1]
    v_pk_add_f32 v[170:171], v[170:171], v[154:155] op_sel_hi:[1,0] neg_lo:[0,1] neg_hi:[0,1]
    v_pk_add_f32 v[172:173], v[172:173], v[154:155] op_sel_hi:[1,0] neg_lo:[0,1] neg_hi:[0,1]
    v_pk_add_f32 v[174:175], v[174:175], v[154:155] op_sel_hi:[1,0] neg_lo:[0,1] neg_hi:[0,1]
    v_cvt_pk_bf16_f32 v104, v160, v161
    v_cvt_pk_bf16_f32 v105, v162, v163
    v_cvt_pk_bf16_f32 v106, v164, v165
    v_cvt_pk_bf16_f32 v107, v166, v167
    v_cvt_pk_bf16_f32 v108, v168, v169
    v_cvt_pk_bf16_f32 v109, v170, v171
    v_cvt_pk_bf16_f32 v110, v172, v173
    v_cvt_pk_bf16_f32 v111, v174, v175
    v_lshlrev_b32 v160, 16, v104
    v_and_b32 v161, 0xffff0000, v104
    v_lshlrev_b32 v162, 16, v105
    v_and_b32 v163, 0xffff0000, v105
    v_lshlrev_b32 v164, 16, v106
    v_and_b32 v165, 0xffff0000, v106
    v_lshlrev_b32 v166, 16, v107
    v_and_b32 v167, 0xffff0000, v107
    v_lshlrev_b32 v168, 16, v108
    v_and_b32 v169, 0xffff0000, v108
    v_lshlrev_b32 v170, 16, v109
    v_and_b32 v171, 0xffff0000, v109
    v_lshlrev_b32 v172, 16, v110
    v_and_b32 v173, 0xffff0000, v110
    v_lshlrev_b32 v174, 16, v111
    v_and_b32 v175, 0xffff0000, v111
    v_pk_mul_f32 v[160:161], v[160:161], v[152:153] op_sel_hi:[1,0]
    v_pk_mul_f32 v[162:163], v[162:163], v[152:153] op_sel_hi:[1,0]
    v_pk_mul_f32 v[164:165], v[164:165], v[152:153] op_sel_hi:[1,0]
    v_pk_mul_f32 v[166:167], v[166:167], v[152:153] op_sel_hi:[1,0]
    v_pk_mul_f32 v[168:169], v[168:169], v[152:153] op_sel_hi:[1,0]
    v_pk_mul_f32 v[170:171], v[170:171], v[152:153] op_sel_hi:[1,0]
    v_pk_mul_f32 v[172:173], v[172:173], v[152:153] op_sel_hi:[1,0]
    v_pk_mul_f32 v[174:175], v[174:175], v[152:153] op_sel_hi:[1,0]
    v_cvt_pk_bf16_f32 v160, v160, v161
    v_cvt_pk_bf16_f32 v162, v162, v163
    s_add_u32 s26, s24, 0x2e0000
    s_add_u32 m0, s29, 0x17000
    s_nop 0
    buffer_load_dwordx4 v136, s[16:19], s26 offen lds
    v_cvt_pk_bf16_f32 v164, v164, v165
    v_cvt_pk_bf16_f32 v166, v166, v167
    v_cvt_pk_bf16_f32 v168, v168, v169
    v_cvt_pk_bf16_f32 v170, v170, v171
    v_cvt_pk_bf16_f32 v172, v172, v173
    v_cvt_pk_bf16_f32 v174, v174, v175
    v_accvgpr_write_b32 a104, v160
    v_accvgpr_write_b32 a105, v162
    v_accvgpr_write_b32 a106, v164
    v_accvgpr_write_b32 a107, v166
    v_accvgpr_write_b32 a108, v168
    v_accvgpr_write_b32 a109, v170
    v_accvgpr_write_b32 a110, v172
    v_accvgpr_write_b32 a111, v174
    v_lshlrev_b32 v160, 16, v112
    v_and_b32 v161, 0xffff0000, v112
    v_lshlrev_b32 v162, 16, v113
    v_and_b32 v163, 0xffff0000, v113
    v_lshlrev_b32 v164, 16, v114
    v_and_b32 v165, 0xffff0000, v114
    v_lshlrev_b32 v166, 16, v115
    v_and_b32 v167, 0xffff0000, v115
    v_lshlrev_b32 v168, 16, v116
    v_and_b32 v169, 0xffff0000, v116
    v_lshlrev_b32 v170, 16, v117
    v_and_b32 v171, 0xffff0000, v117
    v_lshlrev_b32 v172, 16, v118
    v_and_b32 v173, 0xffff0000, v118
    v_lshlrev_b32 v174, 16, v119
    v_and_b32 v175, 0xffff0000, v119
    v_pk_add_f32 v[160:161], v[160:161], v[154:155] op_sel_hi:[1,0] neg_lo:[0,1] neg_hi:[0,1]
    v_pk_add_f32 v[162:163], v[162:163], v[154:155] op_sel_hi:[1,0] neg_lo:[0,1] neg_hi:[0,1]
    v_pk_add_f32 v[164:165], v[164:165], v[154:155] op_sel_hi:[1,0] neg_lo:[0,1] neg_hi:[0,1]
    v_pk_add_f32 v[166:167], v[166:167], v[154:155] op_sel_hi:[1,0] neg_lo:[0,1] neg_hi:[0,1]
    v_pk_add_f32 v[168:169], v[168:169], v[154:155] op_sel_hi:[1,0] neg_lo:[0,1] neg_hi:[0,1]
    v_pk_add_f32 v[170:171], v[170:171], v[154:155] op_sel_hi:[1,0] neg_lo:[0,1] neg_hi:[0,1]
    v_pk_add_f32 v[172:173], v[172:173], v[154:155] op_sel_hi:[1,0] neg_lo:[0,1] neg_hi:[0,1]
    v_pk_add_f32 v[174:175], v[174:175], v[154:155] op_sel_hi:[1,0] neg_lo:[0,1] neg_hi:[0,1]
    v_cvt_pk_bf16_f32 v112, v160, v161
    v_cvt_pk_bf16_f32 v113, v162, v163
    v_cvt_pk_bf16_f32 v114, v164, v165
    v_cvt_pk_bf16_f32 v115, v166, v167
    v_cvt_pk_bf16_f32 v116, v168, v169
    v_cvt_pk_bf16_f32 v117, v170, v171
    v_cvt_pk_bf16_f32 v118, v172, v173
    v_cvt_pk_bf16_f32 v119, v174, v175
    v_lshlrev_b32 v160, 16, v112
    v_and_b32 v161, 0xffff0000, v112
    v_lshlrev_b32 v162, 16, v113
    v_and_b32 v163, 0xffff0000, v113
    v_lshlrev_b32 v138, 2, v137
    v_lshlrev_b32 v138, 3, v137
    s_sub_u32 s26, s101, 96
    s_lshl_b32 s26, s26, 2
    s_add_u32 s26, s26, s21
    s_min_u32 s26, s26, 512
    s_lshl_b32 s26, s26, 13
    s_cmp_eq_u32 s41, 0
    s_cselect_b32 s6, 0x400000, 0
    s_mov_b32 s7, 0x20000
    s_mov_b32 s4, s66
    s_and_b32 s5, s67, 0xffff
    buffer_load_dword v143, v138, s[4:7], s26 offen
    v_lshlrev_b32 v164, 16, v114
    v_and_b32 v165, 0xffff0000, v114
    v_lshlrev_b32 v166, 16, v115
    v_and_b32 v167, 0xffff0000, v115
    v_lshlrev_b32 v168, 16, v116
    v_and_b32 v169, 0xffff0000, v116
    v_lshlrev_b32 v170, 16, v117
    v_and_b32 v171, 0xffff0000, v117
    v_lshlrev_b32 v172, 16, v118
    v_and_b32 v173, 0xffff0000, v118
    v_lshlrev_b32 v174, 16, v119
    v_and_b32 v175, 0xffff0000, v119
    v_pk_mul_f32 v[160:161], v[160:161], v[152:153] op_sel_hi:[1,0]
    v_pk_mul_f32 v[162:163], v[162:163], v[152:153] op_sel_hi:[1,0]
    v_pk_mul_f32 v[164:165], v[164:165], v[152:153] op_sel_hi:[1,0]
    v_pk_mul_f32 v[166:167], v[166:167], v[152:153] op_sel_hi:[1,0]
    v_pk_mul_f32 v[168:169], v[168:169], v[152:153] op_sel_hi:[1,0]
    v_pk_mul_f32 v[170:171], v[170:171], v[152:153] op_sel_hi:[1,0]
    v_pk_mul_f32 v[172:173], v[172:173], v[152:153] op_sel_hi:[1,0]
    v_pk_mul_f32 v[174:175], v[174:175], v[152:153] op_sel_hi:[1,0]
    v_cvt_pk_bf16_f32 v160, v160, v161
    v_cvt_pk_bf16_f32 v162, v162, v163
    v_cvt_pk_bf16_f32 v164, v164, v165
    v_cvt_pk_bf16_f32 v166, v166, v167
    v_cvt_pk_bf16_f32 v168, v168, v169
    v_cvt_pk_bf16_f32 v170, v170, v171
    v_cvt_pk_bf16_f32 v172, v172, v173
    v_cvt_pk_bf16_f32 v174, v174, v175
    v_accvgpr_write_b32 a112, v160
    v_accvgpr_write_b32 a113, v162
    v_accvgpr_write_b32 a114, v164
    v_accvgpr_write_b32 a115, v166
    v_accvgpr_write_b32 a116, v168
    v_accvgpr_write_b32 a117, v170
    v_accvgpr_write_b32 a118, v172
    v_accvgpr_write_b32 a119, v174
    v_lshlrev_b32 v160, 16, v120
    v_and_b32 v161, 0xffff0000, v120
    v_lshlrev_b32 v162, 16, v121
    v_and_b32 v163, 0xffff0000, v121
    v_lshlrev_b32 v164, 16, v122
    v_and_b32 v165, 0xffff0000, v122
    v_lshlrev_b32 v166, 16, v123
    v_and_b32 v167, 0xffff0000, v123
    v_lshlrev_b32 v168, 16, v124
    v_and_b32 v169, 0xffff0000, v124
    v_lshlrev_b32 v170, 16, v125
    v_and_b32 v171, 0xffff0000, v125
    v_lshlrev_b32 v172, 16, v126
    v_and_b32 v173, 0xffff0000, v126
    v_lshlrev_b32 v174, 16, v127
    v_and_b32 v175, 0xffff0000, v127
    v_pk_add_f32 v[160:161], v[160:161], v[154:155] op_sel_hi:[1,0] neg_lo:[0,1] neg_hi:[0,1]
    v_pk_add_f32 v[162:163], v[162:163], v[154:155] op_sel_hi:[1,0] neg_lo:[0,1] neg_hi:[0,1]
    v_pk_add_f32 v[164:165], v[164:165], v[154:155] op_sel_hi:[1,0] neg_lo:[0,1] neg_hi:[0,1]
    v_pk_add_f32 v[166:167], v[166:167], v[154:155] op_sel_hi:[1,0] neg_lo:[0,1] neg_hi:[0,1]
    v_pk_add_f32 v[168:169], v[168:169], v[154:155] op_sel_hi:[1,0] neg_lo:[0,1] neg_hi:[0,1]
    v_pk_add_f32 v[170:171], v[170:171], v[154:155] op_sel_hi:[1,0] neg_lo:[0,1] neg_hi:[0,1]
    v_pk_add_f32 v[172:173], v[172:173], v[154:155] op_sel_hi:[1,0] neg_lo:[0,1] neg_hi:[0,1]
    v_pk_add_f32 v[174:175], v[174:175], v[154:155] op_sel_hi:[1,0] neg_lo:[0,1] neg_hi:[0,1]
    v_cvt_pk_bf16_f32 v120, v160, v161
    v_cvt_pk_bf16_f32 v121, v162, v163
    v_cvt_pk_bf16_f32 v122, v164, v165
    v_cvt_pk_bf16_f32 v123, v166, v167
    v_cvt_pk_bf16_f32 v124, v168, v169
    v_cvt_pk_bf16_f32 v125, v170, v171
    v_cvt_pk_bf16_f32 v126, v172, v173
    v_cvt_pk_bf16_f32 v127, v174, v175
    v_lshlrev_b32 v160, 16, v120
    v_and_b32 v161, 0xffff0000, v120
    v_lshlrev_b32 v162, 16, v121
    v_and_b32 v163, 0xffff0000, v121
    v_lshlrev_b32 v164, 16, v122
    v_and_b32 v165, 0xffff0000, v122
    v_lshlrev_b32 v166, 16, v123
    v_and_b32 v167, 0xffff0000, v123
    v_lshlrev_b32 v168, 16, v124
    v_and_b32 v169, 0xffff0000, v124
    v_lshlrev_b32 v170, 16, v125
    v_and_b32 v171, 0xffff0000, v125
    v_lshlrev_b32 v172, 16, v126
    v_and_b32 v173, 0xffff0000, v126
    v_lshlrev_b32 v174, 16, v127
    v_and_b32 v175, 0xffff0000, v127
    v_pk_mul_f32 v[160:161], v[160:161], v[152:153] op_sel_hi:[1,0]
    v_pk_mul_f32 v[162:163], v[162:163], v[152:153] op_sel_hi:[1,0]
    v_pk_mul_f32 v[164:165], v[164:165], v[152:153] op_sel_hi:[1,0]
    v_pk_mul_f32 v[166:167], v[166:167], v[152:153] op_sel_hi:[1,0]
    v_pk_mul_f32 v[168:169], v[168:169], v[152:153] op_sel_hi:[1,0]
    v_pk_mul_f32 v[170:171], v[170:171], v[152:153] op_sel_hi:[1,0]
    v_pk_mul_f32 v[172:173], v[172:173], v[152:153] op_sel_hi:[1,0]
    v_pk_mul_f32 v[174:175], v[174:175], v[152:153] op_sel_hi:[1,0]
    v_cvt_pk_bf16_f32 v160, v160, v161
    v_cvt_pk_bf16_f32 v162, v162, v163
    v_cvt_pk_bf16_f32 v164, v164, v165
    v_cvt_pk_bf16_f32 v166, v166, v167
    v_cvt_pk_bf16_f32 v168, v168, v169
    v_cvt_pk_bf16_f32 v170, v170, v171
    v_cvt_pk_bf16_f32 v172, v172, v173
    v_cvt_pk_bf16_f32 v174, v174, v175
    v_accvgpr_write_b32 a120, v160
    v_accvgpr_write_b32 a121, v162
    v_accvgpr_write_b32 a122, v164
    v_accvgpr_write_b32 a123, v166
    v_accvgpr_write_b32 a124, v168
    v_accvgpr_write_b32 a125, v170
    v_accvgpr_write_b32 a126, v172
    v_accvgpr_write_b32 a127, v174
    buffer_load_dwordx2 v[140:141], off, s[92:95], 0 offset:36 sc1
    s_nop 3
L_p1_unit:
    s_cmp_ge_u32 s38, 96
    s_cbranch_scc1 L_p1_end
    s_lshr_b32 s26, s38, 5
    s_add_u32 s27, s26, 1
    s_lshl_b32 s25, s27, 24
    s_lshl_b32 s27, s20, 2
    s_add_u32 s27, s27, s21
    s_lshl_b32 s27, s27, 5
    s_and_b32 s28, s38, 31
    s_add_u32 s27, s27, s28
    s_lshl_b32 s27, s27, 13
    s_add_u32 s25, s25, s27
    s_lshr_b32 s26, s38, 5
    s_cmp_eq_u32 s26, 1
    s_cbranch_scc1 L_p1_v
    s_waitcnt vmcnt(16)
    s_barrier
    ds_read_b64_tr_b16 v[64:65], v128
    ds_read_b64_tr_b16 v[66:67], v128 offset:1024
    ds_read_b64_tr_b16 v[68:69], v129
    ds_read_b64_tr_b16 v[70:71], v129 offset:1024
    ds_read_b64_tr_b16 v[72:73], v130
    ds_read_b64_tr_b16 v[74:75], v130 offset:1024
    ds_read_b64_tr_b16 v[76:77], v131
    ds_read_b64_tr_b16 v[78:79], v131 offset:1024
    ds_read_b64_tr_b16 v[80:81], v132
    ds_read_b64_tr_b16 v[82:83], v132 offset:1024
    ds_read_b64_tr_b16 v[84:85], v133
    ds_read_b64_tr_b16 v[86:87], v133 offset:1024
    ds_read_b64_tr_b16 v[88:89], v134
    ds_read_b64_tr_b16 v[90:91], v134 offset:1024
    s_waitcnt lgkmcnt(12)
    v_mfma_f32_16x16x32_bf16 v[0:3], v[64:67], a[0:3], 0
    ds_read_b64_tr_b16 v[92:93], v135
    v_mfma_f32_16x16x32_bf16 v[4:7], v[64:67], a[64:67], 0
    ds_read_b64_tr_b16 v[94:95], v135 offset:1024
    s_add_u32 s26, s24, 0x300000
    s_add_u32 m0, s29, 0x18000
    s_nop 0
    buffer_load_dwordx4 v136, s[16:19], s26 offen lds
    s_waitcnt lgkmcnt(12)
    v_mfma_f32_16x16x32_bf16 v[8:11], v[68:71], a[0:3], 0
    ds_read_b64_tr_b16 v[96:97], v128 offset:8192
    v_mfma_f32_16x16x32_bf16 v[12:15], v[68:71], a[64:67], 0
    ds_read_b64_tr_b16 v[98:99], v128 offset:9216
    s_add_u32 s26, s24, 0x320000
    s_add_u32 m0, s29, 0x19000
    s_nop 0
    buffer_load_dwordx4 v136, s[16:19], s26 offen lds
    s_waitcnt lgkmcnt(12)
    v_mfma_f32_16x16x32_bf16 v[16:19], v[72:75], a[0:3], 0
    ds_read_b64_tr_b16 v[100:101], v129 offset:8192
    v_mfma_f32_16x16x32_bf16 v[20:23], v[72:75], a[64:67], 0
    ds_read_b64_tr_b16 v[102:103], v129 offset:9216
    s_add_u32 s26, s24, 0x340000
    s_add_u32 m0, s29, 0x1a000
    s_nop 0
    buffer_load_dwordx4 v136, s[16:19], s26 offen lds
    s_waitcnt lgkmcnt(12)
    v_mfma_f32_16x16x32_bf16 v[24:27], v[76:79], a[0:3], 0
    ds_read_b64_tr_b16 v[104:105], v130 offset:8192
    v_mfma_f32_16x16x32_bf16 v[28:31], v[76:79], a[64:67], 0
    ds_read_b64_tr_b16 v[106:107], v130 offset:9216
    s_add_u32 s26, s24, 0x360000
    s_add_u32 m0, s29, 0x1b000
    s_nop 0
    buffer_load_dwordx4 v136, s[16:19], s26 offen lds
    s_waitcnt lgkmcnt(12)
    v_mfma_f32_16x16x32_bf16 v[32:35], v[80:83], a[0:3], 0
    ds_read_b64_tr_b16 v[108:109], v131 offset:8192
    v_mfma_f32_16x16x32_bf16 v[36:39], v[80:83], a[64:67], 0
    ds_read_b64_tr_b16 v[110:111], v131 offset:9216
    s_add_u32 s26, s24, 0x380000
    s_add_u32 m0, s29, 0x1c000
    s_nop 0
    buffer_load_dwordx4 v136, s[16:19], s26 offen lds
    s_waitcnt lgkmcnt(12)
    v_mfma_f32_16x16x32_bf16 v[40:43], v[84:87], a[0:3], 0
    ds_read_b64_tr_b16 v[112:113], v132 offset:8192
    v_mfma_f32_16x16x32_bf16 v[44:47], v[84:87], a[64:67], 0
    ds_read_b64_tr_b16 v[114:115], v132 offset:9216
    s_add_u32 s26, s24, 0x3a0000
    s_add_u32 m0, s29, 0x1d000
    s_nop 0
    buffer_load_dwordx4 v136, s[16:19], s26 offen lds
    s_waitcnt lgkmcnt(12)
    v_mfma_f32_16x16x32_bf16 v[48:51], v[88:91], a[0:3], 0
    ds_read_b64_tr_b16 v[116:117], v133 offset:8192
    v_mfma_f32_16x16x32_bf16 v[52:55], v[88:91], a[64:67], 0
    ds_read_b64_tr_b16 v[118:119], v133 offset:9216
    s_add_u32 s26, s24, 0x3c0000
    s_add_u32 m0, s29, 0x1e000
    s_nop 0
    buffer_load_dwordx4 v136, s[16:19], s26 offen lds
    s_waitcnt lgkmcnt(12)
    v_mfma_f32_16x16x32_bf16 v[56:59], v[92:95], a[0:3], 0
    ds_read_b64_tr_b16 v[120:121], v134 offset:8192
    v_mfma_f32_16x16x32_bf16 v[60:63], v[92:95], a[64:67], 0
    ds_read_b64_tr_b16 v[122:123], v134 offset:9216
    s_add_u32 s26, s24, 0x3e0000
    s_add_u32 m0, s29, 0x1f000
    s_nop 0
    buffer_load_dwordx4 v136, s[16:19], s26 offen lds
    s_waitcnt lgkmcnt(12)
    v_mfma_f32_16x16x32_bf16 v[0:3], v[96:99], a[4:7], v[0:3]
    ds_read_b64_tr_b16 v[124:125], v135 offset:8192
    v_mfma_f32_16x16x32_bf16 v[4:7], v[96:99], a[68:71], v[4:7]
    ds_read_b64_tr_b16 v[126:127], v135 offset:9216
    s_waitcnt lgkmcnt(12)
    v_mfma_f32_16x16x32_bf16 v[8:11], v[100:103], a[4:7], v[8:11]
    ds_read_b64_tr_b16 v[64:65], v128 offset:16384
    v_mfma_f32_16x16x32_bf16 v[12:15], v[100:103], a[68:71], v[12:15]
    ds_read_b64_tr_b16 v[66:67], v128 offset:17408
    s_waitcnt lgkmcnt(12)
    v_mfma_f32_16x16x32_bf16 v[16:19], v[104:107], a[4:7], v[16:19]
    ds_read_b64_tr_b16 v[68:69], v129 offset:16384
    v_mfma_f32_16x16x32_bf16 v[20:23], v[104:107], a[68:71], v[20:23]
    ds_read_b64_tr_b16 v[70:71], v129 offset:17408
    s_waitcnt lgkmcnt(12)
    v_mfma_f32_16x16x32_bf16 v[24:27], v[108:111], a[4:7], v[24:27]
    ds_read_b64_tr_b16 v[72:73], v130 offset:16384
    v_mfma_f32_16x16x32_bf16 v[28:31], v[108:111], a[68:71], v[28:31]
    ds_read_b64_tr_b16 v[74:75], v130 offset:17408
    s_waitcnt lgkmcnt(12)
    v_mfma_f32_16x16x32_bf16 v[32:35], v[112:115], a[4:7], v[32:35]
    ds_read_b64_tr_b16 v[76:77], v131 offset:16384
    v_mfma_f32_16x16x32_bf16 v[36:39], v[112:115], a[68:71], v[36:39]
    ds_read_b64_tr_b16 v[78:79], v131 offset:17408
    s_waitcnt lgkmcnt(12)
    v_mfma_f32_16x16x32_bf16 v[40:43], v[116:119], a[4:7], v[40:43]
    ds_read_b64_tr_b16 v[80:81], v132 offset:16384
    v_mfma_f32_16x16x32_bf16 v[44:47], v[116:119], a[68:71], v[44:47]
    ds_read_b64_tr_b16 v[82:83], v132 offset:17408
    s_waitcnt lgkmcnt(12)
    v_mfma_f32_16x16x32_bf16 v[48:51], v[120:123], a[4:7], v[48:51]
    ds_read_b64_tr_b16 v[84:85], v133 offset:16384
    v_mfma_f32_16x16x32_bf16 v[52:55], v[120:123], a[68:71], v[52:55]
    ds_read_b64_tr_b16 v[86:87], v133 offset:17408
    s_waitcnt lgkmcnt(12)
    v_mfma_f32_16x16x32_bf16 v[56:59], v[124:127], a[4:7], v[56:59]
    ds_read_b64_tr_b16 v[88:89], v134 offset:16384
    v_mfma_f32_16x16x32_bf16 v[60:63], v[124:127], a[68:71], v[60:63]
    ds_read_b64_tr_b16 v[90:91], v134 offset:17408
    s_waitcnt lgkmcnt(12)
    v_mfma_f32_16x16x32_bf16 v[0:3], v[64:67], a[8:11], v[0:3]
    ds_read_b64_tr_b16 v[92:93], v135 offset:16384
    v_mfma_f32_16x16x32_bf16 v[4:7], v[64:67], a[72:75], v[4:7]
    ds_read_b64_tr_b16 v[94:95], v135 offset:17408
    s_waitcnt lgkmcnt(12)
    v_mfma_f32_16x16x32_bf16 v[8:11], v[68:71], a[8:11], v[8:11]
    ds_read_b64_tr_b16 v[96:97], v128 offset:24576
    v_mfma_f32_16x16x32_bf16 v[12:15], v[68:71], a[72:75], v[12:15]
    ds_read_b64_tr_b16 v[98:99], v128 offset:25600
    s_waitcnt lgkmcnt(12)
    v_mfma_f32_16x16x32_bf16 v[16:19], v[72:75], a[8:11], v[16:19]
    ds_read_b64_tr_b16 v[100:101], v129 offset:24576
    v_mfma_f32_16x16x32_bf16 v[20:23], v[72:75], a[72:75], v[20:23]
    ds_read_b64_tr_b16 v[102:103], v129 offset:25600
    s_waitcnt lgkmcnt(12)
    v_mfma_f32_16x16x32_bf16 v[24:27], v[76:79], a[8:11], v[24:27]
    ds_read_b64_tr_b16 v[104:105], v130 offset:24576
    v_mfma_f32_16x16x32_bf16 v[28:31], v[76:79], a[72:75], v[28:31]
    ds_read_b64_tr_b16 v[106:107], v130 offset:25600
    s_waitcnt lgkmcnt(12)
    v_mfma_f32_16x16x32_bf16 v[32:35], v[80:83], a[8:11], v[32:35]
    ds_read_b64_tr_b16 v[108:109], v131 offset:24576
    v_mfma_f32_16x16x32_bf16 v[36:39], v[80:83], a[72:75], v[36:39]
    ds_read_b64_tr_b16 v[110:111], v131 offset:25600
    s_waitcnt lgkmcnt(12)
    v_mfma_f32_16x16x32_bf16 v[40:43], v[84:87], a[8:11], v[40:43]
    ds_read_b64_tr_b16 v[112:113], v132 offset:24576
    v_mfma_f32_16x16x32_bf16 v[44:47], v[84:87], a[72:75], v[44:47]
    ds_read_b64_tr_b16 v[114:115], v132 offset:25600
    s_waitcnt lgkmcnt(12)
    v_mfma_f32_16x16x32_bf16 v[48:51], v[88:91], a[8:11], v[48:51]
    ds_read_b64_tr_b16 v[116:117], v133 offset:24576
    v_mfma_f32_16x16x32_bf16 v[52:55], v[88:91], a[72:75], v[52:55]
    ds_read_b64_tr_b16 v[118:119], v133 offset:25600
    s_waitcnt lgkmcnt(12)
    v_mfma_f32_16x16x32_bf16 v[56:59], v[92:95], a[8:11], v[56:59]
    ds_read_b64_tr_b16 v[120:121], v134 offset:24576
    v_mfma_f32_16x16x32_bf16 v[60:63], v[92:95], a[72:75], v[60:63]
    ds_read_b64_tr_b16 v[122:123], v134 offset:25600
    s_waitcnt lgkmcnt(12)
    v_mfma_f32_16x16x32_bf16 v[0:3], v[96:99], a[12:15], v[0:3]
    ds_read_b64_tr_b16 v[124:125], v135 offset:24576
    v_mfma_f32_16x16x32_bf16 v[4:7], v[96:99], a[76:79], v[4:7]
    ds_read_b64_tr_b16 v[126:127], v135 offset:25600
    s_waitcnt lgkmcnt(12)
    v_mfma_f32_16x16x32_bf16 v[8:11], v[100:103], a[12:15], v[8:11]
    v_mfma_f32_16x16x32_bf16 v[12:15], v[100:103], a[76:79], v[12:15]
    s_waitcnt lgkmcnt(10)
    v_mfma_f32_16x16x32_bf16 v[16:19], v[104:107], a[12:15], v[16:19]
    v_mfma_f32_16x16x32_bf16 v[20:23], v[104:107], a[76:79], v[20:23]
    s_waitcnt lgkmcnt(8)
    v_mfma_f32_16x16x32_bf16 v[24:27], v[108:111], a[12:15], v[24:27]
    v_mfma_f32_16x16x32_bf16 v[28:31], v[108:111], a[76:79], v[28:31]
    s_waitcnt lgkmcnt(6)
    v_mfma_f32_16x16x32_bf16 v[32:35], v[112:115], a[12:15], v[32:35]
    v_mfma_f32_16x16x32_bf16 v[36:39], v[112:115], a[76:79], v[36:39]
    s_waitcnt lgkmcnt(4)
    v_mfma_f32_16x16x32_bf16 v[40:43], v[116:119], a[12:15], v[40:43]
    v_mfma_f32_16x16x32_bf16 v[44:47], v[116:119], a[76:79], v[44:47]
    s_waitcnt lgkmcnt(2)
    v_mfma_f32_16x16x32_bf16 v[48:51], v[120:123], a[12:15], v[48:51]
    v_mfma_f32_16x16x32_bf16 v[52:55], v[120:123], a[76:79], v[52:55]
    s_waitcnt lgkmcnt(0)
    v_mfma_f32_16x16x32_bf16 v[56:59], v[124:127], a[12:15], v[56:59]
    v_mfma_f32_16x16x32_bf16 v[60:63], v[124:127], a[76:79], v[60:63]
    s_waitcnt vmcnt(16)
    s_barrier
    ds_read_b64_tr_b16 v[64:65], v128 offset:32768
    ds_read_b64_tr_b16 v[66:67], v128 offset:33792
    ds_read_b64_tr_b16 v[68:69], v129 offset:32768
    ds_read_b64_tr_b16 v[70:71], v129 offset:33792
    ds_read_b64_tr_b16 v[72:73], v130 offset:32768
    ds_read_b64_tr_b16 v[74:75], v130 offset:33792
    ds_read_b64_tr_b16 v[76:77], v131 offset:32768
    ds_read_b64_tr_b16 v[78:79], v131 offset:33792
    ds_read_b64_tr_b16 v[80:81], v132 offset:32768
    ds_read_b64_tr_b16 v[82:83], v132 offset:33792
    ds_read_b64_tr_b16 v[84:85], v133 offset:32768
    ds_read_b64_tr_b16 v[86:87], v133 offset:33792
    ds_read_b64_tr_b16 v[88:89], v134 offset:32768
    ds_read_b64_tr_b16 v[90:91], v134 offset:33792
    s_add_u32 s39, s39, s37
    s_lshr_b32 s26, s39, 5
    s_cmp_eq_u32 s26, 0
    s_cselect_b64 s[16:17], s[62:63], s[60:61]
    s_cmp_eq_u32 s26, 1
    s_cselect_b64 s[16:17], s[64:65], s[16:17]
    s_and_b32 s17, s17, 0xffff
    s_cmp_lt_u32 s39, 96
    s_cselect_b32 s18, 0x400000, 0
    s_and_b32 s24, s39, 31
    s_lshl_b32 s24, s24, 8
    s_waitcnt lgkmcnt(12)
    v_mfma_f32_16x16x32_bf16 v[0:3], v[64:67], a[16:19], v[0:3]
    ds_read_b64_tr_b16 v[92:93], v135 offset:32768
    v_mfma_f32_16x16x32_bf16 v[4:7], v[64:67], a[80:83], v[4:7]
    ds_read_b64_tr_b16 v[94:95], v135 offset:33792
    s_add_u32 s26, s24, 0x0
    s_add_u32 m0, s29, 0x0
    s_nop 0
    buffer_load_dwordx4 v136, s[16:19], s26 offen lds
    s_waitcnt lgkmcnt(12)
    v_mfma_f32_16x16x32_bf16 v[8:11], v[68:71], a[16:19], v[8:11]
    ds_read_b64_tr_b16 v[96:97], v128 offset:40960
    v_mfma_f32_16x16x32_bf16 v[12:15], v[68:71], a[80:83], v[12:15]
    ds_read_b64_tr_b16 v[98:99], v128 offset:41984
    s_add_u32 s26, s24, 0x20000
    s_add_u32 m0, s29, 0x1000
    s_nop 0
    buffer_load_dwordx4 v136, s[16:19], s26 offen lds
    s_waitcnt lgkmcnt(12)
    v_mfma_f32_16x16x32_bf16 v[16:19], v[72:75], a[16:19], v[16:19]
    ds_read_b64_tr_b16 v[100:101], v129 offset:40960
    v_mfma_f32_16x16x32_bf16 v[20:23], v[72:75], a[80:83], v[20:23]
    ds_read_b64_tr_b16 v[102:103], v129 offset:41984
    s_add_u32 s26, s24, 0x40000
    s_add_u32 m0, s29, 0x2000
    s_nop 0
    buffer_load_dwordx4 v136, s[16:19], s26 offen lds
    s_waitcnt lgkmcnt(12)
    v_mfma_f32_16x16x32_bf16 v[24:27], v[76:79], a[16:19], v[24:27]
    ds_read_b64_tr_b16 v[104:105], v130 offset:40960
    v_mfma_f32_16x16x32_bf16 v[28:31], v[76:79], a[80:83], v[28:31]
    ds_read_b64_tr_b16 v[106:107], v130 offset:41984
    s_add_u32 s26, s24, 0x60000
    s_add_u32 m0, s29, 0x3000
    s_nop 0
    buffer_load_dwordx4 v136, s[16:19], s26 offen lds
    s_waitcnt lgkmcnt(12)
    v_mfma_f32_16x16x32_bf16 v[32:35], v[80:83], a[16:19], v[32:35]
    ds_read_b64_tr_b16 v[108:109], v131 offset:40960
    v_mfma_f32_16x16x32_bf16 v[36:39], v[80:83], a[80:83], v[36:39]
    ds_read_b64_tr_b16 v[110:111], v131 offset:41984
    s_add_u32 s26, s24, 0x80000
    s_add_u32 m0, s29, 0x4000
    s_nop 0
    buffer_load_dwordx4 v136, s[16:19], s26 offen lds
    s_waitcnt lgkmcnt(12)
    v_mfma_f32_16x16x32_bf16 v[40:43], v[84:87], a[16:19], v[40:43]
    ds_read_b64_tr_b16 v[112:113], v132 offset:40960
    v_mfma_f32_16x16x32_bf16 v[44:47], v[84:87], a[80:83], v[44:47]
    ds_read_b64_tr_b16 v[114:115], v132 offset:41984
    s_add_u32 s26, s24, 0xa0000
    s_add_u32 m0, s29, 0x5000
    s_nop 0
    buffer_load_dwordx4 v136, s[16:19], s26 offen lds
    s_waitcnt lgkmcnt(12)
    v_mfma_f32_16x16x32_bf16 v[48:51], v[88:91], a[16:19], v[48:51]
    ds_read_b64_tr_b16 v[116:117], v133 offset:40960
    v_mfma_f32_16x16x32_bf16 v[52:55], v[88:91], a[80:83], v[52:55]
    ds_read_b64_tr_b16 v[118:119], v133 offset:41984
    s_add_u32 s26, s24, 0xc0000
    s_add_u32 m0, s29, 0x6000
    s_nop 0
    buffer_load_dwordx4 v136, s[16:19], s26 offen lds
    s_waitcnt lgkmcnt(12)
    v_mfma_f32_16x16x32_bf16 v[56:59], v[92:95], a[16:19], v[56:59]
    ds_read_b64_tr_b16 v[120:121], v134 offset:40960
    v_mfma_f32_16x16x32_bf16 v[60:63], v[92:95], a[80:83], v[60:63]
    ds_read_b64_tr_b16 v[122:123], v134 offset:41984
    s_add_u32 s26, s24, 0xe0000
    s_add_u32 m0, s29, 0x7000
    s_nop 0
    buffer_load_dwordx4 v136, s[16:19], s26 offen lds
    s_waitcnt lgkmcnt(12)
    v_mfma_f32_16x16x32_bf16 v[0:3], v[96:99], a[20:23], v[0:3]
    ds_read_b64_tr_b16 v[124:125], v135 offset:40960
    v_mfma_f32_16x16x32_bf16 v[4:7], v[96:99], a[84:87], v[4:7]
    ds_read_b64_tr_b16 v[126:127], v135 offset:41984
    s_waitcnt lgkmcnt(12)
    v_mfma_f32_16x16x32_bf16 v[8:11], v[100:103], a[20:23], v[8:11]
    ds_read_b64_tr_b16 v[64:65], v128 offset:49152
    v_mfma_f32_16x16x32_bf16 v[12:15], v[100:103], a[84:87], v[12:15]
    ds_read_b64_tr_b16 v[66:67], v128 offset:50176
    s_waitcnt lgkmcnt(12)
    v_mfma_f32_16x16x32_bf16 v[16:19], v[104:107], a[20:23], v[16:19]
    ds_read_b64_tr_b16 v[68:69], v129 offset:49152
    v_mfma_f32_16x16x32_bf16 v[20:23], v[104:107], a[84:87], v[20:23]
    ds_read_b64_tr_b16 v[70:71], v129 offset:50176
    s_waitcnt lgkmcnt(12)
    v_mfma_f32_16x16x32_bf16 v[24:27], v[108:111], a[20:23], v[24:27]
    ds_read_b64_tr_b16 v[72:73], v130 offset:49152
    v_mfma_f32_16x16x32_bf16 v[28:31], v[108:111], a[84:87], v[28:31]
    ds_read_b64_tr_b16 v[74:75], v130 offset:50176
    s_waitcnt lgkmcnt(12)
    v_mfma_f32_16x16x32_bf16 v[32:35], v[112:115], a[20:23], v[32:35]
    ds_read_b64_tr_b16 v[76:77], v131 offset:49152
    v_mfma_f32_16x16x32_bf16 v[36:39], v[112:115], a[84:87], v[36:39]
    ds_read_b64_tr_b16 v[78:79], v131 offset:50176
    s_waitcnt lgkmcnt(12)
    v_mfma_f32_16x16x32_bf16 v[40:43], v[116:119], a[20:23], v[40:43]
    ds_read_b64_tr_b16 v[80:81], v132 offset:49152
    v_mfma_f32_16x16x32_bf16 v[44:47], v[116:119], a[84:87], v[44:47]
    ds_read_b64_tr_b16 v[82:83], v132 offset:50176
    s_waitcnt lgkmcnt(12)
    v_mfma_f32_16x16x32_bf16 v[48:51], v[120:123], a[20:23], v[48:51]
    ds_read_b64_tr_b16 v[84:85], v133 offset:49152
    v_mfma_f32_16x16x32_bf16 v[52:55], v[120:123], a[84:87], v[52:55]
    ds_read_b64_tr_b16 v[86:87], v133 offset:50176
    s_waitcnt lgkmcnt(12)
    v_mfma_f32_16x16x32_bf16 v[56:59], v[124:127], a[20:23], v[56:59]
    ds_read_b64_tr_b16 v[88:89], v134 offset:49152
    v_mfma_f32_16x16x32_bf16 v[60:63], v[124:127], a[84:87], v[60:63]
    ds_read_b64_tr_b16 v[90:91], v134 offset:50176
    s_waitcnt lgkmcnt(12)
    v_mfma_f32_16x16x32_bf16 v[0:3], v[64:67], a[24:27], v[0:3]
    ds_read_b64_tr_b16 v[92:93], v135 offset:49152
    v_mfma_f32_16x16x32_bf16 v[4:7], v[64:67], a[88:91], v[4:7]
    ds_read_b64_tr_b16 v[94:95], v135 offset:50176
    s_waitcnt lgkmcnt(12)
    v_mfma_f32_16x16x32_bf16 v[8:11], v[68:71], a[24:27], v[8:11]
    ds_read_b64_tr_b16 v[96:97], v128 offset:57344
    v_mfma_f32_16x16x32_bf16 v[12:15], v[68:71], a[88:91], v[12:15]
    ds_read_b64_tr_b16 v[98:99], v128 offset:58368
    s_waitcnt lgkmcnt(12)
    v_mfma_f32_16x16x32_bf16 v[16:19], v[72:75], a[24:27], v[16:19]
    ds_read_b64_tr_b16 v[100:101], v129 offset:57344
    v_mfma_f32_16x16x32_bf16 v[20:23], v[72:75], a[88:91], v[20:23]
    ds_read_b64_tr_b16 v[102:103], v129 offset:58368
    s_waitcnt lgkmcnt(12)
    v_mfma_f32_16x16x32_bf16 v[24:27], v[76:79], a[24:27], v[24:27]
    ds_read_b64_tr_b16 v[104:105], v130 offset:57344
    v_mfma_f32_16x16x32_bf16 v[28:31], v[76:79], a[88:91], v[28:31]
    ds_read_b64_tr_b16 v[106:107], v130 offset:58368
    s_waitcnt lgkmcnt(12)
    v_mfma_f32_16x16x32_bf16 v[32:35], v[80:83], a[24:27], v[32:35]
    ds_read_b64_tr_b16 v[108:109], v131 offset:57344
    v_mfma_f32_16x16x32_bf16 v[36:39], v[80:83], a[88:91], v[36:39]
    ds_read_b64_tr_b16 v[110:111], v131 offset:58368
    s_waitcnt lgkmcnt(12)
    v_mfma_f32_16x16x32_bf16 v[40:43], v[84:87], a[24:27], v[40:43]
    ds_read_b64_tr_b16 v[112:113], v132 offset:57344
    v_mfma_f32_16x16x32_bf16 v[44:47], v[84:87], a[88:91], v[44:47]
    ds_read_b64_tr_b16 v[114:115], v132 offset:58368
    s_waitcnt lgkmcnt(12)
    v_mfma_f32_16x16x32_bf16 v[48:51], v[88:91], a[24:27], v[48:51]
    ds_read_b64_tr_b16 v[116:117], v133 offset:57344
    v_mfma_f32_16x16x32_bf16 v[52:55], v[88:91], a[88:91], v[52:55]
    ds_read_b64_tr_b16 v[118:119], v133 offset:58368
    s_waitcnt lgkmcnt(12)
    v_mfma_f32_16x16x32_bf16 v[56:59], v[92:95], a[24:27], v[56:59]
    ds_read_b64_tr_b16 v[120:121], v134 offset:57344
    v_mfma_f32_16x16x32_bf16 v[60:63], v[92:95], a[88:91], v[60:63]
    ds_read_b64_tr_b16 v[122:123], v134 offset:58368
    s_waitcnt lgkmcnt(12)
    v_mfma_f32_16x16x32_bf16 v[0:3], v[96:99], a[28:31], v[0:3]
    ds_read_b64_tr_b16 v[124:125], v135 offset:57344
    v_mfma_f32_16x16x32_bf16 v[4:7], v[96:99], a[92:95], v[4:7]
    ds_read_b64_tr_b16 v[126:127], v135 offset:58368
    s_waitcnt lgkmcnt(12)
    v_mfma_f32_16x16x32_bf16 v[8:11], v[100:103], a[28:31], v[8:11]
    v_mfma_f32_16x16x32_bf16 v[12:15], v[100:103], a[92:95], v[12:15]
    s_waitcnt lgkmcnt(10)
    v_mfma_f32_16x16x32_bf16 v[16:19], v[104:107], a[28:31], v[16:19]
    v_mfma_f32_16x16x32_bf16 v[20:23], v[104:107], a[92:95], v[20:23]
    s_waitcnt lgkmcnt(8)
    v_mfma_f32_16x16x32_bf16 v[24:27], v[108:111], a[28:31], v[24:27]
    v_mfma_f32_16x16x32_bf16 v[28:31], v[108:111], a[92:95], v[28:31]
    s_waitcnt lgkmcnt(6)
    v_mfma_f32_16x16x32_bf16 v[32:35], v[112:115], a[28:31], v[32:35]
    v_mfma_f32_16x16x32_bf16 v[36:39], v[112:115], a[92:95], v[36:39]
    s_waitcnt lgkmcnt(4)
    v_mfma_f32_16x16x32_bf16 v[40:43], v[116:119], a[28:31], v[40:43]
    v_mfma_f32_16x16x32_bf16 v[44:47], v[116:119], a[92:95], v[44:47]
    s_waitcnt lgkmcnt(2)
    v_mfma_f32_16x16x32_bf16 v[48:51], v[120:123], a[28:31], v[48:51]
    v_mfma_f32_16x16x32_bf16 v[52:55], v[120:123], a[92:95], v[52:55]
    s_waitcnt lgkmcnt(0)
    v_mfma_f32_16x16x32_bf16 v[56:59], v[124:127], a[28:31], v[56:59]
    v_mfma_f32_16x16x32_bf16 v[60:63], v[124:127], a[92:95], v[60:63]
    v_xor_b32 v128, 0x10000, v128
    v_xor_b32 v129, 0x10000, v129
    v_xor_b32 v130, 0x10000, v130
    v_xor_b32 v131, 0x10000, v131
    v_xor_b32 v132, 0x10000, v132
    v_xor_b32 v133, 0x10000, v133
    v_xor_b32 v134, 0x10000, v134
    v_xor_b32 v135, 0x10000, v135
    s_waitcnt vmcnt(16)
    s_barrier
    ds_read_b64_tr_b16 v[64:65], v128
    ds_read_b64_tr_b16 v[66:67], v128 offset:1024
    ds_read_b64_tr_b16 v[68:69], v129
    ds_read_b64_tr_b16 v[70:71], v129 offset:1024
    ds_read_b64_tr_b16 v[72:73], v130
    ds_read_b64_tr_b16 v[74:75], v130 offset:1024
    ds_read_b64_tr_b16 v[76:77], v131
    ds_read_b64_tr_b16 v[78:79], v131 offset:1024
    ds_read_b64_tr_b16 v[80:81], v132
    ds_read_b64_tr_b16 v[82:83], v132 offset:1024
    ds_read_b64_tr_b16 v[84:85], v133
    ds_read_b64_tr_b16 v[86:87], v133 offset:1024
    ds_read_b64_tr_b16 v[88:89], v134
    ds_read_b64_tr_b16 v[90:91], v134 offset:1024
    s_cmp_eq_u32 s40, 0
    s_cbranch_scc1 L_nopf_90
    s_cmp_lg_u32 s87, 0
    s_cbranch_scc1 L_modeok_91
    v_readfirstlane_b32 s96, v140
    v_readfirstlane_b32 s97, v141
    s_nop 0
    s_cmp_lg_u32 s97, 0
    s_cselect_b32 s87, s96, 0
    s_cmp_eq_u32 s87, 1
    s_cbranch_scc1 L_modeok_91
    s_mov_b32 s96, 0
L_mode_92:
    buffer_load_dwordx2 v[140:141], off, s[92:95], 0 offset:36 sc1
    s_waitcnt vmcnt(0)
    v_readfirstlane_b32 s87, v140
    v_readfirstlane_b32 s97, v141
    s_nop 0
    s_min_u32 s97, s97, s87
    s_cmp_lg_u32 s97, 0
    s_cbranch_scc1 L_moded_93
    s_sleep 4
    s_add_u32 s96, s96, 1
    s_cmp_lg_u32 s96, 0x100
    s_cbranch_scc1 L_modef_94
    v_mov_b32 v140, 2
    v_mov_b32 v141, 0
    s_mov_b64 exec, 1
    buffer_atomic_cmpswap v[140:141], off, s[92:95], 0 offset:36
    s_mov_b64 exec, -1
L_modef_94:
    s_cmp_lt_u32 s96, 0x10000
    s_cbranch_scc1 L_mode_92
L_moded_93:
    s_cmp_lg_u32 s87, 1
    s_cbranch_scc1 L_fallback
L_modeok_91:
    s_cmp_lg_u32 s100, 0
    s_cbranch_scc1 L_flag_95
    v_mov_b32 v138, 1
    s_mov_b64 exec, 1
    buffer_store_dword v138, off, s[8:11], s40 sc1
    s_mov_b64 exec, -1
L_flag_95:
    s_mov_b32 s40, 0
L_nopf_90:
    s_waitcnt lgkmcnt(12)
    v_mfma_f32_16x16x32_bf16 v[0:3], v[64:67], a[32:35], v[0:3]
    ds_read_b64_tr_b16 v[92:93], v135
    v_mfma_f32_16x16x32_bf16 v[4:7], v[64:67], a[96:99], v[4:7]
    ds_read_b64_tr_b16 v[94:95], v135 offset:1024
    s_add_u32 s26, s24, 0x100000
    s_add_u32 m0, s29, 0x8000
    s_nop 0
    buffer_load_dwordx4 v136, s[16:19], s26 offen lds
    s_waitcnt lgkmcnt(12)
    v_mfma_f32_16x16x32_bf16 v[8:11], v[68:71], a[32:35], v[8:11]
    ds_read_b64_tr_b16 v[96:97], v128 offset:8192
    v_mfma_f32_16x16x32_bf16 v[12:15], v[68:71], a[96:99], v[12:15]
    ds_read_b64_tr_b16 v[98:99], v128 offset:9216
    s_add_u32 s26, s24, 0x120000
    s_add_u32 m0, s29, 0x9000
    s_nop 0
    buffer_load_dwordx4 v136, s[16:19], s26 offen lds
    s_waitcnt lgkmcnt(12)
    v_mfma_f32_16x16x32_bf16 v[16:19], v[72:75], a[32:35], v[16:19]
    ds_read_b64_tr_b16 v[100:101], v129 offset:8192
    v_mfma_f32_16x16x32_bf16 v[20:23], v[72:75], a[96:99], v[20:23]
    ds_read_b64_tr_b16 v[102:103], v129 offset:9216
    s_add_u32 s26, s24, 0x140000
    s_add_u32 m0, s29, 0xa000
    s_nop 0
    buffer_load_dwordx4 v136, s[16:19], s26 offen lds
    s_waitcnt lgkmcnt(12)
    v_mfma_f32_16x16x32_bf16 v[24:27], v[76:79], a[32:35], v[24:27]
    ds_read_b64_tr_b16 v[104:105], v130 offset:8192
    v_mfma_f32_16x16x32_bf16 v[28:31], v[76:79], a[96:99], v[28:31]
    ds_read_b64_tr_b16 v[106:107], v130 offset:9216
    s_add_u32 s26, s24, 0x160000
    s_add_u32 m0, s29, 0xb000
    s_nop 0
    buffer_load_dwordx4 v136, s[16:19], s26 offen lds
    s_waitcnt lgkmcnt(12)
    v_mfma_f32_16x16x32_bf16 v[32:35], v[80:83], a[32:35], v[32:35]
    ds_read_b64_tr_b16 v[108:109], v131 offset:8192
    v_mfma_f32_16x16x32_bf16 v[36:39], v[80:83], a[96:99], v[36:39]
    ds_read_b64_tr_b16 v[110:111], v131 offset:9216
    s_add_u32 s26, s24, 0x180000
    s_add_u32 m0, s29, 0xc000
    s_nop 0
    buffer_load_dwordx4 v136, s[16:19], s26 offen lds
    s_waitcnt lgkmcnt(12)
    v_mfma_f32_16x16x32_bf16 v[40:43], v[84:87], a[32:35], v[40:43]
    ds_read_b64_tr_b16 v[112:113], v132 offset:8192
    v_mfma_f32_16x16x32_bf16 v[44:47], v[84:87], a[96:99], v[44:47]
    ds_read_b64_tr_b16 v[114:115], v132 offset:9216
    s_add_u32 s26, s24, 0x1a0000
    s_add_u32 m0, s29, 0xd000
    s_nop 0
    buffer_load_dwordx4 v136, s[16:19], s26 offen lds
    s_waitcnt lgkmcnt(12)
    v_mfma_f32_16x16x32_bf16 v[48:51], v[88:91], a[32:35], v[48:51]
    ds_read_b64_tr_b16 v[116:117], v133 offset:8192
    v_mfma_f32_16x16x32_bf16 v[52:55], v[88:91], a[96:99], v[52:55]
    ds_read_b64_tr_b16 v[118:119], v133 offset:9216
    s_add_u32 s26, s24, 0x1c0000
    s_add_u32 m0, s29, 0xe000
    s_nop 0
    buffer_load_dwordx4 v136, s[16:19], s26 offen lds
    s_waitcnt lgkmcnt(12)
    v_mfma_f32_16x16x32_bf16 v[56:59], v[92:95], a[32:35], v[56:59]
    ds_read_b64_tr_b16 v[120:121], v134 offset:8192
    v_mfma_f32_16x16x32_bf16 v[60:63], v[92:95], a[96:99], v[60:63]
    ds_read_b64_tr_b16 v[122:123], v134 offset:9216
    s_add_u32 s26, s24, 0x1e0000
    s_add_u32 m0, s29, 0xf000
    s_nop 0
    buffer_load_dwordx4 v136, s[16:19], s26 offen lds
    s_waitcnt lgkmcnt(12)
    v_mfma_f32_16x16x32_bf16 v[0:3], v[96:99], a[36:39], v[0:3]
    ds_read_b64_tr_b16 v[124:125], v135 offset:8192
    v_mfma_f32_16x16x32_bf16 v[4:7], v[96:99], a[100:103], v[4:7]
    ds_read_b64_tr_b16 v[126:127], v135 offset:9216
    s_waitcnt lgkmcnt(12)
    v_mfma_f32_16x16x32_bf16 v[8:11], v[100:103], a[36:39], v[8:11]
    ds_read_b64_tr_b16 v[64:65], v128 offset:16384
    v_mfma_f32_16x16x32_bf16 v[12:15], v[100:103], a[100:103], v[12:15]
    ds_read_b64_tr_b16 v[66:67], v128 offset:17408
    s_waitcnt lgkmcnt(12)
    v_mfma_f32_16x16x32_bf16 v[16:19], v[104:107], a[36:39], v[16:19]
    ds_read_b64_tr_b16 v[68:69], v129 offset:16384
    v_mfma_f32_16x16x32_bf16 v[20:23], v[104:107], a[100:103], v[20:23]
    ds_read_b64_tr_b16 v[70:71], v129 offset:17408
    s_waitcnt lgkmcnt(12)
    v_mfma_f32_16x16x32_bf16 v[24:27], v[108:111], a[36:39], v[24:27]
    ds_read_b64_tr_b16 v[72:73], v130 offset:16384
    v_mfma_f32_16x16x32_bf16 v[28:31], v[108:111], a[100:103], v[28:31]
    ds_read_b64_tr_b16 v[74:75], v130 offset:17408
    s_waitcnt lgkmcnt(12)
    v_mfma_f32_16x16x32_bf16 v[32:35], v[112:115], a[36:39], v[32:35]
    ds_read_b64_tr_b16 v[76:77], v131 offset:16384
    v_mfma_f32_16x16x32_bf16 v[36:39], v[112:115], a[100:103], v[36:39]
    ds_read_b64_tr_b16 v[78:79], v131 offset:17408
    s_waitcnt lgkmcnt(12)
    v_mfma_f32_16x16x32_bf16 v[40:43], v[116:119], a[36:39], v[40:43]
    ds_read_b64_tr_b16 v[80:81], v132 offset:16384
    v_mfma_f32_16x16x32_bf16 v[44:47], v[116:119], a[100:103], v[44:47]
    ds_read_b64_tr_b16 v[82:83], v132 offset:17408
    s_waitcnt lgkmcnt(12)
    v_mfma_f32_16x16x32_bf16 v[48:51], v[120:123], a[36:39], v[48:51]
    ds_read_b64_tr_b16 v[84:85], v133 offset:16384
    v_mfma_f32_16x16x32_bf16 v[52:55], v[120:123], a[100:103], v[52:55]
    ds_read_b64_tr_b16 v[86:87], v133 offset:17408
    s_waitcnt lgkmcnt(12)
    v_mfma_f32_16x16x32_bf16 v[56:59], v[124:127], a[36:39], v[56:59]
    ds_read_b64_tr_b16 v[88:89], v134 offset:16384
    v_mfma_f32_16x16x32_bf16 v[60:63], v[124:127], a[100:103], v[60:63]
    ds_read_b64_tr_b16 v[90:91], v134 offset:17408
    s_waitcnt lgkmcnt(12)
    v_mfma_f32_16x16x32_bf16 v[0:3], v[64:67], a[40:43], v[0:3]
    ds_read_b64_tr_b16 v[92:93], v135 offset:16384
    v_mfma_f32_16x16x32_bf16 v[4:7], v[64:67], a[104:107], v[4:7]
    ds_read_b64_tr_b16 v[94:95], v135 offset:17408
    s_waitcnt lgkmcnt(12)
    v_mfma_f32_16x16x32_bf16 v[8:11], v[68:71], a[40:43], v[8:11]
    ds_read_b64_tr_b16 v[96:97], v128 offset:24576
    v_mfma_f32_16x16x32_bf16 v[12:15], v[68:71], a[104:107], v[12:15]
    ds_read_b64_tr_b16 v[98:99], v128 offset:25600
    s_waitcnt lgkmcnt(12)
    v_mfma_f32_16x16x32_bf16 v[16:19], v[72:75], a[40:43], v[16:19]
    ds_read_b64_tr_b16 v[100:101], v129 offset:24576
    v_mfma_f32_16x16x32_bf16 v[20:23], v[72:75], a[104:107], v[20:23]
    ds_read_b64_tr_b16 v[102:103], v129 offset:25600
    s_waitcnt lgkmcnt(12)
    v_mfma_f32_16x16x32_bf16 v[24:27], v[76:79], a[40:43], v[24:27]
    ds_read_b64_tr_b16 v[104:105], v130 offset:24576
    v_mfma_f32_16x16x32_bf16 v[28:31], v[76:79], a[104:107], v[28:31]
    ds_read_b64_tr_b16 v[106:107], v130 offset:25600
    s_waitcnt lgkmcnt(12)
    v_mfma_f32_16x16x32_bf16 v[32:35], v[80:83], a[40:43], v[32:35]
    ds_read_b64_tr_b16 v[108:109], v131 offset:24576
    v_mfma_f32_16x16x32_bf16 v[36:39], v[80:83], a[104:107], v[36:39]
    ds_read_b64_tr_b16 v[110:111], v131 offset:25600
    s_waitcnt lgkmcnt(12)
    v_mfma_f32_16x16x32_bf16 v[40:43], v[84:87], a[40:43], v[40:43]
    ds_read_b64_tr_b16 v[112:113], v132 offset:24576
    v_mfma_f32_16x16x32_bf16 v[44:47], v[84:87], a[104:107], v[44:47]
    ds_read_b64_tr_b16 v[114:115], v132 offset:25600
    s_waitcnt lgkmcnt(12)
    v_mfma_f32_16x16x32_bf16 v[48:51], v[88:91], a[40:43], v[48:51]
    ds_read_b64_tr_b16 v[116:117], v133 offset:24576
    v_mfma_f32_16x16x32_bf16 v[52:55], v[88:91], a[104:107], v[52:55]
    ds_read_b64_tr_b16 v[118:119], v133 offset:25600
    s_waitcnt lgkmcnt(12)
    v_mfma_f32_16x16x32_bf16 v[56:59], v[92:95], a[40:43], v[56:59]
    ds_read_b64_tr_b16 v[120:121], v134 offset:24576
    v_mfma_f32_16x16x32_bf16 v[60:63], v[92:95], a[104:107], v[60:63]
    ds_read_b64_tr_b16 v[122:123], v134 offset:25600
    s_waitcnt lgkmcnt(12)
    v_mfma_f32_16x16x32_bf16 v[0:3], v[96:99], a[44:47], v[0:3]
    ds_read_b64_tr_b16 v[124:125], v135 offset:24576
    v_mfma_f32_16x16x32_bf16 v[4:7], v[96:99], a[108:111], v[4:7]
    ds_read_b64_tr_b16 v[126:127], v135 offset:25600
    s_waitcnt lgkmcnt(12)
    v_mfma_f32_16x16x32_bf16 v[8:11], v[100:103], a[44:47], v[8:11]
    v_mfma_f32_16x16x32_bf16 v[12:15], v[100:103], a[108:111], v[12:15]
    s_waitcnt lgkmcnt(10)
    v_mfma_f32_16x16x32_bf16 v[16:19], v[104:107], a[44:47], v[16:19]
    v_mfma_f32_16x16x32_bf16 v[20:23], v[104:107], a[108:111], v[20:23]
    s_waitcnt lgkmcnt(8)
    v_mfma_f32_16x16x32_bf16 v[24:27], v[108:111], a[44:47], v[24:27]
    v_mfma_f32_16x16x32_bf16 v[28:31], v[108:111], a[108:111], v[28:31]
    s_waitcnt lgkmcnt(6)
    v_mfma_f32_16x16x32_bf16 v[32:35], v[112:115], a[44:47], v[32:35]
    v_mfma_f32_16x16x32_bf16 v[36:39], v[112:115], a[108:111], v[36:39]
    s_waitcnt lgkmcnt(4)
    v_mfma_f32_16x16x32_bf16 v[40:43], v[116:119], a[44:47], v[40:43]
    v_mfma_f32_16x16x32_bf16 v[44:47], v[116:119], a[108:111], v[44:47]
    s_waitcnt lgkmcnt(2)
    v_mfma_f32_16x16x32_bf16 v[48:51], v[120:123], a[44:47], v[48:51]
    v_mfma_f32_16x16x32_bf16 v[52:55], v[120:123], a[108:111], v[52:55]
    s_waitcnt lgkmcnt(0)
    v_mfma_f32_16x16x32_bf16 v[56:59], v[124:127], a[44:47], v[56:59]
    v_mfma_f32_16x16x32_bf16 v[60:63], v[124:127], a[108:111], v[60:63]
    s_waitcnt vmcnt(16)
    s_barrier
    ds_read_b64_tr_b16 v[64:65], v128 offset:32768
    ds_read_b64_tr_b16 v[66:67], v128 offset:33792
    ds_read_b64_tr_b16 v[68:69], v129 offset:32768
    ds_read_b64_tr_b16 v[70:71], v129 offset:33792
    ds_read_b64_tr_b16 v[72:73], v130 offset:32768
    ds_read_b64_tr_b16 v[74:75], v130 offset:33792
    ds_read_b64_tr_b16 v[76:77], v131 offset:32768
    ds_read_b64_tr_b16 v[78:79], v131 offset:33792
    ds_read_b64_tr_b16 v[80:81], v132 offset:32768
    ds_read_b64_tr_b16 v[82:83], v132 offset:33792
    ds_read_b64_tr_b16 v[84:85], v133 offset:32768
    ds_read_b64_tr_b16 v[86:87], v133 offset:33792
    ds_read_b64_tr_b16 v[88:89], v134 offset:32768
    ds_read_b64_tr_b16 v[90:91], v134 offset:33792
    s_waitcnt lgkmcnt(12)
    v_mfma_f32_16x16x32_bf16 v[0:3], v[64:67], a[48:51], v[0:3]
    ds_read_b64_tr_b16 v[92:93], v135 offset:32768
    v_mfma_f32_16x16x32_bf16 v[4:7], v[64:67], a[112:115], v[4:7]
    ds_read_b64_tr_b16 v[94:95], v135 offset:33792
    s_add_u32 s26, s24, 0x200000
    s_add_u32 m0, s29, 0x10000
    s_nop 0
    buffer_load_dwordx4 v136, s[16:19], s26 offen lds
    s_waitcnt lgkmcnt(12)
    v_mfma_f32_16x16x32_bf16 v[8:11], v[68:71], a[48:51], v[8:11]
    ds_read_b64_tr_b16 v[96:97], v128 offset:40960
    v_mfma_f32_16x16x32_bf16 v[12:15], v[68:71], a[112:115], v[12:15]
    ds_read_b64_tr_b16 v[98:99], v128 offset:41984
    s_add_u32 s26, s24, 0x220000
    s_add_u32 m0, s29, 0x11000
    s_nop 0
    buffer_load_dwordx4 v136, s[16:19], s26 offen lds
    s_waitcnt lgkmcnt(12)
    v_mfma_f32_16x16x32_bf16 v[16:19], v[72:75], a[48:51], v[16:19]
    ds_read_b64_tr_b16 v[100:101], v129 offset:40960
    v_mfma_f32_16x16x32_bf16 v[20:23], v[72:75], a[112:115], v[20:23]
    ds_read_b64_tr_b16 v[102:103], v129 offset:41984
    s_add_u32 s26, s24, 0x240000
    s_add_u32 m0, s29, 0x12000
    s_nop 0
    buffer_load_dwordx4 v136, s[16:19], s26 offen lds
    s_waitcnt lgkmcnt(12)
    v_mfma_f32_16x16x32_bf16 v[24:27], v[76:79], a[48:51], v[24:27]
    ds_read_b64_tr_b16 v[104:105], v130 offset:40960
    v_mfma_f32_16x16x32_bf16 v[28:31], v[76:79], a[112:115], v[28:31]
    ds_read_b64_tr_b16 v[106:107], v130 offset:41984
    s_add_u32 s26, s24, 0x260000
    s_add_u32 m0, s29, 0x13000
    s_nop 0
    buffer_load_dwordx4 v136, s[16:19], s26 offen lds
    s_waitcnt lgkmcnt(12)
    v_mfma_f32_16x16x32_bf16 v[32:35], v[80:83], a[48:51], v[32:35]
    ds_read_b64_tr_b16 v[108:109], v131 offset:40960
    v_mfma_f32_16x16x32_bf16 v[36:39], v[80:83], a[112:115], v[36:39]
    ds_read_b64_tr_b16 v[110:111], v131 offset:41984
    s_add_u32 s26, s24, 0x280000
    s_add_u32 m0, s29, 0x14000
    s_nop 0
    buffer_load_dwordx4 v136, s[16:19], s26 offen lds
    s_waitcnt lgkmcnt(12)
    v_mfma_f32_16x16x32_bf16 v[40:43], v[84:87], a[48:51], v[40:43]
    ds_read_b64_tr_b16 v[112:113], v132 offset:40960
    v_mfma_f32_16x16x32_bf16 v[44:47], v[84:87], a[112:115], v[44:47]
    ds_read_b64_tr_b16 v[114:115], v132 offset:41984
    s_add_u32 s26, s24, 0x2a0000
    s_add_u32 m0, s29, 0x15000
    s_nop 0
    buffer_load_dwordx4 v136, s[16:19], s26 offen lds
    s_waitcnt lgkmcnt(12)
    v_mfma_f32_16x16x32_bf16 v[48:51], v[88:91], a[48:51], v[48:51]
    ds_read_b64_tr_b16 v[116:117], v133 offset:40960
    v_mfma_f32_16x16x32_bf16 v[52:55], v[88:91], a[112:115], v[52:55]
    ds_read_b64_tr_b16 v[118:119], v133 offset:41984
    s_add_u32 s26, s24, 0x2c0000
    s_add_u32 m0, s29, 0x16000
    s_nop 0
    buffer_load_dwordx4 v136, s[16:19], s26 offen lds
    s_waitcnt lgkmcnt(12)
    v_mfma_f32_16x16x32_bf16 v[56:59], v[92:95], a[48:51], v[56:59]
    ds_read_b64_tr_b16 v[120:121], v134 offset:40960
    v_mfma_f32_16x16x32_bf16 v[60:63], v[92:95], a[112:115], v[60:63]
    ds_read_b64_tr_b16 v[122:123], v134 offset:41984
    s_add_u32 s26, s24, 0x2e0000
    s_add_u32 m0, s29, 0x17000
    s_nop 0
    buffer_load_dwordx4 v136, s[16:19], s26 offen lds
    s_waitcnt lgkmcnt(12)
    v_mfma_f32_16x16x32_bf16 v[0:3], v[96:99], a[52:55], v[0:3]
    ds_read_b64_tr_b16 v[124:125], v135 offset:40960
    v_mfma_f32_16x16x32_bf16 v[4:7], v[96:99], a[116:119], v[4:7]
    ds_read_b64_tr_b16 v[126:127], v135 offset:41984
    s_waitcnt lgkmcnt(12)
    v_mfma_f32_16x16x32_bf16 v[8:11], v[100:103], a[52:55], v[8:11]
    ds_read_b64_tr_b16 v[64:65], v128 offset:49152
    v_mfma_f32_16x16x32_bf16 v[12:15], v[100:103], a[116:119], v[12:15]
    ds_read_b64_tr_b16 v[66:67], v128 offset:50176
    s_waitcnt lgkmcnt(12)
    v_mfma_f32_16x16x32_bf16 v[16:19], v[104:107], a[52:55], v[16:19]
    ds_read_b64_tr_b16 v[68:69], v129 offset:49152
    v_mfma_f32_16x16x32_bf16 v[20:23], v[104:107], a[116:119], v[20:23]
    ds_read_b64_tr_b16 v[70:71], v129 offset:50176
    s_waitcnt lgkmcnt(12)
    v_mfma_f32_16x16x32_bf16 v[24:27], v[108:111], a[52:55], v[24:27]
    ds_read_b64_tr_b16 v[72:73], v130 offset:49152
    v_mfma_f32_16x16x32_bf16 v[28:31], v[108:111], a[116:119], v[28:31]
    ds_read_b64_tr_b16 v[74:75], v130 offset:50176
    s_waitcnt lgkmcnt(12)
    v_mfma_f32_16x16x32_bf16 v[32:35], v[112:115], a[52:55], v[32:35]
    ds_read_b64_tr_b16 v[76:77], v131 offset:49152
    v_mfma_f32_16x16x32_bf16 v[36:39], v[112:115], a[116:119], v[36:39]
    ds_read_b64_tr_b16 v[78:79], v131 offset:50176
    s_waitcnt lgkmcnt(12)
    v_mfma_f32_16x16x32_bf16 v[40:43], v[116:119], a[52:55], v[40:43]
    ds_read_b64_tr_b16 v[80:81], v132 offset:49152
    v_mfma_f32_16x16x32_bf16 v[44:47], v[116:119], a[116:119], v[44:47]
    ds_read_b64_tr_b16 v[82:83], v132 offset:50176
    s_waitcnt lgkmcnt(12)
    v_mfma_f32_16x16x32_bf16 v[48:51], v[120:123], a[52:55], v[48:51]
    ds_read_b64_tr_b16 v[84:85], v133 offset:49152
    v_mfma_f32_16x16x32_bf16 v[52:55], v[120:123], a[116:119], v[52:55]
    ds_read_b64_tr_b16 v[86:87], v133 offset:50176
    s_waitcnt lgkmcnt(12)
    v_mfma_f32_16x16x32_bf16 v[56:59], v[124:127], a[52:55], v[56:59]
    ds_read_b64_tr_b16 v[88:89], v134 offset:49152
    v_mfma_f32_16x16x32_bf16 v[60:63], v[124:127], a[116:119], v[60:63]
    ds_read_b64_tr_b16 v[90:91], v134 offset:50176
    s_waitcnt lgkmcnt(12)
    v_mfma_f32_16x16x32_bf16 v[0:3], v[64:67], a[56:59], v[0:3]
    ds_read_b64_tr_b16 v[92:93], v135 offset:49152
    v_mfma_f32_16x16x32_bf16 v[4:7], v[64:67], a[120:123], v[4:7]
    ds_read_b64_tr_b16 v[94:95], v135 offset:50176
    s_waitcnt lgkmcnt(12)
    v_mfma_f32_16x16x32_bf16 v[8:11], v[68:71], a[56:59], v[8:11]
    ds_read_b64_tr_b16 v[96:97], v128 offset:57344
    v_mfma_f32_16x16x32_bf16 v[12:15], v[68:71], a[120:123], v[12:15]
    ds_read_b64_tr_b16 v[98:99], v128 offset:58368
    s_waitcnt lgkmcnt(12)
    v_mfma_f32_16x16x32_bf16 v[16:19], v[72:75], a[56:59], v[16:19]
    ds_read_b64_tr_b16 v[100:101], v129 offset:57344
    v_mfma_f32_16x16x32_bf16 v[20:23], v[72:75], a[120:123], v[20:23]
    ds_read_b64_tr_b16 v[102:103], v129 offset:58368
    s_waitcnt lgkmcnt(12)
    v_mfma_f32_16x16x32_bf16 v[24:27], v[76:79], a[56:59], v[24:27]
    ds_read_b64_tr_b16 v[104:105], v130 offset:57344
    v_mfma_f32_16x16x32_bf16 v[28:31], v[76:79], a[120:123], v[28:31]
    ds_read_b64_tr_b16 v[106:107], v130 offset:58368
    s_waitcnt lgkmcnt(12)
    v_mfma_f32_16x16x32_bf16 v[32:35], v[80:83], a[56:59], v[32:35]
    ds_read_b64_tr_b16 v[108:109], v131 offset:57344
    v_mfma_f32_16x16x32_bf16 v[36:39], v[80:83], a[120:123], v[36:39]
    ds_read_b64_tr_b16 v[110:111], v131 offset:58368
    s_waitcnt lgkmcnt(12)
    v_mfma_f32_16x16x32_bf16 v[40:43], v[84:87], a[56:59], v[40:43]
    ds_read_b64_tr_b16 v[112:113], v132 offset:57344
    v_mfma_f32_16x16x32_bf16 v[44:47], v[84:87], a[120:123], v[44:47]
    ds_read_b64_tr_b16 v[114:115], v132 offset:58368
    s_waitcnt lgkmcnt(12)
    v_mfma_f32_16x16x32_bf16 v[48:51], v[88:91], a[56:59], v[48:51]
    ds_read_b64_tr_b16 v[116:117], v133 offset:57344
    v_mfma_f32_16x16x32_bf16 v[52:55], v[88:91], a[120:123], v[52:55]
    ds_read_b64_tr_b16 v[118:119], v133 offset:58368
    s_waitcnt lgkmcnt(12)
    v_mfma_f32_16x16x32_bf16 v[56:59], v[92:95], a[56:59], v[56:59]
    ds_read_b64_tr_b16 v[120:121], v134 offset:57344
    v_mfma_f32_16x16x32_bf16 v[60:63], v[92:95], a[120:123], v[60:63]
    ds_read_b64_tr_b16 v[122:123], v134 offset:58368
    s_waitcnt lgkmcnt(12)
    v_mfma_f32_16x16x32_bf16 v[0:3], v[96:99], a[60:63], v[0:3]
    ds_read_b64_tr_b16 v[124:125], v135 offset:57344
    v_mfma_f32_16x16x32_bf16 v[4:7], v[96:99], a[124:127], v[4:7]
    ds_read_b64_tr_b16 v[126:127], v135 offset:58368
    s_waitcnt lgkmcnt(12)
    v_mfma_f32_16x16x32_bf16 v[8:11], v[100:103], a[60:63], v[8:11]
    v_mfma_f32_16x16x32_bf16 v[12:15], v[100:103], a[124:127], v[12:15]
    s_waitcnt lgkmcnt(10)
    v_mfma_f32_16x16x32_bf16 v[16:19], v[104:107], a[60:63], v[16:19]
    v_mfma_f32_16x16x32_bf16 v[20:23], v[104:107], a[124:127], v[20:23]
    s_waitcnt lgkmcnt(8)
    v_mfma_f32_16x16x32_bf16 v[24:27], v[108:111], a[60:63], v[24:27]
    v_mfma_f32_16x16x32_bf16 v[28:31], v[108:111], a[124:127], v[28:31]
    s_waitcnt lgkmcnt(6)
    v_mfma_f32_16x16x32_bf16 v[32:35], v[112:115], a[60:63], v[32:35]
    v_mfma_f32_16x16x32_bf16 v[36:39], v[112:115], a[124:127], v[36:39]
    s_waitcnt lgkmcnt(4)
    v_mfma_f32_16x16x32_bf16 v[40:43], v[116:119], a[60:63], v[40:43]
    v_mfma_f32_16x16x32_bf16 v[44:47], v[116:119], a[124:127], v[44:47]
    s_waitcnt lgkmcnt(2)
    v_mfma_f32_16x16x32_bf16 v[48:51], v[120:123], a[60:63], v[48:51]
    v_mfma_f32_16x16x32_bf16 v[52:55], v[120:123], a[124:127], v[52:55]
    s_waitcnt lgkmcnt(0)
    v_mfma_f32_16x16x32_bf16 v[56:59], v[124:127], a[60:63], v[56:59]
    v_mfma_f32_16x16x32_bf16 v[60:63], v[124:127], a[124:127], v[60:63]
    v_xor_b32 v128, 0x10000, v128
    v_xor_b32 v129, 0x10000, v129
    v_xor_b32 v130, 0x10000, v130
    v_xor_b32 v131, 0x10000, v131
    v_xor_b32 v132, 0x10000, v132
    v_xor_b32 v133, 0x10000, v133
    v_xor_b32 v134, 0x10000, v134
    v_xor_b32 v135, 0x10000, v135
    v_cvt_pk_bf16_f32 v144, v0, v8
    v_cvt_pk_bf16_f32 v145, v1, v9
    v_cvt_pk_bf16_f32 v146, v2, v10
    v_cvt_pk_bf16_f32 v147, v3, v11
    buffer_store_dwordx4 v[144:147], v137, s[8:11], s25 offen sc1
    v_cvt_pk_bf16_f32 v148, v16, v24
    v_cvt_pk_bf16_f32 v149, v17, v25
    v_cvt_pk_bf16_f32 v150, v18, v26
    v_cvt_pk_bf16_f32 v151, v19, v27
    buffer_store_dwordx4 v[148:151], v137, s[8:11], s25 offen offset:1024 sc1
    v_cvt_pk_bf16_f32 v152, v32, v40
    v_cvt_pk_bf16_f32 v153, v33, v41
    v_cvt_pk_bf16_f32 v154, v34, v42
    v_cvt_pk_bf16_f32 v155, v35, v43
    buffer_store_dwordx4 v[152:155], v137, s[8:11], s25 offen offset:2048 sc1
    v_cvt_pk_bf16_f32 v156, v48, v56
    v_cvt_pk_bf16_f32 v157, v49, v57
    v_cvt_pk_bf16_f32 v158, v50, v58
    v_cvt_pk_bf16_f32 v159, v51, v59
    buffer_store_dwordx4 v[156:159], v137, s[8:11], s25 offen offset:3072 sc1
    v_cvt_pk_bf16_f32 v144, v4, v12
    v_cvt_pk_bf16_f32 v145, v5, v13
    v_cvt_pk_bf16_f32 v146, v6, v14
    v_cvt_pk_bf16_f32 v147, v7, v15
    s_add_u32 s25, s25, 4096
    buffer_store_dwordx4 v[144:147], v137, s[8:11], s25 offen sc1
    v_cvt_pk_bf16_f32 v148, v20, v28
    v_cvt_pk_bf16_f32 v149, v21, v29
    v_cvt_pk_bf16_f32 v150, v22, v30
    v_cvt_pk_bf16_f32 v151, v23, v31
    buffer_store_dwordx4 v[148:151], v137, s[8:11], s25 offen offset:1024 sc1
    v_cvt_pk_bf16_f32 v152, v36, v44
    v_cvt_pk_bf16_f32 v153, v37, v45
    v_cvt_pk_bf16_f32 v154, v38, v46
    v_cvt_pk_bf16_f32 v155, v39, v47
    buffer_store_dwordx4 v[152:155], v137, s[8:11], s25 offen offset:2048 sc1
    v_cvt_pk_bf16_f32 v156, v52, v60
    v_cvt_pk_bf16_f32 v157, v53, v61
    v_cvt_pk_bf16_f32 v158, v54, v62
    v_cvt_pk_bf16_f32 v159, v55, v63
    buffer_store_dwordx4 v[156:159], v137, s[8:11], s25 offen offset:3072 sc1
    s_branch L_p1_next
L_p1_v:
    s_waitcnt vmcnt(16)
    s_barrier
    ds_read_b64_tr_b16 v[64:65], v128
    ds_read_b64_tr_b16 v[66:67], v128 offset:1024
    ds_read_b64_tr_b16 v[68:69], v129
    ds_read_b64_tr_b16 v[70:71], v129 offset:1024
    ds_read_b64_tr_b16 v[72:73], v130
    ds_read_b64_tr_b16 v[74:75], v130 offset:1024
    ds_read_b64_tr_b16 v[76:77], v131
    ds_read_b64_tr_b16 v[78:79], v131 offset:1024
    ds_read_b64_tr_b16 v[80:81], v132
    ds_read_b64_tr_b16 v[82:83], v132 offset:1024
    ds_read_b64_tr_b16 v[84:85], v133
    ds_read_b64_tr_b16 v[86:87], v133 offset:1024
    ds_read_b64_tr_b16 v[88:89], v134
    ds_read_b64_tr_b16 v[90:91], v134 offset:1024
    s_waitcnt lgkmcnt(12)
    v_mfma_f32_16x16x32_bf16 v[0:3], a[0:3], v[64:67], 0
    ds_read_b64_tr_b16 v[92:93], v135
    v_mfma_f32_16x16x32_bf16 v[4:7], a[64:67], v[64:67], 0
    ds_read_b64_tr_b16 v[94:95], v135 offset:1024
    s_add_u32 s26, s24, 0x300000
    s_add_u32 m0, s29, 0x18000
    s_nop 0
    buffer_load_dwordx4 v136, s[16:19], s26 offen lds
    s_waitcnt lgkmcnt(12)
    v_mfma_f32_16x16x32_bf16 v[8:11], a[0:3], v[68:71], 0
    ds_read_b64_tr_b16 v[96:97], v128 offset:8192
    v_mfma_f32_16x16x32_bf16 v[12:15], a[64:67], v[68:71], 0
    ds_read_b64_tr_b16 v[98:99], v128 offset:9216
    s_add_u32 s26, s24, 0x320000
    s_add_u32 m0, s29, 0x19000
    s_nop 0
    buffer_load_dwordx4 v136, s[16:19], s26 offen lds
    s_waitcnt lgkmcnt(12)
    v_mfma_f32_16x16x32_bf16 v[16:19], a[0:3], v[72:75], 0
    ds_read_b64_tr_b16 v[100:101], v129 offset:8192
    v_mfma_f32_16x16x32_bf16 v[20:23], a[64:67], v[72:75], 0
    ds_read_b64_tr_b16 v[102:103], v129 offset:9216
    s_add_u32 s26, s24, 0x340000
    s_add_u32 m0, s29, 0x1a000
    s_nop 0
    buffer_load_dwordx4 v136, s[16:19], s26 offen lds
    s_waitcnt lgkmcnt(12)
    v_mfma_f32_16x16x32_bf16 v[24:27], a[0:3], v[76:79], 0
    ds_read_b64_tr_b16 v[104:105], v130 offset:8192
    v_mfma_f32_16x16x32_bf16 v[28:31], a[64:67], v[76:79], 0
    ds_read_b64_tr_b16 v[106:107], v130 offset:9216
    s_add_u32 s26, s24, 0x360000
    s_add_u32 m0, s29, 0x1b000
    s_nop 0
    buffer_load_dwordx4 v136, s[16:19], s26 offen lds
    s_waitcnt lgkmcnt(12)
    v_mfma_f32_16x16x32_bf16 v[32:35], a[0:3], v[80:83], 0
    ds_read_b64_tr_b16 v[108:109], v131 offset:8192
    v_mfma_f32_16x16x32_bf16 v[36:39], a[64:67], v[80:83], 0
    ds_read_b64_tr_b16 v[110:111], v131 offset:9216
    s_add_u32 s26, s24, 0x380000
    s_add_u32 m0, s29, 0x1c000
    s_nop 0
    buffer_load_dwordx4 v136, s[16:19], s26 offen lds
    s_waitcnt lgkmcnt(12)
    v_mfma_f32_16x16x32_bf16 v[40:43], a[0:3], v[84:87], 0
    ds_read_b64_tr_b16 v[112:113], v132 offset:8192
    v_mfma_f32_16x16x32_bf16 v[44:47], a[64:67], v[84:87], 0
    ds_read_b64_tr_b16 v[114:115], v132 offset:9216
    s_add_u32 s26, s24, 0x3a0000
    s_add_u32 m0, s29, 0x1d000
    s_nop 0
    buffer_load_dwordx4 v136, s[16:19], s26 offen lds
    s_waitcnt lgkmcnt(12)
    v_mfma_f32_16x16x32_bf16 v[48:51], a[0:3], v[88:91], 0
    ds_read_b64_tr_b16 v[116:117], v133 offset:8192
    v_mfma_f32_16x16x32_bf16 v[52:55], a[64:67], v[88:91], 0
    ds_read_b64_tr_b16 v[118:119], v133 offset:9216
    s_add_u32 s26, s24, 0x3c0000
    s_add_u32 m0, s29, 0x1e000
    s_nop 0
    buffer_load_dwordx4 v136, s[16:19], s26 offen lds
    s_waitcnt lgkmcnt(12)
    v_mfma_f32_16x16x32_bf16 v[56:59], a[0:3], v[92:95], 0
    ds_read_b64_tr_b16 v[120:121], v134 offset:8192
    v_mfma_f32_16x16x32_bf16 v[60:63], a[64:67], v[92:95], 0
    ds_read_b64_tr_b16 v[122:123], v134 offset:9216
    s_add_u32 s26, s24, 0x3e0000
    s_add_u32 m0, s29, 0x1f000
    s_nop 0
    buffer_load_dwordx4 v136, s[16:19], s26 offen lds
    s_waitcnt lgkmcnt(12)
    v_mfma_f32_16x16x32_bf16 v[0:3], a[4:7], v[96:99], v[0:3]
    ds_read_b64_tr_b16 v[124:125], v135 offset:8192
    v_mfma_f32_16x16x32_bf16 v[4:7], a[68:71], v[96:99], v[4:7]
    ds_read_b64_tr_b16 v[126:127], v135 offset:9216
    s_waitcnt lgkmcnt(12)
    v_mfma_f32_16x16x32_bf16 v[8:11], a[4:7], v[100:103], v[8:11]
    ds_read_b64_tr_b16 v[64:65], v128 offset:16384
    v_mfma_f32_16x16x32_bf16 v[12:15], a[68:71], v[100:103], v[12:15]
    ds_read_b64_tr_b16 v[66:67], v128 offset:17408
    s_waitcnt lgkmcnt(12)
    v_mfma_f32_16x16x32_bf16 v[16:19], a[4:7], v[104:107], v[16:19]
    ds_read_b64_tr_b16 v[68:69], v129 offset:16384
    v_mfma_f32_16x16x32_bf16 v[20:23], a[68:71], v[104:107], v[20:23]
    ds_read_b64_tr_b16 v[70:71], v129 offset:17408
    s_waitcnt lgkmcnt(12)
    v_mfma_f32_16x16x32_bf16 v[24:27], a[4:7], v[108:111], v[24:27]
    ds_read_b64_tr_b16 v[72:73], v130 offset:16384
    v_mfma_f32_16x16x32_bf16 v[28:31], a[68:71], v[108:111], v[28:31]
    ds_read_b64_tr_b16 v[74:75], v130 offset:17408
    s_waitcnt lgkmcnt(12)
    v_mfma_f32_16x16x32_bf16 v[32:35], a[4:7], v[112:115], v[32:35]
    ds_read_b64_tr_b16 v[76:77], v131 offset:16384
    v_mfma_f32_16x16x32_bf16 v[36:39], a[68:71], v[112:115], v[36:39]
    ds_read_b64_tr_b16 v[78:79], v131 offset:17408
    s_waitcnt lgkmcnt(12)
    v_mfma_f32_16x16x32_bf16 v[40:43], a[4:7], v[116:119], v[40:43]
    ds_read_b64_tr_b16 v[80:81], v132 offset:16384
    v_mfma_f32_16x16x32_bf16 v[44:47], a[68:71], v[116:119], v[44:47]
    ds_read_b64_tr_b16 v[82:83], v132 offset:17408
    s_waitcnt lgkmcnt(12)
    v_mfma_f32_16x16x32_bf16 v[48:51], a[4:7], v[120:123], v[48:51]
    ds_read_b64_tr_b16 v[84:85], v133 offset:16384
    v_mfma_f32_16x16x32_bf16 v[52:55], a[68:71], v[120:123], v[52:55]
    ds_read_b64_tr_b16 v[86:87], v133 offset:17408
    s_waitcnt lgkmcnt(12)
    v_mfma_f32_16x16x32_bf16 v[56:59], a[4:7], v[124:127], v[56:59]
    ds_read_b64_tr_b16 v[88:89], v134 offset:16384
    v_mfma_f32_16x16x32_bf16 v[60:63], a[68:71], v[124:127], v[60:63]
    ds_read_b64_tr_b16 v[90:91], v134 offset:17408
    s_waitcnt lgkmcnt(12)
    v_mfma_f32_16x16x32_bf16 v[0:3], a[8:11], v[64:67], v[0:3]
    ds_read_b64_tr_b16 v[92:93], v135 offset:16384
    v_mfma_f32_16x16x32_bf16 v[4:7], a[72:75], v[64:67], v[4:7]
    ds_read_b64_tr_b16 v[94:95], v135 offset:17408
    s_waitcnt lgkmcnt(12)
    v_mfma_f32_16x16x32_bf16 v[8:11], a[8:11], v[68:71], v[8:11]
    ds_read_b64_tr_b16 v[96:97], v128 offset:24576
    v_mfma_f32_16x16x32_bf16 v[12:15], a[72:75], v[68:71], v[12:15]
    ds_read_b64_tr_b16 v[98:99], v128 offset:25600
    s_waitcnt lgkmcnt(12)
    v_mfma_f32_16x16x32_bf16 v[16:19], a[8:11], v[72:75], v[16:19]
    ds_read_b64_tr_b16 v[100:101], v129 offset:24576
    v_mfma_f32_16x16x32_bf16 v[20:23], a[72:75], v[72:75], v[20:23]
    ds_read_b64_tr_b16 v[102:103], v129 offset:25600
    s_waitcnt lgkmcnt(12)
    v_mfma_f32_16x16x32_bf16 v[24:27], a[8:11], v[76:79], v[24:27]
    ds_read_b64_tr_b16 v[104:105], v130 offset:24576
    v_mfma_f32_16x16x32_bf16 v[28:31], a[72:75], v[76:79], v[28:31]
    ds_read_b64_tr_b16 v[106:107], v130 offset:25600
    s_waitcnt lgkmcnt(12)
    v_mfma_f32_16x16x32_bf16 v[32:35], a[8:11], v[80:83], v[32:35]
    ds_read_b64_tr_b16 v[108:109], v131 offset:24576
    v_mfma_f32_16x16x32_bf16 v[36:39], a[72:75], v[80:83], v[36:39]
    ds_read_b64_tr_b16 v[110:111], v131 offset:25600
    s_waitcnt lgkmcnt(12)
    v_mfma_f32_16x16x32_bf16 v[40:43], a[8:11], v[84:87], v[40:43]
    ds_read_b64_tr_b16 v[112:113], v132 offset:24576
    v_mfma_f32_16x16x32_bf16 v[44:47], a[72:75], v[84:87], v[44:47]
    ds_read_b64_tr_b16 v[114:115], v132 offset:25600
    s_waitcnt lgkmcnt(12)
    v_mfma_f32_16x16x32_bf16 v[48:51], a[8:11], v[88:91], v[48:51]
    ds_read_b64_tr_b16 v[116:117], v133 offset:24576
    v_mfma_f32_16x16x32_bf16 v[52:55], a[72:75], v[88:91], v[52:55]
    ds_read_b64_tr_b16 v[118:119], v133 offset:25600
    s_waitcnt lgkmcnt(12)
    v_mfma_f32_16x16x32_bf16 v[56:59], a[8:11], v[92:95], v[56:59]
    ds_read_b64_tr_b16 v[120:121], v134 offset:24576
    v_mfma_f32_16x16x32_bf16 v[60:63], a[72:75], v[92:95], v[60:63]
    ds_read_b64_tr_b16 v[122:123], v134 offset:25600
    s_waitcnt lgkmcnt(12)
    v_mfma_f32_16x16x32_bf16 v[0:3], a[12:15], v[96:99], v[0:3]
    ds_read_b64_tr_b16 v[124:125], v135 offset:24576
    v_mfma_f32_16x16x32_bf16 v[4:7], a[76:79], v[96:99], v[4:7]
    ds_read_b64_tr_b16 v[126:127], v135 offset:25600
    s_waitcnt lgkmcnt(12)
    v_mfma_f32_16x16x32_bf16 v[8:11], a[12:15], v[100:103], v[8:11]
    v_mfma_f32_16x16x32_bf16 v[12:15], a[76:79], v[100:103], v[12:15]
    s_waitcnt lgkmcnt(10)
    v_mfma_f32_16x16x32_bf16 v[16:19], a[12:15], v[104:107], v[16:19]
    v_mfma_f32_16x16x32_bf16 v[20:23], a[76:79], v[104:107], v[20:23]
    s_waitcnt lgkmcnt(8)
    v_mfma_f32_16x16x32_bf16 v[24:27], a[12:15], v[108:111], v[24:27]
    v_mfma_f32_16x16x32_bf16 v[28:31], a[76:79], v[108:111], v[28:31]
    s_waitcnt lgkmcnt(6)
    v_mfma_f32_16x16x32_bf16 v[32:35], a[12:15], v[112:115], v[32:35]
    v_mfma_f32_16x16x32_bf16 v[36:39], a[76:79], v[112:115], v[36:39]
    s_waitcnt lgkmcnt(4)
    v_mfma_f32_16x16x32_bf16 v[40:43], a[12:15], v[116:119], v[40:43]
    v_mfma_f32_16x16x32_bf16 v[44:47], a[76:79], v[116:119], v[44:47]
    s_waitcnt lgkmcnt(2)
    v_mfma_f32_16x16x32_bf16 v[48:51], a[12:15], v[120:123], v[48:51]
    v_mfma_f32_16x16x32_bf16 v[52:55], a[76:79], v[120:123], v[52:55]
    s_waitcnt lgkmcnt(0)
    v_mfma_f32_16x16x32_bf16 v[56:59], a[12:15], v[124:127], v[56:59]
    v_mfma_f32_16x16x32_bf16 v[60:63], a[76:79], v[124:127], v[60:63]
    s_waitcnt vmcnt(16)
    s_barrier
    ds_read_b64_tr_b16 v[64:65], v128 offset:32768
    ds_read_b64_tr_b16 v[66:67], v128 offset:33792
    ds_read_b64_tr_b16 v[68:69], v129 offset:32768
    ds_read_b64_tr_b16 v[70:71], v129 offset:33792
    ds_read_b64_tr_b16 v[72:73], v130 offset:32768
    ds_read_b64_tr_b16 v[74:75], v130 offset:33792
    ds_read_b64_tr_b16 v[76:77], v131 offset:32768
    ds_read_b64_tr_b16 v[78:79], v131 offset:33792
    ds_read_b64_tr_b16 v[80:81], v132 offset:32768
    ds_read_b64_tr_b16 v[82:83], v132 offset:33792
    ds_read_b64_tr_b16 v[84:85], v133 offset:32768
    ds_read_b64_tr_b16 v[86:87], v133 offset:33792
    ds_read_b64_tr_b16 v[88:89], v134 offset:32768
    ds_read_b64_tr_b16 v[90:91], v134 offset:33792
    s_add_u32 s39, s39, s37
    s_lshr_b32 s26, s39, 5
    s_cmp_eq_u32 s26, 0
    s_cselect_b64 s[16:17], s[62:63], s[60:61]
    s_cmp_eq_u32 s26, 1
    s_cselect_b64 s[16:17], s[64:65], s[16:17]
    s_and_b32 s17, s17, 0xffff
    s_cmp_lt_u32 s39, 96
    s_cselect_b32 s18, 0x400000, 0
    s_and_b32 s24, s39, 31
    s_lshl_b32 s24, s24, 8
    s_waitcnt lgkmcnt(12)
    v_mfma_f32_16x16x32_bf16 v[0:3], a[16:19], v[64:67], v[0:3]
    ds_read_b64_tr_b16 v[92:93], v135 offset:32768
    v_mfma_f32_16x16x32_bf16 v[4:7], a[80:83], v[64:67], v[4:7]
    ds_read_b64_tr_b16 v[94:95], v135 offset:33792
    s_add_u32 s26, s24, 0x0
    s_add_u32 m0, s29, 0x0
    s_nop 0
    buffer_load_dwordx4 v136, s[16:19], s26 offen lds
    s_waitcnt lgkmcnt(12)
    v_mfma_f32_16x16x32_bf16 v[8:11], a[16:19], v[68:71], v[8:11]
    ds_read_b64_tr_b16 v[96:97], v128 offset:40960
    v_mfma_f32_16x16x32_bf16 v[12:15], a[80:83], v[68:71], v[12:15]
    ds_read_b64_tr_b16 v[98:99], v128 offset:41984
    s_add_u32 s26, s24, 0x20000
    s_add_u32 m0, s29, 0x1000
    s_nop 0
    buffer_load_dwordx4 v136, s[16:19], s26 offen lds
    s_waitcnt lgkmcnt(12)
    v_mfma_f32_16x16x32_bf16 v[16:19], a[16:19], v[72:75], v[16:19]
    ds_read_b64_tr_b16 v[100:101], v129 offset:40960
    v_mfma_f32_16x16x32_bf16 v[20:23], a[80:83], v[72:75], v[20:23]
    ds_read_b64_tr_b16 v[102:103], v129 offset:41984
    s_add_u32 s26, s24, 0x40000
    s_add_u32 m0, s29, 0x2000
    s_nop 0
    buffer_load_dwordx4 v136, s[16:19], s26 offen lds
    s_waitcnt lgkmcnt(12)
    v_mfma_f32_16x16x32_bf16 v[24:27], a[16:19], v[76:79], v[24:27]
    ds_read_b64_tr_b16 v[104:105], v130 offset:40960
    v_mfma_f32_16x16x32_bf16 v[28:31], a[80:83], v[76:79], v[28:31]
    ds_read_b64_tr_b16 v[106:107], v130 offset:41984
    s_add_u32 s26, s24, 0x60000
    s_add_u32 m0, s29, 0x3000
    s_nop 0
    buffer_load_dwordx4 v136, s[16:19], s26 offen lds
    s_waitcnt lgkmcnt(12)
    v_mfma_f32_16x16x32_bf16 v[32:35], a[16:19], v[80:83], v[32:35]
    ds_read_b64_tr_b16 v[108:109], v131 offset:40960
    v_mfma_f32_16x16x32_bf16 v[36:39], a[80:83], v[80:83], v[36:39]
    ds_read_b64_tr_b16 v[110:111], v131 offset:41984
    s_add_u32 s26, s24, 0x80000
    s_add_u32 m0, s29, 0x4000
    s_nop 0
    buffer_load_dwordx4 v136, s[16:19], s26 offen lds
    s_waitcnt lgkmcnt(12)
    v_mfma_f32_16x16x32_bf16 v[40:43], a[16:19], v[84:87], v[40:43]
    ds_read_b64_tr_b16 v[112:113], v132 offset:40960
    v_mfma_f32_16x16x32_bf16 v[44:47], a[80:83], v[84:87], v[44:47]
    ds_read_b64_tr_b16 v[114:115], v132 offset:41984
    s_add_u32 s26, s24, 0xa0000
    s_add_u32 m0, s29, 0x5000
    s_nop 0
    buffer_load_dwordx4 v136, s[16:19], s26 offen lds
    s_waitcnt lgkmcnt(12)
    v_mfma_f32_16x16x32_bf16 v[48:51], a[16:19], v[88:91], v[48:51]
    ds_read_b64_tr_b16 v[116:117], v133 offset:40960
    v_mfma_f32_16x16x32_bf16 v[52:55], a[80:83], v[88:91], v[52:55]
    ds_read_b64_tr_b16 v[118:119], v133 offset:41984
    s_add_u32 s26, s24, 0xc0000
    s_add_u32 m0, s29, 0x6000
    s_nop 0
    buffer_load_dwordx4 v136, s[16:19], s26 offen lds
    s_waitcnt lgkmcnt(12)
    v_mfma_f32_16x16x32_bf16 v[56:59], a[16:19], v[92:95], v[56:59]
    ds_read_b64_tr_b16 v[120:121], v134 offset:40960
    v_mfma_f32_16x16x32_bf16 v[60:63], a[80:83], v[92:95], v[60:63]
    ds_read_b64_tr_b16 v[122:123], v134 offset:41984
    s_add_u32 s26, s24, 0xe0000
    s_add_u32 m0, s29, 0x7000
    s_nop 0
    buffer_load_dwordx4 v136, s[16:19], s26 offen lds
    s_waitcnt lgkmcnt(12)
    v_mfma_f32_16x16x32_bf16 v[0:3], a[20:23], v[96:99], v[0:3]
    ds_read_b64_tr_b16 v[124:125], v135 offset:40960
    v_mfma_f32_16x16x32_bf16 v[4:7], a[84:87], v[96:99], v[4:7]
    ds_read_b64_tr_b16 v[126:127], v135 offset:41984
    s_waitcnt lgkmcnt(12)
    v_mfma_f32_16x16x32_bf16 v[8:11], a[20:23], v[100:103], v[8:11]
    ds_read_b64_tr_b16 v[64:65], v128 offset:49152
    v_mfma_f32_16x16x32_bf16 v[12:15], a[84:87], v[100:103], v[12:15]
    ds_read_b64_tr_b16 v[66:67], v128 offset:50176
    s_waitcnt lgkmcnt(12)
    v_mfma_f32_16x16x32_bf16 v[16:19], a[20:23], v[104:107], v[16:19]
    ds_read_b64_tr_b16 v[68:69], v129 offset:49152
    v_mfma_f32_16x16x32_bf16 v[20:23], a[84:87], v[104:107], v[20:23]
    ds_read_b64_tr_b16 v[70:71], v129 offset:50176
    s_waitcnt lgkmcnt(12)
    v_mfma_f32_16x16x32_bf16 v[24:27], a[20:23], v[108:111], v[24:27]
    ds_read_b64_tr_b16 v[72:73], v130 offset:49152
    v_mfma_f32_16x16x32_bf16 v[28:31], a[84:87], v[108:111], v[28:31]
    ds_read_b64_tr_b16 v[74:75], v130 offset:50176
    s_waitcnt lgkmcnt(12)
    v_mfma_f32_16x16x32_bf16 v[32:35], a[20:23], v[112:115], v[32:35]
    ds_read_b64_tr_b16 v[76:77], v131 offset:49152
    v_mfma_f32_16x16x32_bf16 v[36:39], a[84:87], v[112:115], v[36:39]
    ds_read_b64_tr_b16 v[78:79], v131 offset:50176
    s_waitcnt lgkmcnt(12)
    v_mfma_f32_16x16x32_bf16 v[40:43], a[20:23], v[116:119], v[40:43]
    ds_read_b64_tr_b16 v[80:81], v132 offset:49152
    v_mfma_f32_16x16x32_bf16 v[44:47], a[84:87], v[116:119], v[44:47]
    ds_read_b64_tr_b16 v[82:83], v132 offset:50176
    s_waitcnt lgkmcnt(12)
    v_mfma_f32_16x16x32_bf16 v[48:51], a[20:23], v[120:123], v[48:51]
    ds_read_b64_tr_b16 v[84:85], v133 offset:49152
    v_mfma_f32_16x16x32_bf16 v[52:55], a[84:87], v[120:123], v[52:55]
    ds_read_b64_tr_b16 v[86:87], v133 offset:50176
    s_waitcnt lgkmcnt(12)
    v_mfma_f32_16x16x32_bf16 v[56:59], a[20:23], v[124:127], v[56:59]
    ds_read_b64_tr_b16 v[88:89], v134 offset:49152
    v_mfma_f32_16x16x32_bf16 v[60:63], a[84:87], v[124:127], v[60:63]
    ds_read_b64_tr_b16 v[90:91], v134 offset:50176
    s_waitcnt lgkmcnt(12)
    v_mfma_f32_16x16x32_bf16 v[0:3], a[24:27], v[64:67], v[0:3]
    ds_read_b64_tr_b16 v[92:93], v135 offset:49152
    v_mfma_f32_16x16x32_bf16 v[4:7], a[88:91], v[64:67], v[4:7]
    ds_read_b64_tr_b16 v[94:95], v135 offset:50176
    s_waitcnt lgkmcnt(12)
    v_mfma_f32_16x16x32_bf16 v[8:11], a[24:27], v[68:71], v[8:11]
    ds_read_b64_tr_b16 v[96:97], v128 offset:57344
    v_mfma_f32_16x16x32_bf16 v[12:15], a[88:91], v[68:71], v[12:15]
    ds_read_b64_tr_b16 v[98:99], v128 offset:58368
    s_waitcnt lgkmcnt(12)
    v_mfma_f32_16x16x32_bf16 v[16:19], a[24:27], v[72:75], v[16:19]
    ds_read_b64_tr_b16 v[100:101], v129 offset:57344
    v_mfma_f32_16x16x32_bf16 v[20:23], a[88:91], v[72:75], v[20:23]
    ds_read_b64_tr_b16 v[102:103], v129 offset:58368
    s_waitcnt lgkmcnt(12)
    v_mfma_f32_16x16x32_bf16 v[24:27], a[24:27], v[76:79], v[24:27]
    ds_read_b64_tr_b16 v[104:105], v130 offset:57344
    v_mfma_f32_16x16x32_bf16 v[28:31], a[88:91], v[76:79], v[28:31]
    ds_read_b64_tr_b16 v[106:107], v130 offset:58368
    s_waitcnt lgkmcnt(12)
    v_mfma_f32_16x16x32_bf16 v[32:35], a[24:27], v[80:83], v[32:35]
    ds_read_b64_tr_b16 v[108:109], v131 offset:57344
    v_mfma_f32_16x16x32_bf16 v[36:39], a[88:91], v[80:83], v[36:39]
    ds_read_b64_tr_b16 v[110:111], v131 offset:58368
    s_waitcnt lgkmcnt(12)
    v_mfma_f32_16x16x32_bf16 v[40:43], a[24:27], v[84:87], v[40:43]
    ds_read_b64_tr_b16 v[112:113], v132 offset:57344
    v_mfma_f32_16x16x32_bf16 v[44:47], a[88:91], v[84:87], v[44:47]
    ds_read_b64_tr_b16 v[114:115], v132 offset:58368
    s_waitcnt lgkmcnt(12)
    v_mfma_f32_16x16x32_bf16 v[48:51], a[24:27], v[88:91], v[48:51]
    ds_read_b64_tr_b16 v[116:117], v133 offset:57344
    v_mfma_f32_16x16x32_bf16 v[52:55], a[88:91], v[88:91], v[52:55]
    ds_read_b64_tr_b16 v[118:119], v133 offset:58368
    s_waitcnt lgkmcnt(12)
    v_mfma_f32_16x16x32_bf16 v[56:59], a[24:27], v[92:95], v[56:59]
    ds_read_b64_tr_b16 v[120:121], v134 offset:57344
    v_mfma_f32_16x16x32_bf16 v[60:63], a[88:91], v[92:95], v[60:63]
    ds_read_b64_tr_b16 v[122:123], v134 offset:58368
    s_waitcnt lgkmcnt(12)
    v_mfma_f32_16x16x32_bf16 v[0:3], a[28:31], v[96:99], v[0:3]
    ds_read_b64_tr_b16 v[124:125], v135 offset:57344
    v_mfma_f32_16x16x32_bf16 v[4:7], a[92:95], v[96:99], v[4:7]
    ds_read_b64_tr_b16 v[126:127], v135 offset:58368
    s_waitcnt lgkmcnt(12)
    v_mfma_f32_16x16x32_bf16 v[8:11], a[28:31], v[100:103], v[8:11]
    v_mfma_f32_16x16x32_bf16 v[12:15], a[92:95], v[100:103], v[12:15]
    s_waitcnt lgkmcnt(10)
    v_mfma_f32_16x16x32_bf16 v[16:19], a[28:31], v[104:107], v[16:19]
    v_mfma_f32_16x16x32_bf16 v[20:23], a[92:95], v[104:107], v[20:23]
    s_waitcnt lgkmcnt(8)
    v_mfma_f32_16x16x32_bf16 v[24:27], a[28:31], v[108:111], v[24:27]
    v_mfma_f32_16x16x32_bf16 v[28:31], a[92:95], v[108:111], v[28:31]
    s_waitcnt lgkmcnt(6)
    v_mfma_f32_16x16x32_bf16 v[32:35], a[28:31], v[112:115], v[32:35]
    v_mfma_f32_16x16x32_bf16 v[36:39], a[92:95], v[112:115], v[36:39]
    s_waitcnt lgkmcnt(4)
    v_mfma_f32_16x16x32_bf16 v[40:43], a[28:31], v[116:119], v[40:43]
    v_mfma_f32_16x16x32_bf16 v[44:47], a[92:95], v[116:119], v[44:47]
    s_waitcnt lgkmcnt(2)
    v_mfma_f32_16x16x32_bf16 v[48:51], a[28:31], v[120:123], v[48:51]
    v_mfma_f32_16x16x32_bf16 v[52:55], a[92:95], v[120:123], v[52:55]
    s_waitcnt lgkmcnt(0)
    v_mfma_f32_16x16x32_bf16 v[56:59], a[28:31], v[124:127], v[56:59]
    v_mfma_f32_16x16x32_bf16 v[60:63], a[92:95], v[124:127], v[60:63]
    v_xor_b32 v128, 0x10000, v128
    v_xor_b32 v129, 0x10000, v129
    v_xor_b32 v130, 0x10000, v130
    v_xor_b32 v131, 0x10000, v131
    v_xor_b32 v132, 0x10000, v132
    v_xor_b32 v133, 0x10000, v133
    v_xor_b32 v134, 0x10000, v134
    v_xor_b32 v135, 0x10000, v135
    s_waitcnt vmcnt(16)
    s_barrier
    ds_read_b64_tr_b16 v[64:65], v128
    ds_read_b64_tr_b16 v[66:67], v128 offset:1024
    ds_read_b64_tr_b16 v[68:69], v129
    ds_read_b64_tr_b16 v[70:71], v129 offset:1024
    ds_read_b64_tr_b16 v[72:73], v130
    ds_read_b64_tr_b16 v[74:75], v130 offset:1024
    ds_read_b64_tr_b16 v[76:77], v131
    ds_read_b64_tr_b16 v[78:79], v131 offset:1024
    ds_read_b64_tr_b16 v[80:81], v132
    ds_read_b64_tr_b16 v[82:83], v132 offset:1024
    ds_read_b64_tr_b16 v[84:85], v133
    ds_read_b64_tr_b16 v[86:87], v133 offset:1024
    ds_read_b64_tr_b16 v[88:89], v134
    ds_read_b64_tr_b16 v[90:91], v134 offset:1024
    s_cmp_eq_u32 s40, 0
    s_cbranch_scc1 L_nopf_96
    s_cmp_lg_u32 s87, 0
    s_cbranch_scc1 L_modeok_97
    v_readfirstlane_b32 s96, v140
    v_readfirstlane_b32 s97, v141
    s_nop 0
    s_cmp_lg_u32 s97, 0
    s_cselect_b32 s87, s96, 0
    s_cmp_eq_u32 s87, 1
    s_cbranch_scc1 L_modeok_97
    s_mov_b32 s96, 0
L_mode_98:
    buffer_load_dwordx2 v[140:141], off, s[92:95], 0 offset:36 sc1
    s_waitcnt vmcnt(0)
    v_readfirstlane_b32 s87, v140
    v_readfirstlane_b32 s97, v141
    s_nop 0
    s_min_u32 s97, s97, s87
    s_cmp_lg_u32 s97, 0
    s_cbranch_scc1 L_moded_99
    s_sleep 4
    s_add_u32 s96, s96, 1
    s_cmp_lg_u32 s96, 0x100
    s_cbranch_scc1 L_modef_100
    v_mov_b32 v140, 2
    v_mov_b32 v141, 0
    s_mov_b64 exec, 1
    buffer_atomic_cmpswap v[140:141], off, s[92:95], 0 offset:36
    s_mov_b64 exec, -1
L_modef_100:
    s_cmp_lt_u32 s96, 0x10000
    s_cbranch_scc1 L_mode_98
L_moded_99:
    s_cmp_lg_u32 s87, 1
    s_cbranch_scc1 L_fallback
L_modeok_97:
    s_cmp_lg_u32 s100, 0
    s_cbranch_scc1 L_flag_101
    v_mov_b32 v138, 1
    s_mov_b64 exec, 1
    buffer_store_dword v138, off, s[8:11], s40 sc1
    s_mov_b64 exec, -1
L_flag_101:
    s_mov_b32 s40, 0
L_nopf_96:
    s_waitcnt lgkmcnt(12)
    v_mfma_f32_16x16x32_bf16 v[0:3], a[32:35], v[64:67], v[0:3]
    ds_read_b64_tr_b16 v[92:93], v135
    v_mfma_f32_16x16x32_bf16 v[4:7], a[96:99], v[64:67], v[4:7]
    ds_read_b64_tr_b16 v[94:95], v135 offset:1024
    s_add_u32 s26, s24, 0x100000
    s_add_u32 m0, s29, 0x8000
    s_nop 0
    buffer_load_dwordx4 v136, s[16:19], s26 offen lds
    s_waitcnt lgkmcnt(12)
    v_mfma_f32_16x16x32_bf16 v[8:11], a[32:35], v[68:71], v[8:11]
    ds_read_b64_tr_b16 v[96:97], v128 offset:8192
    v_mfma_f32_16x16x32_bf16 v[12:15], a[96:99], v[68:71], v[12:15]
    ds_read_b64_tr_b16 v[98:99], v128 offset:9216
    s_add_u32 s26, s24, 0x120000
    s_add_u32 m0, s29, 0x9000
    s_nop 0
    buffer_load_dwordx4 v136, s[16:19], s26 offen lds
    s_waitcnt lgkmcnt(12)
    v_mfma_f32_16x16x32_bf16 v[16:19], a[32:35], v[72:75], v[16:19]
    ds_read_b64_tr_b16 v[100:101], v129 offset:8192
    v_mfma_f32_16x16x32_bf16 v[20:23], a[96:99], v[72:75], v[20:23]
    ds_read_b64_tr_b16 v[102:103], v129 offset:9216
    s_add_u32 s26, s24, 0x140000
    s_add_u32 m0, s29, 0xa000
    s_nop 0
    buffer_load_dwordx4 v136, s[16:19], s26 offen lds
    s_waitcnt lgkmcnt(12)
    v_mfma_f32_16x16x32_bf16 v[24:27], a[32:35], v[76:79], v[24:27]
    ds_read_b64_tr_b16 v[104:105], v130 offset:8192
    v_mfma_f32_16x16x32_bf16 v[28:31], a[96:99], v[76:79], v[28:31]
    ds_read_b64_tr_b16 v[106:107], v130 offset:9216
    s_add_u32 s26, s24, 0x160000
    s_add_u32 m0, s29, 0xb000
    s_nop 0
    buffer_load_dwordx4 v136, s[16:19], s26 offen lds
    s_waitcnt lgkmcnt(12)
    v_mfma_f32_16x16x32_bf16 v[32:35], a[32:35], v[80:83], v[32:35]
    ds_read_b64_tr_b16 v[108:109], v131 offset:8192
    v_mfma_f32_16x16x32_bf16 v[36:39], a[96:99], v[80:83], v[36:39]
    ds_read_b64_tr_b16 v[110:111], v131 offset:9216
    s_add_u32 s26, s24, 0x180000
    s_add_u32 m0, s29, 0xc000
    s_nop 0
    buffer_load_dwordx4 v136, s[16:19], s26 offen lds
    s_waitcnt lgkmcnt(12)
    v_mfma_f32_16x16x32_bf16 v[40:43], a[32:35], v[84:87], v[40:43]
    ds_read_b64_tr_b16 v[112:113], v132 offset:8192
    v_mfma_f32_16x16x32_bf16 v[44:47], a[96:99], v[84:87], v[44:47]
    ds_read_b64_tr_b16 v[114:115], v132 offset:9216
    s_add_u32 s26, s24, 0x1a0000
    s_add_u32 m0, s29, 0xd000
    s_nop 0
    buffer_load_dwordx4 v136, s[16:19], s26 offen lds
    s_waitcnt lgkmcnt(12)
    v_mfma_f32_16x16x32_bf16 v[48:51], a[32:35], v[88:91], v[48:51]
    ds_read_b64_tr_b16 v[116:117], v133 offset:8192
    v_mfma_f32_16x16x32_bf16 v[52:55], a[96:99], v[88:91], v[52:55]
    ds_read_b64_tr_b16 v[118:119], v133 offset:9216
    s_add_u32 s26, s24, 0x1c0000
    s_add_u32 m0, s29, 0xe000
    s_nop 0
    buffer_load_dwordx4 v136, s[16:19], s26 offen lds
    s_waitcnt lgkmcnt(12)
    v_mfma_f32_16x16x32_bf16 v[56:59], a[32:35], v[92:95], v[56:59]
    ds_read_b64_tr_b16 v[120:121], v134 offset:8192
    v_mfma_f32_16x16x32_bf16 v[60:63], a[96:99], v[92:95], v[60:63]
    ds_read_b64_tr_b16 v[122:123], v134 offset:9216
    s_add_u32 s26, s24, 0x1e0000
    s_add_u32 m0, s29, 0xf000
    s_nop 0
    buffer_load_dwordx4 v136, s[16:19], s26 offen lds
    s_waitcnt lgkmcnt(12)
    v_mfma_f32_16x16x32_bf16 v[0:3], a[36:39], v[96:99], v[0:3]
    ds_read_b64_tr_b16 v[124:125], v135 offset:8192
    v_mfma_f32_16x16x32_bf16 v[4:7], a[100:103], v[96:99], v[4:7]
    ds_read_b64_tr_b16 v[126:127], v135 offset:9216
    s_waitcnt lgkmcnt(12)
    v_mfma_f32_16x16x32_bf16 v[8:11], a[36:39], v[100:103], v[8:11]
    ds_read_b64_tr_b16 v[64:65], v128 offset:16384
    v_mfma_f32_16x16x32_bf16 v[12:15], a[100:103], v[100:103], v[12:15]
    ds_read_b64_tr_b16 v[66:67], v128 offset:17408
    s_waitcnt lgkmcnt(12)
    v_mfma_f32_16x16x32_bf16 v[16:19], a[36:39], v[104:107], v[16:19]
    ds_read_b64_tr_b16 v[68:69], v129 offset:16384
    v_mfma_f32_16x16x32_bf16 v[20:23], a[100:103], v[104:107], v[20:23]
    ds_read_b64_tr_b16 v[70:71], v129 offset:17408
    s_waitcnt lgkmcnt(12)
    v_mfma_f32_16x16x32_bf16 v[24:27], a[36:39], v[108:111], v[24:27]
    ds_read_b64_tr_b16 v[72:73], v130 offset:16384
    v_mfma_f32_16x16x32_bf16 v[28:31], a[100:103], v[108:111], v[28:31]
    ds_read_b64_tr_b16 v[74:75], v130 offset:17408
    s_waitcnt lgkmcnt(12)
    v_mfma_f32_16x16x32_bf16 v[32:35], a[36:39], v[112:115], v[32:35]
    ds_read_b64_tr_b16 v[76:77], v131 offset:16384
    v_mfma_f32_16x16x32_bf16 v[36:39], a[100:103], v[112:115], v[36:39]
    ds_read_b64_tr_b16 v[78:79], v131 offset:17408
    s_waitcnt lgkmcnt(12)
    v_mfma_f32_16x16x32_bf16 v[40:43], a[36:39], v[116:119], v[40:43]
    ds_read_b64_tr_b16 v[80:81], v132 offset:16384
    v_mfma_f32_16x16x32_bf16 v[44:47], a[100:103], v[116:119], v[44:47]
    ds_read_b64_tr_b16 v[82:83], v132 offset:17408
    s_waitcnt lgkmcnt(12)
    v_mfma_f32_16x16x32_bf16 v[48:51], a[36:39], v[120:123], v[48:51]
    ds_read_b64_tr_b16 v[84:85], v133 offset:16384
    v_mfma_f32_16x16x32_bf16 v[52:55], a[100:103], v[120:123], v[52:55]
    ds_read_b64_tr_b16 v[86:87], v133 offset:17408
    s_waitcnt lgkmcnt(12)
    v_mfma_f32_16x16x32_bf16 v[56:59], a[36:39], v[124:127], v[56:59]
    ds_read_b64_tr_b16 v[88:89], v134 offset:16384
    v_mfma_f32_16x16x32_bf16 v[60:63], a[100:103], v[124:127], v[60:63]
    ds_read_b64_tr_b16 v[90:91], v134 offset:17408
    s_waitcnt lgkmcnt(12)
    v_mfma_f32_16x16x32_bf16 v[0:3], a[40:43], v[64:67], v[0:3]
    ds_read_b64_tr_b16 v[92:93], v135 offset:16384
    v_mfma_f32_16x16x32_bf16 v[4:7], a[104:107], v[64:67], v[4:7]
    ds_read_b64_tr_b16 v[94:95], v135 offset:17408
    s_waitcnt lgkmcnt(12)
    v_mfma_f32_16x16x32_bf16 v[8:11], a[40:43], v[68:71], v[8:11]
    ds_read_b64_tr_b16 v[96:97], v128 offset:24576
    v_mfma_f32_16x16x32_bf16 v[12:15], a[104:107], v[68:71], v[12:15]
    ds_read_b64_tr_b16 v[98:99], v128 offset:25600
    s_waitcnt lgkmcnt(12)
    v_mfma_f32_16x16x32_bf16 v[16:19], a[40:43], v[72:75], v[16:19]
    ds_read_b64_tr_b16 v[100:101], v129 offset:24576
    v_mfma_f32_16x16x32_bf16 v[20:23], a[104:107], v[72:75], v[20:23]
    ds_read_b64_tr_b16 v[102:103], v129 offset:25600
    s_waitcnt lgkmcnt(12)
    v_mfma_f32_16x16x32_bf16 v[24:27], a[40:43], v[76:79], v[24:27]
    ds_read_b64_tr_b16 v[104:105], v130 offset:24576
    v_mfma_f32_16x16x32_bf16 v[28:31], a[104:107], v[76:79], v[28:31]
    ds_read_b64_tr_b16 v[106:107], v130 offset:25600
    s_waitcnt lgkmcnt(12)
    v_mfma_f32_16x16x32_bf16 v[32:35], a[40:43], v[80:83], v[32:35]
    ds_read_b64_tr_b16 v[108:109], v131 offset:24576
    v_mfma_f32_16x16x32_bf16 v[36:39], a[104:107], v[80:83], v[36:39]
    ds_read_b64_tr_b16 v[110:111], v131 offset:25600
    s_waitcnt lgkmcnt(12)
    v_mfma_f32_16x16x32_bf16 v[40:43], a[40:43], v[84:87], v[40:43]
    ds_read_b64_tr_b16 v[112:113], v132 offset:24576
    v_mfma_f32_16x16x32_bf16 v[44:47], a[104:107], v[84:87], v[44:47]
    ds_read_b64_tr_b16 v[114:115], v132 offset:25600
    s_waitcnt lgkmcnt(12)
    v_mfma_f32_16x16x32_bf16 v[48:51], a[40:43], v[88:91], v[48:51]
    ds_read_b64_tr_b16 v[116:117], v133 offset:24576
    v_mfma_f32_16x16x32_bf16 v[52:55], a[104:107], v[88:91], v[52:55]
    ds_read_b64_tr_b16 v[118:119], v133 offset:25600
    s_waitcnt lgkmcnt(12)
    v_mfma_f32_16x16x32_bf16 v[56:59], a[40:43], v[92:95], v[56:59]
    ds_read_b64_tr_b16 v[120:121], v134 offset:24576
    v_mfma_f32_16x16x32_bf16 v[60:63], a[104:107], v[92:95], v[60:63]
    ds_read_b64_tr_b16 v[122:123], v134 offset:25600
    s_waitcnt lgkmcnt(12)
    v_mfma_f32_16x16x32_bf16 v[0:3], a[44:47], v[96:99], v[0:3]
    ds_read_b64_tr_b16 v[124:125], v135 offset:24576
    v_mfma_f32_16x16x32_bf16 v[4:7], a[108:111], v[96:99], v[4:7]
    ds_read_b64_tr_b16 v[126:127], v135 offset:25600
    s_waitcnt lgkmcnt(12)
    v_mfma_f32_16x16x32_bf16 v[8:11], a[44:47], v[100:103], v[8:11]
    v_mfma_f32_16x16x32_bf16 v[12:15], a[108:111], v[100:103], v[12:15]
    s_waitcnt lgkmcnt(10)
    v_mfma_f32_16x16x32_bf16 v[16:19], a[44:47], v[104:107], v[16:19]
    v_mfma_f32_16x16x32_bf16 v[20:23], a[108:111], v[104:107], v[20:23]
    s_waitcnt lgkmcnt(8)
    v_mfma_f32_16x16x32_bf16 v[24:27], a[44:47], v[108:111], v[24:27]
    v_mfma_f32_16x16x32_bf16 v[28:31], a[108:111], v[108:111], v[28:31]
    s_waitcnt lgkmcnt(6)
    v_mfma_f32_16x16x32_bf16 v[32:35], a[44:47], v[112:115], v[32:35]
    v_mfma_f32_16x16x32_bf16 v[36:39], a[108:111], v[112:115], v[36:39]
    s_waitcnt lgkmcnt(4)
    v_mfma_f32_16x16x32_bf16 v[40:43], a[44:47], v[116:119], v[40:43]
    v_mfma_f32_16x16x32_bf16 v[44:47], a[108:111], v[116:119], v[44:47]
    s_waitcnt lgkmcnt(2)
    v_mfma_f32_16x16x32_bf16 v[48:51], a[44:47], v[120:123], v[48:51]
    v_mfma_f32_16x16x32_bf16 v[52:55], a[108:111], v[120:123], v[52:55]
    s_waitcnt lgkmcnt(0)
    v_mfma_f32_16x16x32_bf16 v[56:59], a[44:47], v[124:127], v[56:59]
    v_mfma_f32_16x16x32_bf16 v[60:63], a[108:111], v[124:127], v[60:63]
    s_waitcnt vmcnt(16)
    s_barrier
    ds_read_b64_tr_b16 v[64:65], v128 offset:32768
    ds_read_b64_tr_b16 v[66:67], v128 offset:33792
    ds_read_b64_tr_b16 v[68:69], v129 offset:32768
    ds_read_b64_tr_b16 v[70:71], v129 offset:33792
    ds_read_b64_tr_b16 v[72:73], v130 offset:32768
    ds_read_b64_tr_b16 v[74:75], v130 offset:33792
    ds_read_b64_tr_b16 v[76:77], v131 offset:32768
    ds_read_b64_tr_b16 v[78:79], v131 offset:33792
    ds_read_b64_tr_b16 v[80:81], v132 offset:32768
    ds_read_b64_tr_b16 v[82:83], v132 offset:33792
    ds_read_b64_tr_b16 v[84:85], v133 offset:32768
    ds_read_b64_tr_b16 v[86:87], v133 offset:33792
    ds_read_b64_tr_b16 v[88:89], v134 offset:32768
    ds_read_b64_tr_b16 v[90:91], v134 offset:33792
    s_waitcnt lgkmcnt(12)
    v_mfma_f32_16x16x32_bf16 v[0:3], a[48:51], v[64:67], v[0:3]
    ds_read_b64_tr_b16 v[92:93], v135 offset:32768
    v_mfma_f32_16x16x32_bf16 v[4:7], a[112:115], v[64:67], v[4:7]
    ds_read_b64_tr_b16 v[94:95], v135 offset:33792
    s_add_u32 s26, s24, 0x200000
    s_add_u32 m0, s29, 0x10000
    s_nop 0
    buffer_load_dwordx4 v136, s[16:19], s26 offen lds
    s_waitcnt lgkmcnt(12)
    v_mfma_f32_16x16x32_bf16 v[8:11], a[48:51], v[68:71], v[8:11]
    ds_read_b64_tr_b16 v[96:97], v128 offset:40960
    v_mfma_f32_16x16x32_bf16 v[12:15], a[112:115], v[68:71], v[12:15]
    ds_read_b64_tr_b16 v[98:99], v128 offset:41984
    s_add_u32 s26, s24, 0x220000
    s_add_u32 m0, s29, 0x11000
    s_nop 0
    buffer_load_dwordx4 v136, s[16:19], s26 offen lds
    s_waitcnt lgkmcnt(12)
    v_mfma_f32_16x16x32_bf16 v[16:19], a[48:51], v[72:75], v[16:19]
    ds_read_b64_tr_b16 v[100:101], v129 offset:40960
    v_mfma_f32_16x16x32_bf16 v[20:23], a[112:115], v[72:75], v[20:23]
    ds_read_b64_tr_b16 v[102:103], v129 offset:41984
    s_add_u32 s26, s24, 0x240000
    s_add_u32 m0, s29, 0x12000
    s_nop 0
    buffer_load_dwordx4 v136, s[16:19], s26 offen lds
    s_waitcnt lgkmcnt(12)
    v_mfma_f32_16x16x32_bf16 v[24:27], a[48:51], v[76:79], v[24:27]
    ds_read_b64_tr_b16 v[104:105], v130 offset:40960
    v_mfma_f32_16x16x32_bf16 v[28:31], a[112:115], v[76:79], v[28:31]
    ds_read_b64_tr_b16 v[106:107], v130 offset:41984
    s_add_u32 s26, s24, 0x260000
    s_add_u32 m0, s29, 0x13000
    s_nop 0
    buffer_load_dwordx4 v136, s[16:19], s26 offen lds
    s_waitcnt lgkmcnt(12)
    v_mfma_f32_16x16x32_bf16 v[32:35], a[48:51], v[80:83], v[32:35]
    ds_read_b64_tr_b16 v[108:109], v131 offset:40960
    v_mfma_f32_16x16x32_bf16 v[36:39], a[112:115], v[80:83], v[36:39]
    ds_read_b64_tr_b16 v[110:111], v131 offset:41984
    s_add_u32 s26, s24, 0x280000
    s_add_u32 m0, s29, 0x14000
    s_nop 0
    buffer_load_dwordx4 v136, s[16:19], s26 offen lds
    s_waitcnt lgkmcnt(12)
    v_mfma_f32_16x16x32_bf16 v[40:43], a[48:51], v[84:87], v[40:43]
    ds_read_b64_tr_b16 v[112:113], v132 offset:40960
    v_mfma_f32_16x16x32_bf16 v[44:47], a[112:115], v[84:87], v[44:47]
    ds_read_b64_tr_b16 v[114:115], v132 offset:41984
    s_add_u32 s26, s24, 0x2a0000
    s_add_u32 m0, s29, 0x15000
    s_nop 0
    buffer_load_dwordx4 v136, s[16:19], s26 offen lds
    s_waitcnt lgkmcnt(12)
    v_mfma_f32_16x16x32_bf16 v[48:51], a[48:51], v[88:91], v[48:51]
    ds_read_b64_tr_b16 v[116:117], v133 offset:40960
    v_mfma_f32_16x16x32_bf16 v[52:55], a[112:115], v[88:91], v[52:55]
    ds_read_b64_tr_b16 v[118:119], v133 offset:41984
    s_add_u32 s26, s24, 0x2c0000
    s_add_u32 m0, s29, 0x16000
    s_nop 0
    buffer_load_dwordx4 v136, s[16:19], s26 offen lds
    s_waitcnt lgkmcnt(12)
    v_mfma_f32_16x16x32_bf16 v[56:59], a[48:51], v[92:95], v[56:59]
    ds_read_b64_tr_b16 v[120:121], v134 offset:40960
    v_mfma_f32_16x16x32_bf16 v[60:63], a[112:115], v[92:95], v[60:63]
    ds_read_b64_tr_b16 v[122:123], v134 offset:41984
    s_add_u32 s26, s24, 0x2e0000
    s_add_u32 m0, s29, 0x17000
    s_nop 0
    buffer_load_dwordx4 v136, s[16:19], s26 offen lds
    s_waitcnt lgkmcnt(12)
    v_mfma_f32_16x16x32_bf16 v[0:3], a[52:55], v[96:99], v[0:3]
    ds_read_b64_tr_b16 v[124:125], v135 offset:40960
    v_mfma_f32_16x16x32_bf16 v[4:7], a[116:119], v[96:99], v[4:7]
    ds_read_b64_tr_b16 v[126:127], v135 offset:41984
    s_waitcnt lgkmcnt(12)
    v_mfma_f32_16x16x32_bf16 v[8:11], a[52:55], v[100:103], v[8:11]
    ds_read_b64_tr_b16 v[64:65], v128 offset:49152
    v_mfma_f32_16x16x32_bf16 v[12:15], a[116:119], v[100:103], v[12:15]
    ds_read_b64_tr_b16 v[66:67], v128 offset:50176
    s_waitcnt lgkmcnt(12)
    v_mfma_f32_16x16x32_bf16 v[16:19], a[52:55], v[104:107], v[16:19]
    ds_read_b64_tr_b16 v[68:69], v129 offset:49152
    v_mfma_f32_16x16x32_bf16 v[20:23], a[116:119], v[104:107], v[20:23]
    ds_read_b64_tr_b16 v[70:71], v129 offset:50176
    s_waitcnt lgkmcnt(12)
    v_mfma_f32_16x16x32_bf16 v[24:27], a[52:55], v[108:111], v[24:27]
    ds_read_b64_tr_b16 v[72:73], v130 offset:49152
    v_mfma_f32_16x16x32_bf16 v[28:31], a[116:119], v[108:111], v[28:31]
    ds_read_b64_tr_b16 v[74:75], v130 offset:50176
    s_waitcnt lgkmcnt(12)
    v_mfma_f32_16x16x32_bf16 v[32:35], a[52:55], v[112:115], v[32:35]
    ds_read_b64_tr_b16 v[76:77], v131 offset:49152
    v_mfma_f32_16x16x32_bf16 v[36:39], a[116:119], v[112:115], v[36:39]
    ds_read_b64_tr_b16 v[78:79], v131 offset:50176
    s_waitcnt lgkmcnt(12)
    v_mfma_f32_16x16x32_bf16 v[40:43], a[52:55], v[116:119], v[40:43]
    ds_read_b64_tr_b16 v[80:81], v132 offset:49152
    v_mfma_f32_16x16x32_bf16 v[44:47], a[116:119], v[116:119], v[44:47]
    ds_read_b64_tr_b16 v[82:83], v132 offset:50176
    s_waitcnt lgkmcnt(12)
    v_mfma_f32_16x16x32_bf16 v[48:51], a[52:55], v[120:123], v[48:51]
    ds_read_b64_tr_b16 v[84:85], v133 offset:49152
    v_mfma_f32_16x16x32_bf16 v[52:55], a[116:119], v[120:123], v[52:55]
    ds_read_b64_tr_b16 v[86:87], v133 offset:50176
    s_waitcnt lgkmcnt(12)
    v_mfma_f32_16x16x32_bf16 v[56:59], a[52:55], v[124:127], v[56:59]
    ds_read_b64_tr_b16 v[88:89], v134 offset:49152
    v_mfma_f32_16x16x32_bf16 v[60:63], a[116:119], v[124:127], v[60:63]
    ds_read_b64_tr_b16 v[90:91], v134 offset:50176
    s_waitcnt lgkmcnt(12)
    v_mfma_f32_16x16x32_bf16 v[0:3], a[56:59], v[64:67], v[0:3]
    ds_read_b64_tr_b16 v[92:93], v135 offset:49152
    v_mfma_f32_16x16x32_bf16 v[4:7], a[120:123], v[64:67], v[4:7]
    ds_read_b64_tr_b16 v[94:95], v135 offset:50176
    s_waitcnt lgkmcnt(12)
    v_mfma_f32_16x16x32_bf16 v[8:11], a[56:59], v[68:71], v[8:11]
    ds_read_b64_tr_b16 v[96:97], v128 offset:57344
    v_mfma_f32_16x16x32_bf16 v[12:15], a[120:123], v[68:71], v[12:15]
    ds_read_b64_tr_b16 v[98:99], v128 offset:58368
    s_waitcnt lgkmcnt(12)
    v_mfma_f32_16x16x32_bf16 v[16:19], a[56:59], v[72:75], v[16:19]
    ds_read_b64_tr_b16 v[100:101], v129 offset:57344
    v_mfma_f32_16x16x32_bf16 v[20:23], a[120:123], v[72:75], v[20:23]
    ds_read_b64_tr_b16 v[102:103], v129 offset:58368
    s_waitcnt lgkmcnt(12)
    v_mfma_f32_16x16x32_bf16 v[24:27], a[56:59], v[76:79], v[24:27]
    ds_read_b64_tr_b16 v[104:105], v130 offset:57344
    v_mfma_f32_16x16x32_bf16 v[28:31], a[120:123], v[76:79], v[28:31]
    ds_read_b64_tr_b16 v[106:107], v130 offset:58368
    s_waitcnt lgkmcnt(12)
    v_mfma_f32_16x16x32_bf16 v[32:35], a[56:59], v[80:83], v[32:35]
    ds_read_b64_tr_b16 v[108:109], v131 offset:57344
    v_mfma_f32_16x16x32_bf16 v[36:39], a[120:123], v[80:83], v[36:39]
    ds_read_b64_tr_b16 v[110:111], v131 offset:58368
    s_waitcnt lgkmcnt(12)
    v_mfma_f32_16x16x32_bf16 v[40:43], a[56:59], v[84:87], v[40:43]
    ds_read_b64_tr_b16 v[112:113], v132 offset:57344
    v_mfma_f32_16x16x32_bf16 v[44:47], a[120:123], v[84:87], v[44:47]
    ds_read_b64_tr_b16 v[114:115], v132 offset:58368
    s_waitcnt lgkmcnt(12)
    v_mfma_f32_16x16x32_bf16 v[48:51], a[56:59], v[88:91], v[48:51]
    ds_read_b64_tr_b16 v[116:117], v133 offset:57344
    v_mfma_f32_16x16x32_bf16 v[52:55], a[120:123], v[88:91], v[52:55]
    ds_read_b64_tr_b16 v[118:119], v133 offset:58368
    s_waitcnt lgkmcnt(12)
    v_mfma_f32_16x16x32_bf16 v[56:59], a[56:59], v[92:95], v[56:59]
    ds_read_b64_tr_b16 v[120:121], v134 offset:57344
    v_mfma_f32_16x16x32_bf16 v[60:63], a[120:123], v[92:95], v[60:63]
    ds_read_b64_tr_b16 v[122:123], v134 offset:58368
    s_waitcnt lgkmcnt(12)
    v_mfma_f32_16x16x32_bf16 v[0:3], a[60:63], v[96:99], v[0:3]
    ds_read_b64_tr_b16 v[124:125], v135 offset:57344
    v_mfma_f32_16x16x32_bf16 v[4:7], a[124:127], v[96:99], v[4:7]
    ds_read_b64_tr_b16 v[126:127], v135 offset:58368
    s_waitcnt lgkmcnt(12)
    v_mfma_f32_16x16x32_bf16 v[8:11], a[60:63], v[100:103], v[8:11]
    v_mfma_f32_16x16x32_bf16 v[12:15], a[124:127], v[100:103], v[12:15]
    s_waitcnt lgkmcnt(10)
    v_mfma_f32_16x16x32_bf16 v[16:19], a[60:63], v[104:107], v[16:19]
    v_mfma_f32_16x16x32_bf16 v[20:23], a[124:127], v[104:107], v[20:23]
    s_waitcnt lgkmcnt(8)
    v_mfma_f32_16x16x32_bf16 v[24:27], a[60:63], v[108:111], v[24:27]
    v_mfma_f32_16x16x32_bf16 v[28:31], a[124:127], v[108:111], v[28:31]
    s_waitcnt lgkmcnt(6)
    v_mfma_f32_16x16x32_bf16 v[32:35], a[60:63], v[112:115], v[32:35]
    v_mfma_f32_16x16x32_bf16 v[36:39], a[124:127], v[112:115], v[36:39]
    s_waitcnt lgkmcnt(4)
    v_mfma_f32_16x16x32_bf16 v[40:43], a[60:63], v[116:119], v[40:43]
    v_mfma_f32_16x16x32_bf16 v[44:47], a[124:127], v[116:119], v[44:47]
    s_waitcnt lgkmcnt(2)
    v_mfma_f32_16x16x32_bf16 v[48:51], a[60:63], v[120:123], v[48:51]
    v_mfma_f32_16x16x32_bf16 v[52:55], a[124:127], v[120:123], v[52:55]
    s_waitcnt lgkmcnt(0)
    v_mfma_f32_16x16x32_bf16 v[56:59], a[60:63], v[124:127], v[56:59]
    v_mfma_f32_16x16x32_bf16 v[60:63], a[124:127], v[124:127], v[60:63]
    v_xor_b32 v128, 0x10000, v128
    v_xor_b32 v129, 0x10000, v129
    v_xor_b32 v130, 0x10000, v130
    v_xor_b32 v131, 0x10000, v131
    v_xor_b32 v132, 0x10000, v132
    v_xor_b32 v133, 0x10000, v133
    v_xor_b32 v134, 0x10000, v134
    v_xor_b32 v135, 0x10000, v135
    v_cvt_pk_bf16_f32 v144, v0, v1
    v_cvt_pk_bf16_f32 v145, v2, v3
    v_cvt_pk_bf16_f32 v146, v4, v5
    v_cvt_pk_bf16_f32 v147, v6, v7
    buffer_store_dwordx4 v[144:147], v137, s[8:11], s25 offen sc1
    v_cvt_pk_bf16_f32 v148, v8, v9
    v_cvt_pk_bf16_f32 v149, v10, v11
    v_cvt_pk_bf16_f32 v150, v12, v13
    v_cvt_pk_bf16_f32 v151, v14, v15
    buffer_store_dwordx4 v[148:151], v137, s[8:11], s25 offen offset:1024 sc1
    v_cvt_pk_bf16_f32 v152, v16, v17
    v_cvt_pk_bf16_f32 v153, v18, v19
    v_cvt_pk_bf16_f32 v154, v20, v21
    v_cvt_pk_bf16_f32 v155, v22, v23
    buffer_store_dwordx4 v[152:155], v137, s[8:11], s25 offen offset:2048 sc1
    v_cvt_pk_bf16_f32 v156, v24, v25
    v_cvt_pk_bf16_f32 v157, v26, v27
    v_cvt_pk_bf16_f32 v158, v28, v29
    v_cvt_pk_bf16_f32 v159, v30, v31
    buffer_store_dwordx4 v[156:159], v137, s[8:11], s25 offen offset:3072 sc1
    v_cvt_pk_bf16_f32 v144, v32, v33
    v_cvt_pk_bf16_f32 v145, v34, v35
    v_cvt_pk_bf16_f32 v146, v36, v37
    v_cvt_pk_bf16_f32 v147, v38, v39
    s_add_u32 s25, s25, 4096
    buffer_store_dwordx4 v[144:147], v137, s[8:11], s25 offen sc1
    v_cvt_pk_bf16_f32 v148, v40, v41
    v_cvt_pk_bf16_f32 v149, v42, v43
    v_cvt_pk_bf16_f32 v150, v44, v45
    v_cvt_pk_bf16_f32 v151, v46, v47
    buffer_store_dwordx4 v[148:151], v137, s[8:11], s25 offen offset:1024 sc1
    v_cvt_pk_bf16_f32 v152, v48, v49
    v_cvt_pk_bf16_f32 v153, v50, v51
    v_cvt_pk_bf16_f32 v154, v52, v53
    v_cvt_pk_bf16_f32 v155, v54, v55
    buffer_store_dwordx4 v[152:155], v137, s[8:11], s25 offen offset:2048 sc1
    v_cvt_pk_bf16_f32 v156, v56, v57
    v_cvt_pk_bf16_f32 v157, v58, v59
    v_cvt_pk_bf16_f32 v158, v60, v61
    v_cvt_pk_bf16_f32 v159, v62, v63
    buffer_store_dwordx4 v[156:159], v137, s[8:11], s25 offen offset:3072 sc1
    s_cmp_lg_u32 s20, 15
    s_cbranch_scc1 L_p1_next
    v_mov_b32 v0, -1
    v_mov_b32 v1, -1
    v_mov_b32 v2, -1
    v_mov_b32 v3, -1
    s_sub_u32 s26, s25, 0x2001000
    s_lshr_b32 s26, s26, 1
    s_add_u32 s26, s26, 0x240000
    buffer_store_dwordx4 v[0:3], v137, s[8:11], s26 offen sc1
    buffer_store_dwordx4 v[0:3], v137, s[8:11], s26 offen offset:1024 sc1
    buffer_store_dwordx4 v[0:3], v137, s[8:11], s26 offen offset:2048 sc1
    buffer_store_dwordx4 v[0:3], v137, s[8:11], s26 offen offset:3072 sc1
    s_nop 1
L_p1_next:
    s_add_u32 s80, s80, 1
    s_lshl_b32 s40, s38, 4
    s_add_u32 s40, s40, s20
    s_lshl_b32 s40, s40, 2
    s_add_u32 s40, s40, 0x2000
    s_sub_u32 s44, s25, 4095
    s_add_u32 s38, s38, s37
    s_branch L_p1_unit
L_p1_end:
    s_waitcnt vmcnt(0)
    s_barrier
    s_cmp_eq_u32 s40, 0
    s_cbranch_scc1 L_nopf_102
    s_cmp_lg_u32 s87, 0
    s_cbranch_scc1 L_modeok_103
    v_readfirstlane_b32 s96, v140
    v_readfirstlane_b32 s97, v141
    s_nop 0
    s_cmp_lg_u32 s97, 0
    s_cselect_b32 s87, s96, 0
    s_cmp_eq_u32 s87, 1
    s_cbranch_scc1 L_modeok_103
    s_mov_b32 s96, 0
L_mode_104:
    buffer_load_dwordx2 v[140:141], off, s[92:95], 0 offset:36 sc1
    s_waitcnt vmcnt(0)
    v_readfirstlane_b32 s87, v140
    v_readfirstlane_b32 s97, v141
    s_nop 0
    s_min_u32 s97, s97, s87
    s_cmp_lg_u32 s97, 0
    s_cbranch_scc1 L_moded_105
    s_sleep 4
    s_add_u32 s96, s96, 1
    s_cmp_lg_u32 s96, 0x100
    s_cbranch_scc1 L_modef_106
    v_mov_b32 v140, 2
    v_mov_b32 v141, 0
    s_mov_b64 exec, 1
    buffer_atomic_cmpswap v[140:141], off, s[92:95], 0 offset:36
    s_mov_b64 exec, -1
L_modef_106:
    s_cmp_lt_u32 s96, 0x10000
    s_cbranch_scc1 L_mode_104
L_moded_105:
    s_cmp_lg_u32 s87, 1
    s_cbranch_scc1 L_fallback
L_modeok_103:
    s_cmp_lg_u32 s100, 0
    s_cbranch_scc1 L_flag_107
    v_mov_b32 v138, 1
    s_mov_b64 exec, 1
    buffer_store_dword v138, off, s[8:11], s40 sc1
    s_mov_b64 exec, -1
L_flag_107:
    s_mov_b32 s40, 0
L_nopf_102:
    s_cmp_lg_u32 s41, 0
    s_cbranch_scc1 L_p1done
    s_mov_b32 s41, 1
    s_mul_i32 s22, s101, 171
    s_lshr_b32 s22, s22, 11
    s_mul_i32 s26, s22, 12
    s_sub_u32 s20, s101, s26
    s_add_u32 s20, s20, 4
    s_mul_i32 s27, s101, 683
    s_lshr_b32 s27, s27, 11
    s_mul_i32 s26, s27, 3
    s_sub_u32 s26, s101, s26
    s_cmp_eq_u32 s26, 2
    s_cselect_b32 s28, 10, 11
    s_cmp_ge_u32 s101, 192
    s_cselect_b32 s20, s26, s20
    s_cselect_b32 s22, s27, s22
    s_cselect_b32 s37, s28, 16
    s_branch L_p1_pass
L_p1done:
    v_mbcnt_lo_u32_b32 v0, -1, 0
    v_mbcnt_hi_u32_b32 v0, -1, v0
    s_lshl_b32 s96, s100, 6
    v_add_u32 v0, s96, v0
    s_and_b32 s20, s101, 15
    s_lshr_b32 s22, s101, 4
    s_mov_b32 s23, 14
    v_mov_b32 v1, 0
    s_lshl_b32 s24, s20, 7
    s_add_u32 s24, s24, 0x1000
    s_mul_i32 s25, s22, 14
    s_lshr_b32 s25, s25, 4
    s_add_u32 s25, s25, 12
    s_cmp_lg_u32 s100, 0
    s_cbranch_scc1 L_polls_110
    s_mov_b32 exec_lo, 0x1
    s_mov_b32 exec_hi, 0
    s_mov_b32 s96, 0
L_poll_108:
    buffer_load_dword v2, v1, s[8:11], s24 offen sc1
    s_waitcnt vmcnt(0)
    v_cmp_gt_u32 vcc, s25, v2
    s_cbranch_vccz L_polld_109
    v_readfirstlane_b32 s97, v2
    s_nop 0
    s_sub_u32 s97, s25, s97
    s_cmp_lt_i32 s97, 3
    s_cbranch_scc1 L_near_111
    s_sleep 40
    s_cmp_lt_i32 s97, 5
    s_cbranch_scc1 L_near_111
    s_sleep 100
L_near_111:
    s_sleep 4
    s_add_u32 s96, s96, 1
    s_cmp_lt_u32 s96, 0x10000
    s_cbranch_scc1 L_poll_108
L_polld_109:
    s_mov_b64 exec, -1
L_polls_110:
    s_barrier
    s_load_dwordx2 s[12:13], s[0:1], 40
    s_waitcnt lgkmcnt(0)
    s_and_b32 s13, s13, 0xffff
    s_mov_b32 s14, 0x400000
    s_mov_b32 s15, 0x20000
    v_lshrrev_b32 v4, 6, v0
    s_nop 0
    v_readfirstlane_b32 s21, v4
    v_and_b32 v1, 63, v0
    v_lshrrev_b32 v2, 4, v1
    v_and_b32 v3, 15, v1
    v_lshrrev_b32 v6, 2, v3
    v_lshlrev_b32 v240, 4, v1
    v_lshlrev_b32 v241, 3, v1
    s_lshl_b32 s27, s21, 10
    s_lshl_b32 s24, s21, 5
    v_xor_b32 v4, s24, v240
    v_add_u32 v8, s27, v4
    v_xor_b32 v9, 128, v8
    v_lshl_add_u32 v4, v2, 2, v6
    v_and_b32 v5, 7, v4
    v_lshlrev_b32 v4, 10, v4
    v_lshl_add_u32 v4, v5, 5, v4
    v_and_b32 v5, 3, v3
    v_lshlrev_b32 v5, 4, v5
    v_xor_b32 v4, v5, v4
    s_lshl_b32 s24, s21, 8
    v_add_u32 v10, s24, v4
    s_lshl_b32 s25, s20, 18
    s_add_u32 s24, s25, 0x0
    s_add_u32 m0, s27, 0x0
    s_nop 0
    buffer_load_dwordx4 v8, s[12:15], s24 offen lds
    s_add_u32 s24, s25, 0x1000
    s_add_u32 m0, s27, 0x1000
    s_nop 0
    buffer_load_dwordx4 v9, s[12:15], s24 offen lds
    s_add_u32 s24, s25, 0x2000
    s_add_u32 m0, s27, 0x2000
    s_nop 0
    buffer_load_dwordx4 v8, s[12:15], s24 offen lds
    s_add_u32 s24, s25, 0x3000
    s_add_u32 m0, s27, 0x3000
    s_nop 0
    buffer_load_dwordx4 v9, s[12:15], s24 offen lds
    s_add_u32 s24, s25, 0x4000
    s_add_u32 m0, s27, 0x4000
    s_nop 0
    buffer_load_dwordx4 v8, s[12:15], s24 offen lds
    s_add_u32 s24, s25, 0x5000
    s_add_u32 m0, s27, 0x5000
    s_nop 0
    buffer_load_dwordx4 v9, s[12:15], s24 offen lds
    s_add_u32 s24, s25, 0x6000
    s_add_u32 m0, s27, 0x6000
    s_nop 0
    buffer_load_dwordx4 v8, s[12:15], s24 offen lds
    s_add_u32 s24, s25, 0x7000
    s_add_u32 m0, s27, 0x7000
    s_nop 0
    buffer_load_dwordx4 v9, s[12:15], s24 offen lds
    s_add_u32 s24, s25, 0x8000
    s_add_u32 m0, s27, 0x8000
    s_nop 0
    buffer_load_dwordx4 v8, s[12:15], s24 offen lds
    s_add_u32 s24, s25, 0x9000
    s_add_u32 m0, s27, 0x9000
    s_nop 0
    buffer_load_dwordx4 v9, s[12:15], s24 offen lds
    s_add_u32 s24, s25, 0xa000
    s_add_u32 m0, s27, 0xa000
    s_nop 0
    buffer_load_dwordx4 v8, s[12:15], s24 offen lds
    s_add_u32 s24, s25, 0xb000
    s_add_u32 m0, s27, 0xb000
    s_nop 0
    buffer_load_dwordx4 v9, s[12:15], s24 offen lds
    s_add_u32 s24, s25, 0xc000
    s_add_u32 m0, s27, 0xc000
    s_nop 0
    buffer_load_dwordx4 v8, s[12:15], s24 offen lds
    s_add_u32 s24, s25, 0xd000
    s_add_u32 m0, s27, 0xd000
    s_nop 0
    buffer_load_dwordx4 v9, s[12:15], s24 offen lds
    s_add_u32 s24, s25, 0xe000
    s_add_u32 m0, s27, 0xe000
    s_nop 0
    buffer_load_dwordx4 v8, s[12:15], s24 offen lds
    s_add_u32 s24, s25, 0xf000
    s_add_u32 m0, s27, 0xf000
    s_nop 0
    buffer_load_dwordx4 v9, s[12:15], s24 offen lds
    s_add_u32 s24, s25, 0x10000
    s_add_u32 m0, s27, 0x10000
    s_nop 0
    buffer_load_dwordx4 v8, s[12:15], s24 offen lds
    s_add_u32 s24, s25, 0x11000
    s_add_u32 m0, s27, 0x11000
    s_nop 0
    buffer_load_dwordx4 v9, s[12:15], s24 offen lds
    s_add_u32 s24, s25, 0x12000
    s_add_u32 m0, s27, 0x12000
    s_nop 0
    buffer_load_dwordx4 v8, s[12:15], s24 offen lds
    s_add_u32 s24, s25, 0x13000
    s_add_u32 m0, s27, 0x13000
    s_nop 0
    buffer_load_dwordx4 v9, s[12:15], s24 offen lds
    s_add_u32 s24, s25, 0x14000
    s_add_u32 m0, s27, 0x14000
    s_nop 0
    buffer_load_dwordx4 v8, s[12:15], s24 offen lds
    s_add_u32 s24, s25, 0x15000
    s_add_u32 m0, s27, 0x15000
    s_nop 0
    buffer_load_dwordx4 v9, s[12:15], s24 offen lds
    s_add_u32 s24, s25, 0x16000
    s_add_u32 m0, s27, 0x16000
    s_nop 0
    buffer_load_dwordx4 v8, s[12:15], s24 offen lds
    s_add_u32 s24, s25, 0x17000
    s_add_u32 m0, s27, 0x17000
    s_nop 0
    buffer_load_dwordx4 v9, s[12:15], s24 offen lds
    s_add_u32 s24, s25, 0x18000
    s_add_u32 m0, s27, 0x18000
    s_nop 0
    buffer_load_dwordx4 v8, s[12:15], s24 offen lds
    s_add_u32 s24, s25, 0x19000
    s_add_u32 m0, s27, 0x19000
    s_nop 0
    buffer_load_dwordx4 v9, s[12:15], s24 offen lds
    s_add_u32 s24, s25, 0x1a000
    s_add_u32 m0, s27, 0x1a000
    s_nop 0
    buffer_load_dwordx4 v8, s[12:15], s24 offen lds
    s_add_u32 s24, s25, 0x1b000
    s_add_u32 m0, s27, 0x1b000
    s_nop 0
    buffer_load_dwordx4 v9, s[12:15], s24 offen lds
    s_add_u32 s24, s25, 0x1c000
    s_add_u32 m0, s27, 0x1c000
    s_nop 0
    buffer_load_dwordx4 v8, s[12:15], s24 offen lds
    s_add_u32 s24, s25, 0x1d000
    s_add_u32 m0, s27, 0x1d000
    s_nop 0
    buffer_load_dwordx4 v9, s[12:15], s24 offen lds
    s_add_u32 s24, s25, 0x1e000
    s_add_u32 m0, s27, 0x1e000
    s_nop 0
    buffer_load_dwordx4 v8, s[12:15], s24 offen lds
    s_add_u32 s24, s25, 0x1f000
    s_add_u32 m0, s27, 0x1f000
    s_nop 0
    buffer_load_dwordx4 v9, s[12:15], s24 offen lds
    s_waitcnt vmcnt(0)
    s_barrier
    v_xor_b32 v11, 0x0, v10
    ds_read_b64_tr_b16 a[0:1], v11
    ds_read_b64_tr_b16 a[2:3], v11 offset:16384
    ds_read_b64_tr_b16 a[32:33], v11 offset:32768
    ds_read_b64_tr_b16 a[34:35], v11 offset:49152
    v_xor_b32 v11, 0x8, v10
    ds_read_b64_tr_b16 a[4:5], v11
    ds_read_b64_tr_b16 a[6:7], v11 offset:16384
    ds_read_b64_tr_b16 a[36:37], v11 offset:32768
    ds_read_b64_tr_b16 a[38:39], v11 offset:49152
    s_waitcnt lgkmcnt(0)
    v_xor_b32 v11, 0x40, v10
    ds_read_b64_tr_b16 a[8:9], v11
    ds_read_b64_tr_b16 a[10:11], v11 offset:16384
    ds_read_b64_tr_b16 a[40:41], v11 offset:32768
    ds_read_b64_tr_b16 a[42:43], v11 offset:49152
    v_xor_b32 v11, 0x48, v10
    ds_read_b64_tr_b16 a[12:13], v11
    ds_read_b64_tr_b16 a[14:15], v11 offset:16384
    ds_read_b64_tr_b16 a[44:45], v11 offset:32768
    ds_read_b64_tr_b16 a[46:47], v11 offset:49152
    s_waitcnt lgkmcnt(0)
    v_xor_b32 v11, 0x80, v10
    ds_read_b64_tr_b16 a[16:17], v11
    ds_read_b64_tr_b16 a[18:19], v11 offset:16384
    ds_read_b64_tr_b16 a[48:49], v11 offset:32768
    ds_read_b64_tr_b16 a[50:51], v11 offset:49152
    v_xor_b32 v11, 0x88, v10
    ds_read_b64_tr_b16 a[20:21], v11
    ds_read_b64_tr_b16 a[22:23], v11 offset:16384
    ds_read_b64_tr_b16 a[52:53], v11 offset:32768
    ds_read_b64_tr_b16 a[54:55], v11 offset:49152
    s_waitcnt lgkmcnt(0)
    v_xor_b32 v11, 0xc0, v10
    ds_read_b64_tr_b16 a[24:25], v11
    ds_read_b64_tr_b16 a[26:27], v11 offset:16384
    ds_read_b64_tr_b16 a[56:57], v11 offset:32768
    ds_read_b64_tr_b16 a[58:59], v11 offset:49152
    v_xor_b32 v11, 0xc8, v10
    ds_read_b64_tr_b16 a[28:29], v11
    ds_read_b64_tr_b16 a[30:31], v11 offset:16384
    ds_read_b64_tr_b16 a[60:61], v11 offset:32768
    ds_read_b64_tr_b16 a[62:63], v11 offset:49152
    s_waitcnt lgkmcnt(0)
    v_xor_b32 v11, 0x10000, v10
    ds_read_b64_tr_b16 a[64:65], v11
    ds_read_b64_tr_b16 a[66:67], v11 offset:16384
    ds_read_b64_tr_b16 a[96:97], v11 offset:32768
    ds_read_b64_tr_b16 a[98:99], v11 offset:49152
    v_xor_b32 v11, 0x10008, v10
    ds_read_b64_tr_b16 a[68:69], v11
    ds_read_b64_tr_b16 a[70:71], v11 offset:16384
    ds_read_b64_tr_b16 a[100:101], v11 offset:32768
    ds_read_b64_tr_b16 a[102:103], v11 offset:49152
    s_waitcnt lgkmcnt(0)
    v_xor_b32 v11, 0x10040, v10
    ds_read_b64_tr_b16 a[72:73], v11
    ds_read_b64_tr_b16 a[74:75], v11 offset:16384
    ds_read_b64_tr_b16 a[104:105], v11 offset:32768
    ds_read_b64_tr_b16 a[106:107], v11 offset:49152
    v_xor_b32 v11, 0x10048, v10
    ds_read_b64_tr_b16 a[76:77], v11
    ds_read_b64_tr_b16 a[78:79], v11 offset:16384
    ds_read_b64_tr_b16 a[108:109], v11 offset:32768
    ds_read_b64_tr_b16 a[110:111], v11 offset:49152
    s_waitcnt lgkmcnt(0)
    v_xor_b32 v11, 0x10080, v10
    ds_read_b64_tr_b16 a[80:81], v11
    ds_read_b64_tr_b16 a[82:83], v11 offset:16384
    ds_read_b64_tr_b16 a[112:113], v11 offset:32768
    ds_read_b64_tr_b16 a[114:115], v11 offset:49152
    v_xor_b32 v11, 0x10088, v10
    ds_read_b64_tr_b16 a[84:85], v11
    ds_read_b64_tr_b16 a[86:87], v11 offset:16384
    ds_read_b64_tr_b16 a[116:117], v11 offset:32768
    ds_read_b64_tr_b16 a[118:119], v11 offset:49152
    s_waitcnt lgkmcnt(0)
    v_xor_b32 v11, 0x100c0, v10
    ds_read_b64_tr_b16 a[88:89], v11
    ds_read_b64_tr_b16 a[90:91], v11 offset:16384
    ds_read_b64_tr_b16 a[120:121], v11 offset:32768
    ds_read_b64_tr_b16 a[122:123], v11 offset:49152
    v_xor_b32 v11, 0x100c8, v10
    ds_read_b64_tr_b16 a[92:93], v11
    ds_read_b64_tr_b16 a[94:95], v11 offset:16384
    ds_read_b64_tr_b16 a[124:125], v11 offset:32768
    ds_read_b64_tr_b16 a[126:127], v11 offset:49152
    s_waitcnt lgkmcnt(0)
    s_barrier
    s_lshl_b32 s25, s20, 18
    s_add_u32 s24, s25, 0x20000
    s_add_u32 m0, s27, 0x0
    s_nop 0
    buffer_load_dwordx4 v8, s[12:15], s24 offen lds
    s_add_u32 s24, s25, 0x21000
    s_add_u32 m0, s27, 0x1000
    s_nop 0
    buffer_load_dwordx4 v9, s[12:15], s24 offen lds
    s_add_u32 s24, s25, 0x22000
    s_add_u32 m0, s27, 0x2000
    s_nop 0
    buffer_load_dwordx4 v8, s[12:15], s24 offen lds
    s_add_u32 s24, s25, 0x23000
    s_add_u32 m0, s27, 0x3000
    s_nop 0
    buffer_load_dwordx4 v9, s[12:15], s24 offen lds
    s_add_u32 s24, s25, 0x24000
    s_add_u32 m0, s27, 0x4000
    s_nop 0
    buffer_load_dwordx4 v8, s[12:15], s24 offen lds
    s_add_u32 s24, s25, 0x25000
    s_add_u32 m0, s27, 0x5000
    s_nop 0
    buffer_load_dwordx4 v9, s[12:15], s24 offen lds
    s_add_u32 s24, s25, 0x26000
    s_add_u32 m0, s27, 0x6000
    s_nop 0
    buffer_load_dwordx4 v8, s[12:15], s24 offen lds
    s_add_u32 s24, s25, 0x27000
    s_add_u32 m0, s27, 0x7000
    s_nop 0
    buffer_load_dwordx4 v9, s[12:15], s24 offen lds
    s_add_u32 s24, s25, 0x28000
    s_add_u32 m0, s27, 0x8000
    s_nop 0
    buffer_load_dwordx4 v8, s[12:15], s24 offen lds
    s_add_u32 s24, s25, 0x29000
    s_add_u32 m0, s27, 0x9000
    s_nop 0
    buffer_load_dwordx4 v9, s[12:15], s24 offen lds
    s_add_u32 s24, s25, 0x2a000
    s_add_u32 m0, s27, 0xa000
    s_nop 0
    buffer_load_dwordx4 v8, s[12:15], s24 offen lds
    s_add_u32 s24, s25, 0x2b000
    s_add_u32 m0, s27, 0xb000
    s_nop 0
    buffer_load_dwordx4 v9, s[12:15], s24 offen lds
    s_add_u32 s24, s25, 0x2c000
    s_add_u32 m0, s27, 0xc000
    s_nop 0
    buffer_load_dwordx4 v8, s[12:15], s24 offen lds
    s_add_u32 s24, s25, 0x2d000
    s_add_u32 m0, s27, 0xd000
    s_nop 0
    buffer_load_dwordx4 v9, s[12:15], s24 offen lds
    s_add_u32 s24, s25, 0x2e000
    s_add_u32 m0, s27, 0xe000
    s_nop 0
    buffer_load_dwordx4 v8, s[12:15], s24 offen lds
    s_add_u32 s24, s25, 0x2f000
    s_add_u32 m0, s27, 0xf000
    s_nop 0
    buffer_load_dwordx4 v9, s[12:15], s24 offen lds
    s_add_u32 s24, s25, 0x30000
    s_add_u32 m0, s27, 0x10000
    s_nop 0
    buffer_load_dwordx4 v8, s[12:15], s24 offen lds
    s_add_u32 s24, s25, 0x31000
    s_add_u32 m0, s27, 0x11000
    s_nop 0
    buffer_load_dwordx4 v9, s[12:15], s24 offen lds
    s_add_u32 s24, s25, 0x32000
    s_add_u32 m0, s27, 0x12000
    s_nop 0
    buffer_load_dwordx4 v8, s[12:15], s24 offen lds
    s_add_u32 s24, s25, 0x33000
    s_add_u32 m0, s27, 0x13000
    s_nop 0
    buffer_load_dwordx4 v9, s[12:15], s24 offen lds
    s_add_u32 s24, s25, 0x34000
    s_add_u32 m0, s27, 0x14000
    s_nop 0
    buffer_load_dwordx4 v8, s[12:15], s24 offen lds
    s_add_u32 s24, s25, 0x35000
    s_add_u32 m0, s27, 0x15000
    s_nop 0
    buffer_load_dwordx4 v9, s[12:15], s24 offen lds
    s_add_u32 s24, s25, 0x36000
    s_add_u32 m0, s27, 0x16000
    s_nop 0
    buffer_load_dwordx4 v8, s[12:15], s24 offen lds
    s_add_u32 s24, s25, 0x37000
    s_add_u32 m0, s27, 0x17000
    s_nop 0
    buffer_load_dwordx4 v9, s[12:15], s24 offen lds
    s_add_u32 s24, s25, 0x38000
    s_add_u32 m0, s27, 0x18000
    s_nop 0
    buffer_load_dwordx4 v8, s[12:15], s24 offen lds
    s_add_u32 s24, s25, 0x39000
    s_add_u32 m0, s27, 0x19000
    s_nop 0
    buffer_load_dwordx4 v9, s[12:15], s24 offen lds
    s_add_u32 s24, s25, 0x3a000
    s_add_u32 m0, s27, 0x1a000
    s_nop 0
    buffer_load_dwordx4 v8, s[12:15], s24 offen lds
    s_add_u32 s24, s25, 0x3b000
    s_add_u32 m0, s27, 0x1b000
    s_nop 0
    buffer_load_dwordx4 v9, s[12:15], s24 offen lds
    s_add_u32 s24, s25, 0x3c000
    s_add_u32 m0, s27, 0x1c000
    s_nop 0
    buffer_load_dwordx4 v8, s[12:15], s24 offen lds
    s_add_u32 s24, s25, 0x3d000
    s_add_u32 m0, s27, 0x1d000
    s_nop 0
    buffer_load_dwordx4 v9, s[12:15], s24 offen lds
    s_add_u32 s24, s25, 0x3e000
    s_add_u32 m0, s27, 0x1e000
    s_nop 0
    buffer_load_dwordx4 v8, s[12:15], s24 offen lds
    s_add_u32 s24, s25, 0x3f000
    s_add_u32 m0, s27, 0x1f000
    s_nop 0
    buffer_load_dwordx4 v9, s[12:15], s24 offen lds
    s_waitcnt vmcnt(0)
    s_barrier
    v_xor_b32 v11, 0x0, v10
    ds_read_b64_tr_b16 a[128:129], v11
    ds_read_b64_tr_b16 a[130:131], v11 offset:16384
    ds_read_b64_tr_b16 a[160:161], v11 offset:32768
    ds_read_b64_tr_b16 a[162:163], v11 offset:49152
    v_xor_b32 v11, 0x8, v10
    ds_read_b64_tr_b16 a[132:133], v11
    ds_read_b64_tr_b16 a[134:135], v11 offset:16384
    ds_read_b64_tr_b16 a[164:165], v11 offset:32768
    ds_read_b64_tr_b16 a[166:167], v11 offset:49152
    s_waitcnt lgkmcnt(0)
    v_xor_b32 v11, 0x40, v10
    ds_read_b64_tr_b16 a[136:137], v11
    ds_read_b64_tr_b16 a[138:139], v11 offset:16384
    ds_read_b64_tr_b16 a[168:169], v11 offset:32768
    ds_read_b64_tr_b16 a[170:171], v11 offset:49152
    v_xor_b32 v11, 0x48, v10
    ds_read_b64_tr_b16 a[140:141], v11
    ds_read_b64_tr_b16 a[142:143], v11 offset:16384
    ds_read_b64_tr_b16 a[172:173], v11 offset:32768
    ds_read_b64_tr_b16 a[174:175], v11 offset:49152
    s_waitcnt lgkmcnt(0)
    v_xor_b32 v11, 0x80, v10
    ds_read_b64_tr_b16 a[144:145], v11
    ds_read_b64_tr_b16 a[146:147], v11 offset:16384
    ds_read_b64_tr_b16 a[176:177], v11 offset:32768
    ds_read_b64_tr_b16 a[178:179], v11 offset:49152
    v_xor_b32 v11, 0x88, v10
    ds_read_b64_tr_b16 a[148:149], v11
    ds_read_b64_tr_b16 a[150:151], v11 offset:16384
    ds_read_b64_tr_b16 a[180:181], v11 offset:32768
    ds_read_b64_tr_b16 a[182:183], v11 offset:49152
    s_waitcnt lgkmcnt(0)
    v_xor_b32 v11, 0xc0, v10
    ds_read_b64_tr_b16 a[152:153], v11
    ds_read_b64_tr_b16 a[154:155], v11 offset:16384
    ds_read_b64_tr_b16 a[184:185], v11 offset:32768
    ds_read_b64_tr_b16 a[186:187], v11 offset:49152
    v_xor_b32 v11, 0xc8, v10
    ds_read_b64_tr_b16 a[156:157], v11
    ds_read_b64_tr_b16 a[158:159], v11 offset:16384
    ds_read_b64_tr_b16 a[188:189], v11 offset:32768
    ds_read_b64_tr_b16 a[190:191], v11 offset:49152
    s_waitcnt lgkmcnt(0)
    v_xor_b32 v11, 0x10000, v10
    ds_read_b64_tr_b16 a[192:193], v11
    ds_read_b64_tr_b16 a[194:195], v11 offset:16384
    ds_read_b64_tr_b16 a[224:225], v11 offset:32768
    ds_read_b64_tr_b16 a[226:227], v11 offset:49152
    v_xor_b32 v11, 0x10008, v10
    ds_read_b64_tr_b16 a[196:197], v11
    ds_read_b64_tr_b16 a[198:199], v11 offset:16384
    ds_read_b64_tr_b16 a[228:229], v11 offset:32768
    ds_read_b64_tr_b16 a[230:231], v11 offset:49152
    s_waitcnt lgkmcnt(0)
    v_xor_b32 v11, 0x10040, v10
    ds_read_b64_tr_b16 a[200:201], v11
    ds_read_b64_tr_b16 a[202:203], v11 offset:16384
    ds_read_b64_tr_b16 a[232:233], v11 offset:32768
    ds_read_b64_tr_b16 a[234:235], v11 offset:49152
    v_xor_b32 v11, 0x10048, v10
    ds_read_b64_tr_b16 a[204:205], v11
    ds_read_b64_tr_b16 a[206:207], v11 offset:16384
    ds_read_b64_tr_b16 a[236:237], v11 offset:32768
    ds_read_b64_tr_b16 a[238:239], v11 offset:49152
    s_waitcnt lgkmcnt(0)
    v_xor_b32 v11, 0x10080, v10
    ds_read_b64_tr_b16 a[208:209], v11
    ds_read_b64_tr_b16 a[210:211], v11 offset:16384
    ds_read_b64_tr_b16 a[240:241], v11 offset:32768
    ds_read_b64_tr_b16 a[242:243], v11 offset:49152
    v_xor_b32 v11, 0x10088, v10
    ds_read_b64_tr_b16 a[212:213], v11
    ds_read_b64_tr_b16 a[214:215], v11 offset:16384
    ds_read_b64_tr_b16 a[244:245], v11 offset:32768
    ds_read_b64_tr_b16 a[246:247], v11 offset:49152
    s_waitcnt lgkmcnt(0)
    v_xor_b32 v11, 0x100c0, v10
    ds_read_b64_tr_b16 a[216:217], v11
    ds_read_b64_tr_b16 a[218:219], v11 offset:16384
    ds_read_b64_tr_b16 a[248:249], v11 offset:32768
    ds_read_b64_tr_b16 a[250:251], v11 offset:49152
    v_xor_b32 v11, 0x100c8, v10
    ds_read_b64_tr_b16 a[220:221], v11
    ds_read_b64_tr_b16 a[222:223], v11 offset:16384
    ds_read_b64_tr_b16 a[252:253], v11 offset:32768
    ds_read_b64_tr_b16 a[254:255], v11 offset:49152
    s_waitcnt lgkmcnt(0)
    s_barrier
    s_and_b32 s24, s21, 1
    s_lshl_b32 s24, s24, 4
    v_add_u32 v4, s24, v3
    v_lshlrev_b32 v5, 2, v2
    v_sub_u32 v4, v4, v5
    v_cmp_le_i32 s[30:31], 0, v4
    v_cmp_le_i32 s[32:33], 1, v4
    v_cmp_le_i32 s[34:35], 2, v4
    v_cmp_le_i32 s[36:37], 3, v4
    v_cmp_le_i32 s[38:39], 16, v4
    v_cmp_le_i32 s[40:41], 17, v4
    v_cmp_le_i32 s[42:43], 18, v4
    v_cmp_le_i32 s[44:45], 19, v4
    s_mov_b32 s28, 0x3e0293ee
    s_mov_b32 s29, 0x3e0293ee
    s_mov_b32 s53, 0xff000000
    v_mov_b32 v136, 0x3f803f80
    v_mov_b32 v137, 0x3f803f80
    v_mov_b32 v138, 0x3f803f80
    v_mov_b32 v139, 0x3f803f80
    v_lshlrev_b32 v4, 10, v3
    v_lshl_add_u32 v4, v2, 4, v4
    s_lshl_b32 s24, s21, 8
    v_add_u32 v242, s24, v4
    s_lshl_b32 s24, s21, 12
    v_add_u32 v243, s24, v240
    v_mov_b32 v244, v240
    s_add_u32 s24, s24, 0x22000
    v_xor_b32 v7, v2, v6
    v_lshl_add_u32 v4, v2, 4, v7
    v_and_b32 v5, 3, v3
    v_lshl_add_u32 v4, v4, 2, v5
    v_lshl_add_u32 v253, v4, 2, s24
    v_lshl_add_u32 v4, v3, 2, v7
    v_lshl_add_u32 v254, v4, 4, s24
    s_load_dwordx2 s[12:13], s[0:1], 0
    s_waitcnt lgkmcnt(0)
    s_and_b32 s13, s13, 0xffff
    s_mov_b32 s14, 0x200000
    s_mov_b32 s15, 0x20000
    s_load_dwordx2 s[16:17], s[0:1], 96
    s_waitcnt lgkmcnt(0)
    s_and_b32 s17, s17, 0xffff
    s_mov_b32 s18, 0x200000
    s_mov_b32 s19, 0x20000
    s_load_dwordx2 s[56:57], s[0:1], 64
    s_waitcnt lgkmcnt(0)
    s_and_b32 s57, s57, 0xffff
    s_mov_b32 s58, 0x400
    s_mov_b32 s59, 0x20000
    v_and_b32 v100, 63, v0
    v_lshlrev_b32 v240, 4, v100
    buffer_load_dwordx4 v[236:239], v240, s[56:59], 0 offen
    s_mov_b32 s65, 0x3f80
    s_mov_b32 s66, 0x3f800000
    s_waitcnt vmcnt(0)
    s_sub_u32 s67, s101, 128
    s_cmp_ge_u32 s67, 56
    s_cbranch_scc1 L_nostage_112
L_nostage_112:
    v_lshrrev_b32 v246, 2, v240
    s_lshl_b32 s24, s20, 7
    s_add_u32 s24, s24, 0x2000
    s_cmp_lg_u32 s100, 0
    s_cbranch_scc1 L_polls_115
    s_mov_b32 exec_lo, 0xffffffff
    s_mov_b32 exec_hi, 0
    s_mov_b32 s96, 0
L_poll_113:
    buffer_load_dword v247, v246, s[8:11], s24 offen sc1
    s_waitcnt vmcnt(0)
    v_cmp_gt_u32 vcc, 1, v247
    s_cbranch_vccz L_polld_114
    s_sleep 32
    s_add_u32 s96, s96, 1
    s_cmp_lt_u32 s96, 0x10000
    s_cbranch_scc1 L_poll_113
L_polld_114:
    s_mov_b64 exec, -1
L_polls_115:
    s_barrier
    s_lshl_b32 s24, s20, 7
    s_add_u32 s24, s24, 0x2800
    s_cmp_lg_u32 s100, 0
    s_cbranch_scc1 L_polls_118
    s_mov_b32 exec_lo, 0xffffffff
    s_mov_b32 exec_hi, 0
    s_mov_b32 s96, 0
L_poll_116:
    buffer_load_dword v247, v246, s[8:11], s24 offen sc1
    s_waitcnt vmcnt(0)
    v_cmp_gt_u32 vcc, 1, v247
    s_cbranch_vccz L_polld_117
    s_sleep 32
    s_add_u32 s96, s96, 1
    s_cmp_lt_u32 s96, 0x10000
    s_cbranch_scc1 L_poll_116
L_polld_117:
    s_mov_b64 exec, -1
L_polls_118:
    s_barrier
    s_lshl_b32 s24, s20, 7
    s_add_u32 s24, s24, 0x3000
    s_cmp_lg_u32 s100, 0
    s_cbranch_scc1 L_polls_121
    s_mov_b32 exec_lo, 0xffffffff
    s_mov_b32 exec_hi, 0
    s_mov_b32 s96, 0
L_poll_119:
    buffer_load_dword v247, v246, s[8:11], s24 offen sc1
    s_waitcnt vmcnt(0)
    v_cmp_gt_u32 vcc, 1, v247
    s_cbranch_vccz L_polld_120
    s_sleep 32
    s_add_u32 s96, s96, 1
    s_cmp_lt_u32 s96, 0x10000
    s_cbranch_scc1 L_poll_119
L_polld_120:
    s_mov_b64 exec, -1
L_polls_121:
    s_barrier
    s_mov_b32 s80, 0
    s_mov_b32 s82, 0
    v_add_u32 v105, 0x8000, v240
    v_add_u32 v106, 0x10000, v240
    v_add_u32 v107, 0x18000, v240
    s_lshl_b32 s24, s21, 12
    s_add_u32 s24, s24, 0x22000
    v_add_u32 v109, s24, v240
    s_nop 4
L_p2_seg:
    s_cmp_ge_u32 s22, 64
    s_cbranch_scc1 L_p2_end
    v_lshrrev_b32 v246, 2, v240
    s_lshl_b32 s24, s20, 7
    s_add_u32 s24, s24, 0x1000
    s_mul_i32 s25, s22, 10
    s_lshr_b32 s25, s25, 4
    s_add_u32 s25, s25, 17
    s_cmp_lg_u32 s100, 0
    s_cbranch_scc1 L_polls_124
    s_mov_b32 exec_lo, 0x1
    s_mov_b32 exec_hi, 0
    s_mov_b32 s96, 0
L_poll_122:
    buffer_load_dword v247, v246, s[8:11], s24 offen sc1
    s_waitcnt vmcnt(0)
    v_cmp_gt_u32 vcc, s25, v247
    s_cbranch_vccz L_polld_123
    v_readfirstlane_b32 s97, v247
    s_nop 0
    s_sub_u32 s97, s25, s97
    s_cmp_lt_i32 s97, 3
    s_cbranch_scc1 L_near_125
    s_sleep 40
    s_cmp_lt_i32 s97, 5
    s_cbranch_scc1 L_near_125
    s_sleep 100
L_near_125:
    s_sleep 4
    s_add_u32 s96, s96, 1
    s_cmp_lt_u32 s96, 0x10000
    s_cbranch_scc1 L_poll_122
L_polld_123:
    s_mov_b64 exec, -1
L_polls_124:
    s_barrier
    s_cmp_ge_u32 s67, 56
    s_cbranch_scc1 L_nostage_126
    v_mbcnt_lo_u32_b32 v0, -1, 0
    v_mbcnt_hi_u32_b32 v0, -1, v0
    s_lshl_b32 s96, s100, 6
    v_add_u32 v0, s96, v0
    v_lshrrev_b32 v2, 6, v0
    s_nop 0
    v_readfirstlane_b32 s68, v2
    v_and_b32 v1, 63, v0
    s_lshl_b32 s73, s68, 10
    v_lshrrev_b32 v2, 2, v1
    s_lshl_b32 s71, s68, 4
    v_add_u32 v2, s71, v2
    s_movk_i32 s71, 3584
    v_mul_lo_u32 v2, v2, s71
    v_and_b32 v3, 3, v1
    v_lshl_add_u32 v4, v3, 4, v2
    s_cmp_lg_u32 s80, 0
    s_cbranch_scc1 L_part_127
    s_load_dwordx2 s[76:77], s[0:1], 72
    s_waitcnt lgkmcnt(0)
    s_and_b32 s77, s77, 0xffff
    s_mov_b32 s78, 0x1c0000
    s_mov_b32 s79, 0x20000
    s_lshl_b32 s71, s67, 6
    s_add_u32 s71, s71, 0x0
    s_add_u32 m0, s73, 0x8000
    s_nop 0
    buffer_load_dwordx4 v4, s[76:79], s71 offen lds
    s_lshl_b32 s71, s67, 6
    s_add_u32 s71, s71, 0x38000
    s_add_u32 m0, s73, 0x9000
    s_nop 0
    buffer_load_dwordx4 v4, s[76:79], s71 offen lds
    s_lshl_b32 s71, s67, 6
    s_add_u32 s71, s71, 0x70000
    s_add_u32 m0, s73, 0xa000
    s_nop 0
    buffer_load_dwordx4 v4, s[76:79], s71 offen lds
    s_lshl_b32 s71, s67, 6
    s_add_u32 s71, s71, 0xa8000
    s_add_u32 m0, s73, 0xb000
    s_nop 0
    buffer_load_dwordx4 v4, s[76:79], s71 offen lds
    s_lshl_b32 s71, s67, 6
    s_add_u32 s71, s71, 0xe0000
    s_add_u32 m0, s73, 0xc000
    s_nop 0
    buffer_load_dwordx4 v4, s[76:79], s71 offen lds
    s_lshl_b32 s71, s67, 6
    s_add_u32 s71, s71, 0x118000
    s_add_u32 m0, s73, 0xd000
    s_nop 0
    buffer_load_dwordx4 v4, s[76:79], s71 offen lds
    s_lshl_b32 s71, s67, 6
    s_add_u32 s71, s71, 0x150000
    s_add_u32 m0, s73, 0xe000
    s_nop 0
    buffer_load_dwordx4 v4, s[76:79], s71 offen lds
    s_lshl_b32 s71, s67, 6
    s_add_u32 s71, s71, 0x188000
    s_add_u32 m0, s73, 0xf000
    s_nop 0
    buffer_load_dwordx4 v4, s[76:79], s71 offen lds
L_part_127:
    s_cmp_lg_u32 s80, 4
    s_cbranch_scc1 L_part_128
    s_load_dwordx2 s[76:77], s[0:1], 80
    s_waitcnt lgkmcnt(0)
    s_and_b32 s77, s77, 0xffff
    s_mov_b32 s78, 0x1c0000
    s_mov_b32 s79, 0x20000
    s_lshl_b32 s71, s67, 6
    s_add_u32 s71, s71, 0x0
    s_add_u32 m0, s73, 0x10000
    s_nop 0
    buffer_load_dwordx4 v4, s[76:79], s71 offen lds
    s_lshl_b32 s71, s67, 6
    s_add_u32 s71, s71, 0x38000
    s_add_u32 m0, s73, 0x11000
    s_nop 0
    buffer_load_dwordx4 v4, s[76:79], s71 offen lds
    s_lshl_b32 s71, s67, 6
    s_add_u32 s71, s71, 0x70000
    s_add_u32 m0, s73, 0x12000
    s_nop 0
    buffer_load_dwordx4 v4, s[76:79], s71 offen lds
    s_lshl_b32 s71, s67, 6
    s_add_u32 s71, s71, 0xa8000
    s_add_u32 m0, s73, 0x13000
    s_nop 0
    buffer_load_dwordx4 v4, s[76:79], s71 offen lds
    s_lshl_b32 s71, s67, 6
    s_add_u32 s71, s71, 0xe0000
    s_add_u32 m0, s73, 0x14000
    s_nop 0
    buffer_load_dwordx4 v4, s[76:79], s71 offen lds
    s_lshl_b32 s71, s67, 6
    s_add_u32 s71, s71, 0x118000
    s_add_u32 m0, s73, 0x15000
    s_nop 0
    buffer_load_dwordx4 v4, s[76:79], s71 offen lds
    s_lshl_b32 s71, s67, 6
    s_add_u32 s71, s71, 0x150000
    s_add_u32 m0, s73, 0x16000
    s_nop 0
    buffer_load_dwordx4 v4, s[76:79], s71 offen lds
    s_lshl_b32 s71, s67, 6
    s_add_u32 s71, s71, 0x188000
    s_add_u32 m0, s73, 0x17000
    s_nop 0
    buffer_load_dwordx4 v4, s[76:79], s71 offen lds
L_part_128:
    s_cmp_lg_u32 s80, 8
    s_cbranch_scc1 L_part_129
    s_load_dwordx2 s[76:77], s[0:1], 88
    s_waitcnt lgkmcnt(0)
    s_and_b32 s77, s77, 0xffff
    s_mov_b32 s78, 0x1c0000
    s_mov_b32 s79, 0x20000
    v_lshlrev_b32 v5, 4, v1
    v_add_u32 v5, s73, v5
    s_lshl_b32 s71, s67, 15
    s_add_u32 s71, s71, 0
    s_add_u32 m0, s73, 0x18000
    s_nop 0
    buffer_load_dwordx4 v5, s[76:79], s71 offen lds
    s_lshl_b32 s71, s67, 15
    s_add_u32 s71, s71, 4096
    s_add_u32 m0, s73, 0x19000
    s_nop 0
    buffer_load_dwordx4 v5, s[76:79], s71 offen lds
    s_lshl_b32 s71, s67, 15
    s_add_u32 s71, s71, 8192
    s_add_u32 m0, s73, 0x1a000
    s_nop 0
    buffer_load_dwordx4 v5, s[76:79], s71 offen lds
    s_lshl_b32 s71, s67, 15
    s_add_u32 s71, s71, 12288
    s_add_u32 m0, s73, 0x1b000
    s_nop 0
    buffer_load_dwordx4 v5, s[76:79], s71 offen lds
    s_lshl_b32 s71, s67, 15
    s_add_u32 s71, s71, 16384
    s_add_u32 m0, s73, 0x1c000
    s_nop 0
    buffer_load_dwordx4 v5, s[76:79], s71 offen lds
    s_lshl_b32 s71, s67, 15
    s_add_u32 s71, s71, 20480
    s_add_u32 m0, s73, 0x1d000
    s_nop 0
    buffer_load_dwordx4 v5, s[76:79], s71 offen lds
    s_lshl_b32 s71, s67, 15
    s_add_u32 s71, s71, 24576
    s_add_u32 m0, s73, 0x1e000
    s_nop 0
    buffer_load_dwordx4 v5, s[76:79], s71 offen lds
    s_lshl_b32 s71, s67, 15
    s_add_u32 s71, s71, 28672
    s_add_u32 m0, s73, 0x1f000
    s_nop 0
    buffer_load_dwordx4 v5, s[76:79], s71 offen lds
L_part_129:
L_nostage_126:
    s_lshl_b32 s24, s22, 5
    s_lshl_b32 s25, s20, 1
    s_add_u32 s24, s24, s25
    s_lshr_b32 s25, s21, 1
    s_add_u32 s24, s24, s25
    s_lshl_b32 s25, s24, 13
    s_add_u32 s47, s25, 0x1000000
    s_add_u32 s54, s47, 4096
    s_add_u32 s48, s25, 0x2000000
    s_add_u32 s55, s48, 4096
    s_and_b32 s26, s21, 1
    s_lshl_b32 s26, s26, 12
    s_add_u32 s46, s25, s26
    s_add_u32 s46, s46, 0x3000000
    s_lshl_b32 s25, s24, 12
    s_add_u32 s49, s25, 0x240000
    s_lshl_b32 s24, s22, 4
    s_add_u32 s24, s24, s20
    s_lshl_b32 s24, s24, 15
    s_add_u32 s51, s24, 0x4000000
    s_cmp_ge_u32 s22, 60
    s_cselect_b32 s81, 1, 0
    s_lshl_b32 s60, s20, 1
    s_lshr_b32 s24, s100, 1
    s_add_u32 s60, s60, s24
    s_cmp_ge_u32 s22, 62
    s_cselect_b32 s24, 1, 0
    s_max_u32 s82, s82, s24
    s_lshl_b32 s24, s82, 3
    s_and_b32 s24, s24, 16
    s_add_u32 s24, s24, s20
    s_cmp_lg_u32 s82, 0
    s_cselect_b32 s60, s24, s60
    s_cselect_b32 s61, 0, 0x20000
    s_cselect_b32 s24, 17, 18
    s_lshl_b32 s50, s100, s24
    s_and_b32 s50, s50, 0x60000
    s_lshl_b32 s24, s60, 10
    s_add_u32 s50, s50, s24
    s_lshl_b32 s24, s22, 19
    s_add_u32 s50, s50, s24
    s_add_u32 s50, s50, 0x4000000
    s_add_u32 s61, s61, s50
    s_and_b32 s24, s82, 2
    s_lshl_b32 s24, s24, 13
    s_add_u32 s51, s51, s24
    s_lshl_b32 s24, s22, 5
    s_add_u32 s60, s60, s24
    s_lshl_b32 s64, s60, 10
    buffer_load_dwordx4 v[96:99], v240, s[12:15], s64 offen
    s_lshl_b32 s52, s22, 6
    s_add_u32 s52, s52, 0x4000
    s_lshl_b32 s24, s22, 7
    s_and_b32 s25, s82, 2
    s_lshl_b32 s25, s25, 7
    s_add_u32 s24, s24, s25
    s_add_u32 s24, s24, 0x6a00
    s_cmp_lg_u32 s81, 0
    s_cselect_b32 s52, s24, s52
    s_cmp_ge_u32 s22, 61
    s_cselect_b32 s83, s87, 0
    s_and_b32 s83, s83, 1
    s_cbranch_scc0 L_notouch_130
    buffer_load_dword v245, off, s[8:11], s52 sc1
    s_cmp_lg_u32 s82, 0
    s_cselect_b32 s25, 2, 3
    v_lshlrev_b32 v246, s25, v240
    s_lshl_b32 s24, s27, s25
    s_add_u32 s24, s24, s51
    buffer_load_dword v245, v246, s[8:11], s24 offen sc1
    s_cmp_eq_u32 s82, 0
    s_cbranch_scc1 L_notouch_130
    s_mov_b32 s83, 3
    v_mov_b32 v140, -1
    v_mov_b32 v141, -1
    v_mov_b32 v142, -1
    v_mov_b32 v143, -1
    s_waitcnt vmcnt(0)
    s_barrier
    buffer_store_dwordx4 v[140:143], v242, s[8:11], s51 offen
    buffer_store_dwordx4 v[140:143], v242, s[8:11], s51 offen offset:64
    buffer_store_dwordx4 v[140:143], v242, s[8:11], s51 offen offset:128
    buffer_store_dwordx4 v[140:143], v242, s[8:11], s51 offen offset:192
L_notouch_130:
    buffer_load_dwordx4 v[0:3], v240, s[8:11], s46 offen
    buffer_load_dwordx4 v[4:7], v240, s[8:11], s46 offen offset:1024
    buffer_load_dwordx4 v[8:11], v240, s[8:11], s46 offen offset:2048
    buffer_load_dwordx4 v[12:15], v240, s[8:11], s46 offen offset:3072
    buffer_load_dwordx4 v[16:19], v240, s[8:11], s47 offen
    buffer_load_dwordx4 v[20:23], v240, s[8:11], s47 offen offset:1024
    buffer_load_dwordx4 v[24:27], v240, s[8:11], s47 offen offset:2048
    buffer_load_dwordx4 v[28:31], v240, s[8:11], s47 offen offset:3072
    buffer_load_dwordx4 v[32:35], v240, s[8:11], s54 offen
    buffer_load_dwordx4 v[36:39], v240, s[8:11], s54 offen offset:1024
    buffer_load_dwordx4 v[40:43], v240, s[8:11], s54 offen offset:2048
    buffer_load_dwordx4 v[44:47], v240, s[8:11], s54 offen offset:3072
    buffer_load_dwordx4 v[64:67], v240, s[8:11], s48 offen
    buffer_load_dwordx4 v[68:71], v240, s[8:11], s48 offen offset:1024
    buffer_load_dwordx4 v[72:75], v240, s[8:11], s48 offen offset:2048
    buffer_load_dwordx4 v[76:79], v240, s[8:11], s48 offen offset:3072
    buffer_load_dwordx4 v[80:83], v240, s[8:11], s55 offen
    buffer_load_dwordx4 v[84:87], v240, s[8:11], s55 offen offset:1024
    buffer_load_dwordx4 v[88:91], v240, s[8:11], s55 offen offset:2048
    buffer_load_dwordx4 v[92:95], v240, s[8:11], s55 offen offset:3072
    s_waitcnt vmcnt(8)
    v_mfma_f32_16x16x32_bf16 v[116:119], v[16:19], v[0:3], 0
    v_mfma_f32_16x16x32_bf16 v[116:119], v[20:23], v[4:7], v[116:119]
    v_mfma_f32_16x16x32_bf16 v[116:119], v[24:27], v[8:11], v[116:119]
    v_mfma_f32_16x16x32_bf16 v[116:119], v[28:31], v[12:15], v[116:119]
    v_mfma_f32_16x16x32_bf16 v[120:123], v[32:35], v[0:3], 0
    v_mfma_f32_16x16x32_bf16 v[120:123], v[36:39], v[4:7], v[120:123]
    v_mfma_f32_16x16x32_bf16 v[120:123], v[40:43], v[8:11], v[120:123]
    v_mfma_f32_16x16x32_bf16 v[120:123], v[44:47], v[12:15], v[120:123]
    v_mov_b32 v247, s53
    v_cndmask_b32 v116, v247, v116, s[30:31]
    v_cndmask_b32 v117, v247, v117, s[32:33]
    v_cndmask_b32 v118, v247, v118, s[34:35]
    v_cndmask_b32 v119, v247, v119, s[36:37]
    s_nop 2
    v_cndmask_b32 v120, v247, v120, s[38:39]
    v_cndmask_b32 v121, v247, v121, s[40:41]
    v_cndmask_b32 v122, v247, v122, s[42:43]
    v_cndmask_b32 v123, v247, v123, s[44:45]
    v_max3_f32 v246, v116, v117, v118
    v_max3_f32 v246, v246, v119, v120
    v_max3_f32 v246, v246, v121, v122
    v_max_f32 v246, v246, v123
    v_mov_b32 v247, v246
    s_nop 1
    v_permlane32_swap_b32 v247, v246
    v_max_f32 v246, v247, v246
    v_mov_b32 v247, v246
    s_nop 1
    v_permlane16_swap_b32 v247, v246
    v_max_f32 v246, v247, v246
    v_mul_f32 v248, s28, v246
    v_pk_fma_f32 v[116:117], v[116:117], s[28:29], v[248:249] op_sel_hi:[1,1,0] neg_lo:[0,0,1] neg_hi:[0,0,1]
    v_pk_fma_f32 v[118:119], v[118:119], s[28:29], v[248:249] op_sel_hi:[1,1,0] neg_lo:[0,0,1] neg_hi:[0,0,1]
    v_pk_fma_f32 v[120:121], v[120:121], s[28:29], v[248:249] op_sel_hi:[1,1,0] neg_lo:[0,0,1] neg_hi:[0,0,1]
    v_pk_fma_f32 v[122:123], v[122:123], s[28:29], v[248:249] op_sel_hi:[1,1,0] neg_lo:[0,0,1] neg_hi:[0,0,1]
    v_exp_f32 v116, v116
    v_exp_f32 v117, v117
    v_exp_f32 v118, v118
    v_exp_f32 v119, v119
    v_exp_f32 v120, v120
    v_exp_f32 v121, v121
    v_exp_f32 v122, v122
    v_exp_f32 v123, v123
    v_cvt_pk_bf16_f32 v124, v116, v117
    v_cvt_pk_bf16_f32 v125, v118, v119
    v_cvt_pk_bf16_f32 v126, v120, v121
    v_cvt_pk_bf16_f32 v127, v122, v123
    v_mov_b32 v129, 0
    s_nop 0
    v_mfma_f32_16x16x32_bf16 v[132:135], v[136:139], v[124:127], 0
    s_waitcnt vmcnt(7)
    v_mfma_f32_16x16x32_bf16 v[140:143], v[64:67], v[124:127], 0
    s_waitcnt vmcnt(6)
    v_mfma_f32_16x16x32_bf16 v[144:147], v[68:71], v[124:127], 0
    s_waitcnt vmcnt(5)
    v_mfma_f32_16x16x32_bf16 v[148:151], v[72:75], v[124:127], 0
    s_waitcnt vmcnt(4)
    v_mfma_f32_16x16x32_bf16 v[152:155], v[76:79], v[124:127], 0
    s_waitcnt vmcnt(3)
    v_mfma_f32_16x16x32_bf16 v[156:159], v[80:83], v[124:127], 0
    s_waitcnt vmcnt(2)
    v_mfma_f32_16x16x32_bf16 v[160:163], v[84:87], v[124:127], 0
    s_waitcnt vmcnt(1)
    v_mfma_f32_16x16x32_bf16 v[164:167], v[88:91], v[124:127], 0
    s_waitcnt vmcnt(0)
    v_mfma_f32_16x16x32_bf16 v[168:171], v[92:95], v[124:127], 0
    v_lshrrev_b32 v246, 2, v240
    s_lshl_b32 s24, s20, 7
    s_add_u32 s24, s24, 0x1000
    s_add_u32 s25, s22, 1
    s_sub_u32 s26, s22, 1
    s_min_u32 s26, s26, 61
    s_cmp_lg_u32 s81, 0
    s_cselect_b32 s25, s26, s25
    s_cmp_lg_u32 s100, 0
    s_cbranch_scc1 L_polls_133
    s_mov_b32 exec_lo, 0x11
    s_mov_b32 exec_hi, 0
    s_mov_b32 s96, 0
L_poll_131:
    buffer_load_dword v247, v246, s[8:11], s24 offen sc1
    s_waitcnt vmcnt(0)
    v_cmp_gt_u32 vcc, s25, v247
    s_cbranch_vccz L_polld_132
    v_readfirstlane_b32 s97, v247
    s_nop 0
    s_sub_u32 s97, s25, s97
    s_cmp_lt_i32 s97, 3
    s_cbranch_scc1 L_near_134
    s_sleep 40
    s_cmp_lt_i32 s97, 5
    s_cbranch_scc1 L_near_134
    s_sleep 100
L_near_134:
    s_sleep 4
    s_add_u32 s96, s96, 1
    s_cmp_lt_u32 s96, 0x10000
    s_cbranch_scc1 L_poll_131
L_polld_132:
    s_mov_b64 exec, -1
L_polls_133:
    s_barrier
    s_cmp_eq_u32 s81, 0
    s_cbranch_scc1 L_kmf_136
    s_cmp_lg_u32 s83, 3
    s_cbranch_scc1 L_noinit_138
    s_lshl_b32 s26, s20, 2
    s_add_u32 s26, s26, s52
    s_cmp_lg_u32 s100, 0
    s_cbranch_scc1 L_flag_139
    v_mov_b32 v246, 1
    s_mov_b64 exec, 1
    buffer_store_dword v246, off, s[8:11], s26
    s_mov_b64 exec, -1
L_flag_139:
L_noinit_138:
    s_lshr_b32 s26, s21, 1
    s_lshl_b32 s26, s26, 4
    s_add_u32 s24, s24, s26
    s_mov_b32 s96, 0
    buffer_load_dword v245, off, s[8:11], s24 sc1
    buffer_load_dwordx4 v[220:223], v240, s[8:11], s49 offen sc1
    buffer_load_dwordx4 v[224:227], v240, s[8:11], s49 offen offset:1024 sc1
    buffer_load_dwordx4 v[228:231], v240, s[8:11], s49 offen offset:2048 sc1
    buffer_load_dwordx4 v[232:235], v240, s[8:11], s49 offen offset:3072 sc1
    s_sleep 14
L_kmp_135:
    buffer_load_dword v245, off, s[8:11], s24 sc1
    buffer_load_dwordx4 v[220:223], v240, s[8:11], s49 offen sc1
    buffer_load_dwordx4 v[224:227], v240, s[8:11], s49 offen offset:1024 sc1
    buffer_load_dwordx4 v[228:231], v240, s[8:11], s49 offen offset:2048 sc1
    buffer_load_dwordx4 v[232:235], v240, s[8:11], s49 offen offset:3072 sc1
    s_add_u32 s96, s96, 1
    s_waitcnt vmcnt(5)
    v_max3_u32 v246, v220, v221, v222
    v_max3_u32 v246, v246, v223, v224
    v_max3_u32 v246, v246, v225, v226
    v_max3_u32 v246, v246, v227, v228
    v_max3_u32 v246, v246, v229, v230
    v_max3_u32 v246, v246, v231, v232
    v_max3_u32 v246, v246, v233, v234
    v_max_u32 v246, v246, v235
    v_cmp_eq_u32 vcc, -1, v246
    v_readfirstlane_b32 s26, v245
    s_cbranch_vccz L_kmo_137
    s_cmp_gt_u32 s26, s22
    s_cbranch_scc1 L_kmf_136
    s_cmp_lt_u32 s96, 0x10000
    s_cbranch_scc1 L_kmp_135
L_kmf_136:
    buffer_load_dwordx4 v[220:223], v240, s[8:11], s49 offen sc1
    buffer_load_dwordx4 v[224:227], v240, s[8:11], s49 offen offset:1024 sc1
    buffer_load_dwordx4 v[228:231], v240, s[8:11], s49 offen offset:2048 sc1
    buffer_load_dwordx4 v[232:235], v240, s[8:11], s49 offen offset:3072 sc1
    s_waitcnt vmcnt(0)
L_kmo_137:
    ds_write_b32 v253, v221
    ds_write_b32 v253, v223 offset:64
    ds_write_b32 v253, v225 offset:1024
    ds_write_b32 v253, v227 offset:1088
    ds_write_b32 v253, v229 offset:2048
    ds_write_b32 v253, v231 offset:2112
    ds_write_b32 v253, v233 offset:3072
    ds_write_b32 v253, v235 offset:3136
    ds_read_b128 v[48:51], v254
    ds_read_b128 v[52:55], v254 offset:1024
    ds_read_b128 v[56:59], v254 offset:2048
    ds_read_b128 v[60:63], v254 offset:3072
    s_cmp_lg_u32 s83, 3
    s_cbranch_scc1 L_noside_140
    s_mov_b32 s62, 0x8f00
    buffer_load_dword v104, off, s[8:11], s62 sc1
    v_bfe_u32 v108, v240, 2, 6
    buffer_load_dword v108, v108, s[8:11], s52 offen sc1
L_noside_140:
    s_waitcnt lgkmcnt(3)
    v_mfma_f32_16x16x32_bf16 v[112:115], v[48:51], v[0:3], 0
    s_waitcnt lgkmcnt(2)
    v_mfma_f32_16x16x32_bf16 v[112:115], v[52:55], v[4:7], v[112:115]
    s_waitcnt lgkmcnt(1)
    v_mfma_f32_16x16x32_bf16 v[112:115], v[56:59], v[8:11], v[112:115]
    s_waitcnt lgkmcnt(0)
    v_mfma_f32_16x16x32_bf16 v[112:115], v[60:63], v[12:15], v[112:115]
    s_nop 7
    v_pk_fma_f32 v[114:115], v[112:113], s[28:29], v[248:249] op_sel_hi:[1,1,0] neg_lo:[0,0,1] neg_hi:[0,0,1]
    v_max_f32 v246, v114, v115
    v_cmp_lt_f32 vcc, 0x42200000, v246
    s_cbranch_vccnz L_redo_141
L_redone_142:
    v_exp_f32 v114, v114
    v_exp_f32 v115, v115
    s_nop 0
    v_cvt_pk_bf16_f32 v128, v114, v115
    s_nop 1
    v_mfma_f32_16x16x16_bf16 v[132:135], v[136:137], v[128:129], v[132:135]
    v_mfma_f32_16x16x16_bf16 v[140:143], v[220:221], v[128:129], v[140:143]
    v_mfma_f32_16x16x16_bf16 v[144:147], v[222:223], v[128:129], v[144:147]
    v_mfma_f32_16x16x16_bf16 v[148:151], v[224:225], v[128:129], v[148:151]
    v_rcp_f32 v250, v132
    v_mfma_f32_16x16x16_bf16 v[152:155], v[226:227], v[128:129], v[152:155]
    v_mul_f32 v140, v250, v140
    v_mul_f32 v141, v250, v141
    v_mfma_f32_16x16x16_bf16 v[156:159], v[228:229], v[128:129], v[156:159]
    v_mul_f32 v142, v250, v142
    v_mul_f32 v143, v250, v143
    v_mfma_f32_16x16x16_bf16 v[160:163], v[230:231], v[128:129], v[160:163]
    v_cvt_pk_bf16_f32 v140, v140, v141
    v_cvt_pk_bf16_f32 v141, v142, v143
    v_mfma_f32_16x16x16_bf16 v[164:167], v[232:233], v[128:129], v[164:167]
    v_mul_f32 v144, v250, v144
    v_mul_f32 v145, v250, v145
    v_mfma_f32_16x16x16_bf16 v[168:171], v[234:235], v[128:129], v[168:171]
    v_mul_f32 v146, v250, v146
    v_mul_f32 v147, v250, v147
    v_cvt_pk_bf16_f32 v142, v144, v145
    v_cvt_pk_bf16_f32 v143, v146, v147
    ds_write_b128 v243, v[140:143]
    v_pk_mul_f32 v[148:149], v[148:149], v[250:251] op_sel_hi:[1,0]
    v_pk_mul_f32 v[150:151], v[150:151], v[250:251] op_sel_hi:[1,0]
    v_cvt_pk_bf16_f32 v144, v148, v149
    v_cvt_pk_bf16_f32 v145, v150, v151
    v_pk_mul_f32 v[152:153], v[152:153], v[250:251] op_sel_hi:[1,0]
    v_pk_mul_f32 v[154:155], v[154:155], v[250:251] op_sel_hi:[1,0]
    v_cvt_pk_bf16_f32 v146, v152, v153
    v_cvt_pk_bf16_f32 v147, v154, v155
    ds_write_b128 v243, v[144:147] offset:1024
    v_pk_mul_f32 v[156:157], v[156:157], v[250:251] op_sel_hi:[1,0]
    v_pk_mul_f32 v[158:159], v[158:159], v[250:251] op_sel_hi:[1,0]
    v_cvt_pk_bf16_f32 v148, v156, v157
    v_cvt_pk_bf16_f32 v149, v158, v159
    v_pk_mul_f32 v[160:161], v[160:161], v[250:251] op_sel_hi:[1,0]
    v_pk_mul_f32 v[162:163], v[162:163], v[250:251] op_sel_hi:[1,0]
    v_cvt_pk_bf16_f32 v150, v160, v161
    v_cvt_pk_bf16_f32 v151, v162, v163
    ds_write_b128 v243, v[148:151] offset:2048
    v_pk_mul_f32 v[164:165], v[164:165], v[250:251] op_sel_hi:[1,0]
    v_pk_mul_f32 v[166:167], v[166:167], v[250:251] op_sel_hi:[1,0]
    v_cvt_pk_bf16_f32 v152, v164, v165
    v_cvt_pk_bf16_f32 v153, v166, v167
    v_pk_mul_f32 v[168:169], v[168:169], v[250:251] op_sel_hi:[1,0]
    v_pk_mul_f32 v[170:171], v[170:171], v[250:251] op_sel_hi:[1,0]
    v_cvt_pk_bf16_f32 v154, v168, v169
    v_cvt_pk_bf16_f32 v155, v170, v171
    ds_write_b128 v243, v[152:155] offset:3072
    s_waitcnt lgkmcnt(0)
    s_barrier
    s_lshr_b32 s25, s82, 1
    s_lshl_b32 s24, s25, 12
    v_add_u32 v246, s24, v244
    ds_read_b128 v[0:3], v246
    ds_read_b128 v[4:7], v246 offset:1024
    ds_read_b128 v[8:11], v246 offset:2048
    ds_read_b128 v[12:15], v246 offset:3072
    ds_read_b128 v[32:35], v246 offset:8192
    ds_read_b128 v[36:39], v246 offset:9216
    ds_read_b128 v[40:43], v246 offset:10240
    ds_read_b128 v[44:47], v246 offset:11264
    v_xor_b32 v243, 0x4000, v243
    s_waitcnt lgkmcnt(7)
    v_mfma_f32_16x16x32_bf16 v[172:175], a[0:3], v[0:3], 0
    v_mfma_f32_16x16x32_bf16 v[176:179], a[4:7], v[0:3], 0
    s_waitcnt lgkmcnt(6)
    v_mfma_f32_16x16x32_bf16 v[172:175], a[32:35], v[4:7], v[172:175]
    v_mfma_f32_16x16x32_bf16 v[176:179], a[36:39], v[4:7], v[176:179]
    s_waitcnt lgkmcnt(5)
    v_mfma_f32_16x16x32_bf16 v[172:175], a[64:67], v[8:11], v[172:175]
    v_mfma_f32_16x16x32_bf16 v[176:179], a[68:71], v[8:11], v[176:179]
    s_waitcnt lgkmcnt(4)
    v_mfma_f32_16x16x32_bf16 v[172:175], a[96:99], v[12:15], v[172:175]
    v_mfma_f32_16x16x32_bf16 v[176:179], a[100:103], v[12:15], v[176:179]
    s_waitcnt lgkmcnt(3)
    v_mfma_f32_16x16x32_bf16 v[172:175], a[128:131], v[32:35], v[172:175]
    v_mfma_f32_16x16x32_bf16 v[176:179], a[132:135], v[32:35], v[176:179]
    s_waitcnt lgkmcnt(2)
    v_mfma_f32_16x16x32_bf16 v[172:175], a[160:163], v[36:39], v[172:175]
    v_mfma_f32_16x16x32_bf16 v[176:179], a[164:167], v[36:39], v[176:179]
    s_waitcnt lgkmcnt(1)
    v_mfma_f32_16x16x32_bf16 v[172:175], a[192:195], v[40:43], v[172:175]
    v_mfma_f32_16x16x32_bf16 v[176:179], a[196:199], v[40:43], v[176:179]
    s_waitcnt lgkmcnt(0)
    v_mfma_f32_16x16x32_bf16 v[172:175], a[224:227], v[44:47], v[172:175]
    v_mfma_f32_16x16x32_bf16 v[176:179], a[228:231], v[44:47], v[176:179]
    v_mfma_f32_16x16x32_bf16 v[180:183], a[8:11], v[0:3], 0
    v_mfma_f32_16x16x32_bf16 v[184:187], a[12:15], v[0:3], 0
    ds_read_b128 v[16:19], v244 offset:4096
    v_mfma_f32_16x16x32_bf16 v[180:183], a[40:43], v[4:7], v[180:183]
    v_mfma_f32_16x16x32_bf16 v[184:187], a[44:47], v[4:7], v[184:187]
    ds_read_b128 v[20:23], v244 offset:5120
    v_cvt_pk_bf16_f32 v140, v172, v173
    v_cvt_pk_bf16_f32 v141, v174, v175
    v_cvt_pk_bf16_f32 v142, v176, v177
    v_cvt_pk_bf16_f32 v143, v178, v179
    v_min_u32 v140, 0xfffffffe, v140
    s_add_u32 s24, s51, 0
    s_cmp_lg_u32 s83, 0
    s_cbranch_scc1 L_near_145
    buffer_store_dwordx4 v[140:143], v242, s[8:11], s24 offen sc1
    s_branch L_far_146
L_near_145:
    buffer_store_dwordx4 v[140:143], v242, s[8:11], s24 offen
L_far_146:
    v_mfma_f32_16x16x32_bf16 v[180:183], a[72:75], v[8:11], v[180:183]
    v_mfma_f32_16x16x32_bf16 v[184:187], a[76:79], v[8:11], v[184:187]
    ds_read_b128 v[24:27], v244 offset:6144
    v_mfma_f32_16x16x32_bf16 v[180:183], a[104:107], v[12:15], v[180:183]
    v_mfma_f32_16x16x32_bf16 v[184:187], a[108:111], v[12:15], v[184:187]
    ds_read_b128 v[28:31], v244 offset:7168
    v_mfma_f32_16x16x32_bf16 v[180:183], a[136:139], v[32:35], v[180:183]
    v_mfma_f32_16x16x32_bf16 v[184:187], a[140:143], v[32:35], v[184:187]
    ds_read_b128 v[48:51], v244 offset:12288
    v_mfma_f32_16x16x32_bf16 v[180:183], a[168:171], v[36:39], v[180:183]
    v_mfma_f32_16x16x32_bf16 v[184:187], a[172:175], v[36:39], v[184:187]
    ds_read_b128 v[52:55], v244 offset:13312
    v_mfma_f32_16x16x32_bf16 v[180:183], a[200:203], v[40:43], v[180:183]
    v_mfma_f32_16x16x32_bf16 v[184:187], a[204:207], v[40:43], v[184:187]
    ds_read_b128 v[56:59], v244 offset:14336
    v_mfma_f32_16x16x32_bf16 v[180:183], a[232:235], v[44:47], v[180:183]
    v_mfma_f32_16x16x32_bf16 v[184:187], a[236:239], v[44:47], v[184:187]
    ds_read_b128 v[60:63], v244 offset:15360
    v_mfma_f32_16x16x32_bf16 v[188:191], a[16:19], v[0:3], 0
    v_mfma_f32_16x16x32_bf16 v[192:195], a[20:23], v[0:3], 0
    v_mfma_f32_16x16x32_bf16 v[188:191], a[48:51], v[4:7], v[188:191]
    v_mfma_f32_16x16x32_bf16 v[192:195], a[52:55], v[4:7], v[192:195]
    v_cvt_pk_bf16_f32 v144, v180, v181
    v_cvt_pk_bf16_f32 v145, v182, v183
    v_cvt_pk_bf16_f32 v146, v184, v185
    v_cvt_pk_bf16_f32 v147, v186, v187
    v_min_u32 v144, 0xfffffffe, v144
    s_cmp_lg_u32 s83, 0
    s_cbranch_scc1 L_near_147
    buffer_store_dwordx4 v[144:147], v242, s[8:11], s24 offen offset:64 sc1
    s_branch L_far_148
L_near_147:
    buffer_store_dwordx4 v[144:147], v242, s[8:11], s24 offen offset:64
L_far_148:
    v_mfma_f32_16x16x32_bf16 v[188:191], a[80:83], v[8:11], v[188:191]
    v_mfma_f32_16x16x32_bf16 v[192:195], a[84:87], v[8:11], v[192:195]
    v_mfma_f32_16x16x32_bf16 v[188:191], a[112:115], v[12:15], v[188:191]
    v_mfma_f32_16x16x32_bf16 v[192:195], a[116:119], v[12:15], v[192:195]
    v_mfma_f32_16x16x32_bf16 v[188:191], a[144:147], v[32:35], v[188:191]
    v_mfma_f32_16x16x32_bf16 v[192:195], a[148:151], v[32:35], v[192:195]
    v_mfma_f32_16x16x32_bf16 v[188:191], a[176:179], v[36:39], v[188:191]
    v_mfma_f32_16x16x32_bf16 v[192:195], a[180:183], v[36:39], v[192:195]
    v_mfma_f32_16x16x32_bf16 v[188:191], a[208:211], v[40:43], v[188:191]
    v_mfma_f32_16x16x32_bf16 v[192:195], a[212:215], v[40:43], v[192:195]
    v_mfma_f32_16x16x32_bf16 v[188:191], a[240:243], v[44:47], v[188:191]
    v_mfma_f32_16x16x32_bf16 v[192:195], a[244:247], v[44:47], v[192:195]
    v_mfma_f32_16x16x32_bf16 v[196:199], a[24:27], v[0:3], 0
    v_mfma_f32_16x16x32_bf16 v[200:203], a[28:31], v[0:3], 0
    v_mfma_f32_16x16x32_bf16 v[196:199], a[56:59], v[4:7], v[196:199]
    v_mfma_f32_16x16x32_bf16 v[200:203], a[60:63], v[4:7], v[200:203]
    v_cvt_pk_bf16_f32 v148, v188, v189
    v_cvt_pk_bf16_f32 v149, v190, v191
    v_cvt_pk_bf16_f32 v150, v192, v193
    v_cvt_pk_bf16_f32 v151, v194, v195
    v_min_u32 v148, 0xfffffffe, v148
    s_cmp_lg_u32 s83, 0
    s_cbranch_scc1 L_near_149
    buffer_store_dwordx4 v[148:151], v242, s[8:11], s24 offen offset:128 sc1
    s_branch L_far_150
L_near_149:
    buffer_store_dwordx4 v[148:151], v242, s[8:11], s24 offen offset:128
L_far_150:
    v_mfma_f32_16x16x32_bf16 v[196:199], a[88:91], v[8:11], v[196:199]
    v_mfma_f32_16x16x32_bf16 v[200:203], a[92:95], v[8:11], v[200:203]
    v_mfma_f32_16x16x32_bf16 v[196:199], a[120:123], v[12:15], v[196:199]
    v_mfma_f32_16x16x32_bf16 v[200:203], a[124:127], v[12:15], v[200:203]
    v_mfma_f32_16x16x32_bf16 v[196:199], a[152:155], v[32:35], v[196:199]
    v_mfma_f32_16x16x32_bf16 v[200:203], a[156:159], v[32:35], v[200:203]
    v_mfma_f32_16x16x32_bf16 v[196:199], a[184:187], v[36:39], v[196:199]
    v_mfma_f32_16x16x32_bf16 v[200:203], a[188:191], v[36:39], v[200:203]
    v_mfma_f32_16x16x32_bf16 v[196:199], a[216:219], v[40:43], v[196:199]
    v_mfma_f32_16x16x32_bf16 v[200:203], a[220:223], v[40:43], v[200:203]
    v_mfma_f32_16x16x32_bf16 v[196:199], a[248:251], v[44:47], v[196:199]
    v_mfma_f32_16x16x32_bf16 v[200:203], a[252:255], v[44:47], v[200:203]
    v_xor_b32 v244, 0x4000, v244
    s_cmp_lg_u32 s82, 0
    s_cbranch_scc1 L_half_143
    s_waitcnt lgkmcnt(0)
    v_mfma_f32_16x16x32_bf16 v[204:207], a[0:3], v[16:19], 0
    v_mfma_f32_16x16x32_bf16 v[208:211], a[4:7], v[16:19], 0
    v_mfma_f32_16x16x32_bf16 v[204:207], a[32:35], v[20:23], v[204:207]
    v_mfma_f32_16x16x32_bf16 v[208:211], a[36:39], v[20:23], v[208:211]
    v_cvt_pk_bf16_f32 v152, v196, v197
    v_cvt_pk_bf16_f32 v153, v198, v199
    v_cvt_pk_bf16_f32 v154, v200, v201
    v_cvt_pk_bf16_f32 v155, v202, v203
    v_min_u32 v152, 0xfffffffe, v152
    s_cmp_lg_u32 s83, 0
    s_cbranch_scc1 L_near_151
    buffer_store_dwordx4 v[152:155], v242, s[8:11], s24 offen offset:192 sc1
    s_branch L_far_152
L_near_151:
    buffer_store_dwordx4 v[152:155], v242, s[8:11], s24 offen offset:192
L_far_152:
    v_mfma_f32_16x16x32_bf16 v[204:207], a[64:67], v[24:27], v[204:207]
    v_mfma_f32_16x16x32_bf16 v[208:211], a[68:71], v[24:27], v[208:211]
    v_mfma_f32_16x16x32_bf16 v[204:207], a[96:99], v[28:31], v[204:207]
    v_mfma_f32_16x16x32_bf16 v[208:211], a[100:103], v[28:31], v[208:211]
    v_mfma_f32_16x16x32_bf16 v[204:207], a[128:131], v[48:51], v[204:207]
    v_mfma_f32_16x16x32_bf16 v[208:211], a[132:135], v[48:51], v[208:211]
    v_mfma_f32_16x16x32_bf16 v[204:207], a[160:163], v[52:55], v[204:207]
    v_mfma_f32_16x16x32_bf16 v[208:211], a[164:167], v[52:55], v[208:211]
    v_mfma_f32_16x16x32_bf16 v[204:207], a[192:195], v[56:59], v[204:207]
    v_mfma_f32_16x16x32_bf16 v[208:211], a[196:199], v[56:59], v[208:211]
    v_mfma_f32_16x16x32_bf16 v[204:207], a[224:227], v[60:63], v[204:207]
    v_mfma_f32_16x16x32_bf16 v[208:211], a[228:231], v[60:63], v[208:211]
    v_mfma_f32_16x16x32_bf16 v[212:215], a[8:11], v[16:19], 0
    v_mfma_f32_16x16x32_bf16 v[216:219], a[12:15], v[16:19], 0
    v_mfma_f32_16x16x32_bf16 v[212:215], a[40:43], v[20:23], v[212:215]
    v_mfma_f32_16x16x32_bf16 v[216:219], a[44:47], v[20:23], v[216:219]
    v_cvt_pk_bf16_f32 v140, v204, v205
    v_cvt_pk_bf16_f32 v141, v206, v207
    v_cvt_pk_bf16_f32 v142, v208, v209
    v_cvt_pk_bf16_f32 v143, v210, v211
    v_min_u32 v140, 0xfffffffe, v140
    s_add_u32 s24, s51, 16384
    s_cmp_lg_u32 s83, 0
    s_cbranch_scc1 L_near_153
    buffer_store_dwordx4 v[140:143], v242, s[8:11], s24 offen sc1
    s_branch L_far_154
L_near_153:
    buffer_store_dwordx4 v[140:143], v242, s[8:11], s24 offen
L_far_154:
    v_mfma_f32_16x16x32_bf16 v[212:215], a[72:75], v[24:27], v[212:215]
    v_mfma_f32_16x16x32_bf16 v[216:219], a[76:79], v[24:27], v[216:219]
    v_mfma_f32_16x16x32_bf16 v[212:215], a[104:107], v[28:31], v[212:215]
    v_mfma_f32_16x16x32_bf16 v[216:219], a[108:111], v[28:31], v[216:219]
    v_mfma_f32_16x16x32_bf16 v[212:215], a[136:139], v[48:51], v[212:215]
    v_mfma_f32_16x16x32_bf16 v[216:219], a[140:143], v[48:51], v[216:219]
    v_mfma_f32_16x16x32_bf16 v[212:215], a[168:171], v[52:55], v[212:215]
    v_mfma_f32_16x16x32_bf16 v[216:219], a[172:175], v[52:55], v[216:219]
    v_mfma_f32_16x16x32_bf16 v[212:215], a[200:203], v[56:59], v[212:215]
    v_mfma_f32_16x16x32_bf16 v[216:219], a[204:207], v[56:59], v[216:219]
    v_mfma_f32_16x16x32_bf16 v[212:215], a[232:235], v[60:63], v[212:215]
    v_mfma_f32_16x16x32_bf16 v[216:219], a[236:239], v[60:63], v[216:219]
    s_waitcnt vmcnt(5)
    v_mfma_f32_16x16x32_bf16 v[220:223], a[16:19], v[16:19], 0
    v_mfma_f32_16x16x32_bf16 v[224:227], a[20:23], v[16:19], 0
    v_mfma_f32_16x16x32_bf16 v[220:223], a[48:51], v[20:23], v[220:223]
    v_mfma_f32_16x16x32_bf16 v[224:227], a[52:55], v[20:23], v[224:227]
    v_cvt_pk_bf16_f32 v144, v212, v213
    v_cvt_pk_bf16_f32 v145, v214, v215
    v_cvt_pk_bf16_f32 v146, v216, v217
    v_cvt_pk_bf16_f32 v147, v218, v219
    v_min_u32 v144, 0xfffffffe, v144
    s_cmp_lg_u32 s83, 0
    s_cbranch_scc1 L_near_155
    buffer_store_dwordx4 v[144:147], v242, s[8:11], s24 offen offset:64 sc1
    s_branch L_far_156
L_near_155:
    buffer_store_dwordx4 v[144:147], v242, s[8:11], s24 offen offset:64
L_far_156:
    v_mfma_f32_16x16x32_bf16 v[220:223], a[80:83], v[24:27], v[220:223]
    v_mfma_f32_16x16x32_bf16 v[224:227], a[84:87], v[24:27], v[224:227]
    v_mfma_f32_16x16x32_bf16 v[220:223], a[112:115], v[28:31], v[220:223]
    v_mfma_f32_16x16x32_bf16 v[224:227], a[116:119], v[28:31], v[224:227]
    v_mfma_f32_16x16x32_bf16 v[220:223], a[144:147], v[48:51], v[220:223]
    v_mfma_f32_16x16x32_bf16 v[224:227], a[148:151], v[48:51], v[224:227]
    v_mfma_f32_16x16x32_bf16 v[220:223], a[176:179], v[52:55], v[220:223]
    v_mfma_f32_16x16x32_bf16 v[224:227], a[180:183], v[52:55], v[224:227]
    v_mfma_f32_16x16x32_bf16 v[220:223], a[208:211], v[56:59], v[220:223]
    v_mfma_f32_16x16x32_bf16 v[224:227], a[212:215], v[56:59], v[224:227]
    v_mfma_f32_16x16x32_bf16 v[220:223], a[240:243], v[60:63], v[220:223]
    v_mfma_f32_16x16x32_bf16 v[224:227], a[244:247], v[60:63], v[224:227]
    v_mfma_f32_16x16x32_bf16 v[228:231], a[24:27], v[16:19], 0
    v_mfma_f32_16x16x32_bf16 v[232:235], a[28:31], v[16:19], 0
    v_mfma_f32_16x16x32_bf16 v[228:231], a[56:59], v[20:23], v[228:231]
    v_mfma_f32_16x16x32_bf16 v[232:235], a[60:63], v[20:23], v[232:235]
    v_cvt_pk_bf16_f32 v148, v220, v221
    v_cvt_pk_bf16_f32 v149, v222, v223
    v_cvt_pk_bf16_f32 v150, v224, v225
    v_cvt_pk_bf16_f32 v151, v226, v227
    v_min_u32 v148, 0xfffffffe, v148
    s_cmp_lg_u32 s83, 0
    s_cbranch_scc1 L_near_157
    buffer_store_dwordx4 v[148:151], v242, s[8:11], s24 offen offset:128 sc1
    s_branch L_far_158
L_near_157:
    buffer_store_dwordx4 v[148:151], v242, s[8:11], s24 offen offset:128
L_far_158:
    v_mfma_f32_16x16x32_bf16 v[228:231], a[88:91], v[24:27], v[228:231]
    v_mfma_f32_16x16x32_bf16 v[232:235], a[92:95], v[24:27], v[232:235]
    v_mfma_f32_16x16x32_bf16 v[228:231], a[120:123], v[28:31], v[228:231]
    v_mfma_f32_16x16x32_bf16 v[232:235], a[124:127], v[28:31], v[232:235]
    v_mfma_f32_16x16x32_bf16 v[228:231], a[152:155], v[48:51], v[228:231]
    v_mfma_f32_16x16x32_bf16 v[232:235], a[156:159], v[48:51], v[232:235]
    v_mfma_f32_16x16x32_bf16 v[228:231], a[184:187], v[52:55], v[228:231]
    v_mfma_f32_16x16x32_bf16 v[232:235], a[188:191], v[52:55], v[232:235]
    v_mfma_f32_16x16x32_bf16 v[228:231], a[216:219], v[56:59], v[228:231]
    v_mfma_f32_16x16x32_bf16 v[232:235], a[220:223], v[56:59], v[232:235]
    v_mfma_f32_16x16x32_bf16 v[228:231], a[248:251], v[60:63], v[228:231]
    v_mfma_f32_16x16x32_bf16 v[232:235], a[252:255], v[60:63], v[232:235]
    s_nop 3
    v_cvt_pk_bf16_f32 v152, v228, v229
    v_cvt_pk_bf16_f32 v153, v230, v231
    s_nop 1
    v_cvt_pk_bf16_f32 v154, v232, v233
    v_cvt_pk_bf16_f32 v155, v234, v235
    v_min_u32 v152, 0xfffffffe, v152
    s_cmp_lg_u32 s83, 0
    s_cbranch_scc1 L_near_159
    buffer_store_dwordx4 v[152:155], v242, s[8:11], s24 offen offset:192 sc1
    s_branch L_far_160
L_near_159:
    buffer_store_dwordx4 v[152:155], v242, s[8:11], s24 offen offset:192
L_far_160:
    s_branch L_proj_144
L_half_143:
    s_nop 7
    v_cvt_pk_bf16_f32 v152, v196, v197
    v_cvt_pk_bf16_f32 v153, v198, v199
    v_cvt_pk_bf16_f32 v154, v200, v201
    v_cvt_pk_bf16_f32 v155, v202, v203
    v_min_u32 v152, 0xfffffffe, v152
    s_cmp_lg_u32 s83, 0
    s_cbranch_scc1 L_near_161
    buffer_store_dwordx4 v[152:155], v242, s[8:11], s24 offen offset:192 sc1
    s_branch L_far_162
L_near_161:
    buffer_store_dwordx4 v[152:155], v242, s[8:11], s24 offen offset:192
L_far_162:
    s_waitcnt lgkmcnt(0)
L_proj_144:
    s_cmp_lg_u32 s83, 3
    s_cbranch_scc1 L_flags_165
    s_waitcnt vmcnt(4)
    v_cmp_eq_u32 vcc, 0, v108
    s_cbranch_vccz L_parts_163
    v_lshrrev_b32 v246, 2, v240
    s_mov_b32 exec_lo, 0xffff
    s_mov_b32 exec_hi, 0
    s_mov_b32 s96, 0
L_poll_166:
    buffer_load_dword v247, v246, s[8:11], s52 offen sc1
    s_waitcnt vmcnt(0)
    v_cmp_gt_u32 vcc, 1, v247
    s_cbranch_vccz L_polld_167
    s_sleep 1
    s_add_u32 s96, s96, 1
    s_cmp_lt_u32 s96, 0x10000
    s_cbranch_scc1 L_poll_166
L_polld_167:
    s_mov_b64 exec, -1
    s_branch L_parts_163
L_flags_165:
    s_mov_b32 s62, 0x8f00
    buffer_load_dword v104, off, s[8:11], s62 sc1
    s_waitcnt vmcnt(0)
    s_barrier
    s_lshl_b32 s26, s20, 2
    s_add_u32 s26, s26, s52
    s_cmp_lg_u32 s100, 0
    s_cbranch_scc1 L_flag_169
    v_mov_b32 v246, 1
    s_mov_b64 exec, 1
    s_cmp_lg_u32 s83, 0
    s_cbranch_scc1 L_near_170
    buffer_store_dword v246, off, s[8:11], s26 sc1
    s_branch L_far_171
L_near_170:
    buffer_store_dword v246, off, s[8:11], s26
L_far_171:
    s_mov_b64 exec, -1
L_flag_169:
    v_lshrrev_b32 v246, 2, v240
    s_cmp_lg_u32 s100, 0
    s_cbranch_scc1 L_polls_174
    s_mov_b32 exec_lo, 0xffff
    s_mov_b32 exec_hi, 0
    s_mov_b32 s96, 0
L_poll_172:
    buffer_load_dword v247, v246, s[8:11], s52 offen sc1
    s_waitcnt vmcnt(0)
    v_cmp_gt_u32 vcc, 1, v247
    s_cbranch_vccz L_polld_173
    s_sleep 1
    s_add_u32 s96, s96, 1
    s_cmp_lt_u32 s96, 0x10000
    s_cbranch_scc1 L_poll_172
L_polld_173:
    s_mov_b64 exec, -1
L_polls_174:
    s_barrier
L_parts_163:
    s_cmp_lg_u32 s83, 0
    s_cbranch_scc1 L_near_181
    buffer_load_dwordx4 v[48:51], v240, s[8:11], s50 offen
    buffer_load_dwordx4 v[52:55], v105, s[8:11], s50 offen
    buffer_load_dwordx4 v[56:59], v106, s[8:11], s50 offen
    buffer_load_dwordx4 v[60:63], v107, s[8:11], s50 offen
    s_branch L_far_182
L_near_181:
    buffer_load_dwordx4 v[48:51], v240, s[8:11], s50 offen sc1
    buffer_load_dwordx4 v[52:55], v105, s[8:11], s50 offen sc1
    buffer_load_dwordx4 v[56:59], v106, s[8:11], s50 offen sc1
    buffer_load_dwordx4 v[60:63], v107, s[8:11], s50 offen sc1
L_far_182:
    v_mov_b32 v68, 0
    v_mov_b32 v69, 0
    v_mov_b32 v70, 0
    v_mov_b32 v71, 0
    v_mov_b32 v72, 0
    v_mov_b32 v73, 0
    v_mov_b32 v74, 0
    v_mov_b32 v75, 0
    s_mov_b32 s96, 0
L_gp_176:
    s_cmp_lg_u32 s83, 0
    s_cbranch_scc1 L_near_183
    buffer_load_dwordx4 v[32:35], v240, s[8:11], s61 offen
    buffer_load_dwordx4 v[36:39], v105, s[8:11], s61 offen
    buffer_load_dwordx4 v[40:43], v106, s[8:11], s61 offen
    buffer_load_dwordx4 v[44:47], v107, s[8:11], s61 offen
    s_branch L_far_184
L_near_183:
    buffer_load_dwordx4 v[32:35], v240, s[8:11], s61 offen sc1
    buffer_load_dwordx4 v[36:39], v105, s[8:11], s61 offen sc1
    buffer_load_dwordx4 v[40:43], v106, s[8:11], s61 offen sc1
    buffer_load_dwordx4 v[44:47], v107, s[8:11], s61 offen sc1
L_far_184:
    s_waitcnt vmcnt(4)
    v_max3_u32 v246, v48, v52, v56
    v_max_u32 v246, v246, v60
    v_cmp_eq_u32 vcc, -1, v246
    s_cbranch_vccz L_gb_177
    buffer_load_dwordx4 v[48:51], v240, s[8:11], s50 offen sc1
    buffer_load_dwordx4 v[52:55], v105, s[8:11], s50 offen sc1
    buffer_load_dwordx4 v[56:59], v106, s[8:11], s50 offen sc1
    buffer_load_dwordx4 v[60:63], v107, s[8:11], s50 offen sc1
    s_waitcnt vmcnt(4)
    v_max3_u32 v246, v32, v36, v40
    v_max_u32 v246, v246, v44
    v_cmp_eq_u32 vcc, -1, v246
    s_add_u32 s96, s96, 1
    s_cbranch_vccz L_ga_178
    s_cmp_lt_u32 s96, 0x10000
    s_cbranch_scc1 L_gp_176
L_gb_177:
    v_dot2_f32_bf16 v68, v48, s65, v68
    v_dot2_f32_bf16 v69, v48, s66, v69
    v_dot2_f32_bf16 v70, v49, s65, v70
    v_dot2_f32_bf16 v71, v49, s66, v71
    v_dot2_f32_bf16 v72, v50, s65, v72
    v_dot2_f32_bf16 v73, v50, s66, v73
    v_dot2_f32_bf16 v74, v51, s65, v74
    v_dot2_f32_bf16 v75, v51, s66, v75
    v_dot2_f32_bf16 v68, v52, s65, v68
    v_dot2_f32_bf16 v69, v52, s66, v69
    v_dot2_f32_bf16 v70, v53, s65, v70
    v_dot2_f32_bf16 v71, v53, s66, v71
    v_dot2_f32_bf16 v72, v54, s65, v72
    v_dot2_f32_bf16 v73, v54, s66, v73
    v_dot2_f32_bf16 v74, v55, s65, v74
    v_dot2_f32_bf16 v75, v55, s66, v75
    v_dot2_f32_bf16 v68, v56, s65, v68
    v_dot2_f32_bf16 v69, v56, s66, v69
    v_dot2_f32_bf16 v70, v57, s65, v70
    v_dot2_f32_bf16 v71, v57, s66, v71
    v_dot2_f32_bf16 v72, v58, s65, v72
    v_dot2_f32_bf16 v73, v58, s66, v73
    v_dot2_f32_bf16 v74, v59, s65, v74
    v_dot2_f32_bf16 v75, v59, s66, v75
    v_dot2_f32_bf16 v68, v60, s65, v68
    v_dot2_f32_bf16 v69, v60, s66, v69
    v_dot2_f32_bf16 v70, v61, s65, v70
    v_dot2_f32_bf16 v71, v61, s66, v71
    v_dot2_f32_bf16 v72, v62, s65, v72
    v_dot2_f32_bf16 v73, v62, s66, v73
    v_dot2_f32_bf16 v74, v63, s65, v74
    v_dot2_f32_bf16 v75, v63, s66, v75
    s_cmp_lg_u32 s82, 0
    s_cbranch_scc1 L_gd_179
    s_waitcnt vmcnt(0)
L_ga_178:
    v_dot2_f32_bf16 v68, v32, s65, v68
    v_dot2_f32_bf16 v69, v32, s66, v69
    v_dot2_f32_bf16 v70, v33, s65, v70
    v_dot2_f32_bf16 v71, v33, s66, v71
    v_dot2_f32_bf16 v72, v34, s65, v72
    v_dot2_f32_bf16 v73, v34, s66, v73
    v_dot2_f32_bf16 v74, v35, s65, v74
    v_dot2_f32_bf16 v75, v35, s66, v75
    v_dot2_f32_bf16 v68, v36, s65, v68
    v_dot2_f32_bf16 v69, v36, s66, v69
    v_dot2_f32_bf16 v70, v37, s65, v70
    v_dot2_f32_bf16 v71, v37, s66, v71
    v_dot2_f32_bf16 v72, v38, s65, v72
    v_dot2_f32_bf16 v73, v38, s66, v73
    v_dot2_f32_bf16 v74, v39, s65, v74
    v_dot2_f32_bf16 v75, v39, s66, v75
    v_dot2_f32_bf16 v68, v40, s65, v68
    v_dot2_f32_bf16 v69, v40, s66, v69
    v_dot2_f32_bf16 v70, v41, s65, v70
    v_dot2_f32_bf16 v71, v41, s66, v71
    v_dot2_f32_bf16 v72, v42, s65, v72
    v_dot2_f32_bf16 v73, v42, s66, v73
    v_dot2_f32_bf16 v74, v43, s65, v74
    v_dot2_f32_bf16 v75, v43, s66, v75
    v_dot2_f32_bf16 v68, v44, s65, v68
    v_dot2_f32_bf16 v69, v44, s66, v69
    v_dot2_f32_bf16 v70, v45, s65, v70
    v_dot2_f32_bf16 v71, v45, s66, v71
    v_dot2_f32_bf16 v72, v46, s65, v72
    v_dot2_f32_bf16 v73, v46, s66, v73
    v_dot2_f32_bf16 v74, v47, s65, v74
    v_dot2_f32_bf16 v75, v47, s66, v75
L_gd_179:
    s_nop 2
    ds_write_b128 v109, v[68:71]
    ds_write_b128 v109, v[72:75] offset:1024
    s_cmp_lg_u32 s82, 0
    s_cselect_b32 s24, 3, 1
    s_and_b32 s24, s24, s100
    s_waitcnt lgkmcnt(0)
    s_barrier
    s_cbranch_scc1 L_nofin_175
    ds_read_b128 v[112:115], v109 offset:4096
    ds_read_b128 v[116:119], v109 offset:5120
    s_cmp_eq_u32 s82, 0
    s_cbranch_scc1 L_g1_180
    ds_read_b128 v[120:123], v109 offset:8192
    ds_read_b128 v[124:127], v109 offset:9216
    ds_read_b128 v[128:131], v109 offset:12288
    ds_read_b128 v[132:135], v109 offset:13312
    s_waitcnt lgkmcnt(0)
    v_pk_add_f32 v[120:121], v[120:121], v[128:129]
    v_pk_add_f32 v[122:123], v[122:123], v[130:131]
    v_pk_add_f32 v[124:125], v[124:125], v[132:133]
    v_pk_add_f32 v[126:127], v[126:127], v[134:135]
    v_pk_add_f32 v[112:113], v[112:113], v[120:121]
    v_pk_add_f32 v[114:115], v[114:115], v[122:123]
    v_pk_add_f32 v[116:117], v[116:117], v[124:125]
    v_pk_add_f32 v[118:119], v[118:119], v[126:127]
L_g1_180:
    s_waitcnt lgkmcnt(0)
    v_pk_add_f32 v[68:69], v[68:69], v[112:113]
    v_pk_add_f32 v[70:71], v[70:71], v[114:115]
    v_pk_add_f32 v[72:73], v[72:73], v[116:117]
    v_pk_add_f32 v[74:75], v[74:75], v[118:119]
    v_cvt_pk_bf16_f32 v0, v68, v69
    v_cvt_pk_bf16_f32 v1, v70, v71
    v_cvt_pk_bf16_f32 v2, v72, v73
    v_cvt_pk_bf16_f32 v3, v74, v75
    v_lshlrev_b32 v68, 16, v0
    v_and_b32 v69, 0xffff0000, v0
    v_lshlrev_b32 v76, 16, v96
    v_and_b32 v77, 0xffff0000, v96
    v_lshlrev_b32 v70, 16, v1
    v_and_b32 v71, 0xffff0000, v1
    v_lshlrev_b32 v78, 16, v97
    v_and_b32 v79, 0xffff0000, v97
    v_lshlrev_b32 v72, 16, v2
    v_and_b32 v73, 0xffff0000, v2
    v_lshlrev_b32 v80, 16, v98
    v_and_b32 v81, 0xffff0000, v98
    v_lshlrev_b32 v74, 16, v3
    v_and_b32 v75, 0xffff0000, v3
    v_lshlrev_b32 v82, 16, v99
    v_and_b32 v83, 0xffff0000, v99
    v_pk_add_f32 v[68:69], v[68:69], v[76:77]
    v_pk_add_f32 v[70:71], v[70:71], v[78:79]
    v_pk_add_f32 v[72:73], v[72:73], v[80:81]
    v_pk_add_f32 v[74:75], v[74:75], v[82:83]
    v_cvt_pk_bf16_f32 v4, v68, v69
    v_cvt_pk_bf16_f32 v5, v70, v71
    v_cvt_pk_bf16_f32 v6, v72, v73
    v_cvt_pk_bf16_f32 v7, v74, v75
    v_lshlrev_b32 v68, 16, v4
    v_and_b32 v69, 0xffff0000, v4
    v_lshlrev_b32 v70, 16, v5
    v_and_b32 v71, 0xffff0000, v5
    v_lshlrev_b32 v72, 16, v6
    v_and_b32 v73, 0xffff0000, v6
    v_lshlrev_b32 v74, 16, v7
    v_and_b32 v75, 0xffff0000, v7
    v_add_f32 v84, v68, v69
    v_add_f32 v84, v84, v70
    v_add_f32 v84, v84, v71
    v_add_f32 v84, v84, v72
    v_add_f32 v84, v84, v73
    v_add_f32 v84, v84, v74
    v_add_f32 v84, v84, v75
    s_nop 1
    v_add_f32_dpp v84, v84, v84 row_ror:1 row_mask:0xf bank_mask:0xf
    s_nop 1
    v_add_f32_dpp v84, v84, v84 row_ror:2 row_mask:0xf bank_mask:0xf
    s_nop 1
    v_add_f32_dpp v84, v84, v84 row_ror:4 row_mask:0xf bank_mask:0xf
    s_nop 1
    v_add_f32_dpp v84, v84, v84 row_ror:8 row_mask:0xf bank_mask:0xf
    v_mov_b32 v85, v84
    s_nop 1
    v_permlane32_swap_b32 v85, v84
    v_add_f32 v84, v85, v84
    v_mov_b32 v85, v84
    s_nop 1
    v_permlane16_swap_b32 v85, v84
    v_add_f32 v84, v85, v84
    v_mul_f32 v84, 0x3b000000, v84
    v_cvt_pk_bf16_f32 v86, v84, v84
    v_and_b32 v86, 0xffff0000, v86
    v_sub_f32 v87, v84, v86
    v_sub_f32 v76, v68, v86
    v_sub_f32 v77, v69, v86
    v_sub_f32 v78, v70, v86
    v_sub_f32 v79, v71, v86
    v_sub_f32 v80, v72, v86
    v_sub_f32 v81, v73, v86
    v_sub_f32 v82, v74, v86
    v_sub_f32 v83, v75, v86
    v_mul_f32 v100, v76, v76
    v_fmac_f32 v100, v77, v77
    v_fmac_f32 v100, v78, v78
    v_fmac_f32 v100, v79, v79
    v_fmac_f32 v100, v80, v80
    v_fmac_f32 v100, v81, v81
    v_fmac_f32 v100, v82, v82
    v_fmac_f32 v100, v83, v83
    s_nop 1
    v_add_f32_dpp v100, v100, v100 row_ror:1 row_mask:0xf bank_mask:0xf
    s_nop 1
    v_add_f32_dpp v100, v100, v100 row_ror:2 row_mask:0xf bank_mask:0xf
    s_nop 1
    v_add_f32_dpp v100, v100, v100 row_ror:4 row_mask:0xf bank_mask:0xf
    s_nop 1
    v_add_f32_dpp v100, v100, v100 row_ror:8 row_mask:0xf bank_mask:0xf
    v_mov_b32 v85, v100
    s_nop 1
    v_permlane32_swap_b32 v85, v100
    v_add_f32 v100, v85, v100
    v_mov_b32 v85, v100
    s_nop 1
    v_permlane16_swap_b32 v85, v100
    v_add_f32 v100, v85, v100
    v_mul_f32 v85, v87, v87
    v_mul_f32 v100, 0x3b000000, v100
    v_sub_f32 v100, v100, v85
    v_max_f32 v100, 0, v100
    v_cvt_pk_bf16_f32 v100, v100, v100
    v_and_b32 v100, 0xffff0000, v100
    v_add_f32 v100, 0x3727c5ac, v100
    v_cvt_pk_bf16_f32 v100, v100, v100
    v_and_b32 v100, 0xffff0000, v100
    v_sqrt_f32 v100, v100
    s_nop 0
    v_cvt_pk_bf16_f32 v100, v100, v100
    v_and_b32 v100, 0xffff0000, v100
    v_rcp_f32 v100, v100
    v_cvt_pk_bf16_f32 v8, v76, v77
    v_cvt_pk_bf16_f32 v9, v78, v79
    v_cvt_pk_bf16_f32 v10, v80, v81
    v_cvt_pk_bf16_f32 v11, v82, v83
    v_lshlrev_b32 v76, 16, v8
    v_and_b32 v77, 0xffff0000, v8
    v_lshlrev_b32 v78, 16, v9
    v_and_b32 v79, 0xffff0000, v9
    v_lshlrev_b32 v80, 16, v10
    v_and_b32 v81, 0xffff0000, v10
    v_lshlrev_b32 v82, 16, v11
    v_and_b32 v83, 0xffff0000, v11
    v_mul_f32 v76, v100, v76
    v_mul_f32 v77, v100, v77
    v_mul_f32 v78, v100, v78
    v_mul_f32 v79, v100, v79
    v_mul_f32 v80, v100, v80
    v_mul_f32 v81, v100, v81
    v_mul_f32 v82, v100, v82
    v_mul_f32 v83, v100, v83
    v_cvt_pk_bf16_f32 v8, v76, v77
    v_cvt_pk_bf16_f32 v9, v78, v79
    v_cvt_pk_bf16_f32 v10, v80, v81
    v_cvt_pk_bf16_f32 v11, v82, v83
    v_lshlrev_b32 v76, 16, v8
    v_and_b32 v77, 0xffff0000, v8
    v_lshlrev_b32 v78, 16, v9
    v_and_b32 v79, 0xffff0000, v9
    v_lshlrev_b32 v80, 16, v10
    v_and_b32 v81, 0xffff0000, v10
    v_lshlrev_b32 v82, 16, v11
    v_and_b32 v83, 0xffff0000, v11
    v_lshlrev_b32 v88, 16, v236
    v_and_b32 v89, 0xffff0000, v236
    v_lshlrev_b32 v90, 16, v237
    v_and_b32 v91, 0xffff0000, v237
    v_lshlrev_b32 v92, 16, v238
    v_and_b32 v93, 0xffff0000, v238
    v_lshlrev_b32 v94, 16, v239
    v_and_b32 v95, 0xffff0000, v239
    v_mul_f32 v84, v76, v88
    v_fmac_f32 v84, v77, v89
    v_fmac_f32 v84, v78, v90
    v_fmac_f32 v84, v79, v91
    v_fmac_f32 v84, v80, v92
    v_fmac_f32 v84, v81, v93
    v_fmac_f32 v84, v82, v94
    v_fmac_f32 v84, v83, v95
    s_nop 1
    v_add_f32_dpp v84, v84, v84 row_ror:1 row_mask:0xf bank_mask:0xf
    s_nop 1
    v_add_f32_dpp v84, v84, v84 row_ror:2 row_mask:0xf bank_mask:0xf
    s_nop 1
    v_add_f32_dpp v84, v84, v84 row_ror:4 row_mask:0xf bank_mask:0xf
    s_nop 1
    v_add_f32_dpp v84, v84, v84 row_ror:8 row_mask:0xf bank_mask:0xf
    v_mov_b32 v85, v84
    s_nop 1
    v_permlane32_swap_b32 v85, v84
    v_add_f32 v84, v85, v84
    v_mov_b32 v85, v84
    s_nop 1
    v_permlane16_swap_b32 v85, v84
    v_add_f32 v84, v85, v84
    v_cvt_pk_bf16_f32 v84, v84, v84
    v_and_b32 v84, 0xffff0000, v84
    v_ashrrev_i32 v85, 31, v84
    v_or_b32 v85, 0x80000000, v85
    v_xor_b32 v84, v84, v85
    v_and_b32 v84, 0xffff0000, v84
    s_sub_u32 s62, 0x87ff, s60
    v_or_b32 v84, s62, v84
    s_lshl_b32 s62, s60, 2
    s_mov_b64 exec, 1
    s_add_u32 s63, s62, 0x6f00
    s_lshl_b32 s96, s60, 7
    s_add_u32 s96, s96, 0xfffcb000
    s_cmp_ge_u32 s60, 1984
    s_cselect_b32 s63, s96, s63
    s_cmp_ge_u32 s60, 1792
    s_cselect_b32 s63, s63, 0x7ff00000
    buffer_store_dword v84, off, s[8:11], s63 sc1
    s_mov_b64 exec, -1
    v_pk_add_f32 v[68:69], v[68:69], v[76:77]
    v_pk_add_f32 v[70:71], v[70:71], v[78:79]
    v_pk_add_f32 v[72:73], v[72:73], v[80:81]
    v_pk_add_f32 v[74:75], v[74:75], v[82:83]
    v_cvt_pk_bf16_f32 v12, v68, v69
    v_cvt_pk_bf16_f32 v13, v70, v71
    v_cvt_pk_bf16_f32 v14, v72, v73
    v_cvt_pk_bf16_f32 v15, v74, v75
    buffer_store_dwordx4 v[12:15], v240, s[16:19], s64 offen sc1
    s_mov_b64 exec, 1
    v_cmp_ge_u32 vcc, v104, v84
    s_cselect_b32 s63, 1, 0
    s_and_b32 s63, s63, vcc_lo
    s_cbranch_scc1 L_nokey_185
    s_mov_b64 exec, -1
    s_add_u32 s63, s64, 0x6000000
    buffer_store_dwordx4 v[4:7], v240, s[8:11], s63 offen sc1
    s_add_u32 s63, s64, 0x6200000
    buffer_store_dwordx4 v[8:11], v240, s[8:11], s63 offen sc1
    s_mov_b64 exec, 1
    s_add_u32 s62, s62, 0x6000
    s_waitcnt vmcnt(0)
    buffer_store_dword v84, off, s[8:11], s62 sc1
L_nokey_185:
    s_mov_b64 exec, -1
L_nofin_175:
    s_add_u32 s80, s80, 4
    s_add_u32 s22, s22, s23
    s_sub_u32 s24, s22, 68
    s_cmp_lt_u32 s24, 2
    s_cselect_b32 s82, 2, 0
    s_cselect_b32 s24, 6, 0
    s_sub_u32 s22, s22, s24
    s_branch L_p2_seg
L_redo_141:
    v_mfma_f32_16x16x32_bf16 v[116:119], v[16:19], v[0:3], 0
    v_mfma_f32_16x16x32_bf16 v[116:119], v[20:23], v[4:7], v[116:119]
    v_mfma_f32_16x16x32_bf16 v[116:119], v[24:27], v[8:11], v[116:119]
    v_mfma_f32_16x16x32_bf16 v[116:119], v[28:31], v[12:15], v[116:119]
    v_mfma_f32_16x16x32_bf16 v[120:123], v[32:35], v[0:3], 0
    v_mfma_f32_16x16x32_bf16 v[120:123], v[36:39], v[4:7], v[120:123]
    v_mfma_f32_16x16x32_bf16 v[120:123], v[40:43], v[8:11], v[120:123]
    v_mfma_f32_16x16x32_bf16 v[120:123], v[44:47], v[12:15], v[120:123]
    v_mov_b32 v247, s53
    v_cndmask_b32 v116, v247, v116, s[30:31]
    v_cndmask_b32 v117, v247, v117, s[32:33]
    v_cndmask_b32 v118, v247, v118, s[34:35]
    v_cndmask_b32 v119, v247, v119, s[36:37]
    s_nop 2
    v_cndmask_b32 v120, v247, v120, s[38:39]
    v_cndmask_b32 v121, v247, v121, s[40:41]
    v_cndmask_b32 v122, v247, v122, s[42:43]
    v_cndmask_b32 v123, v247, v123, s[44:45]
    v_max3_f32 v246, v116, v117, v118
    v_max3_f32 v246, v246, v119, v120
    v_max3_f32 v246, v246, v121, v122
    v_max_f32 v246, v246, v123
    v_max3_f32 v246, v246, v112, v113
    v_mov_b32 v247, v246
    s_nop 1
    v_permlane32_swap_b32 v247, v246
    v_max_f32 v246, v247, v246
    v_mov_b32 v247, v246
    s_nop 1
    v_permlane16_swap_b32 v247, v246
    v_max_f32 v246, v247, v246
    v_mul_f32 v248, s28, v246
    v_pk_fma_f32 v[116:117], v[116:117], s[28:29], v[248:249] op_sel_hi:[1,1,0] neg_lo:[0,0,1] neg_hi:[0,0,1]
    v_pk_fma_f32 v[118:119], v[118:119], s[28:29], v[248:249] op_sel_hi:[1,1,0] neg_lo:[0,0,1] neg_hi:[0,0,1]
    v_pk_fma_f32 v[120:121], v[120:121], s[28:29], v[248:249] op_sel_hi:[1,1,0] neg_lo:[0,0,1] neg_hi:[0,0,1]
    v_pk_fma_f32 v[122:123], v[122:123], s[28:29], v[248:249] op_sel_hi:[1,1,0] neg_lo:[0,0,1] neg_hi:[0,0,1]
    v_exp_f32 v116, v116
    v_exp_f32 v117, v117
    v_exp_f32 v118, v118
    v_exp_f32 v119, v119
    v_exp_f32 v120, v120
    v_exp_f32 v121, v121
    v_exp_f32 v122, v122
    v_exp_f32 v123, v123
    v_cvt_pk_bf16_f32 v124, v116, v117
    v_cvt_pk_bf16_f32 v125, v118, v119
    v_cvt_pk_bf16_f32 v126, v120, v121
    v_cvt_pk_bf16_f32 v127, v122, v123
    v_mov_b32 v129, 0
    s_nop 0
    v_mfma_f32_16x16x32_bf16 v[132:135], v[136:139], v[124:127], 0
    v_mfma_f32_16x16x32_bf16 v[140:143], v[64:67], v[124:127], 0
    v_mfma_f32_16x16x32_bf16 v[144:147], v[68:71], v[124:127], 0
    v_mfma_f32_16x16x32_bf16 v[148:151], v[72:75], v[124:127], 0
    v_mfma_f32_16x16x32_bf16 v[152:155], v[76:79], v[124:127], 0
    v_mfma_f32_16x16x32_bf16 v[156:159], v[80:83], v[124:127], 0
    v_mfma_f32_16x16x32_bf16 v[160:163], v[84:87], v[124:127], 0
    v_mfma_f32_16x16x32_bf16 v[164:167], v[88:91], v[124:127], 0
    v_mfma_f32_16x16x32_bf16 v[168:171], v[92:95], v[124:127], 0
    v_pk_fma_f32 v[114:115], v[112:113], s[28:29], v[248:249] op_sel_hi:[1,1,0] neg_lo:[0,0,1] neg_hi:[0,0,1]
    s_nop 6
    s_branch L_redone_142
L_p2_end:
    s_cmp_ge_u32 s67, 56
    s_cbranch_scc1 L_exit
    s_mov_b32 s74, 0
    s_mov_b32 s75, 0
    v_mov_b32 v202, 0x7ffffff0
    v_mbcnt_lo_u32_b32 v0, -1, 0
    v_mbcnt_hi_u32_b32 v0, -1, v0
    s_lshl_b32 s96, s100, 6
    v_add_u32 v0, s96, v0
    v_lshlrev_b32 v1, 6, v0
    s_getpc_b64 s[70:71]
L_pc_186:
    s_add_u32 s70, s70, L_ffn_round-L_pc_186
    s_addc_u32 s71, s71, 0
    v_min_u32 v1, L_code_end-L_ffn_round-4, v1
    global_load_dword v3, v1, s[70:71]
    v_mov_b32 v1, 0
    s_and_b32 s71, s101, 15
    s_lshl_b32 s71, s71, 7
    s_add_u32 s71, s71, 0x1000
    s_mov_b32 s72, 57
    s_cmp_lg_u32 s100, 0
    s_cbranch_scc1 L_polls_189
    s_mov_b32 exec_lo, 0x1
    s_mov_b32 exec_hi, 0
    s_mov_b32 s96, 0
L_poll_187:
    buffer_load_dword v2, v1, s[8:11], s71 offen sc1
    s_waitcnt vmcnt(0)
    v_cmp_gt_u32 vcc, s72, v2
    s_cbranch_vccz L_polld_188
    v_readfirstlane_b32 s97, v2
    s_nop 0
    s_sub_u32 s97, s72, s97
    s_cmp_lt_i32 s97, 3
    s_cbranch_scc1 L_near_190
    s_sleep 40
    s_cmp_lt_i32 s97, 5
    s_cbranch_scc1 L_near_190
    s_sleep 100
L_near_190:
    s_sleep 16
    s_add_u32 s96, s96, 1
    s_cmp_lt_u32 s96, 0x10000
    s_cbranch_scc1 L_poll_187
L_polld_188:
    s_mov_b64 exec, -1
L_polls_189:
    s_barrier
L_ffn_round:
    v_mbcnt_lo_u32_b32 v0, -1, 0
    v_mbcnt_hi_u32_b32 v0, -1, v0
    s_lshl_b32 s96, s100, 6
    v_add_u32 v0, s96, v0
    s_cmp_lg_u32 s75, 0
    s_cbranch_scc1 L_ffn_re
    v_lshlrev_b32 v30, 5, v0
    s_mov_b32 s69, 0x6000
    v_cmp_le_u32 vcc, 224, v0
    v_mov_b32 v29, s75
    v_add_u32 v29, -1, v29
    v_cndmask_b32 v19, 0, v29, vcc
    s_mov_b32 s70, 0
L_kpoll_191:
    buffer_load_dwordx4 v[20:23], v30, s[8:11], s69 offen sc1
    buffer_load_dwordx4 v[24:27], v30, s[8:11], s69 offen offset:16 sc1
    s_waitcnt vmcnt(0)
    v_min3_u32 v28, v20, v21, v22
    v_min3_u32 v28, v28, v23, v24
    v_min3_u32 v28, v28, v25, v26
    v_min_u32 v28, v28, v27
    v_or_b32 v28, v28, v19
    v_cmp_eq_u32 vcc, 0, v28
    s_cbranch_vccz L_kpolld_192
    s_sleep 6
    s_add_u32 s70, s70, 1
    s_cmp_lt_u32 s70, 0x10000
    s_cbranch_scc1 L_kpoll_191
L_kpolld_192:
    v_bfi_b32 v20, v19, 0, v20
    v_bfi_b32 v21, v19, 0, v21
    v_bfi_b32 v22, v19, 0, v22
    v_bfi_b32 v23, v19, 0, v23
    v_bfi_b32 v24, v19, 0, v24
    v_bfi_b32 v25, v19, 0, v25
    v_bfi_b32 v26, v19, 0, v26
    v_bfi_b32 v27, v19, 0, v27
    v_lshrrev_b32 v30, 6, v0
    v_lshlrev_b32 v30, 2, v30
    v_add_u32 v30, 0x20400, v30
    v_mov_b32 v31, 0x20400
    s_waitcnt vmcnt(0)
    v_max3_u32 v28, v20, v21, v22
    v_max3_u32 v28, v28, v23, v24
    v_max3_u32 v28, v28, v25, v26
    v_max_u32 v28, v28, v27
    s_nop 1
    v_max_u32_dpp v28, v28, v28 row_ror:1 row_mask:0xf bank_mask:0xf
    s_nop 1
    v_max_u32_dpp v28, v28, v28 row_ror:2 row_mask:0xf bank_mask:0xf
    s_nop 1
    v_max_u32_dpp v28, v28, v28 row_ror:4 row_mask:0xf bank_mask:0xf
    s_nop 1
    v_max_u32_dpp v28, v28, v28 row_ror:8 row_mask:0xf bank_mask:0xf
    v_mov_b32 v29, v28
    s_nop 1
    v_permlane32_swap_b32 v29, v28
    v_max_u32 v28, v29, v28
    v_mov_b32 v29, v28
    s_nop 1
    v_permlane16_swap_b32 v29, v28
    v_max_u32 v28, v29, v28
    ds_write_b32 v30, v28
    s_waitcnt lgkmcnt(0)
    s_barrier
    ds_read_b128 v[16:19], v31
    s_waitcnt lgkmcnt(0)
    v_max3_u32 v28, v16, v17, v18
    v_max_u32 v28, v28, v19
    s_nop 0
    v_readfirstlane_b32 s69, v28
    s_nop 1
    v_cmp_ne_u32 vcc, s69, v20
    s_nop 1
    v_cndmask_b32 v20, 0, v20, vcc
    v_cmp_ne_u32 vcc, s69, v21
    s_nop 1
    v_cndmask_b32 v21, 0, v21, vcc
    v_cmp_ne_u32 vcc, s69, v22
    s_nop 1
    v_cndmask_b32 v22, 0, v22, vcc
    v_cmp_ne_u32 vcc, s69, v23
    s_nop 1
    v_cndmask_b32 v23, 0, v23, vcc
    v_cmp_ne_u32 vcc, s69, v24
    s_nop 1
    v_cndmask_b32 v24, 0, v24, vcc
    v_cmp_ne_u32 vcc, s69, v25
    s_nop 1
    v_cndmask_b32 v25, 0, v25, vcc
    v_cmp_ne_u32 vcc, s69, v26
    s_nop 1
    v_cndmask_b32 v26, 0, v26, vcc
    v_cmp_ne_u32 vcc, s69, v27
    s_nop 1
    v_cndmask_b32 v27, 0, v27, vcc
    v_max3_u32 v28, v20, v21, v22
    v_max3_u32 v28, v28, v23, v24
    v_max3_u32 v28, v28, v25, v26
    v_max_u32 v28, v28, v27
    s_nop 1
    v_max_u32_dpp v28, v28, v28 row_ror:1 row_mask:0xf bank_mask:0xf
    s_nop 1
    v_max_u32_dpp v28, v28, v28 row_ror:2 row_mask:0xf bank_mask:0xf
    s_nop 1
    v_max_u32_dpp v28, v28, v28 row_ror:4 row_mask:0xf bank_mask:0xf
    s_nop 1
    v_max_u32_dpp v28, v28, v28 row_ror:8 row_mask:0xf bank_mask:0xf
    v_mov_b32 v29, v28
    s_nop 1
    v_permlane32_swap_b32 v29, v28
    v_max_u32 v28, v29, v28
    v_mov_b32 v29, v28
    s_nop 1
    v_permlane16_swap_b32 v29, v28
    v_max_u32 v28, v29, v28
    ds_write_b32 v30, v28 offset:16
    s_waitcnt lgkmcnt(0)
    s_barrier
    ds_read_b128 v[16:19], v31 offset:16
    s_waitcnt lgkmcnt(0)
    v_max3_u32 v28, v16, v17, v18
    v_max_u32 v28, v28, v19
    s_nop 0
    v_readfirstlane_b32 s70, v28
    s_barrier
    s_cmp_lg_u32 s67, 55
    s_cbranch_scc1 L_ffn_sel
    s_mov_b32 s71, 0x8f00
    s_cmp_lg_u32 s100, 0
    s_cbranch_scc1 L_flag_193
    v_mov_b32 v2, s70
    s_mov_b64 exec, 1
    buffer_store_dword v2, off, s[8:11], s71 sc1
    s_mov_b64 exec, -1
L_flag_193:
    s_branch L_ffn_sel
L_ffn_re:
    v_mul_u32_u24 v30, 12, v0
    v_lshlrev_b32 v31, 7, v0
    v_add_u32 v31, 0x500, v31
    v_mov_b32 v29, 0x20400
    s_cmp_lg_u32 s100, 0
    s_cbranch_scc1 L_rselw_197
    s_mov_b32 s71, 0x8b00
    s_mov_b32 s72, 0
L_rsel_194:
    buffer_load_dword v23, v31, s[8:11], s71 offen sc1
    buffer_load_dwordx3 v[20:22], v30, s[8:11], s71 offen sc1
    s_waitcnt vmcnt(0)
    v_min3_u32 v28, v20, v21, v22
    v_min_u32 v28, v28, v23
    v_cmp_eq_u32 vcc, 0, v28
    s_cbranch_vccz L_rseld_195
    s_sleep 1
    s_add_u32 s72, s72, 1
    s_cmp_lt_u32 s72, 0x10000
    s_cbranch_scc1 L_rsel_194
L_rseld_195:
    v_max3_u32 v28, v20, v21, v22
    v_max_u32 v28, v28, v23
    v_cmp_lt_u32 vcc, s70, v28
    s_cbranch_vccz L_rsele_196
    s_mov_b32 s71, 0x7c00
    v_lshlrev_b32 v31, 2, v0
    v_add_u32 v31, 768, v31
L_rack_198:
    buffer_load_dword v27, v31, s[8:11], s71 offen sc1
    buffer_load_dwordx3 v[24:26], v30, s[8:11], s71 offen sc1
    s_add_u32 s72, s72, 1
    s_waitcnt vmcnt(0)
    v_sub_u32 v24, v20, v24
    v_sub_u32 v25, v21, v25
    v_sub_u32 v26, v22, v26
    v_sub_u32 v27, v23, v27
    v_max3_u32 v28, v24, v25, v26
    v_max_u32 v28, v28, v27
    v_cmp_lt_u32 vcc, s70, v28
    s_cbranch_vccz L_rackd_199
    s_cmp_lt_u32 s72, 0x10000
    s_cbranch_scc1 L_rack_198
L_rackd_199:
    v_max3_u32 v28, v20, v21, v22
    v_max_u32 v28, v28, v23
    s_nop 1
    v_max_u32_dpp v28, v28, v28 row_ror:1 row_mask:0xf bank_mask:0xf
    s_nop 1
    v_max_u32_dpp v28, v28, v28 row_ror:2 row_mask:0xf bank_mask:0xf
    s_nop 1
    v_max_u32_dpp v28, v28, v28 row_ror:4 row_mask:0xf bank_mask:0xf
    s_nop 1
    v_max_u32_dpp v28, v28, v28 row_ror:8 row_mask:0xf bank_mask:0xf
    v_mov_b32 v29, v28
    s_nop 1
    v_permlane32_swap_b32 v29, v28
    v_max_u32 v28, v29, v28
    v_mov_b32 v29, v28
    s_nop 1
    v_permlane16_swap_b32 v29, v28
    v_max_u32 v28, v29, v28
    s_nop 0
    v_readfirstlane_b32 s71, v28
    s_nop 1
    v_cmp_ne_u32 vcc, s71, v20
    s_nop 1
    v_cndmask_b32 v20, 0, v20, vcc
    v_cmp_ne_u32 vcc, s71, v21
    s_nop 1
    v_cndmask_b32 v21, 0, v21, vcc
    v_cmp_ne_u32 vcc, s71, v22
    s_nop 1
    v_cndmask_b32 v22, 0, v22, vcc
    v_cmp_ne_u32 vcc, s71, v23
    s_nop 1
    v_cndmask_b32 v23, 0, v23, vcc
    v_max3_u32 v28, v20, v21, v22
    v_max_u32 v28, v28, v23
    s_nop 1
    v_max_u32_dpp v28, v28, v28 row_ror:1 row_mask:0xf bank_mask:0xf
    s_nop 1
    v_max_u32_dpp v28, v28, v28 row_ror:2 row_mask:0xf bank_mask:0xf
    s_nop 1
    v_max_u32_dpp v28, v28, v28 row_ror:4 row_mask:0xf bank_mask:0xf
    s_nop 1
    v_max_u32_dpp v28, v28, v28 row_ror:8 row_mask:0xf bank_mask:0xf
    v_mov_b32 v29, v28
    s_nop 1
    v_permlane32_swap_b32 v29, v28
    v_max_u32 v28, v29, v28
    v_mov_b32 v29, v28
    s_nop 1
    v_permlane16_swap_b32 v29, v28
    v_max_u32 v28, v29, v28
    s_nop 0
    v_readfirstlane_b32 s72, v28
    s_nop 0
    s_max_u32 s70, s70, s72
    s_min_u32 s72, s71, s69
    s_max_u32 s70, s70, s72
    s_max_u32 s69, s69, s71
    v_mov_b32 v29, 0x20400
L_rsele_196:
    v_mov_b32 v20, s69
    v_mov_b32 v21, s70
    ds_write_b64 v29, v[20:21]
    s_waitcnt lgkmcnt(0)
L_rselw_197:
    s_barrier
    ds_read_b64 v[20:21], v29
    s_waitcnt lgkmcnt(0)
    v_readfirstlane_b32 s69, v20
    v_readfirstlane_b32 s70, v21
    s_nop 3
L_ffn_sel:
    s_and_b32 s71, s69, 2047
    s_lshl_b32 s71, s71, 11
    s_and_b32 s72, s70, 2047
    s_or_b32 s71, s71, s72
    s_add_u32 s71, s71, 1
    s_cmp_eq_u32 s71, s74
    s_cbranch_scc1 L_ffn_same
    s_mov_b32 s74, s71
    s_mov_b32 exec_lo, 0xff
    s_mov_b32 exec_hi, 0
    buffer_store_dwordx2 v[204:205], v202, s[16:19], 0 offen sc1
    s_mov_b64 exec, -1
    v_and_b32 v1, 63, v0
    v_lshrrev_b32 v2, 4, v1
    v_and_b32 v3, 15, v1
    v_lshrrev_b32 v6, 2, v3
    s_and_b32 s71, s69, 2047
    s_sub_u32 s71, 2047, s71
    s_and_b32 s72, s70, 2047
    s_sub_u32 s72, 2047, s72
    v_and_b32 v4, 1, v3
    v_cmp_eq_u32 vcc, 0, v4
    v_mov_b32 v4, s71
    v_mov_b32 v5, s72
    v_cndmask_b32 v4, v5, v4, vcc
    v_lshlrev_b32 v4, 10, v4
    v_lshl_add_u32 v4, v2, 4, v4
    s_mov_b32 s71, 0x6200000
    buffer_load_dwordx4 v[32:35], v4, s[8:11], s71 offen
    buffer_load_dwordx4 v[36:39], v4, s[8:11], s71 offen offset:64
    buffer_load_dwordx4 v[40:43], v4, s[8:11], s71 offen offset:128
    buffer_load_dwordx4 v[44:47], v4, s[8:11], s71 offen offset:192
    buffer_load_dwordx4 v[48:51], v4, s[8:11], s71 offen offset:256
    buffer_load_dwordx4 v[52:55], v4, s[8:11], s71 offen offset:320
    buffer_load_dwordx4 v[56:59], v4, s[8:11], s71 offen offset:384
    buffer_load_dwordx4 v[60:63], v4, s[8:11], s71 offen offset:448
    buffer_load_dwordx4 v[64:67], v4, s[8:11], s71 offen offset:512
    buffer_load_dwordx4 v[68:71], v4, s[8:11], s71 offen offset:576
    buffer_load_dwordx4 v[72:75], v4, s[8:11], s71 offen offset:640
    buffer_load_dwordx4 v[76:79], v4, s[8:11], s71 offen offset:704
    buffer_load_dwordx4 v[80:83], v4, s[8:11], s71 offen offset:768
    buffer_load_dwordx4 v[84:87], v4, s[8:11], s71 offen offset:832
    buffer_load_dwordx4 v[88:91], v4, s[8:11], s71 offen offset:896
    buffer_load_dwordx4 v[92:95], v4, s[8:11], s71 offen offset:960
    v_lshl_add_u32 v4, v2, 3, v6
    v_lshlrev_b32 v4, 6, v4
    v_and_b32 v5, 3, v3
    v_lshl_add_u32 v4, v5, 3, v4
    s_lshr_b32 s71, s68, 1
    s_lshl_b32 s71, s71, 15
    s_and_b32 s72, s68, 1
    s_lshl_b32 s72, s72, 5
    s_add_u32 s71, s71, s72
    s_add_u32 s71, s71, 0x8000
    v_add_u32 v7, s71, v4
    ds_read_b64_tr_b16 v[96:97], v7
    ds_read_b64_tr_b16 v[98:99], v7 offset:256
    ds_read_b64_tr_b16 v[100:101], v7 offset:2048
    ds_read_b64_tr_b16 v[102:103], v7 offset:2304
    ds_read_b64_tr_b16 v[104:105], v7 offset:4096
    ds_read_b64_tr_b16 v[106:107], v7 offset:4352
    ds_read_b64_tr_b16 v[108:109], v7 offset:6144
    ds_read_b64_tr_b16 v[110:111], v7 offset:6400
    s_waitcnt lgkmcnt(0)
    ds_read_b64_tr_b16 v[112:113], v7 offset:8192
    ds_read_b64_tr_b16 v[114:115], v7 offset:8448
    ds_read_b64_tr_b16 v[116:117], v7 offset:10240
    ds_read_b64_tr_b16 v[118:119], v7 offset:10496
    ds_read_b64_tr_b16 v[120:121], v7 offset:12288
    ds_read_b64_tr_b16 v[122:123], v7 offset:12544
    ds_read_b64_tr_b16 v[124:125], v7 offset:14336
    ds_read_b64_tr_b16 v[126:127], v7 offset:14592
    s_waitcnt lgkmcnt(0)
    ds_read_b64_tr_b16 v[128:129], v7 offset:16384
    ds_read_b64_tr_b16 v[130:131], v7 offset:16640
    ds_read_b64_tr_b16 v[132:133], v7 offset:18432
    ds_read_b64_tr_b16 v[134:135], v7 offset:18688
    ds_read_b64_tr_b16 v[136:137], v7 offset:20480
    ds_read_b64_tr_b16 v[138:139], v7 offset:20736
    ds_read_b64_tr_b16 v[140:141], v7 offset:22528
    ds_read_b64_tr_b16 v[142:143], v7 offset:22784
    s_waitcnt lgkmcnt(0)
    ds_read_b64_tr_b16 v[144:145], v7 offset:24576
    ds_read_b64_tr_b16 v[146:147], v7 offset:24832
    ds_read_b64_tr_b16 v[148:149], v7 offset:26624
    ds_read_b64_tr_b16 v[150:151], v7 offset:26880
    ds_read_b64_tr_b16 v[152:153], v7 offset:28672
    ds_read_b64_tr_b16 v[154:155], v7 offset:28928
    ds_read_b64_tr_b16 v[156:157], v7 offset:30720
    ds_read_b64_tr_b16 v[158:159], v7 offset:30976
    s_waitcnt lgkmcnt(0)
    s_waitcnt vmcnt(0)
    v_mfma_f32_16x16x32_bf16 v[8:11], v[32:35], v[96:99], 0
    v_mfma_f32_16x16x32_bf16 v[8:11], v[36:39], v[100:103], v[8:11]
    v_mfma_f32_16x16x32_bf16 v[8:11], v[40:43], v[104:107], v[8:11]
    v_mfma_f32_16x16x32_bf16 v[8:11], v[44:47], v[108:111], v[8:11]
    v_mfma_f32_16x16x32_bf16 v[8:11], v[48:51], v[112:115], v[8:11]
    v_mfma_f32_16x16x32_bf16 v[8:11], v[52:55], v[116:119], v[8:11]
    v_mfma_f32_16x16x32_bf16 v[8:11], v[56:59], v[120:123], v[8:11]
    v_mfma_f32_16x16x32_bf16 v[8:11], v[60:63], v[124:127], v[8:11]
    v_mfma_f32_16x16x32_bf16 v[8:11], v[64:67], v[128:131], v[8:11]
    v_mfma_f32_16x16x32_bf16 v[8:11], v[68:71], v[132:135], v[8:11]
    v_mfma_f32_16x16x32_bf16 v[8:11], v[72:75], v[136:139], v[8:11]
    v_mfma_f32_16x16x32_bf16 v[8:11], v[76:79], v[140:143], v[8:11]
    v_mfma_f32_16x16x32_bf16 v[8:11], v[80:83], v[144:147], v[8:11]
    v_mfma_f32_16x16x32_bf16 v[8:11], v[84:87], v[148:151], v[8:11]
    v_mfma_f32_16x16x32_bf16 v[8:11], v[88:91], v[152:155], v[8:11]
    v_mfma_f32_16x16x32_bf16 v[8:11], v[92:95], v[156:159], v[8:11]
    s_nop 7
    v_cvt_pk_bf16_f32 v8, v8, v8
    v_and_b32 v8, 0xffff0000, v8
    v_cvt_pk_bf16_f32 v9, v9, v9
    v_and_b32 v9, 0xffff0000, v9
    s_cmp_ge_u32 s68, 2
    s_cbranch_scc1 L_ffn_up_200
    v_mul_f32 v13, 0xbfb8aa3b, v8
    v_exp_f32 v13, v13
    s_nop 0
    v_add_f32 v13, 1.0, v13
    v_rcp_f32 v12, v13
    s_nop 0
    v_mul_f32 v8, v12, v8
    v_cvt_pk_bf16_f32 v8, v8, v8
    v_and_b32 v8, 0xffff0000, v8
    v_mul_f32 v13, 0xbfb8aa3b, v9
    v_exp_f32 v13, v13
    s_nop 0
    v_add_f32 v13, 1.0, v13
    v_rcp_f32 v12, v13
    s_nop 0
    v_mul_f32 v9, v12, v9
    v_cvt_pk_bf16_f32 v9, v9, v9
    v_and_b32 v9, 0xffff0000, v9
    s_nop 4
L_ffn_up_200:
    s_lshr_b32 s71, s68, 1
    s_lshl_b32 s71, s71, 8
    s_and_b32 s72, s68, 1
    s_lshl_b32 s72, s72, 6
    s_add_u32 s71, s71, s72
    s_add_u32 s71, s71, 0x20000
    v_lshlrev_b32 v4, 2, v3
    v_add_u32 v4, s71, v4
    ds_write_b32 v4, v8
    ds_write_b32 v4, v9 offset:128
    s_waitcnt lgkmcnt(0)
    s_barrier
    v_and_b32 v4, 1, v3
    v_lshlrev_b32 v4, 7, v4
    v_lshl_add_u32 v4, v2, 5, v4
    v_add_u32 v4, 0x20000, v4
    ds_read_b128 v[32:35], v4
    ds_read_b128 v[36:39], v4 offset:16
    ds_read_b128 v[40:43], v4 offset:256
    ds_read_b128 v[44:47], v4 offset:272
    v_lshl_add_u32 v5, v2, 3, v6
    v_lshlrev_b32 v5, 10, v5
    v_and_b32 v7, 3, v3
    v_lshl_add_u32 v5, v7, 3, v5
    s_lshl_b32 s71, s68, 8
    s_add_u32 s71, s71, 0x18000
    v_add_u32 v7, s71, v5
    s_waitcnt lgkmcnt(0)
    ds_read_b64_tr_b16 v[96:97], v7
    ds_read_b64_tr_b16 v[98:99], v7 offset:4096
    ds_read_b64_tr_b16 v[100:101], v7 offset:32
    ds_read_b64_tr_b16 v[102:103], v7 offset:4128
    ds_read_b64_tr_b16 v[104:105], v7 offset:64
    ds_read_b64_tr_b16 v[106:107], v7 offset:4160
    ds_read_b64_tr_b16 v[108:109], v7 offset:96
    ds_read_b64_tr_b16 v[110:111], v7 offset:4192
    s_waitcnt lgkmcnt(0)
    ds_read_b64_tr_b16 v[112:113], v7 offset:128
    ds_read_b64_tr_b16 v[114:115], v7 offset:4224
    ds_read_b64_tr_b16 v[116:117], v7 offset:160
    ds_read_b64_tr_b16 v[118:119], v7 offset:4256
    ds_read_b64_tr_b16 v[120:121], v7 offset:192
    ds_read_b64_tr_b16 v[122:123], v7 offset:4288
    ds_read_b64_tr_b16 v[124:125], v7 offset:224
    ds_read_b64_tr_b16 v[126:127], v7 offset:4320
    v_mul_f32 v32, v32, v40
    v_mul_f32 v33, v33, v41
    v_mul_f32 v34, v34, v42
    v_mul_f32 v35, v35, v43
    v_mul_f32 v36, v36, v44
    v_mul_f32 v37, v37, v45
    v_mul_f32 v38, v38, v46
    v_mul_f32 v39, v39, v47
    v_cvt_pk_bf16_f32 v48, v32, v33
    v_cvt_pk_bf16_f32 v49, v34, v35
    v_cvt_pk_bf16_f32 v50, v36, v37
    v_cvt_pk_bf16_f32 v51, v38, v39
    s_waitcnt lgkmcnt(0)
    s_nop 0
    v_mfma_f32_16x16x32_bf16 v[56:59], v[48:51], v[96:99], 0
    v_mfma_f32_16x16x32_bf16 v[60:63], v[48:51], v[100:103], 0
    v_mfma_f32_16x16x32_bf16 v[64:67], v[48:51], v[104:107], 0
    v_mfma_f32_16x16x32_bf16 v[68:71], v[48:51], v[108:111], 0
    v_mfma_f32_16x16x32_bf16 v[72:75], v[48:51], v[112:115], 0
    v_mfma_f32_16x16x32_bf16 v[76:79], v[48:51], v[116:119], 0
    v_mfma_f32_16x16x32_bf16 v[80:83], v[48:51], v[120:123], 0
    v_mfma_f32_16x16x32_bf16 v[84:87], v[48:51], v[124:127], 0
    v_cmp_eq_u32 vcc, 0, v2
    v_lshlrev_b32 v4, 11, v2
    v_lshl_add_u32 v4, v3, 2, v4
    s_lshl_b32 s71, s67, 12
    s_lshl_b32 s72, s68, 9
    s_add_u32 s71, s71, s72
    s_add_u32 s71, s71, 0x6410000
    v_cndmask_b32 v56, v57, v56, vcc
    v_cndmask_b32 v60, v61, v60, vcc
    v_cndmask_b32 v64, v65, v64, vcc
    v_cndmask_b32 v68, v69, v68, vcc
    v_cndmask_b32 v72, v73, v72, vcc
    v_cndmask_b32 v76, v77, v76, vcc
    v_cndmask_b32 v80, v81, v80, vcc
    v_cndmask_b32 v84, v85, v84, vcc
    s_mov_b32 exec_hi, 0
    buffer_store_dword v56, v4, s[8:11], s71 offen sc1
    buffer_store_dword v60, v4, s[8:11], s71 offen offset:64 sc1
    buffer_store_dword v64, v4, s[8:11], s71 offen offset:128 sc1
    buffer_store_dword v68, v4, s[8:11], s71 offen offset:192 sc1
    buffer_store_dword v72, v4, s[8:11], s71 offen offset:256 sc1
    buffer_store_dword v76, v4, s[8:11], s71 offen offset:320 sc1
    buffer_store_dword v80, v4, s[8:11], s71 offen offset:384 sc1
    buffer_store_dword v84, v4, s[8:11], s71 offen offset:448 sc1
    s_mov_b64 exec, -1
    s_waitcnt vmcnt(0)
    s_barrier
    s_lshl_b32 s71, s67, 2
    s_lshl_b32 s72, s75, 8
    s_add_u32 s71, s71, s72
    s_add_u32 s71, s71, 0x8000
    s_cmp_lg_u32 s100, 0
    s_cbranch_scc1 L_flag_201
    v_mov_b32 v2, s74
    s_mov_b64 exec, 1
    buffer_store_dword v2, off, s[8:11], s71 sc1
    s_mov_b64 exec, -1
L_flag_201:
    s_cmp_ge_u32 s67, 8
    s_cbranch_scc1 L_ffn_same
    s_load_dwordx2 s[16:17], s[0:1], 96
    s_waitcnt lgkmcnt(0)
    s_and_b32 s17, s17, 0xffff
    s_mov_b32 s18, 0x200000
    s_mov_b32 s19, 0x20000
    v_and_b32 v3, 63, v0
    s_cmp_lt_u32 s100, 2
    s_cselect_b32 s71, s69, s70
    v_mov_b32 v5, s71
    s_and_b32 s71, s71, 2047
    s_sub_u32 s71, 2047, s71
    s_lshl_b32 s71, s71, 10
    s_lshl_b32 s72, s67, 1
    s_and_b32 s96, s100, 1
    s_add_u32 s72, s72, s96
    s_lshl_b32 s96, s72, 6
    s_add_u32 s71, s71, s96
    v_and_b32 v4, 7, v3
    v_lshlrev_b32 v6, 3, v4
    v_add_u32 v6, s71, v6
    v_lshrrev_b32 v7, 3, v3
    v_lshlrev_b32 v7, 12, v7
    v_lshl_add_u32 v7, v4, 4, v7
    s_lshl_b32 s72, s72, 7
    s_lshr_b32 s96, s100, 1
    s_lshl_b32 s96, s96, 11
    s_add_u32 s72, s72, s96
    v_add_u32 v7, s72, v7
    s_mov_b32 s71, 0x6000000
    s_mov_b32 s72, 0x6200000
    buffer_load_dwordx2 v[8:9], v6, s[8:11], s71 offen sc1
    buffer_load_dwordx2 v[10:11], v6, s[8:11], s72 offen sc1
    v_and_b32 v5, 0xffff0000, v5
    v_ashrrev_i32 v4, 31, v5
    v_not_b32 v4, v4
    v_or_b32 v4, 0x80000000, v4
    v_xor_b32 v5, v5, v4
    v_and_b32 v5, 0xffff0000, v5
    v_mul_f32 v23, 0xbfb8aa3b, v5
    v_exp_f32 v23, v23
    s_nop 0
    v_add_f32 v23, 1.0, v23
    v_rcp_f32 v22, v23
    s_nop 0
    v_cvt_pk_bf16_f32 v22, v22, v22
    v_and_b32 v22, 0xffff0000, v22
    v_lshlrev_b32 v1, 2, v0
    s_lshl_b32 s71, s75, 8
    s_add_u32 s71, s71, 0x8000
    s_cmp_lg_u32 s100, 0
    s_cbranch_scc1 L_polls_204
    s_mov_b32 exec_hi, 0xffffff
    s_mov_b32 s96, 0
L_poll_202:
    buffer_load_dword v2, v1, s[8:11], s71 offen sc1
    s_waitcnt vmcnt(0)
    v_cmp_ne_u32 vcc, s74, v2
    s_cbranch_vccz L_polld_203
    s_sleep 2
    s_add_u32 s96, s96, 1
    s_cmp_lt_u32 s96, 0x10000
    s_cbranch_scc1 L_poll_202
L_polld_203:
    s_mov_b64 exec, -1
L_polls_204:
    s_barrier
    s_mov_b32 s71, 0x6410000
    buffer_load_dwordx4 v[32:35], v7, s[8:11], s71 offen sc1
    s_add_u32 s71, s71, 32768
    buffer_load_dwordx4 v[36:39], v7, s[8:11], s71 offen sc1
    s_add_u32 s71, s71, 32768
    buffer_load_dwordx4 v[40:43], v7, s[8:11], s71 offen sc1
    s_add_u32 s71, s71, 32768
    buffer_load_dwordx4 v[44:47], v7, s[8:11], s71 offen sc1
    s_add_u32 s71, s71, 32768
    buffer_load_dwordx4 v[48:51], v7, s[8:11], s71 offen sc1
    s_add_u32 s71, s71, 32768
    buffer_load_dwordx4 v[52:55], v7, s[8:11], s71 offen sc1
    s_add_u32 s71, s71, 32768
    buffer_load_dwordx4 v[56:59], v7, s[8:11], s71 offen sc1
    s_add_u32 s71, s71, 32768
    s_waitcnt vmcnt(7)
    v_lshlrev_b32 v12, 16, v8
    v_and_b32 v13, 0xffff0000, v8
    v_lshlrev_b32 v16, 16, v10
    v_and_b32 v17, 0xffff0000, v10
    v_lshlrev_b32 v14, 16, v9
    v_and_b32 v15, 0xffff0000, v9
    v_lshlrev_b32 v18, 16, v11
    v_and_b32 v19, 0xffff0000, v11
    s_waitcnt vmcnt(0)
    v_pk_add_f32 v[32:33], v[32:33], v[36:37]
    v_pk_add_f32 v[34:35], v[34:35], v[38:39]
    v_pk_add_f32 v[32:33], v[32:33], v[40:41]
    v_pk_add_f32 v[34:35], v[34:35], v[42:43]
    v_pk_add_f32 v[32:33], v[32:33], v[44:45]
    v_pk_add_f32 v[34:35], v[34:35], v[46:47]
    v_pk_add_f32 v[32:33], v[32:33], v[48:49]
    v_pk_add_f32 v[34:35], v[34:35], v[50:51]
    v_pk_add_f32 v[32:33], v[32:33], v[52:53]
    v_pk_add_f32 v[34:35], v[34:35], v[54:55]
    v_pk_add_f32 v[32:33], v[32:33], v[56:57]
    v_pk_add_f32 v[34:35], v[34:35], v[58:59]
    s_nop 0
    v_add_f32_dpp v32, v32, v32 row_ror:8 row_mask:0xf bank_mask:0xf
    v_add_f32_dpp v33, v33, v33 row_ror:8 row_mask:0xf bank_mask:0xf
    v_add_f32_dpp v34, v34, v34 row_ror:8 row_mask:0xf bank_mask:0xf
    v_add_f32_dpp v35, v35, v35 row_ror:8 row_mask:0xf bank_mask:0xf
    v_mov_b32 v24, v32
    s_nop 1
    v_permlane32_swap_b32 v24, v32
    v_add_f32 v32, v24, v32
    v_mov_b32 v24, v32
    s_nop 1
    v_permlane16_swap_b32 v24, v32
    v_add_f32 v32, v24, v32
    v_mov_b32 v24, v33
    s_nop 1
    v_permlane32_swap_b32 v24, v33
    v_add_f32 v33, v24, v33
    v_mov_b32 v24, v33
    s_nop 1
    v_permlane16_swap_b32 v24, v33
    v_add_f32 v33, v24, v33
    v_mov_b32 v24, v34
    s_nop 1
    v_permlane32_swap_b32 v24, v34
    v_add_f32 v34, v24, v34
    v_mov_b32 v24, v34
    s_nop 1
    v_permlane16_swap_b32 v24, v34
    v_add_f32 v34, v24, v34
    v_mov_b32 v24, v35
    s_nop 1
    v_permlane32_swap_b32 v24, v35
    v_add_f32 v35, v24, v35
    v_mov_b32 v24, v35
    s_nop 1
    v_permlane16_swap_b32 v24, v35
    v_add_f32 v35, v24, v35
    v_cvt_pk_bf16_f32 v32, v32, v32
    v_and_b32 v32, 0xffff0000, v32
    v_mul_f32 v32, v22, v32
    v_cvt_pk_bf16_f32 v32, v32, v32
    v_and_b32 v32, 0xffff0000, v32
    v_add_f32 v32, v16, v32
    v_cvt_pk_bf16_f32 v32, v32, v32
    v_and_b32 v32, 0xffff0000, v32
    v_add_f32 v32, v12, v32
    v_cvt_pk_bf16_f32 v33, v33, v33
    v_and_b32 v33, 0xffff0000, v33
    v_mul_f32 v33, v22, v33
    v_cvt_pk_bf16_f32 v33, v33, v33
    v_and_b32 v33, 0xffff0000, v33
    v_add_f32 v33, v17, v33
    v_cvt_pk_bf16_f32 v33, v33, v33
    v_and_b32 v33, 0xffff0000, v33
    v_add_f32 v33, v13, v33
    v_cvt_pk_bf16_f32 v34, v34, v34
    v_and_b32 v34, 0xffff0000, v34
    v_mul_f32 v34, v22, v34
    v_cvt_pk_bf16_f32 v34, v34, v34
    v_and_b32 v34, 0xffff0000, v34
    v_add_f32 v34, v18, v34
    v_cvt_pk_bf16_f32 v34, v34, v34
    v_and_b32 v34, 0xffff0000, v34
    v_add_f32 v34, v14, v34
    v_cvt_pk_bf16_f32 v35, v35, v35
    v_and_b32 v35, 0xffff0000, v35
    v_mul_f32 v35, v22, v35
    v_cvt_pk_bf16_f32 v35, v35, v35
    v_and_b32 v35, 0xffff0000, v35
    v_add_f32 v35, v19, v35
    v_cvt_pk_bf16_f32 v35, v35, v35
    v_and_b32 v35, 0xffff0000, v35
    v_add_f32 v35, v15, v35
    v_cvt_pk_bf16_f32 v200, v32, v33
    v_cvt_pk_bf16_f32 v201, v34, v35
    v_mov_b32 v202, v6
    v_pk_add_f32 v[12:13], v[12:13], v[16:17]
    v_cvt_pk_bf16_f32 v204, v12, v13
    v_pk_add_f32 v[14:15], v[14:15], v[18:19]
    v_cvt_pk_bf16_f32 v205, v14, v15
    s_mov_b32 exec_lo, 0xff
    s_mov_b32 exec_hi, 0
    buffer_store_dwordx2 v[200:201], v202, s[16:19], 0 offen sc1
    s_mov_b64 exec, -1
L_ffn_same:
    s_add_u32 s75, s75, 1
    s_cmp_lt_u32 s75, 2
    s_cbranch_scc1 L_ffn_round
    s_cmp_ge_u32 s67, 8
    s_cbranch_scc1 L_exit
    s_waitcnt vmcnt(0)
L_exit:
    s_endpgm
L_code_end:
.section .rodata,"a"
.p2align 6
.amdhsa_kernel sequential_preLN__memory_aug_recurrent_mem_tr__moe_arch_mod__prompt_kernel
  .amdhsa_next_free_vgpr 512
  .amdhsa_next_free_sgpr 102
  .amdhsa_accum_offset 256
  .amdhsa_group_segment_fixed_size 0
  .amdhsa_kernarg_size 120
  .amdhsa_user_sgpr_count 2
  .amdhsa_user_sgpr_kernarg_segment_ptr 1
  .amdhsa_system_sgpr_workgroup_id_x 1
  .amdhsa_float_denorm_mode_32 3
.end_amdhsa_kernel
```

```asm
; @launch grid=(256,1,1) block=(256,1,1) lds=163840
.amdgcn_target "amdgcn-amd-amdhsa--gfx950"
.text
.globl sequential_preLN__memory_aug_recurrent_mem_tr__moe_arch_mod__prompt_kernel
.p2align 8
.type sequential_preLN__memory_aug_recurrent_mem_tr__moe_arch_mod__prompt_kernel,@function
sequential_preLN__memory_aug_recurrent_mem_tr__moe_arch_mod__prompt_kernel:
    s_cmp_ge_u32 s2, 256
    s_cbranch_scc1 L_exit
    s_load_dwordx2 s[8:9], s[0:1], 112
    s_load_dwordx2 s[92:93], s[0:1], 104
    s_load_dwordx8 s[60:67], s[0:1], 16
    s_load_dwordx2 s[12:13], s[0:1], 0
    v_lshrrev_b32 v1, 6, v0
    s_nop 0
    v_readfirstlane_b32 s100, v1
    s_getreg_b32 s84, hwreg(HW_REG_XCC_ID)
    s_and_b32 s84, s84, 7
    s_lshr_b32 s85, s2, 3
    s_mov_b32 s86, s100
    s_cmp_eq_u32 s2, 7
    s_cbranch_scc1 L_zero
L_noz:
    s_cmp_lg_u32 s84, 0
    s_cbranch_scc1 L_other
    s_xor_b32 s20, s85, 0
    v_lshrrev_b32 v4, 6, v0
    s_nop 0
    v_readfirstlane_b32 s21, v4
    v_and_b32 v1, 63, v0
    v_lshrrev_b32 v2, 4, v1
    v_and_b32 v3, 15, v1
    v_lshrrev_b32 v6, 2, v3
    v_lshlrev_b32 v117, 4, v1
    s_lshl_b32 s51, s21, 10
    s_lshl_b32 s52, s21, 11
    s_mov_b32 s14, 0x400000
    s_mov_b32 s15, 0x20000
    s_lshl_b32 s41, s20, 8
    s_lshl_b32 s42, s20, 17
    s_lshr_b32 s43, s21, 1
    s_lshl_b32 s43, s43, 2
    v_or_b32 v5, s43, v2
    v_lshlrev_b32 v5, 1, v5
    v_xor_b32 v5, v5, v3
    v_lshrrev_b32 v14, 2, v5
    v_and_b32 v14, 2, v14
    v_lshlrev_b32 v5, 4, v5
    s_lshl_b32 s43, s21, 4
    v_add_u32 v4, s43, v2
    v_lshl_add_u32 v8, v4, 13, v5
    s_cmp_lg_u32 s20, 27
    s_cbranch_scc1 L_nocc_1
    v_lshlrev_b32 v25, 3, v117
    s_lshl_b32 s43, s21, 13
    s_getpc_b64 s[4:5]
L_pc_2:
    s_add_u32 s4, s4, L_nocc_1-L_pc_2
    s_addc_u32 s5, s5, 0
    v_add_u32 v25, s43, v25
    v_min_u32 v25, L_code_end-L_nocc_1-4, v25
    global_load_dword v29, v25, s[4:5]
L_nocc_1:
    v_mul_u32_u24 v22, 57, v0
    v_lshrrev_b32 v22, 11, v22
    v_mul_u32_u24 v23, 36, v22
    v_sub_u32 v23, v0, v23
    v_and_b32 v25, 3, v23
    v_and_or_b32 v23, v23, 60, 1
    v_min_u32 v23, 31, v23
    v_lshl_add_u32 v23, v23, 2, v25
    v_lshlrev_b32 v31, 6, v23
    s_add_u32 s43, s20, 2
    s_lshr_b32 s43, s43, 2
    s_sub_u32 s43, s20, s43
    s_mul_i32 s43, s43, 7
    v_add_u32 v22, s43, v22
    s_waitcnt lgkmcnt(0)
    s_mov_b32 s4, s60
    s_and_b32 s5, s61, 0xffff
    s_lshr_b32 s6, 0x5ddddddd, s20
    s_and_b32 s6, s6, 1
    s_lshl_b32 s6, s6, 22
    s_mov_b32 s7, 0x20000
    v_add_u32 v23, 0, v22
    v_and_b32 v25, 448, v23
    v_add_u32 v23, v23, v25
    v_lshl_add_u32 v23, v23, 13, v31
    s_mov_b32 s43, 0x80000
    buffer_load_dword v30, v23, s[4:7], s43 offen
    s_mov_b32 s4, s60
    s_and_b32 s5, s61, 0xffff
    s_lshr_b32 s6, 0x5ddddddd, s20
    s_and_b32 s6, s6, 1
    s_lshl_b32 s6, s6, 22
    s_mov_b32 s7, 0x20000
    v_add_u32 v23, 161, v22
    v_and_b32 v25, 448, v23
    v_add_u32 v23, v23, v25
    v_lshl_add_u32 v23, v23, 13, v31
    s_mov_b32 s43, 0x80000
    buffer_load_dword v30, v23, s[4:7], s43 offen
    s_and_b32 s9, s9, 0xffff
    s_mov_b32 s10, 0x10000000
    s_mov_b32 s11, 0x20000
    s_and_b32 s93, s93, 0xffff
    s_mov_b32 s94, 0x100
    s_mov_b32 s95, 0x20000
    s_mov_b32 s87, 0
    s_cmp_lg_u32 s86, 0
    s_cbranch_scc1 L_reg_3
    s_lshl_b32 s97, s84, 4
    s_lshl_b32 s96, 1, s85
    v_mov_b32 v250, s96
    v_mov_b32 v251, 256
    s_mov_b64 exec, 1
    buffer_atomic_add_x2 v[250:251], off, s[92:95], s97 offset:64
    s_mov_b64 exec, -1
    s_mov_b32 s86, 1
L_reg_3:
    s_mov_b32 s16, s92
    s_mov_b32 s17, s93
    s_mov_b32 s18, s94
    s_mov_b32 s19, s95
    s_mov_b32 s88, s20
    s_mov_b32 s12, s60
    s_and_b32 s13, s61, 0xffff
    v_xor_b32 v15, 0, v14
    v_lshl_add_u32 v15, v15, 15, v8
    s_add_u32 s43, s41, 0x0
    s_add_u32 m0, s51, 0x8000
    s_nop 0
    buffer_load_dwordx4 v15, s[12:15], s43 offen nt lds
    s_add_u32 s43, s41, 0x8000
    s_add_u32 m0, s51, 0x9000
    s_nop 0
    buffer_load_dwordx4 v15, s[12:15], s43 offen nt lds
    s_add_u32 s43, s41, 0x100000
    s_add_u32 m0, s51, 0xa000
    s_nop 0
    buffer_load_dwordx4 v15, s[12:15], s43 offen nt lds
    s_add_u32 s43, s41, 0x108000
    s_add_u32 m0, s51, 0xb000
    s_nop 0
    buffer_load_dwordx4 v15, s[12:15], s43 offen nt lds
    s_add_u32 s43, s41, 0x200000
    s_add_u32 m0, s51, 0xc000
    s_nop 0
    buffer_load_dwordx4 v15, s[12:15], s43 offen nt lds
    s_add_u32 s43, s41, 0x208000
    s_add_u32 m0, s51, 0xd000
    s_nop 0
    buffer_load_dwordx4 v15, s[12:15], s43 offen nt lds
    s_add_u32 s43, s41, 0x300000
    s_add_u32 m0, s51, 0xe000
    s_nop 0
    buffer_load_dwordx4 v15, s[12:15], s43 offen nt lds
    s_add_u32 s43, s41, 0x308000
    s_add_u32 m0, s51, 0xf000
    s_nop 0
    buffer_load_dwordx4 v15, s[12:15], s43 offen nt lds
    v_xor_b32 v15, 2, v14
    v_lshl_add_u32 v15, v15, 15, v8
    s_add_u32 s43, s41, 0x0
    s_add_u32 m0, s51, 0x10000
    s_nop 0
    buffer_load_dwordx4 v15, s[12:15], s43 offen nt lds
    s_add_u32 s43, s41, 0x8000
    s_add_u32 m0, s51, 0x11000
    s_nop 0
    buffer_load_dwordx4 v15, s[12:15], s43 offen nt lds
    s_add_u32 s43, s41, 0x100000
    s_add_u32 m0, s51, 0x12000
    s_nop 0
    buffer_load_dwordx4 v15, s[12:15], s43 offen nt lds
    s_add_u32 s43, s41, 0x108000
    s_add_u32 m0, s51, 0x13000
    s_nop 0
    buffer_load_dwordx4 v15, s[12:15], s43 offen nt lds
    s_add_u32 s43, s41, 0x200000
    s_add_u32 m0, s51, 0x14000
    s_nop 0
    buffer_load_dwordx4 v15, s[12:15], s43 offen nt lds
    s_add_u32 s43, s41, 0x208000
    s_add_u32 m0, s51, 0x15000
    s_nop 0
    buffer_load_dwordx4 v15, s[12:15], s43 offen nt lds
    s_add_u32 s43, s41, 0x300000
    s_add_u32 m0, s51, 0x16000
    s_nop 0
    buffer_load_dwordx4 v15, s[12:15], s43 offen nt lds
    s_add_u32 s43, s41, 0x308000
    s_add_u32 m0, s51, 0x17000
    s_nop 0
    buffer_load_dwordx4 v15, s[12:15], s43 offen nt lds
    v_xor_b32 v15, 0, v14
    v_lshl_add_u32 v15, v15, 15, v8
    s_add_u32 s43, s41, 0x80000
    s_add_u32 m0, s51, 0x18000
    s_nop 0
    buffer_load_dwordx4 v15, s[12:15], s43 offen nt lds
    s_add_u32 s43, s41, 0x88000
    s_add_u32 m0, s51, 0x19000
    s_nop 0
    buffer_load_dwordx4 v15, s[12:15], s43 offen nt lds
    s_add_u32 s43, s41, 0x180000
    s_add_u32 m0, s51, 0x1a000
    s_nop 0
    buffer_load_dwordx4 v15, s[12:15], s43 offen nt lds
    s_add_u32 s43, s41, 0x188000
    s_add_u32 m0, s51, 0x1b000
    s_nop 0
    buffer_load_dwordx4 v15, s[12:15], s43 offen nt lds
    v_and_b32 v4, 2, v3
    v_cmp_ne_u32 vcc, 0, v4
    v_mov_b32 v4, 0x4444
    v_mov_b32 v5, 0xeeee
    v_cndmask_b32 v116, v4, v5, vcc
    v_lshrrev_b32 v5, 1, v2
    v_lshl_add_u32 v4, v6, 3, v5
    s_lshl_b32 s43, s21, 1
    v_add_u32 v4, s43, v4
    v_add_u32 v5, s20, v4
    v_and_b32 v5, 31, v5
    v_lshl_add_u32 v4, v4, 6, v5
    v_and_b32 v5, 1, v2
    v_lshl_add_u32 v4, v4, 1, v5
    v_and_b32 v5, 3, v3
    v_lshl_add_u32 v4, v4, 2, v5
    v_lshlrev_b32 v118, 4, v4
    v_and_b32 v4, 1, v2
    v_lshlrev_b32 v4, 2, v4
    v_and_b32 v7, 2, v2
    v_add_u32 v4, v4, v7
    v_and_b32 v7, 1, v6
    v_add_u32 v4, v4, v7
    v_lshl_add_u32 v4, v4, 2, v5
    v_lshlrev_b32 v4, 2, v4
    s_and_b32 s43, s21, 1
    s_lshl_b32 s43, s43, 12
    s_lshl_b32 s40, s20, 7
    s_add_u32 s43, s43, s40
    v_add_u32 v119, s43, v4
    v_sub_u32 v7, 0, v2
    v_and_b32 v7, 3, v7
    v_xor_b32 v7, v7, v6
    v_lshl_add_u32 v4, v2, 4, v7
    v_and_b32 v5, 3, v3
    v_lshl_add_u32 v4, v4, 2, v5
    s_add_u32 s43, s51, 16384
    v_lshl_add_u32 v120, v4, 2, s43
    v_sub_u32 v7, 0, v6
    v_and_b32 v7, 3, v7
    v_xor_b32 v7, v7, v2
    v_lshl_add_u32 v4, v3, 2, v7
    v_lshlrev_b32 v121, 4, v4
    v_and_b32 v5, 1, v3
    v_lshl_add_u32 v4, v6, 1, v5
    v_lshl_add_u32 v4, v2, 3, v4
    v_lshlrev_b32 v127, 4, v4
    v_and_or_b32 v122, v116, 8, v127
    s_lshl_b32 s43, s21, 13
    s_add_u32 s43, s43, 32768
    v_add_u32 v123, s43, v117
    v_add_u32 v124, 0x10000, v123
    s_mov_b32 s36, 0xcccccccc
    s_mov_b32 s37, 0xcccccccc
    s_mov_b32 s38, 0x00ff00ff
    s_mov_b32 s39, 0x00ff00ff
    s_mov_b32 s34, 0x3e0293ee
    s_mov_b32 s35, 0x49800000
    s_mov_b32 s50, 0x3f803f80
    v_and_b32 v5, 1, v2
    v_or_b32 v5, 0, v5
    v_xor_b32 v5, v5, v6
    v_and_b32 v7, 2, v5
    v_add_u32 v5, v5, v7
    v_lshlrev_b32 v5, 6, v5
    v_and_b32 v7, 3, v3
    v_lshl_add_u32 v7, v7, 4, v5
    s_lshl_b32 s43, s21, 2
    v_add_u32 v4, s43, v2
    v_lshl_add_u32 v10, v4, 10, v7
    v_and_b32 v5, 1, v2
    v_or_b32 v5, 2, v5
    v_xor_b32 v5, v5, v6
    v_and_b32 v7, 2, v5
    v_add_u32 v5, v5, v7
    v_lshlrev_b32 v5, 6, v5
    v_and_b32 v7, 3, v3
    v_lshl_add_u32 v7, v7, 4, v5
    s_lshl_b32 s43, s21, 2
    v_add_u32 v4, s43, v2
    v_lshl_add_u32 v9, v4, 10, v7
    v_and_b32 v5, 1, v2
    v_lshl_add_u32 v4, v5, 3, v6
    v_lshrrev_b32 v7, 1, v2
    v_lshl_add_u32 v4, v7, 5, v4
    v_lshlrev_b32 v4, 8, v4
    v_lshl_or_b32 v5, v5, 2, v6
    v_lshlrev_b32 v5, 5, v5
    s_lshl_b32 s43, s21, 6
    v_xor_b32 v5, s43, v5
    v_add_u32 v4, v4, v5
    v_and_b32 v5, 3, v3
    v_lshl_add_u32 v4, v5, 3, v4
    v_add_u32 v11, 32768, v4
    s_and_b32 s43, s21, 1
    s_lshl_b32 s43, s43, 12
    v_add_u32 v11, s43, v11
    v_and_b32 v5, 1, v2
    v_lshlrev_b32 v4, 4, v5
    v_lshl_add_u32 v4, v7, 2, v4
    v_and_b32 v7, 1, v6
    v_add_u32 v4, v4, v7
    s_lshl_b32 s43, s21, 5
    v_add_u32 v4, s43, v4
    v_lshlrev_b32 v4, 8, v4
    v_lshl_or_b32 v5, v5, 1, v7
    s_lshl_b32 s43, s21, 1
    s_and_b32 s43, s43, 3
    v_xor_b32 v5, s43, v5
    v_lshl_add_u32 v4, v5, 6, v4
    v_lshrrev_b32 v5, 1, v6
    v_lshl_add_u32 v4, v5, 5, v4
    v_and_b32 v5, 3, v3
    v_lshl_add_u32 v4, v5, 3, v4
    v_add_u32 v12, 32768, v4
    v_mul_u32_u24 v4, 0x0, v2
    v_lshl_add_u32 v4, v3, 7, v4
    s_lshl_b32 s43, s20, 13
    s_add_u32 s43, s43, s52
    s_add_u32 s43, s43, 0xf0000
    v_add_u32 v4, s43, v4
    v_and_b32 v5, 3, v3
    v_lshl_add_u32 v5, v5, 13, v119
    v_cmp_gt_u32 vcc, 2, v2
    s_nop 1
    v_cndmask_b32 v7, v5, v4, vcc
    v_mov_b32 v16, -1
    v_mov_b32 v17, -1
    v_mov_b32 v18, -1
    v_mov_b32 v19, -1
    s_lshl_b32 s43, s20, 13
    s_add_u32 s43, s43, 0x100000
    s_and_b32 s40, s21, 1
    s_lshl_b32 s40, s40, 12
    s_add_u32 s29, s43, s40
    s_add_u32 s43, s43, s52
    s_xor_b32 s40, s43, 0x0
    buffer_store_dwordx4 v[16:19], v117, s[8:11], s43 offen
    buffer_store_dwordx4 v[16:19], v117, s[8:11], s43 offen offset:1024
    s_mov_b32 s43, 0x12000
    buffer_store_dword v16, v119, s[8:11], s43 offen
    s_mov_b32 s43, 0x14000
    buffer_store_dword v16, v119, s[8:11], s43 offen
    s_mov_b32 s43, 0x16000
    buffer_store_dword v16, v119, s[8:11], s43 offen
    s_load_dwordx2 s[4:5], s[0:1], 8
    s_waitcnt lgkmcnt(0)
    s_and_b32 s5, s5, 0xffff
    s_mov_b32 s6, 8192
    s_mov_b32 s7, 0x20000
    v_and_b32 v20, 1, v2
    v_and_b32 v21, 1, v6
    v_lshl_add_u32 v20, v20, 1, v21
    v_lshlrev_b32 v20, 9, v20
    v_and_b32 v21, 3, v3
    v_lshl_add_u32 v20, v21, 4, v20
    v_and_b32 v21, 2, v2
    v_add_u32 v20, v20, v21
    s_and_b32 s43, s20, 1
    s_lshl_b32 s43, s43, 11
    s_bfe_u32 s40, s20, 0x20001
    s_lshl_b32 s40, s40, 7
    s_add_u32 s43, s43, s40
    s_and_b32 s40, s21, 1
    s_lshl_b32 s40, s40, 6
    s_add_u32 s43, s43, s40
    s_lshr_b32 s40, s20, 3
    s_lshl_b32 s40, s40, 2
    s_add_u32 s43, s43, s40
    v_add_u32 v20, s43, v20
    v_lshlrev_b32 v20, 1, v20
    buffer_load_dword v21, v20, s[4:7], 0 offen
    s_mov_b32 s57, 0
    s_lshl_b32 s43, s20, 13
    s_add_u32 s43, s43, s52
    s_add_u32 s30, s43, 0x1000000
    s_add_u32 s31, s43, 0x2000000
    s_lshr_b32 s43, s43, 1
    s_add_u32 s32, s43, 0x220000
    s_waitcnt vmcnt(18)
    s_barrier
    v_xor_b32 v13, 0x0, v11
    v_add_u32 v13, 0x0, v13
    ds_read_b64_tr_b16 v[80:81], v13
    ds_read_b64_tr_b16 v[82:83], v13 offset:1024
    ds_read_b64_tr_b16 v[84:85], v13 offset:16384
    ds_read_b64_tr_b16 v[86:87], v13 offset:17408
    v_xor_b32 v13, 0x20, v11
    v_add_u32 v13, 0x0, v13
    ds_read_b64_tr_b16 v[56:57], v13
    ds_read_b64_tr_b16 v[58:59], v13 offset:1024
    ds_read_b64_tr_b16 v[60:61], v13 offset:16384
    ds_read_b64_tr_b16 v[62:63], v13 offset:17408
    v_xor_b32 v13, 0x1000, v11
    v_add_u32 v13, 0x0, v13
    ds_read_b64_tr_b16 a[0:1], v13
    ds_read_b64_tr_b16 a[2:3], v13 offset:1024
    ds_read_b64_tr_b16 a[4:5], v13 offset:16384
    ds_read_b64_tr_b16 a[6:7], v13 offset:17408
    v_xor_b32 v13, 0x1020, v11
    v_add_u32 v13, 0x0, v13
    ds_read_b64_tr_b16 a[8:9], v13
    ds_read_b64_tr_b16 a[10:11], v13 offset:1024
    ds_read_b64_tr_b16 a[12:13], v13 offset:16384
    ds_read_b64_tr_b16 a[14:15], v13 offset:17408
    s_waitcnt lgkmcnt(0)
    s_barrier
    s_mov_b32 s4, s62
    s_and_b32 s5, s63, 0xffff
    s_lshr_b32 s6, 0x5ddddddd, s20
    s_and_b32 s6, s6, 1
    s_lshl_b32 s6, s6, 22
    s_mov_b32 s7, 0x20000
    v_add_u32 v23, 0, v22
    v_and_b32 v25, 448, v23
    v_add_u32 v23, v23, v25
    v_lshl_add_u32 v23, v23, 13, v31
    s_mov_b32 s43, 0x0
    buffer_load_dword v30, v23, s[4:7], s43 offen
    s_add_u32 s43, s41, 0x280000
    s_add_u32 m0, s51, 0x1c000
    s_nop 0
    buffer_load_dwordx4 v15, s[12:15], s43 offen nt lds
    s_add_u32 s43, s41, 0x288000
    s_add_u32 m0, s51, 0x1d000
    s_nop 0
    buffer_load_dwordx4 v15, s[12:15], s43 offen nt lds
    s_add_u32 s43, s41, 0x380000
    s_add_u32 m0, s51, 0x1e000
    s_nop 0
    buffer_load_dwordx4 v15, s[12:15], s43 offen nt lds
    s_add_u32 s43, s41, 0x388000
    s_add_u32 m0, s51, 0x1f000
    s_nop 0
    buffer_load_dwordx4 v15, s[12:15], s43 offen nt lds
    v_xor_b32 v15, 2, v14
    v_lshl_add_u32 v15, v15, 15, v8
    s_add_u32 s43, s41, 0x80000
    s_add_u32 m0, s51, 0x20000
    s_nop 0
    buffer_load_dwordx4 v15, s[12:15], s43 offen nt lds
    s_add_u32 s43, s41, 0x88000
    s_add_u32 m0, s51, 0x21000
    s_nop 0
    buffer_load_dwordx4 v15, s[12:15], s43 offen nt lds
    s_add_u32 s43, s41, 0x180000
    s_add_u32 m0, s51, 0x22000
    s_nop 0
    buffer_load_dwordx4 v15, s[12:15], s43 offen nt lds
    s_add_u32 s43, s41, 0x188000
    s_add_u32 m0, s51, 0x23000
    s_nop 0
    buffer_load_dwordx4 v15, s[12:15], s43 offen nt lds
    s_waitcnt vmcnt(19)
    s_barrier
    v_xor_b32 v13, 0x0, v11
    v_add_u32 v13, 0x8000, v13
    ds_read_b64_tr_b16 a[32:33], v13
    ds_read_b64_tr_b16 a[34:35], v13 offset:1024
    ds_read_b64_tr_b16 a[36:37], v13 offset:16384
    ds_read_b64_tr_b16 a[38:39], v13 offset:17408
    v_xor_b32 v13, 0x20, v11
    v_add_u32 v13, 0x8000, v13
    ds_read_b64_tr_b16 a[40:41], v13
    ds_read_b64_tr_b16 a[42:43], v13 offset:1024
    ds_read_b64_tr_b16 a[44:45], v13 offset:16384
    ds_read_b64_tr_b16 a[46:47], v13 offset:17408
    v_xor_b32 v13, 0x1000, v11
    v_add_u32 v13, 0x8000, v13
    ds_read_b64_tr_b16 a[64:65], v13
    ds_read_b64_tr_b16 a[66:67], v13 offset:1024
    ds_read_b64_tr_b16 a[68:69], v13 offset:16384
    ds_read_b64_tr_b16 a[70:71], v13 offset:17408
    v_xor_b32 v13, 0x1020, v11
    v_add_u32 v13, 0x8000, v13
    ds_read_b64_tr_b16 a[72:73], v13
    ds_read_b64_tr_b16 a[74:75], v13 offset:1024
    ds_read_b64_tr_b16 a[76:77], v13 offset:16384
    ds_read_b64_tr_b16 a[78:79], v13 offset:17408
    s_waitcnt lgkmcnt(0)
    s_barrier
    s_add_u32 s43, s41, 0x280000
    s_add_u32 m0, s51, 0x24000
    s_nop 0
    buffer_load_dwordx4 v15, s[12:15], s43 offen nt lds
    s_add_u32 s43, s41, 0x288000
    s_add_u32 m0, s51, 0x25000
    s_nop 0
    buffer_load_dwordx4 v15, s[12:15], s43 offen nt lds
    s_add_u32 s43, s41, 0x380000
    s_add_u32 m0, s51, 0x26000
    s_nop 0
    buffer_load_dwordx4 v15, s[12:15], s43 offen nt lds
    s_add_u32 s43, s41, 0x388000
    s_add_u32 m0, s51, 0x27000
    s_nop 0
    buffer_load_dwordx4 v15, s[12:15], s43 offen nt lds
    s_mov_b32 s12, s62
    s_and_b32 s13, s63, 0xffff
    v_xor_b32 v15, 0, v14
    v_lshl_add_u32 v15, v15, 15, v8
    s_add_u32 s43, s41, 0x0
    s_add_u32 m0, s51, 0x8000
    s_nop 0
    buffer_load_dwordx4 v15, s[12:15], s43 offen nt lds
    s_add_u32 s43, s41, 0x8000
    s_add_u32 m0, s51, 0x9000
    s_nop 0
    buffer_load_dwordx4 v15, s[12:15], s43 offen nt lds
    s_add_u32 s43, s41, 0x100000
    s_add_u32 m0, s51, 0xa000
    s_nop 0
    buffer_load_dwordx4 v15, s[12:15], s43 offen nt lds
    s_add_u32 s43, s41, 0x108000
    s_add_u32 m0, s51, 0xb000
    s_nop 0
    buffer_load_dwordx4 v15, s[12:15], s43 offen nt lds
    s_waitcnt vmcnt(12)
    s_barrier
    v_xor_b32 v13, 0x0, v11
    v_add_u32 v13, 0x10000, v13
    ds_read_b64_tr_b16 v[88:89], v13
    ds_read_b64_tr_b16 v[90:91], v13 offset:1024
    ds_read_b64_tr_b16 v[92:93], v13 offset:16384
    ds_read_b64_tr_b16 v[94:95], v13 offset:17408
    v_xor_b32 v13, 0x20, v11
    v_add_u32 v13, 0x10000, v13
    ds_read_b64_tr_b16 v[96:97], v13
    ds_read_b64_tr_b16 v[98:99], v13 offset:1024
    ds_read_b64_tr_b16 v[100:101], v13 offset:16384
    ds_read_b64_tr_b16 v[102:103], v13 offset:17408
    v_xor_b32 v13, 0x1000, v11
    v_add_u32 v13, 0x10000, v13
    ds_read_b64_tr_b16 a[16:17], v13
    ds_read_b64_tr_b16 a[18:19], v13 offset:1024
    ds_read_b64_tr_b16 a[20:21], v13 offset:16384
    ds_read_b64_tr_b16 a[22:23], v13 offset:17408
    v_xor_b32 v13, 0x1020, v11
    v_add_u32 v13, 0x10000, v13
    ds_read_b64_tr_b16 a[24:25], v13
    ds_read_b64_tr_b16 a[26:27], v13 offset:1024
    ds_read_b64_tr_b16 a[28:29], v13 offset:16384
    ds_read_b64_tr_b16 a[30:31], v13 offset:17408
    s_waitcnt lgkmcnt(0)
    s_barrier
    s_add_u32 s43, s41, 0x200000
    s_add_u32 m0, s51, 0xc000
    s_nop 0
    buffer_load_dwordx4 v15, s[12:15], s43 offen nt lds
    s_add_u32 s43, s41, 0x208000
    s_add_u32 m0, s51, 0xd000
    s_nop 0
    buffer_load_dwordx4 v15, s[12:15], s43 offen nt lds
    s_add_u32 s43, s41, 0x300000
    s_add_u32 m0, s51, 0xe000
    s_nop 0
    buffer_load_dwordx4 v15, s[12:15], s43 offen nt lds
    s_add_u32 s43, s41, 0x308000
    s_add_u32 m0, s51, 0xf000
    s_nop 0
    buffer_load_dwordx4 v15, s[12:15], s43 offen nt lds
    v_xor_b32 v15, 2, v14
    v_lshl_add_u32 v15, v15, 15, v8
    s_add_u32 s43, s41, 0x0
    s_add_u32 m0, s51, 0x10000
    s_nop 0
    buffer_load_dwordx4 v15, s[12:15], s43 offen nt lds
    s_add_u32 s43, s41, 0x8000
    s_add_u32 m0, s51, 0x11000
    s_nop 0
    buffer_load_dwordx4 v15, s[12:15], s43 offen nt lds
    s_add_u32 s43, s41, 0x100000
    s_add_u32 m0, s51, 0x12000
    s_nop 0
    buffer_load_dwordx4 v15, s[12:15], s43 offen nt lds
    s_add_u32 s43, s41, 0x108000
    s_add_u32 m0, s51, 0x13000
    s_nop 0
    buffer_load_dwordx4 v15, s[12:15], s43 offen nt lds
    s_waitcnt vmcnt(12)
    s_barrier
    v_xor_b32 v13, 0x0, v11
    v_add_u32 v13, 0x18000, v13
    ds_read_b64_tr_b16 a[48:49], v13
    ds_read_b64_tr_b16 a[50:51], v13 offset:1024
    ds_read_b64_tr_b16 a[52:53], v13 offset:16384
    ds_read_b64_tr_b16 a[54:55], v13 offset:17408
    v_xor_b32 v13, 0x20, v11
    v_add_u32 v13, 0x18000, v13
    ds_read_b64_tr_b16 a[56:57], v13
    ds_read_b64_tr_b16 a[58:59], v13 offset:1024
    ds_read_b64_tr_b16 a[60:61], v13 offset:16384
    ds_read_b64_tr_b16 a[62:63], v13 offset:17408
    v_xor_b32 v13, 0x1000, v11
    v_add_u32 v13, 0x18000, v13
    ds_read_b64_tr_b16 a[80:81], v13
    ds_read_b64_tr_b16 a[82:83], v13 offset:1024
    ds_read_b64_tr_b16 a[84:85], v13 offset:16384
    ds_read_b64_tr_b16 a[86:87], v13 offset:17408
    v_xor_b32 v13, 0x1020, v11
    v_add_u32 v13, 0x18000, v13
    ds_read_b64_tr_b16 a[88:89], v13
    ds_read_b64_tr_b16 a[90:91], v13 offset:1024
    ds_read_b64_tr_b16 a[92:93], v13 offset:16384
    ds_read_b64_tr_b16 a[94:95], v13 offset:17408
    s_waitcnt lgkmcnt(0)
    s_barrier
    s_add_u32 s43, s41, 0x200000
    s_add_u32 m0, s51, 0x14000
    s_nop 0
    buffer_load_dwordx4 v15, s[12:15], s43 offen nt lds
    s_add_u32 s43, s41, 0x208000
    s_add_u32 m0, s51, 0x15000
    s_nop 0
    buffer_load_dwordx4 v15, s[12:15], s43 offen nt lds
    s_add_u32 s43, s41, 0x300000
    s_add_u32 m0, s51, 0x16000
    s_nop 0
    buffer_load_dwordx4 v15, s[12:15], s43 offen nt lds
    s_add_u32 s43, s41, 0x308000
    s_add_u32 m0, s51, 0x17000
    s_nop 0
    buffer_load_dwordx4 v15, s[12:15], s43 offen nt lds
    v_xor_b32 v15, 0, v14
    v_lshl_add_u32 v15, v15, 15, v8
    s_add_u32 s43, s41, 0x80000
    s_add_u32 m0, s51, 0x18000
    s_nop 0
    buffer_load_dwordx4 v15, s[12:15], s43 offen nt lds
    s_add_u32 s43, s41, 0x88000
    s_add_u32 m0, s51, 0x19000
    s_nop 0
    buffer_load_dwordx4 v15, s[12:15], s43 offen nt lds
    s_add_u32 s43, s41, 0x180000
    s_add_u32 m0, s51, 0x1a000
    s_nop 0
    buffer_load_dwordx4 v15, s[12:15], s43 offen nt lds
    s_add_u32 s43, s41, 0x188000
    s_add_u32 m0, s51, 0x1b000
    s_nop 0
    buffer_load_dwordx4 v15, s[12:15], s43 offen nt lds
    s_waitcnt vmcnt(12)
    v_min_u32 v21, 0xfffffffe, v21
    s_mov_b32 s43, 0x10000
    s_mov_b64 exec, s[38:39]
    buffer_store_dword v21, v119, s[8:11], s43 offen
    s_mov_b64 exec, -1
    s_barrier
    v_xor_b32 v13, 0x0, v11
    v_add_u32 v13, 0x0, v13
    ds_read_b64_tr_b16 v[64:65], v13
    ds_read_b64_tr_b16 v[66:67], v13 offset:1024
    ds_read_b64_tr_b16 v[68:69], v13 offset:16384
    ds_read_b64_tr_b16 v[70:71], v13 offset:17408
    v_xor_b32 v13, 0x20, v11
    v_add_u32 v13, 0x0, v13
    ds_read_b64_tr_b16 v[72:73], v13
    ds_read_b64_tr_b16 v[74:75], v13 offset:1024
    ds_read_b64_tr_b16 v[76:77], v13 offset:16384
    ds_read_b64_tr_b16 v[78:79], v13 offset:17408
    v_xor_b32 v13, 0x1000, v11
    v_add_u32 v13, 0x0, v13
    ds_read_b64_tr_b16 a[96:97], v13
    ds_read_b64_tr_b16 a[98:99], v13 offset:1024
    ds_read_b64_tr_b16 a[100:101], v13 offset:16384
    ds_read_b64_tr_b16 a[102:103], v13 offset:17408
    v_xor_b32 v13, 0x1020, v11
    v_add_u32 v13, 0x0, v13
    ds_read_b64_tr_b16 a[104:105], v13
    ds_read_b64_tr_b16 a[106:107], v13 offset:1024
    ds_read_b64_tr_b16 a[108:109], v13 offset:16384
    ds_read_b64_tr_b16 a[110:111], v13 offset:17408
    s_waitcnt lgkmcnt(0)
    s_barrier
    s_add_u32 s43, s41, 0x280000
    s_add_u32 m0, s51, 0x1c000
    s_nop 0
    buffer_load_dwordx4 v15, s[12:15], s43 offen nt lds
    s_add_u32 s43, s41, 0x288000
    s_add_u32 m0, s51, 0x1d000
    s_nop 0
    buffer_load_dwordx4 v15, s[12:15], s43 offen nt lds
    s_add_u32 s43, s41, 0x380000
    s_add_u32 m0, s51, 0x1e000
    s_nop 0
    buffer_load_dwordx4 v15, s[12:15], s43 offen nt lds
    s_add_u32 s43, s41, 0x388000
    s_add_u32 m0, s51, 0x1f000
    s_nop 0
    buffer_load_dwordx4 v15, s[12:15], s43 offen nt lds
    v_xor_b32 v15, 2, v14
    v_lshl_add_u32 v15, v15, 15, v8
    s_add_u32 s43, s41, 0x80000
    s_add_u32 m0, s51, 0x20000
    s_nop 0
    buffer_load_dwordx4 v15, s[12:15], s43 offen nt lds
    s_add_u32 s43, s41, 0x88000
    s_add_u32 m0, s51, 0x21000
    s_nop 0
    buffer_load_dwordx4 v15, s[12:15], s43 offen nt lds
    s_add_u32 s43, s41, 0x180000
    s_add_u32 m0, s51, 0x22000
    s_nop 0
    buffer_load_dwordx4 v15, s[12:15], s43 offen nt lds
    s_add_u32 s43, s41, 0x188000
    s_add_u32 m0, s51, 0x23000
    s_nop 0
    buffer_load_dwordx4 v15, s[12:15], s43 offen nt lds
    s_waitcnt vmcnt(12)
    s_barrier
    v_xor_b32 v13, 0x0, v11
    v_add_u32 v13, 0x8000, v13
    ds_read_b64_tr_b16 a[128:129], v13
    ds_read_b64_tr_b16 a[130:131], v13 offset:1024
    ds_read_b64_tr_b16 a[132:133], v13 offset:16384
    ds_read_b64_tr_b16 a[134:135], v13 offset:17408
    v_xor_b32 v13, 0x20, v11
    v_add_u32 v13, 0x8000, v13
    ds_read_b64_tr_b16 a[136:137], v13
    ds_read_b64_tr_b16 a[138:139], v13 offset:1024
    ds_read_b64_tr_b16 a[140:141], v13 offset:16384
    ds_read_b64_tr_b16 a[142:143], v13 offset:17408
    v_xor_b32 v13, 0x1000, v11
    v_add_u32 v13, 0x8000, v13
    ds_read_b64_tr_b16 a[160:161], v13
    ds_read_b64_tr_b16 a[162:163], v13 offset:1024
    ds_read_b64_tr_b16 a[164:165], v13 offset:16384
    ds_read_b64_tr_b16 a[166:167], v13 offset:17408
    v_xor_b32 v13, 0x1020, v11
    v_add_u32 v13, 0x8000, v13
    ds_read_b64_tr_b16 a[168:169], v13
    ds_read_b64_tr_b16 a[170:171], v13 offset:1024
    ds_read_b64_tr_b16 a[172:173], v13 offset:16384
    ds_read_b64_tr_b16 a[174:175], v13 offset:17408
    s_waitcnt lgkmcnt(0)
    s_barrier
    buffer_load_dwordx2 v[26:27], off, s[16:19], 0 offset:36 sc1
    s_add_u32 s43, s41, 0x280000
    s_add_u32 m0, s51, 0x24000
    s_nop 0
    buffer_load_dwordx4 v15, s[12:15], s43 offen nt lds
    s_add_u32 s43, s41, 0x288000
    s_add_u32 m0, s51, 0x25000
    s_nop 0
    buffer_load_dwordx4 v15, s[12:15], s43 offen nt lds
    s_add_u32 s43, s41, 0x380000
    s_add_u32 m0, s51, 0x26000
    s_nop 0
    buffer_load_dwordx4 v15, s[12:15], s43 offen nt lds
    s_add_u32 s43, s41, 0x388000
    s_add_u32 m0, s51, 0x27000
    s_nop 0
    buffer_load_dwordx4 v15, s[12:15], s43 offen nt lds
    s_mov_b32 s12, s64
    s_and_b32 s13, s65, 0xffff
    v_xor_b32 v15, 0, v14
    v_lshl_add_u32 v15, v15, 15, v8
    s_add_u32 s43, s41, 0x0
    s_add_u32 m0, s51, 0x8000
    s_nop 0
    buffer_load_dwordx4 v15, s[12:15], s43 offen lds
    s_add_u32 s43, s41, 0x8000
    s_add_u32 m0, s51, 0x9000
    s_nop 0
    buffer_load_dwordx4 v15, s[12:15], s43 offen lds
    s_add_u32 s43, s41, 0x100000
    s_add_u32 m0, s51, 0xa000
    s_nop 0
    buffer_load_dwordx4 v15, s[12:15], s43 offen lds
    s_add_u32 s43, s41, 0x108000
    s_add_u32 m0, s51, 0xb000
    s_nop 0
    buffer_load_dwordx4 v15, s[12:15], s43 offen lds
    s_waitcnt vmcnt(13)
    s_barrier
    v_xor_b32 v13, 0x0, v11
    v_add_u32 v13, 0x10000, v13
    ds_read_b64_tr_b16 v[104:105], v13
    ds_read_b64_tr_b16 v[106:107], v13 offset:1024
    ds_read_b64_tr_b16 v[108:109], v13 offset:16384
    ds_read_b64_tr_b16 v[110:111], v13 offset:17408
    v_xor_b32 v13, 0x20, v11
    v_add_u32 v13, 0x10000, v13
    ds_read_b64_tr_b16 v[32:33], v13
    ds_read_b64_tr_b16 v[34:35], v13 offset:1024
    ds_read_b64_tr_b16 v[36:37], v13 offset:16384
    ds_read_b64_tr_b16 v[38:39], v13 offset:17408
    v_xor_b32 v13, 0x1000, v11
    v_add_u32 v13, 0x10000, v13
    ds_read_b64_tr_b16 a[112:113], v13
    ds_read_b64_tr_b16 a[114:115], v13 offset:1024
    ds_read_b64_tr_b16 a[116:117], v13 offset:16384
    ds_read_b64_tr_b16 a[118:119], v13 offset:17408
    v_xor_b32 v13, 0x1020, v11
    v_add_u32 v13, 0x10000, v13
    ds_read_b64_tr_b16 a[120:121], v13
    ds_read_b64_tr_b16 a[122:123], v13 offset:1024
    ds_read_b64_tr_b16 a[124:125], v13 offset:16384
    ds_read_b64_tr_b16 a[126:127], v13 offset:17408
    s_waitcnt lgkmcnt(0)
    s_barrier
    s_add_u32 s43, s41, 0x200000
    s_add_u32 m0, s51, 0xc000
    s_nop 0
    buffer_load_dwordx4 v15, s[12:15], s43 offen lds
    s_add_u32 s43, s41, 0x208000
    s_add_u32 m0, s51, 0xd000
    s_nop 0
    buffer_load_dwordx4 v15, s[12:15], s43 offen lds
    s_add_u32 s43, s41, 0x300000
    s_add_u32 m0, s51, 0xe000
    s_nop 0
    buffer_load_dwordx4 v15, s[12:15], s43 offen lds
    s_add_u32 s43, s41, 0x308000
    s_add_u32 m0, s51, 0xf000
    s_nop 0
    buffer_load_dwordx4 v15, s[12:15], s43 offen lds
    v_xor_b32 v15, 2, v14
    v_lshl_add_u32 v15, v15, 15, v8
    s_add_u32 s43, s41, 0x0
    s_add_u32 m0, s51, 0x10000
    s_nop 0
    buffer_load_dwordx4 v15, s[12:15], s43 offen lds
    s_add_u32 s43, s41, 0x8000
    s_add_u32 m0, s51, 0x11000
    s_nop 0
    buffer_load_dwordx4 v15, s[12:15], s43 offen lds
    s_add_u32 s43, s41, 0x100000
    s_add_u32 m0, s51, 0x12000
    s_nop 0
    buffer_load_dwordx4 v15, s[12:15], s43 offen lds
    s_add_u32 s43, s41, 0x108000
    s_add_u32 m0, s51, 0x13000
    s_nop 0
    buffer_load_dwordx4 v15, s[12:15], s43 offen lds
    s_waitcnt vmcnt(12)
    s_barrier
    v_xor_b32 v13, 0x0, v11
    v_add_u32 v13, 0x18000, v13
    ds_read_b64_tr_b16 a[144:145], v13
    ds_read_b64_tr_b16 a[146:147], v13 offset:1024
    ds_read_b64_tr_b16 a[148:149], v13 offset:16384
    ds_read_b64_tr_b16 a[150:151], v13 offset:17408
    v_xor_b32 v13, 0x20, v11
    v_add_u32 v13, 0x18000, v13
    ds_read_b64_tr_b16 a[152:153], v13
    ds_read_b64_tr_b16 a[154:155], v13 offset:1024
    ds_read_b64_tr_b16 a[156:157], v13 offset:16384
    ds_read_b64_tr_b16 a[158:159], v13 offset:17408
    v_xor_b32 v13, 0x1000, v11
    v_add_u32 v13, 0x18000, v13
    ds_read_b64_tr_b16 a[176:177], v13
    ds_read_b64_tr_b16 a[178:179], v13 offset:1024
    ds_read_b64_tr_b16 a[180:181], v13 offset:16384
    ds_read_b64_tr_b16 a[182:183], v13 offset:17408
    v_xor_b32 v13, 0x1020, v11
    v_add_u32 v13, 0x18000, v13
    ds_read_b64_tr_b16 a[184:185], v13
    ds_read_b64_tr_b16 a[186:187], v13 offset:1024
    ds_read_b64_tr_b16 a[188:189], v13 offset:16384
    ds_read_b64_tr_b16 a[190:191], v13 offset:17408
    s_waitcnt lgkmcnt(0)
    s_barrier
    s_add_u32 s43, s41, 0x200000
    s_add_u32 m0, s51, 0x14000
    s_nop 0
    buffer_load_dwordx4 v15, s[12:15], s43 offen lds
    s_add_u32 s43, s41, 0x208000
    s_add_u32 m0, s51, 0x15000
    s_nop 0
    buffer_load_dwordx4 v15, s[12:15], s43 offen lds
    s_add_u32 s43, s41, 0x300000
    s_add_u32 m0, s51, 0x16000
    s_nop 0
    buffer_load_dwordx4 v15, s[12:15], s43 offen lds
    s_add_u32 s43, s41, 0x308000
    s_add_u32 m0, s51, 0x17000
    s_nop 0
    buffer_load_dwordx4 v15, s[12:15], s43 offen lds
    s_mov_b32 s12, s66
    s_and_b32 s13, s67, 0xffff
    s_add_u32 s43, s42, 0x80
    s_add_u32 m0, s51, 0x18000
    s_nop 0
    buffer_load_dwordx4 v10, s[12:15], s43 offen lds
    s_add_u32 s43, s42, 0x4080
    s_add_u32 m0, s51, 0x19000
    s_nop 0
    buffer_load_dwordx4 v9, s[12:15], s43 offen lds
    s_add_u32 s43, s42, 0x8080
    s_add_u32 m0, s51, 0x1a000
    s_nop 0
    buffer_load_dwordx4 v10, s[12:15], s43 offen lds
    s_add_u32 s43, s42, 0xc080
    s_add_u32 m0, s51, 0x1b000
    s_nop 0
    buffer_load_dwordx4 v9, s[12:15], s43 offen lds
    s_waitcnt vmcnt(12)
    s_barrier
    v_xor_b32 v13, 0x0, v11
    v_add_u32 v13, 0x0, v13
    ds_read_b64_tr_b16 a[192:193], v13
    ds_read_b64_tr_b16 a[194:195], v13 offset:1024
    ds_read_b64_tr_b16 a[196:197], v13 offset:16384
    ds_read_b64_tr_b16 a[198:199], v13 offset:17408
    v_xor_b32 v13, 0x20, v11
    v_add_u32 v13, 0x0, v13
    ds_read_b64_tr_b16 a[200:201], v13
    ds_read_b64_tr_b16 a[202:203], v13 offset:1024
    ds_read_b64_tr_b16 a[204:205], v13 offset:16384
    ds_read_b64_tr_b16 a[206:207], v13 offset:17408
    v_xor_b32 v13, 0x1000, v11
    v_add_u32 v13, 0x0, v13
    ds_read_b64_tr_b16 a[224:225], v13
    ds_read_b64_tr_b16 a[226:227], v13 offset:1024
    ds_read_b64_tr_b16 a[228:229], v13 offset:16384
    ds_read_b64_tr_b16 a[230:231], v13 offset:17408
    v_xor_b32 v13, 0x1020, v11
    v_add_u32 v13, 0x0, v13
    ds_read_b64_tr_b16 a[232:233], v13
    ds_read_b64_tr_b16 a[234:235], v13 offset:1024
    ds_read_b64_tr_b16 a[236:237], v13 offset:16384
    ds_read_b64_tr_b16 a[238:239], v13 offset:17408
    s_waitcnt lgkmcnt(0)
    s_barrier
    s_add_u32 s43, s42, 0x10280
    s_add_u32 m0, s51, 0x1c000
    s_nop 0
    buffer_load_dwordx4 v10, s[12:15], s43 offen lds
    s_add_u32 s43, s42, 0x14280
    s_add_u32 m0, s51, 0x1d000
    s_nop 0
    buffer_load_dwordx4 v9, s[12:15], s43 offen lds
    s_add_u32 s43, s42, 0x18280
    s_add_u32 m0, s51, 0x1e000
    s_nop 0
    buffer_load_dwordx4 v10, s[12:15], s43 offen lds
    s_add_u32 s43, s42, 0x1c280
    s_add_u32 m0, s51, 0x1f000
    s_nop 0
    buffer_load_dwordx4 v9, s[12:15], s43 offen lds
    s_add_u32 s43, s42, 0x10080
    s_add_u32 m0, s51, 0x20000
    s_nop 0
    buffer_load_dwordx4 v10, s[12:15], s43 offen lds
    s_add_u32 s43, s42, 0x14080
    s_add_u32 m0, s51, 0x21000
    s_nop 0
    buffer_load_dwordx4 v9, s[12:15], s43 offen lds
    s_add_u32 s43, s42, 0x18080
    s_add_u32 m0, s51, 0x22000
    s_nop 0
    buffer_load_dwordx4 v10, s[12:15], s43 offen lds
    s_add_u32 s43, s42, 0x1c080
    s_add_u32 m0, s51, 0x23000
    s_nop 0
    buffer_load_dwordx4 v9, s[12:15], s43 offen lds
    s_waitcnt vmcnt(12)
    v_readfirstlane_b32 s57, v26
    v_readfirstlane_b32 s43, v27
    s_nop 0
    s_cmp_lg_u32 s43, 0
    s_cselect_b32 s57, s57, 0
    s_barrier
    s_cmp_lg_u32 s21, 0
    s_cbranch_scc1 L_arr_4
    v_mov_b32 v23, 1
    s_mov_b64 exec, 1
    buffer_atomic_add v23, off, s[16:19], 0 offset:4
    s_mov_b64 exec, -1
L_arr_4:
    v_xor_b32 v13, 0x0, v11
    v_add_u32 v13, 0x8000, v13
    ds_read_b64_tr_b16 v[128:129], v13
    ds_read_b64_tr_b16 v[130:131], v13 offset:1024
    ds_read_b64_tr_b16 v[132:133], v13 offset:16384
    ds_read_b64_tr_b16 v[134:135], v13 offset:17408
    v_xor_b32 v13, 0x20, v11
    v_add_u32 v13, 0x8000, v13
    ds_read_b64_tr_b16 v[136:137], v13
    ds_read_b64_tr_b16 v[138:139], v13 offset:1024
    ds_read_b64_tr_b16 v[140:141], v13 offset:16384
    ds_read_b64_tr_b16 v[142:143], v13 offset:17408
    v_xor_b32 v13, 0x1000, v11
    v_add_u32 v13, 0x8000, v13
    ds_read_b64_tr_b16 v[160:161], v13
    ds_read_b64_tr_b16 v[162:163], v13 offset:1024
    ds_read_b64_tr_b16 v[164:165], v13 offset:16384
    ds_read_b64_tr_b16 v[166:167], v13 offset:17408
    v_xor_b32 v13, 0x1020, v11
    v_add_u32 v13, 0x8000, v13
    ds_read_b64_tr_b16 v[168:169], v13
    ds_read_b64_tr_b16 v[170:171], v13 offset:1024
    ds_read_b64_tr_b16 v[172:173], v13 offset:16384
    ds_read_b64_tr_b16 v[174:175], v13 offset:17408
    s_waitcnt lgkmcnt(0)
    s_barrier
    s_add_u32 s43, s42, 0x280
    s_add_u32 m0, s51, 0x24000
    s_nop 0
    buffer_load_dwordx4 v10, s[12:15], s43 offen lds
    s_add_u32 s43, s42, 0x4280
    s_add_u32 m0, s51, 0x25000
    s_nop 0
    buffer_load_dwordx4 v9, s[12:15], s43 offen lds
    s_add_u32 s43, s42, 0x8280
    s_add_u32 m0, s51, 0x26000
    s_nop 0
    buffer_load_dwordx4 v10, s[12:15], s43 offen lds
    s_add_u32 s43, s42, 0xc280
    s_add_u32 m0, s51, 0x27000
    s_nop 0
    buffer_load_dwordx4 v9, s[12:15], s43 offen lds
    s_mov_b32 s12, s64
    s_and_b32 s13, s65, 0xffff
    v_xor_b32 v15, 0, v14
    v_lshl_add_u32 v15, v15, 15, v8
    s_add_u32 s43, s41, 0x80000
    s_add_u32 m0, s51, 0x8000
    s_nop 0
    buffer_load_dwordx4 v15, s[12:15], s43 offen lds
    s_add_u32 s43, s41, 0x88000
    s_add_u32 m0, s51, 0x9000
    s_nop 0
    buffer_load_dwordx4 v15, s[12:15], s43 offen lds
    s_add_u32 s43, s41, 0x180000
    s_add_u32 m0, s51, 0xa000
    s_nop 0
    buffer_load_dwordx4 v15, s[12:15], s43 offen lds
    s_add_u32 s43, s41, 0x188000
    s_add_u32 m0, s51, 0xb000
    s_nop 0
    buffer_load_dwordx4 v15, s[12:15], s43 offen lds
    s_waitcnt vmcnt(12)
    s_barrier
    v_xor_b32 v13, 0x0, v12
    v_add_u32 v13, 0x10000, v13
    ds_read_b64_tr_b16 v[192:193], v13
    ds_read_b64_tr_b16 v[194:195], v13 offset:512
    ds_read_b64_tr_b16 v[196:197], v13 offset:2048
    ds_read_b64_tr_b16 v[198:199], v13 offset:2560
    v_xor_b32 v13, 0x2000, v12
    v_add_u32 v13, 0x10000, v13
    ds_read_b64_tr_b16 v[200:201], v13
    ds_read_b64_tr_b16 v[202:203], v13 offset:512
    ds_read_b64_tr_b16 v[204:205], v13 offset:2048
    ds_read_b64_tr_b16 v[206:207], v13 offset:2560
    v_xor_b32 v13, 0x40, v12
    v_add_u32 v13, 0x10000, v13
    ds_read_b64_tr_b16 v[224:225], v13
    ds_read_b64_tr_b16 v[226:227], v13 offset:512
    ds_read_b64_tr_b16 v[228:229], v13 offset:2048
    ds_read_b64_tr_b16 v[230:231], v13 offset:2560
    v_xor_b32 v13, 0x2040, v12
    v_add_u32 v13, 0x10000, v13
    ds_read_b64_tr_b16 v[232:233], v13
    ds_read_b64_tr_b16 v[234:235], v13 offset:512
    ds_read_b64_tr_b16 v[236:237], v13 offset:2048
    ds_read_b64_tr_b16 v[238:239], v13 offset:2560
    s_waitcnt lgkmcnt(0)
    s_barrier
    s_add_u32 s43, s41, 0x280000
    s_add_u32 m0, s51, 0xc000
    s_nop 0
    buffer_load_dwordx4 v15, s[12:15], s43 offen lds
    s_add_u32 s43, s41, 0x288000
    s_add_u32 m0, s51, 0xd000
    s_nop 0
    buffer_load_dwordx4 v15, s[12:15], s43 offen lds
    s_add_u32 s43, s41, 0x380000
    s_add_u32 m0, s51, 0xe000
    s_nop 0
    buffer_load_dwordx4 v15, s[12:15], s43 offen lds
    s_add_u32 s43, s41, 0x388000
    s_add_u32 m0, s51, 0xf000
    s_nop 0
    buffer_load_dwordx4 v15, s[12:15], s43 offen lds
    v_xor_b32 v15, 2, v14
    v_lshl_add_u32 v15, v15, 15, v8
    s_add_u32 s43, s41, 0x80000
    s_add_u32 m0, s51, 0x10000
    s_nop 0
    buffer_load_dwordx4 v15, s[12:15], s43 offen lds
    s_add_u32 s43, s41, 0x88000
    s_add_u32 m0, s51, 0x11000
    s_nop 0
    buffer_load_dwordx4 v15, s[12:15], s43 offen lds
    s_add_u32 s43, s41, 0x180000
    s_add_u32 m0, s51, 0x12000
    s_nop 0
    buffer_load_dwordx4 v15, s[12:15], s43 offen lds
    s_add_u32 s43, s41, 0x188000
    s_add_u32 m0, s51, 0x13000
    s_nop 0
    buffer_load_dwordx4 v15, s[12:15], s43 offen lds
    s_waitcnt vmcnt(12)
    s_barrier
    v_xor_b32 v13, 0x0, v12
    v_add_u32 v13, 0x18000, v13
    ds_read_b64_tr_b16 v[208:209], v13
    ds_read_b64_tr_b16 v[210:211], v13 offset:512
    ds_read_b64_tr_b16 v[212:213], v13 offset:2048
    ds_read_b64_tr_b16 v[214:215], v13 offset:2560
    v_xor_b32 v13, 0x2000, v12
    v_add_u32 v13, 0x18000, v13
    ds_read_b64_tr_b16 v[216:217], v13
    ds_read_b64_tr_b16 v[218:219], v13 offset:512
    ds_read_b64_tr_b16 v[220:221], v13 offset:2048
    ds_read_b64_tr_b16 v[222:223], v13 offset:2560
    v_xor_b32 v13, 0x40, v12
    v_add_u32 v13, 0x18000, v13
    ds_read_b64_tr_b16 v[240:241], v13
    ds_read_b64_tr_b16 v[242:243], v13 offset:512
    ds_read_b64_tr_b16 v[244:245], v13 offset:2048
    ds_read_b64_tr_b16 v[246:247], v13 offset:2560
    v_xor_b32 v13, 0x2040, v12
    v_add_u32 v13, 0x18000, v13
    ds_read_b64_tr_b16 v[248:249], v13
    ds_read_b64_tr_b16 v[250:251], v13 offset:512
    ds_read_b64_tr_b16 v[252:253], v13 offset:2048
    ds_read_b64_tr_b16 v[254:255], v13 offset:2560
    s_waitcnt lgkmcnt(0)
    s_barrier
    s_add_u32 s43, s41, 0x280000
    s_add_u32 m0, s51, 0x14000
    s_nop 0
    buffer_load_dwordx4 v15, s[12:15], s43 offen lds
    s_add_u32 s43, s41, 0x288000
    s_add_u32 m0, s51, 0x15000
    s_nop 0
    buffer_load_dwordx4 v15, s[12:15], s43 offen lds
    s_add_u32 s43, s41, 0x380000
    s_add_u32 m0, s51, 0x16000
    s_nop 0
    buffer_load_dwordx4 v15, s[12:15], s43 offen lds
    s_add_u32 s43, s41, 0x388000
    s_add_u32 m0, s51, 0x17000
    s_nop 0
    buffer_load_dwordx4 v15, s[12:15], s43 offen lds
    ds_write_b128 v124, v[192:195]
    ds_write_b128 v124, v[196:199] offset:1024
    ds_write_b128 v124, v[200:203] offset:2048
    ds_write_b128 v124, v[204:207] offset:3072
    ds_write_b128 v124, v[208:211] offset:4096
    ds_write_b128 v124, v[212:215] offset:5120
    ds_write_b128 v124, v[216:219] offset:6144
    ds_write_b128 v124, v[220:223] offset:7168
    ds_write_b128 v124, v[224:227] offset:32768
    ds_write_b128 v124, v[228:231] offset:33792
    ds_write_b128 v124, v[232:235] offset:34816
    ds_write_b128 v124, v[236:239] offset:35840
    ds_write_b128 v124, v[240:243] offset:36864
    ds_write_b128 v124, v[244:247] offset:37888
    ds_write_b128 v124, v[248:251] offset:38912
    ds_write_b128 v124, v[252:255] offset:39936
    s_waitcnt vmcnt(8)
    s_barrier
    v_xor_b32 v13, 0x0, v11
    v_add_u32 v13, 0x0, v13
    ds_read_b64_tr_b16 a[208:209], v13
    ds_read_b64_tr_b16 a[210:211], v13 offset:1024
    ds_read_b64_tr_b16 a[212:213], v13 offset:16384
    ds_read_b64_tr_b16 a[214:215], v13 offset:17408
    v_xor_b32 v13, 0x20, v11
    v_add_u32 v13, 0x0, v13
    ds_read_b64_tr_b16 a[216:217], v13
    ds_read_b64_tr_b16 a[218:219], v13 offset:1024
    ds_read_b64_tr_b16 a[220:221], v13 offset:16384
    ds_read_b64_tr_b16 a[222:223], v13 offset:17408
    v_xor_b32 v13, 0x1000, v11
    v_add_u32 v13, 0x0, v13
    ds_read_b64_tr_b16 a[240:241], v13
    ds_read_b64_tr_b16 a[242:243], v13 offset:1024
    ds_read_b64_tr_b16 a[244:245], v13 offset:16384
    ds_read_b64_tr_b16 a[246:247], v13 offset:17408
    v_xor_b32 v13, 0x1020, v11
    v_add_u32 v13, 0x0, v13
    ds_read_b64_tr_b16 a[248:249], v13
    ds_read_b64_tr_b16 a[250:251], v13 offset:1024
    ds_read_b64_tr_b16 a[252:253], v13 offset:16384
    ds_read_b64_tr_b16 a[254:255], v13 offset:17408
    s_waitcnt lgkmcnt(0)
    s_barrier
    s_mov_b32 s43, 0x10000
    buffer_load_dword v30, v7, s[8:11], s43 offen sc1
    s_cmp_lg_u32 s20, 28
    s_cbranch_scc1 L_nocc_5
    v_lshlrev_b32 v25, 2, v117
    s_lshl_b32 s43, s21, 12
    s_getpc_b64 s[4:5]
L_pc_6:
    s_add_u32 s4, s4, L_nocc_5-L_pc_6
    s_addc_u32 s5, s5, 0
    v_add_u32 v25, s43, v25
    v_min_u32 v25, L_code_end-L_nocc_5-4, v25
    global_load_dword v29, v25, s[4:5]
L_nocc_5:
L_chain_warm:
    s_mov_b32 s12, s66
    s_and_b32 s13, s67, 0xffff
    s_add_u32 s43, s42, 0x0
    s_add_u32 m0, s51, 0x8000
    s_nop 0
    buffer_load_dwordx4 v10, s[12:15], s43 offen lds
    s_add_u32 s43, s42, 0x4000
    s_add_u32 m0, s51, 0x9000
    s_nop 0
    buffer_load_dwordx4 v9, s[12:15], s43 offen lds
    s_add_u32 s43, s42, 0x8000
    s_add_u32 m0, s51, 0xa000
    s_nop 0
    buffer_load_dwordx4 v10, s[12:15], s43 offen lds
    s_add_u32 s43, s42, 0xc000
    s_add_u32 m0, s51, 0xb000
    s_nop 0
    buffer_load_dwordx4 v9, s[12:15], s43 offen lds
    s_add_u32 s43, s42, 0x10200
    s_add_u32 m0, s51, 0xc000
    s_nop 0
    buffer_load_dwordx4 v10, s[12:15], s43 offen lds
    s_add_u32 s43, s42, 0x14200
    s_add_u32 m0, s51, 0xd000
    s_nop 0
    buffer_load_dwordx4 v9, s[12:15], s43 offen lds
    s_add_u32 s43, s42, 0x18200
    s_add_u32 m0, s51, 0xe000
    s_nop 0
    buffer_load_dwordx4 v10, s[12:15], s43 offen lds
    s_add_u32 s43, s42, 0x1c200
    s_add_u32 m0, s51, 0xf000
    s_nop 0
    buffer_load_dwordx4 v9, s[12:15], s43 offen lds
    s_waitcnt vmcnt(9)
    s_barrier
    v_xor_b32 v13, 0x0, v11
    v_add_u32 v13, 0x8000, v13
    ds_read_b64_tr_b16 v[144:145], v13
    ds_read_b64_tr_b16 v[146:147], v13 offset:1024
    ds_read_b64_tr_b16 v[148:149], v13 offset:16384
    ds_read_b64_tr_b16 v[150:151], v13 offset:17408
    v_xor_b32 v13, 0x20, v11
    v_add_u32 v13, 0x8000, v13
    ds_read_b64_tr_b16 v[152:153], v13
    ds_read_b64_tr_b16 v[154:155], v13 offset:1024
    ds_read_b64_tr_b16 v[156:157], v13 offset:16384
    ds_read_b64_tr_b16 v[158:159], v13 offset:17408
    v_xor_b32 v13, 0x1000, v11
    v_add_u32 v13, 0x8000, v13
    ds_read_b64_tr_b16 v[176:177], v13
    ds_read_b64_tr_b16 v[178:179], v13 offset:1024
    ds_read_b64_tr_b16 v[180:181], v13 offset:16384
    ds_read_b64_tr_b16 v[182:183], v13 offset:17408
    v_xor_b32 v13, 0x1020, v11
    v_add_u32 v13, 0x8000, v13
    ds_read_b64_tr_b16 v[184:185], v13
    ds_read_b64_tr_b16 v[186:187], v13 offset:1024
    ds_read_b64_tr_b16 v[188:189], v13 offset:16384
    ds_read_b64_tr_b16 v[190:191], v13 offset:17408
    s_waitcnt lgkmcnt(0)
    s_barrier
    s_add_u32 s43, s42, 0x10000
    s_add_u32 m0, s51, 0x10000
    s_nop 0
    buffer_load_dwordx4 v10, s[12:15], s43 offen lds
    s_add_u32 s43, s42, 0x14000
    s_add_u32 m0, s51, 0x11000
    s_nop 0
    buffer_load_dwordx4 v9, s[12:15], s43 offen lds
    s_add_u32 s43, s42, 0x18000
    s_add_u32 m0, s51, 0x12000
    s_nop 0
    buffer_load_dwordx4 v10, s[12:15], s43 offen lds
    s_add_u32 s43, s42, 0x1c000
    s_add_u32 m0, s51, 0x13000
    s_nop 0
    buffer_load_dwordx4 v9, s[12:15], s43 offen lds
    s_add_u32 s43, s42, 0x200
    s_add_u32 m0, s51, 0x14000
    s_nop 0
    buffer_load_dwordx4 v10, s[12:15], s43 offen lds
    s_add_u32 s43, s42, 0x4200
    s_add_u32 m0, s51, 0x15000
    s_nop 0
    buffer_load_dwordx4 v9, s[12:15], s43 offen lds
    s_add_u32 s43, s42, 0x8200
    s_add_u32 m0, s51, 0x16000
    s_nop 0
    buffer_load_dwordx4 v10, s[12:15], s43 offen lds
    s_add_u32 s43, s42, 0xc200
    s_add_u32 m0, s51, 0x17000
    s_nop 0
    buffer_load_dwordx4 v9, s[12:15], s43 offen lds
    v_lshlrev_b32 v26, 3, v117
    v_and_b32 v26, 2048, v26
    s_lshl_b32 s43, s20, 6
    s_add_u32 s43, s43, 0x2000
    buffer_load_dword v26, v26, s[8:11], s43 offen sc1
    buffer_load_dword v27, off, s[16:19], 0 offset:4 sc1
    s_waitcnt vmcnt(10)
    v_min_u32 v21, 0xfffffffe, v21
    s_mov_b32 s43, 0x10000
    s_mov_b64 exec, s[38:39]
    buffer_store_dword v21, v119, s[8:11], s43 offen
    s_mov_b64 exec, -1
    v_mov_b32 v16, -1
    v_mov_b32 v17, -1
    v_mov_b32 v18, -1
    v_mov_b32 v19, -1
    s_lshl_b32 s43, s20, 13
    s_add_u32 s43, s43, 0x100000
    s_and_b32 s40, s21, 1
    s_lshl_b32 s40, s40, 12
    s_add_u32 s29, s43, s40
    s_add_u32 s43, s43, s52
    s_xor_b32 s40, s43, 0x0
    s_mov_b32 s43, 0x12000
    buffer_store_dword v16, v119, s[8:11], s43 offen
    s_mov_b32 s43, 0x14000
    buffer_store_dword v16, v119, s[8:11], s43 offen
    s_mov_b32 s43, 0x16000
    buffer_store_dword v16, v119, s[8:11], s43 offen
    s_barrier
    v_xor_b32 v13, 0x0, v12
    v_add_u32 v13, 0x0, v13
    ds_read_b64_tr_b16 v[192:193], v13
    ds_read_b64_tr_b16 v[194:195], v13 offset:512
    ds_read_b64_tr_b16 v[196:197], v13 offset:2048
    ds_read_b64_tr_b16 v[198:199], v13 offset:2560
    v_xor_b32 v13, 0x2000, v12
    v_add_u32 v13, 0x0, v13
    ds_read_b64_tr_b16 v[200:201], v13
    ds_read_b64_tr_b16 v[202:203], v13 offset:512
    ds_read_b64_tr_b16 v[204:205], v13 offset:2048
    ds_read_b64_tr_b16 v[206:207], v13 offset:2560
    v_xor_b32 v13, 0x40, v12
    v_add_u32 v13, 0x0, v13
    ds_read_b64_tr_b16 v[224:225], v13
    ds_read_b64_tr_b16 v[226:227], v13 offset:512
    ds_read_b64_tr_b16 v[228:229], v13 offset:2048
    ds_read_b64_tr_b16 v[230:231], v13 offset:2560
    v_xor_b32 v13, 0x2040, v12
    v_add_u32 v13, 0x0, v13
    ds_read_b64_tr_b16 v[232:233], v13
    ds_read_b64_tr_b16 v[234:235], v13 offset:512
    ds_read_b64_tr_b16 v[236:237], v13 offset:2048
    ds_read_b64_tr_b16 v[238:239], v13 offset:2560
    s_lshr_b32 s43, s20, 1
    s_lshl_b32 s43, s43, 7
    s_and_b32 s40, s20, 1
    s_lshl_b32 s40, s40, 4
    s_add_u32 s43, s43, s40
    s_add_u32 s44, s43, 0x1000
    s_cmp_eq_u32 s21, 0
    s_cselect_b32 s44, s44, 0x7ff00000
    s_mov_b32 s22, 0
    s_mov_b32 s33, 0
    s_xor_b32 s53, s29, 1024
    s_add_u32 s23, s51, 0x10000
    s_add_u32 s48, s23, 4096
    s_mov_b32 s24, 0x12000
    s_add_u32 s55, s24, 16384
    s_mov_b32 s25, 0x100000
    s_mov_b32 s26, 0x101000
    v_mov_b32 v112, 0
    v_mov_b32 v113, 0
    v_mov_b32 v114, 0
    v_mov_b32 v115, 0
    ds_write_b128 v117, v[112:115] offset:22528
    ds_write_b128 v117, v[112:115] offset:23552
    s_cmp_lg_u32 s21, 0
    s_cselect_b32 s40, -1, 0
    v_mov_b32 v126, s40
    v_bfe_u32 v1, v117, 4, 1
    v_lshlrev_b32 v1, 4, v1
    s_movk_i32 s43, 0x3f80
    v_lshlrev_b32 v125, v1, s43
    v_bfe_u32 v1, v117, 5, 3
    v_cmp_eq_u32 s[68:69], 0, v1
    v_cmp_eq_u32 s[70:71], 1, v1
    v_cmp_eq_u32 s[72:73], 2, v1
    v_cmp_eq_u32 s[74:75], 3, v1
    v_mov_b32 v40, 0
    v_mov_b32 v41, 0
    v_mov_b32 v42, 0
    v_mov_b32 v43, 0
    v_mov_b32 v44, 0
    v_mov_b32 v45, 0
    v_mov_b32 v46, 0
    v_mov_b32 v47, 0
    v_mov_b32 v48, 0
    v_mov_b32 v49, 0
    v_mov_b32 v50, 0
    v_mov_b32 v51, 0
    v_mov_b32 v52, 0
    v_mov_b32 v53, 0
    v_mov_b32 v54, 0
    v_mov_b32 v55, 0
    s_mov_b32 s45, 0
    s_mov_b32 s46, 0
    s_mov_b32 s47, 0
    s_mov_b32 s76, 0
    s_and_b32 s43, s21, 1
    s_lshl_b32 s43, s43, 5
    s_add_u32 s43, s43, s20
    s_lshl_b32 s43, s43, 6
    s_add_u32 s28, s43, 0x2000
    s_mov_b32 s59, 0
    s_waitcnt vmcnt(4) lgkmcnt(0)
    v_readlane_b32 s43, v26, 0
    v_readlane_b32 s40, v26, 16
    s_nop 0
    s_min_u32 s43, s43, s40
    s_cmp_lg_u32 s43, 0
    s_cselect_b32 s57, s57, 0
    v_readfirstlane_b32 s43, v27
    s_nop 0
    s_cmp_ge_u32 s43, 32
    s_cselect_b32 s57, s57, 0
    s_cmp_lg_u32 s57, 1
    s_cbranch_scc1 L_nokv_7
    s_add_u32 m0, s52, 8192
    s_nop 0
    buffer_load_dwordx4 v117, s[8:11], s30 offen lds
    buffer_load_dwordx4 v117, s[8:11], s30 offen offset:1024 lds
    s_add_u32 m0, s52, 0x6000
    s_nop 0
    buffer_load_dwordx4 v117, s[8:11], s31 offen lds
    buffer_load_dwordx4 v117, s[8:11], s31 offen offset:1024 lds
L_nokv_7:
    s_barrier
    v_xor_b32 v13, 0x0, v12
    v_add_u32 v13, 0x8000, v13
    ds_read_b64_tr_b16 v[208:209], v13
    ds_read_b64_tr_b16 v[210:211], v13 offset:512
    ds_read_b64_tr_b16 v[212:213], v13 offset:2048
    ds_read_b64_tr_b16 v[214:215], v13 offset:2560
    v_xor_b32 v13, 0x2000, v12
    v_add_u32 v13, 0x8000, v13
    ds_read_b64_tr_b16 v[216:217], v13
    ds_read_b64_tr_b16 v[218:219], v13 offset:512
    ds_read_b64_tr_b16 v[220:221], v13 offset:2048
    ds_read_b64_tr_b16 v[222:223], v13 offset:2560
    v_xor_b32 v13, 0x40, v12
    v_add_u32 v13, 0x8000, v13
    ds_read_b64_tr_b16 v[240:241], v13
    ds_read_b64_tr_b16 v[242:243], v13 offset:512
    ds_read_b64_tr_b16 v[244:245], v13 offset:2048
    ds_read_b64_tr_b16 v[246:247], v13 offset:2560
    v_xor_b32 v13, 0x2040, v12
    v_add_u32 v13, 0x8000, v13
    ds_read_b64_tr_b16 v[248:249], v13
    ds_read_b64_tr_b16 v[250:251], v13 offset:512
    ds_read_b64_tr_b16 v[252:253], v13 offset:2048
    ds_read_b64_tr_b16 v[254:255], v13 offset:2560
    ds_write_b128 v123, v[80:83]
    ds_write_b128 v123, v[84:87] offset:1024
    ds_write_b128 v123, v[56:59] offset:2048
    ds_write_b128 v123, v[60:63] offset:3072
    ds_write_b128 v123, v[88:91] offset:4096
    ds_write_b128 v123, v[92:95] offset:5120
    ds_write_b128 v123, v[96:99] offset:6144
    ds_write_b128 v123, v[100:103] offset:7168
    s_cmp_eq_u32 s57, 1
    s_cbranch_scc1 L_started_8
    s_mov_b32 s96, 0
L_mode_9:
    buffer_load_dwordx2 v[2:3], off, s[92:95], 0 offset:36 sc1
    s_waitcnt vmcnt(0)
    v_readfirstlane_b32 s87, v2
    v_readfirstlane_b32 s97, v3
    s_nop 0
    s_min_u32 s97, s97, s87
    s_cmp_lg_u32 s97, 0
    s_cbranch_scc1 L_moded_10
    s_sleep 4
    s_add_u32 s96, s96, 1
    s_cmp_lg_u32 s96, 0x100
    s_cbranch_scc1 L_modef_11
    v_mov_b32 v2, 2
    v_mov_b32 v3, 0
    s_mov_b64 exec, 1
    buffer_atomic_cmpswap v[2:3], off, s[92:95], 0 offset:36
    s_mov_b64 exec, -1
L_modef_11:
    s_cmp_lt_u32 s96, 0x10000
    s_cbranch_scc1 L_mode_9
L_moded_10:
    s_cmp_lg_u32 s87, 1
    s_cbranch_scc1 L_fallback
    v_lshrrev_b32 v1, 4, v117
    v_and_b32 v2, 15, v1
    v_lshrrev_b32 v1, 4, v1
    v_lshlrev_b32 v1, 11, v1
    v_lshl_add_u32 v1, v2, 2, v1
    s_lshl_b32 s43, s20, 6
    s_add_u32 s43, s43, 0x2000
    s_mov_b32 exec_lo, 0x10001
    s_mov_b32 exec_hi, 0
    s_mov_b32 s96, 0
L_poll_12:
    buffer_load_dword v2, v1, s[8:11], s43 offen sc1
    s_waitcnt vmcnt(0)
    v_cmp_gt_u32 vcc, 1, v2
    s_cbranch_vccz L_polld_13
    s_sleep 8
    s_add_u32 s96, s96, 1
    s_cmp_lt_u32 s96, 0x10000
    s_cbranch_scc1 L_poll_12
L_polld_13:
    s_mov_b64 exec, -1
    s_add_u32 m0, s52, 8192
    s_nop 0
    buffer_load_dwordx4 v117, s[8:11], s30 offen lds
    buffer_load_dwordx4 v117, s[8:11], s30 offen offset:1024 lds
    s_add_u32 m0, s52, 0x6000
    s_nop 0
    buffer_load_dwordx4 v117, s[8:11], s31 offen lds
    buffer_load_dwordx4 v117, s[8:11], s31 offen offset:1024 lds
    s_mov_b32 s49, 0
L_cb_poll_15:
    buffer_load_dword v3, off, s[16:19], 0 offset:4 sc1
    s_waitcnt vmcnt(0)
    v_readfirstlane_b32 s43, v3
    s_nop 0
    s_cmp_ge_u32 s43, 32
    s_cbranch_scc1 L_started_8
    s_sleep 8
    s_add_u32 s49, s49, 1
    s_cmp_lt_u32 s49, 0x40000
    s_cbranch_scc1 L_cb_poll_15
L_started_8:
    v_lshrrev_b32 v1, 2, v117
    s_cmp_lt_u32 s21, 2
    s_cselect_b64 vcc, -1, 0
    v_cndmask_b32 v119, v119, v1, vcc
    s_add_u32 m0, s51, 4096
    v_mov_b32 v24, v32
    v_mov_b32 v25, v33
    v_mov_b32 v26, v34
    v_mov_b32 v27, v35
    v_mov_b32 v28, v36
    v_mov_b32 v29, v37
    v_mov_b32 v30, v38
    v_mov_b32 v31, v39
    s_add_u32 s30, s30, 0x40000
    s_add_u32 s31, s31, 0x40000
    s_mov_b32 s49, 0
    s_waitcnt vmcnt(0) lgkmcnt(0)
    s_barrier
    ds_write_b128 v123, v[64:67] offset:32768
    ds_write_b128 v123, v[68:71] offset:33792
    ds_write_b128 v123, v[72:75] offset:34816
    ds_write_b128 v123, v[76:79] offset:35840
    ds_write_b128 v123, v[104:107] offset:36864
    ds_write_b128 v123, v[108:111] offset:37888
    ds_write_b128 v123, v[32:35] offset:38912
    ds_write_b128 v123, v[36:39] offset:39936
    v_mov_b32 v32, 0
    v_mov_b32 v33, 0
    v_mov_b32 v34, 0
    v_mov_b32 v35, 0
    v_mov_b32 v36, 0
    v_mov_b32 v37, 0
    v_mov_b32 v38, 0
    v_mov_b32 v39, 0
    s_nop 4
    s_cmp_eq_u32 s21, 1
    s_cbranch_scc1 L_chain_top1_f
    s_cmp_eq_u32 s21, 2
    s_cbranch_scc1 L_chain_top2_f
    s_cmp_eq_u32 s21, 3
    s_cbranch_scc1 L_chain_top3_f
.p2align 6
L_chain_top0_f:
    buffer_load_dwordx4 v[0:3], v117, s[8:11], s23 offen nt
    v_mov_b32 v15, 0
    v_mov_b32 v15, 0
    v_mov_b32 v15, 0
    v_mov_b32 v15, 0
    v_mov_b32 v15, 0
    v_mov_b32 v15, 0
    v_mov_b32 v15, 0
    v_mov_b32 v15, 0
    v_mov_b32 v15, 0
    v_mov_b32 v15, 0
    v_mov_b32 v15, 0
    v_mov_b32 v15, 0
    v_mov_b32 v15, 0
    v_mov_b32 v15, 0
    v_mov_b32 v15, 0
    v_mov_b32 v15, 0
    buffer_load_dwordx4 v[0:3], v117, s[8:11], s23 offen sc1
    v_mov_b32 v15, 0
    v_mov_b32 v15, 0
    v_mov_b32 v15, 0
    v_mov_b32 v15, 0
    v_mov_b32 v15, 0
    v_mov_b32 v15, 0
    v_mov_b32 v15, 0
    v_mov_b32 v15, 0
    v_mov_b32 v15, 0
    v_mov_b32 v15, 0
    v_mov_b32 v15, 0
    v_mov_b32 v15, 0
    v_mov_b32 v15, 0
    v_mov_b32 v15, 0
    v_mov_b32 v15, 0
    v_mov_b32 v15, 0
L_mret_17:
    buffer_load_dwordx4 v[0:3], v117, s[8:11], s23 offen sc1
    s_add_u32 s45, s45, 1
    s_cmp_lt_u32 s45, 0x10000
    s_cselect_b32 s56, -2, -1
    s_nop 3
    v_mov_b32 v32, 0
    v_mov_b32 v33, 0
    v_mov_b32 v34, 0
    v_mov_b32 v35, 0
    s_waitcnt vmcnt(2)
    v_max3_u32 v15, v0, v1, v2
    v_max_u32 v15, v15, v3
    v_cmp_lt_u32 vcc, s56, v15
    v_smfmac_f32_16x16x64_bf16 v[32:35], v[0:3], v[80:87], v116
    s_cbranch_vccnz L_mret_17
    ds_write_b128 v117, v[0:3]
    v_smfmac_f32_16x16x64_bf16 v[36:39], v[0:3], v[56:63], v116
    buffer_load_dwordx4 v[4:7], v117, s[8:11], s48 offen nt
    v_smfmac_f32_16x16x64_bf16 v[40:43], v[0:3], v[64:71], v116
    buffer_load_dwordx4 v117, s[8:11], s48 offen nt lds
    s_mov_b32 m0, 8192
    v_smfmac_f32_16x16x64_bf16 v[44:47], v[0:3], v[72:79], v116
    s_waitcnt lgkmcnt(0)
    s_barrier
    ds_read_b128 v[8:11], v117 offset:1024
    v_smfmac_f32_16x16x64_bf16 v[48:51], v[0:3], a[192:199], v116
    ds_read_b128 v[16:19], v117 offset:2048
    ds_read_b128 v[20:23], v117 offset:3072
    v_smfmac_f32_16x16x64_bf16 v[52:55], v[0:3], a[200:207], v116
    ds_read_b128 v[80:83], v117 offset:14336
    s_waitcnt lgkmcnt(3)
    v_smfmac_f32_16x16x64_bf16 v[32:35], v[8:11], a[0:7], v116
    ds_read_b128 v[84:87], v117 offset:15360
    v_smfmac_f32_16x16x64_bf16 v[36:39], v[8:11], a[8:15], v116
    buffer_store_dwordx4 v[112:115], v117, s[8:11], s32 offen sc1
    s_waitcnt lgkmcnt(3)
    v_smfmac_f32_16x16x64_bf16 v[32:35], v[16:19], a[32:39], v116
    ds_read_b128 v[56:59], v117 offset:8192
    v_smfmac_f32_16x16x64_bf16 v[36:39], v[16:19], a[40:47], v116
    ds_read_b128 v[60:63], v117 offset:9216
    s_waitcnt lgkmcnt(4)
    v_smfmac_f32_16x16x64_bf16 v[32:35], v[20:23], a[64:71], v116
    ds_read_b128 v[64:67], v117 offset:10240
    v_smfmac_f32_16x16x64_bf16 v[36:39], v[20:23], a[72:79], v116
    ds_read_b128 v[68:71], v117 offset:11264
    v_smfmac_f32_16x16x64_bf16 v[40:43], v[8:11], a[96:103], v116
    ds_read_b128 v[72:75], v117 offset:12288
    v_smfmac_f32_16x16x64_bf16 v[40:43], v[16:19], a[128:135], v116
    ds_read_b128 v[76:79], v117 offset:13312
    v_smfmac_f32_16x16x64_bf16 v[40:43], v[20:23], a[160:167], v116
    s_waitcnt vmcnt(2)
    v_max3_u32 v15, v4, v5, v6
    v_smfmac_f32_16x16x64_bf16 v[44:47], v[8:11], a[104:111], v116
    v_max_u32 v15, v15, v7
    v_smfmac_f32_16x16x64_bf16 v[44:47], v[16:19], a[136:143], v116
    s_waitcnt vmcnt(1) lgkmcnt(0)
    v_cmp_lt_u32 vcc, s56, v15
    v_smfmac_f32_16x16x64_bf16 v[44:47], v[20:23], a[168:175], v116
    s_cbranch_vccnz L_mret_18
L_mgo_19:
    v_smfmac_f32_16x16x64_bf16 v[44:47], v[4:7], v[24:31], v116
    s_barrier
    ds_read_b128 v[12:15], v117 offset:5120
    v_smfmac_f32_16x16x64_bf16 v[32:35], v[4:7], v[88:95], v116
    ds_read_b128 v[24:27], v117 offset:6144
    v_smfmac_f32_16x16x64_bf16 v[36:39], v[4:7], v[96:103], v116
    ds_read_b128 v[28:31], v117 offset:7168
    v_smfmac_f32_16x16x64_bf16 v[40:43], v[4:7], v[104:111], v116
    ds_read_b128 v[88:91], v117 offset:24576
    s_waitcnt lgkmcnt(3)
    v_smfmac_f32_16x16x64_bf16 v[32:35], v[12:15], a[16:23], v116
    ds_read_b128 v[92:95], v117 offset:25600
    s_waitcnt lgkmcnt(3)
    v_smfmac_f32_16x16x64_bf16 v[32:35], v[24:27], a[48:55], v116
    buffer_load_dwordx4 v117, s[8:11], s30 offen lds
    s_waitcnt lgkmcnt(2)
    v_smfmac_f32_16x16x64_bf16 v[32:35], v[28:31], a[80:87], v116
    ds_read_b128 v[96:99], v117 offset:23552
    v_smfmac_f32_16x16x64_bf16 v[36:39], v[12:15], a[24:31], v116
    ds_read_b128 v[100:103], v117 offset:23552
    v_smfmac_f32_16x16x64_bf16 v[36:39], v[24:27], a[56:63], v116
    buffer_load_dwordx4 v117, s[8:11], s30 offen offset:1024 lds
    s_add_u32 m0, s52, 0x6000
    v_add_f32 v32, v32, v34
    v_smfmac_f32_16x16x64_bf16 v[36:39], v[28:31], a[88:95], v116
    ds_read_b128 v[104:107], v117 offset:23552
    v_add_f32 v33, v33, v35
    v_smfmac_f32_16x16x64_bf16 v[40:43], v[12:15], a[112:119], v116
    ds_read_b128 v[108:111], v117 offset:23552
    v_mul_f32 v32, s34, v32
    v_smfmac_f32_16x16x64_bf16 v[40:43], v[24:27], a[144:151], v116
    buffer_load_dword v125, v119, s[8:11], s28 offen sc1
    v_mul_f32 v33, s34, v33
    v_smfmac_f32_16x16x64_bf16 v[40:43], v[28:31], a[176:183], v116
    ds_read_b128 v[0:3], v124
    v_add_f32 v36, v36, v38
    v_smfmac_f32_16x16x64_bf16 v[48:51], v[4:7], a[208:215], v116
    v_add_f32 v37, v37, v39
    v_smfmac_f32_16x16x64_bf16 v[52:55], v[4:7], a[216:223], v116
    s_waitcnt lgkmcnt(5)
    buffer_load_dwordx4 v117, s[8:11], s31 offen lds
    v_mul_f32 v36, s34, v36
    v_smfmac_f32_16x16x64_bf16 v[44:47], v[12:15], a[120:127], v116
    ds_read_b128 v[4:7], v124 offset:1024
    v_mul_f32 v37, s34, v37
    v_smfmac_f32_16x16x64_bf16 v[44:47], v[24:27], a[152:159], v116
    v_cvt_pk_bf16_f32 v34, v32, v36
    v_smfmac_f32_16x16x64_bf16 v[44:47], v[28:31], a[184:191], v116
    buffer_load_dwordx4 v117, s[8:11], s31 offen offset:1024 lds
    s_mov_b32 m0, 4096
    v_cvt_pk_bf16_f32 v35, v33, v37
    v_add_f32 v40, v40, v42
    v_smfmac_f32_16x16x64_bf16 v[48:51], v[8:11], a[224:231], v116
    ds_write2_b32 v120, v34, v35 offset0:32 offset1:48
    v_add_f32 v41, v41, v43
    v_smfmac_f32_16x16x64_bf16 v[52:55], v[8:11], a[232:239], v116
    v_add_f32 v44, v44, v46
    v_add_f32 v45, v45, v47
    v_cvt_pk_bf16_f32 v113, v40, v44
    v_cvt_pk_bf16_f32 v115, v41, v45
    v_smfmac_f32_16x16x64_bf16 v[48:51], v[12:15], a[240:247], v116
    ds_write2_b32 v120, v113, v115 offset0:0 offset1:16
    v_smfmac_f32_16x16x64_bf16 v[52:55], v[12:15], a[248:255], v116
    s_cmp_eq_u32 s22, 63
    s_cbranch_scc1 L_chain_last_f
    buffer_store_dword v126, off, s[8:11], s44 sc1
    v_smfmac_f32_16x16x64_bf16 v[48:51], v[16:19], v[128:135], v116
    v_smfmac_f32_16x16x64_bf16 v[48:51], v[20:23], v[160:167], v116
    v_smfmac_f32_16x16x64_bf16 v[48:51], v[24:27], v[144:151], v116
    s_waitcnt lgkmcnt(0)
    s_barrier
    v_smfmac_f32_16x16x64_bf16 v[48:51], v[28:31], v[176:183], v116
    ds_read_b128 v[32:35], v121 offset:16384
    ds_read_b128 v[36:39], v121 offset:17408
    v_smfmac_f32_16x16x64_bf16 v[52:55], v[16:19], v[136:143], v116
    ds_read_b128 v[40:43], v121 offset:18432
    ds_read_b128 v[44:47], v121 offset:19456
    v_smfmac_f32_16x16x64_bf16 v[52:55], v[20:23], v[168:175], v116
    ds_read_b128 v[8:11], v124 offset:32768
    v_add_f32 v48, v48, v50
    v_smfmac_f32_16x16x64_bf16 v[52:55], v[24:27], v[152:159], v116
    ds_read_b128 v[12:15], v124 offset:33792
    v_add_f32 v49, v49, v51
    v_smfmac_f32_16x16x64_bf16 v[52:55], v[28:31], v[184:191], v116
    s_waitcnt lgkmcnt(5)
    v_cvt_pk_bf16_f32 v112, v48, v49
    v_mfma_f32_16x16x32_bf16 v[56:59], v[56:59], v[32:35], 0
    s_waitcnt lgkmcnt(4)
    v_mov_b32 v48, s50
    v_mov_b32 v49, s50
    v_mfma_f32_16x16x32_bf16 v[56:59], v[60:63], v[36:39], v[56:59]
    ds_read_b128 v[16:19], v124 offset:2048
    s_waitcnt lgkmcnt(4)
    v_mov_b32 v50, s50
    v_mov_b32 v51, s50
    v_mfma_f32_16x16x32_bf16 v[56:59], v[64:67], v[40:43], v[56:59]
    ds_read_b128 v[20:23], v124 offset:3072
    s_waitcnt lgkmcnt(4)
    v_add_f32 v52, v52, v54
    v_mfma_f32_16x16x32_bf16 v[56:59], v[68:71], v[44:47], v[56:59]
    ds_read_b128 v[24:27], v124 offset:4096
    v_add_f32 v53, v53, v55
    v_mfma_f32_16x16x32_bf16 v[60:63], v[72:75], v[32:35], 0
    ds_read_b128 v[28:31], v124 offset:5120
    v_cvt_pk_bf16_f32 v114, v52, v53
    v_mov_b32 v53, 0
    v_mfma_f32_16x16x32_bf16 v[60:63], v[76:79], v[36:39], v[60:63]
    v_exp_f32 v56, v56
    v_mfma_f32_16x16x32_bf16 v[60:63], v[80:83], v[40:43], v[60:63]
    v_exp_f32 v57, v57
    v_mfma_f32_16x16x32_bf16 v[60:63], v[84:87], v[44:47], v[60:63]
    v_exp_f32 v58, v58
    v_mfma_f32_16x16x32_bf16 v[64:67], v[32:35], v[32:35], 0
    v_exp_f32 v59, v59
    v_cvt_pk_bf16_f32 v68, v56, v57
    v_mfma_f32_16x16x32_bf16 v[64:67], v[36:39], v[36:39], v[64:67]
    v_exp_f32 v60, v60
    v_cvt_pk_bf16_f32 v69, v58, v59
    v_mfma_f32_16x16x32_bf16 v[64:67], v[40:43], v[40:43], v[64:67]
    v_exp_f32 v61, v61
    v_mfma_f32_16x16x32_bf16 v[64:67], v[44:47], v[44:47], v[64:67]
    v_exp_f32 v62, v62
    v_exp_f32 v63, v63
    v_cvt_pk_bf16_f32 v70, v60, v61
    v_cvt_pk_bf16_f32 v71, v62, v63
    s_nop 1
    v_mfma_f32_16x16x32_bf16 v[72:75], v[88:91], v[68:71], 0
    s_nop 0
    v_exp_f32 v64, v64
    v_mfma_f32_16x16x32_bf16 v[76:79], v[92:95], v[68:71], 0
    v_exp_f32 v65, v65
    v_mfma_f32_16x16x32_bf16 v[80:83], v[48:51], v[68:71], 0
    v_cvt_pk_bf16_f32 v52, v64, v65
    s_nop 1
    v_mfma_f32_16x16x16_bf16 v[72:75], v[112:113], v[52:53], v[72:75]
    ds_read_b128 v[32:35], v124 offset:6144
    v_mfma_f32_16x16x16_bf16 v[76:79], v[114:115], v[52:53], v[76:79]
    ds_read_b128 v[36:39], v124 offset:7168
    v_mfma_f32_16x16x16_bf16 v[80:83], v[48:49], v[52:53], v[80:83]
L_norm_20:
    s_mov_b64 vcc, s[36:37]
    v_mov_b32 v122, v122
    v_mov_b32 v122, v122
    v_mov_b32 v122, v122
    v_cndmask_b32_dpp v76, v72, v76, vcc quad_perm:[2,3,2,3] row_mask:0xf bank_mask:0xf
    v_cndmask_b32_dpp v77, v73, v77, vcc quad_perm:[2,3,2,3] row_mask:0xf bank_mask:0xf
    v_cndmask_b32_dpp v78, v74, v78, vcc quad_perm:[2,3,2,3] row_mask:0xf bank_mask:0xf
    v_cndmask_b32_dpp v79, v75, v79, vcc quad_perm:[2,3,2,3] row_mask:0xf bank_mask:0xf
    v_rcp_f32_dpp v84, v80 quad_perm:[2,3,2,3] row_mask:0xf bank_mask:0xf
    s_nop 0
    v_pk_mul_f32 v[76:77], v[76:77], v[84:85] op_sel_hi:[1,0]
    v_pk_mul_f32 v[78:79], v[78:79], v[84:85] op_sel_hi:[1,0]
    v_cvt_pk_bf16_f32 v72, v76, v77
    v_cvt_pk_bf16_f32 v73, v78, v79
    ds_write_b64 v122, v[72:73] offset:20480
    v_max_f32_dpp v86, v80, v84 quad_perm:[2,3,2,3] row_mask:0xf bank_mask:0xf
    v_mov_b32_dpp v60, v72 quad_perm:[0,1,0,1] row_mask:0xf bank_mask:0xf
    v_mov_b32_dpp v61, v73 quad_perm:[0,1,0,1] row_mask:0xf bank_mask:0xf
    v_cmp_lt_f32 vcc, s35, v86
    v_mov_b32_dpp v62, v72 quad_perm:[2,3,2,3] row_mask:0xf bank_mask:0xf
    v_mov_b32_dpp v63, v73 quad_perm:[2,3,2,3] row_mask:0xf bank_mask:0xf
    s_nop 1
    v_smfmac_f32_16x16x64_bf16 v[96:99], v[60:63], v[192:199], v116
    s_cbranch_vccnz L_smax_21
    v_smfmac_f32_16x16x64_bf16 v[100:103], v[60:63], v[224:231], v116
    s_waitcnt lgkmcnt(0)
    s_barrier
    ds_read_b128 v[92:95], v127 offset:20992
    ds_read_b128 v[80:83], v127 offset:21504
    ds_read_b128 v[84:87], v127 offset:22016
    v_smfmac_f32_16x16x64_bf16 v[104:107], v[60:63], v[0:7], v116
    ds_read_b128 v[40:43], v124 offset:34816
    v_smfmac_f32_16x16x64_bf16 v[108:111], v[60:63], v[8:15], v116
    ds_read_b128 v[56:59], v124 offset:36864
    s_waitcnt lgkmcnt(4)
    v_smfmac_f32_16x16x64_bf16 v[96:99], v[92:95], v[200:207], v116
    s_waitcnt lgkmcnt(3)
    v_smfmac_f32_16x16x64_bf16 v[96:99], v[80:83], v[208:215], v116
    ds_read_b128 v[44:47], v124 offset:35840
    s_waitcnt lgkmcnt(3)
    v_smfmac_f32_16x16x64_bf16 v[96:99], v[84:87], v[216:223], v116
    ds_read_b128 v[68:71], v124 offset:39936
    v_smfmac_f32_16x16x64_bf16 v[100:103], v[92:95], v[232:239], v116
    ds_read_b128 v[64:67], v124 offset:38912
    v_smfmac_f32_16x16x64_bf16 v[100:103], v[80:83], v[240:247], v116
    ds_read_b128 v[60:63], v124 offset:37888
    v_cvt_pk_bf16_f32 v72, v96, v98
    v_smfmac_f32_16x16x64_bf16 v[100:103], v[84:87], v[248:255], v116
    v_and_or_b32 v72, v72, -2, s33
    v_smfmac_f32_16x16x64_bf16 v[104:107], v[92:95], v[16:23], v116
    v_cvt_pk_bf16_f32 v74, v97, v99
    v_smfmac_f32_16x16x64_bf16 v[104:107], v[80:83], v[24:31], v116
    v_cvt_pk_bf16_f32 v73, v100, v102
    v_cvt_pk_bf16_f32 v75, v101, v103
    v_smfmac_f32_16x16x64_bf16 v[104:107], v[84:87], v[32:39], v116
    buffer_store_dwordx4 v[72:75], v118, s[8:11], s25 offen
    s_waitcnt lgkmcnt(3)
    v_smfmac_f32_16x16x64_bf16 v[108:111], v[92:95], v[40:47], v116
    s_waitcnt lgkmcnt(0)
    v_smfmac_f32_16x16x64_bf16 v[108:111], v[80:83], v[56:63], v116
    v_cvt_pk_bf16_f32 v76, v104, v106
    v_smfmac_f32_16x16x64_bf16 v[108:111], v[84:87], v[64:71], v116
    v_and_or_b32 v76, v76, -2, s33
    v_cvt_pk_bf16_f32 v78, v105, v107
    v_mov_b32 v122, v122
    v_mov_b32 v122, v122
    v_mov_b32 v122, v122
    v_mov_b32 v122, v122
    v_mov_b32 v122, v122
    v_mov_b32 v122, v122
    v_cvt_pk_bf16_f32 v77, v108, v110
    v_cvt_pk_bf16_f32 v79, v109, v111
    buffer_store_dwordx4 v[76:79], v118, s[8:11], s26 offen
    s_add_u32 s30, s30, 0x40000
    s_add_u32 s31, s31, 0x40000
    s_add_u32 s32, s32, 0x20000
    s_add_u32 s23, s24, 0
    s_add_u32 s48, s23, 4096
    s_xor_b32 s25, s25, 0x0
    s_xor_b32 s26, s26, 0x0
    s_mov_b32 s35, 0x49800000
    v_mov_b32 v126, s22
    s_add_u32 s22, s22, 1
    v_mov_b32 v32, 0
    v_mov_b32 v33, 0
    v_mov_b32 v34, 0
    v_mov_b32 v35, 0
    v_mov_b32 v36, 0
    v_mov_b32 v37, 0
    v_mov_b32 v38, 0
    v_mov_b32 v39, 0
    v_mov_b32 v40, 0
    v_mov_b32 v41, 0
    v_mov_b32 v42, 0
    v_mov_b32 v43, 0
    v_mov_b32 v44, 0
    v_mov_b32 v45, 0
    v_mov_b32 v46, 0
    v_mov_b32 v47, 0
    v_mov_b32 v48, 0
    v_mov_b32 v49, 0
    v_mov_b32 v50, 0
    v_mov_b32 v51, 0
    v_mov_b32 v52, 0
    v_mov_b32 v53, 0
    v_mov_b32 v54, 0
    v_mov_b32 v55, 0
    ds_read_b128 v[80:83], v123
    ds_read_b128 v[84:87], v123 offset:1024
    ds_read_b128 v[56:59], v123 offset:2048
    ds_read_b128 v[60:63], v123 offset:3072
    ds_read_b128 v[64:67], v123 offset:32768
    ds_read_b128 v[68:71], v123 offset:33792
    ds_read_b128 v[72:75], v123 offset:34816
    ds_read_b128 v[76:79], v123 offset:35840
    ds_read_b128 v[88:91], v123 offset:4096
    ds_read_b128 v[92:95], v123 offset:5120
    ds_read_b128 v[96:99], v123 offset:6144
    ds_read_b128 v[100:103], v123 offset:7168
    ds_read_b128 v[104:107], v123 offset:36864
    ds_read_b128 v[108:111], v123 offset:37888
    ds_read_b128 v[24:27], v123 offset:38912
    ds_read_b128 v[28:31], v123 offset:39936
    s_add_u32 s24, s24, 8192
    s_bitset0_b32 s24, 15
    s_xor_b32 s55, s24, 16384
    s_xor_b32 s29, s29, 0x0
    s_xor_b32 s53, s29, 1024
    s_bfe_u32 s33, s22, 0x10000
    s_add_u32 s40, s22, 5
    s_lshr_b32 s40, s40, 2
    s_min_u32 s40, s40, 16
    s_bfm_b32 s58, s40, 0
    s_waitcnt vmcnt(5)
    v_cmp_eq_u32 vcc, 0, v125
    s_nop 0
    s_and_b64 vcc, vcc, s[58:59]
    s_cbranch_scc1 L_kvw_22
L_kvb_23:
    v_mov_b32 v15, 0
    s_nop 2
    v_mov_b32 v15, 0
    s_nop 2
    v_mov_b32 v15, 0
    s_nop 2
    v_mov_b32 v15, 0
    s_nop 2
    v_mov_b32 v15, 0
    s_nop 2
    v_mov_b32 v15, 0
    s_nop 2
    v_mov_b32 v15, 0
    s_nop 2
    v_mov_b32 v15, 0
    s_nop 2
    v_mov_b32 v15, 0
    s_nop 2
    v_mov_b32 v15, 0
    s_nop 2
    v_mov_b32 v15, 0
    s_nop 2
    v_mov_b32 v15, 0
    s_nop 2
    v_mov_b32 v15, 0
    s_nop 2
    v_mov_b32 v15, 0
    s_nop 2
    v_mov_b32 v15, 0
    s_nop 2
    v_mov_b32 v15, 0
    s_nop 2
    v_mov_b32 v15, 0
    s_nop 2
    v_mov_b32 v15, 0
    s_nop 2
    v_mov_b32 v15, 0
    s_nop 2
    v_mov_b32 v15, 0
    s_nop 2
    v_mov_b32 v15, 0
    s_nop 2
    v_mov_b32 v15, 0
    s_nop 2
    v_mov_b32 v15, 0
    s_nop 2
    v_mov_b32 v15, 0
    s_nop 2
    v_mov_b32 v15, 0
    s_nop 2
    v_mov_b32 v15, 0
    s_nop 2
    v_mov_b32 v15, 0
    s_nop 2
    v_mov_b32 v15, 0
    s_nop 2
    v_mov_b32 v15, 0
    s_nop 2
    v_mov_b32 v15, 0
    s_nop 2
    v_mov_b32 v15, 0
    s_nop 2
    s_waitcnt lgkmcnt(0)
    s_branch L_chain_top0_f
.p2align 6
L_chain_top1_f:
    buffer_load_dwordx4 v[0:3], v117, s[8:11], s23 offen nt
    v_mov_b32 v15, 0
    v_mov_b32 v15, 0
    v_mov_b32 v15, 0
    v_mov_b32 v15, 0
    v_mov_b32 v15, 0
    v_mov_b32 v15, 0
    v_mov_b32 v15, 0
    v_mov_b32 v15, 0
    v_mov_b32 v15, 0
    v_mov_b32 v15, 0
    v_mov_b32 v15, 0
    v_mov_b32 v15, 0
    v_mov_b32 v15, 0
    v_mov_b32 v15, 0
    v_mov_b32 v15, 0
    v_mov_b32 v15, 0
    buffer_load_dwordx4 v[0:3], v117, s[8:11], s23 offen sc1
    v_mov_b32 v15, 0
    v_mov_b32 v15, 0
    v_mov_b32 v15, 0
    v_mov_b32 v15, 0
    v_mov_b32 v15, 0
    v_mov_b32 v15, 0
    v_mov_b32 v15, 0
    v_mov_b32 v15, 0
    v_mov_b32 v15, 0
    v_mov_b32 v15, 0
    v_mov_b32 v15, 0
    v_mov_b32 v15, 0
    v_mov_b32 v15, 0
    v_mov_b32 v15, 0
    v_mov_b32 v15, 0
    v_mov_b32 v15, 0
L_mret_24:
    buffer_load_dwordx4 v[0:3], v117, s[8:11], s23 offen sc1
    s_add_u32 s45, s45, 1
    s_cmp_lt_u32 s45, 0x10000
    s_cselect_b32 s56, -2, -1
    s_nop 3
    v_mov_b32 v32, 0
    v_mov_b32 v33, 0
    v_mov_b32 v34, 0
    v_mov_b32 v35, 0
    s_waitcnt vmcnt(2)
    v_max3_u32 v15, v0, v1, v2
    v_max_u32 v15, v15, v3
    v_cmp_lt_u32 vcc, s56, v15
    v_smfmac_f32_16x16x64_bf16 v[32:35], v[0:3], v[80:87], v116
    s_cbranch_vccnz L_mret_24
    ds_write_b128 v117, v[0:3] offset:1024
    v_smfmac_f32_16x16x64_bf16 v[36:39], v[0:3], v[56:63], v116
    buffer_load_dwordx4 v[4:7], v117, s[8:11], s48 offen nt
    v_smfmac_f32_16x16x64_bf16 v[40:43], v[0:3], v[64:71], v116
    buffer_load_dwordx4 v117, s[8:11], s48 offen nt lds
    s_mov_b32 m0, 10240
    v_smfmac_f32_16x16x64_bf16 v[44:47], v[0:3], v[72:79], v116
    s_waitcnt lgkmcnt(0)
    s_barrier
    ds_read_b128 v[8:11], v117
    v_smfmac_f32_16x16x64_bf16 v[48:51], v[0:3], a[192:199], v116
    ds_read_b128 v[16:19], v117 offset:3072
    ds_read_b128 v[20:23], v117 offset:2048
    v_smfmac_f32_16x16x64_bf16 v[52:55], v[0:3], a[200:207], v116
    ds_read_b128 v[80:83], v117 offset:14336
    s_waitcnt lgkmcnt(3)
    v_smfmac_f32_16x16x64_bf16 v[32:35], v[8:11], a[0:7], v116
    ds_read_b128 v[84:87], v117 offset:15360
    v_smfmac_f32_16x16x64_bf16 v[36:39], v[8:11], a[8:15], v116
    ds_read_b128 v[56:59], v117 offset:8192
    s_waitcnt lgkmcnt(4)
    v_smfmac_f32_16x16x64_bf16 v[32:35], v[16:19], a[32:39], v116
    ds_read_b128 v[60:63], v117 offset:9216
    v_smfmac_f32_16x16x64_bf16 v[36:39], v[16:19], a[40:47], v116
    buffer_store_dwordx4 v[112:115], v117, s[8:11], s32 offen sc1
    s_waitcnt lgkmcnt(4)
    v_smfmac_f32_16x16x64_bf16 v[32:35], v[20:23], a[64:71], v116
    ds_read_b128 v[64:67], v117 offset:10240
    v_smfmac_f32_16x16x64_bf16 v[36:39], v[20:23], a[72:79], v116
    ds_read_b128 v[68:71], v117 offset:11264
    v_smfmac_f32_16x16x64_bf16 v[40:43], v[8:11], a[96:103], v116
    ds_read_b128 v[72:75], v117 offset:12288
    v_smfmac_f32_16x16x64_bf16 v[40:43], v[16:19], a[128:135], v116
    ds_read_b128 v[76:79], v117 offset:13312
    v_smfmac_f32_16x16x64_bf16 v[40:43], v[20:23], a[160:167], v116
    s_waitcnt vmcnt(2)
    v_max3_u32 v15, v4, v5, v6
    v_smfmac_f32_16x16x64_bf16 v[44:47], v[8:11], a[104:111], v116
    v_max_u32 v15, v15, v7
    v_smfmac_f32_16x16x64_bf16 v[44:47], v[16:19], a[136:143], v116
    s_waitcnt vmcnt(1) lgkmcnt(0)
    v_cmp_lt_u32 vcc, s56, v15
    v_smfmac_f32_16x16x64_bf16 v[44:47], v[20:23], a[168:175], v116
    s_cbranch_vccnz L_mret_25
L_mgo_26:
    v_smfmac_f32_16x16x64_bf16 v[44:47], v[4:7], v[24:31], v116
    s_barrier
    ds_read_b128 v[12:15], v117 offset:4096
    v_smfmac_f32_16x16x64_bf16 v[32:35], v[4:7], v[88:95], v116
    ds_read_b128 v[24:27], v117 offset:7168
    v_smfmac_f32_16x16x64_bf16 v[36:39], v[4:7], v[96:103], v116
    ds_read_b128 v[28:31], v117 offset:6144
    v_smfmac_f32_16x16x64_bf16 v[40:43], v[4:7], v[104:111], v116
    ds_read_b128 v[88:91], v117 offset:26624
    s_waitcnt lgkmcnt(3)
    v_smfmac_f32_16x16x64_bf16 v[32:35], v[12:15], a[16:23], v116
    ds_read_b128 v[92:95], v117 offset:27648
    s_waitcnt lgkmcnt(3)
    v_smfmac_f32_16x16x64_bf16 v[32:35], v[24:27], a[48:55], v116
    buffer_load_dwordx4 v117, s[8:11], s30 offen lds
    s_waitcnt lgkmcnt(2)
    v_smfmac_f32_16x16x64_bf16 v[32:35], v[28:31], a[80:87], v116
    ds_read_b128 v[96:99], v117 offset:23552
    v_smfmac_f32_16x16x64_bf16 v[36:39], v[12:15], a[24:31], v116
    ds_read_b128 v[100:103], v117 offset:23552
    v_smfmac_f32_16x16x64_bf16 v[36:39], v[24:27], a[56:63], v116
    buffer_load_dwordx4 v117, s[8:11], s30 offen offset:1024 lds
    s_add_u32 m0, s52, 0x6000
    v_add_f32 v32, v32, v34
    v_smfmac_f32_16x16x64_bf16 v[36:39], v[28:31], a[88:95], v116
    ds_read_b128 v[104:107], v117 offset:23552
    v_add_f32 v33, v33, v35
    v_smfmac_f32_16x16x64_bf16 v[40:43], v[12:15], a[112:119], v116
    ds_read_b128 v[108:111], v117 offset:23552
    v_mul_f32 v32, s34, v32
    v_smfmac_f32_16x16x64_bf16 v[40:43], v[24:27], a[144:151], v116
    buffer_load_dword v125, v119, s[8:11], s28 offen sc1
    v_mul_f32 v33, s34, v33
    v_smfmac_f32_16x16x64_bf16 v[40:43], v[28:31], a[176:183], v116
    ds_read_b128 v[0:3], v124
    v_add_f32 v36, v36, v38
    v_smfmac_f32_16x16x64_bf16 v[48:51], v[4:7], a[208:215], v116
    v_add_f32 v37, v37, v39
    v_smfmac_f32_16x16x64_bf16 v[52:55], v[4:7], a[216:223], v116
    s_waitcnt lgkmcnt(5)
    buffer_load_dwordx4 v117, s[8:11], s31 offen lds
    v_mul_f32 v36, s34, v36
    v_smfmac_f32_16x16x64_bf16 v[44:47], v[12:15], a[120:127], v116
    ds_read_b128 v[4:7], v124 offset:1024
    v_mul_f32 v37, s34, v37
    v_smfmac_f32_16x16x64_bf16 v[44:47], v[24:27], a[152:159], v116
    v_cvt_pk_bf16_f32 v34, v32, v36
    v_smfmac_f32_16x16x64_bf16 v[44:47], v[28:31], a[184:191], v116
    buffer_load_dwordx4 v117, s[8:11], s31 offen offset:1024 lds
    s_mov_b32 m0, 5120
    v_cvt_pk_bf16_f32 v35, v33, v37
    v_add_f32 v40, v40, v42
    v_smfmac_f32_16x16x64_bf16 v[48:51], v[8:11], a[224:231], v116
    ds_write2_b32 v120, v34, v35 offset0:32 offset1:48
    v_add_f32 v41, v41, v43
    v_smfmac_f32_16x16x64_bf16 v[52:55], v[8:11], a[232:239], v116
    v_add_f32 v44, v44, v46
    v_add_f32 v45, v45, v47
    v_cvt_pk_bf16_f32 v113, v40, v44
    v_cvt_pk_bf16_f32 v115, v41, v45
    v_smfmac_f32_16x16x64_bf16 v[48:51], v[12:15], a[240:247], v116
    ds_write2_b32 v120, v113, v115 offset0:0 offset1:16
    v_smfmac_f32_16x16x64_bf16 v[52:55], v[12:15], a[248:255], v116
    s_cmp_eq_u32 s22, 63
    s_cbranch_scc1 L_chain_last_f
    v_smfmac_f32_16x16x64_bf16 v[48:51], v[16:19], v[128:135], v116
    v_smfmac_f32_16x16x64_bf16 v[48:51], v[20:23], v[160:167], v116
    v_smfmac_f32_16x16x64_bf16 v[48:51], v[24:27], v[144:151], v116
    s_waitcnt lgkmcnt(0)
    s_barrier
    v_smfmac_f32_16x16x64_bf16 v[48:51], v[28:31], v[176:183], v116
    ds_read_b128 v[32:35], v121 offset:16384
    ds_read_b128 v[36:39], v121 offset:17408
    v_smfmac_f32_16x16x64_bf16 v[52:55], v[16:19], v[136:143], v116
    ds_read_b128 v[40:43], v121 offset:18432
    ds_read_b128 v[44:47], v121 offset:19456
    v_smfmac_f32_16x16x64_bf16 v[52:55], v[20:23], v[168:175], v116
    ds_read_b128 v[8:11], v124 offset:32768
    v_add_f32 v48, v48, v50
    v_smfmac_f32_16x16x64_bf16 v[52:55], v[24:27], v[152:159], v116
    ds_read_b128 v[12:15], v124 offset:33792
    v_add_f32 v49, v49, v51
    v_smfmac_f32_16x16x64_bf16 v[52:55], v[28:31], v[184:191], v116
    s_waitcnt lgkmcnt(5)
    v_cvt_pk_bf16_f32 v112, v48, v49
    v_mfma_f32_16x16x32_bf16 v[56:59], v[56:59], v[32:35], 0
    s_waitcnt lgkmcnt(4)
    v_mov_b32 v48, s50
    v_mov_b32 v49, s50
    v_mfma_f32_16x16x32_bf16 v[56:59], v[60:63], v[36:39], v[56:59]
    ds_read_b128 v[16:19], v124 offset:2048
    s_waitcnt lgkmcnt(4)
    v_mov_b32 v50, s50
    v_mov_b32 v51, s50
    v_mfma_f32_16x16x32_bf16 v[56:59], v[64:67], v[40:43], v[56:59]
    ds_read_b128 v[20:23], v124 offset:3072
    s_waitcnt lgkmcnt(4)
    v_add_f32 v52, v52, v54
    v_mfma_f32_16x16x32_bf16 v[56:59], v[68:71], v[44:47], v[56:59]
    ds_read_b128 v[24:27], v124 offset:4096
    v_add_f32 v53, v53, v55
    v_mfma_f32_16x16x32_bf16 v[60:63], v[72:75], v[32:35], 0
    ds_read_b128 v[28:31], v124 offset:5120
    v_cvt_pk_bf16_f32 v114, v52, v53
    v_mov_b32 v53, 0
    v_mfma_f32_16x16x32_bf16 v[60:63], v[76:79], v[36:39], v[60:63]
    v_exp_f32 v56, v56
    v_mfma_f32_16x16x32_bf16 v[60:63], v[80:83], v[40:43], v[60:63]
    v_exp_f32 v57, v57
    v_mfma_f32_16x16x32_bf16 v[60:63], v[84:87], v[44:47], v[60:63]
    v_exp_f32 v58, v58
    v_mfma_f32_16x16x32_bf16 v[64:67], v[32:35], v[32:35], 0
    v_exp_f32 v59, v59
    v_cvt_pk_bf16_f32 v68, v56, v57
    v_mfma_f32_16x16x32_bf16 v[64:67], v[36:39], v[36:39], v[64:67]
    v_exp_f32 v60, v60
    v_cvt_pk_bf16_f32 v69, v58, v59
    v_mfma_f32_16x16x32_bf16 v[64:67], v[40:43], v[40:43], v[64:67]
    v_exp_f32 v61, v61
    v_mfma_f32_16x16x32_bf16 v[64:67], v[44:47], v[44:47], v[64:67]
    v_exp_f32 v62, v62
    v_exp_f32 v63, v63
    v_cvt_pk_bf16_f32 v70, v60, v61
    v_cvt_pk_bf16_f32 v71, v62, v63
    s_nop 1
    v_mfma_f32_16x16x32_bf16 v[72:75], v[88:91], v[68:71], 0
    s_nop 0
    v_exp_f32 v64, v64
    v_mfma_f32_16x16x32_bf16 v[76:79], v[92:95], v[68:71], 0
    v_exp_f32 v65, v65
    v_mfma_f32_16x16x32_bf16 v[80:83], v[48:51], v[68:71], 0
    v_cvt_pk_bf16_f32 v52, v64, v65
    s_nop 1
    v_mfma_f32_16x16x16_bf16 v[72:75], v[112:113], v[52:53], v[72:75]
    ds_read_b128 v[32:35], v124 offset:6144
    v_mfma_f32_16x16x16_bf16 v[76:79], v[114:115], v[52:53], v[76:79]
    ds_read_b128 v[36:39], v124 offset:7168
    v_mfma_f32_16x16x16_bf16 v[80:83], v[48:49], v[52:53], v[80:83]
L_norm_27:
    s_mov_b64 vcc, s[36:37]
    v_mov_b32 v122, v122
    v_mov_b32 v122, v122
    v_mov_b32 v122, v122
    v_cndmask_b32_dpp v76, v72, v76, vcc quad_perm:[2,3,2,3] row_mask:0xf bank_mask:0xf
    v_cndmask_b32_dpp v77, v73, v77, vcc quad_perm:[2,3,2,3] row_mask:0xf bank_mask:0xf
    v_cndmask_b32_dpp v78, v74, v78, vcc quad_perm:[2,3,2,3] row_mask:0xf bank_mask:0xf
    v_cndmask_b32_dpp v79, v75, v79, vcc quad_perm:[2,3,2,3] row_mask:0xf bank_mask:0xf
    v_rcp_f32_dpp v84, v80 quad_perm:[2,3,2,3] row_mask:0xf bank_mask:0xf
    s_nop 0
    v_pk_mul_f32 v[76:77], v[76:77], v[84:85] op_sel_hi:[1,0]
    v_pk_mul_f32 v[78:79], v[78:79], v[84:85] op_sel_hi:[1,0]
    v_cvt_pk_bf16_f32 v72, v76, v77
    v_cvt_pk_bf16_f32 v73, v78, v79
    ds_write_b64 v122, v[72:73] offset:20992
    v_max_f32_dpp v86, v80, v84 quad_perm:[2,3,2,3] row_mask:0xf bank_mask:0xf
    v_mov_b32_dpp v60, v72 quad_perm:[0,1,0,1] row_mask:0xf bank_mask:0xf
    v_mov_b32_dpp v61, v73 quad_perm:[0,1,0,1] row_mask:0xf bank_mask:0xf
    v_cmp_lt_f32 vcc, s35, v86
    v_mov_b32_dpp v62, v72 quad_perm:[2,3,2,3] row_mask:0xf bank_mask:0xf
    v_mov_b32_dpp v63, v73 quad_perm:[2,3,2,3] row_mask:0xf bank_mask:0xf
    s_nop 1
    v_smfmac_f32_16x16x64_bf16 v[96:99], v[60:63], v[192:199], v116
    s_cbranch_vccnz L_smax_28
    v_smfmac_f32_16x16x64_bf16 v[100:103], v[60:63], v[224:231], v116
    s_waitcnt lgkmcnt(0)
    s_barrier
    ds_read_b128 v[92:95], v127 offset:20480
    ds_read_b128 v[80:83], v127 offset:22016
    ds_read_b128 v[84:87], v127 offset:21504
    v_smfmac_f32_16x16x64_bf16 v[104:107], v[60:63], v[0:7], v116
    ds_read_b128 v[40:43], v124 offset:34816
    v_smfmac_f32_16x16x64_bf16 v[108:111], v[60:63], v[8:15], v116
    ds_read_b128 v[56:59], v124 offset:36864
    s_waitcnt lgkmcnt(4)
    v_smfmac_f32_16x16x64_bf16 v[96:99], v[92:95], v[200:207], v116
    s_waitcnt lgkmcnt(3)
    v_smfmac_f32_16x16x64_bf16 v[96:99], v[80:83], v[208:215], v116
    ds_read_b128 v[44:47], v124 offset:35840
    s_waitcnt lgkmcnt(3)
    v_smfmac_f32_16x16x64_bf16 v[96:99], v[84:87], v[216:223], v116
    ds_read_b128 v[68:71], v124 offset:39936
    v_smfmac_f32_16x16x64_bf16 v[100:103], v[92:95], v[232:239], v116
    ds_read_b128 v[64:67], v124 offset:38912
    v_smfmac_f32_16x16x64_bf16 v[100:103], v[80:83], v[240:247], v116
    ds_read_b128 v[60:63], v124 offset:37888
    v_cvt_pk_bf16_f32 v72, v96, v98
    v_smfmac_f32_16x16x64_bf16 v[100:103], v[84:87], v[248:255], v116
    v_and_or_b32 v72, v72, -2, s33
    v_smfmac_f32_16x16x64_bf16 v[104:107], v[92:95], v[16:23], v116
    v_cvt_pk_bf16_f32 v74, v97, v99
    v_smfmac_f32_16x16x64_bf16 v[104:107], v[80:83], v[24:31], v116
    v_cvt_pk_bf16_f32 v73, v100, v102
    v_cvt_pk_bf16_f32 v75, v101, v103
    v_smfmac_f32_16x16x64_bf16 v[104:107], v[84:87], v[32:39], v116
    buffer_store_dwordx4 v[72:75], v118, s[8:11], s25 offen
    s_waitcnt lgkmcnt(3)
    v_smfmac_f32_16x16x64_bf16 v[108:111], v[92:95], v[40:47], v116
    s_waitcnt lgkmcnt(0)
    v_smfmac_f32_16x16x64_bf16 v[108:111], v[80:83], v[56:63], v116
    v_cvt_pk_bf16_f32 v76, v104, v106
    v_smfmac_f32_16x16x64_bf16 v[108:111], v[84:87], v[64:71], v116
    v_and_or_b32 v76, v76, -2, s33
    v_cvt_pk_bf16_f32 v78, v105, v107
    v_mov_b32 v122, v122
    v_mov_b32 v122, v122
    v_mov_b32 v122, v122
    v_mov_b32 v122, v122
    v_mov_b32 v122, v122
    v_mov_b32 v122, v122
    v_cvt_pk_bf16_f32 v77, v108, v110
    v_cvt_pk_bf16_f32 v79, v109, v111
    buffer_store_dwordx4 v[76:79], v118, s[8:11], s26 offen
    s_add_u32 s30, s30, 0x40000
    s_add_u32 s31, s31, 0x40000
    s_add_u32 s32, s32, 0x20000
    s_add_u32 s23, s24, 1024
    s_add_u32 s48, s23, 4096
    s_xor_b32 s25, s25, 0x0
    s_xor_b32 s26, s26, 0x0
    s_mov_b32 s35, 0x49800000
    s_add_u32 s22, s22, 1
    v_mov_b32 v32, 0
    v_mov_b32 v33, 0
    v_mov_b32 v34, 0
    v_mov_b32 v35, 0
    v_mov_b32 v36, 0
    v_mov_b32 v37, 0
    v_mov_b32 v38, 0
    v_mov_b32 v39, 0
    v_mov_b32 v40, 0
    v_mov_b32 v41, 0
    v_mov_b32 v42, 0
    v_mov_b32 v43, 0
    v_mov_b32 v44, 0
    v_mov_b32 v45, 0
    v_mov_b32 v46, 0
    v_mov_b32 v47, 0
    v_mov_b32 v48, 0
    v_mov_b32 v49, 0
    v_mov_b32 v50, 0
    v_mov_b32 v51, 0
    v_mov_b32 v52, 0
    v_mov_b32 v53, 0
    v_mov_b32 v54, 0
    v_mov_b32 v55, 0
    ds_read_b128 v[80:83], v123
    ds_read_b128 v[84:87], v123 offset:1024
    ds_read_b128 v[56:59], v123 offset:2048
    ds_read_b128 v[60:63], v123 offset:3072
    ds_read_b128 v[64:67], v123 offset:32768
    ds_read_b128 v[68:71], v123 offset:33792
    ds_read_b128 v[72:75], v123 offset:34816
    ds_read_b128 v[76:79], v123 offset:35840
    ds_read_b128 v[88:91], v123 offset:4096
    ds_read_b128 v[92:95], v123 offset:5120
    ds_read_b128 v[96:99], v123 offset:6144
    ds_read_b128 v[100:103], v123 offset:7168
    ds_read_b128 v[104:107], v123 offset:36864
    ds_read_b128 v[108:111], v123 offset:37888
    ds_read_b128 v[24:27], v123 offset:38912
    ds_read_b128 v[28:31], v123 offset:39936
    s_add_u32 s24, s24, 8192
    s_bitset0_b32 s24, 15
    s_xor_b32 s55, s24, 16384
    s_xor_b32 s29, s29, 0x0
    s_xor_b32 s53, s29, 1024
    s_bfe_u32 s33, s22, 0x10000
    s_add_u32 s40, s22, 5
    s_lshr_b32 s40, s40, 2
    s_min_u32 s40, s40, 16
    s_bfm_b32 s58, s40, 0
    s_waitcnt vmcnt(4)
    v_cmp_eq_u32 vcc, 0, v125
    s_nop 0
    s_and_b64 vcc, vcc, s[58:59]
    s_cbranch_scc1 L_kvw_29
L_kvb_30:
    v_mov_b32 v15, 0
    s_nop 2
    v_mov_b32 v15, 0
    s_nop 2
    v_mov_b32 v15, 0
    s_nop 2
    v_mov_b32 v15, 0
    s_nop 2
    v_mov_b32 v15, 0
    s_nop 2
    v_mov_b32 v15, 0
    s_nop 2
    v_mov_b32 v15, 0
    s_nop 2
    v_mov_b32 v15, 0
    s_nop 2
    v_mov_b32 v15, 0
    s_nop 2
    v_mov_b32 v15, 0
    s_nop 2
    v_mov_b32 v15, 0
    s_nop 2
    v_mov_b32 v15, 0
    s_nop 2
    v_mov_b32 v15, 0
    s_nop 2
    v_mov_b32 v15, 0
    s_nop 2
    v_mov_b32 v15, 0
    s_nop 2
    v_mov_b32 v15, 0
    s_nop 2
    v_mov_b32 v15, 0
    s_nop 2
    v_mov_b32 v15, 0
    s_nop 2
    v_mov_b32 v15, 0
    s_nop 2
    v_mov_b32 v15, 0
    s_nop 2
    v_mov_b32 v15, 0
    s_nop 2
    v_mov_b32 v15, 0
    s_nop 2
    v_mov_b32 v15, 0
    s_nop 2
    v_mov_b32 v15, 0
    s_nop 2
    v_mov_b32 v15, 0
    s_nop 2
    v_mov_b32 v15, 0
    s_nop 2
    v_mov_b32 v15, 0
    s_nop 2
    v_mov_b32 v15, 0
    s_nop 2
    v_mov_b32 v15, 0
    s_nop 2
    v_mov_b32 v15, 0
    s_nop 2
    v_mov_b32 v15, 0
    s_nop 2
    s_waitcnt lgkmcnt(0)
    s_branch L_chain_top1_f
.p2align 6
L_chain_top2_f:
    buffer_load_dwordx4 v[0:3], v117, s[8:11], s23 offen nt
    v_mov_b32 v48, 0
    v_mov_b32 v49, 0
    v_mov_b32 v50, 0
    v_mov_b32 v51, 0
    v_mov_b32 v52, 0
    v_mov_b32 v53, 0
    v_mov_b32 v15, 0
    v_mov_b32 v15, 0
    v_mov_b32 v15, 0
    v_mov_b32 v15, 0
    v_mov_b32 v15, 0
    v_mov_b32 v15, 0
    v_mov_b32 v15, 0
    v_mov_b32 v15, 0
    v_mov_b32 v15, 0
    v_mov_b32 v15, 0
    buffer_load_dwordx4 v[0:3], v117, s[8:11], s23 offen sc1
    s_waitcnt vmcnt(3)
    v_mov_b32 v36, 0
    v_mov_b32 v37, 0
    v_mov_b32 v38, 0
    v_mov_b32 v39, 0
    v_mov_b32 v40, 0
    v_mov_b32 v41, 0
    v_mov_b32 v42, 0
    v_mov_b32 v43, 0
    v_mov_b32 v44, 0
    v_mov_b32 v45, 0
    v_mov_b32 v46, 0
    v_mov_b32 v47, 0
    v_mov_b32 v15, 0
    v_mov_b32 v15, 0
    v_mov_b32 v15, 0
    v_mov_b32 v15, 0
L_mret_31:
    buffer_load_dwordx4 v[0:3], v117, s[8:11], s23 offen sc1
    s_add_u32 s45, s45, 1
    s_cmp_lt_u32 s45, 0x10000
    s_cselect_b32 s56, -2, -1
    s_nop 3
    v_mov_b32 v32, 0
    v_mov_b32 v33, 0
    v_mov_b32 v34, 0
    v_mov_b32 v35, 0
    s_waitcnt vmcnt(2)
    v_max3_u32 v15, v0, v1, v2
    v_max_u32 v15, v15, v3
    v_cmp_lt_u32 vcc, s56, v15
    v_smfmac_f32_16x16x64_bf16 v[32:35], v[0:3], v[80:87], v116
    s_cbranch_vccnz L_mret_31
    ds_write_b128 v117, v[0:3] offset:2048
    v_smfmac_f32_16x16x64_bf16 v[36:39], v[0:3], v[56:63], v116
    buffer_load_dwordx4 v[4:7], v117, s[8:11], s48 offen nt
    v_smfmac_f32_16x16x64_bf16 v[40:43], v[0:3], v[64:71], v116
    buffer_load_dwordx4 v117, s[8:11], s48 offen nt lds
    s_mov_b32 m0, 12288
    v_smfmac_f32_16x16x64_bf16 v[44:47], v[0:3], v[72:79], v116
    s_waitcnt lgkmcnt(0)
    s_barrier
    ds_read_b128 v[8:11], v117 offset:3072
    v_smfmac_f32_16x16x64_bf16 v[48:51], v[0:3], a[192:199], v116
    ds_read_b128 v[16:19], v117
    ds_read_b128 v[20:23], v117 offset:1024
    v_smfmac_f32_16x16x64_bf16 v[52:55], v[0:3], a[200:207], v116
    ds_read_b128 v[80:83], v117 offset:14336
    s_waitcnt lgkmcnt(3)
    v_smfmac_f32_16x16x64_bf16 v[32:35], v[8:11], a[0:7], v116
    ds_read_b128 v[84:87], v117 offset:15360
    v_smfmac_f32_16x16x64_bf16 v[36:39], v[8:11], a[8:15], v116
    ds_read_b128 v[56:59], v117 offset:8192
    s_waitcnt lgkmcnt(4)
    v_smfmac_f32_16x16x64_bf16 v[32:35], v[16:19], a[32:39], v116
    ds_read_b128 v[60:63], v117 offset:9216
    v_smfmac_f32_16x16x64_bf16 v[36:39], v[16:19], a[40:47], v116
    ds_read_b128 v[64:67], v117 offset:10240
    s_waitcnt lgkmcnt(5)
    v_smfmac_f32_16x16x64_bf16 v[32:35], v[20:23], a[64:71], v116
    ds_read_b128 v[68:71], v117 offset:11264
    v_smfmac_f32_16x16x64_bf16 v[36:39], v[20:23], a[72:79], v116
    buffer_store_dwordx4 v[112:115], v117, s[8:11], s32 offen sc1
    v_smfmac_f32_16x16x64_bf16 v[40:43], v[8:11], a[96:103], v116
    ds_read_b128 v[72:75], v117 offset:12288
    v_smfmac_f32_16x16x64_bf16 v[40:43], v[16:19], a[128:135], v116
    ds_read_b128 v[76:79], v117 offset:13312
    v_smfmac_f32_16x16x64_bf16 v[40:43], v[20:23], a[160:167], v116
    s_waitcnt vmcnt(2)
    v_max3_u32 v15, v4, v5, v6
    v_smfmac_f32_16x16x64_bf16 v[44:47], v[8:11], a[104:111], v116
    v_max_u32 v15, v15, v7
    v_smfmac_f32_16x16x64_bf16 v[44:47], v[16:19], a[136:143], v116
    s_waitcnt vmcnt(1) lgkmcnt(0)
    v_cmp_lt_u32 vcc, s56, v15
    v_smfmac_f32_16x16x64_bf16 v[44:47], v[20:23], a[168:175], v116
    s_cbranch_vccnz L_mret_32
L_mgo_33:
    v_smfmac_f32_16x16x64_bf16 v[44:47], v[4:7], v[24:31], v116
    s_barrier
    ds_read_b128 v[12:15], v117 offset:7168
    v_smfmac_f32_16x16x64_bf16 v[32:35], v[4:7], v[88:95], v116
    ds_read_b128 v[24:27], v117 offset:4096
    v_smfmac_f32_16x16x64_bf16 v[36:39], v[4:7], v[96:103], v116
    ds_read_b128 v[28:31], v117 offset:5120
    v_smfmac_f32_16x16x64_bf16 v[40:43], v[4:7], v[104:111], v116
    ds_read_b128 v[88:91], v117 offset:28672
    s_waitcnt lgkmcnt(3)
    v_smfmac_f32_16x16x64_bf16 v[32:35], v[12:15], a[16:23], v116
    ds_read_b128 v[92:95], v117 offset:29696
    s_waitcnt lgkmcnt(3)
    v_smfmac_f32_16x16x64_bf16 v[32:35], v[24:27], a[48:55], v116
    buffer_load_dwordx4 v117, s[8:11], s30 offen lds
    s_waitcnt lgkmcnt(2)
    v_smfmac_f32_16x16x64_bf16 v[32:35], v[28:31], a[80:87], v116
    ds_read_b128 v[96:99], v117 offset:23552
    v_smfmac_f32_16x16x64_bf16 v[36:39], v[12:15], a[24:31], v116
    ds_read_b128 v[100:103], v117 offset:23552
    v_smfmac_f32_16x16x64_bf16 v[36:39], v[24:27], a[56:63], v116
    buffer_load_dwordx4 v117, s[8:11], s30 offen offset:1024 lds
    s_add_u32 m0, s52, 0x6000
    v_add_f32 v32, v32, v34
    v_smfmac_f32_16x16x64_bf16 v[36:39], v[28:31], a[88:95], v116
    ds_read_b128 v[104:107], v117 offset:23552
    v_add_f32 v33, v33, v35
    v_smfmac_f32_16x16x64_bf16 v[40:43], v[12:15], a[112:119], v116
    ds_read_b128 v[108:111], v117 offset:23552
    v_mul_f32 v32, s34, v32
    v_smfmac_f32_16x16x64_bf16 v[40:43], v[24:27], a[144:151], v116
    s_waitcnt lgkmcnt(4)
    buffer_load_dwordx4 v117, s[8:11], s31 offen lds
    v_mul_f32 v33, s34, v33
    v_smfmac_f32_16x16x64_bf16 v[40:43], v[28:31], a[176:183], v116
    ds_read_b128 v[0:3], v124
    v_add_f32 v36, v36, v38
    v_smfmac_f32_16x16x64_bf16 v[48:51], v[4:7], a[208:215], v116
    v_add_f32 v37, v37, v39
    v_smfmac_f32_16x16x64_bf16 v[52:55], v[4:7], a[216:223], v116
    buffer_load_dwordx4 v117, s[8:11], s31 offen offset:1024 lds
    s_mov_b32 m0, 6144
    v_mul_f32 v36, s34, v36
    v_smfmac_f32_16x16x64_bf16 v[44:47], v[12:15], a[120:127], v116
    ds_read_b128 v[4:7], v124 offset:1024
    v_mul_f32 v37, s34, v37
    v_smfmac_f32_16x16x64_bf16 v[44:47], v[24:27], a[152:159], v116
    v_cvt_pk_bf16_f32 v34, v32, v36
    v_smfmac_f32_16x16x64_bf16 v[44:47], v[28:31], a[184:191], v116
    v_cvt_pk_bf16_f32 v35, v33, v37
    v_add_f32 v40, v40, v42
    v_smfmac_f32_16x16x64_bf16 v[48:51], v[8:11], a[224:231], v116
    ds_write2_b32 v120, v34, v35 offset0:32 offset1:48
    v_add_f32 v41, v41, v43
    v_smfmac_f32_16x16x64_bf16 v[52:55], v[8:11], a[232:239], v116
    v_add_f32 v44, v44, v46
    v_add_f32 v45, v45, v47
    v_cvt_pk_bf16_f32 v113, v40, v44
    v_cvt_pk_bf16_f32 v115, v41, v45
    v_smfmac_f32_16x16x64_bf16 v[48:51], v[12:15], a[240:247], v116
    ds_write2_b32 v120, v113, v115 offset0:0 offset1:16
    v_smfmac_f32_16x16x64_bf16 v[52:55], v[12:15], a[248:255], v116
    s_cmp_eq_u32 s22, 63
    s_cbranch_scc1 L_chain_last_f
    v_smfmac_f32_16x16x64_bf16 v[48:51], v[16:19], v[128:135], v116
    buffer_store_dword v126, v119, s[8:11], s55 offen
    v_smfmac_f32_16x16x64_bf16 v[48:51], v[20:23], v[160:167], v116
    v_smfmac_f32_16x16x64_bf16 v[48:51], v[24:27], v[144:151], v116
    s_waitcnt lgkmcnt(0)
    s_barrier
    v_smfmac_f32_16x16x64_bf16 v[48:51], v[28:31], v[176:183], v116
    ds_read_b128 v[32:35], v121 offset:16384
    ds_read_b128 v[36:39], v121 offset:17408
    v_smfmac_f32_16x16x64_bf16 v[52:55], v[16:19], v[136:143], v116
    ds_read_b128 v[40:43], v121 offset:18432
    ds_read_b128 v[44:47], v121 offset:19456
    v_smfmac_f32_16x16x64_bf16 v[52:55], v[20:23], v[168:175], v116
    ds_read_b128 v[8:11], v124 offset:32768
    v_add_f32 v48, v48, v50
    v_smfmac_f32_16x16x64_bf16 v[52:55], v[24:27], v[152:159], v116
    ds_read_b128 v[12:15], v124 offset:33792
    v_add_f32 v49, v49, v51
    v_smfmac_f32_16x16x64_bf16 v[52:55], v[28:31], v[184:191], v116
    s_waitcnt lgkmcnt(5)
    v_cvt_pk_bf16_f32 v112, v48, v49
    v_mfma_f32_16x16x32_bf16 v[56:59], v[56:59], v[32:35], 0
    s_waitcnt lgkmcnt(4)
    v_mov_b32 v48, s50
    v_mov_b32 v49, s50
    v_mfma_f32_16x16x32_bf16 v[56:59], v[60:63], v[36:39], v[56:59]
    ds_read_b128 v[16:19], v124 offset:2048
    s_waitcnt lgkmcnt(4)
    v_mov_b32 v50, s50
    v_mov_b32 v51, s50
    v_mfma_f32_16x16x32_bf16 v[56:59], v[64:67], v[40:43], v[56:59]
    ds_read_b128 v[20:23], v124 offset:3072
    s_waitcnt lgkmcnt(4)
    v_add_f32 v52, v52, v54
    v_mfma_f32_16x16x32_bf16 v[56:59], v[68:71], v[44:47], v[56:59]
    ds_read_b128 v[24:27], v124 offset:4096
    v_add_f32 v53, v53, v55
    v_mfma_f32_16x16x32_bf16 v[60:63], v[72:75], v[32:35], 0
    ds_read_b128 v[28:31], v124 offset:5120
    v_cvt_pk_bf16_f32 v114, v52, v53
    v_mov_b32 v53, 0
    v_mfma_f32_16x16x32_bf16 v[60:63], v[76:79], v[36:39], v[60:63]
    v_exp_f32 v56, v56
    v_mfma_f32_16x16x32_bf16 v[60:63], v[80:83], v[40:43], v[60:63]
    v_exp_f32 v57, v57
    v_mfma_f32_16x16x32_bf16 v[60:63], v[84:87], v[44:47], v[60:63]
    v_exp_f32 v58, v58
    v_mfma_f32_16x16x32_bf16 v[64:67], v[32:35], v[32:35], 0
    v_exp_f32 v59, v59
    v_cvt_pk_bf16_f32 v68, v56, v57
    v_mfma_f32_16x16x32_bf16 v[64:67], v[36:39], v[36:39], v[64:67]
    v_exp_f32 v60, v60
    v_cvt_pk_bf16_f32 v69, v58, v59
    v_mfma_f32_16x16x32_bf16 v[64:67], v[40:43], v[40:43], v[64:67]
    v_exp_f32 v61, v61
    v_mfma_f32_16x16x32_bf16 v[64:67], v[44:47], v[44:47], v[64:67]
    v_exp_f32 v62, v62
    v_exp_f32 v63, v63
    v_cvt_pk_bf16_f32 v70, v60, v61
    v_cvt_pk_bf16_f32 v71, v62, v63
    s_nop 1
    v_mfma_f32_16x16x32_bf16 v[72:75], v[88:91], v[68:71], 0
    s_nop 0
    v_exp_f32 v64, v64
    v_mfma_f32_16x16x32_bf16 v[76:79], v[92:95], v[68:71], 0
    v_exp_f32 v65, v65
    v_mfma_f32_16x16x32_bf16 v[80:83], v[48:51], v[68:71], 0
    v_cvt_pk_bf16_f32 v52, v64, v65
    s_nop 1
    v_mfma_f32_16x16x16_bf16 v[72:75], v[112:113], v[52:53], v[72:75]
    ds_read_b128 v[32:35], v124 offset:6144
    v_mfma_f32_16x16x16_bf16 v[76:79], v[114:115], v[52:53], v[76:79]
    ds_read_b128 v[36:39], v124 offset:7168
    v_mfma_f32_16x16x16_bf16 v[80:83], v[48:49], v[52:53], v[80:83]
L_norm_34:
    s_mov_b64 vcc, s[36:37]
    v_mov_b32 v122, v122
    v_mov_b32 v122, v122
    v_mov_b32 v122, v122
    v_cndmask_b32_dpp v76, v72, v76, vcc quad_perm:[2,3,2,3] row_mask:0xf bank_mask:0xf
    v_cndmask_b32_dpp v77, v73, v77, vcc quad_perm:[2,3,2,3] row_mask:0xf bank_mask:0xf
    v_cndmask_b32_dpp v78, v74, v78, vcc quad_perm:[2,3,2,3] row_mask:0xf bank_mask:0xf
    v_cndmask_b32_dpp v79, v75, v79, vcc quad_perm:[2,3,2,3] row_mask:0xf bank_mask:0xf
    v_rcp_f32_dpp v84, v80 quad_perm:[2,3,2,3] row_mask:0xf bank_mask:0xf
    s_nop 0
    v_pk_mul_f32 v[76:77], v[76:77], v[84:85] op_sel_hi:[1,0]
    v_pk_mul_f32 v[78:79], v[78:79], v[84:85] op_sel_hi:[1,0]
    v_cvt_pk_bf16_f32 v72, v76, v77
    v_cvt_pk_bf16_f32 v73, v78, v79
    ds_write_b64 v122, v[72:73] offset:21504
    v_max_f32_dpp v86, v80, v84 quad_perm:[2,3,2,3] row_mask:0xf bank_mask:0xf
    v_mov_b32_dpp v60, v72 quad_perm:[0,1,0,1] row_mask:0xf bank_mask:0xf
    v_mov_b32_dpp v61, v73 quad_perm:[0,1,0,1] row_mask:0xf bank_mask:0xf
    v_cmp_lt_f32 vcc, s35, v86
    v_mov_b32_dpp v62, v72 quad_perm:[2,3,2,3] row_mask:0xf bank_mask:0xf
    v_mov_b32_dpp v63, v73 quad_perm:[2,3,2,3] row_mask:0xf bank_mask:0xf
    s_nop 1
    v_smfmac_f32_16x16x64_bf16 v[96:99], v[60:63], v[192:199], v116
    s_cbranch_vccnz L_smax_35
    v_smfmac_f32_16x16x64_bf16 v[100:103], v[60:63], v[224:231], v116
    s_waitcnt lgkmcnt(0)
    s_barrier
    ds_read_b128 v[92:95], v127 offset:22016
    ds_read_b128 v[80:83], v127 offset:20480
    ds_read_b128 v[84:87], v127 offset:20992
    v_smfmac_f32_16x16x64_bf16 v[104:107], v[60:63], v[0:7], v116
    ds_read_b128 v[40:43], v124 offset:34816
    v_smfmac_f32_16x16x64_bf16 v[108:111], v[60:63], v[8:15], v116
    ds_read_b128 v[56:59], v124 offset:36864
    s_waitcnt lgkmcnt(4)
    v_smfmac_f32_16x16x64_bf16 v[96:99], v[92:95], v[200:207], v116
    s_waitcnt lgkmcnt(3)
    v_smfmac_f32_16x16x64_bf16 v[96:99], v[80:83], v[208:215], v116
    ds_read_b128 v[44:47], v124 offset:35840
    s_waitcnt lgkmcnt(3)
    v_smfmac_f32_16x16x64_bf16 v[96:99], v[84:87], v[216:223], v116
    ds_read_b128 v[68:71], v124 offset:39936
    v_smfmac_f32_16x16x64_bf16 v[100:103], v[92:95], v[232:239], v116
    ds_read_b128 v[64:67], v124 offset:38912
    v_smfmac_f32_16x16x64_bf16 v[100:103], v[80:83], v[240:247], v116
    ds_read_b128 v[60:63], v124 offset:37888
    v_cvt_pk_bf16_f32 v72, v96, v98
    v_smfmac_f32_16x16x64_bf16 v[100:103], v[84:87], v[248:255], v116
    v_and_or_b32 v72, v72, -2, s33
    v_smfmac_f32_16x16x64_bf16 v[104:107], v[92:95], v[16:23], v116
    v_cvt_pk_bf16_f32 v74, v97, v99
    v_smfmac_f32_16x16x64_bf16 v[104:107], v[80:83], v[24:31], v116
    v_cvt_pk_bf16_f32 v73, v100, v102
    v_cvt_pk_bf16_f32 v75, v101, v103
    v_smfmac_f32_16x16x64_bf16 v[104:107], v[84:87], v[32:39], v116
    buffer_store_dwordx4 v[72:75], v118, s[8:11], s25 offen
    s_waitcnt lgkmcnt(3)
    v_smfmac_f32_16x16x64_bf16 v[108:111], v[92:95], v[40:47], v116
    s_waitcnt lgkmcnt(0)
    v_smfmac_f32_16x16x64_bf16 v[108:111], v[80:83], v[56:63], v116
    v_cvt_pk_bf16_f32 v76, v104, v106
    v_smfmac_f32_16x16x64_bf16 v[108:111], v[84:87], v[64:71], v116
    v_and_or_b32 v76, v76, -2, s33
    v_cvt_pk_bf16_f32 v78, v105, v107
    v_mov_b32 v122, v122
    v_mov_b32 v122, v122
    v_mov_b32 v122, v122
    v_mov_b32 v122, v122
    v_mov_b32 v122, v122
    v_mov_b32 v122, v122
    v_cvt_pk_bf16_f32 v77, v108, v110
    v_cvt_pk_bf16_f32 v79, v109, v111
    buffer_store_dwordx4 v[76:79], v118, s[8:11], s26 offen
    ds_read_b128 v[80:83], v123
    ds_read_b128 v[84:87], v123 offset:1024
    ds_read_b128 v[56:59], v123 offset:2048
    ds_read_b128 v[60:63], v123 offset:3072
    ds_read_b128 v[64:67], v123 offset:32768
    ds_read_b128 v[68:71], v123 offset:33792
    ds_read_b128 v[72:75], v123 offset:34816
    ds_read_b128 v[76:79], v123 offset:35840
    ds_read_b128 v[88:91], v123 offset:4096
    ds_read_b128 v[92:95], v123 offset:5120
    ds_read_b128 v[96:99], v123 offset:6144
    ds_read_b128 v[100:103], v123 offset:7168
    ds_read_b128 v[104:107], v123 offset:36864
    ds_read_b128 v[108:111], v123 offset:37888
    ds_read_b128 v[24:27], v123 offset:38912
    ds_read_b128 v[28:31], v123 offset:39936
    s_add_u32 s30, s30, 0x40000
    s_add_u32 s31, s31, 0x40000
    s_add_u32 s32, s32, 0x20000
    s_add_u32 s23, s24, 2048
    s_add_u32 s48, s23, 4096
    s_xor_b32 s25, s25, 0x0
    s_xor_b32 s26, s26, 0x0
    s_mov_b32 s35, 0x49800000
    s_add_u32 s22, s22, 1
    v_cndmask_b32 v12, 0, v125, s[68:69]
    v_cndmask_b32 v13, 0, v125, s[70:71]
    v_cndmask_b32 v14, 0, v125, s[72:73]
    v_cndmask_b32 v15, 0, v125, s[74:75]
    v_mov_b32 v54, 0
    v_mov_b32 v55, 0
    v_mov_b32 v52, 0
    v_mov_b32 v52, 0
    v_mov_b32 v52, 0
    v_mov_b32 v52, 0
    v_mov_b32 v52, 0
    v_mov_b32 v52, 0
    v_mov_b32 v52, 0
    v_mov_b32 v52, 0
    v_mov_b32 v52, 0
    v_mov_b32 v52, 0
    v_mov_b32 v52, 0
    v_mov_b32 v52, 0
    v_mov_b32 v52, 0
    v_mov_b32 v52, 0
    v_mov_b32 v52, 0
    v_mov_b32 v52, 0
    v_mov_b32 v52, 0
    v_mov_b32 v52, 0
    v_mov_b32 v52, 0
    buffer_load_dwordx4 v[4:7], v117, s[8:11], s29 offen sc1
    buffer_load_dwordx4 v[8:11], v117, s[8:11], s53 offen sc1
    buffer_load_dwordx4 v[16:19], v117, s[8:11], s29 offen offset:2048 sc1
    buffer_load_dwordx4 v[20:23], v117, s[8:11], s53 offen offset:2048 sc1
    v_mov_b32 v52, 0
    v_mov_b32 v52, 0
    v_mov_b32 v52, 0
    v_mov_b32 v52, 0
    v_mov_b32 v52, 0
    v_mov_b32 v52, 0
    v_mov_b32 v52, 0
    v_mov_b32 v52, 0
    v_mov_b32 v52, 0
    v_mov_b32 v52, 0
    v_mov_b32 v52, 0
    v_mov_b32 v52, 0
    v_mov_b32 v52, 0
    v_mov_b32 v52, 0
    v_mov_b32 v52, 0
    v_mov_b32 v52, 0
    v_mov_b32 v52, 0
    v_mov_b32 v52, 0
    v_mov_b32 v52, 0
    v_mov_b32 v52, 0
    v_mov_b32 v52, 0
    v_mov_b32 v52, 0
    v_mov_b32 v52, 0
    v_mov_b32 v52, 0
    v_mov_b32 v52, 0
    v_mov_b32 v52, 0
    v_mov_b32 v52, 0
    v_mov_b32 v52, 0
    v_mov_b32 v52, 0
    v_mov_b32 v52, 0
    v_mov_b32 v52, 0
    v_mov_b32 v52, 0
    v_mov_b32 v52, 0
    v_mov_b32 v52, 0
    v_mov_b32 v52, 0
    v_mov_b32 v52, 0
    v_mov_b32 v52, 0
    v_mov_b32 v52, 0
    v_mov_b32 v52, 0
    v_mov_b32 v52, 0
    buffer_load_dwordx4 v[32:35], v117, s[8:11], s29 offen sc1
    buffer_load_dwordx4 v[36:39], v117, s[8:11], s53 offen sc1
    buffer_load_dwordx4 v[40:43], v117, s[8:11], s29 offen offset:2048 sc1
    buffer_load_dwordx4 v[44:47], v117, s[8:11], s53 offen offset:2048 sc1
    v_mov_b32 v52, 0
L_rl_36:
    s_waitcnt vmcnt(7)
    v_mfma_f32_16x16x32_bf16 v[48:51], v[4:7], v[12:15], 0
    v_xor_b32 v52, s33, v4
    s_waitcnt vmcnt(6)
    v_mfma_f32_16x16x32_bf16 v[48:51], v[8:11], v[12:15], v[48:51]
    v_xor_b32 v53, s33, v8
    v_or_b32 v52, v52, v53
    s_waitcnt vmcnt(5)
    v_mfma_f32_16x16x32_bf16 v[48:51], v[16:19], v[12:15], v[48:51]
    v_xor_b32 v53, s33, v16
    v_or_b32 v52, v52, v53
    s_waitcnt vmcnt(4)
    v_mfma_f32_16x16x32_bf16 v[48:51], v[20:23], v[12:15], v[48:51]
    v_xor_b32 v53, s33, v20
    v_or_b32 v52, v52, v53
    v_and_b32 v52, 1, v52
    v_cmp_ne_u32 vcc, 0, v52
    s_cbranch_vccnz L_rslow_37
L_rgo_38:
    s_nop 2
    v_permlane32_swap_b32 v48, v50
    v_permlane32_swap_b32 v49, v51
    v_pk_add_f32 v[48:49], v[48:49], v[50:51]
    s_mov_b64 exec, s[38:39]
    v_cvt_pk_bf16_f32 v12, v48, v49
    v_min_u32 v12, 0xfffffffe, v12
    buffer_store_dword v12, v119, s[8:11], s24 offen
    s_mov_b64 exec, -1
    s_add_u32 s24, s24, 8192
    s_bitset0_b32 s24, 15
    s_xor_b32 s55, s24, 16384
    s_xor_b32 s29, s29, 0x0
    s_xor_b32 s53, s29, 1024
    s_bfe_u32 s33, s22, 0x10000
    s_waitcnt lgkmcnt(0)
    s_branch L_chain_top2_f
.p2align 6
L_chain_top3_f:
    buffer_load_dwordx4 v[0:3], v117, s[8:11], s23 offen nt
    v_mov_b32 v48, 0
    v_mov_b32 v49, 0
    v_mov_b32 v50, 0
    v_mov_b32 v51, 0
    v_mov_b32 v52, 0
    v_mov_b32 v53, 0
    v_mov_b32 v15, 0
    v_mov_b32 v15, 0
    v_mov_b32 v15, 0
    v_mov_b32 v15, 0
    v_mov_b32 v15, 0
    v_mov_b32 v15, 0
    v_mov_b32 v15, 0
    v_mov_b32 v15, 0
    v_mov_b32 v15, 0
    v_mov_b32 v15, 0
    buffer_load_dwordx4 v[0:3], v117, s[8:11], s23 offen sc1
    s_waitcnt vmcnt(3)
    v_mov_b32 v36, 0
    v_mov_b32 v37, 0
    v_mov_b32 v38, 0
    v_mov_b32 v39, 0
    v_mov_b32 v40, 0
    v_mov_b32 v41, 0
    v_mov_b32 v42, 0
    v_mov_b32 v43, 0
    v_mov_b32 v44, 0
    v_mov_b32 v45, 0
    v_mov_b32 v46, 0
    v_mov_b32 v47, 0
    v_mov_b32 v15, 0
    v_mov_b32 v15, 0
    v_mov_b32 v15, 0
    v_mov_b32 v15, 0
L_mret_39:
    buffer_load_dwordx4 v[0:3], v117, s[8:11], s23 offen sc1
    s_add_u32 s45, s45, 1
    s_cmp_lt_u32 s45, 0x10000
    s_cselect_b32 s56, -2, -1
    s_nop 3
    v_mov_b32 v32, 0
    v_mov_b32 v33, 0
    v_mov_b32 v34, 0
    v_mov_b32 v35, 0
    s_waitcnt vmcnt(2)
    v_max3_u32 v15, v0, v1, v2
    v_max_u32 v15, v15, v3
    v_cmp_lt_u32 vcc, s56, v15
    v_smfmac_f32_16x16x64_bf16 v[32:35], v[0:3], v[80:87], v116
    s_cbranch_vccnz L_mret_39
    ds_write_b128 v117, v[0:3] offset:3072
    v_smfmac_f32_16x16x64_bf16 v[36:39], v[0:3], v[56:63], v116
    buffer_load_dwordx4 v[4:7], v117, s[8:11], s48 offen nt
    v_smfmac_f32_16x16x64_bf16 v[40:43], v[0:3], v[64:71], v116
    buffer_load_dwordx4 v117, s[8:11], s48 offen nt lds
    s_mov_b32 m0, 14336
    v_smfmac_f32_16x16x64_bf16 v[44:47], v[0:3], v[72:79], v116
    s_waitcnt lgkmcnt(0)
    s_barrier
    ds_read_b128 v[8:11], v117 offset:2048
    v_smfmac_f32_16x16x64_bf16 v[48:51], v[0:3], a[192:199], v116
    ds_read_b128 v[16:19], v117 offset:1024
    ds_read_b128 v[20:23], v117
    v_smfmac_f32_16x16x64_bf16 v[52:55], v[0:3], a[200:207], v116
    ds_read_b128 v[80:83], v117 offset:14336
    s_waitcnt lgkmcnt(3)
    v_smfmac_f32_16x16x64_bf16 v[32:35], v[8:11], a[0:7], v116
    ds_read_b128 v[84:87], v117 offset:15360
    v_smfmac_f32_16x16x64_bf16 v[36:39], v[8:11], a[8:15], v116
    ds_read_b128 v[56:59], v117 offset:8192
    s_waitcnt lgkmcnt(4)
    v_smfmac_f32_16x16x64_bf16 v[32:35], v[16:19], a[32:39], v116
    ds_read_b128 v[60:63], v117 offset:9216
    v_smfmac_f32_16x16x64_bf16 v[36:39], v[16:19], a[40:47], v116
    ds_read_b128 v[64:67], v117 offset:10240
    s_waitcnt lgkmcnt(5)
    v_smfmac_f32_16x16x64_bf16 v[32:35], v[20:23], a[64:71], v116
    ds_read_b128 v[68:71], v117 offset:11264
    v_smfmac_f32_16x16x64_bf16 v[36:39], v[20:23], a[72:79], v116
    ds_read_b128 v[72:75], v117 offset:12288
    v_smfmac_f32_16x16x64_bf16 v[40:43], v[8:11], a[96:103], v116
    ds_read_b128 v[76:79], v117 offset:13312
    v_smfmac_f32_16x16x64_bf16 v[40:43], v[16:19], a[128:135], v116
    buffer_store_dwordx4 v[112:115], v117, s[8:11], s32 offen sc1
    v_smfmac_f32_16x16x64_bf16 v[40:43], v[20:23], a[160:167], v116
    s_waitcnt vmcnt(2)
    v_max3_u32 v15, v4, v5, v6
    v_smfmac_f32_16x16x64_bf16 v[44:47], v[8:11], a[104:111], v116
    v_max_u32 v15, v15, v7
    v_smfmac_f32_16x16x64_bf16 v[44:47], v[16:19], a[136:143], v116
    s_waitcnt vmcnt(1) lgkmcnt(0)
    v_cmp_lt_u32 vcc, s56, v15
    v_smfmac_f32_16x16x64_bf16 v[44:47], v[20:23], a[168:175], v116
    s_cbranch_vccnz L_mret_40
L_mgo_41:
    v_smfmac_f32_16x16x64_bf16 v[44:47], v[4:7], v[24:31], v116
    s_barrier
    ds_read_b128 v[12:15], v117 offset:6144
    v_smfmac_f32_16x16x64_bf16 v[32:35], v[4:7], v[88:95], v116
    ds_read_b128 v[24:27], v117 offset:5120
    v_smfmac_f32_16x16x64_bf16 v[36:39], v[4:7], v[96:103], v116
    ds_read_b128 v[28:31], v117 offset:4096
    v_smfmac_f32_16x16x64_bf16 v[40:43], v[4:7], v[104:111], v116
    ds_read_b128 v[88:91], v117 offset:30720
    s_waitcnt lgkmcnt(3)
    v_smfmac_f32_16x16x64_bf16 v[32:35], v[12:15], a[16:23], v116
    ds_read_b128 v[92:95], v117 offset:31744
    s_waitcnt lgkmcnt(3)
    v_smfmac_f32_16x16x64_bf16 v[32:35], v[24:27], a[48:55], v116
    ds_read_b128 v[96:99], v117 offset:23552
    s_waitcnt lgkmcnt(3)
    v_smfmac_f32_16x16x64_bf16 v[32:35], v[28:31], a[80:87], v116
    buffer_load_dwordx4 v117, s[8:11], s30 offen lds
    v_smfmac_f32_16x16x64_bf16 v[36:39], v[12:15], a[24:31], v116
    ds_read_b128 v[100:103], v117 offset:23552
    v_smfmac_f32_16x16x64_bf16 v[36:39], v[24:27], a[56:63], v116
    ds_read_b128 v[104:107], v117 offset:23552
    v_add_f32 v32, v32, v34
    v_smfmac_f32_16x16x64_bf16 v[36:39], v[28:31], a[88:95], v116
    buffer_load_dwordx4 v117, s[8:11], s30 offen offset:1024 lds
    s_add_u32 m0, s52, 0x6000
    v_add_f32 v33, v33, v35
    v_smfmac_f32_16x16x64_bf16 v[40:43], v[12:15], a[112:119], v116
    ds_read_b128 v[108:111], v117 offset:23552
    v_mul_f32 v32, s34, v32
    v_smfmac_f32_16x16x64_bf16 v[40:43], v[24:27], a[144:151], v116
    ds_read_b128 v[0:3], v124
    v_mul_f32 v33, s34, v33
    v_smfmac_f32_16x16x64_bf16 v[40:43], v[28:31], a[176:183], v116
    s_waitcnt lgkmcnt(5)
    buffer_load_dwordx4 v117, s[8:11], s31 offen lds
    v_add_f32 v36, v36, v38
    v_smfmac_f32_16x16x64_bf16 v[48:51], v[4:7], a[208:215], v116
    v_add_f32 v37, v37, v39
    v_smfmac_f32_16x16x64_bf16 v[52:55], v[4:7], a[216:223], v116
    ds_read_b128 v[4:7], v124 offset:1024
    v_mul_f32 v36, s34, v36
    v_smfmac_f32_16x16x64_bf16 v[44:47], v[12:15], a[120:127], v116
    buffer_load_dwordx4 v117, s[8:11], s31 offen offset:1024 lds
    s_mov_b32 m0, 7168
    v_mul_f32 v37, s34, v37
    v_smfmac_f32_16x16x64_bf16 v[44:47], v[24:27], a[152:159], v116
    v_cvt_pk_bf16_f32 v34, v32, v36
    v_smfmac_f32_16x16x64_bf16 v[44:47], v[28:31], a[184:191], v116
    v_cvt_pk_bf16_f32 v35, v33, v37
    v_add_f32 v40, v40, v42
    v_smfmac_f32_16x16x64_bf16 v[48:51], v[8:11], a[224:231], v116
    ds_write2_b32 v120, v34, v35 offset0:32 offset1:48
    v_add_f32 v41, v41, v43
    v_smfmac_f32_16x16x64_bf16 v[52:55], v[8:11], a[232:239], v116
    v_add_f32 v44, v44, v46
    v_add_f32 v45, v45, v47
    v_cvt_pk_bf16_f32 v113, v40, v44
    v_cvt_pk_bf16_f32 v115, v41, v45
    v_smfmac_f32_16x16x64_bf16 v[48:51], v[12:15], a[240:247], v116
    ds_write2_b32 v120, v113, v115 offset0:0 offset1:16
    v_smfmac_f32_16x16x64_bf16 v[52:55], v[12:15], a[248:255], v116
    s_cmp_eq_u32 s22, 63
    s_cbranch_scc1 L_chain_last_f
    v_smfmac_f32_16x16x64_bf16 v[48:51], v[16:19], v[128:135], v116
    v_smfmac_f32_16x16x64_bf16 v[48:51], v[20:23], v[160:167], v116
    buffer_store_dword v126, v119, s[8:11], s55 offen
    v_smfmac_f32_16x16x64_bf16 v[48:51], v[24:27], v[144:151], v116
    s_waitcnt lgkmcnt(0)
    s_barrier
    v_smfmac_f32_16x16x64_bf16 v[48:51], v[28:31], v[176:183], v116
    ds_read_b128 v[32:35], v121 offset:16384
    ds_read_b128 v[36:39], v121 offset:17408
    v_smfmac_f32_16x16x64_bf16 v[52:55], v[16:19], v[136:143], v116
    ds_read_b128 v[40:43], v121 offset:18432
    ds_read_b128 v[44:47], v121 offset:19456
    v_smfmac_f32_16x16x64_bf16 v[52:55], v[20:23], v[168:175], v116
    ds_read_b128 v[8:11], v124 offset:32768
    v_add_f32 v48, v48, v50
    v_smfmac_f32_16x16x64_bf16 v[52:55], v[24:27], v[152:159], v116
    ds_read_b128 v[12:15], v124 offset:33792
    v_add_f32 v49, v49, v51
    v_smfmac_f32_16x16x64_bf16 v[52:55], v[28:31], v[184:191], v116
    s_waitcnt lgkmcnt(5)
    v_cvt_pk_bf16_f32 v112, v48, v49
    v_mfma_f32_16x16x32_bf16 v[56:59], v[56:59], v[32:35], 0
    s_waitcnt lgkmcnt(4)
    v_mov_b32 v48, s50
    v_mov_b32 v49, s50
    v_mfma_f32_16x16x32_bf16 v[56:59], v[60:63], v[36:39], v[56:59]
    ds_read_b128 v[16:19], v124 offset:2048
    s_waitcnt lgkmcnt(4)
    v_mov_b32 v50, s50
    v_mov_b32 v51, s50
    v_mfma_f32_16x16x32_bf16 v[56:59], v[64:67], v[40:43], v[56:59]
    ds_read_b128 v[20:23], v124 offset:3072
    s_waitcnt lgkmcnt(4)
    v_add_f32 v52, v52, v54
    v_mfma_f32_16x16x32_bf16 v[56:59], v[68:71], v[44:47], v[56:59]
    ds_read_b128 v[24:27], v124 offset:4096
    v_add_f32 v53, v53, v55
    v_mfma_f32_16x16x32_bf16 v[60:63], v[72:75], v[32:35], 0
    ds_read_b128 v[28:31], v124 offset:5120
    v_cvt_pk_bf16_f32 v114, v52, v53
    v_mov_b32 v53, 0
    v_mfma_f32_16x16x32_bf16 v[60:63], v[76:79], v[36:39], v[60:63]
    v_exp_f32 v56, v56
    v_mfma_f32_16x16x32_bf16 v[60:63], v[80:83], v[40:43], v[60:63]
    v_exp_f32 v57, v57
    v_mfma_f32_16x16x32_bf16 v[60:63], v[84:87], v[44:47], v[60:63]
    v_exp_f32 v58, v58
    v_mfma_f32_16x16x32_bf16 v[64:67], v[32:35], v[32:35], 0
    v_exp_f32 v59, v59
    v_cvt_pk_bf16_f32 v68, v56, v57
    v_mfma_f32_16x16x32_bf16 v[64:67], v[36:39], v[36:39], v[64:67]
    v_exp_f32 v60, v60
    v_cvt_pk_bf16_f32 v69, v58, v59
    v_mfma_f32_16x16x32_bf16 v[64:67], v[40:43], v[40:43], v[64:67]
    v_exp_f32 v61, v61
    v_mfma_f32_16x16x32_bf16 v[64:67], v[44:47], v[44:47], v[64:67]
    v_exp_f32 v62, v62
    v_exp_f32 v63, v63
    v_cvt_pk_bf16_f32 v70, v60, v61
    v_cvt_pk_bf16_f32 v71, v62, v63
    s_nop 1
    v_mfma_f32_16x16x32_bf16 v[72:75], v[88:91], v[68:71], 0
    s_nop 0
    v_exp_f32 v64, v64
    v_mfma_f32_16x16x32_bf16 v[76:79], v[92:95], v[68:71], 0
    v_exp_f32 v65, v65
    v_mfma_f32_16x16x32_bf16 v[80:83], v[48:51], v[68:71], 0
    v_cvt_pk_bf16_f32 v52, v64, v65
    s_nop 1
    v_mfma_f32_16x16x16_bf16 v[72:75], v[112:113], v[52:53], v[72:75]
    ds_read_b128 v[32:35], v124 offset:6144
    v_mfma_f32_16x16x16_bf16 v[76:79], v[114:115], v[52:53], v[76:79]
    ds_read_b128 v[36:39], v124 offset:7168
    v_mfma_f32_16x16x16_bf16 v[80:83], v[48:49], v[52:53], v[80:83]
L_norm_42:
    s_mov_b64 vcc, s[36:37]
    v_mov_b32 v122, v122
    v_mov_b32 v122, v122
    v_mov_b32 v122, v122
    v_cndmask_b32_dpp v76, v72, v76, vcc quad_perm:[2,3,2,3] row_mask:0xf bank_mask:0xf
    v_cndmask_b32_dpp v77, v73, v77, vcc quad_perm:[2,3,2,3] row_mask:0xf bank_mask:0xf
    v_cndmask_b32_dpp v78, v74, v78, vcc quad_perm:[2,3,2,3] row_mask:0xf bank_mask:0xf
    v_cndmask_b32_dpp v79, v75, v79, vcc quad_perm:[2,3,2,3] row_mask:0xf bank_mask:0xf
    v_rcp_f32_dpp v84, v80 quad_perm:[2,3,2,3] row_mask:0xf bank_mask:0xf
    s_nop 0
    v_pk_mul_f32 v[76:77], v[76:77], v[84:85] op_sel_hi:[1,0]
    v_pk_mul_f32 v[78:79], v[78:79], v[84:85] op_sel_hi:[1,0]
    v_cvt_pk_bf16_f32 v72, v76, v77
    v_cvt_pk_bf16_f32 v73, v78, v79
    ds_write_b64 v122, v[72:73] offset:22016
    v_max_f32_dpp v86, v80, v84 quad_perm:[2,3,2,3] row_mask:0xf bank_mask:0xf
    v_mov_b32_dpp v60, v72 quad_perm:[0,1,0,1] row_mask:0xf bank_mask:0xf
    v_mov_b32_dpp v61, v73 quad_perm:[0,1,0,1] row_mask:0xf bank_mask:0xf
    v_cmp_lt_f32 vcc, s35, v86
    v_mov_b32_dpp v62, v72 quad_perm:[2,3,2,3] row_mask:0xf bank_mask:0xf
    v_mov_b32_dpp v63, v73 quad_perm:[2,3,2,3] row_mask:0xf bank_mask:0xf
    s_nop 1
    v_smfmac_f32_16x16x64_bf16 v[96:99], v[60:63], v[192:199], v116
    s_cbranch_vccnz L_smax_43
    v_smfmac_f32_16x16x64_bf16 v[100:103], v[60:63], v[224:231], v116
    s_waitcnt lgkmcnt(0)
    s_barrier
    ds_read_b128 v[92:95], v127 offset:21504
    ds_read_b128 v[80:83], v127 offset:20992
    ds_read_b128 v[84:87], v127 offset:20480
    v_smfmac_f32_16x16x64_bf16 v[104:107], v[60:63], v[0:7], v116
    ds_read_b128 v[40:43], v124 offset:34816
    v_smfmac_f32_16x16x64_bf16 v[108:111], v[60:63], v[8:15], v116
    ds_read_b128 v[56:59], v124 offset:36864
    s_waitcnt lgkmcnt(4)
    v_smfmac_f32_16x16x64_bf16 v[96:99], v[92:95], v[200:207], v116
    s_waitcnt lgkmcnt(3)
    v_smfmac_f32_16x16x64_bf16 v[96:99], v[80:83], v[208:215], v116
    ds_read_b128 v[44:47], v124 offset:35840
    s_waitcnt lgkmcnt(3)
    v_smfmac_f32_16x16x64_bf16 v[96:99], v[84:87], v[216:223], v116
    ds_read_b128 v[68:71], v124 offset:39936
    v_smfmac_f32_16x16x64_bf16 v[100:103], v[92:95], v[232:239], v116
    ds_read_b128 v[64:67], v124 offset:38912
    v_smfmac_f32_16x16x64_bf16 v[100:103], v[80:83], v[240:247], v116
    ds_read_b128 v[60:63], v124 offset:37888
    v_cvt_pk_bf16_f32 v72, v96, v98
    v_smfmac_f32_16x16x64_bf16 v[100:103], v[84:87], v[248:255], v116
    v_and_or_b32 v72, v72, -2, s33
    v_smfmac_f32_16x16x64_bf16 v[104:107], v[92:95], v[16:23], v116
    v_cvt_pk_bf16_f32 v74, v97, v99
    v_smfmac_f32_16x16x64_bf16 v[104:107], v[80:83], v[24:31], v116
    v_cvt_pk_bf16_f32 v73, v100, v102
    v_cvt_pk_bf16_f32 v75, v101, v103
    v_smfmac_f32_16x16x64_bf16 v[104:107], v[84:87], v[32:39], v116
    buffer_store_dwordx4 v[72:75], v118, s[8:11], s25 offen
    s_waitcnt lgkmcnt(3)
    v_smfmac_f32_16x16x64_bf16 v[108:111], v[92:95], v[40:47], v116
    s_waitcnt lgkmcnt(0)
    v_smfmac_f32_16x16x64_bf16 v[108:111], v[80:83], v[56:63], v116
    v_cvt_pk_bf16_f32 v76, v104, v106
    v_smfmac_f32_16x16x64_bf16 v[108:111], v[84:87], v[64:71], v116
    v_and_or_b32 v76, v76, -2, s33
    v_cvt_pk_bf16_f32 v78, v105, v107
    v_mov_b32 v122, v122
    v_mov_b32 v122, v122
    v_mov_b32 v122, v122
    v_mov_b32 v122, v122
    v_mov_b32 v122, v122
    v_mov_b32 v122, v122
    v_cvt_pk_bf16_f32 v77, v108, v110
    v_cvt_pk_bf16_f32 v79, v109, v111
    buffer_store_dwordx4 v[76:79], v118, s[8:11], s26 offen
    ds_read_b128 v[80:83], v123
    ds_read_b128 v[84:87], v123 offset:1024
    ds_read_b128 v[56:59], v123 offset:2048
    ds_read_b128 v[60:63], v123 offset:3072
    ds_read_b128 v[64:67], v123 offset:32768
    ds_read_b128 v[68:71], v123 offset:33792
    ds_read_b128 v[72:75], v123 offset:34816
    ds_read_b128 v[76:79], v123 offset:35840
    ds_read_b128 v[88:91], v123 offset:4096
    ds_read_b128 v[92:95], v123 offset:5120
    ds_read_b128 v[96:99], v123 offset:6144
    ds_read_b128 v[100:103], v123 offset:7168
    ds_read_b128 v[104:107], v123 offset:36864
    ds_read_b128 v[108:111], v123 offset:37888
    ds_read_b128 v[24:27], v123 offset:38912
    ds_read_b128 v[28:31], v123 offset:39936
    s_add_u32 s30, s30, 0x40000
    s_add_u32 s31, s31, 0x40000
    s_add_u32 s32, s32, 0x20000
    s_add_u32 s23, s24, 3072
    s_add_u32 s48, s23, 4096
    s_xor_b32 s25, s25, 0x0
    s_xor_b32 s26, s26, 0x0
    s_mov_b32 s35, 0x49800000
    s_add_u32 s22, s22, 1
    v_cndmask_b32 v12, 0, v125, s[68:69]
    v_cndmask_b32 v13, 0, v125, s[70:71]
    v_cndmask_b32 v14, 0, v125, s[72:73]
    v_cndmask_b32 v15, 0, v125, s[74:75]
    v_mov_b32 v54, 0
    v_mov_b32 v55, 0
    v_mov_b32 v52, 0
    v_mov_b32 v52, 0
    v_mov_b32 v52, 0
    v_mov_b32 v52, 0
    v_mov_b32 v52, 0
    v_mov_b32 v52, 0
    v_mov_b32 v52, 0
    v_mov_b32 v52, 0
    v_mov_b32 v52, 0
    v_mov_b32 v52, 0
    v_mov_b32 v52, 0
    v_mov_b32 v52, 0
    v_mov_b32 v52, 0
    v_mov_b32 v52, 0
    v_mov_b32 v52, 0
    v_mov_b32 v52, 0
    v_mov_b32 v52, 0
    v_mov_b32 v52, 0
    v_mov_b32 v52, 0
    v_mov_b32 v52, 0
    v_mov_b32 v52, 0
    v_mov_b32 v52, 0
    v_mov_b32 v52, 0
    v_mov_b32 v52, 0
    v_mov_b32 v52, 0
    v_mov_b32 v52, 0
    v_mov_b32 v52, 0
    v_mov_b32 v52, 0
    v_mov_b32 v52, 0
    v_mov_b32 v52, 0
    v_mov_b32 v52, 0
    v_mov_b32 v52, 0
    v_mov_b32 v52, 0
    v_mov_b32 v52, 0
    v_mov_b32 v52, 0
    v_mov_b32 v52, 0
    v_mov_b32 v52, 0
    v_mov_b32 v52, 0
    v_mov_b32 v52, 0
    v_mov_b32 v52, 0
    v_mov_b32 v52, 0
    v_mov_b32 v52, 0
    v_mov_b32 v52, 0
    v_mov_b32 v52, 0
    v_mov_b32 v52, 0
    v_mov_b32 v52, 0
    v_mov_b32 v52, 0
    v_mov_b32 v52, 0
    v_mov_b32 v52, 0
    buffer_load_dwordx4 v[4:7], v117, s[8:11], s29 offen sc1
    buffer_load_dwordx4 v[8:11], v117, s[8:11], s53 offen sc1
    buffer_load_dwordx4 v[16:19], v117, s[8:11], s29 offen offset:2048 sc1
    buffer_load_dwordx4 v[20:23], v117, s[8:11], s53 offen offset:2048 sc1
    v_mov_b32 v52, 0
    v_mov_b32 v52, 0
    v_mov_b32 v52, 0
    v_mov_b32 v52, 0
    v_mov_b32 v52, 0
    v_mov_b32 v52, 0
    v_mov_b32 v52, 0
    v_mov_b32 v52, 0
    v_mov_b32 v52, 0
    v_mov_b32 v52, 0
    v_mov_b32 v52, 0
    v_mov_b32 v52, 0
    v_mov_b32 v52, 0
    v_mov_b32 v52, 0
    v_mov_b32 v52, 0
    v_mov_b32 v52, 0
    v_mov_b32 v52, 0
    v_mov_b32 v52, 0
    v_mov_b32 v52, 0
    v_mov_b32 v52, 0
    v_mov_b32 v52, 0
    v_mov_b32 v52, 0
    v_mov_b32 v52, 0
    v_mov_b32 v52, 0
    v_mov_b32 v52, 0
    v_mov_b32 v52, 0
    v_mov_b32 v52, 0
    v_mov_b32 v52, 0
    v_mov_b32 v52, 0
    v_mov_b32 v52, 0
    buffer_load_dwordx4 v[32:35], v117, s[8:11], s29 offen sc1
    buffer_load_dwordx4 v[36:39], v117, s[8:11], s53 offen sc1
    buffer_load_dwordx4 v[40:43], v117, s[8:11], s29 offen offset:2048 sc1
    buffer_load_dwordx4 v[44:47], v117, s[8:11], s53 offen offset:2048 sc1
    v_mov_b32 v52, 0
L_rl_44:
    s_waitcnt vmcnt(7)
    v_mfma_f32_16x16x32_bf16 v[48:51], v[4:7], v[12:15], 0
    v_xor_b32 v52, s33, v4
    s_waitcnt vmcnt(6)
    v_mfma_f32_16x16x32_bf16 v[48:51], v[8:11], v[12:15], v[48:51]
    v_xor_b32 v53, s33, v8
    v_or_b32 v52, v52, v53
    s_waitcnt vmcnt(5)
    v_mfma_f32_16x16x32_bf16 v[48:51], v[16:19], v[12:15], v[48:51]
    v_xor_b32 v53, s33, v16
    v_or_b32 v52, v52, v53
    s_waitcnt vmcnt(4)
    v_mfma_f32_16x16x32_bf16 v[48:51], v[20:23], v[12:15], v[48:51]
    v_xor_b32 v53, s33, v20
    v_or_b32 v52, v52, v53
    v_and_b32 v52, 1, v52
    v_cmp_ne_u32 vcc, 0, v52
    s_cbranch_vccnz L_rslow_45
L_rgo_46:
    s_nop 2
    v_permlane32_swap_b32 v48, v50
    v_permlane32_swap_b32 v49, v51
    v_pk_add_f32 v[48:49], v[48:49], v[50:51]
    s_mov_b64 exec, s[38:39]
    v_cvt_pk_bf16_f32 v12, v48, v49
    v_min_u32 v12, 0xfffffffe, v12
    buffer_store_dword v12, v119, s[8:11], s24 offen
    s_mov_b64 exec, -1
    s_add_u32 s24, s24, 8192
    s_bitset0_b32 s24, 15
    s_xor_b32 s55, s24, 16384
    s_xor_b32 s29, s29, 0x0
    s_xor_b32 s53, s29, 1024
    s_bfe_u32 s33, s22, 0x10000
    s_waitcnt lgkmcnt(0)
    s_branch L_chain_top3_f
L_chain_last_f:
    s_nop 1
    v_smfmac_f32_16x16x64_bf16 v[48:51], v[16:19], v[128:135], v116
    v_smfmac_f32_16x16x64_bf16 v[48:51], v[20:23], v[160:167], v116
    v_smfmac_f32_16x16x64_bf16 v[48:51], v[24:27], v[144:151], v116
    v_smfmac_f32_16x16x64_bf16 v[48:51], v[28:31], v[176:183], v116
    v_smfmac_f32_16x16x64_bf16 v[52:55], v[16:19], v[136:143], v116
    v_smfmac_f32_16x16x64_bf16 v[52:55], v[20:23], v[168:175], v116
    v_smfmac_f32_16x16x64_bf16 v[52:55], v[24:27], v[152:159], v116
    v_smfmac_f32_16x16x64_bf16 v[52:55], v[28:31], v[184:191], v116
    v_add_f32 v48, v48, v50
    v_add_f32 v49, v49, v51
    v_cvt_pk_bf16_f32 v112, v48, v49
    s_nop 4
    v_add_f32 v52, v52, v54
    v_add_f32 v53, v53, v55
    v_cvt_pk_bf16_f32 v114, v52, v53
    s_add_u32 s32, s32, 0x20000
    buffer_store_dwordx4 v[112:115], v117, s[8:11], s32 offen sc1
    v_mov_b32 v94, 64
    s_waitcnt vmcnt(0) lgkmcnt(0)
    s_barrier
    s_mov_b64 exec, 1
    buffer_store_dword v94, off, s[8:11], s44 sc1
    s_mov_b64 exec, -1
    s_endpgm
L_mret_18:
    s_mov_b32 s43, m0
    s_mov_b32 m0, 4096
    buffer_load_dwordx4 v[4:7], v117, s[8:11], s48 offen sc1
    buffer_load_dwordx4 v117, s[8:11], s48 offen sc1 lds
    s_mov_b32 m0, 8192
    s_mov_b32 m0, s43
    s_waitcnt vmcnt(0)
    v_max3_u32 v15, v4, v5, v6
    v_max_u32 v15, v15, v7
    v_cmp_lt_u32 vcc, s56, v15
    s_add_u32 s47, s47, 1
    s_add_u32 s49, s49, 1
    s_cmp_ge_u32 s49, 0x10000
    s_cbranch_scc1 L_mgo_19
    s_cbranch_vccnz L_mret_18
    s_branch L_mgo_19
L_smax_21:
    s_add_u32 s47, s47, 1
    s_mov_b32 s35, 0x7f800000
    s_waitcnt lgkmcnt(0)
    s_sub_u32 s43, s30, 0x40000
    s_add_u32 s40, s43, 4096
    s_nop 7
    buffer_load_dwordx4 v[56:59], v117, s[8:11], s43 offen
    buffer_load_dwordx4 v[60:63], v117, s[8:11], s43 offen offset:1024
    buffer_load_dwordx4 v[64:67], v117, s[8:11], s43 offen offset:2048
    buffer_load_dwordx4 v[68:71], v117, s[8:11], s43 offen offset:3072
    buffer_load_dwordx4 v[72:75], v117, s[8:11], s40 offen
    buffer_load_dwordx4 v[76:79], v117, s[8:11], s40 offen offset:1024
    buffer_load_dwordx4 v[80:83], v117, s[8:11], s40 offen offset:2048
    buffer_load_dwordx4 v[84:87], v117, s[8:11], s40 offen offset:3072
    ds_read_b128 v[32:35], v121 offset:16384
    ds_read_b128 v[36:39], v121 offset:17408
    ds_read_b128 v[40:43], v121 offset:18432
    ds_read_b128 v[44:47], v121 offset:19456
    v_mov_b32 v96, 0
    v_mov_b32 v97, 0
    v_mov_b32 v98, 0
    v_mov_b32 v99, 0
    v_mov_b32 v100, 0
    v_mov_b32 v101, 0
    v_mov_b32 v102, 0
    v_mov_b32 v103, 0
    v_mov_b32 v104, 0
    v_mov_b32 v105, 0
    v_mov_b32 v106, 0
    v_mov_b32 v107, 0
    v_mov_b32 v108, 0
    v_mov_b32 v109, 0
    v_mov_b32 v110, 0
    v_mov_b32 v111, 0
    s_waitcnt vmcnt(0) lgkmcnt(0)
    v_mfma_f32_16x16x32_bf16 v[56:59], v[56:59], v[32:35], 0
    v_mfma_f32_16x16x32_bf16 v[56:59], v[60:63], v[36:39], v[56:59]
    v_mfma_f32_16x16x32_bf16 v[56:59], v[64:67], v[40:43], v[56:59]
    v_mfma_f32_16x16x32_bf16 v[56:59], v[68:71], v[44:47], v[56:59]
    v_mfma_f32_16x16x32_bf16 v[60:63], v[72:75], v[32:35], 0
    v_mfma_f32_16x16x32_bf16 v[60:63], v[76:79], v[36:39], v[60:63]
    v_mfma_f32_16x16x32_bf16 v[60:63], v[80:83], v[40:43], v[60:63]
    v_mfma_f32_16x16x32_bf16 v[60:63], v[84:87], v[44:47], v[60:63]
    v_mfma_f32_16x16x32_bf16 v[64:67], v[32:35], v[32:35], 0
    v_mfma_f32_16x16x32_bf16 v[64:67], v[36:39], v[36:39], v[64:67]
    v_mfma_f32_16x16x32_bf16 v[64:67], v[40:43], v[40:43], v[64:67]
    v_mfma_f32_16x16x32_bf16 v[64:67], v[44:47], v[44:47], v[64:67]
    v_max3_f32 v84, v56, v57, v58
    v_max3_f32 v84, v84, v59, v60
    v_max3_f32 v84, v84, v61, v62
    s_nop 4
    v_max3_f32 v84, v84, v63, v64
    v_max_f32 v84, v84, v65
    v_mov_b32 v85, v84
    s_nop 1
    v_permlane32_swap_b32 v85, v84
    v_max_f32 v84, v85, v84
    v_mov_b32 v85, v84
    s_nop 1
    v_permlane16_swap_b32 v85, v84
    v_max_f32 v84, v85, v84
    v_sub_f32 v56, v56, v84
    v_sub_f32 v57, v57, v84
    v_sub_f32 v58, v58, v84
    v_sub_f32 v59, v59, v84
    v_sub_f32 v60, v60, v84
    v_sub_f32 v61, v61, v84
    v_sub_f32 v62, v62, v84
    v_sub_f32 v63, v63, v84
    v_sub_f32 v64, v64, v84
    v_sub_f32 v65, v65, v84
    v_exp_f32 v56, v56
    v_exp_f32 v57, v57
    v_exp_f32 v58, v58
    v_exp_f32 v59, v59
    v_exp_f32 v60, v60
    v_exp_f32 v61, v61
    v_exp_f32 v62, v62
    v_exp_f32 v63, v63
    v_exp_f32 v64, v64
    v_exp_f32 v65, v65
    v_cvt_pk_bf16_f32 v68, v56, v57
    v_cvt_pk_bf16_f32 v69, v58, v59
    v_cvt_pk_bf16_f32 v70, v60, v61
    v_cvt_pk_bf16_f32 v71, v62, v63
    v_cvt_pk_bf16_f32 v52, v64, v65
    s_nop 0
    v_mfma_f32_16x16x32_bf16 v[72:75], v[88:91], v[68:71], 0
    v_mfma_f32_16x16x32_bf16 v[76:79], v[92:95], v[68:71], 0
    v_mfma_f32_16x16x32_bf16 v[80:83], v[48:51], v[68:71], 0
    v_mfma_f32_16x16x16_bf16 v[72:75], v[112:113], v[52:53], v[72:75]
    v_mfma_f32_16x16x16_bf16 v[76:79], v[114:115], v[52:53], v[76:79]
    v_mfma_f32_16x16x16_bf16 v[80:83], v[48:49], v[52:53], v[80:83]
    ds_read_b128 v[32:35], v124 offset:6144
    ds_read_b128 v[36:39], v124 offset:7168
    ds_read_b128 v[40:43], v124 offset:34816
    ds_read_b128 v[44:47], v124 offset:35840
    ds_read_b128 v[56:59], v124 offset:36864
    ds_read_b128 v[64:67], v124 offset:38912
    ds_read_b128 v[68:71], v124 offset:39936
    s_waitcnt lgkmcnt(0)
    s_branch L_norm_20
L_kvw_22:
    s_add_u32 s47, s47, 1
    s_add_u32 s49, s49, 1
    s_cmp_ge_u32 s49, 0x10000
    s_cbranch_scc1 L_kvb_23
    s_sleep 4
    buffer_load_dword v125, v119, s[8:11], s28 offen sc1
    s_waitcnt vmcnt(0)
    v_cmp_eq_u32 vcc, 0, v125
    s_nop 0
    s_and_b64 vcc, vcc, s[58:59]
    s_cbranch_scc1 L_kvw_22
    s_branch L_kvb_23
L_mret_25:
    s_mov_b32 s43, m0
    s_mov_b32 m0, 5120
    buffer_load_dwordx4 v[4:7], v117, s[8:11], s48 offen sc1
    buffer_load_dwordx4 v117, s[8:11], s48 offen sc1 lds
    s_mov_b32 m0, 10240
    s_mov_b32 m0, s43
    s_waitcnt vmcnt(0)
    v_max3_u32 v15, v4, v5, v6
    v_max_u32 v15, v15, v7
    v_cmp_lt_u32 vcc, s56, v15
    s_add_u32 s47, s47, 1
    s_add_u32 s49, s49, 1
    s_cmp_ge_u32 s49, 0x10000
    s_cbranch_scc1 L_mgo_26
    s_cbranch_vccnz L_mret_25
    s_branch L_mgo_26
L_smax_28:
    s_add_u32 s47, s47, 1
    s_mov_b32 s35, 0x7f800000
    s_waitcnt lgkmcnt(0)
    s_sub_u32 s43, s30, 0x40800
    s_add_u32 s40, s43, 4096
    s_nop 7
    buffer_load_dwordx4 v[56:59], v117, s[8:11], s43 offen
    buffer_load_dwordx4 v[60:63], v117, s[8:11], s43 offen offset:1024
    buffer_load_dwordx4 v[64:67], v117, s[8:11], s43 offen offset:2048
    buffer_load_dwordx4 v[68:71], v117, s[8:11], s43 offen offset:3072
    buffer_load_dwordx4 v[72:75], v117, s[8:11], s40 offen
    buffer_load_dwordx4 v[76:79], v117, s[8:11], s40 offen offset:1024
    buffer_load_dwordx4 v[80:83], v117, s[8:11], s40 offen offset:2048
    buffer_load_dwordx4 v[84:87], v117, s[8:11], s40 offen offset:3072
    ds_read_b128 v[32:35], v121 offset:16384
    ds_read_b128 v[36:39], v121 offset:17408
    ds_read_b128 v[40:43], v121 offset:18432
    ds_read_b128 v[44:47], v121 offset:19456
    v_mov_b32 v96, 0
    v_mov_b32 v97, 0
    v_mov_b32 v98, 0
    v_mov_b32 v99, 0
    v_mov_b32 v100, 0
    v_mov_b32 v101, 0
    v_mov_b32 v102, 0
    v_mov_b32 v103, 0
    v_mov_b32 v104, 0
    v_mov_b32 v105, 0
    v_mov_b32 v106, 0
    v_mov_b32 v107, 0
    v_mov_b32 v108, 0
    v_mov_b32 v109, 0
    v_mov_b32 v110, 0
    v_mov_b32 v111, 0
    s_waitcnt vmcnt(0) lgkmcnt(0)
    v_mfma_f32_16x16x32_bf16 v[56:59], v[56:59], v[32:35], 0
    v_mfma_f32_16x16x32_bf16 v[56:59], v[60:63], v[36:39], v[56:59]
    v_mfma_f32_16x16x32_bf16 v[56:59], v[64:67], v[40:43], v[56:59]
    v_mfma_f32_16x16x32_bf16 v[56:59], v[68:71], v[44:47], v[56:59]
    v_mfma_f32_16x16x32_bf16 v[60:63], v[72:75], v[32:35], 0
    v_mfma_f32_16x16x32_bf16 v[60:63], v[76:79], v[36:39], v[60:63]
    v_mfma_f32_16x16x32_bf16 v[60:63], v[80:83], v[40:43], v[60:63]
    v_mfma_f32_16x16x32_bf16 v[60:63], v[84:87], v[44:47], v[60:63]
    v_mfma_f32_16x16x32_bf16 v[64:67], v[32:35], v[32:35], 0
    v_mfma_f32_16x16x32_bf16 v[64:67], v[36:39], v[36:39], v[64:67]
    v_mfma_f32_16x16x32_bf16 v[64:67], v[40:43], v[40:43], v[64:67]
    v_mfma_f32_16x16x32_bf16 v[64:67], v[44:47], v[44:47], v[64:67]
    v_max3_f32 v84, v56, v57, v58
    v_max3_f32 v84, v84, v59, v60
    v_max3_f32 v84, v84, v61, v62
    s_nop 4
    v_max3_f32 v84, v84, v63, v64
    v_max_f32 v84, v84, v65
    v_mov_b32 v85, v84
    s_nop 1
    v_permlane32_swap_b32 v85, v84
    v_max_f32 v84, v85, v84
    v_mov_b32 v85, v84
    s_nop 1
    v_permlane16_swap_b32 v85, v84
    v_max_f32 v84, v85, v84
    v_sub_f32 v56, v56, v84
    v_sub_f32 v57, v57, v84
    v_sub_f32 v58, v58, v84
    v_sub_f32 v59, v59, v84
    v_sub_f32 v60, v60, v84
    v_sub_f32 v61, v61, v84
    v_sub_f32 v62, v62, v84
    v_sub_f32 v63, v63, v84
    v_sub_f32 v64, v64, v84
    v_sub_f32 v65, v65, v84
    v_exp_f32 v56, v56
    v_exp_f32 v57, v57
    v_exp_f32 v58, v58
    v_exp_f32 v59, v59
    v_exp_f32 v60, v60
    v_exp_f32 v61, v61
    v_exp_f32 v62, v62
    v_exp_f32 v63, v63
    v_exp_f32 v64, v64
    v_exp_f32 v65, v65
    v_cvt_pk_bf16_f32 v68, v56, v57
    v_cvt_pk_bf16_f32 v69, v58, v59
    v_cvt_pk_bf16_f32 v70, v60, v61
    v_cvt_pk_bf16_f32 v71, v62, v63
    v_cvt_pk_bf16_f32 v52, v64, v65
    s_nop 0
    v_mfma_f32_16x16x32_bf16 v[72:75], v[88:91], v[68:71], 0
    v_mfma_f32_16x16x32_bf16 v[76:79], v[92:95], v[68:71], 0
    v_mfma_f32_16x16x32_bf16 v[80:83], v[48:51], v[68:71], 0
    v_mfma_f32_16x16x16_bf16 v[72:75], v[112:113], v[52:53], v[72:75]
    v_mfma_f32_16x16x16_bf16 v[76:79], v[114:115], v[52:53], v[76:79]
    v_mfma_f32_16x16x16_bf16 v[80:83], v[48:49], v[52:53], v[80:83]
    ds_read_b128 v[32:35], v124 offset:6144
    ds_read_b128 v[36:39], v124 offset:7168
    ds_read_b128 v[40:43], v124 offset:34816
    ds_read_b128 v[44:47], v124 offset:35840
    ds_read_b128 v[56:59], v124 offset:36864
    ds_read_b128 v[64:67], v124 offset:38912
    ds_read_b128 v[68:71], v124 offset:39936
    s_waitcnt lgkmcnt(0)
    s_branch L_norm_27
L_kvw_29:
    s_add_u32 s47, s47, 1
    s_add_u32 s49, s49, 1
    s_cmp_ge_u32 s49, 0x10000
    s_cbranch_scc1 L_kvb_30
    s_sleep 4
    buffer_load_dword v125, v119, s[8:11], s28 offen sc1
    s_waitcnt vmcnt(0)
    v_cmp_eq_u32 vcc, 0, v125
    s_nop 0
    s_and_b64 vcc, vcc, s[58:59]
    s_cbranch_scc1 L_kvw_29
    s_branch L_kvb_30
L_mret_32:
    s_mov_b32 s43, m0
    s_mov_b32 m0, 6144
    buffer_load_dwordx4 v[4:7], v117, s[8:11], s48 offen sc1
    buffer_load_dwordx4 v117, s[8:11], s48 offen sc1 lds
    s_mov_b32 m0, 12288
    s_mov_b32 m0, s43
    s_waitcnt vmcnt(0)
    v_max3_u32 v15, v4, v5, v6
    v_max_u32 v15, v15, v7
    v_cmp_lt_u32 vcc, s56, v15
    s_add_u32 s47, s47, 1
    s_add_u32 s49, s49, 1
    s_cmp_ge_u32 s49, 0x10000
    s_cbranch_scc1 L_mgo_33
    s_cbranch_vccnz L_mret_32
    s_branch L_mgo_33
L_smax_35:
    s_add_u32 s47, s47, 1
    s_mov_b32 s35, 0x7f800000
    s_waitcnt lgkmcnt(0)
    s_sub_u32 s43, s30, 0x41000
    s_add_u32 s40, s43, 4096
    s_nop 7
    buffer_load_dwordx4 v[56:59], v117, s[8:11], s43 offen
    buffer_load_dwordx4 v[60:63], v117, s[8:11], s43 offen offset:1024
    buffer_load_dwordx4 v[64:67], v117, s[8:11], s43 offen offset:2048
    buffer_load_dwordx4 v[68:71], v117, s[8:11], s43 offen offset:3072
    buffer_load_dwordx4 v[72:75], v117, s[8:11], s40 offen
    buffer_load_dwordx4 v[76:79], v117, s[8:11], s40 offen offset:1024
    buffer_load_dwordx4 v[80:83], v117, s[8:11], s40 offen offset:2048
    buffer_load_dwordx4 v[84:87], v117, s[8:11], s40 offen offset:3072
    ds_read_b128 v[32:35], v121 offset:16384
    ds_read_b128 v[36:39], v121 offset:17408
    ds_read_b128 v[40:43], v121 offset:18432
    ds_read_b128 v[44:47], v121 offset:19456
    v_mov_b32 v96, 0
    v_mov_b32 v97, 0
    v_mov_b32 v98, 0
    v_mov_b32 v99, 0
    v_mov_b32 v100, 0
    v_mov_b32 v101, 0
    v_mov_b32 v102, 0
    v_mov_b32 v103, 0
    v_mov_b32 v104, 0
    v_mov_b32 v105, 0
    v_mov_b32 v106, 0
    v_mov_b32 v107, 0
    v_mov_b32 v108, 0
    v_mov_b32 v109, 0
    v_mov_b32 v110, 0
    v_mov_b32 v111, 0
    s_waitcnt vmcnt(0) lgkmcnt(0)
    v_mfma_f32_16x16x32_bf16 v[56:59], v[56:59], v[32:35], 0
    v_mfma_f32_16x16x32_bf16 v[56:59], v[60:63], v[36:39], v[56:59]
    v_mfma_f32_16x16x32_bf16 v[56:59], v[64:67], v[40:43], v[56:59]
    v_mfma_f32_16x16x32_bf16 v[56:59], v[68:71], v[44:47], v[56:59]
    v_mfma_f32_16x16x32_bf16 v[60:63], v[72:75], v[32:35], 0
    v_mfma_f32_16x16x32_bf16 v[60:63], v[76:79], v[36:39], v[60:63]
    v_mfma_f32_16x16x32_bf16 v[60:63], v[80:83], v[40:43], v[60:63]
    v_mfma_f32_16x16x32_bf16 v[60:63], v[84:87], v[44:47], v[60:63]
    v_mfma_f32_16x16x32_bf16 v[64:67], v[32:35], v[32:35], 0
    v_mfma_f32_16x16x32_bf16 v[64:67], v[36:39], v[36:39], v[64:67]
    v_mfma_f32_16x16x32_bf16 v[64:67], v[40:43], v[40:43], v[64:67]
    v_mfma_f32_16x16x32_bf16 v[64:67], v[44:47], v[44:47], v[64:67]
    v_max3_f32 v84, v56, v57, v58
    v_max3_f32 v84, v84, v59, v60
    v_max3_f32 v84, v84, v61, v62
    s_nop 4
    v_max3_f32 v84, v84, v63, v64
    v_max_f32 v84, v84, v65
    v_mov_b32 v85, v84
    s_nop 1
    v_permlane32_swap_b32 v85, v84
    v_max_f32 v84, v85, v84
    v_mov_b32 v85, v84
    s_nop 1
    v_permlane16_swap_b32 v85, v84
    v_max_f32 v84, v85, v84
    v_sub_f32 v56, v56, v84
    v_sub_f32 v57, v57, v84
    v_sub_f32 v58, v58, v84
    v_sub_f32 v59, v59, v84
    v_sub_f32 v60, v60, v84
    v_sub_f32 v61, v61, v84
    v_sub_f32 v62, v62, v84
    v_sub_f32 v63, v63, v84
    v_sub_f32 v64, v64, v84
    v_sub_f32 v65, v65, v84
    v_exp_f32 v56, v56
    v_exp_f32 v57, v57
    v_exp_f32 v58, v58
    v_exp_f32 v59, v59
    v_exp_f32 v60, v60
    v_exp_f32 v61, v61
    v_exp_f32 v62, v62
    v_exp_f32 v63, v63
    v_exp_f32 v64, v64
    v_exp_f32 v65, v65
    v_cvt_pk_bf16_f32 v68, v56, v57
    v_cvt_pk_bf16_f32 v69, v58, v59
    v_cvt_pk_bf16_f32 v70, v60, v61
    v_cvt_pk_bf16_f32 v71, v62, v63
    v_cvt_pk_bf16_f32 v52, v64, v65
    s_nop 0
    v_mfma_f32_16x16x32_bf16 v[72:75], v[88:91], v[68:71], 0
    v_mfma_f32_16x16x32_bf16 v[76:79], v[92:95], v[68:71], 0
    v_mfma_f32_16x16x32_bf16 v[80:83], v[48:51], v[68:71], 0
    v_mfma_f32_16x16x16_bf16 v[72:75], v[112:113], v[52:53], v[72:75]
    v_mfma_f32_16x16x16_bf16 v[76:79], v[114:115], v[52:53], v[76:79]
    v_mfma_f32_16x16x16_bf16 v[80:83], v[48:49], v[52:53], v[80:83]
    ds_read_b128 v[32:35], v124 offset:6144
    ds_read_b128 v[36:39], v124 offset:7168
    ds_read_b128 v[40:43], v124 offset:34816
    ds_read_b128 v[44:47], v124 offset:35840
    ds_read_b128 v[56:59], v124 offset:36864
    ds_read_b128 v[64:67], v124 offset:38912
    ds_read_b128 v[68:71], v124 offset:39936
    s_waitcnt lgkmcnt(0)
    s_branch L_norm_34
L_rslow_37:
    buffer_load_dwordx4 v[4:7], v117, s[8:11], s29 offen sc1
    buffer_load_dwordx4 v[8:11], v117, s[8:11], s53 offen sc1
    buffer_load_dwordx4 v[16:19], v117, s[8:11], s29 offen offset:2048 sc1
    buffer_load_dwordx4 v[20:23], v117, s[8:11], s53 offen offset:2048 sc1
    s_add_u32 s46, s46, 1
    s_add_u32 s49, s49, 1
    s_cmp_ge_u32 s49, 0x10000
    s_cbranch_scc1 L_rgo_38
    s_waitcnt vmcnt(7)
    v_mfma_f32_16x16x32_bf16 v[48:51], v[32:35], v[12:15], 0
    v_xor_b32 v52, s33, v32
    s_waitcnt vmcnt(6)
    v_mfma_f32_16x16x32_bf16 v[48:51], v[36:39], v[12:15], v[48:51]
    v_xor_b32 v53, s33, v36
    v_or_b32 v52, v52, v53
    s_waitcnt vmcnt(5)
    v_mfma_f32_16x16x32_bf16 v[48:51], v[40:43], v[12:15], v[48:51]
    v_xor_b32 v53, s33, v40
    v_or_b32 v52, v52, v53
    s_waitcnt vmcnt(4)
    v_mfma_f32_16x16x32_bf16 v[48:51], v[44:47], v[12:15], v[48:51]
    v_xor_b32 v53, s33, v44
    v_or_b32 v52, v52, v53
    v_and_b32 v52, 1, v52
    v_cmp_ne_u32 vcc, 0, v52
    s_cbranch_vccz L_rgo_38
    buffer_load_dwordx4 v[32:35], v117, s[8:11], s29 offen sc1
    buffer_load_dwordx4 v[36:39], v117, s[8:11], s53 offen sc1
    buffer_load_dwordx4 v[40:43], v117, s[8:11], s29 offen offset:2048 sc1
    buffer_load_dwordx4 v[44:47], v117, s[8:11], s53 offen offset:2048 sc1
    s_add_u32 s46, s46, 1
    s_branch L_rl_36
L_mret_40:
    s_mov_b32 s43, m0
    s_mov_b32 m0, 7168
    buffer_load_dwordx4 v[4:7], v117, s[8:11], s48 offen sc1
    buffer_load_dwordx4 v117, s[8:11], s48 offen sc1 lds
    s_mov_b32 m0, 14336
    s_mov_b32 m0, s43
    s_waitcnt vmcnt(0)
    v_max3_u32 v15, v4, v5, v6
    v_max_u32 v15, v15, v7
    v_cmp_lt_u32 vcc, s56, v15
    s_add_u32 s47, s47, 1
    s_add_u32 s49, s49, 1
    s_cmp_ge_u32 s49, 0x10000
    s_cbranch_scc1 L_mgo_41
    s_cbranch_vccnz L_mret_40
    s_branch L_mgo_41
L_smax_43:
    s_add_u32 s47, s47, 1
    s_mov_b32 s35, 0x7f800000
    s_waitcnt lgkmcnt(0)
    s_sub_u32 s43, s30, 0x41800
    s_add_u32 s40, s43, 4096
    s_nop 7
    buffer_load_dwordx4 v[56:59], v117, s[8:11], s43 offen
    buffer_load_dwordx4 v[60:63], v117, s[8:11], s43 offen offset:1024
    buffer_load_dwordx4 v[64:67], v117, s[8:11], s43 offen offset:2048
    buffer_load_dwordx4 v[68:71], v117, s[8:11], s43 offen offset:3072
    buffer_load_dwordx4 v[72:75], v117, s[8:11], s40 offen
    buffer_load_dwordx4 v[76:79], v117, s[8:11], s40 offen offset:1024
    buffer_load_dwordx4 v[80:83], v117, s[8:11], s40 offen offset:2048
    buffer_load_dwordx4 v[84:87], v117, s[8:11], s40 offen offset:3072
    ds_read_b128 v[32:35], v121 offset:16384
    ds_read_b128 v[36:39], v121 offset:17408
    ds_read_b128 v[40:43], v121 offset:18432
    ds_read_b128 v[44:47], v121 offset:19456
    v_mov_b32 v96, 0
    v_mov_b32 v97, 0
    v_mov_b32 v98, 0
    v_mov_b32 v99, 0
    v_mov_b32 v100, 0
    v_mov_b32 v101, 0
    v_mov_b32 v102, 0
    v_mov_b32 v103, 0
    v_mov_b32 v104, 0
    v_mov_b32 v105, 0
    v_mov_b32 v106, 0
    v_mov_b32 v107, 0
    v_mov_b32 v108, 0
    v_mov_b32 v109, 0
    v_mov_b32 v110, 0
    v_mov_b32 v111, 0
    s_waitcnt vmcnt(0) lgkmcnt(0)
    v_mfma_f32_16x16x32_bf16 v[56:59], v[56:59], v[32:35], 0
    v_mfma_f32_16x16x32_bf16 v[56:59], v[60:63], v[36:39], v[56:59]
    v_mfma_f32_16x16x32_bf16 v[56:59], v[64:67], v[40:43], v[56:59]
    v_mfma_f32_16x16x32_bf16 v[56:59], v[68:71], v[44:47], v[56:59]
    v_mfma_f32_16x16x32_bf16 v[60:63], v[72:75], v[32:35], 0
    v_mfma_f32_16x16x32_bf16 v[60:63], v[76:79], v[36:39], v[60:63]
    v_mfma_f32_16x16x32_bf16 v[60:63], v[80:83], v[40:43], v[60:63]
    v_mfma_f32_16x16x32_bf16 v[60:63], v[84:87], v[44:47], v[60:63]
    v_mfma_f32_16x16x32_bf16 v[64:67], v[32:35], v[32:35], 0
    v_mfma_f32_16x16x32_bf16 v[64:67], v[36:39], v[36:39], v[64:67]
    v_mfma_f32_16x16x32_bf16 v[64:67], v[40:43], v[40:43], v[64:67]
    v_mfma_f32_16x16x32_bf16 v[64:67], v[44:47], v[44:47], v[64:67]
    v_max3_f32 v84, v56, v57, v58
    v_max3_f32 v84, v84, v59, v60
    v_max3_f32 v84, v84, v61, v62
    s_nop 4
    v_max3_f32 v84, v84, v63, v64
    v_max_f32 v84, v84, v65
    v_mov_b32 v85, v84
    s_nop 1
    v_permlane32_swap_b32 v85, v84
    v_max_f32 v84, v85, v84
    v_mov_b32 v85, v84
    s_nop 1
    v_permlane16_swap_b32 v85, v84
    v_max_f32 v84, v85, v84
    v_sub_f32 v56, v56, v84
    v_sub_f32 v57, v57, v84
    v_sub_f32 v58, v58, v84
    v_sub_f32 v59, v59, v84
    v_sub_f32 v60, v60, v84
    v_sub_f32 v61, v61, v84
    v_sub_f32 v62, v62, v84
    v_sub_f32 v63, v63, v84
    v_sub_f32 v64, v64, v84
    v_sub_f32 v65, v65, v84
    v_exp_f32 v56, v56
    v_exp_f32 v57, v57
    v_exp_f32 v58, v58
    v_exp_f32 v59, v59
    v_exp_f32 v60, v60
    v_exp_f32 v61, v61
    v_exp_f32 v62, v62
    v_exp_f32 v63, v63
    v_exp_f32 v64, v64
    v_exp_f32 v65, v65
    v_cvt_pk_bf16_f32 v68, v56, v57
    v_cvt_pk_bf16_f32 v69, v58, v59
    v_cvt_pk_bf16_f32 v70, v60, v61
    v_cvt_pk_bf16_f32 v71, v62, v63
    v_cvt_pk_bf16_f32 v52, v64, v65
    s_nop 0
    v_mfma_f32_16x16x32_bf16 v[72:75], v[88:91], v[68:71], 0
    v_mfma_f32_16x16x32_bf16 v[76:79], v[92:95], v[68:71], 0
    v_mfma_f32_16x16x32_bf16 v[80:83], v[48:51], v[68:71], 0
    v_mfma_f32_16x16x16_bf16 v[72:75], v[112:113], v[52:53], v[72:75]
    v_mfma_f32_16x16x16_bf16 v[76:79], v[114:115], v[52:53], v[76:79]
    v_mfma_f32_16x16x16_bf16 v[80:83], v[48:49], v[52:53], v[80:83]
    ds_read_b128 v[32:35], v124 offset:6144
    ds_read_b128 v[36:39], v124 offset:7168
    ds_read_b128 v[40:43], v124 offset:34816
    ds_read_b128 v[44:47], v124 offset:35840
    ds_read_b128 v[56:59], v124 offset:36864
    ds_read_b128 v[64:67], v124 offset:38912
    ds_read_b128 v[68:71], v124 offset:39936
    s_waitcnt lgkmcnt(0)
    s_branch L_norm_42
L_rslow_45:
    buffer_load_dwordx4 v[4:7], v117, s[8:11], s29 offen sc1
    buffer_load_dwordx4 v[8:11], v117, s[8:11], s53 offen sc1
    buffer_load_dwordx4 v[16:19], v117, s[8:11], s29 offen offset:2048 sc1
    buffer_load_dwordx4 v[20:23], v117, s[8:11], s53 offen offset:2048 sc1
    s_add_u32 s46, s46, 1
    s_add_u32 s49, s49, 1
    s_cmp_ge_u32 s49, 0x10000
    s_cbranch_scc1 L_rgo_46
    s_waitcnt vmcnt(7)
    v_mfma_f32_16x16x32_bf16 v[48:51], v[32:35], v[12:15], 0
    v_xor_b32 v52, s33, v32
    s_waitcnt vmcnt(6)
    v_mfma_f32_16x16x32_bf16 v[48:51], v[36:39], v[12:15], v[48:51]
    v_xor_b32 v53, s33, v36
    v_or_b32 v52, v52, v53
    s_waitcnt vmcnt(5)
    v_mfma_f32_16x16x32_bf16 v[48:51], v[40:43], v[12:15], v[48:51]
    v_xor_b32 v53, s33, v40
    v_or_b32 v52, v52, v53
    s_waitcnt vmcnt(4)
    v_mfma_f32_16x16x32_bf16 v[48:51], v[44:47], v[12:15], v[48:51]
    v_xor_b32 v53, s33, v44
    v_or_b32 v52, v52, v53
    v_and_b32 v52, 1, v52
    v_cmp_ne_u32 vcc, 0, v52
    s_cbranch_vccz L_rgo_46
    buffer_load_dwordx4 v[32:35], v117, s[8:11], s29 offen sc1
    buffer_load_dwordx4 v[36:39], v117, s[8:11], s53 offen sc1
    buffer_load_dwordx4 v[40:43], v117, s[8:11], s29 offen offset:2048 sc1
    buffer_load_dwordx4 v[44:47], v117, s[8:11], s53 offen offset:2048 sc1
    s_add_u32 s46, s46, 1
    s_branch L_rl_44
L_zero:
    s_waitcnt lgkmcnt(0)
    s_and_b32 s9, s9, 0xffff
    s_mov_b32 s10, 0x10000000
    s_mov_b32 s11, 0x20000
    s_and_b32 s93, s93, 0xffff
    s_mov_b32 s94, 0x100
    s_mov_b32 s95, 0x20000
    s_mov_b32 s87, 0
    s_cmp_lg_u32 s86, 0
    s_cbranch_scc1 L_reg_47
    s_lshl_b32 s97, s84, 4
    s_lshl_b32 s96, 1, s85
    v_mov_b32 v250, s96
    v_mov_b32 v251, 256
    s_mov_b64 exec, 1
    buffer_atomic_add_x2 v[250:251], off, s[92:95], s97 offset:64
    s_mov_b64 exec, -1
    s_mov_b32 s86, 1
L_reg_47:
    v_mov_b32 v4, 0
    v_mov_b32 v5, 0
    v_mov_b32 v6, 0
    v_mov_b32 v7, 0
    v_lshlrev_b32 v1, 4, v0
    s_mov_b32 s97, 0x0
    buffer_store_dwordx4 v[4:7], v1, s[8:11], s97 offen sc1
    s_mov_b32 s97, 0x1000
    buffer_store_dwordx4 v[4:7], v1, s[8:11], s97 offen sc1
    s_mov_b32 s97, 0x2000
    buffer_store_dwordx4 v[4:7], v1, s[8:11], s97 offen sc1
    s_mov_b32 s97, 0x3000
    buffer_store_dwordx4 v[4:7], v1, s[8:11], s97 offen sc1
    s_mov_b32 s97, 0x4000
    buffer_store_dwordx4 v[4:7], v1, s[8:11], s97 offen sc1
    s_mov_b32 s97, 0x5000
    buffer_store_dwordx4 v[4:7], v1, s[8:11], s97 offen sc1
    s_mov_b32 s97, 0x6000
    buffer_store_dwordx4 v[4:7], v1, s[8:11], s97 offen sc1
    s_mov_b32 s97, 0x7000
    buffer_store_dwordx4 v[4:7], v1, s[8:11], s97 offen sc1
    s_mov_b32 s97, 0x8000
    buffer_store_dwordx4 v[4:7], v1, s[8:11], s97 offen sc1
    s_mov_b32 s97, 0x9000
    buffer_store_dwordx4 v[4:7], v1, s[8:11], s97 offen sc1
    s_mov_b32 s97, 0xa000
    buffer_store_dwordx4 v[4:7], v1, s[8:11], s97 offen sc1
    s_waitcnt vmcnt(0)
    s_barrier
    s_cmp_lg_u32 s100, 0
    s_cbranch_scc1 L_flag_48
    v_mov_b32 v2, 1
    s_mov_b64 exec, 1
    buffer_store_dword v2, off, s[92:95], 40 sc1
    s_mov_b64 exec, -1
L_flag_48:
    s_cmp_lg_u32 s100, 0
    s_cbranch_scc1 L_noz
    s_mov_b64 exec, 0xff
    s_mov_b32 s96, 0
L_count:
    buffer_load_dwordx2 v[2:3], v1, s[92:95], 0 offen offset:64 sc1
    s_waitcnt vmcnt(0)
    v_cmp_le_u32 vcc, 8192, v3
    v_add_u32 v2, 1, v2
    v_xor_b32 v3, 8192, v3
    v_or_b32 v2, v2, v3
    s_mov_b32 s4, vcc_lo
    v_cmp_eq_u32 vcc, 0, v2
    v_mov_b32 v2, 1
    s_nop 1
    s_cmp_eq_u32 vcc_lo, 0xff
    s_cbranch_scc1 L_propose
    v_mov_b32 v2, 2
    s_andn2_b32 s4, s4, vcc_lo
    s_cbranch_scc1 L_propose
    s_sleep 2
    s_add_u32 s96, s96, 1
    s_cmp_lt_u32 s96, 0x100
    s_cbranch_scc1 L_count
L_propose:
    v_mov_b32 v3, 0
    s_mov_b64 exec, 1
    buffer_atomic_cmpswap v[2:3], off, s[92:95], 0 offset:36
    s_mov_b64 exec, -1
    s_branch L_noz
L_fallback:
    s_mov_b32 s87, 2
    s_waitcnt vmcnt(0) lgkmcnt(0)
    s_barrier
    v_mbcnt_lo_u32_b32 v0, -1, 0
    v_mbcnt_hi_u32_b32 v0, -1, v0
    s_lshl_b32 s96, s100, 6
    v_add_u32 v0, s96, v0
    s_mov_b32 s97, 44
    s_cmp_lg_u32 s100, 0
    s_cbranch_scc1 L_at_49
    s_mov_b64 exec, 1
    v_mov_b32 v2, 1
    buffer_atomic_add v2, off, s[92:95], s97 sc0
    s_mov_b64 exec, -1
L_at_49:
    s_cmp_lg_u32 s100, 0
    s_cbranch_scc1 L_at2_50
    s_mov_b64 exec, 1
    v_mov_b32 v1, 8
    s_waitcnt vmcnt(0)
    ds_write_b32 v1, v2
    s_waitcnt lgkmcnt(0)
    s_mov_b64 exec, -1
L_at2_50:
    s_barrier
    v_mov_b32 v1, 8
    ds_read_b32 v2, v1
    s_waitcnt lgkmcnt(0)
    v_readfirstlane_b32 s85, v2
    s_barrier
    s_sub_u32 s101, s85, 32
    s_cmp_ge_u32 s85, 32
    s_cbranch_scc1 L_bulk
    s_mov_b32 s20, s85
    v_lshrrev_b32 v4, 6, v0
    s_nop 0
    v_readfirstlane_b32 s21, v4
    v_and_b32 v1, 63, v0
    v_lshrrev_b32 v2, 4, v1
    v_and_b32 v3, 15, v1
    v_lshrrev_b32 v6, 2, v3
    v_lshlrev_b32 v117, 4, v1
    s_lshl_b32 s51, s21, 10
    s_lshl_b32 s52, s21, 11
    s_load_dwordx8 s[60:67], s[0:1], 16
    s_mov_b32 s14, 0x400000
    s_mov_b32 s15, 0x20000
    s_lshl_b32 s41, s20, 8
    s_lshl_b32 s42, s20, 17
    s_lshr_b32 s43, s21, 1
    s_lshl_b32 s43, s43, 2
    v_or_b32 v5, s43, v2
    v_lshlrev_b32 v5, 1, v5
    v_xor_b32 v5, v5, v3
    v_lshrrev_b32 v14, 2, v5
    v_and_b32 v14, 2, v14
    v_lshlrev_b32 v5, 4, v5
    s_lshl_b32 s43, s21, 4
    v_add_u32 v4, s43, v2
    v_lshl_add_u32 v8, v4, 13, v5
    s_waitcnt lgkmcnt(0)
    s_mov_b32 s16, s92
    s_mov_b32 s17, s93
    s_mov_b32 s18, s94
    s_mov_b32 s19, s95
    s_mov_b32 s88, s20
    s_mov_b32 s12, s60
    s_and_b32 s13, s61, 0xffff
    v_xor_b32 v15, 0, v14
    v_lshl_add_u32 v15, v15, 15, v8
    s_add_u32 s43, s41, 0x0
    s_add_u32 m0, s51, 0x8000
    s_nop 0
    buffer_load_dwordx4 v15, s[12:15], s43 offen nt lds
    s_add_u32 s43, s41, 0x8000
    s_add_u32 m0, s51, 0x9000
    s_nop 0
    buffer_load_dwordx4 v15, s[12:15], s43 offen nt lds
    s_add_u32 s43, s41, 0x100000
    s_add_u32 m0, s51, 0xa000
    s_nop 0
    buffer_load_dwordx4 v15, s[12:15], s43 offen nt lds
    s_add_u32 s43, s41, 0x108000
    s_add_u32 m0, s51, 0xb000
    s_nop 0
    buffer_load_dwordx4 v15, s[12:15], s43 offen nt lds
    s_add_u32 s43, s41, 0x200000
    s_add_u32 m0, s51, 0xc000
    s_nop 0
    buffer_load_dwordx4 v15, s[12:15], s43 offen nt lds
    s_add_u32 s43, s41, 0x208000
    s_add_u32 m0, s51, 0xd000
    s_nop 0
    buffer_load_dwordx4 v15, s[12:15], s43 offen nt lds
    s_add_u32 s43, s41, 0x300000
    s_add_u32 m0, s51, 0xe000
    s_nop 0
    buffer_load_dwordx4 v15, s[12:15], s43 offen nt lds
    s_add_u32 s43, s41, 0x308000
    s_add_u32 m0, s51, 0xf000
    s_nop 0
    buffer_load_dwordx4 v15, s[12:15], s43 offen nt lds
    v_xor_b32 v15, 2, v14
    v_lshl_add_u32 v15, v15, 15, v8
    s_add_u32 s43, s41, 0x0
    s_add_u32 m0, s51, 0x10000
    s_nop 0
    buffer_load_dwordx4 v15, s[12:15], s43 offen nt lds
    s_add_u32 s43, s41, 0x8000
    s_add_u32 m0, s51, 0x11000
    s_nop 0
    buffer_load_dwordx4 v15, s[12:15], s43 offen nt lds
    s_add_u32 s43, s41, 0x100000
    s_add_u32 m0, s51, 0x12000
    s_nop 0
    buffer_load_dwordx4 v15, s[12:15], s43 offen nt lds
    s_add_u32 s43, s41, 0x108000
    s_add_u32 m0, s51, 0x13000
    s_nop 0
    buffer_load_dwordx4 v15, s[12:15], s43 offen nt lds
    s_add_u32 s43, s41, 0x200000
    s_add_u32 m0, s51, 0x14000
    s_nop 0
    buffer_load_dwordx4 v15, s[12:15], s43 offen nt lds
    s_add_u32 s43, s41, 0x208000
    s_add_u32 m0, s51, 0x15000
    s_nop 0
    buffer_load_dwordx4 v15, s[12:15], s43 offen nt lds
    s_add_u32 s43, s41, 0x300000
    s_add_u32 m0, s51, 0x16000
    s_nop 0
    buffer_load_dwordx4 v15, s[12:15], s43 offen nt lds
    s_add_u32 s43, s41, 0x308000
    s_add_u32 m0, s51, 0x17000
    s_nop 0
    buffer_load_dwordx4 v15, s[12:15], s43 offen nt lds
    v_xor_b32 v15, 0, v14
    v_lshl_add_u32 v15, v15, 15, v8
    s_add_u32 s43, s41, 0x80000
    s_add_u32 m0, s51, 0x18000
    s_nop 0
    buffer_load_dwordx4 v15, s[12:15], s43 offen nt lds
    s_add_u32 s43, s41, 0x88000
    s_add_u32 m0, s51, 0x19000
    s_nop 0
    buffer_load_dwordx4 v15, s[12:15], s43 offen nt lds
    s_add_u32 s43, s41, 0x180000
    s_add_u32 m0, s51, 0x1a000
    s_nop 0
    buffer_load_dwordx4 v15, s[12:15], s43 offen nt lds
    s_add_u32 s43, s41, 0x188000
    s_add_u32 m0, s51, 0x1b000
    s_nop 0
    buffer_load_dwordx4 v15, s[12:15], s43 offen nt lds
    v_and_b32 v4, 2, v3
    v_cmp_ne_u32 vcc, 0, v4
    v_mov_b32 v4, 0x4444
    v_mov_b32 v5, 0xeeee
    v_cndmask_b32 v116, v4, v5, vcc
    v_lshrrev_b32 v5, 1, v2
    v_lshl_add_u32 v4, v6, 3, v5
    s_lshl_b32 s43, s21, 1
    v_add_u32 v4, s43, v4
    v_add_u32 v5, s20, v4
    v_and_b32 v5, 31, v5
    v_lshl_add_u32 v4, v4, 6, v5
    v_and_b32 v5, 1, v2
    v_lshl_add_u32 v4, v4, 1, v5
    v_and_b32 v5, 3, v3
    v_lshl_add_u32 v4, v4, 2, v5
    v_lshlrev_b32 v118, 4, v4
    v_and_b32 v4, 1, v2
    v_lshlrev_b32 v4, 2, v4
    v_and_b32 v7, 2, v2
    v_add_u32 v4, v4, v7
    v_and_b32 v7, 1, v6
    v_add_u32 v4, v4, v7
    v_lshl_add_u32 v4, v4, 2, v5
    v_lshlrev_b32 v4, 2, v4
    s_and_b32 s43, s21, 1
    s_lshl_b32 s43, s43, 12
    s_lshl_b32 s40, s20, 7
    s_add_u32 s43, s43, s40
    v_add_u32 v119, s43, v4
    v_sub_u32 v7, 0, v2
    v_and_b32 v7, 3, v7
    v_xor_b32 v7, v7, v6
    v_lshl_add_u32 v4, v2, 4, v7
    v_and_b32 v5, 3, v3
    v_lshl_add_u32 v4, v4, 2, v5
    s_add_u32 s43, s51, 16384
    v_lshl_add_u32 v120, v4, 2, s43
    v_sub_u32 v7, 0, v6
    v_and_b32 v7, 3, v7
    v_xor_b32 v7, v7, v2
    v_lshl_add_u32 v4, v3, 2, v7
    v_lshlrev_b32 v121, 4, v4
    v_and_b32 v5, 1, v3
    v_lshl_add_u32 v4, v6, 1, v5
    v_lshl_add_u32 v4, v2, 3, v4
    v_lshlrev_b32 v127, 4, v4
    v_and_or_b32 v122, v116, 8, v127
    s_lshl_b32 s43, s21, 13
    s_add_u32 s43, s43, 32768
    v_add_u32 v123, s43, v117
    v_add_u32 v124, 0x10000, v123
    s_mov_b32 s36, 0xcccccccc
    s_mov_b32 s37, 0xcccccccc
    s_mov_b32 s38, 0x00ff00ff
    s_mov_b32 s39, 0x00ff00ff
    s_mov_b32 s34, 0x3e0293ee
    s_mov_b32 s35, 0x49800000
    s_mov_b32 s50, 0x3f803f80
    v_and_b32 v5, 1, v2
    v_or_b32 v5, 0, v5
    v_xor_b32 v5, v5, v6
    v_and_b32 v7, 2, v5
    v_add_u32 v5, v5, v7
    v_lshlrev_b32 v5, 6, v5
    v_and_b32 v7, 3, v3
    v_lshl_add_u32 v7, v7, 4, v5
    s_lshl_b32 s43, s21, 2
    v_add_u32 v4, s43, v2
    v_lshl_add_u32 v10, v4, 10, v7
    v_and_b32 v5, 1, v2
    v_or_b32 v5, 2, v5
    v_xor_b32 v5, v5, v6
    v_and_b32 v7, 2, v5
    v_add_u32 v5, v5, v7
    v_lshlrev_b32 v5, 6, v5
    v_and_b32 v7, 3, v3
    v_lshl_add_u32 v7, v7, 4, v5
    s_lshl_b32 s43, s21, 2
    v_add_u32 v4, s43, v2
    v_lshl_add_u32 v9, v4, 10, v7
    v_and_b32 v5, 1, v2
    v_lshl_add_u32 v4, v5, 3, v6
    v_lshrrev_b32 v7, 1, v2
    v_lshl_add_u32 v4, v7, 5, v4
    v_lshlrev_b32 v4, 8, v4
    v_lshl_or_b32 v5, v5, 2, v6
    v_lshlrev_b32 v5, 5, v5
    s_lshl_b32 s43, s21, 6
    v_xor_b32 v5, s43, v5
    v_add_u32 v4, v4, v5
    v_and_b32 v5, 3, v3
    v_lshl_add_u32 v4, v5, 3, v4
    v_add_u32 v11, 32768, v4
    s_and_b32 s43, s21, 1
    s_lshl_b32 s43, s43, 12
    v_add_u32 v11, s43, v11
    v_and_b32 v5, 1, v2
    v_lshlrev_b32 v4, 4, v5
    v_lshl_add_u32 v4, v7, 2, v4
    v_and_b32 v7, 1, v6
    v_add_u32 v4, v4, v7
    s_lshl_b32 s43, s21, 5
    v_add_u32 v4, s43, v4
    v_lshlrev_b32 v4, 8, v4
    v_lshl_or_b32 v5, v5, 1, v7
    s_lshl_b32 s43, s21, 1
    s_and_b32 s43, s43, 3
    v_xor_b32 v5, s43, v5
    v_lshl_add_u32 v4, v5, 6, v4
    v_lshrrev_b32 v5, 1, v6
    v_lshl_add_u32 v4, v5, 5, v4
    v_and_b32 v5, 3, v3
    v_lshl_add_u32 v4, v5, 3, v4
    v_add_u32 v12, 32768, v4
    v_mov_b32 v16, -1
    v_mov_b32 v17, -1
    v_mov_b32 v18, -1
    v_mov_b32 v19, -1
    s_lshl_b32 s43, s20, 13
    s_add_u32 s43, s43, 0x7100000
    s_and_b32 s40, s21, 1
    s_lshl_b32 s40, s40, 12
    s_add_u32 s29, s43, s40
    s_add_u32 s43, s43, s52
    s_xor_b32 s40, s43, 0x0
    buffer_store_dwordx4 v[16:19], v117, s[8:11], s43 offen sc1
    buffer_store_dwordx4 v[16:19], v117, s[8:11], s43 offen offset:1024 sc1
    s_mov_b32 s43, 0x7012000
    buffer_store_dword v16, v119, s[8:11], s43 offen sc1
    s_mov_b32 s43, 0x7014000
    buffer_store_dword v16, v119, s[8:11], s43 offen sc1
    s_mov_b32 s43, 0x7016000
    buffer_store_dword v16, v119, s[8:11], s43 offen sc1
    s_load_dwordx2 s[4:5], s[0:1], 8
    s_waitcnt lgkmcnt(0)
    s_and_b32 s5, s5, 0xffff
    s_mov_b32 s6, 8192
    s_mov_b32 s7, 0x20000
    v_and_b32 v20, 1, v2
    v_and_b32 v21, 1, v6
    v_lshl_add_u32 v20, v20, 1, v21
    v_lshlrev_b32 v20, 9, v20
    v_and_b32 v21, 3, v3
    v_lshl_add_u32 v20, v21, 4, v20
    v_and_b32 v21, 2, v2
    v_add_u32 v20, v20, v21
    s_and_b32 s43, s20, 1
    s_lshl_b32 s43, s43, 11
    s_bfe_u32 s40, s20, 0x20001
    s_lshl_b32 s40, s40, 7
    s_add_u32 s43, s43, s40
    s_and_b32 s40, s21, 1
    s_lshl_b32 s40, s40, 6
    s_add_u32 s43, s43, s40
    s_lshr_b32 s40, s20, 3
    s_lshl_b32 s40, s40, 2
    s_add_u32 s43, s43, s40
    v_add_u32 v20, s43, v20
    v_lshlrev_b32 v20, 1, v20
    buffer_load_dword v21, v20, s[4:7], 0 offen
    s_mov_b32 s57, 0
    s_lshl_b32 s43, s20, 13
    s_add_u32 s43, s43, s52
    s_add_u32 s30, s43, 0x1000000
    s_add_u32 s31, s43, 0x2000000
    s_lshr_b32 s43, s43, 1
    s_add_u32 s32, s43, 0x220000
    s_waitcnt vmcnt(18)
    s_barrier
    v_xor_b32 v13, 0x0, v11
    v_add_u32 v13, 0x0, v13
    ds_read_b64_tr_b16 v[80:81], v13
    ds_read_b64_tr_b16 v[82:83], v13 offset:1024
    ds_read_b64_tr_b16 v[84:85], v13 offset:16384
    ds_read_b64_tr_b16 v[86:87], v13 offset:17408
    v_xor_b32 v13, 0x20, v11
    v_add_u32 v13, 0x0, v13
    ds_read_b64_tr_b16 v[56:57], v13
    ds_read_b64_tr_b16 v[58:59], v13 offset:1024
    ds_read_b64_tr_b16 v[60:61], v13 offset:16384
    ds_read_b64_tr_b16 v[62:63], v13 offset:17408
    v_xor_b32 v13, 0x1000, v11
    v_add_u32 v13, 0x0, v13
    ds_read_b64_tr_b16 a[0:1], v13
    ds_read_b64_tr_b16 a[2:3], v13 offset:1024
    ds_read_b64_tr_b16 a[4:5], v13 offset:16384
    ds_read_b64_tr_b16 a[6:7], v13 offset:17408
    v_xor_b32 v13, 0x1020, v11
    v_add_u32 v13, 0x0, v13
    ds_read_b64_tr_b16 a[8:9], v13
    ds_read_b64_tr_b16 a[10:11], v13 offset:1024
    ds_read_b64_tr_b16 a[12:13], v13 offset:16384
    ds_read_b64_tr_b16 a[14:15], v13 offset:17408
    s_waitcnt lgkmcnt(0)
    s_barrier
    s_add_u32 s43, s41, 0x280000
    s_add_u32 m0, s51, 0x1c000
    s_nop 0
    buffer_load_dwordx4 v15, s[12:15], s43 offen nt lds
    s_add_u32 s43, s41, 0x288000
    s_add_u32 m0, s51, 0x1d000
    s_nop 0
    buffer_load_dwordx4 v15, s[12:15], s43 offen nt lds
    s_add_u32 s43, s41, 0x380000
    s_add_u32 m0, s51, 0x1e000
    s_nop 0
    buffer_load_dwordx4 v15, s[12:15], s43 offen nt lds
    s_add_u32 s43, s41, 0x388000
    s_add_u32 m0, s51, 0x1f000
    s_nop 0
    buffer_load_dwordx4 v15, s[12:15], s43 offen nt lds
    v_xor_b32 v15, 2, v14
    v_lshl_add_u32 v15, v15, 15, v8
    s_add_u32 s43, s41, 0x80000
    s_add_u32 m0, s51, 0x20000
    s_nop 0
    buffer_load_dwordx4 v15, s[12:15], s43 offen nt lds
    s_add_u32 s43, s41, 0x88000
    s_add_u32 m0, s51, 0x21000
    s_nop 0
    buffer_load_dwordx4 v15, s[12:15], s43 offen nt lds
    s_add_u32 s43, s41, 0x180000
    s_add_u32 m0, s51, 0x22000
    s_nop 0
    buffer_load_dwordx4 v15, s[12:15], s43 offen nt lds
    s_add_u32 s43, s41, 0x188000
    s_add_u32 m0, s51, 0x23000
    s_nop 0
    buffer_load_dwordx4 v15, s[12:15], s43 offen nt lds
    s_waitcnt vmcnt(18)
    s_barrier
    v_xor_b32 v13, 0x0, v11
    v_add_u32 v13, 0x8000, v13
    ds_read_b64_tr_b16 a[32:33], v13
    ds_read_b64_tr_b16 a[34:35], v13 offset:1024
    ds_read_b64_tr_b16 a[36:37], v13 offset:16384
    ds_read_b64_tr_b16 a[38:39], v13 offset:17408
    v_xor_b32 v13, 0x20, v11
    v_add_u32 v13, 0x8000, v13
    ds_read_b64_tr_b16 a[40:41], v13
    ds_read_b64_tr_b16 a[42:43], v13 offset:1024
    ds_read_b64_tr_b16 a[44:45], v13 offset:16384
    ds_read_b64_tr_b16 a[46:47], v13 offset:17408
    v_xor_b32 v13, 0x1000, v11
    v_add_u32 v13, 0x8000, v13
    ds_read_b64_tr_b16 a[64:65], v13
    ds_read_b64_tr_b16 a[66:67], v13 offset:1024
    ds_read_b64_tr_b16 a[68:69], v13 offset:16384
    ds_read_b64_tr_b16 a[70:71], v13 offset:17408
    v_xor_b32 v13, 0x1020, v11
    v_add_u32 v13, 0x8000, v13
    ds_read_b64_tr_b16 a[72:73], v13
    ds_read_b64_tr_b16 a[74:75], v13 offset:1024
    ds_read_b64_tr_b16 a[76:77], v13 offset:16384
    ds_read_b64_tr_b16 a[78:79], v13 offset:17408
    s_waitcnt lgkmcnt(0)
    s_barrier
    s_add_u32 s43, s41, 0x280000
    s_add_u32 m0, s51, 0x24000
    s_nop 0
    buffer_load_dwordx4 v15, s[12:15], s43 offen nt lds
    s_add_u32 s43, s41, 0x288000
    s_add_u32 m0, s51, 0x25000
    s_nop 0
    buffer_load_dwordx4 v15, s[12:15], s43 offen nt lds
    s_add_u32 s43, s41, 0x380000
    s_add_u32 m0, s51, 0x26000
    s_nop 0
    buffer_load_dwordx4 v15, s[12:15], s43 offen nt lds
    s_add_u32 s43, s41, 0x388000
    s_add_u32 m0, s51, 0x27000
    s_nop 0
    buffer_load_dwordx4 v15, s[12:15], s43 offen nt lds
    s_mov_b32 s12, s62
    s_and_b32 s13, s63, 0xffff
    v_xor_b32 v15, 0, v14
    v_lshl_add_u32 v15, v15, 15, v8
    s_add_u32 s43, s41, 0x0
    s_add_u32 m0, s51, 0x8000
    s_nop 0
    buffer_load_dwordx4 v15, s[12:15], s43 offen nt lds
    s_add_u32 s43, s41, 0x8000
    s_add_u32 m0, s51, 0x9000
    s_nop 0
    buffer_load_dwordx4 v15, s[12:15], s43 offen nt lds
    s_add_u32 s43, s41, 0x100000
    s_add_u32 m0, s51, 0xa000
    s_nop 0
    buffer_load_dwordx4 v15, s[12:15], s43 offen nt lds
    s_add_u32 s43, s41, 0x108000
    s_add_u32 m0, s51, 0xb000
    s_nop 0
    buffer_load_dwordx4 v15, s[12:15], s43 offen nt lds
    s_waitcnt vmcnt(12)
    s_barrier
    v_xor_b32 v13, 0x0, v11
    v_add_u32 v13, 0x10000, v13
    ds_read_b64_tr_b16 v[88:89], v13
    ds_read_b64_tr_b16 v[90:91], v13 offset:1024
    ds_read_b64_tr_b16 v[92:93], v13 offset:16384
    ds_read_b64_tr_b16 v[94:95], v13 offset:17408
    v_xor_b32 v13, 0x20, v11
    v_add_u32 v13, 0x10000, v13
    ds_read_b64_tr_b16 v[96:97], v13
    ds_read_b64_tr_b16 v[98:99], v13 offset:1024
    ds_read_b64_tr_b16 v[100:101], v13 offset:16384
    ds_read_b64_tr_b16 v[102:103], v13 offset:17408
    v_xor_b32 v13, 0x1000, v11
    v_add_u32 v13, 0x10000, v13
    ds_read_b64_tr_b16 a[16:17], v13
    ds_read_b64_tr_b16 a[18:19], v13 offset:1024
    ds_read_b64_tr_b16 a[20:21], v13 offset:16384
    ds_read_b64_tr_b16 a[22:23], v13 offset:17408
    v_xor_b32 v13, 0x1020, v11
    v_add_u32 v13, 0x10000, v13
    ds_read_b64_tr_b16 a[24:25], v13
    ds_read_b64_tr_b16 a[26:27], v13 offset:1024
    ds_read_b64_tr_b16 a[28:29], v13 offset:16384
    ds_read_b64_tr_b16 a[30:31], v13 offset:17408
    s_waitcnt lgkmcnt(0)
    s_barrier
    s_add_u32 s43, s41, 0x200000
    s_add_u32 m0, s51, 0xc000
    s_nop 0
    buffer_load_dwordx4 v15, s[12:15], s43 offen nt lds
    s_add_u32 s43, s41, 0x208000
    s_add_u32 m0, s51, 0xd000
    s_nop 0
    buffer_load_dwordx4 v15, s[12:15], s43 offen nt lds
    s_add_u32 s43, s41, 0x300000
    s_add_u32 m0, s51, 0xe000
    s_nop 0
    buffer_load_dwordx4 v15, s[12:15], s43 offen nt lds
    s_add_u32 s43, s41, 0x308000
    s_add_u32 m0, s51, 0xf000
    s_nop 0
    buffer_load_dwordx4 v15, s[12:15], s43 offen nt lds
    v_xor_b32 v15, 2, v14
    v_lshl_add_u32 v15, v15, 15, v8
    s_add_u32 s43, s41, 0x0
    s_add_u32 m0, s51, 0x10000
    s_nop 0
    buffer_load_dwordx4 v15, s[12:15], s43 offen nt lds
    s_add_u32 s43, s41, 0x8000
    s_add_u32 m0, s51, 0x11000
    s_nop 0
    buffer_load_dwordx4 v15, s[12:15], s43 offen nt lds
    s_add_u32 s43, s41, 0x100000
    s_add_u32 m0, s51, 0x12000
    s_nop 0
    buffer_load_dwordx4 v15, s[12:15], s43 offen nt lds
    s_add_u32 s43, s41, 0x108000
    s_add_u32 m0, s51, 0x13000
    s_nop 0
    buffer_load_dwordx4 v15, s[12:15], s43 offen nt lds
    s_waitcnt vmcnt(12)
    s_barrier
    v_xor_b32 v13, 0x0, v11
    v_add_u32 v13, 0x18000, v13
    ds_read_b64_tr_b16 a[48:49], v13
    ds_read_b64_tr_b16 a[50:51], v13 offset:1024
    ds_read_b64_tr_b16 a[52:53], v13 offset:16384
    ds_read_b64_tr_b16 a[54:55], v13 offset:17408
    v_xor_b32 v13, 0x20, v11
    v_add_u32 v13, 0x18000, v13
    ds_read_b64_tr_b16 a[56:57], v13
    ds_read_b64_tr_b16 a[58:59], v13 offset:1024
    ds_read_b64_tr_b16 a[60:61], v13 offset:16384
    ds_read_b64_tr_b16 a[62:63], v13 offset:17408
    v_xor_b32 v13, 0x1000, v11
    v_add_u32 v13, 0x18000, v13
    ds_read_b64_tr_b16 a[80:81], v13
    ds_read_b64_tr_b16 a[82:83], v13 offset:1024
    ds_read_b64_tr_b16 a[84:85], v13 offset:16384
    ds_read_b64_tr_b16 a[86:87], v13 offset:17408
    v_xor_b32 v13, 0x1020, v11
    v_add_u32 v13, 0x18000, v13
    ds_read_b64_tr_b16 a[88:89], v13
    ds_read_b64_tr_b16 a[90:91], v13 offset:1024
    ds_read_b64_tr_b16 a[92:93], v13 offset:16384
    ds_read_b64_tr_b16 a[94:95], v13 offset:17408
    s_waitcnt lgkmcnt(0)
    s_barrier
    s_add_u32 s43, s41, 0x200000
    s_add_u32 m0, s51, 0x14000
    s_nop 0
    buffer_load_dwordx4 v15, s[12:15], s43 offen nt lds
    s_add_u32 s43, s41, 0x208000
    s_add_u32 m0, s51, 0x15000
    s_nop 0
    buffer_load_dwordx4 v15, s[12:15], s43 offen nt lds
    s_add_u32 s43, s41, 0x300000
    s_add_u32 m0, s51, 0x16000
    s_nop 0
    buffer_load_dwordx4 v15, s[12:15], s43 offen nt lds
    s_add_u32 s43, s41, 0x308000
    s_add_u32 m0, s51, 0x17000
    s_nop 0
    buffer_load_dwordx4 v15, s[12:15], s43 offen nt lds
    v_xor_b32 v15, 0, v14
    v_lshl_add_u32 v15, v15, 15, v8
    s_add_u32 s43, s41, 0x80000
    s_add_u32 m0, s51, 0x18000
    s_nop 0
    buffer_load_dwordx4 v15, s[12:15], s43 offen nt lds
    s_add_u32 s43, s41, 0x88000
    s_add_u32 m0, s51, 0x19000
    s_nop 0
    buffer_load_dwordx4 v15, s[12:15], s43 offen nt lds
    s_add_u32 s43, s41, 0x180000
    s_add_u32 m0, s51, 0x1a000
    s_nop 0
    buffer_load_dwordx4 v15, s[12:15], s43 offen nt lds
    s_add_u32 s43, s41, 0x188000
    s_add_u32 m0, s51, 0x1b000
    s_nop 0
    buffer_load_dwordx4 v15, s[12:15], s43 offen nt lds
    s_waitcnt vmcnt(12)
    v_min_u32 v21, 0xfffffffe, v21
    s_mov_b32 s43, 0x7010000
    s_mov_b64 exec, s[38:39]
    buffer_store_dword v21, v119, s[8:11], s43 offen sc1
    s_mov_b64 exec, -1
    s_barrier
    v_xor_b32 v13, 0x0, v11
    v_add_u32 v13, 0x0, v13
    ds_read_b64_tr_b16 v[64:65], v13
    ds_read_b64_tr_b16 v[66:67], v13 offset:1024
    ds_read_b64_tr_b16 v[68:69], v13 offset:16384
    ds_read_b64_tr_b16 v[70:71], v13 offset:17408
    v_xor_b32 v13, 0x20, v11
    v_add_u32 v13, 0x0, v13
    ds_read_b64_tr_b16 v[72:73], v13
    ds_read_b64_tr_b16 v[74:75], v13 offset:1024
    ds_read_b64_tr_b16 v[76:77], v13 offset:16384
    ds_read_b64_tr_b16 v[78:79], v13 offset:17408
    v_xor_b32 v13, 0x1000, v11
    v_add_u32 v13, 0x0, v13
    ds_read_b64_tr_b16 a[96:97], v13
    ds_read_b64_tr_b16 a[98:99], v13 offset:1024
    ds_read_b64_tr_b16 a[100:101], v13 offset:16384
    ds_read_b64_tr_b16 a[102:103], v13 offset:17408
    v_xor_b32 v13, 0x1020, v11
    v_add_u32 v13, 0x0, v13
    ds_read_b64_tr_b16 a[104:105], v13
    ds_read_b64_tr_b16 a[106:107], v13 offset:1024
    ds_read_b64_tr_b16 a[108:109], v13 offset:16384
    ds_read_b64_tr_b16 a[110:111], v13 offset:17408
    s_waitcnt lgkmcnt(0)
    s_barrier
    s_add_u32 s43, s41, 0x280000
    s_add_u32 m0, s51, 0x1c000
    s_nop 0
    buffer_load_dwordx4 v15, s[12:15], s43 offen nt lds
    s_add_u32 s43, s41, 0x288000
    s_add_u32 m0, s51, 0x1d000
    s_nop 0
    buffer_load_dwordx4 v15, s[12:15], s43 offen nt lds
    s_add_u32 s43, s41, 0x380000
    s_add_u32 m0, s51, 0x1e000
    s_nop 0
    buffer_load_dwordx4 v15, s[12:15], s43 offen nt lds
    s_add_u32 s43, s41, 0x388000
    s_add_u32 m0, s51, 0x1f000
    s_nop 0
    buffer_load_dwordx4 v15, s[12:15], s43 offen nt lds
    v_xor_b32 v15, 2, v14
    v_lshl_add_u32 v15, v15, 15, v8
    s_add_u32 s43, s41, 0x80000
    s_add_u32 m0, s51, 0x20000
    s_nop 0
    buffer_load_dwordx4 v15, s[12:15], s43 offen nt lds
    s_add_u32 s43, s41, 0x88000
    s_add_u32 m0, s51, 0x21000
    s_nop 0
    buffer_load_dwordx4 v15, s[12:15], s43 offen nt lds
    s_add_u32 s43, s41, 0x180000
    s_add_u32 m0, s51, 0x22000
    s_nop 0
    buffer_load_dwordx4 v15, s[12:15], s43 offen nt lds
    s_add_u32 s43, s41, 0x188000
    s_add_u32 m0, s51, 0x23000
    s_nop 0
    buffer_load_dwordx4 v15, s[12:15], s43 offen nt lds
    s_waitcnt vmcnt(12)
    s_barrier
    v_xor_b32 v13, 0x0, v11
    v_add_u32 v13, 0x8000, v13
    ds_read_b64_tr_b16 a[128:129], v13
    ds_read_b64_tr_b16 a[130:131], v13 offset:1024
    ds_read_b64_tr_b16 a[132:133], v13 offset:16384
    ds_read_b64_tr_b16 a[134:135], v13 offset:17408
    v_xor_b32 v13, 0x20, v11
    v_add_u32 v13, 0x8000, v13
    ds_read_b64_tr_b16 a[136:137], v13
    ds_read_b64_tr_b16 a[138:139], v13 offset:1024
    ds_read_b64_tr_b16 a[140:141], v13 offset:16384
    ds_read_b64_tr_b16 a[142:143], v13 offset:17408
    v_xor_b32 v13, 0x1000, v11
    v_add_u32 v13, 0x8000, v13
    ds_read_b64_tr_b16 a[160:161], v13
    ds_read_b64_tr_b16 a[162:163], v13 offset:1024
    ds_read_b64_tr_b16 a[164:165], v13 offset:16384
    ds_read_b64_tr_b16 a[166:167], v13 offset:17408
    v_xor_b32 v13, 0x1020, v11
    v_add_u32 v13, 0x8000, v13
    ds_read_b64_tr_b16 a[168:169], v13
    ds_read_b64_tr_b16 a[170:171], v13 offset:1024
    ds_read_b64_tr_b16 a[172:173], v13 offset:16384
    ds_read_b64_tr_b16 a[174:175], v13 offset:17408
    s_waitcnt lgkmcnt(0)
    s_barrier
    s_add_u32 s43, s41, 0x280000
    s_add_u32 m0, s51, 0x24000
    s_nop 0
    buffer_load_dwordx4 v15, s[12:15], s43 offen nt lds
    s_add_u32 s43, s41, 0x288000
    s_add_u32 m0, s51, 0x25000
    s_nop 0
    buffer_load_dwordx4 v15, s[12:15], s43 offen nt lds
    s_add_u32 s43, s41, 0x380000
    s_add_u32 m0, s51, 0x26000
    s_nop 0
    buffer_load_dwordx4 v15, s[12:15], s43 offen nt lds
    s_add_u32 s43, s41, 0x388000
    s_add_u32 m0, s51, 0x27000
    s_nop 0
    buffer_load_dwordx4 v15, s[12:15], s43 offen nt lds
    s_mov_b32 s12, s64
    s_and_b32 s13, s65, 0xffff
    v_xor_b32 v15, 0, v14
    v_lshl_add_u32 v15, v15, 15, v8
    s_add_u32 s43, s41, 0x0
    s_add_u32 m0, s51, 0x8000
    s_nop 0
    buffer_load_dwordx4 v15, s[12:15], s43 offen lds
    s_add_u32 s43, s41, 0x8000
    s_add_u32 m0, s51, 0x9000
    s_nop 0
    buffer_load_dwordx4 v15, s[12:15], s43 offen lds
    s_add_u32 s43, s41, 0x100000
    s_add_u32 m0, s51, 0xa000
    s_nop 0
    buffer_load_dwordx4 v15, s[12:15], s43 offen lds
    s_add_u32 s43, s41, 0x108000
    s_add_u32 m0, s51, 0xb000
    s_nop 0
    buffer_load_dwordx4 v15, s[12:15], s43 offen lds
    s_waitcnt vmcnt(12)
    s_barrier
    v_xor_b32 v13, 0x0, v11
    v_add_u32 v13, 0x10000, v13
    ds_read_b64_tr_b16 v[104:105], v13
    ds_read_b64_tr_b16 v[106:107], v13 offset:1024
    ds_read_b64_tr_b16 v[108:109], v13 offset:16384
    ds_read_b64_tr_b16 v[110:111], v13 offset:17408
    v_xor_b32 v13, 0x20, v11
    v_add_u32 v13, 0x10000, v13
    ds_read_b64_tr_b16 v[32:33], v13
    ds_read_b64_tr_b16 v[34:35], v13 offset:1024
    ds_read_b64_tr_b16 v[36:37], v13 offset:16384
    ds_read_b64_tr_b16 v[38:39], v13 offset:17408
    v_xor_b32 v13, 0x1000, v11
    v_add_u32 v13, 0x10000, v13
    ds_read_b64_tr_b16 a[112:113], v13
    ds_read_b64_tr_b16 a[114:115], v13 offset:1024
    ds_read_b64_tr_b16 a[116:117], v13 offset:16384
    ds_read_b64_tr_b16 a[118:119], v13 offset:17408
    v_xor_b32 v13, 0x1020, v11
    v_add_u32 v13, 0x10000, v13
    ds_read_b64_tr_b16 a[120:121], v13
    ds_read_b64_tr_b16 a[122:123], v13 offset:1024
    ds_read_b64_tr_b16 a[124:125], v13 offset:16384
    ds_read_b64_tr_b16 a[126:127], v13 offset:17408
    s_waitcnt lgkmcnt(0)
    s_barrier
    s_add_u32 s43, s41, 0x200000
    s_add_u32 m0, s51, 0xc000
    s_nop 0
    buffer_load_dwordx4 v15, s[12:15], s43 offen lds
    s_add_u32 s43, s41, 0x208000
    s_add_u32 m0, s51, 0xd000
    s_nop 0
    buffer_load_dwordx4 v15, s[12:15], s43 offen lds
    s_add_u32 s43, s41, 0x300000
    s_add_u32 m0, s51, 0xe000
    s_nop 0
    buffer_load_dwordx4 v15, s[12:15], s43 offen lds
    s_add_u32 s43, s41, 0x308000
    s_add_u32 m0, s51, 0xf000
    s_nop 0
    buffer_load_dwordx4 v15, s[12:15], s43 offen lds
    v_xor_b32 v15, 2, v14
    v_lshl_add_u32 v15, v15, 15, v8
    s_add_u32 s43, s41, 0x0
    s_add_u32 m0, s51, 0x10000
    s_nop 0
    buffer_load_dwordx4 v15, s[12:15], s43 offen lds
    s_add_u32 s43, s41, 0x8000
    s_add_u32 m0, s51, 0x11000
    s_nop 0
    buffer_load_dwordx4 v15, s[12:15], s43 offen lds
    s_add_u32 s43, s41, 0x100000
    s_add_u32 m0, s51, 0x12000
    s_nop 0
    buffer_load_dwordx4 v15, s[12:15], s43 offen lds
    s_add_u32 s43, s41, 0x108000
    s_add_u32 m0, s51, 0x13000
    s_nop 0
    buffer_load_dwordx4 v15, s[12:15], s43 offen lds
    s_waitcnt vmcnt(12)
    s_barrier
    v_xor_b32 v13, 0x0, v11
    v_add_u32 v13, 0x18000, v13
    ds_read_b64_tr_b16 a[144:145], v13
    ds_read_b64_tr_b16 a[146:147], v13 offset:1024
    ds_read_b64_tr_b16 a[148:149], v13 offset:16384
    ds_read_b64_tr_b16 a[150:151], v13 offset:17408
    v_xor_b32 v13, 0x20, v11
    v_add_u32 v13, 0x18000, v13
    ds_read_b64_tr_b16 a[152:153], v13
    ds_read_b64_tr_b16 a[154:155], v13 offset:1024
    ds_read_b64_tr_b16 a[156:157], v13 offset:16384
    ds_read_b64_tr_b16 a[158:159], v13 offset:17408
    v_xor_b32 v13, 0x1000, v11
    v_add_u32 v13, 0x18000, v13
    ds_read_b64_tr_b16 a[176:177], v13
    ds_read_b64_tr_b16 a[178:179], v13 offset:1024
    ds_read_b64_tr_b16 a[180:181], v13 offset:16384
    ds_read_b64_tr_b16 a[182:183], v13 offset:17408
    v_xor_b32 v13, 0x1020, v11
    v_add_u32 v13, 0x18000, v13
    ds_read_b64_tr_b16 a[184:185], v13
    ds_read_b64_tr_b16 a[186:187], v13 offset:1024
    ds_read_b64_tr_b16 a[188:189], v13 offset:16384
    ds_read_b64_tr_b16 a[190:191], v13 offset:17408
    s_waitcnt lgkmcnt(0)
    s_barrier
    s_add_u32 s43, s41, 0x200000
    s_add_u32 m0, s51, 0x14000
    s_nop 0
    buffer_load_dwordx4 v15, s[12:15], s43 offen lds
    s_add_u32 s43, s41, 0x208000
    s_add_u32 m0, s51, 0x15000
    s_nop 0
    buffer_load_dwordx4 v15, s[12:15], s43 offen lds
    s_add_u32 s43, s41, 0x300000
    s_add_u32 m0, s51, 0x16000
    s_nop 0
    buffer_load_dwordx4 v15, s[12:15], s43 offen lds
    s_add_u32 s43, s41, 0x308000
    s_add_u32 m0, s51, 0x17000
    s_nop 0
    buffer_load_dwordx4 v15, s[12:15], s43 offen lds
    s_mov_b32 s12, s66
    s_and_b32 s13, s67, 0xffff
    s_add_u32 s43, s42, 0x80
    s_add_u32 m0, s51, 0x18000
    s_nop 0
    buffer_load_dwordx4 v10, s[12:15], s43 offen lds
    s_add_u32 s43, s42, 0x4080
    s_add_u32 m0, s51, 0x19000
    s_nop 0
    buffer_load_dwordx4 v9, s[12:15], s43 offen lds
    s_add_u32 s43, s42, 0x8080
    s_add_u32 m0, s51, 0x1a000
    s_nop 0
    buffer_load_dwordx4 v10, s[12:15], s43 offen lds
    s_add_u32 s43, s42, 0xc080
    s_add_u32 m0, s51, 0x1b000
    s_nop 0
    buffer_load_dwordx4 v9, s[12:15], s43 offen lds
    s_waitcnt vmcnt(12)
    s_barrier
    v_xor_b32 v13, 0x0, v11
    v_add_u32 v13, 0x0, v13
    ds_read_b64_tr_b16 a[192:193], v13
    ds_read_b64_tr_b16 a[194:195], v13 offset:1024
    ds_read_b64_tr_b16 a[196:197], v13 offset:16384
    ds_read_b64_tr_b16 a[198:199], v13 offset:17408
    v_xor_b32 v13, 0x20, v11
    v_add_u32 v13, 0x0, v13
    ds_read_b64_tr_b16 a[200:201], v13
    ds_read_b64_tr_b16 a[202:203], v13 offset:1024
    ds_read_b64_tr_b16 a[204:205], v13 offset:16384
    ds_read_b64_tr_b16 a[206:207], v13 offset:17408
    v_xor_b32 v13, 0x1000, v11
    v_add_u32 v13, 0x0, v13
    ds_read_b64_tr_b16 a[224:225], v13
    ds_read_b64_tr_b16 a[226:227], v13 offset:1024
    ds_read_b64_tr_b16 a[228:229], v13 offset:16384
    ds_read_b64_tr_b16 a[230:231], v13 offset:17408
    v_xor_b32 v13, 0x1020, v11
    v_add_u32 v13, 0x0, v13
    ds_read_b64_tr_b16 a[232:233], v13
    ds_read_b64_tr_b16 a[234:235], v13 offset:1024
    ds_read_b64_tr_b16 a[236:237], v13 offset:16384
    ds_read_b64_tr_b16 a[238:239], v13 offset:17408
    s_waitcnt lgkmcnt(0)
    s_barrier
    s_add_u32 s43, s42, 0x10280
    s_add_u32 m0, s51, 0x1c000
    s_nop 0
    buffer_load_dwordx4 v10, s[12:15], s43 offen lds
    s_add_u32 s43, s42, 0x14280
    s_add_u32 m0, s51, 0x1d000
    s_nop 0
    buffer_load_dwordx4 v9, s[12:15], s43 offen lds
    s_add_u32 s43, s42, 0x18280
    s_add_u32 m0, s51, 0x1e000
    s_nop 0
    buffer_load_dwordx4 v10, s[12:15], s43 offen lds
    s_add_u32 s43, s42, 0x1c280
    s_add_u32 m0, s51, 0x1f000
    s_nop 0
    buffer_load_dwordx4 v9, s[12:15], s43 offen lds
    s_add_u32 s43, s42, 0x10080
    s_add_u32 m0, s51, 0x20000
    s_nop 0
    buffer_load_dwordx4 v10, s[12:15], s43 offen lds
    s_add_u32 s43, s42, 0x14080
    s_add_u32 m0, s51, 0x21000
    s_nop 0
    buffer_load_dwordx4 v9, s[12:15], s43 offen lds
    s_add_u32 s43, s42, 0x18080
    s_add_u32 m0, s51, 0x22000
    s_nop 0
    buffer_load_dwordx4 v10, s[12:15], s43 offen lds
    s_add_u32 s43, s42, 0x1c080
    s_add_u32 m0, s51, 0x23000
    s_nop 0
    buffer_load_dwordx4 v9, s[12:15], s43 offen lds
    s_waitcnt vmcnt(12)
    s_barrier
    s_cmp_lg_u32 s21, 0
    s_cbranch_scc1 L_arr_51
    v_mov_b32 v23, 1
    s_mov_b64 exec, 1
    buffer_atomic_add v23, off, s[16:19], 0 offset:8
    s_mov_b64 exec, -1
L_arr_51:
    v_xor_b32 v13, 0x0, v11
    v_add_u32 v13, 0x8000, v13
    ds_read_b64_tr_b16 v[128:129], v13
    ds_read_b64_tr_b16 v[130:131], v13 offset:1024
    ds_read_b64_tr_b16 v[132:133], v13 offset:16384
    ds_read_b64_tr_b16 v[134:135], v13 offset:17408
    v_xor_b32 v13, 0x20, v11
    v_add_u32 v13, 0x8000, v13
    ds_read_b64_tr_b16 v[136:137], v13
    ds_read_b64_tr_b16 v[138:139], v13 offset:1024
    ds_read_b64_tr_b16 v[140:141], v13 offset:16384
    ds_read_b64_tr_b16 v[142:143], v13 offset:17408
    v_xor_b32 v13, 0x1000, v11
    v_add_u32 v13, 0x8000, v13
    ds_read_b64_tr_b16 v[160:161], v13
    ds_read_b64_tr_b16 v[162:163], v13 offset:1024
    ds_read_b64_tr_b16 v[164:165], v13 offset:16384
    ds_read_b64_tr_b16 v[166:167], v13 offset:17408
    v_xor_b32 v13, 0x1020, v11
    v_add_u32 v13, 0x8000, v13
    ds_read_b64_tr_b16 v[168:169], v13
    ds_read_b64_tr_b16 v[170:171], v13 offset:1024
    ds_read_b64_tr_b16 v[172:173], v13 offset:16384
    ds_read_b64_tr_b16 v[174:175], v13 offset:17408
    s_waitcnt lgkmcnt(0)
    s_barrier
    s_add_u32 s43, s42, 0x280
    s_add_u32 m0, s51, 0x24000
    s_nop 0
    buffer_load_dwordx4 v10, s[12:15], s43 offen lds
    s_add_u32 s43, s42, 0x4280
    s_add_u32 m0, s51, 0x25000
    s_nop 0
    buffer_load_dwordx4 v9, s[12:15], s43 offen lds
    s_add_u32 s43, s42, 0x8280
    s_add_u32 m0, s51, 0x26000
    s_nop 0
    buffer_load_dwordx4 v10, s[12:15], s43 offen lds
    s_add_u32 s43, s42, 0xc280
    s_add_u32 m0, s51, 0x27000
    s_nop 0
    buffer_load_dwordx4 v9, s[12:15], s43 offen lds
    s_mov_b32 s12, s64
    s_and_b32 s13, s65, 0xffff
    v_xor_b32 v15, 0, v14
    v_lshl_add_u32 v15, v15, 15, v8
    s_add_u32 s43, s41, 0x80000
    s_add_u32 m0, s51, 0x8000
    s_nop 0
    buffer_load_dwordx4 v15, s[12:15], s43 offen lds
    s_add_u32 s43, s41, 0x88000
    s_add_u32 m0, s51, 0x9000
    s_nop 0
    buffer_load_dwordx4 v15, s[12:15], s43 offen lds
    s_add_u32 s43, s41, 0x180000
    s_add_u32 m0, s51, 0xa000
    s_nop 0
    buffer_load_dwordx4 v15, s[12:15], s43 offen lds
    s_add_u32 s43, s41, 0x188000
    s_add_u32 m0, s51, 0xb000
    s_nop 0
    buffer_load_dwordx4 v15, s[12:15], s43 offen lds
    s_waitcnt vmcnt(12)
    s_barrier
    v_xor_b32 v13, 0x0, v12
    v_add_u32 v13, 0x10000, v13
    ds_read_b64_tr_b16 v[192:193], v13
    ds_read_b64_tr_b16 v[194:195], v13 offset:512
    ds_read_b64_tr_b16 v[196:197], v13 offset:2048
    ds_read_b64_tr_b16 v[198:199], v13 offset:2560
    v_xor_b32 v13, 0x2000, v12
    v_add_u32 v13, 0x10000, v13
    ds_read_b64_tr_b16 v[200:201], v13
    ds_read_b64_tr_b16 v[202:203], v13 offset:512
    ds_read_b64_tr_b16 v[204:205], v13 offset:2048
    ds_read_b64_tr_b16 v[206:207], v13 offset:2560
    v_xor_b32 v13, 0x40, v12
    v_add_u32 v13, 0x10000, v13
    ds_read_b64_tr_b16 v[224:225], v13
    ds_read_b64_tr_b16 v[226:227], v13 offset:512
    ds_read_b64_tr_b16 v[228:229], v13 offset:2048
    ds_read_b64_tr_b16 v[230:231], v13 offset:2560
    v_xor_b32 v13, 0x2040, v12
    v_add_u32 v13, 0x10000, v13
    ds_read_b64_tr_b16 v[232:233], v13
    ds_read_b64_tr_b16 v[234:235], v13 offset:512
    ds_read_b64_tr_b16 v[236:237], v13 offset:2048
    ds_read_b64_tr_b16 v[238:239], v13 offset:2560
    s_waitcnt lgkmcnt(0)
    s_barrier
    s_add_u32 s43, s41, 0x280000
    s_add_u32 m0, s51, 0xc000
    s_nop 0
    buffer_load_dwordx4 v15, s[12:15], s43 offen lds
    s_add_u32 s43, s41, 0x288000
    s_add_u32 m0, s51, 0xd000
    s_nop 0
    buffer_load_dwordx4 v15, s[12:15], s43 offen lds
    s_add_u32 s43, s41, 0x380000
    s_add_u32 m0, s51, 0xe000
    s_nop 0
    buffer_load_dwordx4 v15, s[12:15], s43 offen lds
    s_add_u32 s43, s41, 0x388000
    s_add_u32 m0, s51, 0xf000
    s_nop 0
    buffer_load_dwordx4 v15, s[12:15], s43 offen lds
    v_xor_b32 v15, 2, v14
    v_lshl_add_u32 v15, v15, 15, v8
    s_add_u32 s43, s41, 0x80000
    s_add_u32 m0, s51, 0x10000
    s_nop 0
    buffer_load_dwordx4 v15, s[12:15], s43 offen lds
    s_add_u32 s43, s41, 0x88000
    s_add_u32 m0, s51, 0x11000
    s_nop 0
    buffer_load_dwordx4 v15, s[12:15], s43 offen lds
    s_add_u32 s43, s41, 0x180000
    s_add_u32 m0, s51, 0x12000
    s_nop 0
    buffer_load_dwordx4 v15, s[12:15], s43 offen lds
    s_add_u32 s43, s41, 0x188000
    s_add_u32 m0, s51, 0x13000
    s_nop 0
    buffer_load_dwordx4 v15, s[12:15], s43 offen lds
    s_waitcnt vmcnt(12)
    s_barrier
    v_xor_b32 v13, 0x0, v12
    v_add_u32 v13, 0x18000, v13
    ds_read_b64_tr_b16 v[208:209], v13
    ds_read_b64_tr_b16 v[210:211], v13 offset:512
    ds_read_b64_tr_b16 v[212:213], v13 offset:2048
    ds_read_b64_tr_b16 v[214:215], v13 offset:2560
    v_xor_b32 v13, 0x2000, v12
    v_add_u32 v13, 0x18000, v13
    ds_read_b64_tr_b16 v[216:217], v13
    ds_read_b64_tr_b16 v[218:219], v13 offset:512
    ds_read_b64_tr_b16 v[220:221], v13 offset:2048
    ds_read_b64_tr_b16 v[222:223], v13 offset:2560
    v_xor_b32 v13, 0x40, v12
    v_add_u32 v13, 0x18000, v13
    ds_read_b64_tr_b16 v[240:241], v13
    ds_read_b64_tr_b16 v[242:243], v13 offset:512
    ds_read_b64_tr_b16 v[244:245], v13 offset:2048
    ds_read_b64_tr_b16 v[246:247], v13 offset:2560
    v_xor_b32 v13, 0x2040, v12
    v_add_u32 v13, 0x18000, v13
    ds_read_b64_tr_b16 v[248:249], v13
    ds_read_b64_tr_b16 v[250:251], v13 offset:512
    ds_read_b64_tr_b16 v[252:253], v13 offset:2048
    ds_read_b64_tr_b16 v[254:255], v13 offset:2560
    s_waitcnt lgkmcnt(0)
    s_barrier
    s_add_u32 s43, s41, 0x280000
    s_add_u32 m0, s51, 0x14000
    s_nop 0
    buffer_load_dwordx4 v15, s[12:15], s43 offen lds
    s_add_u32 s43, s41, 0x288000
    s_add_u32 m0, s51, 0x15000
    s_nop 0
    buffer_load_dwordx4 v15, s[12:15], s43 offen lds
    s_add_u32 s43, s41, 0x380000
    s_add_u32 m0, s51, 0x16000
    s_nop 0
    buffer_load_dwordx4 v15, s[12:15], s43 offen lds
    s_add_u32 s43, s41, 0x388000
    s_add_u32 m0, s51, 0x17000
    s_nop 0
    buffer_load_dwordx4 v15, s[12:15], s43 offen lds
    ds_write_b128 v124, v[192:195]
    ds_write_b128 v124, v[196:199] offset:1024
    ds_write_b128 v124, v[200:203] offset:2048
    ds_write_b128 v124, v[204:207] offset:3072
    ds_write_b128 v124, v[208:211] offset:4096
    ds_write_b128 v124, v[212:215] offset:5120
    ds_write_b128 v124, v[216:219] offset:6144
    ds_write_b128 v124, v[220:223] offset:7168
    ds_write_b128 v124, v[224:227] offset:32768
    ds_write_b128 v124, v[228:231] offset:33792
    ds_write_b128 v124, v[232:235] offset:34816
    ds_write_b128 v124, v[236:239] offset:35840
    ds_write_b128 v124, v[240:243] offset:36864
    ds_write_b128 v124, v[244:247] offset:37888
    ds_write_b128 v124, v[248:251] offset:38912
    ds_write_b128 v124, v[252:255] offset:39936
    s_waitcnt vmcnt(8)
    s_barrier
    v_xor_b32 v13, 0x0, v11
    v_add_u32 v13, 0x0, v13
    ds_read_b64_tr_b16 a[208:209], v13
    ds_read_b64_tr_b16 a[210:211], v13 offset:1024
    ds_read_b64_tr_b16 a[212:213], v13 offset:16384
    ds_read_b64_tr_b16 a[214:215], v13 offset:17408
    v_xor_b32 v13, 0x20, v11
    v_add_u32 v13, 0x0, v13
    ds_read_b64_tr_b16 a[216:217], v13
    ds_read_b64_tr_b16 a[218:219], v13 offset:1024
    ds_read_b64_tr_b16 a[220:221], v13 offset:16384
    ds_read_b64_tr_b16 a[222:223], v13 offset:17408
    v_xor_b32 v13, 0x1000, v11
    v_add_u32 v13, 0x0, v13
    ds_read_b64_tr_b16 a[240:241], v13
    ds_read_b64_tr_b16 a[242:243], v13 offset:1024
    ds_read_b64_tr_b16 a[244:245], v13 offset:16384
    ds_read_b64_tr_b16 a[246:247], v13 offset:17408
    v_xor_b32 v13, 0x1020, v11
    v_add_u32 v13, 0x0, v13
    ds_read_b64_tr_b16 a[248:249], v13
    ds_read_b64_tr_b16 a[250:251], v13 offset:1024
    ds_read_b64_tr_b16 a[252:253], v13 offset:16384
    ds_read_b64_tr_b16 a[254:255], v13 offset:17408
    s_waitcnt lgkmcnt(0)
    s_barrier
    s_mov_b32 s12, s66
    s_and_b32 s13, s67, 0xffff
    s_add_u32 s43, s42, 0x0
    s_add_u32 m0, s51, 0x8000
    s_nop 0
    buffer_load_dwordx4 v10, s[12:15], s43 offen lds
    s_add_u32 s43, s42, 0x4000
    s_add_u32 m0, s51, 0x9000
    s_nop 0
    buffer_load_dwordx4 v9, s[12:15], s43 offen lds
    s_add_u32 s43, s42, 0x8000
    s_add_u32 m0, s51, 0xa000
    s_nop 0
    buffer_load_dwordx4 v10, s[12:15], s43 offen lds
    s_add_u32 s43, s42, 0xc000
    s_add_u32 m0, s51, 0xb000
    s_nop 0
    buffer_load_dwordx4 v9, s[12:15], s43 offen lds
    s_add_u32 s43, s42, 0x10200
    s_add_u32 m0, s51, 0xc000
    s_nop 0
    buffer_load_dwordx4 v10, s[12:15], s43 offen lds
    s_add_u32 s43, s42, 0x14200
    s_add_u32 m0, s51, 0xd000
    s_nop 0
    buffer_load_dwordx4 v9, s[12:15], s43 offen lds
    s_add_u32 s43, s42, 0x18200
    s_add_u32 m0, s51, 0xe000
    s_nop 0
    buffer_load_dwordx4 v10, s[12:15], s43 offen lds
    s_add_u32 s43, s42, 0x1c200
    s_add_u32 m0, s51, 0xf000
    s_nop 0
    buffer_load_dwordx4 v9, s[12:15], s43 offen lds
    s_waitcnt vmcnt(8)
    s_barrier
    v_xor_b32 v13, 0x0, v11
    v_add_u32 v13, 0x8000, v13
    ds_read_b64_tr_b16 v[144:145], v13
    ds_read_b64_tr_b16 v[146:147], v13 offset:1024
    ds_read_b64_tr_b16 v[148:149], v13 offset:16384
    ds_read_b64_tr_b16 v[150:151], v13 offset:17408
    v_xor_b32 v13, 0x20, v11
    v_add_u32 v13, 0x8000, v13
    ds_read_b64_tr_b16 v[152:153], v13
    ds_read_b64_tr_b16 v[154:155], v13 offset:1024
    ds_read_b64_tr_b16 v[156:157], v13 offset:16384
    ds_read_b64_tr_b16 v[158:159], v13 offset:17408
    v_xor_b32 v13, 0x1000, v11
    v_add_u32 v13, 0x8000, v13
    ds_read_b64_tr_b16 v[176:177], v13
    ds_read_b64_tr_b16 v[178:179], v13 offset:1024
    ds_read_b64_tr_b16 v[180:181], v13 offset:16384
    ds_read_b64_tr_b16 v[182:183], v13 offset:17408
    v_xor_b32 v13, 0x1020, v11
    v_add_u32 v13, 0x8000, v13
    ds_read_b64_tr_b16 v[184:185], v13
    ds_read_b64_tr_b16 v[186:187], v13 offset:1024
    ds_read_b64_tr_b16 v[188:189], v13 offset:16384
    ds_read_b64_tr_b16 v[190:191], v13 offset:17408
    s_waitcnt lgkmcnt(0)
    s_barrier
    s_add_u32 s43, s42, 0x10000
    s_add_u32 m0, s51, 0x10000
    s_nop 0
    buffer_load_dwordx4 v10, s[12:15], s43 offen lds
    s_add_u32 s43, s42, 0x14000
    s_add_u32 m0, s51, 0x11000
    s_nop 0
    buffer_load_dwordx4 v9, s[12:15], s43 offen lds
    s_add_u32 s43, s42, 0x18000
    s_add_u32 m0, s51, 0x12000
    s_nop 0
    buffer_load_dwordx4 v10, s[12:15], s43 offen lds
    s_add_u32 s43, s42, 0x1c000
    s_add_u32 m0, s51, 0x13000
    s_nop 0
    buffer_load_dwordx4 v9, s[12:15], s43 offen lds
    s_add_u32 s43, s42, 0x200
    s_add_u32 m0, s51, 0x14000
    s_nop 0
    buffer_load_dwordx4 v10, s[12:15], s43 offen lds
    s_add_u32 s43, s42, 0x4200
    s_add_u32 m0, s51, 0x15000
    s_nop 0
    buffer_load_dwordx4 v9, s[12:15], s43 offen lds
    s_add_u32 s43, s42, 0x8200
    s_add_u32 m0, s51, 0x16000
    s_nop 0
    buffer_load_dwordx4 v10, s[12:15], s43 offen lds
    s_add_u32 s43, s42, 0xc200
    s_add_u32 m0, s51, 0x17000
    s_nop 0
    buffer_load_dwordx4 v9, s[12:15], s43 offen lds
    s_waitcnt vmcnt(8)
    s_barrier
    v_xor_b32 v13, 0x0, v12
    v_add_u32 v13, 0x0, v13
    ds_read_b64_tr_b16 v[192:193], v13
    ds_read_b64_tr_b16 v[194:195], v13 offset:512
    ds_read_b64_tr_b16 v[196:197], v13 offset:2048
    ds_read_b64_tr_b16 v[198:199], v13 offset:2560
    v_xor_b32 v13, 0x2000, v12
    v_add_u32 v13, 0x0, v13
    ds_read_b64_tr_b16 v[200:201], v13
    ds_read_b64_tr_b16 v[202:203], v13 offset:512
    ds_read_b64_tr_b16 v[204:205], v13 offset:2048
    ds_read_b64_tr_b16 v[206:207], v13 offset:2560
    v_xor_b32 v13, 0x40, v12
    v_add_u32 v13, 0x0, v13
    ds_read_b64_tr_b16 v[224:225], v13
    ds_read_b64_tr_b16 v[226:227], v13 offset:512
    ds_read_b64_tr_b16 v[228:229], v13 offset:2048
    ds_read_b64_tr_b16 v[230:231], v13 offset:2560
    v_xor_b32 v13, 0x2040, v12
    v_add_u32 v13, 0x0, v13
    ds_read_b64_tr_b16 v[232:233], v13
    ds_read_b64_tr_b16 v[234:235], v13 offset:512
    ds_read_b64_tr_b16 v[236:237], v13 offset:2048
    ds_read_b64_tr_b16 v[238:239], v13 offset:2560
    s_lshr_b32 s43, s20, 1
    s_lshl_b32 s43, s43, 7
    s_and_b32 s40, s20, 1
    s_lshl_b32 s40, s40, 4
    s_add_u32 s43, s43, s40
    s_add_u32 s44, s43, 0x1000
    s_cmp_eq_u32 s21, 0
    s_cselect_b32 s44, s44, 0x7ff00000
    s_mov_b32 s22, 0
    s_mov_b32 s33, 0
    s_xor_b32 s53, s29, 1024
    s_add_u32 s23, s51, 0x7010000
    s_add_u32 s48, s23, 4096
    s_mov_b32 s24, 0x7012000
    s_add_u32 s55, s24, 16384
    s_mov_b32 s25, 0x7100000
    s_mov_b32 s26, 0x7101000
    v_mov_b32 v112, 0
    v_mov_b32 v113, 0
    v_mov_b32 v114, 0
    v_mov_b32 v115, 0
    ds_write_b128 v117, v[112:115] offset:22528
    ds_write_b128 v117, v[112:115] offset:23552
    s_cmp_lg_u32 s21, 0
    s_cselect_b32 s40, -1, 0
    v_mov_b32 v126, s40
    v_bfe_u32 v1, v117, 4, 1
    v_lshlrev_b32 v1, 4, v1
    s_movk_i32 s43, 0x3f80
    v_lshlrev_b32 v125, v1, s43
    v_bfe_u32 v1, v117, 5, 3
    v_cmp_eq_u32 s[68:69], 0, v1
    v_cmp_eq_u32 s[70:71], 1, v1
    v_cmp_eq_u32 s[72:73], 2, v1
    v_cmp_eq_u32 s[74:75], 3, v1
    v_mov_b32 v40, 0
    v_mov_b32 v41, 0
    v_mov_b32 v42, 0
    v_mov_b32 v43, 0
    v_mov_b32 v44, 0
    v_mov_b32 v45, 0
    v_mov_b32 v46, 0
    v_mov_b32 v47, 0
    v_mov_b32 v48, 0
    v_mov_b32 v49, 0
    v_mov_b32 v50, 0
    v_mov_b32 v51, 0
    v_mov_b32 v52, 0
    v_mov_b32 v53, 0
    v_mov_b32 v54, 0
    v_mov_b32 v55, 0
    s_mov_b32 s45, 0
    s_mov_b32 s46, 0
    s_mov_b32 s47, 0
    s_mov_b32 s76, 0
    s_and_b32 s43, s21, 1
    s_lshl_b32 s43, s43, 5
    s_add_u32 s43, s43, s20
    s_lshl_b32 s43, s43, 6
    s_add_u32 s28, s43, 0x2000
    s_mov_b32 s59, 0
    s_waitcnt vmcnt(0) lgkmcnt(0)
    s_barrier
    v_xor_b32 v13, 0x0, v12
    v_add_u32 v13, 0x8000, v13
    ds_read_b64_tr_b16 v[208:209], v13
    ds_read_b64_tr_b16 v[210:211], v13 offset:512
    ds_read_b64_tr_b16 v[212:213], v13 offset:2048
    ds_read_b64_tr_b16 v[214:215], v13 offset:2560
    v_xor_b32 v13, 0x2000, v12
    v_add_u32 v13, 0x8000, v13
    ds_read_b64_tr_b16 v[216:217], v13
    ds_read_b64_tr_b16 v[218:219], v13 offset:512
    ds_read_b64_tr_b16 v[220:221], v13 offset:2048
    ds_read_b64_tr_b16 v[222:223], v13 offset:2560
    v_xor_b32 v13, 0x40, v12
    v_add_u32 v13, 0x8000, v13
    ds_read_b64_tr_b16 v[240:241], v13
    ds_read_b64_tr_b16 v[242:243], v13 offset:512
    ds_read_b64_tr_b16 v[244:245], v13 offset:2048
    ds_read_b64_tr_b16 v[246:247], v13 offset:2560
    v_xor_b32 v13, 0x2040, v12
    v_add_u32 v13, 0x8000, v13
    ds_read_b64_tr_b16 v[248:249], v13
    ds_read_b64_tr_b16 v[250:251], v13 offset:512
    ds_read_b64_tr_b16 v[252:253], v13 offset:2048
    ds_read_b64_tr_b16 v[254:255], v13 offset:2560
    ds_write_b128 v123, v[80:83]
    ds_write_b128 v123, v[84:87] offset:1024
    ds_write_b128 v123, v[56:59] offset:2048
    ds_write_b128 v123, v[60:63] offset:3072
    ds_write_b128 v123, v[88:91] offset:4096
    ds_write_b128 v123, v[92:95] offset:5120
    ds_write_b128 v123, v[96:99] offset:6144
    ds_write_b128 v123, v[100:103] offset:7168
    s_cmp_eq_u32 s57, 1
    s_cbranch_scc1 L_started_52
    v_lshrrev_b32 v1, 4, v117
    v_and_b32 v2, 15, v1
    v_lshrrev_b32 v1, 4, v1
    v_lshlrev_b32 v1, 11, v1
    v_lshl_add_u32 v1, v2, 2, v1
    s_lshl_b32 s43, s20, 6
    s_add_u32 s43, s43, 0x2000
    s_mov_b32 exec_lo, 0x10001
    s_mov_b32 exec_hi, 0
    s_mov_b32 s96, 0
L_poll_53:
    buffer_load_dword v2, v1, s[8:11], s43 offen sc1
    s_waitcnt vmcnt(0)
    v_cmp_gt_u32 vcc, 1, v2
    s_cbranch_vccz L_polld_54
    s_sleep 8
    s_add_u32 s96, s96, 1
    s_cmp_lt_u32 s96, 0x10000
    s_cbranch_scc1 L_poll_53
L_polld_54:
    s_mov_b64 exec, -1
    s_add_u32 m0, s52, 8192
    s_nop 0
    buffer_load_dwordx4 v117, s[8:11], s30 offen lds
    buffer_load_dwordx4 v117, s[8:11], s30 offen offset:1024 lds
    s_add_u32 m0, s52, 0x6000
    s_nop 0
    buffer_load_dwordx4 v117, s[8:11], s31 offen lds
    buffer_load_dwordx4 v117, s[8:11], s31 offen offset:1024 lds
    s_mov_b32 s49, 0
L_cb_poll_56:
    buffer_load_dword v3, off, s[16:19], 0 offset:8 sc1
    s_waitcnt vmcnt(0)
    v_readfirstlane_b32 s43, v3
    s_nop 0
    s_cmp_ge_u32 s43, 32
    s_cbranch_scc1 L_started_52
    s_sleep 8
    s_add_u32 s49, s49, 1
    s_cmp_lt_u32 s49, 0x40000
    s_cbranch_scc1 L_cb_poll_56
L_started_52:
    v_lshrrev_b32 v1, 2, v117
    s_cmp_lt_u32 s21, 2
    s_cselect_b64 vcc, -1, 0
    v_cndmask_b32 v119, v119, v1, vcc
    s_add_u32 m0, s51, 4096
    v_mov_b32 v24, v32
    v_mov_b32 v25, v33
    v_mov_b32 v26, v34
    v_mov_b32 v27, v35
    v_mov_b32 v28, v36
    v_mov_b32 v29, v37
    v_mov_b32 v30, v38
    v_mov_b32 v31, v39
    s_add_u32 s30, s30, 0x40000
    s_add_u32 s31, s31, 0x40000
    s_mov_b32 s49, 0
    s_waitcnt vmcnt(0) lgkmcnt(0)
    s_barrier
    ds_write_b128 v123, v[64:67] offset:32768
    ds_write_b128 v123, v[68:71] offset:33792
    ds_write_b128 v123, v[72:75] offset:34816
    ds_write_b128 v123, v[76:79] offset:35840
    ds_write_b128 v123, v[104:107] offset:36864
    ds_write_b128 v123, v[108:111] offset:37888
    ds_write_b128 v123, v[32:35] offset:38912
    ds_write_b128 v123, v[36:39] offset:39936
    v_mov_b32 v32, 0
    v_mov_b32 v33, 0
    v_mov_b32 v34, 0
    v_mov_b32 v35, 0
    v_mov_b32 v36, 0
    v_mov_b32 v37, 0
    v_mov_b32 v38, 0
    v_mov_b32 v39, 0
    s_nop 4
    s_cmp_eq_u32 s21, 1
    s_cbranch_scc1 L_chain_top1_s
    s_cmp_eq_u32 s21, 2
    s_cbranch_scc1 L_chain_top2_s
    s_cmp_eq_u32 s21, 3
    s_cbranch_scc1 L_chain_top3_s
.p2align 6
L_chain_top0_s:
    buffer_load_dwordx4 v[0:3], v117, s[8:11], s23 offen sc1
    v_mov_b32 v15, 0
    v_mov_b32 v15, 0
    v_mov_b32 v15, 0
    v_mov_b32 v15, 0
    v_mov_b32 v15, 0
    v_mov_b32 v15, 0
    v_mov_b32 v15, 0
    v_mov_b32 v15, 0
    v_mov_b32 v15, 0
    v_mov_b32 v15, 0
    v_mov_b32 v15, 0
    v_mov_b32 v15, 0
    v_mov_b32 v15, 0
    v_mov_b32 v15, 0
    v_mov_b32 v15, 0
    v_mov_b32 v15, 0
    buffer_load_dwordx4 v[0:3], v117, s[8:11], s23 offen sc1
    v_mov_b32 v15, 0
    v_mov_b32 v15, 0
    v_mov_b32 v15, 0
    v_mov_b32 v15, 0
    v_mov_b32 v15, 0
    v_mov_b32 v15, 0
    v_mov_b32 v15, 0
    v_mov_b32 v15, 0
    v_mov_b32 v15, 0
    v_mov_b32 v15, 0
    v_mov_b32 v15, 0
    v_mov_b32 v15, 0
    v_mov_b32 v15, 0
    v_mov_b32 v15, 0
    v_mov_b32 v15, 0
    v_mov_b32 v15, 0
L_mret_58:
    buffer_load_dwordx4 v[0:3], v117, s[8:11], s23 offen sc1
    s_add_u32 s45, s45, 1
    s_cmp_lt_u32 s45, 0x10000
    s_cselect_b32 s56, -2, -1
    s_nop 3
    v_mov_b32 v32, 0
    v_mov_b32 v33, 0
    v_mov_b32 v34, 0
    v_mov_b32 v35, 0
    s_waitcnt vmcnt(2)
    v_max3_u32 v15, v0, v1, v2
    v_max_u32 v15, v15, v3
    v_cmp_lt_u32 vcc, s56, v15
    v_smfmac_f32_16x16x64_bf16 v[32:35], v[0:3], v[80:87], v116
    s_cbranch_vccnz L_mret_58
    ds_write_b128 v117, v[0:3]
    v_smfmac_f32_16x16x64_bf16 v[36:39], v[0:3], v[56:63], v116
    buffer_load_dwordx4 v[4:7], v117, s[8:11], s48 offen sc1
    v_smfmac_f32_16x16x64_bf16 v[40:43], v[0:3], v[64:71], v116
    buffer_load_dwordx4 v117, s[8:11], s48 offen sc1 lds
    s_mov_b32 m0, 8192
    v_smfmac_f32_16x16x64_bf16 v[44:47], v[0:3], v[72:79], v116
    s_waitcnt lgkmcnt(0)
    s_barrier
    ds_read_b128 v[8:11], v117 offset:1024
    v_smfmac_f32_16x16x64_bf16 v[48:51], v[0:3], a[192:199], v116
    ds_read_b128 v[16:19], v117 offset:2048
    ds_read_b128 v[20:23], v117 offset:3072
    v_smfmac_f32_16x16x64_bf16 v[52:55], v[0:3], a[200:207], v116
    ds_read_b128 v[80:83], v117 offset:14336
    s_waitcnt lgkmcnt(3)
    v_smfmac_f32_16x16x64_bf16 v[32:35], v[8:11], a[0:7], v116
    ds_read_b128 v[84:87], v117 offset:15360
    v_smfmac_f32_16x16x64_bf16 v[36:39], v[8:11], a[8:15], v116
    buffer_store_dwordx4 v[112:115], v117, s[8:11], s32 offen sc1
    s_waitcnt lgkmcnt(3)
    v_smfmac_f32_16x16x64_bf16 v[32:35], v[16:19], a[32:39], v116
    ds_read_b128 v[56:59], v117 offset:8192
    v_smfmac_f32_16x16x64_bf16 v[36:39], v[16:19], a[40:47], v116
    ds_read_b128 v[60:63], v117 offset:9216
    s_waitcnt lgkmcnt(4)
    v_smfmac_f32_16x16x64_bf16 v[32:35], v[20:23], a[64:71], v116
    ds_read_b128 v[64:67], v117 offset:10240
    v_smfmac_f32_16x16x64_bf16 v[36:39], v[20:23], a[72:79], v116
    ds_read_b128 v[68:71], v117 offset:11264
    v_smfmac_f32_16x16x64_bf16 v[40:43], v[8:11], a[96:103], v116
    ds_read_b128 v[72:75], v117 offset:12288
    v_smfmac_f32_16x16x64_bf16 v[40:43], v[16:19], a[128:135], v116
    ds_read_b128 v[76:79], v117 offset:13312
    v_smfmac_f32_16x16x64_bf16 v[40:43], v[20:23], a[160:167], v116
    s_waitcnt vmcnt(2)
    v_max3_u32 v15, v4, v5, v6
    v_smfmac_f32_16x16x64_bf16 v[44:47], v[8:11], a[104:111], v116
    v_max_u32 v15, v15, v7
    v_smfmac_f32_16x16x64_bf16 v[44:47], v[16:19], a[136:143], v116
    s_waitcnt vmcnt(1) lgkmcnt(0)
    v_cmp_lt_u32 vcc, s56, v15
    v_smfmac_f32_16x16x64_bf16 v[44:47], v[20:23], a[168:175], v116
    s_cbranch_vccnz L_mret_59
L_mgo_60:
    v_smfmac_f32_16x16x64_bf16 v[44:47], v[4:7], v[24:31], v116
    s_barrier
    ds_read_b128 v[12:15], v117 offset:5120
    v_smfmac_f32_16x16x64_bf16 v[32:35], v[4:7], v[88:95], v116
    ds_read_b128 v[24:27], v117 offset:6144
    v_smfmac_f32_16x16x64_bf16 v[36:39], v[4:7], v[96:103], v116
    ds_read_b128 v[28:31], v117 offset:7168
    v_smfmac_f32_16x16x64_bf16 v[40:43], v[4:7], v[104:111], v116
    ds_read_b128 v[88:91], v117 offset:24576
    s_waitcnt lgkmcnt(3)
    v_smfmac_f32_16x16x64_bf16 v[32:35], v[12:15], a[16:23], v116
    ds_read_b128 v[92:95], v117 offset:25600
    s_waitcnt lgkmcnt(3)
    v_smfmac_f32_16x16x64_bf16 v[32:35], v[24:27], a[48:55], v116
    buffer_load_dwordx4 v117, s[8:11], s30 offen lds
    s_waitcnt lgkmcnt(2)
    v_smfmac_f32_16x16x64_bf16 v[32:35], v[28:31], a[80:87], v116
    ds_read_b128 v[96:99], v117 offset:23552
    v_smfmac_f32_16x16x64_bf16 v[36:39], v[12:15], a[24:31], v116
    ds_read_b128 v[100:103], v117 offset:23552
    v_smfmac_f32_16x16x64_bf16 v[36:39], v[24:27], a[56:63], v116
    buffer_load_dwordx4 v117, s[8:11], s30 offen offset:1024 lds
    s_add_u32 m0, s52, 0x6000
    v_add_f32 v32, v32, v34
    v_smfmac_f32_16x16x64_bf16 v[36:39], v[28:31], a[88:95], v116
    ds_read_b128 v[104:107], v117 offset:23552
    v_add_f32 v33, v33, v35
    v_smfmac_f32_16x16x64_bf16 v[40:43], v[12:15], a[112:119], v116
    ds_read_b128 v[108:111], v117 offset:23552
    v_mul_f32 v32, s34, v32
    v_smfmac_f32_16x16x64_bf16 v[40:43], v[24:27], a[144:151], v116
    buffer_load_dword v125, v119, s[8:11], s28 offen sc1
    v_mul_f32 v33, s34, v33
    v_smfmac_f32_16x16x64_bf16 v[40:43], v[28:31], a[176:183], v116
    ds_read_b128 v[0:3], v124
    v_add_f32 v36, v36, v38
    v_smfmac_f32_16x16x64_bf16 v[48:51], v[4:7], a[208:215], v116
    v_add_f32 v37, v37, v39
    v_smfmac_f32_16x16x64_bf16 v[52:55], v[4:7], a[216:223], v116
    s_waitcnt lgkmcnt(5)
    buffer_load_dwordx4 v117, s[8:11], s31 offen lds
    v_mul_f32 v36, s34, v36
    v_smfmac_f32_16x16x64_bf16 v[44:47], v[12:15], a[120:127], v116
    ds_read_b128 v[4:7], v124 offset:1024
    v_mul_f32 v37, s34, v37
    v_smfmac_f32_16x16x64_bf16 v[44:47], v[24:27], a[152:159], v116
    v_cvt_pk_bf16_f32 v34, v32, v36
    v_smfmac_f32_16x16x64_bf16 v[44:47], v[28:31], a[184:191], v116
    buffer_load_dwordx4 v117, s[8:11], s31 offen offset:1024 lds
    s_mov_b32 m0, 4096
    v_cvt_pk_bf16_f32 v35, v33, v37
    v_add_f32 v40, v40, v42
    v_smfmac_f32_16x16x64_bf16 v[48:51], v[8:11], a[224:231], v116
    ds_write2_b32 v120, v34, v35 offset0:32 offset1:48
    v_add_f32 v41, v41, v43
    v_smfmac_f32_16x16x64_bf16 v[52:55], v[8:11], a[232:239], v116
    v_add_f32 v44, v44, v46
    v_add_f32 v45, v45, v47
    v_cvt_pk_bf16_f32 v113, v40, v44
    v_cvt_pk_bf16_f32 v115, v41, v45
    v_smfmac_f32_16x16x64_bf16 v[48:51], v[12:15], a[240:247], v116
    ds_write2_b32 v120, v113, v115 offset0:0 offset1:16
    v_smfmac_f32_16x16x64_bf16 v[52:55], v[12:15], a[248:255], v116
    s_cmp_eq_u32 s22, 63
    s_cbranch_scc1 L_chain_last_s
    buffer_store_dword v126, off, s[8:11], s44 sc1
    v_smfmac_f32_16x16x64_bf16 v[48:51], v[16:19], v[128:135], v116
    v_smfmac_f32_16x16x64_bf16 v[48:51], v[20:23], v[160:167], v116
    v_smfmac_f32_16x16x64_bf16 v[48:51], v[24:27], v[144:151], v116
    s_waitcnt lgkmcnt(0)
    s_barrier
    v_smfmac_f32_16x16x64_bf16 v[48:51], v[28:31], v[176:183], v116
    ds_read_b128 v[32:35], v121 offset:16384
    ds_read_b128 v[36:39], v121 offset:17408
    v_smfmac_f32_16x16x64_bf16 v[52:55], v[16:19], v[136:143], v116
    ds_read_b128 v[40:43], v121 offset:18432
    ds_read_b128 v[44:47], v121 offset:19456
    v_smfmac_f32_16x16x64_bf16 v[52:55], v[20:23], v[168:175], v116
    ds_read_b128 v[8:11], v124 offset:32768
    v_add_f32 v48, v48, v50
    v_smfmac_f32_16x16x64_bf16 v[52:55], v[24:27], v[152:159], v116
    ds_read_b128 v[12:15], v124 offset:33792
    v_add_f32 v49, v49, v51
    v_smfmac_f32_16x16x64_bf16 v[52:55], v[28:31], v[184:191], v116
    s_waitcnt lgkmcnt(5)
    v_cvt_pk_bf16_f32 v112, v48, v49
    v_mfma_f32_16x16x32_bf16 v[56:59], v[56:59], v[32:35], 0
    s_waitcnt lgkmcnt(4)
    v_mov_b32 v48, s50
    v_mov_b32 v49, s50
    v_mfma_f32_16x16x32_bf16 v[56:59], v[60:63], v[36:39], v[56:59]
    ds_read_b128 v[16:19], v124 offset:2048
    s_waitcnt lgkmcnt(4)
    v_mov_b32 v50, s50
    v_mov_b32 v51, s50
    v_mfma_f32_16x16x32_bf16 v[56:59], v[64:67], v[40:43], v[56:59]
    ds_read_b128 v[20:23], v124 offset:3072
    s_waitcnt lgkmcnt(4)
    v_add_f32 v52, v52, v54
    v_mfma_f32_16x16x32_bf16 v[56:59], v[68:71], v[44:47], v[56:59]
    ds_read_b128 v[24:27], v124 offset:4096
    v_add_f32 v53, v53, v55
    v_mfma_f32_16x16x32_bf16 v[60:63], v[72:75], v[32:35], 0
    ds_read_b128 v[28:31], v124 offset:5120
    v_cvt_pk_bf16_f32 v114, v52, v53
    v_mov_b32 v53, 0
    v_mfma_f32_16x16x32_bf16 v[60:63], v[76:79], v[36:39], v[60:63]
    v_exp_f32 v56, v56
    v_mfma_f32_16x16x32_bf16 v[60:63], v[80:83], v[40:43], v[60:63]
    v_exp_f32 v57, v57
    v_mfma_f32_16x16x32_bf16 v[60:63], v[84:87], v[44:47], v[60:63]
    v_exp_f32 v58, v58
    v_mfma_f32_16x16x32_bf16 v[64:67], v[32:35], v[32:35], 0
    v_exp_f32 v59, v59
    v_cvt_pk_bf16_f32 v68, v56, v57
    v_mfma_f32_16x16x32_bf16 v[64:67], v[36:39], v[36:39], v[64:67]
    v_exp_f32 v60, v60
    v_cvt_pk_bf16_f32 v69, v58, v59
    v_mfma_f32_16x16x32_bf16 v[64:67], v[40:43], v[40:43], v[64:67]
    v_exp_f32 v61, v61
    v_mfma_f32_16x16x32_bf16 v[64:67], v[44:47], v[44:47], v[64:67]
    v_exp_f32 v62, v62
    v_exp_f32 v63, v63
    v_cvt_pk_bf16_f32 v70, v60, v61
    v_cvt_pk_bf16_f32 v71, v62, v63
    s_nop 1
    v_mfma_f32_16x16x32_bf16 v[72:75], v[88:91], v[68:71], 0
    s_nop 0
    v_exp_f32 v64, v64
    v_mfma_f32_16x16x32_bf16 v[76:79], v[92:95], v[68:71], 0
    v_exp_f32 v65, v65
    v_mfma_f32_16x16x32_bf16 v[80:83], v[48:51], v[68:71], 0
    v_cvt_pk_bf16_f32 v52, v64, v65
    s_nop 1
    v_mfma_f32_16x16x16_bf16 v[72:75], v[112:113], v[52:53], v[72:75]
    ds_read_b128 v[32:35], v124 offset:6144
    v_mfma_f32_16x16x16_bf16 v[76:79], v[114:115], v[52:53], v[76:79]
    ds_read_b128 v[36:39], v124 offset:7168
    v_mfma_f32_16x16x16_bf16 v[80:83], v[48:49], v[52:53], v[80:83]
L_norm_61:
    s_mov_b64 vcc, s[36:37]
    v_mov_b32 v122, v122
    v_mov_b32 v122, v122
    v_mov_b32 v122, v122
    v_cndmask_b32_dpp v76, v72, v76, vcc quad_perm:[2,3,2,3] row_mask:0xf bank_mask:0xf
    v_cndmask_b32_dpp v77, v73, v77, vcc quad_perm:[2,3,2,3] row_mask:0xf bank_mask:0xf
    v_cndmask_b32_dpp v78, v74, v78, vcc quad_perm:[2,3,2,3] row_mask:0xf bank_mask:0xf
    v_cndmask_b32_dpp v79, v75, v79, vcc quad_perm:[2,3,2,3] row_mask:0xf bank_mask:0xf
    v_rcp_f32_dpp v84, v80 quad_perm:[2,3,2,3] row_mask:0xf bank_mask:0xf
    s_nop 0
    v_pk_mul_f32 v[76:77], v[76:77], v[84:85] op_sel_hi:[1,0]
    v_pk_mul_f32 v[78:79], v[78:79], v[84:85] op_sel_hi:[1,0]
    v_cvt_pk_bf16_f32 v72, v76, v77
    v_cvt_pk_bf16_f32 v73, v78, v79
    ds_write_b64 v122, v[72:73] offset:20480
    v_max_f32_dpp v86, v80, v84 quad_perm:[2,3,2,3] row_mask:0xf bank_mask:0xf
    v_mov_b32_dpp v60, v72 quad_perm:[0,1,0,1] row_mask:0xf bank_mask:0xf
    v_mov_b32_dpp v61, v73 quad_perm:[0,1,0,1] row_mask:0xf bank_mask:0xf
    v_cmp_lt_f32 vcc, s35, v86
    v_mov_b32_dpp v62, v72 quad_perm:[2,3,2,3] row_mask:0xf bank_mask:0xf
    v_mov_b32_dpp v63, v73 quad_perm:[2,3,2,3] row_mask:0xf bank_mask:0xf
    s_nop 1
    v_smfmac_f32_16x16x64_bf16 v[96:99], v[60:63], v[192:199], v116
    s_cbranch_vccnz L_smax_62
    v_smfmac_f32_16x16x64_bf16 v[100:103], v[60:63], v[224:231], v116
    s_waitcnt lgkmcnt(0)
    s_barrier
    ds_read_b128 v[92:95], v127 offset:20992
    ds_read_b128 v[80:83], v127 offset:21504
    ds_read_b128 v[84:87], v127 offset:22016
    v_smfmac_f32_16x16x64_bf16 v[104:107], v[60:63], v[0:7], v116
    ds_read_b128 v[40:43], v124 offset:34816
    v_smfmac_f32_16x16x64_bf16 v[108:111], v[60:63], v[8:15], v116
    ds_read_b128 v[56:59], v124 offset:36864
    s_waitcnt lgkmcnt(4)
    v_smfmac_f32_16x16x64_bf16 v[96:99], v[92:95], v[200:207], v116
    s_waitcnt lgkmcnt(3)
    v_smfmac_f32_16x16x64_bf16 v[96:99], v[80:83], v[208:215], v116
    ds_read_b128 v[44:47], v124 offset:35840
    s_waitcnt lgkmcnt(3)
    v_smfmac_f32_16x16x64_bf16 v[96:99], v[84:87], v[216:223], v116
    ds_read_b128 v[68:71], v124 offset:39936
    v_smfmac_f32_16x16x64_bf16 v[100:103], v[92:95], v[232:239], v116
    ds_read_b128 v[64:67], v124 offset:38912
    v_smfmac_f32_16x16x64_bf16 v[100:103], v[80:83], v[240:247], v116
    ds_read_b128 v[60:63], v124 offset:37888
    v_cvt_pk_bf16_f32 v72, v96, v98
    v_smfmac_f32_16x16x64_bf16 v[100:103], v[84:87], v[248:255], v116
    v_and_or_b32 v72, v72, -2, s33
    v_smfmac_f32_16x16x64_bf16 v[104:107], v[92:95], v[16:23], v116
    v_cvt_pk_bf16_f32 v74, v97, v99
    v_smfmac_f32_16x16x64_bf16 v[104:107], v[80:83], v[24:31], v116
    v_cvt_pk_bf16_f32 v73, v100, v102
    v_cvt_pk_bf16_f32 v75, v101, v103
    v_smfmac_f32_16x16x64_bf16 v[104:107], v[84:87], v[32:39], v116
    buffer_store_dwordx4 v[72:75], v118, s[8:11], s25 offen sc1
    s_waitcnt lgkmcnt(3)
    v_smfmac_f32_16x16x64_bf16 v[108:111], v[92:95], v[40:47], v116
    s_waitcnt lgkmcnt(0)
    v_smfmac_f32_16x16x64_bf16 v[108:111], v[80:83], v[56:63], v116
    v_cvt_pk_bf16_f32 v76, v104, v106
    v_smfmac_f32_16x16x64_bf16 v[108:111], v[84:87], v[64:71], v116
    v_and_or_b32 v76, v76, -2, s33
    v_cvt_pk_bf16_f32 v78, v105, v107
    v_mov_b32 v122, v122
    v_mov_b32 v122, v122
    v_mov_b32 v122, v122
    v_mov_b32 v122, v122
    v_mov_b32 v122, v122
    v_mov_b32 v122, v122
    v_cvt_pk_bf16_f32 v77, v108, v110
    v_cvt_pk_bf16_f32 v79, v109, v111
    buffer_store_dwordx4 v[76:79], v118, s[8:11], s26 offen sc1
    s_add_u32 s30, s30, 0x40000
    s_add_u32 s31, s31, 0x40000
    s_add_u32 s32, s32, 0x20000
    s_add_u32 s23, s24, 0
    s_add_u32 s48, s23, 4096
    s_xor_b32 s25, s25, 0x0
    s_xor_b32 s26, s26, 0x0
    s_mov_b32 s35, 0x49800000
    v_mov_b32 v126, s22
    s_add_u32 s22, s22, 1
    v_mov_b32 v32, 0
    v_mov_b32 v33, 0
    v_mov_b32 v34, 0
    v_mov_b32 v35, 0
    v_mov_b32 v36, 0
    v_mov_b32 v37, 0
    v_mov_b32 v38, 0
    v_mov_b32 v39, 0
    v_mov_b32 v40, 0
    v_mov_b32 v41, 0
    v_mov_b32 v42, 0
    v_mov_b32 v43, 0
    v_mov_b32 v44, 0
    v_mov_b32 v45, 0
    v_mov_b32 v46, 0
    v_mov_b32 v47, 0
    v_mov_b32 v48, 0
    v_mov_b32 v49, 0
    v_mov_b32 v50, 0
    v_mov_b32 v51, 0
    v_mov_b32 v52, 0
    v_mov_b32 v53, 0
    v_mov_b32 v54, 0
    v_mov_b32 v55, 0
    ds_read_b128 v[80:83], v123
    ds_read_b128 v[84:87], v123 offset:1024
    ds_read_b128 v[56:59], v123 offset:2048
    ds_read_b128 v[60:63], v123 offset:3072
    ds_read_b128 v[64:67], v123 offset:32768
    ds_read_b128 v[68:71], v123 offset:33792
    ds_read_b128 v[72:75], v123 offset:34816
    ds_read_b128 v[76:79], v123 offset:35840
    ds_read_b128 v[88:91], v123 offset:4096
    ds_read_b128 v[92:95], v123 offset:5120
    ds_read_b128 v[96:99], v123 offset:6144
    ds_read_b128 v[100:103], v123 offset:7168
    ds_read_b128 v[104:107], v123 offset:36864
    ds_read_b128 v[108:111], v123 offset:37888
    ds_read_b128 v[24:27], v123 offset:38912
    ds_read_b128 v[28:31], v123 offset:39936
    s_add_u32 s24, s24, 8192
    s_bitset0_b32 s24, 15
    s_xor_b32 s55, s24, 16384
    s_xor_b32 s29, s29, 0x0
    s_xor_b32 s53, s29, 1024
    s_bfe_u32 s33, s22, 0x10000
    s_add_u32 s40, s22, 5
    s_lshr_b32 s40, s40, 2
    s_min_u32 s40, s40, 16
    s_bfm_b32 s58, s40, 0
    s_waitcnt vmcnt(5)
    v_cmp_eq_u32 vcc, 0, v125
    s_nop 0
    s_and_b64 vcc, vcc, s[58:59]
    s_cbranch_scc1 L_kvw_63
L_kvb_64:
    v_mov_b32 v15, 0
    s_nop 2
    v_mov_b32 v15, 0
    s_nop 2
    v_mov_b32 v15, 0
    s_nop 2
    v_mov_b32 v15, 0
    s_nop 2
    v_mov_b32 v15, 0
    s_nop 2
    v_mov_b32 v15, 0
    s_nop 2
    v_mov_b32 v15, 0
    s_nop 2
    v_mov_b32 v15, 0
    s_nop 2
    v_mov_b32 v15, 0
    s_nop 2
    v_mov_b32 v15, 0
    s_nop 2
    v_mov_b32 v15, 0
    s_nop 2
    v_mov_b32 v15, 0
    s_nop 2
    v_mov_b32 v15, 0
    s_nop 2
    v_mov_b32 v15, 0
    s_nop 2
    v_mov_b32 v15, 0
    s_nop 2
    v_mov_b32 v15, 0
    s_nop 2
    v_mov_b32 v15, 0
    s_nop 2
    v_mov_b32 v15, 0
    s_nop 2
    v_mov_b32 v15, 0
    s_nop 2
    v_mov_b32 v15, 0
    s_nop 2
    v_mov_b32 v15, 0
    s_nop 2
    v_mov_b32 v15, 0
    s_nop 2
    v_mov_b32 v15, 0
    s_nop 2
    v_mov_b32 v15, 0
    s_nop 2
    v_mov_b32 v15, 0
    s_nop 2
    v_mov_b32 v15, 0
    s_nop 2
    v_mov_b32 v15, 0
    s_nop 2
    v_mov_b32 v15, 0
    s_nop 2
    v_mov_b32 v15, 0
    s_nop 2
    v_mov_b32 v15, 0
    s_nop 2
    v_mov_b32 v15, 0
    s_nop 2
    s_waitcnt lgkmcnt(0)
    s_branch L_chain_top0_s
.p2align 6
L_chain_top1_s:
    buffer_load_dwordx4 v[0:3], v117, s[8:11], s23 offen sc1
    v_mov_b32 v15, 0
    v_mov_b32 v15, 0
    v_mov_b32 v15, 0
    v_mov_b32 v15, 0
    v_mov_b32 v15, 0
    v_mov_b32 v15, 0
    v_mov_b32 v15, 0
    v_mov_b32 v15, 0
    v_mov_b32 v15, 0
    v_mov_b32 v15, 0
    v_mov_b32 v15, 0
    v_mov_b32 v15, 0
    v_mov_b32 v15, 0
    v_mov_b32 v15, 0
    v_mov_b32 v15, 0
    v_mov_b32 v15, 0
    buffer_load_dwordx4 v[0:3], v117, s[8:11], s23 offen sc1
    v_mov_b32 v15, 0
    v_mov_b32 v15, 0
    v_mov_b32 v15, 0
    v_mov_b32 v15, 0
    v_mov_b32 v15, 0
    v_mov_b32 v15, 0
    v_mov_b32 v15, 0
    v_mov_b32 v15, 0
    v_mov_b32 v15, 0
    v_mov_b32 v15, 0
    v_mov_b32 v15, 0
    v_mov_b32 v15, 0
    v_mov_b32 v15, 0
    v_mov_b32 v15, 0
    v_mov_b32 v15, 0
    v_mov_b32 v15, 0
L_mret_65:
    buffer_load_dwordx4 v[0:3], v117, s[8:11], s23 offen sc1
    s_add_u32 s45, s45, 1
    s_cmp_lt_u32 s45, 0x10000
    s_cselect_b32 s56, -2, -1
    s_nop 3
    v_mov_b32 v32, 0
    v_mov_b32 v33, 0
    v_mov_b32 v34, 0
    v_mov_b32 v35, 0
    s_waitcnt vmcnt(2)
    v_max3_u32 v15, v0, v1, v2
    v_max_u32 v15, v15, v3
    v_cmp_lt_u32 vcc, s56, v15
    v_smfmac_f32_16x16x64_bf16 v[32:35], v[0:3], v[80:87], v116
    s_cbranch_vccnz L_mret_65
    ds_write_b128 v117, v[0:3] offset:1024
    v_smfmac_f32_16x16x64_bf16 v[36:39], v[0:3], v[56:63], v116
    buffer_load_dwordx4 v[4:7], v117, s[8:11], s48 offen sc1
    v_smfmac_f32_16x16x64_bf16 v[40:43], v[0:3], v[64:71], v116
    buffer_load_dwordx4 v117, s[8:11], s48 offen sc1 lds
    s_mov_b32 m0, 10240
    v_smfmac_f32_16x16x64_bf16 v[44:47], v[0:3], v[72:79], v116
    s_waitcnt lgkmcnt(0)
    s_barrier
    ds_read_b128 v[8:11], v117
    v_smfmac_f32_16x16x64_bf16 v[48:51], v[0:3], a[192:199], v116
    ds_read_b128 v[16:19], v117 offset:3072
    ds_read_b128 v[20:23], v117 offset:2048
    v_smfmac_f32_16x16x64_bf16 v[52:55], v[0:3], a[200:207], v116
    ds_read_b128 v[80:83], v117 offset:14336
    s_waitcnt lgkmcnt(3)
    v_smfmac_f32_16x16x64_bf16 v[32:35], v[8:11], a[0:7], v116
    ds_read_b128 v[84:87], v117 offset:15360
    v_smfmac_f32_16x16x64_bf16 v[36:39], v[8:11], a[8:15], v116
    ds_read_b128 v[56:59], v117 offset:8192
    s_waitcnt lgkmcnt(4)
    v_smfmac_f32_16x16x64_bf16 v[32:35], v[16:19], a[32:39], v116
    ds_read_b128 v[60:63], v117 offset:9216
    v_smfmac_f32_16x16x64_bf16 v[36:39], v[16:19], a[40:47], v116
    buffer_store_dwordx4 v[112:115], v117, s[8:11], s32 offen sc1
    s_waitcnt lgkmcnt(4)
    v_smfmac_f32_16x16x64_bf16 v[32:35], v[20:23], a[64:71], v116
    ds_read_b128 v[64:67], v117 offset:10240
    v_smfmac_f32_16x16x64_bf16 v[36:39], v[20:23], a[72:79], v116
    ds_read_b128 v[68:71], v117 offset:11264
    v_smfmac_f32_16x16x64_bf16 v[40:43], v[8:11], a[96:103], v116
    ds_read_b128 v[72:75], v117 offset:12288
    v_smfmac_f32_16x16x64_bf16 v[40:43], v[16:19], a[128:135], v116
    ds_read_b128 v[76:79], v117 offset:13312
    v_smfmac_f32_16x16x64_bf16 v[40:43], v[20:23], a[160:167], v116
    s_waitcnt vmcnt(2)
    v_max3_u32 v15, v4, v5, v6
    v_smfmac_f32_16x16x64_bf16 v[44:47], v[8:11], a[104:111], v116
    v_max_u32 v15, v15, v7
    v_smfmac_f32_16x16x64_bf16 v[44:47], v[16:19], a[136:143], v116
    s_waitcnt vmcnt(1) lgkmcnt(0)
    v_cmp_lt_u32 vcc, s56, v15
    v_smfmac_f32_16x16x64_bf16 v[44:47], v[20:23], a[168:175], v116
    s_cbranch_vccnz L_mret_66
L_mgo_67:
    v_smfmac_f32_16x16x64_bf16 v[44:47], v[4:7], v[24:31], v116
    s_barrier
    ds_read_b128 v[12:15], v117 offset:4096
    v_smfmac_f32_16x16x64_bf16 v[32:35], v[4:7], v[88:95], v116
    ds_read_b128 v[24:27], v117 offset:7168
    v_smfmac_f32_16x16x64_bf16 v[36:39], v[4:7], v[96:103], v116
    ds_read_b128 v[28:31], v117 offset:6144
    v_smfmac_f32_16x16x64_bf16 v[40:43], v[4:7], v[104:111], v116
    ds_read_b128 v[88:91], v117 offset:26624
    s_waitcnt lgkmcnt(3)
    v_smfmac_f32_16x16x64_bf16 v[32:35], v[12:15], a[16:23], v116
    ds_read_b128 v[92:95], v117 offset:27648
    s_waitcnt lgkmcnt(3)
    v_smfmac_f32_16x16x64_bf16 v[32:35], v[24:27], a[48:55], v116
    buffer_load_dwordx4 v117, s[8:11], s30 offen lds
    s_waitcnt lgkmcnt(2)
    v_smfmac_f32_16x16x64_bf16 v[32:35], v[28:31], a[80:87], v116
    ds_read_b128 v[96:99], v117 offset:23552
    v_smfmac_f32_16x16x64_bf16 v[36:39], v[12:15], a[24:31], v116
    ds_read_b128 v[100:103], v117 offset:23552
    v_smfmac_f32_16x16x64_bf16 v[36:39], v[24:27], a[56:63], v116
    buffer_load_dwordx4 v117, s[8:11], s30 offen offset:1024 lds
    s_add_u32 m0, s52, 0x6000
    v_add_f32 v32, v32, v34
    v_smfmac_f32_16x16x64_bf16 v[36:39], v[28:31], a[88:95], v116
    ds_read_b128 v[104:107], v117 offset:23552
    v_add_f32 v33, v33, v35
    v_smfmac_f32_16x16x64_bf16 v[40:43], v[12:15], a[112:119], v116
    ds_read_b128 v[108:111], v117 offset:23552
    v_mul_f32 v32, s34, v32
    v_smfmac_f32_16x16x64_bf16 v[40:43], v[24:27], a[144:151], v116
    buffer_load_dword v125, v119, s[8:11], s28 offen sc1
    v_mul_f32 v33, s34, v33
    v_smfmac_f32_16x16x64_bf16 v[40:43], v[28:31], a[176:183], v116
    ds_read_b128 v[0:3], v124
    v_add_f32 v36, v36, v38
    v_smfmac_f32_16x16x64_bf16 v[48:51], v[4:7], a[208:215], v116
    v_add_f32 v37, v37, v39
    v_smfmac_f32_16x16x64_bf16 v[52:55], v[4:7], a[216:223], v116
    s_waitcnt lgkmcnt(5)
    buffer_load_dwordx4 v117, s[8:11], s31 offen lds
    v_mul_f32 v36, s34, v36
    v_smfmac_f32_16x16x64_bf16 v[44:47], v[12:15], a[120:127], v116
    ds_read_b128 v[4:7], v124 offset:1024
    v_mul_f32 v37, s34, v37
    v_smfmac_f32_16x16x64_bf16 v[44:47], v[24:27], a[152:159], v116
    v_cvt_pk_bf16_f32 v34, v32, v36
    v_smfmac_f32_16x16x64_bf16 v[44:47], v[28:31], a[184:191], v116
    buffer_load_dwordx4 v117, s[8:11], s31 offen offset:1024 lds
    s_mov_b32 m0, 5120
    v_cvt_pk_bf16_f32 v35, v33, v37
    v_add_f32 v40, v40, v42
    v_smfmac_f32_16x16x64_bf16 v[48:51], v[8:11], a[224:231], v116
    ds_write2_b32 v120, v34, v35 offset0:32 offset1:48
    v_add_f32 v41, v41, v43
    v_smfmac_f32_16x16x64_bf16 v[52:55], v[8:11], a[232:239], v116
    v_add_f32 v44, v44, v46
    v_add_f32 v45, v45, v47
    v_cvt_pk_bf16_f32 v113, v40, v44
    v_cvt_pk_bf16_f32 v115, v41, v45
    v_smfmac_f32_16x16x64_bf16 v[48:51], v[12:15], a[240:247], v116
    ds_write2_b32 v120, v113, v115 offset0:0 offset1:16
    v_smfmac_f32_16x16x64_bf16 v[52:55], v[12:15], a[248:255], v116
    s_cmp_eq_u32 s22, 63
    s_cbranch_scc1 L_chain_last_s
    v_smfmac_f32_16x16x64_bf16 v[48:51], v[16:19], v[128:135], v116
    v_smfmac_f32_16x16x64_bf16 v[48:51], v[20:23], v[160:167], v116
    v_smfmac_f32_16x16x64_bf16 v[48:51], v[24:27], v[144:151], v116
    s_waitcnt lgkmcnt(0)
    s_barrier
    v_smfmac_f32_16x16x64_bf16 v[48:51], v[28:31], v[176:183], v116
    ds_read_b128 v[32:35], v121 offset:16384
    ds_read_b128 v[36:39], v121 offset:17408
    v_smfmac_f32_16x16x64_bf16 v[52:55], v[16:19], v[136:143], v116
    ds_read_b128 v[40:43], v121 offset:18432
    ds_read_b128 v[44:47], v121 offset:19456
    v_smfmac_f32_16x16x64_bf16 v[52:55], v[20:23], v[168:175], v116
    ds_read_b128 v[8:11], v124 offset:32768
    v_add_f32 v48, v48, v50
    v_smfmac_f32_16x16x64_bf16 v[52:55], v[24:27], v[152:159], v116
    ds_read_b128 v[12:15], v124 offset:33792
    v_add_f32 v49, v49, v51
    v_smfmac_f32_16x16x64_bf16 v[52:55], v[28:31], v[184:191], v116
    s_waitcnt lgkmcnt(5)
    v_cvt_pk_bf16_f32 v112, v48, v49
    v_mfma_f32_16x16x32_bf16 v[56:59], v[56:59], v[32:35], 0
    s_waitcnt lgkmcnt(4)
    v_mov_b32 v48, s50
    v_mov_b32 v49, s50
    v_mfma_f32_16x16x32_bf16 v[56:59], v[60:63], v[36:39], v[56:59]
    ds_read_b128 v[16:19], v124 offset:2048
    s_waitcnt lgkmcnt(4)
    v_mov_b32 v50, s50
    v_mov_b32 v51, s50
    v_mfma_f32_16x16x32_bf16 v[56:59], v[64:67], v[40:43], v[56:59]
    ds_read_b128 v[20:23], v124 offset:3072
    s_waitcnt lgkmcnt(4)
    v_add_f32 v52, v52, v54
    v_mfma_f32_16x16x32_bf16 v[56:59], v[68:71], v[44:47], v[56:59]
    ds_read_b128 v[24:27], v124 offset:4096
    v_add_f32 v53, v53, v55
    v_mfma_f32_16x16x32_bf16 v[60:63], v[72:75], v[32:35], 0
    ds_read_b128 v[28:31], v124 offset:5120
    v_cvt_pk_bf16_f32 v114, v52, v53
    v_mov_b32 v53, 0
    v_mfma_f32_16x16x32_bf16 v[60:63], v[76:79], v[36:39], v[60:63]
    v_exp_f32 v56, v56
    v_mfma_f32_16x16x32_bf16 v[60:63], v[80:83], v[40:43], v[60:63]
    v_exp_f32 v57, v57
    v_mfma_f32_16x16x32_bf16 v[60:63], v[84:87], v[44:47], v[60:63]
    v_exp_f32 v58, v58
    v_mfma_f32_16x16x32_bf16 v[64:67], v[32:35], v[32:35], 0
    v_exp_f32 v59, v59
    v_cvt_pk_bf16_f32 v68, v56, v57
    v_mfma_f32_16x16x32_bf16 v[64:67], v[36:39], v[36:39], v[64:67]
    v_exp_f32 v60, v60
    v_cvt_pk_bf16_f32 v69, v58, v59
    v_mfma_f32_16x16x32_bf16 v[64:67], v[40:43], v[40:43], v[64:67]
    v_exp_f32 v61, v61
    v_mfma_f32_16x16x32_bf16 v[64:67], v[44:47], v[44:47], v[64:67]
    v_exp_f32 v62, v62
    v_exp_f32 v63, v63
    v_cvt_pk_bf16_f32 v70, v60, v61
    v_cvt_pk_bf16_f32 v71, v62, v63
    s_nop 1
    v_mfma_f32_16x16x32_bf16 v[72:75], v[88:91], v[68:71], 0
    s_nop 0
    v_exp_f32 v64, v64
    v_mfma_f32_16x16x32_bf16 v[76:79], v[92:95], v[68:71], 0
    v_exp_f32 v65, v65
    v_mfma_f32_16x16x32_bf16 v[80:83], v[48:51], v[68:71], 0
    v_cvt_pk_bf16_f32 v52, v64, v65
    s_nop 1
    v_mfma_f32_16x16x16_bf16 v[72:75], v[112:113], v[52:53], v[72:75]
    ds_read_b128 v[32:35], v124 offset:6144
    v_mfma_f32_16x16x16_bf16 v[76:79], v[114:115], v[52:53], v[76:79]
    ds_read_b128 v[36:39], v124 offset:7168
    v_mfma_f32_16x16x16_bf16 v[80:83], v[48:49], v[52:53], v[80:83]
L_norm_68:
    s_mov_b64 vcc, s[36:37]
    v_mov_b32 v122, v122
    v_mov_b32 v122, v122
    v_mov_b32 v122, v122
    v_cndmask_b32_dpp v76, v72, v76, vcc quad_perm:[2,3,2,3] row_mask:0xf bank_mask:0xf
    v_cndmask_b32_dpp v77, v73, v77, vcc quad_perm:[2,3,2,3] row_mask:0xf bank_mask:0xf
    v_cndmask_b32_dpp v78, v74, v78, vcc quad_perm:[2,3,2,3] row_mask:0xf bank_mask:0xf
    v_cndmask_b32_dpp v79, v75, v79, vcc quad_perm:[2,3,2,3] row_mask:0xf bank_mask:0xf
    v_rcp_f32_dpp v84, v80 quad_perm:[2,3,2,3] row_mask:0xf bank_mask:0xf
    s_nop 0
    v_pk_mul_f32 v[76:77], v[76:77], v[84:85] op_sel_hi:[1,0]
    v_pk_mul_f32 v[78:79], v[78:79], v[84:85] op_sel_hi:[1,0]
    v_cvt_pk_bf16_f32 v72, v76, v77
    v_cvt_pk_bf16_f32 v73, v78, v79
    ds_write_b64 v122, v[72:73] offset:20992
    v_max_f32_dpp v86, v80, v84 quad_perm:[2,3,2,3] row_mask:0xf bank_mask:0xf
    v_mov_b32_dpp v60, v72 quad_perm:[0,1,0,1] row_mask:0xf bank_mask:0xf
    v_mov_b32_dpp v61, v73 quad_perm:[0,1,0,1] row_mask:0xf bank_mask:0xf
    v_cmp_lt_f32 vcc, s35, v86
    v_mov_b32_dpp v62, v72 quad_perm:[2,3,2,3] row_mask:0xf bank_mask:0xf
    v_mov_b32_dpp v63, v73 quad_perm:[2,3,2,3] row_mask:0xf bank_mask:0xf
    s_nop 1
    v_smfmac_f32_16x16x64_bf16 v[96:99], v[60:63], v[192:199], v116
    s_cbranch_vccnz L_smax_69
    v_smfmac_f32_16x16x64_bf16 v[100:103], v[60:63], v[224:231], v116
    s_waitcnt lgkmcnt(0)
    s_barrier
    ds_read_b128 v[92:95], v127 offset:20480
    ds_read_b128 v[80:83], v127 offset:22016
    ds_read_b128 v[84:87], v127 offset:21504
    v_smfmac_f32_16x16x64_bf16 v[104:107], v[60:63], v[0:7], v116
    ds_read_b128 v[40:43], v124 offset:34816
    v_smfmac_f32_16x16x64_bf16 v[108:111], v[60:63], v[8:15], v116
    ds_read_b128 v[56:59], v124 offset:36864
    s_waitcnt lgkmcnt(4)
    v_smfmac_f32_16x16x64_bf16 v[96:99], v[92:95], v[200:207], v116
    s_waitcnt lgkmcnt(3)
    v_smfmac_f32_16x16x64_bf16 v[96:99], v[80:83], v[208:215], v116
    ds_read_b128 v[44:47], v124 offset:35840
    s_waitcnt lgkmcnt(3)
    v_smfmac_f32_16x16x64_bf16 v[96:99], v[84:87], v[216:223], v116
    ds_read_b128 v[68:71], v124 offset:39936
    v_smfmac_f32_16x16x64_bf16 v[100:103], v[92:95], v[232:239], v116
    ds_read_b128 v[64:67], v124 offset:38912
    v_smfmac_f32_16x16x64_bf16 v[100:103], v[80:83], v[240:247], v116
    ds_read_b128 v[60:63], v124 offset:37888
    v_cvt_pk_bf16_f32 v72, v96, v98
    v_smfmac_f32_16x16x64_bf16 v[100:103], v[84:87], v[248:255], v116
    v_and_or_b32 v72, v72, -2, s33
    v_smfmac_f32_16x16x64_bf16 v[104:107], v[92:95], v[16:23], v116
    v_cvt_pk_bf16_f32 v74, v97, v99
    v_smfmac_f32_16x16x64_bf16 v[104:107], v[80:83], v[24:31], v116
    v_cvt_pk_bf16_f32 v73, v100, v102
    v_cvt_pk_bf16_f32 v75, v101, v103
    v_smfmac_f32_16x16x64_bf16 v[104:107], v[84:87], v[32:39], v116
    buffer_store_dwordx4 v[72:75], v118, s[8:11], s25 offen sc1
    s_waitcnt lgkmcnt(3)
    v_smfmac_f32_16x16x64_bf16 v[108:111], v[92:95], v[40:47], v116
    s_waitcnt lgkmcnt(0)
    v_smfmac_f32_16x16x64_bf16 v[108:111], v[80:83], v[56:63], v116
    v_cvt_pk_bf16_f32 v76, v104, v106
    v_smfmac_f32_16x16x64_bf16 v[108:111], v[84:87], v[64:71], v116
    v_and_or_b32 v76, v76, -2, s33
    v_cvt_pk_bf16_f32 v78, v105, v107
    v_mov_b32 v122, v122
    v_mov_b32 v122, v122
    v_mov_b32 v122, v122
    v_mov_b32 v122, v122
    v_mov_b32 v122, v122
    v_mov_b32 v122, v122
    v_cvt_pk_bf16_f32 v77, v108, v110
    v_cvt_pk_bf16_f32 v79, v109, v111
    buffer_store_dwordx4 v[76:79], v118, s[8:11], s26 offen sc1
    s_add_u32 s30, s30, 0x40000
    s_add_u32 s31, s31, 0x40000
    s_add_u32 s32, s32, 0x20000
    s_add_u32 s23, s24, 1024
    s_add_u32 s48, s23, 4096
    s_xor_b32 s25, s25, 0x0
    s_xor_b32 s26, s26, 0x0
    s_mov_b32 s35, 0x49800000
    s_add_u32 s22, s22, 1
    v_mov_b32 v32, 0
    v_mov_b32 v33, 0
    v_mov_b32 v34, 0
    v_mov_b32 v35, 0
    v_mov_b32 v36, 0
    v_mov_b32 v37, 0
    v_mov_b32 v38, 0
    v_mov_b32 v39, 0
    v_mov_b32 v40, 0
    v_mov_b32 v41, 0
    v_mov_b32 v42, 0
    v_mov_b32 v43, 0
    v_mov_b32 v44, 0
    v_mov_b32 v45, 0
    v_mov_b32 v46, 0
    v_mov_b32 v47, 0
    v_mov_b32 v48, 0
    v_mov_b32 v49, 0
    v_mov_b32 v50, 0
    v_mov_b32 v51, 0
    v_mov_b32 v52, 0
    v_mov_b32 v53, 0
    v_mov_b32 v54, 0
    v_mov_b32 v55, 0
    ds_read_b128 v[80:83], v123
    ds_read_b128 v[84:87], v123 offset:1024
    ds_read_b128 v[56:59], v123 offset:2048
    ds_read_b128 v[60:63], v123 offset:3072
    ds_read_b128 v[64:67], v123 offset:32768
    ds_read_b128 v[68:71], v123 offset:33792
    ds_read_b128 v[72:75], v123 offset:34816
    ds_read_b128 v[76:79], v123 offset:35840
    ds_read_b128 v[88:91], v123 offset:4096
    ds_read_b128 v[92:95], v123 offset:5120
    ds_read_b128 v[96:99], v123 offset:6144
    ds_read_b128 v[100:103], v123 offset:7168
    ds_read_b128 v[104:107], v123 offset:36864
    ds_read_b128 v[108:111], v123 offset:37888
    ds_read_b128 v[24:27], v123 offset:38912
    ds_read_b128 v[28:31], v123 offset:39936
    s_add_u32 s24, s24, 8192
    s_bitset0_b32 s24, 15
    s_xor_b32 s55, s24, 16384
    s_xor_b32 s29, s29, 0x0
    s_xor_b32 s53, s29, 1024
    s_bfe_u32 s33, s22, 0x10000
    s_add_u32 s40, s22, 5
    s_lshr_b32 s40, s40, 2
    s_min_u32 s40, s40, 16
    s_bfm_b32 s58, s40, 0
    s_waitcnt vmcnt(4)
    v_cmp_eq_u32 vcc, 0, v125
    s_nop 0
    s_and_b64 vcc, vcc, s[58:59]
    s_cbranch_scc1 L_kvw_70
L_kvb_71:
    v_mov_b32 v15, 0
    s_nop 2
    v_mov_b32 v15, 0
    s_nop 2
    v_mov_b32 v15, 0
    s_nop 2
    v_mov_b32 v15, 0
    s_nop 2
    v_mov_b32 v15, 0
    s_nop 2
    v_mov_b32 v15, 0
    s_nop 2
    v_mov_b32 v15, 0
    s_nop 2
    v_mov_b32 v15, 0
    s_nop 2
    v_mov_b32 v15, 0
    s_nop 2
    v_mov_b32 v15, 0
    s_nop 2
    v_mov_b32 v15, 0
    s_nop 2
    v_mov_b32 v15, 0
    s_nop 2
    v_mov_b32 v15, 0
    s_nop 2
    v_mov_b32 v15, 0
    s_nop 2
    v_mov_b32 v15, 0
    s_nop 2
    v_mov_b32 v15, 0
    s_nop 2
    v_mov_b32 v15, 0
    s_nop 2
    v_mov_b32 v15, 0
    s_nop 2
    v_mov_b32 v15, 0
    s_nop 2
    v_mov_b32 v15, 0
    s_nop 2
    v_mov_b32 v15, 0
    s_nop 2
    v_mov_b32 v15, 0
    s_nop 2
    v_mov_b32 v15, 0
    s_nop 2
    v_mov_b32 v15, 0
    s_nop 2
    v_mov_b32 v15, 0
    s_nop 2
    v_mov_b32 v15, 0
    s_nop 2
    v_mov_b32 v15, 0
    s_nop 2
    v_mov_b32 v15, 0
    s_nop 2
    v_mov_b32 v15, 0
    s_nop 2
    v_mov_b32 v15, 0
    s_nop 2
    v_mov_b32 v15, 0
    s_nop 2
    s_waitcnt lgkmcnt(0)
    s_branch L_chain_top1_s
.p2align 6
L_chain_top2_s:
    buffer_load_dwordx4 v[0:3], v117, s[8:11], s23 offen sc1
    v_mov_b32 v48, 0
    v_mov_b32 v49, 0
    v_mov_b32 v50, 0
    v_mov_b32 v51, 0
    v_mov_b32 v52, 0
    v_mov_b32 v53, 0
    v_mov_b32 v15, 0
    v_mov_b32 v15, 0
    v_mov_b32 v15, 0
    v_mov_b32 v15, 0
    v_mov_b32 v15, 0
    v_mov_b32 v15, 0
    v_mov_b32 v15, 0
    v_mov_b32 v15, 0
    v_mov_b32 v15, 0
    v_mov_b32 v15, 0
    buffer_load_dwordx4 v[0:3], v117, s[8:11], s23 offen sc1
    s_waitcnt vmcnt(3)
    v_mov_b32 v36, 0
    v_mov_b32 v37, 0
    v_mov_b32 v38, 0
    v_mov_b32 v39, 0
    v_mov_b32 v40, 0
    v_mov_b32 v41, 0
    v_mov_b32 v42, 0
    v_mov_b32 v43, 0
    v_mov_b32 v44, 0
    v_mov_b32 v45, 0
    v_mov_b32 v46, 0
    v_mov_b32 v47, 0
    v_mov_b32 v15, 0
    v_mov_b32 v15, 0
    v_mov_b32 v15, 0
    v_mov_b32 v15, 0
L_mret_72:
    buffer_load_dwordx4 v[0:3], v117, s[8:11], s23 offen sc1
    s_add_u32 s45, s45, 1
    s_cmp_lt_u32 s45, 0x10000
    s_cselect_b32 s56, -2, -1
    s_nop 3
    v_mov_b32 v32, 0
    v_mov_b32 v33, 0
    v_mov_b32 v34, 0
    v_mov_b32 v35, 0
    s_waitcnt vmcnt(2)
    v_max3_u32 v15, v0, v1, v2
    v_max_u32 v15, v15, v3
    v_cmp_lt_u32 vcc, s56, v15
    v_smfmac_f32_16x16x64_bf16 v[32:35], v[0:3], v[80:87], v116
    s_cbranch_vccnz L_mret_72
    ds_write_b128 v117, v[0:3] offset:2048
    v_smfmac_f32_16x16x64_bf16 v[36:39], v[0:3], v[56:63], v116
    buffer_load_dwordx4 v[4:7], v117, s[8:11], s48 offen sc1
    v_smfmac_f32_16x16x64_bf16 v[40:43], v[0:3], v[64:71], v116
    buffer_load_dwordx4 v117, s[8:11], s48 offen sc1 lds
    s_mov_b32 m0, 12288
    v_smfmac_f32_16x16x64_bf16 v[44:47], v[0:3], v[72:79], v116
    s_waitcnt lgkmcnt(0)
    s_barrier
    ds_read_b128 v[8:11], v117 offset:3072
    v_smfmac_f32_16x16x64_bf16 v[48:51], v[0:3], a[192:199], v116
    ds_read_b128 v[16:19], v117
    ds_read_b128 v[20:23], v117 offset:1024
    v_smfmac_f32_16x16x64_bf16 v[52:55], v[0:3], a[200:207], v116
    ds_read_b128 v[80:83], v117 offset:14336
    s_waitcnt lgkmcnt(3)
    v_smfmac_f32_16x16x64_bf16 v[32:35], v[8:11], a[0:7], v116
    ds_read_b128 v[84:87], v117 offset:15360
    v_smfmac_f32_16x16x64_bf16 v[36:39], v[8:11], a[8:15], v116
    ds_read_b128 v[56:59], v117 offset:8192
    s_waitcnt lgkmcnt(4)
    v_smfmac_f32_16x16x64_bf16 v[32:35], v[16:19], a[32:39], v116
    ds_read_b128 v[60:63], v117 offset:9216
    v_smfmac_f32_16x16x64_bf16 v[36:39], v[16:19], a[40:47], v116
    ds_read_b128 v[64:67], v117 offset:10240
    s_waitcnt lgkmcnt(5)
    v_smfmac_f32_16x16x64_bf16 v[32:35], v[20:23], a[64:71], v116
    ds_read_b128 v[68:71], v117 offset:11264
    v_smfmac_f32_16x16x64_bf16 v[36:39], v[20:23], a[72:79], v116
    buffer_store_dwordx4 v[112:115], v117, s[8:11], s32 offen sc1
    v_smfmac_f32_16x16x64_bf16 v[40:43], v[8:11], a[96:103], v116
    ds_read_b128 v[72:75], v117 offset:12288
    v_smfmac_f32_16x16x64_bf16 v[40:43], v[16:19], a[128:135], v116
    ds_read_b128 v[76:79], v117 offset:13312
    v_smfmac_f32_16x16x64_bf16 v[40:43], v[20:23], a[160:167], v116
    s_waitcnt vmcnt(2)
    v_max3_u32 v15, v4, v5, v6
    v_smfmac_f32_16x16x64_bf16 v[44:47], v[8:11], a[104:111], v116
    v_max_u32 v15, v15, v7
    v_smfmac_f32_16x16x64_bf16 v[44:47], v[16:19], a[136:143], v116
    s_waitcnt vmcnt(1) lgkmcnt(0)
    v_cmp_lt_u32 vcc, s56, v15
    v_smfmac_f32_16x16x64_bf16 v[44:47], v[20:23], a[168:175], v116
    s_cbranch_vccnz L_mret_73
L_mgo_74:
    v_smfmac_f32_16x16x64_bf16 v[44:47], v[4:7], v[24:31], v116
    s_barrier
    ds_read_b128 v[12:15], v117 offset:7168
    v_smfmac_f32_16x16x64_bf16 v[32:35], v[4:7], v[88:95], v116
    ds_read_b128 v[24:27], v117 offset:4096
    v_smfmac_f32_16x16x64_bf16 v[36:39], v[4:7], v[96:103], v116
    ds_read_b128 v[28:31], v117 offset:5120
    v_smfmac_f32_16x16x64_bf16 v[40:43], v[4:7], v[104:111], v116
    ds_read_b128 v[88:91], v117 offset:28672
    s_waitcnt lgkmcnt(3)
    v_smfmac_f32_16x16x64_bf16 v[32:35], v[12:15], a[16:23], v116
    ds_read_b128 v[92:95], v117 offset:29696
    s_waitcnt lgkmcnt(3)
    v_smfmac_f32_16x16x64_bf16 v[32:35], v[24:27], a[48:55], v116
    buffer_load_dwordx4 v117, s[8:11], s30 offen lds
    s_waitcnt lgkmcnt(2)
    v_smfmac_f32_16x16x64_bf16 v[32:35], v[28:31], a[80:87], v116
    ds_read_b128 v[96:99], v117 offset:23552
    v_smfmac_f32_16x16x64_bf16 v[36:39], v[12:15], a[24:31], v116
    ds_read_b128 v[100:103], v117 offset:23552
    v_smfmac_f32_16x16x64_bf16 v[36:39], v[24:27], a[56:63], v116
    buffer_load_dwordx4 v117, s[8:11], s30 offen offset:1024 lds
    s_add_u32 m0, s52, 0x6000
    v_add_f32 v32, v32, v34
    v_smfmac_f32_16x16x64_bf16 v[36:39], v[28:31], a[88:95], v116
    ds_read_b128 v[104:107], v117 offset:23552
    v_add_f32 v33, v33, v35
    v_smfmac_f32_16x16x64_bf16 v[40:43], v[12:15], a[112:119], v116
    ds_read_b128 v[108:111], v117 offset:23552
    v_mul_f32 v32, s34, v32
    v_smfmac_f32_16x16x64_bf16 v[40:43], v[24:27], a[144:151], v116
    s_waitcnt lgkmcnt(4)
    buffer_load_dwordx4 v117, s[8:11], s31 offen lds
    v_mul_f32 v33, s34, v33
    v_smfmac_f32_16x16x64_bf16 v[40:43], v[28:31], a[176:183], v116
    ds_read_b128 v[0:3], v124
    v_add_f32 v36, v36, v38
    v_smfmac_f32_16x16x64_bf16 v[48:51], v[4:7], a[208:215], v116
    v_add_f32 v37, v37, v39
    v_smfmac_f32_16x16x64_bf16 v[52:55], v[4:7], a[216:223], v116
    buffer_load_dwordx4 v117, s[8:11], s31 offen offset:1024 lds
    s_mov_b32 m0, 6144
    v_mul_f32 v36, s34, v36
    v_smfmac_f32_16x16x64_bf16 v[44:47], v[12:15], a[120:127], v116
    ds_read_b128 v[4:7], v124 offset:1024
    v_mul_f32 v37, s34, v37
    v_smfmac_f32_16x16x64_bf16 v[44:47], v[24:27], a[152:159], v116
    v_cvt_pk_bf16_f32 v34, v32, v36
    v_smfmac_f32_16x16x64_bf16 v[44:47], v[28:31], a[184:191], v116
    v_cvt_pk_bf16_f32 v35, v33, v37
    v_add_f32 v40, v40, v42
    v_smfmac_f32_16x16x64_bf16 v[48:51], v[8:11], a[224:231], v116
    ds_write2_b32 v120, v34, v35 offset0:32 offset1:48
    v_add_f32 v41, v41, v43
    v_smfmac_f32_16x16x64_bf16 v[52:55], v[8:11], a[232:239], v116
    v_add_f32 v44, v44, v46
    v_add_f32 v45, v45, v47
    v_cvt_pk_bf16_f32 v113, v40, v44
    v_cvt_pk_bf16_f32 v115, v41, v45
    v_smfmac_f32_16x16x64_bf16 v[48:51], v[12:15], a[240:247], v116
    ds_write2_b32 v120, v113, v115 offset0:0 offset1:16
    v_smfmac_f32_16x16x64_bf16 v[52:55], v[12:15], a[248:255], v116
    s_cmp_eq_u32 s22, 63
    s_cbranch_scc1 L_chain_last_s
    v_smfmac_f32_16x16x64_bf16 v[48:51], v[16:19], v[128:135], v116
    buffer_store_dword v126, v119, s[8:11], s55 offen sc1
    v_smfmac_f32_16x16x64_bf16 v[48:51], v[20:23], v[160:167], v116
    v_smfmac_f32_16x16x64_bf16 v[48:51], v[24:27], v[144:151], v116
    s_waitcnt lgkmcnt(0)
    s_barrier
    v_smfmac_f32_16x16x64_bf16 v[48:51], v[28:31], v[176:183], v116
    ds_read_b128 v[32:35], v121 offset:16384
    ds_read_b128 v[36:39], v121 offset:17408
    v_smfmac_f32_16x16x64_bf16 v[52:55], v[16:19], v[136:143], v116
    ds_read_b128 v[40:43], v121 offset:18432
    ds_read_b128 v[44:47], v121 offset:19456
    v_smfmac_f32_16x16x64_bf16 v[52:55], v[20:23], v[168:175], v116
    ds_read_b128 v[8:11], v124 offset:32768
    v_add_f32 v48, v48, v50
    v_smfmac_f32_16x16x64_bf16 v[52:55], v[24:27], v[152:159], v116
    ds_read_b128 v[12:15], v124 offset:33792
    v_add_f32 v49, v49, v51
    v_smfmac_f32_16x16x64_bf16 v[52:55], v[28:31], v[184:191], v116
    s_waitcnt lgkmcnt(5)
    v_cvt_pk_bf16_f32 v112, v48, v49
    v_mfma_f32_16x16x32_bf16 v[56:59], v[56:59], v[32:35], 0
    s_waitcnt lgkmcnt(4)
    v_mov_b32 v48, s50
    v_mov_b32 v49, s50
    v_mfma_f32_16x16x32_bf16 v[56:59], v[60:63], v[36:39], v[56:59]
    ds_read_b128 v[16:19], v124 offset:2048
    s_waitcnt lgkmcnt(4)
    v_mov_b32 v50, s50
    v_mov_b32 v51, s50
    v_mfma_f32_16x16x32_bf16 v[56:59], v[64:67], v[40:43], v[56:59]
    ds_read_b128 v[20:23], v124 offset:3072
    s_waitcnt lgkmcnt(4)
    v_add_f32 v52, v52, v54
    v_mfma_f32_16x16x32_bf16 v[56:59], v[68:71], v[44:47], v[56:59]
    ds_read_b128 v[24:27], v124 offset:4096
    v_add_f32 v53, v53, v55
    v_mfma_f32_16x16x32_bf16 v[60:63], v[72:75], v[32:35], 0
    ds_read_b128 v[28:31], v124 offset:5120
    v_cvt_pk_bf16_f32 v114, v52, v53
    v_mov_b32 v53, 0
    v_mfma_f32_16x16x32_bf16 v[60:63], v[76:79], v[36:39], v[60:63]
    v_exp_f32 v56, v56
    v_mfma_f32_16x16x32_bf16 v[60:63], v[80:83], v[40:43], v[60:63]
    v_exp_f32 v57, v57
    v_mfma_f32_16x16x32_bf16 v[60:63], v[84:87], v[44:47], v[60:63]
    v_exp_f32 v58, v58
    v_mfma_f32_16x16x32_bf16 v[64:67], v[32:35], v[32:35], 0
    v_exp_f32 v59, v59
    v_cvt_pk_bf16_f32 v68, v56, v57
    v_mfma_f32_16x16x32_bf16 v[64:67], v[36:39], v[36:39], v[64:67]
    v_exp_f32 v60, v60
    v_cvt_pk_bf16_f32 v69, v58, v59
    v_mfma_f32_16x16x32_bf16 v[64:67], v[40:43], v[40:43], v[64:67]
    v_exp_f32 v61, v61
    v_mfma_f32_16x16x32_bf16 v[64:67], v[44:47], v[44:47], v[64:67]
    v_exp_f32 v62, v62
    v_exp_f32 v63, v63
    v_cvt_pk_bf16_f32 v70, v60, v61
    v_cvt_pk_bf16_f32 v71, v62, v63
    s_nop 1
    v_mfma_f32_16x16x32_bf16 v[72:75], v[88:91], v[68:71], 0
    s_nop 0
    v_exp_f32 v64, v64
    v_mfma_f32_16x16x32_bf16 v[76:79], v[92:95], v[68:71], 0
    v_exp_f32 v65, v65
    v_mfma_f32_16x16x32_bf16 v[80:83], v[48:51], v[68:71], 0
    v_cvt_pk_bf16_f32 v52, v64, v65
    s_nop 1
    v_mfma_f32_16x16x16_bf16 v[72:75], v[112:113], v[52:53], v[72:75]
    ds_read_b128 v[32:35], v124 offset:6144
    v_mfma_f32_16x16x16_bf16 v[76:79], v[114:115], v[52:53], v[76:79]
    ds_read_b128 v[36:39], v124 offset:7168
    v_mfma_f32_16x16x16_bf16 v[80:83], v[48:49], v[52:53], v[80:83]
L_norm_75:
    s_mov_b64 vcc, s[36:37]
    v_mov_b32 v122, v122
    v_mov_b32 v122, v122
    v_mov_b32 v122, v122
    v_cndmask_b32_dpp v76, v72, v76, vcc quad_perm:[2,3,2,3] row_mask:0xf bank_mask:0xf
    v_cndmask_b32_dpp v77, v73, v77, vcc quad_perm:[2,3,2,3] row_mask:0xf bank_mask:0xf
    v_cndmask_b32_dpp v78, v74, v78, vcc quad_perm:[2,3,2,3] row_mask:0xf bank_mask:0xf
    v_cndmask_b32_dpp v79, v75, v79, vcc quad_perm:[2,3,2,3] row_mask:0xf bank_mask:0xf
    v_rcp_f32_dpp v84, v80 quad_perm:[2,3,2,3] row_mask:0xf bank_mask:0xf
    s_nop 0
    v_pk_mul_f32 v[76:77], v[76:77], v[84:85] op_sel_hi:[1,0]
    v_pk_mul_f32 v[78:79], v[78:79], v[84:85] op_sel_hi:[1,0]
    v_cvt_pk_bf16_f32 v72, v76, v77
    v_cvt_pk_bf16_f32 v73, v78, v79
    ds_write_b64 v122, v[72:73] offset:21504
    v_max_f32_dpp v86, v80, v84 quad_perm:[2,3,2,3] row_mask:0xf bank_mask:0xf
    v_mov_b32_dpp v60, v72 quad_perm:[0,1,0,1] row_mask:0xf bank_mask:0xf
    v_mov_b32_dpp v61, v73 quad_perm:[0,1,0,1] row_mask:0xf bank_mask:0xf
    v_cmp_lt_f32 vcc, s35, v86
    v_mov_b32_dpp v62, v72 quad_perm:[2,3,2,3] row_mask:0xf bank_mask:0xf
    v_mov_b32_dpp v63, v73 quad_perm:[2,3,2,3] row_mask:0xf bank_mask:0xf
    s_nop 1
    v_smfmac_f32_16x16x64_bf16 v[96:99], v[60:63], v[192:199], v116
    s_cbranch_vccnz L_smax_76
    v_smfmac_f32_16x16x64_bf16 v[100:103], v[60:63], v[224:231], v116
    s_waitcnt lgkmcnt(0)
    s_barrier
    ds_read_b128 v[92:95], v127 offset:22016
    ds_read_b128 v[80:83], v127 offset:20480
    ds_read_b128 v[84:87], v127 offset:20992
    v_smfmac_f32_16x16x64_bf16 v[104:107], v[60:63], v[0:7], v116
    ds_read_b128 v[40:43], v124 offset:34816
    v_smfmac_f32_16x16x64_bf16 v[108:111], v[60:63], v[8:15], v116
    ds_read_b128 v[56:59], v124 offset:36864
    s_waitcnt lgkmcnt(4)
    v_smfmac_f32_16x16x64_bf16 v[96:99], v[92:95], v[200:207], v116
    s_waitcnt lgkmcnt(3)
    v_smfmac_f32_16x16x64_bf16 v[96:99], v[80:83], v[208:215], v116
    ds_read_b128 v[44:47], v124 offset:35840
    s_waitcnt lgkmcnt(3)
    v_smfmac_f32_16x16x64_bf16 v[96:99], v[84:87], v[216:223], v116
    ds_read_b128 v[68:71], v124 offset:39936
    v_smfmac_f32_16x16x64_bf16 v[100:103], v[92:95], v[232:239], v116
    ds_read_b128 v[64:67], v124 offset:38912
    v_smfmac_f32_16x16x64_bf16 v[100:103], v[80:83], v[240:247], v116
    ds_read_b128 v[60:63], v124 offset:37888
    v_cvt_pk_bf16_f32 v72, v96, v98
    v_smfmac_f32_16x16x64_bf16 v[100:103], v[84:87], v[248:255], v116
    v_and_or_b32 v72, v72, -2, s33
    v_smfmac_f32_16x16x64_bf16 v[104:107], v[92:95], v[16:23], v116
    v_cvt_pk_bf16_f32 v74, v97, v99
    v_smfmac_f32_16x16x64_bf16 v[104:107], v[80:83], v[24:31], v116
    v_cvt_pk_bf16_f32 v73, v100, v102
    v_cvt_pk_bf16_f32 v75, v101, v103
    v_smfmac_f32_16x16x64_bf16 v[104:107], v[84:87], v[32:39], v116
    buffer_store_dwordx4 v[72:75], v118, s[8:11], s25 offen sc1
    s_waitcnt lgkmcnt(3)
    v_smfmac_f32_16x16x64_bf16 v[108:111], v[92:95], v[40:47], v116
    s_waitcnt lgkmcnt(0)
    v_smfmac_f32_16x16x64_bf16 v[108:111], v[80:83], v[56:63], v116
    v_cvt_pk_bf16_f32 v76, v104, v106
    v_smfmac_f32_16x16x64_bf16 v[108:111], v[84:87], v[64:71], v116
    v_and_or_b32 v76, v76, -2, s33
    v_cvt_pk_bf16_f32 v78, v105, v107
    v_mov_b32 v122, v122
    v_mov_b32 v122, v122
    v_mov_b32 v122, v122
    v_mov_b32 v122, v122
    v_mov_b32 v122, v122
    v_mov_b32 v122, v122
    v_cvt_pk_bf16_f32 v77, v108, v110
    v_cvt_pk_bf16_f32 v79, v109, v111
    buffer_store_dwordx4 v[76:79], v118, s[8:11], s26 offen sc1
    ds_read_b128 v[80:83], v123
    ds_read_b128 v[84:87], v123 offset:1024
    ds_read_b128 v[56:59], v123 offset:2048
    ds_read_b128 v[60:63], v123 offset:3072
    ds_read_b128 v[64:67], v123 offset:32768
    ds_read_b128 v[68:71], v123 offset:33792
    ds_read_b128 v[72:75], v123 offset:34816
    ds_read_b128 v[76:79], v123 offset:35840
    ds_read_b128 v[88:91], v123 offset:4096
    ds_read_b128 v[92:95], v123 offset:5120
    ds_read_b128 v[96:99], v123 offset:6144
    ds_read_b128 v[100:103], v123 offset:7168
    ds_read_b128 v[104:107], v123 offset:36864
    ds_read_b128 v[108:111], v123 offset:37888
    ds_read_b128 v[24:27], v123 offset:38912
    ds_read_b128 v[28:31], v123 offset:39936
    s_add_u32 s30, s30, 0x40000
    s_add_u32 s31, s31, 0x40000
    s_add_u32 s32, s32, 0x20000
    s_add_u32 s23, s24, 2048
    s_add_u32 s48, s23, 4096
    s_xor_b32 s25, s25, 0x0
    s_xor_b32 s26, s26, 0x0
    s_mov_b32 s35, 0x49800000
    s_add_u32 s22, s22, 1
    v_cndmask_b32 v12, 0, v125, s[68:69]
    v_cndmask_b32 v13, 0, v125, s[70:71]
    v_cndmask_b32 v14, 0, v125, s[72:73]
    v_cndmask_b32 v15, 0, v125, s[74:75]
    v_mov_b32 v54, 0
    v_mov_b32 v55, 0
    v_mov_b32 v52, 0
    v_mov_b32 v52, 0
    v_mov_b32 v52, 0
    v_mov_b32 v52, 0
    v_mov_b32 v52, 0
    v_mov_b32 v52, 0
    v_mov_b32 v52, 0
    v_mov_b32 v52, 0
    v_mov_b32 v52, 0
    v_mov_b32 v52, 0
    v_mov_b32 v52, 0
    v_mov_b32 v52, 0
    v_mov_b32 v52, 0
    v_mov_b32 v52, 0
    v_mov_b32 v52, 0
    v_mov_b32 v52, 0
    v_mov_b32 v52, 0
    v_mov_b32 v52, 0
    v_mov_b32 v52, 0
    buffer_load_dwordx4 v[4:7], v117, s[8:11], s29 offen sc1
    buffer_load_dwordx4 v[8:11], v117, s[8:11], s53 offen sc1
    buffer_load_dwordx4 v[16:19], v117, s[8:11], s29 offen offset:2048 sc1
    buffer_load_dwordx4 v[20:23], v117, s[8:11], s53 offen offset:2048 sc1
    v_mov_b32 v52, 0
    v_mov_b32 v52, 0
    v_mov_b32 v52, 0
    v_mov_b32 v52, 0
    v_mov_b32 v52, 0
    v_mov_b32 v52, 0
    v_mov_b32 v52, 0
    v_mov_b32 v52, 0
    v_mov_b32 v52, 0
    v_mov_b32 v52, 0
    v_mov_b32 v52, 0
    v_mov_b32 v52, 0
    v_mov_b32 v52, 0
    v_mov_b32 v52, 0
    v_mov_b32 v52, 0
    v_mov_b32 v52, 0
    v_mov_b32 v52, 0
    v_mov_b32 v52, 0
    v_mov_b32 v52, 0
    v_mov_b32 v52, 0
    v_mov_b32 v52, 0
    v_mov_b32 v52, 0
    v_mov_b32 v52, 0
    v_mov_b32 v52, 0
    v_mov_b32 v52, 0
    v_mov_b32 v52, 0
    v_mov_b32 v52, 0
    v_mov_b32 v52, 0
    v_mov_b32 v52, 0
    v_mov_b32 v52, 0
    v_mov_b32 v52, 0
    v_mov_b32 v52, 0
    v_mov_b32 v52, 0
    v_mov_b32 v52, 0
    v_mov_b32 v52, 0
    v_mov_b32 v52, 0
    v_mov_b32 v52, 0
    v_mov_b32 v52, 0
    v_mov_b32 v52, 0
    v_mov_b32 v52, 0
    buffer_load_dwordx4 v[32:35], v117, s[8:11], s29 offen sc1
    buffer_load_dwordx4 v[36:39], v117, s[8:11], s53 offen sc1
    buffer_load_dwordx4 v[40:43], v117, s[8:11], s29 offen offset:2048 sc1
    buffer_load_dwordx4 v[44:47], v117, s[8:11], s53 offen offset:2048 sc1
    v_mov_b32 v52, 0
L_rl_77:
    s_waitcnt vmcnt(7)
    v_mfma_f32_16x16x32_bf16 v[48:51], v[4:7], v[12:15], 0
    v_xor_b32 v52, s33, v4
    s_waitcnt vmcnt(6)
    v_mfma_f32_16x16x32_bf16 v[48:51], v[8:11], v[12:15], v[48:51]
    v_xor_b32 v53, s33, v8
    v_or_b32 v52, v52, v53
    s_waitcnt vmcnt(5)
    v_mfma_f32_16x16x32_bf16 v[48:51], v[16:19], v[12:15], v[48:51]
    v_xor_b32 v53, s33, v16
    v_or_b32 v52, v52, v53
    s_waitcnt vmcnt(4)
    v_mfma_f32_16x16x32_bf16 v[48:51], v[20:23], v[12:15], v[48:51]
    v_xor_b32 v53, s33, v20
    v_or_b32 v52, v52, v53
    v_and_b32 v52, 1, v52
    v_cmp_ne_u32 vcc, 0, v52
    s_cbranch_vccnz L_rslow_78
L_rgo_79:
    s_nop 2
    v_permlane32_swap_b32 v48, v50
    v_permlane32_swap_b32 v49, v51
    v_pk_add_f32 v[48:49], v[48:49], v[50:51]
    s_mov_b64 exec, s[38:39]
    v_cvt_pk_bf16_f32 v12, v48, v49
    v_min_u32 v12, 0xfffffffe, v12
    buffer_store_dword v12, v119, s[8:11], s24 offen sc1
    s_mov_b64 exec, -1
    s_add_u32 s24, s24, 8192
    s_bitset0_b32 s24, 15
    s_xor_b32 s55, s24, 16384
    s_xor_b32 s29, s29, 0x0
    s_xor_b32 s53, s29, 1024
    s_bfe_u32 s33, s22, 0x10000
    s_waitcnt lgkmcnt(0)
    s_branch L_chain_top2_s
.p2align 6
L_chain_top3_s:
    buffer_load_dwordx4 v[0:3], v117, s[8:11], s23 offen sc1
    v_mov_b32 v48, 0
    v_mov_b32 v49, 0
    v_mov_b32 v50, 0
    v_mov_b32 v51, 0
    v_mov_b32 v52, 0
    v_mov_b32 v53, 0
    v_mov_b32 v15, 0
    v_mov_b32 v15, 0
    v_mov_b32 v15, 0
    v_mov_b32 v15, 0
    v_mov_b32 v15, 0
    v_mov_b32 v15, 0
    v_mov_b32 v15, 0
    v_mov_b32 v15, 0
    v_mov_b32 v15, 0
    v_mov_b32 v15, 0
    buffer_load_dwordx4 v[0:3], v117, s[8:11], s23 offen sc1
    s_waitcnt vmcnt(3)
    v_mov_b32 v36, 0
    v_mov_b32 v37, 0
    v_mov_b32 v38, 0
    v_mov_b32 v39, 0
    v_mov_b32 v40, 0
    v_mov_b32 v41, 0
    v_mov_b32 v42, 0
    v_mov_b32 v43, 0
    v_mov_b32 v44, 0
    v_mov_b32 v45, 0
    v_mov_b32 v46, 0
    v_mov_b32 v47, 0
    v_mov_b32 v15, 0
    v_mov_b32 v15, 0
    v_mov_b32 v15, 0
    v_mov_b32 v15, 0
L_mret_80:
    buffer_load_dwordx4 v[0:3], v117, s[8:11], s23 offen sc1
    s_add_u32 s45, s45, 1
    s_cmp_lt_u32 s45, 0x10000
    s_cselect_b32 s56, -2, -1
    s_nop 3
    v_mov_b32 v32, 0
    v_mov_b32 v33, 0
    v_mov_b32 v34, 0
    v_mov_b32 v35, 0
    s_waitcnt vmcnt(2)
    v_max3_u32 v15, v0, v1, v2
    v_max_u32 v15, v15, v3
    v_cmp_lt_u32 vcc, s56, v15
    v_smfmac_f32_16x16x64_bf16 v[32:35], v[0:3], v[80:87], v116
    s_cbranch_vccnz L_mret_80
    ds_write_b128 v117, v[0:3] offset:3072
    v_smfmac_f32_16x16x64_bf16 v[36:39], v[0:3], v[56:63], v116
    buffer_load_dwordx4 v[4:7], v117, s[8:11], s48 offen sc1
    v_smfmac_f32_16x16x64_bf16 v[40:43], v[0:3], v[64:71], v116
    buffer_load_dwordx4 v117, s[8:11], s48 offen sc1 lds
    s_mov_b32 m0, 14336
    v_smfmac_f32_16x16x64_bf16 v[44:47], v[0:3], v[72:79], v116
    s_waitcnt lgkmcnt(0)
    s_barrier
    ds_read_b128 v[8:11], v117 offset:2048
    v_smfmac_f32_16x16x64_bf16 v[48:51], v[0:3], a[192:199], v116
    ds_read_b128 v[16:19], v117 offset:1024
    ds_read_b128 v[20:23], v117
    v_smfmac_f32_16x16x64_bf16 v[52:55], v[0:3], a[200:207], v116
    ds_read_b128 v[80:83], v117 offset:14336
    s_waitcnt lgkmcnt(3)
    v_smfmac_f32_16x16x64_bf16 v[32:35], v[8:11], a[0:7], v116
    ds_read_b128 v[84:87], v117 offset:15360
    v_smfmac_f32_16x16x64_bf16 v[36:39], v[8:11], a[8:15], v116
    ds_read_b128 v[56:59], v117 offset:8192
    s_waitcnt lgkmcnt(4)
    v_smfmac_f32_16x16x64_bf16 v[32:35], v[16:19], a[32:39], v116
    ds_read_b128 v[60:63], v117 offset:9216
    v_smfmac_f32_16x16x64_bf16 v[36:39], v[16:19], a[40:47], v116
    ds_read_b128 v[64:67], v117 offset:10240
    s_waitcnt lgkmcnt(5)
    v_smfmac_f32_16x16x64_bf16 v[32:35], v[20:23], a[64:71], v116
    ds_read_b128 v[68:71], v117 offset:11264
    v_smfmac_f32_16x16x64_bf16 v[36:39], v[20:23], a[72:79], v116
    ds_read_b128 v[72:75], v117 offset:12288
    v_smfmac_f32_16x16x64_bf16 v[40:43], v[8:11], a[96:103], v116
    ds_read_b128 v[76:79], v117 offset:13312
    v_smfmac_f32_16x16x64_bf16 v[40:43], v[16:19], a[128:135], v116
    buffer_store_dwordx4 v[112:115], v117, s[8:11], s32 offen sc1
    v_smfmac_f32_16x16x64_bf16 v[40:43], v[20:23], a[160:167], v116
    s_waitcnt vmcnt(2)
    v_max3_u32 v15, v4, v5, v6
    v_smfmac_f32_16x16x64_bf16 v[44:47], v[8:11], a[104:111], v116
    v_max_u32 v15, v15, v7
    v_smfmac_f32_16x16x64_bf16 v[44:47], v[16:19], a[136:143], v116
    s_waitcnt vmcnt(1) lgkmcnt(0)
    v_cmp_lt_u32 vcc, s56, v15
    v_smfmac_f32_16x16x64_bf16 v[44:47], v[20:23], a[168:175], v116
    s_cbranch_vccnz L_mret_81
L_mgo_82:
    v_smfmac_f32_16x16x64_bf16 v[44:47], v[4:7], v[24:31], v116
    s_barrier
    ds_read_b128 v[12:15], v117 offset:6144
    v_smfmac_f32_16x16x64_bf16 v[32:35], v[4:7], v[88:95], v116
    ds_read_b128 v[24:27], v117 offset:5120
    v_smfmac_f32_16x16x64_bf16 v[36:39], v[4:7], v[96:103], v116
    ds_read_b128 v[28:31], v117 offset:4096
    v_smfmac_f32_16x16x64_bf16 v[40:43], v[4:7], v[104:111], v116
    ds_read_b128 v[88:91], v117 offset:30720
    s_waitcnt lgkmcnt(3)
    v_smfmac_f32_16x16x64_bf16 v[32:35], v[12:15], a[16:23], v116
    ds_read_b128 v[92:95], v117 offset:31744
    s_waitcnt lgkmcnt(3)
    v_smfmac_f32_16x16x64_bf16 v[32:35], v[24:27], a[48:55], v116
    ds_read_b128 v[96:99], v117 offset:23552
    s_waitcnt lgkmcnt(3)
    v_smfmac_f32_16x16x64_bf16 v[32:35], v[28:31], a[80:87], v116
    buffer_load_dwordx4 v117, s[8:11], s30 offen lds
    v_smfmac_f32_16x16x64_bf16 v[36:39], v[12:15], a[24:31], v116
    ds_read_b128 v[100:103], v117 offset:23552
    v_smfmac_f32_16x16x64_bf16 v[36:39], v[24:27], a[56:63], v116
    ds_read_b128 v[104:107], v117 offset:23552
    v_add_f32 v32, v32, v34
    v_smfmac_f32_16x16x64_bf16 v[36:39], v[28:31], a[88:95], v116
    buffer_load_dwordx4 v117, s[8:11], s30 offen offset:1024 lds
    s_add_u32 m0, s52, 0x6000
    v_add_f32 v33, v33, v35
    v_smfmac_f32_16x16x64_bf16 v[40:43], v[12:15], a[112:119], v116
    ds_read_b128 v[108:111], v117 offset:23552
    v_mul_f32 v32, s34, v32
    v_smfmac_f32_16x16x64_bf16 v[40:43], v[24:27], a[144:151], v116
    ds_read_b128 v[0:3], v124
    v_mul_f32 v33, s34, v33
    v_smfmac_f32_16x16x64_bf16 v[40:43], v[28:31], a[176:183], v116
    s_waitcnt lgkmcnt(5)
    buffer_load_dwordx4 v117, s[8:11], s31 offen lds
    v_add_f32 v36, v36, v38
    v_smfmac_f32_16x16x64_bf16 v[48:51], v[4:7], a[208:215], v116
    v_add_f32 v37, v37, v39
    v_smfmac_f32_16x16x64_bf16 v[52:55], v[4:7], a[216:223], v116
    ds_read_b128 v[4:7], v124 offset:1024
    v_mul_f32 v36, s34, v36
    v_smfmac_f32_16x16x64_bf16 v[44:47], v[12:15], a[120:127], v116
    buffer_load_dwordx4 v117, s[8:11], s31 offen offset:1024 lds
    s_mov_b32 m0, 7168
    v_mul_f32 v37, s34, v37
    v_smfmac_f32_16x16x64_bf16 v[44:47], v[24:27], a[152:159], v116
    v_cvt_pk_bf16_f32 v34, v32, v36
    v_smfmac_f32_16x16x64_bf16 v[44:47], v[28:31], a[184:191], v116
    v_cvt_pk_bf16_f32 v35, v33, v37
    v_add_f32 v40, v40, v42
    v_smfmac_f32_16x16x64_bf16 v[48:51], v[8:11], a[224:231], v116
    ds_write2_b32 v120, v34, v35 offset0:32 offset1:48
    v_add_f32 v41, v41, v43
    v_smfmac_f32_16x16x64_bf16 v[52:55], v[8:11], a[232:239], v116
    v_add_f32 v44, v44, v46
    v_add_f32 v45, v45, v47
    v_cvt_pk_bf16_f32 v113, v40, v44
    v_cvt_pk_bf16_f32 v115, v41, v45
    v_smfmac_f32_16x16x64_bf16 v[48:51], v[12:15], a[240:247], v116
    ds_write2_b32 v120, v113, v115 offset0:0 offset1:16
    v_smfmac_f32_16x16x64_bf16 v[52:55], v[12:15], a[248:255], v116
    s_cmp_eq_u32 s22, 63
    s_cbranch_scc1 L_chain_last_s
    v_smfmac_f32_16x16x64_bf16 v[48:51], v[16:19], v[128:135], v116
    v_smfmac_f32_16x16x64_bf16 v[48:51], v[20:23], v[160:167], v116
    buffer_store_dword v126, v119, s[8:11], s55 offen sc1
    v_smfmac_f32_16x16x64_bf16 v[48:51], v[24:27], v[144:151], v116
    s_waitcnt lgkmcnt(0)
    s_barrier
    v_smfmac_f32_16x16x64_bf16 v[48:51], v[28:31], v[176:183], v116
    ds_read_b128 v[32:35], v121 offset:16384
    ds_read_b128 v[36:39], v121 offset:17408
    v_smfmac_f32_16x16x64_bf16 v[52:55], v[16:19], v[136:143], v116
    ds_read_b128 v[40:43], v121 offset:18432
    ds_read_b128 v[44:47], v121 offset:19456
    v_smfmac_f32_16x16x64_bf16 v[52:55], v[20:23], v[168:175], v116
    ds_read_b128 v[8:11], v124 offset:32768
    v_add_f32 v48, v48, v50
    v_smfmac_f32_16x16x64_bf16 v[52:55], v[24:27], v[152:159], v116
    ds_read_b128 v[12:15], v124 offset:33792
    v_add_f32 v49, v49, v51
    v_smfmac_f32_16x16x64_bf16 v[52:55], v[28:31], v[184:191], v116
    s_waitcnt lgkmcnt(5)
    v_cvt_pk_bf16_f32 v112, v48, v49
    v_mfma_f32_16x16x32_bf16 v[56:59], v[56:59], v[32:35], 0
    s_waitcnt lgkmcnt(4)
    v_mov_b32 v48, s50
    v_mov_b32 v49, s50
    v_mfma_f32_16x16x32_bf16 v[56:59], v[60:63], v[36:39], v[56:59]
    ds_read_b128 v[16:19], v124 offset:2048
    s_waitcnt lgkmcnt(4)
    v_mov_b32 v50, s50
    v_mov_b32 v51, s50
    v_mfma_f32_16x16x32_bf16 v[56:59], v[64:67], v[40:43], v[56:59]
    ds_read_b128 v[20:23], v124 offset:3072
    s_waitcnt lgkmcnt(4)
    v_add_f32 v52, v52, v54
    v_mfma_f32_16x16x32_bf16 v[56:59], v[68:71], v[44:47], v[56:59]
    ds_read_b128 v[24:27], v124 offset:4096
    v_add_f32 v53, v53, v55
    v_mfma_f32_16x16x32_bf16 v[60:63], v[72:75], v[32:35], 0
    ds_read_b128 v[28:31], v124 offset:5120
    v_cvt_pk_bf16_f32 v114, v52, v53
    v_mov_b32 v53, 0
    v_mfma_f32_16x16x32_bf16 v[60:63], v[76:79], v[36:39], v[60:63]
    v_exp_f32 v56, v56
    v_mfma_f32_16x16x32_bf16 v[60:63], v[80:83], v[40:43], v[60:63]
    v_exp_f32 v57, v57
    v_mfma_f32_16x16x32_bf16 v[60:63], v[84:87], v[44:47], v[60:63]
    v_exp_f32 v58, v58
    v_mfma_f32_16x16x32_bf16 v[64:67], v[32:35], v[32:35], 0
    v_exp_f32 v59, v59
    v_cvt_pk_bf16_f32 v68, v56, v57
    v_mfma_f32_16x16x32_bf16 v[64:67], v[36:39], v[36:39], v[64:67]
    v_exp_f32 v60, v60
    v_cvt_pk_bf16_f32 v69, v58, v59
    v_mfma_f32_16x16x32_bf16 v[64:67], v[40:43], v[40:43], v[64:67]
    v_exp_f32 v61, v61
    v_mfma_f32_16x16x32_bf16 v[64:67], v[44:47], v[44:47], v[64:67]
    v_exp_f32 v62, v62
    v_exp_f32 v63, v63
    v_cvt_pk_bf16_f32 v70, v60, v61
    v_cvt_pk_bf16_f32 v71, v62, v63
    s_nop 1
    v_mfma_f32_16x16x32_bf16 v[72:75], v[88:91], v[68:71], 0
    s_nop 0
    v_exp_f32 v64, v64
    v_mfma_f32_16x16x32_bf16 v[76:79], v[92:95], v[68:71], 0
    v_exp_f32 v65, v65
    v_mfma_f32_16x16x32_bf16 v[80:83], v[48:51], v[68:71], 0
    v_cvt_pk_bf16_f32 v52, v64, v65
    s_nop 1
    v_mfma_f32_16x16x16_bf16 v[72:75], v[112:113], v[52:53], v[72:75]
    ds_read_b128 v[32:35], v124 offset:6144
    v_mfma_f32_16x16x16_bf16 v[76:79], v[114:115], v[52:53], v[76:79]
    ds_read_b128 v[36:39], v124 offset:7168
    v_mfma_f32_16x16x16_bf16 v[80:83], v[48:49], v[52:53], v[80:83]
L_norm_83:
    s_mov_b64 vcc, s[36:37]
    v_mov_b32 v122, v122
    v_mov_b32 v122, v122
    v_mov_b32 v122, v122
    v_cndmask_b32_dpp v76, v72, v76, vcc quad_perm:[2,3,2,3] row_mask:0xf bank_mask:0xf
    v_cndmask_b32_dpp v77, v73, v77, vcc quad_perm:[2,3,2,3] row_mask:0xf bank_mask:0xf
    v_cndmask_b32_dpp v78, v74, v78, vcc quad_perm:[2,3,2,3] row_mask:0xf bank_mask:0xf
    v_cndmask_b32_dpp v79, v75, v79, vcc quad_perm:[2,3,2,3] row_mask:0xf bank_mask:0xf
    v_rcp_f32_dpp v84, v80 quad_perm:[2,3,2,3] row_mask:0xf bank_mask:0xf
    s_nop 0
    v_pk_mul_f32 v[76:77], v[76:77], v[84:85] op_sel_hi:[1,0]
    v_pk_mul_f32 v[78:79], v[78:79], v[84:85] op_sel_hi:[1,0]
    v_cvt_pk_bf16_f32 v72, v76, v77
    v_cvt_pk_bf16_f32 v73, v78, v79
    ds_write_b64 v122, v[72:73] offset:22016
    v_max_f32_dpp v86, v80, v84 quad_perm:[2,3,2,3] row_mask:0xf bank_mask:0xf
    v_mov_b32_dpp v60, v72 quad_perm:[0,1,0,1] row_mask:0xf bank_mask:0xf
    v_mov_b32_dpp v61, v73 quad_perm:[0,1,0,1] row_mask:0xf bank_mask:0xf
    v_cmp_lt_f32 vcc, s35, v86
    v_mov_b32_dpp v62, v72 quad_perm:[2,3,2,3] row_mask:0xf bank_mask:0xf
    v_mov_b32_dpp v63, v73 quad_perm:[2,3,2,3] row_mask:0xf bank_mask:0xf
    s_nop 1
    v_smfmac_f32_16x16x64_bf16 v[96:99], v[60:63], v[192:199], v116
    s_cbranch_vccnz L_smax_84
    v_smfmac_f32_16x16x64_bf16 v[100:103], v[60:63], v[224:231], v116
    s_waitcnt lgkmcnt(0)
    s_barrier
    ds_read_b128 v[92:95], v127 offset:21504
    ds_read_b128 v[80:83], v127 offset:20992
    ds_read_b128 v[84:87], v127 offset:20480
    v_smfmac_f32_16x16x64_bf16 v[104:107], v[60:63], v[0:7], v116
    ds_read_b128 v[40:43], v124 offset:34816
    v_smfmac_f32_16x16x64_bf16 v[108:111], v[60:63], v[8:15], v116
    ds_read_b128 v[56:59], v124 offset:36864
    s_waitcnt lgkmcnt(4)
    v_smfmac_f32_16x16x64_bf16 v[96:99], v[92:95], v[200:207], v116
    s_waitcnt lgkmcnt(3)
    v_smfmac_f32_16x16x64_bf16 v[96:99], v[80:83], v[208:215], v116
    ds_read_b128 v[44:47], v124 offset:35840
    s_waitcnt lgkmcnt(3)
    v_smfmac_f32_16x16x64_bf16 v[96:99], v[84:87], v[216:223], v116
    ds_read_b128 v[68:71], v124 offset:39936
    v_smfmac_f32_16x16x64_bf16 v[100:103], v[92:95], v[232:239], v116
    ds_read_b128 v[64:67], v124 offset:38912
    v_smfmac_f32_16x16x64_bf16 v[100:103], v[80:83], v[240:247], v116
    ds_read_b128 v[60:63], v124 offset:37888
    v_cvt_pk_bf16_f32 v72, v96, v98
    v_smfmac_f32_16x16x64_bf16 v[100:103], v[84:87], v[248:255], v116
    v_and_or_b32 v72, v72, -2, s33
    v_smfmac_f32_16x16x64_bf16 v[104:107], v[92:95], v[16:23], v116
    v_cvt_pk_bf16_f32 v74, v97, v99
    v_smfmac_f32_16x16x64_bf16 v[104:107], v[80:83], v[24:31], v116
    v_cvt_pk_bf16_f32 v73, v100, v102
    v_cvt_pk_bf16_f32 v75, v101, v103
    v_smfmac_f32_16x16x64_bf16 v[104:107], v[84:87], v[32:39], v116
    buffer_store_dwordx4 v[72:75], v118, s[8:11], s25 offen sc1
    s_waitcnt lgkmcnt(3)
    v_smfmac_f32_16x16x64_bf16 v[108:111], v[92:95], v[40:47], v116
    s_waitcnt lgkmcnt(0)
    v_smfmac_f32_16x16x64_bf16 v[108:111], v[80:83], v[56:63], v116
    v_cvt_pk_bf16_f32 v76, v104, v106
    v_smfmac_f32_16x16x64_bf16 v[108:111], v[84:87], v[64:71], v116
    v_and_or_b32 v76, v76, -2, s33
    v_cvt_pk_bf16_f32 v78, v105, v107
    v_mov_b32 v122, v122
    v_mov_b32 v122, v122
    v_mov_b32 v122, v122
    v_mov_b32 v122, v122
    v_mov_b32 v122, v122
    v_mov_b32 v122, v122
    v_cvt_pk_bf16_f32 v77, v108, v110
    v_cvt_pk_bf16_f32 v79, v109, v111
    buffer_store_dwordx4 v[76:79], v118, s[8:11], s26 offen sc1
    ds_read_b128 v[80:83], v123
    ds_read_b128 v[84:87], v123 offset:1024
    ds_read_b128 v[56:59], v123 offset:2048
    ds_read_b128 v[60:63], v123 offset:3072
    ds_read_b128 v[64:67], v123 offset:32768
    ds_read_b128 v[68:71], v123 offset:33792
    ds_read_b128 v[72:75], v123 offset:34816
    ds_read_b128 v[76:79], v123 offset:35840
    ds_read_b128 v[88:91], v123 offset:4096
    ds_read_b128 v[92:95], v123 offset:5120
    ds_read_b128 v[96:99], v123 offset:6144
    ds_read_b128 v[100:103], v123 offset:7168
    ds_read_b128 v[104:107], v123 offset:36864
    ds_read_b128 v[108:111], v123 offset:37888
    ds_read_b128 v[24:27], v123 offset:38912
    ds_read_b128 v[28:31], v123 offset:39936
    s_add_u32 s30, s30, 0x40000
    s_add_u32 s31, s31, 0x40000
    s_add_u32 s32, s32, 0x20000
    s_add_u32 s23, s24, 3072
    s_add_u32 s48, s23, 4096
    s_xor_b32 s25, s25, 0x0
    s_xor_b32 s26, s26, 0x0
    s_mov_b32 s35, 0x49800000
    s_add_u32 s22, s22, 1
    v_cndmask_b32 v12, 0, v125, s[68:69]
    v_cndmask_b32 v13, 0, v125, s[70:71]
    v_cndmask_b32 v14, 0, v125, s[72:73]
    v_cndmask_b32 v15, 0, v125, s[74:75]
    v_mov_b32 v54, 0
    v_mov_b32 v55, 0
    v_mov_b32 v52, 0
    v_mov_b32 v52, 0
    v_mov_b32 v52, 0
    v_mov_b32 v52, 0
    v_mov_b32 v52, 0
    v_mov_b32 v52, 0
    v_mov_b32 v52, 0
    v_mov_b32 v52, 0
    v_mov_b32 v52, 0
    v_mov_b32 v52, 0
    v_mov_b32 v52, 0
    v_mov_b32 v52, 0
    v_mov_b32 v52, 0
    v_mov_b32 v52, 0
    v_mov_b32 v52, 0
    v_mov_b32 v52, 0
    v_mov_b32 v52, 0
    v_mov_b32 v52, 0
    v_mov_b32 v52, 0
    v_mov_b32 v52, 0
    v_mov_b32 v52, 0
    v_mov_b32 v52, 0
    v_mov_b32 v52, 0
    v_mov_b32 v52, 0
    v_mov_b32 v52, 0
    v_mov_b32 v52, 0
    v_mov_b32 v52, 0
    v_mov_b32 v52, 0
    v_mov_b32 v52, 0
    v_mov_b32 v52, 0
    v_mov_b32 v52, 0
    v_mov_b32 v52, 0
    v_mov_b32 v52, 0
    v_mov_b32 v52, 0
    v_mov_b32 v52, 0
    v_mov_b32 v52, 0
    v_mov_b32 v52, 0
    v_mov_b32 v52, 0
    v_mov_b32 v52, 0
    v_mov_b32 v52, 0
    v_mov_b32 v52, 0
    v_mov_b32 v52, 0
    v_mov_b32 v52, 0
    v_mov_b32 v52, 0
    v_mov_b32 v52, 0
    v_mov_b32 v52, 0
    v_mov_b32 v52, 0
    v_mov_b32 v52, 0
    v_mov_b32 v52, 0
    buffer_load_dwordx4 v[4:7], v117, s[8:11], s29 offen sc1
    buffer_load_dwordx4 v[8:11], v117, s[8:11], s53 offen sc1
    buffer_load_dwordx4 v[16:19], v117, s[8:11], s29 offen offset:2048 sc1
    buffer_load_dwordx4 v[20:23], v117, s[8:11], s53 offen offset:2048 sc1
    v_mov_b32 v52, 0
    v_mov_b32 v52, 0
    v_mov_b32 v52, 0
    v_mov_b32 v52, 0
    v_mov_b32 v52, 0
    v_mov_b32 v52, 0
    v_mov_b32 v52, 0
    v_mov_b32 v52, 0
    v_mov_b32 v52, 0
    v_mov_b32 v52, 0
    v_mov_b32 v52, 0
    v_mov_b32 v52, 0
    v_mov_b32 v52, 0
    v_mov_b32 v52, 0
    v_mov_b32 v52, 0
    v_mov_b32 v52, 0
    v_mov_b32 v52, 0
    v_mov_b32 v52, 0
    v_mov_b32 v52, 0
    v_mov_b32 v52, 0
    v_mov_b32 v52, 0
    v_mov_b32 v52, 0
    v_mov_b32 v52, 0
    v_mov_b32 v52, 0
    v_mov_b32 v52, 0
    v_mov_b32 v52, 0
    v_mov_b32 v52, 0
    v_mov_b32 v52, 0
    v_mov_b32 v52, 0
    v_mov_b32 v52, 0
    buffer_load_dwordx4 v[32:35], v117, s[8:11], s29 offen sc1
    buffer_load_dwordx4 v[36:39], v117, s[8:11], s53 offen sc1
    buffer_load_dwordx4 v[40:43], v117, s[8:11], s29 offen offset:2048 sc1
    buffer_load_dwordx4 v[44:47], v117, s[8:11], s53 offen offset:2048 sc1
    v_mov_b32 v52, 0
L_rl_85:
    s_waitcnt vmcnt(7)
    v_mfma_f32_16x16x32_bf16 v[48:51], v[4:7], v[12:15], 0
    v_xor_b32 v52, s33, v4
    s_waitcnt vmcnt(6)
    v_mfma_f32_16x16x32_bf16 v[48:51], v[8:11], v[12:15], v[48:51]
    v_xor_b32 v53, s33, v8
    v_or_b32 v52, v52, v53
    s_waitcnt vmcnt(5)
    v_mfma_f32_16x16x32_bf16 v[48:51], v[16:19], v[12:15], v[48:51]
    v_xor_b32 v53, s33, v16
    v_or_b32 v52, v52, v53
    s_waitcnt vmcnt(4)
    v_mfma_f32_16x16x32_bf16 v[48:51], v[20:23], v[12:15], v[48:51]
    v_xor_b32 v53, s33, v20
    v_or_b32 v52, v52, v53
    v_and_b32 v52, 1, v52
    v_cmp_ne_u32 vcc, 0, v52
    s_cbranch_vccnz L_rslow_86
L_rgo_87:
    s_nop 2
    v_permlane32_swap_b32 v48, v50
    v_permlane32_swap_b32 v49, v51
    v_pk_add_f32 v[48:49], v[48:49], v[50:51]
    s_mov_b64 exec, s[38:39]
    v_cvt_pk_bf16_f32 v12, v48, v49
    v_min_u32 v12, 0xfffffffe, v12
    buffer_store_dword v12, v119, s[8:11], s24 offen sc1
    s_mov_b64 exec, -1
    s_add_u32 s24, s24, 8192
    s_bitset0_b32 s24, 15
    s_xor_b32 s55, s24, 16384
    s_xor_b32 s29, s29, 0x0
    s_xor_b32 s53, s29, 1024
    s_bfe_u32 s33, s22, 0x10000
    s_waitcnt lgkmcnt(0)
    s_branch L_chain_top3_s
L_chain_last_s:
    s_nop 1
    v_smfmac_f32_16x16x64_bf16 v[48:51], v[16:19], v[128:135], v116
    v_smfmac_f32_16x16x64_bf16 v[48:51], v[20:23], v[160:167], v116
    v_smfmac_f32_16x16x64_bf16 v[48:51], v[24:27], v[144:151], v116
    v_smfmac_f32_16x16x64_bf16 v[48:51], v[28:31], v[176:183], v116
    v_smfmac_f32_16x16x64_bf16 v[52:55], v[16:19], v[136:143], v116
    v_smfmac_f32_16x16x64_bf16 v[52:55], v[20:23], v[168:175], v116
    v_smfmac_f32_16x16x64_bf16 v[52:55], v[24:27], v[152:159], v116
    v_smfmac_f32_16x16x64_bf16 v[52:55], v[28:31], v[184:191], v116
    v_add_f32 v48, v48, v50
    v_add_f32 v49, v49, v51
    v_cvt_pk_bf16_f32 v112, v48, v49
    s_nop 4
    v_add_f32 v52, v52, v54
    v_add_f32 v53, v53, v55
    v_cvt_pk_bf16_f32 v114, v52, v53
    s_add_u32 s32, s32, 0x20000
    buffer_store_dwordx4 v[112:115], v117, s[8:11], s32 offen sc1
    v_mov_b32 v94, 64
    s_waitcnt vmcnt(0) lgkmcnt(0)
    s_barrier
    s_mov_b64 exec, 1
    buffer_store_dword v94, off, s[8:11], s44 sc1
    s_mov_b64 exec, -1
    s_endpgm
L_mret_59:
    s_mov_b32 s43, m0
    s_mov_b32 m0, 4096
    buffer_load_dwordx4 v[4:7], v117, s[8:11], s48 offen sc1
    buffer_load_dwordx4 v117, s[8:11], s48 offen sc1 lds
    s_mov_b32 m0, 8192
    s_mov_b32 m0, s43
    s_waitcnt vmcnt(0)
    v_max3_u32 v15, v4, v5, v6
    v_max_u32 v15, v15, v7
    v_cmp_lt_u32 vcc, s56, v15
    s_add_u32 s47, s47, 1
    s_add_u32 s49, s49, 1
    s_cmp_ge_u32 s49, 0x10000
    s_cbranch_scc1 L_mgo_60
    s_cbranch_vccnz L_mret_59
    s_branch L_mgo_60
L_smax_62:
    s_add_u32 s47, s47, 1
    s_mov_b32 s35, 0x7f800000
    s_waitcnt lgkmcnt(0)
    s_sub_u32 s43, s30, 0x40000
    s_add_u32 s40, s43, 4096
    s_nop 7
    buffer_load_dwordx4 v[56:59], v117, s[8:11], s43 offen
    buffer_load_dwordx4 v[60:63], v117, s[8:11], s43 offen offset:1024
    buffer_load_dwordx4 v[64:67], v117, s[8:11], s43 offen offset:2048
    buffer_load_dwordx4 v[68:71], v117, s[8:11], s43 offen offset:3072
    buffer_load_dwordx4 v[72:75], v117, s[8:11], s40 offen
    buffer_load_dwordx4 v[76:79], v117, s[8:11], s40 offen offset:1024
    buffer_load_dwordx4 v[80:83], v117, s[8:11], s40 offen offset:2048
    buffer_load_dwordx4 v[84:87], v117, s[8:11], s40 offen offset:3072
    ds_read_b128 v[32:35], v121 offset:16384
    ds_read_b128 v[36:39], v121 offset:17408
    ds_read_b128 v[40:43], v121 offset:18432
    ds_read_b128 v[44:47], v121 offset:19456
    v_mov_b32 v96, 0
    v_mov_b32 v97, 0
    v_mov_b32 v98, 0
    v_mov_b32 v99, 0
    v_mov_b32 v100, 0
    v_mov_b32 v101, 0
    v_mov_b32 v102, 0
    v_mov_b32 v103, 0
    v_mov_b32 v104, 0
    v_mov_b32 v105, 0
    v_mov_b32 v106, 0
    v_mov_b32 v107, 0
    v_mov_b32 v108, 0
    v_mov_b32 v109, 0
    v_mov_b32 v110, 0
    v_mov_b32 v111, 0
    s_waitcnt vmcnt(0) lgkmcnt(0)
    v_mfma_f32_16x16x32_bf16 v[56:59], v[56:59], v[32:35], 0
    v_mfma_f32_16x16x32_bf16 v[56:59], v[60:63], v[36:39], v[56:59]
    v_mfma_f32_16x16x32_bf16 v[56:59], v[64:67], v[40:43], v[56:59]
    v_mfma_f32_16x16x32_bf16 v[56:59], v[68:71], v[44:47], v[56:59]
    v_mfma_f32_16x16x32_bf16 v[60:63], v[72:75], v[32:35], 0
    v_mfma_f32_16x16x32_bf16 v[60:63], v[76:79], v[36:39], v[60:63]
    v_mfma_f32_16x16x32_bf16 v[60:63], v[80:83], v[40:43], v[60:63]
    v_mfma_f32_16x16x32_bf16 v[60:63], v[84:87], v[44:47], v[60:63]
    v_mfma_f32_16x16x32_bf16 v[64:67], v[32:35], v[32:35], 0
    v_mfma_f32_16x16x32_bf16 v[64:67], v[36:39], v[36:39], v[64:67]
    v_mfma_f32_16x16x32_bf16 v[64:67], v[40:43], v[40:43], v[64:67]
    v_mfma_f32_16x16x32_bf16 v[64:67], v[44:47], v[44:47], v[64:67]
    v_max3_f32 v84, v56, v57, v58
    v_max3_f32 v84, v84, v59, v60
    v_max3_f32 v84, v84, v61, v62
    s_nop 4
    v_max3_f32 v84, v84, v63, v64
    v_max_f32 v84, v84, v65
    v_mov_b32 v85, v84
    s_nop 1
    v_permlane32_swap_b32 v85, v84
    v_max_f32 v84, v85, v84
    v_mov_b32 v85, v84
    s_nop 1
    v_permlane16_swap_b32 v85, v84
    v_max_f32 v84, v85, v84
    v_sub_f32 v56, v56, v84
    v_sub_f32 v57, v57, v84
    v_sub_f32 v58, v58, v84
    v_sub_f32 v59, v59, v84
    v_sub_f32 v60, v60, v84
    v_sub_f32 v61, v61, v84
    v_sub_f32 v62, v62, v84
    v_sub_f32 v63, v63, v84
    v_sub_f32 v64, v64, v84
    v_sub_f32 v65, v65, v84
    v_exp_f32 v56, v56
    v_exp_f32 v57, v57
    v_exp_f32 v58, v58
    v_exp_f32 v59, v59
    v_exp_f32 v60, v60
    v_exp_f32 v61, v61
    v_exp_f32 v62, v62
    v_exp_f32 v63, v63
    v_exp_f32 v64, v64
    v_exp_f32 v65, v65
    v_cvt_pk_bf16_f32 v68, v56, v57
    v_cvt_pk_bf16_f32 v69, v58, v59
    v_cvt_pk_bf16_f32 v70, v60, v61
    v_cvt_pk_bf16_f32 v71, v62, v63
    v_cvt_pk_bf16_f32 v52, v64, v65
    s_nop 0
    v_mfma_f32_16x16x32_bf16 v[72:75], v[88:91], v[68:71], 0
    v_mfma_f32_16x16x32_bf16 v[76:79], v[92:95], v[68:71], 0
    v_mfma_f32_16x16x32_bf16 v[80:83], v[48:51], v[68:71], 0
    v_mfma_f32_16x16x16_bf16 v[72:75], v[112:113], v[52:53], v[72:75]
    v_mfma_f32_16x16x16_bf16 v[76:79], v[114:115], v[52:53], v[76:79]
    v_mfma_f32_16x16x16_bf16 v[80:83], v[48:49], v[52:53], v[80:83]
    ds_read_b128 v[32:35], v124 offset:6144
    ds_read_b128 v[36:39], v124 offset:7168
    ds_read_b128 v[40:43], v124 offset:34816
    ds_read_b128 v[44:47], v124 offset:35840
    ds_read_b128 v[56:59], v124 offset:36864
    ds_read_b128 v[64:67], v124 offset:38912
    ds_read_b128 v[68:71], v124 offset:39936
    s_waitcnt lgkmcnt(0)
    s_branch L_norm_61
L_kvw_63:
    s_add_u32 s47, s47, 1
    s_add_u32 s49, s49, 1
    s_cmp_ge_u32 s49, 0x10000
    s_cbranch_scc1 L_kvb_64
    s_sleep 4
    buffer_load_dword v125, v119, s[8:11], s28 offen sc1
    s_waitcnt vmcnt(0)
    v_cmp_eq_u32 vcc, 0, v125
    s_nop 0
    s_and_b64 vcc, vcc, s[58:59]
    s_cbranch_scc1 L_kvw_63
    s_branch L_kvb_64
L_mret_66:
    s_mov_b32 s43, m0
    s_mov_b32 m0, 5120
    buffer_load_dwordx4 v[4:7], v117, s[8:11], s48 offen sc1
    buffer_load_dwordx4 v117, s[8:11], s48 offen sc1 lds
    s_mov_b32 m0, 10240
    s_mov_b32 m0, s43
    s_waitcnt vmcnt(0)
    v_max3_u32 v15, v4, v5, v6
    v_max_u32 v15, v15, v7
    v_cmp_lt_u32 vcc, s56, v15
    s_add_u32 s47, s47, 1
    s_add_u32 s49, s49, 1
    s_cmp_ge_u32 s49, 0x10000
    s_cbranch_scc1 L_mgo_67
    s_cbranch_vccnz L_mret_66
    s_branch L_mgo_67
L_smax_69:
    s_add_u32 s47, s47, 1
    s_mov_b32 s35, 0x7f800000
    s_waitcnt lgkmcnt(0)
    s_sub_u32 s43, s30, 0x40800
    s_add_u32 s40, s43, 4096
    s_nop 7
    buffer_load_dwordx4 v[56:59], v117, s[8:11], s43 offen
    buffer_load_dwordx4 v[60:63], v117, s[8:11], s43 offen offset:1024
    buffer_load_dwordx4 v[64:67], v117, s[8:11], s43 offen offset:2048
    buffer_load_dwordx4 v[68:71], v117, s[8:11], s43 offen offset:3072
    buffer_load_dwordx4 v[72:75], v117, s[8:11], s40 offen
    buffer_load_dwordx4 v[76:79], v117, s[8:11], s40 offen offset:1024
    buffer_load_dwordx4 v[80:83], v117, s[8:11], s40 offen offset:2048
    buffer_load_dwordx4 v[84:87], v117, s[8:11], s40 offen offset:3072
    ds_read_b128 v[32:35], v121 offset:16384
    ds_read_b128 v[36:39], v121 offset:17408
    ds_read_b128 v[40:43], v121 offset:18432
    ds_read_b128 v[44:47], v121 offset:19456
    v_mov_b32 v96, 0
    v_mov_b32 v97, 0
    v_mov_b32 v98, 0
    v_mov_b32 v99, 0
    v_mov_b32 v100, 0
    v_mov_b32 v101, 0
    v_mov_b32 v102, 0
    v_mov_b32 v103, 0
    v_mov_b32 v104, 0
    v_mov_b32 v105, 0
    v_mov_b32 v106, 0
    v_mov_b32 v107, 0
    v_mov_b32 v108, 0
    v_mov_b32 v109, 0
    v_mov_b32 v110, 0
    v_mov_b32 v111, 0
    s_waitcnt vmcnt(0) lgkmcnt(0)
    v_mfma_f32_16x16x32_bf16 v[56:59], v[56:59], v[32:35], 0
    v_mfma_f32_16x16x32_bf16 v[56:59], v[60:63], v[36:39], v[56:59]
    v_mfma_f32_16x16x32_bf16 v[56:59], v[64:67], v[40:43], v[56:59]
    v_mfma_f32_16x16x32_bf16 v[56:59], v[68:71], v[44:47], v[56:59]
    v_mfma_f32_16x16x32_bf16 v[60:63], v[72:75], v[32:35], 0
    v_mfma_f32_16x16x32_bf16 v[60:63], v[76:79], v[36:39], v[60:63]
    v_mfma_f32_16x16x32_bf16 v[60:63], v[80:83], v[40:43], v[60:63]
    v_mfma_f32_16x16x32_bf16 v[60:63], v[84:87], v[44:47], v[60:63]
    v_mfma_f32_16x16x32_bf16 v[64:67], v[32:35], v[32:35], 0
    v_mfma_f32_16x16x32_bf16 v[64:67], v[36:39], v[36:39], v[64:67]
    v_mfma_f32_16x16x32_bf16 v[64:67], v[40:43], v[40:43], v[64:67]
    v_mfma_f32_16x16x32_bf16 v[64:67], v[44:47], v[44:47], v[64:67]
    v_max3_f32 v84, v56, v57, v58
    v_max3_f32 v84, v84, v59, v60
    v_max3_f32 v84, v84, v61, v62
    s_nop 4
    v_max3_f32 v84, v84, v63, v64
    v_max_f32 v84, v84, v65
    v_mov_b32 v85, v84
    s_nop 1
    v_permlane32_swap_b32 v85, v84
    v_max_f32 v84, v85, v84
    v_mov_b32 v85, v84
    s_nop 1
    v_permlane16_swap_b32 v85, v84
    v_max_f32 v84, v85, v84
    v_sub_f32 v56, v56, v84
    v_sub_f32 v57, v57, v84
    v_sub_f32 v58, v58, v84
    v_sub_f32 v59, v59, v84
    v_sub_f32 v60, v60, v84
    v_sub_f32 v61, v61, v84
    v_sub_f32 v62, v62, v84
    v_sub_f32 v63, v63, v84
    v_sub_f32 v64, v64, v84
    v_sub_f32 v65, v65, v84
    v_exp_f32 v56, v56
    v_exp_f32 v57, v57
    v_exp_f32 v58, v58
    v_exp_f32 v59, v59
    v_exp_f32 v60, v60
    v_exp_f32 v61, v61
    v_exp_f32 v62, v62
    v_exp_f32 v63, v63
    v_exp_f32 v64, v64
    v_exp_f32 v65, v65
    v_cvt_pk_bf16_f32 v68, v56, v57
    v_cvt_pk_bf16_f32 v69, v58, v59
    v_cvt_pk_bf16_f32 v70, v60, v61
    v_cvt_pk_bf16_f32 v71, v62, v63
    v_cvt_pk_bf16_f32 v52, v64, v65
    s_nop 0
    v_mfma_f32_16x16x32_bf16 v[72:75], v[88:91], v[68:71], 0
    v_mfma_f32_16x16x32_bf16 v[76:79], v[92:95], v[68:71], 0
    v_mfma_f32_16x16x32_bf16 v[80:83], v[48:51], v[68:71], 0
    v_mfma_f32_16x16x16_bf16 v[72:75], v[112:113], v[52:53], v[72:75]
    v_mfma_f32_16x16x16_bf16 v[76:79], v[114:115], v[52:53], v[76:79]
    v_mfma_f32_16x16x16_bf16 v[80:83], v[48:49], v[52:53], v[80:83]
    ds_read_b128 v[32:35], v124 offset:6144
    ds_read_b128 v[36:39], v124 offset:7168
    ds_read_b128 v[40:43], v124 offset:34816
    ds_read_b128 v[44:47], v124 offset:35840
    ds_read_b128 v[56:59], v124 offset:36864
    ds_read_b128 v[64:67], v124 offset:38912
    ds_read_b128 v[68:71], v124 offset:39936
    s_waitcnt lgkmcnt(0)
    s_branch L_norm_68
L_kvw_70:
    s_add_u32 s47, s47, 1
    s_add_u32 s49, s49, 1
    s_cmp_ge_u32 s49, 0x10000
    s_cbranch_scc1 L_kvb_71
    s_sleep 4
    buffer_load_dword v125, v119, s[8:11], s28 offen sc1
    s_waitcnt vmcnt(0)
    v_cmp_eq_u32 vcc, 0, v125
    s_nop 0
    s_and_b64 vcc, vcc, s[58:59]
    s_cbranch_scc1 L_kvw_70
    s_branch L_kvb_71
L_mret_73:
    s_mov_b32 s43, m0
    s_mov_b32 m0, 6144
    buffer_load_dwordx4 v[4:7], v117, s[8:11], s48 offen sc1
    buffer_load_dwordx4 v117, s[8:11], s48 offen sc1 lds
    s_mov_b32 m0, 12288
    s_mov_b32 m0, s43
    s_waitcnt vmcnt(0)
    v_max3_u32 v15, v4, v5, v6
    v_max_u32 v15, v15, v7
    v_cmp_lt_u32 vcc, s56, v15
    s_add_u32 s47, s47, 1
    s_add_u32 s49, s49, 1
    s_cmp_ge_u32 s49, 0x10000
    s_cbranch_scc1 L_mgo_74
    s_cbranch_vccnz L_mret_73
    s_branch L_mgo_74
L_smax_76:
    s_add_u32 s47, s47, 1
    s_mov_b32 s35, 0x7f800000
    s_waitcnt lgkmcnt(0)
    s_sub_u32 s43, s30, 0x41000
    s_add_u32 s40, s43, 4096
    s_nop 7
    buffer_load_dwordx4 v[56:59], v117, s[8:11], s43 offen
    buffer_load_dwordx4 v[60:63], v117, s[8:11], s43 offen offset:1024
    buffer_load_dwordx4 v[64:67], v117, s[8:11], s43 offen offset:2048
    buffer_load_dwordx4 v[68:71], v117, s[8:11], s43 offen offset:3072
    buffer_load_dwordx4 v[72:75], v117, s[8:11], s40 offen
    buffer_load_dwordx4 v[76:79], v117, s[8:11], s40 offen offset:1024
    buffer_load_dwordx4 v[80:83], v117, s[8:11], s40 offen offset:2048
    buffer_load_dwordx4 v[84:87], v117, s[8:11], s40 offen offset:3072
    ds_read_b128 v[32:35], v121 offset:16384
    ds_read_b128 v[36:39], v121 offset:17408
    ds_read_b128 v[40:43], v121 offset:18432
    ds_read_b128 v[44:47], v121 offset:19456
    v_mov_b32 v96, 0
    v_mov_b32 v97, 0
    v_mov_b32 v98, 0
    v_mov_b32 v99, 0
    v_mov_b32 v100, 0
    v_mov_b32 v101, 0
    v_mov_b32 v102, 0
    v_mov_b32 v103, 0
    v_mov_b32 v104, 0
    v_mov_b32 v105, 0
    v_mov_b32 v106, 0
    v_mov_b32 v107, 0
    v_mov_b32 v108, 0
    v_mov_b32 v109, 0
    v_mov_b32 v110, 0
    v_mov_b32 v111, 0
    s_waitcnt vmcnt(0) lgkmcnt(0)
    v_mfma_f32_16x16x32_bf16 v[56:59], v[56:59], v[32:35], 0
    v_mfma_f32_16x16x32_bf16 v[56:59], v[60:63], v[36:39], v[56:59]
    v_mfma_f32_16x16x32_bf16 v[56:59], v[64:67], v[40:43], v[56:59]
    v_mfma_f32_16x16x32_bf16 v[56:59], v[68:71], v[44:47], v[56:59]
    v_mfma_f32_16x16x32_bf16 v[60:63], v[72:75], v[32:35], 0
    v_mfma_f32_16x16x32_bf16 v[60:63], v[76:79], v[36:39], v[60:63]
    v_mfma_f32_16x16x32_bf16 v[60:63], v[80:83], v[40:43], v[60:63]
    v_mfma_f32_16x16x32_bf16 v[60:63], v[84:87], v[44:47], v[60:63]
    v_mfma_f32_16x16x32_bf16 v[64:67], v[32:35], v[32:35], 0
    v_mfma_f32_16x16x32_bf16 v[64:67], v[36:39], v[36:39], v[64:67]
    v_mfma_f32_16x16x32_bf16 v[64:67], v[40:43], v[40:43], v[64:67]
    v_mfma_f32_16x16x32_bf16 v[64:67], v[44:47], v[44:47], v[64:67]
    v_max3_f32 v84, v56, v57, v58
    v_max3_f32 v84, v84, v59, v60
    v_max3_f32 v84, v84, v61, v62
    s_nop 4
    v_max3_f32 v84, v84, v63, v64
    v_max_f32 v84, v84, v65
    v_mov_b32 v85, v84
    s_nop 1
    v_permlane32_swap_b32 v85, v84
    v_max_f32 v84, v85, v84
    v_mov_b32 v85, v84
    s_nop 1
    v_permlane16_swap_b32 v85, v84
    v_max_f32 v84, v85, v84
    v_sub_f32 v56, v56, v84
    v_sub_f32 v57, v57, v84
    v_sub_f32 v58, v58, v84
    v_sub_f32 v59, v59, v84
    v_sub_f32 v60, v60, v84
    v_sub_f32 v61, v61, v84
    v_sub_f32 v62, v62, v84
    v_sub_f32 v63, v63, v84
    v_sub_f32 v64, v64, v84
    v_sub_f32 v65, v65, v84
    v_exp_f32 v56, v56
    v_exp_f32 v57, v57
    v_exp_f32 v58, v58
    v_exp_f32 v59, v59
    v_exp_f32 v60, v60
    v_exp_f32 v61, v61
    v_exp_f32 v62, v62
    v_exp_f32 v63, v63
    v_exp_f32 v64, v64
    v_exp_f32 v65, v65
    v_cvt_pk_bf16_f32 v68, v56, v57
    v_cvt_pk_bf16_f32 v69, v58, v59
    v_cvt_pk_bf16_f32 v70, v60, v61
    v_cvt_pk_bf16_f32 v71, v62, v63
    v_cvt_pk_bf16_f32 v52, v64, v65
    s_nop 0
    v_mfma_f32_16x16x32_bf16 v[72:75], v[88:91], v[68:71], 0
    v_mfma_f32_16x16x32_bf16 v[76:79], v[92:95], v[68:71], 0
    v_mfma_f32_16x16x32_bf16 v[80:83], v[48:51], v[68:71], 0
    v_mfma_f32_16x16x16_bf16 v[72:75], v[112:113], v[52:53], v[72:75]
    v_mfma_f32_16x16x16_bf16 v[76:79], v[114:115], v[52:53], v[76:79]
    v_mfma_f32_16x16x16_bf16 v[80:83], v[48:49], v[52:53], v[80:83]
    ds_read_b128 v[32:35], v124 offset:6144
    ds_read_b128 v[36:39], v124 offset:7168
    ds_read_b128 v[40:43], v124 offset:34816
    ds_read_b128 v[44:47], v124 offset:35840
    ds_read_b128 v[56:59], v124 offset:36864
    ds_read_b128 v[64:67], v124 offset:38912
    ds_read_b128 v[68:71], v124 offset:39936
    s_waitcnt lgkmcnt(0)
    s_branch L_norm_75
L_rslow_78:
    buffer_load_dwordx4 v[4:7], v117, s[8:11], s29 offen sc1
    buffer_load_dwordx4 v[8:11], v117, s[8:11], s53 offen sc1
    buffer_load_dwordx4 v[16:19], v117, s[8:11], s29 offen offset:2048 sc1
    buffer_load_dwordx4 v[20:23], v117, s[8:11], s53 offen offset:2048 sc1
    s_add_u32 s46, s46, 1
    s_add_u32 s49, s49, 1
    s_cmp_ge_u32 s49, 0x10000
    s_cbranch_scc1 L_rgo_79
    s_waitcnt vmcnt(7)
    v_mfma_f32_16x16x32_bf16 v[48:51], v[32:35], v[12:15], 0
    v_xor_b32 v52, s33, v32
    s_waitcnt vmcnt(6)
    v_mfma_f32_16x16x32_bf16 v[48:51], v[36:39], v[12:15], v[48:51]
    v_xor_b32 v53, s33, v36
    v_or_b32 v52, v52, v53
    s_waitcnt vmcnt(5)
    v_mfma_f32_16x16x32_bf16 v[48:51], v[40:43], v[12:15], v[48:51]
    v_xor_b32 v53, s33, v40
    v_or_b32 v52, v52, v53
    s_waitcnt vmcnt(4)
    v_mfma_f32_16x16x32_bf16 v[48:51], v[44:47], v[12:15], v[48:51]
    v_xor_b32 v53, s33, v44
    v_or_b32 v52, v52, v53
    v_and_b32 v52, 1, v52
    v_cmp_ne_u32 vcc, 0, v52
    s_cbranch_vccz L_rgo_79
    buffer_load_dwordx4 v[32:35], v117, s[8:11], s29 offen sc1
    buffer_load_dwordx4 v[36:39], v117, s[8:11], s53 offen sc1
    buffer_load_dwordx4 v[40:43], v117, s[8:11], s29 offen offset:2048 sc1
    buffer_load_dwordx4 v[44:47], v117, s[8:11], s53 offen offset:2048 sc1
    s_add_u32 s46, s46, 1
    s_branch L_rl_77
L_mret_81:
    s_mov_b32 s43, m0
    s_mov_b32 m0, 7168
    buffer_load_dwordx4 v[4:7], v117, s[8:11], s48 offen sc1
    buffer_load_dwordx4 v117, s[8:11], s48 offen sc1 lds
    s_mov_b32 m0, 14336
    s_mov_b32 m0, s43
    s_waitcnt vmcnt(0)
    v_max3_u32 v15, v4, v5, v6
    v_max_u32 v15, v15, v7
    v_cmp_lt_u32 vcc, s56, v15
    s_add_u32 s47, s47, 1
    s_add_u32 s49, s49, 1
    s_cmp_ge_u32 s49, 0x10000
    s_cbranch_scc1 L_mgo_82
    s_cbranch_vccnz L_mret_81
    s_branch L_mgo_82
L_smax_84:
    s_add_u32 s47, s47, 1
    s_mov_b32 s35, 0x7f800000
    s_waitcnt lgkmcnt(0)
    s_sub_u32 s43, s30, 0x41800
    s_add_u32 s40, s43, 4096
    s_nop 7
    buffer_load_dwordx4 v[56:59], v117, s[8:11], s43 offen
    buffer_load_dwordx4 v[60:63], v117, s[8:11], s43 offen offset:1024
    buffer_load_dwordx4 v[64:67], v117, s[8:11], s43 offen offset:2048
    buffer_load_dwordx4 v[68:71], v117, s[8:11], s43 offen offset:3072
    buffer_load_dwordx4 v[72:75], v117, s[8:11], s40 offen
    buffer_load_dwordx4 v[76:79], v117, s[8:11], s40 offen offset:1024
    buffer_load_dwordx4 v[80:83], v117, s[8:11], s40 offen offset:2048
    buffer_load_dwordx4 v[84:87], v117, s[8:11], s40 offen offset:3072
    ds_read_b128 v[32:35], v121 offset:16384
    ds_read_b128 v[36:39], v121 offset:17408
    ds_read_b128 v[40:43], v121 offset:18432
    ds_read_b128 v[44:47], v121 offset:19456
    v_mov_b32 v96, 0
    v_mov_b32 v97, 0
    v_mov_b32 v98, 0
    v_mov_b32 v99, 0
    v_mov_b32 v100, 0
    v_mov_b32 v101, 0
    v_mov_b32 v102, 0
    v_mov_b32 v103, 0
    v_mov_b32 v104, 0
    v_mov_b32 v105, 0
    v_mov_b32 v106, 0
    v_mov_b32 v107, 0
    v_mov_b32 v108, 0
    v_mov_b32 v109, 0
    v_mov_b32 v110, 0
    v_mov_b32 v111, 0
    s_waitcnt vmcnt(0) lgkmcnt(0)
    v_mfma_f32_16x16x32_bf16 v[56:59], v[56:59], v[32:35], 0
    v_mfma_f32_16x16x32_bf16 v[56:59], v[60:63], v[36:39], v[56:59]
    v_mfma_f32_16x16x32_bf16 v[56:59], v[64:67], v[40:43], v[56:59]
    v_mfma_f32_16x16x32_bf16 v[56:59], v[68:71], v[44:47], v[56:59]
    v_mfma_f32_16x16x32_bf16 v[60:63], v[72:75], v[32:35], 0
    v_mfma_f32_16x16x32_bf16 v[60:63], v[76:79], v[36:39], v[60:63]
    v_mfma_f32_16x16x32_bf16 v[60:63], v[80:83], v[40:43], v[60:63]
    v_mfma_f32_16x16x32_bf16 v[60:63], v[84:87], v[44:47], v[60:63]
    v_mfma_f32_16x16x32_bf16 v[64:67], v[32:35], v[32:35], 0
    v_mfma_f32_16x16x32_bf16 v[64:67], v[36:39], v[36:39], v[64:67]
    v_mfma_f32_16x16x32_bf16 v[64:67], v[40:43], v[40:43], v[64:67]
    v_mfma_f32_16x16x32_bf16 v[64:67], v[44:47], v[44:47], v[64:67]
    v_max3_f32 v84, v56, v57, v58
    v_max3_f32 v84, v84, v59, v60
    v_max3_f32 v84, v84, v61, v62
    s_nop 4
    v_max3_f32 v84, v84, v63, v64
    v_max_f32 v84, v84, v65
    v_mov_b32 v85, v84
    s_nop 1
    v_permlane32_swap_b32 v85, v84
    v_max_f32 v84, v85, v84
    v_mov_b32 v85, v84
    s_nop 1
    v_permlane16_swap_b32 v85, v84
    v_max_f32 v84, v85, v84
    v_sub_f32 v56, v56, v84
    v_sub_f32 v57, v57, v84
    v_sub_f32 v58, v58, v84
    v_sub_f32 v59, v59, v84
    v_sub_f32 v60, v60, v84
    v_sub_f32 v61, v61, v84
    v_sub_f32 v62, v62, v84
    v_sub_f32 v63, v63, v84
    v_sub_f32 v64, v64, v84
    v_sub_f32 v65, v65, v84
    v_exp_f32 v56, v56
    v_exp_f32 v57, v57
    v_exp_f32 v58, v58
    v_exp_f32 v59, v59
    v_exp_f32 v60, v60
    v_exp_f32 v61, v61
    v_exp_f32 v62, v62
    v_exp_f32 v63, v63
    v_exp_f32 v64, v64
    v_exp_f32 v65, v65
    v_cvt_pk_bf16_f32 v68, v56, v57
    v_cvt_pk_bf16_f32 v69, v58, v59
    v_cvt_pk_bf16_f32 v70, v60, v61
    v_cvt_pk_bf16_f32 v71, v62, v63
    v_cvt_pk_bf16_f32 v52, v64, v65
    s_nop 0
    v_mfma_f32_16x16x32_bf16 v[72:75], v[88:91], v[68:71], 0
    v_mfma_f32_16x16x32_bf16 v[76:79], v[92:95], v[68:71], 0
    v_mfma_f32_16x16x32_bf16 v[80:83], v[48:51], v[68:71], 0
    v_mfma_f32_16x16x16_bf16 v[72:75], v[112:113], v[52:53], v[72:75]
    v_mfma_f32_16x16x16_bf16 v[76:79], v[114:115], v[52:53], v[76:79]
    v_mfma_f32_16x16x16_bf16 v[80:83], v[48:49], v[52:53], v[80:83]
    ds_read_b128 v[32:35], v124 offset:6144
    ds_read_b128 v[36:39], v124 offset:7168
    ds_read_b128 v[40:43], v124 offset:34816
    ds_read_b128 v[44:47], v124 offset:35840
    ds_read_b128 v[56:59], v124 offset:36864
    ds_read_b128 v[64:67], v124 offset:38912
    ds_read_b128 v[68:71], v124 offset:39936
    s_waitcnt lgkmcnt(0)
    s_branch L_norm_83
L_rslow_86:
    buffer_load_dwordx4 v[4:7], v117, s[8:11], s29 offen sc1
    buffer_load_dwordx4 v[8:11], v117, s[8:11], s53 offen sc1
    buffer_load_dwordx4 v[16:19], v117, s[8:11], s29 offen offset:2048 sc1
    buffer_load_dwordx4 v[20:23], v117, s[8:11], s53 offen offset:2048 sc1
    s_add_u32 s46, s46, 1
    s_add_u32 s49, s49, 1
    s_cmp_ge_u32 s49, 0x10000
    s_cbranch_scc1 L_rgo_87
    s_waitcnt vmcnt(7)
    v_mfma_f32_16x16x32_bf16 v[48:51], v[32:35], v[12:15], 0
    v_xor_b32 v52, s33, v32
    s_waitcnt vmcnt(6)
    v_mfma_f32_16x16x32_bf16 v[48:51], v[36:39], v[12:15], v[48:51]
    v_xor_b32 v53, s33, v36
    v_or_b32 v52, v52, v53
    s_waitcnt vmcnt(5)
    v_mfma_f32_16x16x32_bf16 v[48:51], v[40:43], v[12:15], v[48:51]
    v_xor_b32 v53, s33, v40
    v_or_b32 v52, v52, v53
    s_waitcnt vmcnt(4)
    v_mfma_f32_16x16x32_bf16 v[48:51], v[44:47], v[12:15], v[48:51]
    v_xor_b32 v53, s33, v44
    v_or_b32 v52, v52, v53
    v_and_b32 v52, 1, v52
    v_cmp_ne_u32 vcc, 0, v52
    s_cbranch_vccz L_rgo_87
    buffer_load_dwordx4 v[32:35], v117, s[8:11], s29 offen sc1
    buffer_load_dwordx4 v[36:39], v117, s[8:11], s53 offen sc1
    buffer_load_dwordx4 v[40:43], v117, s[8:11], s29 offen offset:2048 sc1
    buffer_load_dwordx4 v[44:47], v117, s[8:11], s53 offen offset:2048 sc1
    s_add_u32 s46, s46, 1
    s_branch L_rl_85
L_bulk:
    s_load_dwordx8 s[60:67], s[0:1], 16
    s_load_dwordx2 s[12:13], s[0:1], 0
    s_waitcnt lgkmcnt(0)
    s_branch L_bulk2
.p2align 7
L_other:
    s_sub_u32 s101, s84, 1
    s_lshl_b32 s101, s101, 5
    s_add_u32 s101, s101, s85
    s_cmp_ge_u32 s85, 2
    s_cbranch_scc1 L_nobc
    v_lshlrev_b32 v1, 6, v0
    s_lshl_b32 s96, s85, 14
    s_getpc_b64 s[4:5]
L_pc_88:
    s_add_u32 s4, s4, L_bulk2-L_pc_88
    s_addc_u32 s5, s5, 0
    v_add_u32 v1, s96, v1
    v_min_u32 v1, L_code_end-L_bulk2-4, v1
    global_load_dword v255, v1, s[4:5]
L_nobc:
    s_waitcnt lgkmcnt(0)
    s_and_b32 s9, s9, 0xffff
    s_mov_b32 s10, 0x10000000
    s_mov_b32 s11, 0x20000
    s_and_b32 s93, s93, 0xffff
    s_mov_b32 s94, 0x100
    s_mov_b32 s95, 0x20000
    s_mov_b32 s87, 0
    s_cmp_lg_u32 s86, 0
    s_cbranch_scc1 L_reg_89
    s_lshl_b32 s97, s84, 4
    s_lshl_b32 s96, 1, s85
    v_mov_b32 v250, s96
    v_mov_b32 v251, 256
    s_mov_b64 exec, 1
    buffer_atomic_add_x2 v[250:251], off, s[92:95], s97 offset:64
    s_mov_b64 exec, -1
    s_mov_b32 s86, 1
L_reg_89:
L_bulk2:
    s_add_u32 s88, s101, 32
    s_mov_b32 s41, 0
    s_lshr_b32 s20, s101, 6
    s_and_b32 s22, s101, 63
    s_cmp_ge_u32 s101, 192
    s_cselect_b32 s37, 32, 1000
L_p1go:
    s_mov_b32 s40, 0
    s_mov_b32 s80, 0
    s_mov_b32 s23, 0
L_p1_pass:
    v_mbcnt_lo_u32_b32 v0, -1, 0
    v_mbcnt_hi_u32_b32 v0, -1, v0
    s_lshl_b32 s96, s100, 6
    v_add_u32 v0, s96, v0
    s_and_b32 s13, s13, 0xffff
    s_mov_b32 s14, 0x200000
    s_mov_b32 s15, 0x20000
    v_lshrrev_b32 v147, 6, v0
    s_nop 0
    v_readfirstlane_b32 s21, v147
    v_and_b32 v144, 63, v0
    v_lshrrev_b32 v145, 4, v144
    v_and_b32 v146, 15, v144
    v_lshrrev_b32 v149, 2, v146
    v_lshlrev_b32 v137, 4, v144
    s_lshl_b32 s29, s21, 10
    s_lshl_b32 s26, s20, 7
    s_lshl_b32 s27, s21, 5
    s_add_u32 s26, s26, s27
    v_add_u32 v147, s26, v146
    v_lshlrev_b32 v147, 10, v147
    v_lshl_add_u32 v139, v145, 4, v147
    s_mov_b32 s26, 0x0
    buffer_load_dwordx4 v[0:3], v139, s[12:15], s26 offen
    buffer_load_dwordx4 v[4:7], v139, s[12:15], s26 offen offset:64
    buffer_load_dwordx4 v[8:11], v139, s[12:15], s26 offen offset:128
    buffer_load_dwordx4 v[12:15], v139, s[12:15], s26 offen offset:192
    buffer_load_dwordx4 v[16:19], v139, s[12:15], s26 offen offset:256
    buffer_load_dwordx4 v[20:23], v139, s[12:15], s26 offen offset:320
    buffer_load_dwordx4 v[24:27], v139, s[12:15], s26 offen offset:384
    buffer_load_dwordx4 v[28:31], v139, s[12:15], s26 offen offset:448
    buffer_load_dwordx4 v[32:35], v139, s[12:15], s26 offen offset:512
    buffer_load_dwordx4 v[36:39], v139, s[12:15], s26 offen offset:576
    buffer_load_dwordx4 v[40:43], v139, s[12:15], s26 offen offset:640
    buffer_load_dwordx4 v[44:47], v139, s[12:15], s26 offen offset:704
    buffer_load_dwordx4 v[48:51], v139, s[12:15], s26 offen offset:768
    buffer_load_dwordx4 v[52:55], v139, s[12:15], s26 offen offset:832
    buffer_load_dwordx4 v[56:59], v139, s[12:15], s26 offen offset:896
    buffer_load_dwordx4 v[60:63], v139, s[12:15], s26 offen offset:960
    s_mov_b32 s26, 0x4000
    buffer_load_dwordx4 v[64:67], v139, s[12:15], s26 offen
    buffer_load_dwordx4 v[68:71], v139, s[12:15], s26 offen offset:64
    buffer_load_dwordx4 v[72:75], v139, s[12:15], s26 offen offset:128
    buffer_load_dwordx4 v[76:79], v139, s[12:15], s26 offen offset:192
    buffer_load_dwordx4 v[80:83], v139, s[12:15], s26 offen offset:256
    buffer_load_dwordx4 v[84:87], v139, s[12:15], s26 offen offset:320
    buffer_load_dwordx4 v[88:91], v139, s[12:15], s26 offen offset:384
    buffer_load_dwordx4 v[92:95], v139, s[12:15], s26 offen offset:448
    buffer_load_dwordx4 v[96:99], v139, s[12:15], s26 offen offset:512
    buffer_load_dwordx4 v[100:103], v139, s[12:15], s26 offen offset:576
    buffer_load_dwordx4 v[104:107], v139, s[12:15], s26 offen offset:640
    buffer_load_dwordx4 v[108:111], v139, s[12:15], s26 offen offset:704
    buffer_load_dwordx4 v[112:115], v139, s[12:15], s26 offen offset:768
    buffer_load_dwordx4 v[116:119], v139, s[12:15], s26 offen offset:832
    buffer_load_dwordx4 v[120:123], v139, s[12:15], s26 offen offset:896
    buffer_load_dwordx4 v[124:127], v139, s[12:15], s26 offen offset:960
    s_lshr_b32 s26, s21, 1
    s_lshl_b32 s26, s26, 2
    v_or_b32 v148, s26, v145
    v_lshlrev_b32 v148, 1, v148
    v_xor_b32 v148, v148, v146
    v_lshlrev_b32 v148, 4, v148
    s_lshl_b32 s26, s21, 2
    v_add_u32 v147, s26, v145
    v_lshl_add_u32 v136, v147, 13, v148
    v_lshl_add_u32 v147, v145, 3, v149
    v_lshlrev_b32 v147, 8, v147
    v_and_b32 v148, 1, v145
    v_lshl_or_b32 v148, v148, 2, v149
    v_lshl_add_u32 v147, v148, 5, v147
    v_and_b32 v148, 3, v146
    v_lshl_add_u32 v128, v148, 3, v147
    v_xor_b32 v129, 32, v128
    v_xor_b32 v130, 64, v128
    v_xor_b32 v131, 96, v128
    v_xor_b32 v132, 128, v128
    v_xor_b32 v133, 160, v128
    v_xor_b32 v134, 192, v128
    v_xor_b32 v135, 224, v128
    s_mov_b32 s19, 0x20000
    s_mov_b32 s38, s22
    s_mov_b32 s39, s22
    v_mov_b32 v158, 0x3f803f80
    s_lshr_b32 s26, s39, 5
    s_cmp_eq_u32 s26, 0
    s_cselect_b64 s[16:17], s[62:63], s[60:61]
    s_cmp_eq_u32 s26, 1
    s_cselect_b64 s[16:17], s[64:65], s[16:17]
    s_and_b32 s17, s17, 0xffff
    s_cmp_lt_u32 s39, 96
    s_cselect_b32 s18, 0x400000, 0
    s_and_b32 s24, s39, 31
    s_lshl_b32 s24, s24, 8
    s_waitcnt vmcnt(16)
    v_pk_mov_b32 v[150:151], 0, 0
    v_pk_mov_b32 v[152:153], 0, 0
    v_dot2_f32_bf16 v150, v0, v158, v150
    v_dot2_f32_bf16 v152, v0, v0, v152
    v_dot2_f32_bf16 v151, v1, v158, v151
    v_dot2_f32_bf16 v153, v1, v1, v153
    v_dot2_f32_bf16 v150, v2, v158, v150
    v_dot2_f32_bf16 v152, v2, v2, v152
    v_dot2_f32_bf16 v151, v3, v158, v151
    v_dot2_f32_bf16 v153, v3, v3, v153
    v_dot2_f32_bf16 v150, v4, v158, v150
    v_dot2_f32_bf16 v152, v4, v4, v152
    v_dot2_f32_bf16 v151, v5, v158, v151
    v_dot2_f32_bf16 v153, v5, v5, v153
    v_dot2_f32_bf16 v150, v6, v158, v150
    v_dot2_f32_bf16 v152, v6, v6, v152
    v_dot2_f32_bf16 v151, v7, v158, v151
    v_dot2_f32_bf16 v153, v7, v7, v153
    v_dot2_f32_bf16 v150, v8, v158, v150
    v_dot2_f32_bf16 v152, v8, v8, v152
    v_dot2_f32_bf16 v151, v9, v158, v151
    v_dot2_f32_bf16 v153, v9, v9, v153
    v_dot2_f32_bf16 v150, v10, v158, v150
    v_dot2_f32_bf16 v152, v10, v10, v152
    v_dot2_f32_bf16 v151, v11, v158, v151
    v_dot2_f32_bf16 v153, v11, v11, v153
    v_dot2_f32_bf16 v150, v12, v158, v150
    v_dot2_f32_bf16 v152, v12, v12, v152
    v_dot2_f32_bf16 v151, v13, v158, v151
    v_dot2_f32_bf16 v153, v13, v13, v153
    v_dot2_f32_bf16 v150, v14, v158, v150
    v_dot2_f32_bf16 v152, v14, v14, v152
    v_dot2_f32_bf16 v151, v15, v158, v151
    v_dot2_f32_bf16 v153, v15, v15, v153
    v_dot2_f32_bf16 v150, v16, v158, v150
    v_dot2_f32_bf16 v152, v16, v16, v152
    v_dot2_f32_bf16 v151, v17, v158, v151
    v_dot2_f32_bf16 v153, v17, v17, v153
    v_dot2_f32_bf16 v150, v18, v158, v150
    v_dot2_f32_bf16 v152, v18, v18, v152
    v_dot2_f32_bf16 v151, v19, v158, v151
    v_dot2_f32_bf16 v153, v19, v19, v153
    v_dot2_f32_bf16 v150, v20, v158, v150
    v_dot2_f32_bf16 v152, v20, v20, v152
    v_dot2_f32_bf16 v151, v21, v158, v151
    v_dot2_f32_bf16 v153, v21, v21, v153
    v_dot2_f32_bf16 v150, v22, v158, v150
    v_dot2_f32_bf16 v152, v22, v22, v152
    v_dot2_f32_bf16 v151, v23, v158, v151
    v_dot2_f32_bf16 v153, v23, v23, v153
    v_dot2_f32_bf16 v150, v24, v158, v150
    v_dot2_f32_bf16 v152, v24, v24, v152
    v_dot2_f32_bf16 v151, v25, v158, v151
    v_dot2_f32_bf16 v153, v25, v25, v153
    v_dot2_f32_bf16 v150, v26, v158, v150
    v_dot2_f32_bf16 v152, v26, v26, v152
    v_dot2_f32_bf16 v151, v27, v158, v151
    v_dot2_f32_bf16 v153, v27, v27, v153
    v_dot2_f32_bf16 v150, v28, v158, v150
    v_dot2_f32_bf16 v152, v28, v28, v152
    v_dot2_f32_bf16 v151, v29, v158, v151
    v_dot2_f32_bf16 v153, v29, v29, v153
    v_dot2_f32_bf16 v150, v30, v158, v150
    v_dot2_f32_bf16 v152, v30, v30, v152
    v_dot2_f32_bf16 v151, v31, v158, v151
    v_dot2_f32_bf16 v153, v31, v31, v153
    v_dot2_f32_bf16 v150, v32, v158, v150
    v_dot2_f32_bf16 v152, v32, v32, v152
    v_dot2_f32_bf16 v151, v33, v158, v151
    v_dot2_f32_bf16 v153, v33, v33, v153
    v_dot2_f32_bf16 v150, v34, v158, v150
    v_dot2_f32_bf16 v152, v34, v34, v152
    v_dot2_f32_bf16 v151, v35, v158, v151
    v_dot2_f32_bf16 v153, v35, v35, v153
    v_dot2_f32_bf16 v150, v36, v158, v150
    v_dot2_f32_bf16 v152, v36, v36, v152
    v_dot2_f32_bf16 v151, v37, v158, v151
    v_dot2_f32_bf16 v153, v37, v37, v153
    v_dot2_f32_bf16 v150, v38, v158, v150
    v_dot2_f32_bf16 v152, v38, v38, v152
    v_dot2_f32_bf16 v151, v39, v158, v151
    v_dot2_f32_bf16 v153, v39, v39, v153
    v_dot2_f32_bf16 v150, v40, v158, v150
    v_dot2_f32_bf16 v152, v40, v40, v152
    v_dot2_f32_bf16 v151, v41, v158, v151
    v_dot2_f32_bf16 v153, v41, v41, v153
    v_dot2_f32_bf16 v150, v42, v158, v150
    v_dot2_f32_bf16 v152, v42, v42, v152
    v_dot2_f32_bf16 v151, v43, v158, v151
    v_dot2_f32_bf16 v153, v43, v43, v153
    v_dot2_f32_bf16 v150, v44, v158, v150
    v_dot2_f32_bf16 v152, v44, v44, v152
    v_dot2_f32_bf16 v151, v45, v158, v151
    v_dot2_f32_bf16 v153, v45, v45, v153
    v_dot2_f32_bf16 v150, v46, v158, v150
    v_dot2_f32_bf16 v152, v46, v46, v152
    v_dot2_f32_bf16 v151, v47, v158, v151
    v_dot2_f32_bf16 v153, v47, v47, v153
    v_dot2_f32_bf16 v150, v48, v158, v150
    v_dot2_f32_bf16 v152, v48, v48, v152
    v_dot2_f32_bf16 v151, v49, v158, v151
    v_dot2_f32_bf16 v153, v49, v49, v153
    s_add_u32 s26, s24, 0x0
    s_add_u32 m0, s29, 0x0
    s_nop 0
    buffer_load_dwordx4 v136, s[16:19], s26 offen lds
    v_dot2_f32_bf16 v150, v50, v158, v150
    v_dot2_f32_bf16 v152, v50, v50, v152
    v_dot2_f32_bf16 v151, v51, v158, v151
    v_dot2_f32_bf16 v153, v51, v51, v153
    v_dot2_f32_bf16 v150, v52, v158, v150
    v_dot2_f32_bf16 v152, v52, v52, v152
    v_dot2_f32_bf16 v151, v53, v158, v151
    v_dot2_f32_bf16 v153, v53, v53, v153
    v_dot2_f32_bf16 v150, v54, v158, v150
    v_dot2_f32_bf16 v152, v54, v54, v152
    v_dot2_f32_bf16 v151, v55, v158, v151
    v_dot2_f32_bf16 v153, v55, v55, v153
    v_dot2_f32_bf16 v150, v56, v158, v150
    v_dot2_f32_bf16 v152, v56, v56, v152
    v_dot2_f32_bf16 v151, v57, v158, v151
    v_dot2_f32_bf16 v153, v57, v57, v153
    v_dot2_f32_bf16 v150, v58, v158, v150
    v_dot2_f32_bf16 v152, v58, v58, v152
    v_dot2_f32_bf16 v151, v59, v158, v151
    v_dot2_f32_bf16 v153, v59, v59, v153
    v_dot2_f32_bf16 v150, v60, v158, v150
    v_dot2_f32_bf16 v152, v60, v60, v152
    v_dot2_f32_bf16 v151, v61, v158, v151
    v_dot2_f32_bf16 v153, v61, v61, v153
    v_dot2_f32_bf16 v150, v62, v158, v150
    v_dot2_f32_bf16 v152, v62, v62, v152
    v_dot2_f32_bf16 v151, v63, v158, v151
    v_dot2_f32_bf16 v153, v63, v63, v153
    s_nop 1
    v_add_f32 v150, v150, v151
    v_add_f32 v152, v152, v153
    v_mov_b32 v157, v150
    s_nop 1
    v_permlane32_swap_b32 v157, v150
    v_add_f32 v150, v157, v150
    v_mov_b32 v157, v150
    s_nop 1
    v_permlane16_swap_b32 v157, v150
    v_add_f32 v150, v157, v150
    v_mov_b32 v157, v152
    s_nop 1
    v_permlane32_swap_b32 v157, v152
    v_add_f32 v152, v157, v152
    v_mov_b32 v157, v152
    s_nop 1
    v_permlane16_swap_b32 v157, v152
    v_add_f32 v152, v157, v152
    v_mul_f32 v150, 0x3b000000, v150
    v_cvt_pk_bf16_f32 v154, v150, v150
    v_and_b32 v154, 0xffff0000, v154
    v_sub_f32 v156, v150, v154
    v_mul_f32 v157, v150, v150
    v_mul_f32 v152, 0x3b000000, v152
    v_sub_f32 v152, v152, v157
    v_max_f32 v152, 0, v152
    v_cvt_pk_bf16_f32 v152, v152, v152
    v_and_b32 v152, 0xffff0000, v152
    v_add_f32 v152, 0x3727c5ac, v152
    v_cvt_pk_bf16_f32 v152, v152, v152
    v_and_b32 v152, 0xffff0000, v152
    v_sqrt_f32 v152, v152
    s_nop 0
    v_cvt_pk_bf16_f32 v152, v152, v152
    v_and_b32 v152, 0xffff0000, v152
    v_rcp_f32 v152, v152
    v_lshlrev_b32 v160, 16, v0
    v_and_b32 v161, 0xffff0000, v0
    v_lshlrev_b32 v162, 16, v1
    v_and_b32 v163, 0xffff0000, v1
    v_lshlrev_b32 v164, 16, v2
    v_and_b32 v165, 0xffff0000, v2
    v_lshlrev_b32 v166, 16, v3
    v_and_b32 v167, 0xffff0000, v3
    v_lshlrev_b32 v168, 16, v4
    v_and_b32 v169, 0xffff0000, v4
    v_lshlrev_b32 v170, 16, v5
    v_and_b32 v171, 0xffff0000, v5
    v_lshlrev_b32 v172, 16, v6
    v_and_b32 v173, 0xffff0000, v6
    v_lshlrev_b32 v174, 16, v7
    v_and_b32 v175, 0xffff0000, v7
    v_pk_add_f32 v[160:161], v[160:161], v[154:155] op_sel_hi:[1,0] neg_lo:[0,1] neg_hi:[0,1]
    v_pk_add_f32 v[162:163], v[162:163], v[154:155] op_sel_hi:[1,0] neg_lo:[0,1] neg_hi:[0,1]
    v_pk_add_f32 v[164:165], v[164:165], v[154:155] op_sel_hi:[1,0] neg_lo:[0,1] neg_hi:[0,1]
    v_pk_add_f32 v[166:167], v[166:167], v[154:155] op_sel_hi:[1,0] neg_lo:[0,1] neg_hi:[0,1]
    v_pk_add_f32 v[168:169], v[168:169], v[154:155] op_sel_hi:[1,0] neg_lo:[0,1] neg_hi:[0,1]
    v_pk_add_f32 v[170:171], v[170:171], v[154:155] op_sel_hi:[1,0] neg_lo:[0,1] neg_hi:[0,1]
    s_add_u32 s26, s24, 0x20000
    s_add_u32 m0, s29, 0x1000
    s_nop 0
    buffer_load_dwordx4 v136, s[16:19], s26 offen lds
    v_pk_add_f32 v[172:173], v[172:173], v[154:155] op_sel_hi:[1,0] neg_lo:[0,1] neg_hi:[0,1]
    v_pk_add_f32 v[174:175], v[174:175], v[154:155] op_sel_hi:[1,0] neg_lo:[0,1] neg_hi:[0,1]
    v_cvt_pk_bf16_f32 v0, v160, v161
    v_cvt_pk_bf16_f32 v1, v162, v163
    v_cvt_pk_bf16_f32 v2, v164, v165
    v_cvt_pk_bf16_f32 v3, v166, v167
    v_cvt_pk_bf16_f32 v4, v168, v169
    v_cvt_pk_bf16_f32 v5, v170, v171
    v_cvt_pk_bf16_f32 v6, v172, v173
    v_cvt_pk_bf16_f32 v7, v174, v175
    v_lshlrev_b32 v160, 16, v0
    v_and_b32 v161, 0xffff0000, v0
    v_lshlrev_b32 v162, 16, v1
    v_and_b32 v163, 0xffff0000, v1
    v_lshlrev_b32 v164, 16, v2
    v_and_b32 v165, 0xffff0000, v2
    v_lshlrev_b32 v166, 16, v3
    v_and_b32 v167, 0xffff0000, v3
    v_lshlrev_b32 v168, 16, v4
    v_and_b32 v169, 0xffff0000, v4
    v_lshlrev_b32 v170, 16, v5
    v_and_b32 v171, 0xffff0000, v5
    v_lshlrev_b32 v172, 16, v6
    v_and_b32 v173, 0xffff0000, v6
    v_lshlrev_b32 v174, 16, v7
    v_and_b32 v175, 0xffff0000, v7
    v_pk_mul_f32 v[160:161], v[160:161], v[152:153] op_sel_hi:[1,0]
    v_pk_mul_f32 v[162:163], v[162:163], v[152:153] op_sel_hi:[1,0]
    v_pk_mul_f32 v[164:165], v[164:165], v[152:153] op_sel_hi:[1,0]
    v_pk_mul_f32 v[166:167], v[166:167], v[152:153] op_sel_hi:[1,0]
    v_pk_mul_f32 v[168:169], v[168:169], v[152:153] op_sel_hi:[1,0]
    v_pk_mul_f32 v[170:171], v[170:171], v[152:153] op_sel_hi:[1,0]
    v_pk_mul_f32 v[172:173], v[172:173], v[152:153] op_sel_hi:[1,0]
    v_pk_mul_f32 v[174:175], v[174:175], v[152:153] op_sel_hi:[1,0]
    v_cvt_pk_bf16_f32 v160, v160, v161
    v_cvt_pk_bf16_f32 v162, v162, v163
    v_cvt_pk_bf16_f32 v164, v164, v165
    v_cvt_pk_bf16_f32 v166, v166, v167
    v_cvt_pk_bf16_f32 v168, v168, v169
    v_cvt_pk_bf16_f32 v170, v170, v171
    v_cvt_pk_bf16_f32 v172, v172, v173
    v_cvt_pk_bf16_f32 v174, v174, v175
    v_accvgpr_write_b32 a0, v160
    v_accvgpr_write_b32 a1, v162
    v_accvgpr_write_b32 a2, v164
    v_accvgpr_write_b32 a3, v166
    v_accvgpr_write_b32 a4, v168
    v_accvgpr_write_b32 a5, v170
    v_accvgpr_write_b32 a6, v172
    v_accvgpr_write_b32 a7, v174
    s_add_u32 s26, s24, 0x40000
    s_add_u32 m0, s29, 0x2000
    s_nop 0
    buffer_load_dwordx4 v136, s[16:19], s26 offen lds
    v_lshlrev_b32 v160, 16, v8
    v_and_b32 v161, 0xffff0000, v8
    v_lshlrev_b32 v162, 16, v9
    v_and_b32 v163, 0xffff0000, v9
    v_lshlrev_b32 v164, 16, v10
    v_and_b32 v165, 0xffff0000, v10
    v_lshlrev_b32 v166, 16, v11
    v_and_b32 v167, 0xffff0000, v11
    v_lshlrev_b32 v168, 16, v12
    v_and_b32 v169, 0xffff0000, v12
    v_lshlrev_b32 v170, 16, v13
    v_and_b32 v171, 0xffff0000, v13
    v_lshlrev_b32 v172, 16, v14
    v_and_b32 v173, 0xffff0000, v14
    v_lshlrev_b32 v174, 16, v15
    v_and_b32 v175, 0xffff0000, v15
    v_pk_add_f32 v[160:161], v[160:161], v[154:155] op_sel_hi:[1,0] neg_lo:[0,1] neg_hi:[0,1]
    v_pk_add_f32 v[162:163], v[162:163], v[154:155] op_sel_hi:[1,0] neg_lo:[0,1] neg_hi:[0,1]
    v_pk_add_f32 v[164:165], v[164:165], v[154:155] op_sel_hi:[1,0] neg_lo:[0,1] neg_hi:[0,1]
    v_pk_add_f32 v[166:167], v[166:167], v[154:155] op_sel_hi:[1,0] neg_lo:[0,1] neg_hi:[0,1]
    v_pk_add_f32 v[168:169], v[168:169], v[154:155] op_sel_hi:[1,0] neg_lo:[0,1] neg_hi:[0,1]
    v_pk_add_f32 v[170:171], v[170:171], v[154:155] op_sel_hi:[1,0] neg_lo:[0,1] neg_hi:[0,1]
    v_pk_add_f32 v[172:173], v[172:173], v[154:155] op_sel_hi:[1,0] neg_lo:[0,1] neg_hi:[0,1]
    v_pk_add_f32 v[174:175], v[174:175], v[154:155] op_sel_hi:[1,0] neg_lo:[0,1] neg_hi:[0,1]
    v_cvt_pk_bf16_f32 v8, v160, v161
    v_cvt_pk_bf16_f32 v9, v162, v163
    v_cvt_pk_bf16_f32 v10, v164, v165
    v_cvt_pk_bf16_f32 v11, v166, v167
    v_cvt_pk_bf16_f32 v12, v168, v169
    v_cvt_pk_bf16_f32 v13, v170, v171
    v_cvt_pk_bf16_f32 v14, v172, v173
    v_cvt_pk_bf16_f32 v15, v174, v175
    v_lshlrev_b32 v160, 16, v8
    v_and_b32 v161, 0xffff0000, v8
    v_lshlrev_b32 v162, 16, v9
    v_and_b32 v163, 0xffff0000, v9
    v_lshlrev_b32 v164, 16, v10
    v_and_b32 v165, 0xffff0000, v10
    v_lshlrev_b32 v166, 16, v11
    v_and_b32 v167, 0xffff0000, v11
    v_lshlrev_b32 v168, 16, v12
    v_and_b32 v169, 0xffff0000, v12
    v_lshlrev_b32 v170, 16, v13
    v_and_b32 v171, 0xffff0000, v13
    v_lshlrev_b32 v172, 16, v14
    v_and_b32 v173, 0xffff0000, v14
    v_lshlrev_b32 v174, 16, v15
    v_and_b32 v175, 0xffff0000, v15
    v_pk_mul_f32 v[160:161], v[160:161], v[152:153] op_sel_hi:[1,0]
    v_pk_mul_f32 v[162:163], v[162:163], v[152:153] op_sel_hi:[1,0]
    s_add_u32 s26, s24, 0x60000
    s_add_u32 m0, s29, 0x3000
    s_nop 0
    buffer_load_dwordx4 v136, s[16:19], s26 offen lds
    v_pk_mul_f32 v[164:165], v[164:165], v[152:153] op_sel_hi:[1,0]
    v_pk_mul_f32 v[166:167], v[166:167], v[152:153] op_sel_hi:[1,0]
    v_pk_mul_f32 v[168:169], v[168:169], v[152:153] op_sel_hi:[1,0]
    v_pk_mul_f32 v[170:171], v[170:171], v[152:153] op_sel_hi:[1,0]
    v_pk_mul_f32 v[172:173], v[172:173], v[152:153] op_sel_hi:[1,0]
    v_pk_mul_f32 v[174:175], v[174:175], v[152:153] op_sel_hi:[1,0]
    v_cvt_pk_bf16_f32 v160, v160, v161
    v_cvt_pk_bf16_f32 v162, v162, v163
    v_cvt_pk_bf16_f32 v164, v164, v165
    v_cvt_pk_bf16_f32 v166, v166, v167
    v_cvt_pk_bf16_f32 v168, v168, v169
    v_cvt_pk_bf16_f32 v170, v170, v171
    v_cvt_pk_bf16_f32 v172, v172, v173
    v_cvt_pk_bf16_f32 v174, v174, v175
    v_accvgpr_write_b32 a8, v160
    v_accvgpr_write_b32 a9, v162
    v_accvgpr_write_b32 a10, v164
    v_accvgpr_write_b32 a11, v166
    v_accvgpr_write_b32 a12, v168
    v_accvgpr_write_b32 a13, v170
    v_accvgpr_write_b32 a14, v172
    v_accvgpr_write_b32 a15, v174
    v_lshlrev_b32 v160, 16, v16
    v_and_b32 v161, 0xffff0000, v16
    v_lshlrev_b32 v162, 16, v17
    v_and_b32 v163, 0xffff0000, v17
    v_lshlrev_b32 v164, 16, v18
    v_and_b32 v165, 0xffff0000, v18
    v_lshlrev_b32 v166, 16, v19
    v_and_b32 v167, 0xffff0000, v19
    v_lshlrev_b32 v168, 16, v20
    v_and_b32 v169, 0xffff0000, v20
    v_lshlrev_b32 v170, 16, v21
    v_and_b32 v171, 0xffff0000, v21
    v_lshlrev_b32 v172, 16, v22
    v_and_b32 v173, 0xffff0000, v22
    v_lshlrev_b32 v174, 16, v23
    v_and_b32 v175, 0xffff0000, v23
    v_pk_add_f32 v[160:161], v[160:161], v[154:155] op_sel_hi:[1,0] neg_lo:[0,1] neg_hi:[0,1]
    v_pk_add_f32 v[162:163], v[162:163], v[154:155] op_sel_hi:[1,0] neg_lo:[0,1] neg_hi:[0,1]
    v_pk_add_f32 v[164:165], v[164:165], v[154:155] op_sel_hi:[1,0] neg_lo:[0,1] neg_hi:[0,1]
    v_pk_add_f32 v[166:167], v[166:167], v[154:155] op_sel_hi:[1,0] neg_lo:[0,1] neg_hi:[0,1]
    v_pk_add_f32 v[168:169], v[168:169], v[154:155] op_sel_hi:[1,0] neg_lo:[0,1] neg_hi:[0,1]
    v_pk_add_f32 v[170:171], v[170:171], v[154:155] op_sel_hi:[1,0] neg_lo:[0,1] neg_hi:[0,1]
    v_pk_add_f32 v[172:173], v[172:173], v[154:155] op_sel_hi:[1,0] neg_lo:[0,1] neg_hi:[0,1]
    v_pk_add_f32 v[174:175], v[174:175], v[154:155] op_sel_hi:[1,0] neg_lo:[0,1] neg_hi:[0,1]
    v_cvt_pk_bf16_f32 v16, v160, v161
    v_cvt_pk_bf16_f32 v17, v162, v163
    v_cvt_pk_bf16_f32 v18, v164, v165
    v_cvt_pk_bf16_f32 v19, v166, v167
    s_add_u32 s26, s24, 0x80000
    s_add_u32 m0, s29, 0x4000
    s_nop 0
    buffer_load_dwordx4 v136, s[16:19], s26 offen lds
    v_cvt_pk_bf16_f32 v20, v168, v169
    v_cvt_pk_bf16_f32 v21, v170, v171
    v_cvt_pk_bf16_f32 v22, v172, v173
    v_cvt_pk_bf16_f32 v23, v174, v175
    v_lshlrev_b32 v160, 16, v16
    v_and_b32 v161, 0xffff0000, v16
    v_lshlrev_b32 v162, 16, v17
    v_and_b32 v163, 0xffff0000, v17
    v_lshlrev_b32 v164, 16, v18
    v_and_b32 v165, 0xffff0000, v18
    v_lshlrev_b32 v166, 16, v19
    v_and_b32 v167, 0xffff0000, v19
    v_lshlrev_b32 v168, 16, v20
    v_and_b32 v169, 0xffff0000, v20
    v_lshlrev_b32 v170, 16, v21
    v_and_b32 v171, 0xffff0000, v21
    v_lshlrev_b32 v172, 16, v22
    v_and_b32 v173, 0xffff0000, v22
    v_lshlrev_b32 v174, 16, v23
    v_and_b32 v175, 0xffff0000, v23
    v_pk_mul_f32 v[160:161], v[160:161], v[152:153] op_sel_hi:[1,0]
    v_pk_mul_f32 v[162:163], v[162:163], v[152:153] op_sel_hi:[1,0]
    v_pk_mul_f32 v[164:165], v[164:165], v[152:153] op_sel_hi:[1,0]
    v_pk_mul_f32 v[166:167], v[166:167], v[152:153] op_sel_hi:[1,0]
    v_pk_mul_f32 v[168:169], v[168:169], v[152:153] op_sel_hi:[1,0]
    v_pk_mul_f32 v[170:171], v[170:171], v[152:153] op_sel_hi:[1,0]
    v_pk_mul_f32 v[172:173], v[172:173], v[152:153] op_sel_hi:[1,0]
    v_pk_mul_f32 v[174:175], v[174:175], v[152:153] op_sel_hi:[1,0]
    v_cvt_pk_bf16_f32 v160, v160, v161
    v_cvt_pk_bf16_f32 v162, v162, v163
    v_cvt_pk_bf16_f32 v164, v164, v165
    v_cvt_pk_bf16_f32 v166, v166, v167
    v_cvt_pk_bf16_f32 v168, v168, v169
    v_cvt_pk_bf16_f32 v170, v170, v171
    v_cvt_pk_bf16_f32 v172, v172, v173
    v_cvt_pk_bf16_f32 v174, v174, v175
    v_accvgpr_write_b32 a16, v160
    v_accvgpr_write_b32 a17, v162
    v_accvgpr_write_b32 a18, v164
    v_accvgpr_write_b32 a19, v166
    v_accvgpr_write_b32 a20, v168
    v_accvgpr_write_b32 a21, v170
    v_accvgpr_write_b32 a22, v172
    v_accvgpr_write_b32 a23, v174
    v_lshlrev_b32 v160, 16, v24
    v_and_b32 v161, 0xffff0000, v24
    v_lshlrev_b32 v162, 16, v25
    v_and_b32 v163, 0xffff0000, v25
    v_lshlrev_b32 v164, 16, v26
    v_and_b32 v165, 0xffff0000, v26
    s_add_u32 s26, s24, 0xa0000
    s_add_u32 m0, s29, 0x5000
    s_nop 0
    buffer_load_dwordx4 v136, s[16:19], s26 offen lds
    v_lshlrev_b32 v166, 16, v27
    v_and_b32 v167, 0xffff0000, v27
    v_lshlrev_b32 v168, 16, v28
    v_and_b32 v169, 0xffff0000, v28
    v_lshlrev_b32 v170, 16, v29
    v_and_b32 v171, 0xffff0000, v29
    v_lshlrev_b32 v172, 16, v30
    v_and_b32 v173, 0xffff0000, v30
    v_lshlrev_b32 v174, 16, v31
    v_and_b32 v175, 0xffff0000, v31
    v_pk_add_f32 v[160:161], v[160:161], v[154:155] op_sel_hi:[1,0] neg_lo:[0,1] neg_hi:[0,1]
    v_pk_add_f32 v[162:163], v[162:163], v[154:155] op_sel_hi:[1,0] neg_lo:[0,1] neg_hi:[0,1]
    v_pk_add_f32 v[164:165], v[164:165], v[154:155] op_sel_hi:[1,0] neg_lo:[0,1] neg_hi:[0,1]
    v_pk_add_f32 v[166:167], v[166:167], v[154:155] op_sel_hi:[1,0] neg_lo:[0,1] neg_hi:[0,1]
    v_pk_add_f32 v[168:169], v[168:169], v[154:155] op_sel_hi:[1,0] neg_lo:[0,1] neg_hi:[0,1]
    v_pk_add_f32 v[170:171], v[170:171], v[154:155] op_sel_hi:[1,0] neg_lo:[0,1] neg_hi:[0,1]
    v_pk_add_f32 v[172:173], v[172:173], v[154:155] op_sel_hi:[1,0] neg_lo:[0,1] neg_hi:[0,1]
    v_pk_add_f32 v[174:175], v[174:175], v[154:155] op_sel_hi:[1,0] neg_lo:[0,1] neg_hi:[0,1]
    v_cvt_pk_bf16_f32 v24, v160, v161
    v_cvt_pk_bf16_f32 v25, v162, v163
    v_cvt_pk_bf16_f32 v26, v164, v165
    v_cvt_pk_bf16_f32 v27, v166, v167
    v_cvt_pk_bf16_f32 v28, v168, v169
    v_cvt_pk_bf16_f32 v29, v170, v171
    v_cvt_pk_bf16_f32 v30, v172, v173
    v_cvt_pk_bf16_f32 v31, v174, v175
    v_lshlrev_b32 v160, 16, v24
    v_and_b32 v161, 0xffff0000, v24
    v_lshlrev_b32 v162, 16, v25
    v_and_b32 v163, 0xffff0000, v25
    v_lshlrev_b32 v164, 16, v26
    v_and_b32 v165, 0xffff0000, v26
    v_lshlrev_b32 v166, 16, v27
    v_and_b32 v167, 0xffff0000, v27
    v_lshlrev_b32 v168, 16, v28
    v_and_b32 v169, 0xffff0000, v28
    v_lshlrev_b32 v170, 16, v29
    v_and_b32 v171, 0xffff0000, v29
    v_lshlrev_b32 v172, 16, v30
    v_and_b32 v173, 0xffff0000, v30
    v_lshlrev_b32 v174, 16, v31
    v_and_b32 v175, 0xffff0000, v31
    v_pk_mul_f32 v[160:161], v[160:161], v[152:153] op_sel_hi:[1,0]
    v_pk_mul_f32 v[162:163], v[162:163], v[152:153] op_sel_hi:[1,0]
    v_pk_mul_f32 v[164:165], v[164:165], v[152:153] op_sel_hi:[1,0]
    v_pk_mul_f32 v[166:167], v[166:167], v[152:153] op_sel_hi:[1,0]
    v_pk_mul_f32 v[168:169], v[168:169], v[152:153] op_sel_hi:[1,0]
    v_pk_mul_f32 v[170:171], v[170:171], v[152:153] op_sel_hi:[1,0]
    v_pk_mul_f32 v[172:173], v[172:173], v[152:153] op_sel_hi:[1,0]
    v_pk_mul_f32 v[174:175], v[174:175], v[152:153] op_sel_hi:[1,0]
    s_add_u32 s26, s24, 0xc0000
    s_add_u32 m0, s29, 0x6000
    s_nop 0
    buffer_load_dwordx4 v136, s[16:19], s26 offen lds
    v_cvt_pk_bf16_f32 v160, v160, v161
    v_cvt_pk_bf16_f32 v162, v162, v163
    v_cvt_pk_bf16_f32 v164, v164, v165
    v_cvt_pk_bf16_f32 v166, v166, v167
    v_cvt_pk_bf16_f32 v168, v168, v169
    v_cvt_pk_bf16_f32 v170, v170, v171
    v_cvt_pk_bf16_f32 v172, v172, v173
    v_cvt_pk_bf16_f32 v174, v174, v175
    v_accvgpr_write_b32 a24, v160
    v_accvgpr_write_b32 a25, v162
    v_accvgpr_write_b32 a26, v164
    v_accvgpr_write_b32 a27, v166
    v_accvgpr_write_b32 a28, v168
    v_accvgpr_write_b32 a29, v170
    v_accvgpr_write_b32 a30, v172
    v_accvgpr_write_b32 a31, v174
    v_lshlrev_b32 v160, 16, v32
    v_and_b32 v161, 0xffff0000, v32
    v_lshlrev_b32 v162, 16, v33
    v_and_b32 v163, 0xffff0000, v33
    v_lshlrev_b32 v164, 16, v34
    v_and_b32 v165, 0xffff0000, v34
    v_lshlrev_b32 v166, 16, v35
    v_and_b32 v167, 0xffff0000, v35
    v_lshlrev_b32 v168, 16, v36
    v_and_b32 v169, 0xffff0000, v36
    v_lshlrev_b32 v170, 16, v37
    v_and_b32 v171, 0xffff0000, v37
    v_lshlrev_b32 v172, 16, v38
    v_and_b32 v173, 0xffff0000, v38
    v_lshlrev_b32 v174, 16, v39
    v_and_b32 v175, 0xffff0000, v39
    v_pk_add_f32 v[160:161], v[160:161], v[154:155] op_sel_hi:[1,0] neg_lo:[0,1] neg_hi:[0,1]
    v_pk_add_f32 v[162:163], v[162:163], v[154:155] op_sel_hi:[1,0] neg_lo:[0,1] neg_hi:[0,1]
    v_pk_add_f32 v[164:165], v[164:165], v[154:155] op_sel_hi:[1,0] neg_lo:[0,1] neg_hi:[0,1]
    v_pk_add_f32 v[166:167], v[166:167], v[154:155] op_sel_hi:[1,0] neg_lo:[0,1] neg_hi:[0,1]
    v_pk_add_f32 v[168:169], v[168:169], v[154:155] op_sel_hi:[1,0] neg_lo:[0,1] neg_hi:[0,1]
    v_pk_add_f32 v[170:171], v[170:171], v[154:155] op_sel_hi:[1,0] neg_lo:[0,1] neg_hi:[0,1]
    v_pk_add_f32 v[172:173], v[172:173], v[154:155] op_sel_hi:[1,0] neg_lo:[0,1] neg_hi:[0,1]
    v_pk_add_f32 v[174:175], v[174:175], v[154:155] op_sel_hi:[1,0] neg_lo:[0,1] neg_hi:[0,1]
    v_cvt_pk_bf16_f32 v32, v160, v161
    v_cvt_pk_bf16_f32 v33, v162, v163
    v_cvt_pk_bf16_f32 v34, v164, v165
    v_cvt_pk_bf16_f32 v35, v166, v167
    v_cvt_pk_bf16_f32 v36, v168, v169
    v_cvt_pk_bf16_f32 v37, v170, v171
    v_cvt_pk_bf16_f32 v38, v172, v173
    v_cvt_pk_bf16_f32 v39, v174, v175
    v_lshlrev_b32 v160, 16, v32
    v_and_b32 v161, 0xffff0000, v32
    s_add_u32 s26, s24, 0xe0000
    s_add_u32 m0, s29, 0x7000
    s_nop 0
    buffer_load_dwordx4 v136, s[16:19], s26 offen lds
    v_lshlrev_b32 v162, 16, v33
    v_and_b32 v163, 0xffff0000, v33
    v_lshlrev_b32 v164, 16, v34
    v_and_b32 v165, 0xffff0000, v34
    v_lshlrev_b32 v166, 16, v35
    v_and_b32 v167, 0xffff0000, v35
    v_lshlrev_b32 v168, 16, v36
    v_and_b32 v169, 0xffff0000, v36
    v_lshlrev_b32 v170, 16, v37
    v_and_b32 v171, 0xffff0000, v37
    v_lshlrev_b32 v172, 16, v38
    v_and_b32 v173, 0xffff0000, v38
    v_lshlrev_b32 v174, 16, v39
    v_and_b32 v175, 0xffff0000, v39
    v_pk_mul_f32 v[160:161], v[160:161], v[152:153] op_sel_hi:[1,0]
    v_pk_mul_f32 v[162:163], v[162:163], v[152:153] op_sel_hi:[1,0]
    v_pk_mul_f32 v[164:165], v[164:165], v[152:153] op_sel_hi:[1,0]
    v_pk_mul_f32 v[166:167], v[166:167], v[152:153] op_sel_hi:[1,0]
    v_pk_mul_f32 v[168:169], v[168:169], v[152:153] op_sel_hi:[1,0]
    v_pk_mul_f32 v[170:171], v[170:171], v[152:153] op_sel_hi:[1,0]
    v_pk_mul_f32 v[172:173], v[172:173], v[152:153] op_sel_hi:[1,0]
    v_pk_mul_f32 v[174:175], v[174:175], v[152:153] op_sel_hi:[1,0]
    v_cvt_pk_bf16_f32 v160, v160, v161
    v_cvt_pk_bf16_f32 v162, v162, v163
    v_cvt_pk_bf16_f32 v164, v164, v165
    v_cvt_pk_bf16_f32 v166, v166, v167
    v_cvt_pk_bf16_f32 v168, v168, v169
    v_cvt_pk_bf16_f32 v170, v170, v171
    v_cvt_pk_bf16_f32 v172, v172, v173
    v_cvt_pk_bf16_f32 v174, v174, v175
    v_accvgpr_write_b32 a32, v160
    v_accvgpr_write_b32 a33, v162
    v_accvgpr_write_b32 a34, v164
    v_accvgpr_write_b32 a35, v166
    v_accvgpr_write_b32 a36, v168
    v_accvgpr_write_b32 a37, v170
    v_accvgpr_write_b32 a38, v172
    v_accvgpr_write_b32 a39, v174
    v_lshlrev_b32 v160, 16, v40
    v_and_b32 v161, 0xffff0000, v40
    v_lshlrev_b32 v162, 16, v41
    v_and_b32 v163, 0xffff0000, v41
    v_lshlrev_b32 v164, 16, v42
    v_and_b32 v165, 0xffff0000, v42
    v_lshlrev_b32 v166, 16, v43
    v_and_b32 v167, 0xffff0000, v43
    v_lshlrev_b32 v168, 16, v44
    v_and_b32 v169, 0xffff0000, v44
    v_lshlrev_b32 v170, 16, v45
    v_and_b32 v171, 0xffff0000, v45
    s_add_u32 s26, s24, 0x100000
    s_add_u32 m0, s29, 0x8000
    s_nop 0
    buffer_load_dwordx4 v136, s[16:19], s26 offen lds
    v_lshlrev_b32 v172, 16, v46
    v_and_b32 v173, 0xffff0000, v46
    v_lshlrev_b32 v174, 16, v47
    v_and_b32 v175, 0xffff0000, v47
    v_pk_add_f32 v[160:161], v[160:161], v[154:155] op_sel_hi:[1,0] neg_lo:[0,1] neg_hi:[0,1]
    v_pk_add_f32 v[162:163], v[162:163], v[154:155] op_sel_hi:[1,0] neg_lo:[0,1] neg_hi:[0,1]
    v_pk_add_f32 v[164:165], v[164:165], v[154:155] op_sel_hi:[1,0] neg_lo:[0,1] neg_hi:[0,1]
    v_pk_add_f32 v[166:167], v[166:167], v[154:155] op_sel_hi:[1,0] neg_lo:[0,1] neg_hi:[0,1]
    v_pk_add_f32 v[168:169], v[168:169], v[154:155] op_sel_hi:[1,0] neg_lo:[0,1] neg_hi:[0,1]
    v_pk_add_f32 v[170:171], v[170:171], v[154:155] op_sel_hi:[1,0] neg_lo:[0,1] neg_hi:[0,1]
    v_pk_add_f32 v[172:173], v[172:173], v[154:155] op_sel_hi:[1,0] neg_lo:[0,1] neg_hi:[0,1]
    v_pk_add_f32 v[174:175], v[174:175], v[154:155] op_sel_hi:[1,0] neg_lo:[0,1] neg_hi:[0,1]
    v_cvt_pk_bf16_f32 v40, v160, v161
    v_cvt_pk_bf16_f32 v41, v162, v163
    v_cvt_pk_bf16_f32 v42, v164, v165
    v_cvt_pk_bf16_f32 v43, v166, v167
    v_cvt_pk_bf16_f32 v44, v168, v169
    v_cvt_pk_bf16_f32 v45, v170, v171
    v_cvt_pk_bf16_f32 v46, v172, v173
    v_cvt_pk_bf16_f32 v47, v174, v175
    v_lshlrev_b32 v160, 16, v40
    v_and_b32 v161, 0xffff0000, v40
    v_lshlrev_b32 v162, 16, v41
    v_and_b32 v163, 0xffff0000, v41
    v_lshlrev_b32 v164, 16, v42
    v_and_b32 v165, 0xffff0000, v42
    v_lshlrev_b32 v166, 16, v43
    v_and_b32 v167, 0xffff0000, v43
    v_lshlrev_b32 v168, 16, v44
    v_and_b32 v169, 0xffff0000, v44
    v_lshlrev_b32 v170, 16, v45
    v_and_b32 v171, 0xffff0000, v45
    v_lshlrev_b32 v172, 16, v46
    v_and_b32 v173, 0xffff0000, v46
    v_lshlrev_b32 v174, 16, v47
    v_and_b32 v175, 0xffff0000, v47
    v_pk_mul_f32 v[160:161], v[160:161], v[152:153] op_sel_hi:[1,0]
    v_pk_mul_f32 v[162:163], v[162:163], v[152:153] op_sel_hi:[1,0]
    v_pk_mul_f32 v[164:165], v[164:165], v[152:153] op_sel_hi:[1,0]
    v_pk_mul_f32 v[166:167], v[166:167], v[152:153] op_sel_hi:[1,0]
    v_pk_mul_f32 v[168:169], v[168:169], v[152:153] op_sel_hi:[1,0]
    v_pk_mul_f32 v[170:171], v[170:171], v[152:153] op_sel_hi:[1,0]
    v_pk_mul_f32 v[172:173], v[172:173], v[152:153] op_sel_hi:[1,0]
    v_pk_mul_f32 v[174:175], v[174:175], v[152:153] op_sel_hi:[1,0]
    v_cvt_pk_bf16_f32 v160, v160, v161
    v_cvt_pk_bf16_f32 v162, v162, v163
    v_cvt_pk_bf16_f32 v164, v164, v165
    v_cvt_pk_bf16_f32 v166, v166, v167
    v_cvt_pk_bf16_f32 v168, v168, v169
    v_cvt_pk_bf16_f32 v170, v170, v171
    s_add_u32 s26, s24, 0x120000
    s_add_u32 m0, s29, 0x9000
    s_nop 0
    buffer_load_dwordx4 v136, s[16:19], s26 offen lds
    v_cvt_pk_bf16_f32 v172, v172, v173
    v_cvt_pk_bf16_f32 v174, v174, v175
    v_accvgpr_write_b32 a40, v160
    v_accvgpr_write_b32 a41, v162
    v_accvgpr_write_b32 a42, v164
    v_accvgpr_write_b32 a43, v166
    v_accvgpr_write_b32 a44, v168
    v_accvgpr_write_b32 a45, v170
    v_accvgpr_write_b32 a46, v172
    v_accvgpr_write_b32 a47, v174
    v_lshlrev_b32 v160, 16, v48
    v_and_b32 v161, 0xffff0000, v48
    v_lshlrev_b32 v162, 16, v49
    v_and_b32 v163, 0xffff0000, v49
    v_lshlrev_b32 v164, 16, v50
    v_and_b32 v165, 0xffff0000, v50
    v_lshlrev_b32 v166, 16, v51
    v_and_b32 v167, 0xffff0000, v51
    v_lshlrev_b32 v168, 16, v52
    v_and_b32 v169, 0xffff0000, v52
    v_lshlrev_b32 v170, 16, v53
    v_and_b32 v171, 0xffff0000, v53
    v_lshlrev_b32 v172, 16, v54
    v_and_b32 v173, 0xffff0000, v54
    v_lshlrev_b32 v174, 16, v55
    v_and_b32 v175, 0xffff0000, v55
    v_pk_add_f32 v[160:161], v[160:161], v[154:155] op_sel_hi:[1,0] neg_lo:[0,1] neg_hi:[0,1]
    v_pk_add_f32 v[162:163], v[162:163], v[154:155] op_sel_hi:[1,0] neg_lo:[0,1] neg_hi:[0,1]
    v_pk_add_f32 v[164:165], v[164:165], v[154:155] op_sel_hi:[1,0] neg_lo:[0,1] neg_hi:[0,1]
    v_pk_add_f32 v[166:167], v[166:167], v[154:155] op_sel_hi:[1,0] neg_lo:[0,1] neg_hi:[0,1]
    v_pk_add_f32 v[168:169], v[168:169], v[154:155] op_sel_hi:[1,0] neg_lo:[0,1] neg_hi:[0,1]
    v_pk_add_f32 v[170:171], v[170:171], v[154:155] op_sel_hi:[1,0] neg_lo:[0,1] neg_hi:[0,1]
    v_pk_add_f32 v[172:173], v[172:173], v[154:155] op_sel_hi:[1,0] neg_lo:[0,1] neg_hi:[0,1]
    v_pk_add_f32 v[174:175], v[174:175], v[154:155] op_sel_hi:[1,0] neg_lo:[0,1] neg_hi:[0,1]
    v_cvt_pk_bf16_f32 v48, v160, v161
    v_cvt_pk_bf16_f32 v49, v162, v163
    v_cvt_pk_bf16_f32 v50, v164, v165
    v_cvt_pk_bf16_f32 v51, v166, v167
    v_cvt_pk_bf16_f32 v52, v168, v169
    v_cvt_pk_bf16_f32 v53, v170, v171
    v_cvt_pk_bf16_f32 v54, v172, v173
    v_cvt_pk_bf16_f32 v55, v174, v175
    v_lshlrev_b32 v160, 16, v48
    v_and_b32 v161, 0xffff0000, v48
    v_lshlrev_b32 v162, 16, v49
    v_and_b32 v163, 0xffff0000, v49
    v_lshlrev_b32 v164, 16, v50
    v_and_b32 v165, 0xffff0000, v50
    v_lshlrev_b32 v166, 16, v51
    v_and_b32 v167, 0xffff0000, v51
    s_add_u32 s26, s24, 0x140000
    s_add_u32 m0, s29, 0xa000
    s_nop 0
    buffer_load_dwordx4 v136, s[16:19], s26 offen lds
    v_lshlrev_b32 v168, 16, v52
    v_and_b32 v169, 0xffff0000, v52
    v_lshlrev_b32 v170, 16, v53
    v_and_b32 v171, 0xffff0000, v53
    v_lshlrev_b32 v172, 16, v54
    v_and_b32 v173, 0xffff0000, v54
    v_lshlrev_b32 v174, 16, v55
    v_and_b32 v175, 0xffff0000, v55
    v_pk_mul_f32 v[160:161], v[160:161], v[152:153] op_sel_hi:[1,0]
    v_pk_mul_f32 v[162:163], v[162:163], v[152:153] op_sel_hi:[1,0]
    v_pk_mul_f32 v[164:165], v[164:165], v[152:153] op_sel_hi:[1,0]
    v_pk_mul_f32 v[166:167], v[166:167], v[152:153] op_sel_hi:[1,0]
    v_pk_mul_f32 v[168:169], v[168:169], v[152:153] op_sel_hi:[1,0]
    v_pk_mul_f32 v[170:171], v[170:171], v[152:153] op_sel_hi:[1,0]
    v_pk_mul_f32 v[172:173], v[172:173], v[152:153] op_sel_hi:[1,0]
    v_pk_mul_f32 v[174:175], v[174:175], v[152:153] op_sel_hi:[1,0]
    v_cvt_pk_bf16_f32 v160, v160, v161
    v_cvt_pk_bf16_f32 v162, v162, v163
    v_cvt_pk_bf16_f32 v164, v164, v165
    v_cvt_pk_bf16_f32 v166, v166, v167
    v_cvt_pk_bf16_f32 v168, v168, v169
    v_cvt_pk_bf16_f32 v170, v170, v171
    v_cvt_pk_bf16_f32 v172, v172, v173
    v_cvt_pk_bf16_f32 v174, v174, v175
    v_accvgpr_write_b32 a48, v160
    v_accvgpr_write_b32 a49, v162
    v_accvgpr_write_b32 a50, v164
    v_accvgpr_write_b32 a51, v166
    v_accvgpr_write_b32 a52, v168
    v_accvgpr_write_b32 a53, v170
    v_accvgpr_write_b32 a54, v172
    v_accvgpr_write_b32 a55, v174
    v_lshlrev_b32 v160, 16, v56
    v_and_b32 v161, 0xffff0000, v56
    v_lshlrev_b32 v162, 16, v57
    v_and_b32 v163, 0xffff0000, v57
    v_lshlrev_b32 v164, 16, v58
    v_and_b32 v165, 0xffff0000, v58
    v_lshlrev_b32 v166, 16, v59
    v_and_b32 v167, 0xffff0000, v59
    v_lshlrev_b32 v168, 16, v60
    v_and_b32 v169, 0xffff0000, v60
    v_lshlrev_b32 v170, 16, v61
    v_and_b32 v171, 0xffff0000, v61
    v_lshlrev_b32 v172, 16, v62
    v_and_b32 v173, 0xffff0000, v62
    v_lshlrev_b32 v174, 16, v63
    v_and_b32 v175, 0xffff0000, v63
    v_pk_add_f32 v[160:161], v[160:161], v[154:155] op_sel_hi:[1,0] neg_lo:[0,1] neg_hi:[0,1]
    v_pk_add_f32 v[162:163], v[162:163], v[154:155] op_sel_hi:[1,0] neg_lo:[0,1] neg_hi:[0,1]
    s_add_u32 s26, s24, 0x160000
    s_add_u32 m0, s29, 0xb000
    s_nop 0
    buffer_load_dwordx4 v136, s[16:19], s26 offen lds
    v_pk_add_f32 v[164:165], v[164:165], v[154:155] op_sel_hi:[1,0] neg_lo:[0,1] neg_hi:[0,1]
    v_pk_add_f32 v[166:167], v[166:167], v[154:155] op_sel_hi:[1,0] neg_lo:[0,1] neg_hi:[0,1]
    v_pk_add_f32 v[168:169], v[168:169], v[154:155] op_sel_hi:[1,0] neg_lo:[0,1] neg_hi:[0,1]
    v_pk_add_f32 v[170:171], v[170:171], v[154:155] op_sel_hi:[1,0] neg_lo:[0,1] neg_hi:[0,1]
    v_pk_add_f32 v[172:173], v[172:173], v[154:155] op_sel_hi:[1,0] neg_lo:[0,1] neg_hi:[0,1]
    v_pk_add_f32 v[174:175], v[174:175], v[154:155] op_sel_hi:[1,0] neg_lo:[0,1] neg_hi:[0,1]
    v_cvt_pk_bf16_f32 v56, v160, v161
    v_cvt_pk_bf16_f32 v57, v162, v163
    v_cvt_pk_bf16_f32 v58, v164, v165
    v_cvt_pk_bf16_f32 v59, v166, v167
    v_cvt_pk_bf16_f32 v60, v168, v169
    v_cvt_pk_bf16_f32 v61, v170, v171
    v_cvt_pk_bf16_f32 v62, v172, v173
    v_cvt_pk_bf16_f32 v63, v174, v175
    v_lshlrev_b32 v160, 16, v56
    v_and_b32 v161, 0xffff0000, v56
    v_lshlrev_b32 v162, 16, v57
    v_and_b32 v163, 0xffff0000, v57
    v_lshlrev_b32 v164, 16, v58
    v_and_b32 v165, 0xffff0000, v58
    v_lshlrev_b32 v166, 16, v59
    v_and_b32 v167, 0xffff0000, v59
    v_lshlrev_b32 v168, 16, v60
    v_and_b32 v169, 0xffff0000, v60
    v_lshlrev_b32 v170, 16, v61
    v_and_b32 v171, 0xffff0000, v61
    v_lshlrev_b32 v172, 16, v62
    v_and_b32 v173, 0xffff0000, v62
    v_lshlrev_b32 v174, 16, v63
    v_and_b32 v175, 0xffff0000, v63
    v_pk_mul_f32 v[160:161], v[160:161], v[152:153] op_sel_hi:[1,0]
    v_pk_mul_f32 v[162:163], v[162:163], v[152:153] op_sel_hi:[1,0]
    v_pk_mul_f32 v[164:165], v[164:165], v[152:153] op_sel_hi:[1,0]
    v_pk_mul_f32 v[166:167], v[166:167], v[152:153] op_sel_hi:[1,0]
    v_pk_mul_f32 v[168:169], v[168:169], v[152:153] op_sel_hi:[1,0]
    v_pk_mul_f32 v[170:171], v[170:171], v[152:153] op_sel_hi:[1,0]
    v_pk_mul_f32 v[172:173], v[172:173], v[152:153] op_sel_hi:[1,0]
    v_pk_mul_f32 v[174:175], v[174:175], v[152:153] op_sel_hi:[1,0]
    v_cvt_pk_bf16_f32 v160, v160, v161
    v_cvt_pk_bf16_f32 v162, v162, v163
    v_cvt_pk_bf16_f32 v164, v164, v165
    v_cvt_pk_bf16_f32 v166, v166, v167
    v_cvt_pk_bf16_f32 v168, v168, v169
    v_cvt_pk_bf16_f32 v170, v170, v171
    v_cvt_pk_bf16_f32 v172, v172, v173
    v_cvt_pk_bf16_f32 v174, v174, v175
    v_accvgpr_write_b32 a56, v160
    v_accvgpr_write_b32 a57, v162
    v_accvgpr_write_b32 a58, v164
    v_accvgpr_write_b32 a59, v166
    s_add_u32 s26, s24, 0x180000
    s_add_u32 m0, s29, 0xc000
    s_nop 0
    buffer_load_dwordx4 v136, s[16:19], s26 offen lds
    v_accvgpr_write_b32 a60, v168
    v_accvgpr_write_b32 a61, v170
    v_accvgpr_write_b32 a62, v172
    v_accvgpr_write_b32 a63, v174
    s_waitcnt vmcnt(13)
    v_pk_mov_b32 v[150:151], 0, 0
    v_pk_mov_b32 v[152:153], 0, 0
    v_dot2_f32_bf16 v150, v64, v158, v150
    v_dot2_f32_bf16 v152, v64, v64, v152
    v_dot2_f32_bf16 v151, v65, v158, v151
    v_dot2_f32_bf16 v153, v65, v65, v153
    v_dot2_f32_bf16 v150, v66, v158, v150
    v_dot2_f32_bf16 v152, v66, v66, v152
    v_dot2_f32_bf16 v151, v67, v158, v151
    v_dot2_f32_bf16 v153, v67, v67, v153
    v_dot2_f32_bf16 v150, v68, v158, v150
    v_dot2_f32_bf16 v152, v68, v68, v152
    v_dot2_f32_bf16 v151, v69, v158, v151
    v_dot2_f32_bf16 v153, v69, v69, v153
    v_dot2_f32_bf16 v150, v70, v158, v150
    v_dot2_f32_bf16 v152, v70, v70, v152
    v_dot2_f32_bf16 v151, v71, v158, v151
    v_dot2_f32_bf16 v153, v71, v71, v153
    v_dot2_f32_bf16 v150, v72, v158, v150
    v_dot2_f32_bf16 v152, v72, v72, v152
    v_dot2_f32_bf16 v151, v73, v158, v151
    v_dot2_f32_bf16 v153, v73, v73, v153
    v_dot2_f32_bf16 v150, v74, v158, v150
    v_dot2_f32_bf16 v152, v74, v74, v152
    v_dot2_f32_bf16 v151, v75, v158, v151
    v_dot2_f32_bf16 v153, v75, v75, v153
    v_dot2_f32_bf16 v150, v76, v158, v150
    v_dot2_f32_bf16 v152, v76, v76, v152
    v_dot2_f32_bf16 v151, v77, v158, v151
    v_dot2_f32_bf16 v153, v77, v77, v153
    v_dot2_f32_bf16 v150, v78, v158, v150
    v_dot2_f32_bf16 v152, v78, v78, v152
    v_dot2_f32_bf16 v151, v79, v158, v151
    v_dot2_f32_bf16 v153, v79, v79, v153
    v_dot2_f32_bf16 v150, v80, v158, v150
    v_dot2_f32_bf16 v152, v80, v80, v152
    v_dot2_f32_bf16 v151, v81, v158, v151
    v_dot2_f32_bf16 v153, v81, v81, v153
    v_dot2_f32_bf16 v150, v82, v158, v150
    v_dot2_f32_bf16 v152, v82, v82, v152
    v_dot2_f32_bf16 v151, v83, v158, v151
    v_dot2_f32_bf16 v153, v83, v83, v153
    v_dot2_f32_bf16 v150, v84, v158, v150
    v_dot2_f32_bf16 v152, v84, v84, v152
    v_dot2_f32_bf16 v151, v85, v158, v151
    v_dot2_f32_bf16 v153, v85, v85, v153
    v_dot2_f32_bf16 v150, v86, v158, v150
    v_dot2_f32_bf16 v152, v86, v86, v152
    s_add_u32 s26, s24, 0x1a0000
    s_add_u32 m0, s29, 0xd000
    s_nop 0
    buffer_load_dwordx4 v136, s[16:19], s26 offen lds
    v_dot2_f32_bf16 v151, v87, v158, v151
    v_dot2_f32_bf16 v153, v87, v87, v153
    v_dot2_f32_bf16 v150, v88, v158, v150
    v_dot2_f32_bf16 v152, v88, v88, v152
    v_dot2_f32_bf16 v151, v89, v158, v151
    v_dot2_f32_bf16 v153, v89, v89, v153
    v_dot2_f32_bf16 v150, v90, v158, v150
    v_dot2_f32_bf16 v152, v90, v90, v152
    v_dot2_f32_bf16 v151, v91, v158, v151
    v_dot2_f32_bf16 v153, v91, v91, v153
    v_dot2_f32_bf16 v150, v92, v158, v150
    v_dot2_f32_bf16 v152, v92, v92, v152
    v_dot2_f32_bf16 v151, v93, v158, v151
    v_dot2_f32_bf16 v153, v93, v93, v153
    v_dot2_f32_bf16 v150, v94, v158, v150
    v_dot2_f32_bf16 v152, v94, v94, v152
    v_dot2_f32_bf16 v151, v95, v158, v151
    v_dot2_f32_bf16 v153, v95, v95, v153
    v_dot2_f32_bf16 v150, v96, v158, v150
    v_dot2_f32_bf16 v152, v96, v96, v152
    v_dot2_f32_bf16 v151, v97, v158, v151
    v_dot2_f32_bf16 v153, v97, v97, v153
    v_dot2_f32_bf16 v150, v98, v158, v150
    v_dot2_f32_bf16 v152, v98, v98, v152
    v_dot2_f32_bf16 v151, v99, v158, v151
    v_dot2_f32_bf16 v153, v99, v99, v153
    v_dot2_f32_bf16 v150, v100, v158, v150
    v_dot2_f32_bf16 v152, v100, v100, v152
    v_dot2_f32_bf16 v151, v101, v158, v151
    v_dot2_f32_bf16 v153, v101, v101, v153
    v_dot2_f32_bf16 v150, v102, v158, v150
    v_dot2_f32_bf16 v152, v102, v102, v152
    v_dot2_f32_bf16 v151, v103, v158, v151
    v_dot2_f32_bf16 v153, v103, v103, v153
    v_dot2_f32_bf16 v150, v104, v158, v150
    v_dot2_f32_bf16 v152, v104, v104, v152
    v_dot2_f32_bf16 v151, v105, v158, v151
    v_dot2_f32_bf16 v153, v105, v105, v153
    v_dot2_f32_bf16 v150, v106, v158, v150
    v_dot2_f32_bf16 v152, v106, v106, v152
    v_dot2_f32_bf16 v151, v107, v158, v151
    v_dot2_f32_bf16 v153, v107, v107, v153
    v_dot2_f32_bf16 v150, v108, v158, v150
    v_dot2_f32_bf16 v152, v108, v108, v152
    v_dot2_f32_bf16 v151, v109, v158, v151
    v_dot2_f32_bf16 v153, v109, v109, v153
    v_dot2_f32_bf16 v150, v110, v158, v150
    v_dot2_f32_bf16 v152, v110, v110, v152
    v_dot2_f32_bf16 v151, v111, v158, v151
    v_dot2_f32_bf16 v153, v111, v111, v153
    s_add_u32 s26, s24, 0x1c0000
    s_add_u32 m0, s29, 0xe000
    s_nop 0
    buffer_load_dwordx4 v136, s[16:19], s26 offen lds
    v_dot2_f32_bf16 v150, v112, v158, v150
    v_dot2_f32_bf16 v152, v112, v112, v152
    v_dot2_f32_bf16 v151, v113, v158, v151
    v_dot2_f32_bf16 v153, v113, v113, v153
    v_dot2_f32_bf16 v150, v114, v158, v150
    v_dot2_f32_bf16 v152, v114, v114, v152
    v_dot2_f32_bf16 v151, v115, v158, v151
    v_dot2_f32_bf16 v153, v115, v115, v153
    v_dot2_f32_bf16 v150, v116, v158, v150
    v_dot2_f32_bf16 v152, v116, v116, v152
    v_dot2_f32_bf16 v151, v117, v158, v151
    v_dot2_f32_bf16 v153, v117, v117, v153
    v_dot2_f32_bf16 v150, v118, v158, v150
    v_dot2_f32_bf16 v152, v118, v118, v152
    v_dot2_f32_bf16 v151, v119, v158, v151
    v_dot2_f32_bf16 v153, v119, v119, v153
    v_dot2_f32_bf16 v150, v120, v158, v150
    v_dot2_f32_bf16 v152, v120, v120, v152
    v_dot2_f32_bf16 v151, v121, v158, v151
    v_dot2_f32_bf16 v153, v121, v121, v153
    v_dot2_f32_bf16 v150, v122, v158, v150
    v_dot2_f32_bf16 v152, v122, v122, v152
    v_dot2_f32_bf16 v151, v123, v158, v151
    v_dot2_f32_bf16 v153, v123, v123, v153
    v_dot2_f32_bf16 v150, v124, v158, v150
    v_dot2_f32_bf16 v152, v124, v124, v152
    v_dot2_f32_bf16 v151, v125, v158, v151
    v_dot2_f32_bf16 v153, v125, v125, v153
    v_dot2_f32_bf16 v150, v126, v158, v150
    v_dot2_f32_bf16 v152, v126, v126, v152
    v_dot2_f32_bf16 v151, v127, v158, v151
    v_dot2_f32_bf16 v153, v127, v127, v153
    s_nop 1
    v_add_f32 v150, v150, v151
    v_add_f32 v152, v152, v153
    v_mov_b32 v157, v150
    s_nop 1
    v_permlane32_swap_b32 v157, v150
    v_add_f32 v150, v157, v150
    v_mov_b32 v157, v150
    s_nop 1
    v_permlane16_swap_b32 v157, v150
    v_add_f32 v150, v157, v150
    v_mov_b32 v157, v152
    s_nop 1
    v_permlane32_swap_b32 v157, v152
    v_add_f32 v152, v157, v152
    v_mov_b32 v157, v152
    s_nop 1
    v_permlane16_swap_b32 v157, v152
    v_add_f32 v152, v157, v152
    v_mul_f32 v150, 0x3b000000, v150
    v_cvt_pk_bf16_f32 v154, v150, v150
    v_and_b32 v154, 0xffff0000, v154
    v_sub_f32 v156, v150, v154
    v_mul_f32 v157, v150, v150
    v_mul_f32 v152, 0x3b000000, v152
    v_sub_f32 v152, v152, v157
    v_max_f32 v152, 0, v152
    v_cvt_pk_bf16_f32 v152, v152, v152
    v_and_b32 v152, 0xffff0000, v152
    v_add_f32 v152, 0x3727c5ac, v152
    v_cvt_pk_bf16_f32 v152, v152, v152
    v_and_b32 v152, 0xffff0000, v152
    v_sqrt_f32 v152, v152
    s_nop 0
    v_cvt_pk_bf16_f32 v152, v152, v152
    v_and_b32 v152, 0xffff0000, v152
    v_rcp_f32 v152, v152
    v_lshlrev_b32 v160, 16, v64
    v_and_b32 v161, 0xffff0000, v64
    v_lshlrev_b32 v162, 16, v65
    v_and_b32 v163, 0xffff0000, v65
    v_lshlrev_b32 v164, 16, v66
    v_and_b32 v165, 0xffff0000, v66
    v_lshlrev_b32 v166, 16, v67
    v_and_b32 v167, 0xffff0000, v67
    v_lshlrev_b32 v168, 16, v68
    v_and_b32 v169, 0xffff0000, v68
    v_lshlrev_b32 v170, 16, v69
    v_and_b32 v171, 0xffff0000, v69
    v_lshlrev_b32 v172, 16, v70
    v_and_b32 v173, 0xffff0000, v70
    v_lshlrev_b32 v174, 16, v71
    v_and_b32 v175, 0xffff0000, v71
    v_pk_add_f32 v[160:161], v[160:161], v[154:155] op_sel_hi:[1,0] neg_lo:[0,1] neg_hi:[0,1]
    v_pk_add_f32 v[162:163], v[162:163], v[154:155] op_sel_hi:[1,0] neg_lo:[0,1] neg_hi:[0,1]
    s_add_u32 s26, s24, 0x1e0000
    s_add_u32 m0, s29, 0xf000
    s_nop 0
    buffer_load_dwordx4 v136, s[16:19], s26 offen lds
    v_pk_add_f32 v[164:165], v[164:165], v[154:155] op_sel_hi:[1,0] neg_lo:[0,1] neg_hi:[0,1]
    v_pk_add_f32 v[166:167], v[166:167], v[154:155] op_sel_hi:[1,0] neg_lo:[0,1] neg_hi:[0,1]
    v_pk_add_f32 v[168:169], v[168:169], v[154:155] op_sel_hi:[1,0] neg_lo:[0,1] neg_hi:[0,1]
    v_pk_add_f32 v[170:171], v[170:171], v[154:155] op_sel_hi:[1,0] neg_lo:[0,1] neg_hi:[0,1]
    v_pk_add_f32 v[172:173], v[172:173], v[154:155] op_sel_hi:[1,0] neg_lo:[0,1] neg_hi:[0,1]
    v_pk_add_f32 v[174:175], v[174:175], v[154:155] op_sel_hi:[1,0] neg_lo:[0,1] neg_hi:[0,1]
    v_cvt_pk_bf16_f32 v64, v160, v161
    v_cvt_pk_bf16_f32 v65, v162, v163
    v_cvt_pk_bf16_f32 v66, v164, v165
    v_cvt_pk_bf16_f32 v67, v166, v167
    v_cvt_pk_bf16_f32 v68, v168, v169
    v_cvt_pk_bf16_f32 v69, v170, v171
    v_cvt_pk_bf16_f32 v70, v172, v173
    v_cvt_pk_bf16_f32 v71, v174, v175
    v_lshlrev_b32 v160, 16, v64
    v_and_b32 v161, 0xffff0000, v64
    v_lshlrev_b32 v162, 16, v65
    v_and_b32 v163, 0xffff0000, v65
    v_lshlrev_b32 v164, 16, v66
    v_and_b32 v165, 0xffff0000, v66
    v_lshlrev_b32 v166, 16, v67
    v_and_b32 v167, 0xffff0000, v67
    v_lshlrev_b32 v168, 16, v68
    v_and_b32 v169, 0xffff0000, v68
    v_lshlrev_b32 v170, 16, v69
    v_and_b32 v171, 0xffff0000, v69
    v_lshlrev_b32 v172, 16, v70
    v_and_b32 v173, 0xffff0000, v70
    v_lshlrev_b32 v174, 16, v71
    v_and_b32 v175, 0xffff0000, v71
    v_pk_mul_f32 v[160:161], v[160:161], v[152:153] op_sel_hi:[1,0]
    v_pk_mul_f32 v[162:163], v[162:163], v[152:153] op_sel_hi:[1,0]
    v_pk_mul_f32 v[164:165], v[164:165], v[152:153] op_sel_hi:[1,0]
    v_pk_mul_f32 v[166:167], v[166:167], v[152:153] op_sel_hi:[1,0]
    v_pk_mul_f32 v[168:169], v[168:169], v[152:153] op_sel_hi:[1,0]
    v_pk_mul_f32 v[170:171], v[170:171], v[152:153] op_sel_hi:[1,0]
    v_pk_mul_f32 v[172:173], v[172:173], v[152:153] op_sel_hi:[1,0]
    v_pk_mul_f32 v[174:175], v[174:175], v[152:153] op_sel_hi:[1,0]
    v_cvt_pk_bf16_f32 v160, v160, v161
    v_cvt_pk_bf16_f32 v162, v162, v163
    v_cvt_pk_bf16_f32 v164, v164, v165
    v_cvt_pk_bf16_f32 v166, v166, v167
    v_cvt_pk_bf16_f32 v168, v168, v169
    v_cvt_pk_bf16_f32 v170, v170, v171
    v_cvt_pk_bf16_f32 v172, v172, v173
    v_cvt_pk_bf16_f32 v174, v174, v175
    v_accvgpr_write_b32 a64, v160
    v_accvgpr_write_b32 a65, v162
    v_accvgpr_write_b32 a66, v164
    v_accvgpr_write_b32 a67, v166
    s_add_u32 s26, s24, 0x200000
    s_add_u32 m0, s29, 0x10000
    s_nop 0
    buffer_load_dwordx4 v136, s[16:19], s26 offen lds
    v_accvgpr_write_b32 a68, v168
    v_accvgpr_write_b32 a69, v170
    v_accvgpr_write_b32 a70, v172
    v_accvgpr_write_b32 a71, v174
    v_lshlrev_b32 v160, 16, v72
    v_and_b32 v161, 0xffff0000, v72
    v_lshlrev_b32 v162, 16, v73
    v_and_b32 v163, 0xffff0000, v73
    v_lshlrev_b32 v164, 16, v74
    v_and_b32 v165, 0xffff0000, v74
    v_lshlrev_b32 v166, 16, v75
    v_and_b32 v167, 0xffff0000, v75
    v_lshlrev_b32 v168, 16, v76
    v_and_b32 v169, 0xffff0000, v76
    v_lshlrev_b32 v170, 16, v77
    v_and_b32 v171, 0xffff0000, v77
    v_lshlrev_b32 v172, 16, v78
    v_and_b32 v173, 0xffff0000, v78
    v_lshlrev_b32 v174, 16, v79
    v_and_b32 v175, 0xffff0000, v79
    v_pk_add_f32 v[160:161], v[160:161], v[154:155] op_sel_hi:[1,0] neg_lo:[0,1] neg_hi:[0,1]
    v_pk_add_f32 v[162:163], v[162:163], v[154:155] op_sel_hi:[1,0] neg_lo:[0,1] neg_hi:[0,1]
    v_pk_add_f32 v[164:165], v[164:165], v[154:155] op_sel_hi:[1,0] neg_lo:[0,1] neg_hi:[0,1]
    v_pk_add_f32 v[166:167], v[166:167], v[154:155] op_sel_hi:[1,0] neg_lo:[0,1] neg_hi:[0,1]
    v_pk_add_f32 v[168:169], v[168:169], v[154:155] op_sel_hi:[1,0] neg_lo:[0,1] neg_hi:[0,1]
    v_pk_add_f32 v[170:171], v[170:171], v[154:155] op_sel_hi:[1,0] neg_lo:[0,1] neg_hi:[0,1]
    v_pk_add_f32 v[172:173], v[172:173], v[154:155] op_sel_hi:[1,0] neg_lo:[0,1] neg_hi:[0,1]
    v_pk_add_f32 v[174:175], v[174:175], v[154:155] op_sel_hi:[1,0] neg_lo:[0,1] neg_hi:[0,1]
    v_cvt_pk_bf16_f32 v72, v160, v161
    v_cvt_pk_bf16_f32 v73, v162, v163
    v_cvt_pk_bf16_f32 v74, v164, v165
    v_cvt_pk_bf16_f32 v75, v166, v167
    v_cvt_pk_bf16_f32 v76, v168, v169
    v_cvt_pk_bf16_f32 v77, v170, v171
    v_cvt_pk_bf16_f32 v78, v172, v173
    v_cvt_pk_bf16_f32 v79, v174, v175
    v_lshlrev_b32 v160, 16, v72
    v_and_b32 v161, 0xffff0000, v72
    v_lshlrev_b32 v162, 16, v73
    v_and_b32 v163, 0xffff0000, v73
    v_lshlrev_b32 v164, 16, v74
    v_and_b32 v165, 0xffff0000, v74
    v_lshlrev_b32 v166, 16, v75
    v_and_b32 v167, 0xffff0000, v75
    v_lshlrev_b32 v168, 16, v76
    v_and_b32 v169, 0xffff0000, v76
    v_lshlrev_b32 v170, 16, v77
    v_and_b32 v171, 0xffff0000, v77
    v_lshlrev_b32 v172, 16, v78
    v_and_b32 v173, 0xffff0000, v78
    s_add_u32 s26, s24, 0x220000
    s_add_u32 m0, s29, 0x11000
    s_nop 0
    buffer_load_dwordx4 v136, s[16:19], s26 offen lds
    v_lshlrev_b32 v174, 16, v79
    v_and_b32 v175, 0xffff0000, v79
    v_pk_mul_f32 v[160:161], v[160:161], v[152:153] op_sel_hi:[1,0]
    v_pk_mul_f32 v[162:163], v[162:163], v[152:153] op_sel_hi:[1,0]
    v_pk_mul_f32 v[164:165], v[164:165], v[152:153] op_sel_hi:[1,0]
    v_pk_mul_f32 v[166:167], v[166:167], v[152:153] op_sel_hi:[1,0]
    v_pk_mul_f32 v[168:169], v[168:169], v[152:153] op_sel_hi:[1,0]
    v_pk_mul_f32 v[170:171], v[170:171], v[152:153] op_sel_hi:[1,0]
    v_pk_mul_f32 v[172:173], v[172:173], v[152:153] op_sel_hi:[1,0]
    v_pk_mul_f32 v[174:175], v[174:175], v[152:153] op_sel_hi:[1,0]
    v_cvt_pk_bf16_f32 v160, v160, v161
    v_cvt_pk_bf16_f32 v162, v162, v163
    v_cvt_pk_bf16_f32 v164, v164, v165
    v_cvt_pk_bf16_f32 v166, v166, v167
    v_cvt_pk_bf16_f32 v168, v168, v169
    v_cvt_pk_bf16_f32 v170, v170, v171
    v_cvt_pk_bf16_f32 v172, v172, v173
    v_cvt_pk_bf16_f32 v174, v174, v175
    v_accvgpr_write_b32 a72, v160
    v_accvgpr_write_b32 a73, v162
    v_accvgpr_write_b32 a74, v164
    v_accvgpr_write_b32 a75, v166
    v_accvgpr_write_b32 a76, v168
    v_accvgpr_write_b32 a77, v170
    v_accvgpr_write_b32 a78, v172
    v_accvgpr_write_b32 a79, v174
    v_lshlrev_b32 v160, 16, v80
    v_and_b32 v161, 0xffff0000, v80
    v_lshlrev_b32 v162, 16, v81
    v_and_b32 v163, 0xffff0000, v81
    v_lshlrev_b32 v164, 16, v82
    v_and_b32 v165, 0xffff0000, v82
    v_lshlrev_b32 v166, 16, v83
    v_and_b32 v167, 0xffff0000, v83
    v_lshlrev_b32 v168, 16, v84
    v_and_b32 v169, 0xffff0000, v84
    v_lshlrev_b32 v170, 16, v85
    v_and_b32 v171, 0xffff0000, v85
    v_lshlrev_b32 v172, 16, v86
    v_and_b32 v173, 0xffff0000, v86
    v_lshlrev_b32 v174, 16, v87
    v_and_b32 v175, 0xffff0000, v87
    v_pk_add_f32 v[160:161], v[160:161], v[154:155] op_sel_hi:[1,0] neg_lo:[0,1] neg_hi:[0,1]
    v_pk_add_f32 v[162:163], v[162:163], v[154:155] op_sel_hi:[1,0] neg_lo:[0,1] neg_hi:[0,1]
    v_pk_add_f32 v[164:165], v[164:165], v[154:155] op_sel_hi:[1,0] neg_lo:[0,1] neg_hi:[0,1]
    v_pk_add_f32 v[166:167], v[166:167], v[154:155] op_sel_hi:[1,0] neg_lo:[0,1] neg_hi:[0,1]
    v_pk_add_f32 v[168:169], v[168:169], v[154:155] op_sel_hi:[1,0] neg_lo:[0,1] neg_hi:[0,1]
    v_pk_add_f32 v[170:171], v[170:171], v[154:155] op_sel_hi:[1,0] neg_lo:[0,1] neg_hi:[0,1]
    v_pk_add_f32 v[172:173], v[172:173], v[154:155] op_sel_hi:[1,0] neg_lo:[0,1] neg_hi:[0,1]
    v_pk_add_f32 v[174:175], v[174:175], v[154:155] op_sel_hi:[1,0] neg_lo:[0,1] neg_hi:[0,1]
    s_add_u32 s26, s24, 0x240000
    s_add_u32 m0, s29, 0x12000
    s_nop 0
    buffer_load_dwordx4 v136, s[16:19], s26 offen lds
    v_cvt_pk_bf16_f32 v80, v160, v161
    v_cvt_pk_bf16_f32 v81, v162, v163
    v_cvt_pk_bf16_f32 v82, v164, v165
    v_cvt_pk_bf16_f32 v83, v166, v167
    v_cvt_pk_bf16_f32 v84, v168, v169
    v_cvt_pk_bf16_f32 v85, v170, v171
    v_cvt_pk_bf16_f32 v86, v172, v173
    v_cvt_pk_bf16_f32 v87, v174, v175
    v_lshlrev_b32 v160, 16, v80
    v_and_b32 v161, 0xffff0000, v80
    v_lshlrev_b32 v162, 16, v81
    v_and_b32 v163, 0xffff0000, v81
    v_lshlrev_b32 v164, 16, v82
    v_and_b32 v165, 0xffff0000, v82
    v_lshlrev_b32 v166, 16, v83
    v_and_b32 v167, 0xffff0000, v83
    v_lshlrev_b32 v168, 16, v84
    v_and_b32 v169, 0xffff0000, v84
    v_lshlrev_b32 v170, 16, v85
    v_and_b32 v171, 0xffff0000, v85
    v_lshlrev_b32 v172, 16, v86
    v_and_b32 v173, 0xffff0000, v86
    v_lshlrev_b32 v174, 16, v87
    v_and_b32 v175, 0xffff0000, v87
    v_pk_mul_f32 v[160:161], v[160:161], v[152:153] op_sel_hi:[1,0]
    v_pk_mul_f32 v[162:163], v[162:163], v[152:153] op_sel_hi:[1,0]
    v_pk_mul_f32 v[164:165], v[164:165], v[152:153] op_sel_hi:[1,0]
    v_pk_mul_f32 v[166:167], v[166:167], v[152:153] op_sel_hi:[1,0]
    v_pk_mul_f32 v[168:169], v[168:169], v[152:153] op_sel_hi:[1,0]
    v_pk_mul_f32 v[170:171], v[170:171], v[152:153] op_sel_hi:[1,0]
    v_pk_mul_f32 v[172:173], v[172:173], v[152:153] op_sel_hi:[1,0]
    v_pk_mul_f32 v[174:175], v[174:175], v[152:153] op_sel_hi:[1,0]
    v_cvt_pk_bf16_f32 v160, v160, v161
    v_cvt_pk_bf16_f32 v162, v162, v163
    v_cvt_pk_bf16_f32 v164, v164, v165
    v_cvt_pk_bf16_f32 v166, v166, v167
    v_cvt_pk_bf16_f32 v168, v168, v169
    v_cvt_pk_bf16_f32 v170, v170, v171
    v_cvt_pk_bf16_f32 v172, v172, v173
    v_cvt_pk_bf16_f32 v174, v174, v175
    v_accvgpr_write_b32 a80, v160
    v_accvgpr_write_b32 a81, v162
    v_accvgpr_write_b32 a82, v164
    v_accvgpr_write_b32 a83, v166
    v_accvgpr_write_b32 a84, v168
    v_accvgpr_write_b32 a85, v170
    v_accvgpr_write_b32 a86, v172
    v_accvgpr_write_b32 a87, v174
    v_lshlrev_b32 v160, 16, v88
    v_and_b32 v161, 0xffff0000, v88
    s_add_u32 s26, s24, 0x260000
    s_add_u32 m0, s29, 0x13000
    s_nop 0
    buffer_load_dwordx4 v136, s[16:19], s26 offen lds
    v_lshlrev_b32 v162, 16, v89
    v_and_b32 v163, 0xffff0000, v89
    v_lshlrev_b32 v164, 16, v90
    v_and_b32 v165, 0xffff0000, v90
    v_lshlrev_b32 v166, 16, v91
    v_and_b32 v167, 0xffff0000, v91
    v_lshlrev_b32 v168, 16, v92
    v_and_b32 v169, 0xffff0000, v92
    v_lshlrev_b32 v170, 16, v93
    v_and_b32 v171, 0xffff0000, v93
    v_lshlrev_b32 v172, 16, v94
    v_and_b32 v173, 0xffff0000, v94
    v_lshlrev_b32 v174, 16, v95
    v_and_b32 v175, 0xffff0000, v95
    v_pk_add_f32 v[160:161], v[160:161], v[154:155] op_sel_hi:[1,0] neg_lo:[0,1] neg_hi:[0,1]
    v_pk_add_f32 v[162:163], v[162:163], v[154:155] op_sel_hi:[1,0] neg_lo:[0,1] neg_hi:[0,1]
    v_pk_add_f32 v[164:165], v[164:165], v[154:155] op_sel_hi:[1,0] neg_lo:[0,1] neg_hi:[0,1]
    v_pk_add_f32 v[166:167], v[166:167], v[154:155] op_sel_hi:[1,0] neg_lo:[0,1] neg_hi:[0,1]
    v_pk_add_f32 v[168:169], v[168:169], v[154:155] op_sel_hi:[1,0] neg_lo:[0,1] neg_hi:[0,1]
    v_pk_add_f32 v[170:171], v[170:171], v[154:155] op_sel_hi:[1,0] neg_lo:[0,1] neg_hi:[0,1]
    v_pk_add_f32 v[172:173], v[172:173], v[154:155] op_sel_hi:[1,0] neg_lo:[0,1] neg_hi:[0,1]
    v_pk_add_f32 v[174:175], v[174:175], v[154:155] op_sel_hi:[1,0] neg_lo:[0,1] neg_hi:[0,1]
    v_cvt_pk_bf16_f32 v88, v160, v161
    v_cvt_pk_bf16_f32 v89, v162, v163
    v_cvt_pk_bf16_f32 v90, v164, v165
    v_cvt_pk_bf16_f32 v91, v166, v167
    v_cvt_pk_bf16_f32 v92, v168, v169
    v_cvt_pk_bf16_f32 v93, v170, v171
    v_cvt_pk_bf16_f32 v94, v172, v173
    v_cvt_pk_bf16_f32 v95, v174, v175
    v_lshlrev_b32 v160, 16, v88
    v_and_b32 v161, 0xffff0000, v88
    v_lshlrev_b32 v162, 16, v89
    v_and_b32 v163, 0xffff0000, v89
    v_lshlrev_b32 v164, 16, v90
    v_and_b32 v165, 0xffff0000, v90
    v_lshlrev_b32 v166, 16, v91
    v_and_b32 v167, 0xffff0000, v91
    v_lshlrev_b32 v168, 16, v92
    v_and_b32 v169, 0xffff0000, v92
    v_lshlrev_b32 v170, 16, v93
    v_and_b32 v171, 0xffff0000, v93
    v_lshlrev_b32 v172, 16, v94
    v_and_b32 v173, 0xffff0000, v94
    v_lshlrev_b32 v174, 16, v95
    v_and_b32 v175, 0xffff0000, v95
    v_pk_mul_f32 v[160:161], v[160:161], v[152:153] op_sel_hi:[1,0]
    v_pk_mul_f32 v[162:163], v[162:163], v[152:153] op_sel_hi:[1,0]
    v_pk_mul_f32 v[164:165], v[164:165], v[152:153] op_sel_hi:[1,0]
    v_pk_mul_f32 v[166:167], v[166:167], v[152:153] op_sel_hi:[1,0]
    s_add_u32 s26, s24, 0x280000
    s_add_u32 m0, s29, 0x14000
    s_nop 0
    buffer_load_dwordx4 v136, s[16:19], s26 offen lds
    v_pk_mul_f32 v[168:169], v[168:169], v[152:153] op_sel_hi:[1,0]
    v_pk_mul_f32 v[170:171], v[170:171], v[152:153] op_sel_hi:[1,0]
    v_pk_mul_f32 v[172:173], v[172:173], v[152:153] op_sel_hi:[1,0]
    v_pk_mul_f32 v[174:175], v[174:175], v[152:153] op_sel_hi:[1,0]
    v_cvt_pk_bf16_f32 v160, v160, v161
    v_cvt_pk_bf16_f32 v162, v162, v163
    v_cvt_pk_bf16_f32 v164, v164, v165
    v_cvt_pk_bf16_f32 v166, v166, v167
    v_cvt_pk_bf16_f32 v168, v168, v169
    v_cvt_pk_bf16_f32 v170, v170, v171
    v_cvt_pk_bf16_f32 v172, v172, v173
    v_cvt_pk_bf16_f32 v174, v174, v175
    v_accvgpr_write_b32 a88, v160
    v_accvgpr_write_b32 a89, v162
    v_accvgpr_write_b32 a90, v164
    v_accvgpr_write_b32 a91, v166
    v_accvgpr_write_b32 a92, v168
    v_accvgpr_write_b32 a93, v170
    v_accvgpr_write_b32 a94, v172
    v_accvgpr_write_b32 a95, v174
    v_lshlrev_b32 v160, 16, v96
    v_and_b32 v161, 0xffff0000, v96
    v_lshlrev_b32 v162, 16, v97
    v_and_b32 v163, 0xffff0000, v97
    v_lshlrev_b32 v164, 16, v98
    v_and_b32 v165, 0xffff0000, v98
    v_lshlrev_b32 v166, 16, v99
    v_and_b32 v167, 0xffff0000, v99
    v_lshlrev_b32 v168, 16, v100
    v_and_b32 v169, 0xffff0000, v100
    v_lshlrev_b32 v170, 16, v101
    v_and_b32 v171, 0xffff0000, v101
    v_lshlrev_b32 v172, 16, v102
    v_and_b32 v173, 0xffff0000, v102
    v_lshlrev_b32 v174, 16, v103
    v_and_b32 v175, 0xffff0000, v103
    v_pk_add_f32 v[160:161], v[160:161], v[154:155] op_sel_hi:[1,0] neg_lo:[0,1] neg_hi:[0,1]
    v_pk_add_f32 v[162:163], v[162:163], v[154:155] op_sel_hi:[1,0] neg_lo:[0,1] neg_hi:[0,1]
    v_pk_add_f32 v[164:165], v[164:165], v[154:155] op_sel_hi:[1,0] neg_lo:[0,1] neg_hi:[0,1]
    v_pk_add_f32 v[166:167], v[166:167], v[154:155] op_sel_hi:[1,0] neg_lo:[0,1] neg_hi:[0,1]
    v_pk_add_f32 v[168:169], v[168:169], v[154:155] op_sel_hi:[1,0] neg_lo:[0,1] neg_hi:[0,1]
    v_pk_add_f32 v[170:171], v[170:171], v[154:155] op_sel_hi:[1,0] neg_lo:[0,1] neg_hi:[0,1]
    v_pk_add_f32 v[172:173], v[172:173], v[154:155] op_sel_hi:[1,0] neg_lo:[0,1] neg_hi:[0,1]
    v_pk_add_f32 v[174:175], v[174:175], v[154:155] op_sel_hi:[1,0] neg_lo:[0,1] neg_hi:[0,1]
    v_cvt_pk_bf16_f32 v96, v160, v161
    v_cvt_pk_bf16_f32 v97, v162, v163
    v_cvt_pk_bf16_f32 v98, v164, v165
    v_cvt_pk_bf16_f32 v99, v166, v167
    v_cvt_pk_bf16_f32 v100, v168, v169
    v_cvt_pk_bf16_f32 v101, v170, v171
    s_add_u32 s26, s24, 0x2a0000
    s_add_u32 m0, s29, 0x15000
    s_nop 0
    buffer_load_dwordx4 v136, s[16:19], s26 offen lds
    v_cvt_pk_bf16_f32 v102, v172, v173
    v_cvt_pk_bf16_f32 v103, v174, v175
    v_lshlrev_b32 v160, 16, v96
    v_and_b32 v161, 0xffff0000, v96
    v_lshlrev_b32 v162, 16, v97
    v_and_b32 v163, 0xffff0000, v97
    v_lshlrev_b32 v164, 16, v98
    v_and_b32 v165, 0xffff0000, v98
    v_lshlrev_b32 v166, 16, v99
    v_and_b32 v167, 0xffff0000, v99
    v_lshlrev_b32 v168, 16, v100
    v_and_b32 v169, 0xffff0000, v100
    v_lshlrev_b32 v170, 16, v101
    v_and_b32 v171, 0xffff0000, v101
    v_lshlrev_b32 v172, 16, v102
    v_and_b32 v173, 0xffff0000, v102
    v_lshlrev_b32 v174, 16, v103
    v_and_b32 v175, 0xffff0000, v103
    v_pk_mul_f32 v[160:161], v[160:161], v[152:153] op_sel_hi:[1,0]
    v_pk_mul_f32 v[162:163], v[162:163], v[152:153] op_sel_hi:[1,0]
    v_pk_mul_f32 v[164:165], v[164:165], v[152:153] op_sel_hi:[1,0]
    v_pk_mul_f32 v[166:167], v[166:167], v[152:153] op_sel_hi:[1,0]
    v_pk_mul_f32 v[168:169], v[168:169], v[152:153] op_sel_hi:[1,0]
    v_pk_mul_f32 v[170:171], v[170:171], v[152:153] op_sel_hi:[1,0]
    v_pk_mul_f32 v[172:173], v[172:173], v[152:153] op_sel_hi:[1,0]
    v_pk_mul_f32 v[174:175], v[174:175], v[152:153] op_sel_hi:[1,0]
    v_cvt_pk_bf16_f32 v160, v160, v161
    v_cvt_pk_bf16_f32 v162, v162, v163
    v_cvt_pk_bf16_f32 v164, v164, v165
    v_cvt_pk_bf16_f32 v166, v166, v167
    v_cvt_pk_bf16_f32 v168, v168, v169
    v_cvt_pk_bf16_f32 v170, v170, v171
    v_cvt_pk_bf16_f32 v172, v172, v173
    v_cvt_pk_bf16_f32 v174, v174, v175
    v_accvgpr_write_b32 a96, v160
    v_accvgpr_write_b32 a97, v162
    v_accvgpr_write_b32 a98, v164
    v_accvgpr_write_b32 a99, v166
    v_accvgpr_write_b32 a100, v168
    v_accvgpr_write_b32 a101, v170
    v_accvgpr_write_b32 a102, v172
    v_accvgpr_write_b32 a103, v174
    v_lshlrev_b32 v160, 16, v104
    v_and_b32 v161, 0xffff0000, v104
    v_lshlrev_b32 v162, 16, v105
    v_and_b32 v163, 0xffff0000, v105
    v_lshlrev_b32 v164, 16, v106
    v_and_b32 v165, 0xffff0000, v106
    v_lshlrev_b32 v166, 16, v107
    v_and_b32 v167, 0xffff0000, v107
    s_add_u32 s26, s24, 0x2c0000
    s_add_u32 m0, s29, 0x16000
    s_nop 0
    buffer_load_dwordx4 v136, s[16:19], s26 offen lds
    v_lshlrev_b32 v168, 16, v108
    v_and_b32 v169, 0xffff0000, v108
    v_lshlrev_b32 v170, 16, v109
    v_and_b32 v171, 0xffff0000, v109
    v_lshlrev_b32 v172, 16, v110
    v_and_b32 v173, 0xffff0000, v110
    v_lshlrev_b32 v174, 16, v111
    v_and_b32 v175, 0xffff0000, v111
    v_pk_add_f32 v[160:161], v[160:161], v[154:155] op_sel_hi:[1,0] neg_lo:[0,1] neg_hi:[0,1]
    v_pk_add_f32 v[162:163], v[162:163], v[154:155] op_sel_hi:[1,0] neg_lo:[0,1] neg_hi:[0,1]
    v_pk_add_f32 v[164:165], v[164:165], v[154:155] op_sel_hi:[1,0] neg_lo:[0,1] neg_hi:[0,1]
    v_pk_add_f32 v[166:167], v[166:167], v[154:155] op_sel_hi:[1,0] neg_lo:[0,1] neg_hi:[0,1]
    v_pk_add_f32 v[168:169], v[168:169], v[154:155] op_sel_hi:[1,0] neg_lo:[0,1] neg_hi:[0,1]
    v_pk_add_f32 v[170:171], v[170:171], v[154:155] op_sel_hi:[1,0] neg_lo:[0,1] neg_hi:[0,1]
    v_pk_add_f32 v[172:173], v[172:173], v[154:155] op_sel_hi:[1,0] neg_lo:[0,1] neg_hi:[0,1]
    v_pk_add_f32 v[174:175], v[174:175], v[154:155] op_sel_hi:[1,0] neg_lo:[0,1] neg_hi:[0,1]
    v_cvt_pk_bf16_f32 v104, v160, v161
    v_cvt_pk_bf16_f32 v105, v162, v163
    v_cvt_pk_bf16_f32 v106, v164, v165
    v_cvt_pk_bf16_f32 v107, v166, v167
    v_cvt_pk_bf16_f32 v108, v168, v169
    v_cvt_pk_bf16_f32 v109, v170, v171
    v_cvt_pk_bf16_f32 v110, v172, v173
    v_cvt_pk_bf16_f32 v111, v174, v175
    v_lshlrev_b32 v160, 16, v104
    v_and_b32 v161, 0xffff0000, v104
    v_lshlrev_b32 v162, 16, v105
    v_and_b32 v163, 0xffff0000, v105
    v_lshlrev_b32 v164, 16, v106
    v_and_b32 v165, 0xffff0000, v106
    v_lshlrev_b32 v166, 16, v107
    v_and_b32 v167, 0xffff0000, v107
    v_lshlrev_b32 v168, 16, v108
    v_and_b32 v169, 0xffff0000, v108
    v_lshlrev_b32 v170, 16, v109
    v_and_b32 v171, 0xffff0000, v109
    v_lshlrev_b32 v172, 16, v110
    v_and_b32 v173, 0xffff0000, v110
    v_lshlrev_b32 v174, 16, v111
    v_and_b32 v175, 0xffff0000, v111
    v_pk_mul_f32 v[160:161], v[160:161], v[152:153] op_sel_hi:[1,0]
    v_pk_mul_f32 v[162:163], v[162:163], v[152:153] op_sel_hi:[1,0]
    v_pk_mul_f32 v[164:165], v[164:165], v[152:153] op_sel_hi:[1,0]
    v_pk_mul_f32 v[166:167], v[166:167], v[152:153] op_sel_hi:[1,0]
    v_pk_mul_f32 v[168:169], v[168:169], v[152:153] op_sel_hi:[1,0]
    v_pk_mul_f32 v[170:171], v[170:171], v[152:153] op_sel_hi:[1,0]
    v_pk_mul_f32 v[172:173], v[172:173], v[152:153] op_sel_hi:[1,0]
    v_pk_mul_f32 v[174:175], v[174:175], v[152:153] op_sel_hi:[1,0]
    v_cvt_pk_bf16_f32 v160, v160, v161
    v_cvt_pk_bf16_f32 v162, v162, v163
    s_add_u32 s26, s24, 0x2e0000
    s_add_u32 m0, s29, 0x17000
    s_nop 0
    buffer_load_dwordx4 v136, s[16:19], s26 offen lds
    v_cvt_pk_bf16_f32 v164, v164, v165
    v_cvt_pk_bf16_f32 v166, v166, v167
    v_cvt_pk_bf16_f32 v168, v168, v169
    v_cvt_pk_bf16_f32 v170, v170, v171
    v_cvt_pk_bf16_f32 v172, v172, v173
    v_cvt_pk_bf16_f32 v174, v174, v175
    v_accvgpr_write_b32 a104, v160
    v_accvgpr_write_b32 a105, v162
    v_accvgpr_write_b32 a106, v164
    v_accvgpr_write_b32 a107, v166
    v_accvgpr_write_b32 a108, v168
    v_accvgpr_write_b32 a109, v170
    v_accvgpr_write_b32 a110, v172
    v_accvgpr_write_b32 a111, v174
    v_lshlrev_b32 v160, 16, v112
    v_and_b32 v161, 0xffff0000, v112
    v_lshlrev_b32 v162, 16, v113
    v_and_b32 v163, 0xffff0000, v113
    v_lshlrev_b32 v164, 16, v114
    v_and_b32 v165, 0xffff0000, v114
    v_lshlrev_b32 v166, 16, v115
    v_and_b32 v167, 0xffff0000, v115
    v_lshlrev_b32 v168, 16, v116
    v_and_b32 v169, 0xffff0000, v116
    v_lshlrev_b32 v170, 16, v117
    v_and_b32 v171, 0xffff0000, v117
    v_lshlrev_b32 v172, 16, v118
    v_and_b32 v173, 0xffff0000, v118
    v_lshlrev_b32 v174, 16, v119
    v_and_b32 v175, 0xffff0000, v119
    v_pk_add_f32 v[160:161], v[160:161], v[154:155] op_sel_hi:[1,0] neg_lo:[0,1] neg_hi:[0,1]
    v_pk_add_f32 v[162:163], v[162:163], v[154:155] op_sel_hi:[1,0] neg_lo:[0,1] neg_hi:[0,1]
    v_pk_add_f32 v[164:165], v[164:165], v[154:155] op_sel_hi:[1,0] neg_lo:[0,1] neg_hi:[0,1]
    v_pk_add_f32 v[166:167], v[166:167], v[154:155] op_sel_hi:[1,0] neg_lo:[0,1] neg_hi:[0,1]
    v_pk_add_f32 v[168:169], v[168:169], v[154:155] op_sel_hi:[1,0] neg_lo:[0,1] neg_hi:[0,1]
    v_pk_add_f32 v[170:171], v[170:171], v[154:155] op_sel_hi:[1,0] neg_lo:[0,1] neg_hi:[0,1]
    v_pk_add_f32 v[172:173], v[172:173], v[154:155] op_sel_hi:[1,0] neg_lo:[0,1] neg_hi:[0,1]
    v_pk_add_f32 v[174:175], v[174:175], v[154:155] op_sel_hi:[1,0] neg_lo:[0,1] neg_hi:[0,1]
    v_cvt_pk_bf16_f32 v112, v160, v161
    v_cvt_pk_bf16_f32 v113, v162, v163
    v_cvt_pk_bf16_f32 v114, v164, v165
    v_cvt_pk_bf16_f32 v115, v166, v167
    v_cvt_pk_bf16_f32 v116, v168, v169
    v_cvt_pk_bf16_f32 v117, v170, v171
    v_cvt_pk_bf16_f32 v118, v172, v173
    v_cvt_pk_bf16_f32 v119, v174, v175
    v_lshlrev_b32 v160, 16, v112
    v_and_b32 v161, 0xffff0000, v112
    v_lshlrev_b32 v162, 16, v113
    v_and_b32 v163, 0xffff0000, v113
    v_lshlrev_b32 v138, 2, v137
    v_lshlrev_b32 v138, 3, v137
    s_sub_u32 s26, s101, 96
    s_lshl_b32 s26, s26, 2
    s_add_u32 s26, s26, s21
    s_min_u32 s26, s26, 512
    s_lshl_b32 s26, s26, 13
    s_cmp_eq_u32 s41, 0
    s_cselect_b32 s6, 0x400000, 0
    s_mov_b32 s7, 0x20000
    s_mov_b32 s4, s66
    s_and_b32 s5, s67, 0xffff
    buffer_load_dword v143, v138, s[4:7], s26 offen
    v_lshlrev_b32 v164, 16, v114
    v_and_b32 v165, 0xffff0000, v114
    v_lshlrev_b32 v166, 16, v115
    v_and_b32 v167, 0xffff0000, v115
    v_lshlrev_b32 v168, 16, v116
    v_and_b32 v169, 0xffff0000, v116
    v_lshlrev_b32 v170, 16, v117
    v_and_b32 v171, 0xffff0000, v117
    v_lshlrev_b32 v172, 16, v118
    v_and_b32 v173, 0xffff0000, v118
    v_lshlrev_b32 v174, 16, v119
    v_and_b32 v175, 0xffff0000, v119
    v_pk_mul_f32 v[160:161], v[160:161], v[152:153] op_sel_hi:[1,0]
    v_pk_mul_f32 v[162:163], v[162:163], v[152:153] op_sel_hi:[1,0]
    v_pk_mul_f32 v[164:165], v[164:165], v[152:153] op_sel_hi:[1,0]
    v_pk_mul_f32 v[166:167], v[166:167], v[152:153] op_sel_hi:[1,0]
    v_pk_mul_f32 v[168:169], v[168:169], v[152:153] op_sel_hi:[1,0]
    v_pk_mul_f32 v[170:171], v[170:171], v[152:153] op_sel_hi:[1,0]
    v_pk_mul_f32 v[172:173], v[172:173], v[152:153] op_sel_hi:[1,0]
    v_pk_mul_f32 v[174:175], v[174:175], v[152:153] op_sel_hi:[1,0]
    v_cvt_pk_bf16_f32 v160, v160, v161
    v_cvt_pk_bf16_f32 v162, v162, v163
    v_cvt_pk_bf16_f32 v164, v164, v165
    v_cvt_pk_bf16_f32 v166, v166, v167
    v_cvt_pk_bf16_f32 v168, v168, v169
    v_cvt_pk_bf16_f32 v170, v170, v171
    v_cvt_pk_bf16_f32 v172, v172, v173
    v_cvt_pk_bf16_f32 v174, v174, v175
    v_accvgpr_write_b32 a112, v160
    v_accvgpr_write_b32 a113, v162
    v_accvgpr_write_b32 a114, v164
    v_accvgpr_write_b32 a115, v166
    v_accvgpr_write_b32 a116, v168
    v_accvgpr_write_b32 a117, v170
    v_accvgpr_write_b32 a118, v172
    v_accvgpr_write_b32 a119, v174
    v_lshlrev_b32 v160, 16, v120
    v_and_b32 v161, 0xffff0000, v120
    v_lshlrev_b32 v162, 16, v121
    v_and_b32 v163, 0xffff0000, v121
    v_lshlrev_b32 v164, 16, v122
    v_and_b32 v165, 0xffff0000, v122
    v_lshlrev_b32 v166, 16, v123
    v_and_b32 v167, 0xffff0000, v123
    v_lshlrev_b32 v168, 16, v124
    v_and_b32 v169, 0xffff0000, v124
    v_lshlrev_b32 v170, 16, v125
    v_and_b32 v171, 0xffff0000, v125
    v_lshlrev_b32 v172, 16, v126
    v_and_b32 v173, 0xffff0000, v126
    v_lshlrev_b32 v174, 16, v127
    v_and_b32 v175, 0xffff0000, v127
    v_pk_add_f32 v[160:161], v[160:161], v[154:155] op_sel_hi:[1,0] neg_lo:[0,1] neg_hi:[0,1]
    v_pk_add_f32 v[162:163], v[162:163], v[154:155] op_sel_hi:[1,0] neg_lo:[0,1] neg_hi:[0,1]
    v_pk_add_f32 v[164:165], v[164:165], v[154:155] op_sel_hi:[1,0] neg_lo:[0,1] neg_hi:[0,1]
    v_pk_add_f32 v[166:167], v[166:167], v[154:155] op_sel_hi:[1,0] neg_lo:[0,1] neg_hi:[0,1]
    v_pk_add_f32 v[168:169], v[168:169], v[154:155] op_sel_hi:[1,0] neg_lo:[0,1] neg_hi:[0,1]
    v_pk_add_f32 v[170:171], v[170:171], v[154:155] op_sel_hi:[1,0] neg_lo:[0,1] neg_hi:[0,1]
    v_pk_add_f32 v[172:173], v[172:173], v[154:155] op_sel_hi:[1,0] neg_lo:[0,1] neg_hi:[0,1]
    v_pk_add_f32 v[174:175], v[174:175], v[154:155] op_sel_hi:[1,0] neg_lo:[0,1] neg_hi:[0,1]
    v_cvt_pk_bf16_f32 v120, v160, v161
    v_cvt_pk_bf16_f32 v121, v162, v163
    v_cvt_pk_bf16_f32 v122, v164, v165
    v_cvt_pk_bf16_f32 v123, v166, v167
    v_cvt_pk_bf16_f32 v124, v168, v169
    v_cvt_pk_bf16_f32 v125, v170, v171
    v_cvt_pk_bf16_f32 v126, v172, v173
    v_cvt_pk_bf16_f32 v127, v174, v175
    v_lshlrev_b32 v160, 16, v120
    v_and_b32 v161, 0xffff0000, v120
    v_lshlrev_b32 v162, 16, v121
    v_and_b32 v163, 0xffff0000, v121
    v_lshlrev_b32 v164, 16, v122
    v_and_b32 v165, 0xffff0000, v122
    v_lshlrev_b32 v166, 16, v123
    v_and_b32 v167, 0xffff0000, v123
    v_lshlrev_b32 v168, 16, v124
    v_and_b32 v169, 0xffff0000, v124
    v_lshlrev_b32 v170, 16, v125
    v_and_b32 v171, 0xffff0000, v125
    v_lshlrev_b32 v172, 16, v126
    v_and_b32 v173, 0xffff0000, v126
    v_lshlrev_b32 v174, 16, v127
    v_and_b32 v175, 0xffff0000, v127
    v_pk_mul_f32 v[160:161], v[160:161], v[152:153] op_sel_hi:[1,0]
    v_pk_mul_f32 v[162:163], v[162:163], v[152:153] op_sel_hi:[1,0]
    v_pk_mul_f32 v[164:165], v[164:165], v[152:153] op_sel_hi:[1,0]
    v_pk_mul_f32 v[166:167], v[166:167], v[152:153] op_sel_hi:[1,0]
    v_pk_mul_f32 v[168:169], v[168:169], v[152:153] op_sel_hi:[1,0]
    v_pk_mul_f32 v[170:171], v[170:171], v[152:153] op_sel_hi:[1,0]
    v_pk_mul_f32 v[172:173], v[172:173], v[152:153] op_sel_hi:[1,0]
    v_pk_mul_f32 v[174:175], v[174:175], v[152:153] op_sel_hi:[1,0]
    v_cvt_pk_bf16_f32 v160, v160, v161
    v_cvt_pk_bf16_f32 v162, v162, v163
    v_cvt_pk_bf16_f32 v164, v164, v165
    v_cvt_pk_bf16_f32 v166, v166, v167
    v_cvt_pk_bf16_f32 v168, v168, v169
    v_cvt_pk_bf16_f32 v170, v170, v171
    v_cvt_pk_bf16_f32 v172, v172, v173
    v_cvt_pk_bf16_f32 v174, v174, v175
    v_accvgpr_write_b32 a120, v160
    v_accvgpr_write_b32 a121, v162
    v_accvgpr_write_b32 a122, v164
    v_accvgpr_write_b32 a123, v166
    v_accvgpr_write_b32 a124, v168
    v_accvgpr_write_b32 a125, v170
    v_accvgpr_write_b32 a126, v172
    v_accvgpr_write_b32 a127, v174
    buffer_load_dwordx2 v[140:141], off, s[92:95], 0 offset:36 sc1
    s_nop 3
L_p1_unit:
    s_cmp_ge_u32 s38, 96
    s_cbranch_scc1 L_p1_end
    s_lshr_b32 s26, s38, 5
    s_add_u32 s27, s26, 1
    s_lshl_b32 s25, s27, 24
    s_lshl_b32 s27, s20, 2
    s_add_u32 s27, s27, s21
    s_lshl_b32 s27, s27, 5
    s_and_b32 s28, s38, 31
    s_add_u32 s27, s27, s28
    s_lshl_b32 s27, s27, 13
    s_add_u32 s25, s25, s27
    s_lshr_b32 s26, s38, 5
    s_cmp_eq_u32 s26, 1
    s_cbranch_scc1 L_p1_v
    s_waitcnt vmcnt(16)
    s_barrier
    ds_read_b64_tr_b16 v[64:65], v128
    ds_read_b64_tr_b16 v[66:67], v128 offset:1024
    ds_read_b64_tr_b16 v[68:69], v129
    ds_read_b64_tr_b16 v[70:71], v129 offset:1024
    ds_read_b64_tr_b16 v[72:73], v130
    ds_read_b64_tr_b16 v[74:75], v130 offset:1024
    ds_read_b64_tr_b16 v[76:77], v131
    ds_read_b64_tr_b16 v[78:79], v131 offset:1024
    ds_read_b64_tr_b16 v[80:81], v132
    ds_read_b64_tr_b16 v[82:83], v132 offset:1024
    ds_read_b64_tr_b16 v[84:85], v133
    ds_read_b64_tr_b16 v[86:87], v133 offset:1024
    ds_read_b64_tr_b16 v[88:89], v134
    ds_read_b64_tr_b16 v[90:91], v134 offset:1024
    s_waitcnt lgkmcnt(12)
    v_mfma_f32_16x16x32_bf16 v[0:3], v[64:67], a[0:3], 0
    ds_read_b64_tr_b16 v[92:93], v135
    v_mfma_f32_16x16x32_bf16 v[4:7], v[64:67], a[64:67], 0
    ds_read_b64_tr_b16 v[94:95], v135 offset:1024
    s_add_u32 s26, s24, 0x300000
    s_add_u32 m0, s29, 0x18000
    s_nop 0
    buffer_load_dwordx4 v136, s[16:19], s26 offen lds
    s_waitcnt lgkmcnt(12)
    v_mfma_f32_16x16x32_bf16 v[8:11], v[68:71], a[0:3], 0
    ds_read_b64_tr_b16 v[96:97], v128 offset:8192
    v_mfma_f32_16x16x32_bf16 v[12:15], v[68:71], a[64:67], 0
    ds_read_b64_tr_b16 v[98:99], v128 offset:9216
    s_add_u32 s26, s24, 0x320000
    s_add_u32 m0, s29, 0x19000
    s_nop 0
    buffer_load_dwordx4 v136, s[16:19], s26 offen lds
    s_waitcnt lgkmcnt(12)
    v_mfma_f32_16x16x32_bf16 v[16:19], v[72:75], a[0:3], 0
    ds_read_b64_tr_b16 v[100:101], v129 offset:8192
    v_mfma_f32_16x16x32_bf16 v[20:23], v[72:75], a[64:67], 0
    ds_read_b64_tr_b16 v[102:103], v129 offset:9216
    s_add_u32 s26, s24, 0x340000
    s_add_u32 m0, s29, 0x1a000
    s_nop 0
    buffer_load_dwordx4 v136, s[16:19], s26 offen lds
    s_waitcnt lgkmcnt(12)
    v_mfma_f32_16x16x32_bf16 v[24:27], v[76:79], a[0:3], 0
    ds_read_b64_tr_b16 v[104:105], v130 offset:8192
    v_mfma_f32_16x16x32_bf16 v[28:31], v[76:79], a[64:67], 0
    ds_read_b64_tr_b16 v[106:107], v130 offset:9216
    s_add_u32 s26, s24, 0x360000
    s_add_u32 m0, s29, 0x1b000
    s_nop 0
    buffer_load_dwordx4 v136, s[16:19], s26 offen lds
    s_waitcnt lgkmcnt(12)
    v_mfma_f32_16x16x32_bf16 v[32:35], v[80:83], a[0:3], 0
    ds_read_b64_tr_b16 v[108:109], v131 offset:8192
    v_mfma_f32_16x16x32_bf16 v[36:39], v[80:83], a[64:67], 0
    ds_read_b64_tr_b16 v[110:111], v131 offset:9216
    s_add_u32 s26, s24, 0x380000
    s_add_u32 m0, s29, 0x1c000
    s_nop 0
    buffer_load_dwordx4 v136, s[16:19], s26 offen lds
    s_waitcnt lgkmcnt(12)
    v_mfma_f32_16x16x32_bf16 v[40:43], v[84:87], a[0:3], 0
    ds_read_b64_tr_b16 v[112:113], v132 offset:8192
    v_mfma_f32_16x16x32_bf16 v[44:47], v[84:87], a[64:67], 0
    ds_read_b64_tr_b16 v[114:115], v132 offset:9216
    s_add_u32 s26, s24, 0x3a0000
    s_add_u32 m0, s29, 0x1d000
    s_nop 0
    buffer_load_dwordx4 v136, s[16:19], s26 offen lds
    s_waitcnt lgkmcnt(12)
    v_mfma_f32_16x16x32_bf16 v[48:51], v[88:91], a[0:3], 0
    ds_read_b64_tr_b16 v[116:117], v133 offset:8192
    v_mfma_f32_16x16x32_bf16 v[52:55], v[88:91], a[64:67], 0
    ds_read_b64_tr_b16 v[118:119], v133 offset:9216
    s_add_u32 s26, s24, 0x3c0000
    s_add_u32 m0, s29, 0x1e000
    s_nop 0
    buffer_load_dwordx4 v136, s[16:19], s26 offen lds
    s_waitcnt lgkmcnt(12)
    v_mfma_f32_16x16x32_bf16 v[56:59], v[92:95], a[0:3], 0
    ds_read_b64_tr_b16 v[120:121], v134 offset:8192
    v_mfma_f32_16x16x32_bf16 v[60:63], v[92:95], a[64:67], 0
    ds_read_b64_tr_b16 v[122:123], v134 offset:9216
    s_add_u32 s26, s24, 0x3e0000
    s_add_u32 m0, s29, 0x1f000
    s_nop 0
    buffer_load_dwordx4 v136, s[16:19], s26 offen lds
    s_waitcnt lgkmcnt(12)
    v_mfma_f32_16x16x32_bf16 v[0:3], v[96:99], a[4:7], v[0:3]
    ds_read_b64_tr_b16 v[124:125], v135 offset:8192
    v_mfma_f32_16x16x32_bf16 v[4:7], v[96:99], a[68:71], v[4:7]
    ds_read_b64_tr_b16 v[126:127], v135 offset:9216
    s_waitcnt lgkmcnt(12)
    v_mfma_f32_16x16x32_bf16 v[8:11], v[100:103], a[4:7], v[8:11]
    ds_read_b64_tr_b16 v[64:65], v128 offset:16384
    v_mfma_f32_16x16x32_bf16 v[12:15], v[100:103], a[68:71], v[12:15]
    ds_read_b64_tr_b16 v[66:67], v128 offset:17408
    s_waitcnt lgkmcnt(12)
    v_mfma_f32_16x16x32_bf16 v[16:19], v[104:107], a[4:7], v[16:19]
    ds_read_b64_tr_b16 v[68:69], v129 offset:16384
    v_mfma_f32_16x16x32_bf16 v[20:23], v[104:107], a[68:71], v[20:23]
    ds_read_b64_tr_b16 v[70:71], v129 offset:17408
    s_waitcnt lgkmcnt(12)
    v_mfma_f32_16x16x32_bf16 v[24:27], v[108:111], a[4:7], v[24:27]
    ds_read_b64_tr_b16 v[72:73], v130 offset:16384
    v_mfma_f32_16x16x32_bf16 v[28:31], v[108:111], a[68:71], v[28:31]
    ds_read_b64_tr_b16 v[74:75], v130 offset:17408
    s_waitcnt lgkmcnt(12)
    v_mfma_f32_16x16x32_bf16 v[32:35], v[112:115], a[4:7], v[32:35]
    ds_read_b64_tr_b16 v[76:77], v131 offset:16384
    v_mfma_f32_16x16x32_bf16 v[36:39], v[112:115], a[68:71], v[36:39]
    ds_read_b64_tr_b16 v[78:79], v131 offset:17408
    s_waitcnt lgkmcnt(12)
    v_mfma_f32_16x16x32_bf16 v[40:43], v[116:119], a[4:7], v[40:43]
    ds_read_b64_tr_b16 v[80:81], v132 offset:16384
    v_mfma_f32_16x16x32_bf16 v[44:47], v[116:119], a[68:71], v[44:47]
    ds_read_b64_tr_b16 v[82:83], v132 offset:17408
    s_waitcnt lgkmcnt(12)
    v_mfma_f32_16x16x32_bf16 v[48:51], v[120:123], a[4:7], v[48:51]
    ds_read_b64_tr_b16 v[84:85], v133 offset:16384
    v_mfma_f32_16x16x32_bf16 v[52:55], v[120:123], a[68:71], v[52:55]
    ds_read_b64_tr_b16 v[86:87], v133 offset:17408
    s_waitcnt lgkmcnt(12)
    v_mfma_f32_16x16x32_bf16 v[56:59], v[124:127], a[4:7], v[56:59]
    ds_read_b64_tr_b16 v[88:89], v134 offset:16384
    v_mfma_f32_16x16x32_bf16 v[60:63], v[124:127], a[68:71], v[60:63]
    ds_read_b64_tr_b16 v[90:91], v134 offset:17408
    s_waitcnt lgkmcnt(12)
    v_mfma_f32_16x16x32_bf16 v[0:3], v[64:67], a[8:11], v[0:3]
    ds_read_b64_tr_b16 v[92:93], v135 offset:16384
    v_mfma_f32_16x16x32_bf16 v[4:7], v[64:67], a[72:75], v[4:7]
    ds_read_b64_tr_b16 v[94:95], v135 offset:17408
    s_waitcnt lgkmcnt(12)
    v_mfma_f32_16x16x32_bf16 v[8:11], v[68:71], a[8:11], v[8:11]
    ds_read_b64_tr_b16 v[96:97], v128 offset:24576
    v_mfma_f32_16x16x32_bf16 v[12:15], v[68:71], a[72:75], v[12:15]
    ds_read_b64_tr_b16 v[98:99], v128 offset:25600
    s_waitcnt lgkmcnt(12)
    v_mfma_f32_16x16x32_bf16 v[16:19], v[72:75], a[8:11], v[16:19]
    ds_read_b64_tr_b16 v[100:101], v129 offset:24576
    v_mfma_f32_16x16x32_bf16 v[20:23], v[72:75], a[72:75], v[20:23]
    ds_read_b64_tr_b16 v[102:103], v129 offset:25600
    s_waitcnt lgkmcnt(12)
    v_mfma_f32_16x16x32_bf16 v[24:27], v[76:79], a[8:11], v[24:27]
    ds_read_b64_tr_b16 v[104:105], v130 offset:24576
    v_mfma_f32_16x16x32_bf16 v[28:31], v[76:79], a[72:75], v[28:31]
    ds_read_b64_tr_b16 v[106:107], v130 offset:25600
    s_waitcnt lgkmcnt(12)
    v_mfma_f32_16x16x32_bf16 v[32:35], v[80:83], a[8:11], v[32:35]
    ds_read_b64_tr_b16 v[108:109], v131 offset:24576
    v_mfma_f32_16x16x32_bf16 v[36:39], v[80:83], a[72:75], v[36:39]
    ds_read_b64_tr_b16 v[110:111], v131 offset:25600
    s_waitcnt lgkmcnt(12)
    v_mfma_f32_16x16x32_bf16 v[40:43], v[84:87], a[8:11], v[40:43]
    ds_read_b64_tr_b16 v[112:113], v132 offset:24576
    v_mfma_f32_16x16x32_bf16 v[44:47], v[84:87], a[72:75], v[44:47]
    ds_read_b64_tr_b16 v[114:115], v132 offset:25600
    s_waitcnt lgkmcnt(12)
    v_mfma_f32_16x16x32_bf16 v[48:51], v[88:91], a[8:11], v[48:51]
    ds_read_b64_tr_b16 v[116:117], v133 offset:24576
    v_mfma_f32_16x16x32_bf16 v[52:55], v[88:91], a[72:75], v[52:55]
    ds_read_b64_tr_b16 v[118:119], v133 offset:25600
    s_waitcnt lgkmcnt(12)
    v_mfma_f32_16x16x32_bf16 v[56:59], v[92:95], a[8:11], v[56:59]
    ds_read_b64_tr_b16 v[120:121], v134 offset:24576
    v_mfma_f32_16x16x32_bf16 v[60:63], v[92:95], a[72:75], v[60:63]
    ds_read_b64_tr_b16 v[122:123], v134 offset:25600
    s_waitcnt lgkmcnt(12)
    v_mfma_f32_16x16x32_bf16 v[0:3], v[96:99], a[12:15], v[0:3]
    ds_read_b64_tr_b16 v[124:125], v135 offset:24576
    v_mfma_f32_16x16x32_bf16 v[4:7], v[96:99], a[76:79], v[4:7]
    ds_read_b64_tr_b16 v[126:127], v135 offset:25600
    s_waitcnt lgkmcnt(12)
    v_mfma_f32_16x16x32_bf16 v[8:11], v[100:103], a[12:15], v[8:11]
    v_mfma_f32_16x16x32_bf16 v[12:15], v[100:103], a[76:79], v[12:15]
    s_waitcnt lgkmcnt(10)
    v_mfma_f32_16x16x32_bf16 v[16:19], v[104:107], a[12:15], v[16:19]
    v_mfma_f32_16x16x32_bf16 v[20:23], v[104:107], a[76:79], v[20:23]
    s_waitcnt lgkmcnt(8)
    v_mfma_f32_16x16x32_bf16 v[24:27], v[108:111], a[12:15], v[24:27]
    v_mfma_f32_16x16x32_bf16 v[28:31], v[108:111], a[76:79], v[28:31]
    s_waitcnt lgkmcnt(6)
    v_mfma_f32_16x16x32_bf16 v[32:35], v[112:115], a[12:15], v[32:35]
    v_mfma_f32_16x16x32_bf16 v[36:39], v[112:115], a[76:79], v[36:39]
    s_waitcnt lgkmcnt(4)
    v_mfma_f32_16x16x32_bf16 v[40:43], v[116:119], a[12:15], v[40:43]
    v_mfma_f32_16x16x32_bf16 v[44:47], v[116:119], a[76:79], v[44:47]
    s_waitcnt lgkmcnt(2)
    v_mfma_f32_16x16x32_bf16 v[48:51], v[120:123], a[12:15], v[48:51]
    v_mfma_f32_16x16x32_bf16 v[52:55], v[120:123], a[76:79], v[52:55]
    s_waitcnt lgkmcnt(0)
    v_mfma_f32_16x16x32_bf16 v[56:59], v[124:127], a[12:15], v[56:59]
    v_mfma_f32_16x16x32_bf16 v[60:63], v[124:127], a[76:79], v[60:63]
    s_waitcnt vmcnt(16)
    s_barrier
    ds_read_b64_tr_b16 v[64:65], v128 offset:32768
    ds_read_b64_tr_b16 v[66:67], v128 offset:33792
    ds_read_b64_tr_b16 v[68:69], v129 offset:32768
    ds_read_b64_tr_b16 v[70:71], v129 offset:33792
    ds_read_b64_tr_b16 v[72:73], v130 offset:32768
    ds_read_b64_tr_b16 v[74:75], v130 offset:33792
    ds_read_b64_tr_b16 v[76:77], v131 offset:32768
    ds_read_b64_tr_b16 v[78:79], v131 offset:33792
    ds_read_b64_tr_b16 v[80:81], v132 offset:32768
    ds_read_b64_tr_b16 v[82:83], v132 offset:33792
    ds_read_b64_tr_b16 v[84:85], v133 offset:32768
    ds_read_b64_tr_b16 v[86:87], v133 offset:33792
    ds_read_b64_tr_b16 v[88:89], v134 offset:32768
    ds_read_b64_tr_b16 v[90:91], v134 offset:33792
    s_add_u32 s39, s39, s37
    s_lshr_b32 s26, s39, 5
    s_cmp_eq_u32 s26, 0
    s_cselect_b64 s[16:17], s[62:63], s[60:61]
    s_cmp_eq_u32 s26, 1
    s_cselect_b64 s[16:17], s[64:65], s[16:17]
    s_and_b32 s17, s17, 0xffff
    s_cmp_lt_u32 s39, 96
    s_cselect_b32 s18, 0x400000, 0
    s_and_b32 s24, s39, 31
    s_lshl_b32 s24, s24, 8
    s_waitcnt lgkmcnt(12)
    v_mfma_f32_16x16x32_bf16 v[0:3], v[64:67], a[16:19], v[0:3]
    ds_read_b64_tr_b16 v[92:93], v135 offset:32768
    v_mfma_f32_16x16x32_bf16 v[4:7], v[64:67], a[80:83], v[4:7]
    ds_read_b64_tr_b16 v[94:95], v135 offset:33792
    s_add_u32 s26, s24, 0x0
    s_add_u32 m0, s29, 0x0
    s_nop 0
    buffer_load_dwordx4 v136, s[16:19], s26 offen lds
    s_waitcnt lgkmcnt(12)
    v_mfma_f32_16x16x32_bf16 v[8:11], v[68:71], a[16:19], v[8:11]
    ds_read_b64_tr_b16 v[96:97], v128 offset:40960
    v_mfma_f32_16x16x32_bf16 v[12:15], v[68:71], a[80:83], v[12:15]
    ds_read_b64_tr_b16 v[98:99], v128 offset:41984
    s_add_u32 s26, s24, 0x20000
    s_add_u32 m0, s29, 0x1000
    s_nop 0
    buffer_load_dwordx4 v136, s[16:19], s26 offen lds
    s_waitcnt lgkmcnt(12)
    v_mfma_f32_16x16x32_bf16 v[16:19], v[72:75], a[16:19], v[16:19]
    ds_read_b64_tr_b16 v[100:101], v129 offset:40960
    v_mfma_f32_16x16x32_bf16 v[20:23], v[72:75], a[80:83], v[20:23]
    ds_read_b64_tr_b16 v[102:103], v129 offset:41984
    s_add_u32 s26, s24, 0x40000
    s_add_u32 m0, s29, 0x2000
    s_nop 0
    buffer_load_dwordx4 v136, s[16:19], s26 offen lds
    s_waitcnt lgkmcnt(12)
    v_mfma_f32_16x16x32_bf16 v[24:27], v[76:79], a[16:19], v[24:27]
    ds_read_b64_tr_b16 v[104:105], v130 offset:40960
    v_mfma_f32_16x16x32_bf16 v[28:31], v[76:79], a[80:83], v[28:31]
    ds_read_b64_tr_b16 v[106:107], v130 offset:41984
    s_add_u32 s26, s24, 0x60000
    s_add_u32 m0, s29, 0x3000
    s_nop 0
    buffer_load_dwordx4 v136, s[16:19], s26 offen lds
    s_waitcnt lgkmcnt(12)
    v_mfma_f32_16x16x32_bf16 v[32:35], v[80:83], a[16:19], v[32:35]
    ds_read_b64_tr_b16 v[108:109], v131 offset:40960
    v_mfma_f32_16x16x32_bf16 v[36:39], v[80:83], a[80:83], v[36:39]
    ds_read_b64_tr_b16 v[110:111], v131 offset:41984
    s_add_u32 s26, s24, 0x80000
    s_add_u32 m0, s29, 0x4000
    s_nop 0
    buffer_load_dwordx4 v136, s[16:19], s26 offen lds
    s_waitcnt lgkmcnt(12)
    v_mfma_f32_16x16x32_bf16 v[40:43], v[84:87], a[16:19], v[40:43]
    ds_read_b64_tr_b16 v[112:113], v132 offset:40960
    v_mfma_f32_16x16x32_bf16 v[44:47], v[84:87], a[80:83], v[44:47]
    ds_read_b64_tr_b16 v[114:115], v132 offset:41984
    s_add_u32 s26, s24, 0xa0000
    s_add_u32 m0, s29, 0x5000
    s_nop 0
    buffer_load_dwordx4 v136, s[16:19], s26 offen lds
    s_waitcnt lgkmcnt(12)
    v_mfma_f32_16x16x32_bf16 v[48:51], v[88:91], a[16:19], v[48:51]
    ds_read_b64_tr_b16 v[116:117], v133 offset:40960
    v_mfma_f32_16x16x32_bf16 v[52:55], v[88:91], a[80:83], v[52:55]
    ds_read_b64_tr_b16 v[118:119], v133 offset:41984
    s_add_u32 s26, s24, 0xc0000
    s_add_u32 m0, s29, 0x6000
    s_nop 0
    buffer_load_dwordx4 v136, s[16:19], s26 offen lds
    s_waitcnt lgkmcnt(12)
    v_mfma_f32_16x16x32_bf16 v[56:59], v[92:95], a[16:19], v[56:59]
    ds_read_b64_tr_b16 v[120:121], v134 offset:40960
    v_mfma_f32_16x16x32_bf16 v[60:63], v[92:95], a[80:83], v[60:63]
    ds_read_b64_tr_b16 v[122:123], v134 offset:41984
    s_add_u32 s26, s24, 0xe0000
    s_add_u32 m0, s29, 0x7000
    s_nop 0
    buffer_load_dwordx4 v136, s[16:19], s26 offen lds
    s_waitcnt lgkmcnt(12)
    v_mfma_f32_16x16x32_bf16 v[0:3], v[96:99], a[20:23], v[0:3]
    ds_read_b64_tr_b16 v[124:125], v135 offset:40960
    v_mfma_f32_16x16x32_bf16 v[4:7], v[96:99], a[84:87], v[4:7]
    ds_read_b64_tr_b16 v[126:127], v135 offset:41984
    s_waitcnt lgkmcnt(12)
    v_mfma_f32_16x16x32_bf16 v[8:11], v[100:103], a[20:23], v[8:11]
    ds_read_b64_tr_b16 v[64:65], v128 offset:49152
    v_mfma_f32_16x16x32_bf16 v[12:15], v[100:103], a[84:87], v[12:15]
    ds_read_b64_tr_b16 v[66:67], v128 offset:50176
    s_waitcnt lgkmcnt(12)
    v_mfma_f32_16x16x32_bf16 v[16:19], v[104:107], a[20:23], v[16:19]
    ds_read_b64_tr_b16 v[68:69], v129 offset:49152
    v_mfma_f32_16x16x32_bf16 v[20:23], v[104:107], a[84:87], v[20:23]
    ds_read_b64_tr_b16 v[70:71], v129 offset:50176
    s_waitcnt lgkmcnt(12)
    v_mfma_f32_16x16x32_bf16 v[24:27], v[108:111], a[20:23], v[24:27]
    ds_read_b64_tr_b16 v[72:73], v130 offset:49152
    v_mfma_f32_16x16x32_bf16 v[28:31], v[108:111], a[84:87], v[28:31]
    ds_read_b64_tr_b16 v[74:75], v130 offset:50176
    s_waitcnt lgkmcnt(12)
    v_mfma_f32_16x16x32_bf16 v[32:35], v[112:115], a[20:23], v[32:35]
    ds_read_b64_tr_b16 v[76:77], v131 offset:49152
    v_mfma_f32_16x16x32_bf16 v[36:39], v[112:115], a[84:87], v[36:39]
    ds_read_b64_tr_b16 v[78:79], v131 offset:50176
    s_waitcnt lgkmcnt(12)
    v_mfma_f32_16x16x32_bf16 v[40:43], v[116:119], a[20:23], v[40:43]
    ds_read_b64_tr_b16 v[80:81], v132 offset:49152
    v_mfma_f32_16x16x32_bf16 v[44:47], v[116:119], a[84:87], v[44:47]
    ds_read_b64_tr_b16 v[82:83], v132 offset:50176
    s_waitcnt lgkmcnt(12)
    v_mfma_f32_16x16x32_bf16 v[48:51], v[120:123], a[20:23], v[48:51]
    ds_read_b64_tr_b16 v[84:85], v133 offset:49152
    v_mfma_f32_16x16x32_bf16 v[52:55], v[120:123], a[84:87], v[52:55]
    ds_read_b64_tr_b16 v[86:87], v133 offset:50176
    s_waitcnt lgkmcnt(12)
    v_mfma_f32_16x16x32_bf16 v[56:59], v[124:127], a[20:23], v[56:59]
    ds_read_b64_tr_b16 v[88:89], v134 offset:49152
    v_mfma_f32_16x16x32_bf16 v[60:63], v[124:127], a[84:87], v[60:63]
    ds_read_b64_tr_b16 v[90:91], v134 offset:50176
    s_waitcnt lgkmcnt(12)
    v_mfma_f32_16x16x32_bf16 v[0:3], v[64:67], a[24:27], v[0:3]
    ds_read_b64_tr_b16 v[92:93], v135 offset:49152
    v_mfma_f32_16x16x32_bf16 v[4:7], v[64:67], a[88:91], v[4:7]
    ds_read_b64_tr_b16 v[94:95], v135 offset:50176
    s_waitcnt lgkmcnt(12)
    v_mfma_f32_16x16x32_bf16 v[8:11], v[68:71], a[24:27], v[8:11]
    ds_read_b64_tr_b16 v[96:97], v128 offset:57344
    v_mfma_f32_16x16x32_bf16 v[12:15], v[68:71], a[88:91], v[12:15]
    ds_read_b64_tr_b16 v[98:99], v128 offset:58368
    s_waitcnt lgkmcnt(12)
    v_mfma_f32_16x16x32_bf16 v[16:19], v[72:75], a[24:27], v[16:19]
    ds_read_b64_tr_b16 v[100:101], v129 offset:57344
    v_mfma_f32_16x16x32_bf16 v[20:23], v[72:75], a[88:91], v[20:23]
    ds_read_b64_tr_b16 v[102:103], v129 offset:58368
    s_waitcnt lgkmcnt(12)
    v_mfma_f32_16x16x32_bf16 v[24:27], v[76:79], a[24:27], v[24:27]
    ds_read_b64_tr_b16 v[104:105], v130 offset:57344
    v_mfma_f32_16x16x32_bf16 v[28:31], v[76:79], a[88:91], v[28:31]
    ds_read_b64_tr_b16 v[106:107], v130 offset:58368
    s_waitcnt lgkmcnt(12)
    v_mfma_f32_16x16x32_bf16 v[32:35], v[80:83], a[24:27], v[32:35]
    ds_read_b64_tr_b16 v[108:109], v131 offset:57344
    v_mfma_f32_16x16x32_bf16 v[36:39], v[80:83], a[88:91], v[36:39]
    ds_read_b64_tr_b16 v[110:111], v131 offset:58368
    s_waitcnt lgkmcnt(12)
    v_mfma_f32_16x16x32_bf16 v[40:43], v[84:87], a[24:27], v[40:43]
    ds_read_b64_tr_b16 v[112:113], v132 offset:57344
    v_mfma_f32_16x16x32_bf16 v[44:47], v[84:87], a[88:91], v[44:47]
    ds_read_b64_tr_b16 v[114:115], v132 offset:58368
    s_waitcnt lgkmcnt(12)
    v_mfma_f32_16x16x32_bf16 v[48:51], v[88:91], a[24:27], v[48:51]
    ds_read_b64_tr_b16 v[116:117], v133 offset:57344
    v_mfma_f32_16x16x32_bf16 v[52:55], v[88:91], a[88:91], v[52:55]
    ds_read_b64_tr_b16 v[118:119], v133 offset:58368
    s_waitcnt lgkmcnt(12)
    v_mfma_f32_16x16x32_bf16 v[56:59], v[92:95], a[24:27], v[56:59]
    ds_read_b64_tr_b16 v[120:121], v134 offset:57344
    v_mfma_f32_16x16x32_bf16 v[60:63], v[92:95], a[88:91], v[60:63]
    ds_read_b64_tr_b16 v[122:123], v134 offset:58368
    s_waitcnt lgkmcnt(12)
    v_mfma_f32_16x16x32_bf16 v[0:3], v[96:99], a[28:31], v[0:3]
    ds_read_b64_tr_b16 v[124:125], v135 offset:57344
    v_mfma_f32_16x16x32_bf16 v[4:7], v[96:99], a[92:95], v[4:7]
    ds_read_b64_tr_b16 v[126:127], v135 offset:58368
    s_waitcnt lgkmcnt(12)
    v_mfma_f32_16x16x32_bf16 v[8:11], v[100:103], a[28:31], v[8:11]
    v_mfma_f32_16x16x32_bf16 v[12:15], v[100:103], a[92:95], v[12:15]
    s_waitcnt lgkmcnt(10)
    v_mfma_f32_16x16x32_bf16 v[16:19], v[104:107], a[28:31], v[16:19]
    v_mfma_f32_16x16x32_bf16 v[20:23], v[104:107], a[92:95], v[20:23]
    s_waitcnt lgkmcnt(8)
    v_mfma_f32_16x16x32_bf16 v[24:27], v[108:111], a[28:31], v[24:27]
    v_mfma_f32_16x16x32_bf16 v[28:31], v[108:111], a[92:95], v[28:31]
    s_waitcnt lgkmcnt(6)
    v_mfma_f32_16x16x32_bf16 v[32:35], v[112:115], a[28:31], v[32:35]
    v_mfma_f32_16x16x32_bf16 v[36:39], v[112:115], a[92:95], v[36:39]
    s_waitcnt lgkmcnt(4)
    v_mfma_f32_16x16x32_bf16 v[40:43], v[116:119], a[28:31], v[40:43]
    v_mfma_f32_16x16x32_bf16 v[44:47], v[116:119], a[92:95], v[44:47]
    s_waitcnt lgkmcnt(2)
    v_mfma_f32_16x16x32_bf16 v[48:51], v[120:123], a[28:31], v[48:51]
    v_mfma_f32_16x16x32_bf16 v[52:55], v[120:123], a[92:95], v[52:55]
    s_waitcnt lgkmcnt(0)
    v_mfma_f32_16x16x32_bf16 v[56:59], v[124:127], a[28:31], v[56:59]
    v_mfma_f32_16x16x32_bf16 v[60:63], v[124:127], a[92:95], v[60:63]
    v_xor_b32 v128, 0x10000, v128
    v_xor_b32 v129, 0x10000, v129
    v_xor_b32 v130, 0x10000, v130
    v_xor_b32 v131, 0x10000, v131
    v_xor_b32 v132, 0x10000, v132
    v_xor_b32 v133, 0x10000, v133
    v_xor_b32 v134, 0x10000, v134
    v_xor_b32 v135, 0x10000, v135
    s_waitcnt vmcnt(16)
    s_barrier
    ds_read_b64_tr_b16 v[64:65], v128
    ds_read_b64_tr_b16 v[66:67], v128 offset:1024
    ds_read_b64_tr_b16 v[68:69], v129
    ds_read_b64_tr_b16 v[70:71], v129 offset:1024
    ds_read_b64_tr_b16 v[72:73], v130
    ds_read_b64_tr_b16 v[74:75], v130 offset:1024
    ds_read_b64_tr_b16 v[76:77], v131
    ds_read_b64_tr_b16 v[78:79], v131 offset:1024
    ds_read_b64_tr_b16 v[80:81], v132
    ds_read_b64_tr_b16 v[82:83], v132 offset:1024
    ds_read_b64_tr_b16 v[84:85], v133
    ds_read_b64_tr_b16 v[86:87], v133 offset:1024
    ds_read_b64_tr_b16 v[88:89], v134
    ds_read_b64_tr_b16 v[90:91], v134 offset:1024
    s_cmp_eq_u32 s40, 0
    s_cbranch_scc1 L_nopf_90
    s_cmp_lg_u32 s87, 0
    s_cbranch_scc1 L_modeok_91
    v_readfirstlane_b32 s96, v140
    v_readfirstlane_b32 s97, v141
    s_nop 0
    s_cmp_lg_u32 s97, 0
    s_cselect_b32 s87, s96, 0
    s_cmp_eq_u32 s87, 1
    s_cbranch_scc1 L_modeok_91
    s_mov_b32 s96, 0
L_mode_92:
    buffer_load_dwordx2 v[140:141], off, s[92:95], 0 offset:36 sc1
    s_waitcnt vmcnt(0)
    v_readfirstlane_b32 s87, v140
    v_readfirstlane_b32 s97, v141
    s_nop 0
    s_min_u32 s97, s97, s87
    s_cmp_lg_u32 s97, 0
    s_cbranch_scc1 L_moded_93
    s_sleep 4
    s_add_u32 s96, s96, 1
    s_cmp_lg_u32 s96, 0x100
    s_cbranch_scc1 L_modef_94
    v_mov_b32 v140, 2
    v_mov_b32 v141, 0
    s_mov_b64 exec, 1
    buffer_atomic_cmpswap v[140:141], off, s[92:95], 0 offset:36
    s_mov_b64 exec, -1
L_modef_94:
    s_cmp_lt_u32 s96, 0x10000
    s_cbranch_scc1 L_mode_92
L_moded_93:
    s_cmp_lg_u32 s87, 1
    s_cbranch_scc1 L_fallback
L_modeok_91:
    s_cmp_lg_u32 s100, 0
    s_cbranch_scc1 L_flag_95
    v_mov_b32 v138, 1
    s_mov_b64 exec, 1
    buffer_store_dword v138, off, s[8:11], s40 sc1
    s_mov_b64 exec, -1
L_flag_95:
    s_mov_b32 s40, 0
L_nopf_90:
    s_waitcnt lgkmcnt(12)
    v_mfma_f32_16x16x32_bf16 v[0:3], v[64:67], a[32:35], v[0:3]
    ds_read_b64_tr_b16 v[92:93], v135
    v_mfma_f32_16x16x32_bf16 v[4:7], v[64:67], a[96:99], v[4:7]
    ds_read_b64_tr_b16 v[94:95], v135 offset:1024
    s_add_u32 s26, s24, 0x100000
    s_add_u32 m0, s29, 0x8000
    s_nop 0
    buffer_load_dwordx4 v136, s[16:19], s26 offen lds
    s_waitcnt lgkmcnt(12)
    v_mfma_f32_16x16x32_bf16 v[8:11], v[68:71], a[32:35], v[8:11]
    ds_read_b64_tr_b16 v[96:97], v128 offset:8192
    v_mfma_f32_16x16x32_bf16 v[12:15], v[68:71], a[96:99], v[12:15]
    ds_read_b64_tr_b16 v[98:99], v128 offset:9216
    s_add_u32 s26, s24, 0x120000
    s_add_u32 m0, s29, 0x9000
    s_nop 0
    buffer_load_dwordx4 v136, s[16:19], s26 offen lds
    s_waitcnt lgkmcnt(12)
    v_mfma_f32_16x16x32_bf16 v[16:19], v[72:75], a[32:35], v[16:19]
    ds_read_b64_tr_b16 v[100:101], v129 offset:8192
    v_mfma_f32_16x16x32_bf16 v[20:23], v[72:75], a[96:99], v[20:23]
    ds_read_b64_tr_b16 v[102:103], v129 offset:9216
    s_add_u32 s26, s24, 0x140000
    s_add_u32 m0, s29, 0xa000
    s_nop 0
    buffer_load_dwordx4 v136, s[16:19], s26 offen lds
    s_waitcnt lgkmcnt(12)
    v_mfma_f32_16x16x32_bf16 v[24:27], v[76:79], a[32:35], v[24:27]
    ds_read_b64_tr_b16 v[104:105], v130 offset:8192
    v_mfma_f32_16x16x32_bf16 v[28:31], v[76:79], a[96:99], v[28:31]
    ds_read_b64_tr_b16 v[106:107], v130 offset:9216
    s_add_u32 s26, s24, 0x160000
    s_add_u32 m0, s29, 0xb000
    s_nop 0
    buffer_load_dwordx4 v136, s[16:19], s26 offen lds
    s_waitcnt lgkmcnt(12)
    v_mfma_f32_16x16x32_bf16 v[32:35], v[80:83], a[32:35], v[32:35]
    ds_read_b64_tr_b16 v[108:109], v131 offset:8192
    v_mfma_f32_16x16x32_bf16 v[36:39], v[80:83], a[96:99], v[36:39]
    ds_read_b64_tr_b16 v[110:111], v131 offset:9216
    s_add_u32 s26, s24, 0x180000
    s_add_u32 m0, s29, 0xc000
    s_nop 0
    buffer_load_dwordx4 v136, s[16:19], s26 offen lds
    s_waitcnt lgkmcnt(12)
    v_mfma_f32_16x16x32_bf16 v[40:43], v[84:87], a[32:35], v[40:43]
    ds_read_b64_tr_b16 v[112:113], v132 offset:8192
    v_mfma_f32_16x16x32_bf16 v[44:47], v[84:87], a[96:99], v[44:47]
    ds_read_b64_tr_b16 v[114:115], v132 offset:9216
    s_add_u32 s26, s24, 0x1a0000
    s_add_u32 m0, s29, 0xd000
    s_nop 0
    buffer_load_dwordx4 v136, s[16:19], s26 offen lds
    s_waitcnt lgkmcnt(12)
    v_mfma_f32_16x16x32_bf16 v[48:51], v[88:91], a[32:35], v[48:51]
    ds_read_b64_tr_b16 v[116:117], v133 offset:8192
    v_mfma_f32_16x16x32_bf16 v[52:55], v[88:91], a[96:99], v[52:55]
    ds_read_b64_tr_b16 v[118:119], v133 offset:9216
    s_add_u32 s26, s24, 0x1c0000
    s_add_u32 m0, s29, 0xe000
    s_nop 0
    buffer_load_dwordx4 v136, s[16:19], s26 offen lds
    s_waitcnt lgkmcnt(12)
    v_mfma_f32_16x16x32_bf16 v[56:59], v[92:95], a[32:35], v[56:59]
    ds_read_b64_tr_b16 v[120:121], v134 offset:8192
    v_mfma_f32_16x16x32_bf16 v[60:63], v[92:95], a[96:99], v[60:63]
    ds_read_b64_tr_b16 v[122:123], v134 offset:9216
    s_add_u32 s26, s24, 0x1e0000
    s_add_u32 m0, s29, 0xf000
    s_nop 0
    buffer_load_dwordx4 v136, s[16:19], s26 offen lds
    s_waitcnt lgkmcnt(12)
    v_mfma_f32_16x16x32_bf16 v[0:3], v[96:99], a[36:39], v[0:3]
    ds_read_b64_tr_b16 v[124:125], v135 offset:8192
    v_mfma_f32_16x16x32_bf16 v[4:7], v[96:99], a[100:103], v[4:7]
    ds_read_b64_tr_b16 v[126:127], v135 offset:9216
    s_waitcnt lgkmcnt(12)
    v_mfma_f32_16x16x32_bf16 v[8:11], v[100:103], a[36:39], v[8:11]
    ds_read_b64_tr_b16 v[64:65], v128 offset:16384
    v_mfma_f32_16x16x32_bf16 v[12:15], v[100:103], a[100:103], v[12:15]
    ds_read_b64_tr_b16 v[66:67], v128 offset:17408
    s_waitcnt lgkmcnt(12)
    v_mfma_f32_16x16x32_bf16 v[16:19], v[104:107], a[36:39], v[16:19]
    ds_read_b64_tr_b16 v[68:69], v129 offset:16384
    v_mfma_f32_16x16x32_bf16 v[20:23], v[104:107], a[100:103], v[20:23]
    ds_read_b64_tr_b16 v[70:71], v129 offset:17408
    s_waitcnt lgkmcnt(12)
    v_mfma_f32_16x16x32_bf16 v[24:27], v[108:111], a[36:39], v[24:27]
    ds_read_b64_tr_b16 v[72:73], v130 offset:16384
    v_mfma_f32_16x16x32_bf16 v[28:31], v[108:111], a[100:103], v[28:31]
    ds_read_b64_tr_b16 v[74:75], v130 offset:17408
    s_waitcnt lgkmcnt(12)
    v_mfma_f32_16x16x32_bf16 v[32:35], v[112:115], a[36:39], v[32:35]
    ds_read_b64_tr_b16 v[76:77], v131 offset:16384
    v_mfma_f32_16x16x32_bf16 v[36:39], v[112:115], a[100:103], v[36:39]
    ds_read_b64_tr_b16 v[78:79], v131 offset:17408
    s_waitcnt lgkmcnt(12)
    v_mfma_f32_16x16x32_bf16 v[40:43], v[116:119], a[36:39], v[40:43]
    ds_read_b64_tr_b16 v[80:81], v132 offset:16384
    v_mfma_f32_16x16x32_bf16 v[44:47], v[116:119], a[100:103], v[44:47]
    ds_read_b64_tr_b16 v[82:83], v132 offset:17408
    s_waitcnt lgkmcnt(12)
    v_mfma_f32_16x16x32_bf16 v[48:51], v[120:123], a[36:39], v[48:51]
    ds_read_b64_tr_b16 v[84:85], v133 offset:16384
    v_mfma_f32_16x16x32_bf16 v[52:55], v[120:123], a[100:103], v[52:55]
    ds_read_b64_tr_b16 v[86:87], v133 offset:17408
    s_waitcnt lgkmcnt(12)
    v_mfma_f32_16x16x32_bf16 v[56:59], v[124:127], a[36:39], v[56:59]
    ds_read_b64_tr_b16 v[88:89], v134 offset:16384
    v_mfma_f32_16x16x32_bf16 v[60:63], v[124:127], a[100:103], v[60:63]
    ds_read_b64_tr_b16 v[90:91], v134 offset:17408
    s_waitcnt lgkmcnt(12)
    v_mfma_f32_16x16x32_bf16 v[0:3], v[64:67], a[40:43], v[0:3]
    ds_read_b64_tr_b16 v[92:93], v135 offset:16384
    v_mfma_f32_16x16x32_bf16 v[4:7], v[64:67], a[104:107], v[4:7]
    ds_read_b64_tr_b16 v[94:95], v135 offset:17408
    s_waitcnt lgkmcnt(12)
    v_mfma_f32_16x16x32_bf16 v[8:11], v[68:71], a[40:43], v[8:11]
    ds_read_b64_tr_b16 v[96:97], v128 offset:24576
    v_mfma_f32_16x16x32_bf16 v[12:15], v[68:71], a[104:107], v[12:15]
    ds_read_b64_tr_b16 v[98:99], v128 offset:25600
    s_waitcnt lgkmcnt(12)
    v_mfma_f32_16x16x32_bf16 v[16:19], v[72:75], a[40:43], v[16:19]
    ds_read_b64_tr_b16 v[100:101], v129 offset:24576
    v_mfma_f32_16x16x32_bf16 v[20:23], v[72:75], a[104:107], v[20:23]
    ds_read_b64_tr_b16 v[102:103], v129 offset:25600
    s_waitcnt lgkmcnt(12)
    v_mfma_f32_16x16x32_bf16 v[24:27], v[76:79], a[40:43], v[24:27]
    ds_read_b64_tr_b16 v[104:105], v130 offset:24576
    v_mfma_f32_16x16x32_bf16 v[28:31], v[76:79], a[104:107], v[28:31]
    ds_read_b64_tr_b16 v[106:107], v130 offset:25600
    s_waitcnt lgkmcnt(12)
    v_mfma_f32_16x16x32_bf16 v[32:35], v[80:83], a[40:43], v[32:35]
    ds_read_b64_tr_b16 v[108:109], v131 offset:24576
    v_mfma_f32_16x16x32_bf16 v[36:39], v[80:83], a[104:107], v[36:39]
    ds_read_b64_tr_b16 v[110:111], v131 offset:25600
    s_waitcnt lgkmcnt(12)
    v_mfma_f32_16x16x32_bf16 v[40:43], v[84:87], a[40:43], v[40:43]
    ds_read_b64_tr_b16 v[112:113], v132 offset:24576
    v_mfma_f32_16x16x32_bf16 v[44:47], v[84:87], a[104:107], v[44:47]
    ds_read_b64_tr_b16 v[114:115], v132 offset:25600
    s_waitcnt lgkmcnt(12)
    v_mfma_f32_16x16x32_bf16 v[48:51], v[88:91], a[40:43], v[48:51]
    ds_read_b64_tr_b16 v[116:117], v133 offset:24576
    v_mfma_f32_16x16x32_bf16 v[52:55], v[88:91], a[104:107], v[52:55]
    ds_read_b64_tr_b16 v[118:119], v133 offset:25600
    s_waitcnt lgkmcnt(12)
    v_mfma_f32_16x16x32_bf16 v[56:59], v[92:95], a[40:43], v[56:59]
    ds_read_b64_tr_b16 v[120:121], v134 offset:24576
    v_mfma_f32_16x16x32_bf16 v[60:63], v[92:95], a[104:107], v[60:63]
    ds_read_b64_tr_b16 v[122:123], v134 offset:25600
    s_waitcnt lgkmcnt(12)
    v_mfma_f32_16x16x32_bf16 v[0:3], v[96:99], a[44:47], v[0:3]
    ds_read_b64_tr_b16 v[124:125], v135 offset:24576
    v_mfma_f32_16x16x32_bf16 v[4:7], v[96:99], a[108:111], v[4:7]
    ds_read_b64_tr_b16 v[126:127], v135 offset:25600
    s_waitcnt lgkmcnt(12)
    v_mfma_f32_16x16x32_bf16 v[8:11], v[100:103], a[44:47], v[8:11]
    v_mfma_f32_16x16x32_bf16 v[12:15], v[100:103], a[108:111], v[12:15]
    s_waitcnt lgkmcnt(10)
    v_mfma_f32_16x16x32_bf16 v[16:19], v[104:107], a[44:47], v[16:19]
    v_mfma_f32_16x16x32_bf16 v[20:23], v[104:107], a[108:111], v[20:23]
    s_waitcnt lgkmcnt(8)
    v_mfma_f32_16x16x32_bf16 v[24:27], v[108:111], a[44:47], v[24:27]
    v_mfma_f32_16x16x32_bf16 v[28:31], v[108:111], a[108:111], v[28:31]
    s_waitcnt lgkmcnt(6)
    v_mfma_f32_16x16x32_bf16 v[32:35], v[112:115], a[44:47], v[32:35]
    v_mfma_f32_16x16x32_bf16 v[36:39], v[112:115], a[108:111], v[36:39]
    s_waitcnt lgkmcnt(4)
    v_mfma_f32_16x16x32_bf16 v[40:43], v[116:119], a[44:47], v[40:43]
    v_mfma_f32_16x16x32_bf16 v[44:47], v[116:119], a[108:111], v[44:47]
    s_waitcnt lgkmcnt(2)
    v_mfma_f32_16x16x32_bf16 v[48:51], v[120:123], a[44:47], v[48:51]
    v_mfma_f32_16x16x32_bf16 v[52:55], v[120:123], a[108:111], v[52:55]
    s_waitcnt lgkmcnt(0)
    v_mfma_f32_16x16x32_bf16 v[56:59], v[124:127], a[44:47], v[56:59]
    v_mfma_f32_16x16x32_bf16 v[60:63], v[124:127], a[108:111], v[60:63]
    s_waitcnt vmcnt(16)
    s_barrier
    ds_read_b64_tr_b16 v[64:65], v128 offset:32768
    ds_read_b64_tr_b16 v[66:67], v128 offset:33792
    ds_read_b64_tr_b16 v[68:69], v129 offset:32768
    ds_read_b64_tr_b16 v[70:71], v129 offset:33792
    ds_read_b64_tr_b16 v[72:73], v130 offset:32768
    ds_read_b64_tr_b16 v[74:75], v130 offset:33792
    ds_read_b64_tr_b16 v[76:77], v131 offset:32768
    ds_read_b64_tr_b16 v[78:79], v131 offset:33792
    ds_read_b64_tr_b16 v[80:81], v132 offset:32768
    ds_read_b64_tr_b16 v[82:83], v132 offset:33792
    ds_read_b64_tr_b16 v[84:85], v133 offset:32768
    ds_read_b64_tr_b16 v[86:87], v133 offset:33792
    ds_read_b64_tr_b16 v[88:89], v134 offset:32768
    ds_read_b64_tr_b16 v[90:91], v134 offset:33792
    s_waitcnt lgkmcnt(12)
    v_mfma_f32_16x16x32_bf16 v[0:3], v[64:67], a[48:51], v[0:3]
    ds_read_b64_tr_b16 v[92:93], v135 offset:32768
    v_mfma_f32_16x16x32_bf16 v[4:7], v[64:67], a[112:115], v[4:7]
    ds_read_b64_tr_b16 v[94:95], v135 offset:33792
    s_add_u32 s26, s24, 0x200000
    s_add_u32 m0, s29, 0x10000
    s_nop 0
    buffer_load_dwordx4 v136, s[16:19], s26 offen lds
    s_waitcnt lgkmcnt(12)
    v_mfma_f32_16x16x32_bf16 v[8:11], v[68:71], a[48:51], v[8:11]
    ds_read_b64_tr_b16 v[96:97], v128 offset:40960
    v_mfma_f32_16x16x32_bf16 v[12:15], v[68:71], a[112:115], v[12:15]
    ds_read_b64_tr_b16 v[98:99], v128 offset:41984
    s_add_u32 s26, s24, 0x220000
    s_add_u32 m0, s29, 0x11000
    s_nop 0
    buffer_load_dwordx4 v136, s[16:19], s26 offen lds
    s_waitcnt lgkmcnt(12)
    v_mfma_f32_16x16x32_bf16 v[16:19], v[72:75], a[48:51], v[16:19]
    ds_read_b64_tr_b16 v[100:101], v129 offset:40960
    v_mfma_f32_16x16x32_bf16 v[20:23], v[72:75], a[112:115], v[20:23]
    ds_read_b64_tr_b16 v[102:103], v129 offset:41984
    s_add_u32 s26, s24, 0x240000
    s_add_u32 m0, s29, 0x12000
    s_nop 0
    buffer_load_dwordx4 v136, s[16:19], s26 offen lds
    s_waitcnt lgkmcnt(12)
    v_mfma_f32_16x16x32_bf16 v[24:27], v[76:79], a[48:51], v[24:27]
    ds_read_b64_tr_b16 v[104:105], v130 offset:40960
    v_mfma_f32_16x16x32_bf16 v[28:31], v[76:79], a[112:115], v[28:31]
    ds_read_b64_tr_b16 v[106:107], v130 offset:41984
    s_add_u32 s26, s24, 0x260000
    s_add_u32 m0, s29, 0x13000
    s_nop 0
    buffer_load_dwordx4 v136, s[16:19], s26 offen lds
    s_waitcnt lgkmcnt(12)
    v_mfma_f32_16x16x32_bf16 v[32:35], v[80:83], a[48:51], v[32:35]
    ds_read_b64_tr_b16 v[108:109], v131 offset:40960
    v_mfma_f32_16x16x32_bf16 v[36:39], v[80:83], a[112:115], v[36:39]
    ds_read_b64_tr_b16 v[110:111], v131 offset:41984
    s_add_u32 s26, s24, 0x280000
    s_add_u32 m0, s29, 0x14000
    s_nop 0
    buffer_load_dwordx4 v136, s[16:19], s26 offen lds
    s_waitcnt lgkmcnt(12)
    v_mfma_f32_16x16x32_bf16 v[40:43], v[84:87], a[48:51], v[40:43]
    ds_read_b64_tr_b16 v[112:113], v132 offset:40960
    v_mfma_f32_16x16x32_bf16 v[44:47], v[84:87], a[112:115], v[44:47]
    ds_read_b64_tr_b16 v[114:115], v132 offset:41984
    s_add_u32 s26, s24, 0x2a0000
    s_add_u32 m0, s29, 0x15000
    s_nop 0
    buffer_load_dwordx4 v136, s[16:19], s26 offen lds
    s_waitcnt lgkmcnt(12)
    v_mfma_f32_16x16x32_bf16 v[48:51], v[88:91], a[48:51], v[48:51]
    ds_read_b64_tr_b16 v[116:117], v133 offset:40960
    v_mfma_f32_16x16x32_bf16 v[52:55], v[88:91], a[112:115], v[52:55]
    ds_read_b64_tr_b16 v[118:119], v133 offset:41984
    s_add_u32 s26, s24, 0x2c0000
    s_add_u32 m0, s29, 0x16000
    s_nop 0
    buffer_load_dwordx4 v136, s[16:19], s26 offen lds
    s_waitcnt lgkmcnt(12)
    v_mfma_f32_16x16x32_bf16 v[56:59], v[92:95], a[48:51], v[56:59]
    ds_read_b64_tr_b16 v[120:121], v134 offset:40960
    v_mfma_f32_16x16x32_bf16 v[60:63], v[92:95], a[112:115], v[60:63]
    ds_read_b64_tr_b16 v[122:123], v134 offset:41984
    s_add_u32 s26, s24, 0x2e0000
    s_add_u32 m0, s29, 0x17000
    s_nop 0
    buffer_load_dwordx4 v136, s[16:19], s26 offen lds
    s_waitcnt lgkmcnt(12)
    v_mfma_f32_16x16x32_bf16 v[0:3], v[96:99], a[52:55], v[0:3]
    ds_read_b64_tr_b16 v[124:125], v135 offset:40960
    v_mfma_f32_16x16x32_bf16 v[4:7], v[96:99], a[116:119], v[4:7]
    ds_read_b64_tr_b16 v[126:127], v135 offset:41984
    s_waitcnt lgkmcnt(12)
    v_mfma_f32_16x16x32_bf16 v[8:11], v[100:103], a[52:55], v[8:11]
    ds_read_b64_tr_b16 v[64:65], v128 offset:49152
    v_mfma_f32_16x16x32_bf16 v[12:15], v[100:103], a[116:119], v[12:15]
    ds_read_b64_tr_b16 v[66:67], v128 offset:50176
    s_waitcnt lgkmcnt(12)
    v_mfma_f32_16x16x32_bf16 v[16:19], v[104:107], a[52:55], v[16:19]
    ds_read_b64_tr_b16 v[68:69], v129 offset:49152
    v_mfma_f32_16x16x32_bf16 v[20:23], v[104:107], a[116:119], v[20:23]
    ds_read_b64_tr_b16 v[70:71], v129 offset:50176
    s_waitcnt lgkmcnt(12)
    v_mfma_f32_16x16x32_bf16 v[24:27], v[108:111], a[52:55], v[24:27]
    ds_read_b64_tr_b16 v[72:73], v130 offset:49152
    v_mfma_f32_16x16x32_bf16 v[28:31], v[108:111], a[116:119], v[28:31]
    ds_read_b64_tr_b16 v[74:75], v130 offset:50176
    s_waitcnt lgkmcnt(12)
    v_mfma_f32_16x16x32_bf16 v[32:35], v[112:115], a[52:55], v[32:35]
    ds_read_b64_tr_b16 v[76:77], v131 offset:49152
    v_mfma_f32_16x16x32_bf16 v[36:39], v[112:115], a[116:119], v[36:39]
    ds_read_b64_tr_b16 v[78:79], v131 offset:50176
    s_waitcnt lgkmcnt(12)
    v_mfma_f32_16x16x32_bf16 v[40:43], v[116:119], a[52:55], v[40:43]
    ds_read_b64_tr_b16 v[80:81], v132 offset:49152
    v_mfma_f32_16x16x32_bf16 v[44:47], v[116:119], a[116:119], v[44:47]
    ds_read_b64_tr_b16 v[82:83], v132 offset:50176
    s_waitcnt lgkmcnt(12)
    v_mfma_f32_16x16x32_bf16 v[48:51], v[120:123], a[52:55], v[48:51]
    ds_read_b64_tr_b16 v[84:85], v133 offset:49152
    v_mfma_f32_16x16x32_bf16 v[52:55], v[120:123], a[116:119], v[52:55]
    ds_read_b64_tr_b16 v[86:87], v133 offset:50176
    s_waitcnt lgkmcnt(12)
    v_mfma_f32_16x16x32_bf16 v[56:59], v[124:127], a[52:55], v[56:59]
    ds_read_b64_tr_b16 v[88:89], v134 offset:49152
    v_mfma_f32_16x16x32_bf16 v[60:63], v[124:127], a[116:119], v[60:63]
    ds_read_b64_tr_b16 v[90:91], v134 offset:50176
    s_waitcnt lgkmcnt(12)
    v_mfma_f32_16x16x32_bf16 v[0:3], v[64:67], a[56:59], v[0:3]
    ds_read_b64_tr_b16 v[92:93], v135 offset:49152
    v_mfma_f32_16x16x32_bf16 v[4:7], v[64:67], a[120:123], v[4:7]
    ds_read_b64_tr_b16 v[94:95], v135 offset:50176
    s_waitcnt lgkmcnt(12)
    v_mfma_f32_16x16x32_bf16 v[8:11], v[68:71], a[56:59], v[8:11]
    ds_read_b64_tr_b16 v[96:97], v128 offset:57344
    v_mfma_f32_16x16x32_bf16 v[12:15], v[68:71], a[120:123], v[12:15]
    ds_read_b64_tr_b16 v[98:99], v128 offset:58368
    s_waitcnt lgkmcnt(12)
    v_mfma_f32_16x16x32_bf16 v[16:19], v[72:75], a[56:59], v[16:19]
    ds_read_b64_tr_b16 v[100:101], v129 offset:57344
    v_mfma_f32_16x16x32_bf16 v[20:23], v[72:75], a[120:123], v[20:23]
    ds_read_b64_tr_b16 v[102:103], v129 offset:58368
    s_waitcnt lgkmcnt(12)
    v_mfma_f32_16x16x32_bf16 v[24:27], v[76:79], a[56:59], v[24:27]
    ds_read_b64_tr_b16 v[104:105], v130 offset:57344
    v_mfma_f32_16x16x32_bf16 v[28:31], v[76:79], a[120:123], v[28:31]
    ds_read_b64_tr_b16 v[106:107], v130 offset:58368
    s_waitcnt lgkmcnt(12)
    v_mfma_f32_16x16x32_bf16 v[32:35], v[80:83], a[56:59], v[32:35]
    ds_read_b64_tr_b16 v[108:109], v131 offset:57344
    v_mfma_f32_16x16x32_bf16 v[36:39], v[80:83], a[120:123], v[36:39]
    ds_read_b64_tr_b16 v[110:111], v131 offset:58368
    s_waitcnt lgkmcnt(12)
    v_mfma_f32_16x16x32_bf16 v[40:43], v[84:87], a[56:59], v[40:43]
    ds_read_b64_tr_b16 v[112:113], v132 offset:57344
    v_mfma_f32_16x16x32_bf16 v[44:47], v[84:87], a[120:123], v[44:47]
    ds_read_b64_tr_b16 v[114:115], v132 offset:58368
    s_waitcnt lgkmcnt(12)
    v_mfma_f32_16x16x32_bf16 v[48:51], v[88:91], a[56:59], v[48:51]
    ds_read_b64_tr_b16 v[116:117], v133 offset:57344
    v_mfma_f32_16x16x32_bf16 v[52:55], v[88:91], a[120:123], v[52:55]
    ds_read_b64_tr_b16 v[118:119], v133 offset:58368
    s_waitcnt lgkmcnt(12)
    v_mfma_f32_16x16x32_bf16 v[56:59], v[92:95], a[56:59], v[56:59]
    ds_read_b64_tr_b16 v[120:121], v134 offset:57344
    v_mfma_f32_16x16x32_bf16 v[60:63], v[92:95], a[120:123], v[60:63]
    ds_read_b64_tr_b16 v[122:123], v134 offset:58368
    s_waitcnt lgkmcnt(12)
    v_mfma_f32_16x16x32_bf16 v[0:3], v[96:99], a[60:63], v[0:3]
    ds_read_b64_tr_b16 v[124:125], v135 offset:57344
    v_mfma_f32_16x16x32_bf16 v[4:7], v[96:99], a[124:127], v[4:7]
    ds_read_b64_tr_b16 v[126:127], v135 offset:58368
    s_waitcnt lgkmcnt(12)
    v_mfma_f32_16x16x32_bf16 v[8:11], v[100:103], a[60:63], v[8:11]
    v_mfma_f32_16x16x32_bf16 v[12:15], v[100:103], a[124:127], v[12:15]
    s_waitcnt lgkmcnt(10)
    v_mfma_f32_16x16x32_bf16 v[16:19], v[104:107], a[60:63], v[16:19]
    v_mfma_f32_16x16x32_bf16 v[20:23], v[104:107], a[124:127], v[20:23]
    s_waitcnt lgkmcnt(8)
    v_mfma_f32_16x16x32_bf16 v[24:27], v[108:111], a[60:63], v[24:27]
    v_mfma_f32_16x16x32_bf16 v[28:31], v[108:111], a[124:127], v[28:31]
    s_waitcnt lgkmcnt(6)
    v_mfma_f32_16x16x32_bf16 v[32:35], v[112:115], a[60:63], v[32:35]
    v_mfma_f32_16x16x32_bf16 v[36:39], v[112:115], a[124:127], v[36:39]
    s_waitcnt lgkmcnt(4)
    v_mfma_f32_16x16x32_bf16 v[40:43], v[116:119], a[60:63], v[40:43]
    v_mfma_f32_16x16x32_bf16 v[44:47], v[116:119], a[124:127], v[44:47]
    s_waitcnt lgkmcnt(2)
    v_mfma_f32_16x16x32_bf16 v[48:51], v[120:123], a[60:63], v[48:51]
    v_mfma_f32_16x16x32_bf16 v[52:55], v[120:123], a[124:127], v[52:55]
    s_waitcnt lgkmcnt(0)
    v_mfma_f32_16x16x32_bf16 v[56:59], v[124:127], a[60:63], v[56:59]
    v_mfma_f32_16x16x32_bf16 v[60:63], v[124:127], a[124:127], v[60:63]
    v_xor_b32 v128, 0x10000, v128
    v_xor_b32 v129, 0x10000, v129
    v_xor_b32 v130, 0x10000, v130
    v_xor_b32 v131, 0x10000, v131
    v_xor_b32 v132, 0x10000, v132
    v_xor_b32 v133, 0x10000, v133
    v_xor_b32 v134, 0x10000, v134
    v_xor_b32 v135, 0x10000, v135
    v_cvt_pk_bf16_f32 v144, v0, v8
    v_cvt_pk_bf16_f32 v145, v1, v9
    v_cvt_pk_bf16_f32 v146, v2, v10
    v_cvt_pk_bf16_f32 v147, v3, v11
    buffer_store_dwordx4 v[144:147], v137, s[8:11], s25 offen sc1
    v_cvt_pk_bf16_f32 v148, v16, v24
    v_cvt_pk_bf16_f32 v149, v17, v25
    v_cvt_pk_bf16_f32 v150, v18, v26
    v_cvt_pk_bf16_f32 v151, v19, v27
    buffer_store_dwordx4 v[148:151], v137, s[8:11], s25 offen offset:1024 sc1
    v_cvt_pk_bf16_f32 v152, v32, v40
    v_cvt_pk_bf16_f32 v153, v33, v41
    v_cvt_pk_bf16_f32 v154, v34, v42
    v_cvt_pk_bf16_f32 v155, v35, v43
    buffer_store_dwordx4 v[152:155], v137, s[8:11], s25 offen offset:2048 sc1
    v_cvt_pk_bf16_f32 v156, v48, v56
    v_cvt_pk_bf16_f32 v157, v49, v57
    v_cvt_pk_bf16_f32 v158, v50, v58
    v_cvt_pk_bf16_f32 v159, v51, v59
    buffer_store_dwordx4 v[156:159], v137, s[8:11], s25 offen offset:3072 sc1
    v_cvt_pk_bf16_f32 v144, v4, v12
    v_cvt_pk_bf16_f32 v145, v5, v13
    v_cvt_pk_bf16_f32 v146, v6, v14
    v_cvt_pk_bf16_f32 v147, v7, v15
    s_add_u32 s25, s25, 4096
    buffer_store_dwordx4 v[144:147], v137, s[8:11], s25 offen sc1
    v_cvt_pk_bf16_f32 v148, v20, v28
    v_cvt_pk_bf16_f32 v149, v21, v29
    v_cvt_pk_bf16_f32 v150, v22, v30
    v_cvt_pk_bf16_f32 v151, v23, v31
    buffer_store_dwordx4 v[148:151], v137, s[8:11], s25 offen offset:1024 sc1
    v_cvt_pk_bf16_f32 v152, v36, v44
    v_cvt_pk_bf16_f32 v153, v37, v45
    v_cvt_pk_bf16_f32 v154, v38, v46
    v_cvt_pk_bf16_f32 v155, v39, v47
    buffer_store_dwordx4 v[152:155], v137, s[8:11], s25 offen offset:2048 sc1
    v_cvt_pk_bf16_f32 v156, v52, v60
    v_cvt_pk_bf16_f32 v157, v53, v61
    v_cvt_pk_bf16_f32 v158, v54, v62
    v_cvt_pk_bf16_f32 v159, v55, v63
    buffer_store_dwordx4 v[156:159], v137, s[8:11], s25 offen offset:3072 sc1
    s_branch L_p1_next
L_p1_v:
    s_waitcnt vmcnt(16)
    s_barrier
    ds_read_b64_tr_b16 v[64:65], v128
    ds_read_b64_tr_b16 v[66:67], v128 offset:1024
    ds_read_b64_tr_b16 v[68:69], v129
    ds_read_b64_tr_b16 v[70:71], v129 offset:1024
    ds_read_b64_tr_b16 v[72:73], v130
    ds_read_b64_tr_b16 v[74:75], v130 offset:1024
    ds_read_b64_tr_b16 v[76:77], v131
    ds_read_b64_tr_b16 v[78:79], v131 offset:1024
    ds_read_b64_tr_b16 v[80:81], v132
    ds_read_b64_tr_b16 v[82:83], v132 offset:1024
    ds_read_b64_tr_b16 v[84:85], v133
    ds_read_b64_tr_b16 v[86:87], v133 offset:1024
    ds_read_b64_tr_b16 v[88:89], v134
    ds_read_b64_tr_b16 v[90:91], v134 offset:1024
    s_waitcnt lgkmcnt(12)
    v_mfma_f32_16x16x32_bf16 v[0:3], a[0:3], v[64:67], 0
    ds_read_b64_tr_b16 v[92:93], v135
    v_mfma_f32_16x16x32_bf16 v[4:7], a[64:67], v[64:67], 0
    ds_read_b64_tr_b16 v[94:95], v135 offset:1024
    s_add_u32 s26, s24, 0x300000
    s_add_u32 m0, s29, 0x18000
    s_nop 0
    buffer_load_dwordx4 v136, s[16:19], s26 offen lds
    s_waitcnt lgkmcnt(12)
    v_mfma_f32_16x16x32_bf16 v[8:11], a[0:3], v[68:71], 0
    ds_read_b64_tr_b16 v[96:97], v128 offset:8192
    v_mfma_f32_16x16x32_bf16 v[12:15], a[64:67], v[68:71], 0
    ds_read_b64_tr_b16 v[98:99], v128 offset:9216
    s_add_u32 s26, s24, 0x320000
    s_add_u32 m0, s29, 0x19000
    s_nop 0
    buffer_load_dwordx4 v136, s[16:19], s26 offen lds
    s_waitcnt lgkmcnt(12)
    v_mfma_f32_16x16x32_bf16 v[16:19], a[0:3], v[72:75], 0
    ds_read_b64_tr_b16 v[100:101], v129 offset:8192
    v_mfma_f32_16x16x32_bf16 v[20:23], a[64:67], v[72:75], 0
    ds_read_b64_tr_b16 v[102:103], v129 offset:9216
    s_add_u32 s26, s24, 0x340000
    s_add_u32 m0, s29, 0x1a000
    s_nop 0
    buffer_load_dwordx4 v136, s[16:19], s26 offen lds
    s_waitcnt lgkmcnt(12)
    v_mfma_f32_16x16x32_bf16 v[24:27], a[0:3], v[76:79], 0
    ds_read_b64_tr_b16 v[104:105], v130 offset:8192
    v_mfma_f32_16x16x32_bf16 v[28:31], a[64:67], v[76:79], 0
    ds_read_b64_tr_b16 v[106:107], v130 offset:9216
    s_add_u32 s26, s24, 0x360000
    s_add_u32 m0, s29, 0x1b000
    s_nop 0
    buffer_load_dwordx4 v136, s[16:19], s26 offen lds
    s_waitcnt lgkmcnt(12)
    v_mfma_f32_16x16x32_bf16 v[32:35], a[0:3], v[80:83], 0
    ds_read_b64_tr_b16 v[108:109], v131 offset:8192
    v_mfma_f32_16x16x32_bf16 v[36:39], a[64:67], v[80:83], 0
    ds_read_b64_tr_b16 v[110:111], v131 offset:9216
    s_add_u32 s26, s24, 0x380000
    s_add_u32 m0, s29, 0x1c000
    s_nop 0
    buffer_load_dwordx4 v136, s[16:19], s26 offen lds
    s_waitcnt lgkmcnt(12)
    v_mfma_f32_16x16x32_bf16 v[40:43], a[0:3], v[84:87], 0
    ds_read_b64_tr_b16 v[112:113], v132 offset:8192
    v_mfma_f32_16x16x32_bf16 v[44:47], a[64:67], v[84:87], 0
    ds_read_b64_tr_b16 v[114:115], v132 offset:9216
    s_add_u32 s26, s24, 0x3a0000
    s_add_u32 m0, s29, 0x1d000
    s_nop 0
    buffer_load_dwordx4 v136, s[16:19], s26 offen lds
    s_waitcnt lgkmcnt(12)
    v_mfma_f32_16x16x32_bf16 v[48:51], a[0:3], v[88:91], 0
    ds_read_b64_tr_b16 v[116:117], v133 offset:8192
    v_mfma_f32_16x16x32_bf16 v[52:55], a[64:67], v[88:91], 0
    ds_read_b64_tr_b16 v[118:119], v133 offset:9216
    s_add_u32 s26, s24, 0x3c0000
    s_add_u32 m0, s29, 0x1e000
    s_nop 0
    buffer_load_dwordx4 v136, s[16:19], s26 offen lds
    s_waitcnt lgkmcnt(12)
    v_mfma_f32_16x16x32_bf16 v[56:59], a[0:3], v[92:95], 0
    ds_read_b64_tr_b16 v[120:121], v134 offset:8192
    v_mfma_f32_16x16x32_bf16 v[60:63], a[64:67], v[92:95], 0
    ds_read_b64_tr_b16 v[122:123], v134 offset:9216
    s_add_u32 s26, s24, 0x3e0000
    s_add_u32 m0, s29, 0x1f000
    s_nop 0
    buffer_load_dwordx4 v136, s[16:19], s26 offen lds
    s_waitcnt lgkmcnt(12)
    v_mfma_f32_16x16x32_bf16 v[0:3], a[4:7], v[96:99], v[0:3]
    ds_read_b64_tr_b16 v[124:125], v135 offset:8192
    v_mfma_f32_16x16x32_bf16 v[4:7], a[68:71], v[96:99], v[4:7]
    ds_read_b64_tr_b16 v[126:127], v135 offset:9216
    s_waitcnt lgkmcnt(12)
    v_mfma_f32_16x16x32_bf16 v[8:11], a[4:7], v[100:103], v[8:11]
    ds_read_b64_tr_b16 v[64:65], v128 offset:16384
    v_mfma_f32_16x16x32_bf16 v[12:15], a[68:71], v[100:103], v[12:15]
    ds_read_b64_tr_b16 v[66:67], v128 offset:17408
    s_waitcnt lgkmcnt(12)
    v_mfma_f32_16x16x32_bf16 v[16:19], a[4:7], v[104:107], v[16:19]
    ds_read_b64_tr_b16 v[68:69], v129 offset:16384
    v_mfma_f32_16x16x32_bf16 v[20:23], a[68:71], v[104:107], v[20:23]
    ds_read_b64_tr_b16 v[70:71], v129 offset:17408
    s_waitcnt lgkmcnt(12)
    v_mfma_f32_16x16x32_bf16 v[24:27], a[4:7], v[108:111], v[24:27]
    ds_read_b64_tr_b16 v[72:73], v130 offset:16384
    v_mfma_f32_16x16x32_bf16 v[28:31], a[68:71], v[108:111], v[28:31]
    ds_read_b64_tr_b16 v[74:75], v130 offset:17408
    s_waitcnt lgkmcnt(12)
    v_mfma_f32_16x16x32_bf16 v[32:35], a[4:7], v[112:115], v[32:35]
    ds_read_b64_tr_b16 v[76:77], v131 offset:16384
    v_mfma_f32_16x16x32_bf16 v[36:39], a[68:71], v[112:115], v[36:39]
    ds_read_b64_tr_b16 v[78:79], v131 offset:17408
    s_waitcnt lgkmcnt(12)
    v_mfma_f32_16x16x32_bf16 v[40:43], a[4:7], v[116:119], v[40:43]
    ds_read_b64_tr_b16 v[80:81], v132 offset:16384
    v_mfma_f32_16x16x32_bf16 v[44:47], a[68:71], v[116:119], v[44:47]
    ds_read_b64_tr_b16 v[82:83], v132 offset:17408
    s_waitcnt lgkmcnt(12)
    v_mfma_f32_16x16x32_bf16 v[48:51], a[4:7], v[120:123], v[48:51]
    ds_read_b64_tr_b16 v[84:85], v133 offset:16384
    v_mfma_f32_16x16x32_bf16 v[52:55], a[68:71], v[120:123], v[52:55]
    ds_read_b64_tr_b16 v[86:87], v133 offset:17408
    s_waitcnt lgkmcnt(12)
    v_mfma_f32_16x16x32_bf16 v[56:59], a[4:7], v[124:127], v[56:59]
    ds_read_b64_tr_b16 v[88:89], v134 offset:16384
    v_mfma_f32_16x16x32_bf16 v[60:63], a[68:71], v[124:127], v[60:63]
    ds_read_b64_tr_b16 v[90:91], v134 offset:17408
    s_waitcnt lgkmcnt(12)
    v_mfma_f32_16x16x32_bf16 v[0:3], a[8:11], v[64:67], v[0:3]
    ds_read_b64_tr_b16 v[92:93], v135 offset:16384
    v_mfma_f32_16x16x32_bf16 v[4:7], a[72:75], v[64:67], v[4:7]
    ds_read_b64_tr_b16 v[94:95], v135 offset:17408
    s_waitcnt lgkmcnt(12)
    v_mfma_f32_16x16x32_bf16 v[8:11], a[8:11], v[68:71], v[8:11]
    ds_read_b64_tr_b16 v[96:97], v128 offset:24576
    v_mfma_f32_16x16x32_bf16 v[12:15], a[72:75], v[68:71], v[12:15]
    ds_read_b64_tr_b16 v[98:99], v128 offset:25600
    s_waitcnt lgkmcnt(12)
    v_mfma_f32_16x16x32_bf16 v[16:19], a[8:11], v[72:75], v[16:19]
    ds_read_b64_tr_b16 v[100:101], v129 offset:24576
    v_mfma_f32_16x16x32_bf16 v[20:23], a[72:75], v[72:75], v[20:23]
    ds_read_b64_tr_b16 v[102:103], v129 offset:25600
    s_waitcnt lgkmcnt(12)
    v_mfma_f32_16x16x32_bf16 v[24:27], a[8:11], v[76:79], v[24:27]
    ds_read_b64_tr_b16 v[104:105], v130 offset:24576
    v_mfma_f32_16x16x32_bf16 v[28:31], a[72:75], v[76:79], v[28:31]
    ds_read_b64_tr_b16 v[106:107], v130 offset:25600
    s_waitcnt lgkmcnt(12)
    v_mfma_f32_16x16x32_bf16 v[32:35], a[8:11], v[80:83], v[32:35]
    ds_read_b64_tr_b16 v[108:109], v131 offset:24576
    v_mfma_f32_16x16x32_bf16 v[36:39], a[72:75], v[80:83], v[36:39]
    ds_read_b64_tr_b16 v[110:111], v131 offset:25600
    s_waitcnt lgkmcnt(12)
    v_mfma_f32_16x16x32_bf16 v[40:43], a[8:11], v[84:87], v[40:43]
    ds_read_b64_tr_b16 v[112:113], v132 offset:24576
    v_mfma_f32_16x16x32_bf16 v[44:47], a[72:75], v[84:87], v[44:47]
    ds_read_b64_tr_b16 v[114:115], v132 offset:25600
    s_waitcnt lgkmcnt(12)
    v_mfma_f32_16x16x32_bf16 v[48:51], a[8:11], v[88:91], v[48:51]
    ds_read_b64_tr_b16 v[116:117], v133 offset:24576
    v_mfma_f32_16x16x32_bf16 v[52:55], a[72:75], v[88:91], v[52:55]
    ds_read_b64_tr_b16 v[118:119], v133 offset:25600
    s_waitcnt lgkmcnt(12)
    v_mfma_f32_16x16x32_bf16 v[56:59], a[8:11], v[92:95], v[56:59]
    ds_read_b64_tr_b16 v[120:121], v134 offset:24576
    v_mfma_f32_16x16x32_bf16 v[60:63], a[72:75], v[92:95], v[60:63]
    ds_read_b64_tr_b16 v[122:123], v134 offset:25600
    s_waitcnt lgkmcnt(12)
    v_mfma_f32_16x16x32_bf16 v[0:3], a[12:15], v[96:99], v[0:3]
    ds_read_b64_tr_b16 v[124:125], v135 offset:24576
    v_mfma_f32_16x16x32_bf16 v[4:7], a[76:79], v[96:99], v[4:7]
    ds_read_b64_tr_b16 v[126:127], v135 offset:25600
    s_waitcnt lgkmcnt(12)
    v_mfma_f32_16x16x32_bf16 v[8:11], a[12:15], v[100:103], v[8:11]
    v_mfma_f32_16x16x32_bf16 v[12:15], a[76:79], v[100:103], v[12:15]
    s_waitcnt lgkmcnt(10)
    v_mfma_f32_16x16x32_bf16 v[16:19], a[12:15], v[104:107], v[16:19]
    v_mfma_f32_16x16x32_bf16 v[20:23], a[76:79], v[104:107], v[20:23]
    s_waitcnt lgkmcnt(8)
    v_mfma_f32_16x16x32_bf16 v[24:27], a[12:15], v[108:111], v[24:27]
    v_mfma_f32_16x16x32_bf16 v[28:31], a[76:79], v[108:111], v[28:31]
    s_waitcnt lgkmcnt(6)
    v_mfma_f32_16x16x32_bf16 v[32:35], a[12:15], v[112:115], v[32:35]
    v_mfma_f32_16x16x32_bf16 v[36:39], a[76:79], v[112:115], v[36:39]
    s_waitcnt lgkmcnt(4)
    v_mfma_f32_16x16x32_bf16 v[40:43], a[12:15], v[116:119], v[40:43]
    v_mfma_f32_16x16x32_bf16 v[44:47], a[76:79], v[116:119], v[44:47]
    s_waitcnt lgkmcnt(2)
    v_mfma_f32_16x16x32_bf16 v[48:51], a[12:15], v[120:123], v[48:51]
    v_mfma_f32_16x16x32_bf16 v[52:55], a[76:79], v[120:123], v[52:55]
    s_waitcnt lgkmcnt(0)
    v_mfma_f32_16x16x32_bf16 v[56:59], a[12:15], v[124:127], v[56:59]
    v_mfma_f32_16x16x32_bf16 v[60:63], a[76:79], v[124:127], v[60:63]
    s_waitcnt vmcnt(16)
    s_barrier
    ds_read_b64_tr_b16 v[64:65], v128 offset:32768
    ds_read_b64_tr_b16 v[66:67], v128 offset:33792
    ds_read_b64_tr_b16 v[68:69], v129 offset:32768
    ds_read_b64_tr_b16 v[70:71], v129 offset:33792
    ds_read_b64_tr_b16 v[72:73], v130 offset:32768
    ds_read_b64_tr_b16 v[74:75], v130 offset:33792
    ds_read_b64_tr_b16 v[76:77], v131 offset:32768
    ds_read_b64_tr_b16 v[78:79], v131 offset:33792
    ds_read_b64_tr_b16 v[80:81], v132 offset:32768
    ds_read_b64_tr_b16 v[82:83], v132 offset:33792
    ds_read_b64_tr_b16 v[84:85], v133 offset:32768
    ds_read_b64_tr_b16 v[86:87], v133 offset:33792
    ds_read_b64_tr_b16 v[88:89], v134 offset:32768
    ds_read_b64_tr_b16 v[90:91], v134 offset:33792
    s_add_u32 s39, s39, s37
    s_lshr_b32 s26, s39, 5
    s_cmp_eq_u32 s26, 0
    s_cselect_b64 s[16:17], s[62:63], s[60:61]
    s_cmp_eq_u32 s26, 1
    s_cselect_b64 s[16:17], s[64:65], s[16:17]
    s_and_b32 s17, s17, 0xffff
    s_cmp_lt_u32 s39, 96
    s_cselect_b32 s18, 0x400000, 0
    s_and_b32 s24, s39, 31
    s_lshl_b32 s24, s24, 8
    s_waitcnt lgkmcnt(12)
    v_mfma_f32_16x16x32_bf16 v[0:3], a[16:19], v[64:67], v[0:3]
    ds_read_b64_tr_b16 v[92:93], v135 offset:32768
    v_mfma_f32_16x16x32_bf16 v[4:7], a[80:83], v[64:67], v[4:7]
    ds_read_b64_tr_b16 v[94:95], v135 offset:33792
    s_add_u32 s26, s24, 0x0
    s_add_u32 m0, s29, 0x0
    s_nop 0
    buffer_load_dwordx4 v136, s[16:19], s26 offen lds
    s_waitcnt lgkmcnt(12)
    v_mfma_f32_16x16x32_bf16 v[8:11], a[16:19], v[68:71], v[8:11]
    ds_read_b64_tr_b16 v[96:97], v128 offset:40960
    v_mfma_f32_16x16x32_bf16 v[12:15], a[80:83], v[68:71], v[12:15]
    ds_read_b64_tr_b16 v[98:99], v128 offset:41984
    s_add_u32 s26, s24, 0x20000
    s_add_u32 m0, s29, 0x1000
    s_nop 0
    buffer_load_dwordx4 v136, s[16:19], s26 offen lds
    s_waitcnt lgkmcnt(12)
    v_mfma_f32_16x16x32_bf16 v[16:19], a[16:19], v[72:75], v[16:19]
    ds_read_b64_tr_b16 v[100:101], v129 offset:40960
    v_mfma_f32_16x16x32_bf16 v[20:23], a[80:83], v[72:75], v[20:23]
    ds_read_b64_tr_b16 v[102:103], v129 offset:41984
    s_add_u32 s26, s24, 0x40000
    s_add_u32 m0, s29, 0x2000
    s_nop 0
    buffer_load_dwordx4 v136, s[16:19], s26 offen lds
    s_waitcnt lgkmcnt(12)
    v_mfma_f32_16x16x32_bf16 v[24:27], a[16:19], v[76:79], v[24:27]
    ds_read_b64_tr_b16 v[104:105], v130 offset:40960
    v_mfma_f32_16x16x32_bf16 v[28:31], a[80:83], v[76:79], v[28:31]
    ds_read_b64_tr_b16 v[106:107], v130 offset:41984
    s_add_u32 s26, s24, 0x60000
    s_add_u32 m0, s29, 0x3000
    s_nop 0
    buffer_load_dwordx4 v136, s[16:19], s26 offen lds
    s_waitcnt lgkmcnt(12)
    v_mfma_f32_16x16x32_bf16 v[32:35], a[16:19], v[80:83], v[32:35]
    ds_read_b64_tr_b16 v[108:109], v131 offset:40960
    v_mfma_f32_16x16x32_bf16 v[36:39], a[80:83], v[80:83], v[36:39]
    ds_read_b64_tr_b16 v[110:111], v131 offset:41984
    s_add_u32 s26, s24, 0x80000
    s_add_u32 m0, s29, 0x4000
    s_nop 0
    buffer_load_dwordx4 v136, s[16:19], s26 offen lds
    s_waitcnt lgkmcnt(12)
    v_mfma_f32_16x16x32_bf16 v[40:43], a[16:19], v[84:87], v[40:43]
    ds_read_b64_tr_b16 v[112:113], v132 offset:40960
    v_mfma_f32_16x16x32_bf16 v[44:47], a[80:83], v[84:87], v[44:47]
    ds_read_b64_tr_b16 v[114:115], v132 offset:41984
    s_add_u32 s26, s24, 0xa0000
    s_add_u32 m0, s29, 0x5000
    s_nop 0
    buffer_load_dwordx4 v136, s[16:19], s26 offen lds
    s_waitcnt lgkmcnt(12)
    v_mfma_f32_16x16x32_bf16 v[48:51], a[16:19], v[88:91], v[48:51]
    ds_read_b64_tr_b16 v[116:117], v133 offset:40960
    v_mfma_f32_16x16x32_bf16 v[52:55], a[80:83], v[88:91], v[52:55]
    ds_read_b64_tr_b16 v[118:119], v133 offset:41984
    s_add_u32 s26, s24, 0xc0000
    s_add_u32 m0, s29, 0x6000
    s_nop 0
    buffer_load_dwordx4 v136, s[16:19], s26 offen lds
    s_waitcnt lgkmcnt(12)
    v_mfma_f32_16x16x32_bf16 v[56:59], a[16:19], v[92:95], v[56:59]
    ds_read_b64_tr_b16 v[120:121], v134 offset:40960
    v_mfma_f32_16x16x32_bf16 v[60:63], a[80:83], v[92:95], v[60:63]
    ds_read_b64_tr_b16 v[122:123], v134 offset:41984
    s_add_u32 s26, s24, 0xe0000
    s_add_u32 m0, s29, 0x7000
    s_nop 0
    buffer_load_dwordx4 v136, s[16:19], s26 offen lds
    s_waitcnt lgkmcnt(12)
    v_mfma_f32_16x16x32_bf16 v[0:3], a[20:23], v[96:99], v[0:3]
    ds_read_b64_tr_b16 v[124:125], v135 offset:40960
    v_mfma_f32_16x16x32_bf16 v[4:7], a[84:87], v[96:99], v[4:7]
    ds_read_b64_tr_b16 v[126:127], v135 offset:41984
    s_waitcnt lgkmcnt(12)
    v_mfma_f32_16x16x32_bf16 v[8:11], a[20:23], v[100:103], v[8:11]
    ds_read_b64_tr_b16 v[64:65], v128 offset:49152
    v_mfma_f32_16x16x32_bf16 v[12:15], a[84:87], v[100:103], v[12:15]
    ds_read_b64_tr_b16 v[66:67], v128 offset:50176
    s_waitcnt lgkmcnt(12)
    v_mfma_f32_16x16x32_bf16 v[16:19], a[20:23], v[104:107], v[16:19]
    ds_read_b64_tr_b16 v[68:69], v129 offset:49152
    v_mfma_f32_16x16x32_bf16 v[20:23], a[84:87], v[104:107], v[20:23]
    ds_read_b64_tr_b16 v[70:71], v129 offset:50176
    s_waitcnt lgkmcnt(12)
    v_mfma_f32_16x16x32_bf16 v[24:27], a[20:23], v[108:111], v[24:27]
    ds_read_b64_tr_b16 v[72:73], v130 offset:49152
    v_mfma_f32_16x16x32_bf16 v[28:31], a[84:87], v[108:111], v[28:31]
    ds_read_b64_tr_b16 v[74:75], v130 offset:50176
    s_waitcnt lgkmcnt(12)
    v_mfma_f32_16x16x32_bf16 v[32:35], a[20:23], v[112:115], v[32:35]
    ds_read_b64_tr_b16 v[76:77], v131 offset:49152
    v_mfma_f32_16x16x32_bf16 v[36:39], a[84:87], v[112:115], v[36:39]
    ds_read_b64_tr_b16 v[78:79], v131 offset:50176
    s_waitcnt lgkmcnt(12)
    v_mfma_f32_16x16x32_bf16 v[40:43], a[20:23], v[116:119], v[40:43]
    ds_read_b64_tr_b16 v[80:81], v132 offset:49152
    v_mfma_f32_16x16x32_bf16 v[44:47], a[84:87], v[116:119], v[44:47]
    ds_read_b64_tr_b16 v[82:83], v132 offset:50176
    s_waitcnt lgkmcnt(12)
    v_mfma_f32_16x16x32_bf16 v[48:51], a[20:23], v[120:123], v[48:51]
    ds_read_b64_tr_b16 v[84:85], v133 offset:49152
    v_mfma_f32_16x16x32_bf16 v[52:55], a[84:87], v[120:123], v[52:55]
    ds_read_b64_tr_b16 v[86:87], v133 offset:50176
    s_waitcnt lgkmcnt(12)
    v_mfma_f32_16x16x32_bf16 v[56:59], a[20:23], v[124:127], v[56:59]
    ds_read_b64_tr_b16 v[88:89], v134 offset:49152
    v_mfma_f32_16x16x32_bf16 v[60:63], a[84:87], v[124:127], v[60:63]
    ds_read_b64_tr_b16 v[90:91], v134 offset:50176
    s_waitcnt lgkmcnt(12)
    v_mfma_f32_16x16x32_bf16 v[0:3], a[24:27], v[64:67], v[0:3]
    ds_read_b64_tr_b16 v[92:93], v135 offset:49152
    v_mfma_f32_16x16x32_bf16 v[4:7], a[88:91], v[64:67], v[4:7]
    ds_read_b64_tr_b16 v[94:95], v135 offset:50176
    s_waitcnt lgkmcnt(12)
    v_mfma_f32_16x16x32_bf16 v[8:11], a[24:27], v[68:71], v[8:11]
    ds_read_b64_tr_b16 v[96:97], v128 offset:57344
    v_mfma_f32_16x16x32_bf16 v[12:15], a[88:91], v[68:71], v[12:15]
    ds_read_b64_tr_b16 v[98:99], v128 offset:58368
    s_waitcnt lgkmcnt(12)
    v_mfma_f32_16x16x32_bf16 v[16:19], a[24:27], v[72:75], v[16:19]
    ds_read_b64_tr_b16 v[100:101], v129 offset:57344
    v_mfma_f32_16x16x32_bf16 v[20:23], a[88:91], v[72:75], v[20:23]
    ds_read_b64_tr_b16 v[102:103], v129 offset:58368
    s_waitcnt lgkmcnt(12)
    v_mfma_f32_16x16x32_bf16 v[24:27], a[24:27], v[76:79], v[24:27]
    ds_read_b64_tr_b16 v[104:105], v130 offset:57344
    v_mfma_f32_16x16x32_bf16 v[28:31], a[88:91], v[76:79], v[28:31]
    ds_read_b64_tr_b16 v[106:107], v130 offset:58368
    s_waitcnt lgkmcnt(12)
    v_mfma_f32_16x16x32_bf16 v[32:35], a[24:27], v[80:83], v[32:35]
    ds_read_b64_tr_b16 v[108:109], v131 offset:57344
    v_mfma_f32_16x16x32_bf16 v[36:39], a[88:91], v[80:83], v[36:39]
    ds_read_b64_tr_b16 v[110:111], v131 offset:58368
    s_waitcnt lgkmcnt(12)
    v_mfma_f32_16x16x32_bf16 v[40:43], a[24:27], v[84:87], v[40:43]
    ds_read_b64_tr_b16 v[112:113], v132 offset:57344
    v_mfma_f32_16x16x32_bf16 v[44:47], a[88:91], v[84:87], v[44:47]
    ds_read_b64_tr_b16 v[114:115], v132 offset:58368
    s_waitcnt lgkmcnt(12)
    v_mfma_f32_16x16x32_bf16 v[48:51], a[24:27], v[88:91], v[48:51]
    ds_read_b64_tr_b16 v[116:117], v133 offset:57344
    v_mfma_f32_16x16x32_bf16 v[52:55], a[88:91], v[88:91], v[52:55]
    ds_read_b64_tr_b16 v[118:119], v133 offset:58368
    s_waitcnt lgkmcnt(12)
    v_mfma_f32_16x16x32_bf16 v[56:59], a[24:27], v[92:95], v[56:59]
    ds_read_b64_tr_b16 v[120:121], v134 offset:57344
    v_mfma_f32_16x16x32_bf16 v[60:63], a[88:91], v[92:95], v[60:63]
    ds_read_b64_tr_b16 v[122:123], v134 offset:58368
    s_waitcnt lgkmcnt(12)
    v_mfma_f32_16x16x32_bf16 v[0:3], a[28:31], v[96:99], v[0:3]
    ds_read_b64_tr_b16 v[124:125], v135 offset:57344
    v_mfma_f32_16x16x32_bf16 v[4:7], a[92:95], v[96:99], v[4:7]
    ds_read_b64_tr_b16 v[126:127], v135 offset:58368
    s_waitcnt lgkmcnt(12)
    v_mfma_f32_16x16x32_bf16 v[8:11], a[28:31], v[100:103], v[8:11]
    v_mfma_f32_16x16x32_bf16 v[12:15], a[92:95], v[100:103], v[12:15]
    s_waitcnt lgkmcnt(10)
    v_mfma_f32_16x16x32_bf16 v[16:19], a[28:31], v[104:107], v[16:19]
    v_mfma_f32_16x16x32_bf16 v[20:23], a[92:95], v[104:107], v[20:23]
    s_waitcnt lgkmcnt(8)
    v_mfma_f32_16x16x32_bf16 v[24:27], a[28:31], v[108:111], v[24:27]
    v_mfma_f32_16x16x32_bf16 v[28:31], a[92:95], v[108:111], v[28:31]
    s_waitcnt lgkmcnt(6)
    v_mfma_f32_16x16x32_bf16 v[32:35], a[28:31], v[112:115], v[32:35]
    v_mfma_f32_16x16x32_bf16 v[36:39], a[92:95], v[112:115], v[36:39]
    s_waitcnt lgkmcnt(4)
    v_mfma_f32_16x16x32_bf16 v[40:43], a[28:31], v[116:119], v[40:43]
    v_mfma_f32_16x16x32_bf16 v[44:47], a[92:95], v[116:119], v[44:47]
    s_waitcnt lgkmcnt(2)
    v_mfma_f32_16x16x32_bf16 v[48:51], a[28:31], v[120:123], v[48:51]
    v_mfma_f32_16x16x32_bf16 v[52:55], a[92:95], v[120:123], v[52:55]
    s_waitcnt lgkmcnt(0)
    v_mfma_f32_16x16x32_bf16 v[56:59], a[28:31], v[124:127], v[56:59]
    v_mfma_f32_16x16x32_bf16 v[60:63], a[92:95], v[124:127], v[60:63]
    v_xor_b32 v128, 0x10000, v128
    v_xor_b32 v129, 0x10000, v129
    v_xor_b32 v130, 0x10000, v130
    v_xor_b32 v131, 0x10000, v131
    v_xor_b32 v132, 0x10000, v132
    v_xor_b32 v133, 0x10000, v133
    v_xor_b32 v134, 0x10000, v134
    v_xor_b32 v135, 0x10000, v135
    s_waitcnt vmcnt(16)
    s_barrier
    ds_read_b64_tr_b16 v[64:65], v128
    ds_read_b64_tr_b16 v[66:67], v128 offset:1024
    ds_read_b64_tr_b16 v[68:69], v129
    ds_read_b64_tr_b16 v[70:71], v129 offset:1024
    ds_read_b64_tr_b16 v[72:73], v130
    ds_read_b64_tr_b16 v[74:75], v130 offset:1024
    ds_read_b64_tr_b16 v[76:77], v131
    ds_read_b64_tr_b16 v[78:79], v131 offset:1024
    ds_read_b64_tr_b16 v[80:81], v132
    ds_read_b64_tr_b16 v[82:83], v132 offset:1024
    ds_read_b64_tr_b16 v[84:85], v133
    ds_read_b64_tr_b16 v[86:87], v133 offset:1024
    ds_read_b64_tr_b16 v[88:89], v134
    ds_read_b64_tr_b16 v[90:91], v134 offset:1024
    s_cmp_eq_u32 s40, 0
    s_cbranch_scc1 L_nopf_96
    s_cmp_lg_u32 s87, 0
    s_cbranch_scc1 L_modeok_97
    v_readfirstlane_b32 s96, v140
    v_readfirstlane_b32 s97, v141
    s_nop 0
    s_cmp_lg_u32 s97, 0
    s_cselect_b32 s87, s96, 0
    s_cmp_eq_u32 s87, 1
    s_cbranch_scc1 L_modeok_97
    s_mov_b32 s96, 0
L_mode_98:
    buffer_load_dwordx2 v[140:141], off, s[92:95], 0 offset:36 sc1
    s_waitcnt vmcnt(0)
    v_readfirstlane_b32 s87, v140
    v_readfirstlane_b32 s97, v141
    s_nop 0
    s_min_u32 s97, s97, s87
    s_cmp_lg_u32 s97, 0
    s_cbranch_scc1 L_moded_99
    s_sleep 4
    s_add_u32 s96, s96, 1
    s_cmp_lg_u32 s96, 0x100
    s_cbranch_scc1 L_modef_100
    v_mov_b32 v140, 2
    v_mov_b32 v141, 0
    s_mov_b64 exec, 1
    buffer_atomic_cmpswap v[140:141], off, s[92:95], 0 offset:36
    s_mov_b64 exec, -1
L_modef_100:
    s_cmp_lt_u32 s96, 0x10000
    s_cbranch_scc1 L_mode_98
L_moded_99:
    s_cmp_lg_u32 s87, 1
    s_cbranch_scc1 L_fallback
L_modeok_97:
    s_cmp_lg_u32 s100, 0
    s_cbranch_scc1 L_flag_101
    v_mov_b32 v138, 1
    s_mov_b64 exec, 1
    buffer_store_dword v138, off, s[8:11], s40 sc1
    s_mov_b64 exec, -1
L_flag_101:
    s_mov_b32 s40, 0
L_nopf_96:
    s_waitcnt lgkmcnt(12)
    v_mfma_f32_16x16x32_bf16 v[0:3], a[32:35], v[64:67], v[0:3]
    ds_read_b64_tr_b16 v[92:93], v135
    v_mfma_f32_16x16x32_bf16 v[4:7], a[96:99], v[64:67], v[4:7]
    ds_read_b64_tr_b16 v[94:95], v135 offset:1024
    s_add_u32 s26, s24, 0x100000
    s_add_u32 m0, s29, 0x8000
    s_nop 0
    buffer_load_dwordx4 v136, s[16:19], s26 offen lds
    s_waitcnt lgkmcnt(12)
    v_mfma_f32_16x16x32_bf16 v[8:11], a[32:35], v[68:71], v[8:11]
    ds_read_b64_tr_b16 v[96:97], v128 offset:8192
    v_mfma_f32_16x16x32_bf16 v[12:15], a[96:99], v[68:71], v[12:15]
    ds_read_b64_tr_b16 v[98:99], v128 offset:9216
    s_add_u32 s26, s24, 0x120000
    s_add_u32 m0, s29, 0x9000
    s_nop 0
    buffer_load_dwordx4 v136, s[16:19], s26 offen lds
    s_waitcnt lgkmcnt(12)
    v_mfma_f32_16x16x32_bf16 v[16:19], a[32:35], v[72:75], v[16:19]
    ds_read_b64_tr_b16 v[100:101], v129 offset:8192
    v_mfma_f32_16x16x32_bf16 v[20:23], a[96:99], v[72:75], v[20:23]
    ds_read_b64_tr_b16 v[102:103], v129 offset:9216
    s_add_u32 s26, s24, 0x140000
    s_add_u32 m0, s29, 0xa000
    s_nop 0
    buffer_load_dwordx4 v136, s[16:19], s26 offen lds
    s_waitcnt lgkmcnt(12)
    v_mfma_f32_16x16x32_bf16 v[24:27], a[32:35], v[76:79], v[24:27]
    ds_read_b64_tr_b16 v[104:105], v130 offset:8192
    v_mfma_f32_16x16x32_bf16 v[28:31], a[96:99], v[76:79], v[28:31]
    ds_read_b64_tr_b16 v[106:107], v130 offset:9216
    s_add_u32 s26, s24, 0x160000
    s_add_u32 m0, s29, 0xb000
    s_nop 0
    buffer_load_dwordx4 v136, s[16:19], s26 offen lds
    s_waitcnt lgkmcnt(12)
    v_mfma_f32_16x16x32_bf16 v[32:35], a[32:35], v[80:83], v[32:35]
    ds_read_b64_tr_b16 v[108:109], v131 offset:8192
    v_mfma_f32_16x16x32_bf16 v[36:39], a[96:99], v[80:83], v[36:39]
    ds_read_b64_tr_b16 v[110:111], v131 offset:9216
    s_add_u32 s26, s24, 0x180000
    s_add_u32 m0, s29, 0xc000
    s_nop 0
    buffer_load_dwordx4 v136, s[16:19], s26 offen lds
    s_waitcnt lgkmcnt(12)
    v_mfma_f32_16x16x32_bf16 v[40:43], a[32:35], v[84:87], v[40:43]
    ds_read_b64_tr_b16 v[112:113], v132 offset:8192
    v_mfma_f32_16x16x32_bf16 v[44:47], a[96:99], v[84:87], v[44:47]
    ds_read_b64_tr_b16 v[114:115], v132 offset:9216
    s_add_u32 s26, s24, 0x1a0000
    s_add_u32 m0, s29, 0xd000
    s_nop 0
    buffer_load_dwordx4 v136, s[16:19], s26 offen lds
    s_waitcnt lgkmcnt(12)
    v_mfma_f32_16x16x32_bf16 v[48:51], a[32:35], v[88:91], v[48:51]
    ds_read_b64_tr_b16 v[116:117], v133 offset:8192
    v_mfma_f32_16x16x32_bf16 v[52:55], a[96:99], v[88:91], v[52:55]
    ds_read_b64_tr_b16 v[118:119], v133 offset:9216
    s_add_u32 s26, s24, 0x1c0000
    s_add_u32 m0, s29, 0xe000
    s_nop 0
    buffer_load_dwordx4 v136, s[16:19], s26 offen lds
    s_waitcnt lgkmcnt(12)
    v_mfma_f32_16x16x32_bf16 v[56:59], a[32:35], v[92:95], v[56:59]
    ds_read_b64_tr_b16 v[120:121], v134 offset:8192
    v_mfma_f32_16x16x32_bf16 v[60:63], a[96:99], v[92:95], v[60:63]
    ds_read_b64_tr_b16 v[122:123], v134 offset:9216
    s_add_u32 s26, s24, 0x1e0000
    s_add_u32 m0, s29, 0xf000
    s_nop 0
    buffer_load_dwordx4 v136, s[16:19], s26 offen lds
    s_waitcnt lgkmcnt(12)
    v_mfma_f32_16x16x32_bf16 v[0:3], a[36:39], v[96:99], v[0:3]
    ds_read_b64_tr_b16 v[124:125], v135 offset:8192
    v_mfma_f32_16x16x32_bf16 v[4:7], a[100:103], v[96:99], v[4:7]
    ds_read_b64_tr_b16 v[126:127], v135 offset:9216
    s_waitcnt lgkmcnt(12)
    v_mfma_f32_16x16x32_bf16 v[8:11], a[36:39], v[100:103], v[8:11]
    ds_read_b64_tr_b16 v[64:65], v128 offset:16384
    v_mfma_f32_16x16x32_bf16 v[12:15], a[100:103], v[100:103], v[12:15]
    ds_read_b64_tr_b16 v[66:67], v128 offset:17408
    s_waitcnt lgkmcnt(12)
    v_mfma_f32_16x16x32_bf16 v[16:19], a[36:39], v[104:107], v[16:19]
    ds_read_b64_tr_b16 v[68:69], v129 offset:16384
    v_mfma_f32_16x16x32_bf16 v[20:23], a[100:103], v[104:107], v[20:23]
    ds_read_b64_tr_b16 v[70:71], v129 offset:17408
    s_waitcnt lgkmcnt(12)
    v_mfma_f32_16x16x32_bf16 v[24:27], a[36:39], v[108:111], v[24:27]
    ds_read_b64_tr_b16 v[72:73], v130 offset:16384
    v_mfma_f32_16x16x32_bf16 v[28:31], a[100:103], v[108:111], v[28:31]
    ds_read_b64_tr_b16 v[74:75], v130 offset:17408
    s_waitcnt lgkmcnt(12)
    v_mfma_f32_16x16x32_bf16 v[32:35], a[36:39], v[112:115], v[32:35]
    ds_read_b64_tr_b16 v[76:77], v131 offset:16384
    v_mfma_f32_16x16x32_bf16 v[36:39], a[100:103], v[112:115], v[36:39]
    ds_read_b64_tr_b16 v[78:79], v131 offset:17408
    s_waitcnt lgkmcnt(12)
    v_mfma_f32_16x16x32_bf16 v[40:43], a[36:39], v[116:119], v[40:43]
    ds_read_b64_tr_b16 v[80:81], v132 offset:16384
    v_mfma_f32_16x16x32_bf16 v[44:47], a[100:103], v[116:119], v[44:47]
    ds_read_b64_tr_b16 v[82:83], v132 offset:17408
    s_waitcnt lgkmcnt(12)
    v_mfma_f32_16x16x32_bf16 v[48:51], a[36:39], v[120:123], v[48:51]
    ds_read_b64_tr_b16 v[84:85], v133 offset:16384
    v_mfma_f32_16x16x32_bf16 v[52:55], a[100:103], v[120:123], v[52:55]
    ds_read_b64_tr_b16 v[86:87], v133 offset:17408
    s_waitcnt lgkmcnt(12)
    v_mfma_f32_16x16x32_bf16 v[56:59], a[36:39], v[124:127], v[56:59]
    ds_read_b64_tr_b16 v[88:89], v134 offset:16384
    v_mfma_f32_16x16x32_bf16 v[60:63], a[100:103], v[124:127], v[60:63]
    ds_read_b64_tr_b16 v[90:91], v134 offset:17408
    s_waitcnt lgkmcnt(12)
    v_mfma_f32_16x16x32_bf16 v[0:3], a[40:43], v[64:67], v[0:3]
    ds_read_b64_tr_b16 v[92:93], v135 offset:16384
    v_mfma_f32_16x16x32_bf16 v[4:7], a[104:107], v[64:67], v[4:7]
    ds_read_b64_tr_b16 v[94:95], v135 offset:17408
    s_waitcnt lgkmcnt(12)
    v_mfma_f32_16x16x32_bf16 v[8:11], a[40:43], v[68:71], v[8:11]
    ds_read_b64_tr_b16 v[96:97], v128 offset:24576
    v_mfma_f32_16x16x32_bf16 v[12:15], a[104:107], v[68:71], v[12:15]
    ds_read_b64_tr_b16 v[98:99], v128 offset:25600
    s_waitcnt lgkmcnt(12)
    v_mfma_f32_16x16x32_bf16 v[16:19], a[40:43], v[72:75], v[16:19]
    ds_read_b64_tr_b16 v[100:101], v129 offset:24576
    v_mfma_f32_16x16x32_bf16 v[20:23], a[104:107], v[72:75], v[20:23]
    ds_read_b64_tr_b16 v[102:103], v129 offset:25600
    s_waitcnt lgkmcnt(12)
    v_mfma_f32_16x16x32_bf16 v[24:27], a[40:43], v[76:79], v[24:27]
    ds_read_b64_tr_b16 v[104:105], v130 offset:24576
    v_mfma_f32_16x16x32_bf16 v[28:31], a[104:107], v[76:79], v[28:31]
    ds_read_b64_tr_b16 v[106:107], v130 offset:25600
    s_waitcnt lgkmcnt(12)
    v_mfma_f32_16x16x32_bf16 v[32:35], a[40:43], v[80:83], v[32:35]
    ds_read_b64_tr_b16 v[108:109], v131 offset:24576
    v_mfma_f32_16x16x32_bf16 v[36:39], a[104:107], v[80:83], v[36:39]
    ds_read_b64_tr_b16 v[110:111], v131 offset:25600
    s_waitcnt lgkmcnt(12)
    v_mfma_f32_16x16x32_bf16 v[40:43], a[40:43], v[84:87], v[40:43]
    ds_read_b64_tr_b16 v[112:113], v132 offset:24576
    v_mfma_f32_16x16x32_bf16 v[44:47], a[104:107], v[84:87], v[44:47]
    ds_read_b64_tr_b16 v[114:115], v132 offset:25600
    s_waitcnt lgkmcnt(12)
    v_mfma_f32_16x16x32_bf16 v[48:51], a[40:43], v[88:91], v[48:51]
    ds_read_b64_tr_b16 v[116:117], v133 offset:24576
    v_mfma_f32_16x16x32_bf16 v[52:55], a[104:107], v[88:91], v[52:55]
    ds_read_b64_tr_b16 v[118:119], v133 offset:25600
    s_waitcnt lgkmcnt(12)
    v_mfma_f32_16x16x32_bf16 v[56:59], a[40:43], v[92:95], v[56:59]
    ds_read_b64_tr_b16 v[120:121], v134 offset:24576
    v_mfma_f32_16x16x32_bf16 v[60:63], a[104:107], v[92:95], v[60:63]
    ds_read_b64_tr_b16 v[122:123], v134 offset:25600
    s_waitcnt lgkmcnt(12)
    v_mfma_f32_16x16x32_bf16 v[0:3], a[44:47], v[96:99], v[0:3]
    ds_read_b64_tr_b16 v[124:125], v135 offset:24576
    v_mfma_f32_16x16x32_bf16 v[4:7], a[108:111], v[96:99], v[4:7]
    ds_read_b64_tr_b16 v[126:127], v135 offset:25600
    s_waitcnt lgkmcnt(12)
    v_mfma_f32_16x16x32_bf16 v[8:11], a[44:47], v[100:103], v[8:11]
    v_mfma_f32_16x16x32_bf16 v[12:15], a[108:111], v[100:103], v[12:15]
    s_waitcnt lgkmcnt(10)
    v_mfma_f32_16x16x32_bf16 v[16:19], a[44:47], v[104:107], v[16:19]
    v_mfma_f32_16x16x32_bf16 v[20:23], a[108:111], v[104:107], v[20:23]
    s_waitcnt lgkmcnt(8)
    v_mfma_f32_16x16x32_bf16 v[24:27], a[44:47], v[108:111], v[24:27]
    v_mfma_f32_16x16x32_bf16 v[28:31], a[108:111], v[108:111], v[28:31]
    s_waitcnt lgkmcnt(6)
    v_mfma_f32_16x16x32_bf16 v[32:35], a[44:47], v[112:115], v[32:35]
    v_mfma_f32_16x16x32_bf16 v[36:39], a[108:111], v[112:115], v[36:39]
    s_waitcnt lgkmcnt(4)
    v_mfma_f32_16x16x32_bf16 v[40:43], a[44:47], v[116:119], v[40:43]
    v_mfma_f32_16x16x32_bf16 v[44:47], a[108:111], v[116:119], v[44:47]
    s_waitcnt lgkmcnt(2)
    v_mfma_f32_16x16x32_bf16 v[48:51], a[44:47], v[120:123], v[48:51]
    v_mfma_f32_16x16x32_bf16 v[52:55], a[108:111], v[120:123], v[52:55]
    s_waitcnt lgkmcnt(0)
    v_mfma_f32_16x16x32_bf16 v[56:59], a[44:47], v[124:127], v[56:59]
    v_mfma_f32_16x16x32_bf16 v[60:63], a[108:111], v[124:127], v[60:63]
    s_waitcnt vmcnt(16)
    s_barrier
    ds_read_b64_tr_b16 v[64:65], v128 offset:32768
    ds_read_b64_tr_b16 v[66:67], v128 offset:33792
    ds_read_b64_tr_b16 v[68:69], v129 offset:32768
    ds_read_b64_tr_b16 v[70:71], v129 offset:33792
    ds_read_b64_tr_b16 v[72:73], v130 offset:32768
    ds_read_b64_tr_b16 v[74:75], v130 offset:33792
    ds_read_b64_tr_b16 v[76:77], v131 offset:32768
    ds_read_b64_tr_b16 v[78:79], v131 offset:33792
    ds_read_b64_tr_b16 v[80:81], v132 offset:32768
    ds_read_b64_tr_b16 v[82:83], v132 offset:33792
    ds_read_b64_tr_b16 v[84:85], v133 offset:32768
    ds_read_b64_tr_b16 v[86:87], v133 offset:33792
    ds_read_b64_tr_b16 v[88:89], v134 offset:32768
    ds_read_b64_tr_b16 v[90:91], v134 offset:33792
    s_waitcnt lgkmcnt(12)
    v_mfma_f32_16x16x32_bf16 v[0:3], a[48:51], v[64:67], v[0:3]
    ds_read_b64_tr_b16 v[92:93], v135 offset:32768
    v_mfma_f32_16x16x32_bf16 v[4:7], a[112:115], v[64:67], v[4:7]
    ds_read_b64_tr_b16 v[94:95], v135 offset:33792
    s_add_u32 s26, s24, 0x200000
    s_add_u32 m0, s29, 0x10000
    s_nop 0
    buffer_load_dwordx4 v136, s[16:19], s26 offen lds
    s_waitcnt lgkmcnt(12)
    v_mfma_f32_16x16x32_bf16 v[8:11], a[48:51], v[68:71], v[8:11]
    ds_read_b64_tr_b16 v[96:97], v128 offset:40960
    v_mfma_f32_16x16x32_bf16 v[12:15], a[112:115], v[68:71], v[12:15]
    ds_read_b64_tr_b16 v[98:99], v128 offset:41984
    s_add_u32 s26, s24, 0x220000
    s_add_u32 m0, s29, 0x11000
    s_nop 0
    buffer_load_dwordx4 v136, s[16:19], s26 offen lds
    s_waitcnt lgkmcnt(12)
    v_mfma_f32_16x16x32_bf16 v[16:19], a[48:51], v[72:75], v[16:19]
    ds_read_b64_tr_b16 v[100:101], v129 offset:40960
    v_mfma_f32_16x16x32_bf16 v[20:23], a[112:115], v[72:75], v[20:23]
    ds_read_b64_tr_b16 v[102:103], v129 offset:41984
    s_add_u32 s26, s24, 0x240000
    s_add_u32 m0, s29, 0x12000
    s_nop 0
    buffer_load_dwordx4 v136, s[16:19], s26 offen lds
    s_waitcnt lgkmcnt(12)
    v_mfma_f32_16x16x32_bf16 v[24:27], a[48:51], v[76:79], v[24:27]
    ds_read_b64_tr_b16 v[104:105], v130 offset:40960
    v_mfma_f32_16x16x32_bf16 v[28:31], a[112:115], v[76:79], v[28:31]
    ds_read_b64_tr_b16 v[106:107], v130 offset:41984
    s_add_u32 s26, s24, 0x260000
    s_add_u32 m0, s29, 0x13000
    s_nop 0
    buffer_load_dwordx4 v136, s[16:19], s26 offen lds
    s_waitcnt lgkmcnt(12)
    v_mfma_f32_16x16x32_bf16 v[32:35], a[48:51], v[80:83], v[32:35]
    ds_read_b64_tr_b16 v[108:109], v131 offset:40960
    v_mfma_f32_16x16x32_bf16 v[36:39], a[112:115], v[80:83], v[36:39]
    ds_read_b64_tr_b16 v[110:111], v131 offset:41984
    s_add_u32 s26, s24, 0x280000
    s_add_u32 m0, s29, 0x14000
    s_nop 0
    buffer_load_dwordx4 v136, s[16:19], s26 offen lds
    s_waitcnt lgkmcnt(12)
    v_mfma_f32_16x16x32_bf16 v[40:43], a[48:51], v[84:87], v[40:43]
    ds_read_b64_tr_b16 v[112:113], v132 offset:40960
    v_mfma_f32_16x16x32_bf16 v[44:47], a[112:115], v[84:87], v[44:47]
    ds_read_b64_tr_b16 v[114:115], v132 offset:41984
    s_add_u32 s26, s24, 0x2a0000
    s_add_u32 m0, s29, 0x15000
    s_nop 0
    buffer_load_dwordx4 v136, s[16:19], s26 offen lds
    s_waitcnt lgkmcnt(12)
    v_mfma_f32_16x16x32_bf16 v[48:51], a[48:51], v[88:91], v[48:51]
    ds_read_b64_tr_b16 v[116:117], v133 offset:40960
    v_mfma_f32_16x16x32_bf16 v[52:55], a[112:115], v[88:91], v[52:55]
    ds_read_b64_tr_b16 v[118:119], v133 offset:41984
    s_add_u32 s26, s24, 0x2c0000
    s_add_u32 m0, s29, 0x16000
    s_nop 0
    buffer_load_dwordx4 v136, s[16:19], s26 offen lds
    s_waitcnt lgkmcnt(12)
    v_mfma_f32_16x16x32_bf16 v[56:59], a[48:51], v[92:95], v[56:59]
    ds_read_b64_tr_b16 v[120:121], v134 offset:40960
    v_mfma_f32_16x16x32_bf16 v[60:63], a[112:115], v[92:95], v[60:63]
    ds_read_b64_tr_b16 v[122:123], v134 offset:41984
    s_add_u32 s26, s24, 0x2e0000
    s_add_u32 m0, s29, 0x17000
    s_nop 0
    buffer_load_dwordx4 v136, s[16:19], s26 offen lds
    s_waitcnt lgkmcnt(12)
    v_mfma_f32_16x16x32_bf16 v[0:3], a[52:55], v[96:99], v[0:3]
    ds_read_b64_tr_b16 v[124:125], v135 offset:40960
    v_mfma_f32_16x16x32_bf16 v[4:7], a[116:119], v[96:99], v[4:7]
    ds_read_b64_tr_b16 v[126:127], v135 offset:41984
    s_waitcnt lgkmcnt(12)
    v_mfma_f32_16x16x32_bf16 v[8:11], a[52:55], v[100:103], v[8:11]
    ds_read_b64_tr_b16 v[64:65], v128 offset:49152
    v_mfma_f32_16x16x32_bf16 v[12:15], a[116:119], v[100:103], v[12:15]
    ds_read_b64_tr_b16 v[66:67], v128 offset:50176
    s_waitcnt lgkmcnt(12)
    v_mfma_f32_16x16x32_bf16 v[16:19], a[52:55], v[104:107], v[16:19]
    ds_read_b64_tr_b16 v[68:69], v129 offset:49152
    v_mfma_f32_16x16x32_bf16 v[20:23], a[116:119], v[104:107], v[20:23]
    ds_read_b64_tr_b16 v[70:71], v129 offset:50176
    s_waitcnt lgkmcnt(12)
    v_mfma_f32_16x16x32_bf16 v[24:27], a[52:55], v[108:111], v[24:27]
    ds_read_b64_tr_b16 v[72:73], v130 offset:49152
    v_mfma_f32_16x16x32_bf16 v[28:31], a[116:119], v[108:111], v[28:31]
    ds_read_b64_tr_b16 v[74:75], v130 offset:50176
    s_waitcnt lgkmcnt(12)
    v_mfma_f32_16x16x32_bf16 v[32:35], a[52:55], v[112:115], v[32:35]
    ds_read_b64_tr_b16 v[76:77], v131 offset:49152
    v_mfma_f32_16x16x32_bf16 v[36:39], a[116:119], v[112:115], v[36:39]
    ds_read_b64_tr_b16 v[78:79], v131 offset:50176
    s_waitcnt lgkmcnt(12)
    v_mfma_f32_16x16x32_bf16 v[40:43], a[52:55], v[116:119], v[40:43]
    ds_read_b64_tr_b16 v[80:81], v132 offset:49152
    v_mfma_f32_16x16x32_bf16 v[44:47], a[116:119], v[116:119], v[44:47]
    ds_read_b64_tr_b16 v[82:83], v132 offset:50176
    s_waitcnt lgkmcnt(12)
    v_mfma_f32_16x16x32_bf16 v[48:51], a[52:55], v[120:123], v[48:51]
    ds_read_b64_tr_b16 v[84:85], v133 offset:49152
    v_mfma_f32_16x16x32_bf16 v[52:55], a[116:119], v[120:123], v[52:55]
    ds_read_b64_tr_b16 v[86:87], v133 offset:50176
    s_waitcnt lgkmcnt(12)
    v_mfma_f32_16x16x32_bf16 v[56:59], a[52:55], v[124:127], v[56:59]
    ds_read_b64_tr_b16 v[88:89], v134 offset:49152
    v_mfma_f32_16x16x32_bf16 v[60:63], a[116:119], v[124:127], v[60:63]
    ds_read_b64_tr_b16 v[90:91], v134 offset:50176
    s_waitcnt lgkmcnt(12)
    v_mfma_f32_16x16x32_bf16 v[0:3], a[56:59], v[64:67], v[0:3]
    ds_read_b64_tr_b16 v[92:93], v135 offset:49152
    v_mfma_f32_16x16x32_bf16 v[4:7], a[120:123], v[64:67], v[4:7]
    ds_read_b64_tr_b16 v[94:95], v135 offset:50176
    s_waitcnt lgkmcnt(12)
    v_mfma_f32_16x16x32_bf16 v[8:11], a[56:59], v[68:71], v[8:11]
    ds_read_b64_tr_b16 v[96:97], v128 offset:57344
    v_mfma_f32_16x16x32_bf16 v[12:15], a[120:123], v[68:71], v[12:15]
    ds_read_b64_tr_b16 v[98:99], v128 offset:58368
    s_waitcnt lgkmcnt(12)
    v_mfma_f32_16x16x32_bf16 v[16:19], a[56:59], v[72:75], v[16:19]
    ds_read_b64_tr_b16 v[100:101], v129 offset:57344
    v_mfma_f32_16x16x32_bf16 v[20:23], a[120:123], v[72:75], v[20:23]
    ds_read_b64_tr_b16 v[102:103], v129 offset:58368
    s_waitcnt lgkmcnt(12)
    v_mfma_f32_16x16x32_bf16 v[24:27], a[56:59], v[76:79], v[24:27]
    ds_read_b64_tr_b16 v[104:105], v130 offset:57344
    v_mfma_f32_16x16x32_bf16 v[28:31], a[120:123], v[76:79], v[28:31]
    ds_read_b64_tr_b16 v[106:107], v130 offset:58368
    s_waitcnt lgkmcnt(12)
    v_mfma_f32_16x16x32_bf16 v[32:35], a[56:59], v[80:83], v[32:35]
    ds_read_b64_tr_b16 v[108:109], v131 offset:57344
    v_mfma_f32_16x16x32_bf16 v[36:39], a[120:123], v[80:83], v[36:39]
    ds_read_b64_tr_b16 v[110:111], v131 offset:58368
    s_waitcnt lgkmcnt(12)
    v_mfma_f32_16x16x32_bf16 v[40:43], a[56:59], v[84:87], v[40:43]
    ds_read_b64_tr_b16 v[112:113], v132 offset:57344
    v_mfma_f32_16x16x32_bf16 v[44:47], a[120:123], v[84:87], v[44:47]
    ds_read_b64_tr_b16 v[114:115], v132 offset:58368
    s_waitcnt lgkmcnt(12)
    v_mfma_f32_16x16x32_bf16 v[48:51], a[56:59], v[88:91], v[48:51]
    ds_read_b64_tr_b16 v[116:117], v133 offset:57344
    v_mfma_f32_16x16x32_bf16 v[52:55], a[120:123], v[88:91], v[52:55]
    ds_read_b64_tr_b16 v[118:119], v133 offset:58368
    s_waitcnt lgkmcnt(12)
    v_mfma_f32_16x16x32_bf16 v[56:59], a[56:59], v[92:95], v[56:59]
    ds_read_b64_tr_b16 v[120:121], v134 offset:57344
    v_mfma_f32_16x16x32_bf16 v[60:63], a[120:123], v[92:95], v[60:63]
    ds_read_b64_tr_b16 v[122:123], v134 offset:58368
    s_waitcnt lgkmcnt(12)
    v_mfma_f32_16x16x32_bf16 v[0:3], a[60:63], v[96:99], v[0:3]
    ds_read_b64_tr_b16 v[124:125], v135 offset:57344
    v_mfma_f32_16x16x32_bf16 v[4:7], a[124:127], v[96:99], v[4:7]
    ds_read_b64_tr_b16 v[126:127], v135 offset:58368
    s_waitcnt lgkmcnt(12)
    v_mfma_f32_16x16x32_bf16 v[8:11], a[60:63], v[100:103], v[8:11]
    v_mfma_f32_16x16x32_bf16 v[12:15], a[124:127], v[100:103], v[12:15]
    s_waitcnt lgkmcnt(10)
    v_mfma_f32_16x16x32_bf16 v[16:19], a[60:63], v[104:107], v[16:19]
    v_mfma_f32_16x16x32_bf16 v[20:23], a[124:127], v[104:107], v[20:23]
    s_waitcnt lgkmcnt(8)
    v_mfma_f32_16x16x32_bf16 v[24:27], a[60:63], v[108:111], v[24:27]
    v_mfma_f32_16x16x32_bf16 v[28:31], a[124:127], v[108:111], v[28:31]
    s_waitcnt lgkmcnt(6)
    v_mfma_f32_16x16x32_bf16 v[32:35], a[60:63], v[112:115], v[32:35]
    v_mfma_f32_16x16x32_bf16 v[36:39], a[124:127], v[112:115], v[36:39]
    s_waitcnt lgkmcnt(4)
    v_mfma_f32_16x16x32_bf16 v[40:43], a[60:63], v[116:119], v[40:43]
    v_mfma_f32_16x16x32_bf16 v[44:47], a[124:127], v[116:119], v[44:47]
    s_waitcnt lgkmcnt(2)
    v_mfma_f32_16x16x32_bf16 v[48:51], a[60:63], v[120:123], v[48:51]
    v_mfma_f32_16x16x32_bf16 v[52:55], a[124:127], v[120:123], v[52:55]
    s_waitcnt lgkmcnt(0)
    v_mfma_f32_16x16x32_bf16 v[56:59], a[60:63], v[124:127], v[56:59]
    v_mfma_f32_16x16x32_bf16 v[60:63], a[124:127], v[124:127], v[60:63]
    v_xor_b32 v128, 0x10000, v128
    v_xor_b32 v129, 0x10000, v129
    v_xor_b32 v130, 0x10000, v130
    v_xor_b32 v131, 0x10000, v131
    v_xor_b32 v132, 0x10000, v132
    v_xor_b32 v133, 0x10000, v133
    v_xor_b32 v134, 0x10000, v134
    v_xor_b32 v135, 0x10000, v135
    v_cvt_pk_bf16_f32 v144, v0, v1
    v_cvt_pk_bf16_f32 v145, v2, v3
    v_cvt_pk_bf16_f32 v146, v4, v5
    v_cvt_pk_bf16_f32 v147, v6, v7
    buffer_store_dwordx4 v[144:147], v137, s[8:11], s25 offen sc1
    v_cvt_pk_bf16_f32 v148, v8, v9
    v_cvt_pk_bf16_f32 v149, v10, v11
    v_cvt_pk_bf16_f32 v150, v12, v13
    v_cvt_pk_bf16_f32 v151, v14, v15
    buffer_store_dwordx4 v[148:151], v137, s[8:11], s25 offen offset:1024 sc1
    v_cvt_pk_bf16_f32 v152, v16, v17
    v_cvt_pk_bf16_f32 v153, v18, v19
    v_cvt_pk_bf16_f32 v154, v20, v21
    v_cvt_pk_bf16_f32 v155, v22, v23
    buffer_store_dwordx4 v[152:155], v137, s[8:11], s25 offen offset:2048 sc1
    v_cvt_pk_bf16_f32 v156, v24, v25
    v_cvt_pk_bf16_f32 v157, v26, v27
    v_cvt_pk_bf16_f32 v158, v28, v29
    v_cvt_pk_bf16_f32 v159, v30, v31
    buffer_store_dwordx4 v[156:159], v137, s[8:11], s25 offen offset:3072 sc1
    v_cvt_pk_bf16_f32 v144, v32, v33
    v_cvt_pk_bf16_f32 v145, v34, v35
    v_cvt_pk_bf16_f32 v146, v36, v37
    v_cvt_pk_bf16_f32 v147, v38, v39
    s_add_u32 s25, s25, 4096
    buffer_store_dwordx4 v[144:147], v137, s[8:11], s25 offen sc1
    v_cvt_pk_bf16_f32 v148, v40, v41
    v_cvt_pk_bf16_f32 v149, v42, v43
    v_cvt_pk_bf16_f32 v150, v44, v45
    v_cvt_pk_bf16_f32 v151, v46, v47
    buffer_store_dwordx4 v[148:151], v137, s[8:11], s25 offen offset:1024 sc1
    v_cvt_pk_bf16_f32 v152, v48, v49
    v_cvt_pk_bf16_f32 v153, v50, v51
    v_cvt_pk_bf16_f32 v154, v52, v53
    v_cvt_pk_bf16_f32 v155, v54, v55
    buffer_store_dwordx4 v[152:155], v137, s[8:11], s25 offen offset:2048 sc1
    v_cvt_pk_bf16_f32 v156, v56, v57
    v_cvt_pk_bf16_f32 v157, v58, v59
    v_cvt_pk_bf16_f32 v158, v60, v61
    v_cvt_pk_bf16_f32 v159, v62, v63
    buffer_store_dwordx4 v[156:159], v137, s[8:11], s25 offen offset:3072 sc1
    s_cmp_lg_u32 s20, 15
    s_cbranch_scc1 L_p1_next
    v_mov_b32 v0, -1
    v_mov_b32 v1, -1
    v_mov_b32 v2, -1
    v_mov_b32 v3, -1
    s_sub_u32 s26, s25, 0x2001000
    s_lshr_b32 s26, s26, 1
    s_add_u32 s26, s26, 0x240000
    buffer_store_dwordx4 v[0:3], v137, s[8:11], s26 offen sc1
    buffer_store_dwordx4 v[0:3], v137, s[8:11], s26 offen offset:1024 sc1
    buffer_store_dwordx4 v[0:3], v137, s[8:11], s26 offen offset:2048 sc1
    buffer_store_dwordx4 v[0:3], v137, s[8:11], s26 offen offset:3072 sc1
    s_nop 1
L_p1_next:
    s_add_u32 s80, s80, 1
    s_lshl_b32 s40, s38, 4
    s_add_u32 s40, s40, s20
    s_lshl_b32 s40, s40, 2
    s_add_u32 s40, s40, 0x2000
    s_sub_u32 s44, s25, 4095
    s_add_u32 s38, s38, s37
    s_branch L_p1_unit
L_p1_end:
    s_waitcnt vmcnt(0)
    s_barrier
    s_cmp_eq_u32 s40, 0
    s_cbranch_scc1 L_nopf_102
    s_cmp_lg_u32 s87, 0
    s_cbranch_scc1 L_modeok_103
    v_readfirstlane_b32 s96, v140
    v_readfirstlane_b32 s97, v141
    s_nop 0
    s_cmp_lg_u32 s97, 0
    s_cselect_b32 s87, s96, 0
    s_cmp_eq_u32 s87, 1
    s_cbranch_scc1 L_modeok_103
    s_mov_b32 s96, 0
L_mode_104:
    buffer_load_dwordx2 v[140:141], off, s[92:95], 0 offset:36 sc1
    s_waitcnt vmcnt(0)
    v_readfirstlane_b32 s87, v140
    v_readfirstlane_b32 s97, v141
    s_nop 0
    s_min_u32 s97, s97, s87
    s_cmp_lg_u32 s97, 0
    s_cbranch_scc1 L_moded_105
    s_sleep 4
    s_add_u32 s96, s96, 1
    s_cmp_lg_u32 s96, 0x100
    s_cbranch_scc1 L_modef_106
    v_mov_b32 v140, 2
    v_mov_b32 v141, 0
    s_mov_b64 exec, 1
    buffer_atomic_cmpswap v[140:141], off, s[92:95], 0 offset:36
    s_mov_b64 exec, -1
L_modef_106:
    s_cmp_lt_u32 s96, 0x10000
    s_cbranch_scc1 L_mode_104
L_moded_105:
    s_cmp_lg_u32 s87, 1
    s_cbranch_scc1 L_fallback
L_modeok_103:
    s_cmp_lg_u32 s100, 0
    s_cbranch_scc1 L_flag_107
    v_mov_b32 v138, 1
    s_mov_b64 exec, 1
    buffer_store_dword v138, off, s[8:11], s40 sc1
    s_mov_b64 exec, -1
L_flag_107:
    s_mov_b32 s40, 0
L_nopf_102:
    s_cmp_lg_u32 s41, 0
    s_cbranch_scc1 L_p1done
    s_mov_b32 s41, 1
    s_mul_i32 s22, s101, 171
    s_lshr_b32 s22, s22, 11
    s_mul_i32 s26, s22, 12
    s_sub_u32 s20, s101, s26
    s_add_u32 s20, s20, 4
    s_mul_i32 s27, s101, 683
    s_lshr_b32 s27, s27, 11
    s_mul_i32 s26, s27, 3
    s_sub_u32 s26, s101, s26
    s_cmp_eq_u32 s26, 2
    s_cselect_b32 s28, 10, 11
    s_cmp_ge_u32 s101, 192
    s_cselect_b32 s20, s26, s20
    s_cselect_b32 s22, s27, s22
    s_cselect_b32 s37, s28, 16
    s_branch L_p1_pass
L_p1done:
    v_mbcnt_lo_u32_b32 v0, -1, 0
    v_mbcnt_hi_u32_b32 v0, -1, v0
    s_lshl_b32 s96, s100, 6
    v_add_u32 v0, s96, v0
    s_and_b32 s20, s101, 15
    s_lshr_b32 s22, s101, 4
    s_mov_b32 s23, 14
    v_mov_b32 v1, 0
    s_lshl_b32 s24, s20, 7
    s_add_u32 s24, s24, 0x1000
    s_mul_i32 s25, s22, 14
    s_lshr_b32 s25, s25, 4
    s_add_u32 s25, s25, 12
    s_cmp_lg_u32 s100, 0
    s_cbranch_scc1 L_polls_110
    s_mov_b32 exec_lo, 0x1
    s_mov_b32 exec_hi, 0
    s_mov_b32 s96, 0
L_poll_108:
    buffer_load_dword v2, v1, s[8:11], s24 offen sc1
    s_waitcnt vmcnt(0)
    v_cmp_gt_u32 vcc, s25, v2
    s_cbranch_vccz L_polld_109
    v_readfirstlane_b32 s97, v2
    s_nop 0
    s_sub_u32 s97, s25, s97
    s_cmp_lt_i32 s97, 3
    s_cbranch_scc1 L_near_111
    s_sleep 40
    s_cmp_lt_i32 s97, 5
    s_cbranch_scc1 L_near_111
    s_sleep 100
L_near_111:
    s_sleep 4
    s_add_u32 s96, s96, 1
    s_cmp_lt_u32 s96, 0x10000
    s_cbranch_scc1 L_poll_108
L_polld_109:
    s_mov_b64 exec, -1
L_polls_110:
    s_barrier
    s_load_dwordx2 s[12:13], s[0:1], 40
    s_waitcnt lgkmcnt(0)
    s_and_b32 s13, s13, 0xffff
    s_mov_b32 s14, 0x400000
    s_mov_b32 s15, 0x20000
    v_lshrrev_b32 v4, 6, v0
    s_nop 0
    v_readfirstlane_b32 s21, v4
    v_and_b32 v1, 63, v0
    v_lshrrev_b32 v2, 4, v1
    v_and_b32 v3, 15, v1
    v_lshrrev_b32 v6, 2, v3
    v_lshlrev_b32 v240, 4, v1
    v_lshlrev_b32 v241, 3, v1
    s_lshl_b32 s27, s21, 10
    s_lshl_b32 s24, s21, 5
    v_xor_b32 v4, s24, v240
    v_add_u32 v8, s27, v4
    v_xor_b32 v9, 128, v8
    v_lshl_add_u32 v4, v2, 2, v6
    v_and_b32 v5, 7, v4
    v_lshlrev_b32 v4, 10, v4
    v_lshl_add_u32 v4, v5, 5, v4
    v_and_b32 v5, 3, v3
    v_lshlrev_b32 v5, 4, v5
    v_xor_b32 v4, v5, v4
    s_lshl_b32 s24, s21, 8
    v_add_u32 v10, s24, v4
    s_lshl_b32 s25, s20, 18
    s_add_u32 s24, s25, 0x0
    s_add_u32 m0, s27, 0x0
    s_nop 0
    buffer_load_dwordx4 v8, s[12:15], s24 offen lds
    s_add_u32 s24, s25, 0x1000
    s_add_u32 m0, s27, 0x1000
    s_nop 0
    buffer_load_dwordx4 v9, s[12:15], s24 offen lds
    s_add_u32 s24, s25, 0x2000
    s_add_u32 m0, s27, 0x2000
    s_nop 0
    buffer_load_dwordx4 v8, s[12:15], s24 offen lds
    s_add_u32 s24, s25, 0x3000
    s_add_u32 m0, s27, 0x3000
    s_nop 0
    buffer_load_dwordx4 v9, s[12:15], s24 offen lds
    s_add_u32 s24, s25, 0x4000
    s_add_u32 m0, s27, 0x4000
    s_nop 0
    buffer_load_dwordx4 v8, s[12:15], s24 offen lds
    s_add_u32 s24, s25, 0x5000
    s_add_u32 m0, s27, 0x5000
    s_nop 0
    buffer_load_dwordx4 v9, s[12:15], s24 offen lds
    s_add_u32 s24, s25, 0x6000
    s_add_u32 m0, s27, 0x6000
    s_nop 0
    buffer_load_dwordx4 v8, s[12:15], s24 offen lds
    s_add_u32 s24, s25, 0x7000
    s_add_u32 m0, s27, 0x7000
    s_nop 0
    buffer_load_dwordx4 v9, s[12:15], s24 offen lds
    s_add_u32 s24, s25, 0x8000
    s_add_u32 m0, s27, 0x8000
    s_nop 0
    buffer_load_dwordx4 v8, s[12:15], s24 offen lds
    s_add_u32 s24, s25, 0x9000
    s_add_u32 m0, s27, 0x9000
    s_nop 0
    buffer_load_dwordx4 v9, s[12:15], s24 offen lds
    s_add_u32 s24, s25, 0xa000
    s_add_u32 m0, s27, 0xa000
    s_nop 0
    buffer_load_dwordx4 v8, s[12:15], s24 offen lds
    s_add_u32 s24, s25, 0xb000
    s_add_u32 m0, s27, 0xb000
    s_nop 0
    buffer_load_dwordx4 v9, s[12:15], s24 offen lds
    s_add_u32 s24, s25, 0xc000
    s_add_u32 m0, s27, 0xc000
    s_nop 0
    buffer_load_dwordx4 v8, s[12:15], s24 offen lds
    s_add_u32 s24, s25, 0xd000
    s_add_u32 m0, s27, 0xd000
    s_nop 0
    buffer_load_dwordx4 v9, s[12:15], s24 offen lds
    s_add_u32 s24, s25, 0xe000
    s_add_u32 m0, s27, 0xe000
    s_nop 0
    buffer_load_dwordx4 v8, s[12:15], s24 offen lds
    s_add_u32 s24, s25, 0xf000
    s_add_u32 m0, s27, 0xf000
    s_nop 0
    buffer_load_dwordx4 v9, s[12:15], s24 offen lds
    s_add_u32 s24, s25, 0x10000
    s_add_u32 m0, s27, 0x10000
    s_nop 0
    buffer_load_dwordx4 v8, s[12:15], s24 offen lds
    s_add_u32 s24, s25, 0x11000
    s_add_u32 m0, s27, 0x11000
    s_nop 0
    buffer_load_dwordx4 v9, s[12:15], s24 offen lds
    s_add_u32 s24, s25, 0x12000
    s_add_u32 m0, s27, 0x12000
    s_nop 0
    buffer_load_dwordx4 v8, s[12:15], s24 offen lds
    s_add_u32 s24, s25, 0x13000
    s_add_u32 m0, s27, 0x13000
    s_nop 0
    buffer_load_dwordx4 v9, s[12:15], s24 offen lds
    s_add_u32 s24, s25, 0x14000
    s_add_u32 m0, s27, 0x14000
    s_nop 0
    buffer_load_dwordx4 v8, s[12:15], s24 offen lds
    s_add_u32 s24, s25, 0x15000
    s_add_u32 m0, s27, 0x15000
    s_nop 0
    buffer_load_dwordx4 v9, s[12:15], s24 offen lds
    s_add_u32 s24, s25, 0x16000
    s_add_u32 m0, s27, 0x16000
    s_nop 0
    buffer_load_dwordx4 v8, s[12:15], s24 offen lds
    s_add_u32 s24, s25, 0x17000
    s_add_u32 m0, s27, 0x17000
    s_nop 0
    buffer_load_dwordx4 v9, s[12:15], s24 offen lds
    s_add_u32 s24, s25, 0x18000
    s_add_u32 m0, s27, 0x18000
    s_nop 0
    buffer_load_dwordx4 v8, s[12:15], s24 offen lds
    s_add_u32 s24, s25, 0x19000
    s_add_u32 m0, s27, 0x19000
    s_nop 0
    buffer_load_dwordx4 v9, s[12:15], s24 offen lds
    s_add_u32 s24, s25, 0x1a000
    s_add_u32 m0, s27, 0x1a000
    s_nop 0
    buffer_load_dwordx4 v8, s[12:15], s24 offen lds
    s_add_u32 s24, s25, 0x1b000
    s_add_u32 m0, s27, 0x1b000
    s_nop 0
    buffer_load_dwordx4 v9, s[12:15], s24 offen lds
    s_add_u32 s24, s25, 0x1c000
    s_add_u32 m0, s27, 0x1c000
    s_nop 0
    buffer_load_dwordx4 v8, s[12:15], s24 offen lds
    s_add_u32 s24, s25, 0x1d000
    s_add_u32 m0, s27, 0x1d000
    s_nop 0
    buffer_load_dwordx4 v9, s[12:15], s24 offen lds
    s_add_u32 s24, s25, 0x1e000
    s_add_u32 m0, s27, 0x1e000
    s_nop 0
    buffer_load_dwordx4 v8, s[12:15], s24 offen lds
    s_add_u32 s24, s25, 0x1f000
    s_add_u32 m0, s27, 0x1f000
    s_nop 0
    buffer_load_dwordx4 v9, s[12:15], s24 offen lds
    s_waitcnt vmcnt(0)
    s_barrier
    v_xor_b32 v11, 0x0, v10
    ds_read_b64_tr_b16 a[0:1], v11
    ds_read_b64_tr_b16 a[2:3], v11 offset:16384
    ds_read_b64_tr_b16 a[32:33], v11 offset:32768
    ds_read_b64_tr_b16 a[34:35], v11 offset:49152
    v_xor_b32 v11, 0x8, v10
    ds_read_b64_tr_b16 a[4:5], v11
    ds_read_b64_tr_b16 a[6:7], v11 offset:16384
    ds_read_b64_tr_b16 a[36:37], v11 offset:32768
    ds_read_b64_tr_b16 a[38:39], v11 offset:49152
    s_waitcnt lgkmcnt(0)
    v_xor_b32 v11, 0x40, v10
    ds_read_b64_tr_b16 a[8:9], v11
    ds_read_b64_tr_b16 a[10:11], v11 offset:16384
    ds_read_b64_tr_b16 a[40:41], v11 offset:32768
    ds_read_b64_tr_b16 a[42:43], v11 offset:49152
    v_xor_b32 v11, 0x48, v10
    ds_read_b64_tr_b16 a[12:13], v11
    ds_read_b64_tr_b16 a[14:15], v11 offset:16384
    ds_read_b64_tr_b16 a[44:45], v11 offset:32768
    ds_read_b64_tr_b16 a[46:47], v11 offset:49152
    s_waitcnt lgkmcnt(0)
    v_xor_b32 v11, 0x80, v10
    ds_read_b64_tr_b16 a[16:17], v11
    ds_read_b64_tr_b16 a[18:19], v11 offset:16384
    ds_read_b64_tr_b16 a[48:49], v11 offset:32768
    ds_read_b64_tr_b16 a[50:51], v11 offset:49152
    v_xor_b32 v11, 0x88, v10
    ds_read_b64_tr_b16 a[20:21], v11
    ds_read_b64_tr_b16 a[22:23], v11 offset:16384
    ds_read_b64_tr_b16 a[52:53], v11 offset:32768
    ds_read_b64_tr_b16 a[54:55], v11 offset:49152
    s_waitcnt lgkmcnt(0)
    v_xor_b32 v11, 0xc0, v10
    ds_read_b64_tr_b16 a[24:25], v11
    ds_read_b64_tr_b16 a[26:27], v11 offset:16384
    ds_read_b64_tr_b16 a[56:57], v11 offset:32768
    ds_read_b64_tr_b16 a[58:59], v11 offset:49152
    v_xor_b32 v11, 0xc8, v10
    ds_read_b64_tr_b16 a[28:29], v11
    ds_read_b64_tr_b16 a[30:31], v11 offset:16384
    ds_read_b64_tr_b16 a[60:61], v11 offset:32768
    ds_read_b64_tr_b16 a[62:63], v11 offset:49152
    s_waitcnt lgkmcnt(0)
    v_xor_b32 v11, 0x10000, v10
    ds_read_b64_tr_b16 a[64:65], v11
    ds_read_b64_tr_b16 a[66:67], v11 offset:16384
    ds_read_b64_tr_b16 a[96:97], v11 offset:32768
    ds_read_b64_tr_b16 a[98:99], v11 offset:49152
    v_xor_b32 v11, 0x10008, v10
    ds_read_b64_tr_b16 a[68:69], v11
    ds_read_b64_tr_b16 a[70:71], v11 offset:16384
    ds_read_b64_tr_b16 a[100:101], v11 offset:32768
    ds_read_b64_tr_b16 a[102:103], v11 offset:49152
    s_waitcnt lgkmcnt(0)
    v_xor_b32 v11, 0x10040, v10
    ds_read_b64_tr_b16 a[72:73], v11
    ds_read_b64_tr_b16 a[74:75], v11 offset:16384
    ds_read_b64_tr_b16 a[104:105], v11 offset:32768
    ds_read_b64_tr_b16 a[106:107], v11 offset:49152
    v_xor_b32 v11, 0x10048, v10
    ds_read_b64_tr_b16 a[76:77], v11
    ds_read_b64_tr_b16 a[78:79], v11 offset:16384
    ds_read_b64_tr_b16 a[108:109], v11 offset:32768
    ds_read_b64_tr_b16 a[110:111], v11 offset:49152
    s_waitcnt lgkmcnt(0)
    v_xor_b32 v11, 0x10080, v10
    ds_read_b64_tr_b16 a[80:81], v11
    ds_read_b64_tr_b16 a[82:83], v11 offset:16384
    ds_read_b64_tr_b16 a[112:113], v11 offset:32768
    ds_read_b64_tr_b16 a[114:115], v11 offset:49152
    v_xor_b32 v11, 0x10088, v10
    ds_read_b64_tr_b16 a[84:85], v11
    ds_read_b64_tr_b16 a[86:87], v11 offset:16384
    ds_read_b64_tr_b16 a[116:117], v11 offset:32768
    ds_read_b64_tr_b16 a[118:119], v11 offset:49152
    s_waitcnt lgkmcnt(0)
    v_xor_b32 v11, 0x100c0, v10
    ds_read_b64_tr_b16 a[88:89], v11
    ds_read_b64_tr_b16 a[90:91], v11 offset:16384
    ds_read_b64_tr_b16 a[120:121], v11 offset:32768
    ds_read_b64_tr_b16 a[122:123], v11 offset:49152
    v_xor_b32 v11, 0x100c8, v10
    ds_read_b64_tr_b16 a[92:93], v11
    ds_read_b64_tr_b16 a[94:95], v11 offset:16384
    ds_read_b64_tr_b16 a[124:125], v11 offset:32768
    ds_read_b64_tr_b16 a[126:127], v11 offset:49152
    s_waitcnt lgkmcnt(0)
    s_barrier
    s_lshl_b32 s25, s20, 18
    s_add_u32 s24, s25, 0x20000
    s_add_u32 m0, s27, 0x0
    s_nop 0
    buffer_load_dwordx4 v8, s[12:15], s24 offen lds
    s_add_u32 s24, s25, 0x21000
    s_add_u32 m0, s27, 0x1000
    s_nop 0
    buffer_load_dwordx4 v9, s[12:15], s24 offen lds
    s_add_u32 s24, s25, 0x22000
    s_add_u32 m0, s27, 0x2000
    s_nop 0
    buffer_load_dwordx4 v8, s[12:15], s24 offen lds
    s_add_u32 s24, s25, 0x23000
    s_add_u32 m0, s27, 0x3000
    s_nop 0
    buffer_load_dwordx4 v9, s[12:15], s24 offen lds
    s_add_u32 s24, s25, 0x24000
    s_add_u32 m0, s27, 0x4000
    s_nop 0
    buffer_load_dwordx4 v8, s[12:15], s24 offen lds
    s_add_u32 s24, s25, 0x25000
    s_add_u32 m0, s27, 0x5000
    s_nop 0
    buffer_load_dwordx4 v9, s[12:15], s24 offen lds
    s_add_u32 s24, s25, 0x26000
    s_add_u32 m0, s27, 0x6000
    s_nop 0
    buffer_load_dwordx4 v8, s[12:15], s24 offen lds
    s_add_u32 s24, s25, 0x27000
    s_add_u32 m0, s27, 0x7000
    s_nop 0
    buffer_load_dwordx4 v9, s[12:15], s24 offen lds
    s_add_u32 s24, s25, 0x28000
    s_add_u32 m0, s27, 0x8000
    s_nop 0
    buffer_load_dwordx4 v8, s[12:15], s24 offen lds
    s_add_u32 s24, s25, 0x29000
    s_add_u32 m0, s27, 0x9000
    s_nop 0
    buffer_load_dwordx4 v9, s[12:15], s24 offen lds
    s_add_u32 s24, s25, 0x2a000
    s_add_u32 m0, s27, 0xa000
    s_nop 0
    buffer_load_dwordx4 v8, s[12:15], s24 offen lds
    s_add_u32 s24, s25, 0x2b000
    s_add_u32 m0, s27, 0xb000
    s_nop 0
    buffer_load_dwordx4 v9, s[12:15], s24 offen lds
    s_add_u32 s24, s25, 0x2c000
    s_add_u32 m0, s27, 0xc000
    s_nop 0
    buffer_load_dwordx4 v8, s[12:15], s24 offen lds
    s_add_u32 s24, s25, 0x2d000
    s_add_u32 m0, s27, 0xd000
    s_nop 0
    buffer_load_dwordx4 v9, s[12:15], s24 offen lds
    s_add_u32 s24, s25, 0x2e000
    s_add_u32 m0, s27, 0xe000
    s_nop 0
    buffer_load_dwordx4 v8, s[12:15], s24 offen lds
    s_add_u32 s24, s25, 0x2f000
    s_add_u32 m0, s27, 0xf000
    s_nop 0
    buffer_load_dwordx4 v9, s[12:15], s24 offen lds
    s_add_u32 s24, s25, 0x30000
    s_add_u32 m0, s27, 0x10000
    s_nop 0
    buffer_load_dwordx4 v8, s[12:15], s24 offen lds
    s_add_u32 s24, s25, 0x31000
    s_add_u32 m0, s27, 0x11000
    s_nop 0
    buffer_load_dwordx4 v9, s[12:15], s24 offen lds
    s_add_u32 s24, s25, 0x32000
    s_add_u32 m0, s27, 0x12000
    s_nop 0
    buffer_load_dwordx4 v8, s[12:15], s24 offen lds
    s_add_u32 s24, s25, 0x33000
    s_add_u32 m0, s27, 0x13000
    s_nop 0
    buffer_load_dwordx4 v9, s[12:15], s24 offen lds
    s_add_u32 s24, s25, 0x34000
    s_add_u32 m0, s27, 0x14000
    s_nop 0
    buffer_load_dwordx4 v8, s[12:15], s24 offen lds
    s_add_u32 s24, s25, 0x35000
    s_add_u32 m0, s27, 0x15000
    s_nop 0
    buffer_load_dwordx4 v9, s[12:15], s24 offen lds
    s_add_u32 s24, s25, 0x36000
    s_add_u32 m0, s27, 0x16000
    s_nop 0
    buffer_load_dwordx4 v8, s[12:15], s24 offen lds
    s_add_u32 s24, s25, 0x37000
    s_add_u32 m0, s27, 0x17000
    s_nop 0
    buffer_load_dwordx4 v9, s[12:15], s24 offen lds
    s_add_u32 s24, s25, 0x38000
    s_add_u32 m0, s27, 0x18000
    s_nop 0
    buffer_load_dwordx4 v8, s[12:15], s24 offen lds
    s_add_u32 s24, s25, 0x39000
    s_add_u32 m0, s27, 0x19000
    s_nop 0
    buffer_load_dwordx4 v9, s[12:15], s24 offen lds
    s_add_u32 s24, s25, 0x3a000
    s_add_u32 m0, s27, 0x1a000
    s_nop 0
    buffer_load_dwordx4 v8, s[12:15], s24 offen lds
    s_add_u32 s24, s25, 0x3b000
    s_add_u32 m0, s27, 0x1b000
    s_nop 0
    buffer_load_dwordx4 v9, s[12:15], s24 offen lds
    s_add_u32 s24, s25, 0x3c000
    s_add_u32 m0, s27, 0x1c000
    s_nop 0
    buffer_load_dwordx4 v8, s[12:15], s24 offen lds
    s_add_u32 s24, s25, 0x3d000
    s_add_u32 m0, s27, 0x1d000
    s_nop 0
    buffer_load_dwordx4 v9, s[12:15], s24 offen lds
    s_add_u32 s24, s25, 0x3e000
    s_add_u32 m0, s27, 0x1e000
    s_nop 0
    buffer_load_dwordx4 v8, s[12:15], s24 offen lds
    s_add_u32 s24, s25, 0x3f000
    s_add_u32 m0, s27, 0x1f000
    s_nop 0
    buffer_load_dwordx4 v9, s[12:15], s24 offen lds
    s_waitcnt vmcnt(0)
    s_barrier
    v_xor_b32 v11, 0x0, v10
    ds_read_b64_tr_b16 a[128:129], v11
    ds_read_b64_tr_b16 a[130:131], v11 offset:16384
    ds_read_b64_tr_b16 a[160:161], v11 offset:32768
    ds_read_b64_tr_b16 a[162:163], v11 offset:49152
    v_xor_b32 v11, 0x8, v10
    ds_read_b64_tr_b16 a[132:133], v11
    ds_read_b64_tr_b16 a[134:135], v11 offset:16384
    ds_read_b64_tr_b16 a[164:165], v11 offset:32768
    ds_read_b64_tr_b16 a[166:167], v11 offset:49152
    s_waitcnt lgkmcnt(0)
    v_xor_b32 v11, 0x40, v10
    ds_read_b64_tr_b16 a[136:137], v11
    ds_read_b64_tr_b16 a[138:139], v11 offset:16384
    ds_read_b64_tr_b16 a[168:169], v11 offset:32768
    ds_read_b64_tr_b16 a[170:171], v11 offset:49152
    v_xor_b32 v11, 0x48, v10
    ds_read_b64_tr_b16 a[140:141], v11
    ds_read_b64_tr_b16 a[142:143], v11 offset:16384
    ds_read_b64_tr_b16 a[172:173], v11 offset:32768
    ds_read_b64_tr_b16 a[174:175], v11 offset:49152
    s_waitcnt lgkmcnt(0)
    v_xor_b32 v11, 0x80, v10
    ds_read_b64_tr_b16 a[144:145], v11
    ds_read_b64_tr_b16 a[146:147], v11 offset:16384
    ds_read_b64_tr_b16 a[176:177], v11 offset:32768
    ds_read_b64_tr_b16 a[178:179], v11 offset:49152
    v_xor_b32 v11, 0x88, v10
    ds_read_b64_tr_b16 a[148:149], v11
    ds_read_b64_tr_b16 a[150:151], v11 offset:16384
    ds_read_b64_tr_b16 a[180:181], v11 offset:32768
    ds_read_b64_tr_b16 a[182:183], v11 offset:49152
    s_waitcnt lgkmcnt(0)
    v_xor_b32 v11, 0xc0, v10
    ds_read_b64_tr_b16 a[152:153], v11
    ds_read_b64_tr_b16 a[154:155], v11 offset:16384
    ds_read_b64_tr_b16 a[184:185], v11 offset:32768
    ds_read_b64_tr_b16 a[186:187], v11 offset:49152
    v_xor_b32 v11, 0xc8, v10
    ds_read_b64_tr_b16 a[156:157], v11
    ds_read_b64_tr_b16 a[158:159], v11 offset:16384
    ds_read_b64_tr_b16 a[188:189], v11 offset:32768
    ds_read_b64_tr_b16 a[190:191], v11 offset:49152
    s_waitcnt lgkmcnt(0)
    v_xor_b32 v11, 0x10000, v10
    ds_read_b64_tr_b16 a[192:193], v11
    ds_read_b64_tr_b16 a[194:195], v11 offset:16384
    ds_read_b64_tr_b16 a[224:225], v11 offset:32768
    ds_read_b64_tr_b16 a[226:227], v11 offset:49152
    v_xor_b32 v11, 0x10008, v10
    ds_read_b64_tr_b16 a[196:197], v11
    ds_read_b64_tr_b16 a[198:199], v11 offset:16384
    ds_read_b64_tr_b16 a[228:229], v11 offset:32768
    ds_read_b64_tr_b16 a[230:231], v11 offset:49152
    s_waitcnt lgkmcnt(0)
    v_xor_b32 v11, 0x10040, v10
    ds_read_b64_tr_b16 a[200:201], v11
    ds_read_b64_tr_b16 a[202:203], v11 offset:16384
    ds_read_b64_tr_b16 a[232:233], v11 offset:32768
    ds_read_b64_tr_b16 a[234:235], v11 offset:49152
    v_xor_b32 v11, 0x10048, v10
    ds_read_b64_tr_b16 a[204:205], v11
    ds_read_b64_tr_b16 a[206:207], v11 offset:16384
    ds_read_b64_tr_b16 a[236:237], v11 offset:32768
    ds_read_b64_tr_b16 a[238:239], v11 offset:49152
    s_waitcnt lgkmcnt(0)
    v_xor_b32 v11, 0x10080, v10
    ds_read_b64_tr_b16 a[208:209], v11
    ds_read_b64_tr_b16 a[210:211], v11 offset:16384
    ds_read_b64_tr_b16 a[240:241], v11 offset:32768
    ds_read_b64_tr_b16 a[242:243], v11 offset:49152
    v_xor_b32 v11, 0x10088, v10
    ds_read_b64_tr_b16 a[212:213], v11
    ds_read_b64_tr_b16 a[214:215], v11 offset:16384
    ds_read_b64_tr_b16 a[244:245], v11 offset:32768
    ds_read_b64_tr_b16 a[246:247], v11 offset:49152
    s_waitcnt lgkmcnt(0)
    v_xor_b32 v11, 0x100c0, v10
    ds_read_b64_tr_b16 a[216:217], v11
    ds_read_b64_tr_b16 a[218:219], v11 offset:16384
    ds_read_b64_tr_b16 a[248:249], v11 offset:32768
    ds_read_b64_tr_b16 a[250:251], v11 offset:49152
    v_xor_b32 v11, 0x100c8, v10
    ds_read_b64_tr_b16 a[220:221], v11
    ds_read_b64_tr_b16 a[222:223], v11 offset:16384
    ds_read_b64_tr_b16 a[252:253], v11 offset:32768
    ds_read_b64_tr_b16 a[254:255], v11 offset:49152
    s_waitcnt lgkmcnt(0)
    s_barrier
    s_and_b32 s24, s21, 1
    s_lshl_b32 s24, s24, 4
    v_add_u32 v4, s24, v3
    v_lshlrev_b32 v5, 2, v2
    v_sub_u32 v4, v4, v5
    v_cmp_le_i32 s[30:31], 0, v4
    v_cmp_le_i32 s[32:33], 1, v4
    v_cmp_le_i32 s[34:35], 2, v4
    v_cmp_le_i32 s[36:37], 3, v4
    v_cmp_le_i32 s[38:39], 16, v4
    v_cmp_le_i32 s[40:41], 17, v4
    v_cmp_le_i32 s[42:43], 18, v4
    v_cmp_le_i32 s[44:45], 19, v4
    s_mov_b32 s28, 0x3e0293ee
    s_mov_b32 s29, 0x3e0293ee
    s_mov_b32 s53, 0xff000000
    v_mov_b32 v136, 0x3f803f80
    v_mov_b32 v137, 0x3f803f80
    v_mov_b32 v138, 0x3f803f80
    v_mov_b32 v139, 0x3f803f80
    v_lshlrev_b32 v4, 10, v3
    v_lshl_add_u32 v4, v2, 4, v4
    s_lshl_b32 s24, s21, 8
    v_add_u32 v242, s24, v4
    s_lshl_b32 s24, s21, 12
    v_add_u32 v243, s24, v240
    v_mov_b32 v244, v240
    s_add_u32 s24, s24, 0x22000
    v_xor_b32 v7, v2, v6
    v_lshl_add_u32 v4, v2, 4, v7
    v_and_b32 v5, 3, v3
    v_lshl_add_u32 v4, v4, 2, v5
    v_lshl_add_u32 v253, v4, 2, s24
    v_lshl_add_u32 v4, v3, 2, v7
    v_lshl_add_u32 v254, v4, 4, s24
    s_load_dwordx2 s[12:13], s[0:1], 0
    s_waitcnt lgkmcnt(0)
    s_and_b32 s13, s13, 0xffff
    s_mov_b32 s14, 0x200000
    s_mov_b32 s15, 0x20000
    s_load_dwordx2 s[16:17], s[0:1], 96
    s_waitcnt lgkmcnt(0)
    s_and_b32 s17, s17, 0xffff
    s_mov_b32 s18, 0x200000
    s_mov_b32 s19, 0x20000
    s_load_dwordx2 s[56:57], s[0:1], 64
    s_waitcnt lgkmcnt(0)
    s_and_b32 s57, s57, 0xffff
    s_mov_b32 s58, 0x400
    s_mov_b32 s59, 0x20000
    v_and_b32 v100, 63, v0
    v_lshlrev_b32 v240, 4, v100
    buffer_load_dwordx4 v[236:239], v240, s[56:59], 0 offen
    s_mov_b32 s65, 0x3f80
    s_mov_b32 s66, 0x3f800000
    s_waitcnt vmcnt(0)
    s_sub_u32 s67, s101, 128
    s_cmp_ge_u32 s67, 56
    s_cbranch_scc1 L_nostage_112
L_nostage_112:
    v_lshrrev_b32 v246, 2, v240
    s_lshl_b32 s24, s20, 7
    s_add_u32 s24, s24, 0x2000
    s_cmp_lg_u32 s100, 0
    s_cbranch_scc1 L_polls_115
    s_mov_b32 exec_lo, 0xffffffff
    s_mov_b32 exec_hi, 0
    s_mov_b32 s96, 0
L_poll_113:
    buffer_load_dword v247, v246, s[8:11], s24 offen sc1
    s_waitcnt vmcnt(0)
    v_cmp_gt_u32 vcc, 1, v247
    s_cbranch_vccz L_polld_114
    s_sleep 32
    s_add_u32 s96, s96, 1
    s_cmp_lt_u32 s96, 0x10000
    s_cbranch_scc1 L_poll_113
L_polld_114:
    s_mov_b64 exec, -1
L_polls_115:
    s_barrier
    s_lshl_b32 s24, s20, 7
    s_add_u32 s24, s24, 0x2800
    s_cmp_lg_u32 s100, 0
    s_cbranch_scc1 L_polls_118
    s_mov_b32 exec_lo, 0xffffffff
    s_mov_b32 exec_hi, 0
    s_mov_b32 s96, 0
L_poll_116:
    buffer_load_dword v247, v246, s[8:11], s24 offen sc1
    s_waitcnt vmcnt(0)
    v_cmp_gt_u32 vcc, 1, v247
    s_cbranch_vccz L_polld_117
    s_sleep 32
    s_add_u32 s96, s96, 1
    s_cmp_lt_u32 s96, 0x10000
    s_cbranch_scc1 L_poll_116
L_polld_117:
    s_mov_b64 exec, -1
L_polls_118:
    s_barrier
    s_lshl_b32 s24, s20, 7
    s_add_u32 s24, s24, 0x3000
    s_cmp_lg_u32 s100, 0
    s_cbranch_scc1 L_polls_121
    s_mov_b32 exec_lo, 0xffffffff
    s_mov_b32 exec_hi, 0
    s_mov_b32 s96, 0
L_poll_119:
    buffer_load_dword v247, v246, s[8:11], s24 offen sc1
    s_waitcnt vmcnt(0)
    v_cmp_gt_u32 vcc, 1, v247
    s_cbranch_vccz L_polld_120
    s_sleep 32
    s_add_u32 s96, s96, 1
    s_cmp_lt_u32 s96, 0x10000
    s_cbranch_scc1 L_poll_119
L_polld_120:
    s_mov_b64 exec, -1
L_polls_121:
    s_barrier
    s_mov_b32 s80, 0
    s_mov_b32 s82, 0
    v_add_u32 v105, 0x8000, v240
    v_add_u32 v106, 0x10000, v240
    v_add_u32 v107, 0x18000, v240
    s_lshl_b32 s24, s21, 12
    s_add_u32 s24, s24, 0x22000
    v_add_u32 v109, s24, v240
    s_nop 4
L_p2_seg:
    s_cmp_ge_u32 s22, 64
    s_cbranch_scc1 L_p2_end
    v_lshrrev_b32 v246, 2, v240
    s_lshl_b32 s24, s20, 7
    s_add_u32 s24, s24, 0x1000
    s_mul_i32 s25, s22, 10
    s_lshr_b32 s25, s25, 4
    s_add_u32 s25, s25, 17
    s_cmp_lg_u32 s100, 0
    s_cbranch_scc1 L_polls_124
    s_mov_b32 exec_lo, 0x1
    s_mov_b32 exec_hi, 0
    s_mov_b32 s96, 0
L_poll_122:
    buffer_load_dword v247, v246, s[8:11], s24 offen sc1
    s_waitcnt vmcnt(0)
    v_cmp_gt_u32 vcc, s25, v247
    s_cbranch_vccz L_polld_123
    v_readfirstlane_b32 s97, v247
    s_nop 0
    s_sub_u32 s97, s25, s97
    s_cmp_lt_i32 s97, 3
    s_cbranch_scc1 L_near_125
    s_sleep 40
    s_cmp_lt_i32 s97, 5
    s_cbranch_scc1 L_near_125
    s_sleep 100
L_near_125:
    s_sleep 4
    s_add_u32 s96, s96, 1
    s_cmp_lt_u32 s96, 0x10000
    s_cbranch_scc1 L_poll_122
L_polld_123:
    s_mov_b64 exec, -1
L_polls_124:
    s_barrier
    s_cmp_ge_u32 s67, 56
    s_cbranch_scc1 L_nostage_126
    v_mbcnt_lo_u32_b32 v0, -1, 0
    v_mbcnt_hi_u32_b32 v0, -1, v0
    s_lshl_b32 s96, s100, 6
    v_add_u32 v0, s96, v0
    v_lshrrev_b32 v2, 6, v0
    s_nop 0
    v_readfirstlane_b32 s68, v2
    v_and_b32 v1, 63, v0
    s_lshl_b32 s73, s68, 10
    v_lshrrev_b32 v2, 2, v1
    s_lshl_b32 s71, s68, 4
    v_add_u32 v2, s71, v2
    s_movk_i32 s71, 3584
    v_mul_lo_u32 v2, v2, s71
    v_and_b32 v3, 3, v1
    v_lshl_add_u32 v4, v3, 4, v2
    s_cmp_lg_u32 s80, 0
    s_cbranch_scc1 L_part_127
    s_load_dwordx2 s[76:77], s[0:1], 72
    s_waitcnt lgkmcnt(0)
    s_and_b32 s77, s77, 0xffff
    s_mov_b32 s78, 0x1c0000
    s_mov_b32 s79, 0x20000
    s_lshl_b32 s71, s67, 6
    s_add_u32 s71, s71, 0x0
    s_add_u32 m0, s73, 0x8000
    s_nop 0
    buffer_load_dwordx4 v4, s[76:79], s71 offen nt lds
    s_lshl_b32 s71, s67, 6
    s_add_u32 s71, s71, 0x38000
    s_add_u32 m0, s73, 0x9000
    s_nop 0
    buffer_load_dwordx4 v4, s[76:79], s71 offen nt lds
    s_lshl_b32 s71, s67, 6
    s_add_u32 s71, s71, 0x70000
    s_add_u32 m0, s73, 0xa000
    s_nop 0
    buffer_load_dwordx4 v4, s[76:79], s71 offen nt lds
    s_lshl_b32 s71, s67, 6
    s_add_u32 s71, s71, 0xa8000
    s_add_u32 m0, s73, 0xb000
    s_nop 0
    buffer_load_dwordx4 v4, s[76:79], s71 offen nt lds
    s_lshl_b32 s71, s67, 6
    s_add_u32 s71, s71, 0xe0000
    s_add_u32 m0, s73, 0xc000
    s_nop 0
    buffer_load_dwordx4 v4, s[76:79], s71 offen nt lds
    s_lshl_b32 s71, s67, 6
    s_add_u32 s71, s71, 0x118000
    s_add_u32 m0, s73, 0xd000
    s_nop 0
    buffer_load_dwordx4 v4, s[76:79], s71 offen nt lds
    s_lshl_b32 s71, s67, 6
    s_add_u32 s71, s71, 0x150000
    s_add_u32 m0, s73, 0xe000
    s_nop 0
    buffer_load_dwordx4 v4, s[76:79], s71 offen nt lds
    s_lshl_b32 s71, s67, 6
    s_add_u32 s71, s71, 0x188000
    s_add_u32 m0, s73, 0xf000
    s_nop 0
    buffer_load_dwordx4 v4, s[76:79], s71 offen nt lds
L_part_127:
    s_cmp_lg_u32 s80, 4
    s_cbranch_scc1 L_part_128
    s_load_dwordx2 s[76:77], s[0:1], 80
    s_waitcnt lgkmcnt(0)
    s_and_b32 s77, s77, 0xffff
    s_mov_b32 s78, 0x1c0000
    s_mov_b32 s79, 0x20000
    s_lshl_b32 s71, s67, 6
    s_add_u32 s71, s71, 0x0
    s_add_u32 m0, s73, 0x10000
    s_nop 0
    buffer_load_dwordx4 v4, s[76:79], s71 offen nt lds
    s_lshl_b32 s71, s67, 6
    s_add_u32 s71, s71, 0x38000
    s_add_u32 m0, s73, 0x11000
    s_nop 0
    buffer_load_dwordx4 v4, s[76:79], s71 offen nt lds
    s_lshl_b32 s71, s67, 6
    s_add_u32 s71, s71, 0x70000
    s_add_u32 m0, s73, 0x12000
    s_nop 0
    buffer_load_dwordx4 v4, s[76:79], s71 offen nt lds
    s_lshl_b32 s71, s67, 6
    s_add_u32 s71, s71, 0xa8000
    s_add_u32 m0, s73, 0x13000
    s_nop 0
    buffer_load_dwordx4 v4, s[76:79], s71 offen nt lds
    s_lshl_b32 s71, s67, 6
    s_add_u32 s71, s71, 0xe0000
    s_add_u32 m0, s73, 0x14000
    s_nop 0
    buffer_load_dwordx4 v4, s[76:79], s71 offen nt lds
    s_lshl_b32 s71, s67, 6
    s_add_u32 s71, s71, 0x118000
    s_add_u32 m0, s73, 0x15000
    s_nop 0
    buffer_load_dwordx4 v4, s[76:79], s71 offen nt lds
    s_lshl_b32 s71, s67, 6
    s_add_u32 s71, s71, 0x150000
    s_add_u32 m0, s73, 0x16000
    s_nop 0
    buffer_load_dwordx4 v4, s[76:79], s71 offen nt lds
    s_lshl_b32 s71, s67, 6
    s_add_u32 s71, s71, 0x188000
    s_add_u32 m0, s73, 0x17000
    s_nop 0
    buffer_load_dwordx4 v4, s[76:79], s71 offen nt lds
L_part_128:
    s_cmp_lg_u32 s80, 8
    s_cbranch_scc1 L_part_129
    s_load_dwordx2 s[76:77], s[0:1], 88
    s_waitcnt lgkmcnt(0)
    s_and_b32 s77, s77, 0xffff
    s_mov_b32 s78, 0x1c0000
    s_mov_b32 s79, 0x20000
    v_lshlrev_b32 v5, 4, v1
    v_add_u32 v5, s73, v5
    s_lshl_b32 s71, s67, 15
    s_add_u32 s71, s71, 0
    s_add_u32 m0, s73, 0x18000
    s_nop 0
    buffer_load_dwordx4 v5, s[76:79], s71 offen nt lds
    s_lshl_b32 s71, s67, 15
    s_add_u32 s71, s71, 4096
    s_add_u32 m0, s73, 0x19000
    s_nop 0
    buffer_load_dwordx4 v5, s[76:79], s71 offen nt lds
    s_lshl_b32 s71, s67, 15
    s_add_u32 s71, s71, 8192
    s_add_u32 m0, s73, 0x1a000
    s_nop 0
    buffer_load_dwordx4 v5, s[76:79], s71 offen nt lds
    s_lshl_b32 s71, s67, 15
    s_add_u32 s71, s71, 12288
    s_add_u32 m0, s73, 0x1b000
    s_nop 0
    buffer_load_dwordx4 v5, s[76:79], s71 offen nt lds
    s_lshl_b32 s71, s67, 15
    s_add_u32 s71, s71, 16384
    s_add_u32 m0, s73, 0x1c000
    s_nop 0
    buffer_load_dwordx4 v5, s[76:79], s71 offen nt lds
    s_lshl_b32 s71, s67, 15
    s_add_u32 s71, s71, 20480
    s_add_u32 m0, s73, 0x1d000
    s_nop 0
    buffer_load_dwordx4 v5, s[76:79], s71 offen nt lds
    s_lshl_b32 s71, s67, 15
    s_add_u32 s71, s71, 24576
    s_add_u32 m0, s73, 0x1e000
    s_nop 0
    buffer_load_dwordx4 v5, s[76:79], s71 offen nt lds
    s_lshl_b32 s71, s67, 15
    s_add_u32 s71, s71, 28672
    s_add_u32 m0, s73, 0x1f000
    s_nop 0
    buffer_load_dwordx4 v5, s[76:79], s71 offen nt lds
L_part_129:
L_nostage_126:
    s_lshl_b32 s24, s22, 5
    s_lshl_b32 s25, s20, 1
    s_add_u32 s24, s24, s25
    s_lshr_b32 s25, s21, 1
    s_add_u32 s24, s24, s25
    s_lshl_b32 s25, s24, 13
    s_add_u32 s47, s25, 0x1000000
    s_add_u32 s54, s47, 4096
    s_add_u32 s48, s25, 0x2000000
    s_add_u32 s55, s48, 4096
    s_and_b32 s26, s21, 1
    s_lshl_b32 s26, s26, 12
    s_add_u32 s46, s25, s26
    s_add_u32 s46, s46, 0x3000000
    s_lshl_b32 s25, s24, 12
    s_add_u32 s49, s25, 0x240000
    s_mov_b32 s63, s22
    s_lshl_b32 s24, s63, 4
    s_add_u32 s24, s24, s20
    s_lshl_b32 s24, s24, 15
    s_add_u32 s51, s24, 0x4000000
    s_cmp_ge_u32 s22, 60
    s_cselect_b32 s81, 1, 0
    s_lshl_b32 s60, s20, 1
    s_lshr_b32 s24, s100, 1
    s_add_u32 s60, s60, s24
    s_cmp_ge_u32 s22, 62
    s_cselect_b32 s24, 1, 0
    s_max_u32 s82, s82, s24
    s_lshl_b32 s24, s82, 3
    s_and_b32 s24, s24, 16
    s_add_u32 s24, s24, s20
    s_cmp_lg_u32 s82, 0
    s_cselect_b32 s60, s24, s60
    s_cselect_b32 s61, 0, 0x20000
    s_cselect_b32 s24, 17, 18
    s_lshl_b32 s50, s100, s24
    s_and_b32 s50, s50, 0x60000
    s_lshl_b32 s24, s60, 10
    s_add_u32 s50, s50, s24
    s_lshl_b32 s24, s63, 19
    s_add_u32 s50, s50, s24
    s_add_u32 s50, s50, 0x4000000
    s_add_u32 s61, s61, s50
    s_and_b32 s24, s82, 2
    s_lshl_b32 s24, s24, 13
    s_add_u32 s51, s51, s24
    s_lshl_b32 s24, s22, 5
    s_add_u32 s60, s60, s24
    s_lshl_b32 s64, s60, 10
    buffer_load_dwordx4 v[96:99], v240, s[12:15], s64 offen
    s_lshl_b32 s52, s22, 6
    s_add_u32 s52, s52, 0x4000
    s_lshl_b32 s24, s22, 7
    s_and_b32 s25, s82, 2
    s_lshl_b32 s25, s25, 7
    s_add_u32 s24, s24, s25
    s_add_u32 s24, s24, 0x6a00
    s_cmp_lg_u32 s81, 0
    s_cselect_b32 s52, s24, s52
    s_cmp_ge_u32 s22, 61
    s_cselect_b32 s83, s87, 0
    s_and_b32 s83, s83, 1
    s_cbranch_scc0 L_notouch_130
    buffer_load_dword v245, off, s[8:11], s52 sc1
    s_cmp_lg_u32 s82, 0
    s_cselect_b32 s25, 2, 3
    v_lshlrev_b32 v246, s25, v240
    s_lshl_b32 s24, s27, s25
    s_add_u32 s24, s24, s51
    buffer_load_dword v245, v246, s[8:11], s24 offen sc1
    s_cmp_eq_u32 s82, 0
    s_cbranch_scc1 L_notouch_130
    s_mov_b32 s83, 3
    v_mov_b32 v140, -1
    v_mov_b32 v141, -1
    v_mov_b32 v142, -1
    v_mov_b32 v143, -1
    s_waitcnt vmcnt(0)
    s_barrier
    buffer_store_dwordx4 v[140:143], v242, s[8:11], s51 offen
    buffer_store_dwordx4 v[140:143], v242, s[8:11], s51 offen offset:64
    buffer_store_dwordx4 v[140:143], v242, s[8:11], s51 offen offset:128
    buffer_store_dwordx4 v[140:143], v242, s[8:11], s51 offen offset:192
L_notouch_130:
    buffer_load_dwordx4 v[0:3], v240, s[8:11], s46 offen
    buffer_load_dwordx4 v[4:7], v240, s[8:11], s46 offen offset:1024
    buffer_load_dwordx4 v[8:11], v240, s[8:11], s46 offen offset:2048
    buffer_load_dwordx4 v[12:15], v240, s[8:11], s46 offen offset:3072
    buffer_load_dwordx4 v[16:19], v240, s[8:11], s47 offen
    buffer_load_dwordx4 v[20:23], v240, s[8:11], s47 offen offset:1024
    buffer_load_dwordx4 v[24:27], v240, s[8:11], s47 offen offset:2048
    buffer_load_dwordx4 v[28:31], v240, s[8:11], s47 offen offset:3072
    buffer_load_dwordx4 v[32:35], v240, s[8:11], s54 offen
    buffer_load_dwordx4 v[36:39], v240, s[8:11], s54 offen offset:1024
    buffer_load_dwordx4 v[40:43], v240, s[8:11], s54 offen offset:2048
    buffer_load_dwordx4 v[44:47], v240, s[8:11], s54 offen offset:3072
    buffer_load_dwordx4 v[64:67], v240, s[8:11], s48 offen
    buffer_load_dwordx4 v[68:71], v240, s[8:11], s48 offen offset:1024
    buffer_load_dwordx4 v[72:75], v240, s[8:11], s48 offen offset:2048
    buffer_load_dwordx4 v[76:79], v240, s[8:11], s48 offen offset:3072
    buffer_load_dwordx4 v[80:83], v240, s[8:11], s55 offen
    buffer_load_dwordx4 v[84:87], v240, s[8:11], s55 offen offset:1024
    buffer_load_dwordx4 v[88:91], v240, s[8:11], s55 offen offset:2048
    buffer_load_dwordx4 v[92:95], v240, s[8:11], s55 offen offset:3072
    s_waitcnt vmcnt(8)
    v_mfma_f32_16x16x32_bf16 v[116:119], v[16:19], v[0:3], 0
    v_mfma_f32_16x16x32_bf16 v[116:119], v[20:23], v[4:7], v[116:119]
    v_mfma_f32_16x16x32_bf16 v[116:119], v[24:27], v[8:11], v[116:119]
    v_mfma_f32_16x16x32_bf16 v[116:119], v[28:31], v[12:15], v[116:119]
    v_mfma_f32_16x16x32_bf16 v[120:123], v[32:35], v[0:3], 0
    v_mfma_f32_16x16x32_bf16 v[120:123], v[36:39], v[4:7], v[120:123]
    v_mfma_f32_16x16x32_bf16 v[120:123], v[40:43], v[8:11], v[120:123]
    v_mfma_f32_16x16x32_bf16 v[120:123], v[44:47], v[12:15], v[120:123]
    v_mov_b32 v247, s53
    v_cndmask_b32 v116, v247, v116, s[30:31]
    v_cndmask_b32 v117, v247, v117, s[32:33]
    v_cndmask_b32 v118, v247, v118, s[34:35]
    v_cndmask_b32 v119, v247, v119, s[36:37]
    s_nop 2
    v_cndmask_b32 v120, v247, v120, s[38:39]
    v_cndmask_b32 v121, v247, v121, s[40:41]
    v_cndmask_b32 v122, v247, v122, s[42:43]
    v_cndmask_b32 v123, v247, v123, s[44:45]
    v_max3_f32 v246, v116, v117, v118
    v_max3_f32 v246, v246, v119, v120
    v_max3_f32 v246, v246, v121, v122
    v_max_f32 v246, v246, v123
    v_mov_b32 v247, v246
    s_nop 1
    v_permlane32_swap_b32 v247, v246
    v_max_f32 v246, v247, v246
    v_mov_b32 v247, v246
    s_nop 1
    v_permlane16_swap_b32 v247, v246
    v_max_f32 v246, v247, v246
    v_mul_f32 v248, s28, v246
    v_pk_fma_f32 v[116:117], v[116:117], s[28:29], v[248:249] op_sel_hi:[1,1,0] neg_lo:[0,0,1] neg_hi:[0,0,1]
    v_pk_fma_f32 v[118:119], v[118:119], s[28:29], v[248:249] op_sel_hi:[1,1,0] neg_lo:[0,0,1] neg_hi:[0,0,1]
    v_pk_fma_f32 v[120:121], v[120:121], s[28:29], v[248:249] op_sel_hi:[1,1,0] neg_lo:[0,0,1] neg_hi:[0,0,1]
    v_pk_fma_f32 v[122:123], v[122:123], s[28:29], v[248:249] op_sel_hi:[1,1,0] neg_lo:[0,0,1] neg_hi:[0,0,1]
    v_exp_f32 v116, v116
    v_exp_f32 v117, v117
    v_exp_f32 v118, v118
    v_exp_f32 v119, v119
    v_exp_f32 v120, v120
    v_exp_f32 v121, v121
    v_exp_f32 v122, v122
    v_exp_f32 v123, v123
    v_cvt_pk_bf16_f32 v124, v116, v117
    v_cvt_pk_bf16_f32 v125, v118, v119
    v_cvt_pk_bf16_f32 v126, v120, v121
    v_cvt_pk_bf16_f32 v127, v122, v123
    v_mov_b32 v129, 0
    s_nop 0
    v_mfma_f32_16x16x32_bf16 v[132:135], v[136:139], v[124:127], 0
    s_waitcnt vmcnt(7)
    v_mfma_f32_16x16x32_bf16 v[140:143], v[64:67], v[124:127], 0
    s_waitcnt vmcnt(6)
    v_mfma_f32_16x16x32_bf16 v[144:147], v[68:71], v[124:127], 0
    s_waitcnt vmcnt(5)
    v_mfma_f32_16x16x32_bf16 v[148:151], v[72:75], v[124:127], 0
    s_waitcnt vmcnt(4)
    v_mfma_f32_16x16x32_bf16 v[152:155], v[76:79], v[124:127], 0
    s_waitcnt vmcnt(3)
    v_mfma_f32_16x16x32_bf16 v[156:159], v[80:83], v[124:127], 0
    s_waitcnt vmcnt(2)
    v_mfma_f32_16x16x32_bf16 v[160:163], v[84:87], v[124:127], 0
    s_waitcnt vmcnt(1)
    v_mfma_f32_16x16x32_bf16 v[164:167], v[88:91], v[124:127], 0
    s_waitcnt vmcnt(0)
    v_mfma_f32_16x16x32_bf16 v[168:171], v[92:95], v[124:127], 0
    v_lshrrev_b32 v246, 2, v240
    s_lshl_b32 s24, s20, 7
    s_add_u32 s24, s24, 0x1000
    s_add_u32 s25, s22, 1
    s_sub_u32 s26, s22, 1
    s_min_u32 s26, s26, 61
    s_cmp_lg_u32 s81, 0
    s_cselect_b32 s25, s26, s25
    s_cmp_lg_u32 s100, 0
    s_cbranch_scc1 L_polls_133
    s_mov_b32 exec_lo, 0x11
    s_mov_b32 exec_hi, 0
    s_mov_b32 s96, 0
L_poll_131:
    buffer_load_dword v247, v246, s[8:11], s24 offen sc1
    s_waitcnt vmcnt(0)
    v_cmp_gt_u32 vcc, s25, v247
    s_cbranch_vccz L_polld_132
    v_readfirstlane_b32 s97, v247
    s_nop 0
    s_sub_u32 s97, s25, s97
    s_cmp_lt_i32 s97, 3
    s_cbranch_scc1 L_near_134
    s_sleep 40
    s_cmp_lt_i32 s97, 5
    s_cbranch_scc1 L_near_134
    s_sleep 100
L_near_134:
    s_sleep 4
    s_add_u32 s96, s96, 1
    s_cmp_lt_u32 s96, 0x10000
    s_cbranch_scc1 L_poll_131
L_polld_132:
    s_mov_b64 exec, -1
L_polls_133:
    s_barrier
    s_cmp_eq_u32 s81, 0
    s_cbranch_scc1 L_kmf_136
    s_cmp_lg_u32 s83, 3
    s_cbranch_scc1 L_noinit_138
    s_lshl_b32 s26, s20, 2
    s_add_u32 s26, s26, s52
    s_cmp_lg_u32 s100, 0
    s_cbranch_scc1 L_flag_139
    v_mov_b32 v246, 1
    s_mov_b64 exec, 1
    buffer_store_dword v246, off, s[8:11], s26
    s_mov_b64 exec, -1
L_flag_139:
L_noinit_138:
    s_lshr_b32 s26, s21, 1
    s_lshl_b32 s26, s26, 4
    s_add_u32 s24, s24, s26
    s_mov_b32 s96, 0
    buffer_load_dword v245, off, s[8:11], s24 sc1
    buffer_load_dwordx4 v[220:223], v240, s[8:11], s49 offen sc1
    buffer_load_dwordx4 v[224:227], v240, s[8:11], s49 offen offset:1024 sc1
    buffer_load_dwordx4 v[228:231], v240, s[8:11], s49 offen offset:2048 sc1
    buffer_load_dwordx4 v[232:235], v240, s[8:11], s49 offen offset:3072 sc1
    s_sleep 14
L_kmp_135:
    buffer_load_dword v245, off, s[8:11], s24 sc1
    buffer_load_dwordx4 v[220:223], v240, s[8:11], s49 offen sc1
    buffer_load_dwordx4 v[224:227], v240, s[8:11], s49 offen offset:1024 sc1
    buffer_load_dwordx4 v[228:231], v240, s[8:11], s49 offen offset:2048 sc1
    buffer_load_dwordx4 v[232:235], v240, s[8:11], s49 offen offset:3072 sc1
    s_add_u32 s96, s96, 1
    s_waitcnt vmcnt(5)
    v_max3_u32 v246, v220, v221, v222
    v_max3_u32 v246, v246, v223, v224
    v_max3_u32 v246, v246, v225, v226
    v_max3_u32 v246, v246, v227, v228
    v_max3_u32 v246, v246, v229, v230
    v_max3_u32 v246, v246, v231, v232
    v_max3_u32 v246, v246, v233, v234
    v_max_u32 v246, v246, v235
    v_cmp_eq_u32 vcc, -1, v246
    v_readfirstlane_b32 s26, v245
    s_cbranch_vccz L_kmo_137
    s_cmp_gt_u32 s26, s22
    s_cbranch_scc1 L_kmf_136
    s_cmp_lt_u32 s96, 0x10000
    s_cbranch_scc1 L_kmp_135
L_kmf_136:
    buffer_load_dwordx4 v[220:223], v240, s[8:11], s49 offen sc1
    buffer_load_dwordx4 v[224:227], v240, s[8:11], s49 offen offset:1024 sc1
    buffer_load_dwordx4 v[228:231], v240, s[8:11], s49 offen offset:2048 sc1
    buffer_load_dwordx4 v[232:235], v240, s[8:11], s49 offen offset:3072 sc1
    s_waitcnt vmcnt(0)
L_kmo_137:
    ds_write_b32 v253, v221
    ds_write_b32 v253, v223 offset:64
    ds_write_b32 v253, v225 offset:1024
    ds_write_b32 v253, v227 offset:1088
    ds_write_b32 v253, v229 offset:2048
    ds_write_b32 v253, v231 offset:2112
    ds_write_b32 v253, v233 offset:3072
    ds_write_b32 v253, v235 offset:3136
    ds_read_b128 v[48:51], v254
    ds_read_b128 v[52:55], v254 offset:1024
    ds_read_b128 v[56:59], v254 offset:2048
    ds_read_b128 v[60:63], v254 offset:3072
    s_cmp_lg_u32 s83, 3
    s_cbranch_scc1 L_noside_140
    s_mov_b32 s62, 0x8f00
    buffer_load_dword v104, off, s[8:11], s62 sc1
    v_bfe_u32 v108, v240, 2, 6
    buffer_load_dword v108, v108, s[8:11], s52 offen sc1
L_noside_140:
    s_waitcnt lgkmcnt(3)
    v_mfma_f32_16x16x32_bf16 v[112:115], v[48:51], v[0:3], 0
    s_waitcnt lgkmcnt(2)
    v_mfma_f32_16x16x32_bf16 v[112:115], v[52:55], v[4:7], v[112:115]
    s_waitcnt lgkmcnt(1)
    v_mfma_f32_16x16x32_bf16 v[112:115], v[56:59], v[8:11], v[112:115]
    s_waitcnt lgkmcnt(0)
    v_mfma_f32_16x16x32_bf16 v[112:115], v[60:63], v[12:15], v[112:115]
    s_nop 7
    v_pk_fma_f32 v[114:115], v[112:113], s[28:29], v[248:249] op_sel_hi:[1,1,0] neg_lo:[0,0,1] neg_hi:[0,0,1]
    v_max_f32 v246, v114, v115
    v_cmp_lt_f32 vcc, 0x42200000, v246
    s_cbranch_vccnz L_redo_141
L_redone_142:
    v_exp_f32 v114, v114
    v_exp_f32 v115, v115
    s_nop 0
    v_cvt_pk_bf16_f32 v128, v114, v115
    s_nop 1
    v_mfma_f32_16x16x16_bf16 v[132:135], v[136:137], v[128:129], v[132:135]
    v_mfma_f32_16x16x16_bf16 v[140:143], v[220:221], v[128:129], v[140:143]
    v_mfma_f32_16x16x16_bf16 v[144:147], v[222:223], v[128:129], v[144:147]
    v_mfma_f32_16x16x16_bf16 v[148:151], v[224:225], v[128:129], v[148:151]
    v_rcp_f32 v250, v132
    v_mfma_f32_16x16x16_bf16 v[152:155], v[226:227], v[128:129], v[152:155]
    v_mul_f32 v140, v250, v140
    v_mul_f32 v141, v250, v141
    v_mfma_f32_16x16x16_bf16 v[156:159], v[228:229], v[128:129], v[156:159]
    v_mul_f32 v142, v250, v142
    v_mul_f32 v143, v250, v143
    v_mfma_f32_16x16x16_bf16 v[160:163], v[230:231], v[128:129], v[160:163]
    v_cvt_pk_bf16_f32 v140, v140, v141
    v_cvt_pk_bf16_f32 v141, v142, v143
    v_mfma_f32_16x16x16_bf16 v[164:167], v[232:233], v[128:129], v[164:167]
    v_mul_f32 v144, v250, v144
    v_mul_f32 v145, v250, v145
    v_mfma_f32_16x16x16_bf16 v[168:171], v[234:235], v[128:129], v[168:171]
    v_mul_f32 v146, v250, v146
    v_mul_f32 v147, v250, v147
    v_cvt_pk_bf16_f32 v142, v144, v145
    v_cvt_pk_bf16_f32 v143, v146, v147
    ds_write_b128 v243, v[140:143]
    v_pk_mul_f32 v[148:149], v[148:149], v[250:251] op_sel_hi:[1,0]
    v_pk_mul_f32 v[150:151], v[150:151], v[250:251] op_sel_hi:[1,0]
    v_cvt_pk_bf16_f32 v144, v148, v149
    v_cvt_pk_bf16_f32 v145, v150, v151
    v_pk_mul_f32 v[152:153], v[152:153], v[250:251] op_sel_hi:[1,0]
    v_pk_mul_f32 v[154:155], v[154:155], v[250:251] op_sel_hi:[1,0]
    v_cvt_pk_bf16_f32 v146, v152, v153
    v_cvt_pk_bf16_f32 v147, v154, v155
    ds_write_b128 v243, v[144:147] offset:1024
    v_pk_mul_f32 v[156:157], v[156:157], v[250:251] op_sel_hi:[1,0]
    v_pk_mul_f32 v[158:159], v[158:159], v[250:251] op_sel_hi:[1,0]
    v_cvt_pk_bf16_f32 v148, v156, v157
    v_cvt_pk_bf16_f32 v149, v158, v159
    v_pk_mul_f32 v[160:161], v[160:161], v[250:251] op_sel_hi:[1,0]
    v_pk_mul_f32 v[162:163], v[162:163], v[250:251] op_sel_hi:[1,0]
    v_cvt_pk_bf16_f32 v150, v160, v161
    v_cvt_pk_bf16_f32 v151, v162, v163
    ds_write_b128 v243, v[148:151] offset:2048
    v_pk_mul_f32 v[164:165], v[164:165], v[250:251] op_sel_hi:[1,0]
    v_pk_mul_f32 v[166:167], v[166:167], v[250:251] op_sel_hi:[1,0]
    v_cvt_pk_bf16_f32 v152, v164, v165
    v_cvt_pk_bf16_f32 v153, v166, v167
    v_pk_mul_f32 v[168:169], v[168:169], v[250:251] op_sel_hi:[1,0]
    v_pk_mul_f32 v[170:171], v[170:171], v[250:251] op_sel_hi:[1,0]
    v_cvt_pk_bf16_f32 v154, v168, v169
    v_cvt_pk_bf16_f32 v155, v170, v171
    ds_write_b128 v243, v[152:155] offset:3072
    s_waitcnt lgkmcnt(0)
    s_barrier
    s_lshr_b32 s25, s82, 1
    s_lshl_b32 s24, s25, 12
    v_add_u32 v246, s24, v244
    ds_read_b128 v[0:3], v246
    ds_read_b128 v[4:7], v246 offset:1024
    ds_read_b128 v[8:11], v246 offset:2048
    ds_read_b128 v[12:15], v246 offset:3072
    ds_read_b128 v[32:35], v246 offset:8192
    ds_read_b128 v[36:39], v246 offset:9216
    ds_read_b128 v[40:43], v246 offset:10240
    ds_read_b128 v[44:47], v246 offset:11264
    v_xor_b32 v243, 0x4000, v243
    s_waitcnt lgkmcnt(7)
    v_mfma_f32_16x16x32_bf16 v[172:175], a[0:3], v[0:3], 0
    v_mfma_f32_16x16x32_bf16 v[176:179], a[4:7], v[0:3], 0
    s_waitcnt lgkmcnt(6)
    v_mfma_f32_16x16x32_bf16 v[172:175], a[32:35], v[4:7], v[172:175]
    v_mfma_f32_16x16x32_bf16 v[176:179], a[36:39], v[4:7], v[176:179]
    s_waitcnt lgkmcnt(5)
    v_mfma_f32_16x16x32_bf16 v[172:175], a[64:67], v[8:11], v[172:175]
    v_mfma_f32_16x16x32_bf16 v[176:179], a[68:71], v[8:11], v[176:179]
    s_waitcnt lgkmcnt(4)
    v_mfma_f32_16x16x32_bf16 v[172:175], a[96:99], v[12:15], v[172:175]
    v_mfma_f32_16x16x32_bf16 v[176:179], a[100:103], v[12:15], v[176:179]
    s_waitcnt lgkmcnt(3)
    v_mfma_f32_16x16x32_bf16 v[172:175], a[128:131], v[32:35], v[172:175]
    v_mfma_f32_16x16x32_bf16 v[176:179], a[132:135], v[32:35], v[176:179]
    s_waitcnt lgkmcnt(2)
    v_mfma_f32_16x16x32_bf16 v[172:175], a[160:163], v[36:39], v[172:175]
    v_mfma_f32_16x16x32_bf16 v[176:179], a[164:167], v[36:39], v[176:179]
    s_waitcnt lgkmcnt(1)
    v_mfma_f32_16x16x32_bf16 v[172:175], a[192:195], v[40:43], v[172:175]
    v_mfma_f32_16x16x32_bf16 v[176:179], a[196:199], v[40:43], v[176:179]
    s_waitcnt lgkmcnt(0)
    v_mfma_f32_16x16x32_bf16 v[172:175], a[224:227], v[44:47], v[172:175]
    v_mfma_f32_16x16x32_bf16 v[176:179], a[228:231], v[44:47], v[176:179]
    v_mfma_f32_16x16x32_bf16 v[180:183], a[8:11], v[0:3], 0
    v_mfma_f32_16x16x32_bf16 v[184:187], a[12:15], v[0:3], 0
    ds_read_b128 v[16:19], v244 offset:4096
    v_mfma_f32_16x16x32_bf16 v[180:183], a[40:43], v[4:7], v[180:183]
    v_mfma_f32_16x16x32_bf16 v[184:187], a[44:47], v[4:7], v[184:187]
    ds_read_b128 v[20:23], v244 offset:5120
    v_cvt_pk_bf16_f32 v140, v172, v173
    v_cvt_pk_bf16_f32 v141, v174, v175
    v_cvt_pk_bf16_f32 v142, v176, v177
    v_cvt_pk_bf16_f32 v143, v178, v179
    v_min_u32 v140, 0xfffffffe, v140
    s_add_u32 s24, s51, 0
    s_cmp_lg_u32 s83, 0
    s_cbranch_scc1 L_near_145
    buffer_store_dwordx4 v[140:143], v242, s[8:11], s24 offen sc1
    s_branch L_far_146
L_near_145:
    buffer_store_dwordx4 v[140:143], v242, s[8:11], s24 offen
L_far_146:
    v_mfma_f32_16x16x32_bf16 v[180:183], a[72:75], v[8:11], v[180:183]
    v_mfma_f32_16x16x32_bf16 v[184:187], a[76:79], v[8:11], v[184:187]
    ds_read_b128 v[24:27], v244 offset:6144
    v_mfma_f32_16x16x32_bf16 v[180:183], a[104:107], v[12:15], v[180:183]
    v_mfma_f32_16x16x32_bf16 v[184:187], a[108:111], v[12:15], v[184:187]
    ds_read_b128 v[28:31], v244 offset:7168
    v_mfma_f32_16x16x32_bf16 v[180:183], a[136:139], v[32:35], v[180:183]
    v_mfma_f32_16x16x32_bf16 v[184:187], a[140:143], v[32:35], v[184:187]
    ds_read_b128 v[48:51], v244 offset:12288
    v_mfma_f32_16x16x32_bf16 v[180:183], a[168:171], v[36:39], v[180:183]
    v_mfma_f32_16x16x32_bf16 v[184:187], a[172:175], v[36:39], v[184:187]
    ds_read_b128 v[52:55], v244 offset:13312
    v_mfma_f32_16x16x32_bf16 v[180:183], a[200:203], v[40:43], v[180:183]
    v_mfma_f32_16x16x32_bf16 v[184:187], a[204:207], v[40:43], v[184:187]
    ds_read_b128 v[56:59], v244 offset:14336
    v_mfma_f32_16x16x32_bf16 v[180:183], a[232:235], v[44:47], v[180:183]
    v_mfma_f32_16x16x32_bf16 v[184:187], a[236:239], v[44:47], v[184:187]
    ds_read_b128 v[60:63], v244 offset:15360
    v_mfma_f32_16x16x32_bf16 v[188:191], a[16:19], v[0:3], 0
    v_mfma_f32_16x16x32_bf16 v[192:195], a[20:23], v[0:3], 0
    v_mfma_f32_16x16x32_bf16 v[188:191], a[48:51], v[4:7], v[188:191]
    v_mfma_f32_16x16x32_bf16 v[192:195], a[52:55], v[4:7], v[192:195]
    v_cvt_pk_bf16_f32 v144, v180, v181
    v_cvt_pk_bf16_f32 v145, v182, v183
    v_cvt_pk_bf16_f32 v146, v184, v185
    v_cvt_pk_bf16_f32 v147, v186, v187
    v_min_u32 v144, 0xfffffffe, v144
    s_cmp_lg_u32 s83, 0
    s_cbranch_scc1 L_near_147
    buffer_store_dwordx4 v[144:147], v242, s[8:11], s24 offen offset:64 sc1
    s_branch L_far_148
L_near_147:
    buffer_store_dwordx4 v[144:147], v242, s[8:11], s24 offen offset:64
L_far_148:
    v_mfma_f32_16x16x32_bf16 v[188:191], a[80:83], v[8:11], v[188:191]
    v_mfma_f32_16x16x32_bf16 v[192:195], a[84:87], v[8:11], v[192:195]
    v_mfma_f32_16x16x32_bf16 v[188:191], a[112:115], v[12:15], v[188:191]
    v_mfma_f32_16x16x32_bf16 v[192:195], a[116:119], v[12:15], v[192:195]
    v_mfma_f32_16x16x32_bf16 v[188:191], a[144:147], v[32:35], v[188:191]
    v_mfma_f32_16x16x32_bf16 v[192:195], a[148:151], v[32:35], v[192:195]
    v_mfma_f32_16x16x32_bf16 v[188:191], a[176:179], v[36:39], v[188:191]
    v_mfma_f32_16x16x32_bf16 v[192:195], a[180:183], v[36:39], v[192:195]
    v_mfma_f32_16x16x32_bf16 v[188:191], a[208:211], v[40:43], v[188:191]
    v_mfma_f32_16x16x32_bf16 v[192:195], a[212:215], v[40:43], v[192:195]
    v_mfma_f32_16x16x32_bf16 v[188:191], a[240:243], v[44:47], v[188:191]
    v_mfma_f32_16x16x32_bf16 v[192:195], a[244:247], v[44:47], v[192:195]
    v_mfma_f32_16x16x32_bf16 v[196:199], a[24:27], v[0:3], 0
    v_mfma_f32_16x16x32_bf16 v[200:203], a[28:31], v[0:3], 0
    v_mfma_f32_16x16x32_bf16 v[196:199], a[56:59], v[4:7], v[196:199]
    v_mfma_f32_16x16x32_bf16 v[200:203], a[60:63], v[4:7], v[200:203]
    v_cvt_pk_bf16_f32 v148, v188, v189
    v_cvt_pk_bf16_f32 v149, v190, v191
    v_cvt_pk_bf16_f32 v150, v192, v193
    v_cvt_pk_bf16_f32 v151, v194, v195
    v_min_u32 v148, 0xfffffffe, v148
    s_cmp_lg_u32 s83, 0
    s_cbranch_scc1 L_near_149
    buffer_store_dwordx4 v[148:151], v242, s[8:11], s24 offen offset:128 sc1
    s_branch L_far_150
L_near_149:
    buffer_store_dwordx4 v[148:151], v242, s[8:11], s24 offen offset:128
L_far_150:
    v_mfma_f32_16x16x32_bf16 v[196:199], a[88:91], v[8:11], v[196:199]
    v_mfma_f32_16x16x32_bf16 v[200:203], a[92:95], v[8:11], v[200:203]
    v_mfma_f32_16x16x32_bf16 v[196:199], a[120:123], v[12:15], v[196:199]
    v_mfma_f32_16x16x32_bf16 v[200:203], a[124:127], v[12:15], v[200:203]
    v_mfma_f32_16x16x32_bf16 v[196:199], a[152:155], v[32:35], v[196:199]
    v_mfma_f32_16x16x32_bf16 v[200:203], a[156:159], v[32:35], v[200:203]
    v_mfma_f32_16x16x32_bf16 v[196:199], a[184:187], v[36:39], v[196:199]
    v_mfma_f32_16x16x32_bf16 v[200:203], a[188:191], v[36:39], v[200:203]
    v_mfma_f32_16x16x32_bf16 v[196:199], a[216:219], v[40:43], v[196:199]
    v_mfma_f32_16x16x32_bf16 v[200:203], a[220:223], v[40:43], v[200:203]
    v_mfma_f32_16x16x32_bf16 v[196:199], a[248:251], v[44:47], v[196:199]
    v_mfma_f32_16x16x32_bf16 v[200:203], a[252:255], v[44:47], v[200:203]
    v_xor_b32 v244, 0x4000, v244
    s_cmp_lg_u32 s82, 0
    s_cbranch_scc1 L_half_143
    s_waitcnt lgkmcnt(0)
    v_mfma_f32_16x16x32_bf16 v[204:207], a[0:3], v[16:19], 0
    v_mfma_f32_16x16x32_bf16 v[208:211], a[4:7], v[16:19], 0
    v_mfma_f32_16x16x32_bf16 v[204:207], a[32:35], v[20:23], v[204:207]
    v_mfma_f32_16x16x32_bf16 v[208:211], a[36:39], v[20:23], v[208:211]
    v_cvt_pk_bf16_f32 v152, v196, v197
    v_cvt_pk_bf16_f32 v153, v198, v199
    v_cvt_pk_bf16_f32 v154, v200, v201
    v_cvt_pk_bf16_f32 v155, v202, v203
    v_min_u32 v152, 0xfffffffe, v152
    s_cmp_lg_u32 s83, 0
    s_cbranch_scc1 L_near_151
    buffer_store_dwordx4 v[152:155], v242, s[8:11], s24 offen offset:192 sc1
    s_branch L_far_152
L_near_151:
    buffer_store_dwordx4 v[152:155], v242, s[8:11], s24 offen offset:192
L_far_152:
    v_mfma_f32_16x16x32_bf16 v[204:207], a[64:67], v[24:27], v[204:207]
    v_mfma_f32_16x16x32_bf16 v[208:211], a[68:71], v[24:27], v[208:211]
    v_mfma_f32_16x16x32_bf16 v[204:207], a[96:99], v[28:31], v[204:207]
    v_mfma_f32_16x16x32_bf16 v[208:211], a[100:103], v[28:31], v[208:211]
    v_mfma_f32_16x16x32_bf16 v[204:207], a[128:131], v[48:51], v[204:207]
    v_mfma_f32_16x16x32_bf16 v[208:211], a[132:135], v[48:51], v[208:211]
    v_mfma_f32_16x16x32_bf16 v[204:207], a[160:163], v[52:55], v[204:207]
    v_mfma_f32_16x16x32_bf16 v[208:211], a[164:167], v[52:55], v[208:211]
    v_mfma_f32_16x16x32_bf16 v[204:207], a[192:195], v[56:59], v[204:207]
    v_mfma_f32_16x16x32_bf16 v[208:211], a[196:199], v[56:59], v[208:211]
    v_mfma_f32_16x16x32_bf16 v[204:207], a[224:227], v[60:63], v[204:207]
    v_mfma_f32_16x16x32_bf16 v[208:211], a[228:231], v[60:63], v[208:211]
    v_mfma_f32_16x16x32_bf16 v[212:215], a[8:11], v[16:19], 0
    v_mfma_f32_16x16x32_bf16 v[216:219], a[12:15], v[16:19], 0
    v_mfma_f32_16x16x32_bf16 v[212:215], a[40:43], v[20:23], v[212:215]
    v_mfma_f32_16x16x32_bf16 v[216:219], a[44:47], v[20:23], v[216:219]
    v_cvt_pk_bf16_f32 v140, v204, v205
    v_cvt_pk_bf16_f32 v141, v206, v207
    v_cvt_pk_bf16_f32 v142, v208, v209
    v_cvt_pk_bf16_f32 v143, v210, v211
    v_min_u32 v140, 0xfffffffe, v140
    s_add_u32 s24, s51, 16384
    s_cmp_lg_u32 s83, 0
    s_cbranch_scc1 L_near_153
    buffer_store_dwordx4 v[140:143], v242, s[8:11], s24 offen sc1
    s_branch L_far_154
L_near_153:
    buffer_store_dwordx4 v[140:143], v242, s[8:11], s24 offen
L_far_154:
    v_mfma_f32_16x16x32_bf16 v[212:215], a[72:75], v[24:27], v[212:215]
    v_mfma_f32_16x16x32_bf16 v[216:219], a[76:79], v[24:27], v[216:219]
    v_mfma_f32_16x16x32_bf16 v[212:215], a[104:107], v[28:31], v[212:215]
    v_mfma_f32_16x16x32_bf16 v[216:219], a[108:111], v[28:31], v[216:219]
    v_mfma_f32_16x16x32_bf16 v[212:215], a[136:139], v[48:51], v[212:215]
    v_mfma_f32_16x16x32_bf16 v[216:219], a[140:143], v[48:51], v[216:219]
    v_mfma_f32_16x16x32_bf16 v[212:215], a[168:171], v[52:55], v[212:215]
    v_mfma_f32_16x16x32_bf16 v[216:219], a[172:175], v[52:55], v[216:219]
    v_mfma_f32_16x16x32_bf16 v[212:215], a[200:203], v[56:59], v[212:215]
    v_mfma_f32_16x16x32_bf16 v[216:219], a[204:207], v[56:59], v[216:219]
    v_mfma_f32_16x16x32_bf16 v[212:215], a[232:235], v[60:63], v[212:215]
    v_mfma_f32_16x16x32_bf16 v[216:219], a[236:239], v[60:63], v[216:219]
    s_waitcnt vmcnt(5)
    v_mfma_f32_16x16x32_bf16 v[220:223], a[16:19], v[16:19], 0
    v_mfma_f32_16x16x32_bf16 v[224:227], a[20:23], v[16:19], 0
    v_mfma_f32_16x16x32_bf16 v[220:223], a[48:51], v[20:23], v[220:223]
    v_mfma_f32_16x16x32_bf16 v[224:227], a[52:55], v[20:23], v[224:227]
    v_cvt_pk_bf16_f32 v144, v212, v213
    v_cvt_pk_bf16_f32 v145, v214, v215
    v_cvt_pk_bf16_f32 v146, v216, v217
    v_cvt_pk_bf16_f32 v147, v218, v219
    v_min_u32 v144, 0xfffffffe, v144
    s_cmp_lg_u32 s83, 0
    s_cbranch_scc1 L_near_155
    buffer_store_dwordx4 v[144:147], v242, s[8:11], s24 offen offset:64 sc1
    s_branch L_far_156
L_near_155:
    buffer_store_dwordx4 v[144:147], v242, s[8:11], s24 offen offset:64
L_far_156:
    v_mfma_f32_16x16x32_bf16 v[220:223], a[80:83], v[24:27], v[220:223]
    v_mfma_f32_16x16x32_bf16 v[224:227], a[84:87], v[24:27], v[224:227]
    v_mfma_f32_16x16x32_bf16 v[220:223], a[112:115], v[28:31], v[220:223]
    v_mfma_f32_16x16x32_bf16 v[224:227], a[116:119], v[28:31], v[224:227]
    v_mfma_f32_16x16x32_bf16 v[220:223], a[144:147], v[48:51], v[220:223]
    v_mfma_f32_16x16x32_bf16 v[224:227], a[148:151], v[48:51], v[224:227]
    v_mfma_f32_16x16x32_bf16 v[220:223], a[176:179], v[52:55], v[220:223]
    v_mfma_f32_16x16x32_bf16 v[224:227], a[180:183], v[52:55], v[224:227]
    v_mfma_f32_16x16x32_bf16 v[220:223], a[208:211], v[56:59], v[220:223]
    v_mfma_f32_16x16x32_bf16 v[224:227], a[212:215], v[56:59], v[224:227]
    v_mfma_f32_16x16x32_bf16 v[220:223], a[240:243], v[60:63], v[220:223]
    v_mfma_f32_16x16x32_bf16 v[224:227], a[244:247], v[60:63], v[224:227]
    v_mfma_f32_16x16x32_bf16 v[228:231], a[24:27], v[16:19], 0
    v_mfma_f32_16x16x32_bf16 v[232:235], a[28:31], v[16:19], 0
    v_mfma_f32_16x16x32_bf16 v[228:231], a[56:59], v[20:23], v[228:231]
    v_mfma_f32_16x16x32_bf16 v[232:235], a[60:63], v[20:23], v[232:235]
    v_cvt_pk_bf16_f32 v148, v220, v221
    v_cvt_pk_bf16_f32 v149, v222, v223
    v_cvt_pk_bf16_f32 v150, v224, v225
    v_cvt_pk_bf16_f32 v151, v226, v227
    v_min_u32 v148, 0xfffffffe, v148
    s_cmp_lg_u32 s83, 0
    s_cbranch_scc1 L_near_157
    buffer_store_dwordx4 v[148:151], v242, s[8:11], s24 offen offset:128 sc1
    s_branch L_far_158
L_near_157:
    buffer_store_dwordx4 v[148:151], v242, s[8:11], s24 offen offset:128
L_far_158:
    v_mfma_f32_16x16x32_bf16 v[228:231], a[88:91], v[24:27], v[228:231]
    v_mfma_f32_16x16x32_bf16 v[232:235], a[92:95], v[24:27], v[232:235]
    v_mfma_f32_16x16x32_bf16 v[228:231], a[120:123], v[28:31], v[228:231]
    v_mfma_f32_16x16x32_bf16 v[232:235], a[124:127], v[28:31], v[232:235]
    v_mfma_f32_16x16x32_bf16 v[228:231], a[152:155], v[48:51], v[228:231]
    v_mfma_f32_16x16x32_bf16 v[232:235], a[156:159], v[48:51], v[232:235]
    v_mfma_f32_16x16x32_bf16 v[228:231], a[184:187], v[52:55], v[228:231]
    v_mfma_f32_16x16x32_bf16 v[232:235], a[188:191], v[52:55], v[232:235]
    v_mfma_f32_16x16x32_bf16 v[228:231], a[216:219], v[56:59], v[228:231]
    v_mfma_f32_16x16x32_bf16 v[232:235], a[220:223], v[56:59], v[232:235]
    v_mfma_f32_16x16x32_bf16 v[228:231], a[248:251], v[60:63], v[228:231]
    v_mfma_f32_16x16x32_bf16 v[232:235], a[252:255], v[60:63], v[232:235]
    s_nop 3
    v_cvt_pk_bf16_f32 v152, v228, v229
    v_cvt_pk_bf16_f32 v153, v230, v231
    s_nop 1
    v_cvt_pk_bf16_f32 v154, v232, v233
    v_cvt_pk_bf16_f32 v155, v234, v235
    v_min_u32 v152, 0xfffffffe, v152
    s_cmp_lg_u32 s83, 0
    s_cbranch_scc1 L_near_159
    buffer_store_dwordx4 v[152:155], v242, s[8:11], s24 offen offset:192 sc1
    s_branch L_far_160
L_near_159:
    buffer_store_dwordx4 v[152:155], v242, s[8:11], s24 offen offset:192
L_far_160:
    s_branch L_proj_144
L_half_143:
    s_nop 7
    v_cvt_pk_bf16_f32 v152, v196, v197
    v_cvt_pk_bf16_f32 v153, v198, v199
    v_cvt_pk_bf16_f32 v154, v200, v201
    v_cvt_pk_bf16_f32 v155, v202, v203
    v_min_u32 v152, 0xfffffffe, v152
    s_cmp_lg_u32 s83, 0
    s_cbranch_scc1 L_near_161
    buffer_store_dwordx4 v[152:155], v242, s[8:11], s24 offen offset:192 sc1
    s_branch L_far_162
L_near_161:
    buffer_store_dwordx4 v[152:155], v242, s[8:11], s24 offen offset:192
L_far_162:
    s_waitcnt lgkmcnt(0)
L_proj_144:
    s_cmp_lg_u32 s83, 3
    s_cbranch_scc1 L_flags_165
    s_waitcnt vmcnt(4)
    v_cmp_eq_u32 vcc, 0, v108
    s_cbranch_vccz L_parts_163
    v_lshrrev_b32 v246, 2, v240
    s_mov_b32 exec_lo, 0xffff
    s_mov_b32 exec_hi, 0
    s_mov_b32 s96, 0
L_poll_166:
    buffer_load_dword v247, v246, s[8:11], s52 offen sc1
    s_waitcnt vmcnt(0)
    v_cmp_gt_u32 vcc, 1, v247
    s_cbranch_vccz L_polld_167
    s_sleep 1
    s_add_u32 s96, s96, 1
    s_cmp_lt_u32 s96, 0x10000
    s_cbranch_scc1 L_poll_166
L_polld_167:
    s_mov_b64 exec, -1
    s_branch L_parts_163
L_flags_165:
    s_mov_b32 s62, 0x8f00
    buffer_load_dword v104, off, s[8:11], s62 sc1
    s_waitcnt vmcnt(0)
    s_barrier
    s_lshl_b32 s26, s20, 2
    s_add_u32 s26, s26, s52
    s_cmp_lg_u32 s100, 0
    s_cbranch_scc1 L_flag_169
    v_mov_b32 v246, 1
    s_mov_b64 exec, 1
    s_cmp_lg_u32 s83, 0
    s_cbranch_scc1 L_near_170
    buffer_store_dword v246, off, s[8:11], s26 sc1
    s_branch L_far_171
L_near_170:
    buffer_store_dword v246, off, s[8:11], s26
L_far_171:
    s_mov_b64 exec, -1
L_flag_169:
    v_lshrrev_b32 v246, 2, v240
    s_cmp_lg_u32 s100, 0
    s_cbranch_scc1 L_polls_174
    s_mov_b32 exec_lo, 0xffff
    s_mov_b32 exec_hi, 0
    s_mov_b32 s96, 0
L_poll_172:
    buffer_load_dword v247, v246, s[8:11], s52 offen sc1
    s_waitcnt vmcnt(0)
    v_cmp_gt_u32 vcc, 1, v247
    s_cbranch_vccz L_polld_173
    s_sleep 1
    s_add_u32 s96, s96, 1
    s_cmp_lt_u32 s96, 0x10000
    s_cbranch_scc1 L_poll_172
L_polld_173:
    s_mov_b64 exec, -1
L_polls_174:
    s_barrier
L_parts_163:
    s_cmp_lg_u32 s83, 0
    s_cbranch_scc1 L_near_181
    buffer_load_dwordx4 v[48:51], v240, s[8:11], s50 offen
    buffer_load_dwordx4 v[52:55], v105, s[8:11], s50 offen
    buffer_load_dwordx4 v[56:59], v106, s[8:11], s50 offen
    buffer_load_dwordx4 v[60:63], v107, s[8:11], s50 offen
    s_branch L_far_182
L_near_181:
    buffer_load_dwordx4 v[48:51], v240, s[8:11], s50 offen sc1
    buffer_load_dwordx4 v[52:55], v105, s[8:11], s50 offen sc1
    buffer_load_dwordx4 v[56:59], v106, s[8:11], s50 offen sc1
    buffer_load_dwordx4 v[60:63], v107, s[8:11], s50 offen sc1
L_far_182:
    v_mov_b32 v68, 0
    v_mov_b32 v69, 0
    v_mov_b32 v70, 0
    v_mov_b32 v71, 0
    v_mov_b32 v72, 0
    v_mov_b32 v73, 0
    v_mov_b32 v74, 0
    v_mov_b32 v75, 0
    s_mov_b32 s96, 0
L_gp_176:
    s_cmp_lg_u32 s83, 0
    s_cbranch_scc1 L_near_183
    buffer_load_dwordx4 v[32:35], v240, s[8:11], s61 offen
    buffer_load_dwordx4 v[36:39], v105, s[8:11], s61 offen
    buffer_load_dwordx4 v[40:43], v106, s[8:11], s61 offen
    buffer_load_dwordx4 v[44:47], v107, s[8:11], s61 offen
    s_branch L_far_184
L_near_183:
    buffer_load_dwordx4 v[32:35], v240, s[8:11], s61 offen sc1
    buffer_load_dwordx4 v[36:39], v105, s[8:11], s61 offen sc1
    buffer_load_dwordx4 v[40:43], v106, s[8:11], s61 offen sc1
    buffer_load_dwordx4 v[44:47], v107, s[8:11], s61 offen sc1
L_far_184:
    s_waitcnt vmcnt(4)
    v_max3_u32 v246, v48, v52, v56
    v_max_u32 v246, v246, v60
    v_cmp_eq_u32 vcc, -1, v246
    s_cbranch_vccz L_gb_177
    buffer_load_dwordx4 v[48:51], v240, s[8:11], s50 offen sc1
    buffer_load_dwordx4 v[52:55], v105, s[8:11], s50 offen sc1
    buffer_load_dwordx4 v[56:59], v106, s[8:11], s50 offen sc1
    buffer_load_dwordx4 v[60:63], v107, s[8:11], s50 offen sc1
    s_waitcnt vmcnt(4)
    v_max3_u32 v246, v32, v36, v40
    v_max_u32 v246, v246, v44
    v_cmp_eq_u32 vcc, -1, v246
    s_add_u32 s96, s96, 1
    s_cbranch_vccz L_ga_178
    s_cmp_lt_u32 s96, 0x10000
    s_cbranch_scc1 L_gp_176
L_gb_177:
    v_dot2_f32_bf16 v68, v48, s65, v68
    v_dot2_f32_bf16 v69, v48, s66, v69
    v_dot2_f32_bf16 v70, v49, s65, v70
    v_dot2_f32_bf16 v71, v49, s66, v71
    v_dot2_f32_bf16 v72, v50, s65, v72
    v_dot2_f32_bf16 v73, v50, s66, v73
    v_dot2_f32_bf16 v74, v51, s65, v74
    v_dot2_f32_bf16 v75, v51, s66, v75
    v_dot2_f32_bf16 v68, v52, s65, v68
    v_dot2_f32_bf16 v69, v52, s66, v69
    v_dot2_f32_bf16 v70, v53, s65, v70
    v_dot2_f32_bf16 v71, v53, s66, v71
    v_dot2_f32_bf16 v72, v54, s65, v72
    v_dot2_f32_bf16 v73, v54, s66, v73
    v_dot2_f32_bf16 v74, v55, s65, v74
    v_dot2_f32_bf16 v75, v55, s66, v75
    v_dot2_f32_bf16 v68, v56, s65, v68
    v_dot2_f32_bf16 v69, v56, s66, v69
    v_dot2_f32_bf16 v70, v57, s65, v70
    v_dot2_f32_bf16 v71, v57, s66, v71
    v_dot2_f32_bf16 v72, v58, s65, v72
    v_dot2_f32_bf16 v73, v58, s66, v73
    v_dot2_f32_bf16 v74, v59, s65, v74
    v_dot2_f32_bf16 v75, v59, s66, v75
    v_dot2_f32_bf16 v68, v60, s65, v68
    v_dot2_f32_bf16 v69, v60, s66, v69
    v_dot2_f32_bf16 v70, v61, s65, v70
    v_dot2_f32_bf16 v71, v61, s66, v71
    v_dot2_f32_bf16 v72, v62, s65, v72
    v_dot2_f32_bf16 v73, v62, s66, v73
    v_dot2_f32_bf16 v74, v63, s65, v74
    v_dot2_f32_bf16 v75, v63, s66, v75
    s_cmp_lg_u32 s82, 0
    s_cbranch_scc1 L_gd_179
    s_waitcnt vmcnt(0)
L_ga_178:
    v_dot2_f32_bf16 v68, v32, s65, v68
    v_dot2_f32_bf16 v69, v32, s66, v69
    v_dot2_f32_bf16 v70, v33, s65, v70
    v_dot2_f32_bf16 v71, v33, s66, v71
    v_dot2_f32_bf16 v72, v34, s65, v72
    v_dot2_f32_bf16 v73, v34, s66, v73
    v_dot2_f32_bf16 v74, v35, s65, v74
    v_dot2_f32_bf16 v75, v35, s66, v75
    v_dot2_f32_bf16 v68, v36, s65, v68
    v_dot2_f32_bf16 v69, v36, s66, v69
    v_dot2_f32_bf16 v70, v37, s65, v70
    v_dot2_f32_bf16 v71, v37, s66, v71
    v_dot2_f32_bf16 v72, v38, s65, v72
    v_dot2_f32_bf16 v73, v38, s66, v73
    v_dot2_f32_bf16 v74, v39, s65, v74
    v_dot2_f32_bf16 v75, v39, s66, v75
    v_dot2_f32_bf16 v68, v40, s65, v68
    v_dot2_f32_bf16 v69, v40, s66, v69
    v_dot2_f32_bf16 v70, v41, s65, v70
    v_dot2_f32_bf16 v71, v41, s66, v71
    v_dot2_f32_bf16 v72, v42, s65, v72
    v_dot2_f32_bf16 v73, v42, s66, v73
    v_dot2_f32_bf16 v74, v43, s65, v74
    v_dot2_f32_bf16 v75, v43, s66, v75
    v_dot2_f32_bf16 v68, v44, s65, v68
    v_dot2_f32_bf16 v69, v44, s66, v69
    v_dot2_f32_bf16 v70, v45, s65, v70
    v_dot2_f32_bf16 v71, v45, s66, v71
    v_dot2_f32_bf16 v72, v46, s65, v72
    v_dot2_f32_bf16 v73, v46, s66, v73
    v_dot2_f32_bf16 v74, v47, s65, v74
    v_dot2_f32_bf16 v75, v47, s66, v75
L_gd_179:
    s_nop 2
    ds_write_b128 v109, v[68:71]
    ds_write_b128 v109, v[72:75] offset:1024
    s_cmp_lg_u32 s82, 0
    s_cselect_b32 s24, 3, 1
    s_and_b32 s24, s24, s100
    s_waitcnt lgkmcnt(0)
    s_barrier
    s_cbranch_scc1 L_nofin_175
    ds_read_b128 v[112:115], v109 offset:4096
    ds_read_b128 v[116:119], v109 offset:5120
    s_cmp_eq_u32 s82, 0
    s_cbranch_scc1 L_g1_180
    ds_read_b128 v[120:123], v109 offset:8192
    ds_read_b128 v[124:127], v109 offset:9216
    ds_read_b128 v[128:131], v109 offset:12288
    ds_read_b128 v[132:135], v109 offset:13312
    s_waitcnt lgkmcnt(0)
    v_pk_add_f32 v[120:121], v[120:121], v[128:129]
    v_pk_add_f32 v[122:123], v[122:123], v[130:131]
    v_pk_add_f32 v[124:125], v[124:125], v[132:133]
    v_pk_add_f32 v[126:127], v[126:127], v[134:135]
    v_pk_add_f32 v[112:113], v[112:113], v[120:121]
    v_pk_add_f32 v[114:115], v[114:115], v[122:123]
    v_pk_add_f32 v[116:117], v[116:117], v[124:125]
    v_pk_add_f32 v[118:119], v[118:119], v[126:127]
L_g1_180:
    s_waitcnt lgkmcnt(0)
    v_pk_add_f32 v[68:69], v[68:69], v[112:113]
    v_pk_add_f32 v[70:71], v[70:71], v[114:115]
    v_pk_add_f32 v[72:73], v[72:73], v[116:117]
    v_pk_add_f32 v[74:75], v[74:75], v[118:119]
    v_cvt_pk_bf16_f32 v0, v68, v69
    v_cvt_pk_bf16_f32 v1, v70, v71
    v_cvt_pk_bf16_f32 v2, v72, v73
    v_cvt_pk_bf16_f32 v3, v74, v75
    v_lshlrev_b32 v68, 16, v0
    v_and_b32 v69, 0xffff0000, v0
    v_lshlrev_b32 v76, 16, v96
    v_and_b32 v77, 0xffff0000, v96
    v_lshlrev_b32 v70, 16, v1
    v_and_b32 v71, 0xffff0000, v1
    v_lshlrev_b32 v78, 16, v97
    v_and_b32 v79, 0xffff0000, v97
    v_lshlrev_b32 v72, 16, v2
    v_and_b32 v73, 0xffff0000, v2
    v_lshlrev_b32 v80, 16, v98
    v_and_b32 v81, 0xffff0000, v98
    v_lshlrev_b32 v74, 16, v3
    v_and_b32 v75, 0xffff0000, v3
    v_lshlrev_b32 v82, 16, v99
    v_and_b32 v83, 0xffff0000, v99
    v_pk_add_f32 v[68:69], v[68:69], v[76:77]
    v_pk_add_f32 v[70:71], v[70:71], v[78:79]
    v_pk_add_f32 v[72:73], v[72:73], v[80:81]
    v_pk_add_f32 v[74:75], v[74:75], v[82:83]
    v_cvt_pk_bf16_f32 v4, v68, v69
    v_cvt_pk_bf16_f32 v5, v70, v71
    v_cvt_pk_bf16_f32 v6, v72, v73
    v_cvt_pk_bf16_f32 v7, v74, v75
    v_lshlrev_b32 v68, 16, v4
    v_and_b32 v69, 0xffff0000, v4
    v_lshlrev_b32 v70, 16, v5
    v_and_b32 v71, 0xffff0000, v5
    v_lshlrev_b32 v72, 16, v6
    v_and_b32 v73, 0xffff0000, v6
    v_lshlrev_b32 v74, 16, v7
    v_and_b32 v75, 0xffff0000, v7
    v_add_f32 v84, v68, v69
    v_add_f32 v84, v84, v70
    v_add_f32 v84, v84, v71
    v_add_f32 v84, v84, v72
    v_add_f32 v84, v84, v73
    v_add_f32 v84, v84, v74
    v_add_f32 v84, v84, v75
    s_nop 1
    v_add_f32_dpp v84, v84, v84 row_ror:1 row_mask:0xf bank_mask:0xf
    s_nop 1
    v_add_f32_dpp v84, v84, v84 row_ror:2 row_mask:0xf bank_mask:0xf
    s_nop 1
    v_add_f32_dpp v84, v84, v84 row_ror:4 row_mask:0xf bank_mask:0xf
    s_nop 1
    v_add_f32_dpp v84, v84, v84 row_ror:8 row_mask:0xf bank_mask:0xf
    v_mov_b32 v85, v84
    s_nop 1
    v_permlane32_swap_b32 v85, v84
    v_add_f32 v84, v85, v84
    v_mov_b32 v85, v84
    s_nop 1
    v_permlane16_swap_b32 v85, v84
    v_add_f32 v84, v85, v84
    v_mul_f32 v84, 0x3b000000, v84
    v_cvt_pk_bf16_f32 v86, v84, v84
    v_and_b32 v86, 0xffff0000, v86
    v_sub_f32 v87, v84, v86
    v_sub_f32 v76, v68, v86
    v_sub_f32 v77, v69, v86
    v_sub_f32 v78, v70, v86
    v_sub_f32 v79, v71, v86
    v_sub_f32 v80, v72, v86
    v_sub_f32 v81, v73, v86
    v_sub_f32 v82, v74, v86
    v_sub_f32 v83, v75, v86
    v_mul_f32 v100, v76, v76
    v_fmac_f32 v100, v77, v77
    v_fmac_f32 v100, v78, v78
    v_fmac_f32 v100, v79, v79
    v_fmac_f32 v100, v80, v80
    v_fmac_f32 v100, v81, v81
    v_fmac_f32 v100, v82, v82
    v_fmac_f32 v100, v83, v83
    s_nop 1
    v_add_f32_dpp v100, v100, v100 row_ror:1 row_mask:0xf bank_mask:0xf
    s_nop 1
    v_add_f32_dpp v100, v100, v100 row_ror:2 row_mask:0xf bank_mask:0xf
    s_nop 1
    v_add_f32_dpp v100, v100, v100 row_ror:4 row_mask:0xf bank_mask:0xf
    s_nop 1
    v_add_f32_dpp v100, v100, v100 row_ror:8 row_mask:0xf bank_mask:0xf
    v_mov_b32 v85, v100
    s_nop 1
    v_permlane32_swap_b32 v85, v100
    v_add_f32 v100, v85, v100
    v_mov_b32 v85, v100
    s_nop 1
    v_permlane16_swap_b32 v85, v100
    v_add_f32 v100, v85, v100
    v_mul_f32 v85, v87, v87
    v_mul_f32 v100, 0x3b000000, v100
    v_sub_f32 v100, v100, v85
    v_max_f32 v100, 0, v100
    v_cvt_pk_bf16_f32 v100, v100, v100
    v_and_b32 v100, 0xffff0000, v100
    v_add_f32 v100, 0x3727c5ac, v100
    v_cvt_pk_bf16_f32 v100, v100, v100
    v_and_b32 v100, 0xffff0000, v100
    v_sqrt_f32 v100, v100
    s_nop 0
    v_cvt_pk_bf16_f32 v100, v100, v100
    v_and_b32 v100, 0xffff0000, v100
    v_rcp_f32 v100, v100
    v_cvt_pk_bf16_f32 v8, v76, v77
    v_cvt_pk_bf16_f32 v9, v78, v79
    v_cvt_pk_bf16_f32 v10, v80, v81
    v_cvt_pk_bf16_f32 v11, v82, v83
    v_lshlrev_b32 v76, 16, v8
    v_and_b32 v77, 0xffff0000, v8
    v_lshlrev_b32 v78, 16, v9
    v_and_b32 v79, 0xffff0000, v9
    v_lshlrev_b32 v80, 16, v10
    v_and_b32 v81, 0xffff0000, v10
    v_lshlrev_b32 v82, 16, v11
    v_and_b32 v83, 0xffff0000, v11
    v_mul_f32 v76, v100, v76
    v_mul_f32 v77, v100, v77
    v_mul_f32 v78, v100, v78
    v_mul_f32 v79, v100, v79
    v_mul_f32 v80, v100, v80
    v_mul_f32 v81, v100, v81
    v_mul_f32 v82, v100, v82
    v_mul_f32 v83, v100, v83
    v_cvt_pk_bf16_f32 v8, v76, v77
    v_cvt_pk_bf16_f32 v9, v78, v79
    v_cvt_pk_bf16_f32 v10, v80, v81
    v_cvt_pk_bf16_f32 v11, v82, v83
    v_lshlrev_b32 v76, 16, v8
    v_and_b32 v77, 0xffff0000, v8
    v_lshlrev_b32 v78, 16, v9
    v_and_b32 v79, 0xffff0000, v9
    v_lshlrev_b32 v80, 16, v10
    v_and_b32 v81, 0xffff0000, v10
    v_lshlrev_b32 v82, 16, v11
    v_and_b32 v83, 0xffff0000, v11
    v_lshlrev_b32 v88, 16, v236
    v_and_b32 v89, 0xffff0000, v236
    v_lshlrev_b32 v90, 16, v237
    v_and_b32 v91, 0xffff0000, v237
    v_lshlrev_b32 v92, 16, v238
    v_and_b32 v93, 0xffff0000, v238
    v_lshlrev_b32 v94, 16, v239
    v_and_b32 v95, 0xffff0000, v239
    v_mul_f32 v84, v76, v88
    v_fmac_f32 v84, v77, v89
    v_fmac_f32 v84, v78, v90
    v_fmac_f32 v84, v79, v91
    v_fmac_f32 v84, v80, v92
    v_fmac_f32 v84, v81, v93
    v_fmac_f32 v84, v82, v94
    v_fmac_f32 v84, v83, v95
    s_nop 1
    v_add_f32_dpp v84, v84, v84 row_ror:1 row_mask:0xf bank_mask:0xf
    s_nop 1
    v_add_f32_dpp v84, v84, v84 row_ror:2 row_mask:0xf bank_mask:0xf
    s_nop 1
    v_add_f32_dpp v84, v84, v84 row_ror:4 row_mask:0xf bank_mask:0xf
    s_nop 1
    v_add_f32_dpp v84, v84, v84 row_ror:8 row_mask:0xf bank_mask:0xf
    v_mov_b32 v85, v84
    s_nop 1
    v_permlane32_swap_b32 v85, v84
    v_add_f32 v84, v85, v84
    v_mov_b32 v85, v84
    s_nop 1
    v_permlane16_swap_b32 v85, v84
    v_add_f32 v84, v85, v84
    v_cvt_pk_bf16_f32 v84, v84, v84
    v_and_b32 v84, 0xffff0000, v84
    v_ashrrev_i32 v85, 31, v84
    v_or_b32 v85, 0x80000000, v85
    v_xor_b32 v84, v84, v85
    v_and_b32 v84, 0xffff0000, v84
    s_sub_u32 s62, 0x87ff, s60
    v_or_b32 v84, s62, v84
    s_lshl_b32 s62, s60, 2
    s_mov_b64 exec, 1
    s_add_u32 s63, s62, 0x6f00
    s_lshl_b32 s96, s60, 7
    s_add_u32 s96, s96, 0xfffcb000
    s_cmp_ge_u32 s60, 1984
    s_cselect_b32 s63, s96, s63
    s_cmp_ge_u32 s60, 1792
    s_cselect_b32 s63, s63, 0x7ff00000
    buffer_store_dword v84, off, s[8:11], s63 sc1
    s_mov_b64 exec, -1
    v_pk_add_f32 v[68:69], v[68:69], v[76:77]
    v_pk_add_f32 v[70:71], v[70:71], v[78:79]
    v_pk_add_f32 v[72:73], v[72:73], v[80:81]
    v_pk_add_f32 v[74:75], v[74:75], v[82:83]
    v_cvt_pk_bf16_f32 v12, v68, v69
    v_cvt_pk_bf16_f32 v13, v70, v71
    v_cvt_pk_bf16_f32 v14, v72, v73
    v_cvt_pk_bf16_f32 v15, v74, v75
    buffer_store_dwordx4 v[12:15], v240, s[16:19], s64 offen sc1
    s_mov_b64 exec, 1
    v_cmp_ge_u32 vcc, v104, v84
    s_cselect_b32 s63, 1, 0
    s_and_b32 s63, s63, vcc_lo
    s_cbranch_scc1 L_nokey_185
    s_mov_b64 exec, -1
    s_add_u32 s63, s64, 0x6000000
    buffer_store_dwordx4 v[4:7], v240, s[8:11], s63 offen sc1
    s_add_u32 s63, s64, 0x6200000
    buffer_store_dwordx4 v[8:11], v240, s[8:11], s63 offen sc1
    s_mov_b64 exec, 1
    s_add_u32 s62, s62, 0x6000
    s_waitcnt vmcnt(0)
    buffer_store_dword v84, off, s[8:11], s62 sc1
L_nokey_185:
    s_mov_b64 exec, -1
L_nofin_175:
    s_add_u32 s80, s80, 4
    s_add_u32 s22, s22, s23
    s_sub_u32 s24, s22, 68
    s_cmp_lt_u32 s24, 2
    s_cselect_b32 s82, 2, 0
    s_cselect_b32 s24, 6, 0
    s_sub_u32 s22, s22, s24
    s_branch L_p2_seg
L_redo_141:
    v_mfma_f32_16x16x32_bf16 v[116:119], v[16:19], v[0:3], 0
    v_mfma_f32_16x16x32_bf16 v[116:119], v[20:23], v[4:7], v[116:119]
    v_mfma_f32_16x16x32_bf16 v[116:119], v[24:27], v[8:11], v[116:119]
    v_mfma_f32_16x16x32_bf16 v[116:119], v[28:31], v[12:15], v[116:119]
    v_mfma_f32_16x16x32_bf16 v[120:123], v[32:35], v[0:3], 0
    v_mfma_f32_16x16x32_bf16 v[120:123], v[36:39], v[4:7], v[120:123]
    v_mfma_f32_16x16x32_bf16 v[120:123], v[40:43], v[8:11], v[120:123]
    v_mfma_f32_16x16x32_bf16 v[120:123], v[44:47], v[12:15], v[120:123]
    v_mov_b32 v247, s53
    v_cndmask_b32 v116, v247, v116, s[30:31]
    v_cndmask_b32 v117, v247, v117, s[32:33]
    v_cndmask_b32 v118, v247, v118, s[34:35]
    v_cndmask_b32 v119, v247, v119, s[36:37]
    s_nop 2
    v_cndmask_b32 v120, v247, v120, s[38:39]
    v_cndmask_b32 v121, v247, v121, s[40:41]
    v_cndmask_b32 v122, v247, v122, s[42:43]
    v_cndmask_b32 v123, v247, v123, s[44:45]
    v_max3_f32 v246, v116, v117, v118
    v_max3_f32 v246, v246, v119, v120
    v_max3_f32 v246, v246, v121, v122
    v_max_f32 v246, v246, v123
    v_max3_f32 v246, v246, v112, v113
    v_mov_b32 v247, v246
    s_nop 1
    v_permlane32_swap_b32 v247, v246
    v_max_f32 v246, v247, v246
    v_mov_b32 v247, v246
    s_nop 1
    v_permlane16_swap_b32 v247, v246
    v_max_f32 v246, v247, v246
    v_mul_f32 v248, s28, v246
    v_pk_fma_f32 v[116:117], v[116:117], s[28:29], v[248:249] op_sel_hi:[1,1,0] neg_lo:[0,0,1] neg_hi:[0,0,1]
    v_pk_fma_f32 v[118:119], v[118:119], s[28:29], v[248:249] op_sel_hi:[1,1,0] neg_lo:[0,0,1] neg_hi:[0,0,1]
    v_pk_fma_f32 v[120:121], v[120:121], s[28:29], v[248:249] op_sel_hi:[1,1,0] neg_lo:[0,0,1] neg_hi:[0,0,1]
    v_pk_fma_f32 v[122:123], v[122:123], s[28:29], v[248:249] op_sel_hi:[1,1,0] neg_lo:[0,0,1] neg_hi:[0,0,1]
    v_exp_f32 v116, v116
    v_exp_f32 v117, v117
    v_exp_f32 v118, v118
    v_exp_f32 v119, v119
    v_exp_f32 v120, v120
    v_exp_f32 v121, v121
    v_exp_f32 v122, v122
    v_exp_f32 v123, v123
    v_cvt_pk_bf16_f32 v124, v116, v117
    v_cvt_pk_bf16_f32 v125, v118, v119
    v_cvt_pk_bf16_f32 v126, v120, v121
    v_cvt_pk_bf16_f32 v127, v122, v123
    v_mov_b32 v129, 0
    s_nop 0
    v_mfma_f32_16x16x32_bf16 v[132:135], v[136:139], v[124:127], 0
    v_mfma_f32_16x16x32_bf16 v[140:143], v[64:67], v[124:127], 0
    v_mfma_f32_16x16x32_bf16 v[144:147], v[68:71], v[124:127], 0
    v_mfma_f32_16x16x32_bf16 v[148:151], v[72:75], v[124:127], 0
    v_mfma_f32_16x16x32_bf16 v[152:155], v[76:79], v[124:127], 0
    v_mfma_f32_16x16x32_bf16 v[156:159], v[80:83], v[124:127], 0
    v_mfma_f32_16x16x32_bf16 v[160:163], v[84:87], v[124:127], 0
    v_mfma_f32_16x16x32_bf16 v[164:167], v[88:91], v[124:127], 0
    v_mfma_f32_16x16x32_bf16 v[168:171], v[92:95], v[124:127], 0
    v_pk_fma_f32 v[114:115], v[112:113], s[28:29], v[248:249] op_sel_hi:[1,1,0] neg_lo:[0,0,1] neg_hi:[0,0,1]
    s_nop 6
    s_branch L_redone_142
L_p2_end:
    s_cmp_ge_u32 s67, 56
    s_cbranch_scc1 L_exit
    s_mov_b32 s74, 0
    s_mov_b32 s75, 0
    v_mov_b32 v202, 0x7ffffff0
    v_mbcnt_lo_u32_b32 v0, -1, 0
    v_mbcnt_hi_u32_b32 v0, -1, v0
    s_lshl_b32 s96, s100, 6
    v_add_u32 v0, s96, v0
    v_lshlrev_b32 v1, 6, v0
    s_getpc_b64 s[70:71]
L_pc_186:
    s_add_u32 s70, s70, L_ffn_round-L_pc_186
    s_addc_u32 s71, s71, 0
    v_min_u32 v1, L_code_end-L_ffn_round-4, v1
    global_load_dword v3, v1, s[70:71]
    v_mov_b32 v1, 0
    s_and_b32 s71, s101, 15
    s_lshl_b32 s71, s71, 7
    s_add_u32 s71, s71, 0x1000
    s_mov_b32 s72, 57
    s_cmp_lg_u32 s100, 0
    s_cbranch_scc1 L_polls_189
    s_mov_b32 exec_lo, 0x1
    s_mov_b32 exec_hi, 0
    s_mov_b32 s96, 0
L_poll_187:
    buffer_load_dword v2, v1, s[8:11], s71 offen sc1
    s_waitcnt vmcnt(0)
    v_cmp_gt_u32 vcc, s72, v2
    s_cbranch_vccz L_polld_188
    v_readfirstlane_b32 s97, v2
    s_nop 0
    s_sub_u32 s97, s72, s97
    s_cmp_lt_i32 s97, 3
    s_cbranch_scc1 L_near_190
    s_sleep 40
    s_cmp_lt_i32 s97, 5
    s_cbranch_scc1 L_near_190
    s_sleep 100
L_near_190:
    s_sleep 16
    s_add_u32 s96, s96, 1
    s_cmp_lt_u32 s96, 0x10000
    s_cbranch_scc1 L_poll_187
L_polld_188:
    s_mov_b64 exec, -1
L_polls_189:
    s_barrier
L_ffn_round:
    v_mbcnt_lo_u32_b32 v0, -1, 0
    v_mbcnt_hi_u32_b32 v0, -1, v0
    s_lshl_b32 s96, s100, 6
    v_add_u32 v0, s96, v0
    s_cmp_lg_u32 s75, 0
    s_cbranch_scc1 L_ffn_re
    v_lshlrev_b32 v30, 5, v0
    s_mov_b32 s69, 0x6000
    v_cmp_le_u32 vcc, 224, v0
    v_mov_b32 v29, s75
    v_add_u32 v29, -1, v29
    v_cndmask_b32 v19, 0, v29, vcc
    s_mov_b32 s70, 0
L_kpoll_191:
    buffer_load_dwordx4 v[20:23], v30, s[8:11], s69 offen sc1
    buffer_load_dwordx4 v[24:27], v30, s[8:11], s69 offen offset:16 sc1
    s_waitcnt vmcnt(0)
    v_min3_u32 v28, v20, v21, v22
    v_min3_u32 v28, v28, v23, v24
    v_min3_u32 v28, v28, v25, v26
    v_min_u32 v28, v28, v27
    v_or_b32 v28, v28, v19
    v_cmp_eq_u32 vcc, 0, v28
    s_cbranch_vccz L_kpolld_192
    s_sleep 6
    s_add_u32 s70, s70, 1
    s_cmp_lt_u32 s70, 0x10000
    s_cbranch_scc1 L_kpoll_191
L_kpolld_192:
    v_bfi_b32 v20, v19, 0, v20
    v_bfi_b32 v21, v19, 0, v21
    v_bfi_b32 v22, v19, 0, v22
    v_bfi_b32 v23, v19, 0, v23
    v_bfi_b32 v24, v19, 0, v24
    v_bfi_b32 v25, v19, 0, v25
    v_bfi_b32 v26, v19, 0, v26
    v_bfi_b32 v27, v19, 0, v27
    v_lshrrev_b32 v30, 6, v0
    v_lshlrev_b32 v30, 2, v30
    v_add_u32 v30, 0x20400, v30
    v_mov_b32 v31, 0x20400
    s_waitcnt vmcnt(0)
    v_max3_u32 v28, v20, v21, v22
    v_max3_u32 v28, v28, v23, v24
    v_max3_u32 v28, v28, v25, v26
    v_max_u32 v28, v28, v27
    s_nop 1
    v_max_u32_dpp v28, v28, v28 row_ror:1 row_mask:0xf bank_mask:0xf
    s_nop 1
    v_max_u32_dpp v28, v28, v28 row_ror:2 row_mask:0xf bank_mask:0xf
    s_nop 1
    v_max_u32_dpp v28, v28, v28 row_ror:4 row_mask:0xf bank_mask:0xf
    s_nop 1
    v_max_u32_dpp v28, v28, v28 row_ror:8 row_mask:0xf bank_mask:0xf
    v_mov_b32 v29, v28
    s_nop 1
    v_permlane32_swap_b32 v29, v28
    v_max_u32 v28, v29, v28
    v_mov_b32 v29, v28
    s_nop 1
    v_permlane16_swap_b32 v29, v28
    v_max_u32 v28, v29, v28
    ds_write_b32 v30, v28
    s_waitcnt lgkmcnt(0)
    s_barrier
    ds_read_b128 v[16:19], v31
    s_waitcnt lgkmcnt(0)
    v_max3_u32 v28, v16, v17, v18
    v_max_u32 v28, v28, v19
    s_nop 0
    v_readfirstlane_b32 s69, v28
    s_nop 1
    v_cmp_ne_u32 vcc, s69, v20
    s_nop 1
    v_cndmask_b32 v20, 0, v20, vcc
    v_cmp_ne_u32 vcc, s69, v21
    s_nop 1
    v_cndmask_b32 v21, 0, v21, vcc
    v_cmp_ne_u32 vcc, s69, v22
    s_nop 1
    v_cndmask_b32 v22, 0, v22, vcc
    v_cmp_ne_u32 vcc, s69, v23
    s_nop 1
    v_cndmask_b32 v23, 0, v23, vcc
    v_cmp_ne_u32 vcc, s69, v24
    s_nop 1
    v_cndmask_b32 v24, 0, v24, vcc
    v_cmp_ne_u32 vcc, s69, v25
    s_nop 1
    v_cndmask_b32 v25, 0, v25, vcc
    v_cmp_ne_u32 vcc, s69, v26
    s_nop 1
    v_cndmask_b32 v26, 0, v26, vcc
    v_cmp_ne_u32 vcc, s69, v27
    s_nop 1
    v_cndmask_b32 v27, 0, v27, vcc
    v_max3_u32 v28, v20, v21, v22
    v_max3_u32 v28, v28, v23, v24
    v_max3_u32 v28, v28, v25, v26
    v_max_u32 v28, v28, v27
    s_nop 1
    v_max_u32_dpp v28, v28, v28 row_ror:1 row_mask:0xf bank_mask:0xf
    s_nop 1
    v_max_u32_dpp v28, v28, v28 row_ror:2 row_mask:0xf bank_mask:0xf
    s_nop 1
    v_max_u32_dpp v28, v28, v28 row_ror:4 row_mask:0xf bank_mask:0xf
    s_nop 1
    v_max_u32_dpp v28, v28, v28 row_ror:8 row_mask:0xf bank_mask:0xf
    v_mov_b32 v29, v28
    s_nop 1
    v_permlane32_swap_b32 v29, v28
    v_max_u32 v28, v29, v28
    v_mov_b32 v29, v28
    s_nop 1
    v_permlane16_swap_b32 v29, v28
    v_max_u32 v28, v29, v28
    ds_write_b32 v30, v28 offset:16
    s_waitcnt lgkmcnt(0)
    s_barrier
    ds_read_b128 v[16:19], v31 offset:16
    s_waitcnt lgkmcnt(0)
    v_max3_u32 v28, v16, v17, v18
    v_max_u32 v28, v28, v19
    s_nop 0
    v_readfirstlane_b32 s70, v28
    s_barrier
    s_cmp_lg_u32 s67, 55
    s_cbranch_scc1 L_ffn_sel
    s_mov_b32 s71, 0x8f00
    s_cmp_lg_u32 s100, 0
    s_cbranch_scc1 L_flag_193
    v_mov_b32 v2, s70
    s_mov_b64 exec, 1
    buffer_store_dword v2, off, s[8:11], s71 sc1
    s_mov_b64 exec, -1
L_flag_193:
    s_branch L_ffn_sel
L_ffn_re:
    v_mul_u32_u24 v30, 12, v0
    v_lshlrev_b32 v31, 7, v0
    v_add_u32 v31, 0x500, v31
    v_mov_b32 v29, 0x20400
    s_cmp_lg_u32 s100, 0
    s_cbranch_scc1 L_rselw_197
    s_mov_b32 s71, 0x8b00
    s_mov_b32 s72, 0
L_rsel_194:
    buffer_load_dword v23, v31, s[8:11], s71 offen sc1
    buffer_load_dwordx3 v[20:22], v30, s[8:11], s71 offen sc1
    s_waitcnt vmcnt(0)
    v_min3_u32 v28, v20, v21, v22
    v_min_u32 v28, v28, v23
    v_cmp_eq_u32 vcc, 0, v28
    s_cbranch_vccz L_rseld_195
    s_sleep 1
    s_add_u32 s72, s72, 1
    s_cmp_lt_u32 s72, 0x10000
    s_cbranch_scc1 L_rsel_194
L_rseld_195:
    v_max3_u32 v28, v20, v21, v22
    v_max_u32 v28, v28, v23
    v_cmp_lt_u32 vcc, s70, v28
    s_cbranch_vccz L_rsele_196
    s_mov_b32 s71, 0x7c00
    v_lshlrev_b32 v31, 2, v0
    v_add_u32 v31, 768, v31
L_rack_198:
    buffer_load_dword v27, v31, s[8:11], s71 offen sc1
    buffer_load_dwordx3 v[24:26], v30, s[8:11], s71 offen sc1
    s_add_u32 s72, s72, 1
    s_waitcnt vmcnt(0)
    v_sub_u32 v24, v20, v24
    v_sub_u32 v25, v21, v25
    v_sub_u32 v26, v22, v26
    v_sub_u32 v27, v23, v27
    v_max3_u32 v28, v24, v25, v26
    v_max_u32 v28, v28, v27
    v_cmp_lt_u32 vcc, s70, v28
    s_cbranch_vccz L_rackd_199
    s_cmp_lt_u32 s72, 0x10000
    s_cbranch_scc1 L_rack_198
L_rackd_199:
    v_max3_u32 v28, v20, v21, v22
    v_max_u32 v28, v28, v23
    s_nop 1
    v_max_u32_dpp v28, v28, v28 row_ror:1 row_mask:0xf bank_mask:0xf
    s_nop 1
    v_max_u32_dpp v28, v28, v28 row_ror:2 row_mask:0xf bank_mask:0xf
    s_nop 1
    v_max_u32_dpp v28, v28, v28 row_ror:4 row_mask:0xf bank_mask:0xf
    s_nop 1
    v_max_u32_dpp v28, v28, v28 row_ror:8 row_mask:0xf bank_mask:0xf
    v_mov_b32 v29, v28
    s_nop 1
    v_permlane32_swap_b32 v29, v28
    v_max_u32 v28, v29, v28
    v_mov_b32 v29, v28
    s_nop 1
    v_permlane16_swap_b32 v29, v28
    v_max_u32 v28, v29, v28
    s_nop 0
    v_readfirstlane_b32 s71, v28
    s_nop 1
    v_cmp_ne_u32 vcc, s71, v20
    s_nop 1
    v_cndmask_b32 v20, 0, v20, vcc
    v_cmp_ne_u32 vcc, s71, v21
    s_nop 1
    v_cndmask_b32 v21, 0, v21, vcc
    v_cmp_ne_u32 vcc, s71, v22
    s_nop 1
    v_cndmask_b32 v22, 0, v22, vcc
    v_cmp_ne_u32 vcc, s71, v23
    s_nop 1
    v_cndmask_b32 v23, 0, v23, vcc
    v_max3_u32 v28, v20, v21, v22
    v_max_u32 v28, v28, v23
    s_nop 1
    v_max_u32_dpp v28, v28, v28 row_ror:1 row_mask:0xf bank_mask:0xf
    s_nop 1
    v_max_u32_dpp v28, v28, v28 row_ror:2 row_mask:0xf bank_mask:0xf
    s_nop 1
    v_max_u32_dpp v28, v28, v28 row_ror:4 row_mask:0xf bank_mask:0xf
    s_nop 1
    v_max_u32_dpp v28, v28, v28 row_ror:8 row_mask:0xf bank_mask:0xf
    v_mov_b32 v29, v28
    s_nop 1
    v_permlane32_swap_b32 v29, v28
    v_max_u32 v28, v29, v28
    v_mov_b32 v29, v28
    s_nop 1
    v_permlane16_swap_b32 v29, v28
    v_max_u32 v28, v29, v28
    s_nop 0
    v_readfirstlane_b32 s72, v28
    s_nop 0
    s_max_u32 s70, s70, s72
    s_min_u32 s72, s71, s69
    s_max_u32 s70, s70, s72
    s_max_u32 s69, s69, s71
    v_mov_b32 v29, 0x20400
L_rsele_196:
    v_mov_b32 v20, s69
    v_mov_b32 v21, s70
    ds_write_b64 v29, v[20:21]
    s_waitcnt lgkmcnt(0)
L_rselw_197:
    s_barrier
    ds_read_b64 v[20:21], v29
    s_waitcnt lgkmcnt(0)
    v_readfirstlane_b32 s69, v20
    v_readfirstlane_b32 s70, v21
    s_nop 3
L_ffn_sel:
    s_and_b32 s71, s69, 2047
    s_lshl_b32 s71, s71, 11
    s_and_b32 s72, s70, 2047
    s_or_b32 s71, s71, s72
    s_add_u32 s71, s71, 1
    s_cmp_eq_u32 s71, s74
    s_cbranch_scc1 L_ffn_same
    s_mov_b32 s74, s71
    s_mov_b32 exec_lo, 0xff
    s_mov_b32 exec_hi, 0
    buffer_store_dwordx2 v[204:205], v202, s[16:19], 0 offen sc1
    s_mov_b64 exec, -1
    v_and_b32 v1, 63, v0
    v_lshrrev_b32 v2, 4, v1
    v_and_b32 v3, 15, v1
    v_lshrrev_b32 v6, 2, v3
    s_and_b32 s71, s69, 2047
    s_sub_u32 s71, 2047, s71
    s_and_b32 s72, s70, 2047
    s_sub_u32 s72, 2047, s72
    v_and_b32 v4, 1, v3
    v_cmp_eq_u32 vcc, 0, v4
    v_mov_b32 v4, s71
    v_mov_b32 v5, s72
    v_cndmask_b32 v4, v5, v4, vcc
    v_lshlrev_b32 v4, 10, v4
    v_lshl_add_u32 v4, v2, 4, v4
    s_mov_b32 s71, 0x6200000
    buffer_load_dwordx4 v[32:35], v4, s[8:11], s71 offen
    buffer_load_dwordx4 v[36:39], v4, s[8:11], s71 offen offset:64
    buffer_load_dwordx4 v[40:43], v4, s[8:11], s71 offen offset:128
    buffer_load_dwordx4 v[44:47], v4, s[8:11], s71 offen offset:192
    buffer_load_dwordx4 v[48:51], v4, s[8:11], s71 offen offset:256
    buffer_load_dwordx4 v[52:55], v4, s[8:11], s71 offen offset:320
    buffer_load_dwordx4 v[56:59], v4, s[8:11], s71 offen offset:384
    buffer_load_dwordx4 v[60:63], v4, s[8:11], s71 offen offset:448
    buffer_load_dwordx4 v[64:67], v4, s[8:11], s71 offen offset:512
    buffer_load_dwordx4 v[68:71], v4, s[8:11], s71 offen offset:576
    buffer_load_dwordx4 v[72:75], v4, s[8:11], s71 offen offset:640
    buffer_load_dwordx4 v[76:79], v4, s[8:11], s71 offen offset:704
    buffer_load_dwordx4 v[80:83], v4, s[8:11], s71 offen offset:768
    buffer_load_dwordx4 v[84:87], v4, s[8:11], s71 offen offset:832
    buffer_load_dwordx4 v[88:91], v4, s[8:11], s71 offen offset:896
    buffer_load_dwordx4 v[92:95], v4, s[8:11], s71 offen offset:960
    v_lshl_add_u32 v4, v2, 3, v6
    v_lshlrev_b32 v4, 6, v4
    v_and_b32 v5, 3, v3
    v_lshl_add_u32 v4, v5, 3, v4
    s_lshr_b32 s71, s68, 1
    s_lshl_b32 s71, s71, 15
    s_and_b32 s72, s68, 1
    s_lshl_b32 s72, s72, 5
    s_add_u32 s71, s71, s72
    s_add_u32 s71, s71, 0x8000
    v_add_u32 v7, s71, v4
    ds_read_b64_tr_b16 v[96:97], v7
    ds_read_b64_tr_b16 v[98:99], v7 offset:256
    ds_read_b64_tr_b16 v[100:101], v7 offset:2048
    ds_read_b64_tr_b16 v[102:103], v7 offset:2304
    ds_read_b64_tr_b16 v[104:105], v7 offset:4096
    ds_read_b64_tr_b16 v[106:107], v7 offset:4352
    ds_read_b64_tr_b16 v[108:109], v7 offset:6144
    ds_read_b64_tr_b16 v[110:111], v7 offset:6400
    s_waitcnt lgkmcnt(0)
    ds_read_b64_tr_b16 v[112:113], v7 offset:8192
    ds_read_b64_tr_b16 v[114:115], v7 offset:8448
    ds_read_b64_tr_b16 v[116:117], v7 offset:10240
    ds_read_b64_tr_b16 v[118:119], v7 offset:10496
    ds_read_b64_tr_b16 v[120:121], v7 offset:12288
    ds_read_b64_tr_b16 v[122:123], v7 offset:12544
    ds_read_b64_tr_b16 v[124:125], v7 offset:14336
    ds_read_b64_tr_b16 v[126:127], v7 offset:14592
    s_waitcnt lgkmcnt(0)
    ds_read_b64_tr_b16 v[128:129], v7 offset:16384
    ds_read_b64_tr_b16 v[130:131], v7 offset:16640
    ds_read_b64_tr_b16 v[132:133], v7 offset:18432
    ds_read_b64_tr_b16 v[134:135], v7 offset:18688
    ds_read_b64_tr_b16 v[136:137], v7 offset:20480
    ds_read_b64_tr_b16 v[138:139], v7 offset:20736
    ds_read_b64_tr_b16 v[140:141], v7 offset:22528
    ds_read_b64_tr_b16 v[142:143], v7 offset:22784
    s_waitcnt lgkmcnt(0)
    ds_read_b64_tr_b16 v[144:145], v7 offset:24576
    ds_read_b64_tr_b16 v[146:147], v7 offset:24832
    ds_read_b64_tr_b16 v[148:149], v7 offset:26624
    ds_read_b64_tr_b16 v[150:151], v7 offset:26880
    ds_read_b64_tr_b16 v[152:153], v7 offset:28672
    ds_read_b64_tr_b16 v[154:155], v7 offset:28928
    ds_read_b64_tr_b16 v[156:157], v7 offset:30720
    ds_read_b64_tr_b16 v[158:159], v7 offset:30976
    s_waitcnt lgkmcnt(0)
    s_waitcnt vmcnt(0)
    v_mfma_f32_16x16x32_bf16 v[8:11], v[32:35], v[96:99], 0
    v_mfma_f32_16x16x32_bf16 v[8:11], v[36:39], v[100:103], v[8:11]
    v_mfma_f32_16x16x32_bf16 v[8:11], v[40:43], v[104:107], v[8:11]
    v_mfma_f32_16x16x32_bf16 v[8:11], v[44:47], v[108:111], v[8:11]
    v_mfma_f32_16x16x32_bf16 v[8:11], v[48:51], v[112:115], v[8:11]
    v_mfma_f32_16x16x32_bf16 v[8:11], v[52:55], v[116:119], v[8:11]
    v_mfma_f32_16x16x32_bf16 v[8:11], v[56:59], v[120:123], v[8:11]
    v_mfma_f32_16x16x32_bf16 v[8:11], v[60:63], v[124:127], v[8:11]
    v_mfma_f32_16x16x32_bf16 v[8:11], v[64:67], v[128:131], v[8:11]
    v_mfma_f32_16x16x32_bf16 v[8:11], v[68:71], v[132:135], v[8:11]
    v_mfma_f32_16x16x32_bf16 v[8:11], v[72:75], v[136:139], v[8:11]
    v_mfma_f32_16x16x32_bf16 v[8:11], v[76:79], v[140:143], v[8:11]
    v_mfma_f32_16x16x32_bf16 v[8:11], v[80:83], v[144:147], v[8:11]
    v_mfma_f32_16x16x32_bf16 v[8:11], v[84:87], v[148:151], v[8:11]
    v_mfma_f32_16x16x32_bf16 v[8:11], v[88:91], v[152:155], v[8:11]
    v_mfma_f32_16x16x32_bf16 v[8:11], v[92:95], v[156:159], v[8:11]
    s_nop 7
    v_cvt_pk_bf16_f32 v8, v8, v8
    v_and_b32 v8, 0xffff0000, v8
    v_cvt_pk_bf16_f32 v9, v9, v9
    v_and_b32 v9, 0xffff0000, v9
    s_cmp_ge_u32 s68, 2
    s_cbranch_scc1 L_ffn_up_200
    v_mul_f32 v13, 0xbfb8aa3b, v8
    v_exp_f32 v13, v13
    s_nop 0
    v_add_f32 v13, 1.0, v13
    v_rcp_f32 v12, v13
    s_nop 0
    v_mul_f32 v8, v12, v8
    v_cvt_pk_bf16_f32 v8, v8, v8
    v_and_b32 v8, 0xffff0000, v8
    v_mul_f32 v13, 0xbfb8aa3b, v9
    v_exp_f32 v13, v13
    s_nop 0
    v_add_f32 v13, 1.0, v13
    v_rcp_f32 v12, v13
    s_nop 0
    v_mul_f32 v9, v12, v9
    v_cvt_pk_bf16_f32 v9, v9, v9
    v_and_b32 v9, 0xffff0000, v9
    s_nop 4
L_ffn_up_200:
    s_lshr_b32 s71, s68, 1
    s_lshl_b32 s71, s71, 8
    s_and_b32 s72, s68, 1
    s_lshl_b32 s72, s72, 6
    s_add_u32 s71, s71, s72
    s_add_u32 s71, s71, 0x20000
    v_lshlrev_b32 v4, 2, v3
    v_add_u32 v4, s71, v4
    ds_write_b32 v4, v8
    ds_write_b32 v4, v9 offset:128
    s_waitcnt lgkmcnt(0)
    s_barrier
    v_and_b32 v4, 1, v3
    v_lshlrev_b32 v4, 7, v4
    v_lshl_add_u32 v4, v2, 5, v4
    v_add_u32 v4, 0x20000, v4
    ds_read_b128 v[32:35], v4
    ds_read_b128 v[36:39], v4 offset:16
    ds_read_b128 v[40:43], v4 offset:256
    ds_read_b128 v[44:47], v4 offset:272
    v_lshl_add_u32 v5, v2, 3, v6
    v_lshlrev_b32 v5, 10, v5
    v_and_b32 v7, 3, v3
    v_lshl_add_u32 v5, v7, 3, v5
    s_lshl_b32 s71, s68, 8
    s_add_u32 s71, s71, 0x18000
    v_add_u32 v7, s71, v5
    s_waitcnt lgkmcnt(0)
    ds_read_b64_tr_b16 v[96:97], v7
    ds_read_b64_tr_b16 v[98:99], v7 offset:4096
    ds_read_b64_tr_b16 v[100:101], v7 offset:32
    ds_read_b64_tr_b16 v[102:103], v7 offset:4128
    ds_read_b64_tr_b16 v[104:105], v7 offset:64
    ds_read_b64_tr_b16 v[106:107], v7 offset:4160
    ds_read_b64_tr_b16 v[108:109], v7 offset:96
    ds_read_b64_tr_b16 v[110:111], v7 offset:4192
    s_waitcnt lgkmcnt(0)
    ds_read_b64_tr_b16 v[112:113], v7 offset:128
    ds_read_b64_tr_b16 v[114:115], v7 offset:4224
    ds_read_b64_tr_b16 v[116:117], v7 offset:160
    ds_read_b64_tr_b16 v[118:119], v7 offset:4256
    ds_read_b64_tr_b16 v[120:121], v7 offset:192
    ds_read_b64_tr_b16 v[122:123], v7 offset:4288
    ds_read_b64_tr_b16 v[124:125], v7 offset:224
    ds_read_b64_tr_b16 v[126:127], v7 offset:4320
    v_mul_f32 v32, v32, v40
    v_mul_f32 v33, v33, v41
    v_mul_f32 v34, v34, v42
    v_mul_f32 v35, v35, v43
    v_mul_f32 v36, v36, v44
    v_mul_f32 v37, v37, v45
    v_mul_f32 v38, v38, v46
    v_mul_f32 v39, v39, v47
    v_cvt_pk_bf16_f32 v48, v32, v33
    v_cvt_pk_bf16_f32 v49, v34, v35
    v_cvt_pk_bf16_f32 v50, v36, v37
    v_cvt_pk_bf16_f32 v51, v38, v39
    s_waitcnt lgkmcnt(0)
    s_nop 0
    v_mfma_f32_16x16x32_bf16 v[56:59], v[48:51], v[96:99], 0
    v_mfma_f32_16x16x32_bf16 v[60:63], v[48:51], v[100:103], 0
    v_mfma_f32_16x16x32_bf16 v[64:67], v[48:51], v[104:107], 0
    v_mfma_f32_16x16x32_bf16 v[68:71], v[48:51], v[108:111], 0
    v_mfma_f32_16x16x32_bf16 v[72:75], v[48:51], v[112:115], 0
    v_mfma_f32_16x16x32_bf16 v[76:79], v[48:51], v[116:119], 0
    v_mfma_f32_16x16x32_bf16 v[80:83], v[48:51], v[120:123], 0
    v_mfma_f32_16x16x32_bf16 v[84:87], v[48:51], v[124:127], 0
    v_cmp_eq_u32 vcc, 0, v2
    v_lshlrev_b32 v4, 11, v2
    v_lshl_add_u32 v4, v3, 2, v4
    s_lshl_b32 s71, s67, 12
    s_lshl_b32 s72, s68, 9
    s_add_u32 s71, s71, s72
    s_add_u32 s71, s71, 0x6410000
    v_cndmask_b32 v56, v57, v56, vcc
    v_cndmask_b32 v60, v61, v60, vcc
    v_cndmask_b32 v64, v65, v64, vcc
    v_cndmask_b32 v68, v69, v68, vcc
    v_cndmask_b32 v72, v73, v72, vcc
    v_cndmask_b32 v76, v77, v76, vcc
    v_cndmask_b32 v80, v81, v80, vcc
    v_cndmask_b32 v84, v85, v84, vcc
    s_mov_b32 exec_hi, 0
    buffer_store_dword v56, v4, s[8:11], s71 offen sc1
    buffer_store_dword v60, v4, s[8:11], s71 offen offset:64 sc1
    buffer_store_dword v64, v4, s[8:11], s71 offen offset:128 sc1
    buffer_store_dword v68, v4, s[8:11], s71 offen offset:192 sc1
    buffer_store_dword v72, v4, s[8:11], s71 offen offset:256 sc1
    buffer_store_dword v76, v4, s[8:11], s71 offen offset:320 sc1
    buffer_store_dword v80, v4, s[8:11], s71 offen offset:384 sc1
    buffer_store_dword v84, v4, s[8:11], s71 offen offset:448 sc1
    s_mov_b64 exec, -1
    s_waitcnt vmcnt(0)
    s_barrier
    s_lshl_b32 s71, s67, 2
    s_lshl_b32 s72, s75, 8
    s_add_u32 s71, s71, s72
    s_add_u32 s71, s71, 0x8000
    s_cmp_lg_u32 s100, 0
    s_cbranch_scc1 L_flag_201
    v_mov_b32 v2, s74
    s_mov_b64 exec, 1
    buffer_store_dword v2, off, s[8:11], s71 sc1
    s_mov_b64 exec, -1
L_flag_201:
    s_cmp_ge_u32 s67, 8
    s_cbranch_scc1 L_ffn_same
    s_load_dwordx2 s[16:17], s[0:1], 96
    s_waitcnt lgkmcnt(0)
    s_and_b32 s17, s17, 0xffff
    s_mov_b32 s18, 0x200000
    s_mov_b32 s19, 0x20000
    v_and_b32 v3, 63, v0
    s_cmp_lt_u32 s100, 2
    s_cselect_b32 s71, s69, s70
    v_mov_b32 v5, s71
    s_and_b32 s71, s71, 2047
    s_sub_u32 s71, 2047, s71
    s_lshl_b32 s71, s71, 10
    s_lshl_b32 s72, s67, 1
    s_and_b32 s96, s100, 1
    s_add_u32 s72, s72, s96
    s_lshl_b32 s96, s72, 6
    s_add_u32 s71, s71, s96
    v_and_b32 v4, 7, v3
    v_lshlrev_b32 v6, 3, v4
    v_add_u32 v6, s71, v6
    v_lshrrev_b32 v7, 3, v3
    v_lshlrev_b32 v7, 12, v7
    v_lshl_add_u32 v7, v4, 4, v7
    s_lshl_b32 s72, s72, 7
    s_lshr_b32 s96, s100, 1
    s_lshl_b32 s96, s96, 11
    s_add_u32 s72, s72, s96
    v_add_u32 v7, s72, v7
    s_mov_b32 s71, 0x6000000
    s_mov_b32 s72, 0x6200000
    buffer_load_dwordx2 v[8:9], v6, s[8:11], s71 offen sc1
    buffer_load_dwordx2 v[10:11], v6, s[8:11], s72 offen sc1
    v_and_b32 v5, 0xffff0000, v5
    v_ashrrev_i32 v4, 31, v5
    v_not_b32 v4, v4
    v_or_b32 v4, 0x80000000, v4
    v_xor_b32 v5, v5, v4
    v_and_b32 v5, 0xffff0000, v5
    v_mul_f32 v23, 0xbfb8aa3b, v5
    v_exp_f32 v23, v23
    s_nop 0
    v_add_f32 v23, 1.0, v23
    v_rcp_f32 v22, v23
    s_nop 0
    v_cvt_pk_bf16_f32 v22, v22, v22
    v_and_b32 v22, 0xffff0000, v22
    v_lshlrev_b32 v1, 2, v0
    s_lshl_b32 s71, s75, 8
    s_add_u32 s71, s71, 0x8000
    s_cmp_lg_u32 s100, 0
    s_cbranch_scc1 L_polls_204
    s_mov_b32 exec_hi, 0xffffff
    s_mov_b32 s96, 0
L_poll_202:
    buffer_load_dword v2, v1, s[8:11], s71 offen sc1
    s_waitcnt vmcnt(0)
    v_cmp_ne_u32 vcc, s74, v2
    s_cbranch_vccz L_polld_203
    s_sleep 2
    s_add_u32 s96, s96, 1
    s_cmp_lt_u32 s96, 0x10000
    s_cbranch_scc1 L_poll_202
L_polld_203:
    s_mov_b64 exec, -1
L_polls_204:
    s_barrier
    s_mov_b32 s71, 0x6410000
    buffer_load_dwordx4 v[32:35], v7, s[8:11], s71 offen sc1
    s_add_u32 s71, s71, 32768
    buffer_load_dwordx4 v[36:39], v7, s[8:11], s71 offen sc1
    s_add_u32 s71, s71, 32768
    buffer_load_dwordx4 v[40:43], v7, s[8:11], s71 offen sc1
    s_add_u32 s71, s71, 32768
    buffer_load_dwordx4 v[44:47], v7, s[8:11], s71 offen sc1
    s_add_u32 s71, s71, 32768
    buffer_load_dwordx4 v[48:51], v7, s[8:11], s71 offen sc1
    s_add_u32 s71, s71, 32768
    buffer_load_dwordx4 v[52:55], v7, s[8:11], s71 offen sc1
    s_add_u32 s71, s71, 32768
    buffer_load_dwordx4 v[56:59], v7, s[8:11], s71 offen sc1
    s_add_u32 s71, s71, 32768
    s_waitcnt vmcnt(7)
    v_lshlrev_b32 v12, 16, v8
    v_and_b32 v13, 0xffff0000, v8
    v_lshlrev_b32 v16, 16, v10
    v_and_b32 v17, 0xffff0000, v10
    v_lshlrev_b32 v14, 16, v9
    v_and_b32 v15, 0xffff0000, v9
    v_lshlrev_b32 v18, 16, v11
    v_and_b32 v19, 0xffff0000, v11
    s_waitcnt vmcnt(0)
    v_pk_add_f32 v[32:33], v[32:33], v[36:37]
    v_pk_add_f32 v[34:35], v[34:35], v[38:39]
    v_pk_add_f32 v[32:33], v[32:33], v[40:41]
    v_pk_add_f32 v[34:35], v[34:35], v[42:43]
    v_pk_add_f32 v[32:33], v[32:33], v[44:45]
    v_pk_add_f32 v[34:35], v[34:35], v[46:47]
    v_pk_add_f32 v[32:33], v[32:33], v[48:49]
    v_pk_add_f32 v[34:35], v[34:35], v[50:51]
    v_pk_add_f32 v[32:33], v[32:33], v[52:53]
    v_pk_add_f32 v[34:35], v[34:35], v[54:55]
    v_pk_add_f32 v[32:33], v[32:33], v[56:57]
    v_pk_add_f32 v[34:35], v[34:35], v[58:59]
    s_nop 0
    v_add_f32_dpp v32, v32, v32 row_ror:8 row_mask:0xf bank_mask:0xf
    v_add_f32_dpp v33, v33, v33 row_ror:8 row_mask:0xf bank_mask:0xf
    v_add_f32_dpp v34, v34, v34 row_ror:8 row_mask:0xf bank_mask:0xf
    v_add_f32_dpp v35, v35, v35 row_ror:8 row_mask:0xf bank_mask:0xf
    v_mov_b32 v24, v32
    s_nop 1
    v_permlane32_swap_b32 v24, v32
    v_add_f32 v32, v24, v32
    v_mov_b32 v24, v32
    s_nop 1
    v_permlane16_swap_b32 v24, v32
    v_add_f32 v32, v24, v32
    v_mov_b32 v24, v33
    s_nop 1
    v_permlane32_swap_b32 v24, v33
    v_add_f32 v33, v24, v33
    v_mov_b32 v24, v33
    s_nop 1
    v_permlane16_swap_b32 v24, v33
    v_add_f32 v33, v24, v33
    v_mov_b32 v24, v34
    s_nop 1
    v_permlane32_swap_b32 v24, v34
    v_add_f32 v34, v24, v34
    v_mov_b32 v24, v34
    s_nop 1
    v_permlane16_swap_b32 v24, v34
    v_add_f32 v34, v24, v34
    v_mov_b32 v24, v35
    s_nop 1
    v_permlane32_swap_b32 v24, v35
    v_add_f32 v35, v24, v35
    v_mov_b32 v24, v35
    s_nop 1
    v_permlane16_swap_b32 v24, v35
    v_add_f32 v35, v24, v35
    v_cvt_pk_bf16_f32 v32, v32, v32
    v_and_b32 v32, 0xffff0000, v32
    v_mul_f32 v32, v22, v32
    v_cvt_pk_bf16_f32 v32, v32, v32
    v_and_b32 v32, 0xffff0000, v32
    v_add_f32 v32, v16, v32
    v_cvt_pk_bf16_f32 v32, v32, v32
    v_and_b32 v32, 0xffff0000, v32
    v_add_f32 v32, v12, v32
    v_cvt_pk_bf16_f32 v33, v33, v33
    v_and_b32 v33, 0xffff0000, v33
    v_mul_f32 v33, v22, v33
    v_cvt_pk_bf16_f32 v33, v33, v33
    v_and_b32 v33, 0xffff0000, v33
    v_add_f32 v33, v17, v33
    v_cvt_pk_bf16_f32 v33, v33, v33
    v_and_b32 v33, 0xffff0000, v33
    v_add_f32 v33, v13, v33
    v_cvt_pk_bf16_f32 v34, v34, v34
    v_and_b32 v34, 0xffff0000, v34
    v_mul_f32 v34, v22, v34
    v_cvt_pk_bf16_f32 v34, v34, v34
    v_and_b32 v34, 0xffff0000, v34
    v_add_f32 v34, v18, v34
    v_cvt_pk_bf16_f32 v34, v34, v34
    v_and_b32 v34, 0xffff0000, v34
    v_add_f32 v34, v14, v34
    v_cvt_pk_bf16_f32 v35, v35, v35
    v_and_b32 v35, 0xffff0000, v35
    v_mul_f32 v35, v22, v35
    v_cvt_pk_bf16_f32 v35, v35, v35
    v_and_b32 v35, 0xffff0000, v35
    v_add_f32 v35, v19, v35
    v_cvt_pk_bf16_f32 v35, v35, v35
    v_and_b32 v35, 0xffff0000, v35
    v_add_f32 v35, v15, v35
    v_cvt_pk_bf16_f32 v200, v32, v33
    v_cvt_pk_bf16_f32 v201, v34, v35
    v_mov_b32 v202, v6
    v_pk_add_f32 v[12:13], v[12:13], v[16:17]
    v_cvt_pk_bf16_f32 v204, v12, v13
    v_pk_add_f32 v[14:15], v[14:15], v[18:19]
    v_cvt_pk_bf16_f32 v205, v14, v15
    s_mov_b32 exec_lo, 0xff
    s_mov_b32 exec_hi, 0
    buffer_store_dwordx2 v[200:201], v202, s[16:19], 0 offen sc1
    s_mov_b64 exec, -1
L_ffn_same:
    s_add_u32 s75, s75, 1
    s_cmp_lt_u32 s75, 2
    s_cbranch_scc1 L_ffn_round
    s_cmp_ge_u32 s67, 8
    s_cbranch_scc1 L_exit
    s_waitcnt vmcnt(0)
L_exit:
    s_endpgm
L_code_end:
.section .rodata,"a"
.p2align 6
.amdhsa_kernel sequential_preLN__memory_aug_recurrent_mem_tr__moe_arch_mod__prompt_kernel
  .amdhsa_next_free_vgpr 512
  .amdhsa_next_free_sgpr 102
  .amdhsa_accum_offset 256
  .amdhsa_group_segment_fixed_size 0
  .amdhsa_kernarg_size 120
  .amdhsa_user_sgpr_count 2
  .amdhsa_user_sgpr_kernarg_segment_ptr 1
  .amdhsa_system_sgpr_workgroup_id_x 1
  .amdhsa_float_denorm_mode_32 3
.end_amdhsa_kernel
```

```asm
; @launch grid=(256,1,1) block=(256,1,1) lds=163840
.amdgcn_target "amdgcn-amd-amdhsa--gfx950"
.text
.globl sequential_preLN__memory_aug_recurrent_mem_tr__moe_arch_mod__prompt_kernel
.p2align 8
.type sequential_preLN__memory_aug_recurrent_mem_tr__moe_arch_mod__prompt_kernel,@function
sequential_preLN__memory_aug_recurrent_mem_tr__moe_arch_mod__prompt_kernel:
    s_cmp_ge_u32 s2, 256
    s_cbranch_scc1 L_exit
    s_load_dwordx2 s[8:9], s[0:1], 112
    s_load_dwordx2 s[92:93], s[0:1], 104
    s_load_dwordx8 s[60:67], s[0:1], 16
    s_load_dwordx2 s[12:13], s[0:1], 0
    v_lshrrev_b32 v1, 6, v0
    s_nop 0
    v_readfirstlane_b32 s100, v1
    s_getreg_b32 s84, hwreg(HW_REG_XCC_ID)
    s_and_b32 s84, s84, 7
    s_lshr_b32 s85, s2, 3
    s_mov_b32 s86, s100
    s_cmp_eq_u32 s2, 7
    s_cbranch_scc1 L_zero
L_noz:
    s_cmp_lg_u32 s84, 0
    s_cbranch_scc1 L_other
    s_xor_b32 s20, s85, 0
    v_lshrrev_b32 v4, 6, v0
    s_nop 0
    v_readfirstlane_b32 s21, v4
    v_and_b32 v1, 63, v0
    v_lshrrev_b32 v2, 4, v1
    v_and_b32 v3, 15, v1
    v_lshrrev_b32 v6, 2, v3
    v_lshlrev_b32 v117, 4, v1
    s_lshl_b32 s51, s21, 10
    s_lshl_b32 s52, s21, 11
    s_mov_b32 s14, 0x400000
    s_mov_b32 s15, 0x20000
    s_lshl_b32 s41, s20, 8
    s_lshl_b32 s42, s20, 17
    s_lshr_b32 s43, s21, 1
    s_lshl_b32 s43, s43, 2
    v_or_b32 v5, s43, v2
    v_lshlrev_b32 v5, 1, v5
    v_xor_b32 v5, v5, v3
    v_lshrrev_b32 v14, 2, v5
    v_and_b32 v14, 2, v14
    v_lshlrev_b32 v5, 4, v5
    s_lshl_b32 s43, s21, 4
    v_add_u32 v4, s43, v2
    v_lshl_add_u32 v8, v4, 13, v5
    s_cmp_lg_u32 s20, 27
    s_cbranch_scc1 L_nocc_1
    v_lshlrev_b32 v25, 3, v117
    s_lshl_b32 s43, s21, 13
    s_getpc_b64 s[4:5]
L_pc_2:
    s_add_u32 s4, s4, L_nocc_1-L_pc_2
    s_addc_u32 s5, s5, 0
    v_add_u32 v25, s43, v25
    v_min_u32 v25, L_code_end-L_nocc_1-4, v25
    global_load_dword v29, v25, s[4:5]
L_nocc_1:
    v_mul_u32_u24 v22, 57, v0
    v_lshrrev_b32 v22, 11, v22
    v_mul_u32_u24 v23, 36, v22
    v_sub_u32 v23, v0, v23
    v_and_b32 v25, 3, v23
    v_and_or_b32 v23, v23, 60, 1
    v_min_u32 v23, 31, v23
    v_lshl_add_u32 v23, v23, 2, v25
    v_lshlrev_b32 v31, 6, v23
    s_add_u32 s43, s20, 2
    s_lshr_b32 s43, s43, 2
    s_sub_u32 s43, s20, s43
    s_mul_i32 s43, s43, 7
    v_add_u32 v22, s43, v22
    s_waitcnt lgkmcnt(0)
    s_mov_b32 s4, s60
    s_and_b32 s5, s61, 0xffff
    s_lshr_b32 s6, 0x5ddddddd, s20
    s_and_b32 s6, s6, 1
    s_lshl_b32 s6, s6, 22
    s_mov_b32 s7, 0x20000
    v_add_u32 v23, 0, v22
    v_and_b32 v25, 448, v23
    v_add_u32 v23, v23, v25
    v_lshl_add_u32 v23, v23, 13, v31
    s_mov_b32 s43, 0x80000
    buffer_load_dword v30, v23, s[4:7], s43 offen
    s_mov_b32 s4, s60
    s_and_b32 s5, s61, 0xffff
    s_lshr_b32 s6, 0x5ddddddd, s20
    s_and_b32 s6, s6, 1
    s_lshl_b32 s6, s6, 22
    s_mov_b32 s7, 0x20000
    v_add_u32 v23, 161, v22
    v_and_b32 v25, 448, v23
    v_add_u32 v23, v23, v25
    v_lshl_add_u32 v23, v23, 13, v31
    s_mov_b32 s43, 0x80000
    buffer_load_dword v30, v23, s[4:7], s43 offen
    s_and_b32 s9, s9, 0xffff
    s_mov_b32 s10, 0x10000000
    s_mov_b32 s11, 0x20000
    s_and_b32 s93, s93, 0xffff
    s_mov_b32 s94, 0x100
    s_mov_b32 s95, 0x20000
    s_mov_b32 s87, 0
    s_cmp_lg_u32 s86, 0
    s_cbranch_scc1 L_reg_3
    s_lshl_b32 s97, s84, 4
    s_lshl_b32 s96, 1, s85
    v_mov_b32 v250, s96
    v_mov_b32 v251, 256
    s_mov_b64 exec, 1
    buffer_atomic_add_x2 v[250:251], off, s[92:95], s97 offset:64
    s_mov_b64 exec, -1
    s_mov_b32 s86, 1
L_reg_3:
    s_mov_b32 s16, s92
    s_mov_b32 s17, s93
    s_mov_b32 s18, s94
    s_mov_b32 s19, s95
    s_mov_b32 s88, s20
    s_mov_b32 s12, s60
    s_and_b32 s13, s61, 0xffff
    v_xor_b32 v15, 0, v14
    v_lshl_add_u32 v15, v15, 15, v8
    s_add_u32 s43, s41, 0x0
    s_add_u32 m0, s51, 0x8000
    s_nop 0
    buffer_load_dwordx4 v15, s[12:15], s43 offen nt lds
    s_add_u32 s43, s41, 0x8000
    s_add_u32 m0, s51, 0x9000
    s_nop 0
    buffer_load_dwordx4 v15, s[12:15], s43 offen nt lds
    s_add_u32 s43, s41, 0x100000
    s_add_u32 m0, s51, 0xa000
    s_nop 0
    buffer_load_dwordx4 v15, s[12:15], s43 offen nt lds
    s_add_u32 s43, s41, 0x108000
    s_add_u32 m0, s51, 0xb000
    s_nop 0
    buffer_load_dwordx4 v15, s[12:15], s43 offen nt lds
    s_add_u32 s43, s41, 0x200000
    s_add_u32 m0, s51, 0xc000
    s_nop 0
    buffer_load_dwordx4 v15, s[12:15], s43 offen nt lds
    s_add_u32 s43, s41, 0x208000
    s_add_u32 m0, s51, 0xd000
    s_nop 0
    buffer_load_dwordx4 v15, s[12:15], s43 offen nt lds
    s_add_u32 s43, s41, 0x300000
    s_add_u32 m0, s51, 0xe000
    s_nop 0
    buffer_load_dwordx4 v15, s[12:15], s43 offen nt lds
    s_add_u32 s43, s41, 0x308000
    s_add_u32 m0, s51, 0xf000
    s_nop 0
    buffer_load_dwordx4 v15, s[12:15], s43 offen nt lds
    v_xor_b32 v15, 2, v14
    v_lshl_add_u32 v15, v15, 15, v8
    s_add_u32 s43, s41, 0x0
    s_add_u32 m0, s51, 0x10000
    s_nop 0
    buffer_load_dwordx4 v15, s[12:15], s43 offen nt lds
    s_add_u32 s43, s41, 0x8000
    s_add_u32 m0, s51, 0x11000
    s_nop 0
    buffer_load_dwordx4 v15, s[12:15], s43 offen nt lds
    s_add_u32 s43, s41, 0x100000
    s_add_u32 m0, s51, 0x12000
    s_nop 0
    buffer_load_dwordx4 v15, s[12:15], s43 offen nt lds
    s_add_u32 s43, s41, 0x108000
    s_add_u32 m0, s51, 0x13000
    s_nop 0
    buffer_load_dwordx4 v15, s[12:15], s43 offen nt lds
    s_add_u32 s43, s41, 0x200000
    s_add_u32 m0, s51, 0x14000
    s_nop 0
    buffer_load_dwordx4 v15, s[12:15], s43 offen nt lds
    s_add_u32 s43, s41, 0x208000
    s_add_u32 m0, s51, 0x15000
    s_nop 0
    buffer_load_dwordx4 v15, s[12:15], s43 offen nt lds
    s_add_u32 s43, s41, 0x300000
    s_add_u32 m0, s51, 0x16000
    s_nop 0
    buffer_load_dwordx4 v15, s[12:15], s43 offen nt lds
    s_add_u32 s43, s41, 0x308000
    s_add_u32 m0, s51, 0x17000
    s_nop 0
    buffer_load_dwordx4 v15, s[12:15], s43 offen nt lds
    v_xor_b32 v15, 0, v14
    v_lshl_add_u32 v15, v15, 15, v8
    s_add_u32 s43, s41, 0x80000
    s_add_u32 m0, s51, 0x18000
    s_nop 0
    buffer_load_dwordx4 v15, s[12:15], s43 offen nt lds
    s_add_u32 s43, s41, 0x88000
    s_add_u32 m0, s51, 0x19000
    s_nop 0
    buffer_load_dwordx4 v15, s[12:15], s43 offen nt lds
    s_add_u32 s43, s41, 0x180000
    s_add_u32 m0, s51, 0x1a000
    s_nop 0
    buffer_load_dwordx4 v15, s[12:15], s43 offen nt lds
    s_add_u32 s43, s41, 0x188000
    s_add_u32 m0, s51, 0x1b000
    s_nop 0
    buffer_load_dwordx4 v15, s[12:15], s43 offen nt lds
    v_and_b32 v4, 2, v3
    v_cmp_ne_u32 vcc, 0, v4
    v_mov_b32 v4, 0x4444
    v_mov_b32 v5, 0xeeee
    v_cndmask_b32 v116, v4, v5, vcc
    v_lshrrev_b32 v5, 1, v2
    v_lshl_add_u32 v4, v6, 3, v5
    s_lshl_b32 s43, s21, 1
    v_add_u32 v4, s43, v4
    v_add_u32 v5, s20, v4
    v_and_b32 v5, 31, v5
    v_lshl_add_u32 v4, v4, 6, v5
    v_and_b32 v5, 1, v2
    v_lshl_add_u32 v4, v4, 1, v5
    v_and_b32 v5, 3, v3
    v_lshl_add_u32 v4, v4, 2, v5
    v_lshlrev_b32 v118, 4, v4
    v_and_b32 v4, 1, v2
    v_lshlrev_b32 v4, 2, v4
    v_and_b32 v7, 2, v2
    v_add_u32 v4, v4, v7
    v_and_b32 v7, 1, v6
    v_add_u32 v4, v4, v7
    v_lshl_add_u32 v4, v4, 2, v5
    v_lshlrev_b32 v4, 2, v4
    s_and_b32 s43, s21, 1
    s_lshl_b32 s43, s43, 12
    s_lshl_b32 s40, s20, 7
    s_add_u32 s43, s43, s40
    v_add_u32 v119, s43, v4
    v_sub_u32 v7, 0, v2
    v_and_b32 v7, 3, v7
    v_xor_b32 v7, v7, v6
    v_lshl_add_u32 v4, v2, 4, v7
    v_and_b32 v5, 3, v3
    v_lshl_add_u32 v4, v4, 2, v5
    s_add_u32 s43, s51, 16384
    v_lshl_add_u32 v120, v4, 2, s43
    v_sub_u32 v7, 0, v6
    v_and_b32 v7, 3, v7
    v_xor_b32 v7, v7, v2
    v_lshl_add_u32 v4, v3, 2, v7
    v_lshlrev_b32 v121, 4, v4
    v_and_b32 v5, 1, v3
    v_lshl_add_u32 v4, v6, 1, v5
    v_lshl_add_u32 v4, v2, 3, v4
    v_lshlrev_b32 v127, 4, v4
    v_and_or_b32 v122, v116, 8, v127
    s_lshl_b32 s43, s21, 13
    s_add_u32 s43, s43, 32768
    v_add_u32 v123, s43, v117
    v_add_u32 v124, 0x10000, v123
    s_mov_b32 s36, 0xcccccccc
    s_mov_b32 s37, 0xcccccccc
    s_mov_b32 s38, 0x00ff00ff
    s_mov_b32 s39, 0x00ff00ff
    s_mov_b32 s34, 0x3e0293ee
    s_mov_b32 s35, 0x49800000
    s_mov_b32 s50, 0x3f803f80
    v_and_b32 v5, 1, v2
    v_or_b32 v5, 0, v5
    v_xor_b32 v5, v5, v6
    v_and_b32 v7, 2, v5
    v_add_u32 v5, v5, v7
    v_lshlrev_b32 v5, 6, v5
    v_and_b32 v7, 3, v3
    v_lshl_add_u32 v7, v7, 4, v5
    s_lshl_b32 s43, s21, 2
    v_add_u32 v4, s43, v2
    v_lshl_add_u32 v10, v4, 10, v7
    v_and_b32 v5, 1, v2
    v_or_b32 v5, 2, v5
    v_xor_b32 v5, v5, v6
    v_and_b32 v7, 2, v5
    v_add_u32 v5, v5, v7
    v_lshlrev_b32 v5, 6, v5
    v_and_b32 v7, 3, v3
    v_lshl_add_u32 v7, v7, 4, v5
    s_lshl_b32 s43, s21, 2
    v_add_u32 v4, s43, v2
    v_lshl_add_u32 v9, v4, 10, v7
    v_and_b32 v5, 1, v2
    v_lshl_add_u32 v4, v5, 3, v6
    v_lshrrev_b32 v7, 1, v2
    v_lshl_add_u32 v4, v7, 5, v4
    v_lshlrev_b32 v4, 8, v4
    v_lshl_or_b32 v5, v5, 2, v6
    v_lshlrev_b32 v5, 5, v5
    s_lshl_b32 s43, s21, 6
    v_xor_b32 v5, s43, v5
    v_add_u32 v4, v4, v5
    v_and_b32 v5, 3, v3
    v_lshl_add_u32 v4, v5, 3, v4
    v_add_u32 v11, 32768, v4
    s_and_b32 s43, s21, 1
    s_lshl_b32 s43, s43, 12
    v_add_u32 v11, s43, v11
    v_and_b32 v5, 1, v2
    v_lshlrev_b32 v4, 4, v5
    v_lshl_add_u32 v4, v7, 2, v4
    v_and_b32 v7, 1, v6
    v_add_u32 v4, v4, v7
    s_lshl_b32 s43, s21, 5
    v_add_u32 v4, s43, v4
    v_lshlrev_b32 v4, 8, v4
    v_lshl_or_b32 v5, v5, 1, v7
    s_lshl_b32 s43, s21, 1
    s_and_b32 s43, s43, 3
    v_xor_b32 v5, s43, v5
    v_lshl_add_u32 v4, v5, 6, v4
    v_lshrrev_b32 v5, 1, v6
    v_lshl_add_u32 v4, v5, 5, v4
    v_and_b32 v5, 3, v3
    v_lshl_add_u32 v4, v5, 3, v4
    v_add_u32 v12, 32768, v4
    v_mul_u32_u24 v4, 0x0, v2
    v_lshl_add_u32 v4, v3, 7, v4
    s_lshl_b32 s43, s20, 13
    s_add_u32 s43, s43, s52
    s_add_u32 s43, s43, 0xf0000
    v_add_u32 v4, s43, v4
    v_and_b32 v5, 3, v3
    v_lshl_add_u32 v5, v5, 13, v119
    v_cmp_gt_u32 vcc, 2, v2
    s_nop 1
    v_cndmask_b32 v7, v5, v4, vcc
    v_mov_b32 v16, -1
    v_mov_b32 v17, -1
    v_mov_b32 v18, -1
    v_mov_b32 v19, -1
    s_lshl_b32 s43, s20, 13
    s_add_u32 s43, s43, 0x100000
    s_and_b32 s40, s21, 1
    s_lshl_b32 s40, s40, 12
    s_add_u32 s29, s43, s40
    s_add_u32 s43, s43, s52
    s_xor_b32 s40, s43, 0x0
    buffer_store_dwordx4 v[16:19], v117, s[8:11], s43 offen
    buffer_store_dwordx4 v[16:19], v117, s[8:11], s43 offen offset:1024
    s_mov_b32 s43, 0x12000
    buffer_store_dword v16, v119, s[8:11], s43 offen
    s_mov_b32 s43, 0x14000
    buffer_store_dword v16, v119, s[8:11], s43 offen
    s_mov_b32 s43, 0x16000
    buffer_store_dword v16, v119, s[8:11], s43 offen
    s_load_dwordx2 s[4:5], s[0:1], 8
    s_waitcnt lgkmcnt(0)
    s_and_b32 s5, s5, 0xffff
    s_mov_b32 s6, 8192
    s_mov_b32 s7, 0x20000
    v_and_b32 v20, 1, v2
    v_and_b32 v21, 1, v6
    v_lshl_add_u32 v20, v20, 1, v21
    v_lshlrev_b32 v20, 9, v20
    v_and_b32 v21, 3, v3
    v_lshl_add_u32 v20, v21, 4, v20
    v_and_b32 v21, 2, v2
    v_add_u32 v20, v20, v21
    s_and_b32 s43, s20, 1
    s_lshl_b32 s43, s43, 11
    s_bfe_u32 s40, s20, 0x20001
    s_lshl_b32 s40, s40, 7
    s_add_u32 s43, s43, s40
    s_and_b32 s40, s21, 1
    s_lshl_b32 s40, s40, 6
    s_add_u32 s43, s43, s40
    s_lshr_b32 s40, s20, 3
    s_lshl_b32 s40, s40, 2
    s_add_u32 s43, s43, s40
    v_add_u32 v20, s43, v20
    v_lshlrev_b32 v20, 1, v20
    buffer_load_dword v21, v20, s[4:7], 0 offen
    s_mov_b32 s57, 0
    s_lshl_b32 s43, s20, 13
    s_add_u32 s43, s43, s52
    s_add_u32 s30, s43, 0x1000000
    s_add_u32 s31, s43, 0x2000000
    s_lshr_b32 s43, s43, 1
    s_add_u32 s32, s43, 0x220000
    s_waitcnt vmcnt(18)
    s_barrier
    v_xor_b32 v13, 0x0, v11
    v_add_u32 v13, 0x0, v13
    ds_read_b64_tr_b16 v[80:81], v13
    ds_read_b64_tr_b16 v[82:83], v13 offset:1024
    ds_read_b64_tr_b16 v[84:85], v13 offset:16384
    ds_read_b64_tr_b16 v[86:87], v13 offset:17408
    v_xor_b32 v13, 0x20, v11
    v_add_u32 v13, 0x0, v13
    ds_read_b64_tr_b16 v[56:57], v13
    ds_read_b64_tr_b16 v[58:59], v13 offset:1024
    ds_read_b64_tr_b16 v[60:61], v13 offset:16384
    ds_read_b64_tr_b16 v[62:63], v13 offset:17408
    v_xor_b32 v13, 0x1000, v11
    v_add_u32 v13, 0x0, v13
    ds_read_b64_tr_b16 a[0:1], v13
    ds_read_b64_tr_b16 a[2:3], v13 offset:1024
    ds_read_b64_tr_b16 a[4:5], v13 offset:16384
    ds_read_b64_tr_b16 a[6:7], v13 offset:17408
    v_xor_b32 v13, 0x1020, v11
    v_add_u32 v13, 0x0, v13
    ds_read_b64_tr_b16 a[8:9], v13
    ds_read_b64_tr_b16 a[10:11], v13 offset:1024
    ds_read_b64_tr_b16 a[12:13], v13 offset:16384
    ds_read_b64_tr_b16 a[14:15], v13 offset:17408
    s_waitcnt lgkmcnt(0)
    s_barrier
    s_mov_b32 s4, s62
    s_and_b32 s5, s63, 0xffff
    s_lshr_b32 s6, 0x5ddddddd, s20
    s_and_b32 s6, s6, 1
    s_lshl_b32 s6, s6, 22
    s_mov_b32 s7, 0x20000
    v_add_u32 v23, 0, v22
    v_and_b32 v25, 448, v23
    v_add_u32 v23, v23, v25
    v_lshl_add_u32 v23, v23, 13, v31
    s_mov_b32 s43, 0x0
    buffer_load_dword v30, v23, s[4:7], s43 offen
    s_add_u32 s43, s41, 0x280000
    s_add_u32 m0, s51, 0x1c000
    s_nop 0
    buffer_load_dwordx4 v15, s[12:15], s43 offen nt lds
    s_add_u32 s43, s41, 0x288000
    s_add_u32 m0, s51, 0x1d000
    s_nop 0
    buffer_load_dwordx4 v15, s[12:15], s43 offen nt lds
    s_add_u32 s43, s41, 0x380000
    s_add_u32 m0, s51, 0x1e000
    s_nop 0
    buffer_load_dwordx4 v15, s[12:15], s43 offen nt lds
    s_add_u32 s43, s41, 0x388000
    s_add_u32 m0, s51, 0x1f000
    s_nop 0
    buffer_load_dwordx4 v15, s[12:15], s43 offen nt lds
    v_xor_b32 v15, 2, v14
    v_lshl_add_u32 v15, v15, 15, v8
    s_add_u32 s43, s41, 0x80000
    s_add_u32 m0, s51, 0x20000
    s_nop 0
    buffer_load_dwordx4 v15, s[12:15], s43 offen nt lds
    s_add_u32 s43, s41, 0x88000
    s_add_u32 m0, s51, 0x21000
    s_nop 0
    buffer_load_dwordx4 v15, s[12:15], s43 offen nt lds
    s_add_u32 s43, s41, 0x180000
    s_add_u32 m0, s51, 0x22000
    s_nop 0
    buffer_load_dwordx4 v15, s[12:15], s43 offen nt lds
    s_add_u32 s43, s41, 0x188000
    s_add_u32 m0, s51, 0x23000
    s_nop 0
    buffer_load_dwordx4 v15, s[12:15], s43 offen nt lds
    s_waitcnt vmcnt(19)
    s_barrier
    v_xor_b32 v13, 0x0, v11
    v_add_u32 v13, 0x8000, v13
    ds_read_b64_tr_b16 a[32:33], v13
    ds_read_b64_tr_b16 a[34:35], v13 offset:1024
    ds_read_b64_tr_b16 a[36:37], v13 offset:16384
    ds_read_b64_tr_b16 a[38:39], v13 offset:17408
    v_xor_b32 v13, 0x20, v11
    v_add_u32 v13, 0x8000, v13
    ds_read_b64_tr_b16 a[40:41], v13
    ds_read_b64_tr_b16 a[42:43], v13 offset:1024
    ds_read_b64_tr_b16 a[44:45], v13 offset:16384
    ds_read_b64_tr_b16 a[46:47], v13 offset:17408
    v_xor_b32 v13, 0x1000, v11
    v_add_u32 v13, 0x8000, v13
    ds_read_b64_tr_b16 a[64:65], v13
    ds_read_b64_tr_b16 a[66:67], v13 offset:1024
    ds_read_b64_tr_b16 a[68:69], v13 offset:16384
    ds_read_b64_tr_b16 a[70:71], v13 offset:17408
    v_xor_b32 v13, 0x1020, v11
    v_add_u32 v13, 0x8000, v13
    ds_read_b64_tr_b16 a[72:73], v13
    ds_read_b64_tr_b16 a[74:75], v13 offset:1024
    ds_read_b64_tr_b16 a[76:77], v13 offset:16384
    ds_read_b64_tr_b16 a[78:79], v13 offset:17408
    s_waitcnt lgkmcnt(0)
    s_barrier
    s_add_u32 s43, s41, 0x280000
    s_add_u32 m0, s51, 0x24000
    s_nop 0
    buffer_load_dwordx4 v15, s[12:15], s43 offen nt lds
    s_add_u32 s43, s41, 0x288000
    s_add_u32 m0, s51, 0x25000
    s_nop 0
    buffer_load_dwordx4 v15, s[12:15], s43 offen nt lds
    s_add_u32 s43, s41, 0x380000
    s_add_u32 m0, s51, 0x26000
    s_nop 0
    buffer_load_dwordx4 v15, s[12:15], s43 offen nt lds
    s_add_u32 s43, s41, 0x388000
    s_add_u32 m0, s51, 0x27000
    s_nop 0
    buffer_load_dwordx4 v15, s[12:15], s43 offen nt lds
    s_mov_b32 s12, s62
    s_and_b32 s13, s63, 0xffff
    v_xor_b32 v15, 0, v14
    v_lshl_add_u32 v15, v15, 15, v8
    s_add_u32 s43, s41, 0x0
    s_add_u32 m0, s51, 0x8000
    s_nop 0
    buffer_load_dwordx4 v15, s[12:15], s43 offen nt lds
    s_add_u32 s43, s41, 0x8000
    s_add_u32 m0, s51, 0x9000
    s_nop 0
    buffer_load_dwordx4 v15, s[12:15], s43 offen nt lds
    s_add_u32 s43, s41, 0x100000
    s_add_u32 m0, s51, 0xa000
    s_nop 0
    buffer_load_dwordx4 v15, s[12:15], s43 offen nt lds
    s_add_u32 s43, s41, 0x108000
    s_add_u32 m0, s51, 0xb000
    s_nop 0
    buffer_load_dwordx4 v15, s[12:15], s43 offen nt lds
    s_waitcnt vmcnt(12)
    s_barrier
    v_xor_b32 v13, 0x0, v11
    v_add_u32 v13, 0x10000, v13
    ds_read_b64_tr_b16 v[88:89], v13
    ds_read_b64_tr_b16 v[90:91], v13 offset:1024
    ds_read_b64_tr_b16 v[92:93], v13 offset:16384
    ds_read_b64_tr_b16 v[94:95], v13 offset:17408
    v_xor_b32 v13, 0x20, v11
    v_add_u32 v13, 0x10000, v13
    ds_read_b64_tr_b16 v[96:97], v13
    ds_read_b64_tr_b16 v[98:99], v13 offset:1024
    ds_read_b64_tr_b16 v[100:101], v13 offset:16384
    ds_read_b64_tr_b16 v[102:103], v13 offset:17408
    v_xor_b32 v13, 0x1000, v11
    v_add_u32 v13, 0x10000, v13
    ds_read_b64_tr_b16 a[16:17], v13
    ds_read_b64_tr_b16 a[18:19], v13 offset:1024
    ds_read_b64_tr_b16 a[20:21], v13 offset:16384
    ds_read_b64_tr_b16 a[22:23], v13 offset:17408
    v_xor_b32 v13, 0x1020, v11
    v_add_u32 v13, 0x10000, v13
    ds_read_b64_tr_b16 a[24:25], v13
    ds_read_b64_tr_b16 a[26:27], v13 offset:1024
    ds_read_b64_tr_b16 a[28:29], v13 offset:16384
    ds_read_b64_tr_b16 a[30:31], v13 offset:17408
    s_waitcnt lgkmcnt(0)
    s_barrier
    s_add_u32 s43, s41, 0x200000
    s_add_u32 m0, s51, 0xc000
    s_nop 0
    buffer_load_dwordx4 v15, s[12:15], s43 offen nt lds
    s_add_u32 s43, s41, 0x208000
    s_add_u32 m0, s51, 0xd000
    s_nop 0
    buffer_load_dwordx4 v15, s[12:15], s43 offen nt lds
    s_add_u32 s43, s41, 0x300000
    s_add_u32 m0, s51, 0xe000
    s_nop 0
    buffer_load_dwordx4 v15, s[12:15], s43 offen nt lds
    s_add_u32 s43, s41, 0x308000
    s_add_u32 m0, s51, 0xf000
    s_nop 0
    buffer_load_dwordx4 v15, s[12:15], s43 offen nt lds
    v_xor_b32 v15, 2, v14
    v_lshl_add_u32 v15, v15, 15, v8
    s_add_u32 s43, s41, 0x0
    s_add_u32 m0, s51, 0x10000
    s_nop 0
    buffer_load_dwordx4 v15, s[12:15], s43 offen nt lds
    s_add_u32 s43, s41, 0x8000
    s_add_u32 m0, s51, 0x11000
    s_nop 0
    buffer_load_dwordx4 v15, s[12:15], s43 offen nt lds
    s_add_u32 s43, s41, 0x100000
    s_add_u32 m0, s51, 0x12000
    s_nop 0
    buffer_load_dwordx4 v15, s[12:15], s43 offen nt lds
    s_add_u32 s43, s41, 0x108000
    s_add_u32 m0, s51, 0x13000
    s_nop 0
    buffer_load_dwordx4 v15, s[12:15], s43 offen nt lds
    s_waitcnt vmcnt(12)
    s_barrier
    v_xor_b32 v13, 0x0, v11
    v_add_u32 v13, 0x18000, v13
    ds_read_b64_tr_b16 a[48:49], v13
    ds_read_b64_tr_b16 a[50:51], v13 offset:1024
    ds_read_b64_tr_b16 a[52:53], v13 offset:16384
    ds_read_b64_tr_b16 a[54:55], v13 offset:17408
    v_xor_b32 v13, 0x20, v11
    v_add_u32 v13, 0x18000, v13
    ds_read_b64_tr_b16 a[56:57], v13
    ds_read_b64_tr_b16 a[58:59], v13 offset:1024
    ds_read_b64_tr_b16 a[60:61], v13 offset:16384
    ds_read_b64_tr_b16 a[62:63], v13 offset:17408
    v_xor_b32 v13, 0x1000, v11
    v_add_u32 v13, 0x18000, v13
    ds_read_b64_tr_b16 a[80:81], v13
    ds_read_b64_tr_b16 a[82:83], v13 offset:1024
    ds_read_b64_tr_b16 a[84:85], v13 offset:16384
    ds_read_b64_tr_b16 a[86:87], v13 offset:17408
    v_xor_b32 v13, 0x1020, v11
    v_add_u32 v13, 0x18000, v13
    ds_read_b64_tr_b16 a[88:89], v13
    ds_read_b64_tr_b16 a[90:91], v13 offset:1024
    ds_read_b64_tr_b16 a[92:93], v13 offset:16384
    ds_read_b64_tr_b16 a[94:95], v13 offset:17408
    s_waitcnt lgkmcnt(0)
    s_barrier
    s_add_u32 s43, s41, 0x200000
    s_add_u32 m0, s51, 0x14000
    s_nop 0
    buffer_load_dwordx4 v15, s[12:15], s43 offen nt lds
    s_add_u32 s43, s41, 0x208000
    s_add_u32 m0, s51, 0x15000
    s_nop 0
    buffer_load_dwordx4 v15, s[12:15], s43 offen nt lds
    s_add_u32 s43, s41, 0x300000
    s_add_u32 m0, s51, 0x16000
    s_nop 0
    buffer_load_dwordx4 v15, s[12:15], s43 offen nt lds
    s_add_u32 s43, s41, 0x308000
    s_add_u32 m0, s51, 0x17000
    s_nop 0
    buffer_load_dwordx4 v15, s[12:15], s43 offen nt lds
    v_xor_b32 v15, 0, v14
    v_lshl_add_u32 v15, v15, 15, v8
    s_add_u32 s43, s41, 0x80000
    s_add_u32 m0, s51, 0x18000
    s_nop 0
    buffer_load_dwordx4 v15, s[12:15], s43 offen nt lds
    s_add_u32 s43, s41, 0x88000
    s_add_u32 m0, s51, 0x19000
    s_nop 0
    buffer_load_dwordx4 v15, s[12:15], s43 offen nt lds
    s_add_u32 s43, s41, 0x180000
    s_add_u32 m0, s51, 0x1a000
    s_nop 0
    buffer_load_dwordx4 v15, s[12:15], s43 offen nt lds
    s_add_u32 s43, s41, 0x188000
    s_add_u32 m0, s51, 0x1b000
    s_nop 0
    buffer_load_dwordx4 v15, s[12:15], s43 offen nt lds
    s_waitcnt vmcnt(12)
    v_min_u32 v21, 0xfffffffe, v21
    s_mov_b32 s43, 0x10000
    s_mov_b64 exec, s[38:39]
    buffer_store_dword v21, v119, s[8:11], s43 offen
    s_mov_b64 exec, -1
    s_barrier
    v_xor_b32 v13, 0x0, v11
    v_add_u32 v13, 0x0, v13
    ds_read_b64_tr_b16 v[64:65], v13
    ds_read_b64_tr_b16 v[66:67], v13 offset:1024
    ds_read_b64_tr_b16 v[68:69], v13 offset:16384
    ds_read_b64_tr_b16 v[70:71], v13 offset:17408
    v_xor_b32 v13, 0x20, v11
    v_add_u32 v13, 0x0, v13
    ds_read_b64_tr_b16 v[72:73], v13
    ds_read_b64_tr_b16 v[74:75], v13 offset:1024
    ds_read_b64_tr_b16 v[76:77], v13 offset:16384
    ds_read_b64_tr_b16 v[78:79], v13 offset:17408
    v_xor_b32 v13, 0x1000, v11
    v_add_u32 v13, 0x0, v13
    ds_read_b64_tr_b16 a[96:97], v13
    ds_read_b64_tr_b16 a[98:99], v13 offset:1024
    ds_read_b64_tr_b16 a[100:101], v13 offset:16384
    ds_read_b64_tr_b16 a[102:103], v13 offset:17408
    v_xor_b32 v13, 0x1020, v11
    v_add_u32 v13, 0x0, v13
    ds_read_b64_tr_b16 a[104:105], v13
    ds_read_b64_tr_b16 a[106:107], v13 offset:1024
    ds_read_b64_tr_b16 a[108:109], v13 offset:16384
    ds_read_b64_tr_b16 a[110:111], v13 offset:17408
    s_waitcnt lgkmcnt(0)
    s_barrier
    s_add_u32 s43, s41, 0x280000
    s_add_u32 m0, s51, 0x1c000
    s_nop 0
    buffer_load_dwordx4 v15, s[12:15], s43 offen nt lds
    s_add_u32 s43, s41, 0x288000
    s_add_u32 m0, s51, 0x1d000
    s_nop 0
    buffer_load_dwordx4 v15, s[12:15], s43 offen nt lds
    s_add_u32 s43, s41, 0x380000
    s_add_u32 m0, s51, 0x1e000
    s_nop 0
    buffer_load_dwordx4 v15, s[12:15], s43 offen nt lds
    s_add_u32 s43, s41, 0x388000
    s_add_u32 m0, s51, 0x1f000
    s_nop 0
    buffer_load_dwordx4 v15, s[12:15], s43 offen nt lds
    v_xor_b32 v15, 2, v14
    v_lshl_add_u32 v15, v15, 15, v8
    s_add_u32 s43, s41, 0x80000
    s_add_u32 m0, s51, 0x20000
    s_nop 0
    buffer_load_dwordx4 v15, s[12:15], s43 offen nt lds
    s_add_u32 s43, s41, 0x88000
    s_add_u32 m0, s51, 0x21000
    s_nop 0
    buffer_load_dwordx4 v15, s[12:15], s43 offen nt lds
    s_add_u32 s43, s41, 0x180000
    s_add_u32 m0, s51, 0x22000
    s_nop 0
    buffer_load_dwordx4 v15, s[12:15], s43 offen nt lds
    s_add_u32 s43, s41, 0x188000
    s_add_u32 m0, s51, 0x23000
    s_nop 0
    buffer_load_dwordx4 v15, s[12:15], s43 offen nt lds
    s_waitcnt vmcnt(12)
    s_barrier
    v_xor_b32 v13, 0x0, v11
    v_add_u32 v13, 0x8000, v13
    ds_read_b64_tr_b16 a[128:129], v13
    ds_read_b64_tr_b16 a[130:131], v13 offset:1024
    ds_read_b64_tr_b16 a[132:133], v13 offset:16384
    ds_read_b64_tr_b16 a[134:135], v13 offset:17408
    v_xor_b32 v13, 0x20, v11
    v_add_u32 v13, 0x8000, v13
    ds_read_b64_tr_b16 a[136:137], v13
    ds_read_b64_tr_b16 a[138:139], v13 offset:1024
    ds_read_b64_tr_b16 a[140:141], v13 offset:16384
    ds_read_b64_tr_b16 a[142:143], v13 offset:17408
    v_xor_b32 v13, 0x1000, v11
    v_add_u32 v13, 0x8000, v13
    ds_read_b64_tr_b16 a[160:161], v13
    ds_read_b64_tr_b16 a[162:163], v13 offset:1024
    ds_read_b64_tr_b16 a[164:165], v13 offset:16384
    ds_read_b64_tr_b16 a[166:167], v13 offset:17408
    v_xor_b32 v13, 0x1020, v11
    v_add_u32 v13, 0x8000, v13
    ds_read_b64_tr_b16 a[168:169], v13
    ds_read_b64_tr_b16 a[170:171], v13 offset:1024
    ds_read_b64_tr_b16 a[172:173], v13 offset:16384
    ds_read_b64_tr_b16 a[174:175], v13 offset:17408
    s_waitcnt lgkmcnt(0)
    s_barrier
    buffer_load_dwordx2 v[26:27], off, s[16:19], 0 offset:36 sc1
    s_add_u32 s43, s41, 0x280000
    s_add_u32 m0, s51, 0x24000
    s_nop 0
    buffer_load_dwordx4 v15, s[12:15], s43 offen nt lds
    s_add_u32 s43, s41, 0x288000
    s_add_u32 m0, s51, 0x25000
    s_nop 0
    buffer_load_dwordx4 v15, s[12:15], s43 offen nt lds
    s_add_u32 s43, s41, 0x380000
    s_add_u32 m0, s51, 0x26000
    s_nop 0
    buffer_load_dwordx4 v15, s[12:15], s43 offen nt lds
    s_add_u32 s43, s41, 0x388000
    s_add_u32 m0, s51, 0x27000
    s_nop 0
    buffer_load_dwordx4 v15, s[12:15], s43 offen nt lds
    s_mov_b32 s12, s64
    s_and_b32 s13, s65, 0xffff
    v_xor_b32 v15, 0, v14
    v_lshl_add_u32 v15, v15, 15, v8
    s_add_u32 s43, s41, 0x0
    s_add_u32 m0, s51, 0x8000
    s_nop 0
    buffer_load_dwordx4 v15, s[12:15], s43 offen lds
    s_add_u32 s43, s41, 0x8000
    s_add_u32 m0, s51, 0x9000
    s_nop 0
    buffer_load_dwordx4 v15, s[12:15], s43 offen lds
    s_add_u32 s43, s41, 0x100000
    s_add_u32 m0, s51, 0xa000
    s_nop 0
    buffer_load_dwordx4 v15, s[12:15], s43 offen lds
    s_add_u32 s43, s41, 0x108000
    s_add_u32 m0, s51, 0xb000
    s_nop 0
    buffer_load_dwordx4 v15, s[12:15], s43 offen lds
    s_waitcnt vmcnt(13)
    s_barrier
    v_xor_b32 v13, 0x0, v11
    v_add_u32 v13, 0x10000, v13
    ds_read_b64_tr_b16 v[104:105], v13
    ds_read_b64_tr_b16 v[106:107], v13 offset:1024
    ds_read_b64_tr_b16 v[108:109], v13 offset:16384
    ds_read_b64_tr_b16 v[110:111], v13 offset:17408
    v_xor_b32 v13, 0x20, v11
    v_add_u32 v13, 0x10000, v13
    ds_read_b64_tr_b16 v[32:33], v13
    ds_read_b64_tr_b16 v[34:35], v13 offset:1024
    ds_read_b64_tr_b16 v[36:37], v13 offset:16384
    ds_read_b64_tr_b16 v[38:39], v13 offset:17408
    v_xor_b32 v13, 0x1000, v11
    v_add_u32 v13, 0x10000, v13
    ds_read_b64_tr_b16 a[112:113], v13
    ds_read_b64_tr_b16 a[114:115], v13 offset:1024
    ds_read_b64_tr_b16 a[116:117], v13 offset:16384
    ds_read_b64_tr_b16 a[118:119], v13 offset:17408
    v_xor_b32 v13, 0x1020, v11
    v_add_u32 v13, 0x10000, v13
    ds_read_b64_tr_b16 a[120:121], v13
    ds_read_b64_tr_b16 a[122:123], v13 offset:1024
    ds_read_b64_tr_b16 a[124:125], v13 offset:16384
    ds_read_b64_tr_b16 a[126:127], v13 offset:17408
    s_waitcnt lgkmcnt(0)
    s_barrier
    s_add_u32 s43, s41, 0x200000
    s_add_u32 m0, s51, 0xc000
    s_nop 0
    buffer_load_dwordx4 v15, s[12:15], s43 offen lds
    s_add_u32 s43, s41, 0x208000
    s_add_u32 m0, s51, 0xd000
    s_nop 0
    buffer_load_dwordx4 v15, s[12:15], s43 offen lds
    s_add_u32 s43, s41, 0x300000
    s_add_u32 m0, s51, 0xe000
    s_nop 0
    buffer_load_dwordx4 v15, s[12:15], s43 offen lds
    s_add_u32 s43, s41, 0x308000
    s_add_u32 m0, s51, 0xf000
    s_nop 0
    buffer_load_dwordx4 v15, s[12:15], s43 offen lds
    v_xor_b32 v15, 2, v14
    v_lshl_add_u32 v15, v15, 15, v8
    s_add_u32 s43, s41, 0x0
    s_add_u32 m0, s51, 0x10000
    s_nop 0
    buffer_load_dwordx4 v15, s[12:15], s43 offen lds
    s_add_u32 s43, s41, 0x8000
    s_add_u32 m0, s51, 0x11000
    s_nop 0
    buffer_load_dwordx4 v15, s[12:15], s43 offen lds
    s_add_u32 s43, s41, 0x100000
    s_add_u32 m0, s51, 0x12000
    s_nop 0
    buffer_load_dwordx4 v15, s[12:15], s43 offen lds
    s_add_u32 s43, s41, 0x108000
    s_add_u32 m0, s51, 0x13000
    s_nop 0
    buffer_load_dwordx4 v15, s[12:15], s43 offen lds
    s_waitcnt vmcnt(12)
    s_barrier
    v_xor_b32 v13, 0x0, v11
    v_add_u32 v13, 0x18000, v13
    ds_read_b64_tr_b16 a[144:145], v13
    ds_read_b64_tr_b16 a[146:147], v13 offset:1024
    ds_read_b64_tr_b16 a[148:149], v13 offset:16384
    ds_read_b64_tr_b16 a[150:151], v13 offset:17408
    v_xor_b32 v13, 0x20, v11
    v_add_u32 v13, 0x18000, v13
    ds_read_b64_tr_b16 a[152:153], v13
    ds_read_b64_tr_b16 a[154:155], v13 offset:1024
    ds_read_b64_tr_b16 a[156:157], v13 offset:16384
    ds_read_b64_tr_b16 a[158:159], v13 offset:17408
    v_xor_b32 v13, 0x1000, v11
    v_add_u32 v13, 0x18000, v13
    ds_read_b64_tr_b16 a[176:177], v13
    ds_read_b64_tr_b16 a[178:179], v13 offset:1024
    ds_read_b64_tr_b16 a[180:181], v13 offset:16384
    ds_read_b64_tr_b16 a[182:183], v13 offset:17408
    v_xor_b32 v13, 0x1020, v11
    v_add_u32 v13, 0x18000, v13
    ds_read_b64_tr_b16 a[184:185], v13
    ds_read_b64_tr_b16 a[186:187], v13 offset:1024
    ds_read_b64_tr_b16 a[188:189], v13 offset:16384
    ds_read_b64_tr_b16 a[190:191], v13 offset:17408
    s_waitcnt lgkmcnt(0)
    s_barrier
    s_add_u32 s43, s41, 0x200000
    s_add_u32 m0, s51, 0x14000
    s_nop 0
    buffer_load_dwordx4 v15, s[12:15], s43 offen lds
    s_add_u32 s43, s41, 0x208000
    s_add_u32 m0, s51, 0x15000
    s_nop 0
    buffer_load_dwordx4 v15, s[12:15], s43 offen lds
    s_add_u32 s43, s41, 0x300000
    s_add_u32 m0, s51, 0x16000
    s_nop 0
    buffer_load_dwordx4 v15, s[12:15], s43 offen lds
    s_add_u32 s43, s41, 0x308000
    s_add_u32 m0, s51, 0x17000
    s_nop 0
    buffer_load_dwordx4 v15, s[12:15], s43 offen lds
    s_mov_b32 s12, s66
    s_and_b32 s13, s67, 0xffff
    s_add_u32 s43, s42, 0x80
    s_add_u32 m0, s51, 0x18000
    s_nop 0
    buffer_load_dwordx4 v10, s[12:15], s43 offen lds
    s_add_u32 s43, s42, 0x4080
    s_add_u32 m0, s51, 0x19000
    s_nop 0
    buffer_load_dwordx4 v9, s[12:15], s43 offen lds
    s_add_u32 s43, s42, 0x8080
    s_add_u32 m0, s51, 0x1a000
    s_nop 0
    buffer_load_dwordx4 v10, s[12:15], s43 offen lds
    s_add_u32 s43, s42, 0xc080
    s_add_u32 m0, s51, 0x1b000
    s_nop 0
    buffer_load_dwordx4 v9, s[12:15], s43 offen lds
    s_waitcnt vmcnt(12)
    s_barrier
    v_xor_b32 v13, 0x0, v11
    v_add_u32 v13, 0x0, v13
    ds_read_b64_tr_b16 a[192:193], v13
    ds_read_b64_tr_b16 a[194:195], v13 offset:1024
    ds_read_b64_tr_b16 a[196:197], v13 offset:16384
    ds_read_b64_tr_b16 a[198:199], v13 offset:17408
    v_xor_b32 v13, 0x20, v11
    v_add_u32 v13, 0x0, v13
    ds_read_b64_tr_b16 a[200:201], v13
    ds_read_b64_tr_b16 a[202:203], v13 offset:1024
    ds_read_b64_tr_b16 a[204:205], v13 offset:16384
    ds_read_b64_tr_b16 a[206:207], v13 offset:17408
    v_xor_b32 v13, 0x1000, v11
    v_add_u32 v13, 0x0, v13
    ds_read_b64_tr_b16 a[224:225], v13
    ds_read_b64_tr_b16 a[226:227], v13 offset:1024
    ds_read_b64_tr_b16 a[228:229], v13 offset:16384
    ds_read_b64_tr_b16 a[230:231], v13 offset:17408
    v_xor_b32 v13, 0x1020, v11
    v_add_u32 v13, 0x0, v13
    ds_read_b64_tr_b16 a[232:233], v13
    ds_read_b64_tr_b16 a[234:235], v13 offset:1024
    ds_read_b64_tr_b16 a[236:237], v13 offset:16384
    ds_read_b64_tr_b16 a[238:239], v13 offset:17408
    s_waitcnt lgkmcnt(0)
    s_barrier
    s_add_u32 s43, s42, 0x10280
    s_add_u32 m0, s51, 0x1c000
    s_nop 0
    buffer_load_dwordx4 v10, s[12:15], s43 offen lds
    s_add_u32 s43, s42, 0x14280
    s_add_u32 m0, s51, 0x1d000
    s_nop 0
    buffer_load_dwordx4 v9, s[12:15], s43 offen lds
    s_add_u32 s43, s42, 0x18280
    s_add_u32 m0, s51, 0x1e000
    s_nop 0
    buffer_load_dwordx4 v10, s[12:15], s43 offen lds
    s_add_u32 s43, s42, 0x1c280
    s_add_u32 m0, s51, 0x1f000
    s_nop 0
    buffer_load_dwordx4 v9, s[12:15], s43 offen lds
    s_add_u32 s43, s42, 0x10080
    s_add_u32 m0, s51, 0x20000
    s_nop 0
    buffer_load_dwordx4 v10, s[12:15], s43 offen lds
    s_add_u32 s43, s42, 0x14080
    s_add_u32 m0, s51, 0x21000
    s_nop 0
    buffer_load_dwordx4 v9, s[12:15], s43 offen lds
    s_add_u32 s43, s42, 0x18080
    s_add_u32 m0, s51, 0x22000
    s_nop 0
    buffer_load_dwordx4 v10, s[12:15], s43 offen lds
    s_add_u32 s43, s42, 0x1c080
    s_add_u32 m0, s51, 0x23000
    s_nop 0
    buffer_load_dwordx4 v9, s[12:15], s43 offen lds
    s_waitcnt vmcnt(12)
    v_readfirstlane_b32 s57, v26
    v_readfirstlane_b32 s43, v27
    s_nop 0
    s_cmp_lg_u32 s43, 0
    s_cselect_b32 s57, s57, 0
    s_barrier
    s_cmp_lg_u32 s21, 0
    s_cbranch_scc1 L_arr_4
    v_mov_b32 v23, 1
    s_mov_b64 exec, 1
    buffer_atomic_add v23, off, s[16:19], 0 offset:4
    s_mov_b64 exec, -1
L_arr_4:
    v_xor_b32 v13, 0x0, v11
    v_add_u32 v13, 0x8000, v13
    ds_read_b64_tr_b16 v[128:129], v13
    ds_read_b64_tr_b16 v[130:131], v13 offset:1024
    ds_read_b64_tr_b16 v[132:133], v13 offset:16384
    ds_read_b64_tr_b16 v[134:135], v13 offset:17408
    v_xor_b32 v13, 0x20, v11
    v_add_u32 v13, 0x8000, v13
    ds_read_b64_tr_b16 v[136:137], v13
    ds_read_b64_tr_b16 v[138:139], v13 offset:1024
    ds_read_b64_tr_b16 v[140:141], v13 offset:16384
    ds_read_b64_tr_b16 v[142:143], v13 offset:17408
    v_xor_b32 v13, 0x1000, v11
    v_add_u32 v13, 0x8000, v13
    ds_read_b64_tr_b16 v[160:161], v13
    ds_read_b64_tr_b16 v[162:163], v13 offset:1024
    ds_read_b64_tr_b16 v[164:165], v13 offset:16384
    ds_read_b64_tr_b16 v[166:167], v13 offset:17408
    v_xor_b32 v13, 0x1020, v11
    v_add_u32 v13, 0x8000, v13
    ds_read_b64_tr_b16 v[168:169], v13
    ds_read_b64_tr_b16 v[170:171], v13 offset:1024
    ds_read_b64_tr_b16 v[172:173], v13 offset:16384
    ds_read_b64_tr_b16 v[174:175], v13 offset:17408
    s_waitcnt lgkmcnt(0)
    s_barrier
    s_add_u32 s43, s42, 0x280
    s_add_u32 m0, s51, 0x24000
    s_nop 0
    buffer_load_dwordx4 v10, s[12:15], s43 offen lds
    s_add_u32 s43, s42, 0x4280
    s_add_u32 m0, s51, 0x25000
    s_nop 0
    buffer_load_dwordx4 v9, s[12:15], s43 offen lds
    s_add_u32 s43, s42, 0x8280
    s_add_u32 m0, s51, 0x26000
    s_nop 0
    buffer_load_dwordx4 v10, s[12:15], s43 offen lds
    s_add_u32 s43, s42, 0xc280
    s_add_u32 m0, s51, 0x27000
    s_nop 0
    buffer_load_dwordx4 v9, s[12:15], s43 offen lds
    s_mov_b32 s12, s64
    s_and_b32 s13, s65, 0xffff
    v_xor_b32 v15, 0, v14
    v_lshl_add_u32 v15, v15, 15, v8
    s_add_u32 s43, s41, 0x80000
    s_add_u32 m0, s51, 0x8000
    s_nop 0
    buffer_load_dwordx4 v15, s[12:15], s43 offen lds
    s_add_u32 s43, s41, 0x88000
    s_add_u32 m0, s51, 0x9000
    s_nop 0
    buffer_load_dwordx4 v15, s[12:15], s43 offen lds
    s_add_u32 s43, s41, 0x180000
    s_add_u32 m0, s51, 0xa000
    s_nop 0
    buffer_load_dwordx4 v15, s[12:15], s43 offen lds
    s_add_u32 s43, s41, 0x188000
    s_add_u32 m0, s51, 0xb000
    s_nop 0
    buffer_load_dwordx4 v15, s[12:15], s43 offen lds
    s_waitcnt vmcnt(12)
    s_barrier
    v_xor_b32 v13, 0x0, v12
    v_add_u32 v13, 0x10000, v13
    ds_read_b64_tr_b16 v[192:193], v13
    ds_read_b64_tr_b16 v[194:195], v13 offset:512
    ds_read_b64_tr_b16 v[196:197], v13 offset:2048
    ds_read_b64_tr_b16 v[198:199], v13 offset:2560
    v_xor_b32 v13, 0x2000, v12
    v_add_u32 v13, 0x10000, v13
    ds_read_b64_tr_b16 v[200:201], v13
    ds_read_b64_tr_b16 v[202:203], v13 offset:512
    ds_read_b64_tr_b16 v[204:205], v13 offset:2048
    ds_read_b64_tr_b16 v[206:207], v13 offset:2560
    v_xor_b32 v13, 0x40, v12
    v_add_u32 v13, 0x10000, v13
    ds_read_b64_tr_b16 v[224:225], v13
    ds_read_b64_tr_b16 v[226:227], v13 offset:512
    ds_read_b64_tr_b16 v[228:229], v13 offset:2048
    ds_read_b64_tr_b16 v[230:231], v13 offset:2560
    v_xor_b32 v13, 0x2040, v12
    v_add_u32 v13, 0x10000, v13
    ds_read_b64_tr_b16 v[232:233], v13
    ds_read_b64_tr_b16 v[234:235], v13 offset:512
    ds_read_b64_tr_b16 v[236:237], v13 offset:2048
    ds_read_b64_tr_b16 v[238:239], v13 offset:2560
    s_waitcnt lgkmcnt(0)
    s_barrier
    s_add_u32 s43, s41, 0x280000
    s_add_u32 m0, s51, 0xc000
    s_nop 0
    buffer_load_dwordx4 v15, s[12:15], s43 offen lds
    s_add_u32 s43, s41, 0x288000
    s_add_u32 m0, s51, 0xd000
    s_nop 0
    buffer_load_dwordx4 v15, s[12:15], s43 offen lds
    s_add_u32 s43, s41, 0x380000
    s_add_u32 m0, s51, 0xe000
    s_nop 0
    buffer_load_dwordx4 v15, s[12:15], s43 offen lds
    s_add_u32 s43, s41, 0x388000
    s_add_u32 m0, s51, 0xf000
    s_nop 0
    buffer_load_dwordx4 v15, s[12:15], s43 offen lds
    v_xor_b32 v15, 2, v14
    v_lshl_add_u32 v15, v15, 15, v8
    s_add_u32 s43, s41, 0x80000
    s_add_u32 m0, s51, 0x10000
    s_nop 0
    buffer_load_dwordx4 v15, s[12:15], s43 offen lds
    s_add_u32 s43, s41, 0x88000
    s_add_u32 m0, s51, 0x11000
    s_nop 0
    buffer_load_dwordx4 v15, s[12:15], s43 offen lds
    s_add_u32 s43, s41, 0x180000
    s_add_u32 m0, s51, 0x12000
    s_nop 0
    buffer_load_dwordx4 v15, s[12:15], s43 offen lds
    s_add_u32 s43, s41, 0x188000
    s_add_u32 m0, s51, 0x13000
    s_nop 0
    buffer_load_dwordx4 v15, s[12:15], s43 offen lds
    s_waitcnt vmcnt(12)
    s_barrier
    v_xor_b32 v13, 0x0, v12
    v_add_u32 v13, 0x18000, v13
    ds_read_b64_tr_b16 v[208:209], v13
    ds_read_b64_tr_b16 v[210:211], v13 offset:512
    ds_read_b64_tr_b16 v[212:213], v13 offset:2048
    ds_read_b64_tr_b16 v[214:215], v13 offset:2560
    v_xor_b32 v13, 0x2000, v12
    v_add_u32 v13, 0x18000, v13
    ds_read_b64_tr_b16 v[216:217], v13
    ds_read_b64_tr_b16 v[218:219], v13 offset:512
    ds_read_b64_tr_b16 v[220:221], v13 offset:2048
    ds_read_b64_tr_b16 v[222:223], v13 offset:2560
    v_xor_b32 v13, 0x40, v12
    v_add_u32 v13, 0x18000, v13
    ds_read_b64_tr_b16 v[240:241], v13
    ds_read_b64_tr_b16 v[242:243], v13 offset:512
    ds_read_b64_tr_b16 v[244:245], v13 offset:2048
    ds_read_b64_tr_b16 v[246:247], v13 offset:2560
    v_xor_b32 v13, 0x2040, v12
    v_add_u32 v13, 0x18000, v13
    ds_read_b64_tr_b16 v[248:249], v13
    ds_read_b64_tr_b16 v[250:251], v13 offset:512
    ds_read_b64_tr_b16 v[252:253], v13 offset:2048
    ds_read_b64_tr_b16 v[254:255], v13 offset:2560
    s_waitcnt lgkmcnt(0)
    s_barrier
    s_add_u32 s43, s41, 0x280000
    s_add_u32 m0, s51, 0x14000
    s_nop 0
    buffer_load_dwordx4 v15, s[12:15], s43 offen lds
    s_add_u32 s43, s41, 0x288000
    s_add_u32 m0, s51, 0x15000
    s_nop 0
    buffer_load_dwordx4 v15, s[12:15], s43 offen lds
    s_add_u32 s43, s41, 0x380000
    s_add_u32 m0, s51, 0x16000
    s_nop 0
    buffer_load_dwordx4 v15, s[12:15], s43 offen lds
    s_add_u32 s43, s41, 0x388000
    s_add_u32 m0, s51, 0x17000
    s_nop 0
    buffer_load_dwordx4 v15, s[12:15], s43 offen lds
    ds_write_b128 v124, v[192:195]
    ds_write_b128 v124, v[196:199] offset:1024
    ds_write_b128 v124, v[200:203] offset:2048
    ds_write_b128 v124, v[204:207] offset:3072
    ds_write_b128 v124, v[208:211] offset:4096
    ds_write_b128 v124, v[212:215] offset:5120
    ds_write_b128 v124, v[216:219] offset:6144
    ds_write_b128 v124, v[220:223] offset:7168
    ds_write_b128 v124, v[224:227] offset:32768
    ds_write_b128 v124, v[228:231] offset:33792
    ds_write_b128 v124, v[232:235] offset:34816
    ds_write_b128 v124, v[236:239] offset:35840
    ds_write_b128 v124, v[240:243] offset:36864
    ds_write_b128 v124, v[244:247] offset:37888
    ds_write_b128 v124, v[248:251] offset:38912
    ds_write_b128 v124, v[252:255] offset:39936
    s_waitcnt vmcnt(8)
    s_barrier
    v_xor_b32 v13, 0x0, v11
    v_add_u32 v13, 0x0, v13
    ds_read_b64_tr_b16 a[208:209], v13
    ds_read_b64_tr_b16 a[210:211], v13 offset:1024
    ds_read_b64_tr_b16 a[212:213], v13 offset:16384
    ds_read_b64_tr_b16 a[214:215], v13 offset:17408
    v_xor_b32 v13, 0x20, v11
    v_add_u32 v13, 0x0, v13
    ds_read_b64_tr_b16 a[216:217], v13
    ds_read_b64_tr_b16 a[218:219], v13 offset:1024
    ds_read_b64_tr_b16 a[220:221], v13 offset:16384
    ds_read_b64_tr_b16 a[222:223], v13 offset:17408
    v_xor_b32 v13, 0x1000, v11
    v_add_u32 v13, 0x0, v13
    ds_read_b64_tr_b16 a[240:241], v13
    ds_read_b64_tr_b16 a[242:243], v13 offset:1024
    ds_read_b64_tr_b16 a[244:245], v13 offset:16384
    ds_read_b64_tr_b16 a[246:247], v13 offset:17408
    v_xor_b32 v13, 0x1020, v11
    v_add_u32 v13, 0x0, v13
    ds_read_b64_tr_b16 a[248:249], v13
    ds_read_b64_tr_b16 a[250:251], v13 offset:1024
    ds_read_b64_tr_b16 a[252:253], v13 offset:16384
    ds_read_b64_tr_b16 a[254:255], v13 offset:17408
    s_waitcnt lgkmcnt(0)
    s_barrier
    s_mov_b32 s43, 0x10000
    buffer_load_dword v30, v7, s[8:11], s43 offen sc1
    s_cmp_lg_u32 s20, 28
    s_cbranch_scc1 L_nocc_5
    v_lshlrev_b32 v25, 2, v117
    s_lshl_b32 s43, s21, 12
    s_getpc_b64 s[4:5]
L_pc_6:
    s_add_u32 s4, s4, L_nocc_5-L_pc_6
    s_addc_u32 s5, s5, 0
    v_add_u32 v25, s43, v25
    v_min_u32 v25, L_code_end-L_nocc_5-4, v25
    global_load_dword v29, v25, s[4:5]
L_nocc_5:
L_chain_warm:
    s_mov_b32 s12, s66
    s_and_b32 s13, s67, 0xffff
    s_add_u32 s43, s42, 0x0
    s_add_u32 m0, s51, 0x8000
    s_nop 0
    buffer_load_dwordx4 v10, s[12:15], s43 offen lds
    s_add_u32 s43, s42, 0x4000
    s_add_u32 m0, s51, 0x9000
    s_nop 0
    buffer_load_dwordx4 v9, s[12:15], s43 offen lds
    s_add_u32 s43, s42, 0x8000
    s_add_u32 m0, s51, 0xa000
    s_nop 0
    buffer_load_dwordx4 v10, s[12:15], s43 offen lds
    s_add_u32 s43, s42, 0xc000
    s_add_u32 m0, s51, 0xb000
    s_nop 0
    buffer_load_dwordx4 v9, s[12:15], s43 offen lds
    s_add_u32 s43, s42, 0x10200
    s_add_u32 m0, s51, 0xc000
    s_nop 0
    buffer_load_dwordx4 v10, s[12:15], s43 offen lds
    s_add_u32 s43, s42, 0x14200
    s_add_u32 m0, s51, 0xd000
    s_nop 0
    buffer_load_dwordx4 v9, s[12:15], s43 offen lds
    s_add_u32 s43, s42, 0x18200
    s_add_u32 m0, s51, 0xe000
    s_nop 0
    buffer_load_dwordx4 v10, s[12:15], s43 offen lds
    s_add_u32 s43, s42, 0x1c200
    s_add_u32 m0, s51, 0xf000
    s_nop 0
    buffer_load_dwordx4 v9, s[12:15], s43 offen lds
    s_waitcnt vmcnt(9)
    s_barrier
    v_xor_b32 v13, 0x0, v11
    v_add_u32 v13, 0x8000, v13
    ds_read_b64_tr_b16 v[144:145], v13
    ds_read_b64_tr_b16 v[146:147], v13 offset:1024
    ds_read_b64_tr_b16 v[148:149], v13 offset:16384
    ds_read_b64_tr_b16 v[150:151], v13 offset:17408
    v_xor_b32 v13, 0x20, v11
    v_add_u32 v13, 0x8000, v13
    ds_read_b64_tr_b16 v[152:153], v13
    ds_read_b64_tr_b16 v[154:155], v13 offset:1024
    ds_read_b64_tr_b16 v[156:157], v13 offset:16384
    ds_read_b64_tr_b16 v[158:159], v13 offset:17408
    v_xor_b32 v13, 0x1000, v11
    v_add_u32 v13, 0x8000, v13
    ds_read_b64_tr_b16 v[176:177], v13
    ds_read_b64_tr_b16 v[178:179], v13 offset:1024
    ds_read_b64_tr_b16 v[180:181], v13 offset:16384
    ds_read_b64_tr_b16 v[182:183], v13 offset:17408
    v_xor_b32 v13, 0x1020, v11
    v_add_u32 v13, 0x8000, v13
    ds_read_b64_tr_b16 v[184:185], v13
    ds_read_b64_tr_b16 v[186:187], v13 offset:1024
    ds_read_b64_tr_b16 v[188:189], v13 offset:16384
    ds_read_b64_tr_b16 v[190:191], v13 offset:17408
    s_waitcnt lgkmcnt(0)
    s_barrier
    s_add_u32 s43, s42, 0x10000
    s_add_u32 m0, s51, 0x10000
    s_nop 0
    buffer_load_dwordx4 v10, s[12:15], s43 offen lds
    s_add_u32 s43, s42, 0x14000
    s_add_u32 m0, s51, 0x11000
    s_nop 0
    buffer_load_dwordx4 v9, s[12:15], s43 offen lds
    s_add_u32 s43, s42, 0x18000
    s_add_u32 m0, s51, 0x12000
    s_nop 0
    buffer_load_dwordx4 v10, s[12:15], s43 offen lds
    s_add_u32 s43, s42, 0x1c000
    s_add_u32 m0, s51, 0x13000
    s_nop 0
    buffer_load_dwordx4 v9, s[12:15], s43 offen lds
    s_add_u32 s43, s42, 0x200
    s_add_u32 m0, s51, 0x14000
    s_nop 0
    buffer_load_dwordx4 v10, s[12:15], s43 offen lds
    s_add_u32 s43, s42, 0x4200
    s_add_u32 m0, s51, 0x15000
    s_nop 0
    buffer_load_dwordx4 v9, s[12:15], s43 offen lds
    s_add_u32 s43, s42, 0x8200
    s_add_u32 m0, s51, 0x16000
    s_nop 0
    buffer_load_dwordx4 v10, s[12:15], s43 offen lds
    s_add_u32 s43, s42, 0xc200
    s_add_u32 m0, s51, 0x17000
    s_nop 0
    buffer_load_dwordx4 v9, s[12:15], s43 offen lds
    v_lshlrev_b32 v26, 3, v117
    v_and_b32 v26, 2048, v26
    s_lshl_b32 s43, s20, 6
    s_add_u32 s43, s43, 0x2000
    buffer_load_dword v26, v26, s[8:11], s43 offen sc1
    buffer_load_dword v27, off, s[16:19], 0 offset:4 sc1
    s_waitcnt vmcnt(10)
    v_min_u32 v21, 0xfffffffe, v21
    s_mov_b32 s43, 0x10000
    s_mov_b64 exec, s[38:39]
    buffer_store_dword v21, v119, s[8:11], s43 offen
    s_mov_b64 exec, -1
    v_mov_b32 v16, -1
    v_mov_b32 v17, -1
    v_mov_b32 v18, -1
    v_mov_b32 v19, -1
    s_lshl_b32 s43, s20, 13
    s_add_u32 s43, s43, 0x100000
    s_and_b32 s40, s21, 1
    s_lshl_b32 s40, s40, 12
    s_add_u32 s29, s43, s40
    s_add_u32 s43, s43, s52
    s_xor_b32 s40, s43, 0x0
    s_mov_b32 s43, 0x12000
    buffer_store_dword v16, v119, s[8:11], s43 offen
    s_mov_b32 s43, 0x14000
    buffer_store_dword v16, v119, s[8:11], s43 offen
    s_mov_b32 s43, 0x16000
    buffer_store_dword v16, v119, s[8:11], s43 offen
    s_barrier
    v_xor_b32 v13, 0x0, v12
    v_add_u32 v13, 0x0, v13
    ds_read_b64_tr_b16 v[192:193], v13
    ds_read_b64_tr_b16 v[194:195], v13 offset:512
    ds_read_b64_tr_b16 v[196:197], v13 offset:2048
    ds_read_b64_tr_b16 v[198:199], v13 offset:2560
    v_xor_b32 v13, 0x2000, v12
    v_add_u32 v13, 0x0, v13
    ds_read_b64_tr_b16 v[200:201], v13
    ds_read_b64_tr_b16 v[202:203], v13 offset:512
    ds_read_b64_tr_b16 v[204:205], v13 offset:2048
    ds_read_b64_tr_b16 v[206:207], v13 offset:2560
    v_xor_b32 v13, 0x40, v12
    v_add_u32 v13, 0x0, v13
    ds_read_b64_tr_b16 v[224:225], v13
    ds_read_b64_tr_b16 v[226:227], v13 offset:512
    ds_read_b64_tr_b16 v[228:229], v13 offset:2048
    ds_read_b64_tr_b16 v[230:231], v13 offset:2560
    v_xor_b32 v13, 0x2040, v12
    v_add_u32 v13, 0x0, v13
    ds_read_b64_tr_b16 v[232:233], v13
    ds_read_b64_tr_b16 v[234:235], v13 offset:512
    ds_read_b64_tr_b16 v[236:237], v13 offset:2048
    ds_read_b64_tr_b16 v[238:239], v13 offset:2560
    s_lshr_b32 s43, s20, 1
    s_lshl_b32 s43, s43, 7
    s_and_b32 s40, s20, 1
    s_lshl_b32 s40, s40, 4
    s_add_u32 s43, s43, s40
    s_add_u32 s44, s43, 0x1000
    s_cmp_eq_u32 s21, 0
    s_cselect_b32 s44, s44, 0x7ff00000
    s_mov_b32 s22, 0
    s_mov_b32 s33, 0
    s_xor_b32 s53, s29, 1024
    s_add_u32 s23, s51, 0x10000
    s_add_u32 s48, s23, 4096
    s_mov_b32 s24, 0x12000
    s_add_u32 s55, s24, 16384
    s_mov_b32 s25, 0x100000
    s_mov_b32 s26, 0x101000
    v_mov_b32 v112, 0
    v_mov_b32 v113, 0
    v_mov_b32 v114, 0
    v_mov_b32 v115, 0
    ds_write_b128 v117, v[112:115] offset:22528
    ds_write_b128 v117, v[112:115] offset:23552
    s_cmp_lg_u32 s21, 0
    s_cselect_b32 s40, -1, 0
    v_mov_b32 v126, s40
    v_bfe_u32 v1, v117, 4, 1
    v_lshlrev_b32 v1, 4, v1
    s_movk_i32 s43, 0x3f80
    v_lshlrev_b32 v125, v1, s43
    v_bfe_u32 v1, v117, 5, 3
    v_cmp_eq_u32 s[68:69], 0, v1
    v_cmp_eq_u32 s[70:71], 1, v1
    v_cmp_eq_u32 s[72:73], 2, v1
    v_cmp_eq_u32 s[74:75], 3, v1
    v_mov_b32 v40, 0
    v_mov_b32 v41, 0
    v_mov_b32 v42, 0
    v_mov_b32 v43, 0
    v_mov_b32 v44, 0
    v_mov_b32 v45, 0
    v_mov_b32 v46, 0
    v_mov_b32 v47, 0
    v_mov_b32 v48, 0
    v_mov_b32 v49, 0
    v_mov_b32 v50, 0
    v_mov_b32 v51, 0
    v_mov_b32 v52, 0
    v_mov_b32 v53, 0
    v_mov_b32 v54, 0
    v_mov_b32 v55, 0
    s_mov_b32 s45, 0
    s_mov_b32 s46, 0
    s_mov_b32 s47, 0
    s_mov_b32 s76, 0
    s_and_b32 s43, s21, 1
    s_lshl_b32 s43, s43, 5
    s_add_u32 s43, s43, s20
    s_lshl_b32 s43, s43, 6
    s_add_u32 s28, s43, 0x2000
    s_mov_b32 s59, 0
    s_waitcnt vmcnt(4) lgkmcnt(0)
    v_readlane_b32 s43, v26, 0
    v_readlane_b32 s40, v26, 16
    s_nop 0
    s_min_u32 s43, s43, s40
    s_cmp_lg_u32 s43, 0
    s_cselect_b32 s57, s57, 0
    v_readfirstlane_b32 s43, v27
    s_nop 0
    s_cmp_ge_u32 s43, 32
    s_cselect_b32 s57, s57, 0
    s_cmp_lg_u32 s57, 1
    s_cbranch_scc1 L_nokv_7
    s_add_u32 m0, s52, 8192
    s_nop 0
    buffer_load_dwordx4 v117, s[8:11], s30 offen lds
    buffer_load_dwordx4 v117, s[8:11], s30 offen offset:1024 lds
    s_add_u32 m0, s52, 0x6000
    s_nop 0
    buffer_load_dwordx4 v117, s[8:11], s31 offen lds
    buffer_load_dwordx4 v117, s[8:11], s31 offen offset:1024 lds
L_nokv_7:
    s_barrier
    v_xor_b32 v13, 0x0, v12
    v_add_u32 v13, 0x8000, v13
    ds_read_b64_tr_b16 v[208:209], v13
    ds_read_b64_tr_b16 v[210:211], v13 offset:512
    ds_read_b64_tr_b16 v[212:213], v13 offset:2048
    ds_read_b64_tr_b16 v[214:215], v13 offset:2560
    v_xor_b32 v13, 0x2000, v12
    v_add_u32 v13, 0x8000, v13
    ds_read_b64_tr_b16 v[216:217], v13
    ds_read_b64_tr_b16 v[218:219], v13 offset:512
    ds_read_b64_tr_b16 v[220:221], v13 offset:2048
    ds_read_b64_tr_b16 v[222:223], v13 offset:2560
    v_xor_b32 v13, 0x40, v12
    v_add_u32 v13, 0x8000, v13
    ds_read_b64_tr_b16 v[240:241], v13
    ds_read_b64_tr_b16 v[242:243], v13 offset:512
    ds_read_b64_tr_b16 v[244:245], v13 offset:2048
    ds_read_b64_tr_b16 v[246:247], v13 offset:2560
    v_xor_b32 v13, 0x2040, v12
    v_add_u32 v13, 0x8000, v13
    ds_read_b64_tr_b16 v[248:249], v13
    ds_read_b64_tr_b16 v[250:251], v13 offset:512
    ds_read_b64_tr_b16 v[252:253], v13 offset:2048
    ds_read_b64_tr_b16 v[254:255], v13 offset:2560
    ds_write_b128 v123, v[80:83]
    ds_write_b128 v123, v[84:87] offset:1024
    ds_write_b128 v123, v[56:59] offset:2048
    ds_write_b128 v123, v[60:63] offset:3072
    ds_write_b128 v123, v[88:91] offset:4096
    ds_write_b128 v123, v[92:95] offset:5120
    ds_write_b128 v123, v[96:99] offset:6144
    ds_write_b128 v123, v[100:103] offset:7168
    s_cmp_eq_u32 s57, 1
    s_cbranch_scc1 L_started_8
    s_mov_b32 s96, 0
L_mode_9:
    buffer_load_dwordx2 v[2:3], off, s[92:95], 0 offset:36 sc1
    s_waitcnt vmcnt(0)
    v_readfirstlane_b32 s87, v2
    v_readfirstlane_b32 s97, v3
    s_nop 0
    s_min_u32 s97, s97, s87
    s_cmp_lg_u32 s97, 0
    s_cbranch_scc1 L_moded_10
    s_sleep 4
    s_add_u32 s96, s96, 1
    s_cmp_lg_u32 s96, 0x100
    s_cbranch_scc1 L_modef_11
    v_mov_b32 v2, 2
    v_mov_b32 v3, 0
    s_mov_b64 exec, 1
    buffer_atomic_cmpswap v[2:3], off, s[92:95], 0 offset:36
    s_mov_b64 exec, -1
L_modef_11:
    s_cmp_lt_u32 s96, 0x10000
    s_cbranch_scc1 L_mode_9
L_moded_10:
    s_cmp_lg_u32 s87, 1
    s_cbranch_scc1 L_fallback
    v_lshrrev_b32 v1, 4, v117
    v_and_b32 v2, 15, v1
    v_lshrrev_b32 v1, 4, v1
    v_lshlrev_b32 v1, 11, v1
    v_lshl_add_u32 v1, v2, 2, v1
    s_lshl_b32 s43, s20, 6
    s_add_u32 s43, s43, 0x2000
    s_mov_b32 exec_lo, 0x10001
    s_mov_b32 exec_hi, 0
    s_mov_b32 s96, 0
L_poll_12:
    buffer_load_dword v2, v1, s[8:11], s43 offen sc1
    s_waitcnt vmcnt(0)
    v_cmp_gt_u32 vcc, 1, v2
    s_cbranch_vccz L_polld_13
    s_sleep 8
    s_add_u32 s96, s96, 1
    s_cmp_lt_u32 s96, 0x10000
    s_cbranch_scc1 L_poll_12
L_polld_13:
    s_mov_b64 exec, -1
    s_add_u32 m0, s52, 8192
    s_nop 0
    buffer_load_dwordx4 v117, s[8:11], s30 offen lds
    buffer_load_dwordx4 v117, s[8:11], s30 offen offset:1024 lds
    s_add_u32 m0, s52, 0x6000
    s_nop 0
    buffer_load_dwordx4 v117, s[8:11], s31 offen lds
    buffer_load_dwordx4 v117, s[8:11], s31 offen offset:1024 lds
    s_mov_b32 s49, 0
L_cb_poll_15:
    buffer_load_dword v3, off, s[16:19], 0 offset:4 sc1
    s_waitcnt vmcnt(0)
    v_readfirstlane_b32 s43, v3
    s_nop 0
    s_cmp_ge_u32 s43, 32
    s_cbranch_scc1 L_started_8
    s_sleep 8
    s_add_u32 s49, s49, 1
    s_cmp_lt_u32 s49, 0x40000
    s_cbranch_scc1 L_cb_poll_15
L_started_8:
    v_lshrrev_b32 v1, 2, v117
    s_cmp_lt_u32 s21, 2
    s_cselect_b64 vcc, -1, 0
    v_cndmask_b32 v119, v119, v1, vcc
    s_add_u32 m0, s51, 4096
    v_mov_b32 v24, v32
    v_mov_b32 v25, v33
    v_mov_b32 v26, v34
    v_mov_b32 v27, v35
    v_mov_b32 v28, v36
    v_mov_b32 v29, v37
    v_mov_b32 v30, v38
    v_mov_b32 v31, v39
    s_add_u32 s30, s30, 0x40000
    s_add_u32 s31, s31, 0x40000
    s_mov_b32 s49, 0
    s_waitcnt vmcnt(0) lgkmcnt(0)
    s_barrier
    ds_write_b128 v123, v[64:67] offset:32768
    ds_write_b128 v123, v[68:71] offset:33792
    ds_write_b128 v123, v[72:75] offset:34816
    ds_write_b128 v123, v[76:79] offset:35840
    ds_write_b128 v123, v[104:107] offset:36864
    ds_write_b128 v123, v[108:111] offset:37888
    ds_write_b128 v123, v[32:35] offset:38912
    ds_write_b128 v123, v[36:39] offset:39936
    v_mov_b32 v32, 0
    v_mov_b32 v33, 0
    v_mov_b32 v34, 0
    v_mov_b32 v35, 0
    v_mov_b32 v36, 0
    v_mov_b32 v37, 0
    v_mov_b32 v38, 0
    v_mov_b32 v39, 0
    s_nop 4
    s_cmp_eq_u32 s21, 1
    s_cbranch_scc1 L_chain_top1_f
    s_cmp_eq_u32 s21, 2
    s_cbranch_scc1 L_chain_top2_f
    s_cmp_eq_u32 s21, 3
    s_cbranch_scc1 L_chain_top3_f
.p2align 6
L_chain_top0_f:
    buffer_load_dwordx4 v[0:3], v117, s[8:11], s23 offen nt
    v_mov_b32 v15, 0
    v_mov_b32 v15, 0
    v_mov_b32 v15, 0
    v_mov_b32 v15, 0
    v_mov_b32 v15, 0
    v_mov_b32 v15, 0
    v_mov_b32 v15, 0
    v_mov_b32 v15, 0
    v_mov_b32 v15, 0
    v_mov_b32 v15, 0
    v_mov_b32 v15, 0
    v_mov_b32 v15, 0
    v_mov_b32 v15, 0
    v_mov_b32 v15, 0
    v_mov_b32 v15, 0
    v_mov_b32 v15, 0
    buffer_load_dwordx4 v[0:3], v117, s[8:11], s23 offen sc1
    v_mov_b32 v15, 0
    v_mov_b32 v15, 0
    v_mov_b32 v15, 0
    v_mov_b32 v15, 0
    v_mov_b32 v15, 0
    v_mov_b32 v15, 0
    v_mov_b32 v15, 0
    v_mov_b32 v15, 0
    v_mov_b32 v15, 0
    v_mov_b32 v15, 0
    v_mov_b32 v15, 0
    v_mov_b32 v15, 0
    v_mov_b32 v15, 0
    v_mov_b32 v15, 0
    v_mov_b32 v15, 0
    v_mov_b32 v15, 0
L_mret_17:
    buffer_load_dwordx4 v[0:3], v117, s[8:11], s23 offen sc1
    s_add_u32 s45, s45, 1
    s_cmp_lt_u32 s45, 0x10000
    s_cselect_b32 s56, -2, -1
    s_nop 3
    v_mov_b32 v32, 0
    v_mov_b32 v33, 0
    v_mov_b32 v34, 0
    v_mov_b32 v35, 0
    s_waitcnt vmcnt(2)
    v_max3_u32 v15, v0, v1, v2
    v_max_u32 v15, v15, v3
    v_cmp_lt_u32 vcc, s56, v15
    v_smfmac_f32_16x16x64_bf16 v[32:35], v[0:3], v[80:87], v116
    s_cbranch_vccnz L_mret_17
    ds_write_b128 v117, v[0:3]
    v_smfmac_f32_16x16x64_bf16 v[36:39], v[0:3], v[56:63], v116
    buffer_load_dwordx4 v[4:7], v117, s[8:11], s48 offen nt
    v_smfmac_f32_16x16x64_bf16 v[40:43], v[0:3], v[64:71], v116
    buffer_load_dwordx4 v117, s[8:11], s48 offen nt lds
    s_mov_b32 m0, 8192
    v_smfmac_f32_16x16x64_bf16 v[44:47], v[0:3], v[72:79], v116
    s_waitcnt lgkmcnt(0)
    s_barrier
    ds_read_b128 v[8:11], v117 offset:1024
    v_smfmac_f32_16x16x64_bf16 v[48:51], v[0:3], a[192:199], v116
    ds_read_b128 v[16:19], v117 offset:2048
    ds_read_b128 v[20:23], v117 offset:3072
    v_smfmac_f32_16x16x64_bf16 v[52:55], v[0:3], a[200:207], v116
    ds_read_b128 v[80:83], v117 offset:14336
    s_waitcnt lgkmcnt(3)
    v_smfmac_f32_16x16x64_bf16 v[32:35], v[8:11], a[0:7], v116
    ds_read_b128 v[84:87], v117 offset:15360
    v_smfmac_f32_16x16x64_bf16 v[36:39], v[8:11], a[8:15], v116
    buffer_store_dwordx4 v[112:115], v117, s[8:11], s32 offen sc1
    s_waitcnt lgkmcnt(3)
    v_smfmac_f32_16x16x64_bf16 v[32:35], v[16:19], a[32:39], v116
    ds_read_b128 v[56:59], v117 offset:8192
    v_smfmac_f32_16x16x64_bf16 v[36:39], v[16:19], a[40:47], v116
    ds_read_b128 v[60:63], v117 offset:9216
    s_waitcnt lgkmcnt(4)
    v_smfmac_f32_16x16x64_bf16 v[32:35], v[20:23], a[64:71], v116
    ds_read_b128 v[64:67], v117 offset:10240
    v_smfmac_f32_16x16x64_bf16 v[36:39], v[20:23], a[72:79], v116
    ds_read_b128 v[68:71], v117 offset:11264
    v_smfmac_f32_16x16x64_bf16 v[40:43], v[8:11], a[96:103], v116
    ds_read_b128 v[72:75], v117 offset:12288
    v_smfmac_f32_16x16x64_bf16 v[40:43], v[16:19], a[128:135], v116
    ds_read_b128 v[76:79], v117 offset:13312
    v_smfmac_f32_16x16x64_bf16 v[40:43], v[20:23], a[160:167], v116
    s_waitcnt vmcnt(2)
    v_max3_u32 v15, v4, v5, v6
    v_smfmac_f32_16x16x64_bf16 v[44:47], v[8:11], a[104:111], v116
    v_max_u32 v15, v15, v7
    v_smfmac_f32_16x16x64_bf16 v[44:47], v[16:19], a[136:143], v116
    s_waitcnt vmcnt(1) lgkmcnt(0)
    v_cmp_lt_u32 vcc, s56, v15
    v_smfmac_f32_16x16x64_bf16 v[44:47], v[20:23], a[168:175], v116
    s_cbranch_vccnz L_mret_18
L_mgo_19:
    v_smfmac_f32_16x16x64_bf16 v[44:47], v[4:7], v[24:31], v116
    s_barrier
    ds_read_b128 v[12:15], v117 offset:5120
    v_smfmac_f32_16x16x64_bf16 v[32:35], v[4:7], v[88:95], v116
    ds_read_b128 v[24:27], v117 offset:6144
    v_smfmac_f32_16x16x64_bf16 v[36:39], v[4:7], v[96:103], v116
    ds_read_b128 v[28:31], v117 offset:7168
    v_smfmac_f32_16x16x64_bf16 v[40:43], v[4:7], v[104:111], v116
    ds_read_b128 v[88:91], v117 offset:24576
    s_waitcnt lgkmcnt(3)
    v_smfmac_f32_16x16x64_bf16 v[32:35], v[12:15], a[16:23], v116
    ds_read_b128 v[92:95], v117 offset:25600
    s_waitcnt lgkmcnt(3)
    v_smfmac_f32_16x16x64_bf16 v[32:35], v[24:27], a[48:55], v116
    buffer_load_dwordx4 v117, s[8:11], s30 offen lds
    s_waitcnt lgkmcnt(2)
    v_smfmac_f32_16x16x64_bf16 v[32:35], v[28:31], a[80:87], v116
    ds_read_b128 v[96:99], v117 offset:23552
    v_smfmac_f32_16x16x64_bf16 v[36:39], v[12:15], a[24:31], v116
    ds_read_b128 v[100:103], v117 offset:23552
    v_smfmac_f32_16x16x64_bf16 v[36:39], v[24:27], a[56:63], v116
    buffer_load_dwordx4 v117, s[8:11], s30 offen offset:1024 lds
    s_add_u32 m0, s52, 0x6000
    v_add_f32 v32, v32, v34
    v_smfmac_f32_16x16x64_bf16 v[36:39], v[28:31], a[88:95], v116
    ds_read_b128 v[104:107], v117 offset:23552
    v_add_f32 v33, v33, v35
    v_smfmac_f32_16x16x64_bf16 v[40:43], v[12:15], a[112:119], v116
    ds_read_b128 v[108:111], v117 offset:23552
    v_mul_f32 v32, s34, v32
    v_smfmac_f32_16x16x64_bf16 v[40:43], v[24:27], a[144:151], v116
    buffer_load_dword v125, v119, s[8:11], s28 offen sc1
    v_mul_f32 v33, s34, v33
    v_smfmac_f32_16x16x64_bf16 v[40:43], v[28:31], a[176:183], v116
    ds_read_b128 v[0:3], v124
    v_add_f32 v36, v36, v38
    v_smfmac_f32_16x16x64_bf16 v[48:51], v[4:7], a[208:215], v116
    v_add_f32 v37, v37, v39
    v_smfmac_f32_16x16x64_bf16 v[52:55], v[4:7], a[216:223], v116
    s_waitcnt lgkmcnt(5)
    buffer_load_dwordx4 v117, s[8:11], s31 offen lds
    v_mul_f32 v36, s34, v36
    v_smfmac_f32_16x16x64_bf16 v[44:47], v[12:15], a[120:127], v116
    ds_read_b128 v[4:7], v124 offset:1024
    v_mul_f32 v37, s34, v37
    v_smfmac_f32_16x16x64_bf16 v[44:47], v[24:27], a[152:159], v116
    v_cvt_pk_bf16_f32 v34, v32, v36
    v_smfmac_f32_16x16x64_bf16 v[44:47], v[28:31], a[184:191], v116
    buffer_load_dwordx4 v117, s[8:11], s31 offen offset:1024 lds
    s_mov_b32 m0, 4096
    v_cvt_pk_bf16_f32 v35, v33, v37
    v_add_f32 v40, v40, v42
    v_smfmac_f32_16x16x64_bf16 v[48:51], v[8:11], a[224:231], v116
    ds_write2_b32 v120, v34, v35 offset0:32 offset1:48
    v_add_f32 v41, v41, v43
    v_smfmac_f32_16x16x64_bf16 v[52:55], v[8:11], a[232:239], v116
    v_add_f32 v44, v44, v46
    v_add_f32 v45, v45, v47
    v_cvt_pk_bf16_f32 v113, v40, v44
    v_cvt_pk_bf16_f32 v115, v41, v45
    v_smfmac_f32_16x16x64_bf16 v[48:51], v[12:15], a[240:247], v116
    ds_write2_b32 v120, v113, v115 offset0:0 offset1:16
    v_smfmac_f32_16x16x64_bf16 v[52:55], v[12:15], a[248:255], v116
    s_cmp_eq_u32 s22, 63
    s_cbranch_scc1 L_chain_last_f
    buffer_store_dword v126, off, s[8:11], s44 sc1
    v_smfmac_f32_16x16x64_bf16 v[48:51], v[16:19], v[128:135], v116
    v_smfmac_f32_16x16x64_bf16 v[48:51], v[20:23], v[160:167], v116
    v_smfmac_f32_16x16x64_bf16 v[48:51], v[24:27], v[144:151], v116
    s_waitcnt lgkmcnt(0)
    s_barrier
    v_smfmac_f32_16x16x64_bf16 v[48:51], v[28:31], v[176:183], v116
    ds_read_b128 v[32:35], v121 offset:16384
    ds_read_b128 v[36:39], v121 offset:17408
    v_smfmac_f32_16x16x64_bf16 v[52:55], v[16:19], v[136:143], v116
    ds_read_b128 v[40:43], v121 offset:18432
    ds_read_b128 v[44:47], v121 offset:19456
    v_smfmac_f32_16x16x64_bf16 v[52:55], v[20:23], v[168:175], v116
    ds_read_b128 v[8:11], v124 offset:32768
    v_add_f32 v48, v48, v50
    v_smfmac_f32_16x16x64_bf16 v[52:55], v[24:27], v[152:159], v116
    ds_read_b128 v[12:15], v124 offset:33792
    v_add_f32 v49, v49, v51
    v_smfmac_f32_16x16x64_bf16 v[52:55], v[28:31], v[184:191], v116
    s_waitcnt lgkmcnt(5)
    v_cvt_pk_bf16_f32 v112, v48, v49
    v_mfma_f32_16x16x32_bf16 v[56:59], v[56:59], v[32:35], 0
    s_waitcnt lgkmcnt(4)
    v_mov_b32 v48, s50
    v_mov_b32 v49, s50
    v_mfma_f32_16x16x32_bf16 v[56:59], v[60:63], v[36:39], v[56:59]
    ds_read_b128 v[16:19], v124 offset:2048
    s_waitcnt lgkmcnt(4)
    v_mov_b32 v50, s50
    v_mov_b32 v51, s50
    v_mfma_f32_16x16x32_bf16 v[56:59], v[64:67], v[40:43], v[56:59]
    ds_read_b128 v[20:23], v124 offset:3072
    s_waitcnt lgkmcnt(4)
    v_add_f32 v52, v52, v54
    v_mfma_f32_16x16x32_bf16 v[56:59], v[68:71], v[44:47], v[56:59]
    ds_read_b128 v[24:27], v124 offset:4096
    v_add_f32 v53, v53, v55
    v_mfma_f32_16x16x32_bf16 v[60:63], v[72:75], v[32:35], 0
    ds_read_b128 v[28:31], v124 offset:5120
    v_cvt_pk_bf16_f32 v114, v52, v53
    v_mov_b32 v53, 0
    v_mfma_f32_16x16x32_bf16 v[60:63], v[76:79], v[36:39], v[60:63]
    v_exp_f32 v56, v56
    v_mfma_f32_16x16x32_bf16 v[60:63], v[80:83], v[40:43], v[60:63]
    v_exp_f32 v57, v57
    v_mfma_f32_16x16x32_bf16 v[60:63], v[84:87], v[44:47], v[60:63]
    v_exp_f32 v58, v58
    v_mfma_f32_16x16x32_bf16 v[64:67], v[32:35], v[32:35], 0
    v_exp_f32 v59, v59
    v_cvt_pk_bf16_f32 v68, v56, v57
    v_mfma_f32_16x16x32_bf16 v[64:67], v[36:39], v[36:39], v[64:67]
    v_exp_f32 v60, v60
    v_cvt_pk_bf16_f32 v69, v58, v59
    v_mfma_f32_16x16x32_bf16 v[64:67], v[40:43], v[40:43], v[64:67]
    v_exp_f32 v61, v61
    v_mfma_f32_16x16x32_bf16 v[64:67], v[44:47], v[44:47], v[64:67]
    v_exp_f32 v62, v62
    v_exp_f32 v63, v63
    v_cvt_pk_bf16_f32 v70, v60, v61
    v_cvt_pk_bf16_f32 v71, v62, v63
    s_nop 1
    v_mfma_f32_16x16x32_bf16 v[72:75], v[88:91], v[68:71], 0
    s_nop 0
    v_exp_f32 v64, v64
    v_mfma_f32_16x16x32_bf16 v[76:79], v[92:95], v[68:71], 0
    v_exp_f32 v65, v65
    v_mfma_f32_16x16x32_bf16 v[80:83], v[48:51], v[68:71], 0
    v_cvt_pk_bf16_f32 v52, v64, v65
    s_nop 1
    v_mfma_f32_16x16x16_bf16 v[72:75], v[112:113], v[52:53], v[72:75]
    ds_read_b128 v[32:35], v124 offset:6144
    v_mfma_f32_16x16x16_bf16 v[76:79], v[114:115], v[52:53], v[76:79]
    ds_read_b128 v[36:39], v124 offset:7168
    v_mfma_f32_16x16x16_bf16 v[80:83], v[48:49], v[52:53], v[80:83]
L_norm_20:
    s_mov_b64 vcc, s[36:37]
    v_mov_b32 v122, v122
    v_mov_b32 v122, v122
    v_mov_b32 v122, v122
    v_cndmask_b32_dpp v76, v72, v76, vcc quad_perm:[2,3,2,3] row_mask:0xf bank_mask:0xf
    v_cndmask_b32_dpp v77, v73, v77, vcc quad_perm:[2,3,2,3] row_mask:0xf bank_mask:0xf
    v_cndmask_b32_dpp v78, v74, v78, vcc quad_perm:[2,3,2,3] row_mask:0xf bank_mask:0xf
    v_cndmask_b32_dpp v79, v75, v79, vcc quad_perm:[2,3,2,3] row_mask:0xf bank_mask:0xf
    v_rcp_f32_dpp v84, v80 quad_perm:[2,3,2,3] row_mask:0xf bank_mask:0xf
    s_nop 0
    v_pk_mul_f32 v[76:77], v[76:77], v[84:85] op_sel_hi:[1,0]
    v_pk_mul_f32 v[78:79], v[78:79], v[84:85] op_sel_hi:[1,0]
    v_cvt_pk_bf16_f32 v72, v76, v77
    v_cvt_pk_bf16_f32 v73, v78, v79
    ds_write_b64 v122, v[72:73] offset:20480
    v_max_f32_dpp v86, v80, v84 quad_perm:[2,3,2,3] row_mask:0xf bank_mask:0xf
    v_mov_b32_dpp v60, v72 quad_perm:[0,1,0,1] row_mask:0xf bank_mask:0xf
    v_mov_b32_dpp v61, v73 quad_perm:[0,1,0,1] row_mask:0xf bank_mask:0xf
    v_cmp_lt_f32 vcc, s35, v86
    v_mov_b32_dpp v62, v72 quad_perm:[2,3,2,3] row_mask:0xf bank_mask:0xf
    v_mov_b32_dpp v63, v73 quad_perm:[2,3,2,3] row_mask:0xf bank_mask:0xf
    s_nop 1
    v_smfmac_f32_16x16x64_bf16 v[96:99], v[60:63], v[192:199], v116
    s_cbranch_vccnz L_smax_21
    v_smfmac_f32_16x16x64_bf16 v[100:103], v[60:63], v[224:231], v116
    s_waitcnt lgkmcnt(0)
    s_barrier
    ds_read_b128 v[92:95], v127 offset:20992
    ds_read_b128 v[80:83], v127 offset:21504
    ds_read_b128 v[84:87], v127 offset:22016
    v_smfmac_f32_16x16x64_bf16 v[104:107], v[60:63], v[0:7], v116
    ds_read_b128 v[40:43], v124 offset:34816
    v_smfmac_f32_16x16x64_bf16 v[108:111], v[60:63], v[8:15], v116
    ds_read_b128 v[56:59], v124 offset:36864
    s_waitcnt lgkmcnt(4)
    v_smfmac_f32_16x16x64_bf16 v[96:99], v[92:95], v[200:207], v116
    s_waitcnt lgkmcnt(3)
    v_smfmac_f32_16x16x64_bf16 v[96:99], v[80:83], v[208:215], v116
    ds_read_b128 v[44:47], v124 offset:35840
    s_waitcnt lgkmcnt(3)
    v_smfmac_f32_16x16x64_bf16 v[96:99], v[84:87], v[216:223], v116
    ds_read_b128 v[68:71], v124 offset:39936
    v_smfmac_f32_16x16x64_bf16 v[100:103], v[92:95], v[232:239], v116
    ds_read_b128 v[64:67], v124 offset:38912
    v_smfmac_f32_16x16x64_bf16 v[100:103], v[80:83], v[240:247], v116
    ds_read_b128 v[60:63], v124 offset:37888
    v_cvt_pk_bf16_f32 v72, v96, v98
    v_smfmac_f32_16x16x64_bf16 v[100:103], v[84:87], v[248:255], v116
    v_and_or_b32 v72, v72, -2, s33
    v_smfmac_f32_16x16x64_bf16 v[104:107], v[92:95], v[16:23], v116
    v_cvt_pk_bf16_f32 v74, v97, v99
    v_smfmac_f32_16x16x64_bf16 v[104:107], v[80:83], v[24:31], v116
    v_cvt_pk_bf16_f32 v73, v100, v102
    v_cvt_pk_bf16_f32 v75, v101, v103
    v_smfmac_f32_16x16x64_bf16 v[104:107], v[84:87], v[32:39], v116
    buffer_store_dwordx4 v[72:75], v118, s[8:11], s25 offen
    s_waitcnt lgkmcnt(3)
    v_smfmac_f32_16x16x64_bf16 v[108:111], v[92:95], v[40:47], v116
    s_waitcnt lgkmcnt(0)
    v_smfmac_f32_16x16x64_bf16 v[108:111], v[80:83], v[56:63], v116
    v_cvt_pk_bf16_f32 v76, v104, v106
    v_smfmac_f32_16x16x64_bf16 v[108:111], v[84:87], v[64:71], v116
    v_and_or_b32 v76, v76, -2, s33
    v_cvt_pk_bf16_f32 v78, v105, v107
    v_mov_b32 v122, v122
    v_mov_b32 v122, v122
    v_mov_b32 v122, v122
    v_mov_b32 v122, v122
    v_mov_b32 v122, v122
    v_mov_b32 v122, v122
    v_cvt_pk_bf16_f32 v77, v108, v110
    v_cvt_pk_bf16_f32 v79, v109, v111
    buffer_store_dwordx4 v[76:79], v118, s[8:11], s26 offen
    s_add_u32 s30, s30, 0x40000
    s_add_u32 s31, s31, 0x40000
    s_add_u32 s32, s32, 0x20000
    s_add_u32 s23, s24, 0
    s_add_u32 s48, s23, 4096
    s_xor_b32 s25, s25, 0x0
    s_xor_b32 s26, s26, 0x0
    s_mov_b32 s35, 0x49800000
    v_mov_b32 v126, s22
    s_add_u32 s22, s22, 1
    v_mov_b32 v32, 0
    v_mov_b32 v33, 0
    v_mov_b32 v34, 0
    v_mov_b32 v35, 0
    v_mov_b32 v36, 0
    v_mov_b32 v37, 0
    v_mov_b32 v38, 0
    v_mov_b32 v39, 0
    v_mov_b32 v40, 0
    v_mov_b32 v41, 0
    v_mov_b32 v42, 0
    v_mov_b32 v43, 0
    v_mov_b32 v44, 0
    v_mov_b32 v45, 0
    v_mov_b32 v46, 0
    v_mov_b32 v47, 0
    v_mov_b32 v48, 0
    v_mov_b32 v49, 0
    v_mov_b32 v50, 0
    v_mov_b32 v51, 0
    v_mov_b32 v52, 0
    v_mov_b32 v53, 0
    v_mov_b32 v54, 0
    v_mov_b32 v55, 0
    ds_read_b128 v[80:83], v123
    ds_read_b128 v[84:87], v123 offset:1024
    ds_read_b128 v[56:59], v123 offset:2048
    ds_read_b128 v[60:63], v123 offset:3072
    ds_read_b128 v[64:67], v123 offset:32768
    ds_read_b128 v[68:71], v123 offset:33792
    ds_read_b128 v[72:75], v123 offset:34816
    ds_read_b128 v[76:79], v123 offset:35840
    ds_read_b128 v[88:91], v123 offset:4096
    ds_read_b128 v[92:95], v123 offset:5120
    ds_read_b128 v[96:99], v123 offset:6144
    ds_read_b128 v[100:103], v123 offset:7168
    ds_read_b128 v[104:107], v123 offset:36864
    ds_read_b128 v[108:111], v123 offset:37888
    ds_read_b128 v[24:27], v123 offset:38912
    ds_read_b128 v[28:31], v123 offset:39936
    s_add_u32 s24, s24, 8192
    s_bitset0_b32 s24, 15
    s_xor_b32 s55, s24, 16384
    s_xor_b32 s29, s29, 0x0
    s_xor_b32 s53, s29, 1024
    s_bfe_u32 s33, s22, 0x10000
    s_add_u32 s40, s22, 5
    s_lshr_b32 s40, s40, 2
    s_min_u32 s40, s40, 16
    s_bfm_b32 s58, s40, 0
    s_waitcnt vmcnt(5)
    v_cmp_eq_u32 vcc, 0, v125
    s_nop 0
    s_and_b64 vcc, vcc, s[58:59]
    s_cbranch_scc1 L_kvw_22
L_kvb_23:
    v_mov_b32 v15, 0
    s_nop 2
    v_mov_b32 v15, 0
    s_nop 2
    v_mov_b32 v15, 0
    s_nop 2
    v_mov_b32 v15, 0
    s_nop 2
    v_mov_b32 v15, 0
    s_nop 2
    v_mov_b32 v15, 0
    s_nop 2
    v_mov_b32 v15, 0
    s_nop 2
    v_mov_b32 v15, 0
    s_nop 2
    v_mov_b32 v15, 0
    s_nop 2
    v_mov_b32 v15, 0
    s_nop 2
    v_mov_b32 v15, 0
    s_nop 2
    v_mov_b32 v15, 0
    s_nop 2
    v_mov_b32 v15, 0
    s_nop 2
    v_mov_b32 v15, 0
    s_nop 2
    v_mov_b32 v15, 0
    s_nop 2
    v_mov_b32 v15, 0
    s_nop 2
    v_mov_b32 v15, 0
    s_nop 2
    v_mov_b32 v15, 0
    s_nop 2
    v_mov_b32 v15, 0
    s_nop 2
    v_mov_b32 v15, 0
    s_nop 2
    v_mov_b32 v15, 0
    s_nop 2
    v_mov_b32 v15, 0
    s_nop 2
    v_mov_b32 v15, 0
    s_nop 2
    v_mov_b32 v15, 0
    s_nop 2
    v_mov_b32 v15, 0
    s_nop 2
    v_mov_b32 v15, 0
    s_nop 2
    v_mov_b32 v15, 0
    s_nop 2
    v_mov_b32 v15, 0
    s_nop 2
    v_mov_b32 v15, 0
    s_nop 2
    v_mov_b32 v15, 0
    s_nop 2
    v_mov_b32 v15, 0
    s_nop 2
    s_waitcnt lgkmcnt(0)
    s_branch L_chain_top0_f
.p2align 6
L_chain_top1_f:
    buffer_load_dwordx4 v[0:3], v117, s[8:11], s23 offen nt
    v_mov_b32 v15, 0
    v_mov_b32 v15, 0
    v_mov_b32 v15, 0
    v_mov_b32 v15, 0
    v_mov_b32 v15, 0
    v_mov_b32 v15, 0
    v_mov_b32 v15, 0
    v_mov_b32 v15, 0
    v_mov_b32 v15, 0
    v_mov_b32 v15, 0
    v_mov_b32 v15, 0
    v_mov_b32 v15, 0
    v_mov_b32 v15, 0
    v_mov_b32 v15, 0
    v_mov_b32 v15, 0
    v_mov_b32 v15, 0
    buffer_load_dwordx4 v[0:3], v117, s[8:11], s23 offen sc1
    v_mov_b32 v15, 0
    v_mov_b32 v15, 0
    v_mov_b32 v15, 0
    v_mov_b32 v15, 0
    v_mov_b32 v15, 0
    v_mov_b32 v15, 0
    v_mov_b32 v15, 0
    v_mov_b32 v15, 0
    v_mov_b32 v15, 0
    v_mov_b32 v15, 0
    v_mov_b32 v15, 0
    v_mov_b32 v15, 0
    v_mov_b32 v15, 0
    v_mov_b32 v15, 0
    v_mov_b32 v15, 0
    v_mov_b32 v15, 0
L_mret_24:
    buffer_load_dwordx4 v[0:3], v117, s[8:11], s23 offen sc1
    s_add_u32 s45, s45, 1
    s_cmp_lt_u32 s45, 0x10000
    s_cselect_b32 s56, -2, -1
    s_nop 3
    v_mov_b32 v32, 0
    v_mov_b32 v33, 0
    v_mov_b32 v34, 0
    v_mov_b32 v35, 0
    s_waitcnt vmcnt(2)
    v_max3_u32 v15, v0, v1, v2
    v_max_u32 v15, v15, v3
    v_cmp_lt_u32 vcc, s56, v15
    v_smfmac_f32_16x16x64_bf16 v[32:35], v[0:3], v[80:87], v116
    s_cbranch_vccnz L_mret_24
    ds_write_b128 v117, v[0:3] offset:1024
    v_smfmac_f32_16x16x64_bf16 v[36:39], v[0:3], v[56:63], v116
    buffer_load_dwordx4 v[4:7], v117, s[8:11], s48 offen nt
    v_smfmac_f32_16x16x64_bf16 v[40:43], v[0:3], v[64:71], v116
    buffer_load_dwordx4 v117, s[8:11], s48 offen nt lds
    s_mov_b32 m0, 10240
    v_smfmac_f32_16x16x64_bf16 v[44:47], v[0:3], v[72:79], v116
    s_waitcnt lgkmcnt(0)
    s_barrier
    ds_read_b128 v[8:11], v117
    v_smfmac_f32_16x16x64_bf16 v[48:51], v[0:3], a[192:199], v116
    ds_read_b128 v[16:19], v117 offset:3072
    ds_read_b128 v[20:23], v117 offset:2048
    v_smfmac_f32_16x16x64_bf16 v[52:55], v[0:3], a[200:207], v116
    ds_read_b128 v[80:83], v117 offset:14336
    s_waitcnt lgkmcnt(3)
    v_smfmac_f32_16x16x64_bf16 v[32:35], v[8:11], a[0:7], v116
    ds_read_b128 v[84:87], v117 offset:15360
    v_smfmac_f32_16x16x64_bf16 v[36:39], v[8:11], a[8:15], v116
    ds_read_b128 v[56:59], v117 offset:8192
    s_waitcnt lgkmcnt(4)
    v_smfmac_f32_16x16x64_bf16 v[32:35], v[16:19], a[32:39], v116
    ds_read_b128 v[60:63], v117 offset:9216
    v_smfmac_f32_16x16x64_bf16 v[36:39], v[16:19], a[40:47], v116
    buffer_store_dwordx4 v[112:115], v117, s[8:11], s32 offen sc1
    s_waitcnt lgkmcnt(4)
    v_smfmac_f32_16x16x64_bf16 v[32:35], v[20:23], a[64:71], v116
    ds_read_b128 v[64:67], v117 offset:10240
    v_smfmac_f32_16x16x64_bf16 v[36:39], v[20:23], a[72:79], v116
    ds_read_b128 v[68:71], v117 offset:11264
    v_smfmac_f32_16x16x64_bf16 v[40:43], v[8:11], a[96:103], v116
    ds_read_b128 v[72:75], v117 offset:12288
    v_smfmac_f32_16x16x64_bf16 v[40:43], v[16:19], a[128:135], v116
    ds_read_b128 v[76:79], v117 offset:13312
    v_smfmac_f32_16x16x64_bf16 v[40:43], v[20:23], a[160:167], v116
    s_waitcnt vmcnt(2)
    v_max3_u32 v15, v4, v5, v6
    v_smfmac_f32_16x16x64_bf16 v[44:47], v[8:11], a[104:111], v116
    v_max_u32 v15, v15, v7
    v_smfmac_f32_16x16x64_bf16 v[44:47], v[16:19], a[136:143], v116
    s_waitcnt vmcnt(1) lgkmcnt(0)
    v_cmp_lt_u32 vcc, s56, v15
    v_smfmac_f32_16x16x64_bf16 v[44:47], v[20:23], a[168:175], v116
    s_cbranch_vccnz L_mret_25
L_mgo_26:
    v_smfmac_f32_16x16x64_bf16 v[44:47], v[4:7], v[24:31], v116
    s_barrier
    ds_read_b128 v[12:15], v117 offset:4096
    v_smfmac_f32_16x16x64_bf16 v[32:35], v[4:7], v[88:95], v116
    ds_read_b128 v[24:27], v117 offset:7168
    v_smfmac_f32_16x16x64_bf16 v[36:39], v[4:7], v[96:103], v116
    ds_read_b128 v[28:31], v117 offset:6144
    v_smfmac_f32_16x16x64_bf16 v[40:43], v[4:7], v[104:111], v116
    ds_read_b128 v[88:91], v117 offset:26624
    s_waitcnt lgkmcnt(3)
    v_smfmac_f32_16x16x64_bf16 v[32:35], v[12:15], a[16:23], v116
    ds_read_b128 v[92:95], v117 offset:27648
    s_waitcnt lgkmcnt(3)
    v_smfmac_f32_16x16x64_bf16 v[32:35], v[24:27], a[48:55], v116
    buffer_load_dwordx4 v117, s[8:11], s30 offen lds
    s_waitcnt lgkmcnt(2)
    v_smfmac_f32_16x16x64_bf16 v[32:35], v[28:31], a[80:87], v116
    ds_read_b128 v[96:99], v117 offset:23552
    v_smfmac_f32_16x16x64_bf16 v[36:39], v[12:15], a[24:31], v116
    ds_read_b128 v[100:103], v117 offset:23552
    v_smfmac_f32_16x16x64_bf16 v[36:39], v[24:27], a[56:63], v116
    buffer_load_dwordx4 v117, s[8:11], s30 offen offset:1024 lds
    s_add_u32 m0, s52, 0x6000
    v_add_f32 v32, v32, v34
    v_smfmac_f32_16x16x64_bf16 v[36:39], v[28:31], a[88:95], v116
    ds_read_b128 v[104:107], v117 offset:23552
    v_add_f32 v33, v33, v35
    v_smfmac_f32_16x16x64_bf16 v[40:43], v[12:15], a[112:119], v116
    ds_read_b128 v[108:111], v117 offset:23552
    v_mul_f32 v32, s34, v32
    v_smfmac_f32_16x16x64_bf16 v[40:43], v[24:27], a[144:151], v116
    buffer_load_dword v125, v119, s[8:11], s28 offen sc1
    v_mul_f32 v33, s34, v33
    v_smfmac_f32_16x16x64_bf16 v[40:43], v[28:31], a[176:183], v116
    ds_read_b128 v[0:3], v124
    v_add_f32 v36, v36, v38
    v_smfmac_f32_16x16x64_bf16 v[48:51], v[4:7], a[208:215], v116
    v_add_f32 v37, v37, v39
    v_smfmac_f32_16x16x64_bf16 v[52:55], v[4:7], a[216:223], v116
    s_waitcnt lgkmcnt(5)
    buffer_load_dwordx4 v117, s[8:11], s31 offen lds
    v_mul_f32 v36, s34, v36
    v_smfmac_f32_16x16x64_bf16 v[44:47], v[12:15], a[120:127], v116
    ds_read_b128 v[4:7], v124 offset:1024
    v_mul_f32 v37, s34, v37
    v_smfmac_f32_16x16x64_bf16 v[44:47], v[24:27], a[152:159], v116
    v_cvt_pk_bf16_f32 v34, v32, v36
    v_smfmac_f32_16x16x64_bf16 v[44:47], v[28:31], a[184:191], v116
    buffer_load_dwordx4 v117, s[8:11], s31 offen offset:1024 lds
    s_mov_b32 m0, 5120
    v_cvt_pk_bf16_f32 v35, v33, v37
    v_add_f32 v40, v40, v42
    v_smfmac_f32_16x16x64_bf16 v[48:51], v[8:11], a[224:231], v116
    ds_write2_b32 v120, v34, v35 offset0:32 offset1:48
    v_add_f32 v41, v41, v43
    v_smfmac_f32_16x16x64_bf16 v[52:55], v[8:11], a[232:239], v116
    v_add_f32 v44, v44, v46
    v_add_f32 v45, v45, v47
    v_cvt_pk_bf16_f32 v113, v40, v44
    v_cvt_pk_bf16_f32 v115, v41, v45
    v_smfmac_f32_16x16x64_bf16 v[48:51], v[12:15], a[240:247], v116
    ds_write2_b32 v120, v113, v115 offset0:0 offset1:16
    v_smfmac_f32_16x16x64_bf16 v[52:55], v[12:15], a[248:255], v116
    s_cmp_eq_u32 s22, 63
    s_cbranch_scc1 L_chain_last_f
    v_smfmac_f32_16x16x64_bf16 v[48:51], v[16:19], v[128:135], v116
    v_smfmac_f32_16x16x64_bf16 v[48:51], v[20:23], v[160:167], v116
    v_smfmac_f32_16x16x64_bf16 v[48:51], v[24:27], v[144:151], v116
    s_waitcnt lgkmcnt(0)
    s_barrier
    v_smfmac_f32_16x16x64_bf16 v[48:51], v[28:31], v[176:183], v116
    ds_read_b128 v[32:35], v121 offset:16384
    ds_read_b128 v[36:39], v121 offset:17408
    v_smfmac_f32_16x16x64_bf16 v[52:55], v[16:19], v[136:143], v116
    ds_read_b128 v[40:43], v121 offset:18432
    ds_read_b128 v[44:47], v121 offset:19456
    v_smfmac_f32_16x16x64_bf16 v[52:55], v[20:23], v[168:175], v116
    ds_read_b128 v[8:11], v124 offset:32768
    v_add_f32 v48, v48, v50
    v_smfmac_f32_16x16x64_bf16 v[52:55], v[24:27], v[152:159], v116
    ds_read_b128 v[12:15], v124 offset:33792
    v_add_f32 v49, v49, v51
    v_smfmac_f32_16x16x64_bf16 v[52:55], v[28:31], v[184:191], v116
    s_waitcnt lgkmcnt(5)
    v_cvt_pk_bf16_f32 v112, v48, v49
    v_mfma_f32_16x16x32_bf16 v[56:59], v[56:59], v[32:35], 0
    s_waitcnt lgkmcnt(4)
    v_mov_b32 v48, s50
    v_mov_b32 v49, s50
    v_mfma_f32_16x16x32_bf16 v[56:59], v[60:63], v[36:39], v[56:59]
    ds_read_b128 v[16:19], v124 offset:2048
    s_waitcnt lgkmcnt(4)
    v_mov_b32 v50, s50
    v_mov_b32 v51, s50
    v_mfma_f32_16x16x32_bf16 v[56:59], v[64:67], v[40:43], v[56:59]
    ds_read_b128 v[20:23], v124 offset:3072
    s_waitcnt lgkmcnt(4)
    v_add_f32 v52, v52, v54
    v_mfma_f32_16x16x32_bf16 v[56:59], v[68:71], v[44:47], v[56:59]
    ds_read_b128 v[24:27], v124 offset:4096
    v_add_f32 v53, v53, v55
    v_mfma_f32_16x16x32_bf16 v[60:63], v[72:75], v[32:35], 0
    ds_read_b128 v[28:31], v124 offset:5120
    v_cvt_pk_bf16_f32 v114, v52, v53
    v_mov_b32 v53, 0
    v_mfma_f32_16x16x32_bf16 v[60:63], v[76:79], v[36:39], v[60:63]
    v_exp_f32 v56, v56
    v_mfma_f32_16x16x32_bf16 v[60:63], v[80:83], v[40:43], v[60:63]
    v_exp_f32 v57, v57
    v_mfma_f32_16x16x32_bf16 v[60:63], v[84:87], v[44:47], v[60:63]
    v_exp_f32 v58, v58
    v_mfma_f32_16x16x32_bf16 v[64:67], v[32:35], v[32:35], 0
    v_exp_f32 v59, v59
    v_cvt_pk_bf16_f32 v68, v56, v57
    v_mfma_f32_16x16x32_bf16 v[64:67], v[36:39], v[36:39], v[64:67]
    v_exp_f32 v60, v60
    v_cvt_pk_bf16_f32 v69, v58, v59
    v_mfma_f32_16x16x32_bf16 v[64:67], v[40:43], v[40:43], v[64:67]
    v_exp_f32 v61, v61
    v_mfma_f32_16x16x32_bf16 v[64:67], v[44:47], v[44:47], v[64:67]
    v_exp_f32 v62, v62
    v_exp_f32 v63, v63
    v_cvt_pk_bf16_f32 v70, v60, v61
    v_cvt_pk_bf16_f32 v71, v62, v63
    s_nop 1
    v_mfma_f32_16x16x32_bf16 v[72:75], v[88:91], v[68:71], 0
    s_nop 0
    v_exp_f32 v64, v64
    v_mfma_f32_16x16x32_bf16 v[76:79], v[92:95], v[68:71], 0
    v_exp_f32 v65, v65
    v_mfma_f32_16x16x32_bf16 v[80:83], v[48:51], v[68:71], 0
    v_cvt_pk_bf16_f32 v52, v64, v65
    s_nop 1
    v_mfma_f32_16x16x16_bf16 v[72:75], v[112:113], v[52:53], v[72:75]
    ds_read_b128 v[32:35], v124 offset:6144
    v_mfma_f32_16x16x16_bf16 v[76:79], v[114:115], v[52:53], v[76:79]
    ds_read_b128 v[36:39], v124 offset:7168
    v_mfma_f32_16x16x16_bf16 v[80:83], v[48:49], v[52:53], v[80:83]
L_norm_27:
    s_mov_b64 vcc, s[36:37]
    v_mov_b32 v122, v122
    v_mov_b32 v122, v122
    v_mov_b32 v122, v122
    v_cndmask_b32_dpp v76, v72, v76, vcc quad_perm:[2,3,2,3] row_mask:0xf bank_mask:0xf
    v_cndmask_b32_dpp v77, v73, v77, vcc quad_perm:[2,3,2,3] row_mask:0xf bank_mask:0xf
    v_cndmask_b32_dpp v78, v74, v78, vcc quad_perm:[2,3,2,3] row_mask:0xf bank_mask:0xf
    v_cndmask_b32_dpp v79, v75, v79, vcc quad_perm:[2,3,2,3] row_mask:0xf bank_mask:0xf
    v_rcp_f32_dpp v84, v80 quad_perm:[2,3,2,3] row_mask:0xf bank_mask:0xf
    s_nop 0
    v_pk_mul_f32 v[76:77], v[76:77], v[84:85] op_sel_hi:[1,0]
    v_pk_mul_f32 v[78:79], v[78:79], v[84:85] op_sel_hi:[1,0]
    v_cvt_pk_bf16_f32 v72, v76, v77
    v_cvt_pk_bf16_f32 v73, v78, v79
    ds_write_b64 v122, v[72:73] offset:20992
    v_max_f32_dpp v86, v80, v84 quad_perm:[2,3,2,3] row_mask:0xf bank_mask:0xf
    v_mov_b32_dpp v60, v72 quad_perm:[0,1,0,1] row_mask:0xf bank_mask:0xf
    v_mov_b32_dpp v61, v73 quad_perm:[0,1,0,1] row_mask:0xf bank_mask:0xf
    v_cmp_lt_f32 vcc, s35, v86
    v_mov_b32_dpp v62, v72 quad_perm:[2,3,2,3] row_mask:0xf bank_mask:0xf
    v_mov_b32_dpp v63, v73 quad_perm:[2,3,2,3] row_mask:0xf bank_mask:0xf
    s_nop 1
    v_smfmac_f32_16x16x64_bf16 v[96:99], v[60:63], v[192:199], v116
    s_cbranch_vccnz L_smax_28
    v_smfmac_f32_16x16x64_bf16 v[100:103], v[60:63], v[224:231], v116
    s_waitcnt lgkmcnt(0)
    s_barrier
    ds_read_b128 v[92:95], v127 offset:20480
    ds_read_b128 v[80:83], v127 offset:22016
    ds_read_b128 v[84:87], v127 offset:21504
    v_smfmac_f32_16x16x64_bf16 v[104:107], v[60:63], v[0:7], v116
    ds_read_b128 v[40:43], v124 offset:34816
    v_smfmac_f32_16x16x64_bf16 v[108:111], v[60:63], v[8:15], v116
    ds_read_b128 v[56:59], v124 offset:36864
    s_waitcnt lgkmcnt(4)
    v_smfmac_f32_16x16x64_bf16 v[96:99], v[92:95], v[200:207], v116
    s_waitcnt lgkmcnt(3)
    v_smfmac_f32_16x16x64_bf16 v[96:99], v[80:83], v[208:215], v116
    ds_read_b128 v[44:47], v124 offset:35840
    s_waitcnt lgkmcnt(3)
    v_smfmac_f32_16x16x64_bf16 v[96:99], v[84:87], v[216:223], v116
    ds_read_b128 v[68:71], v124 offset:39936
    v_smfmac_f32_16x16x64_bf16 v[100:103], v[92:95], v[232:239], v116
    ds_read_b128 v[64:67], v124 offset:38912
    v_smfmac_f32_16x16x64_bf16 v[100:103], v[80:83], v[240:247], v116
    ds_read_b128 v[60:63], v124 offset:37888
    v_cvt_pk_bf16_f32 v72, v96, v98
    v_smfmac_f32_16x16x64_bf16 v[100:103], v[84:87], v[248:255], v116
    v_and_or_b32 v72, v72, -2, s33
    v_smfmac_f32_16x16x64_bf16 v[104:107], v[92:95], v[16:23], v116
    v_cvt_pk_bf16_f32 v74, v97, v99
    v_smfmac_f32_16x16x64_bf16 v[104:107], v[80:83], v[24:31], v116
    v_cvt_pk_bf16_f32 v73, v100, v102
    v_cvt_pk_bf16_f32 v75, v101, v103
    v_smfmac_f32_16x16x64_bf16 v[104:107], v[84:87], v[32:39], v116
    buffer_store_dwordx4 v[72:75], v118, s[8:11], s25 offen
    s_waitcnt lgkmcnt(3)
    v_smfmac_f32_16x16x64_bf16 v[108:111], v[92:95], v[40:47], v116
    s_waitcnt lgkmcnt(0)
    v_smfmac_f32_16x16x64_bf16 v[108:111], v[80:83], v[56:63], v116
    v_cvt_pk_bf16_f32 v76, v104, v106
    v_smfmac_f32_16x16x64_bf16 v[108:111], v[84:87], v[64:71], v116
    v_and_or_b32 v76, v76, -2, s33
    v_cvt_pk_bf16_f32 v78, v105, v107
    v_mov_b32 v122, v122
    v_mov_b32 v122, v122
    v_mov_b32 v122, v122
    v_mov_b32 v122, v122
    v_mov_b32 v122, v122
    v_mov_b32 v122, v122
    v_cvt_pk_bf16_f32 v77, v108, v110
    v_cvt_pk_bf16_f32 v79, v109, v111
    buffer_store_dwordx4 v[76:79], v118, s[8:11], s26 offen
    s_add_u32 s30, s30, 0x40000
    s_add_u32 s31, s31, 0x40000
    s_add_u32 s32, s32, 0x20000
    s_add_u32 s23, s24, 1024
    s_add_u32 s48, s23, 4096
    s_xor_b32 s25, s25, 0x0
    s_xor_b32 s26, s26, 0x0
    s_mov_b32 s35, 0x49800000
    s_add_u32 s22, s22, 1
    v_mov_b32 v32, 0
    v_mov_b32 v33, 0
    v_mov_b32 v34, 0
    v_mov_b32 v35, 0
    v_mov_b32 v36, 0
    v_mov_b32 v37, 0
    v_mov_b32 v38, 0
    v_mov_b32 v39, 0
    v_mov_b32 v40, 0
    v_mov_b32 v41, 0
    v_mov_b32 v42, 0
    v_mov_b32 v43, 0
    v_mov_b32 v44, 0
    v_mov_b32 v45, 0
    v_mov_b32 v46, 0
    v_mov_b32 v47, 0
    v_mov_b32 v48, 0
    v_mov_b32 v49, 0
    v_mov_b32 v50, 0
    v_mov_b32 v51, 0
    v_mov_b32 v52, 0
    v_mov_b32 v53, 0
    v_mov_b32 v54, 0
    v_mov_b32 v55, 0
    ds_read_b128 v[80:83], v123
    ds_read_b128 v[84:87], v123 offset:1024
    ds_read_b128 v[56:59], v123 offset:2048
    ds_read_b128 v[60:63], v123 offset:3072
    ds_read_b128 v[64:67], v123 offset:32768
    ds_read_b128 v[68:71], v123 offset:33792
    ds_read_b128 v[72:75], v123 offset:34816
    ds_read_b128 v[76:79], v123 offset:35840
    ds_read_b128 v[88:91], v123 offset:4096
    ds_read_b128 v[92:95], v123 offset:5120
    ds_read_b128 v[96:99], v123 offset:6144
    ds_read_b128 v[100:103], v123 offset:7168
    ds_read_b128 v[104:107], v123 offset:36864
    ds_read_b128 v[108:111], v123 offset:37888
    ds_read_b128 v[24:27], v123 offset:38912
    ds_read_b128 v[28:31], v123 offset:39936
    s_add_u32 s24, s24, 8192
    s_bitset0_b32 s24, 15
    s_xor_b32 s55, s24, 16384
    s_xor_b32 s29, s29, 0x0
    s_xor_b32 s53, s29, 1024
    s_bfe_u32 s33, s22, 0x10000
    s_add_u32 s40, s22, 5
    s_lshr_b32 s40, s40, 2
    s_min_u32 s40, s40, 16
    s_bfm_b32 s58, s40, 0
    s_waitcnt vmcnt(4)
    v_cmp_eq_u32 vcc, 0, v125
    s_nop 0
    s_and_b64 vcc, vcc, s[58:59]
    s_cbranch_scc1 L_kvw_29
L_kvb_30:
    v_mov_b32 v15, 0
    s_nop 2
    v_mov_b32 v15, 0
    s_nop 2
    v_mov_b32 v15, 0
    s_nop 2
    v_mov_b32 v15, 0
    s_nop 2
    v_mov_b32 v15, 0
    s_nop 2
    v_mov_b32 v15, 0
    s_nop 2
    v_mov_b32 v15, 0
    s_nop 2
    v_mov_b32 v15, 0
    s_nop 2
    v_mov_b32 v15, 0
    s_nop 2
    v_mov_b32 v15, 0
    s_nop 2
    v_mov_b32 v15, 0
    s_nop 2
    v_mov_b32 v15, 0
    s_nop 2
    v_mov_b32 v15, 0
    s_nop 2
    v_mov_b32 v15, 0
    s_nop 2
    v_mov_b32 v15, 0
    s_nop 2
    v_mov_b32 v15, 0
    s_nop 2
    v_mov_b32 v15, 0
    s_nop 2
    v_mov_b32 v15, 0
    s_nop 2
    v_mov_b32 v15, 0
    s_nop 2
    v_mov_b32 v15, 0
    s_nop 2
    v_mov_b32 v15, 0
    s_nop 2
    v_mov_b32 v15, 0
    s_nop 2
    v_mov_b32 v15, 0
    s_nop 2
    v_mov_b32 v15, 0
    s_nop 2
    v_mov_b32 v15, 0
    s_nop 2
    v_mov_b32 v15, 0
    s_nop 2
    v_mov_b32 v15, 0
    s_nop 2
    v_mov_b32 v15, 0
    s_nop 2
    v_mov_b32 v15, 0
    s_nop 2
    v_mov_b32 v15, 0
    s_nop 2
    v_mov_b32 v15, 0
    s_nop 2
    s_waitcnt lgkmcnt(0)
    s_branch L_chain_top1_f
.p2align 6
L_chain_top2_f:
    buffer_load_dwordx4 v[0:3], v117, s[8:11], s23 offen nt
    v_mov_b32 v48, 0
    v_mov_b32 v49, 0
    v_mov_b32 v50, 0
    v_mov_b32 v51, 0
    v_mov_b32 v52, 0
    v_mov_b32 v53, 0
    v_mov_b32 v15, 0
    v_mov_b32 v15, 0
    v_mov_b32 v15, 0
    v_mov_b32 v15, 0
    v_mov_b32 v15, 0
    v_mov_b32 v15, 0
    v_mov_b32 v15, 0
    v_mov_b32 v15, 0
    v_mov_b32 v15, 0
    v_mov_b32 v15, 0
    buffer_load_dwordx4 v[0:3], v117, s[8:11], s23 offen sc1
    s_waitcnt vmcnt(3)
    v_mov_b32 v36, 0
    v_mov_b32 v37, 0
    v_mov_b32 v38, 0
    v_mov_b32 v39, 0
    v_mov_b32 v40, 0
    v_mov_b32 v41, 0
    v_mov_b32 v42, 0
    v_mov_b32 v43, 0
    v_mov_b32 v44, 0
    v_mov_b32 v45, 0
    v_mov_b32 v46, 0
    v_mov_b32 v47, 0
    v_mov_b32 v15, 0
    v_mov_b32 v15, 0
    v_mov_b32 v15, 0
    v_mov_b32 v15, 0
L_mret_31:
    buffer_load_dwordx4 v[0:3], v117, s[8:11], s23 offen sc1
    s_add_u32 s45, s45, 1
    s_cmp_lt_u32 s45, 0x10000
    s_cselect_b32 s56, -2, -1
    s_nop 3
    v_mov_b32 v32, 0
    v_mov_b32 v33, 0
    v_mov_b32 v34, 0
    v_mov_b32 v35, 0
    s_waitcnt vmcnt(2)
    v_max3_u32 v15, v0, v1, v2
    v_max_u32 v15, v15, v3
    v_cmp_lt_u32 vcc, s56, v15
    v_smfmac_f32_16x16x64_bf16 v[32:35], v[0:3], v[80:87], v116
    s_cbranch_vccnz L_mret_31
    ds_write_b128 v117, v[0:3] offset:2048
    v_smfmac_f32_16x16x64_bf16 v[36:39], v[0:3], v[56:63], v116
    buffer_load_dwordx4 v[4:7], v117, s[8:11], s48 offen nt
    v_smfmac_f32_16x16x64_bf16 v[40:43], v[0:3], v[64:71], v116
    buffer_load_dwordx4 v117, s[8:11], s48 offen nt lds
    s_mov_b32 m0, 12288
    v_smfmac_f32_16x16x64_bf16 v[44:47], v[0:3], v[72:79], v116
    s_waitcnt lgkmcnt(0)
    s_barrier
    ds_read_b128 v[8:11], v117 offset:3072
    v_smfmac_f32_16x16x64_bf16 v[48:51], v[0:3], a[192:199], v116
    ds_read_b128 v[16:19], v117
    ds_read_b128 v[20:23], v117 offset:1024
    v_smfmac_f32_16x16x64_bf16 v[52:55], v[0:3], a[200:207], v116
    ds_read_b128 v[80:83], v117 offset:14336
    s_waitcnt lgkmcnt(3)
    v_smfmac_f32_16x16x64_bf16 v[32:35], v[8:11], a[0:7], v116
    ds_read_b128 v[84:87], v117 offset:15360
    v_smfmac_f32_16x16x64_bf16 v[36:39], v[8:11], a[8:15], v116
    ds_read_b128 v[56:59], v117 offset:8192
    s_waitcnt lgkmcnt(4)
    v_smfmac_f32_16x16x64_bf16 v[32:35], v[16:19], a[32:39], v116
    ds_read_b128 v[60:63], v117 offset:9216
    v_smfmac_f32_16x16x64_bf16 v[36:39], v[16:19], a[40:47], v116
    ds_read_b128 v[64:67], v117 offset:10240
    s_waitcnt lgkmcnt(5)
    v_smfmac_f32_16x16x64_bf16 v[32:35], v[20:23], a[64:71], v116
    ds_read_b128 v[68:71], v117 offset:11264
    v_smfmac_f32_16x16x64_bf16 v[36:39], v[20:23], a[72:79], v116
    buffer_store_dwordx4 v[112:115], v117, s[8:11], s32 offen sc1
    v_smfmac_f32_16x16x64_bf16 v[40:43], v[8:11], a[96:103], v116
    ds_read_b128 v[72:75], v117 offset:12288
    v_smfmac_f32_16x16x64_bf16 v[40:43], v[16:19], a[128:135], v116
    ds_read_b128 v[76:79], v117 offset:13312
    v_smfmac_f32_16x16x64_bf16 v[40:43], v[20:23], a[160:167], v116
    s_waitcnt vmcnt(2)
    v_max3_u32 v15, v4, v5, v6
    v_smfmac_f32_16x16x64_bf16 v[44:47], v[8:11], a[104:111], v116
    v_max_u32 v15, v15, v7
    v_smfmac_f32_16x16x64_bf16 v[44:47], v[16:19], a[136:143], v116
    s_waitcnt vmcnt(1) lgkmcnt(0)
    v_cmp_lt_u32 vcc, s56, v15
    v_smfmac_f32_16x16x64_bf16 v[44:47], v[20:23], a[168:175], v116
    s_cbranch_vccnz L_mret_32
L_mgo_33:
    v_smfmac_f32_16x16x64_bf16 v[44:47], v[4:7], v[24:31], v116
    s_barrier
    ds_read_b128 v[12:15], v117 offset:7168
    v_smfmac_f32_16x16x64_bf16 v[32:35], v[4:7], v[88:95], v116
    ds_read_b128 v[24:27], v117 offset:4096
    v_smfmac_f32_16x16x64_bf16 v[36:39], v[4:7], v[96:103], v116
    ds_read_b128 v[28:31], v117 offset:5120
    v_smfmac_f32_16x16x64_bf16 v[40:43], v[4:7], v[104:111], v116
    ds_read_b128 v[88:91], v117 offset:28672
    s_waitcnt lgkmcnt(3)
    v_smfmac_f32_16x16x64_bf16 v[32:35], v[12:15], a[16:23], v116
    ds_read_b128 v[92:95], v117 offset:29696
    s_waitcnt lgkmcnt(3)
    v_smfmac_f32_16x16x64_bf16 v[32:35], v[24:27], a[48:55], v116
    buffer_load_dwordx4 v117, s[8:11], s30 offen lds
    s_waitcnt lgkmcnt(2)
    v_smfmac_f32_16x16x64_bf16 v[32:35], v[28:31], a[80:87], v116
    ds_read_b128 v[96:99], v117 offset:23552
    v_smfmac_f32_16x16x64_bf16 v[36:39], v[12:15], a[24:31], v116
    ds_read_b128 v[100:103], v117 offset:23552
    v_smfmac_f32_16x16x64_bf16 v[36:39], v[24:27], a[56:63], v116
    buffer_load_dwordx4 v117, s[8:11], s30 offen offset:1024 lds
    s_add_u32 m0, s52, 0x6000
    v_add_f32 v32, v32, v34
    v_smfmac_f32_16x16x64_bf16 v[36:39], v[28:31], a[88:95], v116
    ds_read_b128 v[104:107], v117 offset:23552
    v_add_f32 v33, v33, v35
    v_smfmac_f32_16x16x64_bf16 v[40:43], v[12:15], a[112:119], v116
    ds_read_b128 v[108:111], v117 offset:23552
    v_mul_f32 v32, s34, v32
    v_smfmac_f32_16x16x64_bf16 v[40:43], v[24:27], a[144:151], v116
    s_waitcnt lgkmcnt(4)
    buffer_load_dwordx4 v117, s[8:11], s31 offen lds
    v_mul_f32 v33, s34, v33
    v_smfmac_f32_16x16x64_bf16 v[40:43], v[28:31], a[176:183], v116
    ds_read_b128 v[0:3], v124
    v_add_f32 v36, v36, v38
    v_smfmac_f32_16x16x64_bf16 v[48:51], v[4:7], a[208:215], v116
    v_add_f32 v37, v37, v39
    v_smfmac_f32_16x16x64_bf16 v[52:55], v[4:7], a[216:223], v116
    buffer_load_dwordx4 v117, s[8:11], s31 offen offset:1024 lds
    s_mov_b32 m0, 6144
    v_mul_f32 v36, s34, v36
    v_smfmac_f32_16x16x64_bf16 v[44:47], v[12:15], a[120:127], v116
    ds_read_b128 v[4:7], v124 offset:1024
    v_mul_f32 v37, s34, v37
    v_smfmac_f32_16x16x64_bf16 v[44:47], v[24:27], a[152:159], v116
    v_cvt_pk_bf16_f32 v34, v32, v36
    v_smfmac_f32_16x16x64_bf16 v[44:47], v[28:31], a[184:191], v116
    v_cvt_pk_bf16_f32 v35, v33, v37
    v_add_f32 v40, v40, v42
    v_smfmac_f32_16x16x64_bf16 v[48:51], v[8:11], a[224:231], v116
    ds_write2_b32 v120, v34, v35 offset0:32 offset1:48
    v_add_f32 v41, v41, v43
    v_smfmac_f32_16x16x64_bf16 v[52:55], v[8:11], a[232:239], v116
    v_add_f32 v44, v44, v46
    v_add_f32 v45, v45, v47
    v_cvt_pk_bf16_f32 v113, v40, v44
    v_cvt_pk_bf16_f32 v115, v41, v45
    v_smfmac_f32_16x16x64_bf16 v[48:51], v[12:15], a[240:247], v116
    ds_write2_b32 v120, v113, v115 offset0:0 offset1:16
    v_smfmac_f32_16x16x64_bf16 v[52:55], v[12:15], a[248:255], v116
    s_cmp_eq_u32 s22, 63
    s_cbranch_scc1 L_chain_last_f
    v_smfmac_f32_16x16x64_bf16 v[48:51], v[16:19], v[128:135], v116
    buffer_store_dword v126, v119, s[8:11], s55 offen
    v_smfmac_f32_16x16x64_bf16 v[48:51], v[20:23], v[160:167], v116
    v_smfmac_f32_16x16x64_bf16 v[48:51], v[24:27], v[144:151], v116
    s_waitcnt lgkmcnt(0)
    s_barrier
    v_smfmac_f32_16x16x64_bf16 v[48:51], v[28:31], v[176:183], v116
    ds_read_b128 v[32:35], v121 offset:16384
    ds_read_b128 v[36:39], v121 offset:17408
    v_smfmac_f32_16x16x64_bf16 v[52:55], v[16:19], v[136:143], v116
    ds_read_b128 v[40:43], v121 offset:18432
    ds_read_b128 v[44:47], v121 offset:19456
    v_smfmac_f32_16x16x64_bf16 v[52:55], v[20:23], v[168:175], v116
    ds_read_b128 v[8:11], v124 offset:32768
    v_add_f32 v48, v48, v50
    v_smfmac_f32_16x16x64_bf16 v[52:55], v[24:27], v[152:159], v116
    ds_read_b128 v[12:15], v124 offset:33792
    v_add_f32 v49, v49, v51
    v_smfmac_f32_16x16x64_bf16 v[52:55], v[28:31], v[184:191], v116
    s_waitcnt lgkmcnt(5)
    v_cvt_pk_bf16_f32 v112, v48, v49
    v_mfma_f32_16x16x32_bf16 v[56:59], v[56:59], v[32:35], 0
    s_waitcnt lgkmcnt(4)
    v_mov_b32 v48, s50
    v_mov_b32 v49, s50
    v_mfma_f32_16x16x32_bf16 v[56:59], v[60:63], v[36:39], v[56:59]
    ds_read_b128 v[16:19], v124 offset:2048
    s_waitcnt lgkmcnt(4)
    v_mov_b32 v50, s50
    v_mov_b32 v51, s50
    v_mfma_f32_16x16x32_bf16 v[56:59], v[64:67], v[40:43], v[56:59]
    ds_read_b128 v[20:23], v124 offset:3072
    s_waitcnt lgkmcnt(4)
    v_add_f32 v52, v52, v54
    v_mfma_f32_16x16x32_bf16 v[56:59], v[68:71], v[44:47], v[56:59]
    ds_read_b128 v[24:27], v124 offset:4096
    v_add_f32 v53, v53, v55
    v_mfma_f32_16x16x32_bf16 v[60:63], v[72:75], v[32:35], 0
    ds_read_b128 v[28:31], v124 offset:5120
    v_cvt_pk_bf16_f32 v114, v52, v53
    v_mov_b32 v53, 0
    v_mfma_f32_16x16x32_bf16 v[60:63], v[76:79], v[36:39], v[60:63]
    v_exp_f32 v56, v56
    v_mfma_f32_16x16x32_bf16 v[60:63], v[80:83], v[40:43], v[60:63]
    v_exp_f32 v57, v57
    v_mfma_f32_16x16x32_bf16 v[60:63], v[84:87], v[44:47], v[60:63]
    v_exp_f32 v58, v58
    v_mfma_f32_16x16x32_bf16 v[64:67], v[32:35], v[32:35], 0
    v_exp_f32 v59, v59
    v_cvt_pk_bf16_f32 v68, v56, v57
    v_mfma_f32_16x16x32_bf16 v[64:67], v[36:39], v[36:39], v[64:67]
    v_exp_f32 v60, v60
    v_cvt_pk_bf16_f32 v69, v58, v59
    v_mfma_f32_16x16x32_bf16 v[64:67], v[40:43], v[40:43], v[64:67]
    v_exp_f32 v61, v61
    v_mfma_f32_16x16x32_bf16 v[64:67], v[44:47], v[44:47], v[64:67]
    v_exp_f32 v62, v62
    v_exp_f32 v63, v63
    v_cvt_pk_bf16_f32 v70, v60, v61
    v_cvt_pk_bf16_f32 v71, v62, v63
    s_nop 1
    v_mfma_f32_16x16x32_bf16 v[72:75], v[88:91], v[68:71], 0
    s_nop 0
    v_exp_f32 v64, v64
    v_mfma_f32_16x16x32_bf16 v[76:79], v[92:95], v[68:71], 0
    v_exp_f32 v65, v65
    v_mfma_f32_16x16x32_bf16 v[80:83], v[48:51], v[68:71], 0
    v_cvt_pk_bf16_f32 v52, v64, v65
    s_nop 1
    v_mfma_f32_16x16x16_bf16 v[72:75], v[112:113], v[52:53], v[72:75]
    ds_read_b128 v[32:35], v124 offset:6144
    v_mfma_f32_16x16x16_bf16 v[76:79], v[114:115], v[52:53], v[76:79]
    ds_read_b128 v[36:39], v124 offset:7168
    v_mfma_f32_16x16x16_bf16 v[80:83], v[48:49], v[52:53], v[80:83]
L_norm_34:
    s_mov_b64 vcc, s[36:37]
    v_mov_b32 v122, v122
    v_mov_b32 v122, v122
    v_mov_b32 v122, v122
    v_cndmask_b32_dpp v76, v72, v76, vcc quad_perm:[2,3,2,3] row_mask:0xf bank_mask:0xf
    v_cndmask_b32_dpp v77, v73, v77, vcc quad_perm:[2,3,2,3] row_mask:0xf bank_mask:0xf
    v_cndmask_b32_dpp v78, v74, v78, vcc quad_perm:[2,3,2,3] row_mask:0xf bank_mask:0xf
    v_cndmask_b32_dpp v79, v75, v79, vcc quad_perm:[2,3,2,3] row_mask:0xf bank_mask:0xf
    v_rcp_f32_dpp v84, v80 quad_perm:[2,3,2,3] row_mask:0xf bank_mask:0xf
    s_nop 0
    v_pk_mul_f32 v[76:77], v[76:77], v[84:85] op_sel_hi:[1,0]
    v_pk_mul_f32 v[78:79], v[78:79], v[84:85] op_sel_hi:[1,0]
    v_cvt_pk_bf16_f32 v72, v76, v77
    v_cvt_pk_bf16_f32 v73, v78, v79
    ds_write_b64 v122, v[72:73] offset:21504
    v_max_f32_dpp v86, v80, v84 quad_perm:[2,3,2,3] row_mask:0xf bank_mask:0xf
    v_mov_b32_dpp v60, v72 quad_perm:[0,1,0,1] row_mask:0xf bank_mask:0xf
    v_mov_b32_dpp v61, v73 quad_perm:[0,1,0,1] row_mask:0xf bank_mask:0xf
    v_cmp_lt_f32 vcc, s35, v86
    v_mov_b32_dpp v62, v72 quad_perm:[2,3,2,3] row_mask:0xf bank_mask:0xf
    v_mov_b32_dpp v63, v73 quad_perm:[2,3,2,3] row_mask:0xf bank_mask:0xf
    s_nop 1
    v_smfmac_f32_16x16x64_bf16 v[96:99], v[60:63], v[192:199], v116
    s_cbranch_vccnz L_smax_35
    v_smfmac_f32_16x16x64_bf16 v[100:103], v[60:63], v[224:231], v116
    s_waitcnt lgkmcnt(0)
    s_barrier
    ds_read_b128 v[92:95], v127 offset:22016
    ds_read_b128 v[80:83], v127 offset:20480
    ds_read_b128 v[84:87], v127 offset:20992
    v_smfmac_f32_16x16x64_bf16 v[104:107], v[60:63], v[0:7], v116
    ds_read_b128 v[40:43], v124 offset:34816
    v_smfmac_f32_16x16x64_bf16 v[108:111], v[60:63], v[8:15], v116
    ds_read_b128 v[56:59], v124 offset:36864
    s_waitcnt lgkmcnt(4)
    v_smfmac_f32_16x16x64_bf16 v[96:99], v[92:95], v[200:207], v116
    s_waitcnt lgkmcnt(3)
    v_smfmac_f32_16x16x64_bf16 v[96:99], v[80:83], v[208:215], v116
    ds_read_b128 v[44:47], v124 offset:35840
    s_waitcnt lgkmcnt(3)
    v_smfmac_f32_16x16x64_bf16 v[96:99], v[84:87], v[216:223], v116
    ds_read_b128 v[68:71], v124 offset:39936
    v_smfmac_f32_16x16x64_bf16 v[100:103], v[92:95], v[232:239], v116
    ds_read_b128 v[64:67], v124 offset:38912
    v_smfmac_f32_16x16x64_bf16 v[100:103], v[80:83], v[240:247], v116
    ds_read_b128 v[60:63], v124 offset:37888
    v_cvt_pk_bf16_f32 v72, v96, v98
    v_smfmac_f32_16x16x64_bf16 v[100:103], v[84:87], v[248:255], v116
    v_and_or_b32 v72, v72, -2, s33
    v_smfmac_f32_16x16x64_bf16 v[104:107], v[92:95], v[16:23], v116
    v_cvt_pk_bf16_f32 v74, v97, v99
    v_smfmac_f32_16x16x64_bf16 v[104:107], v[80:83], v[24:31], v116
    v_cvt_pk_bf16_f32 v73, v100, v102
    v_cvt_pk_bf16_f32 v75, v101, v103
    v_smfmac_f32_16x16x64_bf16 v[104:107], v[84:87], v[32:39], v116
    buffer_store_dwordx4 v[72:75], v118, s[8:11], s25 offen
    s_waitcnt lgkmcnt(3)
    v_smfmac_f32_16x16x64_bf16 v[108:111], v[92:95], v[40:47], v116
    s_waitcnt lgkmcnt(0)
    v_smfmac_f32_16x16x64_bf16 v[108:111], v[80:83], v[56:63], v116
    v_cvt_pk_bf16_f32 v76, v104, v106
    v_smfmac_f32_16x16x64_bf16 v[108:111], v[84:87], v[64:71], v116
    v_and_or_b32 v76, v76, -2, s33
    v_cvt_pk_bf16_f32 v78, v105, v107
    v_mov_b32 v122, v122
    v_mov_b32 v122, v122
    v_mov_b32 v122, v122
    v_mov_b32 v122, v122
    v_mov_b32 v122, v122
    v_mov_b32 v122, v122
    v_cvt_pk_bf16_f32 v77, v108, v110
    v_cvt_pk_bf16_f32 v79, v109, v111
    buffer_store_dwordx4 v[76:79], v118, s[8:11], s26 offen
    ds_read_b128 v[80:83], v123
    ds_read_b128 v[84:87], v123 offset:1024
    ds_read_b128 v[56:59], v123 offset:2048
    ds_read_b128 v[60:63], v123 offset:3072
    ds_read_b128 v[64:67], v123 offset:32768
    ds_read_b128 v[68:71], v123 offset:33792
    ds_read_b128 v[72:75], v123 offset:34816
    ds_read_b128 v[76:79], v123 offset:35840
    ds_read_b128 v[88:91], v123 offset:4096
    ds_read_b128 v[92:95], v123 offset:5120
    ds_read_b128 v[96:99], v123 offset:6144
    ds_read_b128 v[100:103], v123 offset:7168
    ds_read_b128 v[104:107], v123 offset:36864
    ds_read_b128 v[108:111], v123 offset:37888
    ds_read_b128 v[24:27], v123 offset:38912
    ds_read_b128 v[28:31], v123 offset:39936
    s_add_u32 s30, s30, 0x40000
    s_add_u32 s31, s31, 0x40000
    s_add_u32 s32, s32, 0x20000
    s_add_u32 s23, s24, 2048
    s_add_u32 s48, s23, 4096
    s_xor_b32 s25, s25, 0x0
    s_xor_b32 s26, s26, 0x0
    s_mov_b32 s35, 0x49800000
    s_add_u32 s22, s22, 1
    v_cndmask_b32 v12, 0, v125, s[68:69]
    v_cndmask_b32 v13, 0, v125, s[70:71]
    v_cndmask_b32 v14, 0, v125, s[72:73]
    v_cndmask_b32 v15, 0, v125, s[74:75]
    v_mov_b32 v54, 0
    v_mov_b32 v55, 0
    v_mov_b32 v52, 0
    v_mov_b32 v52, 0
    v_mov_b32 v52, 0
    v_mov_b32 v52, 0
    v_mov_b32 v52, 0
    v_mov_b32 v52, 0
    v_mov_b32 v52, 0
    v_mov_b32 v52, 0
    v_mov_b32 v52, 0
    v_mov_b32 v52, 0
    v_mov_b32 v52, 0
    v_mov_b32 v52, 0
    v_mov_b32 v52, 0
    v_mov_b32 v52, 0
    v_mov_b32 v52, 0
    v_mov_b32 v52, 0
    v_mov_b32 v52, 0
    v_mov_b32 v52, 0
    v_mov_b32 v52, 0
    buffer_load_dwordx4 v[4:7], v117, s[8:11], s29 offen sc1
    buffer_load_dwordx4 v[8:11], v117, s[8:11], s53 offen sc1
    buffer_load_dwordx4 v[16:19], v117, s[8:11], s29 offen offset:2048 sc1
    buffer_load_dwordx4 v[20:23], v117, s[8:11], s53 offen offset:2048 sc1
    v_mov_b32 v52, 0
    v_mov_b32 v52, 0
    v_mov_b32 v52, 0
    v_mov_b32 v52, 0
    v_mov_b32 v52, 0
    v_mov_b32 v52, 0
    v_mov_b32 v52, 0
    v_mov_b32 v52, 0
    v_mov_b32 v52, 0
    v_mov_b32 v52, 0
    v_mov_b32 v52, 0
    v_mov_b32 v52, 0
    v_mov_b32 v52, 0
    v_mov_b32 v52, 0
    v_mov_b32 v52, 0
    v_mov_b32 v52, 0
    v_mov_b32 v52, 0
    v_mov_b32 v52, 0
    v_mov_b32 v52, 0
    v_mov_b32 v52, 0
    v_mov_b32 v52, 0
    v_mov_b32 v52, 0
    v_mov_b32 v52, 0
    v_mov_b32 v52, 0
    v_mov_b32 v52, 0
    v_mov_b32 v52, 0
    v_mov_b32 v52, 0
    v_mov_b32 v52, 0
    v_mov_b32 v52, 0
    v_mov_b32 v52, 0
    v_mov_b32 v52, 0
    v_mov_b32 v52, 0
    v_mov_b32 v52, 0
    v_mov_b32 v52, 0
    v_mov_b32 v52, 0
    v_mov_b32 v52, 0
    v_mov_b32 v52, 0
    v_mov_b32 v52, 0
    v_mov_b32 v52, 0
    v_mov_b32 v52, 0
    buffer_load_dwordx4 v[32:35], v117, s[8:11], s29 offen sc1
    buffer_load_dwordx4 v[36:39], v117, s[8:11], s53 offen sc1
    buffer_load_dwordx4 v[40:43], v117, s[8:11], s29 offen offset:2048 sc1
    buffer_load_dwordx4 v[44:47], v117, s[8:11], s53 offen offset:2048 sc1
    v_mov_b32 v52, 0
L_rl_36:
    s_waitcnt vmcnt(7)
    v_mfma_f32_16x16x32_bf16 v[48:51], v[4:7], v[12:15], 0
    v_xor_b32 v52, s33, v4
    s_waitcnt vmcnt(6)
    v_mfma_f32_16x16x32_bf16 v[48:51], v[8:11], v[12:15], v[48:51]
    v_xor_b32 v53, s33, v8
    v_or_b32 v52, v52, v53
    s_waitcnt vmcnt(5)
    v_mfma_f32_16x16x32_bf16 v[48:51], v[16:19], v[12:15], v[48:51]
    v_xor_b32 v53, s33, v16
    v_or_b32 v52, v52, v53
    s_waitcnt vmcnt(4)
    v_mfma_f32_16x16x32_bf16 v[48:51], v[20:23], v[12:15], v[48:51]
    v_xor_b32 v53, s33, v20
    v_or_b32 v52, v52, v53
    v_and_b32 v52, 1, v52
    v_cmp_ne_u32 vcc, 0, v52
    s_cbranch_vccnz L_rslow_37
L_rgo_38:
    s_nop 2
    v_permlane32_swap_b32 v48, v50
    v_permlane32_swap_b32 v49, v51
    v_pk_add_f32 v[48:49], v[48:49], v[50:51]
    s_mov_b64 exec, s[38:39]
    v_cvt_pk_bf16_f32 v12, v48, v49
    v_min_u32 v12, 0xfffffffe, v12
    buffer_store_dword v12, v119, s[8:11], s24 offen
    s_mov_b64 exec, -1
    s_add_u32 s24, s24, 8192
    s_bitset0_b32 s24, 15
    s_xor_b32 s55, s24, 16384
    s_xor_b32 s29, s29, 0x0
    s_xor_b32 s53, s29, 1024
    s_bfe_u32 s33, s22, 0x10000
    s_waitcnt lgkmcnt(0)
    s_branch L_chain_top2_f
.p2align 6
L_chain_top3_f:
    buffer_load_dwordx4 v[0:3], v117, s[8:11], s23 offen nt
    v_mov_b32 v48, 0
    v_mov_b32 v49, 0
    v_mov_b32 v50, 0
    v_mov_b32 v51, 0
    v_mov_b32 v52, 0
    v_mov_b32 v53, 0
    v_mov_b32 v15, 0
    v_mov_b32 v15, 0
    v_mov_b32 v15, 0
    v_mov_b32 v15, 0
    v_mov_b32 v15, 0
    v_mov_b32 v15, 0
    v_mov_b32 v15, 0
    v_mov_b32 v15, 0
    v_mov_b32 v15, 0
    v_mov_b32 v15, 0
    buffer_load_dwordx4 v[0:3], v117, s[8:11], s23 offen sc1
    s_waitcnt vmcnt(3)
    v_mov_b32 v36, 0
    v_mov_b32 v37, 0
    v_mov_b32 v38, 0
    v_mov_b32 v39, 0
    v_mov_b32 v40, 0
    v_mov_b32 v41, 0
    v_mov_b32 v42, 0
    v_mov_b32 v43, 0
    v_mov_b32 v44, 0
    v_mov_b32 v45, 0
    v_mov_b32 v46, 0
    v_mov_b32 v47, 0
    v_mov_b32 v15, 0
    v_mov_b32 v15, 0
    v_mov_b32 v15, 0
    v_mov_b32 v15, 0
L_mret_39:
    buffer_load_dwordx4 v[0:3], v117, s[8:11], s23 offen sc1
    s_add_u32 s45, s45, 1
    s_cmp_lt_u32 s45, 0x10000
    s_cselect_b32 s56, -2, -1
    s_nop 3
    v_mov_b32 v32, 0
    v_mov_b32 v33, 0
    v_mov_b32 v34, 0
    v_mov_b32 v35, 0
    s_waitcnt vmcnt(2)
    v_max3_u32 v15, v0, v1, v2
    v_max_u32 v15, v15, v3
    v_cmp_lt_u32 vcc, s56, v15
    v_smfmac_f32_16x16x64_bf16 v[32:35], v[0:3], v[80:87], v116
    s_cbranch_vccnz L_mret_39
    ds_write_b128 v117, v[0:3] offset:3072
    v_smfmac_f32_16x16x64_bf16 v[36:39], v[0:3], v[56:63], v116
    buffer_load_dwordx4 v[4:7], v117, s[8:11], s48 offen nt
    v_smfmac_f32_16x16x64_bf16 v[40:43], v[0:3], v[64:71], v116
    buffer_load_dwordx4 v117, s[8:11], s48 offen nt lds
    s_mov_b32 m0, 14336
    v_smfmac_f32_16x16x64_bf16 v[44:47], v[0:3], v[72:79], v116
    s_waitcnt lgkmcnt(0)
    s_barrier
    ds_read_b128 v[8:11], v117 offset:2048
    v_smfmac_f32_16x16x64_bf16 v[48:51], v[0:3], a[192:199], v116
    ds_read_b128 v[16:19], v117 offset:1024
    ds_read_b128 v[20:23], v117
    v_smfmac_f32_16x16x64_bf16 v[52:55], v[0:3], a[200:207], v116
    ds_read_b128 v[80:83], v117 offset:14336
    s_waitcnt lgkmcnt(3)
    v_smfmac_f32_16x16x64_bf16 v[32:35], v[8:11], a[0:7], v116
    ds_read_b128 v[84:87], v117 offset:15360
    v_smfmac_f32_16x16x64_bf16 v[36:39], v[8:11], a[8:15], v116
    ds_read_b128 v[56:59], v117 offset:8192
    s_waitcnt lgkmcnt(4)
    v_smfmac_f32_16x16x64_bf16 v[32:35], v[16:19], a[32:39], v116
    ds_read_b128 v[60:63], v117 offset:9216
    v_smfmac_f32_16x16x64_bf16 v[36:39], v[16:19], a[40:47], v116
    ds_read_b128 v[64:67], v117 offset:10240
    s_waitcnt lgkmcnt(5)
    v_smfmac_f32_16x16x64_bf16 v[32:35], v[20:23], a[64:71], v116
    ds_read_b128 v[68:71], v117 offset:11264
    v_smfmac_f32_16x16x64_bf16 v[36:39], v[20:23], a[72:79], v116
    ds_read_b128 v[72:75], v117 offset:12288
    v_smfmac_f32_16x16x64_bf16 v[40:43], v[8:11], a[96:103], v116
    ds_read_b128 v[76:79], v117 offset:13312
    v_smfmac_f32_16x16x64_bf16 v[40:43], v[16:19], a[128:135], v116
    buffer_store_dwordx4 v[112:115], v117, s[8:11], s32 offen sc1
    v_smfmac_f32_16x16x64_bf16 v[40:43], v[20:23], a[160:167], v116
    s_waitcnt vmcnt(2)
    v_max3_u32 v15, v4, v5, v6
    v_smfmac_f32_16x16x64_bf16 v[44:47], v[8:11], a[104:111], v116
    v_max_u32 v15, v15, v7
    v_smfmac_f32_16x16x64_bf16 v[44:47], v[16:19], a[136:143], v116
    s_waitcnt vmcnt(1) lgkmcnt(0)
    v_cmp_lt_u32 vcc, s56, v15
    v_smfmac_f32_16x16x64_bf16 v[44:47], v[20:23], a[168:175], v116
    s_cbranch_vccnz L_mret_40
L_mgo_41:
    v_smfmac_f32_16x16x64_bf16 v[44:47], v[4:7], v[24:31], v116
    s_barrier
    ds_read_b128 v[12:15], v117 offset:6144
    v_smfmac_f32_16x16x64_bf16 v[32:35], v[4:7], v[88:95], v116
    ds_read_b128 v[24:27], v117 offset:5120
    v_smfmac_f32_16x16x64_bf16 v[36:39], v[4:7], v[96:103], v116
    ds_read_b128 v[28:31], v117 offset:4096
    v_smfmac_f32_16x16x64_bf16 v[40:43], v[4:7], v[104:111], v116
    ds_read_b128 v[88:91], v117 offset:30720
    s_waitcnt lgkmcnt(3)
    v_smfmac_f32_16x16x64_bf16 v[32:35], v[12:15], a[16:23], v116
    ds_read_b128 v[92:95], v117 offset:31744
    s_waitcnt lgkmcnt(3)
    v_smfmac_f32_16x16x64_bf16 v[32:35], v[24:27], a[48:55], v116
    ds_read_b128 v[96:99], v117 offset:23552
    s_waitcnt lgkmcnt(3)
    v_smfmac_f32_16x16x64_bf16 v[32:35], v[28:31], a[80:87], v116
    buffer_load_dwordx4 v117, s[8:11], s30 offen lds
    v_smfmac_f32_16x16x64_bf16 v[36:39], v[12:15], a[24:31], v116
    ds_read_b128 v[100:103], v117 offset:23552
    v_smfmac_f32_16x16x64_bf16 v[36:39], v[24:27], a[56:63], v116
    ds_read_b128 v[104:107], v117 offset:23552
    v_add_f32 v32, v32, v34
    v_smfmac_f32_16x16x64_bf16 v[36:39], v[28:31], a[88:95], v116
    buffer_load_dwordx4 v117, s[8:11], s30 offen offset:1024 lds
    s_add_u32 m0, s52, 0x6000
    v_add_f32 v33, v33, v35
    v_smfmac_f32_16x16x64_bf16 v[40:43], v[12:15], a[112:119], v116
    ds_read_b128 v[108:111], v117 offset:23552
    v_mul_f32 v32, s34, v32
    v_smfmac_f32_16x16x64_bf16 v[40:43], v[24:27], a[144:151], v116
    ds_read_b128 v[0:3], v124
    v_mul_f32 v33, s34, v33
    v_smfmac_f32_16x16x64_bf16 v[40:43], v[28:31], a[176:183], v116
    s_waitcnt lgkmcnt(5)
    buffer_load_dwordx4 v117, s[8:11], s31 offen lds
    v_add_f32 v36, v36, v38
    v_smfmac_f32_16x16x64_bf16 v[48:51], v[4:7], a[208:215], v116
    v_add_f32 v37, v37, v39
    v_smfmac_f32_16x16x64_bf16 v[52:55], v[4:7], a[216:223], v116
    ds_read_b128 v[4:7], v124 offset:1024
    v_mul_f32 v36, s34, v36
    v_smfmac_f32_16x16x64_bf16 v[44:47], v[12:15], a[120:127], v116
    buffer_load_dwordx4 v117, s[8:11], s31 offen offset:1024 lds
    s_mov_b32 m0, 7168
    v_mul_f32 v37, s34, v37
    v_smfmac_f32_16x16x64_bf16 v[44:47], v[24:27], a[152:159], v116
    v_cvt_pk_bf16_f32 v34, v32, v36
    v_smfmac_f32_16x16x64_bf16 v[44:47], v[28:31], a[184:191], v116
    v_cvt_pk_bf16_f32 v35, v33, v37
    v_add_f32 v40, v40, v42
    v_smfmac_f32_16x16x64_bf16 v[48:51], v[8:11], a[224:231], v116
    ds_write2_b32 v120, v34, v35 offset0:32 offset1:48
    v_add_f32 v41, v41, v43
    v_smfmac_f32_16x16x64_bf16 v[52:55], v[8:11], a[232:239], v116
    v_add_f32 v44, v44, v46
    v_add_f32 v45, v45, v47
    v_cvt_pk_bf16_f32 v113, v40, v44
    v_cvt_pk_bf16_f32 v115, v41, v45
    v_smfmac_f32_16x16x64_bf16 v[48:51], v[12:15], a[240:247], v116
    ds_write2_b32 v120, v113, v115 offset0:0 offset1:16
    v_smfmac_f32_16x16x64_bf16 v[52:55], v[12:15], a[248:255], v116
    s_cmp_eq_u32 s22, 63
    s_cbranch_scc1 L_chain_last_f
    v_smfmac_f32_16x16x64_bf16 v[48:51], v[16:19], v[128:135], v116
    v_smfmac_f32_16x16x64_bf16 v[48:51], v[20:23], v[160:167], v116
    buffer_store_dword v126, v119, s[8:11], s55 offen
    v_smfmac_f32_16x16x64_bf16 v[48:51], v[24:27], v[144:151], v116
    s_waitcnt lgkmcnt(0)
    s_barrier
    v_smfmac_f32_16x16x64_bf16 v[48:51], v[28:31], v[176:183], v116
    ds_read_b128 v[32:35], v121 offset:16384
    ds_read_b128 v[36:39], v121 offset:17408
    v_smfmac_f32_16x16x64_bf16 v[52:55], v[16:19], v[136:143], v116
    ds_read_b128 v[40:43], v121 offset:18432
    ds_read_b128 v[44:47], v121 offset:19456
    v_smfmac_f32_16x16x64_bf16 v[52:55], v[20:23], v[168:175], v116
    ds_read_b128 v[8:11], v124 offset:32768
    v_add_f32 v48, v48, v50
    v_smfmac_f32_16x16x64_bf16 v[52:55], v[24:27], v[152:159], v116
    ds_read_b128 v[12:15], v124 offset:33792
    v_add_f32 v49, v49, v51
    v_smfmac_f32_16x16x64_bf16 v[52:55], v[28:31], v[184:191], v116
    s_waitcnt lgkmcnt(5)
    v_cvt_pk_bf16_f32 v112, v48, v49
    v_mfma_f32_16x16x32_bf16 v[56:59], v[56:59], v[32:35], 0
    s_waitcnt lgkmcnt(4)
    v_mov_b32 v48, s50
    v_mov_b32 v49, s50
    v_mfma_f32_16x16x32_bf16 v[56:59], v[60:63], v[36:39], v[56:59]
    ds_read_b128 v[16:19], v124 offset:2048
    s_waitcnt lgkmcnt(4)
    v_mov_b32 v50, s50
    v_mov_b32 v51, s50
    v_mfma_f32_16x16x32_bf16 v[56:59], v[64:67], v[40:43], v[56:59]
    ds_read_b128 v[20:23], v124 offset:3072
    s_waitcnt lgkmcnt(4)
    v_add_f32 v52, v52, v54
    v_mfma_f32_16x16x32_bf16 v[56:59], v[68:71], v[44:47], v[56:59]
    ds_read_b128 v[24:27], v124 offset:4096
    v_add_f32 v53, v53, v55
    v_mfma_f32_16x16x32_bf16 v[60:63], v[72:75], v[32:35], 0
    ds_read_b128 v[28:31], v124 offset:5120
    v_cvt_pk_bf16_f32 v114, v52, v53
    v_mov_b32 v53, 0
    v_mfma_f32_16x16x32_bf16 v[60:63], v[76:79], v[36:39], v[60:63]
    v_exp_f32 v56, v56
    v_mfma_f32_16x16x32_bf16 v[60:63], v[80:83], v[40:43], v[60:63]
    v_exp_f32 v57, v57
    v_mfma_f32_16x16x32_bf16 v[60:63], v[84:87], v[44:47], v[60:63]
    v_exp_f32 v58, v58
    v_mfma_f32_16x16x32_bf16 v[64:67], v[32:35], v[32:35], 0
    v_exp_f32 v59, v59
    v_cvt_pk_bf16_f32 v68, v56, v57
    v_mfma_f32_16x16x32_bf16 v[64:67], v[36:39], v[36:39], v[64:67]
    v_exp_f32 v60, v60
    v_cvt_pk_bf16_f32 v69, v58, v59
    v_mfma_f32_16x16x32_bf16 v[64:67], v[40:43], v[40:43], v[64:67]
    v_exp_f32 v61, v61
    v_mfma_f32_16x16x32_bf16 v[64:67], v[44:47], v[44:47], v[64:67]
    v_exp_f32 v62, v62
    v_exp_f32 v63, v63
    v_cvt_pk_bf16_f32 v70, v60, v61
    v_cvt_pk_bf16_f32 v71, v62, v63
    s_nop 1
    v_mfma_f32_16x16x32_bf16 v[72:75], v[88:91], v[68:71], 0
    s_nop 0
    v_exp_f32 v64, v64
    v_mfma_f32_16x16x32_bf16 v[76:79], v[92:95], v[68:71], 0
    v_exp_f32 v65, v65
    v_mfma_f32_16x16x32_bf16 v[80:83], v[48:51], v[68:71], 0
    v_cvt_pk_bf16_f32 v52, v64, v65
    s_nop 1
    v_mfma_f32_16x16x16_bf16 v[72:75], v[112:113], v[52:53], v[72:75]
    ds_read_b128 v[32:35], v124 offset:6144
    v_mfma_f32_16x16x16_bf16 v[76:79], v[114:115], v[52:53], v[76:79]
    ds_read_b128 v[36:39], v124 offset:7168
    v_mfma_f32_16x16x16_bf16 v[80:83], v[48:49], v[52:53], v[80:83]
L_norm_42:
    s_mov_b64 vcc, s[36:37]
    v_mov_b32 v122, v122
    v_mov_b32 v122, v122
    v_mov_b32 v122, v122
    v_cndmask_b32_dpp v76, v72, v76, vcc quad_perm:[2,3,2,3] row_mask:0xf bank_mask:0xf
    v_cndmask_b32_dpp v77, v73, v77, vcc quad_perm:[2,3,2,3] row_mask:0xf bank_mask:0xf
    v_cndmask_b32_dpp v78, v74, v78, vcc quad_perm:[2,3,2,3] row_mask:0xf bank_mask:0xf
    v_cndmask_b32_dpp v79, v75, v79, vcc quad_perm:[2,3,2,3] row_mask:0xf bank_mask:0xf
    v_rcp_f32_dpp v84, v80 quad_perm:[2,3,2,3] row_mask:0xf bank_mask:0xf
    s_nop 0
    v_pk_mul_f32 v[76:77], v[76:77], v[84:85] op_sel_hi:[1,0]
    v_pk_mul_f32 v[78:79], v[78:79], v[84:85] op_sel_hi:[1,0]
    v_cvt_pk_bf16_f32 v72, v76, v77
    v_cvt_pk_bf16_f32 v73, v78, v79
    ds_write_b64 v122, v[72:73] offset:22016
    v_max_f32_dpp v86, v80, v84 quad_perm:[2,3,2,3] row_mask:0xf bank_mask:0xf
    v_mov_b32_dpp v60, v72 quad_perm:[0,1,0,1] row_mask:0xf bank_mask:0xf
    v_mov_b32_dpp v61, v73 quad_perm:[0,1,0,1] row_mask:0xf bank_mask:0xf
    v_cmp_lt_f32 vcc, s35, v86
    v_mov_b32_dpp v62, v72 quad_perm:[2,3,2,3] row_mask:0xf bank_mask:0xf
    v_mov_b32_dpp v63, v73 quad_perm:[2,3,2,3] row_mask:0xf bank_mask:0xf
    s_nop 1
    v_smfmac_f32_16x16x64_bf16 v[96:99], v[60:63], v[192:199], v116
    s_cbranch_vccnz L_smax_43
    v_smfmac_f32_16x16x64_bf16 v[100:103], v[60:63], v[224:231], v116
    s_waitcnt lgkmcnt(0)
    s_barrier
    ds_read_b128 v[92:95], v127 offset:21504
    ds_read_b128 v[80:83], v127 offset:20992
    ds_read_b128 v[84:87], v127 offset:20480
    v_smfmac_f32_16x16x64_bf16 v[104:107], v[60:63], v[0:7], v116
    ds_read_b128 v[40:43], v124 offset:34816
    v_smfmac_f32_16x16x64_bf16 v[108:111], v[60:63], v[8:15], v116
    ds_read_b128 v[56:59], v124 offset:36864
    s_waitcnt lgkmcnt(4)
    v_smfmac_f32_16x16x64_bf16 v[96:99], v[92:95], v[200:207], v116
    s_waitcnt lgkmcnt(3)
    v_smfmac_f32_16x16x64_bf16 v[96:99], v[80:83], v[208:215], v116
    ds_read_b128 v[44:47], v124 offset:35840
    s_waitcnt lgkmcnt(3)
    v_smfmac_f32_16x16x64_bf16 v[96:99], v[84:87], v[216:223], v116
    ds_read_b128 v[68:71], v124 offset:39936
    v_smfmac_f32_16x16x64_bf16 v[100:103], v[92:95], v[232:239], v116
    ds_read_b128 v[64:67], v124 offset:38912
    v_smfmac_f32_16x16x64_bf16 v[100:103], v[80:83], v[240:247], v116
    ds_read_b128 v[60:63], v124 offset:37888
    v_cvt_pk_bf16_f32 v72, v96, v98
    v_smfmac_f32_16x16x64_bf16 v[100:103], v[84:87], v[248:255], v116
    v_and_or_b32 v72, v72, -2, s33
    v_smfmac_f32_16x16x64_bf16 v[104:107], v[92:95], v[16:23], v116
    v_cvt_pk_bf16_f32 v74, v97, v99
    v_smfmac_f32_16x16x64_bf16 v[104:107], v[80:83], v[24:31], v116
    v_cvt_pk_bf16_f32 v73, v100, v102
    v_cvt_pk_bf16_f32 v75, v101, v103
    v_smfmac_f32_16x16x64_bf16 v[104:107], v[84:87], v[32:39], v116
    buffer_store_dwordx4 v[72:75], v118, s[8:11], s25 offen
    s_waitcnt lgkmcnt(3)
    v_smfmac_f32_16x16x64_bf16 v[108:111], v[92:95], v[40:47], v116
    s_waitcnt lgkmcnt(0)
    v_smfmac_f32_16x16x64_bf16 v[108:111], v[80:83], v[56:63], v116
    v_cvt_pk_bf16_f32 v76, v104, v106
    v_smfmac_f32_16x16x64_bf16 v[108:111], v[84:87], v[64:71], v116
    v_and_or_b32 v76, v76, -2, s33
    v_cvt_pk_bf16_f32 v78, v105, v107
    v_mov_b32 v122, v122
    v_mov_b32 v122, v122
    v_mov_b32 v122, v122
    v_mov_b32 v122, v122
    v_mov_b32 v122, v122
    v_mov_b32 v122, v122
    v_cvt_pk_bf16_f32 v77, v108, v110
    v_cvt_pk_bf16_f32 v79, v109, v111
    buffer_store_dwordx4 v[76:79], v118, s[8:11], s26 offen
    ds_read_b128 v[80:83], v123
    ds_read_b128 v[84:87], v123 offset:1024
    ds_read_b128 v[56:59], v123 offset:2048
    ds_read_b128 v[60:63], v123 offset:3072
    ds_read_b128 v[64:67], v123 offset:32768
    ds_read_b128 v[68:71], v123 offset:33792
    ds_read_b128 v[72:75], v123 offset:34816
    ds_read_b128 v[76:79], v123 offset:35840
    ds_read_b128 v[88:91], v123 offset:4096
    ds_read_b128 v[92:95], v123 offset:5120
    ds_read_b128 v[96:99], v123 offset:6144
    ds_read_b128 v[100:103], v123 offset:7168
    ds_read_b128 v[104:107], v123 offset:36864
    ds_read_b128 v[108:111], v123 offset:37888
    ds_read_b128 v[24:27], v123 offset:38912
    ds_read_b128 v[28:31], v123 offset:39936
    s_add_u32 s30, s30, 0x40000
    s_add_u32 s31, s31, 0x40000
    s_add_u32 s32, s32, 0x20000
    s_add_u32 s23, s24, 3072
    s_add_u32 s48, s23, 4096
    s_xor_b32 s25, s25, 0x0
    s_xor_b32 s26, s26, 0x0
    s_mov_b32 s35, 0x49800000
    s_add_u32 s22, s22, 1
    v_cndmask_b32 v12, 0, v125, s[68:69]
    v_cndmask_b32 v13, 0, v125, s[70:71]
    v_cndmask_b32 v14, 0, v125, s[72:73]
    v_cndmask_b32 v15, 0, v125, s[74:75]
    v_mov_b32 v54, 0
    v_mov_b32 v55, 0
    v_mov_b32 v52, 0
    v_mov_b32 v52, 0
    v_mov_b32 v52, 0
    v_mov_b32 v52, 0
    v_mov_b32 v52, 0
    v_mov_b32 v52, 0
    v_mov_b32 v52, 0
    v_mov_b32 v52, 0
    v_mov_b32 v52, 0
    v_mov_b32 v52, 0
    v_mov_b32 v52, 0
    v_mov_b32 v52, 0
    v_mov_b32 v52, 0
    v_mov_b32 v52, 0
    v_mov_b32 v52, 0
    v_mov_b32 v52, 0
    v_mov_b32 v52, 0
    v_mov_b32 v52, 0
    v_mov_b32 v52, 0
    v_mov_b32 v52, 0
    v_mov_b32 v52, 0
    v_mov_b32 v52, 0
    v_mov_b32 v52, 0
    v_mov_b32 v52, 0
    v_mov_b32 v52, 0
    v_mov_b32 v52, 0
    v_mov_b32 v52, 0
    v_mov_b32 v52, 0
    v_mov_b32 v52, 0
    v_mov_b32 v52, 0
    v_mov_b32 v52, 0
    v_mov_b32 v52, 0
    v_mov_b32 v52, 0
    v_mov_b32 v52, 0
    v_mov_b32 v52, 0
    v_mov_b32 v52, 0
    v_mov_b32 v52, 0
    v_mov_b32 v52, 0
    v_mov_b32 v52, 0
    v_mov_b32 v52, 0
    v_mov_b32 v52, 0
    v_mov_b32 v52, 0
    v_mov_b32 v52, 0
    v_mov_b32 v52, 0
    v_mov_b32 v52, 0
    v_mov_b32 v52, 0
    v_mov_b32 v52, 0
    v_mov_b32 v52, 0
    v_mov_b32 v52, 0
    buffer_load_dwordx4 v[4:7], v117, s[8:11], s29 offen sc1
    buffer_load_dwordx4 v[8:11], v117, s[8:11], s53 offen sc1
    buffer_load_dwordx4 v[16:19], v117, s[8:11], s29 offen offset:2048 sc1
    buffer_load_dwordx4 v[20:23], v117, s[8:11], s53 offen offset:2048 sc1
    v_mov_b32 v52, 0
    v_mov_b32 v52, 0
    v_mov_b32 v52, 0
    v_mov_b32 v52, 0
    v_mov_b32 v52, 0
    v_mov_b32 v52, 0
    v_mov_b32 v52, 0
    v_mov_b32 v52, 0
    v_mov_b32 v52, 0
    v_mov_b32 v52, 0
    v_mov_b32 v52, 0
    v_mov_b32 v52, 0
    v_mov_b32 v52, 0
    v_mov_b32 v52, 0
    v_mov_b32 v52, 0
    v_mov_b32 v52, 0
    v_mov_b32 v52, 0
    v_mov_b32 v52, 0
    v_mov_b32 v52, 0
    v_mov_b32 v52, 0
    v_mov_b32 v52, 0
    v_mov_b32 v52, 0
    v_mov_b32 v52, 0
    v_mov_b32 v52, 0
    v_mov_b32 v52, 0
    v_mov_b32 v52, 0
    v_mov_b32 v52, 0
    v_mov_b32 v52, 0
    v_mov_b32 v52, 0
    v_mov_b32 v52, 0
    buffer_load_dwordx4 v[32:35], v117, s[8:11], s29 offen sc1
    buffer_load_dwordx4 v[36:39], v117, s[8:11], s53 offen sc1
    buffer_load_dwordx4 v[40:43], v117, s[8:11], s29 offen offset:2048 sc1
    buffer_load_dwordx4 v[44:47], v117, s[8:11], s53 offen offset:2048 sc1
    v_mov_b32 v52, 0
L_rl_44:
    s_waitcnt vmcnt(7)
    v_mfma_f32_16x16x32_bf16 v[48:51], v[4:7], v[12:15], 0
    v_xor_b32 v52, s33, v4
    s_waitcnt vmcnt(6)
    v_mfma_f32_16x16x32_bf16 v[48:51], v[8:11], v[12:15], v[48:51]
    v_xor_b32 v53, s33, v8
    v_or_b32 v52, v52, v53
    s_waitcnt vmcnt(5)
    v_mfma_f32_16x16x32_bf16 v[48:51], v[16:19], v[12:15], v[48:51]
    v_xor_b32 v53, s33, v16
    v_or_b32 v52, v52, v53
    s_waitcnt vmcnt(4)
    v_mfma_f32_16x16x32_bf16 v[48:51], v[20:23], v[12:15], v[48:51]
    v_xor_b32 v53, s33, v20
    v_or_b32 v52, v52, v53
    v_and_b32 v52, 1, v52
    v_cmp_ne_u32 vcc, 0, v52
    s_cbranch_vccnz L_rslow_45
L_rgo_46:
    s_nop 2
    v_permlane32_swap_b32 v48, v50
    v_permlane32_swap_b32 v49, v51
    v_pk_add_f32 v[48:49], v[48:49], v[50:51]
    s_mov_b64 exec, s[38:39]
    v_cvt_pk_bf16_f32 v12, v48, v49
    v_min_u32 v12, 0xfffffffe, v12
    buffer_store_dword v12, v119, s[8:11], s24 offen
    s_mov_b64 exec, -1
    s_add_u32 s24, s24, 8192
    s_bitset0_b32 s24, 15
    s_xor_b32 s55, s24, 16384
    s_xor_b32 s29, s29, 0x0
    s_xor_b32 s53, s29, 1024
    s_bfe_u32 s33, s22, 0x10000
    s_waitcnt lgkmcnt(0)
    s_branch L_chain_top3_f
L_chain_last_f:
    s_nop 1
    v_smfmac_f32_16x16x64_bf16 v[48:51], v[16:19], v[128:135], v116
    v_smfmac_f32_16x16x64_bf16 v[48:51], v[20:23], v[160:167], v116
    v_smfmac_f32_16x16x64_bf16 v[48:51], v[24:27], v[144:151], v116
    v_smfmac_f32_16x16x64_bf16 v[48:51], v[28:31], v[176:183], v116
    v_smfmac_f32_16x16x64_bf16 v[52:55], v[16:19], v[136:143], v116
    v_smfmac_f32_16x16x64_bf16 v[52:55], v[20:23], v[168:175], v116
    v_smfmac_f32_16x16x64_bf16 v[52:55], v[24:27], v[152:159], v116
    v_smfmac_f32_16x16x64_bf16 v[52:55], v[28:31], v[184:191], v116
    v_add_f32 v48, v48, v50
    v_add_f32 v49, v49, v51
    v_cvt_pk_bf16_f32 v112, v48, v49
    s_nop 4
    v_add_f32 v52, v52, v54
    v_add_f32 v53, v53, v55
    v_cvt_pk_bf16_f32 v114, v52, v53
    s_add_u32 s32, s32, 0x20000
    buffer_store_dwordx4 v[112:115], v117, s[8:11], s32 offen sc1
    v_mov_b32 v94, 64
    s_waitcnt vmcnt(0) lgkmcnt(0)
    s_barrier
    s_mov_b64 exec, 1
    buffer_store_dword v94, off, s[8:11], s44 sc1
    s_mov_b64 exec, -1
    s_endpgm
L_mret_18:
    s_mov_b32 s43, m0
    s_mov_b32 m0, 4096
    buffer_load_dwordx4 v[4:7], v117, s[8:11], s48 offen sc1
    buffer_load_dwordx4 v117, s[8:11], s48 offen sc1 lds
    s_mov_b32 m0, 8192
    s_mov_b32 m0, s43
    s_waitcnt vmcnt(0)
    v_max3_u32 v15, v4, v5, v6
    v_max_u32 v15, v15, v7
    v_cmp_lt_u32 vcc, s56, v15
    s_add_u32 s47, s47, 1
    s_add_u32 s49, s49, 1
    s_cmp_ge_u32 s49, 0x10000
    s_cbranch_scc1 L_mgo_19
    s_cbranch_vccnz L_mret_18
    s_branch L_mgo_19
L_smax_21:
    s_add_u32 s47, s47, 1
    s_mov_b32 s35, 0x7f800000
    s_waitcnt lgkmcnt(0)
    s_sub_u32 s43, s30, 0x40000
    s_add_u32 s40, s43, 4096
    s_nop 7
    buffer_load_dwordx4 v[56:59], v117, s[8:11], s43 offen
    buffer_load_dwordx4 v[60:63], v117, s[8:11], s43 offen offset:1024
    buffer_load_dwordx4 v[64:67], v117, s[8:11], s43 offen offset:2048
    buffer_load_dwordx4 v[68:71], v117, s[8:11], s43 offen offset:3072
    buffer_load_dwordx4 v[72:75], v117, s[8:11], s40 offen
    buffer_load_dwordx4 v[76:79], v117, s[8:11], s40 offen offset:1024
    buffer_load_dwordx4 v[80:83], v117, s[8:11], s40 offen offset:2048
    buffer_load_dwordx4 v[84:87], v117, s[8:11], s40 offen offset:3072
    ds_read_b128 v[32:35], v121 offset:16384
    ds_read_b128 v[36:39], v121 offset:17408
    ds_read_b128 v[40:43], v121 offset:18432
    ds_read_b128 v[44:47], v121 offset:19456
    v_mov_b32 v96, 0
    v_mov_b32 v97, 0
    v_mov_b32 v98, 0
    v_mov_b32 v99, 0
    v_mov_b32 v100, 0
    v_mov_b32 v101, 0
    v_mov_b32 v102, 0
    v_mov_b32 v103, 0
    v_mov_b32 v104, 0
    v_mov_b32 v105, 0
    v_mov_b32 v106, 0
    v_mov_b32 v107, 0
    v_mov_b32 v108, 0
    v_mov_b32 v109, 0
    v_mov_b32 v110, 0
    v_mov_b32 v111, 0
    s_waitcnt vmcnt(0) lgkmcnt(0)
    v_mfma_f32_16x16x32_bf16 v[56:59], v[56:59], v[32:35], 0
    v_mfma_f32_16x16x32_bf16 v[56:59], v[60:63], v[36:39], v[56:59]
    v_mfma_f32_16x16x32_bf16 v[56:59], v[64:67], v[40:43], v[56:59]
    v_mfma_f32_16x16x32_bf16 v[56:59], v[68:71], v[44:47], v[56:59]
    v_mfma_f32_16x16x32_bf16 v[60:63], v[72:75], v[32:35], 0
    v_mfma_f32_16x16x32_bf16 v[60:63], v[76:79], v[36:39], v[60:63]
    v_mfma_f32_16x16x32_bf16 v[60:63], v[80:83], v[40:43], v[60:63]
    v_mfma_f32_16x16x32_bf16 v[60:63], v[84:87], v[44:47], v[60:63]
    v_mfma_f32_16x16x32_bf16 v[64:67], v[32:35], v[32:35], 0
    v_mfma_f32_16x16x32_bf16 v[64:67], v[36:39], v[36:39], v[64:67]
    v_mfma_f32_16x16x32_bf16 v[64:67], v[40:43], v[40:43], v[64:67]
    v_mfma_f32_16x16x32_bf16 v[64:67], v[44:47], v[44:47], v[64:67]
    v_max3_f32 v84, v56, v57, v58
    v_max3_f32 v84, v84, v59, v60
    v_max3_f32 v84, v84, v61, v62
    s_nop 4
    v_max3_f32 v84, v84, v63, v64
    v_max_f32 v84, v84, v65
    v_mov_b32 v85, v84
    s_nop 1
    v_permlane32_swap_b32 v85, v84
    v_max_f32 v84, v85, v84
    v_mov_b32 v85, v84
    s_nop 1
    v_permlane16_swap_b32 v85, v84
    v_max_f32 v84, v85, v84
    v_sub_f32 v56, v56, v84
    v_sub_f32 v57, v57, v84
    v_sub_f32 v58, v58, v84
    v_sub_f32 v59, v59, v84
    v_sub_f32 v60, v60, v84
    v_sub_f32 v61, v61, v84
    v_sub_f32 v62, v62, v84
    v_sub_f32 v63, v63, v84
    v_sub_f32 v64, v64, v84
    v_sub_f32 v65, v65, v84
    v_exp_f32 v56, v56
    v_exp_f32 v57, v57
    v_exp_f32 v58, v58
    v_exp_f32 v59, v59
    v_exp_f32 v60, v60
    v_exp_f32 v61, v61
    v_exp_f32 v62, v62
    v_exp_f32 v63, v63
    v_exp_f32 v64, v64
    v_exp_f32 v65, v65
    v_cvt_pk_bf16_f32 v68, v56, v57
    v_cvt_pk_bf16_f32 v69, v58, v59
    v_cvt_pk_bf16_f32 v70, v60, v61
    v_cvt_pk_bf16_f32 v71, v62, v63
    v_cvt_pk_bf16_f32 v52, v64, v65
    s_nop 0
    v_mfma_f32_16x16x32_bf16 v[72:75], v[88:91], v[68:71], 0
    v_mfma_f32_16x16x32_bf16 v[76:79], v[92:95], v[68:71], 0
    v_mfma_f32_16x16x32_bf16 v[80:83], v[48:51], v[68:71], 0
    v_mfma_f32_16x16x16_bf16 v[72:75], v[112:113], v[52:53], v[72:75]
    v_mfma_f32_16x16x16_bf16 v[76:79], v[114:115], v[52:53], v[76:79]
    v_mfma_f32_16x16x16_bf16 v[80:83], v[48:49], v[52:53], v[80:83]
    ds_read_b128 v[32:35], v124 offset:6144
    ds_read_b128 v[36:39], v124 offset:7168
    ds_read_b128 v[40:43], v124 offset:34816
    ds_read_b128 v[44:47], v124 offset:35840
    ds_read_b128 v[56:59], v124 offset:36864
    ds_read_b128 v[64:67], v124 offset:38912
    ds_read_b128 v[68:71], v124 offset:39936
    s_waitcnt lgkmcnt(0)
    s_branch L_norm_20
L_kvw_22:
    s_add_u32 s47, s47, 1
    s_add_u32 s49, s49, 1
    s_cmp_ge_u32 s49, 0x10000
    s_cbranch_scc1 L_kvb_23
    s_sleep 4
    buffer_load_dword v125, v119, s[8:11], s28 offen sc1
    s_waitcnt vmcnt(0)
    v_cmp_eq_u32 vcc, 0, v125
    s_nop 0
    s_and_b64 vcc, vcc, s[58:59]
    s_cbranch_scc1 L_kvw_22
    s_branch L_kvb_23
L_mret_25:
    s_mov_b32 s43, m0
    s_mov_b32 m0, 5120
    buffer_load_dwordx4 v[4:7], v117, s[8:11], s48 offen sc1
    buffer_load_dwordx4 v117, s[8:11], s48 offen sc1 lds
    s_mov_b32 m0, 10240
    s_mov_b32 m0, s43
    s_waitcnt vmcnt(0)
    v_max3_u32 v15, v4, v5, v6
    v_max_u32 v15, v15, v7
    v_cmp_lt_u32 vcc, s56, v15
    s_add_u32 s47, s47, 1
    s_add_u32 s49, s49, 1
    s_cmp_ge_u32 s49, 0x10000
    s_cbranch_scc1 L_mgo_26
    s_cbranch_vccnz L_mret_25
    s_branch L_mgo_26
L_smax_28:
    s_add_u32 s47, s47, 1
    s_mov_b32 s35, 0x7f800000
    s_waitcnt lgkmcnt(0)
    s_sub_u32 s43, s30, 0x40800
    s_add_u32 s40, s43, 4096
    s_nop 7
    buffer_load_dwordx4 v[56:59], v117, s[8:11], s43 offen
    buffer_load_dwordx4 v[60:63], v117, s[8:11], s43 offen offset:1024
    buffer_load_dwordx4 v[64:67], v117, s[8:11], s43 offen offset:2048
    buffer_load_dwordx4 v[68:71], v117, s[8:11], s43 offen offset:3072
    buffer_load_dwordx4 v[72:75], v117, s[8:11], s40 offen
    buffer_load_dwordx4 v[76:79], v117, s[8:11], s40 offen offset:1024
    buffer_load_dwordx4 v[80:83], v117, s[8:11], s40 offen offset:2048
    buffer_load_dwordx4 v[84:87], v117, s[8:11], s40 offen offset:3072
    ds_read_b128 v[32:35], v121 offset:16384
    ds_read_b128 v[36:39], v121 offset:17408
    ds_read_b128 v[40:43], v121 offset:18432
    ds_read_b128 v[44:47], v121 offset:19456
    v_mov_b32 v96, 0
    v_mov_b32 v97, 0
    v_mov_b32 v98, 0
    v_mov_b32 v99, 0
    v_mov_b32 v100, 0
    v_mov_b32 v101, 0
    v_mov_b32 v102, 0
    v_mov_b32 v103, 0
    v_mov_b32 v104, 0
    v_mov_b32 v105, 0
    v_mov_b32 v106, 0
    v_mov_b32 v107, 0
    v_mov_b32 v108, 0
    v_mov_b32 v109, 0
    v_mov_b32 v110, 0
    v_mov_b32 v111, 0
    s_waitcnt vmcnt(0) lgkmcnt(0)
    v_mfma_f32_16x16x32_bf16 v[56:59], v[56:59], v[32:35], 0
    v_mfma_f32_16x16x32_bf16 v[56:59], v[60:63], v[36:39], v[56:59]
    v_mfma_f32_16x16x32_bf16 v[56:59], v[64:67], v[40:43], v[56:59]
    v_mfma_f32_16x16x32_bf16 v[56:59], v[68:71], v[44:47], v[56:59]
    v_mfma_f32_16x16x32_bf16 v[60:63], v[72:75], v[32:35], 0
    v_mfma_f32_16x16x32_bf16 v[60:63], v[76:79], v[36:39], v[60:63]
    v_mfma_f32_16x16x32_bf16 v[60:63], v[80:83], v[40:43], v[60:63]
    v_mfma_f32_16x16x32_bf16 v[60:63], v[84:87], v[44:47], v[60:63]
    v_mfma_f32_16x16x32_bf16 v[64:67], v[32:35], v[32:35], 0
    v_mfma_f32_16x16x32_bf16 v[64:67], v[36:39], v[36:39], v[64:67]
    v_mfma_f32_16x16x32_bf16 v[64:67], v[40:43], v[40:43], v[64:67]
    v_mfma_f32_16x16x32_bf16 v[64:67], v[44:47], v[44:47], v[64:67]
    v_max3_f32 v84, v56, v57, v58
    v_max3_f32 v84, v84, v59, v60
    v_max3_f32 v84, v84, v61, v62
    s_nop 4
    v_max3_f32 v84, v84, v63, v64
    v_max_f32 v84, v84, v65
    v_mov_b32 v85, v84
    s_nop 1
    v_permlane32_swap_b32 v85, v84
    v_max_f32 v84, v85, v84
    v_mov_b32 v85, v84
    s_nop 1
    v_permlane16_swap_b32 v85, v84
    v_max_f32 v84, v85, v84
    v_sub_f32 v56, v56, v84
    v_sub_f32 v57, v57, v84
    v_sub_f32 v58, v58, v84
    v_sub_f32 v59, v59, v84
    v_sub_f32 v60, v60, v84
    v_sub_f32 v61, v61, v84
    v_sub_f32 v62, v62, v84
    v_sub_f32 v63, v63, v84
    v_sub_f32 v64, v64, v84
    v_sub_f32 v65, v65, v84
    v_exp_f32 v56, v56
    v_exp_f32 v57, v57
    v_exp_f32 v58, v58
    v_exp_f32 v59, v59
    v_exp_f32 v60, v60
    v_exp_f32 v61, v61
    v_exp_f32 v62, v62
    v_exp_f32 v63, v63
    v_exp_f32 v64, v64
    v_exp_f32 v65, v65
    v_cvt_pk_bf16_f32 v68, v56, v57
    v_cvt_pk_bf16_f32 v69, v58, v59
    v_cvt_pk_bf16_f32 v70, v60, v61
    v_cvt_pk_bf16_f32 v71, v62, v63
    v_cvt_pk_bf16_f32 v52, v64, v65
    s_nop 0
    v_mfma_f32_16x16x32_bf16 v[72:75], v[88:91], v[68:71], 0
    v_mfma_f32_16x16x32_bf16 v[76:79], v[92:95], v[68:71], 0
    v_mfma_f32_16x16x32_bf16 v[80:83], v[48:51], v[68:71], 0
    v_mfma_f32_16x16x16_bf16 v[72:75], v[112:113], v[52:53], v[72:75]
    v_mfma_f32_16x16x16_bf16 v[76:79], v[114:115], v[52:53], v[76:79]
    v_mfma_f32_16x16x16_bf16 v[80:83], v[48:49], v[52:53], v[80:83]
    ds_read_b128 v[32:35], v124 offset:6144
    ds_read_b128 v[36:39], v124 offset:7168
    ds_read_b128 v[40:43], v124 offset:34816
    ds_read_b128 v[44:47], v124 offset:35840
    ds_read_b128 v[56:59], v124 offset:36864
    ds_read_b128 v[64:67], v124 offset:38912
    ds_read_b128 v[68:71], v124 offset:39936
    s_waitcnt lgkmcnt(0)
    s_branch L_norm_27
L_kvw_29:
    s_add_u32 s47, s47, 1
    s_add_u32 s49, s49, 1
    s_cmp_ge_u32 s49, 0x10000
    s_cbranch_scc1 L_kvb_30
    s_sleep 4
    buffer_load_dword v125, v119, s[8:11], s28 offen sc1
    s_waitcnt vmcnt(0)
    v_cmp_eq_u32 vcc, 0, v125
    s_nop 0
    s_and_b64 vcc, vcc, s[58:59]
    s_cbranch_scc1 L_kvw_29
    s_branch L_kvb_30
L_mret_32:
    s_mov_b32 s43, m0
    s_mov_b32 m0, 6144
    buffer_load_dwordx4 v[4:7], v117, s[8:11], s48 offen sc1
    buffer_load_dwordx4 v117, s[8:11], s48 offen sc1 lds
    s_mov_b32 m0, 12288
    s_mov_b32 m0, s43
    s_waitcnt vmcnt(0)
    v_max3_u32 v15, v4, v5, v6
    v_max_u32 v15, v15, v7
    v_cmp_lt_u32 vcc, s56, v15
    s_add_u32 s47, s47, 1
    s_add_u32 s49, s49, 1
    s_cmp_ge_u32 s49, 0x10000
    s_cbranch_scc1 L_mgo_33
    s_cbranch_vccnz L_mret_32
    s_branch L_mgo_33
L_smax_35:
    s_add_u32 s47, s47, 1
    s_mov_b32 s35, 0x7f800000
    s_waitcnt lgkmcnt(0)
    s_sub_u32 s43, s30, 0x41000
    s_add_u32 s40, s43, 4096
    s_nop 7
    buffer_load_dwordx4 v[56:59], v117, s[8:11], s43 offen
    buffer_load_dwordx4 v[60:63], v117, s[8:11], s43 offen offset:1024
    buffer_load_dwordx4 v[64:67], v117, s[8:11], s43 offen offset:2048
    buffer_load_dwordx4 v[68:71], v117, s[8:11], s43 offen offset:3072
    buffer_load_dwordx4 v[72:75], v117, s[8:11], s40 offen
    buffer_load_dwordx4 v[76:79], v117, s[8:11], s40 offen offset:1024
    buffer_load_dwordx4 v[80:83], v117, s[8:11], s40 offen offset:2048
    buffer_load_dwordx4 v[84:87], v117, s[8:11], s40 offen offset:3072
    ds_read_b128 v[32:35], v121 offset:16384
    ds_read_b128 v[36:39], v121 offset:17408
    ds_read_b128 v[40:43], v121 offset:18432
    ds_read_b128 v[44:47], v121 offset:19456
    v_mov_b32 v96, 0
    v_mov_b32 v97, 0
    v_mov_b32 v98, 0
    v_mov_b32 v99, 0
    v_mov_b32 v100, 0
    v_mov_b32 v101, 0
    v_mov_b32 v102, 0
    v_mov_b32 v103, 0
    v_mov_b32 v104, 0
    v_mov_b32 v105, 0
    v_mov_b32 v106, 0
    v_mov_b32 v107, 0
    v_mov_b32 v108, 0
    v_mov_b32 v109, 0
    v_mov_b32 v110, 0
    v_mov_b32 v111, 0
    s_waitcnt vmcnt(0) lgkmcnt(0)
    v_mfma_f32_16x16x32_bf16 v[56:59], v[56:59], v[32:35], 0
    v_mfma_f32_16x16x32_bf16 v[56:59], v[60:63], v[36:39], v[56:59]
    v_mfma_f32_16x16x32_bf16 v[56:59], v[64:67], v[40:43], v[56:59]
    v_mfma_f32_16x16x32_bf16 v[56:59], v[68:71], v[44:47], v[56:59]
    v_mfma_f32_16x16x32_bf16 v[60:63], v[72:75], v[32:35], 0
    v_mfma_f32_16x16x32_bf16 v[60:63], v[76:79], v[36:39], v[60:63]
    v_mfma_f32_16x16x32_bf16 v[60:63], v[80:83], v[40:43], v[60:63]
    v_mfma_f32_16x16x32_bf16 v[60:63], v[84:87], v[44:47], v[60:63]
    v_mfma_f32_16x16x32_bf16 v[64:67], v[32:35], v[32:35], 0
    v_mfma_f32_16x16x32_bf16 v[64:67], v[36:39], v[36:39], v[64:67]
    v_mfma_f32_16x16x32_bf16 v[64:67], v[40:43], v[40:43], v[64:67]
    v_mfma_f32_16x16x32_bf16 v[64:67], v[44:47], v[44:47], v[64:67]
    v_max3_f32 v84, v56, v57, v58
    v_max3_f32 v84, v84, v59, v60
    v_max3_f32 v84, v84, v61, v62
    s_nop 4
    v_max3_f32 v84, v84, v63, v64
    v_max_f32 v84, v84, v65
    v_mov_b32 v85, v84
    s_nop 1
    v_permlane32_swap_b32 v85, v84
    v_max_f32 v84, v85, v84
    v_mov_b32 v85, v84
    s_nop 1
    v_permlane16_swap_b32 v85, v84
    v_max_f32 v84, v85, v84
    v_sub_f32 v56, v56, v84
    v_sub_f32 v57, v57, v84
    v_sub_f32 v58, v58, v84
    v_sub_f32 v59, v59, v84
    v_sub_f32 v60, v60, v84
    v_sub_f32 v61, v61, v84
    v_sub_f32 v62, v62, v84
    v_sub_f32 v63, v63, v84
    v_sub_f32 v64, v64, v84
    v_sub_f32 v65, v65, v84
    v_exp_f32 v56, v56
    v_exp_f32 v57, v57
    v_exp_f32 v58, v58
    v_exp_f32 v59, v59
    v_exp_f32 v60, v60
    v_exp_f32 v61, v61
    v_exp_f32 v62, v62
    v_exp_f32 v63, v63
    v_exp_f32 v64, v64
    v_exp_f32 v65, v65
    v_cvt_pk_bf16_f32 v68, v56, v57
    v_cvt_pk_bf16_f32 v69, v58, v59
    v_cvt_pk_bf16_f32 v70, v60, v61
    v_cvt_pk_bf16_f32 v71, v62, v63
    v_cvt_pk_bf16_f32 v52, v64, v65
    s_nop 0
    v_mfma_f32_16x16x32_bf16 v[72:75], v[88:91], v[68:71], 0
    v_mfma_f32_16x16x32_bf16 v[76:79], v[92:95], v[68:71], 0
    v_mfma_f32_16x16x32_bf16 v[80:83], v[48:51], v[68:71], 0
    v_mfma_f32_16x16x16_bf16 v[72:75], v[112:113], v[52:53], v[72:75]
    v_mfma_f32_16x16x16_bf16 v[76:79], v[114:115], v[52:53], v[76:79]
    v_mfma_f32_16x16x16_bf16 v[80:83], v[48:49], v[52:53], v[80:83]
    ds_read_b128 v[32:35], v124 offset:6144
    ds_read_b128 v[36:39], v124 offset:7168
    ds_read_b128 v[40:43], v124 offset:34816
    ds_read_b128 v[44:47], v124 offset:35840
    ds_read_b128 v[56:59], v124 offset:36864
    ds_read_b128 v[64:67], v124 offset:38912
    ds_read_b128 v[68:71], v124 offset:39936
    s_waitcnt lgkmcnt(0)
    s_branch L_norm_34
L_rslow_37:
    buffer_load_dwordx4 v[4:7], v117, s[8:11], s29 offen sc1
    buffer_load_dwordx4 v[8:11], v117, s[8:11], s53 offen sc1
    buffer_load_dwordx4 v[16:19], v117, s[8:11], s29 offen offset:2048 sc1
    buffer_load_dwordx4 v[20:23], v117, s[8:11], s53 offen offset:2048 sc1
    s_add_u32 s46, s46, 1
    s_add_u32 s49, s49, 1
    s_cmp_ge_u32 s49, 0x10000
    s_cbranch_scc1 L_rgo_38
    s_waitcnt vmcnt(7)
    v_mfma_f32_16x16x32_bf16 v[48:51], v[32:35], v[12:15], 0
    v_xor_b32 v52, s33, v32
    s_waitcnt vmcnt(6)
    v_mfma_f32_16x16x32_bf16 v[48:51], v[36:39], v[12:15], v[48:51]
    v_xor_b32 v53, s33, v36
    v_or_b32 v52, v52, v53
    s_waitcnt vmcnt(5)
    v_mfma_f32_16x16x32_bf16 v[48:51], v[40:43], v[12:15], v[48:51]
    v_xor_b32 v53, s33, v40
    v_or_b32 v52, v52, v53
    s_waitcnt vmcnt(4)
    v_mfma_f32_16x16x32_bf16 v[48:51], v[44:47], v[12:15], v[48:51]
    v_xor_b32 v53, s33, v44
    v_or_b32 v52, v52, v53
    v_and_b32 v52, 1, v52
    v_cmp_ne_u32 vcc, 0, v52
    s_cbranch_vccz L_rgo_38
    buffer_load_dwordx4 v[32:35], v117, s[8:11], s29 offen sc1
    buffer_load_dwordx4 v[36:39], v117, s[8:11], s53 offen sc1
    buffer_load_dwordx4 v[40:43], v117, s[8:11], s29 offen offset:2048 sc1
    buffer_load_dwordx4 v[44:47], v117, s[8:11], s53 offen offset:2048 sc1
    s_add_u32 s46, s46, 1
    s_branch L_rl_36
L_mret_40:
    s_mov_b32 s43, m0
    s_mov_b32 m0, 7168
    buffer_load_dwordx4 v[4:7], v117, s[8:11], s48 offen sc1
    buffer_load_dwordx4 v117, s[8:11], s48 offen sc1 lds
    s_mov_b32 m0, 14336
    s_mov_b32 m0, s43
    s_waitcnt vmcnt(0)
    v_max3_u32 v15, v4, v5, v6
    v_max_u32 v15, v15, v7
    v_cmp_lt_u32 vcc, s56, v15
    s_add_u32 s47, s47, 1
    s_add_u32 s49, s49, 1
    s_cmp_ge_u32 s49, 0x10000
    s_cbranch_scc1 L_mgo_41
    s_cbranch_vccnz L_mret_40
    s_branch L_mgo_41
L_smax_43:
    s_add_u32 s47, s47, 1
    s_mov_b32 s35, 0x7f800000
    s_waitcnt lgkmcnt(0)
    s_sub_u32 s43, s30, 0x41800
    s_add_u32 s40, s43, 4096
    s_nop 7
    buffer_load_dwordx4 v[56:59], v117, s[8:11], s43 offen
    buffer_load_dwordx4 v[60:63], v117, s[8:11], s43 offen offset:1024
    buffer_load_dwordx4 v[64:67], v117, s[8:11], s43 offen offset:2048
    buffer_load_dwordx4 v[68:71], v117, s[8:11], s43 offen offset:3072
    buffer_load_dwordx4 v[72:75], v117, s[8:11], s40 offen
    buffer_load_dwordx4 v[76:79], v117, s[8:11], s40 offen offset:1024
    buffer_load_dwordx4 v[80:83], v117, s[8:11], s40 offen offset:2048
    buffer_load_dwordx4 v[84:87], v117, s[8:11], s40 offen offset:3072
    ds_read_b128 v[32:35], v121 offset:16384
    ds_read_b128 v[36:39], v121 offset:17408
    ds_read_b128 v[40:43], v121 offset:18432
    ds_read_b128 v[44:47], v121 offset:19456
    v_mov_b32 v96, 0
    v_mov_b32 v97, 0
    v_mov_b32 v98, 0
    v_mov_b32 v99, 0
    v_mov_b32 v100, 0
    v_mov_b32 v101, 0
    v_mov_b32 v102, 0
    v_mov_b32 v103, 0
    v_mov_b32 v104, 0
    v_mov_b32 v105, 0
    v_mov_b32 v106, 0
    v_mov_b32 v107, 0
    v_mov_b32 v108, 0
    v_mov_b32 v109, 0
    v_mov_b32 v110, 0
    v_mov_b32 v111, 0
    s_waitcnt vmcnt(0) lgkmcnt(0)
    v_mfma_f32_16x16x32_bf16 v[56:59], v[56:59], v[32:35], 0
    v_mfma_f32_16x16x32_bf16 v[56:59], v[60:63], v[36:39], v[56:59]
    v_mfma_f32_16x16x32_bf16 v[56:59], v[64:67], v[40:43], v[56:59]
    v_mfma_f32_16x16x32_bf16 v[56:59], v[68:71], v[44:47], v[56:59]
    v_mfma_f32_16x16x32_bf16 v[60:63], v[72:75], v[32:35], 0
    v_mfma_f32_16x16x32_bf16 v[60:63], v[76:79], v[36:39], v[60:63]
    v_mfma_f32_16x16x32_bf16 v[60:63], v[80:83], v[40:43], v[60:63]
    v_mfma_f32_16x16x32_bf16 v[60:63], v[84:87], v[44:47], v[60:63]
    v_mfma_f32_16x16x32_bf16 v[64:67], v[32:35], v[32:35], 0
    v_mfma_f32_16x16x32_bf16 v[64:67], v[36:39], v[36:39], v[64:67]
    v_mfma_f32_16x16x32_bf16 v[64:67], v[40:43], v[40:43], v[64:67]
    v_mfma_f32_16x16x32_bf16 v[64:67], v[44:47], v[44:47], v[64:67]
    v_max3_f32 v84, v56, v57, v58
    v_max3_f32 v84, v84, v59, v60
    v_max3_f32 v84, v84, v61, v62
    s_nop 4
    v_max3_f32 v84, v84, v63, v64
    v_max_f32 v84, v84, v65
    v_mov_b32 v85, v84
    s_nop 1
    v_permlane32_swap_b32 v85, v84
    v_max_f32 v84, v85, v84
    v_mov_b32 v85, v84
    s_nop 1
    v_permlane16_swap_b32 v85, v84
    v_max_f32 v84, v85, v84
    v_sub_f32 v56, v56, v84
    v_sub_f32 v57, v57, v84
    v_sub_f32 v58, v58, v84
    v_sub_f32 v59, v59, v84
    v_sub_f32 v60, v60, v84
    v_sub_f32 v61, v61, v84
    v_sub_f32 v62, v62, v84
    v_sub_f32 v63, v63, v84
    v_sub_f32 v64, v64, v84
    v_sub_f32 v65, v65, v84
    v_exp_f32 v56, v56
    v_exp_f32 v57, v57
    v_exp_f32 v58, v58
    v_exp_f32 v59, v59
    v_exp_f32 v60, v60
    v_exp_f32 v61, v61
    v_exp_f32 v62, v62
    v_exp_f32 v63, v63
    v_exp_f32 v64, v64
    v_exp_f32 v65, v65
    v_cvt_pk_bf16_f32 v68, v56, v57
    v_cvt_pk_bf16_f32 v69, v58, v59
    v_cvt_pk_bf16_f32 v70, v60, v61
    v_cvt_pk_bf16_f32 v71, v62, v63
    v_cvt_pk_bf16_f32 v52, v64, v65
    s_nop 0
    v_mfma_f32_16x16x32_bf16 v[72:75], v[88:91], v[68:71], 0
    v_mfma_f32_16x16x32_bf16 v[76:79], v[92:95], v[68:71], 0
    v_mfma_f32_16x16x32_bf16 v[80:83], v[48:51], v[68:71], 0
    v_mfma_f32_16x16x16_bf16 v[72:75], v[112:113], v[52:53], v[72:75]
    v_mfma_f32_16x16x16_bf16 v[76:79], v[114:115], v[52:53], v[76:79]
    v_mfma_f32_16x16x16_bf16 v[80:83], v[48:49], v[52:53], v[80:83]
    ds_read_b128 v[32:35], v124 offset:6144
    ds_read_b128 v[36:39], v124 offset:7168
    ds_read_b128 v[40:43], v124 offset:34816
    ds_read_b128 v[44:47], v124 offset:35840
    ds_read_b128 v[56:59], v124 offset:36864
    ds_read_b128 v[64:67], v124 offset:38912
    ds_read_b128 v[68:71], v124 offset:39936
    s_waitcnt lgkmcnt(0)
    s_branch L_norm_42
L_rslow_45:
    buffer_load_dwordx4 v[4:7], v117, s[8:11], s29 offen sc1
    buffer_load_dwordx4 v[8:11], v117, s[8:11], s53 offen sc1
    buffer_load_dwordx4 v[16:19], v117, s[8:11], s29 offen offset:2048 sc1
    buffer_load_dwordx4 v[20:23], v117, s[8:11], s53 offen offset:2048 sc1
    s_add_u32 s46, s46, 1
    s_add_u32 s49, s49, 1
    s_cmp_ge_u32 s49, 0x10000
    s_cbranch_scc1 L_rgo_46
    s_waitcnt vmcnt(7)
    v_mfma_f32_16x16x32_bf16 v[48:51], v[32:35], v[12:15], 0
    v_xor_b32 v52, s33, v32
    s_waitcnt vmcnt(6)
    v_mfma_f32_16x16x32_bf16 v[48:51], v[36:39], v[12:15], v[48:51]
    v_xor_b32 v53, s33, v36
    v_or_b32 v52, v52, v53
    s_waitcnt vmcnt(5)
    v_mfma_f32_16x16x32_bf16 v[48:51], v[40:43], v[12:15], v[48:51]
    v_xor_b32 v53, s33, v40
    v_or_b32 v52, v52, v53
    s_waitcnt vmcnt(4)
    v_mfma_f32_16x16x32_bf16 v[48:51], v[44:47], v[12:15], v[48:51]
    v_xor_b32 v53, s33, v44
    v_or_b32 v52, v52, v53
    v_and_b32 v52, 1, v52
    v_cmp_ne_u32 vcc, 0, v52
    s_cbranch_vccz L_rgo_46
    buffer_load_dwordx4 v[32:35], v117, s[8:11], s29 offen sc1
    buffer_load_dwordx4 v[36:39], v117, s[8:11], s53 offen sc1
    buffer_load_dwordx4 v[40:43], v117, s[8:11], s29 offen offset:2048 sc1
    buffer_load_dwordx4 v[44:47], v117, s[8:11], s53 offen offset:2048 sc1
    s_add_u32 s46, s46, 1
    s_branch L_rl_44
L_zero:
    s_waitcnt lgkmcnt(0)
    s_and_b32 s9, s9, 0xffff
    s_mov_b32 s10, 0x10000000
    s_mov_b32 s11, 0x20000
    s_and_b32 s93, s93, 0xffff
    s_mov_b32 s94, 0x100
    s_mov_b32 s95, 0x20000
    s_mov_b32 s87, 0
    s_cmp_lg_u32 s86, 0
    s_cbranch_scc1 L_reg_47
    s_lshl_b32 s97, s84, 4
    s_lshl_b32 s96, 1, s85
    v_mov_b32 v250, s96
    v_mov_b32 v251, 256
    s_mov_b64 exec, 1
    buffer_atomic_add_x2 v[250:251], off, s[92:95], s97 offset:64
    s_mov_b64 exec, -1
    s_mov_b32 s86, 1
L_reg_47:
    v_mov_b32 v4, 0
    v_mov_b32 v5, 0
    v_mov_b32 v6, 0
    v_mov_b32 v7, 0
    v_lshlrev_b32 v1, 4, v0
    s_mov_b32 s97, 0x0
    buffer_store_dwordx4 v[4:7], v1, s[8:11], s97 offen sc1
    s_mov_b32 s97, 0x1000
    buffer_store_dwordx4 v[4:7], v1, s[8:11], s97 offen sc1
    s_mov_b32 s97, 0x2000
    buffer_store_dwordx4 v[4:7], v1, s[8:11], s97 offen sc1
    s_mov_b32 s97, 0x3000
    buffer_store_dwordx4 v[4:7], v1, s[8:11], s97 offen sc1
    s_mov_b32 s97, 0x4000
    buffer_store_dwordx4 v[4:7], v1, s[8:11], s97 offen sc1
    s_mov_b32 s97, 0x5000
    buffer_store_dwordx4 v[4:7], v1, s[8:11], s97 offen sc1
    s_mov_b32 s97, 0x6000
    buffer_store_dwordx4 v[4:7], v1, s[8:11], s97 offen sc1
    s_mov_b32 s97, 0x7000
    buffer_store_dwordx4 v[4:7], v1, s[8:11], s97 offen sc1
    s_mov_b32 s97, 0x8000
    buffer_store_dwordx4 v[4:7], v1, s[8:11], s97 offen sc1
    s_mov_b32 s97, 0x9000
    buffer_store_dwordx4 v[4:7], v1, s[8:11], s97 offen sc1
    s_mov_b32 s97, 0xa000
    buffer_store_dwordx4 v[4:7], v1, s[8:11], s97 offen sc1
    s_waitcnt vmcnt(0)
    s_barrier
    s_cmp_lg_u32 s100, 0
    s_cbranch_scc1 L_flag_48
    v_mov_b32 v2, 1
    s_mov_b64 exec, 1
    buffer_store_dword v2, off, s[92:95], 40 sc1
    s_mov_b64 exec, -1
L_flag_48:
    s_cmp_lg_u32 s100, 0
    s_cbranch_scc1 L_noz
    s_mov_b64 exec, 0xff
    s_mov_b32 s96, 0
L_count:
    buffer_load_dwordx2 v[2:3], v1, s[92:95], 0 offen offset:64 sc1
    s_waitcnt vmcnt(0)
    v_cmp_le_u32 vcc, 8192, v3
    v_add_u32 v2, 1, v2
    v_xor_b32 v3, 8192, v3
    v_or_b32 v2, v2, v3
    s_mov_b32 s4, vcc_lo
    v_cmp_eq_u32 vcc, 0, v2
    v_mov_b32 v2, 1
    s_nop 1
    s_cmp_eq_u32 vcc_lo, 0xff
    s_cbranch_scc1 L_propose
    v_mov_b32 v2, 2
    s_andn2_b32 s4, s4, vcc_lo
    s_cbranch_scc1 L_propose
    s_sleep 2
    s_add_u32 s96, s96, 1
    s_cmp_lt_u32 s96, 0x100
    s_cbranch_scc1 L_count
L_propose:
    v_mov_b32 v3, 0
    s_mov_b64 exec, 1
    buffer_atomic_cmpswap v[2:3], off, s[92:95], 0 offset:36
    s_mov_b64 exec, -1
    s_branch L_noz
L_fallback:
    s_mov_b32 s87, 2
    s_waitcnt vmcnt(0) lgkmcnt(0)
    s_barrier
    v_mbcnt_lo_u32_b32 v0, -1, 0
    v_mbcnt_hi_u32_b32 v0, -1, v0
    s_lshl_b32 s96, s100, 6
    v_add_u32 v0, s96, v0
    s_mov_b32 s97, 44
    s_cmp_lg_u32 s100, 0
    s_cbranch_scc1 L_at_49
    s_mov_b64 exec, 1
    v_mov_b32 v2, 1
    buffer_atomic_add v2, off, s[92:95], s97 sc0
    s_mov_b64 exec, -1
L_at_49:
    s_cmp_lg_u32 s100, 0
    s_cbranch_scc1 L_at2_50
    s_mov_b64 exec, 1
    v_mov_b32 v1, 8
    s_waitcnt vmcnt(0)
    ds_write_b32 v1, v2
    s_waitcnt lgkmcnt(0)
    s_mov_b64 exec, -1
L_at2_50:
    s_barrier
    v_mov_b32 v1, 8
    ds_read_b32 v2, v1
    s_waitcnt lgkmcnt(0)
    v_readfirstlane_b32 s85, v2
    s_barrier
    s_sub_u32 s101, s85, 32
    s_cmp_ge_u32 s85, 32
    s_cbranch_scc1 L_bulk
    s_mov_b32 s20, s85
    v_lshrrev_b32 v4, 6, v0
    s_nop 0
    v_readfirstlane_b32 s21, v4
    v_and_b32 v1, 63, v0
    v_lshrrev_b32 v2, 4, v1
    v_and_b32 v3, 15, v1
    v_lshrrev_b32 v6, 2, v3
    v_lshlrev_b32 v117, 4, v1
    s_lshl_b32 s51, s21, 10
    s_lshl_b32 s52, s21, 11
    s_load_dwordx8 s[60:67], s[0:1], 16
    s_mov_b32 s14, 0x400000
    s_mov_b32 s15, 0x20000
    s_lshl_b32 s41, s20, 8
    s_lshl_b32 s42, s20, 17
    s_lshr_b32 s43, s21, 1
    s_lshl_b32 s43, s43, 2
    v_or_b32 v5, s43, v2
    v_lshlrev_b32 v5, 1, v5
    v_xor_b32 v5, v5, v3
    v_lshrrev_b32 v14, 2, v5
    v_and_b32 v14, 2, v14
    v_lshlrev_b32 v5, 4, v5
    s_lshl_b32 s43, s21, 4
    v_add_u32 v4, s43, v2
    v_lshl_add_u32 v8, v4, 13, v5
    s_waitcnt lgkmcnt(0)
    s_mov_b32 s16, s92
    s_mov_b32 s17, s93
    s_mov_b32 s18, s94
    s_mov_b32 s19, s95
    s_mov_b32 s88, s20
    s_mov_b32 s12, s60
    s_and_b32 s13, s61, 0xffff
    v_xor_b32 v15, 0, v14
    v_lshl_add_u32 v15, v15, 15, v8
    s_add_u32 s43, s41, 0x0
    s_add_u32 m0, s51, 0x8000
    s_nop 0
    buffer_load_dwordx4 v15, s[12:15], s43 offen nt lds
    s_add_u32 s43, s41, 0x8000
    s_add_u32 m0, s51, 0x9000
    s_nop 0
    buffer_load_dwordx4 v15, s[12:15], s43 offen nt lds
    s_add_u32 s43, s41, 0x100000
    s_add_u32 m0, s51, 0xa000
    s_nop 0
    buffer_load_dwordx4 v15, s[12:15], s43 offen nt lds
    s_add_u32 s43, s41, 0x108000
    s_add_u32 m0, s51, 0xb000
    s_nop 0
    buffer_load_dwordx4 v15, s[12:15], s43 offen nt lds
    s_add_u32 s43, s41, 0x200000
    s_add_u32 m0, s51, 0xc000
    s_nop 0
    buffer_load_dwordx4 v15, s[12:15], s43 offen nt lds
    s_add_u32 s43, s41, 0x208000
    s_add_u32 m0, s51, 0xd000
    s_nop 0
    buffer_load_dwordx4 v15, s[12:15], s43 offen nt lds
    s_add_u32 s43, s41, 0x300000
    s_add_u32 m0, s51, 0xe000
    s_nop 0
    buffer_load_dwordx4 v15, s[12:15], s43 offen nt lds
    s_add_u32 s43, s41, 0x308000
    s_add_u32 m0, s51, 0xf000
    s_nop 0
    buffer_load_dwordx4 v15, s[12:15], s43 offen nt lds
    v_xor_b32 v15, 2, v14
    v_lshl_add_u32 v15, v15, 15, v8
    s_add_u32 s43, s41, 0x0
    s_add_u32 m0, s51, 0x10000
    s_nop 0
    buffer_load_dwordx4 v15, s[12:15], s43 offen nt lds
    s_add_u32 s43, s41, 0x8000
    s_add_u32 m0, s51, 0x11000
    s_nop 0
    buffer_load_dwordx4 v15, s[12:15], s43 offen nt lds
    s_add_u32 s43, s41, 0x100000
    s_add_u32 m0, s51, 0x12000
    s_nop 0
    buffer_load_dwordx4 v15, s[12:15], s43 offen nt lds
    s_add_u32 s43, s41, 0x108000
    s_add_u32 m0, s51, 0x13000
    s_nop 0
    buffer_load_dwordx4 v15, s[12:15], s43 offen nt lds
    s_add_u32 s43, s41, 0x200000
    s_add_u32 m0, s51, 0x14000
    s_nop 0
    buffer_load_dwordx4 v15, s[12:15], s43 offen nt lds
    s_add_u32 s43, s41, 0x208000
    s_add_u32 m0, s51, 0x15000
    s_nop 0
    buffer_load_dwordx4 v15, s[12:15], s43 offen nt lds
    s_add_u32 s43, s41, 0x300000
    s_add_u32 m0, s51, 0x16000
    s_nop 0
    buffer_load_dwordx4 v15, s[12:15], s43 offen nt lds
    s_add_u32 s43, s41, 0x308000
    s_add_u32 m0, s51, 0x17000
    s_nop 0
    buffer_load_dwordx4 v15, s[12:15], s43 offen nt lds
    v_xor_b32 v15, 0, v14
    v_lshl_add_u32 v15, v15, 15, v8
    s_add_u32 s43, s41, 0x80000
    s_add_u32 m0, s51, 0x18000
    s_nop 0
    buffer_load_dwordx4 v15, s[12:15], s43 offen nt lds
    s_add_u32 s43, s41, 0x88000
    s_add_u32 m0, s51, 0x19000
    s_nop 0
    buffer_load_dwordx4 v15, s[12:15], s43 offen nt lds
    s_add_u32 s43, s41, 0x180000
    s_add_u32 m0, s51, 0x1a000
    s_nop 0
    buffer_load_dwordx4 v15, s[12:15], s43 offen nt lds
    s_add_u32 s43, s41, 0x188000
    s_add_u32 m0, s51, 0x1b000
    s_nop 0
    buffer_load_dwordx4 v15, s[12:15], s43 offen nt lds
    v_and_b32 v4, 2, v3
    v_cmp_ne_u32 vcc, 0, v4
    v_mov_b32 v4, 0x4444
    v_mov_b32 v5, 0xeeee
    v_cndmask_b32 v116, v4, v5, vcc
    v_lshrrev_b32 v5, 1, v2
    v_lshl_add_u32 v4, v6, 3, v5
    s_lshl_b32 s43, s21, 1
    v_add_u32 v4, s43, v4
    v_add_u32 v5, s20, v4
    v_and_b32 v5, 31, v5
    v_lshl_add_u32 v4, v4, 6, v5
    v_and_b32 v5, 1, v2
    v_lshl_add_u32 v4, v4, 1, v5
    v_and_b32 v5, 3, v3
    v_lshl_add_u32 v4, v4, 2, v5
    v_lshlrev_b32 v118, 4, v4
    v_and_b32 v4, 1, v2
    v_lshlrev_b32 v4, 2, v4
    v_and_b32 v7, 2, v2
    v_add_u32 v4, v4, v7
    v_and_b32 v7, 1, v6
    v_add_u32 v4, v4, v7
    v_lshl_add_u32 v4, v4, 2, v5
    v_lshlrev_b32 v4, 2, v4
    s_and_b32 s43, s21, 1
    s_lshl_b32 s43, s43, 12
    s_lshl_b32 s40, s20, 7
    s_add_u32 s43, s43, s40
    v_add_u32 v119, s43, v4
    v_sub_u32 v7, 0, v2
    v_and_b32 v7, 3, v7
    v_xor_b32 v7, v7, v6
    v_lshl_add_u32 v4, v2, 4, v7
    v_and_b32 v5, 3, v3
    v_lshl_add_u32 v4, v4, 2, v5
    s_add_u32 s43, s51, 16384
    v_lshl_add_u32 v120, v4, 2, s43
    v_sub_u32 v7, 0, v6
    v_and_b32 v7, 3, v7
    v_xor_b32 v7, v7, v2
    v_lshl_add_u32 v4, v3, 2, v7
    v_lshlrev_b32 v121, 4, v4
    v_and_b32 v5, 1, v3
    v_lshl_add_u32 v4, v6, 1, v5
    v_lshl_add_u32 v4, v2, 3, v4
    v_lshlrev_b32 v127, 4, v4
    v_and_or_b32 v122, v116, 8, v127
    s_lshl_b32 s43, s21, 13
    s_add_u32 s43, s43, 32768
    v_add_u32 v123, s43, v117
    v_add_u32 v124, 0x10000, v123
    s_mov_b32 s36, 0xcccccccc
    s_mov_b32 s37, 0xcccccccc
    s_mov_b32 s38, 0x00ff00ff
    s_mov_b32 s39, 0x00ff00ff
    s_mov_b32 s34, 0x3e0293ee
    s_mov_b32 s35, 0x49800000
    s_mov_b32 s50, 0x3f803f80
    v_and_b32 v5, 1, v2
    v_or_b32 v5, 0, v5
    v_xor_b32 v5, v5, v6
    v_and_b32 v7, 2, v5
    v_add_u32 v5, v5, v7
    v_lshlrev_b32 v5, 6, v5
    v_and_b32 v7, 3, v3
    v_lshl_add_u32 v7, v7, 4, v5
    s_lshl_b32 s43, s21, 2
    v_add_u32 v4, s43, v2
    v_lshl_add_u32 v10, v4, 10, v7
    v_and_b32 v5, 1, v2
    v_or_b32 v5, 2, v5
    v_xor_b32 v5, v5, v6
    v_and_b32 v7, 2, v5
    v_add_u32 v5, v5, v7
    v_lshlrev_b32 v5, 6, v5
    v_and_b32 v7, 3, v3
    v_lshl_add_u32 v7, v7, 4, v5
    s_lshl_b32 s43, s21, 2
    v_add_u32 v4, s43, v2
    v_lshl_add_u32 v9, v4, 10, v7
    v_and_b32 v5, 1, v2
    v_lshl_add_u32 v4, v5, 3, v6
    v_lshrrev_b32 v7, 1, v2
    v_lshl_add_u32 v4, v7, 5, v4
    v_lshlrev_b32 v4, 8, v4
    v_lshl_or_b32 v5, v5, 2, v6
    v_lshlrev_b32 v5, 5, v5
    s_lshl_b32 s43, s21, 6
    v_xor_b32 v5, s43, v5
    v_add_u32 v4, v4, v5
    v_and_b32 v5, 3, v3
    v_lshl_add_u32 v4, v5, 3, v4
    v_add_u32 v11, 32768, v4
    s_and_b32 s43, s21, 1
    s_lshl_b32 s43, s43, 12
    v_add_u32 v11, s43, v11
    v_and_b32 v5, 1, v2
    v_lshlrev_b32 v4, 4, v5
    v_lshl_add_u32 v4, v7, 2, v4
    v_and_b32 v7, 1, v6
    v_add_u32 v4, v4, v7
    s_lshl_b32 s43, s21, 5
    v_add_u32 v4, s43, v4
    v_lshlrev_b32 v4, 8, v4
    v_lshl_or_b32 v5, v5, 1, v7
    s_lshl_b32 s43, s21, 1
    s_and_b32 s43, s43, 3
    v_xor_b32 v5, s43, v5
    v_lshl_add_u32 v4, v5, 6, v4
    v_lshrrev_b32 v5, 1, v6
    v_lshl_add_u32 v4, v5, 5, v4
    v_and_b32 v5, 3, v3
    v_lshl_add_u32 v4, v5, 3, v4
    v_add_u32 v12, 32768, v4
    v_mov_b32 v16, -1
    v_mov_b32 v17, -1
    v_mov_b32 v18, -1
    v_mov_b32 v19, -1
    s_lshl_b32 s43, s20, 13
    s_add_u32 s43, s43, 0x7100000
    s_and_b32 s40, s21, 1
    s_lshl_b32 s40, s40, 12
    s_add_u32 s29, s43, s40
    s_add_u32 s43, s43, s52
    s_xor_b32 s40, s43, 0x0
    buffer_store_dwordx4 v[16:19], v117, s[8:11], s43 offen sc1
    buffer_store_dwordx4 v[16:19], v117, s[8:11], s43 offen offset:1024 sc1
    s_mov_b32 s43, 0x7012000
    buffer_store_dword v16, v119, s[8:11], s43 offen sc1
    s_mov_b32 s43, 0x7014000
    buffer_store_dword v16, v119, s[8:11], s43 offen sc1
    s_mov_b32 s43, 0x7016000
    buffer_store_dword v16, v119, s[8:11], s43 offen sc1
    s_load_dwordx2 s[4:5], s[0:1], 8
    s_waitcnt lgkmcnt(0)
    s_and_b32 s5, s5, 0xffff
    s_mov_b32 s6, 8192
    s_mov_b32 s7, 0x20000
    v_and_b32 v20, 1, v2
    v_and_b32 v21, 1, v6
    v_lshl_add_u32 v20, v20, 1, v21
    v_lshlrev_b32 v20, 9, v20
    v_and_b32 v21, 3, v3
    v_lshl_add_u32 v20, v21, 4, v20
    v_and_b32 v21, 2, v2
    v_add_u32 v20, v20, v21
    s_and_b32 s43, s20, 1
    s_lshl_b32 s43, s43, 11
    s_bfe_u32 s40, s20, 0x20001
    s_lshl_b32 s40, s40, 7
    s_add_u32 s43, s43, s40
    s_and_b32 s40, s21, 1
    s_lshl_b32 s40, s40, 6
    s_add_u32 s43, s43, s40
    s_lshr_b32 s40, s20, 3
    s_lshl_b32 s40, s40, 2
    s_add_u32 s43, s43, s40
    v_add_u32 v20, s43, v20
    v_lshlrev_b32 v20, 1, v20
    buffer_load_dword v21, v20, s[4:7], 0 offen
    s_mov_b32 s57, 0
    s_lshl_b32 s43, s20, 13
    s_add_u32 s43, s43, s52
    s_add_u32 s30, s43, 0x1000000
    s_add_u32 s31, s43, 0x2000000
    s_lshr_b32 s43, s43, 1
    s_add_u32 s32, s43, 0x220000
    s_waitcnt vmcnt(18)
    s_barrier
    v_xor_b32 v13, 0x0, v11
    v_add_u32 v13, 0x0, v13
    ds_read_b64_tr_b16 v[80:81], v13
    ds_read_b64_tr_b16 v[82:83], v13 offset:1024
    ds_read_b64_tr_b16 v[84:85], v13 offset:16384
    ds_read_b64_tr_b16 v[86:87], v13 offset:17408
    v_xor_b32 v13, 0x20, v11
    v_add_u32 v13, 0x0, v13
    ds_read_b64_tr_b16 v[56:57], v13
    ds_read_b64_tr_b16 v[58:59], v13 offset:1024
    ds_read_b64_tr_b16 v[60:61], v13 offset:16384
    ds_read_b64_tr_b16 v[62:63], v13 offset:17408
    v_xor_b32 v13, 0x1000, v11
    v_add_u32 v13, 0x0, v13
    ds_read_b64_tr_b16 a[0:1], v13
    ds_read_b64_tr_b16 a[2:3], v13 offset:1024
    ds_read_b64_tr_b16 a[4:5], v13 offset:16384
    ds_read_b64_tr_b16 a[6:7], v13 offset:17408
    v_xor_b32 v13, 0x1020, v11
    v_add_u32 v13, 0x0, v13
    ds_read_b64_tr_b16 a[8:9], v13
    ds_read_b64_tr_b16 a[10:11], v13 offset:1024
    ds_read_b64_tr_b16 a[12:13], v13 offset:16384
    ds_read_b64_tr_b16 a[14:15], v13 offset:17408
    s_waitcnt lgkmcnt(0)
    s_barrier
    s_add_u32 s43, s41, 0x280000
    s_add_u32 m0, s51, 0x1c000
    s_nop 0
    buffer_load_dwordx4 v15, s[12:15], s43 offen nt lds
    s_add_u32 s43, s41, 0x288000
    s_add_u32 m0, s51, 0x1d000
    s_nop 0
    buffer_load_dwordx4 v15, s[12:15], s43 offen nt lds
    s_add_u32 s43, s41, 0x380000
    s_add_u32 m0, s51, 0x1e000
    s_nop 0
    buffer_load_dwordx4 v15, s[12:15], s43 offen nt lds
    s_add_u32 s43, s41, 0x388000
    s_add_u32 m0, s51, 0x1f000
    s_nop 0
    buffer_load_dwordx4 v15, s[12:15], s43 offen nt lds
    v_xor_b32 v15, 2, v14
    v_lshl_add_u32 v15, v15, 15, v8
    s_add_u32 s43, s41, 0x80000
    s_add_u32 m0, s51, 0x20000
    s_nop 0
    buffer_load_dwordx4 v15, s[12:15], s43 offen nt lds
    s_add_u32 s43, s41, 0x88000
    s_add_u32 m0, s51, 0x21000
    s_nop 0
    buffer_load_dwordx4 v15, s[12:15], s43 offen nt lds
    s_add_u32 s43, s41, 0x180000
    s_add_u32 m0, s51, 0x22000
    s_nop 0
    buffer_load_dwordx4 v15, s[12:15], s43 offen nt lds
    s_add_u32 s43, s41, 0x188000
    s_add_u32 m0, s51, 0x23000
    s_nop 0
    buffer_load_dwordx4 v15, s[12:15], s43 offen nt lds
    s_waitcnt vmcnt(18)
    s_barrier
    v_xor_b32 v13, 0x0, v11
    v_add_u32 v13, 0x8000, v13
    ds_read_b64_tr_b16 a[32:33], v13
    ds_read_b64_tr_b16 a[34:35], v13 offset:1024
    ds_read_b64_tr_b16 a[36:37], v13 offset:16384
    ds_read_b64_tr_b16 a[38:39], v13 offset:17408
    v_xor_b32 v13, 0x20, v11
    v_add_u32 v13, 0x8000, v13
    ds_read_b64_tr_b16 a[40:41], v13
    ds_read_b64_tr_b16 a[42:43], v13 offset:1024
    ds_read_b64_tr_b16 a[44:45], v13 offset:16384
    ds_read_b64_tr_b16 a[46:47], v13 offset:17408
    v_xor_b32 v13, 0x1000, v11
    v_add_u32 v13, 0x8000, v13
    ds_read_b64_tr_b16 a[64:65], v13
    ds_read_b64_tr_b16 a[66:67], v13 offset:1024
    ds_read_b64_tr_b16 a[68:69], v13 offset:16384
    ds_read_b64_tr_b16 a[70:71], v13 offset:17408
    v_xor_b32 v13, 0x1020, v11
    v_add_u32 v13, 0x8000, v13
    ds_read_b64_tr_b16 a[72:73], v13
    ds_read_b64_tr_b16 a[74:75], v13 offset:1024
    ds_read_b64_tr_b16 a[76:77], v13 offset:16384
    ds_read_b64_tr_b16 a[78:79], v13 offset:17408
    s_waitcnt lgkmcnt(0)
    s_barrier
    s_add_u32 s43, s41, 0x280000
    s_add_u32 m0, s51, 0x24000
    s_nop 0
    buffer_load_dwordx4 v15, s[12:15], s43 offen nt lds
    s_add_u32 s43, s41, 0x288000
    s_add_u32 m0, s51, 0x25000
    s_nop 0
    buffer_load_dwordx4 v15, s[12:15], s43 offen nt lds
    s_add_u32 s43, s41, 0x380000
    s_add_u32 m0, s51, 0x26000
    s_nop 0
    buffer_load_dwordx4 v15, s[12:15], s43 offen nt lds
    s_add_u32 s43, s41, 0x388000
    s_add_u32 m0, s51, 0x27000
    s_nop 0
    buffer_load_dwordx4 v15, s[12:15], s43 offen nt lds
    s_mov_b32 s12, s62
    s_and_b32 s13, s63, 0xffff
    v_xor_b32 v15, 0, v14
    v_lshl_add_u32 v15, v15, 15, v8
    s_add_u32 s43, s41, 0x0
    s_add_u32 m0, s51, 0x8000
    s_nop 0
    buffer_load_dwordx4 v15, s[12:15], s43 offen nt lds
    s_add_u32 s43, s41, 0x8000
    s_add_u32 m0, s51, 0x9000
    s_nop 0
    buffer_load_dwordx4 v15, s[12:15], s43 offen nt lds
    s_add_u32 s43, s41, 0x100000
    s_add_u32 m0, s51, 0xa000
    s_nop 0
    buffer_load_dwordx4 v15, s[12:15], s43 offen nt lds
    s_add_u32 s43, s41, 0x108000
    s_add_u32 m0, s51, 0xb000
    s_nop 0
    buffer_load_dwordx4 v15, s[12:15], s43 offen nt lds
    s_waitcnt vmcnt(12)
    s_barrier
    v_xor_b32 v13, 0x0, v11
    v_add_u32 v13, 0x10000, v13
    ds_read_b64_tr_b16 v[88:89], v13
    ds_read_b64_tr_b16 v[90:91], v13 offset:1024
    ds_read_b64_tr_b16 v[92:93], v13 offset:16384
    ds_read_b64_tr_b16 v[94:95], v13 offset:17408
    v_xor_b32 v13, 0x20, v11
    v_add_u32 v13, 0x10000, v13
    ds_read_b64_tr_b16 v[96:97], v13
    ds_read_b64_tr_b16 v[98:99], v13 offset:1024
    ds_read_b64_tr_b16 v[100:101], v13 offset:16384
    ds_read_b64_tr_b16 v[102:103], v13 offset:17408
    v_xor_b32 v13, 0x1000, v11
    v_add_u32 v13, 0x10000, v13
    ds_read_b64_tr_b16 a[16:17], v13
    ds_read_b64_tr_b16 a[18:19], v13 offset:1024
    ds_read_b64_tr_b16 a[20:21], v13 offset:16384
    ds_read_b64_tr_b16 a[22:23], v13 offset:17408
    v_xor_b32 v13, 0x1020, v11
    v_add_u32 v13, 0x10000, v13
    ds_read_b64_tr_b16 a[24:25], v13
    ds_read_b64_tr_b16 a[26:27], v13 offset:1024
    ds_read_b64_tr_b16 a[28:29], v13 offset:16384
    ds_read_b64_tr_b16 a[30:31], v13 offset:17408
    s_waitcnt lgkmcnt(0)
    s_barrier
    s_add_u32 s43, s41, 0x200000
    s_add_u32 m0, s51, 0xc000
    s_nop 0
    buffer_load_dwordx4 v15, s[12:15], s43 offen nt lds
    s_add_u32 s43, s41, 0x208000
    s_add_u32 m0, s51, 0xd000
    s_nop 0
    buffer_load_dwordx4 v15, s[12:15], s43 offen nt lds
    s_add_u32 s43, s41, 0x300000
    s_add_u32 m0, s51, 0xe000
    s_nop 0
    buffer_load_dwordx4 v15, s[12:15], s43 offen nt lds
    s_add_u32 s43, s41, 0x308000
    s_add_u32 m0, s51, 0xf000
    s_nop 0
    buffer_load_dwordx4 v15, s[12:15], s43 offen nt lds
    v_xor_b32 v15, 2, v14
    v_lshl_add_u32 v15, v15, 15, v8
    s_add_u32 s43, s41, 0x0
    s_add_u32 m0, s51, 0x10000
    s_nop 0
    buffer_load_dwordx4 v15, s[12:15], s43 offen nt lds
    s_add_u32 s43, s41, 0x8000
    s_add_u32 m0, s51, 0x11000
    s_nop 0
    buffer_load_dwordx4 v15, s[12:15], s43 offen nt lds
    s_add_u32 s43, s41, 0x100000
    s_add_u32 m0, s51, 0x12000
    s_nop 0
    buffer_load_dwordx4 v15, s[12:15], s43 offen nt lds
    s_add_u32 s43, s41, 0x108000
    s_add_u32 m0, s51, 0x13000
    s_nop 0
    buffer_load_dwordx4 v15, s[12:15], s43 offen nt lds
    s_waitcnt vmcnt(12)
    s_barrier
    v_xor_b32 v13, 0x0, v11
    v_add_u32 v13, 0x18000, v13
    ds_read_b64_tr_b16 a[48:49], v13
    ds_read_b64_tr_b16 a[50:51], v13 offset:1024
    ds_read_b64_tr_b16 a[52:53], v13 offset:16384
    ds_read_b64_tr_b16 a[54:55], v13 offset:17408
    v_xor_b32 v13, 0x20, v11
    v_add_u32 v13, 0x18000, v13
    ds_read_b64_tr_b16 a[56:57], v13
    ds_read_b64_tr_b16 a[58:59], v13 offset:1024
    ds_read_b64_tr_b16 a[60:61], v13 offset:16384
    ds_read_b64_tr_b16 a[62:63], v13 offset:17408
    v_xor_b32 v13, 0x1000, v11
    v_add_u32 v13, 0x18000, v13
    ds_read_b64_tr_b16 a[80:81], v13
    ds_read_b64_tr_b16 a[82:83], v13 offset:1024
    ds_read_b64_tr_b16 a[84:85], v13 offset:16384
    ds_read_b64_tr_b16 a[86:87], v13 offset:17408
    v_xor_b32 v13, 0x1020, v11
    v_add_u32 v13, 0x18000, v13
    ds_read_b64_tr_b16 a[88:89], v13
    ds_read_b64_tr_b16 a[90:91], v13 offset:1024
    ds_read_b64_tr_b16 a[92:93], v13 offset:16384
    ds_read_b64_tr_b16 a[94:95], v13 offset:17408
    s_waitcnt lgkmcnt(0)
    s_barrier
    s_add_u32 s43, s41, 0x200000
    s_add_u32 m0, s51, 0x14000
    s_nop 0
    buffer_load_dwordx4 v15, s[12:15], s43 offen nt lds
    s_add_u32 s43, s41, 0x208000
    s_add_u32 m0, s51, 0x15000
    s_nop 0
    buffer_load_dwordx4 v15, s[12:15], s43 offen nt lds
    s_add_u32 s43, s41, 0x300000
    s_add_u32 m0, s51, 0x16000
    s_nop 0
    buffer_load_dwordx4 v15, s[12:15], s43 offen nt lds
    s_add_u32 s43, s41, 0x308000
    s_add_u32 m0, s51, 0x17000
    s_nop 0
    buffer_load_dwordx4 v15, s[12:15], s43 offen nt lds
    v_xor_b32 v15, 0, v14
    v_lshl_add_u32 v15, v15, 15, v8
    s_add_u32 s43, s41, 0x80000
    s_add_u32 m0, s51, 0x18000
    s_nop 0
    buffer_load_dwordx4 v15, s[12:15], s43 offen nt lds
    s_add_u32 s43, s41, 0x88000
    s_add_u32 m0, s51, 0x19000
    s_nop 0
    buffer_load_dwordx4 v15, s[12:15], s43 offen nt lds
    s_add_u32 s43, s41, 0x180000
    s_add_u32 m0, s51, 0x1a000
    s_nop 0
    buffer_load_dwordx4 v15, s[12:15], s43 offen nt lds
    s_add_u32 s43, s41, 0x188000
    s_add_u32 m0, s51, 0x1b000
    s_nop 0
    buffer_load_dwordx4 v15, s[12:15], s43 offen nt lds
    s_waitcnt vmcnt(12)
    v_min_u32 v21, 0xfffffffe, v21
    s_mov_b32 s43, 0x7010000
    s_mov_b64 exec, s[38:39]
    buffer_store_dword v21, v119, s[8:11], s43 offen sc1
    s_mov_b64 exec, -1
    s_barrier
    v_xor_b32 v13, 0x0, v11
    v_add_u32 v13, 0x0, v13
    ds_read_b64_tr_b16 v[64:65], v13
    ds_read_b64_tr_b16 v[66:67], v13 offset:1024
    ds_read_b64_tr_b16 v[68:69], v13 offset:16384
    ds_read_b64_tr_b16 v[70:71], v13 offset:17408
    v_xor_b32 v13, 0x20, v11
    v_add_u32 v13, 0x0, v13
    ds_read_b64_tr_b16 v[72:73], v13
    ds_read_b64_tr_b16 v[74:75], v13 offset:1024
    ds_read_b64_tr_b16 v[76:77], v13 offset:16384
    ds_read_b64_tr_b16 v[78:79], v13 offset:17408
    v_xor_b32 v13, 0x1000, v11
    v_add_u32 v13, 0x0, v13
    ds_read_b64_tr_b16 a[96:97], v13
    ds_read_b64_tr_b16 a[98:99], v13 offset:1024
    ds_read_b64_tr_b16 a[100:101], v13 offset:16384
    ds_read_b64_tr_b16 a[102:103], v13 offset:17408
    v_xor_b32 v13, 0x1020, v11
    v_add_u32 v13, 0x0, v13
    ds_read_b64_tr_b16 a[104:105], v13
    ds_read_b64_tr_b16 a[106:107], v13 offset:1024
    ds_read_b64_tr_b16 a[108:109], v13 offset:16384
    ds_read_b64_tr_b16 a[110:111], v13 offset:17408
    s_waitcnt lgkmcnt(0)
    s_barrier
    s_add_u32 s43, s41, 0x280000
    s_add_u32 m0, s51, 0x1c000
    s_nop 0
    buffer_load_dwordx4 v15, s[12:15], s43 offen nt lds
    s_add_u32 s43, s41, 0x288000
    s_add_u32 m0, s51, 0x1d000
    s_nop 0
    buffer_load_dwordx4 v15, s[12:15], s43 offen nt lds
    s_add_u32 s43, s41, 0x380000
    s_add_u32 m0, s51, 0x1e000
    s_nop 0
    buffer_load_dwordx4 v15, s[12:15], s43 offen nt lds
    s_add_u32 s43, s41, 0x388000
    s_add_u32 m0, s51, 0x1f000
    s_nop 0
    buffer_load_dwordx4 v15, s[12:15], s43 offen nt lds
    v_xor_b32 v15, 2, v14
    v_lshl_add_u32 v15, v15, 15, v8
    s_add_u32 s43, s41, 0x80000
    s_add_u32 m0, s51, 0x20000
    s_nop 0
    buffer_load_dwordx4 v15, s[12:15], s43 offen nt lds
    s_add_u32 s43, s41, 0x88000
    s_add_u32 m0, s51, 0x21000
    s_nop 0
    buffer_load_dwordx4 v15, s[12:15], s43 offen nt lds
    s_add_u32 s43, s41, 0x180000
    s_add_u32 m0, s51, 0x22000
    s_nop 0
    buffer_load_dwordx4 v15, s[12:15], s43 offen nt lds
    s_add_u32 s43, s41, 0x188000
    s_add_u32 m0, s51, 0x23000
    s_nop 0
    buffer_load_dwordx4 v15, s[12:15], s43 offen nt lds
    s_waitcnt vmcnt(12)
    s_barrier
    v_xor_b32 v13, 0x0, v11
    v_add_u32 v13, 0x8000, v13
    ds_read_b64_tr_b16 a[128:129], v13
    ds_read_b64_tr_b16 a[130:131], v13 offset:1024
    ds_read_b64_tr_b16 a[132:133], v13 offset:16384
    ds_read_b64_tr_b16 a[134:135], v13 offset:17408
    v_xor_b32 v13, 0x20, v11
    v_add_u32 v13, 0x8000, v13
    ds_read_b64_tr_b16 a[136:137], v13
    ds_read_b64_tr_b16 a[138:139], v13 offset:1024
    ds_read_b64_tr_b16 a[140:141], v13 offset:16384
    ds_read_b64_tr_b16 a[142:143], v13 offset:17408
    v_xor_b32 v13, 0x1000, v11
    v_add_u32 v13, 0x8000, v13
    ds_read_b64_tr_b16 a[160:161], v13
    ds_read_b64_tr_b16 a[162:163], v13 offset:1024
    ds_read_b64_tr_b16 a[164:165], v13 offset:16384
    ds_read_b64_tr_b16 a[166:167], v13 offset:17408
    v_xor_b32 v13, 0x1020, v11
    v_add_u32 v13, 0x8000, v13
    ds_read_b64_tr_b16 a[168:169], v13
    ds_read_b64_tr_b16 a[170:171], v13 offset:1024
    ds_read_b64_tr_b16 a[172:173], v13 offset:16384
    ds_read_b64_tr_b16 a[174:175], v13 offset:17408
    s_waitcnt lgkmcnt(0)
    s_barrier
    s_add_u32 s43, s41, 0x280000
    s_add_u32 m0, s51, 0x24000
    s_nop 0
    buffer_load_dwordx4 v15, s[12:15], s43 offen nt lds
    s_add_u32 s43, s41, 0x288000
    s_add_u32 m0, s51, 0x25000
    s_nop 0
    buffer_load_dwordx4 v15, s[12:15], s43 offen nt lds
    s_add_u32 s43, s41, 0x380000
    s_add_u32 m0, s51, 0x26000
    s_nop 0
    buffer_load_dwordx4 v15, s[12:15], s43 offen nt lds
    s_add_u32 s43, s41, 0x388000
    s_add_u32 m0, s51, 0x27000
    s_nop 0
    buffer_load_dwordx4 v15, s[12:15], s43 offen nt lds
    s_mov_b32 s12, s64
    s_and_b32 s13, s65, 0xffff
    v_xor_b32 v15, 0, v14
    v_lshl_add_u32 v15, v15, 15, v8
    s_add_u32 s43, s41, 0x0
    s_add_u32 m0, s51, 0x8000
    s_nop 0
    buffer_load_dwordx4 v15, s[12:15], s43 offen lds
    s_add_u32 s43, s41, 0x8000
    s_add_u32 m0, s51, 0x9000
    s_nop 0
    buffer_load_dwordx4 v15, s[12:15], s43 offen lds
    s_add_u32 s43, s41, 0x100000
    s_add_u32 m0, s51, 0xa000
    s_nop 0
    buffer_load_dwordx4 v15, s[12:15], s43 offen lds
    s_add_u32 s43, s41, 0x108000
    s_add_u32 m0, s51, 0xb000
    s_nop 0
    buffer_load_dwordx4 v15, s[12:15], s43 offen lds
    s_waitcnt vmcnt(12)
    s_barrier
    v_xor_b32 v13, 0x0, v11
    v_add_u32 v13, 0x10000, v13
    ds_read_b64_tr_b16 v[104:105], v13
    ds_read_b64_tr_b16 v[106:107], v13 offset:1024
    ds_read_b64_tr_b16 v[108:109], v13 offset:16384
    ds_read_b64_tr_b16 v[110:111], v13 offset:17408
    v_xor_b32 v13, 0x20, v11
    v_add_u32 v13, 0x10000, v13
    ds_read_b64_tr_b16 v[32:33], v13
    ds_read_b64_tr_b16 v[34:35], v13 offset:1024
    ds_read_b64_tr_b16 v[36:37], v13 offset:16384
    ds_read_b64_tr_b16 v[38:39], v13 offset:17408
    v_xor_b32 v13, 0x1000, v11
    v_add_u32 v13, 0x10000, v13
    ds_read_b64_tr_b16 a[112:113], v13
    ds_read_b64_tr_b16 a[114:115], v13 offset:1024
    ds_read_b64_tr_b16 a[116:117], v13 offset:16384
    ds_read_b64_tr_b16 a[118:119], v13 offset:17408
    v_xor_b32 v13, 0x1020, v11
    v_add_u32 v13, 0x10000, v13
    ds_read_b64_tr_b16 a[120:121], v13
    ds_read_b64_tr_b16 a[122:123], v13 offset:1024
    ds_read_b64_tr_b16 a[124:125], v13 offset:16384
    ds_read_b64_tr_b16 a[126:127], v13 offset:17408
    s_waitcnt lgkmcnt(0)
    s_barrier
    s_add_u32 s43, s41, 0x200000
    s_add_u32 m0, s51, 0xc000
    s_nop 0
    buffer_load_dwordx4 v15, s[12:15], s43 offen lds
    s_add_u32 s43, s41, 0x208000
    s_add_u32 m0, s51, 0xd000
    s_nop 0
    buffer_load_dwordx4 v15, s[12:15], s43 offen lds
    s_add_u32 s43, s41, 0x300000
    s_add_u32 m0, s51, 0xe000
    s_nop 0
    buffer_load_dwordx4 v15, s[12:15], s43 offen lds
    s_add_u32 s43, s41, 0x308000
    s_add_u32 m0, s51, 0xf000
    s_nop 0
    buffer_load_dwordx4 v15, s[12:15], s43 offen lds
    v_xor_b32 v15, 2, v14
    v_lshl_add_u32 v15, v15, 15, v8
    s_add_u32 s43, s41, 0x0
    s_add_u32 m0, s51, 0x10000
    s_nop 0
    buffer_load_dwordx4 v15, s[12:15], s43 offen lds
    s_add_u32 s43, s41, 0x8000
    s_add_u32 m0, s51, 0x11000
    s_nop 0
    buffer_load_dwordx4 v15, s[12:15], s43 offen lds
    s_add_u32 s43, s41, 0x100000
    s_add_u32 m0, s51, 0x12000
    s_nop 0
    buffer_load_dwordx4 v15, s[12:15], s43 offen lds
    s_add_u32 s43, s41, 0x108000
    s_add_u32 m0, s51, 0x13000
    s_nop 0
    buffer_load_dwordx4 v15, s[12:15], s43 offen lds
    s_waitcnt vmcnt(12)
    s_barrier
    v_xor_b32 v13, 0x0, v11
    v_add_u32 v13, 0x18000, v13
    ds_read_b64_tr_b16 a[144:145], v13
    ds_read_b64_tr_b16 a[146:147], v13 offset:1024
    ds_read_b64_tr_b16 a[148:149], v13 offset:16384
    ds_read_b64_tr_b16 a[150:151], v13 offset:17408
    v_xor_b32 v13, 0x20, v11
    v_add_u32 v13, 0x18000, v13
    ds_read_b64_tr_b16 a[152:153], v13
    ds_read_b64_tr_b16 a[154:155], v13 offset:1024
    ds_read_b64_tr_b16 a[156:157], v13 offset:16384
    ds_read_b64_tr_b16 a[158:159], v13 offset:17408
    v_xor_b32 v13, 0x1000, v11
    v_add_u32 v13, 0x18000, v13
    ds_read_b64_tr_b16 a[176:177], v13
    ds_read_b64_tr_b16 a[178:179], v13 offset:1024
    ds_read_b64_tr_b16 a[180:181], v13 offset:16384
    ds_read_b64_tr_b16 a[182:183], v13 offset:17408
    v_xor_b32 v13, 0x1020, v11
    v_add_u32 v13, 0x18000, v13
    ds_read_b64_tr_b16 a[184:185], v13
    ds_read_b64_tr_b16 a[186:187], v13 offset:1024
    ds_read_b64_tr_b16 a[188:189], v13 offset:16384
    ds_read_b64_tr_b16 a[190:191], v13 offset:17408
    s_waitcnt lgkmcnt(0)
    s_barrier
    s_add_u32 s43, s41, 0x200000
    s_add_u32 m0, s51, 0x14000
    s_nop 0
    buffer_load_dwordx4 v15, s[12:15], s43 offen lds
    s_add_u32 s43, s41, 0x208000
    s_add_u32 m0, s51, 0x15000
    s_nop 0
    buffer_load_dwordx4 v15, s[12:15], s43 offen lds
    s_add_u32 s43, s41, 0x300000
    s_add_u32 m0, s51, 0x16000
    s_nop 0
    buffer_load_dwordx4 v15, s[12:15], s43 offen lds
    s_add_u32 s43, s41, 0x308000
    s_add_u32 m0, s51, 0x17000
    s_nop 0
    buffer_load_dwordx4 v15, s[12:15], s43 offen lds
    s_mov_b32 s12, s66
    s_and_b32 s13, s67, 0xffff
    s_add_u32 s43, s42, 0x80
    s_add_u32 m0, s51, 0x18000
    s_nop 0
    buffer_load_dwordx4 v10, s[12:15], s43 offen lds
    s_add_u32 s43, s42, 0x4080
    s_add_u32 m0, s51, 0x19000
    s_nop 0
    buffer_load_dwordx4 v9, s[12:15], s43 offen lds
    s_add_u32 s43, s42, 0x8080
    s_add_u32 m0, s51, 0x1a000
    s_nop 0
    buffer_load_dwordx4 v10, s[12:15], s43 offen lds
    s_add_u32 s43, s42, 0xc080
    s_add_u32 m0, s51, 0x1b000
    s_nop 0
    buffer_load_dwordx4 v9, s[12:15], s43 offen lds
    s_waitcnt vmcnt(12)
    s_barrier
    v_xor_b32 v13, 0x0, v11
    v_add_u32 v13, 0x0, v13
    ds_read_b64_tr_b16 a[192:193], v13
    ds_read_b64_tr_b16 a[194:195], v13 offset:1024
    ds_read_b64_tr_b16 a[196:197], v13 offset:16384
    ds_read_b64_tr_b16 a[198:199], v13 offset:17408
    v_xor_b32 v13, 0x20, v11
    v_add_u32 v13, 0x0, v13
    ds_read_b64_tr_b16 a[200:201], v13
    ds_read_b64_tr_b16 a[202:203], v13 offset:1024
    ds_read_b64_tr_b16 a[204:205], v13 offset:16384
    ds_read_b64_tr_b16 a[206:207], v13 offset:17408
    v_xor_b32 v13, 0x1000, v11
    v_add_u32 v13, 0x0, v13
    ds_read_b64_tr_b16 a[224:225], v13
    ds_read_b64_tr_b16 a[226:227], v13 offset:1024
    ds_read_b64_tr_b16 a[228:229], v13 offset:16384
    ds_read_b64_tr_b16 a[230:231], v13 offset:17408
    v_xor_b32 v13, 0x1020, v11
    v_add_u32 v13, 0x0, v13
    ds_read_b64_tr_b16 a[232:233], v13
    ds_read_b64_tr_b16 a[234:235], v13 offset:1024
    ds_read_b64_tr_b16 a[236:237], v13 offset:16384
    ds_read_b64_tr_b16 a[238:239], v13 offset:17408
    s_waitcnt lgkmcnt(0)
    s_barrier
    s_add_u32 s43, s42, 0x10280
    s_add_u32 m0, s51, 0x1c000
    s_nop 0
    buffer_load_dwordx4 v10, s[12:15], s43 offen lds
    s_add_u32 s43, s42, 0x14280
    s_add_u32 m0, s51, 0x1d000
    s_nop 0
    buffer_load_dwordx4 v9, s[12:15], s43 offen lds
    s_add_u32 s43, s42, 0x18280
    s_add_u32 m0, s51, 0x1e000
    s_nop 0
    buffer_load_dwordx4 v10, s[12:15], s43 offen lds
    s_add_u32 s43, s42, 0x1c280
    s_add_u32 m0, s51, 0x1f000
    s_nop 0
    buffer_load_dwordx4 v9, s[12:15], s43 offen lds
    s_add_u32 s43, s42, 0x10080
    s_add_u32 m0, s51, 0x20000
    s_nop 0
    buffer_load_dwordx4 v10, s[12:15], s43 offen lds
    s_add_u32 s43, s42, 0x14080
    s_add_u32 m0, s51, 0x21000
    s_nop 0
    buffer_load_dwordx4 v9, s[12:15], s43 offen lds
    s_add_u32 s43, s42, 0x18080
    s_add_u32 m0, s51, 0x22000
    s_nop 0
    buffer_load_dwordx4 v10, s[12:15], s43 offen lds
    s_add_u32 s43, s42, 0x1c080
    s_add_u32 m0, s51, 0x23000
    s_nop 0
    buffer_load_dwordx4 v9, s[12:15], s43 offen lds
    s_waitcnt vmcnt(12)
    s_barrier
    s_cmp_lg_u32 s21, 0
    s_cbranch_scc1 L_arr_51
    v_mov_b32 v23, 1
    s_mov_b64 exec, 1
    buffer_atomic_add v23, off, s[16:19], 0 offset:8
    s_mov_b64 exec, -1
L_arr_51:
    v_xor_b32 v13, 0x0, v11
    v_add_u32 v13, 0x8000, v13
    ds_read_b64_tr_b16 v[128:129], v13
    ds_read_b64_tr_b16 v[130:131], v13 offset:1024
    ds_read_b64_tr_b16 v[132:133], v13 offset:16384
    ds_read_b64_tr_b16 v[134:135], v13 offset:17408
    v_xor_b32 v13, 0x20, v11
    v_add_u32 v13, 0x8000, v13
    ds_read_b64_tr_b16 v[136:137], v13
    ds_read_b64_tr_b16 v[138:139], v13 offset:1024
    ds_read_b64_tr_b16 v[140:141], v13 offset:16384
    ds_read_b64_tr_b16 v[142:143], v13 offset:17408
    v_xor_b32 v13, 0x1000, v11
    v_add_u32 v13, 0x8000, v13
    ds_read_b64_tr_b16 v[160:161], v13
    ds_read_b64_tr_b16 v[162:163], v13 offset:1024
    ds_read_b64_tr_b16 v[164:165], v13 offset:16384
    ds_read_b64_tr_b16 v[166:167], v13 offset:17408
    v_xor_b32 v13, 0x1020, v11
    v_add_u32 v13, 0x8000, v13
    ds_read_b64_tr_b16 v[168:169], v13
    ds_read_b64_tr_b16 v[170:171], v13 offset:1024
    ds_read_b64_tr_b16 v[172:173], v13 offset:16384
    ds_read_b64_tr_b16 v[174:175], v13 offset:17408
    s_waitcnt lgkmcnt(0)
    s_barrier
    s_add_u32 s43, s42, 0x280
    s_add_u32 m0, s51, 0x24000
    s_nop 0
    buffer_load_dwordx4 v10, s[12:15], s43 offen lds
    s_add_u32 s43, s42, 0x4280
    s_add_u32 m0, s51, 0x25000
    s_nop 0
    buffer_load_dwordx4 v9, s[12:15], s43 offen lds
    s_add_u32 s43, s42, 0x8280
    s_add_u32 m0, s51, 0x26000
    s_nop 0
    buffer_load_dwordx4 v10, s[12:15], s43 offen lds
    s_add_u32 s43, s42, 0xc280
    s_add_u32 m0, s51, 0x27000
    s_nop 0
    buffer_load_dwordx4 v9, s[12:15], s43 offen lds
    s_mov_b32 s12, s64
    s_and_b32 s13, s65, 0xffff
    v_xor_b32 v15, 0, v14
    v_lshl_add_u32 v15, v15, 15, v8
    s_add_u32 s43, s41, 0x80000
    s_add_u32 m0, s51, 0x8000
    s_nop 0
    buffer_load_dwordx4 v15, s[12:15], s43 offen lds
    s_add_u32 s43, s41, 0x88000
    s_add_u32 m0, s51, 0x9000
    s_nop 0
    buffer_load_dwordx4 v15, s[12:15], s43 offen lds
    s_add_u32 s43, s41, 0x180000
    s_add_u32 m0, s51, 0xa000
    s_nop 0
    buffer_load_dwordx4 v15, s[12:15], s43 offen lds
    s_add_u32 s43, s41, 0x188000
    s_add_u32 m0, s51, 0xb000
    s_nop 0
    buffer_load_dwordx4 v15, s[12:15], s43 offen lds
    s_waitcnt vmcnt(12)
    s_barrier
    v_xor_b32 v13, 0x0, v12
    v_add_u32 v13, 0x10000, v13
    ds_read_b64_tr_b16 v[192:193], v13
    ds_read_b64_tr_b16 v[194:195], v13 offset:512
    ds_read_b64_tr_b16 v[196:197], v13 offset:2048
    ds_read_b64_tr_b16 v[198:199], v13 offset:2560
    v_xor_b32 v13, 0x2000, v12
    v_add_u32 v13, 0x10000, v13
    ds_read_b64_tr_b16 v[200:201], v13
    ds_read_b64_tr_b16 v[202:203], v13 offset:512
    ds_read_b64_tr_b16 v[204:205], v13 offset:2048
    ds_read_b64_tr_b16 v[206:207], v13 offset:2560
    v_xor_b32 v13, 0x40, v12
    v_add_u32 v13, 0x10000, v13
    ds_read_b64_tr_b16 v[224:225], v13
    ds_read_b64_tr_b16 v[226:227], v13 offset:512
    ds_read_b64_tr_b16 v[228:229], v13 offset:2048
    ds_read_b64_tr_b16 v[230:231], v13 offset:2560
    v_xor_b32 v13, 0x2040, v12
    v_add_u32 v13, 0x10000, v13
    ds_read_b64_tr_b16 v[232:233], v13
    ds_read_b64_tr_b16 v[234:235], v13 offset:512
    ds_read_b64_tr_b16 v[236:237], v13 offset:2048
    ds_read_b64_tr_b16 v[238:239], v13 offset:2560
    s_waitcnt lgkmcnt(0)
    s_barrier
    s_add_u32 s43, s41, 0x280000
    s_add_u32 m0, s51, 0xc000
    s_nop 0
    buffer_load_dwordx4 v15, s[12:15], s43 offen lds
    s_add_u32 s43, s41, 0x288000
    s_add_u32 m0, s51, 0xd000
    s_nop 0
    buffer_load_dwordx4 v15, s[12:15], s43 offen lds
    s_add_u32 s43, s41, 0x380000
    s_add_u32 m0, s51, 0xe000
    s_nop 0
    buffer_load_dwordx4 v15, s[12:15], s43 offen lds
    s_add_u32 s43, s41, 0x388000
    s_add_u32 m0, s51, 0xf000
    s_nop 0
    buffer_load_dwordx4 v15, s[12:15], s43 offen lds
    v_xor_b32 v15, 2, v14
    v_lshl_add_u32 v15, v15, 15, v8
    s_add_u32 s43, s41, 0x80000
    s_add_u32 m0, s51, 0x10000
    s_nop 0
    buffer_load_dwordx4 v15, s[12:15], s43 offen lds
    s_add_u32 s43, s41, 0x88000
    s_add_u32 m0, s51, 0x11000
    s_nop 0
    buffer_load_dwordx4 v15, s[12:15], s43 offen lds
    s_add_u32 s43, s41, 0x180000
    s_add_u32 m0, s51, 0x12000
    s_nop 0
    buffer_load_dwordx4 v15, s[12:15], s43 offen lds
    s_add_u32 s43, s41, 0x188000
    s_add_u32 m0, s51, 0x13000
    s_nop 0
    buffer_load_dwordx4 v15, s[12:15], s43 offen lds
    s_waitcnt vmcnt(12)
    s_barrier
    v_xor_b32 v13, 0x0, v12
    v_add_u32 v13, 0x18000, v13
    ds_read_b64_tr_b16 v[208:209], v13
    ds_read_b64_tr_b16 v[210:211], v13 offset:512
    ds_read_b64_tr_b16 v[212:213], v13 offset:2048
    ds_read_b64_tr_b16 v[214:215], v13 offset:2560
    v_xor_b32 v13, 0x2000, v12
    v_add_u32 v13, 0x18000, v13
    ds_read_b64_tr_b16 v[216:217], v13
    ds_read_b64_tr_b16 v[218:219], v13 offset:512
    ds_read_b64_tr_b16 v[220:221], v13 offset:2048
    ds_read_b64_tr_b16 v[222:223], v13 offset:2560
    v_xor_b32 v13, 0x40, v12
    v_add_u32 v13, 0x18000, v13
    ds_read_b64_tr_b16 v[240:241], v13
    ds_read_b64_tr_b16 v[242:243], v13 offset:512
    ds_read_b64_tr_b16 v[244:245], v13 offset:2048
    ds_read_b64_tr_b16 v[246:247], v13 offset:2560
    v_xor_b32 v13, 0x2040, v12
    v_add_u32 v13, 0x18000, v13
    ds_read_b64_tr_b16 v[248:249], v13
    ds_read_b64_tr_b16 v[250:251], v13 offset:512
    ds_read_b64_tr_b16 v[252:253], v13 offset:2048
    ds_read_b64_tr_b16 v[254:255], v13 offset:2560
    s_waitcnt lgkmcnt(0)
    s_barrier
    s_add_u32 s43, s41, 0x280000
    s_add_u32 m0, s51, 0x14000
    s_nop 0
    buffer_load_dwordx4 v15, s[12:15], s43 offen lds
    s_add_u32 s43, s41, 0x288000
    s_add_u32 m0, s51, 0x15000
    s_nop 0
    buffer_load_dwordx4 v15, s[12:15], s43 offen lds
    s_add_u32 s43, s41, 0x380000
    s_add_u32 m0, s51, 0x16000
    s_nop 0
    buffer_load_dwordx4 v15, s[12:15], s43 offen lds
    s_add_u32 s43, s41, 0x388000
    s_add_u32 m0, s51, 0x17000
    s_nop 0
    buffer_load_dwordx4 v15, s[12:15], s43 offen lds
    ds_write_b128 v124, v[192:195]
    ds_write_b128 v124, v[196:199] offset:1024
    ds_write_b128 v124, v[200:203] offset:2048
    ds_write_b128 v124, v[204:207] offset:3072
    ds_write_b128 v124, v[208:211] offset:4096
    ds_write_b128 v124, v[212:215] offset:5120
    ds_write_b128 v124, v[216:219] offset:6144
    ds_write_b128 v124, v[220:223] offset:7168
    ds_write_b128 v124, v[224:227] offset:32768
    ds_write_b128 v124, v[228:231] offset:33792
    ds_write_b128 v124, v[232:235] offset:34816
    ds_write_b128 v124, v[236:239] offset:35840
    ds_write_b128 v124, v[240:243] offset:36864
    ds_write_b128 v124, v[244:247] offset:37888
    ds_write_b128 v124, v[248:251] offset:38912
    ds_write_b128 v124, v[252:255] offset:39936
    s_waitcnt vmcnt(8)
    s_barrier
    v_xor_b32 v13, 0x0, v11
    v_add_u32 v13, 0x0, v13
    ds_read_b64_tr_b16 a[208:209], v13
    ds_read_b64_tr_b16 a[210:211], v13 offset:1024
    ds_read_b64_tr_b16 a[212:213], v13 offset:16384
    ds_read_b64_tr_b16 a[214:215], v13 offset:17408
    v_xor_b32 v13, 0x20, v11
    v_add_u32 v13, 0x0, v13
    ds_read_b64_tr_b16 a[216:217], v13
    ds_read_b64_tr_b16 a[218:219], v13 offset:1024
    ds_read_b64_tr_b16 a[220:221], v13 offset:16384
    ds_read_b64_tr_b16 a[222:223], v13 offset:17408
    v_xor_b32 v13, 0x1000, v11
    v_add_u32 v13, 0x0, v13
    ds_read_b64_tr_b16 a[240:241], v13
    ds_read_b64_tr_b16 a[242:243], v13 offset:1024
    ds_read_b64_tr_b16 a[244:245], v13 offset:16384
    ds_read_b64_tr_b16 a[246:247], v13 offset:17408
    v_xor_b32 v13, 0x1020, v11
    v_add_u32 v13, 0x0, v13
    ds_read_b64_tr_b16 a[248:249], v13
    ds_read_b64_tr_b16 a[250:251], v13 offset:1024
    ds_read_b64_tr_b16 a[252:253], v13 offset:16384
    ds_read_b64_tr_b16 a[254:255], v13 offset:17408
    s_waitcnt lgkmcnt(0)
    s_barrier
    s_mov_b32 s12, s66
    s_and_b32 s13, s67, 0xffff
    s_add_u32 s43, s42, 0x0
    s_add_u32 m0, s51, 0x8000
    s_nop 0
    buffer_load_dwordx4 v10, s[12:15], s43 offen lds
    s_add_u32 s43, s42, 0x4000
    s_add_u32 m0, s51, 0x9000
    s_nop 0
    buffer_load_dwordx4 v9, s[12:15], s43 offen lds
    s_add_u32 s43, s42, 0x8000
    s_add_u32 m0, s51, 0xa000
    s_nop 0
    buffer_load_dwordx4 v10, s[12:15], s43 offen lds
    s_add_u32 s43, s42, 0xc000
    s_add_u32 m0, s51, 0xb000
    s_nop 0
    buffer_load_dwordx4 v9, s[12:15], s43 offen lds
    s_add_u32 s43, s42, 0x10200
    s_add_u32 m0, s51, 0xc000
    s_nop 0
    buffer_load_dwordx4 v10, s[12:15], s43 offen lds
    s_add_u32 s43, s42, 0x14200
    s_add_u32 m0, s51, 0xd000
    s_nop 0
    buffer_load_dwordx4 v9, s[12:15], s43 offen lds
    s_add_u32 s43, s42, 0x18200
    s_add_u32 m0, s51, 0xe000
    s_nop 0
    buffer_load_dwordx4 v10, s[12:15], s43 offen lds
    s_add_u32 s43, s42, 0x1c200
    s_add_u32 m0, s51, 0xf000
    s_nop 0
    buffer_load_dwordx4 v9, s[12:15], s43 offen lds
    s_waitcnt vmcnt(8)
    s_barrier
    v_xor_b32 v13, 0x0, v11
    v_add_u32 v13, 0x8000, v13
    ds_read_b64_tr_b16 v[144:145], v13
    ds_read_b64_tr_b16 v[146:147], v13 offset:1024
    ds_read_b64_tr_b16 v[148:149], v13 offset:16384
    ds_read_b64_tr_b16 v[150:151], v13 offset:17408
    v_xor_b32 v13, 0x20, v11
    v_add_u32 v13, 0x8000, v13
    ds_read_b64_tr_b16 v[152:153], v13
    ds_read_b64_tr_b16 v[154:155], v13 offset:1024
    ds_read_b64_tr_b16 v[156:157], v13 offset:16384
    ds_read_b64_tr_b16 v[158:159], v13 offset:17408
    v_xor_b32 v13, 0x1000, v11
    v_add_u32 v13, 0x8000, v13
    ds_read_b64_tr_b16 v[176:177], v13
    ds_read_b64_tr_b16 v[178:179], v13 offset:1024
    ds_read_b64_tr_b16 v[180:181], v13 offset:16384
    ds_read_b64_tr_b16 v[182:183], v13 offset:17408
    v_xor_b32 v13, 0x1020, v11
    v_add_u32 v13, 0x8000, v13
    ds_read_b64_tr_b16 v[184:185], v13
    ds_read_b64_tr_b16 v[186:187], v13 offset:1024
    ds_read_b64_tr_b16 v[188:189], v13 offset:16384
    ds_read_b64_tr_b16 v[190:191], v13 offset:17408
    s_waitcnt lgkmcnt(0)
    s_barrier
    s_add_u32 s43, s42, 0x10000
    s_add_u32 m0, s51, 0x10000
    s_nop 0
    buffer_load_dwordx4 v10, s[12:15], s43 offen lds
    s_add_u32 s43, s42, 0x14000
    s_add_u32 m0, s51, 0x11000
    s_nop 0
    buffer_load_dwordx4 v9, s[12:15], s43 offen lds
    s_add_u32 s43, s42, 0x18000
    s_add_u32 m0, s51, 0x12000
    s_nop 0
    buffer_load_dwordx4 v10, s[12:15], s43 offen lds
    s_add_u32 s43, s42, 0x1c000
    s_add_u32 m0, s51, 0x13000
    s_nop 0
    buffer_load_dwordx4 v9, s[12:15], s43 offen lds
    s_add_u32 s43, s42, 0x200
    s_add_u32 m0, s51, 0x14000
    s_nop 0
    buffer_load_dwordx4 v10, s[12:15], s43 offen lds
    s_add_u32 s43, s42, 0x4200
    s_add_u32 m0, s51, 0x15000
    s_nop 0
    buffer_load_dwordx4 v9, s[12:15], s43 offen lds
    s_add_u32 s43, s42, 0x8200
    s_add_u32 m0, s51, 0x16000
    s_nop 0
    buffer_load_dwordx4 v10, s[12:15], s43 offen lds
    s_add_u32 s43, s42, 0xc200
    s_add_u32 m0, s51, 0x17000
    s_nop 0
    buffer_load_dwordx4 v9, s[12:15], s43 offen lds
    s_waitcnt vmcnt(8)
    s_barrier
    v_xor_b32 v13, 0x0, v12
    v_add_u32 v13, 0x0, v13
    ds_read_b64_tr_b16 v[192:193], v13
    ds_read_b64_tr_b16 v[194:195], v13 offset:512
    ds_read_b64_tr_b16 v[196:197], v13 offset:2048
    ds_read_b64_tr_b16 v[198:199], v13 offset:2560
    v_xor_b32 v13, 0x2000, v12
    v_add_u32 v13, 0x0, v13
    ds_read_b64_tr_b16 v[200:201], v13
    ds_read_b64_tr_b16 v[202:203], v13 offset:512
    ds_read_b64_tr_b16 v[204:205], v13 offset:2048
    ds_read_b64_tr_b16 v[206:207], v13 offset:2560
    v_xor_b32 v13, 0x40, v12
    v_add_u32 v13, 0x0, v13
    ds_read_b64_tr_b16 v[224:225], v13
    ds_read_b64_tr_b16 v[226:227], v13 offset:512
    ds_read_b64_tr_b16 v[228:229], v13 offset:2048
    ds_read_b64_tr_b16 v[230:231], v13 offset:2560
    v_xor_b32 v13, 0x2040, v12
    v_add_u32 v13, 0x0, v13
    ds_read_b64_tr_b16 v[232:233], v13
    ds_read_b64_tr_b16 v[234:235], v13 offset:512
    ds_read_b64_tr_b16 v[236:237], v13 offset:2048
    ds_read_b64_tr_b16 v[238:239], v13 offset:2560
    s_lshr_b32 s43, s20, 1
    s_lshl_b32 s43, s43, 7
    s_and_b32 s40, s20, 1
    s_lshl_b32 s40, s40, 4
    s_add_u32 s43, s43, s40
    s_add_u32 s44, s43, 0x1000
    s_cmp_eq_u32 s21, 0
    s_cselect_b32 s44, s44, 0x7ff00000
    s_mov_b32 s22, 0
    s_mov_b32 s33, 0
    s_xor_b32 s53, s29, 1024
    s_add_u32 s23, s51, 0x7010000
    s_add_u32 s48, s23, 4096
    s_mov_b32 s24, 0x7012000
    s_add_u32 s55, s24, 16384
    s_mov_b32 s25, 0x7100000
    s_mov_b32 s26, 0x7101000
    v_mov_b32 v112, 0
    v_mov_b32 v113, 0
    v_mov_b32 v114, 0
    v_mov_b32 v115, 0
    ds_write_b128 v117, v[112:115] offset:22528
    ds_write_b128 v117, v[112:115] offset:23552
    s_cmp_lg_u32 s21, 0
    s_cselect_b32 s40, -1, 0
    v_mov_b32 v126, s40
    v_bfe_u32 v1, v117, 4, 1
    v_lshlrev_b32 v1, 4, v1
    s_movk_i32 s43, 0x3f80
    v_lshlrev_b32 v125, v1, s43
    v_bfe_u32 v1, v117, 5, 3
    v_cmp_eq_u32 s[68:69], 0, v1
    v_cmp_eq_u32 s[70:71], 1, v1
    v_cmp_eq_u32 s[72:73], 2, v1
    v_cmp_eq_u32 s[74:75], 3, v1
    v_mov_b32 v40, 0
    v_mov_b32 v41, 0
    v_mov_b32 v42, 0
    v_mov_b32 v43, 0
    v_mov_b32 v44, 0
    v_mov_b32 v45, 0
    v_mov_b32 v46, 0
    v_mov_b32 v47, 0
    v_mov_b32 v48, 0
    v_mov_b32 v49, 0
    v_mov_b32 v50, 0
    v_mov_b32 v51, 0
    v_mov_b32 v52, 0
    v_mov_b32 v53, 0
    v_mov_b32 v54, 0
    v_mov_b32 v55, 0
    s_mov_b32 s45, 0
    s_mov_b32 s46, 0
    s_mov_b32 s47, 0
    s_mov_b32 s76, 0
    s_and_b32 s43, s21, 1
    s_lshl_b32 s43, s43, 5
    s_add_u32 s43, s43, s20
    s_lshl_b32 s43, s43, 6
    s_add_u32 s28, s43, 0x2000
    s_mov_b32 s59, 0
    s_waitcnt vmcnt(0) lgkmcnt(0)
    s_barrier
    v_xor_b32 v13, 0x0, v12
    v_add_u32 v13, 0x8000, v13
    ds_read_b64_tr_b16 v[208:209], v13
    ds_read_b64_tr_b16 v[210:211], v13 offset:512
    ds_read_b64_tr_b16 v[212:213], v13 offset:2048
    ds_read_b64_tr_b16 v[214:215], v13 offset:2560
    v_xor_b32 v13, 0x2000, v12
    v_add_u32 v13, 0x8000, v13
    ds_read_b64_tr_b16 v[216:217], v13
    ds_read_b64_tr_b16 v[218:219], v13 offset:512
    ds_read_b64_tr_b16 v[220:221], v13 offset:2048
    ds_read_b64_tr_b16 v[222:223], v13 offset:2560
    v_xor_b32 v13, 0x40, v12
    v_add_u32 v13, 0x8000, v13
    ds_read_b64_tr_b16 v[240:241], v13
    ds_read_b64_tr_b16 v[242:243], v13 offset:512
    ds_read_b64_tr_b16 v[244:245], v13 offset:2048
    ds_read_b64_tr_b16 v[246:247], v13 offset:2560
    v_xor_b32 v13, 0x2040, v12
    v_add_u32 v13, 0x8000, v13
    ds_read_b64_tr_b16 v[248:249], v13
    ds_read_b64_tr_b16 v[250:251], v13 offset:512
    ds_read_b64_tr_b16 v[252:253], v13 offset:2048
    ds_read_b64_tr_b16 v[254:255], v13 offset:2560
    ds_write_b128 v123, v[80:83]
    ds_write_b128 v123, v[84:87] offset:1024
    ds_write_b128 v123, v[56:59] offset:2048
    ds_write_b128 v123, v[60:63] offset:3072
    ds_write_b128 v123, v[88:91] offset:4096
    ds_write_b128 v123, v[92:95] offset:5120
    ds_write_b128 v123, v[96:99] offset:6144
    ds_write_b128 v123, v[100:103] offset:7168
    s_cmp_eq_u32 s57, 1
    s_cbranch_scc1 L_started_52
    v_lshrrev_b32 v1, 4, v117
    v_and_b32 v2, 15, v1
    v_lshrrev_b32 v1, 4, v1
    v_lshlrev_b32 v1, 11, v1
    v_lshl_add_u32 v1, v2, 2, v1
    s_lshl_b32 s43, s20, 6
    s_add_u32 s43, s43, 0x2000
    s_mov_b32 exec_lo, 0x10001
    s_mov_b32 exec_hi, 0
    s_mov_b32 s96, 0
L_poll_53:
    buffer_load_dword v2, v1, s[8:11], s43 offen sc1
    s_waitcnt vmcnt(0)
    v_cmp_gt_u32 vcc, 1, v2
    s_cbranch_vccz L_polld_54
    s_sleep 8
    s_add_u32 s96, s96, 1
    s_cmp_lt_u32 s96, 0x10000
    s_cbranch_scc1 L_poll_53
L_polld_54:
    s_mov_b64 exec, -1
    s_add_u32 m0, s52, 8192
    s_nop 0
    buffer_load_dwordx4 v117, s[8:11], s30 offen lds
    buffer_load_dwordx4 v117, s[8:11], s30 offen offset:1024 lds
    s_add_u32 m0, s52, 0x6000
    s_nop 0
    buffer_load_dwordx4 v117, s[8:11], s31 offen lds
    buffer_load_dwordx4 v117, s[8:11], s31 offen offset:1024 lds
    s_mov_b32 s49, 0
L_cb_poll_56:
    buffer_load_dword v3, off, s[16:19], 0 offset:8 sc1
    s_waitcnt vmcnt(0)
    v_readfirstlane_b32 s43, v3
    s_nop 0
    s_cmp_ge_u32 s43, 32
    s_cbranch_scc1 L_started_52
    s_sleep 8
    s_add_u32 s49, s49, 1
    s_cmp_lt_u32 s49, 0x40000
    s_cbranch_scc1 L_cb_poll_56
L_started_52:
    v_lshrrev_b32 v1, 2, v117
    s_cmp_lt_u32 s21, 2
    s_cselect_b64 vcc, -1, 0
    v_cndmask_b32 v119, v119, v1, vcc
    s_add_u32 m0, s51, 4096
    v_mov_b32 v24, v32
    v_mov_b32 v25, v33
    v_mov_b32 v26, v34
    v_mov_b32 v27, v35
    v_mov_b32 v28, v36
    v_mov_b32 v29, v37
    v_mov_b32 v30, v38
    v_mov_b32 v31, v39
    s_add_u32 s30, s30, 0x40000
    s_add_u32 s31, s31, 0x40000
    s_mov_b32 s49, 0
    s_waitcnt vmcnt(0) lgkmcnt(0)
    s_barrier
    ds_write_b128 v123, v[64:67] offset:32768
    ds_write_b128 v123, v[68:71] offset:33792
    ds_write_b128 v123, v[72:75] offset:34816
    ds_write_b128 v123, v[76:79] offset:35840
    ds_write_b128 v123, v[104:107] offset:36864
    ds_write_b128 v123, v[108:111] offset:37888
    ds_write_b128 v123, v[32:35] offset:38912
    ds_write_b128 v123, v[36:39] offset:39936
    v_mov_b32 v32, 0
    v_mov_b32 v33, 0
    v_mov_b32 v34, 0
    v_mov_b32 v35, 0
    v_mov_b32 v36, 0
    v_mov_b32 v37, 0
    v_mov_b32 v38, 0
    v_mov_b32 v39, 0
    s_nop 4
    s_cmp_eq_u32 s21, 1
    s_cbranch_scc1 L_chain_top1_s
    s_cmp_eq_u32 s21, 2
    s_cbranch_scc1 L_chain_top2_s
    s_cmp_eq_u32 s21, 3
    s_cbranch_scc1 L_chain_top3_s
.p2align 6
L_chain_top0_s:
    buffer_load_dwordx4 v[0:3], v117, s[8:11], s23 offen sc1
    v_mov_b32 v15, 0
    v_mov_b32 v15, 0
    v_mov_b32 v15, 0
    v_mov_b32 v15, 0
    v_mov_b32 v15, 0
    v_mov_b32 v15, 0
    v_mov_b32 v15, 0
    v_mov_b32 v15, 0
    v_mov_b32 v15, 0
    v_mov_b32 v15, 0
    v_mov_b32 v15, 0
    v_mov_b32 v15, 0
    v_mov_b32 v15, 0
    v_mov_b32 v15, 0
    v_mov_b32 v15, 0
    v_mov_b32 v15, 0
    buffer_load_dwordx4 v[0:3], v117, s[8:11], s23 offen sc1
    v_mov_b32 v15, 0
    v_mov_b32 v15, 0
    v_mov_b32 v15, 0
    v_mov_b32 v15, 0
    v_mov_b32 v15, 0
    v_mov_b32 v15, 0
    v_mov_b32 v15, 0
    v_mov_b32 v15, 0
    v_mov_b32 v15, 0
    v_mov_b32 v15, 0
    v_mov_b32 v15, 0
    v_mov_b32 v15, 0
    v_mov_b32 v15, 0
    v_mov_b32 v15, 0
    v_mov_b32 v15, 0
    v_mov_b32 v15, 0
L_mret_58:
    buffer_load_dwordx4 v[0:3], v117, s[8:11], s23 offen sc1
    s_add_u32 s45, s45, 1
    s_cmp_lt_u32 s45, 0x10000
    s_cselect_b32 s56, -2, -1
    s_nop 3
    v_mov_b32 v32, 0
    v_mov_b32 v33, 0
    v_mov_b32 v34, 0
    v_mov_b32 v35, 0
    s_waitcnt vmcnt(2)
    v_max3_u32 v15, v0, v1, v2
    v_max_u32 v15, v15, v3
    v_cmp_lt_u32 vcc, s56, v15
    v_smfmac_f32_16x16x64_bf16 v[32:35], v[0:3], v[80:87], v116
    s_cbranch_vccnz L_mret_58
    ds_write_b128 v117, v[0:3]
    v_smfmac_f32_16x16x64_bf16 v[36:39], v[0:3], v[56:63], v116
    buffer_load_dwordx4 v[4:7], v117, s[8:11], s48 offen sc1
    v_smfmac_f32_16x16x64_bf16 v[40:43], v[0:3], v[64:71], v116
    buffer_load_dwordx4 v117, s[8:11], s48 offen sc1 lds
    s_mov_b32 m0, 8192
    v_smfmac_f32_16x16x64_bf16 v[44:47], v[0:3], v[72:79], v116
    s_waitcnt lgkmcnt(0)
    s_barrier
    ds_read_b128 v[8:11], v117 offset:1024
    v_smfmac_f32_16x16x64_bf16 v[48:51], v[0:3], a[192:199], v116
    ds_read_b128 v[16:19], v117 offset:2048
    ds_read_b128 v[20:23], v117 offset:3072
    v_smfmac_f32_16x16x64_bf16 v[52:55], v[0:3], a[200:207], v116
    ds_read_b128 v[80:83], v117 offset:14336
    s_waitcnt lgkmcnt(3)
    v_smfmac_f32_16x16x64_bf16 v[32:35], v[8:11], a[0:7], v116
    ds_read_b128 v[84:87], v117 offset:15360
    v_smfmac_f32_16x16x64_bf16 v[36:39], v[8:11], a[8:15], v116
    buffer_store_dwordx4 v[112:115], v117, s[8:11], s32 offen sc1
    s_waitcnt lgkmcnt(3)
    v_smfmac_f32_16x16x64_bf16 v[32:35], v[16:19], a[32:39], v116
    ds_read_b128 v[56:59], v117 offset:8192
    v_smfmac_f32_16x16x64_bf16 v[36:39], v[16:19], a[40:47], v116
    ds_read_b128 v[60:63], v117 offset:9216
    s_waitcnt lgkmcnt(4)
    v_smfmac_f32_16x16x64_bf16 v[32:35], v[20:23], a[64:71], v116
    ds_read_b128 v[64:67], v117 offset:10240
    v_smfmac_f32_16x16x64_bf16 v[36:39], v[20:23], a[72:79], v116
    ds_read_b128 v[68:71], v117 offset:11264
    v_smfmac_f32_16x16x64_bf16 v[40:43], v[8:11], a[96:103], v116
    ds_read_b128 v[72:75], v117 offset:12288
    v_smfmac_f32_16x16x64_bf16 v[40:43], v[16:19], a[128:135], v116
    ds_read_b128 v[76:79], v117 offset:13312
    v_smfmac_f32_16x16x64_bf16 v[40:43], v[20:23], a[160:167], v116
    s_waitcnt vmcnt(2)
    v_max3_u32 v15, v4, v5, v6
    v_smfmac_f32_16x16x64_bf16 v[44:47], v[8:11], a[104:111], v116
    v_max_u32 v15, v15, v7
    v_smfmac_f32_16x16x64_bf16 v[44:47], v[16:19], a[136:143], v116
    s_waitcnt vmcnt(1) lgkmcnt(0)
    v_cmp_lt_u32 vcc, s56, v15
    v_smfmac_f32_16x16x64_bf16 v[44:47], v[20:23], a[168:175], v116
    s_cbranch_vccnz L_mret_59
L_mgo_60:
    v_smfmac_f32_16x16x64_bf16 v[44:47], v[4:7], v[24:31], v116
    s_barrier
    ds_read_b128 v[12:15], v117 offset:5120
    v_smfmac_f32_16x16x64_bf16 v[32:35], v[4:7], v[88:95], v116
    ds_read_b128 v[24:27], v117 offset:6144
    v_smfmac_f32_16x16x64_bf16 v[36:39], v[4:7], v[96:103], v116
    ds_read_b128 v[28:31], v117 offset:7168
    v_smfmac_f32_16x16x64_bf16 v[40:43], v[4:7], v[104:111], v116
    ds_read_b128 v[88:91], v117 offset:24576
    s_waitcnt lgkmcnt(3)
    v_smfmac_f32_16x16x64_bf16 v[32:35], v[12:15], a[16:23], v116
    ds_read_b128 v[92:95], v117 offset:25600
    s_waitcnt lgkmcnt(3)
    v_smfmac_f32_16x16x64_bf16 v[32:35], v[24:27], a[48:55], v116
    buffer_load_dwordx4 v117, s[8:11], s30 offen lds
    s_waitcnt lgkmcnt(2)
    v_smfmac_f32_16x16x64_bf16 v[32:35], v[28:31], a[80:87], v116
    ds_read_b128 v[96:99], v117 offset:23552
    v_smfmac_f32_16x16x64_bf16 v[36:39], v[12:15], a[24:31], v116
    ds_read_b128 v[100:103], v117 offset:23552
    v_smfmac_f32_16x16x64_bf16 v[36:39], v[24:27], a[56:63], v116
    buffer_load_dwordx4 v117, s[8:11], s30 offen offset:1024 lds
    s_add_u32 m0, s52, 0x6000
    v_add_f32 v32, v32, v34
    v_smfmac_f32_16x16x64_bf16 v[36:39], v[28:31], a[88:95], v116
    ds_read_b128 v[104:107], v117 offset:23552
    v_add_f32 v33, v33, v35
    v_smfmac_f32_16x16x64_bf16 v[40:43], v[12:15], a[112:119], v116
    ds_read_b128 v[108:111], v117 offset:23552
    v_mul_f32 v32, s34, v32
    v_smfmac_f32_16x16x64_bf16 v[40:43], v[24:27], a[144:151], v116
    buffer_load_dword v125, v119, s[8:11], s28 offen sc1
    v_mul_f32 v33, s34, v33
    v_smfmac_f32_16x16x64_bf16 v[40:43], v[28:31], a[176:183], v116
    ds_read_b128 v[0:3], v124
    v_add_f32 v36, v36, v38
    v_smfmac_f32_16x16x64_bf16 v[48:51], v[4:7], a[208:215], v116
    v_add_f32 v37, v37, v39
    v_smfmac_f32_16x16x64_bf16 v[52:55], v[4:7], a[216:223], v116
    s_waitcnt lgkmcnt(5)
    buffer_load_dwordx4 v117, s[8:11], s31 offen lds
    v_mul_f32 v36, s34, v36
    v_smfmac_f32_16x16x64_bf16 v[44:47], v[12:15], a[120:127], v116
    ds_read_b128 v[4:7], v124 offset:1024
    v_mul_f32 v37, s34, v37
    v_smfmac_f32_16x16x64_bf16 v[44:47], v[24:27], a[152:159], v116
    v_cvt_pk_bf16_f32 v34, v32, v36
    v_smfmac_f32_16x16x64_bf16 v[44:47], v[28:31], a[184:191], v116
    buffer_load_dwordx4 v117, s[8:11], s31 offen offset:1024 lds
    s_mov_b32 m0, 4096
    v_cvt_pk_bf16_f32 v35, v33, v37
    v_add_f32 v40, v40, v42
    v_smfmac_f32_16x16x64_bf16 v[48:51], v[8:11], a[224:231], v116
    ds_write2_b32 v120, v34, v35 offset0:32 offset1:48
    v_add_f32 v41, v41, v43
    v_smfmac_f32_16x16x64_bf16 v[52:55], v[8:11], a[232:239], v116
    v_add_f32 v44, v44, v46
    v_add_f32 v45, v45, v47
    v_cvt_pk_bf16_f32 v113, v40, v44
    v_cvt_pk_bf16_f32 v115, v41, v45
    v_smfmac_f32_16x16x64_bf16 v[48:51], v[12:15], a[240:247], v116
    ds_write2_b32 v120, v113, v115 offset0:0 offset1:16
    v_smfmac_f32_16x16x64_bf16 v[52:55], v[12:15], a[248:255], v116
    s_cmp_eq_u32 s22, 63
    s_cbranch_scc1 L_chain_last_s
    buffer_store_dword v126, off, s[8:11], s44 sc1
    v_smfmac_f32_16x16x64_bf16 v[48:51], v[16:19], v[128:135], v116
    v_smfmac_f32_16x16x64_bf16 v[48:51], v[20:23], v[160:167], v116
    v_smfmac_f32_16x16x64_bf16 v[48:51], v[24:27], v[144:151], v116
    s_waitcnt lgkmcnt(0)
    s_barrier
    v_smfmac_f32_16x16x64_bf16 v[48:51], v[28:31], v[176:183], v116
    ds_read_b128 v[32:35], v121 offset:16384
    ds_read_b128 v[36:39], v121 offset:17408
    v_smfmac_f32_16x16x64_bf16 v[52:55], v[16:19], v[136:143], v116
    ds_read_b128 v[40:43], v121 offset:18432
    ds_read_b128 v[44:47], v121 offset:19456
    v_smfmac_f32_16x16x64_bf16 v[52:55], v[20:23], v[168:175], v116
    ds_read_b128 v[8:11], v124 offset:32768
    v_add_f32 v48, v48, v50
    v_smfmac_f32_16x16x64_bf16 v[52:55], v[24:27], v[152:159], v116
    ds_read_b128 v[12:15], v124 offset:33792
    v_add_f32 v49, v49, v51
    v_smfmac_f32_16x16x64_bf16 v[52:55], v[28:31], v[184:191], v116
    s_waitcnt lgkmcnt(5)
    v_cvt_pk_bf16_f32 v112, v48, v49
    v_mfma_f32_16x16x32_bf16 v[56:59], v[56:59], v[32:35], 0
    s_waitcnt lgkmcnt(4)
    v_mov_b32 v48, s50
    v_mov_b32 v49, s50
    v_mfma_f32_16x16x32_bf16 v[56:59], v[60:63], v[36:39], v[56:59]
    ds_read_b128 v[16:19], v124 offset:2048
    s_waitcnt lgkmcnt(4)
    v_mov_b32 v50, s50
    v_mov_b32 v51, s50
    v_mfma_f32_16x16x32_bf16 v[56:59], v[64:67], v[40:43], v[56:59]
    ds_read_b128 v[20:23], v124 offset:3072
    s_waitcnt lgkmcnt(4)
    v_add_f32 v52, v52, v54
    v_mfma_f32_16x16x32_bf16 v[56:59], v[68:71], v[44:47], v[56:59]
    ds_read_b128 v[24:27], v124 offset:4096
    v_add_f32 v53, v53, v55
    v_mfma_f32_16x16x32_bf16 v[60:63], v[72:75], v[32:35], 0
    ds_read_b128 v[28:31], v124 offset:5120
    v_cvt_pk_bf16_f32 v114, v52, v53
    v_mov_b32 v53, 0
    v_mfma_f32_16x16x32_bf16 v[60:63], v[76:79], v[36:39], v[60:63]
    v_exp_f32 v56, v56
    v_mfma_f32_16x16x32_bf16 v[60:63], v[80:83], v[40:43], v[60:63]
    v_exp_f32 v57, v57
    v_mfma_f32_16x16x32_bf16 v[60:63], v[84:87], v[44:47], v[60:63]
    v_exp_f32 v58, v58
    v_mfma_f32_16x16x32_bf16 v[64:67], v[32:35], v[32:35], 0
    v_exp_f32 v59, v59
    v_cvt_pk_bf16_f32 v68, v56, v57
    v_mfma_f32_16x16x32_bf16 v[64:67], v[36:39], v[36:39], v[64:67]
    v_exp_f32 v60, v60
    v_cvt_pk_bf16_f32 v69, v58, v59
    v_mfma_f32_16x16x32_bf16 v[64:67], v[40:43], v[40:43], v[64:67]
    v_exp_f32 v61, v61
    v_mfma_f32_16x16x32_bf16 v[64:67], v[44:47], v[44:47], v[64:67]
    v_exp_f32 v62, v62
    v_exp_f32 v63, v63
    v_cvt_pk_bf16_f32 v70, v60, v61
    v_cvt_pk_bf16_f32 v71, v62, v63
    s_nop 1
    v_mfma_f32_16x16x32_bf16 v[72:75], v[88:91], v[68:71], 0
    s_nop 0
    v_exp_f32 v64, v64
    v_mfma_f32_16x16x32_bf16 v[76:79], v[92:95], v[68:71], 0
    v_exp_f32 v65, v65
    v_mfma_f32_16x16x32_bf16 v[80:83], v[48:51], v[68:71], 0
    v_cvt_pk_bf16_f32 v52, v64, v65
    s_nop 1
    v_mfma_f32_16x16x16_bf16 v[72:75], v[112:113], v[52:53], v[72:75]
    ds_read_b128 v[32:35], v124 offset:6144
    v_mfma_f32_16x16x16_bf16 v[76:79], v[114:115], v[52:53], v[76:79]
    ds_read_b128 v[36:39], v124 offset:7168
    v_mfma_f32_16x16x16_bf16 v[80:83], v[48:49], v[52:53], v[80:83]
L_norm_61:
    s_mov_b64 vcc, s[36:37]
    v_mov_b32 v122, v122
    v_mov_b32 v122, v122
    v_mov_b32 v122, v122
    v_cndmask_b32_dpp v76, v72, v76, vcc quad_perm:[2,3,2,3] row_mask:0xf bank_mask:0xf
    v_cndmask_b32_dpp v77, v73, v77, vcc quad_perm:[2,3,2,3] row_mask:0xf bank_mask:0xf
    v_cndmask_b32_dpp v78, v74, v78, vcc quad_perm:[2,3,2,3] row_mask:0xf bank_mask:0xf
    v_cndmask_b32_dpp v79, v75, v79, vcc quad_perm:[2,3,2,3] row_mask:0xf bank_mask:0xf
    v_rcp_f32_dpp v84, v80 quad_perm:[2,3,2,3] row_mask:0xf bank_mask:0xf
    s_nop 0
    v_pk_mul_f32 v[76:77], v[76:77], v[84:85] op_sel_hi:[1,0]
    v_pk_mul_f32 v[78:79], v[78:79], v[84:85] op_sel_hi:[1,0]
    v_cvt_pk_bf16_f32 v72, v76, v77
    v_cvt_pk_bf16_f32 v73, v78, v79
    ds_write_b64 v122, v[72:73] offset:20480
    v_max_f32_dpp v86, v80, v84 quad_perm:[2,3,2,3] row_mask:0xf bank_mask:0xf
    v_mov_b32_dpp v60, v72 quad_perm:[0,1,0,1] row_mask:0xf bank_mask:0xf
    v_mov_b32_dpp v61, v73 quad_perm:[0,1,0,1] row_mask:0xf bank_mask:0xf
    v_cmp_lt_f32 vcc, s35, v86
    v_mov_b32_dpp v62, v72 quad_perm:[2,3,2,3] row_mask:0xf bank_mask:0xf
    v_mov_b32_dpp v63, v73 quad_perm:[2,3,2,3] row_mask:0xf bank_mask:0xf
    s_nop 1
    v_smfmac_f32_16x16x64_bf16 v[96:99], v[60:63], v[192:199], v116
    s_cbranch_vccnz L_smax_62
    v_smfmac_f32_16x16x64_bf16 v[100:103], v[60:63], v[224:231], v116
    s_waitcnt lgkmcnt(0)
    s_barrier
    ds_read_b128 v[92:95], v127 offset:20992
    ds_read_b128 v[80:83], v127 offset:21504
    ds_read_b128 v[84:87], v127 offset:22016
    v_smfmac_f32_16x16x64_bf16 v[104:107], v[60:63], v[0:7], v116
    ds_read_b128 v[40:43], v124 offset:34816
    v_smfmac_f32_16x16x64_bf16 v[108:111], v[60:63], v[8:15], v116
    ds_read_b128 v[56:59], v124 offset:36864
    s_waitcnt lgkmcnt(4)
    v_smfmac_f32_16x16x64_bf16 v[96:99], v[92:95], v[200:207], v116
    s_waitcnt lgkmcnt(3)
    v_smfmac_f32_16x16x64_bf16 v[96:99], v[80:83], v[208:215], v116
    ds_read_b128 v[44:47], v124 offset:35840
    s_waitcnt lgkmcnt(3)
    v_smfmac_f32_16x16x64_bf16 v[96:99], v[84:87], v[216:223], v116
    ds_read_b128 v[68:71], v124 offset:39936
    v_smfmac_f32_16x16x64_bf16 v[100:103], v[92:95], v[232:239], v116
    ds_read_b128 v[64:67], v124 offset:38912
    v_smfmac_f32_16x16x64_bf16 v[100:103], v[80:83], v[240:247], v116
    ds_read_b128 v[60:63], v124 offset:37888
    v_cvt_pk_bf16_f32 v72, v96, v98
    v_smfmac_f32_16x16x64_bf16 v[100:103], v[84:87], v[248:255], v116
    v_and_or_b32 v72, v72, -2, s33
    v_smfmac_f32_16x16x64_bf16 v[104:107], v[92:95], v[16:23], v116
    v_cvt_pk_bf16_f32 v74, v97, v99
    v_smfmac_f32_16x16x64_bf16 v[104:107], v[80:83], v[24:31], v116
    v_cvt_pk_bf16_f32 v73, v100, v102
    v_cvt_pk_bf16_f32 v75, v101, v103
    v_smfmac_f32_16x16x64_bf16 v[104:107], v[84:87], v[32:39], v116
    buffer_store_dwordx4 v[72:75], v118, s[8:11], s25 offen sc1
    s_waitcnt lgkmcnt(3)
    v_smfmac_f32_16x16x64_bf16 v[108:111], v[92:95], v[40:47], v116
    s_waitcnt lgkmcnt(0)
    v_smfmac_f32_16x16x64_bf16 v[108:111], v[80:83], v[56:63], v116
    v_cvt_pk_bf16_f32 v76, v104, v106
    v_smfmac_f32_16x16x64_bf16 v[108:111], v[84:87], v[64:71], v116
    v_and_or_b32 v76, v76, -2, s33
    v_cvt_pk_bf16_f32 v78, v105, v107
    v_mov_b32 v122, v122
    v_mov_b32 v122, v122
    v_mov_b32 v122, v122
    v_mov_b32 v122, v122
    v_mov_b32 v122, v122
    v_mov_b32 v122, v122
    v_cvt_pk_bf16_f32 v77, v108, v110
    v_cvt_pk_bf16_f32 v79, v109, v111
    buffer_store_dwordx4 v[76:79], v118, s[8:11], s26 offen sc1
    s_add_u32 s30, s30, 0x40000
    s_add_u32 s31, s31, 0x40000
    s_add_u32 s32, s32, 0x20000
    s_add_u32 s23, s24, 0
    s_add_u32 s48, s23, 4096
    s_xor_b32 s25, s25, 0x0
    s_xor_b32 s26, s26, 0x0
    s_mov_b32 s35, 0x49800000
    v_mov_b32 v126, s22
    s_add_u32 s22, s22, 1
    v_mov_b32 v32, 0
    v_mov_b32 v33, 0
    v_mov_b32 v34, 0
    v_mov_b32 v35, 0
    v_mov_b32 v36, 0
    v_mov_b32 v37, 0
    v_mov_b32 v38, 0
    v_mov_b32 v39, 0
    v_mov_b32 v40, 0
    v_mov_b32 v41, 0
    v_mov_b32 v42, 0
    v_mov_b32 v43, 0
    v_mov_b32 v44, 0
    v_mov_b32 v45, 0
    v_mov_b32 v46, 0
    v_mov_b32 v47, 0
    v_mov_b32 v48, 0
    v_mov_b32 v49, 0
    v_mov_b32 v50, 0
    v_mov_b32 v51, 0
    v_mov_b32 v52, 0
    v_mov_b32 v53, 0
    v_mov_b32 v54, 0
    v_mov_b32 v55, 0
    ds_read_b128 v[80:83], v123
    ds_read_b128 v[84:87], v123 offset:1024
    ds_read_b128 v[56:59], v123 offset:2048
    ds_read_b128 v[60:63], v123 offset:3072
    ds_read_b128 v[64:67], v123 offset:32768
    ds_read_b128 v[68:71], v123 offset:33792
    ds_read_b128 v[72:75], v123 offset:34816
    ds_read_b128 v[76:79], v123 offset:35840
    ds_read_b128 v[88:91], v123 offset:4096
    ds_read_b128 v[92:95], v123 offset:5120
    ds_read_b128 v[96:99], v123 offset:6144
    ds_read_b128 v[100:103], v123 offset:7168
    ds_read_b128 v[104:107], v123 offset:36864
    ds_read_b128 v[108:111], v123 offset:37888
    ds_read_b128 v[24:27], v123 offset:38912
    ds_read_b128 v[28:31], v123 offset:39936
    s_add_u32 s24, s24, 8192
    s_bitset0_b32 s24, 15
    s_xor_b32 s55, s24, 16384
    s_xor_b32 s29, s29, 0x0
    s_xor_b32 s53, s29, 1024
    s_bfe_u32 s33, s22, 0x10000
    s_add_u32 s40, s22, 5
    s_lshr_b32 s40, s40, 2
    s_min_u32 s40, s40, 16
    s_bfm_b32 s58, s40, 0
    s_waitcnt vmcnt(5)
    v_cmp_eq_u32 vcc, 0, v125
    s_nop 0
    s_and_b64 vcc, vcc, s[58:59]
    s_cbranch_scc1 L_kvw_63
L_kvb_64:
    v_mov_b32 v15, 0
    s_nop 2
    v_mov_b32 v15, 0
    s_nop 2
    v_mov_b32 v15, 0
    s_nop 2
    v_mov_b32 v15, 0
    s_nop 2
    v_mov_b32 v15, 0
    s_nop 2
    v_mov_b32 v15, 0
    s_nop 2
    v_mov_b32 v15, 0
    s_nop 2
    v_mov_b32 v15, 0
    s_nop 2
    v_mov_b32 v15, 0
    s_nop 2
    v_mov_b32 v15, 0
    s_nop 2
    v_mov_b32 v15, 0
    s_nop 2
    v_mov_b32 v15, 0
    s_nop 2
    v_mov_b32 v15, 0
    s_nop 2
    v_mov_b32 v15, 0
    s_nop 2
    v_mov_b32 v15, 0
    s_nop 2
    v_mov_b32 v15, 0
    s_nop 2
    v_mov_b32 v15, 0
    s_nop 2
    v_mov_b32 v15, 0
    s_nop 2
    v_mov_b32 v15, 0
    s_nop 2
    v_mov_b32 v15, 0
    s_nop 2
    v_mov_b32 v15, 0
    s_nop 2
    v_mov_b32 v15, 0
    s_nop 2
    v_mov_b32 v15, 0
    s_nop 2
    v_mov_b32 v15, 0
    s_nop 2
    v_mov_b32 v15, 0
    s_nop 2
    v_mov_b32 v15, 0
    s_nop 2
    v_mov_b32 v15, 0
    s_nop 2
    v_mov_b32 v15, 0
    s_nop 2
    v_mov_b32 v15, 0
    s_nop 2
    v_mov_b32 v15, 0
    s_nop 2
    v_mov_b32 v15, 0
    s_nop 2
    s_waitcnt lgkmcnt(0)
    s_branch L_chain_top0_s
.p2align 6
L_chain_top1_s:
    buffer_load_dwordx4 v[0:3], v117, s[8:11], s23 offen sc1
    v_mov_b32 v15, 0
    v_mov_b32 v15, 0
    v_mov_b32 v15, 0
    v_mov_b32 v15, 0
    v_mov_b32 v15, 0
    v_mov_b32 v15, 0
    v_mov_b32 v15, 0
    v_mov_b32 v15, 0
    v_mov_b32 v15, 0
    v_mov_b32 v15, 0
    v_mov_b32 v15, 0
    v_mov_b32 v15, 0
    v_mov_b32 v15, 0
    v_mov_b32 v15, 0
    v_mov_b32 v15, 0
    v_mov_b32 v15, 0
    buffer_load_dwordx4 v[0:3], v117, s[8:11], s23 offen sc1
    v_mov_b32 v15, 0
    v_mov_b32 v15, 0
    v_mov_b32 v15, 0
    v_mov_b32 v15, 0
    v_mov_b32 v15, 0
    v_mov_b32 v15, 0
    v_mov_b32 v15, 0
    v_mov_b32 v15, 0
    v_mov_b32 v15, 0
    v_mov_b32 v15, 0
    v_mov_b32 v15, 0
    v_mov_b32 v15, 0
    v_mov_b32 v15, 0
    v_mov_b32 v15, 0
    v_mov_b32 v15, 0
    v_mov_b32 v15, 0
L_mret_65:
    buffer_load_dwordx4 v[0:3], v117, s[8:11], s23 offen sc1
    s_add_u32 s45, s45, 1
    s_cmp_lt_u32 s45, 0x10000
    s_cselect_b32 s56, -2, -1
    s_nop 3
    v_mov_b32 v32, 0
    v_mov_b32 v33, 0
    v_mov_b32 v34, 0
    v_mov_b32 v35, 0
    s_waitcnt vmcnt(2)
    v_max3_u32 v15, v0, v1, v2
    v_max_u32 v15, v15, v3
    v_cmp_lt_u32 vcc, s56, v15
    v_smfmac_f32_16x16x64_bf16 v[32:35], v[0:3], v[80:87], v116
    s_cbranch_vccnz L_mret_65
    ds_write_b128 v117, v[0:3] offset:1024
    v_smfmac_f32_16x16x64_bf16 v[36:39], v[0:3], v[56:63], v116
    buffer_load_dwordx4 v[4:7], v117, s[8:11], s48 offen sc1
    v_smfmac_f32_16x16x64_bf16 v[40:43], v[0:3], v[64:71], v116
    buffer_load_dwordx4 v117, s[8:11], s48 offen sc1 lds
    s_mov_b32 m0, 10240
    v_smfmac_f32_16x16x64_bf16 v[44:47], v[0:3], v[72:79], v116
    s_waitcnt lgkmcnt(0)
    s_barrier
    ds_read_b128 v[8:11], v117
    v_smfmac_f32_16x16x64_bf16 v[48:51], v[0:3], a[192:199], v116
    ds_read_b128 v[16:19], v117 offset:3072
    ds_read_b128 v[20:23], v117 offset:2048
    v_smfmac_f32_16x16x64_bf16 v[52:55], v[0:3], a[200:207], v116
    ds_read_b128 v[80:83], v117 offset:14336
    s_waitcnt lgkmcnt(3)
    v_smfmac_f32_16x16x64_bf16 v[32:35], v[8:11], a[0:7], v116
    ds_read_b128 v[84:87], v117 offset:15360
    v_smfmac_f32_16x16x64_bf16 v[36:39], v[8:11], a[8:15], v116
    ds_read_b128 v[56:59], v117 offset:8192
    s_waitcnt lgkmcnt(4)
    v_smfmac_f32_16x16x64_bf16 v[32:35], v[16:19], a[32:39], v116
    ds_read_b128 v[60:63], v117 offset:9216
    v_smfmac_f32_16x16x64_bf16 v[36:39], v[16:19], a[40:47], v116
    buffer_store_dwordx4 v[112:115], v117, s[8:11], s32 offen sc1
    s_waitcnt lgkmcnt(4)
    v_smfmac_f32_16x16x64_bf16 v[32:35], v[20:23], a[64:71], v116
    ds_read_b128 v[64:67], v117 offset:10240
    v_smfmac_f32_16x16x64_bf16 v[36:39], v[20:23], a[72:79], v116
    ds_read_b128 v[68:71], v117 offset:11264
    v_smfmac_f32_16x16x64_bf16 v[40:43], v[8:11], a[96:103], v116
    ds_read_b128 v[72:75], v117 offset:12288
    v_smfmac_f32_16x16x64_bf16 v[40:43], v[16:19], a[128:135], v116
    ds_read_b128 v[76:79], v117 offset:13312
    v_smfmac_f32_16x16x64_bf16 v[40:43], v[20:23], a[160:167], v116
    s_waitcnt vmcnt(2)
    v_max3_u32 v15, v4, v5, v6
    v_smfmac_f32_16x16x64_bf16 v[44:47], v[8:11], a[104:111], v116
    v_max_u32 v15, v15, v7
    v_smfmac_f32_16x16x64_bf16 v[44:47], v[16:19], a[136:143], v116
    s_waitcnt vmcnt(1) lgkmcnt(0)
    v_cmp_lt_u32 vcc, s56, v15
    v_smfmac_f32_16x16x64_bf16 v[44:47], v[20:23], a[168:175], v116
    s_cbranch_vccnz L_mret_66
L_mgo_67:
    v_smfmac_f32_16x16x64_bf16 v[44:47], v[4:7], v[24:31], v116
    s_barrier
    ds_read_b128 v[12:15], v117 offset:4096
    v_smfmac_f32_16x16x64_bf16 v[32:35], v[4:7], v[88:95], v116
    ds_read_b128 v[24:27], v117 offset:7168
    v_smfmac_f32_16x16x64_bf16 v[36:39], v[4:7], v[96:103], v116
    ds_read_b128 v[28:31], v117 offset:6144
    v_smfmac_f32_16x16x64_bf16 v[40:43], v[4:7], v[104:111], v116
    ds_read_b128 v[88:91], v117 offset:26624
    s_waitcnt lgkmcnt(3)
    v_smfmac_f32_16x16x64_bf16 v[32:35], v[12:15], a[16:23], v116
    ds_read_b128 v[92:95], v117 offset:27648
    s_waitcnt lgkmcnt(3)
    v_smfmac_f32_16x16x64_bf16 v[32:35], v[24:27], a[48:55], v116
    buffer_load_dwordx4 v117, s[8:11], s30 offen lds
    s_waitcnt lgkmcnt(2)
    v_smfmac_f32_16x16x64_bf16 v[32:35], v[28:31], a[80:87], v116
    ds_read_b128 v[96:99], v117 offset:23552
    v_smfmac_f32_16x16x64_bf16 v[36:39], v[12:15], a[24:31], v116
    ds_read_b128 v[100:103], v117 offset:23552
    v_smfmac_f32_16x16x64_bf16 v[36:39], v[24:27], a[56:63], v116
    buffer_load_dwordx4 v117, s[8:11], s30 offen offset:1024 lds
    s_add_u32 m0, s52, 0x6000
    v_add_f32 v32, v32, v34
    v_smfmac_f32_16x16x64_bf16 v[36:39], v[28:31], a[88:95], v116
    ds_read_b128 v[104:107], v117 offset:23552
    v_add_f32 v33, v33, v35
    v_smfmac_f32_16x16x64_bf16 v[40:43], v[12:15], a[112:119], v116
    ds_read_b128 v[108:111], v117 offset:23552
    v_mul_f32 v32, s34, v32
    v_smfmac_f32_16x16x64_bf16 v[40:43], v[24:27], a[144:151], v116
    buffer_load_dword v125, v119, s[8:11], s28 offen sc1
    v_mul_f32 v33, s34, v33
    v_smfmac_f32_16x16x64_bf16 v[40:43], v[28:31], a[176:183], v116
    ds_read_b128 v[0:3], v124
    v_add_f32 v36, v36, v38
    v_smfmac_f32_16x16x64_bf16 v[48:51], v[4:7], a[208:215], v116
    v_add_f32 v37, v37, v39
    v_smfmac_f32_16x16x64_bf16 v[52:55], v[4:7], a[216:223], v116
    s_waitcnt lgkmcnt(5)
    buffer_load_dwordx4 v117, s[8:11], s31 offen lds
    v_mul_f32 v36, s34, v36
    v_smfmac_f32_16x16x64_bf16 v[44:47], v[12:15], a[120:127], v116
    ds_read_b128 v[4:7], v124 offset:1024
    v_mul_f32 v37, s34, v37
    v_smfmac_f32_16x16x64_bf16 v[44:47], v[24:27], a[152:159], v116
    v_cvt_pk_bf16_f32 v34, v32, v36
    v_smfmac_f32_16x16x64_bf16 v[44:47], v[28:31], a[184:191], v116
    buffer_load_dwordx4 v117, s[8:11], s31 offen offset:1024 lds
    s_mov_b32 m0, 5120
    v_cvt_pk_bf16_f32 v35, v33, v37
    v_add_f32 v40, v40, v42
    v_smfmac_f32_16x16x64_bf16 v[48:51], v[8:11], a[224:231], v116
    ds_write2_b32 v120, v34, v35 offset0:32 offset1:48
    v_add_f32 v41, v41, v43
    v_smfmac_f32_16x16x64_bf16 v[52:55], v[8:11], a[232:239], v116
    v_add_f32 v44, v44, v46
    v_add_f32 v45, v45, v47
    v_cvt_pk_bf16_f32 v113, v40, v44
    v_cvt_pk_bf16_f32 v115, v41, v45
    v_smfmac_f32_16x16x64_bf16 v[48:51], v[12:15], a[240:247], v116
    ds_write2_b32 v120, v113, v115 offset0:0 offset1:16
    v_smfmac_f32_16x16x64_bf16 v[52:55], v[12:15], a[248:255], v116
    s_cmp_eq_u32 s22, 63
    s_cbranch_scc1 L_chain_last_s
    v_smfmac_f32_16x16x64_bf16 v[48:51], v[16:19], v[128:135], v116
    v_smfmac_f32_16x16x64_bf16 v[48:51], v[20:23], v[160:167], v116
    v_smfmac_f32_16x16x64_bf16 v[48:51], v[24:27], v[144:151], v116
    s_waitcnt lgkmcnt(0)
    s_barrier
    v_smfmac_f32_16x16x64_bf16 v[48:51], v[28:31], v[176:183], v116
    ds_read_b128 v[32:35], v121 offset:16384
    ds_read_b128 v[36:39], v121 offset:17408
    v_smfmac_f32_16x16x64_bf16 v[52:55], v[16:19], v[136:143], v116
    ds_read_b128 v[40:43], v121 offset:18432
    ds_read_b128 v[44:47], v121 offset:19456
    v_smfmac_f32_16x16x64_bf16 v[52:55], v[20:23], v[168:175], v116
    ds_read_b128 v[8:11], v124 offset:32768
    v_add_f32 v48, v48, v50
    v_smfmac_f32_16x16x64_bf16 v[52:55], v[24:27], v[152:159], v116
    ds_read_b128 v[12:15], v124 offset:33792
    v_add_f32 v49, v49, v51
    v_smfmac_f32_16x16x64_bf16 v[52:55], v[28:31], v[184:191], v116
    s_waitcnt lgkmcnt(5)
    v_cvt_pk_bf16_f32 v112, v48, v49
    v_mfma_f32_16x16x32_bf16 v[56:59], v[56:59], v[32:35], 0
    s_waitcnt lgkmcnt(4)
    v_mov_b32 v48, s50
    v_mov_b32 v49, s50
    v_mfma_f32_16x16x32_bf16 v[56:59], v[60:63], v[36:39], v[56:59]
    ds_read_b128 v[16:19], v124 offset:2048
    s_waitcnt lgkmcnt(4)
    v_mov_b32 v50, s50
    v_mov_b32 v51, s50
    v_mfma_f32_16x16x32_bf16 v[56:59], v[64:67], v[40:43], v[56:59]
    ds_read_b128 v[20:23], v124 offset:3072
    s_waitcnt lgkmcnt(4)
    v_add_f32 v52, v52, v54
    v_mfma_f32_16x16x32_bf16 v[56:59], v[68:71], v[44:47], v[56:59]
    ds_read_b128 v[24:27], v124 offset:4096
    v_add_f32 v53, v53, v55
    v_mfma_f32_16x16x32_bf16 v[60:63], v[72:75], v[32:35], 0
    ds_read_b128 v[28:31], v124 offset:5120
    v_cvt_pk_bf16_f32 v114, v52, v53
    v_mov_b32 v53, 0
    v_mfma_f32_16x16x32_bf16 v[60:63], v[76:79], v[36:39], v[60:63]
    v_exp_f32 v56, v56
    v_mfma_f32_16x16x32_bf16 v[60:63], v[80:83], v[40:43], v[60:63]
    v_exp_f32 v57, v57
    v_mfma_f32_16x16x32_bf16 v[60:63], v[84:87], v[44:47], v[60:63]
    v_exp_f32 v58, v58
    v_mfma_f32_16x16x32_bf16 v[64:67], v[32:35], v[32:35], 0
    v_exp_f32 v59, v59
    v_cvt_pk_bf16_f32 v68, v56, v57
    v_mfma_f32_16x16x32_bf16 v[64:67], v[36:39], v[36:39], v[64:67]
    v_exp_f32 v60, v60
    v_cvt_pk_bf16_f32 v69, v58, v59
    v_mfma_f32_16x16x32_bf16 v[64:67], v[40:43], v[40:43], v[64:67]
    v_exp_f32 v61, v61
    v_mfma_f32_16x16x32_bf16 v[64:67], v[44:47], v[44:47], v[64:67]
    v_exp_f32 v62, v62
    v_exp_f32 v63, v63
    v_cvt_pk_bf16_f32 v70, v60, v61
    v_cvt_pk_bf16_f32 v71, v62, v63
    s_nop 1
    v_mfma_f32_16x16x32_bf16 v[72:75], v[88:91], v[68:71], 0
    s_nop 0
    v_exp_f32 v64, v64
    v_mfma_f32_16x16x32_bf16 v[76:79], v[92:95], v[68:71], 0
    v_exp_f32 v65, v65
    v_mfma_f32_16x16x32_bf16 v[80:83], v[48:51], v[68:71], 0
    v_cvt_pk_bf16_f32 v52, v64, v65
    s_nop 1
    v_mfma_f32_16x16x16_bf16 v[72:75], v[112:113], v[52:53], v[72:75]
    ds_read_b128 v[32:35], v124 offset:6144
    v_mfma_f32_16x16x16_bf16 v[76:79], v[114:115], v[52:53], v[76:79]
    ds_read_b128 v[36:39], v124 offset:7168
    v_mfma_f32_16x16x16_bf16 v[80:83], v[48:49], v[52:53], v[80:83]
L_norm_68:
    s_mov_b64 vcc, s[36:37]
    v_mov_b32 v122, v122
    v_mov_b32 v122, v122
    v_mov_b32 v122, v122
    v_cndmask_b32_dpp v76, v72, v76, vcc quad_perm:[2,3,2,3] row_mask:0xf bank_mask:0xf
    v_cndmask_b32_dpp v77, v73, v77, vcc quad_perm:[2,3,2,3] row_mask:0xf bank_mask:0xf
    v_cndmask_b32_dpp v78, v74, v78, vcc quad_perm:[2,3,2,3] row_mask:0xf bank_mask:0xf
    v_cndmask_b32_dpp v79, v75, v79, vcc quad_perm:[2,3,2,3] row_mask:0xf bank_mask:0xf
    v_rcp_f32_dpp v84, v80 quad_perm:[2,3,2,3] row_mask:0xf bank_mask:0xf
    s_nop 0
    v_pk_mul_f32 v[76:77], v[76:77], v[84:85] op_sel_hi:[1,0]
    v_pk_mul_f32 v[78:79], v[78:79], v[84:85] op_sel_hi:[1,0]
    v_cvt_pk_bf16_f32 v72, v76, v77
    v_cvt_pk_bf16_f32 v73, v78, v79
    ds_write_b64 v122, v[72:73] offset:20992
    v_max_f32_dpp v86, v80, v84 quad_perm:[2,3,2,3] row_mask:0xf bank_mask:0xf
    v_mov_b32_dpp v60, v72 quad_perm:[0,1,0,1] row_mask:0xf bank_mask:0xf
    v_mov_b32_dpp v61, v73 quad_perm:[0,1,0,1] row_mask:0xf bank_mask:0xf
    v_cmp_lt_f32 vcc, s35, v86
    v_mov_b32_dpp v62, v72 quad_perm:[2,3,2,3] row_mask:0xf bank_mask:0xf
    v_mov_b32_dpp v63, v73 quad_perm:[2,3,2,3] row_mask:0xf bank_mask:0xf
    s_nop 1
    v_smfmac_f32_16x16x64_bf16 v[96:99], v[60:63], v[192:199], v116
    s_cbranch_vccnz L_smax_69
    v_smfmac_f32_16x16x64_bf16 v[100:103], v[60:63], v[224:231], v116
    s_waitcnt lgkmcnt(0)
    s_barrier
    ds_read_b128 v[92:95], v127 offset:20480
    ds_read_b128 v[80:83], v127 offset:22016
    ds_read_b128 v[84:87], v127 offset:21504
    v_smfmac_f32_16x16x64_bf16 v[104:107], v[60:63], v[0:7], v116
    ds_read_b128 v[40:43], v124 offset:34816
    v_smfmac_f32_16x16x64_bf16 v[108:111], v[60:63], v[8:15], v116
    ds_read_b128 v[56:59], v124 offset:36864
    s_waitcnt lgkmcnt(4)
    v_smfmac_f32_16x16x64_bf16 v[96:99], v[92:95], v[200:207], v116
    s_waitcnt lgkmcnt(3)
    v_smfmac_f32_16x16x64_bf16 v[96:99], v[80:83], v[208:215], v116
    ds_read_b128 v[44:47], v124 offset:35840
    s_waitcnt lgkmcnt(3)
    v_smfmac_f32_16x16x64_bf16 v[96:99], v[84:87], v[216:223], v116
    ds_read_b128 v[68:71], v124 offset:39936
    v_smfmac_f32_16x16x64_bf16 v[100:103], v[92:95], v[232:239], v116
    ds_read_b128 v[64:67], v124 offset:38912
    v_smfmac_f32_16x16x64_bf16 v[100:103], v[80:83], v[240:247], v116
    ds_read_b128 v[60:63], v124 offset:37888
    v_cvt_pk_bf16_f32 v72, v96, v98
    v_smfmac_f32_16x16x64_bf16 v[100:103], v[84:87], v[248:255], v116
    v_and_or_b32 v72, v72, -2, s33
    v_smfmac_f32_16x16x64_bf16 v[104:107], v[92:95], v[16:23], v116
    v_cvt_pk_bf16_f32 v74, v97, v99
    v_smfmac_f32_16x16x64_bf16 v[104:107], v[80:83], v[24:31], v116
    v_cvt_pk_bf16_f32 v73, v100, v102
    v_cvt_pk_bf16_f32 v75, v101, v103
    v_smfmac_f32_16x16x64_bf16 v[104:107], v[84:87], v[32:39], v116
    buffer_store_dwordx4 v[72:75], v118, s[8:11], s25 offen sc1
    s_waitcnt lgkmcnt(3)
    v_smfmac_f32_16x16x64_bf16 v[108:111], v[92:95], v[40:47], v116
    s_waitcnt lgkmcnt(0)
    v_smfmac_f32_16x16x64_bf16 v[108:111], v[80:83], v[56:63], v116
    v_cvt_pk_bf16_f32 v76, v104, v106
    v_smfmac_f32_16x16x64_bf16 v[108:111], v[84:87], v[64:71], v116
    v_and_or_b32 v76, v76, -2, s33
    v_cvt_pk_bf16_f32 v78, v105, v107
    v_mov_b32 v122, v122
    v_mov_b32 v122, v122
    v_mov_b32 v122, v122
    v_mov_b32 v122, v122
    v_mov_b32 v122, v122
    v_mov_b32 v122, v122
    v_cvt_pk_bf16_f32 v77, v108, v110
    v_cvt_pk_bf16_f32 v79, v109, v111
    buffer_store_dwordx4 v[76:79], v118, s[8:11], s26 offen sc1
    s_add_u32 s30, s30, 0x40000
    s_add_u32 s31, s31, 0x40000
    s_add_u32 s32, s32, 0x20000
    s_add_u32 s23, s24, 1024
    s_add_u32 s48, s23, 4096
    s_xor_b32 s25, s25, 0x0
    s_xor_b32 s26, s26, 0x0
    s_mov_b32 s35, 0x49800000
    s_add_u32 s22, s22, 1
    v_mov_b32 v32, 0
    v_mov_b32 v33, 0
    v_mov_b32 v34, 0
    v_mov_b32 v35, 0
    v_mov_b32 v36, 0
    v_mov_b32 v37, 0
    v_mov_b32 v38, 0
    v_mov_b32 v39, 0
    v_mov_b32 v40, 0
    v_mov_b32 v41, 0
    v_mov_b32 v42, 0
    v_mov_b32 v43, 0
    v_mov_b32 v44, 0
    v_mov_b32 v45, 0
    v_mov_b32 v46, 0
    v_mov_b32 v47, 0
    v_mov_b32 v48, 0
    v_mov_b32 v49, 0
    v_mov_b32 v50, 0
    v_mov_b32 v51, 0
    v_mov_b32 v52, 0
    v_mov_b32 v53, 0
    v_mov_b32 v54, 0
    v_mov_b32 v55, 0
    ds_read_b128 v[80:83], v123
    ds_read_b128 v[84:87], v123 offset:1024
    ds_read_b128 v[56:59], v123 offset:2048
    ds_read_b128 v[60:63], v123 offset:3072
    ds_read_b128 v[64:67], v123 offset:32768
    ds_read_b128 v[68:71], v123 offset:33792
    ds_read_b128 v[72:75], v123 offset:34816
    ds_read_b128 v[76:79], v123 offset:35840
    ds_read_b128 v[88:91], v123 offset:4096
    ds_read_b128 v[92:95], v123 offset:5120
    ds_read_b128 v[96:99], v123 offset:6144
    ds_read_b128 v[100:103], v123 offset:7168
    ds_read_b128 v[104:107], v123 offset:36864
    ds_read_b128 v[108:111], v123 offset:37888
    ds_read_b128 v[24:27], v123 offset:38912
    ds_read_b128 v[28:31], v123 offset:39936
    s_add_u32 s24, s24, 8192
    s_bitset0_b32 s24, 15
    s_xor_b32 s55, s24, 16384
    s_xor_b32 s29, s29, 0x0
    s_xor_b32 s53, s29, 1024
    s_bfe_u32 s33, s22, 0x10000
    s_add_u32 s40, s22, 5
    s_lshr_b32 s40, s40, 2
    s_min_u32 s40, s40, 16
    s_bfm_b32 s58, s40, 0
    s_waitcnt vmcnt(4)
    v_cmp_eq_u32 vcc, 0, v125
    s_nop 0
    s_and_b64 vcc, vcc, s[58:59]
    s_cbranch_scc1 L_kvw_70
L_kvb_71:
    v_mov_b32 v15, 0
    s_nop 2
    v_mov_b32 v15, 0
    s_nop 2
    v_mov_b32 v15, 0
    s_nop 2
    v_mov_b32 v15, 0
    s_nop 2
    v_mov_b32 v15, 0
    s_nop 2
    v_mov_b32 v15, 0
    s_nop 2
    v_mov_b32 v15, 0
    s_nop 2
    v_mov_b32 v15, 0
    s_nop 2
    v_mov_b32 v15, 0
    s_nop 2
    v_mov_b32 v15, 0
    s_nop 2
    v_mov_b32 v15, 0
    s_nop 2
    v_mov_b32 v15, 0
    s_nop 2
    v_mov_b32 v15, 0
    s_nop 2
    v_mov_b32 v15, 0
    s_nop 2
    v_mov_b32 v15, 0
    s_nop 2
    v_mov_b32 v15, 0
    s_nop 2
    v_mov_b32 v15, 0
    s_nop 2
    v_mov_b32 v15, 0
    s_nop 2
    v_mov_b32 v15, 0
    s_nop 2
    v_mov_b32 v15, 0
    s_nop 2
    v_mov_b32 v15, 0
    s_nop 2
    v_mov_b32 v15, 0
    s_nop 2
    v_mov_b32 v15, 0
    s_nop 2
    v_mov_b32 v15, 0
    s_nop 2
    v_mov_b32 v15, 0
    s_nop 2
    v_mov_b32 v15, 0
    s_nop 2
    v_mov_b32 v15, 0
    s_nop 2
    v_mov_b32 v15, 0
    s_nop 2
    v_mov_b32 v15, 0
    s_nop 2
    v_mov_b32 v15, 0
    s_nop 2
    v_mov_b32 v15, 0
    s_nop 2
    s_waitcnt lgkmcnt(0)
    s_branch L_chain_top1_s
.p2align 6
L_chain_top2_s:
    buffer_load_dwordx4 v[0:3], v117, s[8:11], s23 offen sc1
    v_mov_b32 v48, 0
    v_mov_b32 v49, 0
    v_mov_b32 v50, 0
    v_mov_b32 v51, 0
    v_mov_b32 v52, 0
    v_mov_b32 v53, 0
    v_mov_b32 v15, 0
    v_mov_b32 v15, 0
    v_mov_b32 v15, 0
    v_mov_b32 v15, 0
    v_mov_b32 v15, 0
    v_mov_b32 v15, 0
    v_mov_b32 v15, 0
    v_mov_b32 v15, 0
    v_mov_b32 v15, 0
    v_mov_b32 v15, 0
    buffer_load_dwordx4 v[0:3], v117, s[8:11], s23 offen sc1
    s_waitcnt vmcnt(3)
    v_mov_b32 v36, 0
    v_mov_b32 v37, 0
    v_mov_b32 v38, 0
    v_mov_b32 v39, 0
    v_mov_b32 v40, 0
    v_mov_b32 v41, 0
    v_mov_b32 v42, 0
    v_mov_b32 v43, 0
    v_mov_b32 v44, 0
    v_mov_b32 v45, 0
    v_mov_b32 v46, 0
    v_mov_b32 v47, 0
    v_mov_b32 v15, 0
    v_mov_b32 v15, 0
    v_mov_b32 v15, 0
    v_mov_b32 v15, 0
L_mret_72:
    buffer_load_dwordx4 v[0:3], v117, s[8:11], s23 offen sc1
    s_add_u32 s45, s45, 1
    s_cmp_lt_u32 s45, 0x10000
    s_cselect_b32 s56, -2, -1
    s_nop 3
    v_mov_b32 v32, 0
    v_mov_b32 v33, 0
    v_mov_b32 v34, 0
    v_mov_b32 v35, 0
    s_waitcnt vmcnt(2)
    v_max3_u32 v15, v0, v1, v2
    v_max_u32 v15, v15, v3
    v_cmp_lt_u32 vcc, s56, v15
    v_smfmac_f32_16x16x64_bf16 v[32:35], v[0:3], v[80:87], v116
    s_cbranch_vccnz L_mret_72
    ds_write_b128 v117, v[0:3] offset:2048
    v_smfmac_f32_16x16x64_bf16 v[36:39], v[0:3], v[56:63], v116
    buffer_load_dwordx4 v[4:7], v117, s[8:11], s48 offen sc1
    v_smfmac_f32_16x16x64_bf16 v[40:43], v[0:3], v[64:71], v116
    buffer_load_dwordx4 v117, s[8:11], s48 offen sc1 lds
    s_mov_b32 m0, 12288
    v_smfmac_f32_16x16x64_bf16 v[44:47], v[0:3], v[72:79], v116
    s_waitcnt lgkmcnt(0)
    s_barrier
    ds_read_b128 v[8:11], v117 offset:3072
    v_smfmac_f32_16x16x64_bf16 v[48:51], v[0:3], a[192:199], v116
    ds_read_b128 v[16:19], v117
    ds_read_b128 v[20:23], v117 offset:1024
    v_smfmac_f32_16x16x64_bf16 v[52:55], v[0:3], a[200:207], v116
    ds_read_b128 v[80:83], v117 offset:14336
    s_waitcnt lgkmcnt(3)
    v_smfmac_f32_16x16x64_bf16 v[32:35], v[8:11], a[0:7], v116
    ds_read_b128 v[84:87], v117 offset:15360
    v_smfmac_f32_16x16x64_bf16 v[36:39], v[8:11], a[8:15], v116
    ds_read_b128 v[56:59], v117 offset:8192
    s_waitcnt lgkmcnt(4)
    v_smfmac_f32_16x16x64_bf16 v[32:35], v[16:19], a[32:39], v116
    ds_read_b128 v[60:63], v117 offset:9216
    v_smfmac_f32_16x16x64_bf16 v[36:39], v[16:19], a[40:47], v116
    ds_read_b128 v[64:67], v117 offset:10240
    s_waitcnt lgkmcnt(5)
    v_smfmac_f32_16x16x64_bf16 v[32:35], v[20:23], a[64:71], v116
    ds_read_b128 v[68:71], v117 offset:11264
    v_smfmac_f32_16x16x64_bf16 v[36:39], v[20:23], a[72:79], v116
    buffer_store_dwordx4 v[112:115], v117, s[8:11], s32 offen sc1
    v_smfmac_f32_16x16x64_bf16 v[40:43], v[8:11], a[96:103], v116
    ds_read_b128 v[72:75], v117 offset:12288
    v_smfmac_f32_16x16x64_bf16 v[40:43], v[16:19], a[128:135], v116
    ds_read_b128 v[76:79], v117 offset:13312
    v_smfmac_f32_16x16x64_bf16 v[40:43], v[20:23], a[160:167], v116
    s_waitcnt vmcnt(2)
    v_max3_u32 v15, v4, v5, v6
    v_smfmac_f32_16x16x64_bf16 v[44:47], v[8:11], a[104:111], v116
    v_max_u32 v15, v15, v7
    v_smfmac_f32_16x16x64_bf16 v[44:47], v[16:19], a[136:143], v116
    s_waitcnt vmcnt(1) lgkmcnt(0)
    v_cmp_lt_u32 vcc, s56, v15
    v_smfmac_f32_16x16x64_bf16 v[44:47], v[20:23], a[168:175], v116
    s_cbranch_vccnz L_mret_73
L_mgo_74:
    v_smfmac_f32_16x16x64_bf16 v[44:47], v[4:7], v[24:31], v116
    s_barrier
    ds_read_b128 v[12:15], v117 offset:7168
    v_smfmac_f32_16x16x64_bf16 v[32:35], v[4:7], v[88:95], v116
    ds_read_b128 v[24:27], v117 offset:4096
    v_smfmac_f32_16x16x64_bf16 v[36:39], v[4:7], v[96:103], v116
    ds_read_b128 v[28:31], v117 offset:5120
    v_smfmac_f32_16x16x64_bf16 v[40:43], v[4:7], v[104:111], v116
    ds_read_b128 v[88:91], v117 offset:28672
    s_waitcnt lgkmcnt(3)
    v_smfmac_f32_16x16x64_bf16 v[32:35], v[12:15], a[16:23], v116
    ds_read_b128 v[92:95], v117 offset:29696
    s_waitcnt lgkmcnt(3)
    v_smfmac_f32_16x16x64_bf16 v[32:35], v[24:27], a[48:55], v116
    buffer_load_dwordx4 v117, s[8:11], s30 offen lds
    s_waitcnt lgkmcnt(2)
    v_smfmac_f32_16x16x64_bf16 v[32:35], v[28:31], a[80:87], v116
    ds_read_b128 v[96:99], v117 offset:23552
    v_smfmac_f32_16x16x64_bf16 v[36:39], v[12:15], a[24:31], v116
    ds_read_b128 v[100:103], v117 offset:23552
    v_smfmac_f32_16x16x64_bf16 v[36:39], v[24:27], a[56:63], v116
    buffer_load_dwordx4 v117, s[8:11], s30 offen offset:1024 lds
    s_add_u32 m0, s52, 0x6000
    v_add_f32 v32, v32, v34
    v_smfmac_f32_16x16x64_bf16 v[36:39], v[28:31], a[88:95], v116
    ds_read_b128 v[104:107], v117 offset:23552
    v_add_f32 v33, v33, v35
    v_smfmac_f32_16x16x64_bf16 v[40:43], v[12:15], a[112:119], v116
    ds_read_b128 v[108:111], v117 offset:23552
    v_mul_f32 v32, s34, v32
    v_smfmac_f32_16x16x64_bf16 v[40:43], v[24:27], a[144:151], v116
    s_waitcnt lgkmcnt(4)
    buffer_load_dwordx4 v117, s[8:11], s31 offen lds
    v_mul_f32 v33, s34, v33
    v_smfmac_f32_16x16x64_bf16 v[40:43], v[28:31], a[176:183], v116
    ds_read_b128 v[0:3], v124
    v_add_f32 v36, v36, v38
    v_smfmac_f32_16x16x64_bf16 v[48:51], v[4:7], a[208:215], v116
    v_add_f32 v37, v37, v39
    v_smfmac_f32_16x16x64_bf16 v[52:55], v[4:7], a[216:223], v116
    buffer_load_dwordx4 v117, s[8:11], s31 offen offset:1024 lds
    s_mov_b32 m0, 6144
    v_mul_f32 v36, s34, v36
    v_smfmac_f32_16x16x64_bf16 v[44:47], v[12:15], a[120:127], v116
    ds_read_b128 v[4:7], v124 offset:1024
    v_mul_f32 v37, s34, v37
    v_smfmac_f32_16x16x64_bf16 v[44:47], v[24:27], a[152:159], v116
    v_cvt_pk_bf16_f32 v34, v32, v36
    v_smfmac_f32_16x16x64_bf16 v[44:47], v[28:31], a[184:191], v116
    v_cvt_pk_bf16_f32 v35, v33, v37
    v_add_f32 v40, v40, v42
    v_smfmac_f32_16x16x64_bf16 v[48:51], v[8:11], a[224:231], v116
    ds_write2_b32 v120, v34, v35 offset0:32 offset1:48
    v_add_f32 v41, v41, v43
    v_smfmac_f32_16x16x64_bf16 v[52:55], v[8:11], a[232:239], v116
    v_add_f32 v44, v44, v46
    v_add_f32 v45, v45, v47
    v_cvt_pk_bf16_f32 v113, v40, v44
    v_cvt_pk_bf16_f32 v115, v41, v45
    v_smfmac_f32_16x16x64_bf16 v[48:51], v[12:15], a[240:247], v116
    ds_write2_b32 v120, v113, v115 offset0:0 offset1:16
    v_smfmac_f32_16x16x64_bf16 v[52:55], v[12:15], a[248:255], v116
    s_cmp_eq_u32 s22, 63
    s_cbranch_scc1 L_chain_last_s
    v_smfmac_f32_16x16x64_bf16 v[48:51], v[16:19], v[128:135], v116
    buffer_store_dword v126, v119, s[8:11], s55 offen sc1
    v_smfmac_f32_16x16x64_bf16 v[48:51], v[20:23], v[160:167], v116
    v_smfmac_f32_16x16x64_bf16 v[48:51], v[24:27], v[144:151], v116
    s_waitcnt lgkmcnt(0)
    s_barrier
    v_smfmac_f32_16x16x64_bf16 v[48:51], v[28:31], v[176:183], v116
    ds_read_b128 v[32:35], v121 offset:16384
    ds_read_b128 v[36:39], v121 offset:17408
    v_smfmac_f32_16x16x64_bf16 v[52:55], v[16:19], v[136:143], v116
    ds_read_b128 v[40:43], v121 offset:18432
    ds_read_b128 v[44:47], v121 offset:19456
    v_smfmac_f32_16x16x64_bf16 v[52:55], v[20:23], v[168:175], v116
    ds_read_b128 v[8:11], v124 offset:32768
    v_add_f32 v48, v48, v50
    v_smfmac_f32_16x16x64_bf16 v[52:55], v[24:27], v[152:159], v116
    ds_read_b128 v[12:15], v124 offset:33792
    v_add_f32 v49, v49, v51
    v_smfmac_f32_16x16x64_bf16 v[52:55], v[28:31], v[184:191], v116
    s_waitcnt lgkmcnt(5)
    v_cvt_pk_bf16_f32 v112, v48, v49
    v_mfma_f32_16x16x32_bf16 v[56:59], v[56:59], v[32:35], 0
    s_waitcnt lgkmcnt(4)
    v_mov_b32 v48, s50
    v_mov_b32 v49, s50
    v_mfma_f32_16x16x32_bf16 v[56:59], v[60:63], v[36:39], v[56:59]
    ds_read_b128 v[16:19], v124 offset:2048
    s_waitcnt lgkmcnt(4)
    v_mov_b32 v50, s50
    v_mov_b32 v51, s50
    v_mfma_f32_16x16x32_bf16 v[56:59], v[64:67], v[40:43], v[56:59]
    ds_read_b128 v[20:23], v124 offset:3072
    s_waitcnt lgkmcnt(4)
    v_add_f32 v52, v52, v54
    v_mfma_f32_16x16x32_bf16 v[56:59], v[68:71], v[44:47], v[56:59]
    ds_read_b128 v[24:27], v124 offset:4096
    v_add_f32 v53, v53, v55
    v_mfma_f32_16x16x32_bf16 v[60:63], v[72:75], v[32:35], 0
    ds_read_b128 v[28:31], v124 offset:5120
    v_cvt_pk_bf16_f32 v114, v52, v53
    v_mov_b32 v53, 0
    v_mfma_f32_16x16x32_bf16 v[60:63], v[76:79], v[36:39], v[60:63]
    v_exp_f32 v56, v56
    v_mfma_f32_16x16x32_bf16 v[60:63], v[80:83], v[40:43], v[60:63]
    v_exp_f32 v57, v57
    v_mfma_f32_16x16x32_bf16 v[60:63], v[84:87], v[44:47], v[60:63]
    v_exp_f32 v58, v58
    v_mfma_f32_16x16x32_bf16 v[64:67], v[32:35], v[32:35], 0
    v_exp_f32 v59, v59
    v_cvt_pk_bf16_f32 v68, v56, v57
    v_mfma_f32_16x16x32_bf16 v[64:67], v[36:39], v[36:39], v[64:67]
    v_exp_f32 v60, v60
    v_cvt_pk_bf16_f32 v69, v58, v59
    v_mfma_f32_16x16x32_bf16 v[64:67], v[40:43], v[40:43], v[64:67]
    v_exp_f32 v61, v61
    v_mfma_f32_16x16x32_bf16 v[64:67], v[44:47], v[44:47], v[64:67]
    v_exp_f32 v62, v62
    v_exp_f32 v63, v63
    v_cvt_pk_bf16_f32 v70, v60, v61
    v_cvt_pk_bf16_f32 v71, v62, v63
    s_nop 1
    v_mfma_f32_16x16x32_bf16 v[72:75], v[88:91], v[68:71], 0
    s_nop 0
    v_exp_f32 v64, v64
    v_mfma_f32_16x16x32_bf16 v[76:79], v[92:95], v[68:71], 0
    v_exp_f32 v65, v65
    v_mfma_f32_16x16x32_bf16 v[80:83], v[48:51], v[68:71], 0
    v_cvt_pk_bf16_f32 v52, v64, v65
    s_nop 1
    v_mfma_f32_16x16x16_bf16 v[72:75], v[112:113], v[52:53], v[72:75]
    ds_read_b128 v[32:35], v124 offset:6144
    v_mfma_f32_16x16x16_bf16 v[76:79], v[114:115], v[52:53], v[76:79]
    ds_read_b128 v[36:39], v124 offset:7168
    v_mfma_f32_16x16x16_bf16 v[80:83], v[48:49], v[52:53], v[80:83]
L_norm_75:
    s_mov_b64 vcc, s[36:37]
    v_mov_b32 v122, v122
    v_mov_b32 v122, v122
    v_mov_b32 v122, v122
    v_cndmask_b32_dpp v76, v72, v76, vcc quad_perm:[2,3,2,3] row_mask:0xf bank_mask:0xf
    v_cndmask_b32_dpp v77, v73, v77, vcc quad_perm:[2,3,2,3] row_mask:0xf bank_mask:0xf
    v_cndmask_b32_dpp v78, v74, v78, vcc quad_perm:[2,3,2,3] row_mask:0xf bank_mask:0xf
    v_cndmask_b32_dpp v79, v75, v79, vcc quad_perm:[2,3,2,3] row_mask:0xf bank_mask:0xf
    v_rcp_f32_dpp v84, v80 quad_perm:[2,3,2,3] row_mask:0xf bank_mask:0xf
    s_nop 0
    v_pk_mul_f32 v[76:77], v[76:77], v[84:85] op_sel_hi:[1,0]
    v_pk_mul_f32 v[78:79], v[78:79], v[84:85] op_sel_hi:[1,0]
    v_cvt_pk_bf16_f32 v72, v76, v77
    v_cvt_pk_bf16_f32 v73, v78, v79
    ds_write_b64 v122, v[72:73] offset:21504
    v_max_f32_dpp v86, v80, v84 quad_perm:[2,3,2,3] row_mask:0xf bank_mask:0xf
    v_mov_b32_dpp v60, v72 quad_perm:[0,1,0,1] row_mask:0xf bank_mask:0xf
    v_mov_b32_dpp v61, v73 quad_perm:[0,1,0,1] row_mask:0xf bank_mask:0xf
    v_cmp_lt_f32 vcc, s35, v86
    v_mov_b32_dpp v62, v72 quad_perm:[2,3,2,3] row_mask:0xf bank_mask:0xf
    v_mov_b32_dpp v63, v73 quad_perm:[2,3,2,3] row_mask:0xf bank_mask:0xf
    s_nop 1
    v_smfmac_f32_16x16x64_bf16 v[96:99], v[60:63], v[192:199], v116
    s_cbranch_vccnz L_smax_76
    v_smfmac_f32_16x16x64_bf16 v[100:103], v[60:63], v[224:231], v116
    s_waitcnt lgkmcnt(0)
    s_barrier
    ds_read_b128 v[92:95], v127 offset:22016
    ds_read_b128 v[80:83], v127 offset:20480
    ds_read_b128 v[84:87], v127 offset:20992
    v_smfmac_f32_16x16x64_bf16 v[104:107], v[60:63], v[0:7], v116
    ds_read_b128 v[40:43], v124 offset:34816
    v_smfmac_f32_16x16x64_bf16 v[108:111], v[60:63], v[8:15], v116
    ds_read_b128 v[56:59], v124 offset:36864
    s_waitcnt lgkmcnt(4)
    v_smfmac_f32_16x16x64_bf16 v[96:99], v[92:95], v[200:207], v116
    s_waitcnt lgkmcnt(3)
    v_smfmac_f32_16x16x64_bf16 v[96:99], v[80:83], v[208:215], v116
    ds_read_b128 v[44:47], v124 offset:35840
    s_waitcnt lgkmcnt(3)
    v_smfmac_f32_16x16x64_bf16 v[96:99], v[84:87], v[216:223], v116
    ds_read_b128 v[68:71], v124 offset:39936
    v_smfmac_f32_16x16x64_bf16 v[100:103], v[92:95], v[232:239], v116
    ds_read_b128 v[64:67], v124 offset:38912
    v_smfmac_f32_16x16x64_bf16 v[100:103], v[80:83], v[240:247], v116
    ds_read_b128 v[60:63], v124 offset:37888
    v_cvt_pk_bf16_f32 v72, v96, v98
    v_smfmac_f32_16x16x64_bf16 v[100:103], v[84:87], v[248:255], v116
    v_and_or_b32 v72, v72, -2, s33
    v_smfmac_f32_16x16x64_bf16 v[104:107], v[92:95], v[16:23], v116
    v_cvt_pk_bf16_f32 v74, v97, v99
    v_smfmac_f32_16x16x64_bf16 v[104:107], v[80:83], v[24:31], v116
    v_cvt_pk_bf16_f32 v73, v100, v102
    v_cvt_pk_bf16_f32 v75, v101, v103
    v_smfmac_f32_16x16x64_bf16 v[104:107], v[84:87], v[32:39], v116
    buffer_store_dwordx4 v[72:75], v118, s[8:11], s25 offen sc1
    s_waitcnt lgkmcnt(3)
    v_smfmac_f32_16x16x64_bf16 v[108:111], v[92:95], v[40:47], v116
    s_waitcnt lgkmcnt(0)
    v_smfmac_f32_16x16x64_bf16 v[108:111], v[80:83], v[56:63], v116
    v_cvt_pk_bf16_f32 v76, v104, v106
    v_smfmac_f32_16x16x64_bf16 v[108:111], v[84:87], v[64:71], v116
    v_and_or_b32 v76, v76, -2, s33
    v_cvt_pk_bf16_f32 v78, v105, v107
    v_mov_b32 v122, v122
    v_mov_b32 v122, v122
    v_mov_b32 v122, v122
    v_mov_b32 v122, v122
    v_mov_b32 v122, v122
    v_mov_b32 v122, v122
    v_cvt_pk_bf16_f32 v77, v108, v110
    v_cvt_pk_bf16_f32 v79, v109, v111
    buffer_store_dwordx4 v[76:79], v118, s[8:11], s26 offen sc1
    ds_read_b128 v[80:83], v123
    ds_read_b128 v[84:87], v123 offset:1024
    ds_read_b128 v[56:59], v123 offset:2048
    ds_read_b128 v[60:63], v123 offset:3072
    ds_read_b128 v[64:67], v123 offset:32768
    ds_read_b128 v[68:71], v123 offset:33792
    ds_read_b128 v[72:75], v123 offset:34816
    ds_read_b128 v[76:79], v123 offset:35840
    ds_read_b128 v[88:91], v123 offset:4096
    ds_read_b128 v[92:95], v123 offset:5120
    ds_read_b128 v[96:99], v123 offset:6144
    ds_read_b128 v[100:103], v123 offset:7168
    ds_read_b128 v[104:107], v123 offset:36864
    ds_read_b128 v[108:111], v123 offset:37888
    ds_read_b128 v[24:27], v123 offset:38912
    ds_read_b128 v[28:31], v123 offset:39936
    s_add_u32 s30, s30, 0x40000
    s_add_u32 s31, s31, 0x40000
    s_add_u32 s32, s32, 0x20000
    s_add_u32 s23, s24, 2048
    s_add_u32 s48, s23, 4096
    s_xor_b32 s25, s25, 0x0
    s_xor_b32 s26, s26, 0x0
    s_mov_b32 s35, 0x49800000
    s_add_u32 s22, s22, 1
    v_cndmask_b32 v12, 0, v125, s[68:69]
    v_cndmask_b32 v13, 0, v125, s[70:71]
    v_cndmask_b32 v14, 0, v125, s[72:73]
    v_cndmask_b32 v15, 0, v125, s[74:75]
    v_mov_b32 v54, 0
    v_mov_b32 v55, 0
    v_mov_b32 v52, 0
    v_mov_b32 v52, 0
    v_mov_b32 v52, 0
    v_mov_b32 v52, 0
    v_mov_b32 v52, 0
    v_mov_b32 v52, 0
    v_mov_b32 v52, 0
    v_mov_b32 v52, 0
    v_mov_b32 v52, 0
    v_mov_b32 v52, 0
    v_mov_b32 v52, 0
    v_mov_b32 v52, 0
    v_mov_b32 v52, 0
    v_mov_b32 v52, 0
    v_mov_b32 v52, 0
    v_mov_b32 v52, 0
    v_mov_b32 v52, 0
    v_mov_b32 v52, 0
    v_mov_b32 v52, 0
    buffer_load_dwordx4 v[4:7], v117, s[8:11], s29 offen sc1
    buffer_load_dwordx4 v[8:11], v117, s[8:11], s53 offen sc1
    buffer_load_dwordx4 v[16:19], v117, s[8:11], s29 offen offset:2048 sc1
    buffer_load_dwordx4 v[20:23], v117, s[8:11], s53 offen offset:2048 sc1
    v_mov_b32 v52, 0
    v_mov_b32 v52, 0
    v_mov_b32 v52, 0
    v_mov_b32 v52, 0
    v_mov_b32 v52, 0
    v_mov_b32 v52, 0
    v_mov_b32 v52, 0
    v_mov_b32 v52, 0
    v_mov_b32 v52, 0
    v_mov_b32 v52, 0
    v_mov_b32 v52, 0
    v_mov_b32 v52, 0
    v_mov_b32 v52, 0
    v_mov_b32 v52, 0
    v_mov_b32 v52, 0
    v_mov_b32 v52, 0
    v_mov_b32 v52, 0
    v_mov_b32 v52, 0
    v_mov_b32 v52, 0
    v_mov_b32 v52, 0
    v_mov_b32 v52, 0
    v_mov_b32 v52, 0
    v_mov_b32 v52, 0
    v_mov_b32 v52, 0
    v_mov_b32 v52, 0
    v_mov_b32 v52, 0
    v_mov_b32 v52, 0
    v_mov_b32 v52, 0
    v_mov_b32 v52, 0
    v_mov_b32 v52, 0
    v_mov_b32 v52, 0
    v_mov_b32 v52, 0
    v_mov_b32 v52, 0
    v_mov_b32 v52, 0
    v_mov_b32 v52, 0
    v_mov_b32 v52, 0
    v_mov_b32 v52, 0
    v_mov_b32 v52, 0
    v_mov_b32 v52, 0
    v_mov_b32 v52, 0
    buffer_load_dwordx4 v[32:35], v117, s[8:11], s29 offen sc1
    buffer_load_dwordx4 v[36:39], v117, s[8:11], s53 offen sc1
    buffer_load_dwordx4 v[40:43], v117, s[8:11], s29 offen offset:2048 sc1
    buffer_load_dwordx4 v[44:47], v117, s[8:11], s53 offen offset:2048 sc1
    v_mov_b32 v52, 0
L_rl_77:
    s_waitcnt vmcnt(7)
    v_mfma_f32_16x16x32_bf16 v[48:51], v[4:7], v[12:15], 0
    v_xor_b32 v52, s33, v4
    s_waitcnt vmcnt(6)
    v_mfma_f32_16x16x32_bf16 v[48:51], v[8:11], v[12:15], v[48:51]
    v_xor_b32 v53, s33, v8
    v_or_b32 v52, v52, v53
    s_waitcnt vmcnt(5)
    v_mfma_f32_16x16x32_bf16 v[48:51], v[16:19], v[12:15], v[48:51]
    v_xor_b32 v53, s33, v16
    v_or_b32 v52, v52, v53
    s_waitcnt vmcnt(4)
    v_mfma_f32_16x16x32_bf16 v[48:51], v[20:23], v[12:15], v[48:51]
    v_xor_b32 v53, s33, v20
    v_or_b32 v52, v52, v53
    v_and_b32 v52, 1, v52
    v_cmp_ne_u32 vcc, 0, v52
    s_cbranch_vccnz L_rslow_78
L_rgo_79:
    s_nop 2
    v_permlane32_swap_b32 v48, v50
    v_permlane32_swap_b32 v49, v51
    v_pk_add_f32 v[48:49], v[48:49], v[50:51]
    s_mov_b64 exec, s[38:39]
    v_cvt_pk_bf16_f32 v12, v48, v49
    v_min_u32 v12, 0xfffffffe, v12
    buffer_store_dword v12, v119, s[8:11], s24 offen sc1
    s_mov_b64 exec, -1
    s_add_u32 s24, s24, 8192
    s_bitset0_b32 s24, 15
    s_xor_b32 s55, s24, 16384
    s_xor_b32 s29, s29, 0x0
    s_xor_b32 s53, s29, 1024
    s_bfe_u32 s33, s22, 0x10000
    s_waitcnt lgkmcnt(0)
    s_branch L_chain_top2_s
.p2align 6
L_chain_top3_s:
    buffer_load_dwordx4 v[0:3], v117, s[8:11], s23 offen sc1
    v_mov_b32 v48, 0
    v_mov_b32 v49, 0
    v_mov_b32 v50, 0
    v_mov_b32 v51, 0
    v_mov_b32 v52, 0
    v_mov_b32 v53, 0
    v_mov_b32 v15, 0
    v_mov_b32 v15, 0
    v_mov_b32 v15, 0
    v_mov_b32 v15, 0
    v_mov_b32 v15, 0
    v_mov_b32 v15, 0
    v_mov_b32 v15, 0
    v_mov_b32 v15, 0
    v_mov_b32 v15, 0
    v_mov_b32 v15, 0
    buffer_load_dwordx4 v[0:3], v117, s[8:11], s23 offen sc1
    s_waitcnt vmcnt(3)
    v_mov_b32 v36, 0
    v_mov_b32 v37, 0
    v_mov_b32 v38, 0
    v_mov_b32 v39, 0
    v_mov_b32 v40, 0
    v_mov_b32 v41, 0
    v_mov_b32 v42, 0
    v_mov_b32 v43, 0
    v_mov_b32 v44, 0
    v_mov_b32 v45, 0
    v_mov_b32 v46, 0
    v_mov_b32 v47, 0
    v_mov_b32 v15, 0
    v_mov_b32 v15, 0
    v_mov_b32 v15, 0
    v_mov_b32 v15, 0
L_mret_80:
    buffer_load_dwordx4 v[0:3], v117, s[8:11], s23 offen sc1
    s_add_u32 s45, s45, 1
    s_cmp_lt_u32 s45, 0x10000
    s_cselect_b32 s56, -2, -1
    s_nop 3
    v_mov_b32 v32, 0
    v_mov_b32 v33, 0
    v_mov_b32 v34, 0
    v_mov_b32 v35, 0
    s_waitcnt vmcnt(2)
    v_max3_u32 v15, v0, v1, v2
    v_max_u32 v15, v15, v3
    v_cmp_lt_u32 vcc, s56, v15
    v_smfmac_f32_16x16x64_bf16 v[32:35], v[0:3], v[80:87], v116
    s_cbranch_vccnz L_mret_80
    ds_write_b128 v117, v[0:3] offset:3072
    v_smfmac_f32_16x16x64_bf16 v[36:39], v[0:3], v[56:63], v116
    buffer_load_dwordx4 v[4:7], v117, s[8:11], s48 offen sc1
    v_smfmac_f32_16x16x64_bf16 v[40:43], v[0:3], v[64:71], v116
    buffer_load_dwordx4 v117, s[8:11], s48 offen sc1 lds
    s_mov_b32 m0, 14336
    v_smfmac_f32_16x16x64_bf16 v[44:47], v[0:3], v[72:79], v116
    s_waitcnt lgkmcnt(0)
    s_barrier
    ds_read_b128 v[8:11], v117 offset:2048
    v_smfmac_f32_16x16x64_bf16 v[48:51], v[0:3], a[192:199], v116
    ds_read_b128 v[16:19], v117 offset:1024
    ds_read_b128 v[20:23], v117
    v_smfmac_f32_16x16x64_bf16 v[52:55], v[0:3], a[200:207], v116
    ds_read_b128 v[80:83], v117 offset:14336
    s_waitcnt lgkmcnt(3)
    v_smfmac_f32_16x16x64_bf16 v[32:35], v[8:11], a[0:7], v116
    ds_read_b128 v[84:87], v117 offset:15360
    v_smfmac_f32_16x16x64_bf16 v[36:39], v[8:11], a[8:15], v116
    ds_read_b128 v[56:59], v117 offset:8192
    s_waitcnt lgkmcnt(4)
    v_smfmac_f32_16x16x64_bf16 v[32:35], v[16:19], a[32:39], v116
    ds_read_b128 v[60:63], v117 offset:9216
    v_smfmac_f32_16x16x64_bf16 v[36:39], v[16:19], a[40:47], v116
    ds_read_b128 v[64:67], v117 offset:10240
    s_waitcnt lgkmcnt(5)
    v_smfmac_f32_16x16x64_bf16 v[32:35], v[20:23], a[64:71], v116
    ds_read_b128 v[68:71], v117 offset:11264
    v_smfmac_f32_16x16x64_bf16 v[36:39], v[20:23], a[72:79], v116
    ds_read_b128 v[72:75], v117 offset:12288
    v_smfmac_f32_16x16x64_bf16 v[40:43], v[8:11], a[96:103], v116
    ds_read_b128 v[76:79], v117 offset:13312
    v_smfmac_f32_16x16x64_bf16 v[40:43], v[16:19], a[128:135], v116
    buffer_store_dwordx4 v[112:115], v117, s[8:11], s32 offen sc1
    v_smfmac_f32_16x16x64_bf16 v[40:43], v[20:23], a[160:167], v116
    s_waitcnt vmcnt(2)
    v_max3_u32 v15, v4, v5, v6
    v_smfmac_f32_16x16x64_bf16 v[44:47], v[8:11], a[104:111], v116
    v_max_u32 v15, v15, v7
    v_smfmac_f32_16x16x64_bf16 v[44:47], v[16:19], a[136:143], v116
    s_waitcnt vmcnt(1) lgkmcnt(0)
    v_cmp_lt_u32 vcc, s56, v15
    v_smfmac_f32_16x16x64_bf16 v[44:47], v[20:23], a[168:175], v116
    s_cbranch_vccnz L_mret_81
L_mgo_82:
    v_smfmac_f32_16x16x64_bf16 v[44:47], v[4:7], v[24:31], v116
    s_barrier
    ds_read_b128 v[12:15], v117 offset:6144
    v_smfmac_f32_16x16x64_bf16 v[32:35], v[4:7], v[88:95], v116
    ds_read_b128 v[24:27], v117 offset:5120
    v_smfmac_f32_16x16x64_bf16 v[36:39], v[4:7], v[96:103], v116
    ds_read_b128 v[28:31], v117 offset:4096
    v_smfmac_f32_16x16x64_bf16 v[40:43], v[4:7], v[104:111], v116
    ds_read_b128 v[88:91], v117 offset:30720
    s_waitcnt lgkmcnt(3)
    v_smfmac_f32_16x16x64_bf16 v[32:35], v[12:15], a[16:23], v116
    ds_read_b128 v[92:95], v117 offset:31744
    s_waitcnt lgkmcnt(3)
    v_smfmac_f32_16x16x64_bf16 v[32:35], v[24:27], a[48:55], v116
    ds_read_b128 v[96:99], v117 offset:23552
    s_waitcnt lgkmcnt(3)
    v_smfmac_f32_16x16x64_bf16 v[32:35], v[28:31], a[80:87], v116
    buffer_load_dwordx4 v117, s[8:11], s30 offen lds
    v_smfmac_f32_16x16x64_bf16 v[36:39], v[12:15], a[24:31], v116
    ds_read_b128 v[100:103], v117 offset:23552
    v_smfmac_f32_16x16x64_bf16 v[36:39], v[24:27], a[56:63], v116
    ds_read_b128 v[104:107], v117 offset:23552
    v_add_f32 v32, v32, v34
    v_smfmac_f32_16x16x64_bf16 v[36:39], v[28:31], a[88:95], v116
    buffer_load_dwordx4 v117, s[8:11], s30 offen offset:1024 lds
    s_add_u32 m0, s52, 0x6000
    v_add_f32 v33, v33, v35
    v_smfmac_f32_16x16x64_bf16 v[40:43], v[12:15], a[112:119], v116
    ds_read_b128 v[108:111], v117 offset:23552
    v_mul_f32 v32, s34, v32
    v_smfmac_f32_16x16x64_bf16 v[40:43], v[24:27], a[144:151], v116
    ds_read_b128 v[0:3], v124
    v_mul_f32 v33, s34, v33
    v_smfmac_f32_16x16x64_bf16 v[40:43], v[28:31], a[176:183], v116
    s_waitcnt lgkmcnt(5)
    buffer_load_dwordx4 v117, s[8:11], s31 offen lds
    v_add_f32 v36, v36, v38
    v_smfmac_f32_16x16x64_bf16 v[48:51], v[4:7], a[208:215], v116
    v_add_f32 v37, v37, v39
    v_smfmac_f32_16x16x64_bf16 v[52:55], v[4:7], a[216:223], v116
    ds_read_b128 v[4:7], v124 offset:1024
    v_mul_f32 v36, s34, v36
    v_smfmac_f32_16x16x64_bf16 v[44:47], v[12:15], a[120:127], v116
    buffer_load_dwordx4 v117, s[8:11], s31 offen offset:1024 lds
    s_mov_b32 m0, 7168
    v_mul_f32 v37, s34, v37
    v_smfmac_f32_16x16x64_bf16 v[44:47], v[24:27], a[152:159], v116
    v_cvt_pk_bf16_f32 v34, v32, v36
    v_smfmac_f32_16x16x64_bf16 v[44:47], v[28:31], a[184:191], v116
    v_cvt_pk_bf16_f32 v35, v33, v37
    v_add_f32 v40, v40, v42
    v_smfmac_f32_16x16x64_bf16 v[48:51], v[8:11], a[224:231], v116
    ds_write2_b32 v120, v34, v35 offset0:32 offset1:48
    v_add_f32 v41, v41, v43
    v_smfmac_f32_16x16x64_bf16 v[52:55], v[8:11], a[232:239], v116
    v_add_f32 v44, v44, v46
    v_add_f32 v45, v45, v47
    v_cvt_pk_bf16_f32 v113, v40, v44
    v_cvt_pk_bf16_f32 v115, v41, v45
    v_smfmac_f32_16x16x64_bf16 v[48:51], v[12:15], a[240:247], v116
    ds_write2_b32 v120, v113, v115 offset0:0 offset1:16
    v_smfmac_f32_16x16x64_bf16 v[52:55], v[12:15], a[248:255], v116
    s_cmp_eq_u32 s22, 63
    s_cbranch_scc1 L_chain_last_s
    v_smfmac_f32_16x16x64_bf16 v[48:51], v[16:19], v[128:135], v116
    v_smfmac_f32_16x16x64_bf16 v[48:51], v[20:23], v[160:167], v116
    buffer_store_dword v126, v119, s[8:11], s55 offen sc1
    v_smfmac_f32_16x16x64_bf16 v[48:51], v[24:27], v[144:151], v116
    s_waitcnt lgkmcnt(0)
    s_barrier
    v_smfmac_f32_16x16x64_bf16 v[48:51], v[28:31], v[176:183], v116
    ds_read_b128 v[32:35], v121 offset:16384
    ds_read_b128 v[36:39], v121 offset:17408
    v_smfmac_f32_16x16x64_bf16 v[52:55], v[16:19], v[136:143], v116
    ds_read_b128 v[40:43], v121 offset:18432
    ds_read_b128 v[44:47], v121 offset:19456
    v_smfmac_f32_16x16x64_bf16 v[52:55], v[20:23], v[168:175], v116
    ds_read_b128 v[8:11], v124 offset:32768
    v_add_f32 v48, v48, v50
    v_smfmac_f32_16x16x64_bf16 v[52:55], v[24:27], v[152:159], v116
    ds_read_b128 v[12:15], v124 offset:33792
    v_add_f32 v49, v49, v51
    v_smfmac_f32_16x16x64_bf16 v[52:55], v[28:31], v[184:191], v116
    s_waitcnt lgkmcnt(5)
    v_cvt_pk_bf16_f32 v112, v48, v49
    v_mfma_f32_16x16x32_bf16 v[56:59], v[56:59], v[32:35], 0
    s_waitcnt lgkmcnt(4)
    v_mov_b32 v48, s50
    v_mov_b32 v49, s50
    v_mfma_f32_16x16x32_bf16 v[56:59], v[60:63], v[36:39], v[56:59]
    ds_read_b128 v[16:19], v124 offset:2048
    s_waitcnt lgkmcnt(4)
    v_mov_b32 v50, s50
    v_mov_b32 v51, s50
    v_mfma_f32_16x16x32_bf16 v[56:59], v[64:67], v[40:43], v[56:59]
    ds_read_b128 v[20:23], v124 offset:3072
    s_waitcnt lgkmcnt(4)
    v_add_f32 v52, v52, v54
    v_mfma_f32_16x16x32_bf16 v[56:59], v[68:71], v[44:47], v[56:59]
    ds_read_b128 v[24:27], v124 offset:4096
    v_add_f32 v53, v53, v55
    v_mfma_f32_16x16x32_bf16 v[60:63], v[72:75], v[32:35], 0
    ds_read_b128 v[28:31], v124 offset:5120
    v_cvt_pk_bf16_f32 v114, v52, v53
    v_mov_b32 v53, 0
    v_mfma_f32_16x16x32_bf16 v[60:63], v[76:79], v[36:39], v[60:63]
    v_exp_f32 v56, v56
    v_mfma_f32_16x16x32_bf16 v[60:63], v[80:83], v[40:43], v[60:63]
    v_exp_f32 v57, v57
    v_mfma_f32_16x16x32_bf16 v[60:63], v[84:87], v[44:47], v[60:63]
    v_exp_f32 v58, v58
    v_mfma_f32_16x16x32_bf16 v[64:67], v[32:35], v[32:35], 0
    v_exp_f32 v59, v59
    v_cvt_pk_bf16_f32 v68, v56, v57
    v_mfma_f32_16x16x32_bf16 v[64:67], v[36:39], v[36:39], v[64:67]
    v_exp_f32 v60, v60
    v_cvt_pk_bf16_f32 v69, v58, v59
    v_mfma_f32_16x16x32_bf16 v[64:67], v[40:43], v[40:43], v[64:67]
    v_exp_f32 v61, v61
    v_mfma_f32_16x16x32_bf16 v[64:67], v[44:47], v[44:47], v[64:67]
    v_exp_f32 v62, v62
    v_exp_f32 v63, v63
    v_cvt_pk_bf16_f32 v70, v60, v61
    v_cvt_pk_bf16_f32 v71, v62, v63
    s_nop 1
    v_mfma_f32_16x16x32_bf16 v[72:75], v[88:91], v[68:71], 0
    s_nop 0
    v_exp_f32 v64, v64
    v_mfma_f32_16x16x32_bf16 v[76:79], v[92:95], v[68:71], 0
    v_exp_f32 v65, v65
    v_mfma_f32_16x16x32_bf16 v[80:83], v[48:51], v[68:71], 0
    v_cvt_pk_bf16_f32 v52, v64, v65
    s_nop 1
    v_mfma_f32_16x16x16_bf16 v[72:75], v[112:113], v[52:53], v[72:75]
    ds_read_b128 v[32:35], v124 offset:6144
    v_mfma_f32_16x16x16_bf16 v[76:79], v[114:115], v[52:53], v[76:79]
    ds_read_b128 v[36:39], v124 offset:7168
    v_mfma_f32_16x16x16_bf16 v[80:83], v[48:49], v[52:53], v[80:83]
L_norm_83:
    s_mov_b64 vcc, s[36:37]
    v_mov_b32 v122, v122
    v_mov_b32 v122, v122
    v_mov_b32 v122, v122
    v_cndmask_b32_dpp v76, v72, v76, vcc quad_perm:[2,3,2,3] row_mask:0xf bank_mask:0xf
    v_cndmask_b32_dpp v77, v73, v77, vcc quad_perm:[2,3,2,3] row_mask:0xf bank_mask:0xf
    v_cndmask_b32_dpp v78, v74, v78, vcc quad_perm:[2,3,2,3] row_mask:0xf bank_mask:0xf
    v_cndmask_b32_dpp v79, v75, v79, vcc quad_perm:[2,3,2,3] row_mask:0xf bank_mask:0xf
    v_rcp_f32_dpp v84, v80 quad_perm:[2,3,2,3] row_mask:0xf bank_mask:0xf
    s_nop 0
    v_pk_mul_f32 v[76:77], v[76:77], v[84:85] op_sel_hi:[1,0]
    v_pk_mul_f32 v[78:79], v[78:79], v[84:85] op_sel_hi:[1,0]
    v_cvt_pk_bf16_f32 v72, v76, v77
    v_cvt_pk_bf16_f32 v73, v78, v79
    ds_write_b64 v122, v[72:73] offset:22016
    v_max_f32_dpp v86, v80, v84 quad_perm:[2,3,2,3] row_mask:0xf bank_mask:0xf
    v_mov_b32_dpp v60, v72 quad_perm:[0,1,0,1] row_mask:0xf bank_mask:0xf
    v_mov_b32_dpp v61, v73 quad_perm:[0,1,0,1] row_mask:0xf bank_mask:0xf
    v_cmp_lt_f32 vcc, s35, v86
    v_mov_b32_dpp v62, v72 quad_perm:[2,3,2,3] row_mask:0xf bank_mask:0xf
    v_mov_b32_dpp v63, v73 quad_perm:[2,3,2,3] row_mask:0xf bank_mask:0xf
    s_nop 1
    v_smfmac_f32_16x16x64_bf16 v[96:99], v[60:63], v[192:199], v116
    s_cbranch_vccnz L_smax_84
    v_smfmac_f32_16x16x64_bf16 v[100:103], v[60:63], v[224:231], v116
    s_waitcnt lgkmcnt(0)
    s_barrier
    ds_read_b128 v[92:95], v127 offset:21504
    ds_read_b128 v[80:83], v127 offset:20992
    ds_read_b128 v[84:87], v127 offset:20480
    v_smfmac_f32_16x16x64_bf16 v[104:107], v[60:63], v[0:7], v116
    ds_read_b128 v[40:43], v124 offset:34816
    v_smfmac_f32_16x16x64_bf16 v[108:111], v[60:63], v[8:15], v116
    ds_read_b128 v[56:59], v124 offset:36864
    s_waitcnt lgkmcnt(4)
    v_smfmac_f32_16x16x64_bf16 v[96:99], v[92:95], v[200:207], v116
    s_waitcnt lgkmcnt(3)
    v_smfmac_f32_16x16x64_bf16 v[96:99], v[80:83], v[208:215], v116
    ds_read_b128 v[44:47], v124 offset:35840
    s_waitcnt lgkmcnt(3)
    v_smfmac_f32_16x16x64_bf16 v[96:99], v[84:87], v[216:223], v116
    ds_read_b128 v[68:71], v124 offset:39936
    v_smfmac_f32_16x16x64_bf16 v[100:103], v[92:95], v[232:239], v116
    ds_read_b128 v[64:67], v124 offset:38912
    v_smfmac_f32_16x16x64_bf16 v[100:103], v[80:83], v[240:247], v116
    ds_read_b128 v[60:63], v124 offset:37888
    v_cvt_pk_bf16_f32 v72, v96, v98
    v_smfmac_f32_16x16x64_bf16 v[100:103], v[84:87], v[248:255], v116
    v_and_or_b32 v72, v72, -2, s33
    v_smfmac_f32_16x16x64_bf16 v[104:107], v[92:95], v[16:23], v116
    v_cvt_pk_bf16_f32 v74, v97, v99
    v_smfmac_f32_16x16x64_bf16 v[104:107], v[80:83], v[24:31], v116
    v_cvt_pk_bf16_f32 v73, v100, v102
    v_cvt_pk_bf16_f32 v75, v101, v103
    v_smfmac_f32_16x16x64_bf16 v[104:107], v[84:87], v[32:39], v116
    buffer_store_dwordx4 v[72:75], v118, s[8:11], s25 offen sc1
    s_waitcnt lgkmcnt(3)
    v_smfmac_f32_16x16x64_bf16 v[108:111], v[92:95], v[40:47], v116
    s_waitcnt lgkmcnt(0)
    v_smfmac_f32_16x16x64_bf16 v[108:111], v[80:83], v[56:63], v116
    v_cvt_pk_bf16_f32 v76, v104, v106
    v_smfmac_f32_16x16x64_bf16 v[108:111], v[84:87], v[64:71], v116
    v_and_or_b32 v76, v76, -2, s33
    v_cvt_pk_bf16_f32 v78, v105, v107
    v_mov_b32 v122, v122
    v_mov_b32 v122, v122
    v_mov_b32 v122, v122
    v_mov_b32 v122, v122
    v_mov_b32 v122, v122
    v_mov_b32 v122, v122
    v_cvt_pk_bf16_f32 v77, v108, v110
    v_cvt_pk_bf16_f32 v79, v109, v111
    buffer_store_dwordx4 v[76:79], v118, s[8:11], s26 offen sc1
    ds_read_b128 v[80:83], v123
    ds_read_b128 v[84:87], v123 offset:1024
    ds_read_b128 v[56:59], v123 offset:2048
    ds_read_b128 v[60:63], v123 offset:3072
    ds_read_b128 v[64:67], v123 offset:32768
    ds_read_b128 v[68:71], v123 offset:33792
    ds_read_b128 v[72:75], v123 offset:34816
    ds_read_b128 v[76:79], v123 offset:35840
    ds_read_b128 v[88:91], v123 offset:4096
    ds_read_b128 v[92:95], v123 offset:5120
    ds_read_b128 v[96:99], v123 offset:6144
    ds_read_b128 v[100:103], v123 offset:7168
    ds_read_b128 v[104:107], v123 offset:36864
    ds_read_b128 v[108:111], v123 offset:37888
    ds_read_b128 v[24:27], v123 offset:38912
    ds_read_b128 v[28:31], v123 offset:39936
    s_add_u32 s30, s30, 0x40000
    s_add_u32 s31, s31, 0x40000
    s_add_u32 s32, s32, 0x20000
    s_add_u32 s23, s24, 3072
    s_add_u32 s48, s23, 4096
    s_xor_b32 s25, s25, 0x0
    s_xor_b32 s26, s26, 0x0
    s_mov_b32 s35, 0x49800000
    s_add_u32 s22, s22, 1
    v_cndmask_b32 v12, 0, v125, s[68:69]
    v_cndmask_b32 v13, 0, v125, s[70:71]
    v_cndmask_b32 v14, 0, v125, s[72:73]
    v_cndmask_b32 v15, 0, v125, s[74:75]
    v_mov_b32 v54, 0
    v_mov_b32 v55, 0
    v_mov_b32 v52, 0
    v_mov_b32 v52, 0
    v_mov_b32 v52, 0
    v_mov_b32 v52, 0
    v_mov_b32 v52, 0
    v_mov_b32 v52, 0
    v_mov_b32 v52, 0
    v_mov_b32 v52, 0
    v_mov_b32 v52, 0
    v_mov_b32 v52, 0
    v_mov_b32 v52, 0
    v_mov_b32 v52, 0
    v_mov_b32 v52, 0
    v_mov_b32 v52, 0
    v_mov_b32 v52, 0
    v_mov_b32 v52, 0
    v_mov_b32 v52, 0
    v_mov_b32 v52, 0
    v_mov_b32 v52, 0
    v_mov_b32 v52, 0
    v_mov_b32 v52, 0
    v_mov_b32 v52, 0
    v_mov_b32 v52, 0
    v_mov_b32 v52, 0
    v_mov_b32 v52, 0
    v_mov_b32 v52, 0
    v_mov_b32 v52, 0
    v_mov_b32 v52, 0
    v_mov_b32 v52, 0
    v_mov_b32 v52, 0
    v_mov_b32 v52, 0
    v_mov_b32 v52, 0
    v_mov_b32 v52, 0
    v_mov_b32 v52, 0
    v_mov_b32 v52, 0
    v_mov_b32 v52, 0
    v_mov_b32 v52, 0
    v_mov_b32 v52, 0
    v_mov_b32 v52, 0
    v_mov_b32 v52, 0
    v_mov_b32 v52, 0
    v_mov_b32 v52, 0
    v_mov_b32 v52, 0
    v_mov_b32 v52, 0
    v_mov_b32 v52, 0
    v_mov_b32 v52, 0
    v_mov_b32 v52, 0
    v_mov_b32 v52, 0
    v_mov_b32 v52, 0
    buffer_load_dwordx4 v[4:7], v117, s[8:11], s29 offen sc1
    buffer_load_dwordx4 v[8:11], v117, s[8:11], s53 offen sc1
    buffer_load_dwordx4 v[16:19], v117, s[8:11], s29 offen offset:2048 sc1
    buffer_load_dwordx4 v[20:23], v117, s[8:11], s53 offen offset:2048 sc1
    v_mov_b32 v52, 0
    v_mov_b32 v52, 0
    v_mov_b32 v52, 0
    v_mov_b32 v52, 0
    v_mov_b32 v52, 0
    v_mov_b32 v52, 0
    v_mov_b32 v52, 0
    v_mov_b32 v52, 0
    v_mov_b32 v52, 0
    v_mov_b32 v52, 0
    v_mov_b32 v52, 0
    v_mov_b32 v52, 0
    v_mov_b32 v52, 0
    v_mov_b32 v52, 0
    v_mov_b32 v52, 0
    v_mov_b32 v52, 0
    v_mov_b32 v52, 0
    v_mov_b32 v52, 0
    v_mov_b32 v52, 0
    v_mov_b32 v52, 0
    v_mov_b32 v52, 0
    v_mov_b32 v52, 0
    v_mov_b32 v52, 0
    v_mov_b32 v52, 0
    v_mov_b32 v52, 0
    v_mov_b32 v52, 0
    v_mov_b32 v52, 0
    v_mov_b32 v52, 0
    v_mov_b32 v52, 0
    v_mov_b32 v52, 0
    buffer_load_dwordx4 v[32:35], v117, s[8:11], s29 offen sc1
    buffer_load_dwordx4 v[36:39], v117, s[8:11], s53 offen sc1
    buffer_load_dwordx4 v[40:43], v117, s[8:11], s29 offen offset:2048 sc1
    buffer_load_dwordx4 v[44:47], v117, s[8:11], s53 offen offset:2048 sc1
    v_mov_b32 v52, 0
L_rl_85:
    s_waitcnt vmcnt(7)
    v_mfma_f32_16x16x32_bf16 v[48:51], v[4:7], v[12:15], 0
    v_xor_b32 v52, s33, v4
    s_waitcnt vmcnt(6)
    v_mfma_f32_16x16x32_bf16 v[48:51], v[8:11], v[12:15], v[48:51]
    v_xor_b32 v53, s33, v8
    v_or_b32 v52, v52, v53
    s_waitcnt vmcnt(5)
    v_mfma_f32_16x16x32_bf16 v[48:51], v[16:19], v[12:15], v[48:51]
    v_xor_b32 v53, s33, v16
    v_or_b32 v52, v52, v53
    s_waitcnt vmcnt(4)
    v_mfma_f32_16x16x32_bf16 v[48:51], v[20:23], v[12:15], v[48:51]
    v_xor_b32 v53, s33, v20
    v_or_b32 v52, v52, v53
    v_and_b32 v52, 1, v52
    v_cmp_ne_u32 vcc, 0, v52
    s_cbranch_vccnz L_rslow_86
L_rgo_87:
    s_nop 2
    v_permlane32_swap_b32 v48, v50
    v_permlane32_swap_b32 v49, v51
    v_pk_add_f32 v[48:49], v[48:49], v[50:51]
    s_mov_b64 exec, s[38:39]
    v_cvt_pk_bf16_f32 v12, v48, v49
    v_min_u32 v12, 0xfffffffe, v12
    buffer_store_dword v12, v119, s[8:11], s24 offen sc1
    s_mov_b64 exec, -1
    s_add_u32 s24, s24, 8192
    s_bitset0_b32 s24, 15
    s_xor_b32 s55, s24, 16384
    s_xor_b32 s29, s29, 0x0
    s_xor_b32 s53, s29, 1024
    s_bfe_u32 s33, s22, 0x10000
    s_waitcnt lgkmcnt(0)
    s_branch L_chain_top3_s
L_chain_last_s:
    s_nop 1
    v_smfmac_f32_16x16x64_bf16 v[48:51], v[16:19], v[128:135], v116
    v_smfmac_f32_16x16x64_bf16 v[48:51], v[20:23], v[160:167], v116
    v_smfmac_f32_16x16x64_bf16 v[48:51], v[24:27], v[144:151], v116
    v_smfmac_f32_16x16x64_bf16 v[48:51], v[28:31], v[176:183], v116
    v_smfmac_f32_16x16x64_bf16 v[52:55], v[16:19], v[136:143], v116
    v_smfmac_f32_16x16x64_bf16 v[52:55], v[20:23], v[168:175], v116
    v_smfmac_f32_16x16x64_bf16 v[52:55], v[24:27], v[152:159], v116
    v_smfmac_f32_16x16x64_bf16 v[52:55], v[28:31], v[184:191], v116
    v_add_f32 v48, v48, v50
    v_add_f32 v49, v49, v51
    v_cvt_pk_bf16_f32 v112, v48, v49
    s_nop 4
    v_add_f32 v52, v52, v54
    v_add_f32 v53, v53, v55
    v_cvt_pk_bf16_f32 v114, v52, v53
    s_add_u32 s32, s32, 0x20000
    buffer_store_dwordx4 v[112:115], v117, s[8:11], s32 offen sc1
    v_mov_b32 v94, 64
    s_waitcnt vmcnt(0) lgkmcnt(0)
    s_barrier
    s_mov_b64 exec, 1
    buffer_store_dword v94, off, s[8:11], s44 sc1
    s_mov_b64 exec, -1
    s_endpgm
L_mret_59:
    s_mov_b32 s43, m0
    s_mov_b32 m0, 4096
    buffer_load_dwordx4 v[4:7], v117, s[8:11], s48 offen sc1
    buffer_load_dwordx4 v117, s[8:11], s48 offen sc1 lds
    s_mov_b32 m0, 8192
    s_mov_b32 m0, s43
    s_waitcnt vmcnt(0)
    v_max3_u32 v15, v4, v5, v6
    v_max_u32 v15, v15, v7
    v_cmp_lt_u32 vcc, s56, v15
    s_add_u32 s47, s47, 1
    s_add_u32 s49, s49, 1
    s_cmp_ge_u32 s49, 0x10000
    s_cbranch_scc1 L_mgo_60
    s_cbranch_vccnz L_mret_59
    s_branch L_mgo_60
L_smax_62:
    s_add_u32 s47, s47, 1
    s_mov_b32 s35, 0x7f800000
    s_waitcnt lgkmcnt(0)
    s_sub_u32 s43, s30, 0x40000
    s_add_u32 s40, s43, 4096
    s_nop 7
    buffer_load_dwordx4 v[56:59], v117, s[8:11], s43 offen
    buffer_load_dwordx4 v[60:63], v117, s[8:11], s43 offen offset:1024
    buffer_load_dwordx4 v[64:67], v117, s[8:11], s43 offen offset:2048
    buffer_load_dwordx4 v[68:71], v117, s[8:11], s43 offen offset:3072
    buffer_load_dwordx4 v[72:75], v117, s[8:11], s40 offen
    buffer_load_dwordx4 v[76:79], v117, s[8:11], s40 offen offset:1024
    buffer_load_dwordx4 v[80:83], v117, s[8:11], s40 offen offset:2048
    buffer_load_dwordx4 v[84:87], v117, s[8:11], s40 offen offset:3072
    ds_read_b128 v[32:35], v121 offset:16384
    ds_read_b128 v[36:39], v121 offset:17408
    ds_read_b128 v[40:43], v121 offset:18432
    ds_read_b128 v[44:47], v121 offset:19456
    v_mov_b32 v96, 0
    v_mov_b32 v97, 0
    v_mov_b32 v98, 0
    v_mov_b32 v99, 0
    v_mov_b32 v100, 0
    v_mov_b32 v101, 0
    v_mov_b32 v102, 0
    v_mov_b32 v103, 0
    v_mov_b32 v104, 0
    v_mov_b32 v105, 0
    v_mov_b32 v106, 0
    v_mov_b32 v107, 0
    v_mov_b32 v108, 0
    v_mov_b32 v109, 0
    v_mov_b32 v110, 0
    v_mov_b32 v111, 0
    s_waitcnt vmcnt(0) lgkmcnt(0)
    v_mfma_f32_16x16x32_bf16 v[56:59], v[56:59], v[32:35], 0
    v_mfma_f32_16x16x32_bf16 v[56:59], v[60:63], v[36:39], v[56:59]
    v_mfma_f32_16x16x32_bf16 v[56:59], v[64:67], v[40:43], v[56:59]
    v_mfma_f32_16x16x32_bf16 v[56:59], v[68:71], v[44:47], v[56:59]
    v_mfma_f32_16x16x32_bf16 v[60:63], v[72:75], v[32:35], 0
    v_mfma_f32_16x16x32_bf16 v[60:63], v[76:79], v[36:39], v[60:63]
    v_mfma_f32_16x16x32_bf16 v[60:63], v[80:83], v[40:43], v[60:63]
    v_mfma_f32_16x16x32_bf16 v[60:63], v[84:87], v[44:47], v[60:63]
    v_mfma_f32_16x16x32_bf16 v[64:67], v[32:35], v[32:35], 0
    v_mfma_f32_16x16x32_bf16 v[64:67], v[36:39], v[36:39], v[64:67]
    v_mfma_f32_16x16x32_bf16 v[64:67], v[40:43], v[40:43], v[64:67]
    v_mfma_f32_16x16x32_bf16 v[64:67], v[44:47], v[44:47], v[64:67]
    v_max3_f32 v84, v56, v57, v58
    v_max3_f32 v84, v84, v59, v60
    v_max3_f32 v84, v84, v61, v62
    s_nop 4
    v_max3_f32 v84, v84, v63, v64
    v_max_f32 v84, v84, v65
    v_mov_b32 v85, v84
    s_nop 1
    v_permlane32_swap_b32 v85, v84
    v_max_f32 v84, v85, v84
    v_mov_b32 v85, v84
    s_nop 1
    v_permlane16_swap_b32 v85, v84
    v_max_f32 v84, v85, v84
    v_sub_f32 v56, v56, v84
    v_sub_f32 v57, v57, v84
    v_sub_f32 v58, v58, v84
    v_sub_f32 v59, v59, v84
    v_sub_f32 v60, v60, v84
    v_sub_f32 v61, v61, v84
    v_sub_f32 v62, v62, v84
    v_sub_f32 v63, v63, v84
    v_sub_f32 v64, v64, v84
    v_sub_f32 v65, v65, v84
    v_exp_f32 v56, v56
    v_exp_f32 v57, v57
    v_exp_f32 v58, v58
    v_exp_f32 v59, v59
    v_exp_f32 v60, v60
    v_exp_f32 v61, v61
    v_exp_f32 v62, v62
    v_exp_f32 v63, v63
    v_exp_f32 v64, v64
    v_exp_f32 v65, v65
    v_cvt_pk_bf16_f32 v68, v56, v57
    v_cvt_pk_bf16_f32 v69, v58, v59
    v_cvt_pk_bf16_f32 v70, v60, v61
    v_cvt_pk_bf16_f32 v71, v62, v63
    v_cvt_pk_bf16_f32 v52, v64, v65
    s_nop 0
    v_mfma_f32_16x16x32_bf16 v[72:75], v[88:91], v[68:71], 0
    v_mfma_f32_16x16x32_bf16 v[76:79], v[92:95], v[68:71], 0
    v_mfma_f32_16x16x32_bf16 v[80:83], v[48:51], v[68:71], 0
    v_mfma_f32_16x16x16_bf16 v[72:75], v[112:113], v[52:53], v[72:75]
    v_mfma_f32_16x16x16_bf16 v[76:79], v[114:115], v[52:53], v[76:79]
    v_mfma_f32_16x16x16_bf16 v[80:83], v[48:49], v[52:53], v[80:83]
    ds_read_b128 v[32:35], v124 offset:6144
    ds_read_b128 v[36:39], v124 offset:7168
    ds_read_b128 v[40:43], v124 offset:34816
    ds_read_b128 v[44:47], v124 offset:35840
    ds_read_b128 v[56:59], v124 offset:36864
    ds_read_b128 v[64:67], v124 offset:38912
    ds_read_b128 v[68:71], v124 offset:39936
    s_waitcnt lgkmcnt(0)
    s_branch L_norm_61
L_kvw_63:
    s_add_u32 s47, s47, 1
    s_add_u32 s49, s49, 1
    s_cmp_ge_u32 s49, 0x10000
    s_cbranch_scc1 L_kvb_64
    s_sleep 4
    buffer_load_dword v125, v119, s[8:11], s28 offen sc1
    s_waitcnt vmcnt(0)
    v_cmp_eq_u32 vcc, 0, v125
    s_nop 0
    s_and_b64 vcc, vcc, s[58:59]
    s_cbranch_scc1 L_kvw_63
    s_branch L_kvb_64
L_mret_66:
    s_mov_b32 s43, m0
    s_mov_b32 m0, 5120
    buffer_load_dwordx4 v[4:7], v117, s[8:11], s48 offen sc1
    buffer_load_dwordx4 v117, s[8:11], s48 offen sc1 lds
    s_mov_b32 m0, 10240
    s_mov_b32 m0, s43
    s_waitcnt vmcnt(0)
    v_max3_u32 v15, v4, v5, v6
    v_max_u32 v15, v15, v7
    v_cmp_lt_u32 vcc, s56, v15
    s_add_u32 s47, s47, 1
    s_add_u32 s49, s49, 1
    s_cmp_ge_u32 s49, 0x10000
    s_cbranch_scc1 L_mgo_67
    s_cbranch_vccnz L_mret_66
    s_branch L_mgo_67
L_smax_69:
    s_add_u32 s47, s47, 1
    s_mov_b32 s35, 0x7f800000
    s_waitcnt lgkmcnt(0)
    s_sub_u32 s43, s30, 0x40800
    s_add_u32 s40, s43, 4096
    s_nop 7
    buffer_load_dwordx4 v[56:59], v117, s[8:11], s43 offen
    buffer_load_dwordx4 v[60:63], v117, s[8:11], s43 offen offset:1024
    buffer_load_dwordx4 v[64:67], v117, s[8:11], s43 offen offset:2048
    buffer_load_dwordx4 v[68:71], v117, s[8:11], s43 offen offset:3072
    buffer_load_dwordx4 v[72:75], v117, s[8:11], s40 offen
    buffer_load_dwordx4 v[76:79], v117, s[8:11], s40 offen offset:1024
    buffer_load_dwordx4 v[80:83], v117, s[8:11], s40 offen offset:2048
    buffer_load_dwordx4 v[84:87], v117, s[8:11], s40 offen offset:3072
    ds_read_b128 v[32:35], v121 offset:16384
    ds_read_b128 v[36:39], v121 offset:17408
    ds_read_b128 v[40:43], v121 offset:18432
    ds_read_b128 v[44:47], v121 offset:19456
    v_mov_b32 v96, 0
    v_mov_b32 v97, 0
    v_mov_b32 v98, 0
    v_mov_b32 v99, 0
    v_mov_b32 v100, 0
    v_mov_b32 v101, 0
    v_mov_b32 v102, 0
    v_mov_b32 v103, 0
    v_mov_b32 v104, 0
    v_mov_b32 v105, 0
    v_mov_b32 v106, 0
    v_mov_b32 v107, 0
    v_mov_b32 v108, 0
    v_mov_b32 v109, 0
    v_mov_b32 v110, 0
    v_mov_b32 v111, 0
    s_waitcnt vmcnt(0) lgkmcnt(0)
    v_mfma_f32_16x16x32_bf16 v[56:59], v[56:59], v[32:35], 0
    v_mfma_f32_16x16x32_bf16 v[56:59], v[60:63], v[36:39], v[56:59]
    v_mfma_f32_16x16x32_bf16 v[56:59], v[64:67], v[40:43], v[56:59]
    v_mfma_f32_16x16x32_bf16 v[56:59], v[68:71], v[44:47], v[56:59]
    v_mfma_f32_16x16x32_bf16 v[60:63], v[72:75], v[32:35], 0
    v_mfma_f32_16x16x32_bf16 v[60:63], v[76:79], v[36:39], v[60:63]
    v_mfma_f32_16x16x32_bf16 v[60:63], v[80:83], v[40:43], v[60:63]
    v_mfma_f32_16x16x32_bf16 v[60:63], v[84:87], v[44:47], v[60:63]
    v_mfma_f32_16x16x32_bf16 v[64:67], v[32:35], v[32:35], 0
    v_mfma_f32_16x16x32_bf16 v[64:67], v[36:39], v[36:39], v[64:67]
    v_mfma_f32_16x16x32_bf16 v[64:67], v[40:43], v[40:43], v[64:67]
    v_mfma_f32_16x16x32_bf16 v[64:67], v[44:47], v[44:47], v[64:67]
    v_max3_f32 v84, v56, v57, v58
    v_max3_f32 v84, v84, v59, v60
    v_max3_f32 v84, v84, v61, v62
    s_nop 4
    v_max3_f32 v84, v84, v63, v64
    v_max_f32 v84, v84, v65
    v_mov_b32 v85, v84
    s_nop 1
    v_permlane32_swap_b32 v85, v84
    v_max_f32 v84, v85, v84
    v_mov_b32 v85, v84
    s_nop 1
    v_permlane16_swap_b32 v85, v84
    v_max_f32 v84, v85, v84
    v_sub_f32 v56, v56, v84
    v_sub_f32 v57, v57, v84
    v_sub_f32 v58, v58, v84
    v_sub_f32 v59, v59, v84
    v_sub_f32 v60, v60, v84
    v_sub_f32 v61, v61, v84
    v_sub_f32 v62, v62, v84
    v_sub_f32 v63, v63, v84
    v_sub_f32 v64, v64, v84
    v_sub_f32 v65, v65, v84
    v_exp_f32 v56, v56
    v_exp_f32 v57, v57
    v_exp_f32 v58, v58
    v_exp_f32 v59, v59
    v_exp_f32 v60, v60
    v_exp_f32 v61, v61
    v_exp_f32 v62, v62
    v_exp_f32 v63, v63
    v_exp_f32 v64, v64
    v_exp_f32 v65, v65
    v_cvt_pk_bf16_f32 v68, v56, v57
    v_cvt_pk_bf16_f32 v69, v58, v59
    v_cvt_pk_bf16_f32 v70, v60, v61
    v_cvt_pk_bf16_f32 v71, v62, v63
    v_cvt_pk_bf16_f32 v52, v64, v65
    s_nop 0
    v_mfma_f32_16x16x32_bf16 v[72:75], v[88:91], v[68:71], 0
    v_mfma_f32_16x16x32_bf16 v[76:79], v[92:95], v[68:71], 0
    v_mfma_f32_16x16x32_bf16 v[80:83], v[48:51], v[68:71], 0
    v_mfma_f32_16x16x16_bf16 v[72:75], v[112:113], v[52:53], v[72:75]
    v_mfma_f32_16x16x16_bf16 v[76:79], v[114:115], v[52:53], v[76:79]
    v_mfma_f32_16x16x16_bf16 v[80:83], v[48:49], v[52:53], v[80:83]
    ds_read_b128 v[32:35], v124 offset:6144
    ds_read_b128 v[36:39], v124 offset:7168
    ds_read_b128 v[40:43], v124 offset:34816
    ds_read_b128 v[44:47], v124 offset:35840
    ds_read_b128 v[56:59], v124 offset:36864
    ds_read_b128 v[64:67], v124 offset:38912
    ds_read_b128 v[68:71], v124 offset:39936
    s_waitcnt lgkmcnt(0)
    s_branch L_norm_68
L_kvw_70:
    s_add_u32 s47, s47, 1
    s_add_u32 s49, s49, 1
    s_cmp_ge_u32 s49, 0x10000
    s_cbranch_scc1 L_kvb_71
    s_sleep 4
    buffer_load_dword v125, v119, s[8:11], s28 offen sc1
    s_waitcnt vmcnt(0)
    v_cmp_eq_u32 vcc, 0, v125
    s_nop 0
    s_and_b64 vcc, vcc, s[58:59]
    s_cbranch_scc1 L_kvw_70
    s_branch L_kvb_71
L_mret_73:
    s_mov_b32 s43, m0
    s_mov_b32 m0, 6144
    buffer_load_dwordx4 v[4:7], v117, s[8:11], s48 offen sc1
    buffer_load_dwordx4 v117, s[8:11], s48 offen sc1 lds
    s_mov_b32 m0, 12288
    s_mov_b32 m0, s43
    s_waitcnt vmcnt(0)
    v_max3_u32 v15, v4, v5, v6
    v_max_u32 v15, v15, v7
    v_cmp_lt_u32 vcc, s56, v15
    s_add_u32 s47, s47, 1
    s_add_u32 s49, s49, 1
    s_cmp_ge_u32 s49, 0x10000
    s_cbranch_scc1 L_mgo_74
    s_cbranch_vccnz L_mret_73
    s_branch L_mgo_74
L_smax_76:
    s_add_u32 s47, s47, 1
    s_mov_b32 s35, 0x7f800000
    s_waitcnt lgkmcnt(0)
    s_sub_u32 s43, s30, 0x41000
    s_add_u32 s40, s43, 4096
    s_nop 7
    buffer_load_dwordx4 v[56:59], v117, s[8:11], s43 offen
    buffer_load_dwordx4 v[60:63], v117, s[8:11], s43 offen offset:1024
    buffer_load_dwordx4 v[64:67], v117, s[8:11], s43 offen offset:2048
    buffer_load_dwordx4 v[68:71], v117, s[8:11], s43 offen offset:3072
    buffer_load_dwordx4 v[72:75], v117, s[8:11], s40 offen
    buffer_load_dwordx4 v[76:79], v117, s[8:11], s40 offen offset:1024
    buffer_load_dwordx4 v[80:83], v117, s[8:11], s40 offen offset:2048
    buffer_load_dwordx4 v[84:87], v117, s[8:11], s40 offen offset:3072
    ds_read_b128 v[32:35], v121 offset:16384
    ds_read_b128 v[36:39], v121 offset:17408
    ds_read_b128 v[40:43], v121 offset:18432
    ds_read_b128 v[44:47], v121 offset:19456
    v_mov_b32 v96, 0
    v_mov_b32 v97, 0
    v_mov_b32 v98, 0
    v_mov_b32 v99, 0
    v_mov_b32 v100, 0
    v_mov_b32 v101, 0
    v_mov_b32 v102, 0
    v_mov_b32 v103, 0
    v_mov_b32 v104, 0
    v_mov_b32 v105, 0
    v_mov_b32 v106, 0
    v_mov_b32 v107, 0
    v_mov_b32 v108, 0
    v_mov_b32 v109, 0
    v_mov_b32 v110, 0
    v_mov_b32 v111, 0
    s_waitcnt vmcnt(0) lgkmcnt(0)
    v_mfma_f32_16x16x32_bf16 v[56:59], v[56:59], v[32:35], 0
    v_mfma_f32_16x16x32_bf16 v[56:59], v[60:63], v[36:39], v[56:59]
    v_mfma_f32_16x16x32_bf16 v[56:59], v[64:67], v[40:43], v[56:59]
    v_mfma_f32_16x16x32_bf16 v[56:59], v[68:71], v[44:47], v[56:59]
    v_mfma_f32_16x16x32_bf16 v[60:63], v[72:75], v[32:35], 0
    v_mfma_f32_16x16x32_bf16 v[60:63], v[76:79], v[36:39], v[60:63]
    v_mfma_f32_16x16x32_bf16 v[60:63], v[80:83], v[40:43], v[60:63]
    v_mfma_f32_16x16x32_bf16 v[60:63], v[84:87], v[44:47], v[60:63]
    v_mfma_f32_16x16x32_bf16 v[64:67], v[32:35], v[32:35], 0
    v_mfma_f32_16x16x32_bf16 v[64:67], v[36:39], v[36:39], v[64:67]
    v_mfma_f32_16x16x32_bf16 v[64:67], v[40:43], v[40:43], v[64:67]
    v_mfma_f32_16x16x32_bf16 v[64:67], v[44:47], v[44:47], v[64:67]
    v_max3_f32 v84, v56, v57, v58
    v_max3_f32 v84, v84, v59, v60
    v_max3_f32 v84, v84, v61, v62
    s_nop 4
    v_max3_f32 v84, v84, v63, v64
    v_max_f32 v84, v84, v65
    v_mov_b32 v85, v84
    s_nop 1
    v_permlane32_swap_b32 v85, v84
    v_max_f32 v84, v85, v84
    v_mov_b32 v85, v84
    s_nop 1
    v_permlane16_swap_b32 v85, v84
    v_max_f32 v84, v85, v84
    v_sub_f32 v56, v56, v84
    v_sub_f32 v57, v57, v84
    v_sub_f32 v58, v58, v84
    v_sub_f32 v59, v59, v84
    v_sub_f32 v60, v60, v84
    v_sub_f32 v61, v61, v84
    v_sub_f32 v62, v62, v84
    v_sub_f32 v63, v63, v84
    v_sub_f32 v64, v64, v84
    v_sub_f32 v65, v65, v84
    v_exp_f32 v56, v56
    v_exp_f32 v57, v57
    v_exp_f32 v58, v58
    v_exp_f32 v59, v59
    v_exp_f32 v60, v60
    v_exp_f32 v61, v61
    v_exp_f32 v62, v62
    v_exp_f32 v63, v63
    v_exp_f32 v64, v64
    v_exp_f32 v65, v65
    v_cvt_pk_bf16_f32 v68, v56, v57
    v_cvt_pk_bf16_f32 v69, v58, v59
    v_cvt_pk_bf16_f32 v70, v60, v61
    v_cvt_pk_bf16_f32 v71, v62, v63
    v_cvt_pk_bf16_f32 v52, v64, v65
    s_nop 0
    v_mfma_f32_16x16x32_bf16 v[72:75], v[88:91], v[68:71], 0
    v_mfma_f32_16x16x32_bf16 v[76:79], v[92:95], v[68:71], 0
    v_mfma_f32_16x16x32_bf16 v[80:83], v[48:51], v[68:71], 0
    v_mfma_f32_16x16x16_bf16 v[72:75], v[112:113], v[52:53], v[72:75]
    v_mfma_f32_16x16x16_bf16 v[76:79], v[114:115], v[52:53], v[76:79]
    v_mfma_f32_16x16x16_bf16 v[80:83], v[48:49], v[52:53], v[80:83]
    ds_read_b128 v[32:35], v124 offset:6144
    ds_read_b128 v[36:39], v124 offset:7168
    ds_read_b128 v[40:43], v124 offset:34816
    ds_read_b128 v[44:47], v124 offset:35840
    ds_read_b128 v[56:59], v124 offset:36864
    ds_read_b128 v[64:67], v124 offset:38912
    ds_read_b128 v[68:71], v124 offset:39936
    s_waitcnt lgkmcnt(0)
    s_branch L_norm_75
L_rslow_78:
    buffer_load_dwordx4 v[4:7], v117, s[8:11], s29 offen sc1
    buffer_load_dwordx4 v[8:11], v117, s[8:11], s53 offen sc1
    buffer_load_dwordx4 v[16:19], v117, s[8:11], s29 offen offset:2048 sc1
    buffer_load_dwordx4 v[20:23], v117, s[8:11], s53 offen offset:2048 sc1
    s_add_u32 s46, s46, 1
    s_add_u32 s49, s49, 1
    s_cmp_ge_u32 s49, 0x10000
    s_cbranch_scc1 L_rgo_79
    s_waitcnt vmcnt(7)
    v_mfma_f32_16x16x32_bf16 v[48:51], v[32:35], v[12:15], 0
    v_xor_b32 v52, s33, v32
    s_waitcnt vmcnt(6)
    v_mfma_f32_16x16x32_bf16 v[48:51], v[36:39], v[12:15], v[48:51]
    v_xor_b32 v53, s33, v36
    v_or_b32 v52, v52, v53
    s_waitcnt vmcnt(5)
    v_mfma_f32_16x16x32_bf16 v[48:51], v[40:43], v[12:15], v[48:51]
    v_xor_b32 v53, s33, v40
    v_or_b32 v52, v52, v53
    s_waitcnt vmcnt(4)
    v_mfma_f32_16x16x32_bf16 v[48:51], v[44:47], v[12:15], v[48:51]
    v_xor_b32 v53, s33, v44
    v_or_b32 v52, v52, v53
    v_and_b32 v52, 1, v52
    v_cmp_ne_u32 vcc, 0, v52
    s_cbranch_vccz L_rgo_79
    buffer_load_dwordx4 v[32:35], v117, s[8:11], s29 offen sc1
    buffer_load_dwordx4 v[36:39], v117, s[8:11], s53 offen sc1
    buffer_load_dwordx4 v[40:43], v117, s[8:11], s29 offen offset:2048 sc1
    buffer_load_dwordx4 v[44:47], v117, s[8:11], s53 offen offset:2048 sc1
    s_add_u32 s46, s46, 1
    s_branch L_rl_77
L_mret_81:
    s_mov_b32 s43, m0
    s_mov_b32 m0, 7168
    buffer_load_dwordx4 v[4:7], v117, s[8:11], s48 offen sc1
    buffer_load_dwordx4 v117, s[8:11], s48 offen sc1 lds
    s_mov_b32 m0, 14336
    s_mov_b32 m0, s43
    s_waitcnt vmcnt(0)
    v_max3_u32 v15, v4, v5, v6
    v_max_u32 v15, v15, v7
    v_cmp_lt_u32 vcc, s56, v15
    s_add_u32 s47, s47, 1
    s_add_u32 s49, s49, 1
    s_cmp_ge_u32 s49, 0x10000
    s_cbranch_scc1 L_mgo_82
    s_cbranch_vccnz L_mret_81
    s_branch L_mgo_82
L_smax_84:
    s_add_u32 s47, s47, 1
    s_mov_b32 s35, 0x7f800000
    s_waitcnt lgkmcnt(0)
    s_sub_u32 s43, s30, 0x41800
    s_add_u32 s40, s43, 4096
    s_nop 7
    buffer_load_dwordx4 v[56:59], v117, s[8:11], s43 offen
    buffer_load_dwordx4 v[60:63], v117, s[8:11], s43 offen offset:1024
    buffer_load_dwordx4 v[64:67], v117, s[8:11], s43 offen offset:2048
    buffer_load_dwordx4 v[68:71], v117, s[8:11], s43 offen offset:3072
    buffer_load_dwordx4 v[72:75], v117, s[8:11], s40 offen
    buffer_load_dwordx4 v[76:79], v117, s[8:11], s40 offen offset:1024
    buffer_load_dwordx4 v[80:83], v117, s[8:11], s40 offen offset:2048
    buffer_load_dwordx4 v[84:87], v117, s[8:11], s40 offen offset:3072
    ds_read_b128 v[32:35], v121 offset:16384
    ds_read_b128 v[36:39], v121 offset:17408
    ds_read_b128 v[40:43], v121 offset:18432
    ds_read_b128 v[44:47], v121 offset:19456
    v_mov_b32 v96, 0
    v_mov_b32 v97, 0
    v_mov_b32 v98, 0
    v_mov_b32 v99, 0
    v_mov_b32 v100, 0
    v_mov_b32 v101, 0
    v_mov_b32 v102, 0
    v_mov_b32 v103, 0
    v_mov_b32 v104, 0
    v_mov_b32 v105, 0
    v_mov_b32 v106, 0
    v_mov_b32 v107, 0
    v_mov_b32 v108, 0
    v_mov_b32 v109, 0
    v_mov_b32 v110, 0
    v_mov_b32 v111, 0
    s_waitcnt vmcnt(0) lgkmcnt(0)
    v_mfma_f32_16x16x32_bf16 v[56:59], v[56:59], v[32:35], 0
    v_mfma_f32_16x16x32_bf16 v[56:59], v[60:63], v[36:39], v[56:59]
    v_mfma_f32_16x16x32_bf16 v[56:59], v[64:67], v[40:43], v[56:59]
    v_mfma_f32_16x16x32_bf16 v[56:59], v[68:71], v[44:47], v[56:59]
    v_mfma_f32_16x16x32_bf16 v[60:63], v[72:75], v[32:35], 0
    v_mfma_f32_16x16x32_bf16 v[60:63], v[76:79], v[36:39], v[60:63]
    v_mfma_f32_16x16x32_bf16 v[60:63], v[80:83], v[40:43], v[60:63]
    v_mfma_f32_16x16x32_bf16 v[60:63], v[84:87], v[44:47], v[60:63]
    v_mfma_f32_16x16x32_bf16 v[64:67], v[32:35], v[32:35], 0
    v_mfma_f32_16x16x32_bf16 v[64:67], v[36:39], v[36:39], v[64:67]
    v_mfma_f32_16x16x32_bf16 v[64:67], v[40:43], v[40:43], v[64:67]
    v_mfma_f32_16x16x32_bf16 v[64:67], v[44:47], v[44:47], v[64:67]
    v_max3_f32 v84, v56, v57, v58
    v_max3_f32 v84, v84, v59, v60
    v_max3_f32 v84, v84, v61, v62
    s_nop 4
    v_max3_f32 v84, v84, v63, v64
    v_max_f32 v84, v84, v65
    v_mov_b32 v85, v84
    s_nop 1
    v_permlane32_swap_b32 v85, v84
    v_max_f32 v84, v85, v84
    v_mov_b32 v85, v84
    s_nop 1
    v_permlane16_swap_b32 v85, v84
    v_max_f32 v84, v85, v84
    v_sub_f32 v56, v56, v84
    v_sub_f32 v57, v57, v84
    v_sub_f32 v58, v58, v84
    v_sub_f32 v59, v59, v84
    v_sub_f32 v60, v60, v84
    v_sub_f32 v61, v61, v84
    v_sub_f32 v62, v62, v84
    v_sub_f32 v63, v63, v84
    v_sub_f32 v64, v64, v84
    v_sub_f32 v65, v65, v84
    v_exp_f32 v56, v56
    v_exp_f32 v57, v57
    v_exp_f32 v58, v58
    v_exp_f32 v59, v59
    v_exp_f32 v60, v60
    v_exp_f32 v61, v61
    v_exp_f32 v62, v62
    v_exp_f32 v63, v63
    v_exp_f32 v64, v64
    v_exp_f32 v65, v65
    v_cvt_pk_bf16_f32 v68, v56, v57
    v_cvt_pk_bf16_f32 v69, v58, v59
    v_cvt_pk_bf16_f32 v70, v60, v61
    v_cvt_pk_bf16_f32 v71, v62, v63
    v_cvt_pk_bf16_f32 v52, v64, v65
    s_nop 0
    v_mfma_f32_16x16x32_bf16 v[72:75], v[88:91], v[68:71], 0
    v_mfma_f32_16x16x32_bf16 v[76:79], v[92:95], v[68:71], 0
    v_mfma_f32_16x16x32_bf16 v[80:83], v[48:51], v[68:71], 0
    v_mfma_f32_16x16x16_bf16 v[72:75], v[112:113], v[52:53], v[72:75]
    v_mfma_f32_16x16x16_bf16 v[76:79], v[114:115], v[52:53], v[76:79]
    v_mfma_f32_16x16x16_bf16 v[80:83], v[48:49], v[52:53], v[80:83]
    ds_read_b128 v[32:35], v124 offset:6144
    ds_read_b128 v[36:39], v124 offset:7168
    ds_read_b128 v[40:43], v124 offset:34816
    ds_read_b128 v[44:47], v124 offset:35840
    ds_read_b128 v[56:59], v124 offset:36864
    ds_read_b128 v[64:67], v124 offset:38912
    ds_read_b128 v[68:71], v124 offset:39936
    s_waitcnt lgkmcnt(0)
    s_branch L_norm_83
L_rslow_86:
    buffer_load_dwordx4 v[4:7], v117, s[8:11], s29 offen sc1
    buffer_load_dwordx4 v[8:11], v117, s[8:11], s53 offen sc1
    buffer_load_dwordx4 v[16:19], v117, s[8:11], s29 offen offset:2048 sc1
    buffer_load_dwordx4 v[20:23], v117, s[8:11], s53 offen offset:2048 sc1
    s_add_u32 s46, s46, 1
    s_add_u32 s49, s49, 1
    s_cmp_ge_u32 s49, 0x10000
    s_cbranch_scc1 L_rgo_87
    s_waitcnt vmcnt(7)
    v_mfma_f32_16x16x32_bf16 v[48:51], v[32:35], v[12:15], 0
    v_xor_b32 v52, s33, v32
    s_waitcnt vmcnt(6)
    v_mfma_f32_16x16x32_bf16 v[48:51], v[36:39], v[12:15], v[48:51]
    v_xor_b32 v53, s33, v36
    v_or_b32 v52, v52, v53
    s_waitcnt vmcnt(5)
    v_mfma_f32_16x16x32_bf16 v[48:51], v[40:43], v[12:15], v[48:51]
    v_xor_b32 v53, s33, v40
    v_or_b32 v52, v52, v53
    s_waitcnt vmcnt(4)
    v_mfma_f32_16x16x32_bf16 v[48:51], v[44:47], v[12:15], v[48:51]
    v_xor_b32 v53, s33, v44
    v_or_b32 v52, v52, v53
    v_and_b32 v52, 1, v52
    v_cmp_ne_u32 vcc, 0, v52
    s_cbranch_vccz L_rgo_87
    buffer_load_dwordx4 v[32:35], v117, s[8:11], s29 offen sc1
    buffer_load_dwordx4 v[36:39], v117, s[8:11], s53 offen sc1
    buffer_load_dwordx4 v[40:43], v117, s[8:11], s29 offen offset:2048 sc1
    buffer_load_dwordx4 v[44:47], v117, s[8:11], s53 offen offset:2048 sc1
    s_add_u32 s46, s46, 1
    s_branch L_rl_85
L_bulk:
    s_load_dwordx8 s[60:67], s[0:1], 16
    s_load_dwordx2 s[12:13], s[0:1], 0
    s_waitcnt lgkmcnt(0)
    s_branch L_bulk2
.p2align 7
L_other:
    s_sub_u32 s101, s84, 1
    s_lshl_b32 s101, s101, 5
    s_add_u32 s101, s101, s85
    s_cmp_ge_u32 s85, 2
    s_cbranch_scc1 L_nobc
    v_lshlrev_b32 v1, 6, v0
    s_lshl_b32 s96, s85, 14
    s_getpc_b64 s[4:5]
L_pc_88:
    s_add_u32 s4, s4, L_bulk2-L_pc_88
    s_addc_u32 s5, s5, 0
    v_add_u32 v1, s96, v1
    v_min_u32 v1, L_code_end-L_bulk2-4, v1
    global_load_dword v255, v1, s[4:5]
L_nobc:
    s_waitcnt lgkmcnt(0)
    s_and_b32 s9, s9, 0xffff
    s_mov_b32 s10, 0x10000000
    s_mov_b32 s11, 0x20000
    s_and_b32 s93, s93, 0xffff
    s_mov_b32 s94, 0x100
    s_mov_b32 s95, 0x20000
    s_mov_b32 s87, 0
    s_cmp_lg_u32 s86, 0
    s_cbranch_scc1 L_reg_89
    s_lshl_b32 s97, s84, 4
    s_lshl_b32 s96, 1, s85
    v_mov_b32 v250, s96
    v_mov_b32 v251, 256
    s_mov_b64 exec, 1
    buffer_atomic_add_x2 v[250:251], off, s[92:95], s97 offset:64
    s_mov_b64 exec, -1
    s_mov_b32 s86, 1
L_reg_89:
L_bulk2:
    s_add_u32 s88, s101, 32
    s_mov_b32 s41, 0
    s_lshr_b32 s20, s101, 6
    s_and_b32 s22, s101, 63
    s_cmp_ge_u32 s101, 192
    s_cselect_b32 s37, 32, 1000
L_p1go:
    s_mov_b32 s40, 0
    s_mov_b32 s80, 0
    s_mov_b32 s23, 0
L_p1_pass:
    v_mbcnt_lo_u32_b32 v0, -1, 0
    v_mbcnt_hi_u32_b32 v0, -1, v0
    s_lshl_b32 s96, s100, 6
    v_add_u32 v0, s96, v0
    s_and_b32 s13, s13, 0xffff
    s_mov_b32 s14, 0x200000
    s_mov_b32 s15, 0x20000
    v_lshrrev_b32 v147, 6, v0
    s_nop 0
    v_readfirstlane_b32 s21, v147
    v_and_b32 v144, 63, v0
    v_lshrrev_b32 v145, 4, v144
    v_and_b32 v146, 15, v144
    v_lshrrev_b32 v149, 2, v146
    v_lshlrev_b32 v137, 4, v144
    s_lshl_b32 s29, s21, 10
    s_lshl_b32 s26, s20, 7
    s_lshl_b32 s27, s21, 5
    s_add_u32 s26, s26, s27
    v_add_u32 v147, s26, v146
    v_lshlrev_b32 v147, 10, v147
    v_lshl_add_u32 v139, v145, 4, v147
    s_mov_b32 s26, 0x0
    buffer_load_dwordx4 v[0:3], v139, s[12:15], s26 offen
    buffer_load_dwordx4 v[4:7], v139, s[12:15], s26 offen offset:64
    buffer_load_dwordx4 v[8:11], v139, s[12:15], s26 offen offset:128
    buffer_load_dwordx4 v[12:15], v139, s[12:15], s26 offen offset:192
    buffer_load_dwordx4 v[16:19], v139, s[12:15], s26 offen offset:256
    buffer_load_dwordx4 v[20:23], v139, s[12:15], s26 offen offset:320
    buffer_load_dwordx4 v[24:27], v139, s[12:15], s26 offen offset:384
    buffer_load_dwordx4 v[28:31], v139, s[12:15], s26 offen offset:448
    buffer_load_dwordx4 v[32:35], v139, s[12:15], s26 offen offset:512
    buffer_load_dwordx4 v[36:39], v139, s[12:15], s26 offen offset:576
    buffer_load_dwordx4 v[40:43], v139, s[12:15], s26 offen offset:640
    buffer_load_dwordx4 v[44:47], v139, s[12:15], s26 offen offset:704
    buffer_load_dwordx4 v[48:51], v139, s[12:15], s26 offen offset:768
    buffer_load_dwordx4 v[52:55], v139, s[12:15], s26 offen offset:832
    buffer_load_dwordx4 v[56:59], v139, s[12:15], s26 offen offset:896
    buffer_load_dwordx4 v[60:63], v139, s[12:15], s26 offen offset:960
    s_mov_b32 s26, 0x4000
    buffer_load_dwordx4 v[64:67], v139, s[12:15], s26 offen
    buffer_load_dwordx4 v[68:71], v139, s[12:15], s26 offen offset:64
    buffer_load_dwordx4 v[72:75], v139, s[12:15], s26 offen offset:128
    buffer_load_dwordx4 v[76:79], v139, s[12:15], s26 offen offset:192
    buffer_load_dwordx4 v[80:83], v139, s[12:15], s26 offen offset:256
    buffer_load_dwordx4 v[84:87], v139, s[12:15], s26 offen offset:320
    buffer_load_dwordx4 v[88:91], v139, s[12:15], s26 offen offset:384
    buffer_load_dwordx4 v[92:95], v139, s[12:15], s26 offen offset:448
    buffer_load_dwordx4 v[96:99], v139, s[12:15], s26 offen offset:512
    buffer_load_dwordx4 v[100:103], v139, s[12:15], s26 offen offset:576
    buffer_load_dwordx4 v[104:107], v139, s[12:15], s26 offen offset:640
    buffer_load_dwordx4 v[108:111], v139, s[12:15], s26 offen offset:704
    buffer_load_dwordx4 v[112:115], v139, s[12:15], s26 offen offset:768
    buffer_load_dwordx4 v[116:119], v139, s[12:15], s26 offen offset:832
    buffer_load_dwordx4 v[120:123], v139, s[12:15], s26 offen offset:896
    buffer_load_dwordx4 v[124:127], v139, s[12:15], s26 offen offset:960
    s_lshr_b32 s26, s21, 1
    s_lshl_b32 s26, s26, 2
    v_or_b32 v148, s26, v145
    v_lshlrev_b32 v148, 1, v148
    v_xor_b32 v148, v148, v146
    v_lshlrev_b32 v148, 4, v148
    s_lshl_b32 s26, s21, 2
    v_add_u32 v147, s26, v145
    v_lshl_add_u32 v136, v147, 13, v148
    v_lshl_add_u32 v147, v145, 3, v149
    v_lshlrev_b32 v147, 8, v147
    v_and_b32 v148, 1, v145
    v_lshl_or_b32 v148, v148, 2, v149
    v_lshl_add_u32 v147, v148, 5, v147
    v_and_b32 v148, 3, v146
    v_lshl_add_u32 v128, v148, 3, v147
    v_xor_b32 v129, 32, v128
    v_xor_b32 v130, 64, v128
    v_xor_b32 v131, 96, v128
    v_xor_b32 v132, 128, v128
    v_xor_b32 v133, 160, v128
    v_xor_b32 v134, 192, v128
    v_xor_b32 v135, 224, v128
    s_mov_b32 s19, 0x20000
    s_mov_b32 s38, s22
    s_mov_b32 s39, s22
    v_mov_b32 v158, 0x3f803f80
    s_lshr_b32 s26, s39, 5
    s_cmp_eq_u32 s26, 0
    s_cselect_b64 s[16:17], s[62:63], s[60:61]
    s_cmp_eq_u32 s26, 1
    s_cselect_b64 s[16:17], s[64:65], s[16:17]
    s_and_b32 s17, s17, 0xffff
    s_cmp_lt_u32 s39, 96
    s_cselect_b32 s18, 0x400000, 0
    s_and_b32 s24, s39, 31
    s_lshl_b32 s24, s24, 8
    s_waitcnt vmcnt(16)
    v_pk_mov_b32 v[150:151], 0, 0
    v_pk_mov_b32 v[152:153], 0, 0
    v_dot2_f32_bf16 v150, v0, v158, v150
    v_dot2_f32_bf16 v152, v0, v0, v152
    v_dot2_f32_bf16 v151, v1, v158, v151
    v_dot2_f32_bf16 v153, v1, v1, v153
    v_dot2_f32_bf16 v150, v2, v158, v150
    v_dot2_f32_bf16 v152, v2, v2, v152
    v_dot2_f32_bf16 v151, v3, v158, v151
    v_dot2_f32_bf16 v153, v3, v3, v153
    v_dot2_f32_bf16 v150, v4, v158, v150
    v_dot2_f32_bf16 v152, v4, v4, v152
    v_dot2_f32_bf16 v151, v5, v158, v151
    v_dot2_f32_bf16 v153, v5, v5, v153
    v_dot2_f32_bf16 v150, v6, v158, v150
    v_dot2_f32_bf16 v152, v6, v6, v152
    v_dot2_f32_bf16 v151, v7, v158, v151
    v_dot2_f32_bf16 v153, v7, v7, v153
    v_dot2_f32_bf16 v150, v8, v158, v150
    v_dot2_f32_bf16 v152, v8, v8, v152
    v_dot2_f32_bf16 v151, v9, v158, v151
    v_dot2_f32_bf16 v153, v9, v9, v153
    v_dot2_f32_bf16 v150, v10, v158, v150
    v_dot2_f32_bf16 v152, v10, v10, v152
    v_dot2_f32_bf16 v151, v11, v158, v151
    v_dot2_f32_bf16 v153, v11, v11, v153
    v_dot2_f32_bf16 v150, v12, v158, v150
    v_dot2_f32_bf16 v152, v12, v12, v152
    v_dot2_f32_bf16 v151, v13, v158, v151
    v_dot2_f32_bf16 v153, v13, v13, v153
    v_dot2_f32_bf16 v150, v14, v158, v150
    v_dot2_f32_bf16 v152, v14, v14, v152
    v_dot2_f32_bf16 v151, v15, v158, v151
    v_dot2_f32_bf16 v153, v15, v15, v153
    v_dot2_f32_bf16 v150, v16, v158, v150
    v_dot2_f32_bf16 v152, v16, v16, v152
    v_dot2_f32_bf16 v151, v17, v158, v151
    v_dot2_f32_bf16 v153, v17, v17, v153
    v_dot2_f32_bf16 v150, v18, v158, v150
    v_dot2_f32_bf16 v152, v18, v18, v152
    v_dot2_f32_bf16 v151, v19, v158, v151
    v_dot2_f32_bf16 v153, v19, v19, v153
    v_dot2_f32_bf16 v150, v20, v158, v150
    v_dot2_f32_bf16 v152, v20, v20, v152
    v_dot2_f32_bf16 v151, v21, v158, v151
    v_dot2_f32_bf16 v153, v21, v21, v153
    v_dot2_f32_bf16 v150, v22, v158, v150
    v_dot2_f32_bf16 v152, v22, v22, v152
    v_dot2_f32_bf16 v151, v23, v158, v151
    v_dot2_f32_bf16 v153, v23, v23, v153
    v_dot2_f32_bf16 v150, v24, v158, v150
    v_dot2_f32_bf16 v152, v24, v24, v152
    v_dot2_f32_bf16 v151, v25, v158, v151
    v_dot2_f32_bf16 v153, v25, v25, v153
    v_dot2_f32_bf16 v150, v26, v158, v150
    v_dot2_f32_bf16 v152, v26, v26, v152
    v_dot2_f32_bf16 v151, v27, v158, v151
    v_dot2_f32_bf16 v153, v27, v27, v153
    v_dot2_f32_bf16 v150, v28, v158, v150
    v_dot2_f32_bf16 v152, v28, v28, v152
    v_dot2_f32_bf16 v151, v29, v158, v151
    v_dot2_f32_bf16 v153, v29, v29, v153
    v_dot2_f32_bf16 v150, v30, v158, v150
    v_dot2_f32_bf16 v152, v30, v30, v152
    v_dot2_f32_bf16 v151, v31, v158, v151
    v_dot2_f32_bf16 v153, v31, v31, v153
    v_dot2_f32_bf16 v150, v32, v158, v150
    v_dot2_f32_bf16 v152, v32, v32, v152
    v_dot2_f32_bf16 v151, v33, v158, v151
    v_dot2_f32_bf16 v153, v33, v33, v153
    v_dot2_f32_bf16 v150, v34, v158, v150
    v_dot2_f32_bf16 v152, v34, v34, v152
    v_dot2_f32_bf16 v151, v35, v158, v151
    v_dot2_f32_bf16 v153, v35, v35, v153
    v_dot2_f32_bf16 v150, v36, v158, v150
    v_dot2_f32_bf16 v152, v36, v36, v152
    v_dot2_f32_bf16 v151, v37, v158, v151
    v_dot2_f32_bf16 v153, v37, v37, v153
    v_dot2_f32_bf16 v150, v38, v158, v150
    v_dot2_f32_bf16 v152, v38, v38, v152
    v_dot2_f32_bf16 v151, v39, v158, v151
    v_dot2_f32_bf16 v153, v39, v39, v153
    v_dot2_f32_bf16 v150, v40, v158, v150
    v_dot2_f32_bf16 v152, v40, v40, v152
    v_dot2_f32_bf16 v151, v41, v158, v151
    v_dot2_f32_bf16 v153, v41, v41, v153
    v_dot2_f32_bf16 v150, v42, v158, v150
    v_dot2_f32_bf16 v152, v42, v42, v152
    v_dot2_f32_bf16 v151, v43, v158, v151
    v_dot2_f32_bf16 v153, v43, v43, v153
    v_dot2_f32_bf16 v150, v44, v158, v150
    v_dot2_f32_bf16 v152, v44, v44, v152
    v_dot2_f32_bf16 v151, v45, v158, v151
    v_dot2_f32_bf16 v153, v45, v45, v153
    v_dot2_f32_bf16 v150, v46, v158, v150
    v_dot2_f32_bf16 v152, v46, v46, v152
    v_dot2_f32_bf16 v151, v47, v158, v151
    v_dot2_f32_bf16 v153, v47, v47, v153
    v_dot2_f32_bf16 v150, v48, v158, v150
    v_dot2_f32_bf16 v152, v48, v48, v152
    v_dot2_f32_bf16 v151, v49, v158, v151
    v_dot2_f32_bf16 v153, v49, v49, v153
    s_add_u32 s26, s24, 0x0
    s_add_u32 m0, s29, 0x0
    s_nop 0
    buffer_load_dwordx4 v136, s[16:19], s26 offen lds
    v_dot2_f32_bf16 v150, v50, v158, v150
    v_dot2_f32_bf16 v152, v50, v50, v152
    v_dot2_f32_bf16 v151, v51, v158, v151
    v_dot2_f32_bf16 v153, v51, v51, v153
    v_dot2_f32_bf16 v150, v52, v158, v150
    v_dot2_f32_bf16 v152, v52, v52, v152
    v_dot2_f32_bf16 v151, v53, v158, v151
    v_dot2_f32_bf16 v153, v53, v53, v153
    v_dot2_f32_bf16 v150, v54, v158, v150
    v_dot2_f32_bf16 v152, v54, v54, v152
    v_dot2_f32_bf16 v151, v55, v158, v151
    v_dot2_f32_bf16 v153, v55, v55, v153
    v_dot2_f32_bf16 v150, v56, v158, v150
    v_dot2_f32_bf16 v152, v56, v56, v152
    v_dot2_f32_bf16 v151, v57, v158, v151
    v_dot2_f32_bf16 v153, v57, v57, v153
    v_dot2_f32_bf16 v150, v58, v158, v150
    v_dot2_f32_bf16 v152, v58, v58, v152
    v_dot2_f32_bf16 v151, v59, v158, v151
    v_dot2_f32_bf16 v153, v59, v59, v153
    v_dot2_f32_bf16 v150, v60, v158, v150
    v_dot2_f32_bf16 v152, v60, v60, v152
    v_dot2_f32_bf16 v151, v61, v158, v151
    v_dot2_f32_bf16 v153, v61, v61, v153
    v_dot2_f32_bf16 v150, v62, v158, v150
    v_dot2_f32_bf16 v152, v62, v62, v152
    v_dot2_f32_bf16 v151, v63, v158, v151
    v_dot2_f32_bf16 v153, v63, v63, v153
    s_nop 1
    v_add_f32 v150, v150, v151
    v_add_f32 v152, v152, v153
    v_mov_b32 v157, v150
    s_nop 1
    v_permlane32_swap_b32 v157, v150
    v_add_f32 v150, v157, v150
    v_mov_b32 v157, v150
    s_nop 1
    v_permlane16_swap_b32 v157, v150
    v_add_f32 v150, v157, v150
    v_mov_b32 v157, v152
    s_nop 1
    v_permlane32_swap_b32 v157, v152
    v_add_f32 v152, v157, v152
    v_mov_b32 v157, v152
    s_nop 1
    v_permlane16_swap_b32 v157, v152
    v_add_f32 v152, v157, v152
    v_mul_f32 v150, 0x3b000000, v150
    v_cvt_pk_bf16_f32 v154, v150, v150
    v_and_b32 v154, 0xffff0000, v154
    v_sub_f32 v156, v150, v154
    v_mul_f32 v157, v150, v150
    v_mul_f32 v152, 0x3b000000, v152
    v_sub_f32 v152, v152, v157
    v_max_f32 v152, 0, v152
    v_cvt_pk_bf16_f32 v152, v152, v152
    v_and_b32 v152, 0xffff0000, v152
    v_add_f32 v152, 0x3727c5ac, v152
    v_cvt_pk_bf16_f32 v152, v152, v152
    v_and_b32 v152, 0xffff0000, v152
    v_sqrt_f32 v152, v152
    s_nop 0
    v_cvt_pk_bf16_f32 v152, v152, v152
    v_and_b32 v152, 0xffff0000, v152
    v_rcp_f32 v152, v152
    v_lshlrev_b32 v160, 16, v0
    v_and_b32 v161, 0xffff0000, v0
    v_lshlrev_b32 v162, 16, v1
    v_and_b32 v163, 0xffff0000, v1
    v_lshlrev_b32 v164, 16, v2
    v_and_b32 v165, 0xffff0000, v2
    v_lshlrev_b32 v166, 16, v3
    v_and_b32 v167, 0xffff0000, v3
    v_lshlrev_b32 v168, 16, v4
    v_and_b32 v169, 0xffff0000, v4
    v_lshlrev_b32 v170, 16, v5
    v_and_b32 v171, 0xffff0000, v5
    v_lshlrev_b32 v172, 16, v6
    v_and_b32 v173, 0xffff0000, v6
    v_lshlrev_b32 v174, 16, v7
    v_and_b32 v175, 0xffff0000, v7
    v_pk_add_f32 v[160:161], v[160:161], v[154:155] op_sel_hi:[1,0] neg_lo:[0,1] neg_hi:[0,1]
    v_pk_add_f32 v[162:163], v[162:163], v[154:155] op_sel_hi:[1,0] neg_lo:[0,1] neg_hi:[0,1]
    v_pk_add_f32 v[164:165], v[164:165], v[154:155] op_sel_hi:[1,0] neg_lo:[0,1] neg_hi:[0,1]
    v_pk_add_f32 v[166:167], v[166:167], v[154:155] op_sel_hi:[1,0] neg_lo:[0,1] neg_hi:[0,1]
    v_pk_add_f32 v[168:169], v[168:169], v[154:155] op_sel_hi:[1,0] neg_lo:[0,1] neg_hi:[0,1]
    v_pk_add_f32 v[170:171], v[170:171], v[154:155] op_sel_hi:[1,0] neg_lo:[0,1] neg_hi:[0,1]
    s_add_u32 s26, s24, 0x20000
    s_add_u32 m0, s29, 0x1000
    s_nop 0
    buffer_load_dwordx4 v136, s[16:19], s26 offen lds
    v_pk_add_f32 v[172:173], v[172:173], v[154:155] op_sel_hi:[1,0] neg_lo:[0,1] neg_hi:[0,1]
    v_pk_add_f32 v[174:175], v[174:175], v[154:155] op_sel_hi:[1,0] neg_lo:[0,1] neg_hi:[0,1]
    v_cvt_pk_bf16_f32 v0, v160, v161
    v_cvt_pk_bf16_f32 v1, v162, v163
    v_cvt_pk_bf16_f32 v2, v164, v165
    v_cvt_pk_bf16_f32 v3, v166, v167
    v_cvt_pk_bf16_f32 v4, v168, v169
    v_cvt_pk_bf16_f32 v5, v170, v171
    v_cvt_pk_bf16_f32 v6, v172, v173
    v_cvt_pk_bf16_f32 v7, v174, v175
    v_lshlrev_b32 v160, 16, v0
    v_and_b32 v161, 0xffff0000, v0
    v_lshlrev_b32 v162, 16, v1
    v_and_b32 v163, 0xffff0000, v1
    v_lshlrev_b32 v164, 16, v2
    v_and_b32 v165, 0xffff0000, v2
    v_lshlrev_b32 v166, 16, v3
    v_and_b32 v167, 0xffff0000, v3
    v_lshlrev_b32 v168, 16, v4
    v_and_b32 v169, 0xffff0000, v4
    v_lshlrev_b32 v170, 16, v5
    v_and_b32 v171, 0xffff0000, v5
    v_lshlrev_b32 v172, 16, v6
    v_and_b32 v173, 0xffff0000, v6
    v_lshlrev_b32 v174, 16, v7
    v_and_b32 v175, 0xffff0000, v7
    v_pk_mul_f32 v[160:161], v[160:161], v[152:153] op_sel_hi:[1,0]
    v_pk_mul_f32 v[162:163], v[162:163], v[152:153] op_sel_hi:[1,0]
    v_pk_mul_f32 v[164:165], v[164:165], v[152:153] op_sel_hi:[1,0]
    v_pk_mul_f32 v[166:167], v[166:167], v[152:153] op_sel_hi:[1,0]
    v_pk_mul_f32 v[168:169], v[168:169], v[152:153] op_sel_hi:[1,0]
    v_pk_mul_f32 v[170:171], v[170:171], v[152:153] op_sel_hi:[1,0]
    v_pk_mul_f32 v[172:173], v[172:173], v[152:153] op_sel_hi:[1,0]
    v_pk_mul_f32 v[174:175], v[174:175], v[152:153] op_sel_hi:[1,0]
    v_cvt_pk_bf16_f32 v160, v160, v161
    v_cvt_pk_bf16_f32 v162, v162, v163
    v_cvt_pk_bf16_f32 v164, v164, v165
    v_cvt_pk_bf16_f32 v166, v166, v167
    v_cvt_pk_bf16_f32 v168, v168, v169
    v_cvt_pk_bf16_f32 v170, v170, v171
    v_cvt_pk_bf16_f32 v172, v172, v173
    v_cvt_pk_bf16_f32 v174, v174, v175
    v_accvgpr_write_b32 a0, v160
    v_accvgpr_write_b32 a1, v162
    v_accvgpr_write_b32 a2, v164
    v_accvgpr_write_b32 a3, v166
    v_accvgpr_write_b32 a4, v168
    v_accvgpr_write_b32 a5, v170
    v_accvgpr_write_b32 a6, v172
    v_accvgpr_write_b32 a7, v174
    s_add_u32 s26, s24, 0x40000
    s_add_u32 m0, s29, 0x2000
    s_nop 0
    buffer_load_dwordx4 v136, s[16:19], s26 offen lds
    v_lshlrev_b32 v160, 16, v8
    v_and_b32 v161, 0xffff0000, v8
    v_lshlrev_b32 v162, 16, v9
    v_and_b32 v163, 0xffff0000, v9
    v_lshlrev_b32 v164, 16, v10
    v_and_b32 v165, 0xffff0000, v10
    v_lshlrev_b32 v166, 16, v11
    v_and_b32 v167, 0xffff0000, v11
    v_lshlrev_b32 v168, 16, v12
    v_and_b32 v169, 0xffff0000, v12
    v_lshlrev_b32 v170, 16, v13
    v_and_b32 v171, 0xffff0000, v13
    v_lshlrev_b32 v172, 16, v14
    v_and_b32 v173, 0xffff0000, v14
    v_lshlrev_b32 v174, 16, v15
    v_and_b32 v175, 0xffff0000, v15
    v_pk_add_f32 v[160:161], v[160:161], v[154:155] op_sel_hi:[1,0] neg_lo:[0,1] neg_hi:[0,1]
    v_pk_add_f32 v[162:163], v[162:163], v[154:155] op_sel_hi:[1,0] neg_lo:[0,1] neg_hi:[0,1]
    v_pk_add_f32 v[164:165], v[164:165], v[154:155] op_sel_hi:[1,0] neg_lo:[0,1] neg_hi:[0,1]
    v_pk_add_f32 v[166:167], v[166:167], v[154:155] op_sel_hi:[1,0] neg_lo:[0,1] neg_hi:[0,1]
    v_pk_add_f32 v[168:169], v[168:169], v[154:155] op_sel_hi:[1,0] neg_lo:[0,1] neg_hi:[0,1]
    v_pk_add_f32 v[170:171], v[170:171], v[154:155] op_sel_hi:[1,0] neg_lo:[0,1] neg_hi:[0,1]
    v_pk_add_f32 v[172:173], v[172:173], v[154:155] op_sel_hi:[1,0] neg_lo:[0,1] neg_hi:[0,1]
    v_pk_add_f32 v[174:175], v[174:175], v[154:155] op_sel_hi:[1,0] neg_lo:[0,1] neg_hi:[0,1]
    v_cvt_pk_bf16_f32 v8, v160, v161
    v_cvt_pk_bf16_f32 v9, v162, v163
    v_cvt_pk_bf16_f32 v10, v164, v165
    v_cvt_pk_bf16_f32 v11, v166, v167
    v_cvt_pk_bf16_f32 v12, v168, v169
    v_cvt_pk_bf16_f32 v13, v170, v171
    v_cvt_pk_bf16_f32 v14, v172, v173
    v_cvt_pk_bf16_f32 v15, v174, v175
    v_lshlrev_b32 v160, 16, v8
    v_and_b32 v161, 0xffff0000, v8
    v_lshlrev_b32 v162, 16, v9
    v_and_b32 v163, 0xffff0000, v9
    v_lshlrev_b32 v164, 16, v10
    v_and_b32 v165, 0xffff0000, v10
    v_lshlrev_b32 v166, 16, v11
    v_and_b32 v167, 0xffff0000, v11
    v_lshlrev_b32 v168, 16, v12
    v_and_b32 v169, 0xffff0000, v12
    v_lshlrev_b32 v170, 16, v13
    v_and_b32 v171, 0xffff0000, v13
    v_lshlrev_b32 v172, 16, v14
    v_and_b32 v173, 0xffff0000, v14
    v_lshlrev_b32 v174, 16, v15
    v_and_b32 v175, 0xffff0000, v15
    v_pk_mul_f32 v[160:161], v[160:161], v[152:153] op_sel_hi:[1,0]
    v_pk_mul_f32 v[162:163], v[162:163], v[152:153] op_sel_hi:[1,0]
    s_add_u32 s26, s24, 0x60000
    s_add_u32 m0, s29, 0x3000
    s_nop 0
    buffer_load_dwordx4 v136, s[16:19], s26 offen lds
    v_pk_mul_f32 v[164:165], v[164:165], v[152:153] op_sel_hi:[1,0]
    v_pk_mul_f32 v[166:167], v[166:167], v[152:153] op_sel_hi:[1,0]
    v_pk_mul_f32 v[168:169], v[168:169], v[152:153] op_sel_hi:[1,0]
    v_pk_mul_f32 v[170:171], v[170:171], v[152:153] op_sel_hi:[1,0]
    v_pk_mul_f32 v[172:173], v[172:173], v[152:153] op_sel_hi:[1,0]
    v_pk_mul_f32 v[174:175], v[174:175], v[152:153] op_sel_hi:[1,0]
    v_cvt_pk_bf16_f32 v160, v160, v161
    v_cvt_pk_bf16_f32 v162, v162, v163
    v_cvt_pk_bf16_f32 v164, v164, v165
    v_cvt_pk_bf16_f32 v166, v166, v167
    v_cvt_pk_bf16_f32 v168, v168, v169
    v_cvt_pk_bf16_f32 v170, v170, v171
    v_cvt_pk_bf16_f32 v172, v172, v173
    v_cvt_pk_bf16_f32 v174, v174, v175
    v_accvgpr_write_b32 a8, v160
    v_accvgpr_write_b32 a9, v162
    v_accvgpr_write_b32 a10, v164
    v_accvgpr_write_b32 a11, v166
    v_accvgpr_write_b32 a12, v168
    v_accvgpr_write_b32 a13, v170
    v_accvgpr_write_b32 a14, v172
    v_accvgpr_write_b32 a15, v174
    v_lshlrev_b32 v160, 16, v16
    v_and_b32 v161, 0xffff0000, v16
    v_lshlrev_b32 v162, 16, v17
    v_and_b32 v163, 0xffff0000, v17
    v_lshlrev_b32 v164, 16, v18
    v_and_b32 v165, 0xffff0000, v18
    v_lshlrev_b32 v166, 16, v19
    v_and_b32 v167, 0xffff0000, v19
    v_lshlrev_b32 v168, 16, v20
    v_and_b32 v169, 0xffff0000, v20
    v_lshlrev_b32 v170, 16, v21
    v_and_b32 v171, 0xffff0000, v21
    v_lshlrev_b32 v172, 16, v22
    v_and_b32 v173, 0xffff0000, v22
    v_lshlrev_b32 v174, 16, v23
    v_and_b32 v175, 0xffff0000, v23
    v_pk_add_f32 v[160:161], v[160:161], v[154:155] op_sel_hi:[1,0] neg_lo:[0,1] neg_hi:[0,1]
    v_pk_add_f32 v[162:163], v[162:163], v[154:155] op_sel_hi:[1,0] neg_lo:[0,1] neg_hi:[0,1]
    v_pk_add_f32 v[164:165], v[164:165], v[154:155] op_sel_hi:[1,0] neg_lo:[0,1] neg_hi:[0,1]
    v_pk_add_f32 v[166:167], v[166:167], v[154:155] op_sel_hi:[1,0] neg_lo:[0,1] neg_hi:[0,1]
    v_pk_add_f32 v[168:169], v[168:169], v[154:155] op_sel_hi:[1,0] neg_lo:[0,1] neg_hi:[0,1]
    v_pk_add_f32 v[170:171], v[170:171], v[154:155] op_sel_hi:[1,0] neg_lo:[0,1] neg_hi:[0,1]
    v_pk_add_f32 v[172:173], v[172:173], v[154:155] op_sel_hi:[1,0] neg_lo:[0,1] neg_hi:[0,1]
    v_pk_add_f32 v[174:175], v[174:175], v[154:155] op_sel_hi:[1,0] neg_lo:[0,1] neg_hi:[0,1]
    v_cvt_pk_bf16_f32 v16, v160, v161
    v_cvt_pk_bf16_f32 v17, v162, v163
    v_cvt_pk_bf16_f32 v18, v164, v165
    v_cvt_pk_bf16_f32 v19, v166, v167
    s_add_u32 s26, s24, 0x80000
    s_add_u32 m0, s29, 0x4000
    s_nop 0
    buffer_load_dwordx4 v136, s[16:19], s26 offen lds
    v_cvt_pk_bf16_f32 v20, v168, v169
    v_cvt_pk_bf16_f32 v21, v170, v171
    v_cvt_pk_bf16_f32 v22, v172, v173
    v_cvt_pk_bf16_f32 v23, v174, v175
    v_lshlrev_b32 v160, 16, v16
    v_and_b32 v161, 0xffff0000, v16
    v_lshlrev_b32 v162, 16, v17
    v_and_b32 v163, 0xffff0000, v17
    v_lshlrev_b32 v164, 16, v18
    v_and_b32 v165, 0xffff0000, v18
    v_lshlrev_b32 v166, 16, v19
    v_and_b32 v167, 0xffff0000, v19
    v_lshlrev_b32 v168, 16, v20
    v_and_b32 v169, 0xffff0000, v20
    v_lshlrev_b32 v170, 16, v21
    v_and_b32 v171, 0xffff0000, v21
    v_lshlrev_b32 v172, 16, v22
    v_and_b32 v173, 0xffff0000, v22
    v_lshlrev_b32 v174, 16, v23
    v_and_b32 v175, 0xffff0000, v23
    v_pk_mul_f32 v[160:161], v[160:161], v[152:153] op_sel_hi:[1,0]
    v_pk_mul_f32 v[162:163], v[162:163], v[152:153] op_sel_hi:[1,0]
    v_pk_mul_f32 v[164:165], v[164:165], v[152:153] op_sel_hi:[1,0]
    v_pk_mul_f32 v[166:167], v[166:167], v[152:153] op_sel_hi:[1,0]
    v_pk_mul_f32 v[168:169], v[168:169], v[152:153] op_sel_hi:[1,0]
    v_pk_mul_f32 v[170:171], v[170:171], v[152:153] op_sel_hi:[1,0]
    v_pk_mul_f32 v[172:173], v[172:173], v[152:153] op_sel_hi:[1,0]
    v_pk_mul_f32 v[174:175], v[174:175], v[152:153] op_sel_hi:[1,0]
    v_cvt_pk_bf16_f32 v160, v160, v161
    v_cvt_pk_bf16_f32 v162, v162, v163
    v_cvt_pk_bf16_f32 v164, v164, v165
    v_cvt_pk_bf16_f32 v166, v166, v167
    v_cvt_pk_bf16_f32 v168, v168, v169
    v_cvt_pk_bf16_f32 v170, v170, v171
    v_cvt_pk_bf16_f32 v172, v172, v173
    v_cvt_pk_bf16_f32 v174, v174, v175
    v_accvgpr_write_b32 a16, v160
    v_accvgpr_write_b32 a17, v162
    v_accvgpr_write_b32 a18, v164
    v_accvgpr_write_b32 a19, v166
    v_accvgpr_write_b32 a20, v168
    v_accvgpr_write_b32 a21, v170
    v_accvgpr_write_b32 a22, v172
    v_accvgpr_write_b32 a23, v174
    v_lshlrev_b32 v160, 16, v24
    v_and_b32 v161, 0xffff0000, v24
    v_lshlrev_b32 v162, 16, v25
    v_and_b32 v163, 0xffff0000, v25
    v_lshlrev_b32 v164, 16, v26
    v_and_b32 v165, 0xffff0000, v26
    s_add_u32 s26, s24, 0xa0000
    s_add_u32 m0, s29, 0x5000
    s_nop 0
    buffer_load_dwordx4 v136, s[16:19], s26 offen lds
    v_lshlrev_b32 v166, 16, v27
    v_and_b32 v167, 0xffff0000, v27
    v_lshlrev_b32 v168, 16, v28
    v_and_b32 v169, 0xffff0000, v28
    v_lshlrev_b32 v170, 16, v29
    v_and_b32 v171, 0xffff0000, v29
    v_lshlrev_b32 v172, 16, v30
    v_and_b32 v173, 0xffff0000, v30
    v_lshlrev_b32 v174, 16, v31
    v_and_b32 v175, 0xffff0000, v31
    v_pk_add_f32 v[160:161], v[160:161], v[154:155] op_sel_hi:[1,0] neg_lo:[0,1] neg_hi:[0,1]
    v_pk_add_f32 v[162:163], v[162:163], v[154:155] op_sel_hi:[1,0] neg_lo:[0,1] neg_hi:[0,1]
    v_pk_add_f32 v[164:165], v[164:165], v[154:155] op_sel_hi:[1,0] neg_lo:[0,1] neg_hi:[0,1]
    v_pk_add_f32 v[166:167], v[166:167], v[154:155] op_sel_hi:[1,0] neg_lo:[0,1] neg_hi:[0,1]
    v_pk_add_f32 v[168:169], v[168:169], v[154:155] op_sel_hi:[1,0] neg_lo:[0,1] neg_hi:[0,1]
    v_pk_add_f32 v[170:171], v[170:171], v[154:155] op_sel_hi:[1,0] neg_lo:[0,1] neg_hi:[0,1]
    v_pk_add_f32 v[172:173], v[172:173], v[154:155] op_sel_hi:[1,0] neg_lo:[0,1] neg_hi:[0,1]
    v_pk_add_f32 v[174:175], v[174:175], v[154:155] op_sel_hi:[1,0] neg_lo:[0,1] neg_hi:[0,1]
    v_cvt_pk_bf16_f32 v24, v160, v161
    v_cvt_pk_bf16_f32 v25, v162, v163
    v_cvt_pk_bf16_f32 v26, v164, v165
    v_cvt_pk_bf16_f32 v27, v166, v167
    v_cvt_pk_bf16_f32 v28, v168, v169
    v_cvt_pk_bf16_f32 v29, v170, v171
    v_cvt_pk_bf16_f32 v30, v172, v173
    v_cvt_pk_bf16_f32 v31, v174, v175
    v_lshlrev_b32 v160, 16, v24
    v_and_b32 v161, 0xffff0000, v24
    v_lshlrev_b32 v162, 16, v25
    v_and_b32 v163, 0xffff0000, v25
    v_lshlrev_b32 v164, 16, v26
    v_and_b32 v165, 0xffff0000, v26
    v_lshlrev_b32 v166, 16, v27
    v_and_b32 v167, 0xffff0000, v27
    v_lshlrev_b32 v168, 16, v28
    v_and_b32 v169, 0xffff0000, v28
    v_lshlrev_b32 v170, 16, v29
    v_and_b32 v171, 0xffff0000, v29
    v_lshlrev_b32 v172, 16, v30
    v_and_b32 v173, 0xffff0000, v30
    v_lshlrev_b32 v174, 16, v31
    v_and_b32 v175, 0xffff0000, v31
    v_pk_mul_f32 v[160:161], v[160:161], v[152:153] op_sel_hi:[1,0]
    v_pk_mul_f32 v[162:163], v[162:163], v[152:153] op_sel_hi:[1,0]
    v_pk_mul_f32 v[164:165], v[164:165], v[152:153] op_sel_hi:[1,0]
    v_pk_mul_f32 v[166:167], v[166:167], v[152:153] op_sel_hi:[1,0]
    v_pk_mul_f32 v[168:169], v[168:169], v[152:153] op_sel_hi:[1,0]
    v_pk_mul_f32 v[170:171], v[170:171], v[152:153] op_sel_hi:[1,0]
    v_pk_mul_f32 v[172:173], v[172:173], v[152:153] op_sel_hi:[1,0]
    v_pk_mul_f32 v[174:175], v[174:175], v[152:153] op_sel_hi:[1,0]
    s_add_u32 s26, s24, 0xc0000
    s_add_u32 m0, s29, 0x6000
    s_nop 0
    buffer_load_dwordx4 v136, s[16:19], s26 offen lds
    v_cvt_pk_bf16_f32 v160, v160, v161
    v_cvt_pk_bf16_f32 v162, v162, v163
    v_cvt_pk_bf16_f32 v164, v164, v165
    v_cvt_pk_bf16_f32 v166, v166, v167
    v_cvt_pk_bf16_f32 v168, v168, v169
    v_cvt_pk_bf16_f32 v170, v170, v171
    v_cvt_pk_bf16_f32 v172, v172, v173
    v_cvt_pk_bf16_f32 v174, v174, v175
    v_accvgpr_write_b32 a24, v160
    v_accvgpr_write_b32 a25, v162
    v_accvgpr_write_b32 a26, v164
    v_accvgpr_write_b32 a27, v166
    v_accvgpr_write_b32 a28, v168
    v_accvgpr_write_b32 a29, v170
    v_accvgpr_write_b32 a30, v172
    v_accvgpr_write_b32 a31, v174
    v_lshlrev_b32 v160, 16, v32
    v_and_b32 v161, 0xffff0000, v32
    v_lshlrev_b32 v162, 16, v33
    v_and_b32 v163, 0xffff0000, v33
    v_lshlrev_b32 v164, 16, v34
    v_and_b32 v165, 0xffff0000, v34
    v_lshlrev_b32 v166, 16, v35
    v_and_b32 v167, 0xffff0000, v35
    v_lshlrev_b32 v168, 16, v36
    v_and_b32 v169, 0xffff0000, v36
    v_lshlrev_b32 v170, 16, v37
    v_and_b32 v171, 0xffff0000, v37
    v_lshlrev_b32 v172, 16, v38
    v_and_b32 v173, 0xffff0000, v38
    v_lshlrev_b32 v174, 16, v39
    v_and_b32 v175, 0xffff0000, v39
    v_pk_add_f32 v[160:161], v[160:161], v[154:155] op_sel_hi:[1,0] neg_lo:[0,1] neg_hi:[0,1]
    v_pk_add_f32 v[162:163], v[162:163], v[154:155] op_sel_hi:[1,0] neg_lo:[0,1] neg_hi:[0,1]
    v_pk_add_f32 v[164:165], v[164:165], v[154:155] op_sel_hi:[1,0] neg_lo:[0,1] neg_hi:[0,1]
    v_pk_add_f32 v[166:167], v[166:167], v[154:155] op_sel_hi:[1,0] neg_lo:[0,1] neg_hi:[0,1]
    v_pk_add_f32 v[168:169], v[168:169], v[154:155] op_sel_hi:[1,0] neg_lo:[0,1] neg_hi:[0,1]
    v_pk_add_f32 v[170:171], v[170:171], v[154:155] op_sel_hi:[1,0] neg_lo:[0,1] neg_hi:[0,1]
    v_pk_add_f32 v[172:173], v[172:173], v[154:155] op_sel_hi:[1,0] neg_lo:[0,1] neg_hi:[0,1]
    v_pk_add_f32 v[174:175], v[174:175], v[154:155] op_sel_hi:[1,0] neg_lo:[0,1] neg_hi:[0,1]
    v_cvt_pk_bf16_f32 v32, v160, v161
    v_cvt_pk_bf16_f32 v33, v162, v163
    v_cvt_pk_bf16_f32 v34, v164, v165
    v_cvt_pk_bf16_f32 v35, v166, v167
    v_cvt_pk_bf16_f32 v36, v168, v169
    v_cvt_pk_bf16_f32 v37, v170, v171
    v_cvt_pk_bf16_f32 v38, v172, v173
    v_cvt_pk_bf16_f32 v39, v174, v175
    v_lshlrev_b32 v160, 16, v32
    v_and_b32 v161, 0xffff0000, v32
    s_add_u32 s26, s24, 0xe0000
    s_add_u32 m0, s29, 0x7000
    s_nop 0
    buffer_load_dwordx4 v136, s[16:19], s26 offen lds
    v_lshlrev_b32 v162, 16, v33
    v_and_b32 v163, 0xffff0000, v33
    v_lshlrev_b32 v164, 16, v34
    v_and_b32 v165, 0xffff0000, v34
    v_lshlrev_b32 v166, 16, v35
    v_and_b32 v167, 0xffff0000, v35
    v_lshlrev_b32 v168, 16, v36
    v_and_b32 v169, 0xffff0000, v36
    v_lshlrev_b32 v170, 16, v37
    v_and_b32 v171, 0xffff0000, v37
    v_lshlrev_b32 v172, 16, v38
    v_and_b32 v173, 0xffff0000, v38
    v_lshlrev_b32 v174, 16, v39
    v_and_b32 v175, 0xffff0000, v39
    v_pk_mul_f32 v[160:161], v[160:161], v[152:153] op_sel_hi:[1,0]
    v_pk_mul_f32 v[162:163], v[162:163], v[152:153] op_sel_hi:[1,0]
    v_pk_mul_f32 v[164:165], v[164:165], v[152:153] op_sel_hi:[1,0]
    v_pk_mul_f32 v[166:167], v[166:167], v[152:153] op_sel_hi:[1,0]
    v_pk_mul_f32 v[168:169], v[168:169], v[152:153] op_sel_hi:[1,0]
    v_pk_mul_f32 v[170:171], v[170:171], v[152:153] op_sel_hi:[1,0]
    v_pk_mul_f32 v[172:173], v[172:173], v[152:153] op_sel_hi:[1,0]
    v_pk_mul_f32 v[174:175], v[174:175], v[152:153] op_sel_hi:[1,0]
    v_cvt_pk_bf16_f32 v160, v160, v161
    v_cvt_pk_bf16_f32 v162, v162, v163
    v_cvt_pk_bf16_f32 v164, v164, v165
    v_cvt_pk_bf16_f32 v166, v166, v167
    v_cvt_pk_bf16_f32 v168, v168, v169
    v_cvt_pk_bf16_f32 v170, v170, v171
    v_cvt_pk_bf16_f32 v172, v172, v173
    v_cvt_pk_bf16_f32 v174, v174, v175
    v_accvgpr_write_b32 a32, v160
    v_accvgpr_write_b32 a33, v162
    v_accvgpr_write_b32 a34, v164
    v_accvgpr_write_b32 a35, v166
    v_accvgpr_write_b32 a36, v168
    v_accvgpr_write_b32 a37, v170
    v_accvgpr_write_b32 a38, v172
    v_accvgpr_write_b32 a39, v174
    v_lshlrev_b32 v160, 16, v40
    v_and_b32 v161, 0xffff0000, v40
    v_lshlrev_b32 v162, 16, v41
    v_and_b32 v163, 0xffff0000, v41
    v_lshlrev_b32 v164, 16, v42
    v_and_b32 v165, 0xffff0000, v42
    v_lshlrev_b32 v166, 16, v43
    v_and_b32 v167, 0xffff0000, v43
    v_lshlrev_b32 v168, 16, v44
    v_and_b32 v169, 0xffff0000, v44
    v_lshlrev_b32 v170, 16, v45
    v_and_b32 v171, 0xffff0000, v45
    s_add_u32 s26, s24, 0x100000
    s_add_u32 m0, s29, 0x8000
    s_nop 0
    buffer_load_dwordx4 v136, s[16:19], s26 offen lds
    v_lshlrev_b32 v172, 16, v46
    v_and_b32 v173, 0xffff0000, v46
    v_lshlrev_b32 v174, 16, v47
    v_and_b32 v175, 0xffff0000, v47
    v_pk_add_f32 v[160:161], v[160:161], v[154:155] op_sel_hi:[1,0] neg_lo:[0,1] neg_hi:[0,1]
    v_pk_add_f32 v[162:163], v[162:163], v[154:155] op_sel_hi:[1,0] neg_lo:[0,1] neg_hi:[0,1]
    v_pk_add_f32 v[164:165], v[164:165], v[154:155] op_sel_hi:[1,0] neg_lo:[0,1] neg_hi:[0,1]
    v_pk_add_f32 v[166:167], v[166:167], v[154:155] op_sel_hi:[1,0] neg_lo:[0,1] neg_hi:[0,1]
    v_pk_add_f32 v[168:169], v[168:169], v[154:155] op_sel_hi:[1,0] neg_lo:[0,1] neg_hi:[0,1]
    v_pk_add_f32 v[170:171], v[170:171], v[154:155] op_sel_hi:[1,0] neg_lo:[0,1] neg_hi:[0,1]
    v_pk_add_f32 v[172:173], v[172:173], v[154:155] op_sel_hi:[1,0] neg_lo:[0,1] neg_hi:[0,1]
    v_pk_add_f32 v[174:175], v[174:175], v[154:155] op_sel_hi:[1,0] neg_lo:[0,1] neg_hi:[0,1]
    v_cvt_pk_bf16_f32 v40, v160, v161
    v_cvt_pk_bf16_f32 v41, v162, v163
    v_cvt_pk_bf16_f32 v42, v164, v165
    v_cvt_pk_bf16_f32 v43, v166, v167
    v_cvt_pk_bf16_f32 v44, v168, v169
    v_cvt_pk_bf16_f32 v45, v170, v171
    v_cvt_pk_bf16_f32 v46, v172, v173
    v_cvt_pk_bf16_f32 v47, v174, v175
    v_lshlrev_b32 v160, 16, v40
    v_and_b32 v161, 0xffff0000, v40
    v_lshlrev_b32 v162, 16, v41
    v_and_b32 v163, 0xffff0000, v41
    v_lshlrev_b32 v164, 16, v42
    v_and_b32 v165, 0xffff0000, v42
    v_lshlrev_b32 v166, 16, v43
    v_and_b32 v167, 0xffff0000, v43
    v_lshlrev_b32 v168, 16, v44
    v_and_b32 v169, 0xffff0000, v44
    v_lshlrev_b32 v170, 16, v45
    v_and_b32 v171, 0xffff0000, v45
    v_lshlrev_b32 v172, 16, v46
    v_and_b32 v173, 0xffff0000, v46
    v_lshlrev_b32 v174, 16, v47
    v_and_b32 v175, 0xffff0000, v47
    v_pk_mul_f32 v[160:161], v[160:161], v[152:153] op_sel_hi:[1,0]
    v_pk_mul_f32 v[162:163], v[162:163], v[152:153] op_sel_hi:[1,0]
    v_pk_mul_f32 v[164:165], v[164:165], v[152:153] op_sel_hi:[1,0]
    v_pk_mul_f32 v[166:167], v[166:167], v[152:153] op_sel_hi:[1,0]
    v_pk_mul_f32 v[168:169], v[168:169], v[152:153] op_sel_hi:[1,0]
    v_pk_mul_f32 v[170:171], v[170:171], v[152:153] op_sel_hi:[1,0]
    v_pk_mul_f32 v[172:173], v[172:173], v[152:153] op_sel_hi:[1,0]
    v_pk_mul_f32 v[174:175], v[174:175], v[152:153] op_sel_hi:[1,0]
    v_cvt_pk_bf16_f32 v160, v160, v161
    v_cvt_pk_bf16_f32 v162, v162, v163
    v_cvt_pk_bf16_f32 v164, v164, v165
    v_cvt_pk_bf16_f32 v166, v166, v167
    v_cvt_pk_bf16_f32 v168, v168, v169
    v_cvt_pk_bf16_f32 v170, v170, v171
    s_add_u32 s26, s24, 0x120000
    s_add_u32 m0, s29, 0x9000
    s_nop 0
    buffer_load_dwordx4 v136, s[16:19], s26 offen lds
    v_cvt_pk_bf16_f32 v172, v172, v173
    v_cvt_pk_bf16_f32 v174, v174, v175
    v_accvgpr_write_b32 a40, v160
    v_accvgpr_write_b32 a41, v162
    v_accvgpr_write_b32 a42, v164
    v_accvgpr_write_b32 a43, v166
    v_accvgpr_write_b32 a44, v168
    v_accvgpr_write_b32 a45, v170
    v_accvgpr_write_b32 a46, v172
    v_accvgpr_write_b32 a47, v174
    v_lshlrev_b32 v160, 16, v48
    v_and_b32 v161, 0xffff0000, v48
    v_lshlrev_b32 v162, 16, v49
    v_and_b32 v163, 0xffff0000, v49
    v_lshlrev_b32 v164, 16, v50
    v_and_b32 v165, 0xffff0000, v50
    v_lshlrev_b32 v166, 16, v51
    v_and_b32 v167, 0xffff0000, v51
    v_lshlrev_b32 v168, 16, v52
    v_and_b32 v169, 0xffff0000, v52
    v_lshlrev_b32 v170, 16, v53
    v_and_b32 v171, 0xffff0000, v53
    v_lshlrev_b32 v172, 16, v54
    v_and_b32 v173, 0xffff0000, v54
    v_lshlrev_b32 v174, 16, v55
    v_and_b32 v175, 0xffff0000, v55
    v_pk_add_f32 v[160:161], v[160:161], v[154:155] op_sel_hi:[1,0] neg_lo:[0,1] neg_hi:[0,1]
    v_pk_add_f32 v[162:163], v[162:163], v[154:155] op_sel_hi:[1,0] neg_lo:[0,1] neg_hi:[0,1]
    v_pk_add_f32 v[164:165], v[164:165], v[154:155] op_sel_hi:[1,0] neg_lo:[0,1] neg_hi:[0,1]
    v_pk_add_f32 v[166:167], v[166:167], v[154:155] op_sel_hi:[1,0] neg_lo:[0,1] neg_hi:[0,1]
    v_pk_add_f32 v[168:169], v[168:169], v[154:155] op_sel_hi:[1,0] neg_lo:[0,1] neg_hi:[0,1]
    v_pk_add_f32 v[170:171], v[170:171], v[154:155] op_sel_hi:[1,0] neg_lo:[0,1] neg_hi:[0,1]
    v_pk_add_f32 v[172:173], v[172:173], v[154:155] op_sel_hi:[1,0] neg_lo:[0,1] neg_hi:[0,1]
    v_pk_add_f32 v[174:175], v[174:175], v[154:155] op_sel_hi:[1,0] neg_lo:[0,1] neg_hi:[0,1]
    v_cvt_pk_bf16_f32 v48, v160, v161
    v_cvt_pk_bf16_f32 v49, v162, v163
    v_cvt_pk_bf16_f32 v50, v164, v165
    v_cvt_pk_bf16_f32 v51, v166, v167
    v_cvt_pk_bf16_f32 v52, v168, v169
    v_cvt_pk_bf16_f32 v53, v170, v171
    v_cvt_pk_bf16_f32 v54, v172, v173
    v_cvt_pk_bf16_f32 v55, v174, v175
    v_lshlrev_b32 v160, 16, v48
    v_and_b32 v161, 0xffff0000, v48
    v_lshlrev_b32 v162, 16, v49
    v_and_b32 v163, 0xffff0000, v49
    v_lshlrev_b32 v164, 16, v50
    v_and_b32 v165, 0xffff0000, v50
    v_lshlrev_b32 v166, 16, v51
    v_and_b32 v167, 0xffff0000, v51
    s_add_u32 s26, s24, 0x140000
    s_add_u32 m0, s29, 0xa000
    s_nop 0
    buffer_load_dwordx4 v136, s[16:19], s26 offen lds
    v_lshlrev_b32 v168, 16, v52
    v_and_b32 v169, 0xffff0000, v52
    v_lshlrev_b32 v170, 16, v53
    v_and_b32 v171, 0xffff0000, v53
    v_lshlrev_b32 v172, 16, v54
    v_and_b32 v173, 0xffff0000, v54
    v_lshlrev_b32 v174, 16, v55
    v_and_b32 v175, 0xffff0000, v55
    v_pk_mul_f32 v[160:161], v[160:161], v[152:153] op_sel_hi:[1,0]
    v_pk_mul_f32 v[162:163], v[162:163], v[152:153] op_sel_hi:[1,0]
    v_pk_mul_f32 v[164:165], v[164:165], v[152:153] op_sel_hi:[1,0]
    v_pk_mul_f32 v[166:167], v[166:167], v[152:153] op_sel_hi:[1,0]
    v_pk_mul_f32 v[168:169], v[168:169], v[152:153] op_sel_hi:[1,0]
    v_pk_mul_f32 v[170:171], v[170:171], v[152:153] op_sel_hi:[1,0]
    v_pk_mul_f32 v[172:173], v[172:173], v[152:153] op_sel_hi:[1,0]
    v_pk_mul_f32 v[174:175], v[174:175], v[152:153] op_sel_hi:[1,0]
    v_cvt_pk_bf16_f32 v160, v160, v161
    v_cvt_pk_bf16_f32 v162, v162, v163
    v_cvt_pk_bf16_f32 v164, v164, v165
    v_cvt_pk_bf16_f32 v166, v166, v167
    v_cvt_pk_bf16_f32 v168, v168, v169
    v_cvt_pk_bf16_f32 v170, v170, v171
    v_cvt_pk_bf16_f32 v172, v172, v173
    v_cvt_pk_bf16_f32 v174, v174, v175
    v_accvgpr_write_b32 a48, v160
    v_accvgpr_write_b32 a49, v162
    v_accvgpr_write_b32 a50, v164
    v_accvgpr_write_b32 a51, v166
    v_accvgpr_write_b32 a52, v168
    v_accvgpr_write_b32 a53, v170
    v_accvgpr_write_b32 a54, v172
    v_accvgpr_write_b32 a55, v174
    v_lshlrev_b32 v160, 16, v56
    v_and_b32 v161, 0xffff0000, v56
    v_lshlrev_b32 v162, 16, v57
    v_and_b32 v163, 0xffff0000, v57
    v_lshlrev_b32 v164, 16, v58
    v_and_b32 v165, 0xffff0000, v58
    v_lshlrev_b32 v166, 16, v59
    v_and_b32 v167, 0xffff0000, v59
    v_lshlrev_b32 v168, 16, v60
    v_and_b32 v169, 0xffff0000, v60
    v_lshlrev_b32 v170, 16, v61
    v_and_b32 v171, 0xffff0000, v61
    v_lshlrev_b32 v172, 16, v62
    v_and_b32 v173, 0xffff0000, v62
    v_lshlrev_b32 v174, 16, v63
    v_and_b32 v175, 0xffff0000, v63
    v_pk_add_f32 v[160:161], v[160:161], v[154:155] op_sel_hi:[1,0] neg_lo:[0,1] neg_hi:[0,1]
    v_pk_add_f32 v[162:163], v[162:163], v[154:155] op_sel_hi:[1,0] neg_lo:[0,1] neg_hi:[0,1]
    s_add_u32 s26, s24, 0x160000
    s_add_u32 m0, s29, 0xb000
    s_nop 0
    buffer_load_dwordx4 v136, s[16:19], s26 offen lds
    v_pk_add_f32 v[164:165], v[164:165], v[154:155] op_sel_hi:[1,0] neg_lo:[0,1] neg_hi:[0,1]
    v_pk_add_f32 v[166:167], v[166:167], v[154:155] op_sel_hi:[1,0] neg_lo:[0,1] neg_hi:[0,1]
    v_pk_add_f32 v[168:169], v[168:169], v[154:155] op_sel_hi:[1,0] neg_lo:[0,1] neg_hi:[0,1]
    v_pk_add_f32 v[170:171], v[170:171], v[154:155] op_sel_hi:[1,0] neg_lo:[0,1] neg_hi:[0,1]
    v_pk_add_f32 v[172:173], v[172:173], v[154:155] op_sel_hi:[1,0] neg_lo:[0,1] neg_hi:[0,1]
    v_pk_add_f32 v[174:175], v[174:175], v[154:155] op_sel_hi:[1,0] neg_lo:[0,1] neg_hi:[0,1]
    v_cvt_pk_bf16_f32 v56, v160, v161
    v_cvt_pk_bf16_f32 v57, v162, v163
    v_cvt_pk_bf16_f32 v58, v164, v165
    v_cvt_pk_bf16_f32 v59, v166, v167
    v_cvt_pk_bf16_f32 v60, v168, v169
    v_cvt_pk_bf16_f32 v61, v170, v171
    v_cvt_pk_bf16_f32 v62, v172, v173
    v_cvt_pk_bf16_f32 v63, v174, v175
    v_lshlrev_b32 v160, 16, v56
    v_and_b32 v161, 0xffff0000, v56
    v_lshlrev_b32 v162, 16, v57
    v_and_b32 v163, 0xffff0000, v57
    v_lshlrev_b32 v164, 16, v58
    v_and_b32 v165, 0xffff0000, v58
    v_lshlrev_b32 v166, 16, v59
    v_and_b32 v167, 0xffff0000, v59
    v_lshlrev_b32 v168, 16, v60
    v_and_b32 v169, 0xffff0000, v60
    v_lshlrev_b32 v170, 16, v61
    v_and_b32 v171, 0xffff0000, v61
    v_lshlrev_b32 v172, 16, v62
    v_and_b32 v173, 0xffff0000, v62
    v_lshlrev_b32 v174, 16, v63
    v_and_b32 v175, 0xffff0000, v63
    v_pk_mul_f32 v[160:161], v[160:161], v[152:153] op_sel_hi:[1,0]
    v_pk_mul_f32 v[162:163], v[162:163], v[152:153] op_sel_hi:[1,0]
    v_pk_mul_f32 v[164:165], v[164:165], v[152:153] op_sel_hi:[1,0]
    v_pk_mul_f32 v[166:167], v[166:167], v[152:153] op_sel_hi:[1,0]
    v_pk_mul_f32 v[168:169], v[168:169], v[152:153] op_sel_hi:[1,0]
    v_pk_mul_f32 v[170:171], v[170:171], v[152:153] op_sel_hi:[1,0]
    v_pk_mul_f32 v[172:173], v[172:173], v[152:153] op_sel_hi:[1,0]
    v_pk_mul_f32 v[174:175], v[174:175], v[152:153] op_sel_hi:[1,0]
    v_cvt_pk_bf16_f32 v160, v160, v161
    v_cvt_pk_bf16_f32 v162, v162, v163
    v_cvt_pk_bf16_f32 v164, v164, v165
    v_cvt_pk_bf16_f32 v166, v166, v167
    v_cvt_pk_bf16_f32 v168, v168, v169
    v_cvt_pk_bf16_f32 v170, v170, v171
    v_cvt_pk_bf16_f32 v172, v172, v173
    v_cvt_pk_bf16_f32 v174, v174, v175
    v_accvgpr_write_b32 a56, v160
    v_accvgpr_write_b32 a57, v162
    v_accvgpr_write_b32 a58, v164
    v_accvgpr_write_b32 a59, v166
    s_add_u32 s26, s24, 0x180000
    s_add_u32 m0, s29, 0xc000
    s_nop 0
    buffer_load_dwordx4 v136, s[16:19], s26 offen lds
    v_accvgpr_write_b32 a60, v168
    v_accvgpr_write_b32 a61, v170
    v_accvgpr_write_b32 a62, v172
    v_accvgpr_write_b32 a63, v174
    s_waitcnt vmcnt(13)
    v_pk_mov_b32 v[150:151], 0, 0
    v_pk_mov_b32 v[152:153], 0, 0
    v_dot2_f32_bf16 v150, v64, v158, v150
    v_dot2_f32_bf16 v152, v64, v64, v152
    v_dot2_f32_bf16 v151, v65, v158, v151
    v_dot2_f32_bf16 v153, v65, v65, v153
    v_dot2_f32_bf16 v150, v66, v158, v150
    v_dot2_f32_bf16 v152, v66, v66, v152
    v_dot2_f32_bf16 v151, v67, v158, v151
    v_dot2_f32_bf16 v153, v67, v67, v153
    v_dot2_f32_bf16 v150, v68, v158, v150
    v_dot2_f32_bf16 v152, v68, v68, v152
    v_dot2_f32_bf16 v151, v69, v158, v151
    v_dot2_f32_bf16 v153, v69, v69, v153
    v_dot2_f32_bf16 v150, v70, v158, v150
    v_dot2_f32_bf16 v152, v70, v70, v152
    v_dot2_f32_bf16 v151, v71, v158, v151
    v_dot2_f32_bf16 v153, v71, v71, v153
    v_dot2_f32_bf16 v150, v72, v158, v150
    v_dot2_f32_bf16 v152, v72, v72, v152
    v_dot2_f32_bf16 v151, v73, v158, v151
    v_dot2_f32_bf16 v153, v73, v73, v153
    v_dot2_f32_bf16 v150, v74, v158, v150
    v_dot2_f32_bf16 v152, v74, v74, v152
    v_dot2_f32_bf16 v151, v75, v158, v151
    v_dot2_f32_bf16 v153, v75, v75, v153
    v_dot2_f32_bf16 v150, v76, v158, v150
    v_dot2_f32_bf16 v152, v76, v76, v152
    v_dot2_f32_bf16 v151, v77, v158, v151
    v_dot2_f32_bf16 v153, v77, v77, v153
    v_dot2_f32_bf16 v150, v78, v158, v150
    v_dot2_f32_bf16 v152, v78, v78, v152
    v_dot2_f32_bf16 v151, v79, v158, v151
    v_dot2_f32_bf16 v153, v79, v79, v153
    v_dot2_f32_bf16 v150, v80, v158, v150
    v_dot2_f32_bf16 v152, v80, v80, v152
    v_dot2_f32_bf16 v151, v81, v158, v151
    v_dot2_f32_bf16 v153, v81, v81, v153
    v_dot2_f32_bf16 v150, v82, v158, v150
    v_dot2_f32_bf16 v152, v82, v82, v152
    v_dot2_f32_bf16 v151, v83, v158, v151
    v_dot2_f32_bf16 v153, v83, v83, v153
    v_dot2_f32_bf16 v150, v84, v158, v150
    v_dot2_f32_bf16 v152, v84, v84, v152
    v_dot2_f32_bf16 v151, v85, v158, v151
    v_dot2_f32_bf16 v153, v85, v85, v153
    v_dot2_f32_bf16 v150, v86, v158, v150
    v_dot2_f32_bf16 v152, v86, v86, v152
    s_add_u32 s26, s24, 0x1a0000
    s_add_u32 m0, s29, 0xd000
    s_nop 0
    buffer_load_dwordx4 v136, s[16:19], s26 offen lds
    v_dot2_f32_bf16 v151, v87, v158, v151
    v_dot2_f32_bf16 v153, v87, v87, v153
    v_dot2_f32_bf16 v150, v88, v158, v150
    v_dot2_f32_bf16 v152, v88, v88, v152
    v_dot2_f32_bf16 v151, v89, v158, v151
    v_dot2_f32_bf16 v153, v89, v89, v153
    v_dot2_f32_bf16 v150, v90, v158, v150
    v_dot2_f32_bf16 v152, v90, v90, v152
    v_dot2_f32_bf16 v151, v91, v158, v151
    v_dot2_f32_bf16 v153, v91, v91, v153
    v_dot2_f32_bf16 v150, v92, v158, v150
    v_dot2_f32_bf16 v152, v92, v92, v152
    v_dot2_f32_bf16 v151, v93, v158, v151
    v_dot2_f32_bf16 v153, v93, v93, v153
    v_dot2_f32_bf16 v150, v94, v158, v150
    v_dot2_f32_bf16 v152, v94, v94, v152
    v_dot2_f32_bf16 v151, v95, v158, v151
    v_dot2_f32_bf16 v153, v95, v95, v153
    v_dot2_f32_bf16 v150, v96, v158, v150
    v_dot2_f32_bf16 v152, v96, v96, v152
    v_dot2_f32_bf16 v151, v97, v158, v151
    v_dot2_f32_bf16 v153, v97, v97, v153
    v_dot2_f32_bf16 v150, v98, v158, v150
    v_dot2_f32_bf16 v152, v98, v98, v152
    v_dot2_f32_bf16 v151, v99, v158, v151
    v_dot2_f32_bf16 v153, v99, v99, v153
    v_dot2_f32_bf16 v150, v100, v158, v150
    v_dot2_f32_bf16 v152, v100, v100, v152
    v_dot2_f32_bf16 v151, v101, v158, v151
    v_dot2_f32_bf16 v153, v101, v101, v153
    v_dot2_f32_bf16 v150, v102, v158, v150
    v_dot2_f32_bf16 v152, v102, v102, v152
    v_dot2_f32_bf16 v151, v103, v158, v151
    v_dot2_f32_bf16 v153, v103, v103, v153
    v_dot2_f32_bf16 v150, v104, v158, v150
    v_dot2_f32_bf16 v152, v104, v104, v152
    v_dot2_f32_bf16 v151, v105, v158, v151
    v_dot2_f32_bf16 v153, v105, v105, v153
    v_dot2_f32_bf16 v150, v106, v158, v150
    v_dot2_f32_bf16 v152, v106, v106, v152
    v_dot2_f32_bf16 v151, v107, v158, v151
    v_dot2_f32_bf16 v153, v107, v107, v153
    v_dot2_f32_bf16 v150, v108, v158, v150
    v_dot2_f32_bf16 v152, v108, v108, v152
    v_dot2_f32_bf16 v151, v109, v158, v151
    v_dot2_f32_bf16 v153, v109, v109, v153
    v_dot2_f32_bf16 v150, v110, v158, v150
    v_dot2_f32_bf16 v152, v110, v110, v152
    v_dot2_f32_bf16 v151, v111, v158, v151
    v_dot2_f32_bf16 v153, v111, v111, v153
    s_add_u32 s26, s24, 0x1c0000
    s_add_u32 m0, s29, 0xe000
    s_nop 0
    buffer_load_dwordx4 v136, s[16:19], s26 offen lds
    v_dot2_f32_bf16 v150, v112, v158, v150
    v_dot2_f32_bf16 v152, v112, v112, v152
    v_dot2_f32_bf16 v151, v113, v158, v151
    v_dot2_f32_bf16 v153, v113, v113, v153
    v_dot2_f32_bf16 v150, v114, v158, v150
    v_dot2_f32_bf16 v152, v114, v114, v152
    v_dot2_f32_bf16 v151, v115, v158, v151
    v_dot2_f32_bf16 v153, v115, v115, v153
    v_dot2_f32_bf16 v150, v116, v158, v150
    v_dot2_f32_bf16 v152, v116, v116, v152
    v_dot2_f32_bf16 v151, v117, v158, v151
    v_dot2_f32_bf16 v153, v117, v117, v153
    v_dot2_f32_bf16 v150, v118, v158, v150
    v_dot2_f32_bf16 v152, v118, v118, v152
    v_dot2_f32_bf16 v151, v119, v158, v151
    v_dot2_f32_bf16 v153, v119, v119, v153
    v_dot2_f32_bf16 v150, v120, v158, v150
    v_dot2_f32_bf16 v152, v120, v120, v152
    v_dot2_f32_bf16 v151, v121, v158, v151
    v_dot2_f32_bf16 v153, v121, v121, v153
    v_dot2_f32_bf16 v150, v122, v158, v150
    v_dot2_f32_bf16 v152, v122, v122, v152
    v_dot2_f32_bf16 v151, v123, v158, v151
    v_dot2_f32_bf16 v153, v123, v123, v153
    v_dot2_f32_bf16 v150, v124, v158, v150
    v_dot2_f32_bf16 v152, v124, v124, v152
    v_dot2_f32_bf16 v151, v125, v158, v151
    v_dot2_f32_bf16 v153, v125, v125, v153
    v_dot2_f32_bf16 v150, v126, v158, v150
    v_dot2_f32_bf16 v152, v126, v126, v152
    v_dot2_f32_bf16 v151, v127, v158, v151
    v_dot2_f32_bf16 v153, v127, v127, v153
    s_nop 1
    v_add_f32 v150, v150, v151
    v_add_f32 v152, v152, v153
    v_mov_b32 v157, v150
    s_nop 1
    v_permlane32_swap_b32 v157, v150
    v_add_f32 v150, v157, v150
    v_mov_b32 v157, v150
    s_nop 1
    v_permlane16_swap_b32 v157, v150
    v_add_f32 v150, v157, v150
    v_mov_b32 v157, v152
    s_nop 1
    v_permlane32_swap_b32 v157, v152
    v_add_f32 v152, v157, v152
    v_mov_b32 v157, v152
    s_nop 1
    v_permlane16_swap_b32 v157, v152
    v_add_f32 v152, v157, v152
    v_mul_f32 v150, 0x3b000000, v150
    v_cvt_pk_bf16_f32 v154, v150, v150
    v_and_b32 v154, 0xffff0000, v154
    v_sub_f32 v156, v150, v154
    v_mul_f32 v157, v150, v150
    v_mul_f32 v152, 0x3b000000, v152
    v_sub_f32 v152, v152, v157
    v_max_f32 v152, 0, v152
    v_cvt_pk_bf16_f32 v152, v152, v152
    v_and_b32 v152, 0xffff0000, v152
    v_add_f32 v152, 0x3727c5ac, v152
    v_cvt_pk_bf16_f32 v152, v152, v152
    v_and_b32 v152, 0xffff0000, v152
    v_sqrt_f32 v152, v152
    s_nop 0
    v_cvt_pk_bf16_f32 v152, v152, v152
    v_and_b32 v152, 0xffff0000, v152
    v_rcp_f32 v152, v152
    v_lshlrev_b32 v160, 16, v64
    v_and_b32 v161, 0xffff0000, v64
    v_lshlrev_b32 v162, 16, v65
    v_and_b32 v163, 0xffff0000, v65
    v_lshlrev_b32 v164, 16, v66
    v_and_b32 v165, 0xffff0000, v66
    v_lshlrev_b32 v166, 16, v67
    v_and_b32 v167, 0xffff0000, v67
    v_lshlrev_b32 v168, 16, v68
    v_and_b32 v169, 0xffff0000, v68
    v_lshlrev_b32 v170, 16, v69
    v_and_b32 v171, 0xffff0000, v69
    v_lshlrev_b32 v172, 16, v70
    v_and_b32 v173, 0xffff0000, v70
    v_lshlrev_b32 v174, 16, v71
    v_and_b32 v175, 0xffff0000, v71
    v_pk_add_f32 v[160:161], v[160:161], v[154:155] op_sel_hi:[1,0] neg_lo:[0,1] neg_hi:[0,1]
    v_pk_add_f32 v[162:163], v[162:163], v[154:155] op_sel_hi:[1,0] neg_lo:[0,1] neg_hi:[0,1]
    s_add_u32 s26, s24, 0x1e0000
    s_add_u32 m0, s29, 0xf000
    s_nop 0
    buffer_load_dwordx4 v136, s[16:19], s26 offen lds
    v_pk_add_f32 v[164:165], v[164:165], v[154:155] op_sel_hi:[1,0] neg_lo:[0,1] neg_hi:[0,1]
    v_pk_add_f32 v[166:167], v[166:167], v[154:155] op_sel_hi:[1,0] neg_lo:[0,1] neg_hi:[0,1]
    v_pk_add_f32 v[168:169], v[168:169], v[154:155] op_sel_hi:[1,0] neg_lo:[0,1] neg_hi:[0,1]
    v_pk_add_f32 v[170:171], v[170:171], v[154:155] op_sel_hi:[1,0] neg_lo:[0,1] neg_hi:[0,1]
    v_pk_add_f32 v[172:173], v[172:173], v[154:155] op_sel_hi:[1,0] neg_lo:[0,1] neg_hi:[0,1]
    v_pk_add_f32 v[174:175], v[174:175], v[154:155] op_sel_hi:[1,0] neg_lo:[0,1] neg_hi:[0,1]
    v_cvt_pk_bf16_f32 v64, v160, v161
    v_cvt_pk_bf16_f32 v65, v162, v163
    v_cvt_pk_bf16_f32 v66, v164, v165
    v_cvt_pk_bf16_f32 v67, v166, v167
    v_cvt_pk_bf16_f32 v68, v168, v169
    v_cvt_pk_bf16_f32 v69, v170, v171
    v_cvt_pk_bf16_f32 v70, v172, v173
    v_cvt_pk_bf16_f32 v71, v174, v175
    v_lshlrev_b32 v160, 16, v64
    v_and_b32 v161, 0xffff0000, v64
    v_lshlrev_b32 v162, 16, v65
    v_and_b32 v163, 0xffff0000, v65
    v_lshlrev_b32 v164, 16, v66
    v_and_b32 v165, 0xffff0000, v66
    v_lshlrev_b32 v166, 16, v67
    v_and_b32 v167, 0xffff0000, v67
    v_lshlrev_b32 v168, 16, v68
    v_and_b32 v169, 0xffff0000, v68
    v_lshlrev_b32 v170, 16, v69
    v_and_b32 v171, 0xffff0000, v69
    v_lshlrev_b32 v172, 16, v70
    v_and_b32 v173, 0xffff0000, v70
    v_lshlrev_b32 v174, 16, v71
    v_and_b32 v175, 0xffff0000, v71
    v_pk_mul_f32 v[160:161], v[160:161], v[152:153] op_sel_hi:[1,0]
    v_pk_mul_f32 v[162:163], v[162:163], v[152:153] op_sel_hi:[1,0]
    v_pk_mul_f32 v[164:165], v[164:165], v[152:153] op_sel_hi:[1,0]
    v_pk_mul_f32 v[166:167], v[166:167], v[152:153] op_sel_hi:[1,0]
    v_pk_mul_f32 v[168:169], v[168:169], v[152:153] op_sel_hi:[1,0]
    v_pk_mul_f32 v[170:171], v[170:171], v[152:153] op_sel_hi:[1,0]
    v_pk_mul_f32 v[172:173], v[172:173], v[152:153] op_sel_hi:[1,0]
    v_pk_mul_f32 v[174:175], v[174:175], v[152:153] op_sel_hi:[1,0]
    v_cvt_pk_bf16_f32 v160, v160, v161
    v_cvt_pk_bf16_f32 v162, v162, v163
    v_cvt_pk_bf16_f32 v164, v164, v165
    v_cvt_pk_bf16_f32 v166, v166, v167
    v_cvt_pk_bf16_f32 v168, v168, v169
    v_cvt_pk_bf16_f32 v170, v170, v171
    v_cvt_pk_bf16_f32 v172, v172, v173
    v_cvt_pk_bf16_f32 v174, v174, v175
    v_accvgpr_write_b32 a64, v160
    v_accvgpr_write_b32 a65, v162
    v_accvgpr_write_b32 a66, v164
    v_accvgpr_write_b32 a67, v166
    s_add_u32 s26, s24, 0x200000
    s_add_u32 m0, s29, 0x10000
    s_nop 0
    buffer_load_dwordx4 v136, s[16:19], s26 offen lds
    v_accvgpr_write_b32 a68, v168
    v_accvgpr_write_b32 a69, v170
    v_accvgpr_write_b32 a70, v172
    v_accvgpr_write_b32 a71, v174
    v_lshlrev_b32 v160, 16, v72
    v_and_b32 v161, 0xffff0000, v72
    v_lshlrev_b32 v162, 16, v73
    v_and_b32 v163, 0xffff0000, v73
    v_lshlrev_b32 v164, 16, v74
    v_and_b32 v165, 0xffff0000, v74
    v_lshlrev_b32 v166, 16, v75
    v_and_b32 v167, 0xffff0000, v75
    v_lshlrev_b32 v168, 16, v76
    v_and_b32 v169, 0xffff0000, v76
    v_lshlrev_b32 v170, 16, v77
    v_and_b32 v171, 0xffff0000, v77
    v_lshlrev_b32 v172, 16, v78
    v_and_b32 v173, 0xffff0000, v78
    v_lshlrev_b32 v174, 16, v79
    v_and_b32 v175, 0xffff0000, v79
    v_pk_add_f32 v[160:161], v[160:161], v[154:155] op_sel_hi:[1,0] neg_lo:[0,1] neg_hi:[0,1]
    v_pk_add_f32 v[162:163], v[162:163], v[154:155] op_sel_hi:[1,0] neg_lo:[0,1] neg_hi:[0,1]
    v_pk_add_f32 v[164:165], v[164:165], v[154:155] op_sel_hi:[1,0] neg_lo:[0,1] neg_hi:[0,1]
    v_pk_add_f32 v[166:167], v[166:167], v[154:155] op_sel_hi:[1,0] neg_lo:[0,1] neg_hi:[0,1]
    v_pk_add_f32 v[168:169], v[168:169], v[154:155] op_sel_hi:[1,0] neg_lo:[0,1] neg_hi:[0,1]
    v_pk_add_f32 v[170:171], v[170:171], v[154:155] op_sel_hi:[1,0] neg_lo:[0,1] neg_hi:[0,1]
    v_pk_add_f32 v[172:173], v[172:173], v[154:155] op_sel_hi:[1,0] neg_lo:[0,1] neg_hi:[0,1]
    v_pk_add_f32 v[174:175], v[174:175], v[154:155] op_sel_hi:[1,0] neg_lo:[0,1] neg_hi:[0,1]
    v_cvt_pk_bf16_f32 v72, v160, v161
    v_cvt_pk_bf16_f32 v73, v162, v163
    v_cvt_pk_bf16_f32 v74, v164, v165
    v_cvt_pk_bf16_f32 v75, v166, v167
    v_cvt_pk_bf16_f32 v76, v168, v169
    v_cvt_pk_bf16_f32 v77, v170, v171
    v_cvt_pk_bf16_f32 v78, v172, v173
    v_cvt_pk_bf16_f32 v79, v174, v175
    v_lshlrev_b32 v160, 16, v72
    v_and_b32 v161, 0xffff0000, v72
    v_lshlrev_b32 v162, 16, v73
    v_and_b32 v163, 0xffff0000, v73
    v_lshlrev_b32 v164, 16, v74
    v_and_b32 v165, 0xffff0000, v74
    v_lshlrev_b32 v166, 16, v75
    v_and_b32 v167, 0xffff0000, v75
    v_lshlrev_b32 v168, 16, v76
    v_and_b32 v169, 0xffff0000, v76
    v_lshlrev_b32 v170, 16, v77
    v_and_b32 v171, 0xffff0000, v77
    v_lshlrev_b32 v172, 16, v78
    v_and_b32 v173, 0xffff0000, v78
    s_add_u32 s26, s24, 0x220000
    s_add_u32 m0, s29, 0x11000
    s_nop 0
    buffer_load_dwordx4 v136, s[16:19], s26 offen lds
    v_lshlrev_b32 v174, 16, v79
    v_and_b32 v175, 0xffff0000, v79
    v_pk_mul_f32 v[160:161], v[160:161], v[152:153] op_sel_hi:[1,0]
    v_pk_mul_f32 v[162:163], v[162:163], v[152:153] op_sel_hi:[1,0]
    v_pk_mul_f32 v[164:165], v[164:165], v[152:153] op_sel_hi:[1,0]
    v_pk_mul_f32 v[166:167], v[166:167], v[152:153] op_sel_hi:[1,0]
    v_pk_mul_f32 v[168:169], v[168:169], v[152:153] op_sel_hi:[1,0]
    v_pk_mul_f32 v[170:171], v[170:171], v[152:153] op_sel_hi:[1,0]
    v_pk_mul_f32 v[172:173], v[172:173], v[152:153] op_sel_hi:[1,0]
    v_pk_mul_f32 v[174:175], v[174:175], v[152:153] op_sel_hi:[1,0]
    v_cvt_pk_bf16_f32 v160, v160, v161
    v_cvt_pk_bf16_f32 v162, v162, v163
    v_cvt_pk_bf16_f32 v164, v164, v165
    v_cvt_pk_bf16_f32 v166, v166, v167
    v_cvt_pk_bf16_f32 v168, v168, v169
    v_cvt_pk_bf16_f32 v170, v170, v171
    v_cvt_pk_bf16_f32 v172, v172, v173
    v_cvt_pk_bf16_f32 v174, v174, v175
    v_accvgpr_write_b32 a72, v160
    v_accvgpr_write_b32 a73, v162
    v_accvgpr_write_b32 a74, v164
    v_accvgpr_write_b32 a75, v166
    v_accvgpr_write_b32 a76, v168
    v_accvgpr_write_b32 a77, v170
    v_accvgpr_write_b32 a78, v172
    v_accvgpr_write_b32 a79, v174
    v_lshlrev_b32 v160, 16, v80
    v_and_b32 v161, 0xffff0000, v80
    v_lshlrev_b32 v162, 16, v81
    v_and_b32 v163, 0xffff0000, v81
    v_lshlrev_b32 v164, 16, v82
    v_and_b32 v165, 0xffff0000, v82
    v_lshlrev_b32 v166, 16, v83
    v_and_b32 v167, 0xffff0000, v83
    v_lshlrev_b32 v168, 16, v84
    v_and_b32 v169, 0xffff0000, v84
    v_lshlrev_b32 v170, 16, v85
    v_and_b32 v171, 0xffff0000, v85
    v_lshlrev_b32 v172, 16, v86
    v_and_b32 v173, 0xffff0000, v86
    v_lshlrev_b32 v174, 16, v87
    v_and_b32 v175, 0xffff0000, v87
    v_pk_add_f32 v[160:161], v[160:161], v[154:155] op_sel_hi:[1,0] neg_lo:[0,1] neg_hi:[0,1]
    v_pk_add_f32 v[162:163], v[162:163], v[154:155] op_sel_hi:[1,0] neg_lo:[0,1] neg_hi:[0,1]
    v_pk_add_f32 v[164:165], v[164:165], v[154:155] op_sel_hi:[1,0] neg_lo:[0,1] neg_hi:[0,1]
    v_pk_add_f32 v[166:167], v[166:167], v[154:155] op_sel_hi:[1,0] neg_lo:[0,1] neg_hi:[0,1]
    v_pk_add_f32 v[168:169], v[168:169], v[154:155] op_sel_hi:[1,0] neg_lo:[0,1] neg_hi:[0,1]
    v_pk_add_f32 v[170:171], v[170:171], v[154:155] op_sel_hi:[1,0] neg_lo:[0,1] neg_hi:[0,1]
    v_pk_add_f32 v[172:173], v[172:173], v[154:155] op_sel_hi:[1,0] neg_lo:[0,1] neg_hi:[0,1]
    v_pk_add_f32 v[174:175], v[174:175], v[154:155] op_sel_hi:[1,0] neg_lo:[0,1] neg_hi:[0,1]
    s_add_u32 s26, s24, 0x240000
    s_add_u32 m0, s29, 0x12000
    s_nop 0
    buffer_load_dwordx4 v136, s[16:19], s26 offen lds
    v_cvt_pk_bf16_f32 v80, v160, v161
    v_cvt_pk_bf16_f32 v81, v162, v163
    v_cvt_pk_bf16_f32 v82, v164, v165
    v_cvt_pk_bf16_f32 v83, v166, v167
    v_cvt_pk_bf16_f32 v84, v168, v169
    v_cvt_pk_bf16_f32 v85, v170, v171
    v_cvt_pk_bf16_f32 v86, v172, v173
    v_cvt_pk_bf16_f32 v87, v174, v175
    v_lshlrev_b32 v160, 16, v80
    v_and_b32 v161, 0xffff0000, v80
    v_lshlrev_b32 v162, 16, v81
    v_and_b32 v163, 0xffff0000, v81
    v_lshlrev_b32 v164, 16, v82
    v_and_b32 v165, 0xffff0000, v82
    v_lshlrev_b32 v166, 16, v83
    v_and_b32 v167, 0xffff0000, v83
    v_lshlrev_b32 v168, 16, v84
    v_and_b32 v169, 0xffff0000, v84
    v_lshlrev_b32 v170, 16, v85
    v_and_b32 v171, 0xffff0000, v85
    v_lshlrev_b32 v172, 16, v86
    v_and_b32 v173, 0xffff0000, v86
    v_lshlrev_b32 v174, 16, v87
    v_and_b32 v175, 0xffff0000, v87
    v_pk_mul_f32 v[160:161], v[160:161], v[152:153] op_sel_hi:[1,0]
    v_pk_mul_f32 v[162:163], v[162:163], v[152:153] op_sel_hi:[1,0]
    v_pk_mul_f32 v[164:165], v[164:165], v[152:153] op_sel_hi:[1,0]
    v_pk_mul_f32 v[166:167], v[166:167], v[152:153] op_sel_hi:[1,0]
    v_pk_mul_f32 v[168:169], v[168:169], v[152:153] op_sel_hi:[1,0]
    v_pk_mul_f32 v[170:171], v[170:171], v[152:153] op_sel_hi:[1,0]
    v_pk_mul_f32 v[172:173], v[172:173], v[152:153] op_sel_hi:[1,0]
    v_pk_mul_f32 v[174:175], v[174:175], v[152:153] op_sel_hi:[1,0]
    v_cvt_pk_bf16_f32 v160, v160, v161
    v_cvt_pk_bf16_f32 v162, v162, v163
    v_cvt_pk_bf16_f32 v164, v164, v165
    v_cvt_pk_bf16_f32 v166, v166, v167
    v_cvt_pk_bf16_f32 v168, v168, v169
    v_cvt_pk_bf16_f32 v170, v170, v171
    v_cvt_pk_bf16_f32 v172, v172, v173
    v_cvt_pk_bf16_f32 v174, v174, v175
    v_accvgpr_write_b32 a80, v160
    v_accvgpr_write_b32 a81, v162
    v_accvgpr_write_b32 a82, v164
    v_accvgpr_write_b32 a83, v166
    v_accvgpr_write_b32 a84, v168
    v_accvgpr_write_b32 a85, v170
    v_accvgpr_write_b32 a86, v172
    v_accvgpr_write_b32 a87, v174
    v_lshlrev_b32 v160, 16, v88
    v_and_b32 v161, 0xffff0000, v88
    s_add_u32 s26, s24, 0x260000
    s_add_u32 m0, s29, 0x13000
    s_nop 0
    buffer_load_dwordx4 v136, s[16:19], s26 offen lds
    v_lshlrev_b32 v162, 16, v89
    v_and_b32 v163, 0xffff0000, v89
    v_lshlrev_b32 v164, 16, v90
    v_and_b32 v165, 0xffff0000, v90
    v_lshlrev_b32 v166, 16, v91
    v_and_b32 v167, 0xffff0000, v91
    v_lshlrev_b32 v168, 16, v92
    v_and_b32 v169, 0xffff0000, v92
    v_lshlrev_b32 v170, 16, v93
    v_and_b32 v171, 0xffff0000, v93
    v_lshlrev_b32 v172, 16, v94
    v_and_b32 v173, 0xffff0000, v94
    v_lshlrev_b32 v174, 16, v95
    v_and_b32 v175, 0xffff0000, v95
    v_pk_add_f32 v[160:161], v[160:161], v[154:155] op_sel_hi:[1,0] neg_lo:[0,1] neg_hi:[0,1]
    v_pk_add_f32 v[162:163], v[162:163], v[154:155] op_sel_hi:[1,0] neg_lo:[0,1] neg_hi:[0,1]
    v_pk_add_f32 v[164:165], v[164:165], v[154:155] op_sel_hi:[1,0] neg_lo:[0,1] neg_hi:[0,1]
    v_pk_add_f32 v[166:167], v[166:167], v[154:155] op_sel_hi:[1,0] neg_lo:[0,1] neg_hi:[0,1]
    v_pk_add_f32 v[168:169], v[168:169], v[154:155] op_sel_hi:[1,0] neg_lo:[0,1] neg_hi:[0,1]
    v_pk_add_f32 v[170:171], v[170:171], v[154:155] op_sel_hi:[1,0] neg_lo:[0,1] neg_hi:[0,1]
    v_pk_add_f32 v[172:173], v[172:173], v[154:155] op_sel_hi:[1,0] neg_lo:[0,1] neg_hi:[0,1]
    v_pk_add_f32 v[174:175], v[174:175], v[154:155] op_sel_hi:[1,0] neg_lo:[0,1] neg_hi:[0,1]
    v_cvt_pk_bf16_f32 v88, v160, v161
    v_cvt_pk_bf16_f32 v89, v162, v163
    v_cvt_pk_bf16_f32 v90, v164, v165
    v_cvt_pk_bf16_f32 v91, v166, v167
    v_cvt_pk_bf16_f32 v92, v168, v169
    v_cvt_pk_bf16_f32 v93, v170, v171
    v_cvt_pk_bf16_f32 v94, v172, v173
    v_cvt_pk_bf16_f32 v95, v174, v175
    v_lshlrev_b32 v160, 16, v88
    v_and_b32 v161, 0xffff0000, v88
    v_lshlrev_b32 v162, 16, v89
    v_and_b32 v163, 0xffff0000, v89
    v_lshlrev_b32 v164, 16, v90
    v_and_b32 v165, 0xffff0000, v90
    v_lshlrev_b32 v166, 16, v91
    v_and_b32 v167, 0xffff0000, v91
    v_lshlrev_b32 v168, 16, v92
    v_and_b32 v169, 0xffff0000, v92
    v_lshlrev_b32 v170, 16, v93
    v_and_b32 v171, 0xffff0000, v93
    v_lshlrev_b32 v172, 16, v94
    v_and_b32 v173, 0xffff0000, v94
    v_lshlrev_b32 v174, 16, v95
    v_and_b32 v175, 0xffff0000, v95
    v_pk_mul_f32 v[160:161], v[160:161], v[152:153] op_sel_hi:[1,0]
    v_pk_mul_f32 v[162:163], v[162:163], v[152:153] op_sel_hi:[1,0]
    v_pk_mul_f32 v[164:165], v[164:165], v[152:153] op_sel_hi:[1,0]
    v_pk_mul_f32 v[166:167], v[166:167], v[152:153] op_sel_hi:[1,0]
    s_add_u32 s26, s24, 0x280000
    s_add_u32 m0, s29, 0x14000
    s_nop 0
    buffer_load_dwordx4 v136, s[16:19], s26 offen lds
    v_pk_mul_f32 v[168:169], v[168:169], v[152:153] op_sel_hi:[1,0]
    v_pk_mul_f32 v[170:171], v[170:171], v[152:153] op_sel_hi:[1,0]
    v_pk_mul_f32 v[172:173], v[172:173], v[152:153] op_sel_hi:[1,0]
    v_pk_mul_f32 v[174:175], v[174:175], v[152:153] op_sel_hi:[1,0]
    v_cvt_pk_bf16_f32 v160, v160, v161
    v_cvt_pk_bf16_f32 v162, v162, v163
    v_cvt_pk_bf16_f32 v164, v164, v165
    v_cvt_pk_bf16_f32 v166, v166, v167
    v_cvt_pk_bf16_f32 v168, v168, v169
    v_cvt_pk_bf16_f32 v170, v170, v171
    v_cvt_pk_bf16_f32 v172, v172, v173
    v_cvt_pk_bf16_f32 v174, v174, v175
    v_accvgpr_write_b32 a88, v160
    v_accvgpr_write_b32 a89, v162
    v_accvgpr_write_b32 a90, v164
    v_accvgpr_write_b32 a91, v166
    v_accvgpr_write_b32 a92, v168
    v_accvgpr_write_b32 a93, v170
    v_accvgpr_write_b32 a94, v172
    v_accvgpr_write_b32 a95, v174
    v_lshlrev_b32 v160, 16, v96
    v_and_b32 v161, 0xffff0000, v96
    v_lshlrev_b32 v162, 16, v97
    v_and_b32 v163, 0xffff0000, v97
    v_lshlrev_b32 v164, 16, v98
    v_and_b32 v165, 0xffff0000, v98
    v_lshlrev_b32 v166, 16, v99
    v_and_b32 v167, 0xffff0000, v99
    v_lshlrev_b32 v168, 16, v100
    v_and_b32 v169, 0xffff0000, v100
    v_lshlrev_b32 v170, 16, v101
    v_and_b32 v171, 0xffff0000, v101
    v_lshlrev_b32 v172, 16, v102
    v_and_b32 v173, 0xffff0000, v102
    v_lshlrev_b32 v174, 16, v103
    v_and_b32 v175, 0xffff0000, v103
    v_pk_add_f32 v[160:161], v[160:161], v[154:155] op_sel_hi:[1,0] neg_lo:[0,1] neg_hi:[0,1]
    v_pk_add_f32 v[162:163], v[162:163], v[154:155] op_sel_hi:[1,0] neg_lo:[0,1] neg_hi:[0,1]
    v_pk_add_f32 v[164:165], v[164:165], v[154:155] op_sel_hi:[1,0] neg_lo:[0,1] neg_hi:[0,1]
    v_pk_add_f32 v[166:167], v[166:167], v[154:155] op_sel_hi:[1,0] neg_lo:[0,1] neg_hi:[0,1]
    v_pk_add_f32 v[168:169], v[168:169], v[154:155] op_sel_hi:[1,0] neg_lo:[0,1] neg_hi:[0,1]
    v_pk_add_f32 v[170:171], v[170:171], v[154:155] op_sel_hi:[1,0] neg_lo:[0,1] neg_hi:[0,1]
    v_pk_add_f32 v[172:173], v[172:173], v[154:155] op_sel_hi:[1,0] neg_lo:[0,1] neg_hi:[0,1]
    v_pk_add_f32 v[174:175], v[174:175], v[154:155] op_sel_hi:[1,0] neg_lo:[0,1] neg_hi:[0,1]
    v_cvt_pk_bf16_f32 v96, v160, v161
    v_cvt_pk_bf16_f32 v97, v162, v163
    v_cvt_pk_bf16_f32 v98, v164, v165
    v_cvt_pk_bf16_f32 v99, v166, v167
    v_cvt_pk_bf16_f32 v100, v168, v169
    v_cvt_pk_bf16_f32 v101, v170, v171
    s_add_u32 s26, s24, 0x2a0000
    s_add_u32 m0, s29, 0x15000
    s_nop 0
    buffer_load_dwordx4 v136, s[16:19], s26 offen lds
    v_cvt_pk_bf16_f32 v102, v172, v173
    v_cvt_pk_bf16_f32 v103, v174, v175
    v_lshlrev_b32 v160, 16, v96
    v_and_b32 v161, 0xffff0000, v96
    v_lshlrev_b32 v162, 16, v97
    v_and_b32 v163, 0xffff0000, v97
    v_lshlrev_b32 v164, 16, v98
    v_and_b32 v165, 0xffff0000, v98
    v_lshlrev_b32 v166, 16, v99
    v_and_b32 v167, 0xffff0000, v99
    v_lshlrev_b32 v168, 16, v100
    v_and_b32 v169, 0xffff0000, v100
    v_lshlrev_b32 v170, 16, v101
    v_and_b32 v171, 0xffff0000, v101
    v_lshlrev_b32 v172, 16, v102
    v_and_b32 v173, 0xffff0000, v102
    v_lshlrev_b32 v174, 16, v103
    v_and_b32 v175, 0xffff0000, v103
    v_pk_mul_f32 v[160:161], v[160:161], v[152:153] op_sel_hi:[1,0]
    v_pk_mul_f32 v[162:163], v[162:163], v[152:153] op_sel_hi:[1,0]
    v_pk_mul_f32 v[164:165], v[164:165], v[152:153] op_sel_hi:[1,0]
    v_pk_mul_f32 v[166:167], v[166:167], v[152:153] op_sel_hi:[1,0]
    v_pk_mul_f32 v[168:169], v[168:169], v[152:153] op_sel_hi:[1,0]
    v_pk_mul_f32 v[170:171], v[170:171], v[152:153] op_sel_hi:[1,0]
    v_pk_mul_f32 v[172:173], v[172:173], v[152:153] op_sel_hi:[1,0]
    v_pk_mul_f32 v[174:175], v[174:175], v[152:153] op_sel_hi:[1,0]
    v_cvt_pk_bf16_f32 v160, v160, v161
    v_cvt_pk_bf16_f32 v162, v162, v163
    v_cvt_pk_bf16_f32 v164, v164, v165
    v_cvt_pk_bf16_f32 v166, v166, v167
    v_cvt_pk_bf16_f32 v168, v168, v169
    v_cvt_pk_bf16_f32 v170, v170, v171
    v_cvt_pk_bf16_f32 v172, v172, v173
    v_cvt_pk_bf16_f32 v174, v174, v175
    v_accvgpr_write_b32 a96, v160
    v_accvgpr_write_b32 a97, v162
    v_accvgpr_write_b32 a98, v164
    v_accvgpr_write_b32 a99, v166
    v_accvgpr_write_b32 a100, v168
    v_accvgpr_write_b32 a101, v170
    v_accvgpr_write_b32 a102, v172
    v_accvgpr_write_b32 a103, v174
    v_lshlrev_b32 v160, 16, v104
    v_and_b32 v161, 0xffff0000, v104
    v_lshlrev_b32 v162, 16, v105
    v_and_b32 v163, 0xffff0000, v105
    v_lshlrev_b32 v164, 16, v106
    v_and_b32 v165, 0xffff0000, v106
    v_lshlrev_b32 v166, 16, v107
    v_and_b32 v167, 0xffff0000, v107
    s_add_u32 s26, s24, 0x2c0000
    s_add_u32 m0, s29, 0x16000
    s_nop 0
    buffer_load_dwordx4 v136, s[16:19], s26 offen lds
    v_lshlrev_b32 v168, 16, v108
    v_and_b32 v169, 0xffff0000, v108
    v_lshlrev_b32 v170, 16, v109
    v_and_b32 v171, 0xffff0000, v109
    v_lshlrev_b32 v172, 16, v110
    v_and_b32 v173, 0xffff0000, v110
    v_lshlrev_b32 v174, 16, v111
    v_and_b32 v175, 0xffff0000, v111
    v_pk_add_f32 v[160:161], v[160:161], v[154:155] op_sel_hi:[1,0] neg_lo:[0,1] neg_hi:[0,1]
    v_pk_add_f32 v[162:163], v[162:163], v[154:155] op_sel_hi:[1,0] neg_lo:[0,1] neg_hi:[0,1]
    v_pk_add_f32 v[164:165], v[164:165], v[154:155] op_sel_hi:[1,0] neg_lo:[0,1] neg_hi:[0,1]
    v_pk_add_f32 v[166:167], v[166:167], v[154:155] op_sel_hi:[1,0] neg_lo:[0,1] neg_hi:[0,1]
    v_pk_add_f32 v[168:169], v[168:169], v[154:155] op_sel_hi:[1,0] neg_lo:[0,1] neg_hi:[0,1]
    v_pk_add_f32 v[170:171], v[170:171], v[154:155] op_sel_hi:[1,0] neg_lo:[0,1] neg_hi:[0,1]
    v_pk_add_f32 v[172:173], v[172:173], v[154:155] op_sel_hi:[1,0] neg_lo:[0,1] neg_hi:[0,1]
    v_pk_add_f32 v[174:175], v[174:175], v[154:155] op_sel_hi:[1,0] neg_lo:[0,1] neg_hi:[0,1]
    v_cvt_pk_bf16_f32 v104, v160, v161
    v_cvt_pk_bf16_f32 v105, v162, v163
    v_cvt_pk_bf16_f32 v106, v164, v165
    v_cvt_pk_bf16_f32 v107, v166, v167
    v_cvt_pk_bf16_f32 v108, v168, v169
    v_cvt_pk_bf16_f32 v109, v170, v171
    v_cvt_pk_bf16_f32 v110, v172, v173
    v_cvt_pk_bf16_f32 v111, v174, v175
    v_lshlrev_b32 v160, 16, v104
    v_and_b32 v161, 0xffff0000, v104
    v_lshlrev_b32 v162, 16, v105
    v_and_b32 v163, 0xffff0000, v105
    v_lshlrev_b32 v164, 16, v106
    v_and_b32 v165, 0xffff0000, v106
    v_lshlrev_b32 v166, 16, v107
    v_and_b32 v167, 0xffff0000, v107
    v_lshlrev_b32 v168, 16, v108
    v_and_b32 v169, 0xffff0000, v108
    v_lshlrev_b32 v170, 16, v109
    v_and_b32 v171, 0xffff0000, v109
    v_lshlrev_b32 v172, 16, v110
    v_and_b32 v173, 0xffff0000, v110
    v_lshlrev_b32 v174, 16, v111
    v_and_b32 v175, 0xffff0000, v111
    v_pk_mul_f32 v[160:161], v[160:161], v[152:153] op_sel_hi:[1,0]
    v_pk_mul_f32 v[162:163], v[162:163], v[152:153] op_sel_hi:[1,0]
    v_pk_mul_f32 v[164:165], v[164:165], v[152:153] op_sel_hi:[1,0]
    v_pk_mul_f32 v[166:167], v[166:167], v[152:153] op_sel_hi:[1,0]
    v_pk_mul_f32 v[168:169], v[168:169], v[152:153] op_sel_hi:[1,0]
    v_pk_mul_f32 v[170:171], v[170:171], v[152:153] op_sel_hi:[1,0]
    v_pk_mul_f32 v[172:173], v[172:173], v[152:153] op_sel_hi:[1,0]
    v_pk_mul_f32 v[174:175], v[174:175], v[152:153] op_sel_hi:[1,0]
    v_cvt_pk_bf16_f32 v160, v160, v161
    v_cvt_pk_bf16_f32 v162, v162, v163
    s_add_u32 s26, s24, 0x2e0000
    s_add_u32 m0, s29, 0x17000
    s_nop 0
    buffer_load_dwordx4 v136, s[16:19], s26 offen lds
    v_cvt_pk_bf16_f32 v164, v164, v165
    v_cvt_pk_bf16_f32 v166, v166, v167
    v_cvt_pk_bf16_f32 v168, v168, v169
    v_cvt_pk_bf16_f32 v170, v170, v171
    v_cvt_pk_bf16_f32 v172, v172, v173
    v_cvt_pk_bf16_f32 v174, v174, v175
    v_accvgpr_write_b32 a104, v160
    v_accvgpr_write_b32 a105, v162
    v_accvgpr_write_b32 a106, v164
    v_accvgpr_write_b32 a107, v166
    v_accvgpr_write_b32 a108, v168
    v_accvgpr_write_b32 a109, v170
    v_accvgpr_write_b32 a110, v172
    v_accvgpr_write_b32 a111, v174
    v_lshlrev_b32 v160, 16, v112
    v_and_b32 v161, 0xffff0000, v112
    v_lshlrev_b32 v162, 16, v113
    v_and_b32 v163, 0xffff0000, v113
    v_lshlrev_b32 v164, 16, v114
    v_and_b32 v165, 0xffff0000, v114
    v_lshlrev_b32 v166, 16, v115
    v_and_b32 v167, 0xffff0000, v115
    v_lshlrev_b32 v168, 16, v116
    v_and_b32 v169, 0xffff0000, v116
    v_lshlrev_b32 v170, 16, v117
    v_and_b32 v171, 0xffff0000, v117
    v_lshlrev_b32 v172, 16, v118
    v_and_b32 v173, 0xffff0000, v118
    v_lshlrev_b32 v174, 16, v119
    v_and_b32 v175, 0xffff0000, v119
    v_pk_add_f32 v[160:161], v[160:161], v[154:155] op_sel_hi:[1,0] neg_lo:[0,1] neg_hi:[0,1]
    v_pk_add_f32 v[162:163], v[162:163], v[154:155] op_sel_hi:[1,0] neg_lo:[0,1] neg_hi:[0,1]
    v_pk_add_f32 v[164:165], v[164:165], v[154:155] op_sel_hi:[1,0] neg_lo:[0,1] neg_hi:[0,1]
    v_pk_add_f32 v[166:167], v[166:167], v[154:155] op_sel_hi:[1,0] neg_lo:[0,1] neg_hi:[0,1]
    v_pk_add_f32 v[168:169], v[168:169], v[154:155] op_sel_hi:[1,0] neg_lo:[0,1] neg_hi:[0,1]
    v_pk_add_f32 v[170:171], v[170:171], v[154:155] op_sel_hi:[1,0] neg_lo:[0,1] neg_hi:[0,1]
    v_pk_add_f32 v[172:173], v[172:173], v[154:155] op_sel_hi:[1,0] neg_lo:[0,1] neg_hi:[0,1]
    v_pk_add_f32 v[174:175], v[174:175], v[154:155] op_sel_hi:[1,0] neg_lo:[0,1] neg_hi:[0,1]
    v_cvt_pk_bf16_f32 v112, v160, v161
    v_cvt_pk_bf16_f32 v113, v162, v163
    v_cvt_pk_bf16_f32 v114, v164, v165
    v_cvt_pk_bf16_f32 v115, v166, v167
    v_cvt_pk_bf16_f32 v116, v168, v169
    v_cvt_pk_bf16_f32 v117, v170, v171
    v_cvt_pk_bf16_f32 v118, v172, v173
    v_cvt_pk_bf16_f32 v119, v174, v175
    v_lshlrev_b32 v160, 16, v112
    v_and_b32 v161, 0xffff0000, v112
    v_lshlrev_b32 v162, 16, v113
    v_and_b32 v163, 0xffff0000, v113
    v_lshlrev_b32 v138, 2, v137
    v_lshlrev_b32 v138, 3, v137
    s_sub_u32 s26, s101, 96
    s_lshl_b32 s26, s26, 2
    s_add_u32 s26, s26, s21
    s_min_u32 s26, s26, 512
    s_lshl_b32 s26, s26, 13
    s_cmp_eq_u32 s41, 0
    s_cselect_b32 s6, 0x400000, 0
    s_mov_b32 s7, 0x20000
    s_mov_b32 s4, s66
    s_and_b32 s5, s67, 0xffff
    buffer_load_dword v143, v138, s[4:7], s26 offen
    v_lshlrev_b32 v164, 16, v114
    v_and_b32 v165, 0xffff0000, v114
    v_lshlrev_b32 v166, 16, v115
    v_and_b32 v167, 0xffff0000, v115
    v_lshlrev_b32 v168, 16, v116
    v_and_b32 v169, 0xffff0000, v116
    v_lshlrev_b32 v170, 16, v117
    v_and_b32 v171, 0xffff0000, v117
    v_lshlrev_b32 v172, 16, v118
    v_and_b32 v173, 0xffff0000, v118
    v_lshlrev_b32 v174, 16, v119
    v_and_b32 v175, 0xffff0000, v119
    v_pk_mul_f32 v[160:161], v[160:161], v[152:153] op_sel_hi:[1,0]
    v_pk_mul_f32 v[162:163], v[162:163], v[152:153] op_sel_hi:[1,0]
    v_pk_mul_f32 v[164:165], v[164:165], v[152:153] op_sel_hi:[1,0]
    v_pk_mul_f32 v[166:167], v[166:167], v[152:153] op_sel_hi:[1,0]
    v_pk_mul_f32 v[168:169], v[168:169], v[152:153] op_sel_hi:[1,0]
    v_pk_mul_f32 v[170:171], v[170:171], v[152:153] op_sel_hi:[1,0]
    v_pk_mul_f32 v[172:173], v[172:173], v[152:153] op_sel_hi:[1,0]
    v_pk_mul_f32 v[174:175], v[174:175], v[152:153] op_sel_hi:[1,0]
    v_cvt_pk_bf16_f32 v160, v160, v161
    v_cvt_pk_bf16_f32 v162, v162, v163
    v_cvt_pk_bf16_f32 v164, v164, v165
    v_cvt_pk_bf16_f32 v166, v166, v167
    v_cvt_pk_bf16_f32 v168, v168, v169
    v_cvt_pk_bf16_f32 v170, v170, v171
    v_cvt_pk_bf16_f32 v172, v172, v173
    v_cvt_pk_bf16_f32 v174, v174, v175
    v_accvgpr_write_b32 a112, v160
    v_accvgpr_write_b32 a113, v162
    v_accvgpr_write_b32 a114, v164
    v_accvgpr_write_b32 a115, v166
    v_accvgpr_write_b32 a116, v168
    v_accvgpr_write_b32 a117, v170
    v_accvgpr_write_b32 a118, v172
    v_accvgpr_write_b32 a119, v174
    v_lshlrev_b32 v160, 16, v120
    v_and_b32 v161, 0xffff0000, v120
    v_lshlrev_b32 v162, 16, v121
    v_and_b32 v163, 0xffff0000, v121
    v_lshlrev_b32 v164, 16, v122
    v_and_b32 v165, 0xffff0000, v122
    v_lshlrev_b32 v166, 16, v123
    v_and_b32 v167, 0xffff0000, v123
    v_lshlrev_b32 v168, 16, v124
    v_and_b32 v169, 0xffff0000, v124
    v_lshlrev_b32 v170, 16, v125
    v_and_b32 v171, 0xffff0000, v125
    v_lshlrev_b32 v172, 16, v126
    v_and_b32 v173, 0xffff0000, v126
    v_lshlrev_b32 v174, 16, v127
    v_and_b32 v175, 0xffff0000, v127
    v_pk_add_f32 v[160:161], v[160:161], v[154:155] op_sel_hi:[1,0] neg_lo:[0,1] neg_hi:[0,1]
    v_pk_add_f32 v[162:163], v[162:163], v[154:155] op_sel_hi:[1,0] neg_lo:[0,1] neg_hi:[0,1]
    v_pk_add_f32 v[164:165], v[164:165], v[154:155] op_sel_hi:[1,0] neg_lo:[0,1] neg_hi:[0,1]
    v_pk_add_f32 v[166:167], v[166:167], v[154:155] op_sel_hi:[1,0] neg_lo:[0,1] neg_hi:[0,1]
    v_pk_add_f32 v[168:169], v[168:169], v[154:155] op_sel_hi:[1,0] neg_lo:[0,1] neg_hi:[0,1]
    v_pk_add_f32 v[170:171], v[170:171], v[154:155] op_sel_hi:[1,0] neg_lo:[0,1] neg_hi:[0,1]
    v_pk_add_f32 v[172:173], v[172:173], v[154:155] op_sel_hi:[1,0] neg_lo:[0,1] neg_hi:[0,1]
    v_pk_add_f32 v[174:175], v[174:175], v[154:155] op_sel_hi:[1,0] neg_lo:[0,1] neg_hi:[0,1]
    v_cvt_pk_bf16_f32 v120, v160, v161
    v_cvt_pk_bf16_f32 v121, v162, v163
    v_cvt_pk_bf16_f32 v122, v164, v165
    v_cvt_pk_bf16_f32 v123, v166, v167
    v_cvt_pk_bf16_f32 v124, v168, v169
    v_cvt_pk_bf16_f32 v125, v170, v171
    v_cvt_pk_bf16_f32 v126, v172, v173
    v_cvt_pk_bf16_f32 v127, v174, v175
    v_lshlrev_b32 v160, 16, v120
    v_and_b32 v161, 0xffff0000, v120
    v_lshlrev_b32 v162, 16, v121
    v_and_b32 v163, 0xffff0000, v121
    v_lshlrev_b32 v164, 16, v122
    v_and_b32 v165, 0xffff0000, v122
    v_lshlrev_b32 v166, 16, v123
    v_and_b32 v167, 0xffff0000, v123
    v_lshlrev_b32 v168, 16, v124
    v_and_b32 v169, 0xffff0000, v124
    v_lshlrev_b32 v170, 16, v125
    v_and_b32 v171, 0xffff0000, v125
    v_lshlrev_b32 v172, 16, v126
    v_and_b32 v173, 0xffff0000, v126
    v_lshlrev_b32 v174, 16, v127
    v_and_b32 v175, 0xffff0000, v127
    v_pk_mul_f32 v[160:161], v[160:161], v[152:153] op_sel_hi:[1,0]
    v_pk_mul_f32 v[162:163], v[162:163], v[152:153] op_sel_hi:[1,0]
    v_pk_mul_f32 v[164:165], v[164:165], v[152:153] op_sel_hi:[1,0]
    v_pk_mul_f32 v[166:167], v[166:167], v[152:153] op_sel_hi:[1,0]
    v_pk_mul_f32 v[168:169], v[168:169], v[152:153] op_sel_hi:[1,0]
    v_pk_mul_f32 v[170:171], v[170:171], v[152:153] op_sel_hi:[1,0]
    v_pk_mul_f32 v[172:173], v[172:173], v[152:153] op_sel_hi:[1,0]
    v_pk_mul_f32 v[174:175], v[174:175], v[152:153] op_sel_hi:[1,0]
    v_cvt_pk_bf16_f32 v160, v160, v161
    v_cvt_pk_bf16_f32 v162, v162, v163
    v_cvt_pk_bf16_f32 v164, v164, v165
    v_cvt_pk_bf16_f32 v166, v166, v167
    v_cvt_pk_bf16_f32 v168, v168, v169
    v_cvt_pk_bf16_f32 v170, v170, v171
    v_cvt_pk_bf16_f32 v172, v172, v173
    v_cvt_pk_bf16_f32 v174, v174, v175
    v_accvgpr_write_b32 a120, v160
    v_accvgpr_write_b32 a121, v162
    v_accvgpr_write_b32 a122, v164
    v_accvgpr_write_b32 a123, v166
    v_accvgpr_write_b32 a124, v168
    v_accvgpr_write_b32 a125, v170
    v_accvgpr_write_b32 a126, v172
    v_accvgpr_write_b32 a127, v174
    buffer_load_dwordx2 v[140:141], off, s[92:95], 0 offset:36 sc1
    s_nop 3
L_p1_unit:
    s_cmp_ge_u32 s38, 96
    s_cbranch_scc1 L_p1_end
    s_lshr_b32 s26, s38, 5
    s_add_u32 s27, s26, 1
    s_lshl_b32 s25, s27, 24
    s_lshl_b32 s27, s20, 2
    s_add_u32 s27, s27, s21
    s_lshl_b32 s27, s27, 5
    s_and_b32 s28, s38, 31
    s_add_u32 s27, s27, s28
    s_lshl_b32 s27, s27, 13
    s_add_u32 s25, s25, s27
    s_lshr_b32 s26, s38, 5
    s_cmp_eq_u32 s26, 1
    s_cbranch_scc1 L_p1_v
    s_waitcnt vmcnt(16)
    s_barrier
    ds_read_b64_tr_b16 v[64:65], v128
    ds_read_b64_tr_b16 v[66:67], v128 offset:1024
    ds_read_b64_tr_b16 v[68:69], v129
    ds_read_b64_tr_b16 v[70:71], v129 offset:1024
    ds_read_b64_tr_b16 v[72:73], v130
    ds_read_b64_tr_b16 v[74:75], v130 offset:1024
    ds_read_b64_tr_b16 v[76:77], v131
    ds_read_b64_tr_b16 v[78:79], v131 offset:1024
    ds_read_b64_tr_b16 v[80:81], v132
    ds_read_b64_tr_b16 v[82:83], v132 offset:1024
    ds_read_b64_tr_b16 v[84:85], v133
    ds_read_b64_tr_b16 v[86:87], v133 offset:1024
    ds_read_b64_tr_b16 v[88:89], v134
    ds_read_b64_tr_b16 v[90:91], v134 offset:1024
    s_waitcnt lgkmcnt(12)
    v_mfma_f32_16x16x32_bf16 v[0:3], v[64:67], a[0:3], 0
    ds_read_b64_tr_b16 v[92:93], v135
    v_mfma_f32_16x16x32_bf16 v[4:7], v[64:67], a[64:67], 0
    ds_read_b64_tr_b16 v[94:95], v135 offset:1024
    s_add_u32 s26, s24, 0x300000
    s_add_u32 m0, s29, 0x18000
    s_nop 0
    buffer_load_dwordx4 v136, s[16:19], s26 offen lds
    s_waitcnt lgkmcnt(12)
    v_mfma_f32_16x16x32_bf16 v[8:11], v[68:71], a[0:3], 0
    ds_read_b64_tr_b16 v[96:97], v128 offset:8192
    v_mfma_f32_16x16x32_bf16 v[12:15], v[68:71], a[64:67], 0
    ds_read_b64_tr_b16 v[98:99], v128 offset:9216
    s_add_u32 s26, s24, 0x320000
    s_add_u32 m0, s29, 0x19000
    s_nop 0
    buffer_load_dwordx4 v136, s[16:19], s26 offen lds
    s_waitcnt lgkmcnt(12)
    v_mfma_f32_16x16x32_bf16 v[16:19], v[72:75], a[0:3], 0
    ds_read_b64_tr_b16 v[100:101], v129 offset:8192
    v_mfma_f32_16x16x32_bf16 v[20:23], v[72:75], a[64:67], 0
    ds_read_b64_tr_b16 v[102:103], v129 offset:9216
    s_add_u32 s26, s24, 0x340000
    s_add_u32 m0, s29, 0x1a000
    s_nop 0
    buffer_load_dwordx4 v136, s[16:19], s26 offen lds
    s_waitcnt lgkmcnt(12)
    v_mfma_f32_16x16x32_bf16 v[24:27], v[76:79], a[0:3], 0
    ds_read_b64_tr_b16 v[104:105], v130 offset:8192
    v_mfma_f32_16x16x32_bf16 v[28:31], v[76:79], a[64:67], 0
    ds_read_b64_tr_b16 v[106:107], v130 offset:9216
    s_add_u32 s26, s24, 0x360000
    s_add_u32 m0, s29, 0x1b000
    s_nop 0
    buffer_load_dwordx4 v136, s[16:19], s26 offen lds
    s_waitcnt lgkmcnt(12)
    v_mfma_f32_16x16x32_bf16 v[32:35], v[80:83], a[0:3], 0
    ds_read_b64_tr_b16 v[108:109], v131 offset:8192
    v_mfma_f32_16x16x32_bf16 v[36:39], v[80:83], a[64:67], 0
    ds_read_b64_tr_b16 v[110:111], v131 offset:9216
    s_add_u32 s26, s24, 0x380000
    s_add_u32 m0, s29, 0x1c000
    s_nop 0
    buffer_load_dwordx4 v136, s[16:19], s26 offen lds
    s_waitcnt lgkmcnt(12)
    v_mfma_f32_16x16x32_bf16 v[40:43], v[84:87], a[0:3], 0
    ds_read_b64_tr_b16 v[112:113], v132 offset:8192
    v_mfma_f32_16x16x32_bf16 v[44:47], v[84:87], a[64:67], 0
    ds_read_b64_tr_b16 v[114:115], v132 offset:9216
    s_add_u32 s26, s24, 0x3a0000
    s_add_u32 m0, s29, 0x1d000
    s_nop 0
    buffer_load_dwordx4 v136, s[16:19], s26 offen lds
    s_waitcnt lgkmcnt(12)
    v_mfma_f32_16x16x32_bf16 v[48:51], v[88:91], a[0:3], 0
    ds_read_b64_tr_b16 v[116:117], v133 offset:8192
    v_mfma_f32_16x16x32_bf16 v[52:55], v[88:91], a[64:67], 0
    ds_read_b64_tr_b16 v[118:119], v133 offset:9216
    s_add_u32 s26, s24, 0x3c0000
    s_add_u32 m0, s29, 0x1e000
    s_nop 0
    buffer_load_dwordx4 v136, s[16:19], s26 offen lds
    s_waitcnt lgkmcnt(12)
    v_mfma_f32_16x16x32_bf16 v[56:59], v[92:95], a[0:3], 0
    ds_read_b64_tr_b16 v[120:121], v134 offset:8192
    v_mfma_f32_16x16x32_bf16 v[60:63], v[92:95], a[64:67], 0
    ds_read_b64_tr_b16 v[122:123], v134 offset:9216
    s_add_u32 s26, s24, 0x3e0000
    s_add_u32 m0, s29, 0x1f000
    s_nop 0
    buffer_load_dwordx4 v136, s[16:19], s26 offen lds
    s_waitcnt lgkmcnt(12)
    v_mfma_f32_16x16x32_bf16 v[0:3], v[96:99], a[4:7], v[0:3]
    ds_read_b64_tr_b16 v[124:125], v135 offset:8192
    v_mfma_f32_16x16x32_bf16 v[4:7], v[96:99], a[68:71], v[4:7]
    ds_read_b64_tr_b16 v[126:127], v135 offset:9216
    s_waitcnt lgkmcnt(12)
    v_mfma_f32_16x16x32_bf16 v[8:11], v[100:103], a[4:7], v[8:11]
    ds_read_b64_tr_b16 v[64:65], v128 offset:16384
    v_mfma_f32_16x16x32_bf16 v[12:15], v[100:103], a[68:71], v[12:15]
    ds_read_b64_tr_b16 v[66:67], v128 offset:17408
    s_waitcnt lgkmcnt(12)
    v_mfma_f32_16x16x32_bf16 v[16:19], v[104:107], a[4:7], v[16:19]
    ds_read_b64_tr_b16 v[68:69], v129 offset:16384
    v_mfma_f32_16x16x32_bf16 v[20:23], v[104:107], a[68:71], v[20:23]
    ds_read_b64_tr_b16 v[70:71], v129 offset:17408
    s_waitcnt lgkmcnt(12)
    v_mfma_f32_16x16x32_bf16 v[24:27], v[108:111], a[4:7], v[24:27]
    ds_read_b64_tr_b16 v[72:73], v130 offset:16384
    v_mfma_f32_16x16x32_bf16 v[28:31], v[108:111], a[68:71], v[28:31]
    ds_read_b64_tr_b16 v[74:75], v130 offset:17408
    s_waitcnt lgkmcnt(12)
    v_mfma_f32_16x16x32_bf16 v[32:35], v[112:115], a[4:7], v[32:35]
    ds_read_b64_tr_b16 v[76:77], v131 offset:16384
    v_mfma_f32_16x16x32_bf16 v[36:39], v[112:115], a[68:71], v[36:39]
    ds_read_b64_tr_b16 v[78:79], v131 offset:17408
    s_waitcnt lgkmcnt(12)
    v_mfma_f32_16x16x32_bf16 v[40:43], v[116:119], a[4:7], v[40:43]
    ds_read_b64_tr_b16 v[80:81], v132 offset:16384
    v_mfma_f32_16x16x32_bf16 v[44:47], v[116:119], a[68:71], v[44:47]
    ds_read_b64_tr_b16 v[82:83], v132 offset:17408
    s_waitcnt lgkmcnt(12)
    v_mfma_f32_16x16x32_bf16 v[48:51], v[120:123], a[4:7], v[48:51]
    ds_read_b64_tr_b16 v[84:85], v133 offset:16384
    v_mfma_f32_16x16x32_bf16 v[52:55], v[120:123], a[68:71], v[52:55]
    ds_read_b64_tr_b16 v[86:87], v133 offset:17408
    s_waitcnt lgkmcnt(12)
    v_mfma_f32_16x16x32_bf16 v[56:59], v[124:127], a[4:7], v[56:59]
    ds_read_b64_tr_b16 v[88:89], v134 offset:16384
    v_mfma_f32_16x16x32_bf16 v[60:63], v[124:127], a[68:71], v[60:63]
    ds_read_b64_tr_b16 v[90:91], v134 offset:17408
    s_waitcnt lgkmcnt(12)
    v_mfma_f32_16x16x32_bf16 v[0:3], v[64:67], a[8:11], v[0:3]
    ds_read_b64_tr_b16 v[92:93], v135 offset:16384
    v_mfma_f32_16x16x32_bf16 v[4:7], v[64:67], a[72:75], v[4:7]
    ds_read_b64_tr_b16 v[94:95], v135 offset:17408
    s_waitcnt lgkmcnt(12)
    v_mfma_f32_16x16x32_bf16 v[8:11], v[68:71], a[8:11], v[8:11]
    ds_read_b64_tr_b16 v[96:97], v128 offset:24576
    v_mfma_f32_16x16x32_bf16 v[12:15], v[68:71], a[72:75], v[12:15]
    ds_read_b64_tr_b16 v[98:99], v128 offset:25600
    s_waitcnt lgkmcnt(12)
    v_mfma_f32_16x16x32_bf16 v[16:19], v[72:75], a[8:11], v[16:19]
    ds_read_b64_tr_b16 v[100:101], v129 offset:24576
    v_mfma_f32_16x16x32_bf16 v[20:23], v[72:75], a[72:75], v[20:23]
    ds_read_b64_tr_b16 v[102:103], v129 offset:25600
    s_waitcnt lgkmcnt(12)
    v_mfma_f32_16x16x32_bf16 v[24:27], v[76:79], a[8:11], v[24:27]
    ds_read_b64_tr_b16 v[104:105], v130 offset:24576
    v_mfma_f32_16x16x32_bf16 v[28:31], v[76:79], a[72:75], v[28:31]
    ds_read_b64_tr_b16 v[106:107], v130 offset:25600
    s_waitcnt lgkmcnt(12)
    v_mfma_f32_16x16x32_bf16 v[32:35], v[80:83], a[8:11], v[32:35]
    ds_read_b64_tr_b16 v[108:109], v131 offset:24576
    v_mfma_f32_16x16x32_bf16 v[36:39], v[80:83], a[72:75], v[36:39]
    ds_read_b64_tr_b16 v[110:111], v131 offset:25600
    s_waitcnt lgkmcnt(12)
    v_mfma_f32_16x16x32_bf16 v[40:43], v[84:87], a[8:11], v[40:43]
    ds_read_b64_tr_b16 v[112:113], v132 offset:24576
    v_mfma_f32_16x16x32_bf16 v[44:47], v[84:87], a[72:75], v[44:47]
    ds_read_b64_tr_b16 v[114:115], v132 offset:25600
    s_waitcnt lgkmcnt(12)
    v_mfma_f32_16x16x32_bf16 v[48:51], v[88:91], a[8:11], v[48:51]
    ds_read_b64_tr_b16 v[116:117], v133 offset:24576
    v_mfma_f32_16x16x32_bf16 v[52:55], v[88:91], a[72:75], v[52:55]
    ds_read_b64_tr_b16 v[118:119], v133 offset:25600
    s_waitcnt lgkmcnt(12)
    v_mfma_f32_16x16x32_bf16 v[56:59], v[92:95], a[8:11], v[56:59]
    ds_read_b64_tr_b16 v[120:121], v134 offset:24576
    v_mfma_f32_16x16x32_bf16 v[60:63], v[92:95], a[72:75], v[60:63]
    ds_read_b64_tr_b16 v[122:123], v134 offset:25600
    s_waitcnt lgkmcnt(12)
    v_mfma_f32_16x16x32_bf16 v[0:3], v[96:99], a[12:15], v[0:3]
    ds_read_b64_tr_b16 v[124:125], v135 offset:24576
    v_mfma_f32_16x16x32_bf16 v[4:7], v[96:99], a[76:79], v[4:7]
    ds_read_b64_tr_b16 v[126:127], v135 offset:25600
    s_waitcnt lgkmcnt(12)
    v_mfma_f32_16x16x32_bf16 v[8:11], v[100:103], a[12:15], v[8:11]
    v_mfma_f32_16x16x32_bf16 v[12:15], v[100:103], a[76:79], v[12:15]
    s_waitcnt lgkmcnt(10)
    v_mfma_f32_16x16x32_bf16 v[16:19], v[104:107], a[12:15], v[16:19]
    v_mfma_f32_16x16x32_bf16 v[20:23], v[104:107], a[76:79], v[20:23]
    s_waitcnt lgkmcnt(8)
    v_mfma_f32_16x16x32_bf16 v[24:27], v[108:111], a[12:15], v[24:27]
    v_mfma_f32_16x16x32_bf16 v[28:31], v[108:111], a[76:79], v[28:31]
    s_waitcnt lgkmcnt(6)
    v_mfma_f32_16x16x32_bf16 v[32:35], v[112:115], a[12:15], v[32:35]
    v_mfma_f32_16x16x32_bf16 v[36:39], v[112:115], a[76:79], v[36:39]
    s_waitcnt lgkmcnt(4)
    v_mfma_f32_16x16x32_bf16 v[40:43], v[116:119], a[12:15], v[40:43]
    v_mfma_f32_16x16x32_bf16 v[44:47], v[116:119], a[76:79], v[44:47]
    s_waitcnt lgkmcnt(2)
    v_mfma_f32_16x16x32_bf16 v[48:51], v[120:123], a[12:15], v[48:51]
    v_mfma_f32_16x16x32_bf16 v[52:55], v[120:123], a[76:79], v[52:55]
    s_waitcnt lgkmcnt(0)
    v_mfma_f32_16x16x32_bf16 v[56:59], v[124:127], a[12:15], v[56:59]
    v_mfma_f32_16x16x32_bf16 v[60:63], v[124:127], a[76:79], v[60:63]
    s_waitcnt vmcnt(16)
    s_barrier
    ds_read_b64_tr_b16 v[64:65], v128 offset:32768
    ds_read_b64_tr_b16 v[66:67], v128 offset:33792
    ds_read_b64_tr_b16 v[68:69], v129 offset:32768
    ds_read_b64_tr_b16 v[70:71], v129 offset:33792
    ds_read_b64_tr_b16 v[72:73], v130 offset:32768
    ds_read_b64_tr_b16 v[74:75], v130 offset:33792
    ds_read_b64_tr_b16 v[76:77], v131 offset:32768
    ds_read_b64_tr_b16 v[78:79], v131 offset:33792
    ds_read_b64_tr_b16 v[80:81], v132 offset:32768
    ds_read_b64_tr_b16 v[82:83], v132 offset:33792
    ds_read_b64_tr_b16 v[84:85], v133 offset:32768
    ds_read_b64_tr_b16 v[86:87], v133 offset:33792
    ds_read_b64_tr_b16 v[88:89], v134 offset:32768
    ds_read_b64_tr_b16 v[90:91], v134 offset:33792
    s_add_u32 s39, s39, s37
    s_lshr_b32 s26, s39, 5
    s_cmp_eq_u32 s26, 0
    s_cselect_b64 s[16:17], s[62:63], s[60:61]
    s_cmp_eq_u32 s26, 1
    s_cselect_b64 s[16:17], s[64:65], s[16:17]
    s_and_b32 s17, s17, 0xffff
    s_cmp_lt_u32 s39, 96
    s_cselect_b32 s18, 0x400000, 0
    s_and_b32 s24, s39, 31
    s_lshl_b32 s24, s24, 8
    s_waitcnt lgkmcnt(12)
    v_mfma_f32_16x16x32_bf16 v[0:3], v[64:67], a[16:19], v[0:3]
    ds_read_b64_tr_b16 v[92:93], v135 offset:32768
    v_mfma_f32_16x16x32_bf16 v[4:7], v[64:67], a[80:83], v[4:7]
    ds_read_b64_tr_b16 v[94:95], v135 offset:33792
    s_add_u32 s26, s24, 0x0
    s_add_u32 m0, s29, 0x0
    s_nop 0
    buffer_load_dwordx4 v136, s[16:19], s26 offen lds
    s_waitcnt lgkmcnt(12)
    v_mfma_f32_16x16x32_bf16 v[8:11], v[68:71], a[16:19], v[8:11]
    ds_read_b64_tr_b16 v[96:97], v128 offset:40960
    v_mfma_f32_16x16x32_bf16 v[12:15], v[68:71], a[80:83], v[12:15]
    ds_read_b64_tr_b16 v[98:99], v128 offset:41984
    s_add_u32 s26, s24, 0x20000
    s_add_u32 m0, s29, 0x1000
    s_nop 0
    buffer_load_dwordx4 v136, s[16:19], s26 offen lds
    s_waitcnt lgkmcnt(12)
    v_mfma_f32_16x16x32_bf16 v[16:19], v[72:75], a[16:19], v[16:19]
    ds_read_b64_tr_b16 v[100:101], v129 offset:40960
    v_mfma_f32_16x16x32_bf16 v[20:23], v[72:75], a[80:83], v[20:23]
    ds_read_b64_tr_b16 v[102:103], v129 offset:41984
    s_add_u32 s26, s24, 0x40000
    s_add_u32 m0, s29, 0x2000
    s_nop 0
    buffer_load_dwordx4 v136, s[16:19], s26 offen lds
    s_waitcnt lgkmcnt(12)
    v_mfma_f32_16x16x32_bf16 v[24:27], v[76:79], a[16:19], v[24:27]
    ds_read_b64_tr_b16 v[104:105], v130 offset:40960
    v_mfma_f32_16x16x32_bf16 v[28:31], v[76:79], a[80:83], v[28:31]
    ds_read_b64_tr_b16 v[106:107], v130 offset:41984
    s_add_u32 s26, s24, 0x60000
    s_add_u32 m0, s29, 0x3000
    s_nop 0
    buffer_load_dwordx4 v136, s[16:19], s26 offen lds
    s_waitcnt lgkmcnt(12)
    v_mfma_f32_16x16x32_bf16 v[32:35], v[80:83], a[16:19], v[32:35]
    ds_read_b64_tr_b16 v[108:109], v131 offset:40960
    v_mfma_f32_16x16x32_bf16 v[36:39], v[80:83], a[80:83], v[36:39]
    ds_read_b64_tr_b16 v[110:111], v131 offset:41984
    s_add_u32 s26, s24, 0x80000
    s_add_u32 m0, s29, 0x4000
    s_nop 0
    buffer_load_dwordx4 v136, s[16:19], s26 offen lds
    s_waitcnt lgkmcnt(12)
    v_mfma_f32_16x16x32_bf16 v[40:43], v[84:87], a[16:19], v[40:43]
    ds_read_b64_tr_b16 v[112:113], v132 offset:40960
    v_mfma_f32_16x16x32_bf16 v[44:47], v[84:87], a[80:83], v[44:47]
    ds_read_b64_tr_b16 v[114:115], v132 offset:41984
    s_add_u32 s26, s24, 0xa0000
    s_add_u32 m0, s29, 0x5000
    s_nop 0
    buffer_load_dwordx4 v136, s[16:19], s26 offen lds
    s_waitcnt lgkmcnt(12)
    v_mfma_f32_16x16x32_bf16 v[48:51], v[88:91], a[16:19], v[48:51]
    ds_read_b64_tr_b16 v[116:117], v133 offset:40960
    v_mfma_f32_16x16x32_bf16 v[52:55], v[88:91], a[80:83], v[52:55]
    ds_read_b64_tr_b16 v[118:119], v133 offset:41984
    s_add_u32 s26, s24, 0xc0000
    s_add_u32 m0, s29, 0x6000
    s_nop 0
    buffer_load_dwordx4 v136, s[16:19], s26 offen lds
    s_waitcnt lgkmcnt(12)
    v_mfma_f32_16x16x32_bf16 v[56:59], v[92:95], a[16:19], v[56:59]
    ds_read_b64_tr_b16 v[120:121], v134 offset:40960
    v_mfma_f32_16x16x32_bf16 v[60:63], v[92:95], a[80:83], v[60:63]
    ds_read_b64_tr_b16 v[122:123], v134 offset:41984
    s_add_u32 s26, s24, 0xe0000
    s_add_u32 m0, s29, 0x7000
    s_nop 0
    buffer_load_dwordx4 v136, s[16:19], s26 offen lds
    s_waitcnt lgkmcnt(12)
    v_mfma_f32_16x16x32_bf16 v[0:3], v[96:99], a[20:23], v[0:3]
    ds_read_b64_tr_b16 v[124:125], v135 offset:40960
    v_mfma_f32_16x16x32_bf16 v[4:7], v[96:99], a[84:87], v[4:7]
    ds_read_b64_tr_b16 v[126:127], v135 offset:41984
    s_waitcnt lgkmcnt(12)
    v_mfma_f32_16x16x32_bf16 v[8:11], v[100:103], a[20:23], v[8:11]
    ds_read_b64_tr_b16 v[64:65], v128 offset:49152
    v_mfma_f32_16x16x32_bf16 v[12:15], v[100:103], a[84:87], v[12:15]
    ds_read_b64_tr_b16 v[66:67], v128 offset:50176
    s_waitcnt lgkmcnt(12)
    v_mfma_f32_16x16x32_bf16 v[16:19], v[104:107], a[20:23], v[16:19]
    ds_read_b64_tr_b16 v[68:69], v129 offset:49152
    v_mfma_f32_16x16x32_bf16 v[20:23], v[104:107], a[84:87], v[20:23]
    ds_read_b64_tr_b16 v[70:71], v129 offset:50176
    s_waitcnt lgkmcnt(12)
    v_mfma_f32_16x16x32_bf16 v[24:27], v[108:111], a[20:23], v[24:27]
    ds_read_b64_tr_b16 v[72:73], v130 offset:49152
    v_mfma_f32_16x16x32_bf16 v[28:31], v[108:111], a[84:87], v[28:31]
    ds_read_b64_tr_b16 v[74:75], v130 offset:50176
    s_waitcnt lgkmcnt(12)
    v_mfma_f32_16x16x32_bf16 v[32:35], v[112:115], a[20:23], v[32:35]
    ds_read_b64_tr_b16 v[76:77], v131 offset:49152
    v_mfma_f32_16x16x32_bf16 v[36:39], v[112:115], a[84:87], v[36:39]
    ds_read_b64_tr_b16 v[78:79], v131 offset:50176
    s_waitcnt lgkmcnt(12)
    v_mfma_f32_16x16x32_bf16 v[40:43], v[116:119], a[20:23], v[40:43]
    ds_read_b64_tr_b16 v[80:81], v132 offset:49152
    v_mfma_f32_16x16x32_bf16 v[44:47], v[116:119], a[84:87], v[44:47]
    ds_read_b64_tr_b16 v[82:83], v132 offset:50176
    s_waitcnt lgkmcnt(12)
    v_mfma_f32_16x16x32_bf16 v[48:51], v[120:123], a[20:23], v[48:51]
    ds_read_b64_tr_b16 v[84:85], v133 offset:49152
    v_mfma_f32_16x16x32_bf16 v[52:55], v[120:123], a[84:87], v[52:55]
    ds_read_b64_tr_b16 v[86:87], v133 offset:50176
    s_waitcnt lgkmcnt(12)
    v_mfma_f32_16x16x32_bf16 v[56:59], v[124:127], a[20:23], v[56:59]
    ds_read_b64_tr_b16 v[88:89], v134 offset:49152
    v_mfma_f32_16x16x32_bf16 v[60:63], v[124:127], a[84:87], v[60:63]
    ds_read_b64_tr_b16 v[90:91], v134 offset:50176
    s_waitcnt lgkmcnt(12)
    v_mfma_f32_16x16x32_bf16 v[0:3], v[64:67], a[24:27], v[0:3]
    ds_read_b64_tr_b16 v[92:93], v135 offset:49152
    v_mfma_f32_16x16x32_bf16 v[4:7], v[64:67], a[88:91], v[4:7]
    ds_read_b64_tr_b16 v[94:95], v135 offset:50176
    s_waitcnt lgkmcnt(12)
    v_mfma_f32_16x16x32_bf16 v[8:11], v[68:71], a[24:27], v[8:11]
    ds_read_b64_tr_b16 v[96:97], v128 offset:57344
    v_mfma_f32_16x16x32_bf16 v[12:15], v[68:71], a[88:91], v[12:15]
    ds_read_b64_tr_b16 v[98:99], v128 offset:58368
    s_waitcnt lgkmcnt(12)
    v_mfma_f32_16x16x32_bf16 v[16:19], v[72:75], a[24:27], v[16:19]
    ds_read_b64_tr_b16 v[100:101], v129 offset:57344
    v_mfma_f32_16x16x32_bf16 v[20:23], v[72:75], a[88:91], v[20:23]
    ds_read_b64_tr_b16 v[102:103], v129 offset:58368
    s_waitcnt lgkmcnt(12)
    v_mfma_f32_16x16x32_bf16 v[24:27], v[76:79], a[24:27], v[24:27]
    ds_read_b64_tr_b16 v[104:105], v130 offset:57344
    v_mfma_f32_16x16x32_bf16 v[28:31], v[76:79], a[88:91], v[28:31]
    ds_read_b64_tr_b16 v[106:107], v130 offset:58368
    s_waitcnt lgkmcnt(12)
    v_mfma_f32_16x16x32_bf16 v[32:35], v[80:83], a[24:27], v[32:35]
    ds_read_b64_tr_b16 v[108:109], v131 offset:57344
    v_mfma_f32_16x16x32_bf16 v[36:39], v[80:83], a[88:91], v[36:39]
    ds_read_b64_tr_b16 v[110:111], v131 offset:58368
    s_waitcnt lgkmcnt(12)
    v_mfma_f32_16x16x32_bf16 v[40:43], v[84:87], a[24:27], v[40:43]
    ds_read_b64_tr_b16 v[112:113], v132 offset:57344
    v_mfma_f32_16x16x32_bf16 v[44:47], v[84:87], a[88:91], v[44:47]
    ds_read_b64_tr_b16 v[114:115], v132 offset:58368
    s_waitcnt lgkmcnt(12)
    v_mfma_f32_16x16x32_bf16 v[48:51], v[88:91], a[24:27], v[48:51]
    ds_read_b64_tr_b16 v[116:117], v133 offset:57344
    v_mfma_f32_16x16x32_bf16 v[52:55], v[88:91], a[88:91], v[52:55]
    ds_read_b64_tr_b16 v[118:119], v133 offset:58368
    s_waitcnt lgkmcnt(12)
    v_mfma_f32_16x16x32_bf16 v[56:59], v[92:95], a[24:27], v[56:59]
    ds_read_b64_tr_b16 v[120:121], v134 offset:57344
    v_mfma_f32_16x16x32_bf16 v[60:63], v[92:95], a[88:91], v[60:63]
    ds_read_b64_tr_b16 v[122:123], v134 offset:58368
    s_waitcnt lgkmcnt(12)
    v_mfma_f32_16x16x32_bf16 v[0:3], v[96:99], a[28:31], v[0:3]
    ds_read_b64_tr_b16 v[124:125], v135 offset:57344
    v_mfma_f32_16x16x32_bf16 v[4:7], v[96:99], a[92:95], v[4:7]
    ds_read_b64_tr_b16 v[126:127], v135 offset:58368
    s_waitcnt lgkmcnt(12)
    v_mfma_f32_16x16x32_bf16 v[8:11], v[100:103], a[28:31], v[8:11]
    v_mfma_f32_16x16x32_bf16 v[12:15], v[100:103], a[92:95], v[12:15]
    s_waitcnt lgkmcnt(10)
    v_mfma_f32_16x16x32_bf16 v[16:19], v[104:107], a[28:31], v[16:19]
    v_mfma_f32_16x16x32_bf16 v[20:23], v[104:107], a[92:95], v[20:23]
    s_waitcnt lgkmcnt(8)
    v_mfma_f32_16x16x32_bf16 v[24:27], v[108:111], a[28:31], v[24:27]
    v_mfma_f32_16x16x32_bf16 v[28:31], v[108:111], a[92:95], v[28:31]
    s_waitcnt lgkmcnt(6)
    v_mfma_f32_16x16x32_bf16 v[32:35], v[112:115], a[28:31], v[32:35]
    v_mfma_f32_16x16x32_bf16 v[36:39], v[112:115], a[92:95], v[36:39]
    s_waitcnt lgkmcnt(4)
    v_mfma_f32_16x16x32_bf16 v[40:43], v[116:119], a[28:31], v[40:43]
    v_mfma_f32_16x16x32_bf16 v[44:47], v[116:119], a[92:95], v[44:47]
    s_waitcnt lgkmcnt(2)
    v_mfma_f32_16x16x32_bf16 v[48:51], v[120:123], a[28:31], v[48:51]
    v_mfma_f32_16x16x32_bf16 v[52:55], v[120:123], a[92:95], v[52:55]
    s_waitcnt lgkmcnt(0)
    v_mfma_f32_16x16x32_bf16 v[56:59], v[124:127], a[28:31], v[56:59]
    v_mfma_f32_16x16x32_bf16 v[60:63], v[124:127], a[92:95], v[60:63]
    v_xor_b32 v128, 0x10000, v128
    v_xor_b32 v129, 0x10000, v129
    v_xor_b32 v130, 0x10000, v130
    v_xor_b32 v131, 0x10000, v131
    v_xor_b32 v132, 0x10000, v132
    v_xor_b32 v133, 0x10000, v133
    v_xor_b32 v134, 0x10000, v134
    v_xor_b32 v135, 0x10000, v135
    s_waitcnt vmcnt(16)
    s_barrier
    ds_read_b64_tr_b16 v[64:65], v128
    ds_read_b64_tr_b16 v[66:67], v128 offset:1024
    ds_read_b64_tr_b16 v[68:69], v129
    ds_read_b64_tr_b16 v[70:71], v129 offset:1024
    ds_read_b64_tr_b16 v[72:73], v130
    ds_read_b64_tr_b16 v[74:75], v130 offset:1024
    ds_read_b64_tr_b16 v[76:77], v131
    ds_read_b64_tr_b16 v[78:79], v131 offset:1024
    ds_read_b64_tr_b16 v[80:81], v132
    ds_read_b64_tr_b16 v[82:83], v132 offset:1024
    ds_read_b64_tr_b16 v[84:85], v133
    ds_read_b64_tr_b16 v[86:87], v133 offset:1024
    ds_read_b64_tr_b16 v[88:89], v134
    ds_read_b64_tr_b16 v[90:91], v134 offset:1024
    s_cmp_eq_u32 s40, 0
    s_cbranch_scc1 L_nopf_90
    s_cmp_lg_u32 s87, 0
    s_cbranch_scc1 L_modeok_91
    v_readfirstlane_b32 s96, v140
    v_readfirstlane_b32 s97, v141
    s_nop 0
    s_cmp_lg_u32 s97, 0
    s_cselect_b32 s87, s96, 0
    s_cmp_eq_u32 s87, 1
    s_cbranch_scc1 L_modeok_91
    s_mov_b32 s96, 0
L_mode_92:
    buffer_load_dwordx2 v[140:141], off, s[92:95], 0 offset:36 sc1
    s_waitcnt vmcnt(0)
    v_readfirstlane_b32 s87, v140
    v_readfirstlane_b32 s97, v141
    s_nop 0
    s_min_u32 s97, s97, s87
    s_cmp_lg_u32 s97, 0
    s_cbranch_scc1 L_moded_93
    s_sleep 4
    s_add_u32 s96, s96, 1
    s_cmp_lg_u32 s96, 0x100
    s_cbranch_scc1 L_modef_94
    v_mov_b32 v140, 2
    v_mov_b32 v141, 0
    s_mov_b64 exec, 1
    buffer_atomic_cmpswap v[140:141], off, s[92:95], 0 offset:36
    s_mov_b64 exec, -1
L_modef_94:
    s_cmp_lt_u32 s96, 0x10000
    s_cbranch_scc1 L_mode_92
L_moded_93:
    s_cmp_lg_u32 s87, 1
    s_cbranch_scc1 L_fallback
L_modeok_91:
    s_cmp_lg_u32 s100, 0
    s_cbranch_scc1 L_flag_95
    v_mov_b32 v138, 1
    s_mov_b64 exec, 1
    buffer_store_dword v138, off, s[8:11], s40 sc1
    s_mov_b64 exec, -1
L_flag_95:
    s_mov_b32 s40, 0
L_nopf_90:
    s_waitcnt lgkmcnt(12)
    v_mfma_f32_16x16x32_bf16 v[0:3], v[64:67], a[32:35], v[0:3]
    ds_read_b64_tr_b16 v[92:93], v135
    v_mfma_f32_16x16x32_bf16 v[4:7], v[64:67], a[96:99], v[4:7]
    ds_read_b64_tr_b16 v[94:95], v135 offset:1024
    s_add_u32 s26, s24, 0x100000
    s_add_u32 m0, s29, 0x8000
    s_nop 0
    buffer_load_dwordx4 v136, s[16:19], s26 offen lds
    s_waitcnt lgkmcnt(12)
    v_mfma_f32_16x16x32_bf16 v[8:11], v[68:71], a[32:35], v[8:11]
    ds_read_b64_tr_b16 v[96:97], v128 offset:8192
    v_mfma_f32_16x16x32_bf16 v[12:15], v[68:71], a[96:99], v[12:15]
    ds_read_b64_tr_b16 v[98:99], v128 offset:9216
    s_add_u32 s26, s24, 0x120000
    s_add_u32 m0, s29, 0x9000
    s_nop 0
    buffer_load_dwordx4 v136, s[16:19], s26 offen lds
    s_waitcnt lgkmcnt(12)
    v_mfma_f32_16x16x32_bf16 v[16:19], v[72:75], a[32:35], v[16:19]
    ds_read_b64_tr_b16 v[100:101], v129 offset:8192
    v_mfma_f32_16x16x32_bf16 v[20:23], v[72:75], a[96:99], v[20:23]
    ds_read_b64_tr_b16 v[102:103], v129 offset:9216
    s_add_u32 s26, s24, 0x140000
    s_add_u32 m0, s29, 0xa000
    s_nop 0
    buffer_load_dwordx4 v136, s[16:19], s26 offen lds
    s_waitcnt lgkmcnt(12)
    v_mfma_f32_16x16x32_bf16 v[24:27], v[76:79], a[32:35], v[24:27]
    ds_read_b64_tr_b16 v[104:105], v130 offset:8192
    v_mfma_f32_16x16x32_bf16 v[28:31], v[76:79], a[96:99], v[28:31]
    ds_read_b64_tr_b16 v[106:107], v130 offset:9216
    s_add_u32 s26, s24, 0x160000
    s_add_u32 m0, s29, 0xb000
    s_nop 0
    buffer_load_dwordx4 v136, s[16:19], s26 offen lds
    s_waitcnt lgkmcnt(12)
    v_mfma_f32_16x16x32_bf16 v[32:35], v[80:83], a[32:35], v[32:35]
    ds_read_b64_tr_b16 v[108:109], v131 offset:8192
    v_mfma_f32_16x16x32_bf16 v[36:39], v[80:83], a[96:99], v[36:39]
    ds_read_b64_tr_b16 v[110:111], v131 offset:9216
    s_add_u32 s26, s24, 0x180000
    s_add_u32 m0, s29, 0xc000
    s_nop 0
    buffer_load_dwordx4 v136, s[16:19], s26 offen lds
    s_waitcnt lgkmcnt(12)
    v_mfma_f32_16x16x32_bf16 v[40:43], v[84:87], a[32:35], v[40:43]
    ds_read_b64_tr_b16 v[112:113], v132 offset:8192
    v_mfma_f32_16x16x32_bf16 v[44:47], v[84:87], a[96:99], v[44:47]
    ds_read_b64_tr_b16 v[114:115], v132 offset:9216
    s_add_u32 s26, s24, 0x1a0000
    s_add_u32 m0, s29, 0xd000
    s_nop 0
    buffer_load_dwordx4 v136, s[16:19], s26 offen lds
    s_waitcnt lgkmcnt(12)
    v_mfma_f32_16x16x32_bf16 v[48:51], v[88:91], a[32:35], v[48:51]
    ds_read_b64_tr_b16 v[116:117], v133 offset:8192
    v_mfma_f32_16x16x32_bf16 v[52:55], v[88:91], a[96:99], v[52:55]
    ds_read_b64_tr_b16 v[118:119], v133 offset:9216
    s_add_u32 s26, s24, 0x1c0000
    s_add_u32 m0, s29, 0xe000
    s_nop 0
    buffer_load_dwordx4 v136, s[16:19], s26 offen lds
    s_waitcnt lgkmcnt(12)
    v_mfma_f32_16x16x32_bf16 v[56:59], v[92:95], a[32:35], v[56:59]
    ds_read_b64_tr_b16 v[120:121], v134 offset:8192
    v_mfma_f32_16x16x32_bf16 v[60:63], v[92:95], a[96:99], v[60:63]
    ds_read_b64_tr_b16 v[122:123], v134 offset:9216
    s_add_u32 s26, s24, 0x1e0000
    s_add_u32 m0, s29, 0xf000
    s_nop 0
    buffer_load_dwordx4 v136, s[16:19], s26 offen lds
    s_waitcnt lgkmcnt(12)
    v_mfma_f32_16x16x32_bf16 v[0:3], v[96:99], a[36:39], v[0:3]
    ds_read_b64_tr_b16 v[124:125], v135 offset:8192
    v_mfma_f32_16x16x32_bf16 v[4:7], v[96:99], a[100:103], v[4:7]
    ds_read_b64_tr_b16 v[126:127], v135 offset:9216
    s_waitcnt lgkmcnt(12)
    v_mfma_f32_16x16x32_bf16 v[8:11], v[100:103], a[36:39], v[8:11]
    ds_read_b64_tr_b16 v[64:65], v128 offset:16384
    v_mfma_f32_16x16x32_bf16 v[12:15], v[100:103], a[100:103], v[12:15]
    ds_read_b64_tr_b16 v[66:67], v128 offset:17408
    s_waitcnt lgkmcnt(12)
    v_mfma_f32_16x16x32_bf16 v[16:19], v[104:107], a[36:39], v[16:19]
    ds_read_b64_tr_b16 v[68:69], v129 offset:16384
    v_mfma_f32_16x16x32_bf16 v[20:23], v[104:107], a[100:103], v[20:23]
    ds_read_b64_tr_b16 v[70:71], v129 offset:17408
    s_waitcnt lgkmcnt(12)
    v_mfma_f32_16x16x32_bf16 v[24:27], v[108:111], a[36:39], v[24:27]
    ds_read_b64_tr_b16 v[72:73], v130 offset:16384
    v_mfma_f32_16x16x32_bf16 v[28:31], v[108:111], a[100:103], v[28:31]
    ds_read_b64_tr_b16 v[74:75], v130 offset:17408
    s_waitcnt lgkmcnt(12)
    v_mfma_f32_16x16x32_bf16 v[32:35], v[112:115], a[36:39], v[32:35]
    ds_read_b64_tr_b16 v[76:77], v131 offset:16384
    v_mfma_f32_16x16x32_bf16 v[36:39], v[112:115], a[100:103], v[36:39]
    ds_read_b64_tr_b16 v[78:79], v131 offset:17408
    s_waitcnt lgkmcnt(12)
    v_mfma_f32_16x16x32_bf16 v[40:43], v[116:119], a[36:39], v[40:43]
    ds_read_b64_tr_b16 v[80:81], v132 offset:16384
    v_mfma_f32_16x16x32_bf16 v[44:47], v[116:119], a[100:103], v[44:47]
    ds_read_b64_tr_b16 v[82:83], v132 offset:17408
    s_waitcnt lgkmcnt(12)
    v_mfma_f32_16x16x32_bf16 v[48:51], v[120:123], a[36:39], v[48:51]
    ds_read_b64_tr_b16 v[84:85], v133 offset:16384
    v_mfma_f32_16x16x32_bf16 v[52:55], v[120:123], a[100:103], v[52:55]
    ds_read_b64_tr_b16 v[86:87], v133 offset:17408
    s_waitcnt lgkmcnt(12)
    v_mfma_f32_16x16x32_bf16 v[56:59], v[124:127], a[36:39], v[56:59]
    ds_read_b64_tr_b16 v[88:89], v134 offset:16384
    v_mfma_f32_16x16x32_bf16 v[60:63], v[124:127], a[100:103], v[60:63]
    ds_read_b64_tr_b16 v[90:91], v134 offset:17408
    s_waitcnt lgkmcnt(12)
    v_mfma_f32_16x16x32_bf16 v[0:3], v[64:67], a[40:43], v[0:3]
    ds_read_b64_tr_b16 v[92:93], v135 offset:16384
    v_mfma_f32_16x16x32_bf16 v[4:7], v[64:67], a[104:107], v[4:7]
    ds_read_b64_tr_b16 v[94:95], v135 offset:17408
    s_waitcnt lgkmcnt(12)
    v_mfma_f32_16x16x32_bf16 v[8:11], v[68:71], a[40:43], v[8:11]
    ds_read_b64_tr_b16 v[96:97], v128 offset:24576
    v_mfma_f32_16x16x32_bf16 v[12:15], v[68:71], a[104:107], v[12:15]
    ds_read_b64_tr_b16 v[98:99], v128 offset:25600
    s_waitcnt lgkmcnt(12)
    v_mfma_f32_16x16x32_bf16 v[16:19], v[72:75], a[40:43], v[16:19]
    ds_read_b64_tr_b16 v[100:101], v129 offset:24576
    v_mfma_f32_16x16x32_bf16 v[20:23], v[72:75], a[104:107], v[20:23]
    ds_read_b64_tr_b16 v[102:103], v129 offset:25600
    s_waitcnt lgkmcnt(12)
    v_mfma_f32_16x16x32_bf16 v[24:27], v[76:79], a[40:43], v[24:27]
    ds_read_b64_tr_b16 v[104:105], v130 offset:24576
    v_mfma_f32_16x16x32_bf16 v[28:31], v[76:79], a[104:107], v[28:31]
    ds_read_b64_tr_b16 v[106:107], v130 offset:25600
    s_waitcnt lgkmcnt(12)
    v_mfma_f32_16x16x32_bf16 v[32:35], v[80:83], a[40:43], v[32:35]
    ds_read_b64_tr_b16 v[108:109], v131 offset:24576
    v_mfma_f32_16x16x32_bf16 v[36:39], v[80:83], a[104:107], v[36:39]
    ds_read_b64_tr_b16 v[110:111], v131 offset:25600
    s_waitcnt lgkmcnt(12)
    v_mfma_f32_16x16x32_bf16 v[40:43], v[84:87], a[40:43], v[40:43]
    ds_read_b64_tr_b16 v[112:113], v132 offset:24576
    v_mfma_f32_16x16x32_bf16 v[44:47], v[84:87], a[104:107], v[44:47]
    ds_read_b64_tr_b16 v[114:115], v132 offset:25600
    s_waitcnt lgkmcnt(12)
    v_mfma_f32_16x16x32_bf16 v[48:51], v[88:91], a[40:43], v[48:51]
    ds_read_b64_tr_b16 v[116:117], v133 offset:24576
    v_mfma_f32_16x16x32_bf16 v[52:55], v[88:91], a[104:107], v[52:55]
    ds_read_b64_tr_b16 v[118:119], v133 offset:25600
    s_waitcnt lgkmcnt(12)
    v_mfma_f32_16x16x32_bf16 v[56:59], v[92:95], a[40:43], v[56:59]
    ds_read_b64_tr_b16 v[120:121], v134 offset:24576
    v_mfma_f32_16x16x32_bf16 v[60:63], v[92:95], a[104:107], v[60:63]
    ds_read_b64_tr_b16 v[122:123], v134 offset:25600
    s_waitcnt lgkmcnt(12)
    v_mfma_f32_16x16x32_bf16 v[0:3], v[96:99], a[44:47], v[0:3]
    ds_read_b64_tr_b16 v[124:125], v135 offset:24576
    v_mfma_f32_16x16x32_bf16 v[4:7], v[96:99], a[108:111], v[4:7]
    ds_read_b64_tr_b16 v[126:127], v135 offset:25600
    s_waitcnt lgkmcnt(12)
    v_mfma_f32_16x16x32_bf16 v[8:11], v[100:103], a[44:47], v[8:11]
    v_mfma_f32_16x16x32_bf16 v[12:15], v[100:103], a[108:111], v[12:15]
    s_waitcnt lgkmcnt(10)
    v_mfma_f32_16x16x32_bf16 v[16:19], v[104:107], a[44:47], v[16:19]
    v_mfma_f32_16x16x32_bf16 v[20:23], v[104:107], a[108:111], v[20:23]
    s_waitcnt lgkmcnt(8)
    v_mfma_f32_16x16x32_bf16 v[24:27], v[108:111], a[44:47], v[24:27]
    v_mfma_f32_16x16x32_bf16 v[28:31], v[108:111], a[108:111], v[28:31]
    s_waitcnt lgkmcnt(6)
    v_mfma_f32_16x16x32_bf16 v[32:35], v[112:115], a[44:47], v[32:35]
    v_mfma_f32_16x16x32_bf16 v[36:39], v[112:115], a[108:111], v[36:39]
    s_waitcnt lgkmcnt(4)
    v_mfma_f32_16x16x32_bf16 v[40:43], v[116:119], a[44:47], v[40:43]
    v_mfma_f32_16x16x32_bf16 v[44:47], v[116:119], a[108:111], v[44:47]
    s_waitcnt lgkmcnt(2)
    v_mfma_f32_16x16x32_bf16 v[48:51], v[120:123], a[44:47], v[48:51]
    v_mfma_f32_16x16x32_bf16 v[52:55], v[120:123], a[108:111], v[52:55]
    s_waitcnt lgkmcnt(0)
    v_mfma_f32_16x16x32_bf16 v[56:59], v[124:127], a[44:47], v[56:59]
    v_mfma_f32_16x16x32_bf16 v[60:63], v[124:127], a[108:111], v[60:63]
    s_waitcnt vmcnt(16)
    s_barrier
    ds_read_b64_tr_b16 v[64:65], v128 offset:32768
    ds_read_b64_tr_b16 v[66:67], v128 offset:33792
    ds_read_b64_tr_b16 v[68:69], v129 offset:32768
    ds_read_b64_tr_b16 v[70:71], v129 offset:33792
    ds_read_b64_tr_b16 v[72:73], v130 offset:32768
    ds_read_b64_tr_b16 v[74:75], v130 offset:33792
    ds_read_b64_tr_b16 v[76:77], v131 offset:32768
    ds_read_b64_tr_b16 v[78:79], v131 offset:33792
    ds_read_b64_tr_b16 v[80:81], v132 offset:32768
    ds_read_b64_tr_b16 v[82:83], v132 offset:33792
    ds_read_b64_tr_b16 v[84:85], v133 offset:32768
    ds_read_b64_tr_b16 v[86:87], v133 offset:33792
    ds_read_b64_tr_b16 v[88:89], v134 offset:32768
    ds_read_b64_tr_b16 v[90:91], v134 offset:33792
    s_waitcnt lgkmcnt(12)
    v_mfma_f32_16x16x32_bf16 v[0:3], v[64:67], a[48:51], v[0:3]
    ds_read_b64_tr_b16 v[92:93], v135 offset:32768
    v_mfma_f32_16x16x32_bf16 v[4:7], v[64:67], a[112:115], v[4:7]
    ds_read_b64_tr_b16 v[94:95], v135 offset:33792
    s_add_u32 s26, s24, 0x200000
    s_add_u32 m0, s29, 0x10000
    s_nop 0
    buffer_load_dwordx4 v136, s[16:19], s26 offen lds
    s_waitcnt lgkmcnt(12)
    v_mfma_f32_16x16x32_bf16 v[8:11], v[68:71], a[48:51], v[8:11]
    ds_read_b64_tr_b16 v[96:97], v128 offset:40960
    v_mfma_f32_16x16x32_bf16 v[12:15], v[68:71], a[112:115], v[12:15]
    ds_read_b64_tr_b16 v[98:99], v128 offset:41984
    s_add_u32 s26, s24, 0x220000
    s_add_u32 m0, s29, 0x11000
    s_nop 0
    buffer_load_dwordx4 v136, s[16:19], s26 offen lds
    s_waitcnt lgkmcnt(12)
    v_mfma_f32_16x16x32_bf16 v[16:19], v[72:75], a[48:51], v[16:19]
    ds_read_b64_tr_b16 v[100:101], v129 offset:40960
    v_mfma_f32_16x16x32_bf16 v[20:23], v[72:75], a[112:115], v[20:23]
    ds_read_b64_tr_b16 v[102:103], v129 offset:41984
    s_add_u32 s26, s24, 0x240000
    s_add_u32 m0, s29, 0x12000
    s_nop 0
    buffer_load_dwordx4 v136, s[16:19], s26 offen lds
    s_waitcnt lgkmcnt(12)
    v_mfma_f32_16x16x32_bf16 v[24:27], v[76:79], a[48:51], v[24:27]
    ds_read_b64_tr_b16 v[104:105], v130 offset:40960
    v_mfma_f32_16x16x32_bf16 v[28:31], v[76:79], a[112:115], v[28:31]
    ds_read_b64_tr_b16 v[106:107], v130 offset:41984
    s_add_u32 s26, s24, 0x260000
    s_add_u32 m0, s29, 0x13000
    s_nop 0
    buffer_load_dwordx4 v136, s[16:19], s26 offen lds
    s_waitcnt lgkmcnt(12)
    v_mfma_f32_16x16x32_bf16 v[32:35], v[80:83], a[48:51], v[32:35]
    ds_read_b64_tr_b16 v[108:109], v131 offset:40960
    v_mfma_f32_16x16x32_bf16 v[36:39], v[80:83], a[112:115], v[36:39]
    ds_read_b64_tr_b16 v[110:111], v131 offset:41984
    s_add_u32 s26, s24, 0x280000
    s_add_u32 m0, s29, 0x14000
    s_nop 0
    buffer_load_dwordx4 v136, s[16:19], s26 offen lds
    s_waitcnt lgkmcnt(12)
    v_mfma_f32_16x16x32_bf16 v[40:43], v[84:87], a[48:51], v[40:43]
    ds_read_b64_tr_b16 v[112:113], v132 offset:40960
    v_mfma_f32_16x16x32_bf16 v[44:47], v[84:87], a[112:115], v[44:47]
    ds_read_b64_tr_b16 v[114:115], v132 offset:41984
    s_add_u32 s26, s24, 0x2a0000
    s_add_u32 m0, s29, 0x15000
    s_nop 0
    buffer_load_dwordx4 v136, s[16:19], s26 offen lds
    s_waitcnt lgkmcnt(12)
    v_mfma_f32_16x16x32_bf16 v[48:51], v[88:91], a[48:51], v[48:51]
    ds_read_b64_tr_b16 v[116:117], v133 offset:40960
    v_mfma_f32_16x16x32_bf16 v[52:55], v[88:91], a[112:115], v[52:55]
    ds_read_b64_tr_b16 v[118:119], v133 offset:41984
    s_add_u32 s26, s24, 0x2c0000
    s_add_u32 m0, s29, 0x16000
    s_nop 0
    buffer_load_dwordx4 v136, s[16:19], s26 offen lds
    s_waitcnt lgkmcnt(12)
    v_mfma_f32_16x16x32_bf16 v[56:59], v[92:95], a[48:51], v[56:59]
    ds_read_b64_tr_b16 v[120:121], v134 offset:40960
    v_mfma_f32_16x16x32_bf16 v[60:63], v[92:95], a[112:115], v[60:63]
    ds_read_b64_tr_b16 v[122:123], v134 offset:41984
    s_add_u32 s26, s24, 0x2e0000
    s_add_u32 m0, s29, 0x17000
    s_nop 0
    buffer_load_dwordx4 v136, s[16:19], s26 offen lds
    s_waitcnt lgkmcnt(12)
    v_mfma_f32_16x16x32_bf16 v[0:3], v[96:99], a[52:55], v[0:3]
    ds_read_b64_tr_b16 v[124:125], v135 offset:40960
    v_mfma_f32_16x16x32_bf16 v[4:7], v[96:99], a[116:119], v[4:7]
    ds_read_b64_tr_b16 v[126:127], v135 offset:41984
    s_waitcnt lgkmcnt(12)
    v_mfma_f32_16x16x32_bf16 v[8:11], v[100:103], a[52:55], v[8:11]
    ds_read_b64_tr_b16 v[64:65], v128 offset:49152
    v_mfma_f32_16x16x32_bf16 v[12:15], v[100:103], a[116:119], v[12:15]
    ds_read_b64_tr_b16 v[66:67], v128 offset:50176
    s_waitcnt lgkmcnt(12)
    v_mfma_f32_16x16x32_bf16 v[16:19], v[104:107], a[52:55], v[16:19]
    ds_read_b64_tr_b16 v[68:69], v129 offset:49152
    v_mfma_f32_16x16x32_bf16 v[20:23], v[104:107], a[116:119], v[20:23]
    ds_read_b64_tr_b16 v[70:71], v129 offset:50176
    s_waitcnt lgkmcnt(12)
    v_mfma_f32_16x16x32_bf16 v[24:27], v[108:111], a[52:55], v[24:27]
    ds_read_b64_tr_b16 v[72:73], v130 offset:49152
    v_mfma_f32_16x16x32_bf16 v[28:31], v[108:111], a[116:119], v[28:31]
    ds_read_b64_tr_b16 v[74:75], v130 offset:50176
    s_waitcnt lgkmcnt(12)
    v_mfma_f32_16x16x32_bf16 v[32:35], v[112:115], a[52:55], v[32:35]
    ds_read_b64_tr_b16 v[76:77], v131 offset:49152
    v_mfma_f32_16x16x32_bf16 v[36:39], v[112:115], a[116:119], v[36:39]
    ds_read_b64_tr_b16 v[78:79], v131 offset:50176
    s_waitcnt lgkmcnt(12)
    v_mfma_f32_16x16x32_bf16 v[40:43], v[116:119], a[52:55], v[40:43]
    ds_read_b64_tr_b16 v[80:81], v132 offset:49152
    v_mfma_f32_16x16x32_bf16 v[44:47], v[116:119], a[116:119], v[44:47]
    ds_read_b64_tr_b16 v[82:83], v132 offset:50176
    s_waitcnt lgkmcnt(12)
    v_mfma_f32_16x16x32_bf16 v[48:51], v[120:123], a[52:55], v[48:51]
    ds_read_b64_tr_b16 v[84:85], v133 offset:49152
    v_mfma_f32_16x16x32_bf16 v[52:55], v[120:123], a[116:119], v[52:55]
    ds_read_b64_tr_b16 v[86:87], v133 offset:50176
    s_waitcnt lgkmcnt(12)
    v_mfma_f32_16x16x32_bf16 v[56:59], v[124:127], a[52:55], v[56:59]
    ds_read_b64_tr_b16 v[88:89], v134 offset:49152
    v_mfma_f32_16x16x32_bf16 v[60:63], v[124:127], a[116:119], v[60:63]
    ds_read_b64_tr_b16 v[90:91], v134 offset:50176
    s_waitcnt lgkmcnt(12)
    v_mfma_f32_16x16x32_bf16 v[0:3], v[64:67], a[56:59], v[0:3]
    ds_read_b64_tr_b16 v[92:93], v135 offset:49152
    v_mfma_f32_16x16x32_bf16 v[4:7], v[64:67], a[120:123], v[4:7]
    ds_read_b64_tr_b16 v[94:95], v135 offset:50176
    s_waitcnt lgkmcnt(12)
    v_mfma_f32_16x16x32_bf16 v[8:11], v[68:71], a[56:59], v[8:11]
    ds_read_b64_tr_b16 v[96:97], v128 offset:57344
    v_mfma_f32_16x16x32_bf16 v[12:15], v[68:71], a[120:123], v[12:15]
    ds_read_b64_tr_b16 v[98:99], v128 offset:58368
    s_waitcnt lgkmcnt(12)
    v_mfma_f32_16x16x32_bf16 v[16:19], v[72:75], a[56:59], v[16:19]
    ds_read_b64_tr_b16 v[100:101], v129 offset:57344
    v_mfma_f32_16x16x32_bf16 v[20:23], v[72:75], a[120:123], v[20:23]
    ds_read_b64_tr_b16 v[102:103], v129 offset:58368
    s_waitcnt lgkmcnt(12)
    v_mfma_f32_16x16x32_bf16 v[24:27], v[76:79], a[56:59], v[24:27]
    ds_read_b64_tr_b16 v[104:105], v130 offset:57344
    v_mfma_f32_16x16x32_bf16 v[28:31], v[76:79], a[120:123], v[28:31]
    ds_read_b64_tr_b16 v[106:107], v130 offset:58368
    s_waitcnt lgkmcnt(12)
    v_mfma_f32_16x16x32_bf16 v[32:35], v[80:83], a[56:59], v[32:35]
    ds_read_b64_tr_b16 v[108:109], v131 offset:57344
    v_mfma_f32_16x16x32_bf16 v[36:39], v[80:83], a[120:123], v[36:39]
    ds_read_b64_tr_b16 v[110:111], v131 offset:58368
    s_waitcnt lgkmcnt(12)
    v_mfma_f32_16x16x32_bf16 v[40:43], v[84:87], a[56:59], v[40:43]
    ds_read_b64_tr_b16 v[112:113], v132 offset:57344
    v_mfma_f32_16x16x32_bf16 v[44:47], v[84:87], a[120:123], v[44:47]
    ds_read_b64_tr_b16 v[114:115], v132 offset:58368
    s_waitcnt lgkmcnt(12)
    v_mfma_f32_16x16x32_bf16 v[48:51], v[88:91], a[56:59], v[48:51]
    ds_read_b64_tr_b16 v[116:117], v133 offset:57344
    v_mfma_f32_16x16x32_bf16 v[52:55], v[88:91], a[120:123], v[52:55]
    ds_read_b64_tr_b16 v[118:119], v133 offset:58368
    s_waitcnt lgkmcnt(12)
    v_mfma_f32_16x16x32_bf16 v[56:59], v[92:95], a[56:59], v[56:59]
    ds_read_b64_tr_b16 v[120:121], v134 offset:57344
    v_mfma_f32_16x16x32_bf16 v[60:63], v[92:95], a[120:123], v[60:63]
    ds_read_b64_tr_b16 v[122:123], v134 offset:58368
    s_waitcnt lgkmcnt(12)
    v_mfma_f32_16x16x32_bf16 v[0:3], v[96:99], a[60:63], v[0:3]
    ds_read_b64_tr_b16 v[124:125], v135 offset:57344
    v_mfma_f32_16x16x32_bf16 v[4:7], v[96:99], a[124:127], v[4:7]
    ds_read_b64_tr_b16 v[126:127], v135 offset:58368
    s_waitcnt lgkmcnt(12)
    v_mfma_f32_16x16x32_bf16 v[8:11], v[100:103], a[60:63], v[8:11]
    v_mfma_f32_16x16x32_bf16 v[12:15], v[100:103], a[124:127], v[12:15]
    s_waitcnt lgkmcnt(10)
    v_mfma_f32_16x16x32_bf16 v[16:19], v[104:107], a[60:63], v[16:19]
    v_mfma_f32_16x16x32_bf16 v[20:23], v[104:107], a[124:127], v[20:23]
    s_waitcnt lgkmcnt(8)
    v_mfma_f32_16x16x32_bf16 v[24:27], v[108:111], a[60:63], v[24:27]
    v_mfma_f32_16x16x32_bf16 v[28:31], v[108:111], a[124:127], v[28:31]
    s_waitcnt lgkmcnt(6)
    v_mfma_f32_16x16x32_bf16 v[32:35], v[112:115], a[60:63], v[32:35]
    v_mfma_f32_16x16x32_bf16 v[36:39], v[112:115], a[124:127], v[36:39]
    s_waitcnt lgkmcnt(4)
    v_mfma_f32_16x16x32_bf16 v[40:43], v[116:119], a[60:63], v[40:43]
    v_mfma_f32_16x16x32_bf16 v[44:47], v[116:119], a[124:127], v[44:47]
    s_waitcnt lgkmcnt(2)
    v_mfma_f32_16x16x32_bf16 v[48:51], v[120:123], a[60:63], v[48:51]
    v_mfma_f32_16x16x32_bf16 v[52:55], v[120:123], a[124:127], v[52:55]
    s_waitcnt lgkmcnt(0)
    v_mfma_f32_16x16x32_bf16 v[56:59], v[124:127], a[60:63], v[56:59]
    v_mfma_f32_16x16x32_bf16 v[60:63], v[124:127], a[124:127], v[60:63]
    v_xor_b32 v128, 0x10000, v128
    v_xor_b32 v129, 0x10000, v129
    v_xor_b32 v130, 0x10000, v130
    v_xor_b32 v131, 0x10000, v131
    v_xor_b32 v132, 0x10000, v132
    v_xor_b32 v133, 0x10000, v133
    v_xor_b32 v134, 0x10000, v134
    v_xor_b32 v135, 0x10000, v135
    v_cvt_pk_bf16_f32 v144, v0, v8
    v_cvt_pk_bf16_f32 v145, v1, v9
    v_cvt_pk_bf16_f32 v146, v2, v10
    v_cvt_pk_bf16_f32 v147, v3, v11
    buffer_store_dwordx4 v[144:147], v137, s[8:11], s25 offen sc1
    v_cvt_pk_bf16_f32 v148, v16, v24
    v_cvt_pk_bf16_f32 v149, v17, v25
    v_cvt_pk_bf16_f32 v150, v18, v26
    v_cvt_pk_bf16_f32 v151, v19, v27
    buffer_store_dwordx4 v[148:151], v137, s[8:11], s25 offen offset:1024 sc1
    v_cvt_pk_bf16_f32 v152, v32, v40
    v_cvt_pk_bf16_f32 v153, v33, v41
    v_cvt_pk_bf16_f32 v154, v34, v42
    v_cvt_pk_bf16_f32 v155, v35, v43
    buffer_store_dwordx4 v[152:155], v137, s[8:11], s25 offen offset:2048 sc1
    v_cvt_pk_bf16_f32 v156, v48, v56
    v_cvt_pk_bf16_f32 v157, v49, v57
    v_cvt_pk_bf16_f32 v158, v50, v58
    v_cvt_pk_bf16_f32 v159, v51, v59
    buffer_store_dwordx4 v[156:159], v137, s[8:11], s25 offen offset:3072 sc1
    v_cvt_pk_bf16_f32 v144, v4, v12
    v_cvt_pk_bf16_f32 v145, v5, v13
    v_cvt_pk_bf16_f32 v146, v6, v14
    v_cvt_pk_bf16_f32 v147, v7, v15
    s_add_u32 s25, s25, 4096
    buffer_store_dwordx4 v[144:147], v137, s[8:11], s25 offen sc1
    v_cvt_pk_bf16_f32 v148, v20, v28
    v_cvt_pk_bf16_f32 v149, v21, v29
    v_cvt_pk_bf16_f32 v150, v22, v30
    v_cvt_pk_bf16_f32 v151, v23, v31
    buffer_store_dwordx4 v[148:151], v137, s[8:11], s25 offen offset:1024 sc1
    v_cvt_pk_bf16_f32 v152, v36, v44
    v_cvt_pk_bf16_f32 v153, v37, v45
    v_cvt_pk_bf16_f32 v154, v38, v46
    v_cvt_pk_bf16_f32 v155, v39, v47
    buffer_store_dwordx4 v[152:155], v137, s[8:11], s25 offen offset:2048 sc1
    v_cvt_pk_bf16_f32 v156, v52, v60
    v_cvt_pk_bf16_f32 v157, v53, v61
    v_cvt_pk_bf16_f32 v158, v54, v62
    v_cvt_pk_bf16_f32 v159, v55, v63
    buffer_store_dwordx4 v[156:159], v137, s[8:11], s25 offen offset:3072 sc1
    s_branch L_p1_next
L_p1_v:
    s_waitcnt vmcnt(16)
    s_barrier
    ds_read_b64_tr_b16 v[64:65], v128
    ds_read_b64_tr_b16 v[66:67], v128 offset:1024
    ds_read_b64_tr_b16 v[68:69], v129
    ds_read_b64_tr_b16 v[70:71], v129 offset:1024
    ds_read_b64_tr_b16 v[72:73], v130
    ds_read_b64_tr_b16 v[74:75], v130 offset:1024
    ds_read_b64_tr_b16 v[76:77], v131
    ds_read_b64_tr_b16 v[78:79], v131 offset:1024
    ds_read_b64_tr_b16 v[80:81], v132
    ds_read_b64_tr_b16 v[82:83], v132 offset:1024
    ds_read_b64_tr_b16 v[84:85], v133
    ds_read_b64_tr_b16 v[86:87], v133 offset:1024
    ds_read_b64_tr_b16 v[88:89], v134
    ds_read_b64_tr_b16 v[90:91], v134 offset:1024
    s_waitcnt lgkmcnt(12)
    v_mfma_f32_16x16x32_bf16 v[0:3], a[0:3], v[64:67], 0
    ds_read_b64_tr_b16 v[92:93], v135
    v_mfma_f32_16x16x32_bf16 v[4:7], a[64:67], v[64:67], 0
    ds_read_b64_tr_b16 v[94:95], v135 offset:1024
    s_add_u32 s26, s24, 0x300000
    s_add_u32 m0, s29, 0x18000
    s_nop 0
    buffer_load_dwordx4 v136, s[16:19], s26 offen lds
    s_waitcnt lgkmcnt(12)
    v_mfma_f32_16x16x32_bf16 v[8:11], a[0:3], v[68:71], 0
    ds_read_b64_tr_b16 v[96:97], v128 offset:8192
    v_mfma_f32_16x16x32_bf16 v[12:15], a[64:67], v[68:71], 0
    ds_read_b64_tr_b16 v[98:99], v128 offset:9216
    s_add_u32 s26, s24, 0x320000
    s_add_u32 m0, s29, 0x19000
    s_nop 0
    buffer_load_dwordx4 v136, s[16:19], s26 offen lds
    s_waitcnt lgkmcnt(12)
    v_mfma_f32_16x16x32_bf16 v[16:19], a[0:3], v[72:75], 0
    ds_read_b64_tr_b16 v[100:101], v129 offset:8192
    v_mfma_f32_16x16x32_bf16 v[20:23], a[64:67], v[72:75], 0
    ds_read_b64_tr_b16 v[102:103], v129 offset:9216
    s_add_u32 s26, s24, 0x340000
    s_add_u32 m0, s29, 0x1a000
    s_nop 0
    buffer_load_dwordx4 v136, s[16:19], s26 offen lds
    s_waitcnt lgkmcnt(12)
    v_mfma_f32_16x16x32_bf16 v[24:27], a[0:3], v[76:79], 0
    ds_read_b64_tr_b16 v[104:105], v130 offset:8192
    v_mfma_f32_16x16x32_bf16 v[28:31], a[64:67], v[76:79], 0
    ds_read_b64_tr_b16 v[106:107], v130 offset:9216
    s_add_u32 s26, s24, 0x360000
    s_add_u32 m0, s29, 0x1b000
    s_nop 0
    buffer_load_dwordx4 v136, s[16:19], s26 offen lds
    s_waitcnt lgkmcnt(12)
    v_mfma_f32_16x16x32_bf16 v[32:35], a[0:3], v[80:83], 0
    ds_read_b64_tr_b16 v[108:109], v131 offset:8192
    v_mfma_f32_16x16x32_bf16 v[36:39], a[64:67], v[80:83], 0
    ds_read_b64_tr_b16 v[110:111], v131 offset:9216
    s_add_u32 s26, s24, 0x380000
    s_add_u32 m0, s29, 0x1c000
    s_nop 0
    buffer_load_dwordx4 v136, s[16:19], s26 offen lds
    s_waitcnt lgkmcnt(12)
    v_mfma_f32_16x16x32_bf16 v[40:43], a[0:3], v[84:87], 0
    ds_read_b64_tr_b16 v[112:113], v132 offset:8192
    v_mfma_f32_16x16x32_bf16 v[44:47], a[64:67], v[84:87], 0
    ds_read_b64_tr_b16 v[114:115], v132 offset:9216
    s_add_u32 s26, s24, 0x3a0000
    s_add_u32 m0, s29, 0x1d000
    s_nop 0
    buffer_load_dwordx4 v136, s[16:19], s26 offen lds
    s_waitcnt lgkmcnt(12)
    v_mfma_f32_16x16x32_bf16 v[48:51], a[0:3], v[88:91], 0
    ds_read_b64_tr_b16 v[116:117], v133 offset:8192
    v_mfma_f32_16x16x32_bf16 v[52:55], a[64:67], v[88:91], 0
    ds_read_b64_tr_b16 v[118:119], v133 offset:9216
    s_add_u32 s26, s24, 0x3c0000
    s_add_u32 m0, s29, 0x1e000
    s_nop 0
    buffer_load_dwordx4 v136, s[16:19], s26 offen lds
    s_waitcnt lgkmcnt(12)
    v_mfma_f32_16x16x32_bf16 v[56:59], a[0:3], v[92:95], 0
    ds_read_b64_tr_b16 v[120:121], v134 offset:8192
    v_mfma_f32_16x16x32_bf16 v[60:63], a[64:67], v[92:95], 0
    ds_read_b64_tr_b16 v[122:123], v134 offset:9216
    s_add_u32 s26, s24, 0x3e0000
    s_add_u32 m0, s29, 0x1f000
    s_nop 0
    buffer_load_dwordx4 v136, s[16:19], s26 offen lds
    s_waitcnt lgkmcnt(12)
    v_mfma_f32_16x16x32_bf16 v[0:3], a[4:7], v[96:99], v[0:3]
    ds_read_b64_tr_b16 v[124:125], v135 offset:8192
    v_mfma_f32_16x16x32_bf16 v[4:7], a[68:71], v[96:99], v[4:7]
    ds_read_b64_tr_b16 v[126:127], v135 offset:9216
    s_waitcnt lgkmcnt(12)
    v_mfma_f32_16x16x32_bf16 v[8:11], a[4:7], v[100:103], v[8:11]
    ds_read_b64_tr_b16 v[64:65], v128 offset:16384
    v_mfma_f32_16x16x32_bf16 v[12:15], a[68:71], v[100:103], v[12:15]
    ds_read_b64_tr_b16 v[66:67], v128 offset:17408
    s_waitcnt lgkmcnt(12)
    v_mfma_f32_16x16x32_bf16 v[16:19], a[4:7], v[104:107], v[16:19]
    ds_read_b64_tr_b16 v[68:69], v129 offset:16384
    v_mfma_f32_16x16x32_bf16 v[20:23], a[68:71], v[104:107], v[20:23]
    ds_read_b64_tr_b16 v[70:71], v129 offset:17408
    s_waitcnt lgkmcnt(12)
    v_mfma_f32_16x16x32_bf16 v[24:27], a[4:7], v[108:111], v[24:27]
    ds_read_b64_tr_b16 v[72:73], v130 offset:16384
    v_mfma_f32_16x16x32_bf16 v[28:31], a[68:71], v[108:111], v[28:31]
    ds_read_b64_tr_b16 v[74:75], v130 offset:17408
    s_waitcnt lgkmcnt(12)
    v_mfma_f32_16x16x32_bf16 v[32:35], a[4:7], v[112:115], v[32:35]
    ds_read_b64_tr_b16 v[76:77], v131 offset:16384
    v_mfma_f32_16x16x32_bf16 v[36:39], a[68:71], v[112:115], v[36:39]
    ds_read_b64_tr_b16 v[78:79], v131 offset:17408
    s_waitcnt lgkmcnt(12)
    v_mfma_f32_16x16x32_bf16 v[40:43], a[4:7], v[116:119], v[40:43]
    ds_read_b64_tr_b16 v[80:81], v132 offset:16384
    v_mfma_f32_16x16x32_bf16 v[44:47], a[68:71], v[116:119], v[44:47]
    ds_read_b64_tr_b16 v[82:83], v132 offset:17408
    s_waitcnt lgkmcnt(12)
    v_mfma_f32_16x16x32_bf16 v[48:51], a[4:7], v[120:123], v[48:51]
    ds_read_b64_tr_b16 v[84:85], v133 offset:16384
    v_mfma_f32_16x16x32_bf16 v[52:55], a[68:71], v[120:123], v[52:55]
    ds_read_b64_tr_b16 v[86:87], v133 offset:17408
    s_waitcnt lgkmcnt(12)
    v_mfma_f32_16x16x32_bf16 v[56:59], a[4:7], v[124:127], v[56:59]
    ds_read_b64_tr_b16 v[88:89], v134 offset:16384
    v_mfma_f32_16x16x32_bf16 v[60:63], a[68:71], v[124:127], v[60:63]
    ds_read_b64_tr_b16 v[90:91], v134 offset:17408
    s_waitcnt lgkmcnt(12)
    v_mfma_f32_16x16x32_bf16 v[0:3], a[8:11], v[64:67], v[0:3]
    ds_read_b64_tr_b16 v[92:93], v135 offset:16384
    v_mfma_f32_16x16x32_bf16 v[4:7], a[72:75], v[64:67], v[4:7]
    ds_read_b64_tr_b16 v[94:95], v135 offset:17408
    s_waitcnt lgkmcnt(12)
    v_mfma_f32_16x16x32_bf16 v[8:11], a[8:11], v[68:71], v[8:11]
    ds_read_b64_tr_b16 v[96:97], v128 offset:24576
    v_mfma_f32_16x16x32_bf16 v[12:15], a[72:75], v[68:71], v[12:15]
    ds_read_b64_tr_b16 v[98:99], v128 offset:25600
    s_waitcnt lgkmcnt(12)
    v_mfma_f32_16x16x32_bf16 v[16:19], a[8:11], v[72:75], v[16:19]
    ds_read_b64_tr_b16 v[100:101], v129 offset:24576
    v_mfma_f32_16x16x32_bf16 v[20:23], a[72:75], v[72:75], v[20:23]
    ds_read_b64_tr_b16 v[102:103], v129 offset:25600
    s_waitcnt lgkmcnt(12)
    v_mfma_f32_16x16x32_bf16 v[24:27], a[8:11], v[76:79], v[24:27]
    ds_read_b64_tr_b16 v[104:105], v130 offset:24576
    v_mfma_f32_16x16x32_bf16 v[28:31], a[72:75], v[76:79], v[28:31]
    ds_read_b64_tr_b16 v[106:107], v130 offset:25600
    s_waitcnt lgkmcnt(12)
    v_mfma_f32_16x16x32_bf16 v[32:35], a[8:11], v[80:83], v[32:35]
    ds_read_b64_tr_b16 v[108:109], v131 offset:24576
    v_mfma_f32_16x16x32_bf16 v[36:39], a[72:75], v[80:83], v[36:39]
    ds_read_b64_tr_b16 v[110:111], v131 offset:25600
    s_waitcnt lgkmcnt(12)
    v_mfma_f32_16x16x32_bf16 v[40:43], a[8:11], v[84:87], v[40:43]
    ds_read_b64_tr_b16 v[112:113], v132 offset:24576
    v_mfma_f32_16x16x32_bf16 v[44:47], a[72:75], v[84:87], v[44:47]
    ds_read_b64_tr_b16 v[114:115], v132 offset:25600
    s_waitcnt lgkmcnt(12)
    v_mfma_f32_16x16x32_bf16 v[48:51], a[8:11], v[88:91], v[48:51]
    ds_read_b64_tr_b16 v[116:117], v133 offset:24576
    v_mfma_f32_16x16x32_bf16 v[52:55], a[72:75], v[88:91], v[52:55]
    ds_read_b64_tr_b16 v[118:119], v133 offset:25600
    s_waitcnt lgkmcnt(12)
    v_mfma_f32_16x16x32_bf16 v[56:59], a[8:11], v[92:95], v[56:59]
    ds_read_b64_tr_b16 v[120:121], v134 offset:24576
    v_mfma_f32_16x16x32_bf16 v[60:63], a[72:75], v[92:95], v[60:63]
    ds_read_b64_tr_b16 v[122:123], v134 offset:25600
    s_waitcnt lgkmcnt(12)
    v_mfma_f32_16x16x32_bf16 v[0:3], a[12:15], v[96:99], v[0:3]
    ds_read_b64_tr_b16 v[124:125], v135 offset:24576
    v_mfma_f32_16x16x32_bf16 v[4:7], a[76:79], v[96:99], v[4:7]
    ds_read_b64_tr_b16 v[126:127], v135 offset:25600
    s_waitcnt lgkmcnt(12)
    v_mfma_f32_16x16x32_bf16 v[8:11], a[12:15], v[100:103], v[8:11]
    v_mfma_f32_16x16x32_bf16 v[12:15], a[76:79], v[100:103], v[12:15]
    s_waitcnt lgkmcnt(10)
    v_mfma_f32_16x16x32_bf16 v[16:19], a[12:15], v[104:107], v[16:19]
    v_mfma_f32_16x16x32_bf16 v[20:23], a[76:79], v[104:107], v[20:23]
    s_waitcnt lgkmcnt(8)
    v_mfma_f32_16x16x32_bf16 v[24:27], a[12:15], v[108:111], v[24:27]
    v_mfma_f32_16x16x32_bf16 v[28:31], a[76:79], v[108:111], v[28:31]
    s_waitcnt lgkmcnt(6)
    v_mfma_f32_16x16x32_bf16 v[32:35], a[12:15], v[112:115], v[32:35]
    v_mfma_f32_16x16x32_bf16 v[36:39], a[76:79], v[112:115], v[36:39]
    s_waitcnt lgkmcnt(4)
    v_mfma_f32_16x16x32_bf16 v[40:43], a[12:15], v[116:119], v[40:43]
    v_mfma_f32_16x16x32_bf16 v[44:47], a[76:79], v[116:119], v[44:47]
    s_waitcnt lgkmcnt(2)
    v_mfma_f32_16x16x32_bf16 v[48:51], a[12:15], v[120:123], v[48:51]
    v_mfma_f32_16x16x32_bf16 v[52:55], a[76:79], v[120:123], v[52:55]
    s_waitcnt lgkmcnt(0)
    v_mfma_f32_16x16x32_bf16 v[56:59], a[12:15], v[124:127], v[56:59]
    v_mfma_f32_16x16x32_bf16 v[60:63], a[76:79], v[124:127], v[60:63]
    s_waitcnt vmcnt(16)
    s_barrier
    ds_read_b64_tr_b16 v[64:65], v128 offset:32768
    ds_read_b64_tr_b16 v[66:67], v128 offset:33792
    ds_read_b64_tr_b16 v[68:69], v129 offset:32768
    ds_read_b64_tr_b16 v[70:71], v129 offset:33792
    ds_read_b64_tr_b16 v[72:73], v130 offset:32768
    ds_read_b64_tr_b16 v[74:75], v130 offset:33792
    ds_read_b64_tr_b16 v[76:77], v131 offset:32768
    ds_read_b64_tr_b16 v[78:79], v131 offset:33792
    ds_read_b64_tr_b16 v[80:81], v132 offset:32768
    ds_read_b64_tr_b16 v[82:83], v132 offset:33792
    ds_read_b64_tr_b16 v[84:85], v133 offset:32768
    ds_read_b64_tr_b16 v[86:87], v133 offset:33792
    ds_read_b64_tr_b16 v[88:89], v134 offset:32768
    ds_read_b64_tr_b16 v[90:91], v134 offset:33792
    s_add_u32 s39, s39, s37
    s_lshr_b32 s26, s39, 5
    s_cmp_eq_u32 s26, 0
    s_cselect_b64 s[16:17], s[62:63], s[60:61]
    s_cmp_eq_u32 s26, 1
    s_cselect_b64 s[16:17], s[64:65], s[16:17]
    s_and_b32 s17, s17, 0xffff
    s_cmp_lt_u32 s39, 96
    s_cselect_b32 s18, 0x400000, 0
    s_and_b32 s24, s39, 31
    s_lshl_b32 s24, s24, 8
    s_waitcnt lgkmcnt(12)
    v_mfma_f32_16x16x32_bf16 v[0:3], a[16:19], v[64:67], v[0:3]
    ds_read_b64_tr_b16 v[92:93], v135 offset:32768
    v_mfma_f32_16x16x32_bf16 v[4:7], a[80:83], v[64:67], v[4:7]
    ds_read_b64_tr_b16 v[94:95], v135 offset:33792
    s_add_u32 s26, s24, 0x0
    s_add_u32 m0, s29, 0x0
    s_nop 0
    buffer_load_dwordx4 v136, s[16:19], s26 offen lds
    s_waitcnt lgkmcnt(12)
    v_mfma_f32_16x16x32_bf16 v[8:11], a[16:19], v[68:71], v[8:11]
    ds_read_b64_tr_b16 v[96:97], v128 offset:40960
    v_mfma_f32_16x16x32_bf16 v[12:15], a[80:83], v[68:71], v[12:15]
    ds_read_b64_tr_b16 v[98:99], v128 offset:41984
    s_add_u32 s26, s24, 0x20000
    s_add_u32 m0, s29, 0x1000
    s_nop 0
    buffer_load_dwordx4 v136, s[16:19], s26 offen lds
    s_waitcnt lgkmcnt(12)
    v_mfma_f32_16x16x32_bf16 v[16:19], a[16:19], v[72:75], v[16:19]
    ds_read_b64_tr_b16 v[100:101], v129 offset:40960
    v_mfma_f32_16x16x32_bf16 v[20:23], a[80:83], v[72:75], v[20:23]
    ds_read_b64_tr_b16 v[102:103], v129 offset:41984
    s_add_u32 s26, s24, 0x40000
    s_add_u32 m0, s29, 0x2000
    s_nop 0
    buffer_load_dwordx4 v136, s[16:19], s26 offen lds
    s_waitcnt lgkmcnt(12)
    v_mfma_f32_16x16x32_bf16 v[24:27], a[16:19], v[76:79], v[24:27]
    ds_read_b64_tr_b16 v[104:105], v130 offset:40960
    v_mfma_f32_16x16x32_bf16 v[28:31], a[80:83], v[76:79], v[28:31]
    ds_read_b64_tr_b16 v[106:107], v130 offset:41984
    s_add_u32 s26, s24, 0x60000
    s_add_u32 m0, s29, 0x3000
    s_nop 0
    buffer_load_dwordx4 v136, s[16:19], s26 offen lds
    s_waitcnt lgkmcnt(12)
    v_mfma_f32_16x16x32_bf16 v[32:35], a[16:19], v[80:83], v[32:35]
    ds_read_b64_tr_b16 v[108:109], v131 offset:40960
    v_mfma_f32_16x16x32_bf16 v[36:39], a[80:83], v[80:83], v[36:39]
    ds_read_b64_tr_b16 v[110:111], v131 offset:41984
    s_add_u32 s26, s24, 0x80000
    s_add_u32 m0, s29, 0x4000
    s_nop 0
    buffer_load_dwordx4 v136, s[16:19], s26 offen lds
    s_waitcnt lgkmcnt(12)
    v_mfma_f32_16x16x32_bf16 v[40:43], a[16:19], v[84:87], v[40:43]
    ds_read_b64_tr_b16 v[112:113], v132 offset:40960
    v_mfma_f32_16x16x32_bf16 v[44:47], a[80:83], v[84:87], v[44:47]
    ds_read_b64_tr_b16 v[114:115], v132 offset:41984
    s_add_u32 s26, s24, 0xa0000
    s_add_u32 m0, s29, 0x5000
    s_nop 0
    buffer_load_dwordx4 v136, s[16:19], s26 offen lds
    s_waitcnt lgkmcnt(12)
    v_mfma_f32_16x16x32_bf16 v[48:51], a[16:19], v[88:91], v[48:51]
    ds_read_b64_tr_b16 v[116:117], v133 offset:40960
    v_mfma_f32_16x16x32_bf16 v[52:55], a[80:83], v[88:91], v[52:55]
    ds_read_b64_tr_b16 v[118:119], v133 offset:41984
    s_add_u32 s26, s24, 0xc0000
    s_add_u32 m0, s29, 0x6000
    s_nop 0
    buffer_load_dwordx4 v136, s[16:19], s26 offen lds
    s_waitcnt lgkmcnt(12)
    v_mfma_f32_16x16x32_bf16 v[56:59], a[16:19], v[92:95], v[56:59]
    ds_read_b64_tr_b16 v[120:121], v134 offset:40960
    v_mfma_f32_16x16x32_bf16 v[60:63], a[80:83], v[92:95], v[60:63]
    ds_read_b64_tr_b16 v[122:123], v134 offset:41984
    s_add_u32 s26, s24, 0xe0000
    s_add_u32 m0, s29, 0x7000
    s_nop 0
    buffer_load_dwordx4 v136, s[16:19], s26 offen lds
    s_waitcnt lgkmcnt(12)
    v_mfma_f32_16x16x32_bf16 v[0:3], a[20:23], v[96:99], v[0:3]
    ds_read_b64_tr_b16 v[124:125], v135 offset:40960
    v_mfma_f32_16x16x32_bf16 v[4:7], a[84:87], v[96:99], v[4:7]
    ds_read_b64_tr_b16 v[126:127], v135 offset:41984
    s_waitcnt lgkmcnt(12)
    v_mfma_f32_16x16x32_bf16 v[8:11], a[20:23], v[100:103], v[8:11]
    ds_read_b64_tr_b16 v[64:65], v128 offset:49152
    v_mfma_f32_16x16x32_bf16 v[12:15], a[84:87], v[100:103], v[12:15]
    ds_read_b64_tr_b16 v[66:67], v128 offset:50176
    s_waitcnt lgkmcnt(12)
    v_mfma_f32_16x16x32_bf16 v[16:19], a[20:23], v[104:107], v[16:19]
    ds_read_b64_tr_b16 v[68:69], v129 offset:49152
    v_mfma_f32_16x16x32_bf16 v[20:23], a[84:87], v[104:107], v[20:23]
    ds_read_b64_tr_b16 v[70:71], v129 offset:50176
    s_waitcnt lgkmcnt(12)
    v_mfma_f32_16x16x32_bf16 v[24:27], a[20:23], v[108:111], v[24:27]
    ds_read_b64_tr_b16 v[72:73], v130 offset:49152
    v_mfma_f32_16x16x32_bf16 v[28:31], a[84:87], v[108:111], v[28:31]
    ds_read_b64_tr_b16 v[74:75], v130 offset:50176
    s_waitcnt lgkmcnt(12)
    v_mfma_f32_16x16x32_bf16 v[32:35], a[20:23], v[112:115], v[32:35]
    ds_read_b64_tr_b16 v[76:77], v131 offset:49152
    v_mfma_f32_16x16x32_bf16 v[36:39], a[84:87], v[112:115], v[36:39]
    ds_read_b64_tr_b16 v[78:79], v131 offset:50176
    s_waitcnt lgkmcnt(12)
    v_mfma_f32_16x16x32_bf16 v[40:43], a[20:23], v[116:119], v[40:43]
    ds_read_b64_tr_b16 v[80:81], v132 offset:49152
    v_mfma_f32_16x16x32_bf16 v[44:47], a[84:87], v[116:119], v[44:47]
    ds_read_b64_tr_b16 v[82:83], v132 offset:50176
    s_waitcnt lgkmcnt(12)
    v_mfma_f32_16x16x32_bf16 v[48:51], a[20:23], v[120:123], v[48:51]
    ds_read_b64_tr_b16 v[84:85], v133 offset:49152
    v_mfma_f32_16x16x32_bf16 v[52:55], a[84:87], v[120:123], v[52:55]
    ds_read_b64_tr_b16 v[86:87], v133 offset:50176
    s_waitcnt lgkmcnt(12)
    v_mfma_f32_16x16x32_bf16 v[56:59], a[20:23], v[124:127], v[56:59]
    ds_read_b64_tr_b16 v[88:89], v134 offset:49152
    v_mfma_f32_16x16x32_bf16 v[60:63], a[84:87], v[124:127], v[60:63]
    ds_read_b64_tr_b16 v[90:91], v134 offset:50176
    s_waitcnt lgkmcnt(12)
    v_mfma_f32_16x16x32_bf16 v[0:3], a[24:27], v[64:67], v[0:3]
    ds_read_b64_tr_b16 v[92:93], v135 offset:49152
    v_mfma_f32_16x16x32_bf16 v[4:7], a[88:91], v[64:67], v[4:7]
    ds_read_b64_tr_b16 v[94:95], v135 offset:50176
    s_waitcnt lgkmcnt(12)
    v_mfma_f32_16x16x32_bf16 v[8:11], a[24:27], v[68:71], v[8:11]
    ds_read_b64_tr_b16 v[96:97], v128 offset:57344
    v_mfma_f32_16x16x32_bf16 v[12:15], a[88:91], v[68:71], v[12:15]
    ds_read_b64_tr_b16 v[98:99], v128 offset:58368
    s_waitcnt lgkmcnt(12)
    v_mfma_f32_16x16x32_bf16 v[16:19], a[24:27], v[72:75], v[16:19]
    ds_read_b64_tr_b16 v[100:101], v129 offset:57344
    v_mfma_f32_16x16x32_bf16 v[20:23], a[88:91], v[72:75], v[20:23]
    ds_read_b64_tr_b16 v[102:103], v129 offset:58368
    s_waitcnt lgkmcnt(12)
    v_mfma_f32_16x16x32_bf16 v[24:27], a[24:27], v[76:79], v[24:27]
    ds_read_b64_tr_b16 v[104:105], v130 offset:57344
    v_mfma_f32_16x16x32_bf16 v[28:31], a[88:91], v[76:79], v[28:31]
    ds_read_b64_tr_b16 v[106:107], v130 offset:58368
    s_waitcnt lgkmcnt(12)
    v_mfma_f32_16x16x32_bf16 v[32:35], a[24:27], v[80:83], v[32:35]
    ds_read_b64_tr_b16 v[108:109], v131 offset:57344
    v_mfma_f32_16x16x32_bf16 v[36:39], a[88:91], v[80:83], v[36:39]
    ds_read_b64_tr_b16 v[110:111], v131 offset:58368
    s_waitcnt lgkmcnt(12)
    v_mfma_f32_16x16x32_bf16 v[40:43], a[24:27], v[84:87], v[40:43]
    ds_read_b64_tr_b16 v[112:113], v132 offset:57344
    v_mfma_f32_16x16x32_bf16 v[44:47], a[88:91], v[84:87], v[44:47]
    ds_read_b64_tr_b16 v[114:115], v132 offset:58368
    s_waitcnt lgkmcnt(12)
    v_mfma_f32_16x16x32_bf16 v[48:51], a[24:27], v[88:91], v[48:51]
    ds_read_b64_tr_b16 v[116:117], v133 offset:57344
    v_mfma_f32_16x16x32_bf16 v[52:55], a[88:91], v[88:91], v[52:55]
    ds_read_b64_tr_b16 v[118:119], v133 offset:58368
    s_waitcnt lgkmcnt(12)
    v_mfma_f32_16x16x32_bf16 v[56:59], a[24:27], v[92:95], v[56:59]
    ds_read_b64_tr_b16 v[120:121], v134 offset:57344
    v_mfma_f32_16x16x32_bf16 v[60:63], a[88:91], v[92:95], v[60:63]
    ds_read_b64_tr_b16 v[122:123], v134 offset:58368
    s_waitcnt lgkmcnt(12)
    v_mfma_f32_16x16x32_bf16 v[0:3], a[28:31], v[96:99], v[0:3]
    ds_read_b64_tr_b16 v[124:125], v135 offset:57344
    v_mfma_f32_16x16x32_bf16 v[4:7], a[92:95], v[96:99], v[4:7]
    ds_read_b64_tr_b16 v[126:127], v135 offset:58368
    s_waitcnt lgkmcnt(12)
    v_mfma_f32_16x16x32_bf16 v[8:11], a[28:31], v[100:103], v[8:11]
    v_mfma_f32_16x16x32_bf16 v[12:15], a[92:95], v[100:103], v[12:15]
    s_waitcnt lgkmcnt(10)
    v_mfma_f32_16x16x32_bf16 v[16:19], a[28:31], v[104:107], v[16:19]
    v_mfma_f32_16x16x32_bf16 v[20:23], a[92:95], v[104:107], v[20:23]
    s_waitcnt lgkmcnt(8)
    v_mfma_f32_16x16x32_bf16 v[24:27], a[28:31], v[108:111], v[24:27]
    v_mfma_f32_16x16x32_bf16 v[28:31], a[92:95], v[108:111], v[28:31]
    s_waitcnt lgkmcnt(6)
    v_mfma_f32_16x16x32_bf16 v[32:35], a[28:31], v[112:115], v[32:35]
    v_mfma_f32_16x16x32_bf16 v[36:39], a[92:95], v[112:115], v[36:39]
    s_waitcnt lgkmcnt(4)
    v_mfma_f32_16x16x32_bf16 v[40:43], a[28:31], v[116:119], v[40:43]
    v_mfma_f32_16x16x32_bf16 v[44:47], a[92:95], v[116:119], v[44:47]
    s_waitcnt lgkmcnt(2)
    v_mfma_f32_16x16x32_bf16 v[48:51], a[28:31], v[120:123], v[48:51]
    v_mfma_f32_16x16x32_bf16 v[52:55], a[92:95], v[120:123], v[52:55]
    s_waitcnt lgkmcnt(0)
    v_mfma_f32_16x16x32_bf16 v[56:59], a[28:31], v[124:127], v[56:59]
    v_mfma_f32_16x16x32_bf16 v[60:63], a[92:95], v[124:127], v[60:63]
    v_xor_b32 v128, 0x10000, v128
    v_xor_b32 v129, 0x10000, v129
    v_xor_b32 v130, 0x10000, v130
    v_xor_b32 v131, 0x10000, v131
    v_xor_b32 v132, 0x10000, v132
    v_xor_b32 v133, 0x10000, v133
    v_xor_b32 v134, 0x10000, v134
    v_xor_b32 v135, 0x10000, v135
    s_waitcnt vmcnt(16)
    s_barrier
    ds_read_b64_tr_b16 v[64:65], v128
    ds_read_b64_tr_b16 v[66:67], v128 offset:1024
    ds_read_b64_tr_b16 v[68:69], v129
    ds_read_b64_tr_b16 v[70:71], v129 offset:1024
    ds_read_b64_tr_b16 v[72:73], v130
    ds_read_b64_tr_b16 v[74:75], v130 offset:1024
    ds_read_b64_tr_b16 v[76:77], v131
    ds_read_b64_tr_b16 v[78:79], v131 offset:1024
    ds_read_b64_tr_b16 v[80:81], v132
    ds_read_b64_tr_b16 v[82:83], v132 offset:1024
    ds_read_b64_tr_b16 v[84:85], v133
    ds_read_b64_tr_b16 v[86:87], v133 offset:1024
    ds_read_b64_tr_b16 v[88:89], v134
    ds_read_b64_tr_b16 v[90:91], v134 offset:1024
    s_cmp_eq_u32 s40, 0
    s_cbranch_scc1 L_nopf_96
    s_cmp_lg_u32 s87, 0
    s_cbranch_scc1 L_modeok_97
    v_readfirstlane_b32 s96, v140
    v_readfirstlane_b32 s97, v141
    s_nop 0
    s_cmp_lg_u32 s97, 0
    s_cselect_b32 s87, s96, 0
    s_cmp_eq_u32 s87, 1
    s_cbranch_scc1 L_modeok_97
    s_mov_b32 s96, 0
L_mode_98:
    buffer_load_dwordx2 v[140:141], off, s[92:95], 0 offset:36 sc1
    s_waitcnt vmcnt(0)
    v_readfirstlane_b32 s87, v140
    v_readfirstlane_b32 s97, v141
    s_nop 0
    s_min_u32 s97, s97, s87
    s_cmp_lg_u32 s97, 0
    s_cbranch_scc1 L_moded_99
    s_sleep 4
    s_add_u32 s96, s96, 1
    s_cmp_lg_u32 s96, 0x100
    s_cbranch_scc1 L_modef_100
    v_mov_b32 v140, 2
    v_mov_b32 v141, 0
    s_mov_b64 exec, 1
    buffer_atomic_cmpswap v[140:141], off, s[92:95], 0 offset:36
    s_mov_b64 exec, -1
L_modef_100:
    s_cmp_lt_u32 s96, 0x10000
    s_cbranch_scc1 L_mode_98
L_moded_99:
    s_cmp_lg_u32 s87, 1
    s_cbranch_scc1 L_fallback
L_modeok_97:
    s_cmp_lg_u32 s100, 0
    s_cbranch_scc1 L_flag_101
    v_mov_b32 v138, 1
    s_mov_b64 exec, 1
    buffer_store_dword v138, off, s[8:11], s40 sc1
    s_mov_b64 exec, -1
L_flag_101:
    s_mov_b32 s40, 0
L_nopf_96:
    s_waitcnt lgkmcnt(12)
    v_mfma_f32_16x16x32_bf16 v[0:3], a[32:35], v[64:67], v[0:3]
    ds_read_b64_tr_b16 v[92:93], v135
    v_mfma_f32_16x16x32_bf16 v[4:7], a[96:99], v[64:67], v[4:7]
    ds_read_b64_tr_b16 v[94:95], v135 offset:1024
    s_add_u32 s26, s24, 0x100000
    s_add_u32 m0, s29, 0x8000
    s_nop 0
    buffer_load_dwordx4 v136, s[16:19], s26 offen lds
    s_waitcnt lgkmcnt(12)
    v_mfma_f32_16x16x32_bf16 v[8:11], a[32:35], v[68:71], v[8:11]
    ds_read_b64_tr_b16 v[96:97], v128 offset:8192
    v_mfma_f32_16x16x32_bf16 v[12:15], a[96:99], v[68:71], v[12:15]
    ds_read_b64_tr_b16 v[98:99], v128 offset:9216
    s_add_u32 s26, s24, 0x120000
    s_add_u32 m0, s29, 0x9000
    s_nop 0
    buffer_load_dwordx4 v136, s[16:19], s26 offen lds
    s_waitcnt lgkmcnt(12)
    v_mfma_f32_16x16x32_bf16 v[16:19], a[32:35], v[72:75], v[16:19]
    ds_read_b64_tr_b16 v[100:101], v129 offset:8192
    v_mfma_f32_16x16x32_bf16 v[20:23], a[96:99], v[72:75], v[20:23]
    ds_read_b64_tr_b16 v[102:103], v129 offset:9216
    s_add_u32 s26, s24, 0x140000
    s_add_u32 m0, s29, 0xa000
    s_nop 0
    buffer_load_dwordx4 v136, s[16:19], s26 offen lds
    s_waitcnt lgkmcnt(12)
    v_mfma_f32_16x16x32_bf16 v[24:27], a[32:35], v[76:79], v[24:27]
    ds_read_b64_tr_b16 v[104:105], v130 offset:8192
    v_mfma_f32_16x16x32_bf16 v[28:31], a[96:99], v[76:79], v[28:31]
    ds_read_b64_tr_b16 v[106:107], v130 offset:9216
    s_add_u32 s26, s24, 0x160000
    s_add_u32 m0, s29, 0xb000
    s_nop 0
    buffer_load_dwordx4 v136, s[16:19], s26 offen lds
    s_waitcnt lgkmcnt(12)
    v_mfma_f32_16x16x32_bf16 v[32:35], a[32:35], v[80:83], v[32:35]
    ds_read_b64_tr_b16 v[108:109], v131 offset:8192
    v_mfma_f32_16x16x32_bf16 v[36:39], a[96:99], v[80:83], v[36:39]
    ds_read_b64_tr_b16 v[110:111], v131 offset:9216
    s_add_u32 s26, s24, 0x180000
    s_add_u32 m0, s29, 0xc000
    s_nop 0
    buffer_load_dwordx4 v136, s[16:19], s26 offen lds
    s_waitcnt lgkmcnt(12)
    v_mfma_f32_16x16x32_bf16 v[40:43], a[32:35], v[84:87], v[40:43]
    ds_read_b64_tr_b16 v[112:113], v132 offset:8192
    v_mfma_f32_16x16x32_bf16 v[44:47], a[96:99], v[84:87], v[44:47]
    ds_read_b64_tr_b16 v[114:115], v132 offset:9216
    s_add_u32 s26, s24, 0x1a0000
    s_add_u32 m0, s29, 0xd000
    s_nop 0
    buffer_load_dwordx4 v136, s[16:19], s26 offen lds
    s_waitcnt lgkmcnt(12)
    v_mfma_f32_16x16x32_bf16 v[48:51], a[32:35], v[88:91], v[48:51]
    ds_read_b64_tr_b16 v[116:117], v133 offset:8192
    v_mfma_f32_16x16x32_bf16 v[52:55], a[96:99], v[88:91], v[52:55]
    ds_read_b64_tr_b16 v[118:119], v133 offset:9216
    s_add_u32 s26, s24, 0x1c0000
    s_add_u32 m0, s29, 0xe000
    s_nop 0
    buffer_load_dwordx4 v136, s[16:19], s26 offen lds
    s_waitcnt lgkmcnt(12)
    v_mfma_f32_16x16x32_bf16 v[56:59], a[32:35], v[92:95], v[56:59]
    ds_read_b64_tr_b16 v[120:121], v134 offset:8192
    v_mfma_f32_16x16x32_bf16 v[60:63], a[96:99], v[92:95], v[60:63]
    ds_read_b64_tr_b16 v[122:123], v134 offset:9216
    s_add_u32 s26, s24, 0x1e0000
    s_add_u32 m0, s29, 0xf000
    s_nop 0
    buffer_load_dwordx4 v136, s[16:19], s26 offen lds
    s_waitcnt lgkmcnt(12)
    v_mfma_f32_16x16x32_bf16 v[0:3], a[36:39], v[96:99], v[0:3]
    ds_read_b64_tr_b16 v[124:125], v135 offset:8192
    v_mfma_f32_16x16x32_bf16 v[4:7], a[100:103], v[96:99], v[4:7]
    ds_read_b64_tr_b16 v[126:127], v135 offset:9216
    s_waitcnt lgkmcnt(12)
    v_mfma_f32_16x16x32_bf16 v[8:11], a[36:39], v[100:103], v[8:11]
    ds_read_b64_tr_b16 v[64:65], v128 offset:16384
    v_mfma_f32_16x16x32_bf16 v[12:15], a[100:103], v[100:103], v[12:15]
    ds_read_b64_tr_b16 v[66:67], v128 offset:17408
    s_waitcnt lgkmcnt(12)
    v_mfma_f32_16x16x32_bf16 v[16:19], a[36:39], v[104:107], v[16:19]
    ds_read_b64_tr_b16 v[68:69], v129 offset:16384
    v_mfma_f32_16x16x32_bf16 v[20:23], a[100:103], v[104:107], v[20:23]
    ds_read_b64_tr_b16 v[70:71], v129 offset:17408
    s_waitcnt lgkmcnt(12)
    v_mfma_f32_16x16x32_bf16 v[24:27], a[36:39], v[108:111], v[24:27]
    ds_read_b64_tr_b16 v[72:73], v130 offset:16384
    v_mfma_f32_16x16x32_bf16 v[28:31], a[100:103], v[108:111], v[28:31]
    ds_read_b64_tr_b16 v[74:75], v130 offset:17408
    s_waitcnt lgkmcnt(12)
    v_mfma_f32_16x16x32_bf16 v[32:35], a[36:39], v[112:115], v[32:35]
    ds_read_b64_tr_b16 v[76:77], v131 offset:16384
    v_mfma_f32_16x16x32_bf16 v[36:39], a[100:103], v[112:115], v[36:39]
    ds_read_b64_tr_b16 v[78:79], v131 offset:17408
    s_waitcnt lgkmcnt(12)
    v_mfma_f32_16x16x32_bf16 v[40:43], a[36:39], v[116:119], v[40:43]
    ds_read_b64_tr_b16 v[80:81], v132 offset:16384
    v_mfma_f32_16x16x32_bf16 v[44:47], a[100:103], v[116:119], v[44:47]
    ds_read_b64_tr_b16 v[82:83], v132 offset:17408
    s_waitcnt lgkmcnt(12)
    v_mfma_f32_16x16x32_bf16 v[48:51], a[36:39], v[120:123], v[48:51]
    ds_read_b64_tr_b16 v[84:85], v133 offset:16384
    v_mfma_f32_16x16x32_bf16 v[52:55], a[100:103], v[120:123], v[52:55]
    ds_read_b64_tr_b16 v[86:87], v133 offset:17408
    s_waitcnt lgkmcnt(12)
    v_mfma_f32_16x16x32_bf16 v[56:59], a[36:39], v[124:127], v[56:59]
    ds_read_b64_tr_b16 v[88:89], v134 offset:16384
    v_mfma_f32_16x16x32_bf16 v[60:63], a[100:103], v[124:127], v[60:63]
    ds_read_b64_tr_b16 v[90:91], v134 offset:17408
    s_waitcnt lgkmcnt(12)
    v_mfma_f32_16x16x32_bf16 v[0:3], a[40:43], v[64:67], v[0:3]
    ds_read_b64_tr_b16 v[92:93], v135 offset:16384
    v_mfma_f32_16x16x32_bf16 v[4:7], a[104:107], v[64:67], v[4:7]
    ds_read_b64_tr_b16 v[94:95], v135 offset:17408
    s_waitcnt lgkmcnt(12)
    v_mfma_f32_16x16x32_bf16 v[8:11], a[40:43], v[68:71], v[8:11]
    ds_read_b64_tr_b16 v[96:97], v128 offset:24576
    v_mfma_f32_16x16x32_bf16 v[12:15], a[104:107], v[68:71], v[12:15]
    ds_read_b64_tr_b16 v[98:99], v128 offset:25600
    s_waitcnt lgkmcnt(12)
    v_mfma_f32_16x16x32_bf16 v[16:19], a[40:43], v[72:75], v[16:19]
    ds_read_b64_tr_b16 v[100:101], v129 offset:24576
    v_mfma_f32_16x16x32_bf16 v[20:23], a[104:107], v[72:75], v[20:23]
    ds_read_b64_tr_b16 v[102:103], v129 offset:25600
    s_waitcnt lgkmcnt(12)
    v_mfma_f32_16x16x32_bf16 v[24:27], a[40:43], v[76:79], v[24:27]
    ds_read_b64_tr_b16 v[104:105], v130 offset:24576
    v_mfma_f32_16x16x32_bf16 v[28:31], a[104:107], v[76:79], v[28:31]
    ds_read_b64_tr_b16 v[106:107], v130 offset:25600
    s_waitcnt lgkmcnt(12)
    v_mfma_f32_16x16x32_bf16 v[32:35], a[40:43], v[80:83], v[32:35]
    ds_read_b64_tr_b16 v[108:109], v131 offset:24576
    v_mfma_f32_16x16x32_bf16 v[36:39], a[104:107], v[80:83], v[36:39]
    ds_read_b64_tr_b16 v[110:111], v131 offset:25600
    s_waitcnt lgkmcnt(12)
    v_mfma_f32_16x16x32_bf16 v[40:43], a[40:43], v[84:87], v[40:43]
    ds_read_b64_tr_b16 v[112:113], v132 offset:24576
    v_mfma_f32_16x16x32_bf16 v[44:47], a[104:107], v[84:87], v[44:47]
    ds_read_b64_tr_b16 v[114:115], v132 offset:25600
    s_waitcnt lgkmcnt(12)
    v_mfma_f32_16x16x32_bf16 v[48:51], a[40:43], v[88:91], v[48:51]
    ds_read_b64_tr_b16 v[116:117], v133 offset:24576
    v_mfma_f32_16x16x32_bf16 v[52:55], a[104:107], v[88:91], v[52:55]
    ds_read_b64_tr_b16 v[118:119], v133 offset:25600
    s_waitcnt lgkmcnt(12)
    v_mfma_f32_16x16x32_bf16 v[56:59], a[40:43], v[92:95], v[56:59]
    ds_read_b64_tr_b16 v[120:121], v134 offset:24576
    v_mfma_f32_16x16x32_bf16 v[60:63], a[104:107], v[92:95], v[60:63]
    ds_read_b64_tr_b16 v[122:123], v134 offset:25600
    s_waitcnt lgkmcnt(12)
    v_mfma_f32_16x16x32_bf16 v[0:3], a[44:47], v[96:99], v[0:3]
    ds_read_b64_tr_b16 v[124:125], v135 offset:24576
    v_mfma_f32_16x16x32_bf16 v[4:7], a[108:111], v[96:99], v[4:7]
    ds_read_b64_tr_b16 v[126:127], v135 offset:25600
    s_waitcnt lgkmcnt(12)
    v_mfma_f32_16x16x32_bf16 v[8:11], a[44:47], v[100:103], v[8:11]
    v_mfma_f32_16x16x32_bf16 v[12:15], a[108:111], v[100:103], v[12:15]
    s_waitcnt lgkmcnt(10)
    v_mfma_f32_16x16x32_bf16 v[16:19], a[44:47], v[104:107], v[16:19]
    v_mfma_f32_16x16x32_bf16 v[20:23], a[108:111], v[104:107], v[20:23]
    s_waitcnt lgkmcnt(8)
    v_mfma_f32_16x16x32_bf16 v[24:27], a[44:47], v[108:111], v[24:27]
    v_mfma_f32_16x16x32_bf16 v[28:31], a[108:111], v[108:111], v[28:31]
    s_waitcnt lgkmcnt(6)
    v_mfma_f32_16x16x32_bf16 v[32:35], a[44:47], v[112:115], v[32:35]
    v_mfma_f32_16x16x32_bf16 v[36:39], a[108:111], v[112:115], v[36:39]
    s_waitcnt lgkmcnt(4)
    v_mfma_f32_16x16x32_bf16 v[40:43], a[44:47], v[116:119], v[40:43]
    v_mfma_f32_16x16x32_bf16 v[44:47], a[108:111], v[116:119], v[44:47]
    s_waitcnt lgkmcnt(2)
    v_mfma_f32_16x16x32_bf16 v[48:51], a[44:47], v[120:123], v[48:51]
    v_mfma_f32_16x16x32_bf16 v[52:55], a[108:111], v[120:123], v[52:55]
    s_waitcnt lgkmcnt(0)
    v_mfma_f32_16x16x32_bf16 v[56:59], a[44:47], v[124:127], v[56:59]
    v_mfma_f32_16x16x32_bf16 v[60:63], a[108:111], v[124:127], v[60:63]
    s_waitcnt vmcnt(16)
    s_barrier
    ds_read_b64_tr_b16 v[64:65], v128 offset:32768
    ds_read_b64_tr_b16 v[66:67], v128 offset:33792
    ds_read_b64_tr_b16 v[68:69], v129 offset:32768
    ds_read_b64_tr_b16 v[70:71], v129 offset:33792
    ds_read_b64_tr_b16 v[72:73], v130 offset:32768
    ds_read_b64_tr_b16 v[74:75], v130 offset:33792
    ds_read_b64_tr_b16 v[76:77], v131 offset:32768
    ds_read_b64_tr_b16 v[78:79], v131 offset:33792
    ds_read_b64_tr_b16 v[80:81], v132 offset:32768
    ds_read_b64_tr_b16 v[82:83], v132 offset:33792
    ds_read_b64_tr_b16 v[84:85], v133 offset:32768
    ds_read_b64_tr_b16 v[86:87], v133 offset:33792
    ds_read_b64_tr_b16 v[88:89], v134 offset:32768
    ds_read_b64_tr_b16 v[90:91], v134 offset:33792
    s_waitcnt lgkmcnt(12)
    v_mfma_f32_16x16x32_bf16 v[0:3], a[48:51], v[64:67], v[0:3]
    ds_read_b64_tr_b16 v[92:93], v135 offset:32768
    v_mfma_f32_16x16x32_bf16 v[4:7], a[112:115], v[64:67], v[4:7]
    ds_read_b64_tr_b16 v[94:95], v135 offset:33792
    s_add_u32 s26, s24, 0x200000
    s_add_u32 m0, s29, 0x10000
    s_nop 0
    buffer_load_dwordx4 v136, s[16:19], s26 offen lds
    s_waitcnt lgkmcnt(12)
    v_mfma_f32_16x16x32_bf16 v[8:11], a[48:51], v[68:71], v[8:11]
    ds_read_b64_tr_b16 v[96:97], v128 offset:40960
    v_mfma_f32_16x16x32_bf16 v[12:15], a[112:115], v[68:71], v[12:15]
    ds_read_b64_tr_b16 v[98:99], v128 offset:41984
    s_add_u32 s26, s24, 0x220000
    s_add_u32 m0, s29, 0x11000
    s_nop 0
    buffer_load_dwordx4 v136, s[16:19], s26 offen lds
    s_waitcnt lgkmcnt(12)
    v_mfma_f32_16x16x32_bf16 v[16:19], a[48:51], v[72:75], v[16:19]
    ds_read_b64_tr_b16 v[100:101], v129 offset:40960
    v_mfma_f32_16x16x32_bf16 v[20:23], a[112:115], v[72:75], v[20:23]
    ds_read_b64_tr_b16 v[102:103], v129 offset:41984
    s_add_u32 s26, s24, 0x240000
    s_add_u32 m0, s29, 0x12000
    s_nop 0
    buffer_load_dwordx4 v136, s[16:19], s26 offen lds
    s_waitcnt lgkmcnt(12)
    v_mfma_f32_16x16x32_bf16 v[24:27], a[48:51], v[76:79], v[24:27]
    ds_read_b64_tr_b16 v[104:105], v130 offset:40960
    v_mfma_f32_16x16x32_bf16 v[28:31], a[112:115], v[76:79], v[28:31]
    ds_read_b64_tr_b16 v[106:107], v130 offset:41984
    s_add_u32 s26, s24, 0x260000
    s_add_u32 m0, s29, 0x13000
    s_nop 0
    buffer_load_dwordx4 v136, s[16:19], s26 offen lds
    s_waitcnt lgkmcnt(12)
    v_mfma_f32_16x16x32_bf16 v[32:35], a[48:51], v[80:83], v[32:35]
    ds_read_b64_tr_b16 v[108:109], v131 offset:40960
    v_mfma_f32_16x16x32_bf16 v[36:39], a[112:115], v[80:83], v[36:39]
    ds_read_b64_tr_b16 v[110:111], v131 offset:41984
    s_add_u32 s26, s24, 0x280000
    s_add_u32 m0, s29, 0x14000
    s_nop 0
    buffer_load_dwordx4 v136, s[16:19], s26 offen lds
    s_waitcnt lgkmcnt(12)
    v_mfma_f32_16x16x32_bf16 v[40:43], a[48:51], v[84:87], v[40:43]
    ds_read_b64_tr_b16 v[112:113], v132 offset:40960
    v_mfma_f32_16x16x32_bf16 v[44:47], a[112:115], v[84:87], v[44:47]
    ds_read_b64_tr_b16 v[114:115], v132 offset:41984
    s_add_u32 s26, s24, 0x2a0000
    s_add_u32 m0, s29, 0x15000
    s_nop 0
    buffer_load_dwordx4 v136, s[16:19], s26 offen lds
    s_waitcnt lgkmcnt(12)
    v_mfma_f32_16x16x32_bf16 v[48:51], a[48:51], v[88:91], v[48:51]
    ds_read_b64_tr_b16 v[116:117], v133 offset:40960
    v_mfma_f32_16x16x32_bf16 v[52:55], a[112:115], v[88:91], v[52:55]
    ds_read_b64_tr_b16 v[118:119], v133 offset:41984
    s_add_u32 s26, s24, 0x2c0000
    s_add_u32 m0, s29, 0x16000
    s_nop 0
    buffer_load_dwordx4 v136, s[16:19], s26 offen lds
    s_waitcnt lgkmcnt(12)
    v_mfma_f32_16x16x32_bf16 v[56:59], a[48:51], v[92:95], v[56:59]
    ds_read_b64_tr_b16 v[120:121], v134 offset:40960
    v_mfma_f32_16x16x32_bf16 v[60:63], a[112:115], v[92:95], v[60:63]
    ds_read_b64_tr_b16 v[122:123], v134 offset:41984
    s_add_u32 s26, s24, 0x2e0000
    s_add_u32 m0, s29, 0x17000
    s_nop 0
    buffer_load_dwordx4 v136, s[16:19], s26 offen lds
    s_waitcnt lgkmcnt(12)
    v_mfma_f32_16x16x32_bf16 v[0:3], a[52:55], v[96:99], v[0:3]
    ds_read_b64_tr_b16 v[124:125], v135 offset:40960
    v_mfma_f32_16x16x32_bf16 v[4:7], a[116:119], v[96:99], v[4:7]
    ds_read_b64_tr_b16 v[126:127], v135 offset:41984
    s_waitcnt lgkmcnt(12)
    v_mfma_f32_16x16x32_bf16 v[8:11], a[52:55], v[100:103], v[8:11]
    ds_read_b64_tr_b16 v[64:65], v128 offset:49152
    v_mfma_f32_16x16x32_bf16 v[12:15], a[116:119], v[100:103], v[12:15]
    ds_read_b64_tr_b16 v[66:67], v128 offset:50176
    s_waitcnt lgkmcnt(12)
    v_mfma_f32_16x16x32_bf16 v[16:19], a[52:55], v[104:107], v[16:19]
    ds_read_b64_tr_b16 v[68:69], v129 offset:49152
    v_mfma_f32_16x16x32_bf16 v[20:23], a[116:119], v[104:107], v[20:23]
    ds_read_b64_tr_b16 v[70:71], v129 offset:50176
    s_waitcnt lgkmcnt(12)
    v_mfma_f32_16x16x32_bf16 v[24:27], a[52:55], v[108:111], v[24:27]
    ds_read_b64_tr_b16 v[72:73], v130 offset:49152
    v_mfma_f32_16x16x32_bf16 v[28:31], a[116:119], v[108:111], v[28:31]
    ds_read_b64_tr_b16 v[74:75], v130 offset:50176
    s_waitcnt lgkmcnt(12)
    v_mfma_f32_16x16x32_bf16 v[32:35], a[52:55], v[112:115], v[32:35]
    ds_read_b64_tr_b16 v[76:77], v131 offset:49152
    v_mfma_f32_16x16x32_bf16 v[36:39], a[116:119], v[112:115], v[36:39]
    ds_read_b64_tr_b16 v[78:79], v131 offset:50176
    s_waitcnt lgkmcnt(12)
    v_mfma_f32_16x16x32_bf16 v[40:43], a[52:55], v[116:119], v[40:43]
    ds_read_b64_tr_b16 v[80:81], v132 offset:49152
    v_mfma_f32_16x16x32_bf16 v[44:47], a[116:119], v[116:119], v[44:47]
    ds_read_b64_tr_b16 v[82:83], v132 offset:50176
    s_waitcnt lgkmcnt(12)
    v_mfma_f32_16x16x32_bf16 v[48:51], a[52:55], v[120:123], v[48:51]
    ds_read_b64_tr_b16 v[84:85], v133 offset:49152
    v_mfma_f32_16x16x32_bf16 v[52:55], a[116:119], v[120:123], v[52:55]
    ds_read_b64_tr_b16 v[86:87], v133 offset:50176
    s_waitcnt lgkmcnt(12)
    v_mfma_f32_16x16x32_bf16 v[56:59], a[52:55], v[124:127], v[56:59]
    ds_read_b64_tr_b16 v[88:89], v134 offset:49152
    v_mfma_f32_16x16x32_bf16 v[60:63], a[116:119], v[124:127], v[60:63]
    ds_read_b64_tr_b16 v[90:91], v134 offset:50176
    s_waitcnt lgkmcnt(12)
    v_mfma_f32_16x16x32_bf16 v[0:3], a[56:59], v[64:67], v[0:3]
    ds_read_b64_tr_b16 v[92:93], v135 offset:49152
    v_mfma_f32_16x16x32_bf16 v[4:7], a[120:123], v[64:67], v[4:7]
    ds_read_b64_tr_b16 v[94:95], v135 offset:50176
    s_waitcnt lgkmcnt(12)
    v_mfma_f32_16x16x32_bf16 v[8:11], a[56:59], v[68:71], v[8:11]
    ds_read_b64_tr_b16 v[96:97], v128 offset:57344
    v_mfma_f32_16x16x32_bf16 v[12:15], a[120:123], v[68:71], v[12:15]
    ds_read_b64_tr_b16 v[98:99], v128 offset:58368
    s_waitcnt lgkmcnt(12)
    v_mfma_f32_16x16x32_bf16 v[16:19], a[56:59], v[72:75], v[16:19]
    ds_read_b64_tr_b16 v[100:101], v129 offset:57344
    v_mfma_f32_16x16x32_bf16 v[20:23], a[120:123], v[72:75], v[20:23]
    ds_read_b64_tr_b16 v[102:103], v129 offset:58368
    s_waitcnt lgkmcnt(12)
    v_mfma_f32_16x16x32_bf16 v[24:27], a[56:59], v[76:79], v[24:27]
    ds_read_b64_tr_b16 v[104:105], v130 offset:57344
    v_mfma_f32_16x16x32_bf16 v[28:31], a[120:123], v[76:79], v[28:31]
    ds_read_b64_tr_b16 v[106:107], v130 offset:58368
    s_waitcnt lgkmcnt(12)
    v_mfma_f32_16x16x32_bf16 v[32:35], a[56:59], v[80:83], v[32:35]
    ds_read_b64_tr_b16 v[108:109], v131 offset:57344
    v_mfma_f32_16x16x32_bf16 v[36:39], a[120:123], v[80:83], v[36:39]
    ds_read_b64_tr_b16 v[110:111], v131 offset:58368
    s_waitcnt lgkmcnt(12)
    v_mfma_f32_16x16x32_bf16 v[40:43], a[56:59], v[84:87], v[40:43]
    ds_read_b64_tr_b16 v[112:113], v132 offset:57344
    v_mfma_f32_16x16x32_bf16 v[44:47], a[120:123], v[84:87], v[44:47]
    ds_read_b64_tr_b16 v[114:115], v132 offset:58368
    s_waitcnt lgkmcnt(12)
    v_mfma_f32_16x16x32_bf16 v[48:51], a[56:59], v[88:91], v[48:51]
    ds_read_b64_tr_b16 v[116:117], v133 offset:57344
    v_mfma_f32_16x16x32_bf16 v[52:55], a[120:123], v[88:91], v[52:55]
    ds_read_b64_tr_b16 v[118:119], v133 offset:58368
    s_waitcnt lgkmcnt(12)
    v_mfma_f32_16x16x32_bf16 v[56:59], a[56:59], v[92:95], v[56:59]
    ds_read_b64_tr_b16 v[120:121], v134 offset:57344
    v_mfma_f32_16x16x32_bf16 v[60:63], a[120:123], v[92:95], v[60:63]
    ds_read_b64_tr_b16 v[122:123], v134 offset:58368
    s_waitcnt lgkmcnt(12)
    v_mfma_f32_16x16x32_bf16 v[0:3], a[60:63], v[96:99], v[0:3]
    ds_read_b64_tr_b16 v[124:125], v135 offset:57344
    v_mfma_f32_16x16x32_bf16 v[4:7], a[124:127], v[96:99], v[4:7]
    ds_read_b64_tr_b16 v[126:127], v135 offset:58368
    s_waitcnt lgkmcnt(12)
    v_mfma_f32_16x16x32_bf16 v[8:11], a[60:63], v[100:103], v[8:11]
    v_mfma_f32_16x16x32_bf16 v[12:15], a[124:127], v[100:103], v[12:15]
    s_waitcnt lgkmcnt(10)
    v_mfma_f32_16x16x32_bf16 v[16:19], a[60:63], v[104:107], v[16:19]
    v_mfma_f32_16x16x32_bf16 v[20:23], a[124:127], v[104:107], v[20:23]
    s_waitcnt lgkmcnt(8)
    v_mfma_f32_16x16x32_bf16 v[24:27], a[60:63], v[108:111], v[24:27]
    v_mfma_f32_16x16x32_bf16 v[28:31], a[124:127], v[108:111], v[28:31]
    s_waitcnt lgkmcnt(6)
    v_mfma_f32_16x16x32_bf16 v[32:35], a[60:63], v[112:115], v[32:35]
    v_mfma_f32_16x16x32_bf16 v[36:39], a[124:127], v[112:115], v[36:39]
    s_waitcnt lgkmcnt(4)
    v_mfma_f32_16x16x32_bf16 v[40:43], a[60:63], v[116:119], v[40:43]
    v_mfma_f32_16x16x32_bf16 v[44:47], a[124:127], v[116:119], v[44:47]
    s_waitcnt lgkmcnt(2)
    v_mfma_f32_16x16x32_bf16 v[48:51], a[60:63], v[120:123], v[48:51]
    v_mfma_f32_16x16x32_bf16 v[52:55], a[124:127], v[120:123], v[52:55]
    s_waitcnt lgkmcnt(0)
    v_mfma_f32_16x16x32_bf16 v[56:59], a[60:63], v[124:127], v[56:59]
    v_mfma_f32_16x16x32_bf16 v[60:63], a[124:127], v[124:127], v[60:63]
    v_xor_b32 v128, 0x10000, v128
    v_xor_b32 v129, 0x10000, v129
    v_xor_b32 v130, 0x10000, v130
    v_xor_b32 v131, 0x10000, v131
    v_xor_b32 v132, 0x10000, v132
    v_xor_b32 v133, 0x10000, v133
    v_xor_b32 v134, 0x10000, v134
    v_xor_b32 v135, 0x10000, v135
    v_cvt_pk_bf16_f32 v144, v0, v1
    v_cvt_pk_bf16_f32 v145, v2, v3
    v_cvt_pk_bf16_f32 v146, v4, v5
    v_cvt_pk_bf16_f32 v147, v6, v7
    buffer_store_dwordx4 v[144:147], v137, s[8:11], s25 offen sc1
    v_cvt_pk_bf16_f32 v148, v8, v9
    v_cvt_pk_bf16_f32 v149, v10, v11
    v_cvt_pk_bf16_f32 v150, v12, v13
    v_cvt_pk_bf16_f32 v151, v14, v15
    buffer_store_dwordx4 v[148:151], v137, s[8:11], s25 offen offset:1024 sc1
    v_cvt_pk_bf16_f32 v152, v16, v17
    v_cvt_pk_bf16_f32 v153, v18, v19
    v_cvt_pk_bf16_f32 v154, v20, v21
    v_cvt_pk_bf16_f32 v155, v22, v23
    buffer_store_dwordx4 v[152:155], v137, s[8:11], s25 offen offset:2048 sc1
    v_cvt_pk_bf16_f32 v156, v24, v25
    v_cvt_pk_bf16_f32 v157, v26, v27
    v_cvt_pk_bf16_f32 v158, v28, v29
    v_cvt_pk_bf16_f32 v159, v30, v31
    buffer_store_dwordx4 v[156:159], v137, s[8:11], s25 offen offset:3072 sc1
    v_cvt_pk_bf16_f32 v144, v32, v33
    v_cvt_pk_bf16_f32 v145, v34, v35
    v_cvt_pk_bf16_f32 v146, v36, v37
    v_cvt_pk_bf16_f32 v147, v38, v39
    s_add_u32 s25, s25, 4096
    buffer_store_dwordx4 v[144:147], v137, s[8:11], s25 offen sc1
    v_cvt_pk_bf16_f32 v148, v40, v41
    v_cvt_pk_bf16_f32 v149, v42, v43
    v_cvt_pk_bf16_f32 v150, v44, v45
    v_cvt_pk_bf16_f32 v151, v46, v47
    buffer_store_dwordx4 v[148:151], v137, s[8:11], s25 offen offset:1024 sc1
    v_cvt_pk_bf16_f32 v152, v48, v49
    v_cvt_pk_bf16_f32 v153, v50, v51
    v_cvt_pk_bf16_f32 v154, v52, v53
    v_cvt_pk_bf16_f32 v155, v54, v55
    buffer_store_dwordx4 v[152:155], v137, s[8:11], s25 offen offset:2048 sc1
    v_cvt_pk_bf16_f32 v156, v56, v57
    v_cvt_pk_bf16_f32 v157, v58, v59
    v_cvt_pk_bf16_f32 v158, v60, v61
    v_cvt_pk_bf16_f32 v159, v62, v63
    buffer_store_dwordx4 v[156:159], v137, s[8:11], s25 offen offset:3072 sc1
    s_cmp_lt_u32 s20, 15
    s_cbranch_scc1 L_p1_next
    v_mov_b32 v0, -1
    v_mov_b32 v1, -1
    v_mov_b32 v2, -1
    v_mov_b32 v3, -1
    s_sub_u32 s26, s25, 0x2001000
    s_lshr_b32 s26, s26, 1
    s_add_u32 s26, s26, 0x240000
    buffer_store_dwordx4 v[0:3], v137, s[8:11], s26 offen sc1
    buffer_store_dwordx4 v[0:3], v137, s[8:11], s26 offen offset:1024 sc1
    buffer_store_dwordx4 v[0:3], v137, s[8:11], s26 offen offset:2048 sc1
    buffer_store_dwordx4 v[0:3], v137, s[8:11], s26 offen offset:3072 sc1
    s_nop 1
L_p1_next:
    s_add_u32 s80, s80, 1
    s_lshl_b32 s40, s38, 4
    s_add_u32 s40, s40, s20
    s_lshl_b32 s40, s40, 2
    s_add_u32 s40, s40, 0x2000
    s_sub_u32 s44, s25, 4095
    s_add_u32 s38, s38, s37
    s_branch L_p1_unit
L_p1_end:
    s_waitcnt vmcnt(0)
    s_barrier
    s_cmp_eq_u32 s40, 0
    s_cbranch_scc1 L_nopf_102
    s_cmp_lg_u32 s87, 0
    s_cbranch_scc1 L_modeok_103
    v_readfirstlane_b32 s96, v140
    v_readfirstlane_b32 s97, v141
    s_nop 0
    s_cmp_lg_u32 s97, 0
    s_cselect_b32 s87, s96, 0
    s_cmp_eq_u32 s87, 1
    s_cbranch_scc1 L_modeok_103
    s_mov_b32 s96, 0
L_mode_104:
    buffer_load_dwordx2 v[140:141], off, s[92:95], 0 offset:36 sc1
    s_waitcnt vmcnt(0)
    v_readfirstlane_b32 s87, v140
    v_readfirstlane_b32 s97, v141
    s_nop 0
    s_min_u32 s97, s97, s87
    s_cmp_lg_u32 s97, 0
    s_cbranch_scc1 L_moded_105
    s_sleep 4
    s_add_u32 s96, s96, 1
    s_cmp_lg_u32 s96, 0x100
    s_cbranch_scc1 L_modef_106
    v_mov_b32 v140, 2
    v_mov_b32 v141, 0
    s_mov_b64 exec, 1
    buffer_atomic_cmpswap v[140:141], off, s[92:95], 0 offset:36
    s_mov_b64 exec, -1
L_modef_106:
    s_cmp_lt_u32 s96, 0x10000
    s_cbranch_scc1 L_mode_104
L_moded_105:
    s_cmp_lg_u32 s87, 1
    s_cbranch_scc1 L_fallback
L_modeok_103:
    s_cmp_lg_u32 s100, 0
    s_cbranch_scc1 L_flag_107
    v_mov_b32 v138, 1
    s_mov_b64 exec, 1
    buffer_store_dword v138, off, s[8:11], s40 sc1
    s_mov_b64 exec, -1
L_flag_107:
    s_mov_b32 s40, 0
L_nopf_102:
    s_cmp_lg_u32 s41, 0
    s_cbranch_scc1 L_p1done
    s_mov_b32 s41, 1
    s_mul_i32 s22, s101, 171
    s_lshr_b32 s22, s22, 11
    s_mul_i32 s26, s22, 12
    s_sub_u32 s20, s101, s26
    s_add_u32 s20, s20, 4
    s_mul_i32 s27, s101, 683
    s_lshr_b32 s27, s27, 11
    s_mul_i32 s26, s27, 3
    s_sub_u32 s26, s101, s26
    s_cmp_eq_u32 s26, 2
    s_cselect_b32 s28, 10, 11
    s_cmp_ge_u32 s101, 192
    s_cselect_b32 s20, s26, s20
    s_cselect_b32 s22, s27, s22
    s_cselect_b32 s37, s28, 16
    s_branch L_p1_pass
L_p1done:
    v_mbcnt_lo_u32_b32 v0, -1, 0
    v_mbcnt_hi_u32_b32 v0, -1, v0
    s_lshl_b32 s96, s100, 6
    v_add_u32 v0, s96, v0
    s_and_b32 s20, s101, 15
    s_lshr_b32 s22, s101, 4
    s_mov_b32 s23, 14
    v_mov_b32 v1, 0
    s_lshl_b32 s24, s20, 7
    s_add_u32 s24, s24, 0x1000
    s_mul_i32 s25, s22, 14
    s_lshr_b32 s25, s25, 4
    s_add_u32 s25, s25, 12
    s_cmp_lg_u32 s100, 0
    s_cbranch_scc1 L_polls_110
    s_mov_b32 exec_lo, 0x1
    s_mov_b32 exec_hi, 0
    s_mov_b32 s96, 0
L_poll_108:
    buffer_load_dword v2, v1, s[8:11], s24 offen sc1
    s_waitcnt vmcnt(0)
    v_cmp_gt_u32 vcc, s25, v2
    s_cbranch_vccz L_polld_109
    v_readfirstlane_b32 s97, v2
    s_nop 0
    s_sub_u32 s97, s25, s97
    s_cmp_lt_i32 s97, 3
    s_cbranch_scc1 L_near_111
    s_sleep 40
    s_cmp_lt_i32 s97, 5
    s_cbranch_scc1 L_near_111
    s_sleep 100
L_near_111:
    s_sleep 4
    s_add_u32 s96, s96, 1
    s_cmp_lt_u32 s96, 0x10000
    s_cbranch_scc1 L_poll_108
L_polld_109:
    s_mov_b64 exec, -1
L_polls_110:
    s_barrier
    s_load_dwordx2 s[12:13], s[0:1], 40
    s_waitcnt lgkmcnt(0)
    s_and_b32 s13, s13, 0xffff
    s_mov_b32 s14, 0x400000
    s_mov_b32 s15, 0x20000
    v_lshrrev_b32 v4, 6, v0
    s_nop 0
    v_readfirstlane_b32 s21, v4
    v_and_b32 v1, 63, v0
    v_lshrrev_b32 v2, 4, v1
    v_and_b32 v3, 15, v1
    v_lshrrev_b32 v6, 2, v3
    v_lshlrev_b32 v240, 4, v1
    v_lshlrev_b32 v241, 3, v1
    s_lshl_b32 s27, s21, 10
    s_lshl_b32 s24, s21, 5
    v_xor_b32 v4, s24, v240
    v_add_u32 v8, s27, v4
    v_xor_b32 v9, 128, v8
    v_lshl_add_u32 v4, v2, 2, v6
    v_and_b32 v5, 7, v4
    v_lshlrev_b32 v4, 10, v4
    v_lshl_add_u32 v4, v5, 5, v4
    v_and_b32 v5, 3, v3
    v_lshlrev_b32 v5, 4, v5
    v_xor_b32 v4, v5, v4
    s_lshl_b32 s24, s21, 8
    v_add_u32 v10, s24, v4
    s_lshl_b32 s25, s20, 18
    s_add_u32 s24, s25, 0x0
    s_add_u32 m0, s27, 0x0
    s_nop 0
    buffer_load_dwordx4 v8, s[12:15], s24 offen lds
    s_add_u32 s24, s25, 0x1000
    s_add_u32 m0, s27, 0x1000
    s_nop 0
    buffer_load_dwordx4 v9, s[12:15], s24 offen lds
    s_add_u32 s24, s25, 0x2000
    s_add_u32 m0, s27, 0x2000
    s_nop 0
    buffer_load_dwordx4 v8, s[12:15], s24 offen lds
    s_add_u32 s24, s25, 0x3000
    s_add_u32 m0, s27, 0x3000
    s_nop 0
    buffer_load_dwordx4 v9, s[12:15], s24 offen lds
    s_add_u32 s24, s25, 0x4000
    s_add_u32 m0, s27, 0x4000
    s_nop 0
    buffer_load_dwordx4 v8, s[12:15], s24 offen lds
    s_add_u32 s24, s25, 0x5000
    s_add_u32 m0, s27, 0x5000
    s_nop 0
    buffer_load_dwordx4 v9, s[12:15], s24 offen lds
    s_add_u32 s24, s25, 0x6000
    s_add_u32 m0, s27, 0x6000
    s_nop 0
    buffer_load_dwordx4 v8, s[12:15], s24 offen lds
    s_add_u32 s24, s25, 0x7000
    s_add_u32 m0, s27, 0x7000
    s_nop 0
    buffer_load_dwordx4 v9, s[12:15], s24 offen lds
    s_add_u32 s24, s25, 0x8000
    s_add_u32 m0, s27, 0x8000
    s_nop 0
    buffer_load_dwordx4 v8, s[12:15], s24 offen lds
    s_add_u32 s24, s25, 0x9000
    s_add_u32 m0, s27, 0x9000
    s_nop 0
    buffer_load_dwordx4 v9, s[12:15], s24 offen lds
    s_add_u32 s24, s25, 0xa000
    s_add_u32 m0, s27, 0xa000
    s_nop 0
    buffer_load_dwordx4 v8, s[12:15], s24 offen lds
    s_add_u32 s24, s25, 0xb000
    s_add_u32 m0, s27, 0xb000
    s_nop 0
    buffer_load_dwordx4 v9, s[12:15], s24 offen lds
    s_add_u32 s24, s25, 0xc000
    s_add_u32 m0, s27, 0xc000
    s_nop 0
    buffer_load_dwordx4 v8, s[12:15], s24 offen lds
    s_add_u32 s24, s25, 0xd000
    s_add_u32 m0, s27, 0xd000
    s_nop 0
    buffer_load_dwordx4 v9, s[12:15], s24 offen lds
    s_add_u32 s24, s25, 0xe000
    s_add_u32 m0, s27, 0xe000
    s_nop 0
    buffer_load_dwordx4 v8, s[12:15], s24 offen lds
    s_add_u32 s24, s25, 0xf000
    s_add_u32 m0, s27, 0xf000
    s_nop 0
    buffer_load_dwordx4 v9, s[12:15], s24 offen lds
    s_add_u32 s24, s25, 0x10000
    s_add_u32 m0, s27, 0x10000
    s_nop 0
    buffer_load_dwordx4 v8, s[12:15], s24 offen lds
    s_add_u32 s24, s25, 0x11000
    s_add_u32 m0, s27, 0x11000
    s_nop 0
    buffer_load_dwordx4 v9, s[12:15], s24 offen lds
    s_add_u32 s24, s25, 0x12000
    s_add_u32 m0, s27, 0x12000
    s_nop 0
    buffer_load_dwordx4 v8, s[12:15], s24 offen lds
    s_add_u32 s24, s25, 0x13000
    s_add_u32 m0, s27, 0x13000
    s_nop 0
    buffer_load_dwordx4 v9, s[12:15], s24 offen lds
    s_add_u32 s24, s25, 0x14000
    s_add_u32 m0, s27, 0x14000
    s_nop 0
    buffer_load_dwordx4 v8, s[12:15], s24 offen lds
    s_add_u32 s24, s25, 0x15000
    s_add_u32 m0, s27, 0x15000
    s_nop 0
    buffer_load_dwordx4 v9, s[12:15], s24 offen lds
    s_add_u32 s24, s25, 0x16000
    s_add_u32 m0, s27, 0x16000
    s_nop 0
    buffer_load_dwordx4 v8, s[12:15], s24 offen lds
    s_add_u32 s24, s25, 0x17000
    s_add_u32 m0, s27, 0x17000
    s_nop 0
    buffer_load_dwordx4 v9, s[12:15], s24 offen lds
    s_add_u32 s24, s25, 0x18000
    s_add_u32 m0, s27, 0x18000
    s_nop 0
    buffer_load_dwordx4 v8, s[12:15], s24 offen lds
    s_add_u32 s24, s25, 0x19000
    s_add_u32 m0, s27, 0x19000
    s_nop 0
    buffer_load_dwordx4 v9, s[12:15], s24 offen lds
    s_add_u32 s24, s25, 0x1a000
    s_add_u32 m0, s27, 0x1a000
    s_nop 0
    buffer_load_dwordx4 v8, s[12:15], s24 offen lds
    s_add_u32 s24, s25, 0x1b000
    s_add_u32 m0, s27, 0x1b000
    s_nop 0
    buffer_load_dwordx4 v9, s[12:15], s24 offen lds
    s_add_u32 s24, s25, 0x1c000
    s_add_u32 m0, s27, 0x1c000
    s_nop 0
    buffer_load_dwordx4 v8, s[12:15], s24 offen lds
    s_add_u32 s24, s25, 0x1d000
    s_add_u32 m0, s27, 0x1d000
    s_nop 0
    buffer_load_dwordx4 v9, s[12:15], s24 offen lds
    s_add_u32 s24, s25, 0x1e000
    s_add_u32 m0, s27, 0x1e000
    s_nop 0
    buffer_load_dwordx4 v8, s[12:15], s24 offen lds
    s_add_u32 s24, s25, 0x1f000
    s_add_u32 m0, s27, 0x1f000
    s_nop 0
    buffer_load_dwordx4 v9, s[12:15], s24 offen lds
    s_waitcnt vmcnt(0)
    s_barrier
    v_xor_b32 v11, 0x0, v10
    ds_read_b64_tr_b16 a[0:1], v11
    ds_read_b64_tr_b16 a[2:3], v11 offset:16384
    ds_read_b64_tr_b16 a[32:33], v11 offset:32768
    ds_read_b64_tr_b16 a[34:35], v11 offset:49152
    v_xor_b32 v11, 0x8, v10
    ds_read_b64_tr_b16 a[4:5], v11
    ds_read_b64_tr_b16 a[6:7], v11 offset:16384
    ds_read_b64_tr_b16 a[36:37], v11 offset:32768
    ds_read_b64_tr_b16 a[38:39], v11 offset:49152
    s_waitcnt lgkmcnt(0)
    v_xor_b32 v11, 0x40, v10
    ds_read_b64_tr_b16 a[8:9], v11
    ds_read_b64_tr_b16 a[10:11], v11 offset:16384
    ds_read_b64_tr_b16 a[40:41], v11 offset:32768
    ds_read_b64_tr_b16 a[42:43], v11 offset:49152
    v_xor_b32 v11, 0x48, v10
    ds_read_b64_tr_b16 a[12:13], v11
    ds_read_b64_tr_b16 a[14:15], v11 offset:16384
    ds_read_b64_tr_b16 a[44:45], v11 offset:32768
    ds_read_b64_tr_b16 a[46:47], v11 offset:49152
    s_waitcnt lgkmcnt(0)
    v_xor_b32 v11, 0x80, v10
    ds_read_b64_tr_b16 a[16:17], v11
    ds_read_b64_tr_b16 a[18:19], v11 offset:16384
    ds_read_b64_tr_b16 a[48:49], v11 offset:32768
    ds_read_b64_tr_b16 a[50:51], v11 offset:49152
    v_xor_b32 v11, 0x88, v10
    ds_read_b64_tr_b16 a[20:21], v11
    ds_read_b64_tr_b16 a[22:23], v11 offset:16384
    ds_read_b64_tr_b16 a[52:53], v11 offset:32768
    ds_read_b64_tr_b16 a[54:55], v11 offset:49152
    s_waitcnt lgkmcnt(0)
    v_xor_b32 v11, 0xc0, v10
    ds_read_b64_tr_b16 a[24:25], v11
    ds_read_b64_tr_b16 a[26:27], v11 offset:16384
    ds_read_b64_tr_b16 a[56:57], v11 offset:32768
    ds_read_b64_tr_b16 a[58:59], v11 offset:49152
    v_xor_b32 v11, 0xc8, v10
    ds_read_b64_tr_b16 a[28:29], v11
    ds_read_b64_tr_b16 a[30:31], v11 offset:16384
    ds_read_b64_tr_b16 a[60:61], v11 offset:32768
    ds_read_b64_tr_b16 a[62:63], v11 offset:49152
    s_waitcnt lgkmcnt(0)
    v_xor_b32 v11, 0x10000, v10
    ds_read_b64_tr_b16 a[64:65], v11
    ds_read_b64_tr_b16 a[66:67], v11 offset:16384
    ds_read_b64_tr_b16 a[96:97], v11 offset:32768
    ds_read_b64_tr_b16 a[98:99], v11 offset:49152
    v_xor_b32 v11, 0x10008, v10
    ds_read_b64_tr_b16 a[68:69], v11
    ds_read_b64_tr_b16 a[70:71], v11 offset:16384
    ds_read_b64_tr_b16 a[100:101], v11 offset:32768
    ds_read_b64_tr_b16 a[102:103], v11 offset:49152
    s_waitcnt lgkmcnt(0)
    v_xor_b32 v11, 0x10040, v10
    ds_read_b64_tr_b16 a[72:73], v11
    ds_read_b64_tr_b16 a[74:75], v11 offset:16384
    ds_read_b64_tr_b16 a[104:105], v11 offset:32768
    ds_read_b64_tr_b16 a[106:107], v11 offset:49152
    v_xor_b32 v11, 0x10048, v10
    ds_read_b64_tr_b16 a[76:77], v11
    ds_read_b64_tr_b16 a[78:79], v11 offset:16384
    ds_read_b64_tr_b16 a[108:109], v11 offset:32768
    ds_read_b64_tr_b16 a[110:111], v11 offset:49152
    s_waitcnt lgkmcnt(0)
    v_xor_b32 v11, 0x10080, v10
    ds_read_b64_tr_b16 a[80:81], v11
    ds_read_b64_tr_b16 a[82:83], v11 offset:16384
    ds_read_b64_tr_b16 a[112:113], v11 offset:32768
    ds_read_b64_tr_b16 a[114:115], v11 offset:49152
    v_xor_b32 v11, 0x10088, v10
    ds_read_b64_tr_b16 a[84:85], v11
    ds_read_b64_tr_b16 a[86:87], v11 offset:16384
    ds_read_b64_tr_b16 a[116:117], v11 offset:32768
    ds_read_b64_tr_b16 a[118:119], v11 offset:49152
    s_waitcnt lgkmcnt(0)
    v_xor_b32 v11, 0x100c0, v10
    ds_read_b64_tr_b16 a[88:89], v11
    ds_read_b64_tr_b16 a[90:91], v11 offset:16384
    ds_read_b64_tr_b16 a[120:121], v11 offset:32768
    ds_read_b64_tr_b16 a[122:123], v11 offset:49152
    v_xor_b32 v11, 0x100c8, v10
    ds_read_b64_tr_b16 a[92:93], v11
    ds_read_b64_tr_b16 a[94:95], v11 offset:16384
    ds_read_b64_tr_b16 a[124:125], v11 offset:32768
    ds_read_b64_tr_b16 a[126:127], v11 offset:49152
    s_waitcnt lgkmcnt(0)
    s_barrier
    s_lshl_b32 s25, s20, 18
    s_add_u32 s24, s25, 0x20000
    s_add_u32 m0, s27, 0x0
    s_nop 0
    buffer_load_dwordx4 v8, s[12:15], s24 offen lds
    s_add_u32 s24, s25, 0x21000
    s_add_u32 m0, s27, 0x1000
    s_nop 0
    buffer_load_dwordx4 v9, s[12:15], s24 offen lds
    s_add_u32 s24, s25, 0x22000
    s_add_u32 m0, s27, 0x2000
    s_nop 0
    buffer_load_dwordx4 v8, s[12:15], s24 offen lds
    s_add_u32 s24, s25, 0x23000
    s_add_u32 m0, s27, 0x3000
    s_nop 0
    buffer_load_dwordx4 v9, s[12:15], s24 offen lds
    s_add_u32 s24, s25, 0x24000
    s_add_u32 m0, s27, 0x4000
    s_nop 0
    buffer_load_dwordx4 v8, s[12:15], s24 offen lds
    s_add_u32 s24, s25, 0x25000
    s_add_u32 m0, s27, 0x5000
    s_nop 0
    buffer_load_dwordx4 v9, s[12:15], s24 offen lds
    s_add_u32 s24, s25, 0x26000
    s_add_u32 m0, s27, 0x6000
    s_nop 0
    buffer_load_dwordx4 v8, s[12:15], s24 offen lds
    s_add_u32 s24, s25, 0x27000
    s_add_u32 m0, s27, 0x7000
    s_nop 0
    buffer_load_dwordx4 v9, s[12:15], s24 offen lds
    s_add_u32 s24, s25, 0x28000
    s_add_u32 m0, s27, 0x8000
    s_nop 0
    buffer_load_dwordx4 v8, s[12:15], s24 offen lds
    s_add_u32 s24, s25, 0x29000
    s_add_u32 m0, s27, 0x9000
    s_nop 0
    buffer_load_dwordx4 v9, s[12:15], s24 offen lds
    s_add_u32 s24, s25, 0x2a000
    s_add_u32 m0, s27, 0xa000
    s_nop 0
    buffer_load_dwordx4 v8, s[12:15], s24 offen lds
    s_add_u32 s24, s25, 0x2b000
    s_add_u32 m0, s27, 0xb000
    s_nop 0
    buffer_load_dwordx4 v9, s[12:15], s24 offen lds
    s_add_u32 s24, s25, 0x2c000
    s_add_u32 m0, s27, 0xc000
    s_nop 0
    buffer_load_dwordx4 v8, s[12:15], s24 offen lds
    s_add_u32 s24, s25, 0x2d000
    s_add_u32 m0, s27, 0xd000
    s_nop 0
    buffer_load_dwordx4 v9, s[12:15], s24 offen lds
    s_add_u32 s24, s25, 0x2e000
    s_add_u32 m0, s27, 0xe000
    s_nop 0
    buffer_load_dwordx4 v8, s[12:15], s24 offen lds
    s_add_u32 s24, s25, 0x2f000
    s_add_u32 m0, s27, 0xf000
    s_nop 0
    buffer_load_dwordx4 v9, s[12:15], s24 offen lds
    s_add_u32 s24, s25, 0x30000
    s_add_u32 m0, s27, 0x10000
    s_nop 0
    buffer_load_dwordx4 v8, s[12:15], s24 offen lds
    s_add_u32 s24, s25, 0x31000
    s_add_u32 m0, s27, 0x11000
    s_nop 0
    buffer_load_dwordx4 v9, s[12:15], s24 offen lds
    s_add_u32 s24, s25, 0x32000
    s_add_u32 m0, s27, 0x12000
    s_nop 0
    buffer_load_dwordx4 v8, s[12:15], s24 offen lds
    s_add_u32 s24, s25, 0x33000
    s_add_u32 m0, s27, 0x13000
    s_nop 0
    buffer_load_dwordx4 v9, s[12:15], s24 offen lds
    s_add_u32 s24, s25, 0x34000
    s_add_u32 m0, s27, 0x14000
    s_nop 0
    buffer_load_dwordx4 v8, s[12:15], s24 offen lds
    s_add_u32 s24, s25, 0x35000
    s_add_u32 m0, s27, 0x15000
    s_nop 0
    buffer_load_dwordx4 v9, s[12:15], s24 offen lds
    s_add_u32 s24, s25, 0x36000
    s_add_u32 m0, s27, 0x16000
    s_nop 0
    buffer_load_dwordx4 v8, s[12:15], s24 offen lds
    s_add_u32 s24, s25, 0x37000
    s_add_u32 m0, s27, 0x17000
    s_nop 0
    buffer_load_dwordx4 v9, s[12:15], s24 offen lds
    s_add_u32 s24, s25, 0x38000
    s_add_u32 m0, s27, 0x18000
    s_nop 0
    buffer_load_dwordx4 v8, s[12:15], s24 offen lds
    s_add_u32 s24, s25, 0x39000
    s_add_u32 m0, s27, 0x19000
    s_nop 0
    buffer_load_dwordx4 v9, s[12:15], s24 offen lds
    s_add_u32 s24, s25, 0x3a000
    s_add_u32 m0, s27, 0x1a000
    s_nop 0
    buffer_load_dwordx4 v8, s[12:15], s24 offen lds
    s_add_u32 s24, s25, 0x3b000
    s_add_u32 m0, s27, 0x1b000
    s_nop 0
    buffer_load_dwordx4 v9, s[12:15], s24 offen lds
    s_add_u32 s24, s25, 0x3c000
    s_add_u32 m0, s27, 0x1c000
    s_nop 0
    buffer_load_dwordx4 v8, s[12:15], s24 offen lds
    s_add_u32 s24, s25, 0x3d000
    s_add_u32 m0, s27, 0x1d000
    s_nop 0
    buffer_load_dwordx4 v9, s[12:15], s24 offen lds
    s_add_u32 s24, s25, 0x3e000
    s_add_u32 m0, s27, 0x1e000
    s_nop 0
    buffer_load_dwordx4 v8, s[12:15], s24 offen lds
    s_add_u32 s24, s25, 0x3f000
    s_add_u32 m0, s27, 0x1f000
    s_nop 0
    buffer_load_dwordx4 v9, s[12:15], s24 offen lds
    s_waitcnt vmcnt(0)
    s_barrier
    v_xor_b32 v11, 0x0, v10
    ds_read_b64_tr_b16 a[128:129], v11
    ds_read_b64_tr_b16 a[130:131], v11 offset:16384
    ds_read_b64_tr_b16 a[160:161], v11 offset:32768
    ds_read_b64_tr_b16 a[162:163], v11 offset:49152
    v_xor_b32 v11, 0x8, v10
    ds_read_b64_tr_b16 a[132:133], v11
    ds_read_b64_tr_b16 a[134:135], v11 offset:16384
    ds_read_b64_tr_b16 a[164:165], v11 offset:32768
    ds_read_b64_tr_b16 a[166:167], v11 offset:49152
    s_waitcnt lgkmcnt(0)
    v_xor_b32 v11, 0x40, v10
    ds_read_b64_tr_b16 a[136:137], v11
    ds_read_b64_tr_b16 a[138:139], v11 offset:16384
    ds_read_b64_tr_b16 a[168:169], v11 offset:32768
    ds_read_b64_tr_b16 a[170:171], v11 offset:49152
    v_xor_b32 v11, 0x48, v10
    ds_read_b64_tr_b16 a[140:141], v11
    ds_read_b64_tr_b16 a[142:143], v11 offset:16384
    ds_read_b64_tr_b16 a[172:173], v11 offset:32768
    ds_read_b64_tr_b16 a[174:175], v11 offset:49152
    s_waitcnt lgkmcnt(0)
    v_xor_b32 v11, 0x80, v10
    ds_read_b64_tr_b16 a[144:145], v11
    ds_read_b64_tr_b16 a[146:147], v11 offset:16384
    ds_read_b64_tr_b16 a[176:177], v11 offset:32768
    ds_read_b64_tr_b16 a[178:179], v11 offset:49152
    v_xor_b32 v11, 0x88, v10
    ds_read_b64_tr_b16 a[148:149], v11
    ds_read_b64_tr_b16 a[150:151], v11 offset:16384
    ds_read_b64_tr_b16 a[180:181], v11 offset:32768
    ds_read_b64_tr_b16 a[182:183], v11 offset:49152
    s_waitcnt lgkmcnt(0)
    v_xor_b32 v11, 0xc0, v10
    ds_read_b64_tr_b16 a[152:153], v11
    ds_read_b64_tr_b16 a[154:155], v11 offset:16384
    ds_read_b64_tr_b16 a[184:185], v11 offset:32768
    ds_read_b64_tr_b16 a[186:187], v11 offset:49152
    v_xor_b32 v11, 0xc8, v10
    ds_read_b64_tr_b16 a[156:157], v11
    ds_read_b64_tr_b16 a[158:159], v11 offset:16384
    ds_read_b64_tr_b16 a[188:189], v11 offset:32768
    ds_read_b64_tr_b16 a[190:191], v11 offset:49152
    s_waitcnt lgkmcnt(0)
    v_xor_b32 v11, 0x10000, v10
    ds_read_b64_tr_b16 a[192:193], v11
    ds_read_b64_tr_b16 a[194:195], v11 offset:16384
    ds_read_b64_tr_b16 a[224:225], v11 offset:32768
    ds_read_b64_tr_b16 a[226:227], v11 offset:49152
    v_xor_b32 v11, 0x10008, v10
    ds_read_b64_tr_b16 a[196:197], v11
    ds_read_b64_tr_b16 a[198:199], v11 offset:16384
    ds_read_b64_tr_b16 a[228:229], v11 offset:32768
    ds_read_b64_tr_b16 a[230:231], v11 offset:49152
    s_waitcnt lgkmcnt(0)
    v_xor_b32 v11, 0x10040, v10
    ds_read_b64_tr_b16 a[200:201], v11
    ds_read_b64_tr_b16 a[202:203], v11 offset:16384
    ds_read_b64_tr_b16 a[232:233], v11 offset:32768
    ds_read_b64_tr_b16 a[234:235], v11 offset:49152
    v_xor_b32 v11, 0x10048, v10
    ds_read_b64_tr_b16 a[204:205], v11
    ds_read_b64_tr_b16 a[206:207], v11 offset:16384
    ds_read_b64_tr_b16 a[236:237], v11 offset:32768
    ds_read_b64_tr_b16 a[238:239], v11 offset:49152
    s_waitcnt lgkmcnt(0)
    v_xor_b32 v11, 0x10080, v10
    ds_read_b64_tr_b16 a[208:209], v11
    ds_read_b64_tr_b16 a[210:211], v11 offset:16384
    ds_read_b64_tr_b16 a[240:241], v11 offset:32768
    ds_read_b64_tr_b16 a[242:243], v11 offset:49152
    v_xor_b32 v11, 0x10088, v10
    ds_read_b64_tr_b16 a[212:213], v11
    ds_read_b64_tr_b16 a[214:215], v11 offset:16384
    ds_read_b64_tr_b16 a[244:245], v11 offset:32768
    ds_read_b64_tr_b16 a[246:247], v11 offset:49152
    s_waitcnt lgkmcnt(0)
    v_xor_b32 v11, 0x100c0, v10
    ds_read_b64_tr_b16 a[216:217], v11
    ds_read_b64_tr_b16 a[218:219], v11 offset:16384
    ds_read_b64_tr_b16 a[248:249], v11 offset:32768
    ds_read_b64_tr_b16 a[250:251], v11 offset:49152
    v_xor_b32 v11, 0x100c8, v10
    ds_read_b64_tr_b16 a[220:221], v11
    ds_read_b64_tr_b16 a[222:223], v11 offset:16384
    ds_read_b64_tr_b16 a[252:253], v11 offset:32768
    ds_read_b64_tr_b16 a[254:255], v11 offset:49152
    s_waitcnt lgkmcnt(0)
    s_barrier
    s_and_b32 s24, s21, 1
    s_lshl_b32 s24, s24, 4
    v_add_u32 v4, s24, v3
    v_lshlrev_b32 v5, 2, v2
    v_sub_u32 v4, v4, v5
    v_cmp_le_i32 s[30:31], 0, v4
    v_cmp_le_i32 s[32:33], 1, v4
    v_cmp_le_i32 s[34:35], 2, v4
    v_cmp_le_i32 s[36:37], 3, v4
    v_cmp_le_i32 s[38:39], 16, v4
    v_cmp_le_i32 s[40:41], 17, v4
    v_cmp_le_i32 s[42:43], 18, v4
    v_cmp_le_i32 s[44:45], 19, v4
    s_mov_b32 s28, 0x3e0293ee
    s_mov_b32 s29, 0x3e0293ee
    s_mov_b32 s53, 0xff000000
    v_mov_b32 v136, 0x3f803f80
    v_mov_b32 v137, 0x3f803f80
    v_mov_b32 v138, 0x3f803f80
    v_mov_b32 v139, 0x3f803f80
    v_lshlrev_b32 v4, 10, v3
    v_lshl_add_u32 v4, v2, 4, v4
    s_lshl_b32 s24, s21, 8
    v_add_u32 v242, s24, v4
    s_lshl_b32 s24, s21, 12
    v_add_u32 v243, s24, v240
    v_mov_b32 v244, v240
    s_add_u32 s24, s24, 0x22000
    v_xor_b32 v7, v2, v6
    v_lshl_add_u32 v4, v2, 4, v7
    v_and_b32 v5, 3, v3
    v_lshl_add_u32 v4, v4, 2, v5
    v_lshl_add_u32 v253, v4, 2, s24
    v_lshl_add_u32 v4, v3, 2, v7
    v_lshl_add_u32 v254, v4, 4, s24
    s_load_dwordx2 s[12:13], s[0:1], 0
    s_waitcnt lgkmcnt(0)
    s_and_b32 s13, s13, 0xffff
    s_mov_b32 s14, 0x200000
    s_mov_b32 s15, 0x20000
    s_load_dwordx2 s[16:17], s[0:1], 96
    s_waitcnt lgkmcnt(0)
    s_and_b32 s17, s17, 0xffff
    s_mov_b32 s18, 0x200000
    s_mov_b32 s19, 0x20000
    s_load_dwordx2 s[56:57], s[0:1], 64
    s_waitcnt lgkmcnt(0)
    s_and_b32 s57, s57, 0xffff
    s_mov_b32 s58, 0x400
    s_mov_b32 s59, 0x20000
    v_and_b32 v100, 63, v0
    v_lshlrev_b32 v240, 4, v100
    buffer_load_dwordx4 v[236:239], v240, s[56:59], 0 offen
    s_mov_b32 s65, 0x3f80
    s_mov_b32 s66, 0x3f800000
    s_waitcnt vmcnt(0)
    s_sub_u32 s67, s101, 128
    s_cmp_ge_u32 s67, 56
    s_cbranch_scc1 L_nostage_112
L_nostage_112:
    v_lshrrev_b32 v246, 2, v240
    s_lshl_b32 s24, s20, 7
    s_add_u32 s24, s24, 0x2000
    s_cmp_lg_u32 s100, 0
    s_cbranch_scc1 L_polls_115
    s_mov_b32 exec_lo, 0xffffffff
    s_mov_b32 exec_hi, 0
    s_mov_b32 s96, 0
L_poll_113:
    buffer_load_dword v247, v246, s[8:11], s24 offen sc1
    s_waitcnt vmcnt(0)
    v_cmp_gt_u32 vcc, 1, v247
    s_cbranch_vccz L_polld_114
    s_sleep 32
    s_add_u32 s96, s96, 1
    s_cmp_lt_u32 s96, 0x10000
    s_cbranch_scc1 L_poll_113
L_polld_114:
    s_mov_b64 exec, -1
L_polls_115:
    s_barrier
    s_lshl_b32 s24, s20, 7
    s_add_u32 s24, s24, 0x2800
    s_cmp_lg_u32 s100, 0
    s_cbranch_scc1 L_polls_118
    s_mov_b32 exec_lo, 0xffffffff
    s_mov_b32 exec_hi, 0
    s_mov_b32 s96, 0
L_poll_116:
    buffer_load_dword v247, v246, s[8:11], s24 offen sc1
    s_waitcnt vmcnt(0)
    v_cmp_gt_u32 vcc, 1, v247
    s_cbranch_vccz L_polld_117
    s_sleep 32
    s_add_u32 s96, s96, 1
    s_cmp_lt_u32 s96, 0x10000
    s_cbranch_scc1 L_poll_116
L_polld_117:
    s_mov_b64 exec, -1
L_polls_118:
    s_barrier
    s_lshl_b32 s24, s20, 7
    s_add_u32 s24, s24, 0x3000
    s_cmp_lg_u32 s100, 0
    s_cbranch_scc1 L_polls_121
    s_mov_b32 exec_lo, 0xffffffff
    s_mov_b32 exec_hi, 0
    s_mov_b32 s96, 0
L_poll_119:
    buffer_load_dword v247, v246, s[8:11], s24 offen sc1
    s_waitcnt vmcnt(0)
    v_cmp_gt_u32 vcc, 1, v247
    s_cbranch_vccz L_polld_120
    s_sleep 32
    s_add_u32 s96, s96, 1
    s_cmp_lt_u32 s96, 0x10000
    s_cbranch_scc1 L_poll_119
L_polld_120:
    s_mov_b64 exec, -1
L_polls_121:
    s_barrier
    s_mov_b32 s80, 0
    s_mov_b32 s82, 0
    v_add_u32 v105, 0x4000, v240
    v_add_u32 v106, 0x8000, v240
    v_add_u32 v107, 0xc000, v240
    s_lshl_b32 s24, s21, 12
    s_add_u32 s24, s24, 0x22000
    v_add_u32 v109, s24, v240
    s_nop 4
L_p2_seg:
    s_cmp_ge_u32 s22, 64
    s_cbranch_scc1 L_p2_end
    v_lshrrev_b32 v246, 2, v240
    s_lshl_b32 s24, s20, 7
    s_add_u32 s24, s24, 0x1000
    s_mul_i32 s25, s22, 10
    s_lshr_b32 s25, s25, 4
    s_add_u32 s25, s25, 17
    s_cmp_lg_u32 s100, 0
    s_cbranch_scc1 L_polls_124
    s_mov_b32 exec_lo, 0x1
    s_mov_b32 exec_hi, 0
    s_mov_b32 s96, 0
L_poll_122:
    buffer_load_dword v247, v246, s[8:11], s24 offen sc1
    s_waitcnt vmcnt(0)
    v_cmp_gt_u32 vcc, s25, v247
    s_cbranch_vccz L_polld_123
    v_readfirstlane_b32 s97, v247
    s_nop 0
    s_sub_u32 s97, s25, s97
    s_cmp_lt_i32 s97, 3
    s_cbranch_scc1 L_near_125
    s_sleep 40
    s_cmp_lt_i32 s97, 5
    s_cbranch_scc1 L_near_125
    s_sleep 100
L_near_125:
    s_sleep 4
    s_add_u32 s96, s96, 1
    s_cmp_lt_u32 s96, 0x10000
    s_cbranch_scc1 L_poll_122
L_polld_123:
    s_mov_b64 exec, -1
L_polls_124:
    s_barrier
    s_cmp_ge_u32 s67, 56
    s_cbranch_scc1 L_nostage_126
    v_mbcnt_lo_u32_b32 v0, -1, 0
    v_mbcnt_hi_u32_b32 v0, -1, v0
    s_lshl_b32 s96, s100, 6
    v_add_u32 v0, s96, v0
    v_lshrrev_b32 v2, 6, v0
    s_nop 0
    v_readfirstlane_b32 s68, v2
    v_and_b32 v1, 63, v0
    s_lshl_b32 s73, s68, 10
    v_lshrrev_b32 v2, 2, v1
    s_lshl_b32 s71, s68, 4
    v_add_u32 v2, s71, v2
    s_movk_i32 s71, 3584
    v_mul_lo_u32 v2, v2, s71
    v_and_b32 v3, 3, v1
    v_lshl_add_u32 v4, v3, 4, v2
    s_cmp_lg_u32 s80, 0
    s_cbranch_scc1 L_part_127
    s_load_dwordx2 s[76:77], s[0:1], 72
    s_waitcnt lgkmcnt(0)
    s_and_b32 s77, s77, 0xffff
    s_mov_b32 s78, 0x1c0000
    s_mov_b32 s79, 0x20000
    s_lshl_b32 s71, s67, 6
    s_add_u32 s71, s71, 0x0
    s_add_u32 m0, s73, 0x8000
    s_nop 0
    buffer_load_dwordx4 v4, s[76:79], s71 offen lds
    s_lshl_b32 s71, s67, 6
    s_add_u32 s71, s71, 0x38000
    s_add_u32 m0, s73, 0x9000
    s_nop 0
    buffer_load_dwordx4 v4, s[76:79], s71 offen lds
    s_lshl_b32 s71, s67, 6
    s_add_u32 s71, s71, 0x70000
    s_add_u32 m0, s73, 0xa000
    s_nop 0
    buffer_load_dwordx4 v4, s[76:79], s71 offen lds
    s_lshl_b32 s71, s67, 6
    s_add_u32 s71, s71, 0xa8000
    s_add_u32 m0, s73, 0xb000
    s_nop 0
    buffer_load_dwordx4 v4, s[76:79], s71 offen lds
    s_lshl_b32 s71, s67, 6
    s_add_u32 s71, s71, 0xe0000
    s_add_u32 m0, s73, 0xc000
    s_nop 0
    buffer_load_dwordx4 v4, s[76:79], s71 offen lds
    s_lshl_b32 s71, s67, 6
    s_add_u32 s71, s71, 0x118000
    s_add_u32 m0, s73, 0xd000
    s_nop 0
    buffer_load_dwordx4 v4, s[76:79], s71 offen lds
    s_lshl_b32 s71, s67, 6
    s_add_u32 s71, s71, 0x150000
    s_add_u32 m0, s73, 0xe000
    s_nop 0
    buffer_load_dwordx4 v4, s[76:79], s71 offen lds
    s_lshl_b32 s71, s67, 6
    s_add_u32 s71, s71, 0x188000
    s_add_u32 m0, s73, 0xf000
    s_nop 0
    buffer_load_dwordx4 v4, s[76:79], s71 offen lds
L_part_127:
    s_cmp_lg_u32 s80, 4
    s_cbranch_scc1 L_part_128
    s_load_dwordx2 s[76:77], s[0:1], 80
    s_waitcnt lgkmcnt(0)
    s_and_b32 s77, s77, 0xffff
    s_mov_b32 s78, 0x1c0000
    s_mov_b32 s79, 0x20000
    s_lshl_b32 s71, s67, 6
    s_add_u32 s71, s71, 0x0
    s_add_u32 m0, s73, 0x10000
    s_nop 0
    buffer_load_dwordx4 v4, s[76:79], s71 offen lds
    s_lshl_b32 s71, s67, 6
    s_add_u32 s71, s71, 0x38000
    s_add_u32 m0, s73, 0x11000
    s_nop 0
    buffer_load_dwordx4 v4, s[76:79], s71 offen lds
    s_lshl_b32 s71, s67, 6
    s_add_u32 s71, s71, 0x70000
    s_add_u32 m0, s73, 0x12000
    s_nop 0
    buffer_load_dwordx4 v4, s[76:79], s71 offen lds
    s_lshl_b32 s71, s67, 6
    s_add_u32 s71, s71, 0xa8000
    s_add_u32 m0, s73, 0x13000
    s_nop 0
    buffer_load_dwordx4 v4, s[76:79], s71 offen lds
    s_lshl_b32 s71, s67, 6
    s_add_u32 s71, s71, 0xe0000
    s_add_u32 m0, s73, 0x14000
    s_nop 0
    buffer_load_dwordx4 v4, s[76:79], s71 offen lds
    s_lshl_b32 s71, s67, 6
    s_add_u32 s71, s71, 0x118000
    s_add_u32 m0, s73, 0x15000
    s_nop 0
    buffer_load_dwordx4 v4, s[76:79], s71 offen lds
    s_lshl_b32 s71, s67, 6
    s_add_u32 s71, s71, 0x150000
    s_add_u32 m0, s73, 0x16000
    s_nop 0
    buffer_load_dwordx4 v4, s[76:79], s71 offen lds
    s_lshl_b32 s71, s67, 6
    s_add_u32 s71, s71, 0x188000
    s_add_u32 m0, s73, 0x17000
    s_nop 0
    buffer_load_dwordx4 v4, s[76:79], s71 offen lds
L_part_128:
    s_cmp_lg_u32 s80, 8
    s_cbranch_scc1 L_part_129
    s_load_dwordx2 s[76:77], s[0:1], 88
    s_waitcnt lgkmcnt(0)
    s_and_b32 s77, s77, 0xffff
    s_mov_b32 s78, 0x1c0000
    s_mov_b32 s79, 0x20000
    v_lshlrev_b32 v5, 4, v1
    v_add_u32 v5, s73, v5
    s_lshl_b32 s71, s67, 15
    s_add_u32 s71, s71, 0
    s_add_u32 m0, s73, 0x18000
    s_nop 0
    buffer_load_dwordx4 v5, s[76:79], s71 offen lds
    s_lshl_b32 s71, s67, 15
    s_add_u32 s71, s71, 4096
    s_add_u32 m0, s73, 0x19000
    s_nop 0
    buffer_load_dwordx4 v5, s[76:79], s71 offen lds
    s_lshl_b32 s71, s67, 15
    s_add_u32 s71, s71, 8192
    s_add_u32 m0, s73, 0x1a000
    s_nop 0
    buffer_load_dwordx4 v5, s[76:79], s71 offen lds
    s_lshl_b32 s71, s67, 15
    s_add_u32 s71, s71, 12288
    s_add_u32 m0, s73, 0x1b000
    s_nop 0
    buffer_load_dwordx4 v5, s[76:79], s71 offen lds
    s_lshl_b32 s71, s67, 15
    s_add_u32 s71, s71, 16384
    s_add_u32 m0, s73, 0x1c000
    s_nop 0
    buffer_load_dwordx4 v5, s[76:79], s71 offen lds
    s_lshl_b32 s71, s67, 15
    s_add_u32 s71, s71, 20480
    s_add_u32 m0, s73, 0x1d000
    s_nop 0
    buffer_load_dwordx4 v5, s[76:79], s71 offen lds
    s_lshl_b32 s71, s67, 15
    s_add_u32 s71, s71, 24576
    s_add_u32 m0, s73, 0x1e000
    s_nop 0
    buffer_load_dwordx4 v5, s[76:79], s71 offen lds
    s_lshl_b32 s71, s67, 15
    s_add_u32 s71, s71, 28672
    s_add_u32 m0, s73, 0x1f000
    s_nop 0
    buffer_load_dwordx4 v5, s[76:79], s71 offen lds
L_part_129:
L_nostage_126:
    s_lshl_b32 s24, s22, 5
    s_lshl_b32 s25, s20, 1
    s_add_u32 s24, s24, s25
    s_lshr_b32 s25, s21, 1
    s_add_u32 s24, s24, s25
    s_lshl_b32 s25, s24, 13
    s_add_u32 s47, s25, 0x1000000
    s_add_u32 s54, s47, 4096
    s_add_u32 s48, s25, 0x2000000
    s_add_u32 s55, s48, 4096
    s_and_b32 s26, s21, 1
    s_lshl_b32 s26, s26, 12
    s_add_u32 s46, s25, s26
    s_add_u32 s46, s46, 0x3000000
    s_lshl_b32 s25, s24, 12
    s_add_u32 s49, s25, 0x240000
    s_cmp_ge_u32 s22, 62
    s_mov_b32 s63, 0x1000000
    s_cselect_b32 s63, 0x4000000, s63
    s_lshl_b32 s24, s22, 18
    s_add_u32 s63, s63, s24
    s_lshl_b32 s24, s20, 14
    s_add_u32 s51, s63, s24
    s_cmp_ge_u32 s22, 60
    s_cselect_b32 s81, 1, 0
    s_lshl_b32 s60, s20, 1
    s_lshr_b32 s24, s100, 1
    s_add_u32 s60, s60, s24
    s_cmp_ge_u32 s22, 62
    s_cselect_b32 s24, 1, 0
    s_max_u32 s82, s82, s24
    s_lshl_b32 s24, s82, 3
    s_and_b32 s24, s24, 16
    s_add_u32 s24, s24, s20
    s_cmp_lg_u32 s82, 0
    s_cselect_b32 s60, s24, s60
    s_cselect_b32 s61, 0, 0x10000
    s_cselect_b32 s24, 16, 17
    s_lshl_b32 s50, s100, s24
    s_and_b32 s50, s50, 0x30000
    s_and_b32 s24, s60, 15
    s_lshl_b32 s24, s24, 10
    s_add_u32 s50, s50, s24
    s_lshr_b32 s24, s60, 4
    s_lshl_b32 s24, s24, 24
    s_add_u32 s50, s50, s24
    s_add_u32 s50, s50, s63
    s_add_u32 s61, s61, s50
    s_and_b32 s24, s82, 2
    s_lshl_b32 s24, s24, 23
    s_add_u32 s51, s51, s24
    s_lshl_b32 s24, s22, 5
    s_add_u32 s60, s60, s24
    s_lshl_b32 s64, s60, 10
    buffer_load_dwordx4 v[96:99], v240, s[12:15], s64 offen
    s_lshl_b32 s52, s22, 6
    s_add_u32 s52, s52, 0x4000
    s_lshl_b32 s24, s22, 7
    s_and_b32 s25, s82, 2
    s_lshl_b32 s25, s25, 7
    s_add_u32 s24, s24, s25
    s_add_u32 s24, s24, 0x6a00
    s_cmp_lg_u32 s81, 0
    s_cselect_b32 s52, s24, s52
    s_cmp_ge_u32 s22, 61
    s_cselect_b32 s83, s87, 0
    s_and_b32 s83, s83, 1
    s_cbranch_scc0 L_notouch_130
    buffer_load_dword v245, off, s[8:11], s52 sc1
    s_cmp_lg_u32 s82, 0
    s_cbranch_scc0 L_notouch_130
    s_cselect_b32 s25, 2, 3
    v_lshlrev_b32 v246, s25, v240
    s_lshl_b32 s24, s27, s25
    s_add_u32 s24, s24, s51
    buffer_load_dword v245, v246, s[8:11], s24 offen sc1
    s_cmp_eq_u32 s82, 0
    s_cbranch_scc1 L_notouch_130
    s_mov_b32 s83, 3
    v_mov_b32 v140, -1
    v_mov_b32 v141, -1
    v_mov_b32 v142, -1
    v_mov_b32 v143, -1
    s_waitcnt vmcnt(0)
    s_barrier
    buffer_store_dwordx4 v[140:143], v242, s[8:11], s51 offen
    buffer_store_dwordx4 v[140:143], v242, s[8:11], s51 offen offset:64
    buffer_store_dwordx4 v[140:143], v242, s[8:11], s51 offen offset:128
    buffer_store_dwordx4 v[140:143], v242, s[8:11], s51 offen offset:192
L_notouch_130:
    buffer_load_dwordx4 v[0:3], v240, s[8:11], s46 offen
    buffer_load_dwordx4 v[4:7], v240, s[8:11], s46 offen offset:1024
    buffer_load_dwordx4 v[8:11], v240, s[8:11], s46 offen offset:2048
    buffer_load_dwordx4 v[12:15], v240, s[8:11], s46 offen offset:3072
    buffer_load_dwordx4 v[16:19], v240, s[8:11], s47 offen
    buffer_load_dwordx4 v[20:23], v240, s[8:11], s47 offen offset:1024
    buffer_load_dwordx4 v[24:27], v240, s[8:11], s47 offen offset:2048
    buffer_load_dwordx4 v[28:31], v240, s[8:11], s47 offen offset:3072
    buffer_load_dwordx4 v[32:35], v240, s[8:11], s54 offen
    buffer_load_dwordx4 v[36:39], v240, s[8:11], s54 offen offset:1024
    buffer_load_dwordx4 v[40:43], v240, s[8:11], s54 offen offset:2048
    buffer_load_dwordx4 v[44:47], v240, s[8:11], s54 offen offset:3072
    buffer_load_dwordx4 v[64:67], v240, s[8:11], s48 offen
    buffer_load_dwordx4 v[68:71], v240, s[8:11], s48 offen offset:1024
    buffer_load_dwordx4 v[72:75], v240, s[8:11], s48 offen offset:2048
    buffer_load_dwordx4 v[76:79], v240, s[8:11], s48 offen offset:3072
    buffer_load_dwordx4 v[80:83], v240, s[8:11], s55 offen
    buffer_load_dwordx4 v[84:87], v240, s[8:11], s55 offen offset:1024
    buffer_load_dwordx4 v[88:91], v240, s[8:11], s55 offen offset:2048
    buffer_load_dwordx4 v[92:95], v240, s[8:11], s55 offen offset:3072
    s_waitcnt vmcnt(8)
    v_mfma_f32_16x16x32_bf16 v[116:119], v[16:19], v[0:3], 0
    v_mfma_f32_16x16x32_bf16 v[116:119], v[20:23], v[4:7], v[116:119]
    v_mfma_f32_16x16x32_bf16 v[116:119], v[24:27], v[8:11], v[116:119]
    v_mfma_f32_16x16x32_bf16 v[116:119], v[28:31], v[12:15], v[116:119]
    v_mfma_f32_16x16x32_bf16 v[120:123], v[32:35], v[0:3], 0
    v_mfma_f32_16x16x32_bf16 v[120:123], v[36:39], v[4:7], v[120:123]
    v_mfma_f32_16x16x32_bf16 v[120:123], v[40:43], v[8:11], v[120:123]
    v_mfma_f32_16x16x32_bf16 v[120:123], v[44:47], v[12:15], v[120:123]
    v_mov_b32 v247, s53
    v_cndmask_b32 v116, v247, v116, s[30:31]
    v_cndmask_b32 v117, v247, v117, s[32:33]
    v_cndmask_b32 v118, v247, v118, s[34:35]
    v_cndmask_b32 v119, v247, v119, s[36:37]
    s_nop 2
    v_cndmask_b32 v120, v247, v120, s[38:39]
    v_cndmask_b32 v121, v247, v121, s[40:41]
    v_cndmask_b32 v122, v247, v122, s[42:43]
    v_cndmask_b32 v123, v247, v123, s[44:45]
    v_max3_f32 v246, v116, v117, v118
    v_max3_f32 v246, v246, v119, v120
    v_max3_f32 v246, v246, v121, v122
    v_max_f32 v246, v246, v123
    v_mov_b32 v247, v246
    s_nop 1
    v_permlane32_swap_b32 v247, v246
    v_max_f32 v246, v247, v246
    v_mov_b32 v247, v246
    s_nop 1
    v_permlane16_swap_b32 v247, v246
    v_max_f32 v246, v247, v246
    v_mul_f32 v248, s28, v246
    v_pk_fma_f32 v[116:117], v[116:117], s[28:29], v[248:249] op_sel_hi:[1,1,0] neg_lo:[0,0,1] neg_hi:[0,0,1]
    v_pk_fma_f32 v[118:119], v[118:119], s[28:29], v[248:249] op_sel_hi:[1,1,0] neg_lo:[0,0,1] neg_hi:[0,0,1]
    v_pk_fma_f32 v[120:121], v[120:121], s[28:29], v[248:249] op_sel_hi:[1,1,0] neg_lo:[0,0,1] neg_hi:[0,0,1]
    v_pk_fma_f32 v[122:123], v[122:123], s[28:29], v[248:249] op_sel_hi:[1,1,0] neg_lo:[0,0,1] neg_hi:[0,0,1]
    v_exp_f32 v116, v116
    v_exp_f32 v117, v117
    v_exp_f32 v118, v118
    v_exp_f32 v119, v119
    v_exp_f32 v120, v120
    v_exp_f32 v121, v121
    v_exp_f32 v122, v122
    v_exp_f32 v123, v123
    v_cvt_pk_bf16_f32 v124, v116, v117
    v_cvt_pk_bf16_f32 v125, v118, v119
    v_cvt_pk_bf16_f32 v126, v120, v121
    v_cvt_pk_bf16_f32 v127, v122, v123
    v_mov_b32 v129, 0
    s_nop 0
    v_mfma_f32_16x16x32_bf16 v[132:135], v[136:139], v[124:127], 0
    s_waitcnt vmcnt(7)
    v_mfma_f32_16x16x32_bf16 v[140:143], v[64:67], v[124:127], 0
    s_waitcnt vmcnt(6)
    v_mfma_f32_16x16x32_bf16 v[144:147], v[68:71], v[124:127], 0
    s_waitcnt vmcnt(5)
    v_mfma_f32_16x16x32_bf16 v[148:151], v[72:75], v[124:127], 0
    s_waitcnt vmcnt(4)
    v_mfma_f32_16x16x32_bf16 v[152:155], v[76:79], v[124:127], 0
    s_waitcnt vmcnt(3)
    v_mfma_f32_16x16x32_bf16 v[156:159], v[80:83], v[124:127], 0
    s_waitcnt vmcnt(2)
    v_mfma_f32_16x16x32_bf16 v[160:163], v[84:87], v[124:127], 0
    s_waitcnt vmcnt(1)
    v_mfma_f32_16x16x32_bf16 v[164:167], v[88:91], v[124:127], 0
    s_waitcnt vmcnt(0)
    v_mfma_f32_16x16x32_bf16 v[168:171], v[92:95], v[124:127], 0
    v_lshrrev_b32 v246, 2, v240
    s_lshl_b32 s24, s20, 7
    s_add_u32 s24, s24, 0x1000
    s_add_u32 s25, s22, 1
    s_sub_u32 s26, s22, 1
    s_min_u32 s26, s26, 61
    s_cmp_lg_u32 s81, 0
    s_cselect_b32 s25, s26, s25
    s_cmp_lg_u32 s100, 0
    s_cbranch_scc1 L_polls_133
    s_mov_b32 exec_lo, 0x11
    s_mov_b32 exec_hi, 0
    s_mov_b32 s96, 0
L_poll_131:
    buffer_load_dword v247, v246, s[8:11], s24 offen sc1
    s_waitcnt vmcnt(0)
    v_cmp_gt_u32 vcc, s25, v247
    s_cbranch_vccz L_polld_132
    v_readfirstlane_b32 s97, v247
    s_nop 0
    s_sub_u32 s97, s25, s97
    s_cmp_lt_i32 s97, 3
    s_cbranch_scc1 L_near_134
    s_sleep 40
    s_cmp_lt_i32 s97, 5
    s_cbranch_scc1 L_near_134
    s_sleep 100
L_near_134:
    s_sleep 4
    s_add_u32 s96, s96, 1
    s_cmp_lt_u32 s96, 0x10000
    s_cbranch_scc1 L_poll_131
L_polld_132:
    s_mov_b64 exec, -1
L_polls_133:
    s_barrier
    s_cmp_eq_u32 s81, 0
    s_cbranch_scc1 L_kmf_136
    s_cmp_lg_u32 s83, 3
    s_cbranch_scc1 L_noinit_138
    s_lshl_b32 s26, s20, 2
    s_add_u32 s26, s26, s52
    s_cmp_lg_u32 s100, 0
    s_cbranch_scc1 L_flag_139
    v_mov_b32 v246, 1
    s_mov_b64 exec, 1
    buffer_store_dword v246, off, s[8:11], s26
    s_mov_b64 exec, -1
L_flag_139:
L_noinit_138:
    s_lshr_b32 s26, s21, 1
    s_lshl_b32 s26, s26, 4
    s_add_u32 s24, s24, s26
    s_mov_b32 s96, 0
    buffer_load_dword v245, off, s[8:11], s24 sc1
    buffer_load_dwordx4 v[220:223], v240, s[8:11], s49 offen sc1
    buffer_load_dwordx4 v[224:227], v240, s[8:11], s49 offen offset:1024 sc1
    buffer_load_dwordx4 v[228:231], v240, s[8:11], s49 offen offset:2048 sc1
    buffer_load_dwordx4 v[232:235], v240, s[8:11], s49 offen offset:3072 sc1
    s_sleep 14
L_kmp_135:
    buffer_load_dword v245, off, s[8:11], s24 sc1
    buffer_load_dwordx4 v[220:223], v240, s[8:11], s49 offen sc1
    buffer_load_dwordx4 v[224:227], v240, s[8:11], s49 offen offset:1024 sc1
    buffer_load_dwordx4 v[228:231], v240, s[8:11], s49 offen offset:2048 sc1
    buffer_load_dwordx4 v[232:235], v240, s[8:11], s49 offen offset:3072 sc1
    s_add_u32 s96, s96, 1
    s_waitcnt vmcnt(5)
    v_max3_u32 v246, v220, v221, v222
    v_max3_u32 v246, v246, v223, v224
    v_max3_u32 v246, v246, v225, v226
    v_max3_u32 v246, v246, v227, v228
    v_max3_u32 v246, v246, v229, v230
    v_max3_u32 v246, v246, v231, v232
    v_max3_u32 v246, v246, v233, v234
    v_max_u32 v246, v246, v235
    v_cmp_eq_u32 vcc, -1, v246
    v_readfirstlane_b32 s26, v245
    s_cbranch_vccz L_kmo_137
    s_cmp_gt_u32 s26, s22
    s_cbranch_scc1 L_kmf_136
    s_cmp_lt_u32 s96, 0x10000
    s_cbranch_scc1 L_kmp_135
L_kmf_136:
    buffer_load_dwordx4 v[220:223], v240, s[8:11], s49 offen sc1
    buffer_load_dwordx4 v[224:227], v240, s[8:11], s49 offen offset:1024 sc1
    buffer_load_dwordx4 v[228:231], v240, s[8:11], s49 offen offset:2048 sc1
    buffer_load_dwordx4 v[232:235], v240, s[8:11], s49 offen offset:3072 sc1
    s_waitcnt vmcnt(0)
L_kmo_137:
    ds_write_b32 v253, v221
    ds_write_b32 v253, v223 offset:64
    ds_write_b32 v253, v225 offset:1024
    ds_write_b32 v253, v227 offset:1088
    ds_write_b32 v253, v229 offset:2048
    ds_write_b32 v253, v231 offset:2112
    ds_write_b32 v253, v233 offset:3072
    ds_write_b32 v253, v235 offset:3136
    ds_read_b128 v[48:51], v254
    ds_read_b128 v[52:55], v254 offset:1024
    ds_read_b128 v[56:59], v254 offset:2048
    ds_read_b128 v[60:63], v254 offset:3072
    s_cmp_lg_u32 s83, 3
    s_cbranch_scc1 L_noside_140
    s_mov_b32 s62, 0x8f00
    buffer_load_dword v104, off, s[8:11], s62 sc1
    v_bfe_u32 v108, v240, 2, 6
    buffer_load_dword v108, v108, s[8:11], s52 offen sc1
L_noside_140:
    s_waitcnt lgkmcnt(3)
    v_mfma_f32_16x16x32_bf16 v[112:115], v[48:51], v[0:3], 0
    s_waitcnt lgkmcnt(2)
    v_mfma_f32_16x16x32_bf16 v[112:115], v[52:55], v[4:7], v[112:115]
    s_waitcnt lgkmcnt(1)
    v_mfma_f32_16x16x32_bf16 v[112:115], v[56:59], v[8:11], v[112:115]
    s_waitcnt lgkmcnt(0)
    v_mfma_f32_16x16x32_bf16 v[112:115], v[60:63], v[12:15], v[112:115]
    s_nop 7
    v_pk_fma_f32 v[114:115], v[112:113], s[28:29], v[248:249] op_sel_hi:[1,1,0] neg_lo:[0,0,1] neg_hi:[0,0,1]
    v_max_f32 v246, v114, v115
    v_cmp_lt_f32 vcc, 0x42200000, v246
    s_cbranch_vccnz L_redo_141
L_redone_142:
    v_exp_f32 v114, v114
    v_exp_f32 v115, v115
    s_nop 0
    v_cvt_pk_bf16_f32 v128, v114, v115
    s_nop 1
    v_mfma_f32_16x16x16_bf16 v[132:135], v[136:137], v[128:129], v[132:135]
    v_mfma_f32_16x16x16_bf16 v[140:143], v[220:221], v[128:129], v[140:143]
    v_mfma_f32_16x16x16_bf16 v[144:147], v[222:223], v[128:129], v[144:147]
    v_mfma_f32_16x16x16_bf16 v[148:151], v[224:225], v[128:129], v[148:151]
    v_rcp_f32 v250, v132
    v_mfma_f32_16x16x16_bf16 v[152:155], v[226:227], v[128:129], v[152:155]
    v_mul_f32 v140, v250, v140
    v_mul_f32 v141, v250, v141
    v_mfma_f32_16x16x16_bf16 v[156:159], v[228:229], v[128:129], v[156:159]
    v_mul_f32 v142, v250, v142
    v_mul_f32 v143, v250, v143
    v_mfma_f32_16x16x16_bf16 v[160:163], v[230:231], v[128:129], v[160:163]
    v_cvt_pk_bf16_f32 v140, v140, v141
    v_cvt_pk_bf16_f32 v141, v142, v143
    v_mfma_f32_16x16x16_bf16 v[164:167], v[232:233], v[128:129], v[164:167]
    v_mul_f32 v144, v250, v144
    v_mul_f32 v145, v250, v145
    v_mfma_f32_16x16x16_bf16 v[168:171], v[234:235], v[128:129], v[168:171]
    v_mul_f32 v146, v250, v146
    v_mul_f32 v147, v250, v147
    v_cvt_pk_bf16_f32 v142, v144, v145
    v_cvt_pk_bf16_f32 v143, v146, v147
    ds_write_b128 v243, v[140:143]
    v_pk_mul_f32 v[148:149], v[148:149], v[250:251] op_sel_hi:[1,0]
    v_pk_mul_f32 v[150:151], v[150:151], v[250:251] op_sel_hi:[1,0]
    v_cvt_pk_bf16_f32 v144, v148, v149
    v_cvt_pk_bf16_f32 v145, v150, v151
    v_pk_mul_f32 v[152:153], v[152:153], v[250:251] op_sel_hi:[1,0]
    v_pk_mul_f32 v[154:155], v[154:155], v[250:251] op_sel_hi:[1,0]
    v_cvt_pk_bf16_f32 v146, v152, v153
    v_cvt_pk_bf16_f32 v147, v154, v155
    ds_write_b128 v243, v[144:147] offset:1024
    v_pk_mul_f32 v[156:157], v[156:157], v[250:251] op_sel_hi:[1,0]
    v_pk_mul_f32 v[158:159], v[158:159], v[250:251] op_sel_hi:[1,0]
    v_cvt_pk_bf16_f32 v148, v156, v157
    v_cvt_pk_bf16_f32 v149, v158, v159
    v_pk_mul_f32 v[160:161], v[160:161], v[250:251] op_sel_hi:[1,0]
    v_pk_mul_f32 v[162:163], v[162:163], v[250:251] op_sel_hi:[1,0]
    v_cvt_pk_bf16_f32 v150, v160, v161
    v_cvt_pk_bf16_f32 v151, v162, v163
    ds_write_b128 v243, v[148:151] offset:2048
    v_pk_mul_f32 v[164:165], v[164:165], v[250:251] op_sel_hi:[1,0]
    v_pk_mul_f32 v[166:167], v[166:167], v[250:251] op_sel_hi:[1,0]
    v_cvt_pk_bf16_f32 v152, v164, v165
    v_cvt_pk_bf16_f32 v153, v166, v167
    v_pk_mul_f32 v[168:169], v[168:169], v[250:251] op_sel_hi:[1,0]
    v_pk_mul_f32 v[170:171], v[170:171], v[250:251] op_sel_hi:[1,0]
    v_cvt_pk_bf16_f32 v154, v168, v169
    v_cvt_pk_bf16_f32 v155, v170, v171
    ds_write_b128 v243, v[152:155] offset:3072
    s_waitcnt lgkmcnt(0)
    s_barrier
    s_lshr_b32 s25, s82, 1
    s_lshl_b32 s24, s25, 12
    v_add_u32 v246, s24, v244
    ds_read_b128 v[0:3], v246
    ds_read_b128 v[4:7], v246 offset:1024
    ds_read_b128 v[8:11], v246 offset:2048
    ds_read_b128 v[12:15], v246 offset:3072
    ds_read_b128 v[32:35], v246 offset:8192
    ds_read_b128 v[36:39], v246 offset:9216
    ds_read_b128 v[40:43], v246 offset:10240
    ds_read_b128 v[44:47], v246 offset:11264
    v_xor_b32 v243, 0x4000, v243
    s_waitcnt lgkmcnt(7)
    v_mfma_f32_16x16x32_bf16 v[172:175], a[0:3], v[0:3], 0
    v_mfma_f32_16x16x32_bf16 v[176:179], a[4:7], v[0:3], 0
    s_waitcnt lgkmcnt(6)
    v_mfma_f32_16x16x32_bf16 v[172:175], a[32:35], v[4:7], v[172:175]
    v_mfma_f32_16x16x32_bf16 v[176:179], a[36:39], v[4:7], v[176:179]
    s_waitcnt lgkmcnt(5)
    v_mfma_f32_16x16x32_bf16 v[172:175], a[64:67], v[8:11], v[172:175]
    v_mfma_f32_16x16x32_bf16 v[176:179], a[68:71], v[8:11], v[176:179]
    s_waitcnt lgkmcnt(4)
    v_mfma_f32_16x16x32_bf16 v[172:175], a[96:99], v[12:15], v[172:175]
    v_mfma_f32_16x16x32_bf16 v[176:179], a[100:103], v[12:15], v[176:179]
    s_waitcnt lgkmcnt(3)
    v_mfma_f32_16x16x32_bf16 v[172:175], a[128:131], v[32:35], v[172:175]
    v_mfma_f32_16x16x32_bf16 v[176:179], a[132:135], v[32:35], v[176:179]
    s_waitcnt lgkmcnt(2)
    v_mfma_f32_16x16x32_bf16 v[172:175], a[160:163], v[36:39], v[172:175]
    v_mfma_f32_16x16x32_bf16 v[176:179], a[164:167], v[36:39], v[176:179]
    s_waitcnt lgkmcnt(1)
    v_mfma_f32_16x16x32_bf16 v[172:175], a[192:195], v[40:43], v[172:175]
    v_mfma_f32_16x16x32_bf16 v[176:179], a[196:199], v[40:43], v[176:179]
    s_waitcnt lgkmcnt(0)
    v_mfma_f32_16x16x32_bf16 v[172:175], a[224:227], v[44:47], v[172:175]
    v_mfma_f32_16x16x32_bf16 v[176:179], a[228:231], v[44:47], v[176:179]
    v_mfma_f32_16x16x32_bf16 v[180:183], a[8:11], v[0:3], 0
    v_mfma_f32_16x16x32_bf16 v[184:187], a[12:15], v[0:3], 0
    ds_read_b128 v[16:19], v244 offset:4096
    v_mfma_f32_16x16x32_bf16 v[180:183], a[40:43], v[4:7], v[180:183]
    v_mfma_f32_16x16x32_bf16 v[184:187], a[44:47], v[4:7], v[184:187]
    ds_read_b128 v[20:23], v244 offset:5120
    v_cvt_pk_bf16_f32 v140, v172, v173
    v_cvt_pk_bf16_f32 v141, v174, v175
    v_cvt_pk_bf16_f32 v142, v176, v177
    v_cvt_pk_bf16_f32 v143, v178, v179
    v_min_u32 v140, 0xfffffffe, v140
    s_add_u32 s24, s51, 0x0
    s_cmp_lg_u32 s83, 0
    s_cbranch_scc1 L_near_145
    buffer_store_dwordx4 v[140:143], v242, s[8:11], s24 offen sc1
    s_branch L_far_146
L_near_145:
    buffer_store_dwordx4 v[140:143], v242, s[8:11], s24 offen
L_far_146:
    v_mfma_f32_16x16x32_bf16 v[180:183], a[72:75], v[8:11], v[180:183]
    v_mfma_f32_16x16x32_bf16 v[184:187], a[76:79], v[8:11], v[184:187]
    ds_read_b128 v[24:27], v244 offset:6144
    v_mfma_f32_16x16x32_bf16 v[180:183], a[104:107], v[12:15], v[180:183]
    v_mfma_f32_16x16x32_bf16 v[184:187], a[108:111], v[12:15], v[184:187]
    ds_read_b128 v[28:31], v244 offset:7168
    v_mfma_f32_16x16x32_bf16 v[180:183], a[136:139], v[32:35], v[180:183]
    v_mfma_f32_16x16x32_bf16 v[184:187], a[140:143], v[32:35], v[184:187]
    ds_read_b128 v[48:51], v244 offset:12288
    v_mfma_f32_16x16x32_bf16 v[180:183], a[168:171], v[36:39], v[180:183]
    v_mfma_f32_16x16x32_bf16 v[184:187], a[172:175], v[36:39], v[184:187]
    ds_read_b128 v[52:55], v244 offset:13312
    v_mfma_f32_16x16x32_bf16 v[180:183], a[200:203], v[40:43], v[180:183]
    v_mfma_f32_16x16x32_bf16 v[184:187], a[204:207], v[40:43], v[184:187]
    ds_read_b128 v[56:59], v244 offset:14336
    v_mfma_f32_16x16x32_bf16 v[180:183], a[232:235], v[44:47], v[180:183]
    v_mfma_f32_16x16x32_bf16 v[184:187], a[236:239], v[44:47], v[184:187]
    ds_read_b128 v[60:63], v244 offset:15360
    v_mfma_f32_16x16x32_bf16 v[188:191], a[16:19], v[0:3], 0
    v_mfma_f32_16x16x32_bf16 v[192:195], a[20:23], v[0:3], 0
    v_mfma_f32_16x16x32_bf16 v[188:191], a[48:51], v[4:7], v[188:191]
    v_mfma_f32_16x16x32_bf16 v[192:195], a[52:55], v[4:7], v[192:195]
    v_cvt_pk_bf16_f32 v144, v180, v181
    v_cvt_pk_bf16_f32 v145, v182, v183
    v_cvt_pk_bf16_f32 v146, v184, v185
    v_cvt_pk_bf16_f32 v147, v186, v187
    v_min_u32 v144, 0xfffffffe, v144
    s_cmp_lg_u32 s83, 0
    s_cbranch_scc1 L_near_147
    buffer_store_dwordx4 v[144:147], v242, s[8:11], s24 offen offset:64 sc1
    s_branch L_far_148
L_near_147:
    buffer_store_dwordx4 v[144:147], v242, s[8:11], s24 offen offset:64
L_far_148:
    v_mfma_f32_16x16x32_bf16 v[188:191], a[80:83], v[8:11], v[188:191]
    v_mfma_f32_16x16x32_bf16 v[192:195], a[84:87], v[8:11], v[192:195]
    v_mfma_f32_16x16x32_bf16 v[188:191], a[112:115], v[12:15], v[188:191]
    v_mfma_f32_16x16x32_bf16 v[192:195], a[116:119], v[12:15], v[192:195]
    v_mfma_f32_16x16x32_bf16 v[188:191], a[144:147], v[32:35], v[188:191]
    v_mfma_f32_16x16x32_bf16 v[192:195], a[148:151], v[32:35], v[192:195]
    v_mfma_f32_16x16x32_bf16 v[188:191], a[176:179], v[36:39], v[188:191]
    v_mfma_f32_16x16x32_bf16 v[192:195], a[180:183], v[36:39], v[192:195]
    v_mfma_f32_16x16x32_bf16 v[188:191], a[208:211], v[40:43], v[188:191]
    v_mfma_f32_16x16x32_bf16 v[192:195], a[212:215], v[40:43], v[192:195]
    v_mfma_f32_16x16x32_bf16 v[188:191], a[240:243], v[44:47], v[188:191]
    v_mfma_f32_16x16x32_bf16 v[192:195], a[244:247], v[44:47], v[192:195]
    v_mfma_f32_16x16x32_bf16 v[196:199], a[24:27], v[0:3], 0
    v_mfma_f32_16x16x32_bf16 v[200:203], a[28:31], v[0:3], 0
    v_mfma_f32_16x16x32_bf16 v[196:199], a[56:59], v[4:7], v[196:199]
    v_mfma_f32_16x16x32_bf16 v[200:203], a[60:63], v[4:7], v[200:203]
    v_cvt_pk_bf16_f32 v148, v188, v189
    v_cvt_pk_bf16_f32 v149, v190, v191
    v_cvt_pk_bf16_f32 v150, v192, v193
    v_cvt_pk_bf16_f32 v151, v194, v195
    v_min_u32 v148, 0xfffffffe, v148
    s_cmp_lg_u32 s83, 0
    s_cbranch_scc1 L_near_149
    buffer_store_dwordx4 v[148:151], v242, s[8:11], s24 offen offset:128 sc1
    s_branch L_far_150
L_near_149:
    buffer_store_dwordx4 v[148:151], v242, s[8:11], s24 offen offset:128
L_far_150:
    v_mfma_f32_16x16x32_bf16 v[196:199], a[88:91], v[8:11], v[196:199]
    v_mfma_f32_16x16x32_bf16 v[200:203], a[92:95], v[8:11], v[200:203]
    v_mfma_f32_16x16x32_bf16 v[196:199], a[120:123], v[12:15], v[196:199]
    v_mfma_f32_16x16x32_bf16 v[200:203], a[124:127], v[12:15], v[200:203]
    v_mfma_f32_16x16x32_bf16 v[196:199], a[152:155], v[32:35], v[196:199]
    v_mfma_f32_16x16x32_bf16 v[200:203], a[156:159], v[32:35], v[200:203]
    v_mfma_f32_16x16x32_bf16 v[196:199], a[184:187], v[36:39], v[196:199]
    v_mfma_f32_16x16x32_bf16 v[200:203], a[188:191], v[36:39], v[200:203]
    v_mfma_f32_16x16x32_bf16 v[196:199], a[216:219], v[40:43], v[196:199]
    v_mfma_f32_16x16x32_bf16 v[200:203], a[220:223], v[40:43], v[200:203]
    v_mfma_f32_16x16x32_bf16 v[196:199], a[248:251], v[44:47], v[196:199]
    v_mfma_f32_16x16x32_bf16 v[200:203], a[252:255], v[44:47], v[200:203]
    v_xor_b32 v244, 0x4000, v244
    s_cmp_lg_u32 s82, 0
    s_cbranch_scc1 L_half_143
    s_waitcnt lgkmcnt(0)
    v_mfma_f32_16x16x32_bf16 v[204:207], a[0:3], v[16:19], 0
    v_mfma_f32_16x16x32_bf16 v[208:211], a[4:7], v[16:19], 0
    v_mfma_f32_16x16x32_bf16 v[204:207], a[32:35], v[20:23], v[204:207]
    v_mfma_f32_16x16x32_bf16 v[208:211], a[36:39], v[20:23], v[208:211]
    v_cvt_pk_bf16_f32 v152, v196, v197
    v_cvt_pk_bf16_f32 v153, v198, v199
    v_cvt_pk_bf16_f32 v154, v200, v201
    v_cvt_pk_bf16_f32 v155, v202, v203
    v_min_u32 v152, 0xfffffffe, v152
    s_cmp_lg_u32 s83, 0
    s_cbranch_scc1 L_near_151
    buffer_store_dwordx4 v[152:155], v242, s[8:11], s24 offen offset:192 sc1
    s_branch L_far_152
L_near_151:
    buffer_store_dwordx4 v[152:155], v242, s[8:11], s24 offen offset:192
L_far_152:
    v_mfma_f32_16x16x32_bf16 v[204:207], a[64:67], v[24:27], v[204:207]
    v_mfma_f32_16x16x32_bf16 v[208:211], a[68:71], v[24:27], v[208:211]
    v_mfma_f32_16x16x32_bf16 v[204:207], a[96:99], v[28:31], v[204:207]
    v_mfma_f32_16x16x32_bf16 v[208:211], a[100:103], v[28:31], v[208:211]
    v_mfma_f32_16x16x32_bf16 v[204:207], a[128:131], v[48:51], v[204:207]
    v_mfma_f32_16x16x32_bf16 v[208:211], a[132:135], v[48:51], v[208:211]
    v_mfma_f32_16x16x32_bf16 v[204:207], a[160:163], v[52:55], v[204:207]
    v_mfma_f32_16x16x32_bf16 v[208:211], a[164:167], v[52:55], v[208:211]
    v_mfma_f32_16x16x32_bf16 v[204:207], a[192:195], v[56:59], v[204:207]
    v_mfma_f32_16x16x32_bf16 v[208:211], a[196:199], v[56:59], v[208:211]
    v_mfma_f32_16x16x32_bf16 v[204:207], a[224:227], v[60:63], v[204:207]
    v_mfma_f32_16x16x32_bf16 v[208:211], a[228:231], v[60:63], v[208:211]
    v_mfma_f32_16x16x32_bf16 v[212:215], a[8:11], v[16:19], 0
    v_mfma_f32_16x16x32_bf16 v[216:219], a[12:15], v[16:19], 0
    v_mfma_f32_16x16x32_bf16 v[212:215], a[40:43], v[20:23], v[212:215]
    v_mfma_f32_16x16x32_bf16 v[216:219], a[44:47], v[20:23], v[216:219]
    v_cvt_pk_bf16_f32 v140, v204, v205
    v_cvt_pk_bf16_f32 v141, v206, v207
    v_cvt_pk_bf16_f32 v142, v208, v209
    v_cvt_pk_bf16_f32 v143, v210, v211
    v_min_u32 v140, 0xfffffffe, v140
    s_add_u32 s24, s51, 0x1000000
    s_cmp_lg_u32 s83, 0
    s_cbranch_scc1 L_near_153
    buffer_store_dwordx4 v[140:143], v242, s[8:11], s24 offen sc1
    s_branch L_far_154
L_near_153:
    buffer_store_dwordx4 v[140:143], v242, s[8:11], s24 offen
L_far_154:
    v_mfma_f32_16x16x32_bf16 v[212:215], a[72:75], v[24:27], v[212:215]
    v_mfma_f32_16x16x32_bf16 v[216:219], a[76:79], v[24:27], v[216:219]
    v_mfma_f32_16x16x32_bf16 v[212:215], a[104:107], v[28:31], v[212:215]
    v_mfma_f32_16x16x32_bf16 v[216:219], a[108:111], v[28:31], v[216:219]
    v_mfma_f32_16x16x32_bf16 v[212:215], a[136:139], v[48:51], v[212:215]
    v_mfma_f32_16x16x32_bf16 v[216:219], a[140:143], v[48:51], v[216:219]
    v_mfma_f32_16x16x32_bf16 v[212:215], a[168:171], v[52:55], v[212:215]
    v_mfma_f32_16x16x32_bf16 v[216:219], a[172:175], v[52:55], v[216:219]
    v_mfma_f32_16x16x32_bf16 v[212:215], a[200:203], v[56:59], v[212:215]
    v_mfma_f32_16x16x32_bf16 v[216:219], a[204:207], v[56:59], v[216:219]
    v_mfma_f32_16x16x32_bf16 v[212:215], a[232:235], v[60:63], v[212:215]
    v_mfma_f32_16x16x32_bf16 v[216:219], a[236:239], v[60:63], v[216:219]
    s_waitcnt vmcnt(5)
    v_mfma_f32_16x16x32_bf16 v[220:223], a[16:19], v[16:19], 0
    v_mfma_f32_16x16x32_bf16 v[224:227], a[20:23], v[16:19], 0
    v_mfma_f32_16x16x32_bf16 v[220:223], a[48:51], v[20:23], v[220:223]
    v_mfma_f32_16x16x32_bf16 v[224:227], a[52:55], v[20:23], v[224:227]
    v_cvt_pk_bf16_f32 v144, v212, v213
    v_cvt_pk_bf16_f32 v145, v214, v215
    v_cvt_pk_bf16_f32 v146, v216, v217
    v_cvt_pk_bf16_f32 v147, v218, v219
    v_min_u32 v144, 0xfffffffe, v144
    s_cmp_lg_u32 s83, 0
    s_cbranch_scc1 L_near_155
    buffer_store_dwordx4 v[144:147], v242, s[8:11], s24 offen offset:64 sc1
    s_branch L_far_156
L_near_155:
    buffer_store_dwordx4 v[144:147], v242, s[8:11], s24 offen offset:64
L_far_156:
    v_mfma_f32_16x16x32_bf16 v[220:223], a[80:83], v[24:27], v[220:223]
    v_mfma_f32_16x16x32_bf16 v[224:227], a[84:87], v[24:27], v[224:227]
    v_mfma_f32_16x16x32_bf16 v[220:223], a[112:115], v[28:31], v[220:223]
    v_mfma_f32_16x16x32_bf16 v[224:227], a[116:119], v[28:31], v[224:227]
    v_mfma_f32_16x16x32_bf16 v[220:223], a[144:147], v[48:51], v[220:223]
    v_mfma_f32_16x16x32_bf16 v[224:227], a[148:151], v[48:51], v[224:227]
    v_mfma_f32_16x16x32_bf16 v[220:223], a[176:179], v[52:55], v[220:223]
    v_mfma_f32_16x16x32_bf16 v[224:227], a[180:183], v[52:55], v[224:227]
    v_mfma_f32_16x16x32_bf16 v[220:223], a[208:211], v[56:59], v[220:223]
    v_mfma_f32_16x16x32_bf16 v[224:227], a[212:215], v[56:59], v[224:227]
    v_mfma_f32_16x16x32_bf16 v[220:223], a[240:243], v[60:63], v[220:223]
    v_mfma_f32_16x16x32_bf16 v[224:227], a[244:247], v[60:63], v[224:227]
    v_mfma_f32_16x16x32_bf16 v[228:231], a[24:27], v[16:19], 0
    v_mfma_f32_16x16x32_bf16 v[232:235], a[28:31], v[16:19], 0
    v_mfma_f32_16x16x32_bf16 v[228:231], a[56:59], v[20:23], v[228:231]
    v_mfma_f32_16x16x32_bf16 v[232:235], a[60:63], v[20:23], v[232:235]
    v_cvt_pk_bf16_f32 v148, v220, v221
    v_cvt_pk_bf16_f32 v149, v222, v223
    v_cvt_pk_bf16_f32 v150, v224, v225
    v_cvt_pk_bf16_f32 v151, v226, v227
    v_min_u32 v148, 0xfffffffe, v148
    s_cmp_lg_u32 s83, 0
    s_cbranch_scc1 L_near_157
    buffer_store_dwordx4 v[148:151], v242, s[8:11], s24 offen offset:128 sc1
    s_branch L_far_158
L_near_157:
    buffer_store_dwordx4 v[148:151], v242, s[8:11], s24 offen offset:128
L_far_158:
    v_mfma_f32_16x16x32_bf16 v[228:231], a[88:91], v[24:27], v[228:231]
    v_mfma_f32_16x16x32_bf16 v[232:235], a[92:95], v[24:27], v[232:235]
    v_mfma_f32_16x16x32_bf16 v[228:231], a[120:123], v[28:31], v[228:231]
    v_mfma_f32_16x16x32_bf16 v[232:235], a[124:127], v[28:31], v[232:235]
    v_mfma_f32_16x16x32_bf16 v[228:231], a[152:155], v[48:51], v[228:231]
    v_mfma_f32_16x16x32_bf16 v[232:235], a[156:159], v[48:51], v[232:235]
    v_mfma_f32_16x16x32_bf16 v[228:231], a[184:187], v[52:55], v[228:231]
    v_mfma_f32_16x16x32_bf16 v[232:235], a[188:191], v[52:55], v[232:235]
    v_mfma_f32_16x16x32_bf16 v[228:231], a[216:219], v[56:59], v[228:231]
    v_mfma_f32_16x16x32_bf16 v[232:235], a[220:223], v[56:59], v[232:235]
    v_mfma_f32_16x16x32_bf16 v[228:231], a[248:251], v[60:63], v[228:231]
    v_mfma_f32_16x16x32_bf16 v[232:235], a[252:255], v[60:63], v[232:235]
    s_nop 3
    v_cvt_pk_bf16_f32 v152, v228, v229
    v_cvt_pk_bf16_f32 v153, v230, v231
    s_nop 1
    v_cvt_pk_bf16_f32 v154, v232, v233
    v_cvt_pk_bf16_f32 v155, v234, v235
    v_min_u32 v152, 0xfffffffe, v152
    s_cmp_lg_u32 s83, 0
    s_cbranch_scc1 L_near_159
    buffer_store_dwordx4 v[152:155], v242, s[8:11], s24 offen offset:192 sc1
    s_branch L_far_160
L_near_159:
    buffer_store_dwordx4 v[152:155], v242, s[8:11], s24 offen offset:192
L_far_160:
    s_branch L_proj_144
L_half_143:
    s_nop 7
    v_cvt_pk_bf16_f32 v152, v196, v197
    v_cvt_pk_bf16_f32 v153, v198, v199
    v_cvt_pk_bf16_f32 v154, v200, v201
    v_cvt_pk_bf16_f32 v155, v202, v203
    v_min_u32 v152, 0xfffffffe, v152
    s_cmp_lg_u32 s83, 0
    s_cbranch_scc1 L_near_161
    buffer_store_dwordx4 v[152:155], v242, s[8:11], s24 offen offset:192 sc1
    s_branch L_far_162
L_near_161:
    buffer_store_dwordx4 v[152:155], v242, s[8:11], s24 offen offset:192
L_far_162:
    s_waitcnt lgkmcnt(0)
L_proj_144:
    s_cmp_lg_u32 s83, 3
    s_cbranch_scc1 L_flags_165
    s_waitcnt vmcnt(4)
    v_cmp_eq_u32 vcc, 0, v108
    s_cbranch_vccz L_parts_163
    v_lshrrev_b32 v246, 2, v240
    s_mov_b32 exec_lo, 0xffff
    s_mov_b32 exec_hi, 0
    s_mov_b32 s96, 0
L_poll_166:
    buffer_load_dword v247, v246, s[8:11], s52 offen sc1
    s_waitcnt vmcnt(0)
    v_cmp_gt_u32 vcc, 1, v247
    s_cbranch_vccz L_polld_167
    s_sleep 1
    s_add_u32 s96, s96, 1
    s_cmp_lt_u32 s96, 0x10000
    s_cbranch_scc1 L_poll_166
L_polld_167:
    s_mov_b64 exec, -1
    s_branch L_parts_163
L_flags_165:
    s_mov_b32 s62, 0x8f00
    buffer_load_dword v104, off, s[8:11], s62 sc1
    s_waitcnt vmcnt(0)
    s_barrier
    s_lshl_b32 s26, s20, 2
    s_add_u32 s26, s26, s52
    s_cmp_lg_u32 s100, 0
    s_cbranch_scc1 L_flag_169
    v_mov_b32 v246, 1
    s_mov_b64 exec, 1
    s_cmp_lg_u32 s83, 0
    s_cbranch_scc1 L_near_170
    buffer_store_dword v246, off, s[8:11], s26 sc1
    s_branch L_far_171
L_near_170:
    buffer_store_dword v246, off, s[8:11], s26
L_far_171:
    s_mov_b64 exec, -1
L_flag_169:
    v_lshrrev_b32 v246, 2, v240
    s_cmp_lg_u32 s100, 0
    s_cbranch_scc1 L_polls_174
    s_mov_b32 exec_lo, 0xffff
    s_mov_b32 exec_hi, 0
    s_mov_b32 s96, 0
L_poll_172:
    buffer_load_dword v247, v246, s[8:11], s52 offen sc1
    s_waitcnt vmcnt(0)
    v_cmp_gt_u32 vcc, 1, v247
    s_cbranch_vccz L_polld_173
    s_sleep 1
    s_add_u32 s96, s96, 1
    s_cmp_lt_u32 s96, 0x10000
    s_cbranch_scc1 L_poll_172
L_polld_173:
    s_mov_b64 exec, -1
L_polls_174:
    s_barrier
L_parts_163:
    s_cmp_lg_u32 s83, 0
    s_cbranch_scc1 L_near_181
    buffer_load_dwordx4 v[48:51], v240, s[8:11], s50 offen sc1
    buffer_load_dwordx4 v[52:55], v105, s[8:11], s50 offen sc1
    buffer_load_dwordx4 v[56:59], v106, s[8:11], s50 offen sc1
    buffer_load_dwordx4 v[60:63], v107, s[8:11], s50 offen sc1
    s_branch L_far_182
L_near_181:
    buffer_load_dwordx4 v[48:51], v240, s[8:11], s50 offen sc1
    buffer_load_dwordx4 v[52:55], v105, s[8:11], s50 offen sc1
    buffer_load_dwordx4 v[56:59], v106, s[8:11], s50 offen sc1
    buffer_load_dwordx4 v[60:63], v107, s[8:11], s50 offen sc1
L_far_182:
    v_mov_b32 v68, 0
    v_mov_b32 v69, 0
    v_mov_b32 v70, 0
    v_mov_b32 v71, 0
    v_mov_b32 v72, 0
    v_mov_b32 v73, 0
    v_mov_b32 v74, 0
    v_mov_b32 v75, 0
    s_mov_b32 s96, 0
L_gp_176:
    s_cmp_lg_u32 s83, 0
    s_cbranch_scc1 L_near_183
    buffer_load_dwordx4 v[32:35], v240, s[8:11], s61 offen sc1
    buffer_load_dwordx4 v[36:39], v105, s[8:11], s61 offen sc1
    buffer_load_dwordx4 v[40:43], v106, s[8:11], s61 offen sc1
    buffer_load_dwordx4 v[44:47], v107, s[8:11], s61 offen sc1
    s_branch L_far_184
L_near_183:
    buffer_load_dwordx4 v[32:35], v240, s[8:11], s61 offen sc1
    buffer_load_dwordx4 v[36:39], v105, s[8:11], s61 offen sc1
    buffer_load_dwordx4 v[40:43], v106, s[8:11], s61 offen sc1
    buffer_load_dwordx4 v[44:47], v107, s[8:11], s61 offen sc1
L_far_184:
    s_waitcnt vmcnt(4)
    v_max3_u32 v246, v48, v52, v56
    v_max_u32 v246, v246, v60
    v_cmp_eq_u32 vcc, -1, v246
    s_cbranch_vccz L_gb_177
    buffer_load_dwordx4 v[48:51], v240, s[8:11], s50 offen sc1
    buffer_load_dwordx4 v[52:55], v105, s[8:11], s50 offen sc1
    buffer_load_dwordx4 v[56:59], v106, s[8:11], s50 offen sc1
    buffer_load_dwordx4 v[60:63], v107, s[8:11], s50 offen sc1
    s_waitcnt vmcnt(4)
    v_max3_u32 v246, v32, v36, v40
    v_max_u32 v246, v246, v44
    v_cmp_eq_u32 vcc, -1, v246
    s_add_u32 s96, s96, 1
    s_cbranch_vccz L_ga_178
    s_cmp_lt_u32 s96, 0x10000
    s_cbranch_scc1 L_gp_176
L_gb_177:
    v_dot2_f32_bf16 v68, v48, s65, v68
    v_dot2_f32_bf16 v69, v48, s66, v69
    v_dot2_f32_bf16 v70, v49, s65, v70
    v_dot2_f32_bf16 v71, v49, s66, v71
    v_dot2_f32_bf16 v72, v50, s65, v72
    v_dot2_f32_bf16 v73, v50, s66, v73
    v_dot2_f32_bf16 v74, v51, s65, v74
    v_dot2_f32_bf16 v75, v51, s66, v75
    v_dot2_f32_bf16 v68, v52, s65, v68
    v_dot2_f32_bf16 v69, v52, s66, v69
    v_dot2_f32_bf16 v70, v53, s65, v70
    v_dot2_f32_bf16 v71, v53, s66, v71
    v_dot2_f32_bf16 v72, v54, s65, v72
    v_dot2_f32_bf16 v73, v54, s66, v73
    v_dot2_f32_bf16 v74, v55, s65, v74
    v_dot2_f32_bf16 v75, v55, s66, v75
    v_dot2_f32_bf16 v68, v56, s65, v68
    v_dot2_f32_bf16 v69, v56, s66, v69
    v_dot2_f32_bf16 v70, v57, s65, v70
    v_dot2_f32_bf16 v71, v57, s66, v71
    v_dot2_f32_bf16 v72, v58, s65, v72
    v_dot2_f32_bf16 v73, v58, s66, v73
    v_dot2_f32_bf16 v74, v59, s65, v74
    v_dot2_f32_bf16 v75, v59, s66, v75
    v_dot2_f32_bf16 v68, v60, s65, v68
    v_dot2_f32_bf16 v69, v60, s66, v69
    v_dot2_f32_bf16 v70, v61, s65, v70
    v_dot2_f32_bf16 v71, v61, s66, v71
    v_dot2_f32_bf16 v72, v62, s65, v72
    v_dot2_f32_bf16 v73, v62, s66, v73
    v_dot2_f32_bf16 v74, v63, s65, v74
    v_dot2_f32_bf16 v75, v63, s66, v75
    s_cmp_lg_u32 s82, 0
    s_cbranch_scc1 L_gd_179
    s_waitcnt vmcnt(0)
L_ga_178:
    v_dot2_f32_bf16 v68, v32, s65, v68
    v_dot2_f32_bf16 v69, v32, s66, v69
    v_dot2_f32_bf16 v70, v33, s65, v70
    v_dot2_f32_bf16 v71, v33, s66, v71
    v_dot2_f32_bf16 v72, v34, s65, v72
    v_dot2_f32_bf16 v73, v34, s66, v73
    v_dot2_f32_bf16 v74, v35, s65, v74
    v_dot2_f32_bf16 v75, v35, s66, v75
    v_dot2_f32_bf16 v68, v36, s65, v68
    v_dot2_f32_bf16 v69, v36, s66, v69
    v_dot2_f32_bf16 v70, v37, s65, v70
    v_dot2_f32_bf16 v71, v37, s66, v71
    v_dot2_f32_bf16 v72, v38, s65, v72
    v_dot2_f32_bf16 v73, v38, s66, v73
    v_dot2_f32_bf16 v74, v39, s65, v74
    v_dot2_f32_bf16 v75, v39, s66, v75
    v_dot2_f32_bf16 v68, v40, s65, v68
    v_dot2_f32_bf16 v69, v40, s66, v69
    v_dot2_f32_bf16 v70, v41, s65, v70
    v_dot2_f32_bf16 v71, v41, s66, v71
    v_dot2_f32_bf16 v72, v42, s65, v72
    v_dot2_f32_bf16 v73, v42, s66, v73
    v_dot2_f32_bf16 v74, v43, s65, v74
    v_dot2_f32_bf16 v75, v43, s66, v75
    v_dot2_f32_bf16 v68, v44, s65, v68
    v_dot2_f32_bf16 v69, v44, s66, v69
    v_dot2_f32_bf16 v70, v45, s65, v70
    v_dot2_f32_bf16 v71, v45, s66, v71
    v_dot2_f32_bf16 v72, v46, s65, v72
    v_dot2_f32_bf16 v73, v46, s66, v73
    v_dot2_f32_bf16 v74, v47, s65, v74
    v_dot2_f32_bf16 v75, v47, s66, v75
L_gd_179:
    s_nop 2
    ds_write_b128 v109, v[68:71]
    ds_write_b128 v109, v[72:75] offset:1024
    s_cmp_lg_u32 s82, 0
    s_cselect_b32 s24, 3, 1
    s_and_b32 s24, s24, s100
    s_waitcnt lgkmcnt(0)
    s_barrier
    s_cbranch_scc1 L_nofin_175
    ds_read_b128 v[112:115], v109 offset:4096
    ds_read_b128 v[116:119], v109 offset:5120
    s_cmp_eq_u32 s82, 0
    s_cbranch_scc1 L_g1_180
    ds_read_b128 v[120:123], v109 offset:8192
    ds_read_b128 v[124:127], v109 offset:9216
    ds_read_b128 v[128:131], v109 offset:12288
    ds_read_b128 v[132:135], v109 offset:13312
    s_waitcnt lgkmcnt(0)
    v_pk_add_f32 v[120:121], v[120:121], v[128:129]
    v_pk_add_f32 v[122:123], v[122:123], v[130:131]
    v_pk_add_f32 v[124:125], v[124:125], v[132:133]
    v_pk_add_f32 v[126:127], v[126:127], v[134:135]
    v_pk_add_f32 v[112:113], v[112:113], v[120:121]
    v_pk_add_f32 v[114:115], v[114:115], v[122:123]
    v_pk_add_f32 v[116:117], v[116:117], v[124:125]
    v_pk_add_f32 v[118:119], v[118:119], v[126:127]
L_g1_180:
    s_waitcnt lgkmcnt(0)
    v_pk_add_f32 v[68:69], v[68:69], v[112:113]
    v_pk_add_f32 v[70:71], v[70:71], v[114:115]
    v_pk_add_f32 v[72:73], v[72:73], v[116:117]
    v_pk_add_f32 v[74:75], v[74:75], v[118:119]
    v_cvt_pk_bf16_f32 v0, v68, v69
    v_cvt_pk_bf16_f32 v1, v70, v71
    v_cvt_pk_bf16_f32 v2, v72, v73
    v_cvt_pk_bf16_f32 v3, v74, v75
    v_lshlrev_b32 v68, 16, v0
    v_and_b32 v69, 0xffff0000, v0
    v_lshlrev_b32 v76, 16, v96
    v_and_b32 v77, 0xffff0000, v96
    v_lshlrev_b32 v70, 16, v1
    v_and_b32 v71, 0xffff0000, v1
    v_lshlrev_b32 v78, 16, v97
    v_and_b32 v79, 0xffff0000, v97
    v_lshlrev_b32 v72, 16, v2
    v_and_b32 v73, 0xffff0000, v2
    v_lshlrev_b32 v80, 16, v98
    v_and_b32 v81, 0xffff0000, v98
    v_lshlrev_b32 v74, 16, v3
    v_and_b32 v75, 0xffff0000, v3
    v_lshlrev_b32 v82, 16, v99
    v_and_b32 v83, 0xffff0000, v99
    v_pk_add_f32 v[68:69], v[68:69], v[76:77]
    v_pk_add_f32 v[70:71], v[70:71], v[78:79]
    v_pk_add_f32 v[72:73], v[72:73], v[80:81]
    v_pk_add_f32 v[74:75], v[74:75], v[82:83]
    v_cvt_pk_bf16_f32 v4, v68, v69
    v_cvt_pk_bf16_f32 v5, v70, v71
    v_cvt_pk_bf16_f32 v6, v72, v73
    v_cvt_pk_bf16_f32 v7, v74, v75
    v_lshlrev_b32 v68, 16, v4
    v_and_b32 v69, 0xffff0000, v4
    v_lshlrev_b32 v70, 16, v5
    v_and_b32 v71, 0xffff0000, v5
    v_lshlrev_b32 v72, 16, v6
    v_and_b32 v73, 0xffff0000, v6
    v_lshlrev_b32 v74, 16, v7
    v_and_b32 v75, 0xffff0000, v7
    v_add_f32 v84, v68, v69
    v_add_f32 v84, v84, v70
    v_add_f32 v84, v84, v71
    v_add_f32 v84, v84, v72
    v_add_f32 v84, v84, v73
    v_add_f32 v84, v84, v74
    v_add_f32 v84, v84, v75
    s_nop 1
    v_add_f32_dpp v84, v84, v84 row_ror:1 row_mask:0xf bank_mask:0xf
    s_nop 1
    v_add_f32_dpp v84, v84, v84 row_ror:2 row_mask:0xf bank_mask:0xf
    s_nop 1
    v_add_f32_dpp v84, v84, v84 row_ror:4 row_mask:0xf bank_mask:0xf
    s_nop 1
    v_add_f32_dpp v84, v84, v84 row_ror:8 row_mask:0xf bank_mask:0xf
    v_mov_b32 v85, v84
    s_nop 1
    v_permlane32_swap_b32 v85, v84
    v_add_f32 v84, v85, v84
    v_mov_b32 v85, v84
    s_nop 1
    v_permlane16_swap_b32 v85, v84
    v_add_f32 v84, v85, v84
    v_mul_f32 v84, 0x3b000000, v84
    v_cvt_pk_bf16_f32 v86, v84, v84
    v_and_b32 v86, 0xffff0000, v86
    v_sub_f32 v87, v84, v86
    v_sub_f32 v76, v68, v86
    v_sub_f32 v77, v69, v86
    v_sub_f32 v78, v70, v86
    v_sub_f32 v79, v71, v86
    v_sub_f32 v80, v72, v86
    v_sub_f32 v81, v73, v86
    v_sub_f32 v82, v74, v86
    v_sub_f32 v83, v75, v86
    v_mul_f32 v100, v76, v76
    v_fmac_f32 v100, v77, v77
    v_fmac_f32 v100, v78, v78
    v_fmac_f32 v100, v79, v79
    v_fmac_f32 v100, v80, v80
    v_fmac_f32 v100, v81, v81
    v_fmac_f32 v100, v82, v82
    v_fmac_f32 v100, v83, v83
    s_nop 1
    v_add_f32_dpp v100, v100, v100 row_ror:1 row_mask:0xf bank_mask:0xf
    s_nop 1
    v_add_f32_dpp v100, v100, v100 row_ror:2 row_mask:0xf bank_mask:0xf
    s_nop 1
    v_add_f32_dpp v100, v100, v100 row_ror:4 row_mask:0xf bank_mask:0xf
    s_nop 1
    v_add_f32_dpp v100, v100, v100 row_ror:8 row_mask:0xf bank_mask:0xf
    v_mov_b32 v85, v100
    s_nop 1
    v_permlane32_swap_b32 v85, v100
    v_add_f32 v100, v85, v100
    v_mov_b32 v85, v100
    s_nop 1
    v_permlane16_swap_b32 v85, v100
    v_add_f32 v100, v85, v100
    v_mul_f32 v85, v87, v87
    v_mul_f32 v100, 0x3b000000, v100
    v_sub_f32 v100, v100, v85
    v_max_f32 v100, 0, v100
    v_cvt_pk_bf16_f32 v100, v100, v100
    v_and_b32 v100, 0xffff0000, v100
    v_add_f32 v100, 0x3727c5ac, v100
    v_cvt_pk_bf16_f32 v100, v100, v100
    v_and_b32 v100, 0xffff0000, v100
    v_sqrt_f32 v100, v100
    s_nop 0
    v_cvt_pk_bf16_f32 v100, v100, v100
    v_and_b32 v100, 0xffff0000, v100
    v_rcp_f32 v100, v100
    v_cvt_pk_bf16_f32 v8, v76, v77
    v_cvt_pk_bf16_f32 v9, v78, v79
    v_cvt_pk_bf16_f32 v10, v80, v81
    v_cvt_pk_bf16_f32 v11, v82, v83
    v_lshlrev_b32 v76, 16, v8
    v_and_b32 v77, 0xffff0000, v8
    v_lshlrev_b32 v78, 16, v9
    v_and_b32 v79, 0xffff0000, v9
    v_lshlrev_b32 v80, 16, v10
    v_and_b32 v81, 0xffff0000, v10
    v_lshlrev_b32 v82, 16, v11
    v_and_b32 v83, 0xffff0000, v11
    v_mul_f32 v76, v100, v76
    v_mul_f32 v77, v100, v77
    v_mul_f32 v78, v100, v78
    v_mul_f32 v79, v100, v79
    v_mul_f32 v80, v100, v80
    v_mul_f32 v81, v100, v81
    v_mul_f32 v82, v100, v82
    v_mul_f32 v83, v100, v83
    v_cvt_pk_bf16_f32 v8, v76, v77
    v_cvt_pk_bf16_f32 v9, v78, v79
    v_cvt_pk_bf16_f32 v10, v80, v81
    v_cvt_pk_bf16_f32 v11, v82, v83
    v_lshlrev_b32 v76, 16, v8
    v_and_b32 v77, 0xffff0000, v8
    v_lshlrev_b32 v78, 16, v9
    v_and_b32 v79, 0xffff0000, v9
    v_lshlrev_b32 v80, 16, v10
    v_and_b32 v81, 0xffff0000, v10
    v_lshlrev_b32 v82, 16, v11
    v_and_b32 v83, 0xffff0000, v11
    v_lshlrev_b32 v88, 16, v236
    v_and_b32 v89, 0xffff0000, v236
    v_lshlrev_b32 v90, 16, v237
    v_and_b32 v91, 0xffff0000, v237
    v_lshlrev_b32 v92, 16, v238
    v_and_b32 v93, 0xffff0000, v238
    v_lshlrev_b32 v94, 16, v239
    v_and_b32 v95, 0xffff0000, v239
    v_mul_f32 v84, v76, v88
    v_fmac_f32 v84, v77, v89
    v_fmac_f32 v84, v78, v90
    v_fmac_f32 v84, v79, v91
    v_fmac_f32 v84, v80, v92
    v_fmac_f32 v84, v81, v93
    v_fmac_f32 v84, v82, v94
    v_fmac_f32 v84, v83, v95
    s_nop 1
    v_add_f32_dpp v84, v84, v84 row_ror:1 row_mask:0xf bank_mask:0xf
    s_nop 1
    v_add_f32_dpp v84, v84, v84 row_ror:2 row_mask:0xf bank_mask:0xf
    s_nop 1
    v_add_f32_dpp v84, v84, v84 row_ror:4 row_mask:0xf bank_mask:0xf
    s_nop 1
    v_add_f32_dpp v84, v84, v84 row_ror:8 row_mask:0xf bank_mask:0xf
    v_mov_b32 v85, v84
    s_nop 1
    v_permlane32_swap_b32 v85, v84
    v_add_f32 v84, v85, v84
    v_mov_b32 v85, v84
    s_nop 1
    v_permlane16_swap_b32 v85, v84
    v_add_f32 v84, v85, v84
    v_cvt_pk_bf16_f32 v84, v84, v84
    v_and_b32 v84, 0xffff0000, v84
    v_ashrrev_i32 v85, 31, v84
    v_or_b32 v85, 0x80000000, v85
    v_xor_b32 v84, v84, v85
    v_and_b32 v84, 0xffff0000, v84
    s_sub_u32 s62, 0x87ff, s60
    v_or_b32 v84, s62, v84
    s_lshl_b32 s62, s60, 2
    s_mov_b64 exec, 1
    s_add_u32 s63, s62, 0x6f00
    s_lshl_b32 s96, s60, 7
    s_add_u32 s96, s96, 0xfffcb000
    s_cmp_ge_u32 s60, 1984
    s_cselect_b32 s63, s96, s63
    s_cmp_ge_u32 s60, 1792
    s_cselect_b32 s63, s63, 0x7ff00000
    buffer_store_dword v84, off, s[8:11], s63 sc1
    s_mov_b64 exec, -1
    v_pk_add_f32 v[68:69], v[68:69], v[76:77]
    v_pk_add_f32 v[70:71], v[70:71], v[78:79]
    v_pk_add_f32 v[72:73], v[72:73], v[80:81]
    v_pk_add_f32 v[74:75], v[74:75], v[82:83]
    v_cvt_pk_bf16_f32 v12, v68, v69
    v_cvt_pk_bf16_f32 v13, v70, v71
    v_cvt_pk_bf16_f32 v14, v72, v73
    v_cvt_pk_bf16_f32 v15, v74, v75
    buffer_store_dwordx4 v[12:15], v240, s[16:19], s64 offen sc1
    s_mov_b64 exec, 1
    v_cmp_ge_u32 vcc, v104, v84
    s_cselect_b32 s63, 1, 0
    s_and_b32 s63, s63, vcc_lo
    s_cbranch_scc1 L_nokey_185
    s_mov_b64 exec, -1
    s_add_u32 s63, s64, 0x6000000
    buffer_store_dwordx4 v[4:7], v240, s[8:11], s63 offen sc1
    s_add_u32 s63, s64, 0x6200000
    buffer_store_dwordx4 v[8:11], v240, s[8:11], s63 offen sc1
    s_mov_b64 exec, 1
    s_add_u32 s62, s62, 0x6000
    s_waitcnt vmcnt(0)
    buffer_store_dword v84, off, s[8:11], s62 sc1
L_nokey_185:
    s_mov_b64 exec, -1
L_nofin_175:
    s_add_u32 s80, s80, 4
    s_add_u32 s22, s22, s23
    s_sub_u32 s24, s22, 68
    s_cmp_lt_u32 s24, 2
    s_cselect_b32 s82, 2, 0
    s_cselect_b32 s24, 6, 0
    s_sub_u32 s22, s22, s24
    s_branch L_p2_seg
L_redo_141:
    v_mfma_f32_16x16x32_bf16 v[116:119], v[16:19], v[0:3], 0
    v_mfma_f32_16x16x32_bf16 v[116:119], v[20:23], v[4:7], v[116:119]
    v_mfma_f32_16x16x32_bf16 v[116:119], v[24:27], v[8:11], v[116:119]
    v_mfma_f32_16x16x32_bf16 v[116:119], v[28:31], v[12:15], v[116:119]
    v_mfma_f32_16x16x32_bf16 v[120:123], v[32:35], v[0:3], 0
    v_mfma_f32_16x16x32_bf16 v[120:123], v[36:39], v[4:7], v[120:123]
    v_mfma_f32_16x16x32_bf16 v[120:123], v[40:43], v[8:11], v[120:123]
    v_mfma_f32_16x16x32_bf16 v[120:123], v[44:47], v[12:15], v[120:123]
    v_mov_b32 v247, s53
    v_cndmask_b32 v116, v247, v116, s[30:31]
    v_cndmask_b32 v117, v247, v117, s[32:33]
    v_cndmask_b32 v118, v247, v118, s[34:35]
    v_cndmask_b32 v119, v247, v119, s[36:37]
    s_nop 2
    v_cndmask_b32 v120, v247, v120, s[38:39]
    v_cndmask_b32 v121, v247, v121, s[40:41]
    v_cndmask_b32 v122, v247, v122, s[42:43]
    v_cndmask_b32 v123, v247, v123, s[44:45]
    v_max3_f32 v246, v116, v117, v118
    v_max3_f32 v246, v246, v119, v120
    v_max3_f32 v246, v246, v121, v122
    v_max_f32 v246, v246, v123
    v_max3_f32 v246, v246, v112, v113
    v_mov_b32 v247, v246
    s_nop 1
    v_permlane32_swap_b32 v247, v246
    v_max_f32 v246, v247, v246
    v_mov_b32 v247, v246
    s_nop 1
    v_permlane16_swap_b32 v247, v246
    v_max_f32 v246, v247, v246
    v_mul_f32 v248, s28, v246
    v_pk_fma_f32 v[116:117], v[116:117], s[28:29], v[248:249] op_sel_hi:[1,1,0] neg_lo:[0,0,1] neg_hi:[0,0,1]
    v_pk_fma_f32 v[118:119], v[118:119], s[28:29], v[248:249] op_sel_hi:[1,1,0] neg_lo:[0,0,1] neg_hi:[0,0,1]
    v_pk_fma_f32 v[120:121], v[120:121], s[28:29], v[248:249] op_sel_hi:[1,1,0] neg_lo:[0,0,1] neg_hi:[0,0,1]
    v_pk_fma_f32 v[122:123], v[122:123], s[28:29], v[248:249] op_sel_hi:[1,1,0] neg_lo:[0,0,1] neg_hi:[0,0,1]
    v_exp_f32 v116, v116
    v_exp_f32 v117, v117
    v_exp_f32 v118, v118
    v_exp_f32 v119, v119
    v_exp_f32 v120, v120
    v_exp_f32 v121, v121
    v_exp_f32 v122, v122
    v_exp_f32 v123, v123
    v_cvt_pk_bf16_f32 v124, v116, v117
    v_cvt_pk_bf16_f32 v125, v118, v119
    v_cvt_pk_bf16_f32 v126, v120, v121
    v_cvt_pk_bf16_f32 v127, v122, v123
    v_mov_b32 v129, 0
    s_nop 0
    v_mfma_f32_16x16x32_bf16 v[132:135], v[136:139], v[124:127], 0
    v_mfma_f32_16x16x32_bf16 v[140:143], v[64:67], v[124:127], 0
    v_mfma_f32_16x16x32_bf16 v[144:147], v[68:71], v[124:127], 0
    v_mfma_f32_16x16x32_bf16 v[148:151], v[72:75], v[124:127], 0
    v_mfma_f32_16x16x32_bf16 v[152:155], v[76:79], v[124:127], 0
    v_mfma_f32_16x16x32_bf16 v[156:159], v[80:83], v[124:127], 0
    v_mfma_f32_16x16x32_bf16 v[160:163], v[84:87], v[124:127], 0
    v_mfma_f32_16x16x32_bf16 v[164:167], v[88:91], v[124:127], 0
    v_mfma_f32_16x16x32_bf16 v[168:171], v[92:95], v[124:127], 0
    v_pk_fma_f32 v[114:115], v[112:113], s[28:29], v[248:249] op_sel_hi:[1,1,0] neg_lo:[0,0,1] neg_hi:[0,0,1]
    s_nop 6
    s_branch L_redone_142
L_p2_end:
    s_cmp_ge_u32 s67, 56
    s_cbranch_scc1 L_exit
    s_mov_b32 s74, 0
    s_mov_b32 s75, 0
    v_mov_b32 v202, 0x7ffffff0
    v_mbcnt_lo_u32_b32 v0, -1, 0
    v_mbcnt_hi_u32_b32 v0, -1, v0
    s_lshl_b32 s96, s100, 6
    v_add_u32 v0, s96, v0
    v_lshlrev_b32 v1, 6, v0
    s_getpc_b64 s[70:71]
L_pc_186:
    s_add_u32 s70, s70, L_ffn_round-L_pc_186
    s_addc_u32 s71, s71, 0
    v_min_u32 v1, L_code_end-L_ffn_round-4, v1
    global_load_dword v3, v1, s[70:71]
    v_mov_b32 v1, 0
    s_and_b32 s71, s101, 15
    s_lshl_b32 s71, s71, 7
    s_add_u32 s71, s71, 0x1000
    s_mov_b32 s72, 57
    s_cmp_lg_u32 s100, 0
    s_cbranch_scc1 L_polls_189
    s_mov_b32 exec_lo, 0x1
    s_mov_b32 exec_hi, 0
    s_mov_b32 s96, 0
L_poll_187:
    buffer_load_dword v2, v1, s[8:11], s71 offen sc1
    s_waitcnt vmcnt(0)
    v_cmp_gt_u32 vcc, s72, v2
    s_cbranch_vccz L_polld_188
    v_readfirstlane_b32 s97, v2
    s_nop 0
    s_sub_u32 s97, s72, s97
    s_cmp_lt_i32 s97, 3
    s_cbranch_scc1 L_near_190
    s_sleep 40
    s_cmp_lt_i32 s97, 5
    s_cbranch_scc1 L_near_190
    s_sleep 100
L_near_190:
    s_sleep 16
    s_add_u32 s96, s96, 1
    s_cmp_lt_u32 s96, 0x10000
    s_cbranch_scc1 L_poll_187
L_polld_188:
    s_mov_b64 exec, -1
L_polls_189:
    s_barrier
L_ffn_round:
    v_mbcnt_lo_u32_b32 v0, -1, 0
    v_mbcnt_hi_u32_b32 v0, -1, v0
    s_lshl_b32 s96, s100, 6
    v_add_u32 v0, s96, v0
    s_cmp_lg_u32 s75, 0
    s_cbranch_scc1 L_ffn_re
    v_lshlrev_b32 v30, 5, v0
    s_mov_b32 s69, 0x6000
    v_cmp_le_u32 vcc, 224, v0
    v_mov_b32 v29, s75
    v_add_u32 v29, -1, v29
    v_cndmask_b32 v19, 0, v29, vcc
    s_mov_b32 s70, 0
L_kpoll_191:
    buffer_load_dwordx4 v[20:23], v30, s[8:11], s69 offen sc1
    buffer_load_dwordx4 v[24:27], v30, s[8:11], s69 offen offset:16 sc1
    s_waitcnt vmcnt(0)
    v_min3_u32 v28, v20, v21, v22
    v_min3_u32 v28, v28, v23, v24
    v_min3_u32 v28, v28, v25, v26
    v_min_u32 v28, v28, v27
    v_or_b32 v28, v28, v19
    v_cmp_eq_u32 vcc, 0, v28
    s_cbranch_vccz L_kpolld_192
    s_sleep 6
    s_add_u32 s70, s70, 1
    s_cmp_lt_u32 s70, 0x10000
    s_cbranch_scc1 L_kpoll_191
L_kpolld_192:
    v_bfi_b32 v20, v19, 0, v20
    v_bfi_b32 v21, v19, 0, v21
    v_bfi_b32 v22, v19, 0, v22
    v_bfi_b32 v23, v19, 0, v23
    v_bfi_b32 v24, v19, 0, v24
    v_bfi_b32 v25, v19, 0, v25
    v_bfi_b32 v26, v19, 0, v26
    v_bfi_b32 v27, v19, 0, v27
    v_lshrrev_b32 v30, 6, v0
    v_lshlrev_b32 v30, 2, v30
    v_add_u32 v30, 0x20400, v30
    v_mov_b32 v31, 0x20400
    s_waitcnt vmcnt(0)
    v_max3_u32 v28, v20, v21, v22
    v_max3_u32 v28, v28, v23, v24
    v_max3_u32 v28, v28, v25, v26
    v_max_u32 v28, v28, v27
    s_nop 1
    v_max_u32_dpp v28, v28, v28 row_ror:1 row_mask:0xf bank_mask:0xf
    s_nop 1
    v_max_u32_dpp v28, v28, v28 row_ror:2 row_mask:0xf bank_mask:0xf
    s_nop 1
    v_max_u32_dpp v28, v28, v28 row_ror:4 row_mask:0xf bank_mask:0xf
    s_nop 1
    v_max_u32_dpp v28, v28, v28 row_ror:8 row_mask:0xf bank_mask:0xf
    v_mov_b32 v29, v28
    s_nop 1
    v_permlane32_swap_b32 v29, v28
    v_max_u32 v28, v29, v28
    v_mov_b32 v29, v28
    s_nop 1
    v_permlane16_swap_b32 v29, v28
    v_max_u32 v28, v29, v28
    ds_write_b32 v30, v28
    s_waitcnt lgkmcnt(0)
    s_barrier
    ds_read_b128 v[16:19], v31
    s_waitcnt lgkmcnt(0)
    v_max3_u32 v28, v16, v17, v18
    v_max_u32 v28, v28, v19
    s_nop 0
    v_readfirstlane_b32 s69, v28
    s_nop 1
    v_cmp_ne_u32 vcc, s69, v20
    s_nop 1
    v_cndmask_b32 v20, 0, v20, vcc
    v_cmp_ne_u32 vcc, s69, v21
    s_nop 1
    v_cndmask_b32 v21, 0, v21, vcc
    v_cmp_ne_u32 vcc, s69, v22
    s_nop 1
    v_cndmask_b32 v22, 0, v22, vcc
    v_cmp_ne_u32 vcc, s69, v23
    s_nop 1
    v_cndmask_b32 v23, 0, v23, vcc
    v_cmp_ne_u32 vcc, s69, v24
    s_nop 1
    v_cndmask_b32 v24, 0, v24, vcc
    v_cmp_ne_u32 vcc, s69, v25
    s_nop 1
    v_cndmask_b32 v25, 0, v25, vcc
    v_cmp_ne_u32 vcc, s69, v26
    s_nop 1
    v_cndmask_b32 v26, 0, v26, vcc
    v_cmp_ne_u32 vcc, s69, v27
    s_nop 1
    v_cndmask_b32 v27, 0, v27, vcc
    v_max3_u32 v28, v20, v21, v22
    v_max3_u32 v28, v28, v23, v24
    v_max3_u32 v28, v28, v25, v26
    v_max_u32 v28, v28, v27
    s_nop 1
    v_max_u32_dpp v28, v28, v28 row_ror:1 row_mask:0xf bank_mask:0xf
    s_nop 1
    v_max_u32_dpp v28, v28, v28 row_ror:2 row_mask:0xf bank_mask:0xf
    s_nop 1
    v_max_u32_dpp v28, v28, v28 row_ror:4 row_mask:0xf bank_mask:0xf
    s_nop 1
    v_max_u32_dpp v28, v28, v28 row_ror:8 row_mask:0xf bank_mask:0xf
    v_mov_b32 v29, v28
    s_nop 1
    v_permlane32_swap_b32 v29, v28
    v_max_u32 v28, v29, v28
    v_mov_b32 v29, v28
    s_nop 1
    v_permlane16_swap_b32 v29, v28
    v_max_u32 v28, v29, v28
    ds_write_b32 v30, v28 offset:16
    s_waitcnt lgkmcnt(0)
    s_barrier
    ds_read_b128 v[16:19], v31 offset:16
    s_waitcnt lgkmcnt(0)
    v_max3_u32 v28, v16, v17, v18
    v_max_u32 v28, v28, v19
    s_nop 0
    v_readfirstlane_b32 s70, v28
    s_barrier
    s_cmp_lg_u32 s67, 55
    s_cbranch_scc1 L_ffn_sel
    s_mov_b32 s71, 0x8f00
    s_cmp_lg_u32 s100, 0
    s_cbranch_scc1 L_flag_193
    v_mov_b32 v2, s70
    s_mov_b64 exec, 1
    buffer_store_dword v2, off, s[8:11], s71 sc1
    s_mov_b64 exec, -1
L_flag_193:
    s_branch L_ffn_sel
L_ffn_re:
    v_mul_u32_u24 v30, 12, v0
    v_lshlrev_b32 v31, 7, v0
    v_add_u32 v31, 0x500, v31
    v_mov_b32 v29, 0x20400
    s_cmp_lg_u32 s100, 0
    s_cbranch_scc1 L_rselw_197
    s_mov_b32 s71, 0x8b00
    s_mov_b32 s72, 0
L_rsel_194:
    buffer_load_dword v23, v31, s[8:11], s71 offen sc1
    buffer_load_dwordx3 v[20:22], v30, s[8:11], s71 offen sc1
    s_waitcnt vmcnt(0)
    v_min3_u32 v28, v20, v21, v22
    v_min_u32 v28, v28, v23
    v_cmp_eq_u32 vcc, 0, v28
    s_cbranch_vccz L_rseld_195
    s_sleep 1
    s_add_u32 s72, s72, 1
    s_cmp_lt_u32 s72, 0x10000
    s_cbranch_scc1 L_rsel_194
L_rseld_195:
    v_max3_u32 v28, v20, v21, v22
    v_max_u32 v28, v28, v23
    v_cmp_lt_u32 vcc, s70, v28
    s_cbranch_vccz L_rsele_196
    s_mov_b32 s71, 0x7c00
    v_lshlrev_b32 v31, 2, v0
    v_add_u32 v31, 768, v31
L_rack_198:
    buffer_load_dword v27, v31, s[8:11], s71 offen sc1
    buffer_load_dwordx3 v[24:26], v30, s[8:11], s71 offen sc1
    s_add_u32 s72, s72, 1
    s_waitcnt vmcnt(0)
    v_sub_u32 v24, v20, v24
    v_sub_u32 v25, v21, v25
    v_sub_u32 v26, v22, v26
    v_sub_u32 v27, v23, v27
    v_max3_u32 v28, v24, v25, v26
    v_max_u32 v28, v28, v27
    v_cmp_lt_u32 vcc, s70, v28
    s_cbranch_vccz L_rackd_199
    s_cmp_lt_u32 s72, 0x10000
    s_cbranch_scc1 L_rack_198
L_rackd_199:
    v_max3_u32 v28, v20, v21, v22
    v_max_u32 v28, v28, v23
    s_nop 1
    v_max_u32_dpp v28, v28, v28 row_ror:1 row_mask:0xf bank_mask:0xf
    s_nop 1
    v_max_u32_dpp v28, v28, v28 row_ror:2 row_mask:0xf bank_mask:0xf
    s_nop 1
    v_max_u32_dpp v28, v28, v28 row_ror:4 row_mask:0xf bank_mask:0xf
    s_nop 1
    v_max_u32_dpp v28, v28, v28 row_ror:8 row_mask:0xf bank_mask:0xf
    v_mov_b32 v29, v28
    s_nop 1
    v_permlane32_swap_b32 v29, v28
    v_max_u32 v28, v29, v28
    v_mov_b32 v29, v28
    s_nop 1
    v_permlane16_swap_b32 v29, v28
    v_max_u32 v28, v29, v28
    s_nop 0
    v_readfirstlane_b32 s71, v28
    s_nop 1
    v_cmp_ne_u32 vcc, s71, v20
    s_nop 1
    v_cndmask_b32 v20, 0, v20, vcc
    v_cmp_ne_u32 vcc, s71, v21
    s_nop 1
    v_cndmask_b32 v21, 0, v21, vcc
    v_cmp_ne_u32 vcc, s71, v22
    s_nop 1
    v_cndmask_b32 v22, 0, v22, vcc
    v_cmp_ne_u32 vcc, s71, v23
    s_nop 1
    v_cndmask_b32 v23, 0, v23, vcc
    v_max3_u32 v28, v20, v21, v22
    v_max_u32 v28, v28, v23
    s_nop 1
    v_max_u32_dpp v28, v28, v28 row_ror:1 row_mask:0xf bank_mask:0xf
    s_nop 1
    v_max_u32_dpp v28, v28, v28 row_ror:2 row_mask:0xf bank_mask:0xf
    s_nop 1
    v_max_u32_dpp v28, v28, v28 row_ror:4 row_mask:0xf bank_mask:0xf
    s_nop 1
    v_max_u32_dpp v28, v28, v28 row_ror:8 row_mask:0xf bank_mask:0xf
    v_mov_b32 v29, v28
    s_nop 1
    v_permlane32_swap_b32 v29, v28
    v_max_u32 v28, v29, v28
    v_mov_b32 v29, v28
    s_nop 1
    v_permlane16_swap_b32 v29, v28
    v_max_u32 v28, v29, v28
    s_nop 0
    v_readfirstlane_b32 s72, v28
    s_nop 0
    s_max_u32 s70, s70, s72
    s_min_u32 s72, s71, s69
    s_max_u32 s70, s70, s72
    s_max_u32 s69, s69, s71
    v_mov_b32 v29, 0x20400
L_rsele_196:
    v_mov_b32 v20, s69
    v_mov_b32 v21, s70
    ds_write_b64 v29, v[20:21]
    s_waitcnt lgkmcnt(0)
L_rselw_197:
    s_barrier
    ds_read_b64 v[20:21], v29
    s_waitcnt lgkmcnt(0)
    v_readfirstlane_b32 s69, v20
    v_readfirstlane_b32 s70, v21
    s_nop 3
L_ffn_sel:
    s_and_b32 s71, s69, 2047
    s_lshl_b32 s71, s71, 11
    s_and_b32 s72, s70, 2047
    s_or_b32 s71, s71, s72
    s_add_u32 s71, s71, 1
    s_cmp_eq_u32 s71, s74
    s_cbranch_scc1 L_ffn_same
    s_mov_b32 s74, s71
    s_mov_b32 exec_lo, 0xff
    s_mov_b32 exec_hi, 0
    buffer_store_dwordx2 v[204:205], v202, s[16:19], 0 offen sc1
    s_mov_b64 exec, -1
    v_and_b32 v1, 63, v0
    v_lshrrev_b32 v2, 4, v1
    v_and_b32 v3, 15, v1
    v_lshrrev_b32 v6, 2, v3
    s_and_b32 s71, s69, 2047
    s_sub_u32 s71, 2047, s71
    s_and_b32 s72, s70, 2047
    s_sub_u32 s72, 2047, s72
    v_and_b32 v4, 1, v3
    v_cmp_eq_u32 vcc, 0, v4
    v_mov_b32 v4, s71
    v_mov_b32 v5, s72
    v_cndmask_b32 v4, v5, v4, vcc
    v_lshlrev_b32 v4, 10, v4
    v_lshl_add_u32 v4, v2, 4, v4
    s_mov_b32 s71, 0x6200000
    buffer_load_dwordx4 v[32:35], v4, s[8:11], s71 offen
    buffer_load_dwordx4 v[36:39], v4, s[8:11], s71 offen offset:64
    buffer_load_dwordx4 v[40:43], v4, s[8:11], s71 offen offset:128
    buffer_load_dwordx4 v[44:47], v4, s[8:11], s71 offen offset:192
    buffer_load_dwordx4 v[48:51], v4, s[8:11], s71 offen offset:256
    buffer_load_dwordx4 v[52:55], v4, s[8:11], s71 offen offset:320
    buffer_load_dwordx4 v[56:59], v4, s[8:11], s71 offen offset:384
    buffer_load_dwordx4 v[60:63], v4, s[8:11], s71 offen offset:448
    buffer_load_dwordx4 v[64:67], v4, s[8:11], s71 offen offset:512
    buffer_load_dwordx4 v[68:71], v4, s[8:11], s71 offen offset:576
    buffer_load_dwordx4 v[72:75], v4, s[8:11], s71 offen offset:640
    buffer_load_dwordx4 v[76:79], v4, s[8:11], s71 offen offset:704
    buffer_load_dwordx4 v[80:83], v4, s[8:11], s71 offen offset:768
    buffer_load_dwordx4 v[84:87], v4, s[8:11], s71 offen offset:832
    buffer_load_dwordx4 v[88:91], v4, s[8:11], s71 offen offset:896
    buffer_load_dwordx4 v[92:95], v4, s[8:11], s71 offen offset:960
    v_lshl_add_u32 v4, v2, 3, v6
    v_lshlrev_b32 v4, 6, v4
    v_and_b32 v5, 3, v3
    v_lshl_add_u32 v4, v5, 3, v4
    s_lshr_b32 s71, s68, 1
    s_lshl_b32 s71, s71, 15
    s_and_b32 s72, s68, 1
    s_lshl_b32 s72, s72, 5
    s_add_u32 s71, s71, s72
    s_add_u32 s71, s71, 0x8000
    v_add_u32 v7, s71, v4
    ds_read_b64_tr_b16 v[96:97], v7
    ds_read_b64_tr_b16 v[98:99], v7 offset:256
    ds_read_b64_tr_b16 v[100:101], v7 offset:2048
    ds_read_b64_tr_b16 v[102:103], v7 offset:2304
    ds_read_b64_tr_b16 v[104:105], v7 offset:4096
    ds_read_b64_tr_b16 v[106:107], v7 offset:4352
    ds_read_b64_tr_b16 v[108:109], v7 offset:6144
    ds_read_b64_tr_b16 v[110:111], v7 offset:6400
    s_waitcnt lgkmcnt(0)
    ds_read_b64_tr_b16 v[112:113], v7 offset:8192
    ds_read_b64_tr_b16 v[114:115], v7 offset:8448
    ds_read_b64_tr_b16 v[116:117], v7 offset:10240
    ds_read_b64_tr_b16 v[118:119], v7 offset:10496
    ds_read_b64_tr_b16 v[120:121], v7 offset:12288
    ds_read_b64_tr_b16 v[122:123], v7 offset:12544
    ds_read_b64_tr_b16 v[124:125], v7 offset:14336
    ds_read_b64_tr_b16 v[126:127], v7 offset:14592
    s_waitcnt lgkmcnt(0)
    ds_read_b64_tr_b16 v[128:129], v7 offset:16384
    ds_read_b64_tr_b16 v[130:131], v7 offset:16640
    ds_read_b64_tr_b16 v[132:133], v7 offset:18432
    ds_read_b64_tr_b16 v[134:135], v7 offset:18688
    ds_read_b64_tr_b16 v[136:137], v7 offset:20480
    ds_read_b64_tr_b16 v[138:139], v7 offset:20736
    ds_read_b64_tr_b16 v[140:141], v7 offset:22528
    ds_read_b64_tr_b16 v[142:143], v7 offset:22784
    s_waitcnt lgkmcnt(0)
    ds_read_b64_tr_b16 v[144:145], v7 offset:24576
    ds_read_b64_tr_b16 v[146:147], v7 offset:24832
    ds_read_b64_tr_b16 v[148:149], v7 offset:26624
    ds_read_b64_tr_b16 v[150:151], v7 offset:26880
    ds_read_b64_tr_b16 v[152:153], v7 offset:28672
    ds_read_b64_tr_b16 v[154:155], v7 offset:28928
    ds_read_b64_tr_b16 v[156:157], v7 offset:30720
    ds_read_b64_tr_b16 v[158:159], v7 offset:30976
    s_waitcnt lgkmcnt(0)
    s_waitcnt vmcnt(0)
    v_mfma_f32_16x16x32_bf16 v[8:11], v[32:35], v[96:99], 0
    v_mfma_f32_16x16x32_bf16 v[8:11], v[36:39], v[100:103], v[8:11]
    v_mfma_f32_16x16x32_bf16 v[8:11], v[40:43], v[104:107], v[8:11]
    v_mfma_f32_16x16x32_bf16 v[8:11], v[44:47], v[108:111], v[8:11]
    v_mfma_f32_16x16x32_bf16 v[8:11], v[48:51], v[112:115], v[8:11]
    v_mfma_f32_16x16x32_bf16 v[8:11], v[52:55], v[116:119], v[8:11]
    v_mfma_f32_16x16x32_bf16 v[8:11], v[56:59], v[120:123], v[8:11]
    v_mfma_f32_16x16x32_bf16 v[8:11], v[60:63], v[124:127], v[8:11]
    v_mfma_f32_16x16x32_bf16 v[8:11], v[64:67], v[128:131], v[8:11]
    v_mfma_f32_16x16x32_bf16 v[8:11], v[68:71], v[132:135], v[8:11]
    v_mfma_f32_16x16x32_bf16 v[8:11], v[72:75], v[136:139], v[8:11]
    v_mfma_f32_16x16x32_bf16 v[8:11], v[76:79], v[140:143], v[8:11]
    v_mfma_f32_16x16x32_bf16 v[8:11], v[80:83], v[144:147], v[8:11]
    v_mfma_f32_16x16x32_bf16 v[8:11], v[84:87], v[148:151], v[8:11]
    v_mfma_f32_16x16x32_bf16 v[8:11], v[88:91], v[152:155], v[8:11]
    v_mfma_f32_16x16x32_bf16 v[8:11], v[92:95], v[156:159], v[8:11]
    s_nop 7
    v_cvt_pk_bf16_f32 v8, v8, v8
    v_and_b32 v8, 0xffff0000, v8
    v_cvt_pk_bf16_f32 v9, v9, v9
    v_and_b32 v9, 0xffff0000, v9
    s_cmp_ge_u32 s68, 2
    s_cbranch_scc1 L_ffn_up_200
    v_mul_f32 v13, 0xbfb8aa3b, v8
    v_exp_f32 v13, v13
    s_nop 0
    v_add_f32 v13, 1.0, v13
    v_rcp_f32 v12, v13
    s_nop 0
    v_mul_f32 v8, v12, v8
    v_cvt_pk_bf16_f32 v8, v8, v8
    v_and_b32 v8, 0xffff0000, v8
    v_mul_f32 v13, 0xbfb8aa3b, v9
    v_exp_f32 v13, v13
    s_nop 0
    v_add_f32 v13, 1.0, v13
    v_rcp_f32 v12, v13
    s_nop 0
    v_mul_f32 v9, v12, v9
    v_cvt_pk_bf16_f32 v9, v9, v9
    v_and_b32 v9, 0xffff0000, v9
    s_nop 4
L_ffn_up_200:
    s_lshr_b32 s71, s68, 1
    s_lshl_b32 s71, s71, 8
    s_and_b32 s72, s68, 1
    s_lshl_b32 s72, s72, 6
    s_add_u32 s71, s71, s72
    s_add_u32 s71, s71, 0x20000
    v_lshlrev_b32 v4, 2, v3
    v_add_u32 v4, s71, v4
    ds_write_b32 v4, v8
    ds_write_b32 v4, v9 offset:128
    s_waitcnt lgkmcnt(0)
    s_barrier
    v_and_b32 v4, 1, v3
    v_lshlrev_b32 v4, 7, v4
    v_lshl_add_u32 v4, v2, 5, v4
    v_add_u32 v4, 0x20000, v4
    ds_read_b128 v[32:35], v4
    ds_read_b128 v[36:39], v4 offset:16
    ds_read_b128 v[40:43], v4 offset:256
    ds_read_b128 v[44:47], v4 offset:272
    v_lshl_add_u32 v5, v2, 3, v6
    v_lshlrev_b32 v5, 10, v5
    v_and_b32 v7, 3, v3
    v_lshl_add_u32 v5, v7, 3, v5
    s_lshl_b32 s71, s68, 8
    s_add_u32 s71, s71, 0x18000
    v_add_u32 v7, s71, v5
    s_waitcnt lgkmcnt(0)
    ds_read_b64_tr_b16 v[96:97], v7
    ds_read_b64_tr_b16 v[98:99], v7 offset:4096
    ds_read_b64_tr_b16 v[100:101], v7 offset:32
    ds_read_b64_tr_b16 v[102:103], v7 offset:4128
    ds_read_b64_tr_b16 v[104:105], v7 offset:64
    ds_read_b64_tr_b16 v[106:107], v7 offset:4160
    ds_read_b64_tr_b16 v[108:109], v7 offset:96
    ds_read_b64_tr_b16 v[110:111], v7 offset:4192
    s_waitcnt lgkmcnt(0)
    ds_read_b64_tr_b16 v[112:113], v7 offset:128
    ds_read_b64_tr_b16 v[114:115], v7 offset:4224
    ds_read_b64_tr_b16 v[116:117], v7 offset:160
    ds_read_b64_tr_b16 v[118:119], v7 offset:4256
    ds_read_b64_tr_b16 v[120:121], v7 offset:192
    ds_read_b64_tr_b16 v[122:123], v7 offset:4288
    ds_read_b64_tr_b16 v[124:125], v7 offset:224
    ds_read_b64_tr_b16 v[126:127], v7 offset:4320
    v_mul_f32 v32, v32, v40
    v_mul_f32 v33, v33, v41
    v_mul_f32 v34, v34, v42
    v_mul_f32 v35, v35, v43
    v_mul_f32 v36, v36, v44
    v_mul_f32 v37, v37, v45
    v_mul_f32 v38, v38, v46
    v_mul_f32 v39, v39, v47
    v_cvt_pk_bf16_f32 v48, v32, v33
    v_cvt_pk_bf16_f32 v49, v34, v35
    v_cvt_pk_bf16_f32 v50, v36, v37
    v_cvt_pk_bf16_f32 v51, v38, v39
    s_waitcnt lgkmcnt(0)
    s_nop 0
    v_mfma_f32_16x16x32_bf16 v[56:59], v[48:51], v[96:99], 0
    v_mfma_f32_16x16x32_bf16 v[60:63], v[48:51], v[100:103], 0
    v_mfma_f32_16x16x32_bf16 v[64:67], v[48:51], v[104:107], 0
    v_mfma_f32_16x16x32_bf16 v[68:71], v[48:51], v[108:111], 0
    v_mfma_f32_16x16x32_bf16 v[72:75], v[48:51], v[112:115], 0
    v_mfma_f32_16x16x32_bf16 v[76:79], v[48:51], v[116:119], 0
    v_mfma_f32_16x16x32_bf16 v[80:83], v[48:51], v[120:123], 0
    v_mfma_f32_16x16x32_bf16 v[84:87], v[48:51], v[124:127], 0
    v_cmp_eq_u32 vcc, 0, v2
    v_lshlrev_b32 v4, 11, v2
    v_lshl_add_u32 v4, v3, 2, v4
    s_lshl_b32 s71, s67, 12
    s_lshl_b32 s72, s68, 9
    s_add_u32 s71, s71, s72
    s_add_u32 s71, s71, 0x6410000
    v_cndmask_b32 v56, v57, v56, vcc
    v_cndmask_b32 v60, v61, v60, vcc
    v_cndmask_b32 v64, v65, v64, vcc
    v_cndmask_b32 v68, v69, v68, vcc
    v_cndmask_b32 v72, v73, v72, vcc
    v_cndmask_b32 v76, v77, v76, vcc
    v_cndmask_b32 v80, v81, v80, vcc
    v_cndmask_b32 v84, v85, v84, vcc
    s_mov_b32 exec_hi, 0
    buffer_store_dword v56, v4, s[8:11], s71 offen sc1
    buffer_store_dword v60, v4, s[8:11], s71 offen offset:64 sc1
    buffer_store_dword v64, v4, s[8:11], s71 offen offset:128 sc1
    buffer_store_dword v68, v4, s[8:11], s71 offen offset:192 sc1
    buffer_store_dword v72, v4, s[8:11], s71 offen offset:256 sc1
    buffer_store_dword v76, v4, s[8:11], s71 offen offset:320 sc1
    buffer_store_dword v80, v4, s[8:11], s71 offen offset:384 sc1
    buffer_store_dword v84, v4, s[8:11], s71 offen offset:448 sc1
    s_mov_b64 exec, -1
    s_waitcnt vmcnt(0)
    s_barrier
    s_lshl_b32 s71, s67, 2
    s_lshl_b32 s72, s75, 8
    s_add_u32 s71, s71, s72
    s_add_u32 s71, s71, 0x8000
    s_cmp_lg_u32 s100, 0
    s_cbranch_scc1 L_flag_201
    v_mov_b32 v2, s74
    s_mov_b64 exec, 1
    buffer_store_dword v2, off, s[8:11], s71 sc1
    s_mov_b64 exec, -1
L_flag_201:
    s_cmp_ge_u32 s67, 8
    s_cbranch_scc1 L_ffn_same
    s_load_dwordx2 s[16:17], s[0:1], 96
    s_waitcnt lgkmcnt(0)
    s_and_b32 s17, s17, 0xffff
    s_mov_b32 s18, 0x200000
    s_mov_b32 s19, 0x20000
    v_and_b32 v3, 63, v0
    s_cmp_lt_u32 s100, 2
    s_cselect_b32 s71, s69, s70
    v_mov_b32 v5, s71
    s_and_b32 s71, s71, 2047
    s_sub_u32 s71, 2047, s71
    s_lshl_b32 s71, s71, 10
    s_lshl_b32 s72, s67, 1
    s_and_b32 s96, s100, 1
    s_add_u32 s72, s72, s96
    s_lshl_b32 s96, s72, 6
    s_add_u32 s71, s71, s96
    v_and_b32 v4, 7, v3
    v_lshlrev_b32 v6, 3, v4
    v_add_u32 v6, s71, v6
    v_lshrrev_b32 v7, 3, v3
    v_lshlrev_b32 v7, 12, v7
    v_lshl_add_u32 v7, v4, 4, v7
    s_lshl_b32 s72, s72, 7
    s_lshr_b32 s96, s100, 1
    s_lshl_b32 s96, s96, 11
    s_add_u32 s72, s72, s96
    v_add_u32 v7, s72, v7
    s_mov_b32 s71, 0x6000000
    s_mov_b32 s72, 0x6200000
    buffer_load_dwordx2 v[8:9], v6, s[8:11], s71 offen sc1
    buffer_load_dwordx2 v[10:11], v6, s[8:11], s72 offen sc1
    v_and_b32 v5, 0xffff0000, v5
    v_ashrrev_i32 v4, 31, v5
    v_not_b32 v4, v4
    v_or_b32 v4, 0x80000000, v4
    v_xor_b32 v5, v5, v4
    v_and_b32 v5, 0xffff0000, v5
    v_mul_f32 v23, 0xbfb8aa3b, v5
    v_exp_f32 v23, v23
    s_nop 0
    v_add_f32 v23, 1.0, v23
    v_rcp_f32 v22, v23
    s_nop 0
    v_cvt_pk_bf16_f32 v22, v22, v22
    v_and_b32 v22, 0xffff0000, v22
    v_lshlrev_b32 v1, 2, v0
    s_lshl_b32 s71, s75, 8
    s_add_u32 s71, s71, 0x8000
    s_cmp_lg_u32 s100, 0
    s_cbranch_scc1 L_polls_204
    s_mov_b32 exec_hi, 0xffffff
    s_mov_b32 s96, 0
L_poll_202:
    buffer_load_dword v2, v1, s[8:11], s71 offen sc1
    s_waitcnt vmcnt(0)
    v_cmp_ne_u32 vcc, s74, v2
    s_cbranch_vccz L_polld_203
    s_sleep 2
    s_add_u32 s96, s96, 1
    s_cmp_lt_u32 s96, 0x10000
    s_cbranch_scc1 L_poll_202
L_polld_203:
    s_mov_b64 exec, -1
L_polls_204:
    s_barrier
    s_mov_b32 s71, 0x6410000
    buffer_load_dwordx4 v[32:35], v7, s[8:11], s71 offen sc1
    s_add_u32 s71, s71, 32768
    buffer_load_dwordx4 v[36:39], v7, s[8:11], s71 offen sc1
    s_add_u32 s71, s71, 32768
    buffer_load_dwordx4 v[40:43], v7, s[8:11], s71 offen sc1
    s_add_u32 s71, s71, 32768
    buffer_load_dwordx4 v[44:47], v7, s[8:11], s71 offen sc1
    s_add_u32 s71, s71, 32768
    buffer_load_dwordx4 v[48:51], v7, s[8:11], s71 offen sc1
    s_add_u32 s71, s71, 32768
    buffer_load_dwordx4 v[52:55], v7, s[8:11], s71 offen sc1
    s_add_u32 s71, s71, 32768
    buffer_load_dwordx4 v[56:59], v7, s[8:11], s71 offen sc1
    s_add_u32 s71, s71, 32768
    s_waitcnt vmcnt(7)
    v_lshlrev_b32 v12, 16, v8
    v_and_b32 v13, 0xffff0000, v8
    v_lshlrev_b32 v16, 16, v10
    v_and_b32 v17, 0xffff0000, v10
    v_lshlrev_b32 v14, 16, v9
    v_and_b32 v15, 0xffff0000, v9
    v_lshlrev_b32 v18, 16, v11
    v_and_b32 v19, 0xffff0000, v11
    s_waitcnt vmcnt(0)
    v_pk_add_f32 v[32:33], v[32:33], v[36:37]
    v_pk_add_f32 v[34:35], v[34:35], v[38:39]
    v_pk_add_f32 v[32:33], v[32:33], v[40:41]
    v_pk_add_f32 v[34:35], v[34:35], v[42:43]
    v_pk_add_f32 v[32:33], v[32:33], v[44:45]
    v_pk_add_f32 v[34:35], v[34:35], v[46:47]
    v_pk_add_f32 v[32:33], v[32:33], v[48:49]
    v_pk_add_f32 v[34:35], v[34:35], v[50:51]
    v_pk_add_f32 v[32:33], v[32:33], v[52:53]
    v_pk_add_f32 v[34:35], v[34:35], v[54:55]
    v_pk_add_f32 v[32:33], v[32:33], v[56:57]
    v_pk_add_f32 v[34:35], v[34:35], v[58:59]
    s_nop 0
    v_add_f32_dpp v32, v32, v32 row_ror:8 row_mask:0xf bank_mask:0xf
    v_add_f32_dpp v33, v33, v33 row_ror:8 row_mask:0xf bank_mask:0xf
    v_add_f32_dpp v34, v34, v34 row_ror:8 row_mask:0xf bank_mask:0xf
    v_add_f32_dpp v35, v35, v35 row_ror:8 row_mask:0xf bank_mask:0xf
    v_mov_b32 v24, v32
    s_nop 1
    v_permlane32_swap_b32 v24, v32
    v_add_f32 v32, v24, v32
    v_mov_b32 v24, v32
    s_nop 1
    v_permlane16_swap_b32 v24, v32
    v_add_f32 v32, v24, v32
    v_mov_b32 v24, v33
    s_nop 1
    v_permlane32_swap_b32 v24, v33
    v_add_f32 v33, v24, v33
    v_mov_b32 v24, v33
    s_nop 1
    v_permlane16_swap_b32 v24, v33
    v_add_f32 v33, v24, v33
    v_mov_b32 v24, v34
    s_nop 1
    v_permlane32_swap_b32 v24, v34
    v_add_f32 v34, v24, v34
    v_mov_b32 v24, v34
    s_nop 1
    v_permlane16_swap_b32 v24, v34
    v_add_f32 v34, v24, v34
    v_mov_b32 v24, v35
    s_nop 1
    v_permlane32_swap_b32 v24, v35
    v_add_f32 v35, v24, v35
    v_mov_b32 v24, v35
    s_nop 1
    v_permlane16_swap_b32 v24, v35
    v_add_f32 v35, v24, v35
    v_cvt_pk_bf16_f32 v32, v32, v32
    v_and_b32 v32, 0xffff0000, v32
    v_mul_f32 v32, v22, v32
    v_cvt_pk_bf16_f32 v32, v32, v32
    v_and_b32 v32, 0xffff0000, v32
    v_add_f32 v32, v16, v32
    v_cvt_pk_bf16_f32 v32, v32, v32
    v_and_b32 v32, 0xffff0000, v32
    v_add_f32 v32, v12, v32
    v_cvt_pk_bf16_f32 v33, v33, v33
    v_and_b32 v33, 0xffff0000, v33
    v_mul_f32 v33, v22, v33
    v_cvt_pk_bf16_f32 v33, v33, v33
    v_and_b32 v33, 0xffff0000, v33
    v_add_f32 v33, v17, v33
    v_cvt_pk_bf16_f32 v33, v33, v33
    v_and_b32 v33, 0xffff0000, v33
    v_add_f32 v33, v13, v33
    v_cvt_pk_bf16_f32 v34, v34, v34
    v_and_b32 v34, 0xffff0000, v34
    v_mul_f32 v34, v22, v34
    v_cvt_pk_bf16_f32 v34, v34, v34
    v_and_b32 v34, 0xffff0000, v34
    v_add_f32 v34, v18, v34
    v_cvt_pk_bf16_f32 v34, v34, v34
    v_and_b32 v34, 0xffff0000, v34
    v_add_f32 v34, v14, v34
    v_cvt_pk_bf16_f32 v35, v35, v35
    v_and_b32 v35, 0xffff0000, v35
    v_mul_f32 v35, v22, v35
    v_cvt_pk_bf16_f32 v35, v35, v35
    v_and_b32 v35, 0xffff0000, v35
    v_add_f32 v35, v19, v35
    v_cvt_pk_bf16_f32 v35, v35, v35
    v_and_b32 v35, 0xffff0000, v35
    v_add_f32 v35, v15, v35
    v_cvt_pk_bf16_f32 v200, v32, v33
    v_cvt_pk_bf16_f32 v201, v34, v35
    v_mov_b32 v202, v6
    v_pk_add_f32 v[12:13], v[12:13], v[16:17]
    v_cvt_pk_bf16_f32 v204, v12, v13
    v_pk_add_f32 v[14:15], v[14:15], v[18:19]
    v_cvt_pk_bf16_f32 v205, v14, v15
    s_mov_b32 exec_lo, 0xff
    s_mov_b32 exec_hi, 0
    buffer_store_dwordx2 v[200:201], v202, s[16:19], 0 offen sc1
    s_mov_b64 exec, -1
L_ffn_same:
    s_add_u32 s75, s75, 1
    s_cmp_lt_u32 s75, 2
    s_cbranch_scc1 L_ffn_round
    s_cmp_ge_u32 s67, 8
    s_cbranch_scc1 L_exit
    s_waitcnt vmcnt(0)
L_exit:
    s_endpgm
L_code_end:
.section .rodata,"a"
.p2align 6
.amdhsa_kernel sequential_preLN__memory_aug_recurrent_mem_tr__moe_arch_mod__prompt_kernel
  .amdhsa_next_free_vgpr 512
  .amdhsa_next_free_sgpr 102
  .amdhsa_accum_offset 256
  .amdhsa_group_segment_fixed_size 0
  .amdhsa_kernarg_size 120
  .amdhsa_user_sgpr_count 2
  .amdhsa_user_sgpr_kernarg_segment_ptr 1
  .amdhsa_system_sgpr_workgroup_id_x 1
  .amdhsa_float_denorm_mode_32 3
.end_amdhsa_kernel
```
